```python
import torch

def _softmax(x, axis=-1):
    return torch.softmax(x, dim=axis)

def _gelu(x):
    return torch.nn.functional.gelu(x, approximate='tanh')

def _silu(x):
    return torch.nn.functional.silu(x)

def _sigmoid(x):
    return torch.sigmoid(x)

def _layernorm(x, axis=-1, eps=1e-05):
    m = x.mean(dim=axis, keepdim=True)
    v = x.var(dim=axis, keepdim=True, unbiased=False)
    return (x - m) / torch.sqrt(v + eps)

def _scatter_add(tgt, idx, src, axis=0):
    return tgt.clone().index_add_(axis, idx, src)

def _segment_sum(src, seg, n):
    out = torch.zeros((n,) + src.shape[1:], dtype=src.dtype)
    return out.index_add_(0, seg, src)

def _pad(x, pw):
    flat = tuple((v for pair in reversed(pw) for v in pair))
    return torch.nn.functional.pad(x, flat)
kernel_name = 'gated_mix__ssm_conv_h3__memory_aug_recurrent_mem_tr__prompt'

def setup_inputs():

    _w = lambda a: (lambda t: t.to(torch.bfloat16) if t.is_floating_point() else t)(torch.as_tensor(a))

    def _A_setup():
        B, S, D = (1, 2048, 1024)
        ks = 4
        return {'q': _w((lambda *s: torch.randn(*s, dtype=torch.bfloat16) * 0.05)(B, S, D)), 'k': _w((lambda *s: torch.randn(*s, dtype=torch.bfloat16) * 0.4)(B, S, D)), 'v': _w((lambda *s: torch.randn(*s, dtype=torch.bfloat16) * 0.4)(B, S, D)), 'shift_k': _w((lambda *s: torch.randn(*s, dtype=torch.bfloat16) * 0.4)(D, ks) * 0.5), 'ssm_k': _w((lambda *s: torch.randn(*s, dtype=torch.bfloat16) * 0.4)(D, S) * (1.0 / S ** 0.5)), 'ssm_D': _w((lambda *s: torch.randn(*s, dtype=torch.bfloat16) * 0.4)(D))}
    _A_in = _A_setup()

    def _B_setup():
        B, S, Dm = (1, 2048, 1024)
        H, Dh = (32, 128)
        M, seg = (8, 32)
        seg = min(seg, S)
        S = S // seg * seg
        return {'x': _w((lambda *s: torch.randn(*s, dtype=torch.bfloat16) * 0.05)(B, S, Dm)), 'mem0': _w((lambda *s: torch.randn(*s, dtype=torch.bfloat16) * 0.4)(B, M, Dm)), 'Wq': _w((lambda *s: torch.randn(*s, dtype=torch.bfloat16) * 6.4)(Dm, H, Dh) * Dm ** (-0.5)), 'Wk': _w((lambda *s: torch.randn(*s, dtype=torch.bfloat16) * 6.4)(Dm, H, Dh) * Dm ** (-0.5)), 'Wv': _w((lambda *s: torch.randn(*s, dtype=torch.bfloat16) * 0.4)(Dm, H, Dh) * Dm ** (-0.5)), 'Wo': _w((lambda *s: torch.randn(*s, dtype=torch.bfloat16) * 0.4)(H, Dh, Dm) * (H * Dh) ** (-0.5)), 'seg_len': seg}
    _B_in = _B_setup()
    return {'A_q': _A_in['q'], 'A_k': _A_in['k'], 'A_v': _A_in['v'], 'A_shift_k': _A_in['shift_k'], 'A_ssm_k': _A_in['ssm_k'], 'A_ssm_D': _A_in['ssm_D'], 'B_x': _B_in['x'], 'B_mem0': _B_in['mem0'], 'B_Wq': _B_in['Wq'], 'B_Wk': _B_in['Wk'], 'B_Wv': _B_in['Wv'], 'B_Wo': _B_in['Wo'], 'B_seg_len': _B_in['seg_len'], 'gate_w': _w((lambda *s: torch.randn(*s, dtype=torch.bfloat16) * 0.05)(1024) * 16.0)}

def reference(A_q, A_k, A_v, A_shift_k, A_ssm_k, A_ssm_D, B_x, B_mem0, B_Wq, B_Wk, B_Wv, B_Wo, B_seg_len, gate_w):

    def _A_ref(q, k, v, shift_k, ssm_k, ssm_D):
        B, S, D = q.shape
        ks = shift_k.shape[-1]
        k_pad = _pad(k, ((0, 0), (ks - 1, 0), (0, 0)))
        k_shift = torch.zeros_like(k)
        for t in range(ks):
            k_shift = k_shift + k_pad[:, t:t + S, :] * shift_k[:, ks - 1 - t][None, None, :]
        kv = k_shift * v
        L = 2 * S
        kv_pad = _pad(kv, ((0, 0), (0, S), (0, 0)))
        kf_pad = _pad(ssm_k, ((0, 0), (0, S)))
        kv_f = (lambda x, axes=(-2, -1): torch.fft.rfft2(x.float(), dim=axes))(kv_pad[:, None, :, :], axes=(1, 2))
        kf_f = (lambda x, axes=(-2, -1): torch.fft.rfft2(x.float(), dim=axes))(kf_pad[:, None, :], axes=(1, 2))
        kf_f = (lambda x, *d: x.permute(*d))(kf_f, 1, 2, 0)
        y_f = kv_f * kf_f[None, :, :, :]
        y = (lambda x, s, axes=(-2, -1): torch.fft.irfft2(x, s=s, dim=axes).to(torch.bfloat16))(y_f, (1, L), axes=(1, 2))[:, 0, :S, :]
        y = y + kv * ssm_D[None, None, :]
        return q * y

    def _B_ref(x, mem0, Wq, Wk, Wv, Wo, seg_len):
        B, S, Dm = x.shape
        H, Dh = (Wq.shape[1], Wq.shape[2])
        M = mem0.shape[1]
        scale = Dh ** (-0.5)
        n_seg = S // seg_len
        L = M + seg_len
        idx = torch.arange(L)
        mask = (idx[:, None] < M) | (idx[:, None] >= idx[None, :])
        mem = mem0
        outs = []
        for s in range(n_seg):
            xs = x[:, s * seg_len:(s + 1) * seg_len, :].clone()
            h = torch.concatenate([mem, xs], axis=1)
            q = torch.einsum('btd,dhe->bhte', h, Wq)
            k = torch.einsum('btd,dhe->bhte', h, Wk)
            v = torch.einsum('btd,dhe->bhte', h, Wv)
            scores = torch.einsum('bhqe,bhke->bhqk', q, k) * scale
            scores = torch.where(mask[None, None], scores, -1000000000.0)
            p = _softmax(scores, axis=-1)
            o = torch.einsum('bhqk,bhke->bhqe', p, v)
            o = torch.einsum('bhte,hed->btd', o, Wo)
            mem = o[:, :M, :].clone()
            outs.append(o[:, M:, :])
        return torch.concatenate(outs, axis=1)
    x = A_q
    g = _sigmoid((x * gate_w).sum(-1, keepdims=True))
    a = _A_ref(x, A_k, A_v, A_shift_k, A_ssm_k, A_ssm_D)
    b = _B_ref(x, B_mem0, B_Wq, B_Wk, B_Wv, B_Wo, B_seg_len)
    return g * a + (1 - g) * b
```

```asm
; @launch kernel=mega_kernel grid=(256,1,1) block=(256,1,1) lds=163840
.amdgcn_target "amdgcn-amd-amdhsa--gfx950"
.text
.globl mega_kernel
.p2align 8
.type mega_kernel,@function
mega_kernel:
    s_cmp_ge_u32 s2, 256
    s_cbranch_scc1 .mg_end_1
    s_load_dwordx4 s[52:55], s[0:1], 120
    s_getreg_b32 s3, hwreg(HW_REG_XCC_ID)
    v_and_b32 v1, 63, v0
    v_lshrrev_b32 v4, 6, v0
    s_and_b32 s3, s3, 7
    v_readfirstlane_b32 s24, v4
    s_waitcnt lgkmcnt(0)

    s_mov_b32 s8, s54
    s_and_b32 s9, s55, 0xffff
    s_mov_b32 s10, 0x10000000
    s_mov_b32 s11, 0x00020000

    s_mov_b32 s20, s52
    s_and_b32 s21, s53, 0xffff
    s_mov_b32 s22, 0x100
    s_mov_b32 s23, 0x00020000

    s_mov_b32 s100, s54
    s_cmp_lg_u32 s24, 0
    s_cbranch_scc1 .noat_4
    s_mov_b64 exec, 1
    v_mov_b32 v5, 1
    s_lshl_b32 s4, s3, 2
    v_mov_b32 v6, s4
    buffer_atomic_add v5, v6, s[20:23], 0 offen sc0 sc1
    v_mov_b32 v7, 163776
    s_waitcnt vmcnt(0)
    ds_write_b32 v7, v5
    s_waitcnt lgkmcnt(0)
    s_mov_b64 exec, -1

.noat_4:
    s_barrier
    v_mov_b32 v7, 163776
    ds_read_b32 v5, v7
    s_waitcnt lgkmcnt(0)
    v_readfirstlane_b32 s26, v5
    s_mov_b32 s25, s3
    s_mov_b32 s27, 0
    s_mov_b32 s97, 0
    s_and_b32 s26, s26, 31

.mg_role_3:
    s_cmp_ge_u32 s25, 4
    s_cbranch_scc1 .mg_bg_2

    s_load_dwordx8 s[44:51], s[0:1], 64
    v_and_b32 v1, 63, v0
    v_and_b32 v2, 15, v1
    v_lshrrev_b32 v3, 4, v1
    s_waitcnt lgkmcnt(0)

    s_lshl_b32 s4, s25, 11
    s_lshl_b32 s5, s26, 6
    s_add_u32 s4, s4, s5
    s_lshl_b32 s5, s24, 21
    s_add_u32 s4, s4, s5
    v_lshrrev_b32 v4, 2, v1
    v_and_b32 v5, 3, v1
    v_lshlrev_b32 v5, 4, v5
    v_lshlrev_b32 v6, 13, v4
    v_add_u32 v6, v6, v5
    v_add_u32 v240, s4, v6
    s_lshl_b32 s4, s25, 2
    s_and_b32 s5, s24, 1
    s_lshl_b32 s5, s5, 1
    s_add_u32 s4, s4, s5
    s_lshr_b32 s5, s24, 1
    s_add_u32 s4, s4, s5
    s_lshl_b32 s4, s4, 19
    s_lshl_b32 s5, s26, 6
    s_add_u32 s4, s4, s5
    v_lshlrev_b32 v6, 11, v4
    v_add_u32 v6, v6, v5
    v_add_u32 v241, s4, v6
    s_lshl_b32 s6, s24, 15
    v_bfe_u32 v4, v2, 2, 1
    v_lshrrev_b32 v5, 3, v2
    v_lshrrev_b32 v8, 1, v3
    v_and_b32 v9, 1, v3
    v_lshl_add_u32 v6, v5, 3, v4
    v_lshl_add_u32 v6, v8, 4, v6
    v_lshl_add_u32 v6, v9, 2, v6
    v_lshl_add_u32 v7, v5, 2, v4
    v_lshl_add_u32 v7, v8, 3, v7
    v_lshl_add_u32 v7, v9, 4, v7
    v_and_b32 v5, 3, v2
    v_lshlrev_b32 v5, 3, v5
    v_lshl_add_u32 v6, v6, 6, v5
    v_lshl_add_u32 v7, v7, 6, v5
    v_add_u32 v6, s6, v6
    v_add_u32 v7, s6, v7
    v_sub_u32 v252, v6, v5
    v_and_b32 v5, 1, v2
    v_lshl_add_u32 v252, v5, 5, v252
    v_bfe_u32 v5, v2, 1, 1
    v_lshl_add_u32 v252, v5, 3, v252

    s_mov_b32 s16, s44
    s_and_b32 s17, s45, 0xffff
    s_mov_b32 s18, 0x800000
    s_mov_b32 s19, 0x00020000

    s_add_u32 m0, s6, 0
    s_mov_b32 s5, 0
    buffer_load_dwordx4 v240, s[16:19], s5 offen lds

    s_add_u32 m0, s6, 1024
    s_mov_b32 s5, 131072
    buffer_load_dwordx4 v240, s[16:19], s5 offen lds

    s_add_u32 m0, s6, 2048
    s_mov_b32 s5, 262144
    buffer_load_dwordx4 v240, s[16:19], s5 offen lds

    s_add_u32 m0, s6, 3072
    s_mov_b32 s5, 393216
    buffer_load_dwordx4 v240, s[16:19], s5 offen lds

    s_add_u32 m0, s6, 4096
    s_mov_b32 s5, 524288
    buffer_load_dwordx4 v240, s[16:19], s5 offen lds

    s_add_u32 m0, s6, 5120
    s_mov_b32 s5, 655360
    buffer_load_dwordx4 v240, s[16:19], s5 offen lds

    s_add_u32 m0, s6, 6144
    s_mov_b32 s5, 786432
    buffer_load_dwordx4 v240, s[16:19], s5 offen lds

    s_add_u32 m0, s6, 7168
    s_mov_b32 s5, 917504
    buffer_load_dwordx4 v240, s[16:19], s5 offen lds

    s_add_u32 m0, s6, 8192
    s_mov_b32 s5, 1048576
    buffer_load_dwordx4 v240, s[16:19], s5 offen lds

    s_add_u32 m0, s6, 9216
    s_mov_b32 s5, 1179648
    buffer_load_dwordx4 v240, s[16:19], s5 offen lds

    s_add_u32 m0, s6, 10240
    s_mov_b32 s5, 1310720
    buffer_load_dwordx4 v240, s[16:19], s5 offen lds

    s_add_u32 m0, s6, 11264
    s_mov_b32 s5, 1441792
    buffer_load_dwordx4 v240, s[16:19], s5 offen lds

    s_add_u32 m0, s6, 12288
    s_mov_b32 s5, 1572864
    buffer_load_dwordx4 v240, s[16:19], s5 offen lds

    s_add_u32 m0, s6, 13312
    s_mov_b32 s5, 1703936
    buffer_load_dwordx4 v240, s[16:19], s5 offen lds

    s_add_u32 m0, s6, 14336
    s_mov_b32 s5, 1835008
    buffer_load_dwordx4 v240, s[16:19], s5 offen lds

    s_add_u32 m0, s6, 15360
    s_mov_b32 s5, 1966080
    buffer_load_dwordx4 v240, s[16:19], s5 offen lds

    s_mov_b32 s16, s46
    s_and_b32 s17, s47, 0xffff
    s_mov_b32 s18, 0x800000
    s_mov_b32 s19, 0x00020000

    s_add_u32 m0, s6, 16384
    s_mov_b32 s5, 0
    buffer_load_dwordx4 v240, s[16:19], s5 offen lds

    s_add_u32 m0, s6, 17408
    s_mov_b32 s5, 131072
    buffer_load_dwordx4 v240, s[16:19], s5 offen lds

    s_add_u32 m0, s6, 18432
    s_mov_b32 s5, 262144
    buffer_load_dwordx4 v240, s[16:19], s5 offen lds

    s_add_u32 m0, s6, 19456
    s_mov_b32 s5, 393216
    buffer_load_dwordx4 v240, s[16:19], s5 offen lds

    s_add_u32 m0, s6, 20480
    s_mov_b32 s5, 524288
    buffer_load_dwordx4 v240, s[16:19], s5 offen lds

    s_add_u32 m0, s6, 21504
    s_mov_b32 s5, 655360
    buffer_load_dwordx4 v240, s[16:19], s5 offen lds

    s_add_u32 m0, s6, 22528
    s_mov_b32 s5, 786432
    buffer_load_dwordx4 v240, s[16:19], s5 offen lds

    s_add_u32 m0, s6, 23552
    s_mov_b32 s5, 917504
    buffer_load_dwordx4 v240, s[16:19], s5 offen lds

    s_add_u32 m0, s6, 24576
    s_mov_b32 s5, 1048576
    buffer_load_dwordx4 v240, s[16:19], s5 offen lds

    s_add_u32 m0, s6, 25600
    s_mov_b32 s5, 1179648
    buffer_load_dwordx4 v240, s[16:19], s5 offen lds

    s_add_u32 m0, s6, 26624
    s_mov_b32 s5, 1310720
    buffer_load_dwordx4 v240, s[16:19], s5 offen lds

    s_add_u32 m0, s6, 27648
    s_mov_b32 s5, 1441792
    buffer_load_dwordx4 v240, s[16:19], s5 offen lds

    s_add_u32 m0, s6, 28672
    s_mov_b32 s5, 1572864
    buffer_load_dwordx4 v240, s[16:19], s5 offen lds

    s_add_u32 m0, s6, 29696
    s_mov_b32 s5, 1703936
    buffer_load_dwordx4 v240, s[16:19], s5 offen lds

    s_add_u32 m0, s6, 30720
    s_mov_b32 s5, 1835008
    buffer_load_dwordx4 v240, s[16:19], s5 offen lds

    s_add_u32 m0, s6, 31744
    s_mov_b32 s5, 1966080
    buffer_load_dwordx4 v240, s[16:19], s5 offen lds

    s_cmp_lg_u32 s97, 0
    s_cbranch_scc1 .vd_7
    v_and_b32 v243, 7, v0
    v_lshlrev_b32 v243, 2, v243
    s_mov_b32 s62, 0

.vp_6:
    buffer_load_dword v242, v243, s[20:23], 0 offen sc1
    s_waitcnt vmcnt(0)
    v_readlane_b32 s64, v242, 0
    v_readlane_b32 s65, v242, 1
    v_readlane_b32 s66, v242, 2
    v_readlane_b32 s67, v242, 3
    v_readlane_b32 s68, v242, 4
    v_readlane_b32 s69, v242, 5
    v_readlane_b32 s70, v242, 6
    v_readlane_b32 s71, v242, 7
    v_cmp_ne_u32 vcc, 32, v242
    s_add_u32 s4, s64, s65
    s_add_u32 s5, s66, s67
    s_add_u32 s72, s68, s69
    s_add_u32 s73, s70, s71
    s_add_u32 s4, s4, s5
    s_add_u32 s72, s72, s73
    s_add_u32 s4, s4, s72
    s_cmp_eq_u64 vcc, 0
    s_cbranch_scc1 .vd_7
    s_cmp_ge_u32 s4, 256
    s_cbranch_scc1 .vs_8
    s_add_u32 s62, s62, 1
    s_cmp_gt_u32 s62, 0x100000
    s_cbranch_scc1 .mg_end_1
    s_branch .vp_6

.vs_8:
    s_lshr_b32 s25, s2, 5
    s_and_b32 s26, s2, 31
    s_mov_b32 s27, 1
    s_mov_b32 s97, 1
    s_waitcnt vmcnt(0) lgkmcnt(0)
    s_barrier
    s_branch .mg_role_3

.vd_7:
    s_mov_b32 s97, 1
    s_sub_u32 s101, 0, s100
    s_and_b32 s101, s101, 0x1fffff
    s_add_u32 s101, s101, 100663296

    s_lshl_b32 s4, s25, 5
    s_add_u32 s4, s4, s26
    s_lshl_b32 s5, s24, 8
    s_add_u32 s4, s4, s5
    s_sub_u32 s4, s4, 0x300
    s_cmp_ge_u32 s4, 2
    s_cbranch_scc1 .nopol_9
    s_waitcnt vmcnt(0)
    v_lshlrev_b32 v4, 2, v1
    s_lshl_b32 s5, s26, 21
    s_add_u32 s5, s5, s101
    s_mov_b32 s82, 0x7fffffff
    s_mov_b32 s83, 0x7fffffff

    s_add_u32 s7, s5, 0
    s_memtime s[72:73]
    s_waitcnt lgkmcnt(0)
    buffer_store_dword v4, v4, s[8:11], s7 offen sc1
    s_waitcnt vmcnt(0)
    s_memtime s[84:85]
    s_waitcnt lgkmcnt(0)
    s_sub_u32 s84, s84, s72
    s_min_u32 s82, s82, s84

    s_add_u32 s7, s5, 8192
    s_memtime s[72:73]
    s_waitcnt lgkmcnt(0)
    buffer_store_dword v4, v4, s[8:11], s7 offen sc1
    s_waitcnt vmcnt(0)
    s_memtime s[84:85]
    s_waitcnt lgkmcnt(0)
    s_sub_u32 s84, s84, s72
    s_min_u32 s83, s83, s84

    s_add_u32 s7, s5, 256
    s_memtime s[72:73]
    s_waitcnt lgkmcnt(0)
    buffer_store_dword v4, v4, s[8:11], s7 offen sc1
    s_waitcnt vmcnt(0)
    s_memtime s[84:85]
    s_waitcnt lgkmcnt(0)
    s_sub_u32 s84, s84, s72
    s_min_u32 s82, s82, s84

    s_add_u32 s7, s5, 8448
    s_memtime s[72:73]
    s_waitcnt lgkmcnt(0)
    buffer_store_dword v4, v4, s[8:11], s7 offen sc1
    s_waitcnt vmcnt(0)
    s_memtime s[84:85]
    s_waitcnt lgkmcnt(0)
    s_sub_u32 s84, s84, s72
    s_min_u32 s83, s83, s84

    s_add_u32 s7, s5, 512
    s_memtime s[72:73]
    s_waitcnt lgkmcnt(0)
    buffer_store_dword v4, v4, s[8:11], s7 offen sc1
    s_waitcnt vmcnt(0)
    s_memtime s[84:85]
    s_waitcnt lgkmcnt(0)
    s_sub_u32 s84, s84, s72
    s_min_u32 s82, s82, s84

    s_add_u32 s7, s5, 8704
    s_memtime s[72:73]
    s_waitcnt lgkmcnt(0)
    buffer_store_dword v4, v4, s[8:11], s7 offen sc1
    s_waitcnt vmcnt(0)
    s_memtime s[84:85]
    s_waitcnt lgkmcnt(0)
    s_sub_u32 s84, s84, s72
    s_min_u32 s83, s83, s84

    s_add_u32 s7, s5, 768
    s_memtime s[72:73]
    s_waitcnt lgkmcnt(0)
    buffer_store_dword v4, v4, s[8:11], s7 offen sc1
    s_waitcnt vmcnt(0)
    s_memtime s[84:85]
    s_waitcnt lgkmcnt(0)
    s_sub_u32 s84, s84, s72
    s_min_u32 s82, s82, s84

    s_add_u32 s7, s5, 8960
    s_memtime s[72:73]
    s_waitcnt lgkmcnt(0)
    buffer_store_dword v4, v4, s[8:11], s7 offen sc1
    s_waitcnt vmcnt(0)
    s_memtime s[84:85]
    s_waitcnt lgkmcnt(0)
    s_sub_u32 s84, s84, s72
    s_min_u32 s83, s83, s84

    s_cmp_lt_u32 s82, s83
    s_cselect_b32 s4, 0, 1
    s_lshl_b32 s4, s4, s26
    s_add_u32 s4, s4, 0x100
    v_mov_b32 v4, s4
    v_mov_b32 v5, 0
    s_mov_b32 s5, 36
    s_mov_b64 exec, 1
    buffer_atomic_add v4, v5, s[20:23], s5 offen sc1
    s_mov_b64 exec, -1

.nopol_9:
    s_waitcnt vmcnt(0)
    ds_read_b64_tr_b16 v[20:21], v252 offset:0
    ds_read_b64_tr_b16 v[22:23], v252 offset:128
    ds_read_b64_tr_b16 v[24:25], v252 offset:2048
    ds_read_b64_tr_b16 v[26:27], v252 offset:2176
    ds_read_b64_tr_b16 v[28:29], v252 offset:4096
    ds_read_b64_tr_b16 v[30:31], v252 offset:4224
    ds_read_b64_tr_b16 v[32:33], v252 offset:6144
    ds_read_b64_tr_b16 v[34:35], v252 offset:6272
    ds_read_b64_tr_b16 v[36:37], v252 offset:8192
    ds_read_b64_tr_b16 v[38:39], v252 offset:8320
    ds_read_b64_tr_b16 v[40:41], v252 offset:10240
    ds_read_b64_tr_b16 v[42:43], v252 offset:10368
    ds_read_b64_tr_b16 v[44:45], v252 offset:12288
    ds_read_b64_tr_b16 v[46:47], v252 offset:12416
    ds_read_b64_tr_b16 v[48:49], v252 offset:14336
    ds_read_b64_tr_b16 v[50:51], v252 offset:14464
    ds_read_b64_tr_b16 v[52:53], v252 offset:16
    ds_read_b64_tr_b16 v[54:55], v252 offset:144
    ds_read_b64_tr_b16 v[56:57], v252 offset:2064
    ds_read_b64_tr_b16 v[58:59], v252 offset:2192
    ds_read_b64_tr_b16 v[60:61], v252 offset:4112
    ds_read_b64_tr_b16 v[62:63], v252 offset:4240
    ds_read_b64_tr_b16 v[64:65], v252 offset:6160
    ds_read_b64_tr_b16 v[66:67], v252 offset:6288
    ds_read_b64_tr_b16 v[68:69], v252 offset:8208
    ds_read_b64_tr_b16 v[70:71], v252 offset:8336
    ds_read_b64_tr_b16 v[72:73], v252 offset:10256
    ds_read_b64_tr_b16 v[74:75], v252 offset:10384
    ds_read_b64_tr_b16 v[76:77], v252 offset:12304
    ds_read_b64_tr_b16 v[78:79], v252 offset:12432
    ds_read_b64_tr_b16 v[80:81], v252 offset:14352
    ds_read_b64_tr_b16 v[82:83], v252 offset:14480
    ds_read_b64_tr_b16 v[84:85], v252 offset:16384
    ds_read_b64_tr_b16 v[86:87], v252 offset:16512
    ds_read_b64_tr_b16 v[88:89], v252 offset:18432
    ds_read_b64_tr_b16 v[90:91], v252 offset:18560
    ds_read_b64_tr_b16 v[92:93], v252 offset:20480
    ds_read_b64_tr_b16 v[94:95], v252 offset:20608
    ds_read_b64_tr_b16 v[96:97], v252 offset:22528
    ds_read_b64_tr_b16 v[98:99], v252 offset:22656
    ds_read_b64_tr_b16 v[100:101], v252 offset:24576
    ds_read_b64_tr_b16 v[102:103], v252 offset:24704
    ds_read_b64_tr_b16 v[104:105], v252 offset:26624
    ds_read_b64_tr_b16 v[106:107], v252 offset:26752
    ds_read_b64_tr_b16 v[108:109], v252 offset:28672
    ds_read_b64_tr_b16 v[110:111], v252 offset:28800
    ds_read_b64_tr_b16 v[112:113], v252 offset:30720
    ds_read_b64_tr_b16 v[114:115], v252 offset:30848
    ds_read_b64_tr_b16 v[116:117], v252 offset:16400
    ds_read_b64_tr_b16 v[118:119], v252 offset:16528
    ds_read_b64_tr_b16 v[120:121], v252 offset:18448
    ds_read_b64_tr_b16 v[122:123], v252 offset:18576
    ds_read_b64_tr_b16 v[124:125], v252 offset:20496
    ds_read_b64_tr_b16 v[126:127], v252 offset:20624
    ds_read_b64_tr_b16 v[128:129], v252 offset:22544
    ds_read_b64_tr_b16 v[130:131], v252 offset:22672
    ds_read_b64_tr_b16 v[132:133], v252 offset:24592
    ds_read_b64_tr_b16 v[134:135], v252 offset:24720
    ds_read_b64_tr_b16 v[136:137], v252 offset:26640
    ds_read_b64_tr_b16 v[138:139], v252 offset:26768
    ds_read_b64_tr_b16 v[140:141], v252 offset:28688
    ds_read_b64_tr_b16 v[142:143], v252 offset:28816
    ds_read_b64_tr_b16 v[144:145], v252 offset:30736
    ds_read_b64_tr_b16 v[146:147], v252 offset:30864
    s_waitcnt lgkmcnt(0)
    s_mov_b32 s16, s48
    s_and_b32 s17, s49, 0xffff
    s_mov_b32 s18, 0x800000
    s_mov_b32 s19, 0x00020000

    s_add_u32 m0, s6, 0
    s_mov_b32 s5, 0
    buffer_load_dwordx4 v240, s[16:19], s5 offen lds

    s_add_u32 m0, s6, 1024
    s_mov_b32 s5, 131072
    buffer_load_dwordx4 v240, s[16:19], s5 offen lds

    s_add_u32 m0, s6, 2048
    s_mov_b32 s5, 262144
    buffer_load_dwordx4 v240, s[16:19], s5 offen lds

    s_add_u32 m0, s6, 3072
    s_mov_b32 s5, 393216
    buffer_load_dwordx4 v240, s[16:19], s5 offen lds

    s_add_u32 m0, s6, 4096
    s_mov_b32 s5, 524288
    buffer_load_dwordx4 v240, s[16:19], s5 offen lds

    s_add_u32 m0, s6, 5120
    s_mov_b32 s5, 655360
    buffer_load_dwordx4 v240, s[16:19], s5 offen lds

    s_add_u32 m0, s6, 6144
    s_mov_b32 s5, 786432
    buffer_load_dwordx4 v240, s[16:19], s5 offen lds

    s_add_u32 m0, s6, 7168
    s_mov_b32 s5, 917504
    buffer_load_dwordx4 v240, s[16:19], s5 offen lds

    s_add_u32 m0, s6, 8192
    s_mov_b32 s5, 1048576
    buffer_load_dwordx4 v240, s[16:19], s5 offen lds

    s_add_u32 m0, s6, 9216
    s_mov_b32 s5, 1179648
    buffer_load_dwordx4 v240, s[16:19], s5 offen lds

    s_add_u32 m0, s6, 10240
    s_mov_b32 s5, 1310720
    buffer_load_dwordx4 v240, s[16:19], s5 offen lds

    s_add_u32 m0, s6, 11264
    s_mov_b32 s5, 1441792
    buffer_load_dwordx4 v240, s[16:19], s5 offen lds

    s_add_u32 m0, s6, 12288
    s_mov_b32 s5, 1572864
    buffer_load_dwordx4 v240, s[16:19], s5 offen lds

    s_add_u32 m0, s6, 13312
    s_mov_b32 s5, 1703936
    buffer_load_dwordx4 v240, s[16:19], s5 offen lds

    s_add_u32 m0, s6, 14336
    s_mov_b32 s5, 1835008
    buffer_load_dwordx4 v240, s[16:19], s5 offen lds

    s_add_u32 m0, s6, 15360
    s_mov_b32 s5, 1966080
    buffer_load_dwordx4 v240, s[16:19], s5 offen lds

    s_mov_b32 s16, s50
    s_and_b32 s17, s51, 0xffff
    s_mov_b32 s18, 0x800000
    s_mov_b32 s19, 0x00020000

    s_add_u32 m0, s6, 16384
    s_mov_b32 s5, 0
    buffer_load_dwordx4 v241, s[16:19], s5 offen lds

    s_add_u32 m0, s6, 17408
    s_mov_b32 s5, 32768
    buffer_load_dwordx4 v241, s[16:19], s5 offen lds

    s_add_u32 m0, s6, 18432
    s_mov_b32 s5, 65536
    buffer_load_dwordx4 v241, s[16:19], s5 offen lds

    s_add_u32 m0, s6, 19456
    s_mov_b32 s5, 98304
    buffer_load_dwordx4 v241, s[16:19], s5 offen lds

    s_add_u32 m0, s6, 20480
    s_mov_b32 s5, 131072
    buffer_load_dwordx4 v241, s[16:19], s5 offen lds

    s_add_u32 m0, s6, 21504
    s_mov_b32 s5, 163840
    buffer_load_dwordx4 v241, s[16:19], s5 offen lds

    s_add_u32 m0, s6, 22528
    s_mov_b32 s5, 196608
    buffer_load_dwordx4 v241, s[16:19], s5 offen lds

    s_add_u32 m0, s6, 23552
    s_mov_b32 s5, 229376
    buffer_load_dwordx4 v241, s[16:19], s5 offen lds

    s_add_u32 m0, s6, 24576
    s_mov_b32 s5, 262144
    buffer_load_dwordx4 v241, s[16:19], s5 offen lds

    s_add_u32 m0, s6, 25600
    s_mov_b32 s5, 294912
    buffer_load_dwordx4 v241, s[16:19], s5 offen lds

    s_add_u32 m0, s6, 26624
    s_mov_b32 s5, 327680
    buffer_load_dwordx4 v241, s[16:19], s5 offen lds

    s_add_u32 m0, s6, 27648
    s_mov_b32 s5, 360448
    buffer_load_dwordx4 v241, s[16:19], s5 offen lds

    s_add_u32 m0, s6, 28672
    s_mov_b32 s5, 393216
    buffer_load_dwordx4 v241, s[16:19], s5 offen lds

    s_add_u32 m0, s6, 29696
    s_mov_b32 s5, 425984
    buffer_load_dwordx4 v241, s[16:19], s5 offen lds

    s_add_u32 m0, s6, 30720
    s_mov_b32 s5, 458752
    buffer_load_dwordx4 v241, s[16:19], s5 offen lds

    s_add_u32 m0, s6, 31744
    s_mov_b32 s5, 491520
    buffer_load_dwordx4 v241, s[16:19], s5 offen lds

    v_accvgpr_write_b32 a0, v20
    v_accvgpr_write_b32 a1, v21
    v_accvgpr_write_b32 a2, v22
    v_accvgpr_write_b32 a3, v23
    v_accvgpr_write_b32 a4, v24
    v_accvgpr_write_b32 a5, v25
    v_accvgpr_write_b32 a6, v26
    v_accvgpr_write_b32 a7, v27
    v_accvgpr_write_b32 a8, v28
    v_accvgpr_write_b32 a9, v29
    v_accvgpr_write_b32 a10, v30
    v_accvgpr_write_b32 a11, v31
    v_accvgpr_write_b32 a12, v32
    v_accvgpr_write_b32 a13, v33
    v_accvgpr_write_b32 a14, v34
    v_accvgpr_write_b32 a15, v35
    v_accvgpr_write_b32 a16, v36
    v_accvgpr_write_b32 a17, v37
    v_accvgpr_write_b32 a18, v38
    v_accvgpr_write_b32 a19, v39
    v_accvgpr_write_b32 a20, v40
    v_accvgpr_write_b32 a21, v41
    v_accvgpr_write_b32 a22, v42
    v_accvgpr_write_b32 a23, v43
    v_accvgpr_write_b32 a24, v44
    v_accvgpr_write_b32 a25, v45
    v_accvgpr_write_b32 a26, v46
    v_accvgpr_write_b32 a27, v47
    v_accvgpr_write_b32 a28, v48
    v_accvgpr_write_b32 a29, v49
    v_accvgpr_write_b32 a30, v50
    v_accvgpr_write_b32 a31, v51
    v_accvgpr_write_b32 a32, v52
    v_accvgpr_write_b32 a33, v53
    v_accvgpr_write_b32 a34, v54
    v_accvgpr_write_b32 a35, v55
    v_accvgpr_write_b32 a36, v56
    v_accvgpr_write_b32 a37, v57
    v_accvgpr_write_b32 a38, v58
    v_accvgpr_write_b32 a39, v59
    v_accvgpr_write_b32 a40, v60
    v_accvgpr_write_b32 a41, v61
    v_accvgpr_write_b32 a42, v62
    v_accvgpr_write_b32 a43, v63
    v_accvgpr_write_b32 a44, v64
    v_accvgpr_write_b32 a45, v65
    v_accvgpr_write_b32 a46, v66
    v_accvgpr_write_b32 a47, v67
    v_accvgpr_write_b32 a48, v68
    v_accvgpr_write_b32 a49, v69
    v_accvgpr_write_b32 a50, v70
    v_accvgpr_write_b32 a51, v71
    v_accvgpr_write_b32 a52, v72
    v_accvgpr_write_b32 a53, v73
    v_accvgpr_write_b32 a54, v74
    v_accvgpr_write_b32 a55, v75
    v_accvgpr_write_b32 a56, v76
    v_accvgpr_write_b32 a57, v77
    v_accvgpr_write_b32 a58, v78
    v_accvgpr_write_b32 a59, v79
    v_accvgpr_write_b32 a60, v80
    v_accvgpr_write_b32 a61, v81
    v_accvgpr_write_b32 a62, v82
    v_accvgpr_write_b32 a63, v83
    v_accvgpr_write_b32 a64, v84
    v_accvgpr_write_b32 a65, v85
    v_accvgpr_write_b32 a66, v86
    v_accvgpr_write_b32 a67, v87
    v_accvgpr_write_b32 a68, v88
    v_accvgpr_write_b32 a69, v89
    v_accvgpr_write_b32 a70, v90
    v_accvgpr_write_b32 a71, v91
    v_accvgpr_write_b32 a72, v92
    v_accvgpr_write_b32 a73, v93
    v_accvgpr_write_b32 a74, v94
    v_accvgpr_write_b32 a75, v95
    v_accvgpr_write_b32 a76, v96
    v_accvgpr_write_b32 a77, v97
    v_accvgpr_write_b32 a78, v98
    v_accvgpr_write_b32 a79, v99
    v_accvgpr_write_b32 a80, v100
    v_accvgpr_write_b32 a81, v101
    v_accvgpr_write_b32 a82, v102
    v_accvgpr_write_b32 a83, v103
    v_accvgpr_write_b32 a84, v104
    v_accvgpr_write_b32 a85, v105
    v_accvgpr_write_b32 a86, v106
    v_accvgpr_write_b32 a87, v107
    v_accvgpr_write_b32 a88, v108
    v_accvgpr_write_b32 a89, v109
    v_accvgpr_write_b32 a90, v110
    v_accvgpr_write_b32 a91, v111
    v_accvgpr_write_b32 a92, v112
    v_accvgpr_write_b32 a93, v113
    v_accvgpr_write_b32 a94, v114
    v_accvgpr_write_b32 a95, v115
    v_accvgpr_write_b32 a96, v116
    v_accvgpr_write_b32 a97, v117
    v_accvgpr_write_b32 a98, v118
    v_accvgpr_write_b32 a99, v119
    v_accvgpr_write_b32 a100, v120
    v_accvgpr_write_b32 a101, v121
    v_accvgpr_write_b32 a102, v122
    v_accvgpr_write_b32 a103, v123
    v_accvgpr_write_b32 a104, v124
    v_accvgpr_write_b32 a105, v125
    v_accvgpr_write_b32 a106, v126
    v_accvgpr_write_b32 a107, v127
    v_accvgpr_write_b32 a108, v128
    v_accvgpr_write_b32 a109, v129
    v_accvgpr_write_b32 a110, v130
    v_accvgpr_write_b32 a111, v131
    v_accvgpr_write_b32 a112, v132
    v_accvgpr_write_b32 a113, v133
    v_accvgpr_write_b32 a114, v134
    v_accvgpr_write_b32 a115, v135
    v_accvgpr_write_b32 a116, v136
    v_accvgpr_write_b32 a117, v137
    v_accvgpr_write_b32 a118, v138
    v_accvgpr_write_b32 a119, v139
    v_accvgpr_write_b32 a120, v140
    v_accvgpr_write_b32 a121, v141
    v_accvgpr_write_b32 a122, v142
    v_accvgpr_write_b32 a123, v143
    v_accvgpr_write_b32 a124, v144
    v_accvgpr_write_b32 a125, v145
    v_accvgpr_write_b32 a126, v146
    v_accvgpr_write_b32 a127, v147
    s_waitcnt vmcnt(0)
    ds_read_b64_tr_b16 v[20:21], v6 offset:0
    ds_read_b64_tr_b16 v[22:23], v6 offset:128
    ds_read_b64_tr_b16 v[24:25], v6 offset:2048
    ds_read_b64_tr_b16 v[26:27], v6 offset:2176
    ds_read_b64_tr_b16 v[28:29], v6 offset:4096
    ds_read_b64_tr_b16 v[30:31], v6 offset:4224
    ds_read_b64_tr_b16 v[32:33], v6 offset:6144
    ds_read_b64_tr_b16 v[34:35], v6 offset:6272
    ds_read_b64_tr_b16 v[36:37], v6 offset:8192
    ds_read_b64_tr_b16 v[38:39], v6 offset:8320
    ds_read_b64_tr_b16 v[40:41], v6 offset:10240
    ds_read_b64_tr_b16 v[42:43], v6 offset:10368
    ds_read_b64_tr_b16 v[44:45], v6 offset:12288
    ds_read_b64_tr_b16 v[46:47], v6 offset:12416
    ds_read_b64_tr_b16 v[48:49], v6 offset:14336
    ds_read_b64_tr_b16 v[50:51], v6 offset:14464
    ds_read_b64_tr_b16 v[52:53], v6 offset:32
    ds_read_b64_tr_b16 v[54:55], v6 offset:160
    ds_read_b64_tr_b16 v[56:57], v6 offset:2080
    ds_read_b64_tr_b16 v[58:59], v6 offset:2208
    ds_read_b64_tr_b16 v[60:61], v6 offset:4128
    ds_read_b64_tr_b16 v[62:63], v6 offset:4256
    ds_read_b64_tr_b16 v[64:65], v6 offset:6176
    ds_read_b64_tr_b16 v[66:67], v6 offset:6304
    ds_read_b64_tr_b16 v[68:69], v6 offset:8224
    ds_read_b64_tr_b16 v[70:71], v6 offset:8352
    ds_read_b64_tr_b16 v[72:73], v6 offset:10272
    ds_read_b64_tr_b16 v[74:75], v6 offset:10400
    ds_read_b64_tr_b16 v[76:77], v6 offset:12320
    ds_read_b64_tr_b16 v[78:79], v6 offset:12448
    ds_read_b64_tr_b16 v[80:81], v6 offset:14368
    ds_read_b64_tr_b16 v[82:83], v6 offset:14496
    ds_read_b64_tr_b16 v[84:85], v7 offset:16384
    ds_read_b64_tr_b16 v[86:87], v7 offset:16512
    ds_read_b64_tr_b16 v[88:89], v7 offset:18432
    ds_read_b64_tr_b16 v[90:91], v7 offset:18560
    ds_read_b64_tr_b16 v[92:93], v7 offset:20480
    ds_read_b64_tr_b16 v[94:95], v7 offset:20608
    ds_read_b64_tr_b16 v[96:97], v7 offset:22528
    ds_read_b64_tr_b16 v[98:99], v7 offset:22656
    ds_read_b64_tr_b16 v[100:101], v7 offset:24576
    ds_read_b64_tr_b16 v[102:103], v7 offset:24704
    ds_read_b64_tr_b16 v[104:105], v7 offset:26624
    ds_read_b64_tr_b16 v[106:107], v7 offset:26752
    ds_read_b64_tr_b16 v[108:109], v7 offset:28672
    ds_read_b64_tr_b16 v[110:111], v7 offset:28800
    ds_read_b64_tr_b16 v[112:113], v7 offset:30720
    ds_read_b64_tr_b16 v[114:115], v7 offset:30848
    ds_read_b64_tr_b16 v[116:117], v7 offset:16416
    ds_read_b64_tr_b16 v[118:119], v7 offset:16544
    ds_read_b64_tr_b16 v[120:121], v7 offset:18464
    ds_read_b64_tr_b16 v[122:123], v7 offset:18592
    ds_read_b64_tr_b16 v[124:125], v7 offset:20512
    ds_read_b64_tr_b16 v[126:127], v7 offset:20640
    ds_read_b64_tr_b16 v[128:129], v7 offset:22560
    ds_read_b64_tr_b16 v[130:131], v7 offset:22688
    ds_read_b64_tr_b16 v[132:133], v7 offset:24608
    ds_read_b64_tr_b16 v[134:135], v7 offset:24736
    ds_read_b64_tr_b16 v[136:137], v7 offset:26656
    ds_read_b64_tr_b16 v[138:139], v7 offset:26784
    ds_read_b64_tr_b16 v[140:141], v7 offset:28704
    ds_read_b64_tr_b16 v[142:143], v7 offset:28832
    ds_read_b64_tr_b16 v[144:145], v7 offset:30752
    ds_read_b64_tr_b16 v[146:147], v7 offset:30880
    s_waitcnt lgkmcnt(0)
    v_accvgpr_write_b32 a128, v20
    v_accvgpr_write_b32 a129, v21
    v_accvgpr_write_b32 a130, v22
    v_accvgpr_write_b32 a131, v23
    v_accvgpr_write_b32 a132, v24
    v_accvgpr_write_b32 a133, v25
    v_accvgpr_write_b32 a134, v26
    v_accvgpr_write_b32 a135, v27
    v_accvgpr_write_b32 a136, v28
    v_accvgpr_write_b32 a137, v29
    v_accvgpr_write_b32 a138, v30
    v_accvgpr_write_b32 a139, v31
    v_accvgpr_write_b32 a140, v32
    v_accvgpr_write_b32 a141, v33
    v_accvgpr_write_b32 a142, v34
    v_accvgpr_write_b32 a143, v35
    v_accvgpr_write_b32 a144, v36
    v_accvgpr_write_b32 a145, v37
    v_accvgpr_write_b32 a146, v38
    v_accvgpr_write_b32 a147, v39
    v_accvgpr_write_b32 a148, v40
    v_accvgpr_write_b32 a149, v41
    v_accvgpr_write_b32 a150, v42
    v_accvgpr_write_b32 a151, v43
    v_accvgpr_write_b32 a152, v44
    v_accvgpr_write_b32 a153, v45
    v_accvgpr_write_b32 a154, v46
    v_accvgpr_write_b32 a155, v47
    v_accvgpr_write_b32 a156, v48
    v_accvgpr_write_b32 a157, v49
    v_accvgpr_write_b32 a158, v50
    v_accvgpr_write_b32 a159, v51
    v_accvgpr_write_b32 a160, v52
    v_accvgpr_write_b32 a161, v53
    v_accvgpr_write_b32 a162, v54
    v_accvgpr_write_b32 a163, v55
    v_accvgpr_write_b32 a164, v56
    v_accvgpr_write_b32 a165, v57
    v_accvgpr_write_b32 a166, v58
    v_accvgpr_write_b32 a167, v59
    v_accvgpr_write_b32 a168, v60
    v_accvgpr_write_b32 a169, v61
    v_accvgpr_write_b32 a170, v62
    v_accvgpr_write_b32 a171, v63
    v_accvgpr_write_b32 a172, v64
    v_accvgpr_write_b32 a173, v65
    v_accvgpr_write_b32 a174, v66
    v_accvgpr_write_b32 a175, v67
    v_accvgpr_write_b32 a176, v68
    v_accvgpr_write_b32 a177, v69
    v_accvgpr_write_b32 a178, v70
    v_accvgpr_write_b32 a179, v71
    v_accvgpr_write_b32 a180, v72
    v_accvgpr_write_b32 a181, v73
    v_accvgpr_write_b32 a182, v74
    v_accvgpr_write_b32 a183, v75
    v_accvgpr_write_b32 a184, v76
    v_accvgpr_write_b32 a185, v77
    v_accvgpr_write_b32 a186, v78
    v_accvgpr_write_b32 a187, v79
    v_accvgpr_write_b32 a188, v80
    v_accvgpr_write_b32 a189, v81
    v_accvgpr_write_b32 a190, v82
    v_accvgpr_write_b32 a191, v83
    v_accvgpr_write_b32 a192, v84
    v_accvgpr_write_b32 a193, v85
    v_accvgpr_write_b32 a194, v86
    v_accvgpr_write_b32 a195, v87
    v_accvgpr_write_b32 a196, v88
    v_accvgpr_write_b32 a197, v89
    v_accvgpr_write_b32 a198, v90
    v_accvgpr_write_b32 a199, v91
    v_accvgpr_write_b32 a200, v92
    v_accvgpr_write_b32 a201, v93
    v_accvgpr_write_b32 a202, v94
    v_accvgpr_write_b32 a203, v95
    v_accvgpr_write_b32 a204, v96
    v_accvgpr_write_b32 a205, v97
    v_accvgpr_write_b32 a206, v98
    v_accvgpr_write_b32 a207, v99
    v_accvgpr_write_b32 a208, v100
    v_accvgpr_write_b32 a209, v101
    v_accvgpr_write_b32 a210, v102
    v_accvgpr_write_b32 a211, v103
    v_accvgpr_write_b32 a212, v104
    v_accvgpr_write_b32 a213, v105
    v_accvgpr_write_b32 a214, v106
    v_accvgpr_write_b32 a215, v107
    v_accvgpr_write_b32 a216, v108
    v_accvgpr_write_b32 a217, v109
    v_accvgpr_write_b32 a218, v110
    v_accvgpr_write_b32 a219, v111
    v_accvgpr_write_b32 a220, v112
    v_accvgpr_write_b32 a221, v113
    v_accvgpr_write_b32 a222, v114
    v_accvgpr_write_b32 a223, v115
    v_accvgpr_write_b32 a224, v116
    v_accvgpr_write_b32 a225, v117
    v_accvgpr_write_b32 a226, v118
    v_accvgpr_write_b32 a227, v119
    v_accvgpr_write_b32 a228, v120
    v_accvgpr_write_b32 a229, v121
    v_accvgpr_write_b32 a230, v122
    v_accvgpr_write_b32 a231, v123
    v_accvgpr_write_b32 a232, v124
    v_accvgpr_write_b32 a233, v125
    v_accvgpr_write_b32 a234, v126
    v_accvgpr_write_b32 a235, v127
    v_accvgpr_write_b32 a236, v128
    v_accvgpr_write_b32 a237, v129
    v_accvgpr_write_b32 a238, v130
    v_accvgpr_write_b32 a239, v131
    v_accvgpr_write_b32 a240, v132
    v_accvgpr_write_b32 a241, v133
    v_accvgpr_write_b32 a242, v134
    v_accvgpr_write_b32 a243, v135
    v_accvgpr_write_b32 a244, v136
    v_accvgpr_write_b32 a245, v137
    v_accvgpr_write_b32 a246, v138
    v_accvgpr_write_b32 a247, v139
    v_accvgpr_write_b32 a248, v140
    v_accvgpr_write_b32 a249, v141
    v_accvgpr_write_b32 a250, v142
    v_accvgpr_write_b32 a251, v143
    v_accvgpr_write_b32 a252, v144
    v_accvgpr_write_b32 a253, v145
    v_accvgpr_write_b32 a254, v146
    v_accvgpr_write_b32 a255, v147
    s_barrier
    v_xor_b32 v7, 0x10000, v7
    ds_read_b64_tr_b16 v[124:125], v7 offset:16384
    ds_read_b64_tr_b16 v[126:127], v7 offset:16512
    ds_read_b64_tr_b16 v[128:129], v7 offset:18432
    ds_read_b64_tr_b16 v[130:131], v7 offset:18560
    ds_read_b64_tr_b16 v[132:133], v7 offset:20480
    ds_read_b64_tr_b16 v[134:135], v7 offset:20608
    ds_read_b64_tr_b16 v[136:137], v7 offset:22528
    ds_read_b64_tr_b16 v[138:139], v7 offset:22656
    ds_read_b64_tr_b16 v[140:141], v7 offset:24576
    ds_read_b64_tr_b16 v[142:143], v7 offset:24704
    ds_read_b64_tr_b16 v[144:145], v7 offset:26624
    ds_read_b64_tr_b16 v[146:147], v7 offset:26752
    ds_read_b64_tr_b16 v[148:149], v7 offset:28672
    ds_read_b64_tr_b16 v[150:151], v7 offset:28800
    ds_read_b64_tr_b16 v[152:153], v7 offset:30720
    ds_read_b64_tr_b16 v[154:155], v7 offset:30848
    ds_read_b64_tr_b16 v[156:157], v7 offset:16416
    ds_read_b64_tr_b16 v[158:159], v7 offset:16544
    ds_read_b64_tr_b16 v[160:161], v7 offset:18464
    ds_read_b64_tr_b16 v[162:163], v7 offset:18592
    ds_read_b64_tr_b16 v[164:165], v7 offset:20512
    ds_read_b64_tr_b16 v[166:167], v7 offset:20640
    ds_read_b64_tr_b16 v[168:169], v7 offset:22560
    ds_read_b64_tr_b16 v[170:171], v7 offset:22688
    ds_read_b64_tr_b16 v[172:173], v7 offset:24608
    ds_read_b64_tr_b16 v[174:175], v7 offset:24736
    ds_read_b64_tr_b16 v[176:177], v7 offset:26656
    ds_read_b64_tr_b16 v[178:179], v7 offset:26784
    ds_read_b64_tr_b16 v[180:181], v7 offset:28704
    ds_read_b64_tr_b16 v[182:183], v7 offset:28832
    ds_read_b64_tr_b16 v[184:185], v7 offset:30752
    ds_read_b64_tr_b16 v[186:187], v7 offset:30880
    s_waitcnt lgkmcnt(0)
    s_barrier
    s_load_dwordx2 s[40:41], s[0:1], 56
    s_waitcnt lgkmcnt(0)

    s_mov_b32 s12, s40
    s_and_b32 s13, s41, 0xffff
    s_mov_b32 s14, 0x4000
    s_mov_b32 s15, 0x00020000

    s_lshr_b32 s79, s26, 2
    s_and_b32 s96, s26, 3
    s_and_b32 s78, s24, 1
    s_lshl_b32 s34, s25, 18
    s_add_u32 s34, s34, 83886080
    v_lshlrev_b32 v14, 4, v1
    s_lshl_b32 s5, s24, 12
    v_add_u32 v8, s5, v14
    v_and_b32 v5, 7, v2
    v_lshrrev_b32 v6, 1, v3
    v_and_b32 v7, 1, v3
    v_lshlrev_b32 v7, 3, v7
    s_lshl_b32 s4, s79, 12
    s_add_u32 s4, s4, 32768

    s_add_u32 s5, s96, 1
    s_and_b32 s5, s5, 3
    s_lshl_b32 s5, s5, 10
    s_add_u32 s5, s5, s4
    v_add_u32 v232, s5, v14

    s_add_u32 s5, s96, 2
    s_and_b32 s5, s5, 3
    s_lshl_b32 s5, s5, 10
    s_add_u32 s5, s5, s4
    v_add_u32 v233, s5, v14

    s_add_u32 s5, s96, 3
    s_and_b32 s5, s5, 3
    s_lshl_b32 s5, s5, 10
    s_add_u32 s5, s5, s4
    v_add_u32 v234, s5, v14

    s_lshl_b32 s5, s78, 9
    v_lshlrev_b32 v10, 8, v6
    v_lshl_add_u32 v10, v2, 4, v10
    v_add_u32 v10, v10, v7
    v_add_u32 v10, s5, v10
    v_add_u32 v18, 16384, v10
    s_lshl_b32 s5, s26, 10
    s_add_u32 s5, s5, 32768
    v_add_u32 v235, s5, v14
    v_add_u32 v10, s5, v10
    v_lshlrev_b32 v11, 8, v6
    v_lshl_add_u32 v11, v5, 4, v11
    s_lshr_b32 s4, s96, 1
    s_lshl_b32 s4, s4, 10
    s_and_b32 s5, s96, 1
    s_lshl_b32 s5, s5, 7
    s_add_u32 s4, s4, s5
    s_lshl_b32 s5, s78, 9
    s_add_u32 s4, s4, s5
    s_add_u32 s4, s4, 2048
    v_add_u32 v11, s4, v11
    v_lshlrev_b32 v12, 8, v6
    v_lshl_add_u32 v12, v2, 4, v12
    s_lshl_b32 s4, s96, 9
    s_add_u32 s4, s4, 4096
    v_add_u32 v12, s4, v12
    s_lshl_b32 s4, s26, 9
    v_lshlrev_b32 v13, 7, v3
    v_lshl_add_u32 v13, v5, 4, v13
    v_add_u32 v13, s4, v13
    v_add_u32 v13, 16384, v13
    v_lshlrev_b32 v15, 7, v6
    v_lshl_add_u32 v15, v5, 4, v15
    v_add_u32 v15, v15, v7
    s_lshl_b32 s5, s78, 8
    s_add_u32 s5, s5, s4
    v_add_u32 v15, s5, v15
    v_and_b32 v4, 31, v1
    v_lshlrev_b32 v236, 4, v4
    v_lshl_add_u32 v236, v6, 14, v236
    v_add_u32 v236, s4, v236
    v_lshlrev_b32 v16, 8, v6
    v_lshl_add_u32 v16, v2, 4, v16
    v_add_u32 v16, v16, v7
    s_lshl_b32 s5, s24, 9
    v_add_u32 v16, s5, v16
    v_cmp_gt_u32 s[58:59], 8, v2
    v_cmp_gt_u32 s[60:61], 32, v1
    v_cmp_gt_u32 s[64:65], 48, v1
    v_mov_b32 v4, 0x4444
    v_mov_b32 v6, 0xeeee
    v_cndmask_b32 v9, v6, v4, s[58:59]
    s_not_b64 s[66:67], s[58:59]
    s_mov_b32 s56, 0x0000ffff
    s_mov_b32 s57, 0x0000ffff
    s_mov_b32 s90, 0x0000ff00
    s_mov_b32 s91, 0x0000ff00
    v_mov_b32 v4, 0xff800000
    v_cndmask_b32 v116, 0, v4, s[60:61]
    v_mov_b32 v117, v116
    v_mov_b32 v118, v116
    v_mov_b32 v119, v116
    s_lshl_b32 s5, s78, 13
    v_add_u32 v246, s5, v14
    v_lshrrev_b32 v6, 1, v3
    v_lshlrev_b32 v247, 9, v6
    v_lshl_add_u32 v247, v2, 4, v247
    s_lshl_b32 s5, s78, 8
    s_add_u32 s5, s5, 12288
    v_add_u32 v247, s5, v247
    v_and_b32 v4, 31, v1
    v_lshlrev_b32 v248, 4, v4
    s_lshl_b32 s5, s78, 9
    s_add_u32 s5, s5, 12288
    v_add_u32 v248, s5, v248

    v_and_b32 v4, 1, v5
    v_lshlrev_b32 v4, 4, v4
    v_mov_b32 v6, 0x3f80
    v_lshlrev_b32 v6, v4, v6
    v_lshrrev_b32 v4, 1, v5

    v_cmp_eq_u32 vcc, 0, v4
    s_nop 1
    v_cndmask_b32 v84, 0, v6, vcc
    v_cmp_eq_u32 vcc, 1, v4
    s_nop 1
    v_cndmask_b32 v85, 0, v6, vcc
    v_cmp_eq_u32 vcc, 2, v4
    s_nop 1
    v_cndmask_b32 v86, 0, v6, vcc
    v_cmp_eq_u32 vcc, 3, v4
    s_nop 1
    v_cndmask_b32 v87, 0, v6, vcc
    v_mov_b32 v120, 0x3f803f80
    v_mov_b32 v188, -1
    v_cndmask_b32 v112, 0, v84, s[60:61]
    v_mov_b32 v121, 0x3f803f80
    v_mov_b32 v189, -1
    v_cndmask_b32 v113, 0, v85, s[60:61]
    v_mov_b32 v122, 0x3f803f80
    v_mov_b32 v190, -1
    v_cndmask_b32 v114, 0, v86, s[60:61]
    v_mov_b32 v123, 0x3f803f80
    v_mov_b32 v191, -1
    v_cndmask_b32 v115, 0, v87, s[60:61]
    s_cmp_lt_u32 s24, 2
    s_cbranch_scc1 .cs_10
    v_mov_b32 v170, 0
    v_mov_b32 v171, 0
    v_mov_b32 v174, 0
    v_mov_b32 v175, 0
    v_mov_b32 v182, 0
    v_mov_b32 v183, 0
.cs_10:
    v_add_u32 v4, 0, v3
    v_xor_b32 v6, v4, v2
    v_lshlrev_b32 v6, 4, v6
    v_lshl_add_u32 v224, v4, 8, v6

    v_add_u32 v4, 4, v3
    v_xor_b32 v6, v4, v2
    v_lshlrev_b32 v6, 4, v6
    v_lshl_add_u32 v225, v4, 8, v6

    v_add_u32 v4, 8, v3
    v_xor_b32 v6, v4, v2
    v_lshlrev_b32 v6, 4, v6
    v_lshl_add_u32 v226, v4, 8, v6

    v_add_u32 v4, 12, v3
    v_xor_b32 v6, v4, v2
    v_lshlrev_b32 v6, 4, v6
    v_lshl_add_u32 v227, v4, 8, v6

    s_add_u32 s5, s96, 0
    s_and_b32 s5, s5, 3
    s_lshl_b32 s5, s5, 2
    v_add_u32 v4, s5, v3
    v_xor_b32 v4, v4, v2
    v_lshlrev_b32 v4, 4, v4
    v_lshl_add_u32 v4, v2, 8, v4
    v_add_u32 v228, 20480, v4

    s_add_u32 s5, s96, 1
    s_and_b32 s5, s5, 3
    s_lshl_b32 s5, s5, 2
    v_add_u32 v4, s5, v3
    v_xor_b32 v4, v4, v2
    v_lshlrev_b32 v4, 4, v4
    v_lshl_add_u32 v4, v2, 8, v4
    v_add_u32 v229, 20480, v4

    s_add_u32 s5, s96, 2
    s_and_b32 s5, s5, 3
    s_lshl_b32 s5, s5, 2
    v_add_u32 v4, s5, v3
    v_xor_b32 v4, v4, v2
    v_lshlrev_b32 v4, 4, v4
    v_lshl_add_u32 v4, v2, 8, v4
    v_add_u32 v230, 20480, v4

    s_add_u32 s5, s96, 3
    s_and_b32 s5, s5, 3
    s_lshl_b32 s5, s5, 2
    v_add_u32 v4, s5, v3
    v_xor_b32 v4, v4, v2
    v_lshlrev_b32 v4, 4, v4
    v_lshl_add_u32 v4, v2, 8, v4
    v_add_u32 v231, 20480, v4

    v_add_u32 v224, 0, v14
    s_add_u32 s5, s96, 0
    s_and_b32 s5, s5, 3
    s_lshl_b32 s5, s5, 10
    s_add_u32 s5, s5, 20480
    v_add_u32 v228, s5, v14

    v_add_u32 v225, 1024, v14
    s_add_u32 s5, s96, 1
    s_and_b32 s5, s5, 3
    s_lshl_b32 s5, s5, 10
    s_add_u32 s5, s5, 20480
    v_add_u32 v229, s5, v14

    v_add_u32 v226, 2048, v14
    s_add_u32 s5, s96, 2
    s_and_b32 s5, s5, 3
    s_lshl_b32 s5, s5, 10
    s_add_u32 s5, s5, 20480
    v_add_u32 v230, s5, v14

    v_add_u32 v227, 3072, v14
    s_add_u32 s5, s96, 3
    s_and_b32 s5, s5, 3
    s_lshl_b32 s5, s5, 10
    s_add_u32 s5, s5, 20480
    v_add_u32 v231, s5, v14

    v_lshlrev_b32 v19, 4, v2
    v_lshl_add_u32 v19, v3, 8, v19
    v_add_u32 v19, 28672, v19
    v_lshlrev_b32 v17, 11, v5
    v_lshl_add_u32 v17, v3, 5, v17
    v_lshrrev_b32 v4, 3, v2
    v_lshl_add_u32 v17, v4, 4, v17
    s_lshl_b32 s5, s24, 9
    v_add_u32 v17, s5, v17
    s_lshl_b32 s4, s25, 3
    s_add_u32 s4, s4, s79
    s_mul_i32 s36, s4, 6144
    s_add_u32 s36, s36, 67108864
    s_lshl_b32 s89, s4, 8
    s_add_u32 s89, s89, 92282880
    v_lshlrev_b32 v253, 13, v1
    s_lshl_b32 s4, s4, 13
    s_add_u32 s38, s4, 16777216
    s_lshl_b32 s5, s96, 11
    s_add_u32 s39, s4, s5
    s_add_u32 s39, s39, 33554432
    s_mov_b32 s37, 0x3e0293ee
    s_mov_b32 s28, 0

    v_mov_b32 v5, 0
    s_mov_b32 s62, 0
    s_mov_b32 s5, 36
.wc_11:
    buffer_load_dword v4, v5, s[20:23], s5 offen sc1
    s_waitcnt vmcnt(0)
    v_readfirstlane_b32 s4, v4
    s_lshr_b32 s4, s4, 8
    s_and_b32 s4, s4, 0xff
    s_cmp_ge_u32 s4, 2
    s_cbranch_scc1 .wcd_12
    s_sleep 6
    s_add_u32 s62, s62, 1
    s_cmp_gt_u32 s62, 0x400000
    s_cbranch_scc1 .mg_end_1
    s_branch .wc_11

.wcd_12:
    v_readfirstlane_b32 s7, v4
    s_and_b32 s5, s26, 7
    s_lshl_b32 s4, s5, 10
    s_lshr_b32 s5, s26, 3
    s_lshl_b32 s5, s5, 14
    s_add_u32 s4, s4, s5
    s_add_u32 s35, s4, s101

    s_bfe_u32 s4, s7, 65536
    s_lshl_b32 s4, s4, 13
    s_add_u32 s4, s4, s35
    s_add_u32 s68, s4, 0

    s_bfe_u32 s4, s7, 65536
    s_lshl_b32 s4, s4, 13
    s_add_u32 s4, s4, s35
    s_add_u32 s69, s4, 1048576

    s_bfe_u32 s4, s7, 65537
    s_lshl_b32 s4, s4, 13
    s_add_u32 s4, s4, s35
    s_add_u32 s70, s4, 2097152

    s_bfe_u32 s4, s7, 65537
    s_lshl_b32 s4, s4, 13
    s_add_u32 s4, s4, s35
    s_add_u32 s71, s4, 3145728

    s_lshl_b32 s5, s25, 16
    v_lshrrev_b32 v6, 1, v3
    v_and_b32 v7, 1, v3
    v_lshlrev_b32 v237, 18, v7
    v_lshl_add_u32 v237, v6, 8, v237
    v_lshl_add_u32 v237, v2, 4, v237
    v_add_u32 v237, s5, v237
    s_lshl_b32 s6, s78, 9
    v_add_u32 v237, s6, v237
    v_add_u32 v238, s5, v14
    s_lshl_b32 s6, s78, 8
    v_lshlrev_b32 v249, 9, v7
    v_lshl_add_u32 v249, v2, 4, v249
    v_add_u32 v249, s6, v249
    v_add_u32 v4, s25, v6
    v_add_u32 v4, 1, v4
    v_and_b32 v4, 3, v4
    v_lshl_add_u32 v239, v4, 16, v249
    s_add_u32 s6, s25, 3
    s_and_b32 s6, s6, 3
    s_lshl_b32 s6, s6, 16
    v_add_u32 v249, s6, v249

    s_lshl_b32 s4, s24, 16
    s_add_u32 s4, s4, s34
    s_cmp_eq_u32 s24, 1
    s_cselect_b32 s5, s69, s68
    s_cmp_eq_u32 s24, 2
    s_cselect_b32 s5, s70, s5
    s_cmp_eq_u32 s24, 3
    s_cselect_b32 s5, s71, s5
    buffer_store_dwordx4 v[188:191], v236, s[8:11], s4 offen sc1
    buffer_store_dwordx4 v[188:191], v235, s[8:11], s4 offen sc1

    buffer_store_dwordx4 v[188:191], v238, s[8:11], s5 offen sc1
    s_add_u32 s5, s5, 262144
    buffer_store_dwordx4 v[188:191], v238, s[8:11], s5 offen sc1
    s_add_u32 s5, s5, 262144
    buffer_store_dwordx4 v[188:191], v238, s[8:11], s5 offen sc1
    s_add_u32 s5, s5, 262144
    buffer_store_dwordx4 v[188:191], v238, s[8:11], s5 offen sc1
    s_add_u32 s5, s5, 262144
    s_add_u32 s4, s36, 0
    s_cmp_eq_u32 s24, 2
    s_cbranch_scc1 .pa_13
    s_cmp_eq_u32 s24, 3
    s_cbranch_scc1 .pv_14
    s_mov_b64 exec, s[90:91]

    buffer_store_dwordx4 v[188:191], v11, s[8:11], s4 offen sc1
    s_add_u32 s4, s4, 196608
    buffer_store_dwordx4 v[188:191], v11, s[8:11], s4 offen sc1
    s_add_u32 s4, s4, 196608
    buffer_store_dwordx4 v[188:191], v11, s[8:11], s4 offen sc1
    s_add_u32 s4, s4, 196608
    buffer_store_dwordx4 v[188:191], v11, s[8:11], s4 offen sc1
    s_add_u32 s4, s4, 196608
    buffer_store_dwordx4 v[188:191], v11, s[8:11], s4 offen sc1
    s_add_u32 s4, s4, 196608
    buffer_store_dwordx4 v[188:191], v11, s[8:11], s4 offen sc1
    s_add_u32 s4, s4, 196608
    buffer_store_dwordx4 v[188:191], v11, s[8:11], s4 offen sc1
    s_add_u32 s4, s4, 196608
    buffer_store_dwordx4 v[188:191], v11, s[8:11], s4 offen sc1
    s_add_u32 s4, s4, 196608
    buffer_store_dwordx4 v[188:191], v11, s[8:11], s4 offen sc1
    s_add_u32 s4, s4, 196608
    buffer_store_dwordx4 v[188:191], v11, s[8:11], s4 offen sc1
    s_add_u32 s4, s4, 196608
    buffer_store_dwordx4 v[188:191], v11, s[8:11], s4 offen sc1
    s_add_u32 s4, s4, 196608
    buffer_store_dwordx4 v[188:191], v11, s[8:11], s4 offen sc1
    s_add_u32 s4, s4, 196608
    buffer_store_dwordx4 v[188:191], v11, s[8:11], s4 offen sc1
    s_add_u32 s4, s4, 196608
    buffer_store_dwordx4 v[188:191], v11, s[8:11], s4 offen sc1
    s_add_u32 s4, s4, 196608
    buffer_store_dwordx4 v[188:191], v11, s[8:11], s4 offen sc1
    s_add_u32 s4, s4, 196608
    buffer_store_dwordx4 v[188:191], v11, s[8:11], s4 offen sc1
    s_add_u32 s4, s4, 196608
    buffer_store_dwordx4 v[188:191], v11, s[8:11], s4 offen sc1
    s_add_u32 s4, s4, 196608
    buffer_store_dwordx4 v[188:191], v11, s[8:11], s4 offen sc1
    s_add_u32 s4, s4, 196608
    buffer_store_dwordx4 v[188:191], v11, s[8:11], s4 offen sc1
    s_add_u32 s4, s4, 196608
    buffer_store_dwordx4 v[188:191], v11, s[8:11], s4 offen sc1
    s_add_u32 s4, s4, 196608
    buffer_store_dwordx4 v[188:191], v11, s[8:11], s4 offen sc1
    s_add_u32 s4, s4, 196608
    buffer_store_dwordx4 v[188:191], v11, s[8:11], s4 offen sc1
    s_add_u32 s4, s4, 196608
    buffer_store_dwordx4 v[188:191], v11, s[8:11], s4 offen sc1
    s_add_u32 s4, s4, 196608
    buffer_store_dwordx4 v[188:191], v11, s[8:11], s4 offen sc1
    s_add_u32 s4, s4, 196608
    buffer_store_dwordx4 v[188:191], v11, s[8:11], s4 offen sc1
    s_add_u32 s4, s4, 196608
    buffer_store_dwordx4 v[188:191], v11, s[8:11], s4 offen sc1
    s_add_u32 s4, s4, 196608
    buffer_store_dwordx4 v[188:191], v11, s[8:11], s4 offen sc1
    s_add_u32 s4, s4, 196608
    buffer_store_dwordx4 v[188:191], v11, s[8:11], s4 offen sc1
    s_add_u32 s4, s4, 196608
    buffer_store_dwordx4 v[188:191], v11, s[8:11], s4 offen sc1
    s_add_u32 s4, s4, 196608
    buffer_store_dwordx4 v[188:191], v11, s[8:11], s4 offen sc1
    s_add_u32 s4, s4, 196608
    buffer_store_dwordx4 v[188:191], v11, s[8:11], s4 offen sc1
    s_add_u32 s4, s4, 196608
    buffer_store_dwordx4 v[188:191], v11, s[8:11], s4 offen sc1
    s_add_u32 s4, s4, 196608
    buffer_store_dwordx4 v[188:191], v11, s[8:11], s4 offen sc1
    s_add_u32 s4, s4, 196608
    buffer_store_dwordx4 v[188:191], v11, s[8:11], s4 offen sc1
    s_add_u32 s4, s4, 196608
    buffer_store_dwordx4 v[188:191], v11, s[8:11], s4 offen sc1
    s_add_u32 s4, s4, 196608
    buffer_store_dwordx4 v[188:191], v11, s[8:11], s4 offen sc1
    s_add_u32 s4, s4, 196608
    buffer_store_dwordx4 v[188:191], v11, s[8:11], s4 offen sc1
    s_add_u32 s4, s4, 196608
    buffer_store_dwordx4 v[188:191], v11, s[8:11], s4 offen sc1
    s_add_u32 s4, s4, 196608
    buffer_store_dwordx4 v[188:191], v11, s[8:11], s4 offen sc1
    s_add_u32 s4, s4, 196608
    buffer_store_dwordx4 v[188:191], v11, s[8:11], s4 offen sc1
    s_add_u32 s4, s4, 196608
    buffer_store_dwordx4 v[188:191], v11, s[8:11], s4 offen sc1
    s_add_u32 s4, s4, 196608
    buffer_store_dwordx4 v[188:191], v11, s[8:11], s4 offen sc1
    s_add_u32 s4, s4, 196608
    buffer_store_dwordx4 v[188:191], v11, s[8:11], s4 offen sc1
    s_add_u32 s4, s4, 196608
    buffer_store_dwordx4 v[188:191], v11, s[8:11], s4 offen sc1
    s_add_u32 s4, s4, 196608
    buffer_store_dwordx4 v[188:191], v11, s[8:11], s4 offen sc1
    s_add_u32 s4, s4, 196608
    buffer_store_dwordx4 v[188:191], v11, s[8:11], s4 offen sc1
    s_add_u32 s4, s4, 196608
    buffer_store_dwordx4 v[188:191], v11, s[8:11], s4 offen sc1
    s_add_u32 s4, s4, 196608
    buffer_store_dwordx4 v[188:191], v11, s[8:11], s4 offen sc1
    s_add_u32 s4, s4, 196608
    buffer_store_dwordx4 v[188:191], v11, s[8:11], s4 offen sc1
    s_add_u32 s4, s4, 196608
    buffer_store_dwordx4 v[188:191], v11, s[8:11], s4 offen sc1
    s_add_u32 s4, s4, 196608
    buffer_store_dwordx4 v[188:191], v11, s[8:11], s4 offen sc1
    s_add_u32 s4, s4, 196608
    buffer_store_dwordx4 v[188:191], v11, s[8:11], s4 offen sc1
    s_add_u32 s4, s4, 196608
    buffer_store_dwordx4 v[188:191], v11, s[8:11], s4 offen sc1
    s_add_u32 s4, s4, 196608
    buffer_store_dwordx4 v[188:191], v11, s[8:11], s4 offen sc1
    s_add_u32 s4, s4, 196608
    buffer_store_dwordx4 v[188:191], v11, s[8:11], s4 offen sc1
    s_add_u32 s4, s4, 196608
    buffer_store_dwordx4 v[188:191], v11, s[8:11], s4 offen sc1
    s_add_u32 s4, s4, 196608
    buffer_store_dwordx4 v[188:191], v11, s[8:11], s4 offen sc1
    s_add_u32 s4, s4, 196608
    buffer_store_dwordx4 v[188:191], v11, s[8:11], s4 offen sc1
    s_add_u32 s4, s4, 196608
    buffer_store_dwordx4 v[188:191], v11, s[8:11], s4 offen sc1
    s_add_u32 s4, s4, 196608
    buffer_store_dwordx4 v[188:191], v11, s[8:11], s4 offen sc1
    s_add_u32 s4, s4, 196608
    buffer_store_dwordx4 v[188:191], v11, s[8:11], s4 offen sc1
    s_add_u32 s4, s4, 196608
    buffer_store_dwordx4 v[188:191], v11, s[8:11], s4 offen sc1
    s_add_u32 s4, s4, 196608
    buffer_store_dwordx4 v[188:191], v11, s[8:11], s4 offen sc1
    s_add_u32 s4, s4, 196608
    buffer_store_dwordx4 v[188:191], v11, s[8:11], s4 offen sc1
    s_add_u32 s4, s4, 196608
    s_branch .pa_13
.pv_14:
    s_mov_b64 exec, s[56:57]
    buffer_store_dwordx4 v[188:191], v12, s[8:11], s4 offen sc1
    s_add_u32 s4, s4, 196608
    buffer_store_dwordx4 v[188:191], v12, s[8:11], s4 offen sc1
    s_add_u32 s4, s4, 196608
    buffer_store_dwordx4 v[188:191], v12, s[8:11], s4 offen sc1
    s_add_u32 s4, s4, 196608
    buffer_store_dwordx4 v[188:191], v12, s[8:11], s4 offen sc1
    s_add_u32 s4, s4, 196608
    buffer_store_dwordx4 v[188:191], v12, s[8:11], s4 offen sc1
    s_add_u32 s4, s4, 196608
    buffer_store_dwordx4 v[188:191], v12, s[8:11], s4 offen sc1
    s_add_u32 s4, s4, 196608
    buffer_store_dwordx4 v[188:191], v12, s[8:11], s4 offen sc1
    s_add_u32 s4, s4, 196608
    buffer_store_dwordx4 v[188:191], v12, s[8:11], s4 offen sc1
    s_add_u32 s4, s4, 196608
    buffer_store_dwordx4 v[188:191], v12, s[8:11], s4 offen sc1
    s_add_u32 s4, s4, 196608
    buffer_store_dwordx4 v[188:191], v12, s[8:11], s4 offen sc1
    s_add_u32 s4, s4, 196608
    buffer_store_dwordx4 v[188:191], v12, s[8:11], s4 offen sc1
    s_add_u32 s4, s4, 196608
    buffer_store_dwordx4 v[188:191], v12, s[8:11], s4 offen sc1
    s_add_u32 s4, s4, 196608
    buffer_store_dwordx4 v[188:191], v12, s[8:11], s4 offen sc1
    s_add_u32 s4, s4, 196608
    buffer_store_dwordx4 v[188:191], v12, s[8:11], s4 offen sc1
    s_add_u32 s4, s4, 196608
    buffer_store_dwordx4 v[188:191], v12, s[8:11], s4 offen sc1
    s_add_u32 s4, s4, 196608
    buffer_store_dwordx4 v[188:191], v12, s[8:11], s4 offen sc1
    s_add_u32 s4, s4, 196608
    buffer_store_dwordx4 v[188:191], v12, s[8:11], s4 offen sc1
    s_add_u32 s4, s4, 196608
    buffer_store_dwordx4 v[188:191], v12, s[8:11], s4 offen sc1
    s_add_u32 s4, s4, 196608
    buffer_store_dwordx4 v[188:191], v12, s[8:11], s4 offen sc1
    s_add_u32 s4, s4, 196608
    buffer_store_dwordx4 v[188:191], v12, s[8:11], s4 offen sc1
    s_add_u32 s4, s4, 196608
    buffer_store_dwordx4 v[188:191], v12, s[8:11], s4 offen sc1
    s_add_u32 s4, s4, 196608
    buffer_store_dwordx4 v[188:191], v12, s[8:11], s4 offen sc1
    s_add_u32 s4, s4, 196608
    buffer_store_dwordx4 v[188:191], v12, s[8:11], s4 offen sc1
    s_add_u32 s4, s4, 196608
    buffer_store_dwordx4 v[188:191], v12, s[8:11], s4 offen sc1
    s_add_u32 s4, s4, 196608
    buffer_store_dwordx4 v[188:191], v12, s[8:11], s4 offen sc1
    s_add_u32 s4, s4, 196608
    buffer_store_dwordx4 v[188:191], v12, s[8:11], s4 offen sc1
    s_add_u32 s4, s4, 196608
    buffer_store_dwordx4 v[188:191], v12, s[8:11], s4 offen sc1
    s_add_u32 s4, s4, 196608
    buffer_store_dwordx4 v[188:191], v12, s[8:11], s4 offen sc1
    s_add_u32 s4, s4, 196608
    buffer_store_dwordx4 v[188:191], v12, s[8:11], s4 offen sc1
    s_add_u32 s4, s4, 196608
    buffer_store_dwordx4 v[188:191], v12, s[8:11], s4 offen sc1
    s_add_u32 s4, s4, 196608
    buffer_store_dwordx4 v[188:191], v12, s[8:11], s4 offen sc1
    s_add_u32 s4, s4, 196608
    buffer_store_dwordx4 v[188:191], v12, s[8:11], s4 offen sc1
    s_add_u32 s4, s4, 196608
    buffer_store_dwordx4 v[188:191], v12, s[8:11], s4 offen sc1
    s_add_u32 s4, s4, 196608
    buffer_store_dwordx4 v[188:191], v12, s[8:11], s4 offen sc1
    s_add_u32 s4, s4, 196608
    buffer_store_dwordx4 v[188:191], v12, s[8:11], s4 offen sc1
    s_add_u32 s4, s4, 196608
    buffer_store_dwordx4 v[188:191], v12, s[8:11], s4 offen sc1
    s_add_u32 s4, s4, 196608
    buffer_store_dwordx4 v[188:191], v12, s[8:11], s4 offen sc1
    s_add_u32 s4, s4, 196608
    buffer_store_dwordx4 v[188:191], v12, s[8:11], s4 offen sc1
    s_add_u32 s4, s4, 196608
    buffer_store_dwordx4 v[188:191], v12, s[8:11], s4 offen sc1
    s_add_u32 s4, s4, 196608
    buffer_store_dwordx4 v[188:191], v12, s[8:11], s4 offen sc1
    s_add_u32 s4, s4, 196608
    buffer_store_dwordx4 v[188:191], v12, s[8:11], s4 offen sc1
    s_add_u32 s4, s4, 196608
    buffer_store_dwordx4 v[188:191], v12, s[8:11], s4 offen sc1
    s_add_u32 s4, s4, 196608
    buffer_store_dwordx4 v[188:191], v12, s[8:11], s4 offen sc1
    s_add_u32 s4, s4, 196608
    buffer_store_dwordx4 v[188:191], v12, s[8:11], s4 offen sc1
    s_add_u32 s4, s4, 196608
    buffer_store_dwordx4 v[188:191], v12, s[8:11], s4 offen sc1
    s_add_u32 s4, s4, 196608
    buffer_store_dwordx4 v[188:191], v12, s[8:11], s4 offen sc1
    s_add_u32 s4, s4, 196608
    buffer_store_dwordx4 v[188:191], v12, s[8:11], s4 offen sc1
    s_add_u32 s4, s4, 196608
    buffer_store_dwordx4 v[188:191], v12, s[8:11], s4 offen sc1
    s_add_u32 s4, s4, 196608
    buffer_store_dwordx4 v[188:191], v12, s[8:11], s4 offen sc1
    s_add_u32 s4, s4, 196608
    buffer_store_dwordx4 v[188:191], v12, s[8:11], s4 offen sc1
    s_add_u32 s4, s4, 196608
    buffer_store_dwordx4 v[188:191], v12, s[8:11], s4 offen sc1
    s_add_u32 s4, s4, 196608
    buffer_store_dwordx4 v[188:191], v12, s[8:11], s4 offen sc1
    s_add_u32 s4, s4, 196608
    buffer_store_dwordx4 v[188:191], v12, s[8:11], s4 offen sc1
    s_add_u32 s4, s4, 196608
    buffer_store_dwordx4 v[188:191], v12, s[8:11], s4 offen sc1
    s_add_u32 s4, s4, 196608
    buffer_store_dwordx4 v[188:191], v12, s[8:11], s4 offen sc1
    s_add_u32 s4, s4, 196608
    buffer_store_dwordx4 v[188:191], v12, s[8:11], s4 offen sc1
    s_add_u32 s4, s4, 196608
    buffer_store_dwordx4 v[188:191], v12, s[8:11], s4 offen sc1
    s_add_u32 s4, s4, 196608
    buffer_store_dwordx4 v[188:191], v12, s[8:11], s4 offen sc1
    s_add_u32 s4, s4, 196608
    buffer_store_dwordx4 v[188:191], v12, s[8:11], s4 offen sc1
    s_add_u32 s4, s4, 196608
    buffer_store_dwordx4 v[188:191], v12, s[8:11], s4 offen sc1
    s_add_u32 s4, s4, 196608
    buffer_store_dwordx4 v[188:191], v12, s[8:11], s4 offen sc1
    s_add_u32 s4, s4, 196608
    buffer_store_dwordx4 v[188:191], v12, s[8:11], s4 offen sc1
    s_add_u32 s4, s4, 196608
    buffer_store_dwordx4 v[188:191], v12, s[8:11], s4 offen sc1
    s_add_u32 s4, s4, 196608
    buffer_store_dwordx4 v[188:191], v12, s[8:11], s4 offen sc1
    s_add_u32 s4, s4, 196608
.pa_13:
    s_mov_b64 exec, -1
    s_waitcnt vmcnt(0) lgkmcnt(0)
    s_barrier
    s_mov_b32 s5, 32
    s_cmp_lg_u32 s24, 0
    s_cbranch_scc1 .sg_15
    s_mov_b64 exec, 1
    v_mov_b32 v4, 1
    v_mov_b32 v5, 0
    buffer_atomic_add v4, v5, s[20:23], s5 offen sc1
    s_mov_b64 exec, -1

.sg_15:
    v_mov_b32 v5, 0
    s_mov_b32 s62, 0
    s_mov_b32 s5, 32
.wc_16:
    buffer_load_dword v4, v5, s[20:23], s5 offen sc1
    s_waitcnt vmcnt(0)
    v_readfirstlane_b32 s4, v4
    s_lshr_b32 s4, s4, 0
    s_and_b32 s4, s4, 0xffff
    s_cmp_ge_u32 s4, 256
    s_cbranch_scc1 .wcd_17
    s_sleep 6
    s_add_u32 s62, s62, 1
    s_cmp_gt_u32 s62, 0x400000
    s_cbranch_scc1 .mg_end_1
    s_branch .wc_16

.wcd_17:
    s_mov_b32 s62, 0
    s_mov_b64 exec, 3
.wf_18:
    buffer_load_dword v4, v253, s[8:11], s89 offen sc1
    s_waitcnt vmcnt(0)
    v_cmp_gt_u32 vcc, 1, v4
    s_cbranch_vccz .wfd_19
    s_sleep 2
    s_add_u32 s62, s62, 1
    s_cmp_gt_u32 s62, 0x400000
    s_cbranch_scc1 .mg_end_1
    s_branch .wf_18

.wfd_19:
    s_mov_b64 exec, -1
    v_readlane_b32 s4, v4, 0
    v_readlane_b32 s93, v4, 1
    s_min_u32 s93, s93, s4
    s_cmp_lg_u32 s24, 2
    s_cbranch_scc1 .nd_20
    s_add_u32 s4, s38, 4096
    s_add_u32 s5, s39, 1024
    s_mov_b32 m0, 20480
    s_nop 0
    buffer_load_dwordx4 v224, s[8:11], s38 offen lds

    s_mov_b32 m0, 21504
    s_nop 0
    buffer_load_dwordx4 v225, s[8:11], s38 offen lds

    s_mov_b32 m0, 22528
    s_nop 0
    buffer_load_dwordx4 v226, s[8:11], s38 offen lds

    s_mov_b32 m0, 23552
    s_nop 0
    buffer_load_dwordx4 v227, s[8:11], s38 offen lds

    s_mov_b32 m0, 24576
    s_nop 0
    buffer_load_dwordx4 v224, s[8:11], s4 offen lds

    s_mov_b32 m0, 25600
    s_nop 0
    buffer_load_dwordx4 v225, s[8:11], s4 offen lds

    s_mov_b32 m0, 26624
    s_nop 0
    buffer_load_dwordx4 v226, s[8:11], s4 offen lds

    s_mov_b32 m0, 27648
    s_nop 0
    buffer_load_dwordx4 v227, s[8:11], s4 offen lds

    s_mov_b32 m0, 28672
    s_nop 0
    buffer_load_dwordx4 v14, s[8:11], s39 offen lds

    s_mov_b32 m0, 29696
    s_nop 0
    buffer_load_dwordx4 v14, s[8:11], s5 offen lds

    s_waitcnt vmcnt(0)
.nd_20:
    s_add_u32 s38, s38, 262144
    s_add_u32 s39, s39, 262144
    s_and_b32 s4, s28, 3
    s_lshl_b32 s5, s4, 16
    s_add_u32 s29, s5, s34
    s_xor_b32 s6, s5, 0x20000
    s_add_u32 s31, s6, s34
    s_add_u32 s32, s29, 16384
    s_add_u32 s33, s29, 20480

    v_mov_b32 v52, 0
    v_mov_b32 v53, 0
    v_mov_b32 v54, 0
    v_mov_b32 v55, 0
    v_mov_b32 v56, 0
    v_mov_b32 v57, 0
    v_mov_b32 v58, 0
    v_mov_b32 v59, 0
    v_mov_b32 v60, 0
    v_mov_b32 v61, 0
    v_mov_b32 v62, 0
    v_mov_b32 v63, 0
    v_mov_b32 v64, 0
    v_mov_b32 v65, 0
    v_mov_b32 v66, 0
    v_mov_b32 v67, 0
    v_mov_b32 v68, 0
    v_mov_b32 v69, 0
    v_mov_b32 v70, 0
    v_mov_b32 v71, 0
    v_mov_b32 v72, 0
    v_mov_b32 v73, 0
    v_mov_b32 v74, 0
    v_mov_b32 v75, 0
    v_mov_b32 v76, 0
    v_mov_b32 v77, 0
    v_mov_b32 v78, 0
    v_mov_b32 v79, 0
    v_mov_b32 v80, 0
    v_mov_b32 v81, 0
    v_mov_b32 v82, 0
    v_mov_b32 v83, 0
    buffer_load_dwordx4 v[20:23], v17, s[12:15], 0 offen offset:0
    buffer_load_dwordx4 v[24:27], v17, s[12:15], 0 offen offset:128
    buffer_load_dwordx4 v[28:31], v17, s[12:15], 0 offen offset:256
    buffer_load_dwordx4 v[32:35], v17, s[12:15], 0 offen offset:384
    s_waitcnt vmcnt(0) lgkmcnt(0)
    v_min_u32 v20, 0xfffffffe, v20
    v_min_u32 v22, 0xfffffffe, v22
    v_min_u32 v24, 0xfffffffe, v24
    v_min_u32 v26, 0xfffffffe, v26
    v_min_u32 v28, 0xfffffffe, v28
    v_min_u32 v30, 0xfffffffe, v30
    v_min_u32 v32, 0xfffffffe, v32
    v_min_u32 v34, 0xfffffffe, v34
    s_mov_b32 s62, 0
    s_mov_b32 s63, 0
    s_lshl_b32 s4, s27, 2
    s_add_u32 s4, s4, s24
    s_cmp_eq_u32 s4, 1
    s_cbranch_scc1 .ent01_22
    s_cmp_eq_u32 s4, 2
    s_cbranch_scc1 .ent02_23
    s_cmp_eq_u32 s4, 3
    s_cbranch_scc1 .ent03_24
    s_cmp_eq_u32 s4, 4
    s_cbranch_scc1 .ent10_25
    s_cmp_eq_u32 s4, 5
    s_cbranch_scc1 .ent11_26
    s_cmp_eq_u32 s4, 6
    s_cbranch_scc1 .ent12_27
    s_cmp_eq_u32 s4, 7
    s_cbranch_scc1 .ent13_28
    s_branch .ent00_21
.p2align 6
.top0_29:
    buffer_load_dwordx4 v[20:23], v8, s[8:11], s29 offen offset:0 sc1
    s_nop 11
    buffer_load_dwordx4 v[24:27], v8, s[8:11], s29 offen offset:1024 sc1
    s_nop 11
    buffer_load_dwordx4 v[28:31], v8, s[8:11], s29 offen offset:2048 sc1
    s_nop 11
    buffer_load_dwordx4 v[32:35], v8, s[8:11], s29 offen offset:3072 sc1
.ent00_21:
    s_waitcnt vmcnt(3)
    v_max_u32 v4, v20, v22
    v_cmp_eq_u32 vcc, -1, v4
    s_cbranch_vccnz .pf_32
    v_smfmac_f32_16x16x64_bf16 v[52:55], v[20:23], a[0:7], v9
    v_smfmac_f32_16x16x64_bf16 v[56:59], v[20:23], a[32:39], v9
    v_smfmac_f32_16x16x64_bf16 v[60:63], v[20:23], a[64:71], v9
    v_smfmac_f32_16x16x64_bf16 v[64:67], v[20:23], a[96:103], v9
.pr_36:
    s_waitcnt vmcnt(2)
    v_max_u32 v4, v24, v26
    v_cmp_eq_u32 vcc, -1, v4
    s_cbranch_vccnz .pf_33
    v_smfmac_f32_16x16x64_bf16 v[52:55], v[24:27], a[8:15], v9
    v_smfmac_f32_16x16x64_bf16 v[56:59], v[24:27], a[40:47], v9
    v_smfmac_f32_16x16x64_bf16 v[60:63], v[24:27], a[72:79], v9
    v_smfmac_f32_16x16x64_bf16 v[64:67], v[24:27], a[104:111], v9
.pr_37:
    s_waitcnt vmcnt(1)
    v_max_u32 v4, v28, v30
    v_cmp_eq_u32 vcc, -1, v4
    s_cbranch_vccnz .pf_34
    v_smfmac_f32_16x16x64_bf16 v[52:55], v[28:31], a[16:23], v9
    v_smfmac_f32_16x16x64_bf16 v[56:59], v[28:31], a[48:55], v9
    v_smfmac_f32_16x16x64_bf16 v[60:63], v[28:31], a[80:87], v9
    v_smfmac_f32_16x16x64_bf16 v[64:67], v[28:31], a[112:119], v9
.pr_38:
    s_waitcnt vmcnt(0)
    v_max_u32 v4, v32, v34
    v_cmp_eq_u32 vcc, -1, v4
    s_cbranch_vccnz .pf_35
    v_smfmac_f32_16x16x64_bf16 v[52:55], v[32:35], a[24:31], v9
    v_smfmac_f32_16x16x64_bf16 v[56:59], v[32:35], a[56:63], v9
    v_smfmac_f32_16x16x64_bf16 v[60:63], v[32:35], a[88:95], v9
    v_smfmac_f32_16x16x64_bf16 v[64:67], v[32:35], a[120:127], v9
.pr_39:
    s_cmp_lg_u32 s63, 0
    s_cbranch_scc1 .ps_31
.pd_30:
    v_cvt_pk_bf16_f32 v104, v52, v53
    v_cvt_pk_bf16_f32 v105, v54, v55
    v_cvt_pk_bf16_f32 v106, v56, v57
    v_cvt_pk_bf16_f32 v107, v58, v59
    ds_write_b64 v16, v[104:105] offset:4096
    v_cvt_pk_bf16_f32 v108, v60, v61
    v_cvt_pk_bf16_f32 v109, v62, v63
    ds_write_b64 v16, v[106:107] offset:6144
    ds_write_b64 v16, v[108:109] offset:0
    s_nop 0
    v_cvt_pk_bf16_f32 v110, v64, v65
    v_cvt_pk_bf16_f32 v111, v66, v67
    ds_write_b64 v16, v[110:111] offset:2048
    v_smfmac_f32_16x16x64_bf16 v[68:71], v[20:23], a[128:135], v9
    v_smfmac_f32_16x16x64_bf16 v[72:75], v[20:23], a[160:167], v9
    s_waitcnt lgkmcnt(0)
    s_barrier
    ds_read_b128 v[36:39], v14 offset:0
    ds_read_b128 v[40:43], v14 offset:1024
    v_smfmac_f32_16x16x64_bf16 v[68:71], v[24:27], a[136:143], v9
    v_smfmac_f32_16x16x64_bf16 v[72:75], v[24:27], a[168:175], v9
    s_waitcnt lgkmcnt(1)
    v_mfma_f32_16x16x32_bf16 v[44:47], v[36:39], v[84:87], 0
    s_waitcnt lgkmcnt(0)
    v_mfma_f32_16x16x32_bf16 v[44:47], v[40:43], v[84:87], v[44:47]
    v_smfmac_f32_16x16x64_bf16 v[68:71], v[28:31], a[144:151], v9
    v_smfmac_f32_16x16x64_bf16 v[72:75], v[28:31], a[176:183], v9
    s_mov_b64 exec, s[66:67]
    v_cvt_pk_bf16_f32 v48, v44, v45
    v_cvt_pk_bf16_f32 v49, v46, v47
    v_min_u32 v48, 0xfffffffe, v48
    buffer_store_dwordx2 v[48:49], v10, s[8:11], s29 offen

    ds_write_b64 v18, v[48:49]
    s_mov_b64 exec, -1

    v_smfmac_f32_16x16x64_bf16 v[68:71], v[32:35], a[152:159], v9
    v_smfmac_f32_16x16x64_bf16 v[72:75], v[32:35], a[184:191], v9
    s_nop 3
    v_cvt_pk_bf16_f32 v104, v68, v69
    v_cvt_pk_bf16_f32 v105, v70, v71
    ds_write_b64 v16, v[104:105] offset:8192
    s_nop 0
    v_cvt_pk_bf16_f32 v106, v72, v73
    v_cvt_pk_bf16_f32 v107, v74, v75
    ds_write_b64 v16, v[106:107] offset:10240
    s_waitcnt lgkmcnt(0)
    s_barrier
    v_mov_b32 v212, v48
    v_min_u32 v213, 0xfffffffe, v49
    v_mov_b32 v214, v48
    v_min_u32 v215, 0xfffffffe, v49
    s_nop 1
    v_permlane16_swap_b32 v212, v214
    v_permlane16_swap_b32 v213, v215

    ds_read_b128 v[36:39], v14 offset:8192
    ds_read_b128 v[40:43], v14 offset:9216
    ds_read_b128 v[44:47], v14 offset:10240
    ds_read_b128 v[48:51], v14 offset:11264
    s_waitcnt lgkmcnt(0)
    v_mfma_f32_16x16x32_bf16 v[104:107], v[84:87], v[36:39], 0
    v_mfma_f32_16x16x32_bf16 v[108:111], v[84:87], v[44:47], 0
    v_mfma_f32_16x16x32_bf16 v[104:107], v[84:87], v[40:43], v[104:107]
    v_mfma_f32_16x16x32_bf16 v[108:111], v[84:87], v[48:51], v[108:111]
    s_nop 7
    v_cndmask_b32 v104, v108, v104, s[60:61]
    v_cndmask_b32 v105, v109, v105, s[60:61]
    v_cndmask_b32 v106, v110, v106, s[60:61]
    v_cndmask_b32 v107, v111, v107, s[60:61]
    v_cvt_pk_bf16_f32 v220, v104, v105
    v_cvt_pk_bf16_f32 v221, v106, v107
    v_min_u32 v220, 0xfffffffe, v220
    v_min_u32 v221, 0xfffffffe, v221
    v_mov_b32 v222, v220
    v_mov_b32 v223, v221
    s_nop 1
    v_permlane16_swap_b32 v220, v222
    v_permlane16_swap_b32 v221, v223

    s_cmp_eq_u32 s28, 63
    s_cbranch_scc1 .last_40
    s_barrier
    buffer_store_dwordx4 v[188:191], v235, s[8:11], s31 offen
    s_barrier
    s_nop 15
    buffer_load_dwordx4 v[20:23], v246, s[8:11], s32 offen offset:0 sc1
    s_nop 3
    buffer_load_dwordx4 v[24:27], v246, s[8:11], s32 offen offset:1024 sc1
    s_nop 3
    buffer_load_dwordx4 v[28:31], v246, s[8:11], s32 offen offset:2048 sc1
    s_nop 3
    buffer_load_dwordx4 v[32:35], v246, s[8:11], s32 offen offset:3072 sc1
    s_nop 3
    buffer_load_dwordx4 v[36:39], v246, s[8:11], s33 offen offset:0 sc1
    s_nop 3
    buffer_load_dwordx4 v[40:43], v246, s[8:11], s33 offen offset:1024 sc1
    s_nop 3
    buffer_load_dwordx4 v[44:47], v246, s[8:11], s33 offen offset:2048 sc1
    s_nop 3
    buffer_load_dwordx4 v[48:51], v246, s[8:11], s33 offen offset:3072 sc1
    s_waitcnt vmcnt(7)
    v_cmp_eq_u32 vcc, -1, v20
    s_cbranch_vccnz .pf_43
    v_smfmac_f32_16x16x64_bf16 v[76:79], v[20:23], a[192:199], v9
    v_smfmac_f32_16x16x64_bf16 v[80:83], v[20:23], a[224:231], v9
.pr_51:
    s_waitcnt vmcnt(6)
    v_cmp_eq_u32 vcc, -1, v24
    s_cbranch_vccnz .pf_44
    v_smfmac_f32_16x16x64_bf16 v[76:79], v[24:27], a[200:207], v9
    v_smfmac_f32_16x16x64_bf16 v[80:83], v[24:27], a[232:239], v9
.pr_52:
    s_waitcnt vmcnt(5)
    v_cmp_eq_u32 vcc, -1, v28
    s_cbranch_vccnz .pf_45
    v_smfmac_f32_16x16x64_bf16 v[76:79], v[28:31], a[208:215], v9
    v_smfmac_f32_16x16x64_bf16 v[80:83], v[28:31], a[240:247], v9
.pr_53:
    s_waitcnt vmcnt(4)
    v_cmp_eq_u32 vcc, -1, v32
    s_cbranch_vccnz .pf_46
    v_smfmac_f32_16x16x64_bf16 v[76:79], v[32:35], a[216:223], v9
    v_smfmac_f32_16x16x64_bf16 v[80:83], v[32:35], a[248:255], v9
.pr_54:
    s_waitcnt vmcnt(3)
    v_cmp_eq_u32 vcc, -1, v36
    s_cbranch_vccnz .pf_47
    v_smfmac_f32_16x16x64_bf16 v[76:79], v[36:39], v[124:131], v9
    v_smfmac_f32_16x16x64_bf16 v[80:83], v[36:39], v[156:163], v9
.pr_55:
    s_waitcnt vmcnt(2)
    v_cmp_eq_u32 vcc, -1, v40
    s_cbranch_vccnz .pf_48
    v_smfmac_f32_16x16x64_bf16 v[76:79], v[40:43], v[132:139], v9
    v_smfmac_f32_16x16x64_bf16 v[80:83], v[40:43], v[164:171], v9
.pr_56:
    s_waitcnt vmcnt(1)
    v_cmp_eq_u32 vcc, -1, v44
    s_cbranch_vccnz .pf_49
    v_smfmac_f32_16x16x64_bf16 v[76:79], v[44:47], v[140:147], v9
    v_smfmac_f32_16x16x64_bf16 v[80:83], v[44:47], v[172:179], v9
.pr_57:
    s_waitcnt vmcnt(0)
    v_cmp_eq_u32 vcc, -1, v48
    s_cbranch_vccnz .pf_50
    v_smfmac_f32_16x16x64_bf16 v[76:79], v[48:51], v[148:155], v9
    v_smfmac_f32_16x16x64_bf16 v[80:83], v[48:51], v[180:187], v9
.pr_58:
    s_cmp_lg_u32 s63, 0
    s_cbranch_scc1 .ps_42
.pd_41:
    s_nop 5
    v_permlane32_swap_b32 v76, v80
    v_permlane32_swap_b32 v77, v81
    v_permlane32_swap_b32 v78, v82
    v_permlane32_swap_b32 v79, v83
    v_add_f32 v76, v76, v80
    v_add_f32 v77, v77, v81
    v_add_f32 v78, v78, v82
    v_add_f32 v79, v79, v83
    v_cvt_pk_bf16_f32 v104, v76, v77
    v_cvt_pk_bf16_f32 v106, v76, v77
    v_cvt_pk_bf16_f32 v105, v78, v79
    v_cvt_pk_bf16_f32 v107, v78, v79
    v_permlane16_swap_b32 v104, v106
    s_nop 0
    v_permlane16_swap_b32 v105, v107
    v_min_u32 v104, 0xfffffffe, v104
    buffer_store_dwordx4 v[104:107], v237, s[8:11], s68 offen sc1

    s_add_u32 s4, s68, 524288
    buffer_store_dwordx4 v[104:107], v237, s[8:11], s4 offen sc1
    ds_write_b128 v247, v[104:107]
    s_waitcnt lgkmcnt(0)
    s_barrier
    v_mov_b32 v52, 0
    v_mov_b32 v53, 0
    v_mov_b32 v54, 0
    v_mov_b32 v55, 0
    v_mov_b32 v56, 0
    v_mov_b32 v57, 0
    v_mov_b32 v58, 0
    v_mov_b32 v59, 0
    v_mov_b32 v60, 0
    v_mov_b32 v61, 0
    v_mov_b32 v62, 0
    v_mov_b32 v63, 0
    v_mov_b32 v64, 0
    v_mov_b32 v65, 0
    v_mov_b32 v66, 0
    v_mov_b32 v67, 0
    v_mov_b32 v68, 0
    v_mov_b32 v69, 0
    v_mov_b32 v70, 0
    v_mov_b32 v71, 0
    v_mov_b32 v72, 0
    v_mov_b32 v73, 0
    v_mov_b32 v74, 0
    v_mov_b32 v75, 0
    v_mov_b32 v76, 0
    v_mov_b32 v77, 0
    v_mov_b32 v78, 0
    v_mov_b32 v79, 0
    v_mov_b32 v80, 0
    v_mov_b32 v81, 0
    v_mov_b32 v82, 0
    v_mov_b32 v83, 0
    s_barrier
    s_add_u32 s6, s28, 2
    s_cmp_lt_u32 s93, s6
    s_cbranch_scc1 .kf_59
.kb_60:
    s_add_u32 s4, s38, 4096
    s_add_u32 s5, s39, 1024
    s_mov_b32 m0, 20480
    s_nop 0
    buffer_load_dwordx4 v224, s[8:11], s38 offen lds

    s_mov_b32 m0, 21504
    s_nop 0
    buffer_load_dwordx4 v225, s[8:11], s38 offen lds

    s_mov_b32 m0, 22528
    s_nop 0
    buffer_load_dwordx4 v226, s[8:11], s38 offen lds

    s_mov_b32 m0, 23552
    s_nop 0
    buffer_load_dwordx4 v227, s[8:11], s38 offen lds

    s_mov_b32 m0, 28672
    s_nop 0
    buffer_load_dwordx4 v14, s[8:11], s39 offen lds

    s_mov_b64 exec, s[90:91]
    buffer_store_dwordx4 v[212:215], v11, s[8:11], s36 offen sc1
    s_mov_b64 exec, -1
    s_mov_b64 exec, s[56:57]
    buffer_store_dwordx4 v[220:223], v12, s[8:11], s36 offen sc1
    s_mov_b64 exec, -1
    s_add_u32 s4, s70, 0
    buffer_store_dwordx4 v[188:191], v238, s[8:11], s4 offen sc1
    s_add_u32 s4, s70, 524288
    buffer_store_dwordx4 v[188:191], v238, s[8:11], s4 offen sc1
    s_add_u32 s28, s28, 1
    s_add_u32 s36, s36, 196608
    s_add_u32 s38, s38, 262144
    s_add_u32 s39, s39, 262144
    s_mov_b32 s4, s68
    s_mov_b32 s68, s69
    s_mov_b32 s69, s70
    s_mov_b32 s70, s71
    s_mov_b32 s71, s4

    s_and_b32 s4, s28, 3
    s_lshl_b32 s5, s4, 16
    s_add_u32 s29, s5, s34
    s_xor_b32 s6, s5, 0x20000
    s_add_u32 s31, s6, s34
    s_add_u32 s32, s29, 16384
    s_add_u32 s33, s29, 20480

    s_waitcnt lgkmcnt(0)
    s_barrier
    s_branch .top0_29
.pf_32:
    buffer_load_dwordx4 v[20:23], v8, s[8:11], s29 offen offset:0 sc1
    s_bitset1_b32 s63, 0
    s_branch .pr_36
.pf_33:
    buffer_load_dwordx4 v[24:27], v8, s[8:11], s29 offen offset:1024 sc1
    s_bitset1_b32 s63, 1
    s_branch .pr_37
.pf_34:
    buffer_load_dwordx4 v[28:31], v8, s[8:11], s29 offen offset:2048 sc1
    s_bitset1_b32 s63, 2
    s_branch .pr_38
.pf_35:
    buffer_load_dwordx4 v[32:35], v8, s[8:11], s29 offen offset:3072 sc1
    s_bitset1_b32 s63, 3
    s_branch .pr_39
.ps_31:
    s_add_u32 s62, s62, 1
    s_cmp_gt_u32 s62, 0x400000
    s_cbranch_scc1 .mg_end_1
    s_bitcmp1_b32 s63, 0
    s_cbranch_scc1 .pw_61
    s_bitcmp1_b32 s63, 1
    s_cbranch_scc1 .pw_62
    s_bitcmp1_b32 s63, 2
    s_cbranch_scc1 .pw_63
.pw_64:
    s_waitcnt vmcnt(0)
    v_max_u32 v4, v32, v34
    v_cmp_eq_u32 vcc, -1, v4
    s_cbranch_vccnz .pg_72
    v_smfmac_f32_16x16x64_bf16 v[52:55], v[32:35], a[24:31], v9
    v_smfmac_f32_16x16x64_bf16 v[56:59], v[32:35], a[56:63], v9
    v_smfmac_f32_16x16x64_bf16 v[60:63], v[32:35], a[88:95], v9
    v_smfmac_f32_16x16x64_bf16 v[64:67], v[32:35], a[120:127], v9
    s_xor_b32 s63, s63, 8
    s_cbranch_scc0 .pd_30
    s_branch .ps_31
.pw_63:
    s_waitcnt vmcnt(0)
    v_max_u32 v4, v28, v30
    v_cmp_eq_u32 vcc, -1, v4
    s_cbranch_vccnz .pg_71
    v_smfmac_f32_16x16x64_bf16 v[52:55], v[28:31], a[16:23], v9
    v_smfmac_f32_16x16x64_bf16 v[56:59], v[28:31], a[48:55], v9
    v_smfmac_f32_16x16x64_bf16 v[60:63], v[28:31], a[80:87], v9
    v_smfmac_f32_16x16x64_bf16 v[64:67], v[28:31], a[112:119], v9
    s_xor_b32 s63, s63, 4
    s_cbranch_scc0 .pd_30
    s_branch .pn_68
.pw_62:
    s_waitcnt vmcnt(0)
    v_max_u32 v4, v24, v26
    v_cmp_eq_u32 vcc, -1, v4
    s_cbranch_vccnz .pg_70
    v_smfmac_f32_16x16x64_bf16 v[52:55], v[24:27], a[8:15], v9
    v_smfmac_f32_16x16x64_bf16 v[56:59], v[24:27], a[40:47], v9
    v_smfmac_f32_16x16x64_bf16 v[60:63], v[24:27], a[72:79], v9
    v_smfmac_f32_16x16x64_bf16 v[64:67], v[24:27], a[104:111], v9
    s_xor_b32 s63, s63, 2
    s_cbranch_scc0 .pd_30
    s_branch .pn_67
.pw_61:
    s_waitcnt vmcnt(0)
    v_max_u32 v4, v20, v22
    v_cmp_eq_u32 vcc, -1, v4
    s_cbranch_vccnz .pg_69
    v_smfmac_f32_16x16x64_bf16 v[52:55], v[20:23], a[0:7], v9
    v_smfmac_f32_16x16x64_bf16 v[56:59], v[20:23], a[32:39], v9
    v_smfmac_f32_16x16x64_bf16 v[60:63], v[20:23], a[64:71], v9
    v_smfmac_f32_16x16x64_bf16 v[64:67], v[20:23], a[96:103], v9
    s_xor_b32 s63, s63, 1
    s_cbranch_scc0 .pd_30
    s_branch .pn_66
.pn_66:
    s_bitcmp1_b32 s63, 1
    s_cbranch_scc0 .pn_67
    v_max_u32 v4, v24, v26
    v_cmp_eq_u32 vcc, -1, v4
    s_cbranch_vccnz .pg_70
    v_smfmac_f32_16x16x64_bf16 v[52:55], v[24:27], a[8:15], v9
    v_smfmac_f32_16x16x64_bf16 v[56:59], v[24:27], a[40:47], v9
    v_smfmac_f32_16x16x64_bf16 v[60:63], v[24:27], a[72:79], v9
    v_smfmac_f32_16x16x64_bf16 v[64:67], v[24:27], a[104:111], v9
    s_xor_b32 s63, s63, 2
    s_cbranch_scc0 .pd_30
.pn_67:
    s_bitcmp1_b32 s63, 2
    s_cbranch_scc0 .pn_68
    v_max_u32 v4, v28, v30
    v_cmp_eq_u32 vcc, -1, v4
    s_cbranch_vccnz .pg_71
    v_smfmac_f32_16x16x64_bf16 v[52:55], v[28:31], a[16:23], v9
    v_smfmac_f32_16x16x64_bf16 v[56:59], v[28:31], a[48:55], v9
    v_smfmac_f32_16x16x64_bf16 v[60:63], v[28:31], a[80:87], v9
    v_smfmac_f32_16x16x64_bf16 v[64:67], v[28:31], a[112:119], v9
    s_xor_b32 s63, s63, 4
    s_cbranch_scc0 .pd_30
.pn_68:
    s_bitcmp1_b32 s63, 3
    s_cbranch_scc0 .ps_31
    v_max_u32 v4, v32, v34
    v_cmp_eq_u32 vcc, -1, v4
    s_cbranch_vccnz .pg_72
    v_smfmac_f32_16x16x64_bf16 v[52:55], v[32:35], a[24:31], v9
    v_smfmac_f32_16x16x64_bf16 v[56:59], v[32:35], a[56:63], v9
    v_smfmac_f32_16x16x64_bf16 v[60:63], v[32:35], a[88:95], v9
    v_smfmac_f32_16x16x64_bf16 v[64:67], v[32:35], a[120:127], v9
    s_xor_b32 s63, s63, 8
    s_cbranch_scc0 .pd_30
    s_branch .ps_31
.pg_69:
    buffer_load_dwordx4 v[20:23], v8, s[8:11], s29 offen offset:0 sc1
    s_branch .pn_66
.pg_70:
    buffer_load_dwordx4 v[24:27], v8, s[8:11], s29 offen offset:1024 sc1
    s_branch .pn_67
.pg_71:
    buffer_load_dwordx4 v[28:31], v8, s[8:11], s29 offen offset:2048 sc1
    s_branch .pn_68
.pg_72:
    buffer_load_dwordx4 v[32:35], v8, s[8:11], s29 offen offset:3072 sc1
    s_branch .ps_31
.last_40:
    s_mov_b64 exec, s[90:91]
    buffer_store_dwordx4 v[212:215], v11, s[8:11], s36 offen sc1
    s_mov_b64 exec, -1
    s_mov_b64 exec, s[56:57]
    buffer_store_dwordx4 v[220:223], v12, s[8:11], s36 offen sc1
    s_mov_b64 exec, -1
    s_branch .rec_fin_5
.pf_43:
    buffer_load_dwordx4 v[20:23], v246, s[8:11], s32 offen offset:0 sc1
    s_bitset1_b32 s63, 0
    s_branch .pr_51
.pf_44:
    buffer_load_dwordx4 v[24:27], v246, s[8:11], s32 offen offset:1024 sc1
    s_bitset1_b32 s63, 1
    s_branch .pr_52
.pf_45:
    buffer_load_dwordx4 v[28:31], v246, s[8:11], s32 offen offset:2048 sc1
    s_bitset1_b32 s63, 2
    s_branch .pr_53
.pf_46:
    buffer_load_dwordx4 v[32:35], v246, s[8:11], s32 offen offset:3072 sc1
    s_bitset1_b32 s63, 3
    s_branch .pr_54
.pf_47:
    buffer_load_dwordx4 v[36:39], v246, s[8:11], s33 offen offset:0 sc1
    s_bitset1_b32 s63, 4
    s_branch .pr_55
.pf_48:
    buffer_load_dwordx4 v[40:43], v246, s[8:11], s33 offen offset:1024 sc1
    s_bitset1_b32 s63, 5
    s_branch .pr_56
.pf_49:
    buffer_load_dwordx4 v[44:47], v246, s[8:11], s33 offen offset:2048 sc1
    s_bitset1_b32 s63, 6
    s_branch .pr_57
.pf_50:
    buffer_load_dwordx4 v[48:51], v246, s[8:11], s33 offen offset:3072 sc1
    s_bitset1_b32 s63, 7
    s_branch .pr_58
.ps_42:
    s_add_u32 s62, s62, 1
    s_cmp_gt_u32 s62, 0x400000
    s_cbranch_scc1 .mg_end_1
    s_bitcmp1_b32 s63, 0
    s_cbranch_scc1 .pw_73
    s_bitcmp1_b32 s63, 1
    s_cbranch_scc1 .pw_74
    s_bitcmp1_b32 s63, 2
    s_cbranch_scc1 .pw_75
    s_bitcmp1_b32 s63, 3
    s_cbranch_scc1 .pw_76
    s_bitcmp1_b32 s63, 4
    s_cbranch_scc1 .pw_77
    s_bitcmp1_b32 s63, 5
    s_cbranch_scc1 .pw_78
    s_bitcmp1_b32 s63, 6
    s_cbranch_scc1 .pw_79
.pw_80:
    s_waitcnt vmcnt(0)
    v_cmp_eq_u32 vcc, -1, v48
    s_cbranch_vccnz .pg_96
    v_smfmac_f32_16x16x64_bf16 v[76:79], v[48:51], v[148:155], v9
    v_smfmac_f32_16x16x64_bf16 v[80:83], v[48:51], v[180:187], v9
    s_xor_b32 s63, s63, 128
    s_cbranch_scc0 .pd_41
    s_branch .ps_42
.pw_79:
    s_waitcnt vmcnt(0)
    v_cmp_eq_u32 vcc, -1, v44
    s_cbranch_vccnz .pg_95
    v_smfmac_f32_16x16x64_bf16 v[76:79], v[44:47], v[140:147], v9
    v_smfmac_f32_16x16x64_bf16 v[80:83], v[44:47], v[172:179], v9
    s_xor_b32 s63, s63, 64
    s_cbranch_scc0 .pd_41
    s_branch .pn_88
.pw_78:
    s_waitcnt vmcnt(0)
    v_cmp_eq_u32 vcc, -1, v40
    s_cbranch_vccnz .pg_94
    v_smfmac_f32_16x16x64_bf16 v[76:79], v[40:43], v[132:139], v9
    v_smfmac_f32_16x16x64_bf16 v[80:83], v[40:43], v[164:171], v9
    s_xor_b32 s63, s63, 32
    s_cbranch_scc0 .pd_41
    s_branch .pn_87
.pw_77:
    s_waitcnt vmcnt(0)
    v_cmp_eq_u32 vcc, -1, v36
    s_cbranch_vccnz .pg_93
    v_smfmac_f32_16x16x64_bf16 v[76:79], v[36:39], v[124:131], v9
    v_smfmac_f32_16x16x64_bf16 v[80:83], v[36:39], v[156:163], v9
    s_xor_b32 s63, s63, 16
    s_cbranch_scc0 .pd_41
    s_branch .pn_86
.pw_76:
    s_waitcnt vmcnt(0)
    v_cmp_eq_u32 vcc, -1, v32
    s_cbranch_vccnz .pg_92
    v_smfmac_f32_16x16x64_bf16 v[76:79], v[32:35], a[216:223], v9
    v_smfmac_f32_16x16x64_bf16 v[80:83], v[32:35], a[248:255], v9
    s_xor_b32 s63, s63, 8
    s_cbranch_scc0 .pd_41
    s_branch .pn_85
.pw_75:
    s_waitcnt vmcnt(0)
    v_cmp_eq_u32 vcc, -1, v28
    s_cbranch_vccnz .pg_91
    v_smfmac_f32_16x16x64_bf16 v[76:79], v[28:31], a[208:215], v9
    v_smfmac_f32_16x16x64_bf16 v[80:83], v[28:31], a[240:247], v9
    s_xor_b32 s63, s63, 4
    s_cbranch_scc0 .pd_41
    s_branch .pn_84
.pw_74:
    s_waitcnt vmcnt(0)
    v_cmp_eq_u32 vcc, -1, v24
    s_cbranch_vccnz .pg_90
    v_smfmac_f32_16x16x64_bf16 v[76:79], v[24:27], a[200:207], v9
    v_smfmac_f32_16x16x64_bf16 v[80:83], v[24:27], a[232:239], v9
    s_xor_b32 s63, s63, 2
    s_cbranch_scc0 .pd_41
    s_branch .pn_83
.pw_73:
    s_waitcnt vmcnt(0)
    v_cmp_eq_u32 vcc, -1, v20
    s_cbranch_vccnz .pg_89
    v_smfmac_f32_16x16x64_bf16 v[76:79], v[20:23], a[192:199], v9
    v_smfmac_f32_16x16x64_bf16 v[80:83], v[20:23], a[224:231], v9
    s_xor_b32 s63, s63, 1
    s_cbranch_scc0 .pd_41
    s_branch .pn_82
.pn_82:
    s_bitcmp1_b32 s63, 1
    s_cbranch_scc0 .pn_83
    v_cmp_eq_u32 vcc, -1, v24
    s_cbranch_vccnz .pg_90
    v_smfmac_f32_16x16x64_bf16 v[76:79], v[24:27], a[200:207], v9
    v_smfmac_f32_16x16x64_bf16 v[80:83], v[24:27], a[232:239], v9
    s_xor_b32 s63, s63, 2
    s_cbranch_scc0 .pd_41
.pn_83:
    s_bitcmp1_b32 s63, 2
    s_cbranch_scc0 .pn_84
    v_cmp_eq_u32 vcc, -1, v28
    s_cbranch_vccnz .pg_91
    v_smfmac_f32_16x16x64_bf16 v[76:79], v[28:31], a[208:215], v9
    v_smfmac_f32_16x16x64_bf16 v[80:83], v[28:31], a[240:247], v9
    s_xor_b32 s63, s63, 4
    s_cbranch_scc0 .pd_41
.pn_84:
    s_bitcmp1_b32 s63, 3
    s_cbranch_scc0 .pn_85
    v_cmp_eq_u32 vcc, -1, v32
    s_cbranch_vccnz .pg_92
    v_smfmac_f32_16x16x64_bf16 v[76:79], v[32:35], a[216:223], v9
    v_smfmac_f32_16x16x64_bf16 v[80:83], v[32:35], a[248:255], v9
    s_xor_b32 s63, s63, 8
    s_cbranch_scc0 .pd_41
.pn_85:
    s_bitcmp1_b32 s63, 4
    s_cbranch_scc0 .pn_86
    v_cmp_eq_u32 vcc, -1, v36
    s_cbranch_vccnz .pg_93
    v_smfmac_f32_16x16x64_bf16 v[76:79], v[36:39], v[124:131], v9
    v_smfmac_f32_16x16x64_bf16 v[80:83], v[36:39], v[156:163], v9
    s_xor_b32 s63, s63, 16
    s_cbranch_scc0 .pd_41
.pn_86:
    s_bitcmp1_b32 s63, 5
    s_cbranch_scc0 .pn_87
    v_cmp_eq_u32 vcc, -1, v40
    s_cbranch_vccnz .pg_94
    v_smfmac_f32_16x16x64_bf16 v[76:79], v[40:43], v[132:139], v9
    v_smfmac_f32_16x16x64_bf16 v[80:83], v[40:43], v[164:171], v9
    s_xor_b32 s63, s63, 32
    s_cbranch_scc0 .pd_41
.pn_87:
    s_bitcmp1_b32 s63, 6
    s_cbranch_scc0 .pn_88
    v_cmp_eq_u32 vcc, -1, v44
    s_cbranch_vccnz .pg_95
    v_smfmac_f32_16x16x64_bf16 v[76:79], v[44:47], v[140:147], v9
    v_smfmac_f32_16x16x64_bf16 v[80:83], v[44:47], v[172:179], v9
    s_xor_b32 s63, s63, 64
    s_cbranch_scc0 .pd_41
.pn_88:
    s_bitcmp1_b32 s63, 7
    s_cbranch_scc0 .ps_42
    v_cmp_eq_u32 vcc, -1, v48
    s_cbranch_vccnz .pg_96
    v_smfmac_f32_16x16x64_bf16 v[76:79], v[48:51], v[148:155], v9
    v_smfmac_f32_16x16x64_bf16 v[80:83], v[48:51], v[180:187], v9
    s_xor_b32 s63, s63, 128
    s_cbranch_scc0 .pd_41
    s_branch .ps_42
.pg_89:
    buffer_load_dwordx4 v[20:23], v246, s[8:11], s32 offen offset:0 sc1
    s_branch .pn_82
.pg_90:
    buffer_load_dwordx4 v[24:27], v246, s[8:11], s32 offen offset:1024 sc1
    s_branch .pn_83
.pg_91:
    buffer_load_dwordx4 v[28:31], v246, s[8:11], s32 offen offset:2048 sc1
    s_branch .pn_84
.pg_92:
    buffer_load_dwordx4 v[32:35], v246, s[8:11], s32 offen offset:3072 sc1
    s_branch .pn_85
.pg_93:
    buffer_load_dwordx4 v[36:39], v246, s[8:11], s33 offen offset:0 sc1
    s_branch .pn_86
.pg_94:
    buffer_load_dwordx4 v[40:43], v246, s[8:11], s33 offen offset:1024 sc1
    s_branch .pn_87
.pg_95:
    buffer_load_dwordx4 v[44:47], v246, s[8:11], s33 offen offset:2048 sc1
    s_branch .pn_88
.pg_96:
    buffer_load_dwordx4 v[48:51], v246, s[8:11], s33 offen offset:3072 sc1
    s_branch .ps_42
.kf_59:
    s_mov_b32 s62, 0
    s_mov_b64 exec, 3
.wf_97:
    buffer_load_dword v4, v253, s[8:11], s89 offen sc1
    s_waitcnt vmcnt(0)
    v_cmp_gt_u32 vcc, s6, v4
    s_cbranch_vccz .wfd_98
    s_sleep 2
    s_add_u32 s62, s62, 1
    s_cmp_gt_u32 s62, 0x400000
    s_cbranch_scc1 .mg_end_1
    s_branch .wf_97

.wfd_98:
    s_mov_b64 exec, -1
    v_readlane_b32 s4, v4, 0
    v_readlane_b32 s93, v4, 1
    s_min_u32 s93, s93, s4
    s_branch .kb_60
.p2align 6
.top1_99:
    buffer_load_dwordx4 v[20:23], v8, s[8:11], s29 offen offset:0 sc1
    s_nop 11
    buffer_load_dwordx4 v[24:27], v8, s[8:11], s29 offen offset:1024 sc1
    s_nop 11
    buffer_load_dwordx4 v[28:31], v8, s[8:11], s29 offen offset:2048 sc1
    s_nop 11
    buffer_load_dwordx4 v[32:35], v8, s[8:11], s29 offen offset:3072 sc1
.ent01_22:
    s_waitcnt vmcnt(3)
    v_max_u32 v4, v20, v22
    v_cmp_eq_u32 vcc, -1, v4
    s_cbranch_vccnz .pf_102
    v_smfmac_f32_16x16x64_bf16 v[52:55], v[20:23], a[0:7], v9
    v_smfmac_f32_16x16x64_bf16 v[56:59], v[20:23], a[32:39], v9
    v_smfmac_f32_16x16x64_bf16 v[60:63], v[20:23], a[64:71], v9
    v_smfmac_f32_16x16x64_bf16 v[64:67], v[20:23], a[96:103], v9
.pr_106:
    s_waitcnt vmcnt(2)
    v_max_u32 v4, v24, v26
    v_cmp_eq_u32 vcc, -1, v4
    s_cbranch_vccnz .pf_103
    v_smfmac_f32_16x16x64_bf16 v[52:55], v[24:27], a[8:15], v9
    v_smfmac_f32_16x16x64_bf16 v[56:59], v[24:27], a[40:47], v9
    v_smfmac_f32_16x16x64_bf16 v[60:63], v[24:27], a[72:79], v9
    v_smfmac_f32_16x16x64_bf16 v[64:67], v[24:27], a[104:111], v9
.pr_107:
    s_waitcnt vmcnt(1)
    v_max_u32 v4, v28, v30
    v_cmp_eq_u32 vcc, -1, v4
    s_cbranch_vccnz .pf_104
    v_smfmac_f32_16x16x64_bf16 v[52:55], v[28:31], a[16:23], v9
    v_smfmac_f32_16x16x64_bf16 v[56:59], v[28:31], a[48:55], v9
    v_smfmac_f32_16x16x64_bf16 v[60:63], v[28:31], a[80:87], v9
    v_smfmac_f32_16x16x64_bf16 v[64:67], v[28:31], a[112:119], v9
.pr_108:
    s_waitcnt vmcnt(0)
    v_max_u32 v4, v32, v34
    v_cmp_eq_u32 vcc, -1, v4
    s_cbranch_vccnz .pf_105
    v_smfmac_f32_16x16x64_bf16 v[52:55], v[32:35], a[24:31], v9
    v_smfmac_f32_16x16x64_bf16 v[56:59], v[32:35], a[56:63], v9
    v_smfmac_f32_16x16x64_bf16 v[60:63], v[32:35], a[88:95], v9
    v_smfmac_f32_16x16x64_bf16 v[64:67], v[32:35], a[120:127], v9
.pr_109:
    s_cmp_lg_u32 s63, 0
    s_cbranch_scc1 .ps_101
.pd_100:
    v_cvt_pk_bf16_f32 v104, v52, v53
    v_cvt_pk_bf16_f32 v105, v54, v55
    v_cvt_pk_bf16_f32 v106, v56, v57
    v_cvt_pk_bf16_f32 v107, v58, v59
    ds_write_b64 v16, v[104:105] offset:4096
    v_cvt_pk_bf16_f32 v108, v60, v61
    v_cvt_pk_bf16_f32 v109, v62, v63
    ds_write_b64 v16, v[106:107] offset:6144
    ds_write_b64 v16, v[108:109] offset:0
    s_nop 0
    v_cvt_pk_bf16_f32 v110, v64, v65
    v_cvt_pk_bf16_f32 v111, v66, v67
    ds_write_b64 v16, v[110:111] offset:2048
    v_smfmac_f32_16x16x64_bf16 v[68:71], v[20:23], a[128:135], v9
    v_smfmac_f32_16x16x64_bf16 v[72:75], v[20:23], a[160:167], v9
    s_waitcnt lgkmcnt(0)
    s_barrier
    ds_read_b128 v[36:39], v14 offset:2048
    ds_read_b128 v[40:43], v14 offset:3072
    v_smfmac_f32_16x16x64_bf16 v[68:71], v[24:27], a[136:143], v9
    v_smfmac_f32_16x16x64_bf16 v[72:75], v[24:27], a[168:175], v9
    s_waitcnt lgkmcnt(1)
    v_mfma_f32_16x16x32_bf16 v[44:47], v[36:39], v[84:87], 0
    s_waitcnt lgkmcnt(0)
    v_mfma_f32_16x16x32_bf16 v[44:47], v[40:43], v[84:87], v[44:47]
    v_smfmac_f32_16x16x64_bf16 v[68:71], v[28:31], a[144:151], v9
    v_smfmac_f32_16x16x64_bf16 v[72:75], v[28:31], a[176:183], v9
    s_mov_b64 exec, s[66:67]
    v_cvt_pk_bf16_f32 v48, v44, v45
    v_cvt_pk_bf16_f32 v49, v46, v47
    v_min_u32 v48, 0xfffffffe, v48
    buffer_store_dwordx2 v[48:49], v10, s[8:11], s29 offen

    ds_write_b64 v18, v[48:49]
    s_mov_b64 exec, -1

    v_smfmac_f32_16x16x64_bf16 v[68:71], v[32:35], a[152:159], v9
    v_smfmac_f32_16x16x64_bf16 v[72:75], v[32:35], a[184:191], v9
    s_nop 3
    v_cvt_pk_bf16_f32 v104, v68, v69
    v_cvt_pk_bf16_f32 v105, v70, v71
    ds_write_b64 v16, v[104:105] offset:8192
    s_nop 0
    v_cvt_pk_bf16_f32 v106, v72, v73
    v_cvt_pk_bf16_f32 v107, v74, v75
    ds_write_b64 v16, v[106:107] offset:10240
    s_waitcnt lgkmcnt(0)
    s_barrier
    v_mov_b32 v212, v48
    v_min_u32 v213, 0xfffffffe, v49
    v_mov_b32 v214, v48
    v_min_u32 v215, 0xfffffffe, v49
    s_nop 1
    v_permlane16_swap_b32 v212, v214
    v_permlane16_swap_b32 v213, v215

    s_cmp_eq_u32 s28, 63
    s_cbranch_scc1 .last_110
    s_barrier
    buffer_store_dwordx4 v[188:191], v236, s[8:11], s31 offen
    s_barrier
    s_nop 15
    buffer_load_dwordx4 v[20:23], v246, s[8:11], s32 offen offset:0 sc1
    s_nop 3
    buffer_load_dwordx4 v[24:27], v246, s[8:11], s32 offen offset:1024 sc1
    s_nop 3
    buffer_load_dwordx4 v[28:31], v246, s[8:11], s32 offen offset:2048 sc1
    s_nop 3
    buffer_load_dwordx4 v[32:35], v246, s[8:11], s32 offen offset:3072 sc1
    s_nop 3
    buffer_load_dwordx4 v[36:39], v246, s[8:11], s33 offen offset:0 sc1
    s_nop 3
    buffer_load_dwordx4 v[40:43], v246, s[8:11], s33 offen offset:1024 sc1
    s_nop 3
    buffer_load_dwordx4 v[44:47], v246, s[8:11], s33 offen offset:2048 sc1
    s_nop 3
    buffer_load_dwordx4 v[48:51], v246, s[8:11], s33 offen offset:3072 sc1
    s_waitcnt vmcnt(7)
    v_cmp_eq_u32 vcc, -1, v20
    s_cbranch_vccnz .pf_113
    v_smfmac_f32_16x16x64_bf16 v[76:79], v[20:23], a[192:199], v9
    v_smfmac_f32_16x16x64_bf16 v[80:83], v[20:23], a[224:231], v9
.pr_121:
    s_waitcnt vmcnt(6)
    v_cmp_eq_u32 vcc, -1, v24
    s_cbranch_vccnz .pf_114
    v_smfmac_f32_16x16x64_bf16 v[76:79], v[24:27], a[200:207], v9
    v_smfmac_f32_16x16x64_bf16 v[80:83], v[24:27], a[232:239], v9
.pr_122:
    s_waitcnt vmcnt(5)
    v_cmp_eq_u32 vcc, -1, v28
    s_cbranch_vccnz .pf_115
    v_smfmac_f32_16x16x64_bf16 v[76:79], v[28:31], a[208:215], v9
    v_smfmac_f32_16x16x64_bf16 v[80:83], v[28:31], a[240:247], v9
.pr_123:
    s_waitcnt vmcnt(4)
    v_cmp_eq_u32 vcc, -1, v32
    s_cbranch_vccnz .pf_116
    v_smfmac_f32_16x16x64_bf16 v[76:79], v[32:35], a[216:223], v9
    v_smfmac_f32_16x16x64_bf16 v[80:83], v[32:35], a[248:255], v9
.pr_124:
    s_waitcnt vmcnt(3)
    v_cmp_eq_u32 vcc, -1, v36
    s_cbranch_vccnz .pf_117
    v_smfmac_f32_16x16x64_bf16 v[76:79], v[36:39], v[124:131], v9
    v_smfmac_f32_16x16x64_bf16 v[80:83], v[36:39], v[156:163], v9
.pr_125:
    s_waitcnt vmcnt(2)
    v_cmp_eq_u32 vcc, -1, v40
    s_cbranch_vccnz .pf_118
    v_smfmac_f32_16x16x64_bf16 v[76:79], v[40:43], v[132:139], v9
    v_smfmac_f32_16x16x64_bf16 v[80:83], v[40:43], v[164:171], v9
.pr_126:
    s_waitcnt vmcnt(1)
    v_cmp_eq_u32 vcc, -1, v44
    s_cbranch_vccnz .pf_119
    v_smfmac_f32_16x16x64_bf16 v[76:79], v[44:47], v[140:147], v9
    v_smfmac_f32_16x16x64_bf16 v[80:83], v[44:47], v[172:179], v9
.pr_127:
    s_waitcnt vmcnt(0)
    v_cmp_eq_u32 vcc, -1, v48
    s_cbranch_vccnz .pf_120
    v_smfmac_f32_16x16x64_bf16 v[76:79], v[48:51], v[148:155], v9
    v_smfmac_f32_16x16x64_bf16 v[80:83], v[48:51], v[180:187], v9
.pr_128:
    s_cmp_lg_u32 s63, 0
    s_cbranch_scc1 .ps_112
.pd_111:
    s_nop 5
    v_permlane32_swap_b32 v76, v80
    v_permlane32_swap_b32 v77, v81
    v_permlane32_swap_b32 v78, v82
    v_permlane32_swap_b32 v79, v83
    v_add_f32 v76, v76, v80
    v_add_f32 v77, v77, v81
    v_add_f32 v78, v78, v82
    v_add_f32 v79, v79, v83
    v_cvt_pk_bf16_f32 v104, v76, v77
    v_cvt_pk_bf16_f32 v106, v76, v77
    v_cvt_pk_bf16_f32 v105, v78, v79
    v_cvt_pk_bf16_f32 v107, v78, v79
    v_permlane16_swap_b32 v104, v106
    s_nop 0
    v_permlane16_swap_b32 v105, v107
    v_min_u32 v104, 0xfffffffe, v104
    buffer_store_dwordx4 v[104:107], v237, s[8:11], s68 offen sc1

    s_add_u32 s4, s68, 524288
    buffer_store_dwordx4 v[104:107], v237, s[8:11], s4 offen sc1
    ds_write_b128 v247, v[104:107]
    s_waitcnt lgkmcnt(0)
    s_barrier
    v_mov_b32 v52, 0
    v_mov_b32 v53, 0
    v_mov_b32 v54, 0
    v_mov_b32 v55, 0
    v_mov_b32 v56, 0
    v_mov_b32 v57, 0
    v_mov_b32 v58, 0
    v_mov_b32 v59, 0
    v_mov_b32 v60, 0
    v_mov_b32 v61, 0
    v_mov_b32 v62, 0
    v_mov_b32 v63, 0
    v_mov_b32 v64, 0
    v_mov_b32 v65, 0
    v_mov_b32 v66, 0
    v_mov_b32 v67, 0
    v_mov_b32 v68, 0
    v_mov_b32 v69, 0
    v_mov_b32 v70, 0
    v_mov_b32 v71, 0
    v_mov_b32 v72, 0
    v_mov_b32 v73, 0
    v_mov_b32 v74, 0
    v_mov_b32 v75, 0
    v_mov_b32 v76, 0
    v_mov_b32 v77, 0
    v_mov_b32 v78, 0
    v_mov_b32 v79, 0
    v_mov_b32 v80, 0
    v_mov_b32 v81, 0
    v_mov_b32 v82, 0
    v_mov_b32 v83, 0
    s_barrier
    s_add_u32 s6, s28, 2
    s_cmp_lt_u32 s93, s6
    s_cbranch_scc1 .kf_129
.kb_130:
    s_add_u32 s4, s38, 4096
    s_add_u32 s5, s39, 1024
    s_mov_b32 m0, 24576
    s_nop 0
    buffer_load_dwordx4 v224, s[8:11], s4 offen lds

    s_mov_b32 m0, 25600
    s_nop 0
    buffer_load_dwordx4 v225, s[8:11], s4 offen lds

    s_mov_b32 m0, 26624
    s_nop 0
    buffer_load_dwordx4 v226, s[8:11], s4 offen lds

    s_mov_b32 m0, 27648
    s_nop 0
    buffer_load_dwordx4 v227, s[8:11], s4 offen lds

    s_mov_b32 m0, 29696
    s_nop 0
    buffer_load_dwordx4 v14, s[8:11], s5 offen lds

    s_mov_b64 exec, s[90:91]
    buffer_store_dwordx4 v[212:215], v11, s[8:11], s36 offen sc1
    s_mov_b64 exec, -1
    s_add_u32 s4, s70, 262144
    buffer_store_dwordx4 v[188:191], v238, s[8:11], s4 offen sc1
    s_add_u32 s4, s70, 786432
    buffer_store_dwordx4 v[188:191], v238, s[8:11], s4 offen sc1
    s_add_u32 s28, s28, 1
    s_add_u32 s36, s36, 196608
    s_add_u32 s38, s38, 262144
    s_add_u32 s39, s39, 262144
    s_mov_b32 s4, s68
    s_mov_b32 s68, s69
    s_mov_b32 s69, s70
    s_mov_b32 s70, s71
    s_mov_b32 s71, s4

    s_and_b32 s4, s28, 3
    s_lshl_b32 s5, s4, 16
    s_add_u32 s29, s5, s34
    s_xor_b32 s6, s5, 0x20000
    s_add_u32 s31, s6, s34
    s_add_u32 s32, s29, 16384
    s_add_u32 s33, s29, 20480

    s_waitcnt lgkmcnt(0)
    s_barrier
    s_branch .top1_99
.pf_102:
    buffer_load_dwordx4 v[20:23], v8, s[8:11], s29 offen offset:0 sc1
    s_bitset1_b32 s63, 0
    s_branch .pr_106
.pf_103:
    buffer_load_dwordx4 v[24:27], v8, s[8:11], s29 offen offset:1024 sc1
    s_bitset1_b32 s63, 1
    s_branch .pr_107
.pf_104:
    buffer_load_dwordx4 v[28:31], v8, s[8:11], s29 offen offset:2048 sc1
    s_bitset1_b32 s63, 2
    s_branch .pr_108
.pf_105:
    buffer_load_dwordx4 v[32:35], v8, s[8:11], s29 offen offset:3072 sc1
    s_bitset1_b32 s63, 3
    s_branch .pr_109
.ps_101:
    s_add_u32 s62, s62, 1
    s_cmp_gt_u32 s62, 0x400000
    s_cbranch_scc1 .mg_end_1
    s_bitcmp1_b32 s63, 0
    s_cbranch_scc1 .pw_131
    s_bitcmp1_b32 s63, 1
    s_cbranch_scc1 .pw_132
    s_bitcmp1_b32 s63, 2
    s_cbranch_scc1 .pw_133
.pw_134:
    s_waitcnt vmcnt(0)
    v_max_u32 v4, v32, v34
    v_cmp_eq_u32 vcc, -1, v4
    s_cbranch_vccnz .pg_142
    v_smfmac_f32_16x16x64_bf16 v[52:55], v[32:35], a[24:31], v9
    v_smfmac_f32_16x16x64_bf16 v[56:59], v[32:35], a[56:63], v9
    v_smfmac_f32_16x16x64_bf16 v[60:63], v[32:35], a[88:95], v9
    v_smfmac_f32_16x16x64_bf16 v[64:67], v[32:35], a[120:127], v9
    s_xor_b32 s63, s63, 8
    s_cbranch_scc0 .pd_100
    s_branch .ps_101
.pw_133:
    s_waitcnt vmcnt(0)
    v_max_u32 v4, v28, v30
    v_cmp_eq_u32 vcc, -1, v4
    s_cbranch_vccnz .pg_141
    v_smfmac_f32_16x16x64_bf16 v[52:55], v[28:31], a[16:23], v9
    v_smfmac_f32_16x16x64_bf16 v[56:59], v[28:31], a[48:55], v9
    v_smfmac_f32_16x16x64_bf16 v[60:63], v[28:31], a[80:87], v9
    v_smfmac_f32_16x16x64_bf16 v[64:67], v[28:31], a[112:119], v9
    s_xor_b32 s63, s63, 4
    s_cbranch_scc0 .pd_100
    s_branch .pn_138
.pw_132:
    s_waitcnt vmcnt(0)
    v_max_u32 v4, v24, v26
    v_cmp_eq_u32 vcc, -1, v4
    s_cbranch_vccnz .pg_140
    v_smfmac_f32_16x16x64_bf16 v[52:55], v[24:27], a[8:15], v9
    v_smfmac_f32_16x16x64_bf16 v[56:59], v[24:27], a[40:47], v9
    v_smfmac_f32_16x16x64_bf16 v[60:63], v[24:27], a[72:79], v9
    v_smfmac_f32_16x16x64_bf16 v[64:67], v[24:27], a[104:111], v9
    s_xor_b32 s63, s63, 2
    s_cbranch_scc0 .pd_100
    s_branch .pn_137
.pw_131:
    s_waitcnt vmcnt(0)
    v_max_u32 v4, v20, v22
    v_cmp_eq_u32 vcc, -1, v4
    s_cbranch_vccnz .pg_139
    v_smfmac_f32_16x16x64_bf16 v[52:55], v[20:23], a[0:7], v9
    v_smfmac_f32_16x16x64_bf16 v[56:59], v[20:23], a[32:39], v9
    v_smfmac_f32_16x16x64_bf16 v[60:63], v[20:23], a[64:71], v9
    v_smfmac_f32_16x16x64_bf16 v[64:67], v[20:23], a[96:103], v9
    s_xor_b32 s63, s63, 1
    s_cbranch_scc0 .pd_100
    s_branch .pn_136
.pn_136:
    s_bitcmp1_b32 s63, 1
    s_cbranch_scc0 .pn_137
    v_max_u32 v4, v24, v26
    v_cmp_eq_u32 vcc, -1, v4
    s_cbranch_vccnz .pg_140
    v_smfmac_f32_16x16x64_bf16 v[52:55], v[24:27], a[8:15], v9
    v_smfmac_f32_16x16x64_bf16 v[56:59], v[24:27], a[40:47], v9
    v_smfmac_f32_16x16x64_bf16 v[60:63], v[24:27], a[72:79], v9
    v_smfmac_f32_16x16x64_bf16 v[64:67], v[24:27], a[104:111], v9
    s_xor_b32 s63, s63, 2
    s_cbranch_scc0 .pd_100
.pn_137:
    s_bitcmp1_b32 s63, 2
    s_cbranch_scc0 .pn_138
    v_max_u32 v4, v28, v30
    v_cmp_eq_u32 vcc, -1, v4
    s_cbranch_vccnz .pg_141
    v_smfmac_f32_16x16x64_bf16 v[52:55], v[28:31], a[16:23], v9
    v_smfmac_f32_16x16x64_bf16 v[56:59], v[28:31], a[48:55], v9
    v_smfmac_f32_16x16x64_bf16 v[60:63], v[28:31], a[80:87], v9
    v_smfmac_f32_16x16x64_bf16 v[64:67], v[28:31], a[112:119], v9
    s_xor_b32 s63, s63, 4
    s_cbranch_scc0 .pd_100
.pn_138:
    s_bitcmp1_b32 s63, 3
    s_cbranch_scc0 .ps_101
    v_max_u32 v4, v32, v34
    v_cmp_eq_u32 vcc, -1, v4
    s_cbranch_vccnz .pg_142
    v_smfmac_f32_16x16x64_bf16 v[52:55], v[32:35], a[24:31], v9
    v_smfmac_f32_16x16x64_bf16 v[56:59], v[32:35], a[56:63], v9
    v_smfmac_f32_16x16x64_bf16 v[60:63], v[32:35], a[88:95], v9
    v_smfmac_f32_16x16x64_bf16 v[64:67], v[32:35], a[120:127], v9
    s_xor_b32 s63, s63, 8
    s_cbranch_scc0 .pd_100
    s_branch .ps_101
.pg_139:
    buffer_load_dwordx4 v[20:23], v8, s[8:11], s29 offen offset:0 sc1
    s_branch .pn_136
.pg_140:
    buffer_load_dwordx4 v[24:27], v8, s[8:11], s29 offen offset:1024 sc1
    s_branch .pn_137
.pg_141:
    buffer_load_dwordx4 v[28:31], v8, s[8:11], s29 offen offset:2048 sc1
    s_branch .pn_138
.pg_142:
    buffer_load_dwordx4 v[32:35], v8, s[8:11], s29 offen offset:3072 sc1
    s_branch .ps_101
.last_110:
    s_mov_b64 exec, s[90:91]
    buffer_store_dwordx4 v[212:215], v11, s[8:11], s36 offen sc1
    s_mov_b64 exec, -1
    s_branch .rec_fin_5
.pf_113:
    buffer_load_dwordx4 v[20:23], v246, s[8:11], s32 offen offset:0 sc1
    s_bitset1_b32 s63, 0
    s_branch .pr_121
.pf_114:
    buffer_load_dwordx4 v[24:27], v246, s[8:11], s32 offen offset:1024 sc1
    s_bitset1_b32 s63, 1
    s_branch .pr_122
.pf_115:
    buffer_load_dwordx4 v[28:31], v246, s[8:11], s32 offen offset:2048 sc1
    s_bitset1_b32 s63, 2
    s_branch .pr_123
.pf_116:
    buffer_load_dwordx4 v[32:35], v246, s[8:11], s32 offen offset:3072 sc1
    s_bitset1_b32 s63, 3
    s_branch .pr_124
.pf_117:
    buffer_load_dwordx4 v[36:39], v246, s[8:11], s33 offen offset:0 sc1
    s_bitset1_b32 s63, 4
    s_branch .pr_125
.pf_118:
    buffer_load_dwordx4 v[40:43], v246, s[8:11], s33 offen offset:1024 sc1
    s_bitset1_b32 s63, 5
    s_branch .pr_126
.pf_119:
    buffer_load_dwordx4 v[44:47], v246, s[8:11], s33 offen offset:2048 sc1
    s_bitset1_b32 s63, 6
    s_branch .pr_127
.pf_120:
    buffer_load_dwordx4 v[48:51], v246, s[8:11], s33 offen offset:3072 sc1
    s_bitset1_b32 s63, 7
    s_branch .pr_128
.ps_112:
    s_add_u32 s62, s62, 1
    s_cmp_gt_u32 s62, 0x400000
    s_cbranch_scc1 .mg_end_1
    s_bitcmp1_b32 s63, 0
    s_cbranch_scc1 .pw_143
    s_bitcmp1_b32 s63, 1
    s_cbranch_scc1 .pw_144
    s_bitcmp1_b32 s63, 2
    s_cbranch_scc1 .pw_145
    s_bitcmp1_b32 s63, 3
    s_cbranch_scc1 .pw_146
    s_bitcmp1_b32 s63, 4
    s_cbranch_scc1 .pw_147
    s_bitcmp1_b32 s63, 5
    s_cbranch_scc1 .pw_148
    s_bitcmp1_b32 s63, 6
    s_cbranch_scc1 .pw_149
.pw_150:
    s_waitcnt vmcnt(0)
    v_cmp_eq_u32 vcc, -1, v48
    s_cbranch_vccnz .pg_166
    v_smfmac_f32_16x16x64_bf16 v[76:79], v[48:51], v[148:155], v9
    v_smfmac_f32_16x16x64_bf16 v[80:83], v[48:51], v[180:187], v9
    s_xor_b32 s63, s63, 128
    s_cbranch_scc0 .pd_111
    s_branch .ps_112
.pw_149:
    s_waitcnt vmcnt(0)
    v_cmp_eq_u32 vcc, -1, v44
    s_cbranch_vccnz .pg_165
    v_smfmac_f32_16x16x64_bf16 v[76:79], v[44:47], v[140:147], v9
    v_smfmac_f32_16x16x64_bf16 v[80:83], v[44:47], v[172:179], v9
    s_xor_b32 s63, s63, 64
    s_cbranch_scc0 .pd_111
    s_branch .pn_158
.pw_148:
    s_waitcnt vmcnt(0)
    v_cmp_eq_u32 vcc, -1, v40
    s_cbranch_vccnz .pg_164
    v_smfmac_f32_16x16x64_bf16 v[76:79], v[40:43], v[132:139], v9
    v_smfmac_f32_16x16x64_bf16 v[80:83], v[40:43], v[164:171], v9
    s_xor_b32 s63, s63, 32
    s_cbranch_scc0 .pd_111
    s_branch .pn_157
.pw_147:
    s_waitcnt vmcnt(0)
    v_cmp_eq_u32 vcc, -1, v36
    s_cbranch_vccnz .pg_163
    v_smfmac_f32_16x16x64_bf16 v[76:79], v[36:39], v[124:131], v9
    v_smfmac_f32_16x16x64_bf16 v[80:83], v[36:39], v[156:163], v9
    s_xor_b32 s63, s63, 16
    s_cbranch_scc0 .pd_111
    s_branch .pn_156
.pw_146:
    s_waitcnt vmcnt(0)
    v_cmp_eq_u32 vcc, -1, v32
    s_cbranch_vccnz .pg_162
    v_smfmac_f32_16x16x64_bf16 v[76:79], v[32:35], a[216:223], v9
    v_smfmac_f32_16x16x64_bf16 v[80:83], v[32:35], a[248:255], v9
    s_xor_b32 s63, s63, 8
    s_cbranch_scc0 .pd_111
    s_branch .pn_155
.pw_145:
    s_waitcnt vmcnt(0)
    v_cmp_eq_u32 vcc, -1, v28
    s_cbranch_vccnz .pg_161
    v_smfmac_f32_16x16x64_bf16 v[76:79], v[28:31], a[208:215], v9
    v_smfmac_f32_16x16x64_bf16 v[80:83], v[28:31], a[240:247], v9
    s_xor_b32 s63, s63, 4
    s_cbranch_scc0 .pd_111
    s_branch .pn_154
.pw_144:
    s_waitcnt vmcnt(0)
    v_cmp_eq_u32 vcc, -1, v24
    s_cbranch_vccnz .pg_160
    v_smfmac_f32_16x16x64_bf16 v[76:79], v[24:27], a[200:207], v9
    v_smfmac_f32_16x16x64_bf16 v[80:83], v[24:27], a[232:239], v9
    s_xor_b32 s63, s63, 2
    s_cbranch_scc0 .pd_111
    s_branch .pn_153
.pw_143:
    s_waitcnt vmcnt(0)
    v_cmp_eq_u32 vcc, -1, v20
    s_cbranch_vccnz .pg_159
    v_smfmac_f32_16x16x64_bf16 v[76:79], v[20:23], a[192:199], v9
    v_smfmac_f32_16x16x64_bf16 v[80:83], v[20:23], a[224:231], v9
    s_xor_b32 s63, s63, 1
    s_cbranch_scc0 .pd_111
    s_branch .pn_152
.pn_152:
    s_bitcmp1_b32 s63, 1
    s_cbranch_scc0 .pn_153
    v_cmp_eq_u32 vcc, -1, v24
    s_cbranch_vccnz .pg_160
    v_smfmac_f32_16x16x64_bf16 v[76:79], v[24:27], a[200:207], v9
    v_smfmac_f32_16x16x64_bf16 v[80:83], v[24:27], a[232:239], v9
    s_xor_b32 s63, s63, 2
    s_cbranch_scc0 .pd_111
.pn_153:
    s_bitcmp1_b32 s63, 2
    s_cbranch_scc0 .pn_154
    v_cmp_eq_u32 vcc, -1, v28
    s_cbranch_vccnz .pg_161
    v_smfmac_f32_16x16x64_bf16 v[76:79], v[28:31], a[208:215], v9
    v_smfmac_f32_16x16x64_bf16 v[80:83], v[28:31], a[240:247], v9
    s_xor_b32 s63, s63, 4
    s_cbranch_scc0 .pd_111
.pn_154:
    s_bitcmp1_b32 s63, 3
    s_cbranch_scc0 .pn_155
    v_cmp_eq_u32 vcc, -1, v32
    s_cbranch_vccnz .pg_162
    v_smfmac_f32_16x16x64_bf16 v[76:79], v[32:35], a[216:223], v9
    v_smfmac_f32_16x16x64_bf16 v[80:83], v[32:35], a[248:255], v9
    s_xor_b32 s63, s63, 8
    s_cbranch_scc0 .pd_111
.pn_155:
    s_bitcmp1_b32 s63, 4
    s_cbranch_scc0 .pn_156
    v_cmp_eq_u32 vcc, -1, v36
    s_cbranch_vccnz .pg_163
    v_smfmac_f32_16x16x64_bf16 v[76:79], v[36:39], v[124:131], v9
    v_smfmac_f32_16x16x64_bf16 v[80:83], v[36:39], v[156:163], v9
    s_xor_b32 s63, s63, 16
    s_cbranch_scc0 .pd_111
.pn_156:
    s_bitcmp1_b32 s63, 5
    s_cbranch_scc0 .pn_157
    v_cmp_eq_u32 vcc, -1, v40
    s_cbranch_vccnz .pg_164
    v_smfmac_f32_16x16x64_bf16 v[76:79], v[40:43], v[132:139], v9
    v_smfmac_f32_16x16x64_bf16 v[80:83], v[40:43], v[164:171], v9
    s_xor_b32 s63, s63, 32
    s_cbranch_scc0 .pd_111
.pn_157:
    s_bitcmp1_b32 s63, 6
    s_cbranch_scc0 .pn_158
    v_cmp_eq_u32 vcc, -1, v44
    s_cbranch_vccnz .pg_165
    v_smfmac_f32_16x16x64_bf16 v[76:79], v[44:47], v[140:147], v9
    v_smfmac_f32_16x16x64_bf16 v[80:83], v[44:47], v[172:179], v9
    s_xor_b32 s63, s63, 64
    s_cbranch_scc0 .pd_111
.pn_158:
    s_bitcmp1_b32 s63, 7
    s_cbranch_scc0 .ps_112
    v_cmp_eq_u32 vcc, -1, v48
    s_cbranch_vccnz .pg_166
    v_smfmac_f32_16x16x64_bf16 v[76:79], v[48:51], v[148:155], v9
    v_smfmac_f32_16x16x64_bf16 v[80:83], v[48:51], v[180:187], v9
    s_xor_b32 s63, s63, 128
    s_cbranch_scc0 .pd_111
    s_branch .ps_112
.pg_159:
    buffer_load_dwordx4 v[20:23], v246, s[8:11], s32 offen offset:0 sc1
    s_branch .pn_152
.pg_160:
    buffer_load_dwordx4 v[24:27], v246, s[8:11], s32 offen offset:1024 sc1
    s_branch .pn_153
.pg_161:
    buffer_load_dwordx4 v[28:31], v246, s[8:11], s32 offen offset:2048 sc1
    s_branch .pn_154
.pg_162:
    buffer_load_dwordx4 v[32:35], v246, s[8:11], s32 offen offset:3072 sc1
    s_branch .pn_155
.pg_163:
    buffer_load_dwordx4 v[36:39], v246, s[8:11], s33 offen offset:0 sc1
    s_branch .pn_156
.pg_164:
    buffer_load_dwordx4 v[40:43], v246, s[8:11], s33 offen offset:1024 sc1
    s_branch .pn_157
.pg_165:
    buffer_load_dwordx4 v[44:47], v246, s[8:11], s33 offen offset:2048 sc1
    s_branch .pn_158
.pg_166:
    buffer_load_dwordx4 v[48:51], v246, s[8:11], s33 offen offset:3072 sc1
    s_branch .ps_112
.kf_129:
    s_mov_b32 s62, 0
    s_mov_b64 exec, 3
.wf_167:
    buffer_load_dword v4, v253, s[8:11], s89 offen sc1
    s_waitcnt vmcnt(0)
    v_cmp_gt_u32 vcc, s6, v4
    s_cbranch_vccz .wfd_168
    s_sleep 2
    s_add_u32 s62, s62, 1
    s_cmp_gt_u32 s62, 0x400000
    s_cbranch_scc1 .mg_end_1
    s_branch .wf_167

.wfd_168:
    s_mov_b64 exec, -1
    v_readlane_b32 s4, v4, 0
    v_readlane_b32 s93, v4, 1
    s_min_u32 s93, s93, s4
    s_branch .kb_130
.p2align 6
.top2_169:
    buffer_load_dwordx4 v[20:23], v8, s[8:11], s29 offen offset:0 sc1
    s_nop 11
    buffer_load_dwordx4 v[24:27], v8, s[8:11], s29 offen offset:1024 sc1
    s_nop 11
    buffer_load_dwordx4 v[28:31], v8, s[8:11], s29 offen offset:2048 sc1
    s_nop 11
    buffer_load_dwordx4 v[32:35], v8, s[8:11], s29 offen offset:3072 sc1
.ent02_23:
    s_waitcnt vmcnt(3)
    v_max_u32 v4, v20, v22
    v_cmp_eq_u32 vcc, -1, v4
    s_cbranch_vccnz .pf_172
    v_smfmac_f32_16x16x64_bf16 v[52:55], v[20:23], a[0:7], v9
    v_smfmac_f32_16x16x64_bf16 v[56:59], v[20:23], a[32:39], v9
    v_smfmac_f32_16x16x64_bf16 v[60:63], v[20:23], a[64:71], v9
    v_smfmac_f32_16x16x64_bf16 v[64:67], v[20:23], a[96:103], v9
.pr_176:
    s_waitcnt vmcnt(2)
    v_max_u32 v4, v24, v26
    v_cmp_eq_u32 vcc, -1, v4
    s_cbranch_vccnz .pf_173
    v_smfmac_f32_16x16x64_bf16 v[52:55], v[24:27], a[8:15], v9
    v_smfmac_f32_16x16x64_bf16 v[56:59], v[24:27], a[40:47], v9
    v_smfmac_f32_16x16x64_bf16 v[60:63], v[24:27], a[72:79], v9
    v_smfmac_f32_16x16x64_bf16 v[64:67], v[24:27], a[104:111], v9
.pr_177:
    s_waitcnt vmcnt(1)
    v_max_u32 v4, v28, v30
    v_cmp_eq_u32 vcc, -1, v4
    s_cbranch_vccnz .pf_174
    v_smfmac_f32_16x16x64_bf16 v[52:55], v[28:31], a[16:23], v9
    v_smfmac_f32_16x16x64_bf16 v[56:59], v[28:31], a[48:55], v9
    v_smfmac_f32_16x16x64_bf16 v[60:63], v[28:31], a[80:87], v9
    v_smfmac_f32_16x16x64_bf16 v[64:67], v[28:31], a[112:119], v9
.pr_178:
    s_waitcnt vmcnt(0)
    v_max_u32 v4, v32, v34
    v_cmp_eq_u32 vcc, -1, v4
    s_cbranch_vccnz .pf_175
    v_smfmac_f32_16x16x64_bf16 v[52:55], v[32:35], a[24:31], v9
    v_smfmac_f32_16x16x64_bf16 v[56:59], v[32:35], a[56:63], v9
    v_smfmac_f32_16x16x64_bf16 v[60:63], v[32:35], a[88:95], v9
    v_smfmac_f32_16x16x64_bf16 v[64:67], v[32:35], a[120:127], v9
.pr_179:
    s_cmp_lg_u32 s63, 0
    s_cbranch_scc1 .ps_171
.pd_170:
    v_cvt_pk_bf16_f32 v104, v52, v53
    v_cvt_pk_bf16_f32 v105, v54, v55
    v_cvt_pk_bf16_f32 v106, v56, v57
    v_cvt_pk_bf16_f32 v107, v58, v59
    ds_write_b64 v16, v[104:105] offset:4096
    v_cvt_pk_bf16_f32 v108, v60, v61
    v_cvt_pk_bf16_f32 v109, v62, v63
    ds_write_b64 v16, v[106:107] offset:6144
    ds_write_b64 v16, v[108:109] offset:0
    s_nop 0
    v_cvt_pk_bf16_f32 v110, v64, v65
    v_cvt_pk_bf16_f32 v111, v66, v67
    ds_write_b64 v16, v[110:111] offset:2048
    v_smfmac_f32_16x16x64_bf16 v[68:71], v[20:23], a[128:135], v9
    v_smfmac_f32_16x16x64_bf16 v[72:75], v[20:23], a[160:167], v9
    s_waitcnt lgkmcnt(0)
    s_barrier
    ds_read_b128 v[36:39], v14 offset:4096
    ds_read_b128 v[40:43], v14 offset:5120
    v_smfmac_f32_16x16x64_bf16 v[68:71], v[24:27], a[136:143], v9
    v_smfmac_f32_16x16x64_bf16 v[72:75], v[24:27], a[168:175], v9
    s_waitcnt lgkmcnt(1)
    v_mfma_f32_16x16x32_bf16 v[44:47], v[36:39], v[84:87], 0
    s_waitcnt lgkmcnt(0)
    v_mfma_f32_16x16x32_bf16 v[44:47], v[40:43], v[84:87], v[44:47]
    v_smfmac_f32_16x16x64_bf16 v[68:71], v[28:31], a[144:151], v9
    v_smfmac_f32_16x16x64_bf16 v[72:75], v[28:31], a[176:183], v9
    s_mov_b64 exec, s[58:59]
    v_cvt_pk_bf16_f32 v48, v44, v45
    v_cvt_pk_bf16_f32 v49, v46, v47
    v_min_u32 v48, 0xfffffffe, v48
    buffer_store_dwordx2 v[48:49], v10, s[8:11], s29 offen

    ds_write_b64 v18, v[48:49]
    s_mov_b64 exec, -1

    v_smfmac_f32_16x16x64_bf16 v[68:71], v[32:35], a[152:159], v9
    v_smfmac_f32_16x16x64_bf16 v[72:75], v[32:35], a[184:191], v9
    s_nop 3
    v_cvt_pk_bf16_f32 v104, v68, v69
    v_cvt_pk_bf16_f32 v105, v70, v71
    ds_write_b64 v16, v[104:105] offset:8192
    s_nop 0
    v_cvt_pk_bf16_f32 v106, v72, v73
    v_cvt_pk_bf16_f32 v107, v74, v75
    ds_write_b64 v16, v[106:107] offset:10240
    buffer_load_dwordx4 v[92:95], v232, s[8:11], s29 offen sc1
    buffer_load_dwordx4 v[96:99], v233, s[8:11], s29 offen sc1
    buffer_load_dwordx4 v[100:103], v234, s[8:11], s29 offen sc1
    ds_read_b128 v[128:131], v228 offset:0
    ds_read_b128 v[132:135], v229 offset:0
    ds_read_b128 v[136:139], v230 offset:0
    ds_read_b128 v[140:143], v231 offset:0
    ds_read_b128 v[144:147], v228 offset:4096
    ds_read_b128 v[148:151], v229 offset:4096
    ds_read_b128 v[152:155], v230 offset:4096
    ds_read_b128 v[156:159], v231 offset:4096
    ds_read_b128 v[160:163], v19 offset:0
    ds_read_b128 v[164:167], v19 offset:1024
    s_waitcnt lgkmcnt(10)
    s_barrier
    s_cmp_eq_u32 s28, 63
    s_cbranch_scc1 .rec_fin_5
    ds_read_b128 v[88:91], v14 offset:16384
    ds_read_b128 v[36:39], v14 offset:8192
    ds_read_b128 v[40:43], v14 offset:9216
    ds_read_b128 v[44:47], v14 offset:10240
    ds_read_b128 v[48:51], v14 offset:11264
    s_waitcnt lgkmcnt(4)
    v_mfma_f32_16x16x32_bf16 v[208:211], v[128:131], v[88:91], 0
    v_mfma_f32_16x16x32_bf16 v[212:215], v[144:147], v[88:91], 0
    v_mfma_f32_16x16x32_bf16 v[216:219], v[88:91], v[88:91], v[116:119]
    s_waitcnt lgkmcnt(0)
    v_mfma_f32_16x16x32_bf16 v[104:107], v[84:87], v[36:39], 0
    v_mfma_f32_16x16x32_bf16 v[108:111], v[84:87], v[44:47], 0
    v_mfma_f32_16x16x32_bf16 v[104:107], v[84:87], v[40:43], v[104:107]
    v_mfma_f32_16x16x32_bf16 v[108:111], v[84:87], v[48:51], v[108:111]
    s_nop 7
    v_cvt_pk_bf16_f32 v168, v104, v105
    v_cvt_pk_bf16_f32 v169, v106, v107
    v_cvt_pk_bf16_f32 v172, v108, v109
    v_cvt_pk_bf16_f32 v173, v110, v111
    s_waitcnt vmcnt(2)
    v_max_u32 v4, v92, v94
    v_cmp_eq_u32 vcc, -1, v4
    s_cbranch_vccnz .pf_182
    v_mfma_f32_16x16x32_bf16 v[208:211], v[132:135], v[92:95], v[208:211]
    v_mfma_f32_16x16x32_bf16 v[212:215], v[148:151], v[92:95], v[212:215]
    v_mfma_f32_16x16x32_bf16 v[216:219], v[92:95], v[92:95], v[216:219]
.pr_185:
    s_waitcnt vmcnt(1)
    v_max_u32 v4, v96, v98
    v_cmp_eq_u32 vcc, -1, v4
    s_cbranch_vccnz .pf_183
    v_mfma_f32_16x16x32_bf16 v[208:211], v[136:139], v[96:99], v[208:211]
    v_mfma_f32_16x16x32_bf16 v[212:215], v[152:155], v[96:99], v[212:215]
    v_mfma_f32_16x16x32_bf16 v[216:219], v[96:99], v[96:99], v[216:219]
.pr_186:
    s_waitcnt vmcnt(0)
    v_max_u32 v4, v100, v102
    v_cmp_eq_u32 vcc, -1, v4
    s_cbranch_vccnz .pf_184
    v_mfma_f32_16x16x32_bf16 v[208:211], v[140:143], v[100:103], v[208:211]
    v_mfma_f32_16x16x32_bf16 v[212:215], v[156:159], v[100:103], v[212:215]
    v_mfma_f32_16x16x32_bf16 v[216:219], v[100:103], v[100:103], v[216:219]
.pr_187:
    s_cmp_lg_u32 s63, 0
    s_cbranch_scc1 .ps_181
.pd_180:
    s_barrier
    s_nop 2
    v_mov_b32_dpp v208, v212 row_ror:8 row_mask:0xf bank_mask:0xc
    v_mov_b32_dpp v209, v213 row_ror:8 row_mask:0xf bank_mask:0xc
    v_mov_b32_dpp v210, v214 row_ror:8 row_mask:0xf bank_mask:0xc
    v_mov_b32_dpp v211, v215 row_ror:8 row_mask:0xf bank_mask:0xc
    v_mov_b32_dpp v216, v218 row_ror:8 row_mask:0xf bank_mask:0xc
    v_mov_b32_dpp v217, v219 row_ror:8 row_mask:0xf bank_mask:0xc
    v_max3_f32 v4, v208, v209, v210
    v_max3_f32 v5, v211, v216, v217
    v_max_f32 v6, v4, v5
    v_max_f32 v4, v4, v5
    s_nop 1
    v_permlane32_swap_b32 v4, v6
    v_max_f32 v5, v4, v6
    v_max_f32 v4, v4, v6
    s_nop 1
    v_permlane16_swap_b32 v4, v5
    v_max_f32 v4, v4, v5
    s_nop 1
    v_max_f32_dpp v4, v4, v4 row_ror:8 row_mask:0xf bank_mask:0xf
    v_mul_f32 v4, s37, v4

    v_fma_f32 v104, v208, s37, -v4
    v_fma_f32 v105, v209, s37, -v4
    v_fma_f32 v106, v210, s37, -v4
    v_fma_f32 v107, v211, s37, -v4
    v_fma_f32 v108, v216, s37, -v4
    v_fma_f32 v109, v217, s37, -v4
    v_exp_f32 v104, v104
    v_exp_f32 v105, v105
    v_exp_f32 v106, v106
    v_exp_f32 v107, v107
    v_exp_f32 v108, v108
    v_exp_f32 v109, v109
    v_cvt_pk_bf16_f32 v176, v104, v105
    v_cvt_pk_bf16_f32 v177, v106, v107
    v_cvt_pk_bf16_f32 v180, v108, v109
    v_mov_b32_dpp v178, v176 row_ror:8 row_mask:0xf bank_mask:0xf
    v_mov_b32_dpp v179, v177 row_ror:8 row_mask:0xf bank_mask:0xf
    v_mov_b32_dpp v181, v180 row_ror:8 row_mask:0xf bank_mask:0xf
    s_nop 0

    v_mfma_f32_16x16x32_bf16 v[208:211], v[120:123], v[176:179], 0
    v_mfma_f32_16x16x32_bf16 v[208:211], v[120:123], v[180:183], v[208:211]
    v_mfma_f32_16x16x32_bf16 v[212:215], v[160:163], v[176:179], 0
    v_mfma_f32_16x16x32_bf16 v[216:219], v[164:167], v[176:179], 0
    v_mfma_f32_16x16x32_bf16 v[212:215], v[168:171], v[180:183], v[212:215]
    v_rcp_f32 v4, v208
    v_mfma_f32_16x16x32_bf16 v[216:219], v[172:175], v[180:183], v[216:219]
    s_mov_b64 exec, s[58:59]
    s_nop 2
    v_mul_f32 v212, v4, v212
    v_mul_f32 v213, v4, v213
    v_mul_f32 v214, v4, v214
    v_mul_f32 v215, v4, v215
    v_cvt_pk_bf16_f32 v184, v212, v213
    v_cvt_pk_bf16_f32 v185, v214, v215
    v_mul_f32 v216, v4, v216
    v_mul_f32 v217, v4, v217
    v_mul_f32 v218, v4, v218
    v_mul_f32 v219, v4, v219
    v_cvt_pk_bf16_f32 v186, v216, v217
    v_cvt_pk_bf16_f32 v187, v218, v219
    v_min_u32 v184, 0xfffffffe, v184
    buffer_store_dwordx4 v[184:187], v13, s[8:11], s29 offen
    s_mov_b64 exec, -1

    s_barrier
    v_mov_b32 v52, 0
    v_mov_b32 v53, 0
    v_mov_b32 v54, 0
    v_mov_b32 v55, 0
    v_mov_b32 v56, 0
    v_mov_b32 v57, 0
    v_mov_b32 v58, 0
    v_mov_b32 v59, 0
    v_mov_b32 v60, 0
    v_mov_b32 v61, 0
    v_mov_b32 v62, 0
    v_mov_b32 v63, 0
    v_mov_b32 v64, 0
    v_mov_b32 v65, 0
    v_mov_b32 v66, 0
    v_mov_b32 v67, 0
    v_mov_b32 v68, 0
    v_mov_b32 v69, 0
    v_mov_b32 v70, 0
    v_mov_b32 v71, 0
    v_mov_b32 v72, 0
    v_mov_b32 v73, 0
    v_mov_b32 v74, 0
    v_mov_b32 v75, 0
    s_mov_b32 s99, s68
    s_add_u32 s28, s28, 1
    s_add_u32 s36, s36, 196608
    s_add_u32 s38, s38, 262144
    s_add_u32 s39, s39, 262144
    s_mov_b32 s4, s68
    s_mov_b32 s68, s69
    s_mov_b32 s69, s70
    s_mov_b32 s70, s71
    s_mov_b32 s71, s4

    s_and_b32 s4, s28, 3
    s_lshl_b32 s5, s4, 16
    s_add_u32 s29, s5, s34
    s_xor_b32 s6, s5, 0x20000
    s_add_u32 s31, s6, s34
    s_add_u32 s32, s29, 16384
    s_add_u32 s33, s29, 20480

    s_barrier
    ds_read_b128 v[36:39], v248
    s_nop 15
    s_add_u32 s4, s99, 0
    buffer_load_dwordx4 v[192:195], v239, s[8:11], s4 offen sc1
    buffer_load_dwordx4 v[196:199], v249, s[8:11], s4 offen sc1

    s_waitcnt lgkmcnt(0)
    v_mfma_f32_16x16x32_bf16 v[76:79], v[36:39], v[112:115], 0
    s_nop 15
    s_add_u32 s4, s99, 262144
    buffer_load_dwordx4 v[200:203], v239, s[8:11], s4 offen sc1
    buffer_load_dwordx4 v[204:207], v249, s[8:11], s4 offen sc1

    s_nop 15
    s_add_u32 s4, s99, 524288
    buffer_load_dwordx4 v[20:23], v239, s[8:11], s4 offen sc1
    buffer_load_dwordx4 v[24:27], v249, s[8:11], s4 offen sc1

    s_nop 15
    s_add_u32 s4, s99, 786432
    buffer_load_dwordx4 v[28:31], v239, s[8:11], s4 offen sc1
    buffer_load_dwordx4 v[32:35], v249, s[8:11], s4 offen sc1

    s_barrier
.gc_189:
    s_waitcnt vmcnt(6)
    v_max_u32 v4, v192, v196
    v_cmp_eq_u32 vcc, -1, v4
    s_cbranch_vccnz .gc_190

    v_mfma_f32_16x16x32_bf16 v[76:79], v[192:195], v[84:87], v[76:79]
    v_mfma_f32_16x16x32_bf16 v[76:79], v[196:199], v[112:115], v[76:79]
.gd_188:
    s_mov_b64 exec, s[58:59]
    s_nop 6
    v_cvt_pk_bf16_f32 v48, v76, v77
    v_cvt_pk_bf16_f32 v49, v78, v79
    v_min_u32 v48, 0xfffffffe, v48
    buffer_store_dwordx2 v[48:49], v15, s[8:11], s29 offen
    s_mov_b64 exec, -1

    s_waitcnt lgkmcnt(0)
    s_barrier
    s_branch .top2_169
.pf_172:
    buffer_load_dwordx4 v[20:23], v8, s[8:11], s29 offen offset:0 sc1
    s_bitset1_b32 s63, 0
    s_branch .pr_176
.pf_173:
    buffer_load_dwordx4 v[24:27], v8, s[8:11], s29 offen offset:1024 sc1
    s_bitset1_b32 s63, 1
    s_branch .pr_177
.pf_174:
    buffer_load_dwordx4 v[28:31], v8, s[8:11], s29 offen offset:2048 sc1
    s_bitset1_b32 s63, 2
    s_branch .pr_178
.pf_175:
    buffer_load_dwordx4 v[32:35], v8, s[8:11], s29 offen offset:3072 sc1
    s_bitset1_b32 s63, 3
    s_branch .pr_179
.ps_171:
    s_add_u32 s62, s62, 1
    s_cmp_gt_u32 s62, 0x400000
    s_cbranch_scc1 .mg_end_1
    s_bitcmp1_b32 s63, 0
    s_cbranch_scc1 .pw_193
    s_bitcmp1_b32 s63, 1
    s_cbranch_scc1 .pw_194
    s_bitcmp1_b32 s63, 2
    s_cbranch_scc1 .pw_195
.pw_196:
    s_waitcnt vmcnt(0)
    v_max_u32 v4, v32, v34
    v_cmp_eq_u32 vcc, -1, v4
    s_cbranch_vccnz .pg_204
    v_smfmac_f32_16x16x64_bf16 v[52:55], v[32:35], a[24:31], v9
    v_smfmac_f32_16x16x64_bf16 v[56:59], v[32:35], a[56:63], v9
    v_smfmac_f32_16x16x64_bf16 v[60:63], v[32:35], a[88:95], v9
    v_smfmac_f32_16x16x64_bf16 v[64:67], v[32:35], a[120:127], v9
    s_xor_b32 s63, s63, 8
    s_cbranch_scc0 .pd_170
    s_branch .ps_171
.pw_195:
    s_waitcnt vmcnt(0)
    v_max_u32 v4, v28, v30
    v_cmp_eq_u32 vcc, -1, v4
    s_cbranch_vccnz .pg_203
    v_smfmac_f32_16x16x64_bf16 v[52:55], v[28:31], a[16:23], v9
    v_smfmac_f32_16x16x64_bf16 v[56:59], v[28:31], a[48:55], v9
    v_smfmac_f32_16x16x64_bf16 v[60:63], v[28:31], a[80:87], v9
    v_smfmac_f32_16x16x64_bf16 v[64:67], v[28:31], a[112:119], v9
    s_xor_b32 s63, s63, 4
    s_cbranch_scc0 .pd_170
    s_branch .pn_200
.pw_194:
    s_waitcnt vmcnt(0)
    v_max_u32 v4, v24, v26
    v_cmp_eq_u32 vcc, -1, v4
    s_cbranch_vccnz .pg_202
    v_smfmac_f32_16x16x64_bf16 v[52:55], v[24:27], a[8:15], v9
    v_smfmac_f32_16x16x64_bf16 v[56:59], v[24:27], a[40:47], v9
    v_smfmac_f32_16x16x64_bf16 v[60:63], v[24:27], a[72:79], v9
    v_smfmac_f32_16x16x64_bf16 v[64:67], v[24:27], a[104:111], v9
    s_xor_b32 s63, s63, 2
    s_cbranch_scc0 .pd_170
    s_branch .pn_199
.pw_193:
    s_waitcnt vmcnt(0)
    v_max_u32 v4, v20, v22
    v_cmp_eq_u32 vcc, -1, v4
    s_cbranch_vccnz .pg_201
    v_smfmac_f32_16x16x64_bf16 v[52:55], v[20:23], a[0:7], v9
    v_smfmac_f32_16x16x64_bf16 v[56:59], v[20:23], a[32:39], v9
    v_smfmac_f32_16x16x64_bf16 v[60:63], v[20:23], a[64:71], v9
    v_smfmac_f32_16x16x64_bf16 v[64:67], v[20:23], a[96:103], v9
    s_xor_b32 s63, s63, 1
    s_cbranch_scc0 .pd_170
    s_branch .pn_198
.pn_198:
    s_bitcmp1_b32 s63, 1
    s_cbranch_scc0 .pn_199
    v_max_u32 v4, v24, v26
    v_cmp_eq_u32 vcc, -1, v4
    s_cbranch_vccnz .pg_202
    v_smfmac_f32_16x16x64_bf16 v[52:55], v[24:27], a[8:15], v9
    v_smfmac_f32_16x16x64_bf16 v[56:59], v[24:27], a[40:47], v9
    v_smfmac_f32_16x16x64_bf16 v[60:63], v[24:27], a[72:79], v9
    v_smfmac_f32_16x16x64_bf16 v[64:67], v[24:27], a[104:111], v9
    s_xor_b32 s63, s63, 2
    s_cbranch_scc0 .pd_170
.pn_199:
    s_bitcmp1_b32 s63, 2
    s_cbranch_scc0 .pn_200
    v_max_u32 v4, v28, v30
    v_cmp_eq_u32 vcc, -1, v4
    s_cbranch_vccnz .pg_203
    v_smfmac_f32_16x16x64_bf16 v[52:55], v[28:31], a[16:23], v9
    v_smfmac_f32_16x16x64_bf16 v[56:59], v[28:31], a[48:55], v9
    v_smfmac_f32_16x16x64_bf16 v[60:63], v[28:31], a[80:87], v9
    v_smfmac_f32_16x16x64_bf16 v[64:67], v[28:31], a[112:119], v9
    s_xor_b32 s63, s63, 4
    s_cbranch_scc0 .pd_170
.pn_200:
    s_bitcmp1_b32 s63, 3
    s_cbranch_scc0 .ps_171
    v_max_u32 v4, v32, v34
    v_cmp_eq_u32 vcc, -1, v4
    s_cbranch_vccnz .pg_204
    v_smfmac_f32_16x16x64_bf16 v[52:55], v[32:35], a[24:31], v9
    v_smfmac_f32_16x16x64_bf16 v[56:59], v[32:35], a[56:63], v9
    v_smfmac_f32_16x16x64_bf16 v[60:63], v[32:35], a[88:95], v9
    v_smfmac_f32_16x16x64_bf16 v[64:67], v[32:35], a[120:127], v9
    s_xor_b32 s63, s63, 8
    s_cbranch_scc0 .pd_170
    s_branch .ps_171
.pg_201:
    buffer_load_dwordx4 v[20:23], v8, s[8:11], s29 offen offset:0 sc1
    s_branch .pn_198
.pg_202:
    buffer_load_dwordx4 v[24:27], v8, s[8:11], s29 offen offset:1024 sc1
    s_branch .pn_199
.pg_203:
    buffer_load_dwordx4 v[28:31], v8, s[8:11], s29 offen offset:2048 sc1
    s_branch .pn_200
.pg_204:
    buffer_load_dwordx4 v[32:35], v8, s[8:11], s29 offen offset:3072 sc1
    s_branch .ps_171
.pf_182:
    buffer_load_dwordx4 v[92:95], v232, s[8:11], s29 offen sc1
    s_bitset1_b32 s63, 1
    s_branch .pr_185
.pf_183:
    buffer_load_dwordx4 v[96:99], v233, s[8:11], s29 offen sc1
    s_bitset1_b32 s63, 2
    s_branch .pr_186
.pf_184:
    buffer_load_dwordx4 v[100:103], v234, s[8:11], s29 offen sc1
    s_bitset1_b32 s63, 3
    s_branch .pr_187
.ps_181:
    s_add_u32 s62, s62, 1
    s_cmp_gt_u32 s62, 0x400000
    s_cbranch_scc1 .mg_end_1
    s_bitcmp1_b32 s63, 1
    s_cbranch_scc1 .pw_205
    s_bitcmp1_b32 s63, 2
    s_cbranch_scc1 .pw_206
.pw_207:
    s_waitcnt vmcnt(0)
    v_max_u32 v4, v100, v102
    v_cmp_eq_u32 vcc, -1, v4
    s_cbranch_vccnz .pg_213
    v_mfma_f32_16x16x32_bf16 v[208:211], v[140:143], v[100:103], v[208:211]
    v_mfma_f32_16x16x32_bf16 v[212:215], v[156:159], v[100:103], v[212:215]
    v_mfma_f32_16x16x32_bf16 v[216:219], v[100:103], v[100:103], v[216:219]
    s_xor_b32 s63, s63, 8
    s_cbranch_scc0 .pd_180
    s_branch .ps_181
.pw_206:
    s_waitcnt vmcnt(0)
    v_max_u32 v4, v96, v98
    v_cmp_eq_u32 vcc, -1, v4
    s_cbranch_vccnz .pg_212
    v_mfma_f32_16x16x32_bf16 v[208:211], v[136:139], v[96:99], v[208:211]
    v_mfma_f32_16x16x32_bf16 v[212:215], v[152:155], v[96:99], v[212:215]
    v_mfma_f32_16x16x32_bf16 v[216:219], v[96:99], v[96:99], v[216:219]
    s_xor_b32 s63, s63, 4
    s_cbranch_scc0 .pd_180
    s_branch .pn_210
.pw_205:
    s_waitcnt vmcnt(0)
    v_max_u32 v4, v92, v94
    v_cmp_eq_u32 vcc, -1, v4
    s_cbranch_vccnz .pg_211
    v_mfma_f32_16x16x32_bf16 v[208:211], v[132:135], v[92:95], v[208:211]
    v_mfma_f32_16x16x32_bf16 v[212:215], v[148:151], v[92:95], v[212:215]
    v_mfma_f32_16x16x32_bf16 v[216:219], v[92:95], v[92:95], v[216:219]
    s_xor_b32 s63, s63, 2
    s_cbranch_scc0 .pd_180
    s_branch .pn_209
.pn_209:
    s_bitcmp1_b32 s63, 2
    s_cbranch_scc0 .pn_210
    v_max_u32 v4, v96, v98
    v_cmp_eq_u32 vcc, -1, v4
    s_cbranch_vccnz .pg_212
    v_mfma_f32_16x16x32_bf16 v[208:211], v[136:139], v[96:99], v[208:211]
    v_mfma_f32_16x16x32_bf16 v[212:215], v[152:155], v[96:99], v[212:215]
    v_mfma_f32_16x16x32_bf16 v[216:219], v[96:99], v[96:99], v[216:219]
    s_xor_b32 s63, s63, 4
    s_cbranch_scc0 .pd_180
.pn_210:
    s_bitcmp1_b32 s63, 3
    s_cbranch_scc0 .ps_181
    v_max_u32 v4, v100, v102
    v_cmp_eq_u32 vcc, -1, v4
    s_cbranch_vccnz .pg_213
    v_mfma_f32_16x16x32_bf16 v[208:211], v[140:143], v[100:103], v[208:211]
    v_mfma_f32_16x16x32_bf16 v[212:215], v[156:159], v[100:103], v[212:215]
    v_mfma_f32_16x16x32_bf16 v[216:219], v[100:103], v[100:103], v[216:219]
    s_xor_b32 s63, s63, 8
    s_cbranch_scc0 .pd_180
    s_branch .ps_181
.pg_211:
    buffer_load_dwordx4 v[92:95], v232, s[8:11], s29 offen sc1
    s_branch .pn_209
.pg_212:
    buffer_load_dwordx4 v[96:99], v233, s[8:11], s29 offen sc1
    s_branch .pn_210
.pg_213:
    buffer_load_dwordx4 v[100:103], v234, s[8:11], s29 offen sc1
    s_branch .ps_181
.gc_190:
    s_waitcnt vmcnt(4)
    v_max_u32 v4, v200, v204
    v_cmp_eq_u32 vcc, -1, v4
    s_cbranch_vccnz .gc_191

    v_mfma_f32_16x16x32_bf16 v[76:79], v[200:203], v[84:87], v[76:79]
    v_mfma_f32_16x16x32_bf16 v[76:79], v[204:207], v[112:115], v[76:79]
    s_branch .gd_188
.gc_191:
    s_waitcnt vmcnt(2)
    v_max_u32 v4, v20, v24
    v_cmp_eq_u32 vcc, -1, v4
    s_cbranch_vccnz .gc_192

    v_mfma_f32_16x16x32_bf16 v[76:79], v[20:23], v[84:87], v[76:79]
    v_mfma_f32_16x16x32_bf16 v[76:79], v[24:27], v[112:115], v[76:79]
    s_branch .gd_188
.gc_192:
    s_waitcnt vmcnt(0)
    v_max_u32 v4, v28, v32
    v_cmp_eq_u32 vcc, -1, v4
    s_cbranch_vccnz .gr_214

    v_mfma_f32_16x16x32_bf16 v[76:79], v[28:31], v[84:87], v[76:79]
    v_mfma_f32_16x16x32_bf16 v[76:79], v[32:35], v[112:115], v[76:79]
    s_branch .gd_188
.gr_214:
    s_add_u32 s4, s99, 786432
    buffer_load_dwordx4 v[28:31], v239, s[8:11], s4 offen sc1
    buffer_load_dwordx4 v[32:35], v249, s[8:11], s4 offen sc1

    s_add_u32 s62, s62, 1
    s_cmp_gt_u32 s62, 0x400000
    s_cbranch_scc1 .mg_end_1
    s_branch .gc_192

.p2align 6
.top3_215:
    buffer_load_dwordx4 v[20:23], v8, s[8:11], s29 offen offset:0 sc1
    s_nop 11
    buffer_load_dwordx4 v[24:27], v8, s[8:11], s29 offen offset:1024 sc1
    s_nop 11
    buffer_load_dwordx4 v[28:31], v8, s[8:11], s29 offen offset:2048 sc1
    s_nop 11
    buffer_load_dwordx4 v[32:35], v8, s[8:11], s29 offen offset:3072 sc1
.ent03_24:
    s_waitcnt vmcnt(3)
    v_max_u32 v4, v20, v22
    v_cmp_eq_u32 vcc, -1, v4
    s_cbranch_vccnz .pf_218
    v_smfmac_f32_16x16x64_bf16 v[52:55], v[20:23], a[0:7], v9
    v_smfmac_f32_16x16x64_bf16 v[56:59], v[20:23], a[32:39], v9
    v_smfmac_f32_16x16x64_bf16 v[60:63], v[20:23], a[64:71], v9
    v_smfmac_f32_16x16x64_bf16 v[64:67], v[20:23], a[96:103], v9
.pr_222:
    s_waitcnt vmcnt(2)
    v_max_u32 v4, v24, v26
    v_cmp_eq_u32 vcc, -1, v4
    s_cbranch_vccnz .pf_219
    v_smfmac_f32_16x16x64_bf16 v[52:55], v[24:27], a[8:15], v9
    v_smfmac_f32_16x16x64_bf16 v[56:59], v[24:27], a[40:47], v9
    v_smfmac_f32_16x16x64_bf16 v[60:63], v[24:27], a[72:79], v9
    v_smfmac_f32_16x16x64_bf16 v[64:67], v[24:27], a[104:111], v9
.pr_223:
    s_waitcnt vmcnt(1)
    v_max_u32 v4, v28, v30
    v_cmp_eq_u32 vcc, -1, v4
    s_cbranch_vccnz .pf_220
    v_smfmac_f32_16x16x64_bf16 v[52:55], v[28:31], a[16:23], v9
    v_smfmac_f32_16x16x64_bf16 v[56:59], v[28:31], a[48:55], v9
    v_smfmac_f32_16x16x64_bf16 v[60:63], v[28:31], a[80:87], v9
    v_smfmac_f32_16x16x64_bf16 v[64:67], v[28:31], a[112:119], v9
.pr_224:
    s_waitcnt vmcnt(0)
    v_max_u32 v4, v32, v34
    v_cmp_eq_u32 vcc, -1, v4
    s_cbranch_vccnz .pf_221
    v_smfmac_f32_16x16x64_bf16 v[52:55], v[32:35], a[24:31], v9
    v_smfmac_f32_16x16x64_bf16 v[56:59], v[32:35], a[56:63], v9
    v_smfmac_f32_16x16x64_bf16 v[60:63], v[32:35], a[88:95], v9
    v_smfmac_f32_16x16x64_bf16 v[64:67], v[32:35], a[120:127], v9
.pr_225:
    s_cmp_lg_u32 s63, 0
    s_cbranch_scc1 .ps_217
.pd_216:
    v_cvt_pk_bf16_f32 v104, v52, v53
    v_cvt_pk_bf16_f32 v105, v54, v55
    v_cvt_pk_bf16_f32 v106, v56, v57
    v_cvt_pk_bf16_f32 v107, v58, v59
    ds_write_b64 v16, v[104:105] offset:4096
    v_cvt_pk_bf16_f32 v108, v60, v61
    v_cvt_pk_bf16_f32 v109, v62, v63
    ds_write_b64 v16, v[106:107] offset:6144
    ds_write_b64 v16, v[108:109] offset:0
    s_nop 0
    v_cvt_pk_bf16_f32 v110, v64, v65
    v_cvt_pk_bf16_f32 v111, v66, v67
    ds_write_b64 v16, v[110:111] offset:2048
    v_smfmac_f32_16x16x64_bf16 v[68:71], v[20:23], a[128:135], v9
    v_smfmac_f32_16x16x64_bf16 v[72:75], v[20:23], a[160:167], v9
    s_waitcnt lgkmcnt(0)
    s_barrier
    ds_read_b128 v[36:39], v14 offset:6144
    ds_read_b128 v[40:43], v14 offset:7168
    v_smfmac_f32_16x16x64_bf16 v[68:71], v[24:27], a[136:143], v9
    v_smfmac_f32_16x16x64_bf16 v[72:75], v[24:27], a[168:175], v9
    s_waitcnt lgkmcnt(1)
    v_mfma_f32_16x16x32_bf16 v[44:47], v[36:39], v[84:87], 0
    s_waitcnt lgkmcnt(0)
    v_mfma_f32_16x16x32_bf16 v[44:47], v[40:43], v[84:87], v[44:47]
    v_smfmac_f32_16x16x64_bf16 v[68:71], v[28:31], a[144:151], v9
    v_smfmac_f32_16x16x64_bf16 v[72:75], v[28:31], a[176:183], v9
    s_mov_b64 exec, s[58:59]
    v_cvt_pk_bf16_f32 v48, v44, v45
    v_cvt_pk_bf16_f32 v49, v46, v47
    v_min_u32 v48, 0xfffffffe, v48
    buffer_store_dwordx2 v[48:49], v10, s[8:11], s29 offen

    ds_write_b64 v18, v[48:49]
    s_mov_b64 exec, -1

    v_smfmac_f32_16x16x64_bf16 v[68:71], v[32:35], a[152:159], v9
    v_smfmac_f32_16x16x64_bf16 v[72:75], v[32:35], a[184:191], v9
    s_nop 3
    v_cvt_pk_bf16_f32 v104, v68, v69
    v_cvt_pk_bf16_f32 v105, v70, v71
    ds_write_b64 v16, v[104:105] offset:8192
    s_nop 0
    v_cvt_pk_bf16_f32 v106, v72, v73
    v_cvt_pk_bf16_f32 v107, v74, v75
    ds_write_b64 v16, v[106:107] offset:10240
    s_waitcnt lgkmcnt(0)
    s_barrier
    s_cmp_eq_u32 s28, 63
    s_cbranch_scc1 .last_226
    s_barrier
    s_barrier
    v_mov_b32 v52, 0
    v_mov_b32 v53, 0
    v_mov_b32 v54, 0
    v_mov_b32 v55, 0
    v_mov_b32 v56, 0
    v_mov_b32 v57, 0
    v_mov_b32 v58, 0
    v_mov_b32 v59, 0
    v_mov_b32 v60, 0
    v_mov_b32 v61, 0
    v_mov_b32 v62, 0
    v_mov_b32 v63, 0
    v_mov_b32 v64, 0
    v_mov_b32 v65, 0
    v_mov_b32 v66, 0
    v_mov_b32 v67, 0
    v_mov_b32 v68, 0
    v_mov_b32 v69, 0
    v_mov_b32 v70, 0
    v_mov_b32 v71, 0
    v_mov_b32 v72, 0
    v_mov_b32 v73, 0
    v_mov_b32 v74, 0
    v_mov_b32 v75, 0
    s_mov_b32 s99, s68
    s_add_u32 s28, s28, 1
    s_add_u32 s36, s36, 196608
    s_add_u32 s38, s38, 262144
    s_add_u32 s39, s39, 262144
    s_mov_b32 s4, s68
    s_mov_b32 s68, s69
    s_mov_b32 s69, s70
    s_mov_b32 s70, s71
    s_mov_b32 s71, s4

    s_and_b32 s4, s28, 3
    s_lshl_b32 s5, s4, 16
    s_add_u32 s29, s5, s34
    s_xor_b32 s6, s5, 0x20000
    s_add_u32 s31, s6, s34
    s_add_u32 s32, s29, 16384
    s_add_u32 s33, s29, 20480

    s_barrier
    ds_read_b128 v[36:39], v248
    s_nop 15
    s_add_u32 s4, s99, 0
    buffer_load_dwordx4 v[192:195], v239, s[8:11], s4 offen sc1
    buffer_load_dwordx4 v[196:199], v249, s[8:11], s4 offen sc1

    s_waitcnt lgkmcnt(0)
    v_mfma_f32_16x16x32_bf16 v[76:79], v[36:39], v[112:115], 0
    s_nop 15
    s_add_u32 s4, s99, 262144
    buffer_load_dwordx4 v[200:203], v239, s[8:11], s4 offen sc1
    buffer_load_dwordx4 v[204:207], v249, s[8:11], s4 offen sc1

    s_nop 15
    s_add_u32 s4, s99, 524288
    buffer_load_dwordx4 v[20:23], v239, s[8:11], s4 offen sc1
    buffer_load_dwordx4 v[24:27], v249, s[8:11], s4 offen sc1

    s_nop 15
    s_add_u32 s4, s99, 786432
    buffer_load_dwordx4 v[28:31], v239, s[8:11], s4 offen sc1
    buffer_load_dwordx4 v[32:35], v249, s[8:11], s4 offen sc1

    s_barrier
.gc_228:
    s_waitcnt vmcnt(6)
    v_max_u32 v4, v192, v196
    v_cmp_eq_u32 vcc, -1, v4
    s_cbranch_vccnz .gc_229

    v_mfma_f32_16x16x32_bf16 v[76:79], v[192:195], v[84:87], v[76:79]
    v_mfma_f32_16x16x32_bf16 v[76:79], v[196:199], v[112:115], v[76:79]
.gd_227:
    s_mov_b64 exec, s[58:59]
    s_nop 6
    v_cvt_pk_bf16_f32 v48, v76, v77
    v_cvt_pk_bf16_f32 v49, v78, v79
    v_min_u32 v48, 0xfffffffe, v48
    buffer_store_dwordx2 v[48:49], v15, s[8:11], s29 offen
    s_mov_b64 exec, -1

    s_waitcnt lgkmcnt(0)
    s_barrier
    s_branch .top3_215
.pf_218:
    buffer_load_dwordx4 v[20:23], v8, s[8:11], s29 offen offset:0 sc1
    s_bitset1_b32 s63, 0
    s_branch .pr_222
.pf_219:
    buffer_load_dwordx4 v[24:27], v8, s[8:11], s29 offen offset:1024 sc1
    s_bitset1_b32 s63, 1
    s_branch .pr_223
.pf_220:
    buffer_load_dwordx4 v[28:31], v8, s[8:11], s29 offen offset:2048 sc1
    s_bitset1_b32 s63, 2
    s_branch .pr_224
.pf_221:
    buffer_load_dwordx4 v[32:35], v8, s[8:11], s29 offen offset:3072 sc1
    s_bitset1_b32 s63, 3
    s_branch .pr_225
.ps_217:
    s_add_u32 s62, s62, 1
    s_cmp_gt_u32 s62, 0x400000
    s_cbranch_scc1 .mg_end_1
    s_bitcmp1_b32 s63, 0
    s_cbranch_scc1 .pw_232
    s_bitcmp1_b32 s63, 1
    s_cbranch_scc1 .pw_233
    s_bitcmp1_b32 s63, 2
    s_cbranch_scc1 .pw_234
.pw_235:
    s_waitcnt vmcnt(0)
    v_max_u32 v4, v32, v34
    v_cmp_eq_u32 vcc, -1, v4
    s_cbranch_vccnz .pg_243
    v_smfmac_f32_16x16x64_bf16 v[52:55], v[32:35], a[24:31], v9
    v_smfmac_f32_16x16x64_bf16 v[56:59], v[32:35], a[56:63], v9
    v_smfmac_f32_16x16x64_bf16 v[60:63], v[32:35], a[88:95], v9
    v_smfmac_f32_16x16x64_bf16 v[64:67], v[32:35], a[120:127], v9
    s_xor_b32 s63, s63, 8
    s_cbranch_scc0 .pd_216
    s_branch .ps_217
.pw_234:
    s_waitcnt vmcnt(0)
    v_max_u32 v4, v28, v30
    v_cmp_eq_u32 vcc, -1, v4
    s_cbranch_vccnz .pg_242
    v_smfmac_f32_16x16x64_bf16 v[52:55], v[28:31], a[16:23], v9
    v_smfmac_f32_16x16x64_bf16 v[56:59], v[28:31], a[48:55], v9
    v_smfmac_f32_16x16x64_bf16 v[60:63], v[28:31], a[80:87], v9
    v_smfmac_f32_16x16x64_bf16 v[64:67], v[28:31], a[112:119], v9
    s_xor_b32 s63, s63, 4
    s_cbranch_scc0 .pd_216
    s_branch .pn_239
.pw_233:
    s_waitcnt vmcnt(0)
    v_max_u32 v4, v24, v26
    v_cmp_eq_u32 vcc, -1, v4
    s_cbranch_vccnz .pg_241
    v_smfmac_f32_16x16x64_bf16 v[52:55], v[24:27], a[8:15], v9
    v_smfmac_f32_16x16x64_bf16 v[56:59], v[24:27], a[40:47], v9
    v_smfmac_f32_16x16x64_bf16 v[60:63], v[24:27], a[72:79], v9
    v_smfmac_f32_16x16x64_bf16 v[64:67], v[24:27], a[104:111], v9
    s_xor_b32 s63, s63, 2
    s_cbranch_scc0 .pd_216
    s_branch .pn_238
.pw_232:
    s_waitcnt vmcnt(0)
    v_max_u32 v4, v20, v22
    v_cmp_eq_u32 vcc, -1, v4
    s_cbranch_vccnz .pg_240
    v_smfmac_f32_16x16x64_bf16 v[52:55], v[20:23], a[0:7], v9
    v_smfmac_f32_16x16x64_bf16 v[56:59], v[20:23], a[32:39], v9
    v_smfmac_f32_16x16x64_bf16 v[60:63], v[20:23], a[64:71], v9
    v_smfmac_f32_16x16x64_bf16 v[64:67], v[20:23], a[96:103], v9
    s_xor_b32 s63, s63, 1
    s_cbranch_scc0 .pd_216
    s_branch .pn_237
.pn_237:
    s_bitcmp1_b32 s63, 1
    s_cbranch_scc0 .pn_238
    v_max_u32 v4, v24, v26
    v_cmp_eq_u32 vcc, -1, v4
    s_cbranch_vccnz .pg_241
    v_smfmac_f32_16x16x64_bf16 v[52:55], v[24:27], a[8:15], v9
    v_smfmac_f32_16x16x64_bf16 v[56:59], v[24:27], a[40:47], v9
    v_smfmac_f32_16x16x64_bf16 v[60:63], v[24:27], a[72:79], v9
    v_smfmac_f32_16x16x64_bf16 v[64:67], v[24:27], a[104:111], v9
    s_xor_b32 s63, s63, 2
    s_cbranch_scc0 .pd_216
.pn_238:
    s_bitcmp1_b32 s63, 2
    s_cbranch_scc0 .pn_239
    v_max_u32 v4, v28, v30
    v_cmp_eq_u32 vcc, -1, v4
    s_cbranch_vccnz .pg_242
    v_smfmac_f32_16x16x64_bf16 v[52:55], v[28:31], a[16:23], v9
    v_smfmac_f32_16x16x64_bf16 v[56:59], v[28:31], a[48:55], v9
    v_smfmac_f32_16x16x64_bf16 v[60:63], v[28:31], a[80:87], v9
    v_smfmac_f32_16x16x64_bf16 v[64:67], v[28:31], a[112:119], v9
    s_xor_b32 s63, s63, 4
    s_cbranch_scc0 .pd_216
.pn_239:
    s_bitcmp1_b32 s63, 3
    s_cbranch_scc0 .ps_217
    v_max_u32 v4, v32, v34
    v_cmp_eq_u32 vcc, -1, v4
    s_cbranch_vccnz .pg_243
    v_smfmac_f32_16x16x64_bf16 v[52:55], v[32:35], a[24:31], v9
    v_smfmac_f32_16x16x64_bf16 v[56:59], v[32:35], a[56:63], v9
    v_smfmac_f32_16x16x64_bf16 v[60:63], v[32:35], a[88:95], v9
    v_smfmac_f32_16x16x64_bf16 v[64:67], v[32:35], a[120:127], v9
    s_xor_b32 s63, s63, 8
    s_cbranch_scc0 .pd_216
    s_branch .ps_217
.pg_240:
    buffer_load_dwordx4 v[20:23], v8, s[8:11], s29 offen offset:0 sc1
    s_branch .pn_237
.pg_241:
    buffer_load_dwordx4 v[24:27], v8, s[8:11], s29 offen offset:1024 sc1
    s_branch .pn_238
.pg_242:
    buffer_load_dwordx4 v[28:31], v8, s[8:11], s29 offen offset:2048 sc1
    s_branch .pn_239
.pg_243:
    buffer_load_dwordx4 v[32:35], v8, s[8:11], s29 offen offset:3072 sc1
    s_branch .ps_217
.last_226:
    s_branch .rec_fin_5
.gc_229:
    s_waitcnt vmcnt(4)
    v_max_u32 v4, v200, v204
    v_cmp_eq_u32 vcc, -1, v4
    s_cbranch_vccnz .gc_230

    v_mfma_f32_16x16x32_bf16 v[76:79], v[200:203], v[84:87], v[76:79]
    v_mfma_f32_16x16x32_bf16 v[76:79], v[204:207], v[112:115], v[76:79]
    s_branch .gd_227
.gc_230:
    s_waitcnt vmcnt(2)
    v_max_u32 v4, v20, v24
    v_cmp_eq_u32 vcc, -1, v4
    s_cbranch_vccnz .gc_231

    v_mfma_f32_16x16x32_bf16 v[76:79], v[20:23], v[84:87], v[76:79]
    v_mfma_f32_16x16x32_bf16 v[76:79], v[24:27], v[112:115], v[76:79]
    s_branch .gd_227
.gc_231:
    s_waitcnt vmcnt(0)
    v_max_u32 v4, v28, v32
    v_cmp_eq_u32 vcc, -1, v4
    s_cbranch_vccnz .gr_244

    v_mfma_f32_16x16x32_bf16 v[76:79], v[28:31], v[84:87], v[76:79]
    v_mfma_f32_16x16x32_bf16 v[76:79], v[32:35], v[112:115], v[76:79]
    s_branch .gd_227
.gr_244:
    s_add_u32 s4, s99, 786432
    buffer_load_dwordx4 v[28:31], v239, s[8:11], s4 offen sc1
    buffer_load_dwordx4 v[32:35], v249, s[8:11], s4 offen sc1

    s_add_u32 s62, s62, 1
    s_cmp_gt_u32 s62, 0x400000
    s_cbranch_scc1 .mg_end_1
    s_branch .gc_231

.p2align 6
.top0_245:
    buffer_load_dwordx4 v[20:23], v8, s[8:11], s29 offen offset:0 sc1
    s_nop 11
    buffer_load_dwordx4 v[24:27], v8, s[8:11], s29 offen offset:1024 sc1
    s_nop 11
    buffer_load_dwordx4 v[28:31], v8, s[8:11], s29 offen offset:2048 sc1
    s_nop 11
    buffer_load_dwordx4 v[32:35], v8, s[8:11], s29 offen offset:3072 sc1
.ent10_25:
    s_waitcnt vmcnt(3)
    v_max_u32 v4, v20, v22
    v_cmp_eq_u32 vcc, -1, v4
    s_cbranch_vccnz .pf_248
    v_smfmac_f32_16x16x64_bf16 v[52:55], v[20:23], a[0:7], v9
    v_smfmac_f32_16x16x64_bf16 v[56:59], v[20:23], a[32:39], v9
    v_smfmac_f32_16x16x64_bf16 v[60:63], v[20:23], a[64:71], v9
    v_smfmac_f32_16x16x64_bf16 v[64:67], v[20:23], a[96:103], v9
.pr_252:
    s_waitcnt vmcnt(2)
    v_max_u32 v4, v24, v26
    v_cmp_eq_u32 vcc, -1, v4
    s_cbranch_vccnz .pf_249
    v_smfmac_f32_16x16x64_bf16 v[52:55], v[24:27], a[8:15], v9
    v_smfmac_f32_16x16x64_bf16 v[56:59], v[24:27], a[40:47], v9
    v_smfmac_f32_16x16x64_bf16 v[60:63], v[24:27], a[72:79], v9
    v_smfmac_f32_16x16x64_bf16 v[64:67], v[24:27], a[104:111], v9
.pr_253:
    s_waitcnt vmcnt(1)
    v_max_u32 v4, v28, v30
    v_cmp_eq_u32 vcc, -1, v4
    s_cbranch_vccnz .pf_250
    v_smfmac_f32_16x16x64_bf16 v[52:55], v[28:31], a[16:23], v9
    v_smfmac_f32_16x16x64_bf16 v[56:59], v[28:31], a[48:55], v9
    v_smfmac_f32_16x16x64_bf16 v[60:63], v[28:31], a[80:87], v9
    v_smfmac_f32_16x16x64_bf16 v[64:67], v[28:31], a[112:119], v9
.pr_254:
    s_waitcnt vmcnt(0)
    v_max_u32 v4, v32, v34
    v_cmp_eq_u32 vcc, -1, v4
    s_cbranch_vccnz .pf_251
    v_smfmac_f32_16x16x64_bf16 v[52:55], v[32:35], a[24:31], v9
    v_smfmac_f32_16x16x64_bf16 v[56:59], v[32:35], a[56:63], v9
    v_smfmac_f32_16x16x64_bf16 v[60:63], v[32:35], a[88:95], v9
    v_smfmac_f32_16x16x64_bf16 v[64:67], v[32:35], a[120:127], v9
.pr_255:
    s_cmp_lg_u32 s63, 0
    s_cbranch_scc1 .ps_247
.pd_246:
    v_cvt_pk_bf16_f32 v104, v52, v53
    v_cvt_pk_bf16_f32 v105, v54, v55
    v_cvt_pk_bf16_f32 v106, v56, v57
    v_cvt_pk_bf16_f32 v107, v58, v59
    ds_write_b64 v16, v[104:105] offset:4096
    v_cvt_pk_bf16_f32 v108, v60, v61
    v_cvt_pk_bf16_f32 v109, v62, v63
    ds_write_b64 v16, v[106:107] offset:6144
    ds_write_b64 v16, v[108:109] offset:0
    s_nop 0
    v_cvt_pk_bf16_f32 v110, v64, v65
    v_cvt_pk_bf16_f32 v111, v66, v67
    ds_write_b64 v16, v[110:111] offset:2048
    v_smfmac_f32_16x16x64_bf16 v[68:71], v[20:23], a[128:135], v9
    v_smfmac_f32_16x16x64_bf16 v[72:75], v[20:23], a[160:167], v9
    s_waitcnt lgkmcnt(0)
    s_barrier
    ds_read_b128 v[36:39], v14 offset:0
    ds_read_b128 v[40:43], v14 offset:1024
    v_smfmac_f32_16x16x64_bf16 v[68:71], v[24:27], a[136:143], v9
    v_smfmac_f32_16x16x64_bf16 v[72:75], v[24:27], a[168:175], v9
    s_waitcnt lgkmcnt(1)
    v_mfma_f32_16x16x32_bf16 v[44:47], v[36:39], v[84:87], 0
    s_waitcnt lgkmcnt(0)
    v_mfma_f32_16x16x32_bf16 v[44:47], v[40:43], v[84:87], v[44:47]
    v_smfmac_f32_16x16x64_bf16 v[68:71], v[28:31], a[144:151], v9
    v_smfmac_f32_16x16x64_bf16 v[72:75], v[28:31], a[176:183], v9
    s_mov_b64 exec, s[66:67]
    v_cvt_pk_bf16_f32 v48, v44, v45
    v_cvt_pk_bf16_f32 v49, v46, v47
    v_min_u32 v48, 0xfffffffe, v48
    buffer_store_dwordx2 v[48:49], v10, s[8:11], s29 offen sc1

    ds_write_b64 v18, v[48:49]
    s_mov_b64 exec, -1

    v_smfmac_f32_16x16x64_bf16 v[68:71], v[32:35], a[152:159], v9
    v_smfmac_f32_16x16x64_bf16 v[72:75], v[32:35], a[184:191], v9
    s_nop 3
    v_cvt_pk_bf16_f32 v104, v68, v69
    v_cvt_pk_bf16_f32 v105, v70, v71
    ds_write_b64 v16, v[104:105] offset:8192
    s_nop 0
    v_cvt_pk_bf16_f32 v106, v72, v73
    v_cvt_pk_bf16_f32 v107, v74, v75
    ds_write_b64 v16, v[106:107] offset:10240
    s_waitcnt lgkmcnt(0)
    s_barrier
    v_mov_b32 v212, v48
    v_min_u32 v213, 0xfffffffe, v49
    v_mov_b32 v214, v48
    v_min_u32 v215, 0xfffffffe, v49
    s_nop 1
    v_permlane16_swap_b32 v212, v214
    v_permlane16_swap_b32 v213, v215

    ds_read_b128 v[36:39], v14 offset:8192
    ds_read_b128 v[40:43], v14 offset:9216
    ds_read_b128 v[44:47], v14 offset:10240
    ds_read_b128 v[48:51], v14 offset:11264
    s_waitcnt lgkmcnt(0)
    v_mfma_f32_16x16x32_bf16 v[104:107], v[84:87], v[36:39], 0
    v_mfma_f32_16x16x32_bf16 v[108:111], v[84:87], v[44:47], 0
    v_mfma_f32_16x16x32_bf16 v[104:107], v[84:87], v[40:43], v[104:107]
    v_mfma_f32_16x16x32_bf16 v[108:111], v[84:87], v[48:51], v[108:111]
    s_nop 7
    v_cndmask_b32 v104, v108, v104, s[60:61]
    v_cndmask_b32 v105, v109, v105, s[60:61]
    v_cndmask_b32 v106, v110, v106, s[60:61]
    v_cndmask_b32 v107, v111, v107, s[60:61]
    v_cvt_pk_bf16_f32 v220, v104, v105
    v_cvt_pk_bf16_f32 v221, v106, v107
    v_min_u32 v220, 0xfffffffe, v220
    v_min_u32 v221, 0xfffffffe, v221
    v_mov_b32 v222, v220
    v_mov_b32 v223, v221
    s_nop 1
    v_permlane16_swap_b32 v220, v222
    v_permlane16_swap_b32 v221, v223

    s_cmp_eq_u32 s28, 63
    s_cbranch_scc1 .last_256
    s_barrier
    buffer_store_dwordx4 v[188:191], v235, s[8:11], s31 offen sc1
    s_barrier
    s_nop 15
    buffer_load_dwordx4 v[20:23], v246, s[8:11], s32 offen offset:0 sc1
    s_nop 3
    buffer_load_dwordx4 v[24:27], v246, s[8:11], s32 offen offset:1024 sc1
    s_nop 3
    buffer_load_dwordx4 v[28:31], v246, s[8:11], s32 offen offset:2048 sc1
    s_nop 3
    buffer_load_dwordx4 v[32:35], v246, s[8:11], s32 offen offset:3072 sc1
    s_nop 3
    buffer_load_dwordx4 v[36:39], v246, s[8:11], s33 offen offset:0 sc1
    s_nop 3
    buffer_load_dwordx4 v[40:43], v246, s[8:11], s33 offen offset:1024 sc1
    s_nop 3
    buffer_load_dwordx4 v[44:47], v246, s[8:11], s33 offen offset:2048 sc1
    s_nop 3
    buffer_load_dwordx4 v[48:51], v246, s[8:11], s33 offen offset:3072 sc1
    s_waitcnt vmcnt(7)
    v_cmp_eq_u32 vcc, -1, v20
    s_cbranch_vccnz .pf_259
    v_smfmac_f32_16x16x64_bf16 v[76:79], v[20:23], a[192:199], v9
    v_smfmac_f32_16x16x64_bf16 v[80:83], v[20:23], a[224:231], v9
.pr_267:
    s_waitcnt vmcnt(6)
    v_cmp_eq_u32 vcc, -1, v24
    s_cbranch_vccnz .pf_260
    v_smfmac_f32_16x16x64_bf16 v[76:79], v[24:27], a[200:207], v9
    v_smfmac_f32_16x16x64_bf16 v[80:83], v[24:27], a[232:239], v9
.pr_268:
    s_waitcnt vmcnt(5)
    v_cmp_eq_u32 vcc, -1, v28
    s_cbranch_vccnz .pf_261
    v_smfmac_f32_16x16x64_bf16 v[76:79], v[28:31], a[208:215], v9
    v_smfmac_f32_16x16x64_bf16 v[80:83], v[28:31], a[240:247], v9
.pr_269:
    s_waitcnt vmcnt(4)
    v_cmp_eq_u32 vcc, -1, v32
    s_cbranch_vccnz .pf_262
    v_smfmac_f32_16x16x64_bf16 v[76:79], v[32:35], a[216:223], v9
    v_smfmac_f32_16x16x64_bf16 v[80:83], v[32:35], a[248:255], v9
.pr_270:
    s_waitcnt vmcnt(3)
    v_cmp_eq_u32 vcc, -1, v36
    s_cbranch_vccnz .pf_263
    v_smfmac_f32_16x16x64_bf16 v[76:79], v[36:39], v[124:131], v9
    v_smfmac_f32_16x16x64_bf16 v[80:83], v[36:39], v[156:163], v9
.pr_271:
    s_waitcnt vmcnt(2)
    v_cmp_eq_u32 vcc, -1, v40
    s_cbranch_vccnz .pf_264
    v_smfmac_f32_16x16x64_bf16 v[76:79], v[40:43], v[132:139], v9
    v_smfmac_f32_16x16x64_bf16 v[80:83], v[40:43], v[164:171], v9
.pr_272:
    s_waitcnt vmcnt(1)
    v_cmp_eq_u32 vcc, -1, v44
    s_cbranch_vccnz .pf_265
    v_smfmac_f32_16x16x64_bf16 v[76:79], v[44:47], v[140:147], v9
    v_smfmac_f32_16x16x64_bf16 v[80:83], v[44:47], v[172:179], v9
.pr_273:
    s_waitcnt vmcnt(0)
    v_cmp_eq_u32 vcc, -1, v48
    s_cbranch_vccnz .pf_266
    v_smfmac_f32_16x16x64_bf16 v[76:79], v[48:51], v[148:155], v9
    v_smfmac_f32_16x16x64_bf16 v[80:83], v[48:51], v[180:187], v9
.pr_274:
    s_cmp_lg_u32 s63, 0
    s_cbranch_scc1 .ps_258
.pd_257:
    s_nop 5
    v_permlane32_swap_b32 v76, v80
    v_permlane32_swap_b32 v77, v81
    v_permlane32_swap_b32 v78, v82
    v_permlane32_swap_b32 v79, v83
    v_add_f32 v76, v76, v80
    v_add_f32 v77, v77, v81
    v_add_f32 v78, v78, v82
    v_add_f32 v79, v79, v83
    v_cvt_pk_bf16_f32 v104, v76, v77
    v_cvt_pk_bf16_f32 v106, v76, v77
    v_cvt_pk_bf16_f32 v105, v78, v79
    v_cvt_pk_bf16_f32 v107, v78, v79
    v_permlane16_swap_b32 v104, v106
    s_nop 0
    v_permlane16_swap_b32 v105, v107
    v_min_u32 v104, 0xfffffffe, v104
    buffer_store_dwordx4 v[104:107], v237, s[8:11], s68 offen sc1

    s_add_u32 s4, s68, 524288
    buffer_store_dwordx4 v[104:107], v237, s[8:11], s4 offen sc1
    ds_write_b128 v247, v[104:107]
    s_waitcnt lgkmcnt(0)
    s_barrier
    v_mov_b32 v52, 0
    v_mov_b32 v53, 0
    v_mov_b32 v54, 0
    v_mov_b32 v55, 0
    v_mov_b32 v56, 0
    v_mov_b32 v57, 0
    v_mov_b32 v58, 0
    v_mov_b32 v59, 0
    v_mov_b32 v60, 0
    v_mov_b32 v61, 0
    v_mov_b32 v62, 0
    v_mov_b32 v63, 0
    v_mov_b32 v64, 0
    v_mov_b32 v65, 0
    v_mov_b32 v66, 0
    v_mov_b32 v67, 0
    v_mov_b32 v68, 0
    v_mov_b32 v69, 0
    v_mov_b32 v70, 0
    v_mov_b32 v71, 0
    v_mov_b32 v72, 0
    v_mov_b32 v73, 0
    v_mov_b32 v74, 0
    v_mov_b32 v75, 0
    v_mov_b32 v76, 0
    v_mov_b32 v77, 0
    v_mov_b32 v78, 0
    v_mov_b32 v79, 0
    v_mov_b32 v80, 0
    v_mov_b32 v81, 0
    v_mov_b32 v82, 0
    v_mov_b32 v83, 0
    s_barrier
    s_add_u32 s6, s28, 2
    s_cmp_lt_u32 s93, s6
    s_cbranch_scc1 .kf_275
.kb_276:
    s_add_u32 s4, s38, 4096
    s_add_u32 s5, s39, 1024
    s_mov_b32 m0, 20480
    s_nop 0
    buffer_load_dwordx4 v224, s[8:11], s38 offen lds

    s_mov_b32 m0, 21504
    s_nop 0
    buffer_load_dwordx4 v225, s[8:11], s38 offen lds

    s_mov_b32 m0, 22528
    s_nop 0
    buffer_load_dwordx4 v226, s[8:11], s38 offen lds

    s_mov_b32 m0, 23552
    s_nop 0
    buffer_load_dwordx4 v227, s[8:11], s38 offen lds

    s_mov_b32 m0, 28672
    s_nop 0
    buffer_load_dwordx4 v14, s[8:11], s39 offen lds

    s_mov_b64 exec, s[90:91]
    buffer_store_dwordx4 v[212:215], v11, s[8:11], s36 offen sc1
    s_mov_b64 exec, -1
    s_mov_b64 exec, s[56:57]
    buffer_store_dwordx4 v[220:223], v12, s[8:11], s36 offen sc1
    s_mov_b64 exec, -1
    s_add_u32 s4, s70, 0
    buffer_store_dwordx4 v[188:191], v238, s[8:11], s4 offen sc1
    s_add_u32 s4, s70, 524288
    buffer_store_dwordx4 v[188:191], v238, s[8:11], s4 offen sc1
    s_add_u32 s28, s28, 1
    s_add_u32 s36, s36, 196608
    s_add_u32 s38, s38, 262144
    s_add_u32 s39, s39, 262144
    s_mov_b32 s4, s68
    s_mov_b32 s68, s69
    s_mov_b32 s69, s70
    s_mov_b32 s70, s71
    s_mov_b32 s71, s4

    s_and_b32 s4, s28, 3
    s_lshl_b32 s5, s4, 16
    s_add_u32 s29, s5, s34
    s_xor_b32 s6, s5, 0x20000
    s_add_u32 s31, s6, s34
    s_add_u32 s32, s29, 16384
    s_add_u32 s33, s29, 20480

    s_waitcnt lgkmcnt(0)
    s_barrier
    s_branch .top0_245
.pf_248:
    buffer_load_dwordx4 v[20:23], v8, s[8:11], s29 offen offset:0 sc1
    s_bitset1_b32 s63, 0
    s_branch .pr_252
.pf_249:
    buffer_load_dwordx4 v[24:27], v8, s[8:11], s29 offen offset:1024 sc1
    s_bitset1_b32 s63, 1
    s_branch .pr_253
.pf_250:
    buffer_load_dwordx4 v[28:31], v8, s[8:11], s29 offen offset:2048 sc1
    s_bitset1_b32 s63, 2
    s_branch .pr_254
.pf_251:
    buffer_load_dwordx4 v[32:35], v8, s[8:11], s29 offen offset:3072 sc1
    s_bitset1_b32 s63, 3
    s_branch .pr_255
.ps_247:
    s_add_u32 s62, s62, 1
    s_cmp_gt_u32 s62, 0x400000
    s_cbranch_scc1 .mg_end_1
    s_bitcmp1_b32 s63, 0
    s_cbranch_scc1 .pw_277
    s_bitcmp1_b32 s63, 1
    s_cbranch_scc1 .pw_278
    s_bitcmp1_b32 s63, 2
    s_cbranch_scc1 .pw_279
.pw_280:
    s_waitcnt vmcnt(0)
    v_max_u32 v4, v32, v34
    v_cmp_eq_u32 vcc, -1, v4
    s_cbranch_vccnz .pg_288
    v_smfmac_f32_16x16x64_bf16 v[52:55], v[32:35], a[24:31], v9
    v_smfmac_f32_16x16x64_bf16 v[56:59], v[32:35], a[56:63], v9
    v_smfmac_f32_16x16x64_bf16 v[60:63], v[32:35], a[88:95], v9
    v_smfmac_f32_16x16x64_bf16 v[64:67], v[32:35], a[120:127], v9
    s_xor_b32 s63, s63, 8
    s_cbranch_scc0 .pd_246
    s_branch .ps_247
.pw_279:
    s_waitcnt vmcnt(0)
    v_max_u32 v4, v28, v30
    v_cmp_eq_u32 vcc, -1, v4
    s_cbranch_vccnz .pg_287
    v_smfmac_f32_16x16x64_bf16 v[52:55], v[28:31], a[16:23], v9
    v_smfmac_f32_16x16x64_bf16 v[56:59], v[28:31], a[48:55], v9
    v_smfmac_f32_16x16x64_bf16 v[60:63], v[28:31], a[80:87], v9
    v_smfmac_f32_16x16x64_bf16 v[64:67], v[28:31], a[112:119], v9
    s_xor_b32 s63, s63, 4
    s_cbranch_scc0 .pd_246
    s_branch .pn_284
.pw_278:
    s_waitcnt vmcnt(0)
    v_max_u32 v4, v24, v26
    v_cmp_eq_u32 vcc, -1, v4
    s_cbranch_vccnz .pg_286
    v_smfmac_f32_16x16x64_bf16 v[52:55], v[24:27], a[8:15], v9
    v_smfmac_f32_16x16x64_bf16 v[56:59], v[24:27], a[40:47], v9
    v_smfmac_f32_16x16x64_bf16 v[60:63], v[24:27], a[72:79], v9
    v_smfmac_f32_16x16x64_bf16 v[64:67], v[24:27], a[104:111], v9
    s_xor_b32 s63, s63, 2
    s_cbranch_scc0 .pd_246
    s_branch .pn_283
.pw_277:
    s_waitcnt vmcnt(0)
    v_max_u32 v4, v20, v22
    v_cmp_eq_u32 vcc, -1, v4
    s_cbranch_vccnz .pg_285
    v_smfmac_f32_16x16x64_bf16 v[52:55], v[20:23], a[0:7], v9
    v_smfmac_f32_16x16x64_bf16 v[56:59], v[20:23], a[32:39], v9
    v_smfmac_f32_16x16x64_bf16 v[60:63], v[20:23], a[64:71], v9
    v_smfmac_f32_16x16x64_bf16 v[64:67], v[20:23], a[96:103], v9
    s_xor_b32 s63, s63, 1
    s_cbranch_scc0 .pd_246
    s_branch .pn_282
.pn_282:
    s_bitcmp1_b32 s63, 1
    s_cbranch_scc0 .pn_283
    v_max_u32 v4, v24, v26
    v_cmp_eq_u32 vcc, -1, v4
    s_cbranch_vccnz .pg_286
    v_smfmac_f32_16x16x64_bf16 v[52:55], v[24:27], a[8:15], v9
    v_smfmac_f32_16x16x64_bf16 v[56:59], v[24:27], a[40:47], v9
    v_smfmac_f32_16x16x64_bf16 v[60:63], v[24:27], a[72:79], v9
    v_smfmac_f32_16x16x64_bf16 v[64:67], v[24:27], a[104:111], v9
    s_xor_b32 s63, s63, 2
    s_cbranch_scc0 .pd_246
.pn_283:
    s_bitcmp1_b32 s63, 2
    s_cbranch_scc0 .pn_284
    v_max_u32 v4, v28, v30
    v_cmp_eq_u32 vcc, -1, v4
    s_cbranch_vccnz .pg_287
    v_smfmac_f32_16x16x64_bf16 v[52:55], v[28:31], a[16:23], v9
    v_smfmac_f32_16x16x64_bf16 v[56:59], v[28:31], a[48:55], v9
    v_smfmac_f32_16x16x64_bf16 v[60:63], v[28:31], a[80:87], v9
    v_smfmac_f32_16x16x64_bf16 v[64:67], v[28:31], a[112:119], v9
    s_xor_b32 s63, s63, 4
    s_cbranch_scc0 .pd_246
.pn_284:
    s_bitcmp1_b32 s63, 3
    s_cbranch_scc0 .ps_247
    v_max_u32 v4, v32, v34
    v_cmp_eq_u32 vcc, -1, v4
    s_cbranch_vccnz .pg_288
    v_smfmac_f32_16x16x64_bf16 v[52:55], v[32:35], a[24:31], v9
    v_smfmac_f32_16x16x64_bf16 v[56:59], v[32:35], a[56:63], v9
    v_smfmac_f32_16x16x64_bf16 v[60:63], v[32:35], a[88:95], v9
    v_smfmac_f32_16x16x64_bf16 v[64:67], v[32:35], a[120:127], v9
    s_xor_b32 s63, s63, 8
    s_cbranch_scc0 .pd_246
    s_branch .ps_247
.pg_285:
    buffer_load_dwordx4 v[20:23], v8, s[8:11], s29 offen offset:0 sc1
    s_branch .pn_282
.pg_286:
    buffer_load_dwordx4 v[24:27], v8, s[8:11], s29 offen offset:1024 sc1
    s_branch .pn_283
.pg_287:
    buffer_load_dwordx4 v[28:31], v8, s[8:11], s29 offen offset:2048 sc1
    s_branch .pn_284
.pg_288:
    buffer_load_dwordx4 v[32:35], v8, s[8:11], s29 offen offset:3072 sc1
    s_branch .ps_247
.last_256:
    s_mov_b64 exec, s[90:91]
    buffer_store_dwordx4 v[212:215], v11, s[8:11], s36 offen sc1
    s_mov_b64 exec, -1
    s_mov_b64 exec, s[56:57]
    buffer_store_dwordx4 v[220:223], v12, s[8:11], s36 offen sc1
    s_mov_b64 exec, -1
    s_branch .rec_fin_5
.pf_259:
    buffer_load_dwordx4 v[20:23], v246, s[8:11], s32 offen offset:0 sc1
    s_bitset1_b32 s63, 0
    s_branch .pr_267
.pf_260:
    buffer_load_dwordx4 v[24:27], v246, s[8:11], s32 offen offset:1024 sc1
    s_bitset1_b32 s63, 1
    s_branch .pr_268
.pf_261:
    buffer_load_dwordx4 v[28:31], v246, s[8:11], s32 offen offset:2048 sc1
    s_bitset1_b32 s63, 2
    s_branch .pr_269
.pf_262:
    buffer_load_dwordx4 v[32:35], v246, s[8:11], s32 offen offset:3072 sc1
    s_bitset1_b32 s63, 3
    s_branch .pr_270
.pf_263:
    buffer_load_dwordx4 v[36:39], v246, s[8:11], s33 offen offset:0 sc1
    s_bitset1_b32 s63, 4
    s_branch .pr_271
.pf_264:
    buffer_load_dwordx4 v[40:43], v246, s[8:11], s33 offen offset:1024 sc1
    s_bitset1_b32 s63, 5
    s_branch .pr_272
.pf_265:
    buffer_load_dwordx4 v[44:47], v246, s[8:11], s33 offen offset:2048 sc1
    s_bitset1_b32 s63, 6
    s_branch .pr_273
.pf_266:
    buffer_load_dwordx4 v[48:51], v246, s[8:11], s33 offen offset:3072 sc1
    s_bitset1_b32 s63, 7
    s_branch .pr_274
.ps_258:
    s_add_u32 s62, s62, 1
    s_cmp_gt_u32 s62, 0x400000
    s_cbranch_scc1 .mg_end_1
    s_bitcmp1_b32 s63, 0
    s_cbranch_scc1 .pw_289
    s_bitcmp1_b32 s63, 1
    s_cbranch_scc1 .pw_290
    s_bitcmp1_b32 s63, 2
    s_cbranch_scc1 .pw_291
    s_bitcmp1_b32 s63, 3
    s_cbranch_scc1 .pw_292
    s_bitcmp1_b32 s63, 4
    s_cbranch_scc1 .pw_293
    s_bitcmp1_b32 s63, 5
    s_cbranch_scc1 .pw_294
    s_bitcmp1_b32 s63, 6
    s_cbranch_scc1 .pw_295
.pw_296:
    s_waitcnt vmcnt(0)
    v_cmp_eq_u32 vcc, -1, v48
    s_cbranch_vccnz .pg_312
    v_smfmac_f32_16x16x64_bf16 v[76:79], v[48:51], v[148:155], v9
    v_smfmac_f32_16x16x64_bf16 v[80:83], v[48:51], v[180:187], v9
    s_xor_b32 s63, s63, 128
    s_cbranch_scc0 .pd_257
    s_branch .ps_258
.pw_295:
    s_waitcnt vmcnt(0)
    v_cmp_eq_u32 vcc, -1, v44
    s_cbranch_vccnz .pg_311
    v_smfmac_f32_16x16x64_bf16 v[76:79], v[44:47], v[140:147], v9
    v_smfmac_f32_16x16x64_bf16 v[80:83], v[44:47], v[172:179], v9
    s_xor_b32 s63, s63, 64
    s_cbranch_scc0 .pd_257
    s_branch .pn_304
.pw_294:
    s_waitcnt vmcnt(0)
    v_cmp_eq_u32 vcc, -1, v40
    s_cbranch_vccnz .pg_310
    v_smfmac_f32_16x16x64_bf16 v[76:79], v[40:43], v[132:139], v9
    v_smfmac_f32_16x16x64_bf16 v[80:83], v[40:43], v[164:171], v9
    s_xor_b32 s63, s63, 32
    s_cbranch_scc0 .pd_257
    s_branch .pn_303
.pw_293:
    s_waitcnt vmcnt(0)
    v_cmp_eq_u32 vcc, -1, v36
    s_cbranch_vccnz .pg_309
    v_smfmac_f32_16x16x64_bf16 v[76:79], v[36:39], v[124:131], v9
    v_smfmac_f32_16x16x64_bf16 v[80:83], v[36:39], v[156:163], v9
    s_xor_b32 s63, s63, 16
    s_cbranch_scc0 .pd_257
    s_branch .pn_302
.pw_292:
    s_waitcnt vmcnt(0)
    v_cmp_eq_u32 vcc, -1, v32
    s_cbranch_vccnz .pg_308
    v_smfmac_f32_16x16x64_bf16 v[76:79], v[32:35], a[216:223], v9
    v_smfmac_f32_16x16x64_bf16 v[80:83], v[32:35], a[248:255], v9
    s_xor_b32 s63, s63, 8
    s_cbranch_scc0 .pd_257
    s_branch .pn_301
.pw_291:
    s_waitcnt vmcnt(0)
    v_cmp_eq_u32 vcc, -1, v28
    s_cbranch_vccnz .pg_307
    v_smfmac_f32_16x16x64_bf16 v[76:79], v[28:31], a[208:215], v9
    v_smfmac_f32_16x16x64_bf16 v[80:83], v[28:31], a[240:247], v9
    s_xor_b32 s63, s63, 4
    s_cbranch_scc0 .pd_257
    s_branch .pn_300
.pw_290:
    s_waitcnt vmcnt(0)
    v_cmp_eq_u32 vcc, -1, v24
    s_cbranch_vccnz .pg_306
    v_smfmac_f32_16x16x64_bf16 v[76:79], v[24:27], a[200:207], v9
    v_smfmac_f32_16x16x64_bf16 v[80:83], v[24:27], a[232:239], v9
    s_xor_b32 s63, s63, 2
    s_cbranch_scc0 .pd_257
    s_branch .pn_299
.pw_289:
    s_waitcnt vmcnt(0)
    v_cmp_eq_u32 vcc, -1, v20
    s_cbranch_vccnz .pg_305
    v_smfmac_f32_16x16x64_bf16 v[76:79], v[20:23], a[192:199], v9
    v_smfmac_f32_16x16x64_bf16 v[80:83], v[20:23], a[224:231], v9
    s_xor_b32 s63, s63, 1
    s_cbranch_scc0 .pd_257
    s_branch .pn_298
.pn_298:
    s_bitcmp1_b32 s63, 1
    s_cbranch_scc0 .pn_299
    v_cmp_eq_u32 vcc, -1, v24
    s_cbranch_vccnz .pg_306
    v_smfmac_f32_16x16x64_bf16 v[76:79], v[24:27], a[200:207], v9
    v_smfmac_f32_16x16x64_bf16 v[80:83], v[24:27], a[232:239], v9
    s_xor_b32 s63, s63, 2
    s_cbranch_scc0 .pd_257
.pn_299:
    s_bitcmp1_b32 s63, 2
    s_cbranch_scc0 .pn_300
    v_cmp_eq_u32 vcc, -1, v28
    s_cbranch_vccnz .pg_307
    v_smfmac_f32_16x16x64_bf16 v[76:79], v[28:31], a[208:215], v9
    v_smfmac_f32_16x16x64_bf16 v[80:83], v[28:31], a[240:247], v9
    s_xor_b32 s63, s63, 4
    s_cbranch_scc0 .pd_257
.pn_300:
    s_bitcmp1_b32 s63, 3
    s_cbranch_scc0 .pn_301
    v_cmp_eq_u32 vcc, -1, v32
    s_cbranch_vccnz .pg_308
    v_smfmac_f32_16x16x64_bf16 v[76:79], v[32:35], a[216:223], v9
    v_smfmac_f32_16x16x64_bf16 v[80:83], v[32:35], a[248:255], v9
    s_xor_b32 s63, s63, 8
    s_cbranch_scc0 .pd_257
.pn_301:
    s_bitcmp1_b32 s63, 4
    s_cbranch_scc0 .pn_302
    v_cmp_eq_u32 vcc, -1, v36
    s_cbranch_vccnz .pg_309
    v_smfmac_f32_16x16x64_bf16 v[76:79], v[36:39], v[124:131], v9
    v_smfmac_f32_16x16x64_bf16 v[80:83], v[36:39], v[156:163], v9
    s_xor_b32 s63, s63, 16
    s_cbranch_scc0 .pd_257
.pn_302:
    s_bitcmp1_b32 s63, 5
    s_cbranch_scc0 .pn_303
    v_cmp_eq_u32 vcc, -1, v40
    s_cbranch_vccnz .pg_310
    v_smfmac_f32_16x16x64_bf16 v[76:79], v[40:43], v[132:139], v9
    v_smfmac_f32_16x16x64_bf16 v[80:83], v[40:43], v[164:171], v9
    s_xor_b32 s63, s63, 32
    s_cbranch_scc0 .pd_257
.pn_303:
    s_bitcmp1_b32 s63, 6
    s_cbranch_scc0 .pn_304
    v_cmp_eq_u32 vcc, -1, v44
    s_cbranch_vccnz .pg_311
    v_smfmac_f32_16x16x64_bf16 v[76:79], v[44:47], v[140:147], v9
    v_smfmac_f32_16x16x64_bf16 v[80:83], v[44:47], v[172:179], v9
    s_xor_b32 s63, s63, 64
    s_cbranch_scc0 .pd_257
.pn_304:
    s_bitcmp1_b32 s63, 7
    s_cbranch_scc0 .ps_258
    v_cmp_eq_u32 vcc, -1, v48
    s_cbranch_vccnz .pg_312
    v_smfmac_f32_16x16x64_bf16 v[76:79], v[48:51], v[148:155], v9
    v_smfmac_f32_16x16x64_bf16 v[80:83], v[48:51], v[180:187], v9
    s_xor_b32 s63, s63, 128
    s_cbranch_scc0 .pd_257
    s_branch .ps_258
.pg_305:
    buffer_load_dwordx4 v[20:23], v246, s[8:11], s32 offen offset:0 sc1
    s_branch .pn_298
.pg_306:
    buffer_load_dwordx4 v[24:27], v246, s[8:11], s32 offen offset:1024 sc1
    s_branch .pn_299
.pg_307:
    buffer_load_dwordx4 v[28:31], v246, s[8:11], s32 offen offset:2048 sc1
    s_branch .pn_300
.pg_308:
    buffer_load_dwordx4 v[32:35], v246, s[8:11], s32 offen offset:3072 sc1
    s_branch .pn_301
.pg_309:
    buffer_load_dwordx4 v[36:39], v246, s[8:11], s33 offen offset:0 sc1
    s_branch .pn_302
.pg_310:
    buffer_load_dwordx4 v[40:43], v246, s[8:11], s33 offen offset:1024 sc1
    s_branch .pn_303
.pg_311:
    buffer_load_dwordx4 v[44:47], v246, s[8:11], s33 offen offset:2048 sc1
    s_branch .pn_304
.pg_312:
    buffer_load_dwordx4 v[48:51], v246, s[8:11], s33 offen offset:3072 sc1
    s_branch .ps_258
.kf_275:
    s_mov_b32 s62, 0
    s_mov_b64 exec, 3
.wf_313:
    buffer_load_dword v4, v253, s[8:11], s89 offen sc1
    s_waitcnt vmcnt(0)
    v_cmp_gt_u32 vcc, s6, v4
    s_cbranch_vccz .wfd_314
    s_sleep 2
    s_add_u32 s62, s62, 1
    s_cmp_gt_u32 s62, 0x400000
    s_cbranch_scc1 .mg_end_1
    s_branch .wf_313

.wfd_314:
    s_mov_b64 exec, -1
    v_readlane_b32 s4, v4, 0
    v_readlane_b32 s93, v4, 1
    s_min_u32 s93, s93, s4
    s_branch .kb_276
.p2align 6
.top1_315:
    buffer_load_dwordx4 v[20:23], v8, s[8:11], s29 offen offset:0 sc1
    s_nop 11
    buffer_load_dwordx4 v[24:27], v8, s[8:11], s29 offen offset:1024 sc1
    s_nop 11
    buffer_load_dwordx4 v[28:31], v8, s[8:11], s29 offen offset:2048 sc1
    s_nop 11
    buffer_load_dwordx4 v[32:35], v8, s[8:11], s29 offen offset:3072 sc1
.ent11_26:
    s_waitcnt vmcnt(3)
    v_max_u32 v4, v20, v22
    v_cmp_eq_u32 vcc, -1, v4
    s_cbranch_vccnz .pf_318
    v_smfmac_f32_16x16x64_bf16 v[52:55], v[20:23], a[0:7], v9
    v_smfmac_f32_16x16x64_bf16 v[56:59], v[20:23], a[32:39], v9
    v_smfmac_f32_16x16x64_bf16 v[60:63], v[20:23], a[64:71], v9
    v_smfmac_f32_16x16x64_bf16 v[64:67], v[20:23], a[96:103], v9
.pr_322:
    s_waitcnt vmcnt(2)
    v_max_u32 v4, v24, v26
    v_cmp_eq_u32 vcc, -1, v4
    s_cbranch_vccnz .pf_319
    v_smfmac_f32_16x16x64_bf16 v[52:55], v[24:27], a[8:15], v9
    v_smfmac_f32_16x16x64_bf16 v[56:59], v[24:27], a[40:47], v9
    v_smfmac_f32_16x16x64_bf16 v[60:63], v[24:27], a[72:79], v9
    v_smfmac_f32_16x16x64_bf16 v[64:67], v[24:27], a[104:111], v9
.pr_323:
    s_waitcnt vmcnt(1)
    v_max_u32 v4, v28, v30
    v_cmp_eq_u32 vcc, -1, v4
    s_cbranch_vccnz .pf_320
    v_smfmac_f32_16x16x64_bf16 v[52:55], v[28:31], a[16:23], v9
    v_smfmac_f32_16x16x64_bf16 v[56:59], v[28:31], a[48:55], v9
    v_smfmac_f32_16x16x64_bf16 v[60:63], v[28:31], a[80:87], v9
    v_smfmac_f32_16x16x64_bf16 v[64:67], v[28:31], a[112:119], v9
.pr_324:
    s_waitcnt vmcnt(0)
    v_max_u32 v4, v32, v34
    v_cmp_eq_u32 vcc, -1, v4
    s_cbranch_vccnz .pf_321
    v_smfmac_f32_16x16x64_bf16 v[52:55], v[32:35], a[24:31], v9
    v_smfmac_f32_16x16x64_bf16 v[56:59], v[32:35], a[56:63], v9
    v_smfmac_f32_16x16x64_bf16 v[60:63], v[32:35], a[88:95], v9
    v_smfmac_f32_16x16x64_bf16 v[64:67], v[32:35], a[120:127], v9
.pr_325:
    s_cmp_lg_u32 s63, 0
    s_cbranch_scc1 .ps_317
.pd_316:
    v_cvt_pk_bf16_f32 v104, v52, v53
    v_cvt_pk_bf16_f32 v105, v54, v55
    v_cvt_pk_bf16_f32 v106, v56, v57
    v_cvt_pk_bf16_f32 v107, v58, v59
    ds_write_b64 v16, v[104:105] offset:4096
    v_cvt_pk_bf16_f32 v108, v60, v61
    v_cvt_pk_bf16_f32 v109, v62, v63
    ds_write_b64 v16, v[106:107] offset:6144
    ds_write_b64 v16, v[108:109] offset:0
    s_nop 0
    v_cvt_pk_bf16_f32 v110, v64, v65
    v_cvt_pk_bf16_f32 v111, v66, v67
    ds_write_b64 v16, v[110:111] offset:2048
    v_smfmac_f32_16x16x64_bf16 v[68:71], v[20:23], a[128:135], v9
    v_smfmac_f32_16x16x64_bf16 v[72:75], v[20:23], a[160:167], v9
    s_waitcnt lgkmcnt(0)
    s_barrier
    ds_read_b128 v[36:39], v14 offset:2048
    ds_read_b128 v[40:43], v14 offset:3072
    v_smfmac_f32_16x16x64_bf16 v[68:71], v[24:27], a[136:143], v9
    v_smfmac_f32_16x16x64_bf16 v[72:75], v[24:27], a[168:175], v9
    s_waitcnt lgkmcnt(1)
    v_mfma_f32_16x16x32_bf16 v[44:47], v[36:39], v[84:87], 0
    s_waitcnt lgkmcnt(0)
    v_mfma_f32_16x16x32_bf16 v[44:47], v[40:43], v[84:87], v[44:47]
    v_smfmac_f32_16x16x64_bf16 v[68:71], v[28:31], a[144:151], v9
    v_smfmac_f32_16x16x64_bf16 v[72:75], v[28:31], a[176:183], v9
    s_mov_b64 exec, s[66:67]
    v_cvt_pk_bf16_f32 v48, v44, v45
    v_cvt_pk_bf16_f32 v49, v46, v47
    v_min_u32 v48, 0xfffffffe, v48
    buffer_store_dwordx2 v[48:49], v10, s[8:11], s29 offen sc1

    ds_write_b64 v18, v[48:49]
    s_mov_b64 exec, -1

    v_smfmac_f32_16x16x64_bf16 v[68:71], v[32:35], a[152:159], v9
    v_smfmac_f32_16x16x64_bf16 v[72:75], v[32:35], a[184:191], v9
    s_nop 3
    v_cvt_pk_bf16_f32 v104, v68, v69
    v_cvt_pk_bf16_f32 v105, v70, v71
    ds_write_b64 v16, v[104:105] offset:8192
    s_nop 0
    v_cvt_pk_bf16_f32 v106, v72, v73
    v_cvt_pk_bf16_f32 v107, v74, v75
    ds_write_b64 v16, v[106:107] offset:10240
    s_waitcnt lgkmcnt(0)
    s_barrier
    v_mov_b32 v212, v48
    v_min_u32 v213, 0xfffffffe, v49
    v_mov_b32 v214, v48
    v_min_u32 v215, 0xfffffffe, v49
    s_nop 1
    v_permlane16_swap_b32 v212, v214
    v_permlane16_swap_b32 v213, v215

    s_cmp_eq_u32 s28, 63
    s_cbranch_scc1 .last_326
    s_barrier
    buffer_store_dwordx4 v[188:191], v236, s[8:11], s31 offen sc1
    s_barrier
    s_nop 15
    buffer_load_dwordx4 v[20:23], v246, s[8:11], s32 offen offset:0 sc1
    s_nop 3
    buffer_load_dwordx4 v[24:27], v246, s[8:11], s32 offen offset:1024 sc1
    s_nop 3
    buffer_load_dwordx4 v[28:31], v246, s[8:11], s32 offen offset:2048 sc1
    s_nop 3
    buffer_load_dwordx4 v[32:35], v246, s[8:11], s32 offen offset:3072 sc1
    s_nop 3
    buffer_load_dwordx4 v[36:39], v246, s[8:11], s33 offen offset:0 sc1
    s_nop 3
    buffer_load_dwordx4 v[40:43], v246, s[8:11], s33 offen offset:1024 sc1
    s_nop 3
    buffer_load_dwordx4 v[44:47], v246, s[8:11], s33 offen offset:2048 sc1
    s_nop 3
    buffer_load_dwordx4 v[48:51], v246, s[8:11], s33 offen offset:3072 sc1
    s_waitcnt vmcnt(7)
    v_cmp_eq_u32 vcc, -1, v20
    s_cbranch_vccnz .pf_329
    v_smfmac_f32_16x16x64_bf16 v[76:79], v[20:23], a[192:199], v9
    v_smfmac_f32_16x16x64_bf16 v[80:83], v[20:23], a[224:231], v9
.pr_337:
    s_waitcnt vmcnt(6)
    v_cmp_eq_u32 vcc, -1, v24
    s_cbranch_vccnz .pf_330
    v_smfmac_f32_16x16x64_bf16 v[76:79], v[24:27], a[200:207], v9
    v_smfmac_f32_16x16x64_bf16 v[80:83], v[24:27], a[232:239], v9
.pr_338:
    s_waitcnt vmcnt(5)
    v_cmp_eq_u32 vcc, -1, v28
    s_cbranch_vccnz .pf_331
    v_smfmac_f32_16x16x64_bf16 v[76:79], v[28:31], a[208:215], v9
    v_smfmac_f32_16x16x64_bf16 v[80:83], v[28:31], a[240:247], v9
.pr_339:
    s_waitcnt vmcnt(4)
    v_cmp_eq_u32 vcc, -1, v32
    s_cbranch_vccnz .pf_332
    v_smfmac_f32_16x16x64_bf16 v[76:79], v[32:35], a[216:223], v9
    v_smfmac_f32_16x16x64_bf16 v[80:83], v[32:35], a[248:255], v9
.pr_340:
    s_waitcnt vmcnt(3)
    v_cmp_eq_u32 vcc, -1, v36
    s_cbranch_vccnz .pf_333
    v_smfmac_f32_16x16x64_bf16 v[76:79], v[36:39], v[124:131], v9
    v_smfmac_f32_16x16x64_bf16 v[80:83], v[36:39], v[156:163], v9
.pr_341:
    s_waitcnt vmcnt(2)
    v_cmp_eq_u32 vcc, -1, v40
    s_cbranch_vccnz .pf_334
    v_smfmac_f32_16x16x64_bf16 v[76:79], v[40:43], v[132:139], v9
    v_smfmac_f32_16x16x64_bf16 v[80:83], v[40:43], v[164:171], v9
.pr_342:
    s_waitcnt vmcnt(1)
    v_cmp_eq_u32 vcc, -1, v44
    s_cbranch_vccnz .pf_335
    v_smfmac_f32_16x16x64_bf16 v[76:79], v[44:47], v[140:147], v9
    v_smfmac_f32_16x16x64_bf16 v[80:83], v[44:47], v[172:179], v9
.pr_343:
    s_waitcnt vmcnt(0)
    v_cmp_eq_u32 vcc, -1, v48
    s_cbranch_vccnz .pf_336
    v_smfmac_f32_16x16x64_bf16 v[76:79], v[48:51], v[148:155], v9
    v_smfmac_f32_16x16x64_bf16 v[80:83], v[48:51], v[180:187], v9
.pr_344:
    s_cmp_lg_u32 s63, 0
    s_cbranch_scc1 .ps_328
.pd_327:
    s_nop 5
    v_permlane32_swap_b32 v76, v80
    v_permlane32_swap_b32 v77, v81
    v_permlane32_swap_b32 v78, v82
    v_permlane32_swap_b32 v79, v83
    v_add_f32 v76, v76, v80
    v_add_f32 v77, v77, v81
    v_add_f32 v78, v78, v82
    v_add_f32 v79, v79, v83
    v_cvt_pk_bf16_f32 v104, v76, v77
    v_cvt_pk_bf16_f32 v106, v76, v77
    v_cvt_pk_bf16_f32 v105, v78, v79
    v_cvt_pk_bf16_f32 v107, v78, v79
    v_permlane16_swap_b32 v104, v106
    s_nop 0
    v_permlane16_swap_b32 v105, v107
    v_min_u32 v104, 0xfffffffe, v104
    buffer_store_dwordx4 v[104:107], v237, s[8:11], s68 offen sc1

    s_add_u32 s4, s68, 524288
    buffer_store_dwordx4 v[104:107], v237, s[8:11], s4 offen sc1
    ds_write_b128 v247, v[104:107]
    s_waitcnt lgkmcnt(0)
    s_barrier
    v_mov_b32 v52, 0
    v_mov_b32 v53, 0
    v_mov_b32 v54, 0
    v_mov_b32 v55, 0
    v_mov_b32 v56, 0
    v_mov_b32 v57, 0
    v_mov_b32 v58, 0
    v_mov_b32 v59, 0
    v_mov_b32 v60, 0
    v_mov_b32 v61, 0
    v_mov_b32 v62, 0
    v_mov_b32 v63, 0
    v_mov_b32 v64, 0
    v_mov_b32 v65, 0
    v_mov_b32 v66, 0
    v_mov_b32 v67, 0
    v_mov_b32 v68, 0
    v_mov_b32 v69, 0
    v_mov_b32 v70, 0
    v_mov_b32 v71, 0
    v_mov_b32 v72, 0
    v_mov_b32 v73, 0
    v_mov_b32 v74, 0
    v_mov_b32 v75, 0
    v_mov_b32 v76, 0
    v_mov_b32 v77, 0
    v_mov_b32 v78, 0
    v_mov_b32 v79, 0
    v_mov_b32 v80, 0
    v_mov_b32 v81, 0
    v_mov_b32 v82, 0
    v_mov_b32 v83, 0
    s_barrier
    s_add_u32 s6, s28, 2
    s_cmp_lt_u32 s93, s6
    s_cbranch_scc1 .kf_345
.kb_346:
    s_add_u32 s4, s38, 4096
    s_add_u32 s5, s39, 1024
    s_mov_b32 m0, 24576
    s_nop 0
    buffer_load_dwordx4 v224, s[8:11], s4 offen lds

    s_mov_b32 m0, 25600
    s_nop 0
    buffer_load_dwordx4 v225, s[8:11], s4 offen lds

    s_mov_b32 m0, 26624
    s_nop 0
    buffer_load_dwordx4 v226, s[8:11], s4 offen lds

    s_mov_b32 m0, 27648
    s_nop 0
    buffer_load_dwordx4 v227, s[8:11], s4 offen lds

    s_mov_b32 m0, 29696
    s_nop 0
    buffer_load_dwordx4 v14, s[8:11], s5 offen lds

    s_mov_b64 exec, s[90:91]
    buffer_store_dwordx4 v[212:215], v11, s[8:11], s36 offen sc1
    s_mov_b64 exec, -1
    s_add_u32 s4, s70, 262144
    buffer_store_dwordx4 v[188:191], v238, s[8:11], s4 offen sc1
    s_add_u32 s4, s70, 786432
    buffer_store_dwordx4 v[188:191], v238, s[8:11], s4 offen sc1
    s_add_u32 s28, s28, 1
    s_add_u32 s36, s36, 196608
    s_add_u32 s38, s38, 262144
    s_add_u32 s39, s39, 262144
    s_mov_b32 s4, s68
    s_mov_b32 s68, s69
    s_mov_b32 s69, s70
    s_mov_b32 s70, s71
    s_mov_b32 s71, s4

    s_and_b32 s4, s28, 3
    s_lshl_b32 s5, s4, 16
    s_add_u32 s29, s5, s34
    s_xor_b32 s6, s5, 0x20000
    s_add_u32 s31, s6, s34
    s_add_u32 s32, s29, 16384
    s_add_u32 s33, s29, 20480

    s_waitcnt lgkmcnt(0)
    s_barrier
    s_branch .top1_315
.pf_318:
    buffer_load_dwordx4 v[20:23], v8, s[8:11], s29 offen offset:0 sc1
    s_bitset1_b32 s63, 0
    s_branch .pr_322
.pf_319:
    buffer_load_dwordx4 v[24:27], v8, s[8:11], s29 offen offset:1024 sc1
    s_bitset1_b32 s63, 1
    s_branch .pr_323
.pf_320:
    buffer_load_dwordx4 v[28:31], v8, s[8:11], s29 offen offset:2048 sc1
    s_bitset1_b32 s63, 2
    s_branch .pr_324
.pf_321:
    buffer_load_dwordx4 v[32:35], v8, s[8:11], s29 offen offset:3072 sc1
    s_bitset1_b32 s63, 3
    s_branch .pr_325
.ps_317:
    s_add_u32 s62, s62, 1
    s_cmp_gt_u32 s62, 0x400000
    s_cbranch_scc1 .mg_end_1
    s_bitcmp1_b32 s63, 0
    s_cbranch_scc1 .pw_347
    s_bitcmp1_b32 s63, 1
    s_cbranch_scc1 .pw_348
    s_bitcmp1_b32 s63, 2
    s_cbranch_scc1 .pw_349
.pw_350:
    s_waitcnt vmcnt(0)
    v_max_u32 v4, v32, v34
    v_cmp_eq_u32 vcc, -1, v4
    s_cbranch_vccnz .pg_358
    v_smfmac_f32_16x16x64_bf16 v[52:55], v[32:35], a[24:31], v9
    v_smfmac_f32_16x16x64_bf16 v[56:59], v[32:35], a[56:63], v9
    v_smfmac_f32_16x16x64_bf16 v[60:63], v[32:35], a[88:95], v9
    v_smfmac_f32_16x16x64_bf16 v[64:67], v[32:35], a[120:127], v9
    s_xor_b32 s63, s63, 8
    s_cbranch_scc0 .pd_316
    s_branch .ps_317
.pw_349:
    s_waitcnt vmcnt(0)
    v_max_u32 v4, v28, v30
    v_cmp_eq_u32 vcc, -1, v4
    s_cbranch_vccnz .pg_357
    v_smfmac_f32_16x16x64_bf16 v[52:55], v[28:31], a[16:23], v9
    v_smfmac_f32_16x16x64_bf16 v[56:59], v[28:31], a[48:55], v9
    v_smfmac_f32_16x16x64_bf16 v[60:63], v[28:31], a[80:87], v9
    v_smfmac_f32_16x16x64_bf16 v[64:67], v[28:31], a[112:119], v9
    s_xor_b32 s63, s63, 4
    s_cbranch_scc0 .pd_316
    s_branch .pn_354
.pw_348:
    s_waitcnt vmcnt(0)
    v_max_u32 v4, v24, v26
    v_cmp_eq_u32 vcc, -1, v4
    s_cbranch_vccnz .pg_356
    v_smfmac_f32_16x16x64_bf16 v[52:55], v[24:27], a[8:15], v9
    v_smfmac_f32_16x16x64_bf16 v[56:59], v[24:27], a[40:47], v9
    v_smfmac_f32_16x16x64_bf16 v[60:63], v[24:27], a[72:79], v9
    v_smfmac_f32_16x16x64_bf16 v[64:67], v[24:27], a[104:111], v9
    s_xor_b32 s63, s63, 2
    s_cbranch_scc0 .pd_316
    s_branch .pn_353
.pw_347:
    s_waitcnt vmcnt(0)
    v_max_u32 v4, v20, v22
    v_cmp_eq_u32 vcc, -1, v4
    s_cbranch_vccnz .pg_355
    v_smfmac_f32_16x16x64_bf16 v[52:55], v[20:23], a[0:7], v9
    v_smfmac_f32_16x16x64_bf16 v[56:59], v[20:23], a[32:39], v9
    v_smfmac_f32_16x16x64_bf16 v[60:63], v[20:23], a[64:71], v9
    v_smfmac_f32_16x16x64_bf16 v[64:67], v[20:23], a[96:103], v9
    s_xor_b32 s63, s63, 1
    s_cbranch_scc0 .pd_316
    s_branch .pn_352
.pn_352:
    s_bitcmp1_b32 s63, 1
    s_cbranch_scc0 .pn_353
    v_max_u32 v4, v24, v26
    v_cmp_eq_u32 vcc, -1, v4
    s_cbranch_vccnz .pg_356
    v_smfmac_f32_16x16x64_bf16 v[52:55], v[24:27], a[8:15], v9
    v_smfmac_f32_16x16x64_bf16 v[56:59], v[24:27], a[40:47], v9
    v_smfmac_f32_16x16x64_bf16 v[60:63], v[24:27], a[72:79], v9
    v_smfmac_f32_16x16x64_bf16 v[64:67], v[24:27], a[104:111], v9
    s_xor_b32 s63, s63, 2
    s_cbranch_scc0 .pd_316
.pn_353:
    s_bitcmp1_b32 s63, 2
    s_cbranch_scc0 .pn_354
    v_max_u32 v4, v28, v30
    v_cmp_eq_u32 vcc, -1, v4
    s_cbranch_vccnz .pg_357
    v_smfmac_f32_16x16x64_bf16 v[52:55], v[28:31], a[16:23], v9
    v_smfmac_f32_16x16x64_bf16 v[56:59], v[28:31], a[48:55], v9
    v_smfmac_f32_16x16x64_bf16 v[60:63], v[28:31], a[80:87], v9
    v_smfmac_f32_16x16x64_bf16 v[64:67], v[28:31], a[112:119], v9
    s_xor_b32 s63, s63, 4
    s_cbranch_scc0 .pd_316
.pn_354:
    s_bitcmp1_b32 s63, 3
    s_cbranch_scc0 .ps_317
    v_max_u32 v4, v32, v34
    v_cmp_eq_u32 vcc, -1, v4
    s_cbranch_vccnz .pg_358
    v_smfmac_f32_16x16x64_bf16 v[52:55], v[32:35], a[24:31], v9
    v_smfmac_f32_16x16x64_bf16 v[56:59], v[32:35], a[56:63], v9
    v_smfmac_f32_16x16x64_bf16 v[60:63], v[32:35], a[88:95], v9
    v_smfmac_f32_16x16x64_bf16 v[64:67], v[32:35], a[120:127], v9
    s_xor_b32 s63, s63, 8
    s_cbranch_scc0 .pd_316
    s_branch .ps_317
.pg_355:
    buffer_load_dwordx4 v[20:23], v8, s[8:11], s29 offen offset:0 sc1
    s_branch .pn_352
.pg_356:
    buffer_load_dwordx4 v[24:27], v8, s[8:11], s29 offen offset:1024 sc1
    s_branch .pn_353
.pg_357:
    buffer_load_dwordx4 v[28:31], v8, s[8:11], s29 offen offset:2048 sc1
    s_branch .pn_354
.pg_358:
    buffer_load_dwordx4 v[32:35], v8, s[8:11], s29 offen offset:3072 sc1
    s_branch .ps_317
.last_326:
    s_mov_b64 exec, s[90:91]
    buffer_store_dwordx4 v[212:215], v11, s[8:11], s36 offen sc1
    s_mov_b64 exec, -1
    s_branch .rec_fin_5
.pf_329:
    buffer_load_dwordx4 v[20:23], v246, s[8:11], s32 offen offset:0 sc1
    s_bitset1_b32 s63, 0
    s_branch .pr_337
.pf_330:
    buffer_load_dwordx4 v[24:27], v246, s[8:11], s32 offen offset:1024 sc1
    s_bitset1_b32 s63, 1
    s_branch .pr_338
.pf_331:
    buffer_load_dwordx4 v[28:31], v246, s[8:11], s32 offen offset:2048 sc1
    s_bitset1_b32 s63, 2
    s_branch .pr_339
.pf_332:
    buffer_load_dwordx4 v[32:35], v246, s[8:11], s32 offen offset:3072 sc1
    s_bitset1_b32 s63, 3
    s_branch .pr_340
.pf_333:
    buffer_load_dwordx4 v[36:39], v246, s[8:11], s33 offen offset:0 sc1
    s_bitset1_b32 s63, 4
    s_branch .pr_341
.pf_334:
    buffer_load_dwordx4 v[40:43], v246, s[8:11], s33 offen offset:1024 sc1
    s_bitset1_b32 s63, 5
    s_branch .pr_342
.pf_335:
    buffer_load_dwordx4 v[44:47], v246, s[8:11], s33 offen offset:2048 sc1
    s_bitset1_b32 s63, 6
    s_branch .pr_343
.pf_336:
    buffer_load_dwordx4 v[48:51], v246, s[8:11], s33 offen offset:3072 sc1
    s_bitset1_b32 s63, 7
    s_branch .pr_344
.ps_328:
    s_add_u32 s62, s62, 1
    s_cmp_gt_u32 s62, 0x400000
    s_cbranch_scc1 .mg_end_1
    s_bitcmp1_b32 s63, 0
    s_cbranch_scc1 .pw_359
    s_bitcmp1_b32 s63, 1
    s_cbranch_scc1 .pw_360
    s_bitcmp1_b32 s63, 2
    s_cbranch_scc1 .pw_361
    s_bitcmp1_b32 s63, 3
    s_cbranch_scc1 .pw_362
    s_bitcmp1_b32 s63, 4
    s_cbranch_scc1 .pw_363
    s_bitcmp1_b32 s63, 5
    s_cbranch_scc1 .pw_364
    s_bitcmp1_b32 s63, 6
    s_cbranch_scc1 .pw_365
.pw_366:
    s_waitcnt vmcnt(0)
    v_cmp_eq_u32 vcc, -1, v48
    s_cbranch_vccnz .pg_382
    v_smfmac_f32_16x16x64_bf16 v[76:79], v[48:51], v[148:155], v9
    v_smfmac_f32_16x16x64_bf16 v[80:83], v[48:51], v[180:187], v9
    s_xor_b32 s63, s63, 128
    s_cbranch_scc0 .pd_327
    s_branch .ps_328
.pw_365:
    s_waitcnt vmcnt(0)
    v_cmp_eq_u32 vcc, -1, v44
    s_cbranch_vccnz .pg_381
    v_smfmac_f32_16x16x64_bf16 v[76:79], v[44:47], v[140:147], v9
    v_smfmac_f32_16x16x64_bf16 v[80:83], v[44:47], v[172:179], v9
    s_xor_b32 s63, s63, 64
    s_cbranch_scc0 .pd_327
    s_branch .pn_374
.pw_364:
    s_waitcnt vmcnt(0)
    v_cmp_eq_u32 vcc, -1, v40
    s_cbranch_vccnz .pg_380
    v_smfmac_f32_16x16x64_bf16 v[76:79], v[40:43], v[132:139], v9
    v_smfmac_f32_16x16x64_bf16 v[80:83], v[40:43], v[164:171], v9
    s_xor_b32 s63, s63, 32
    s_cbranch_scc0 .pd_327
    s_branch .pn_373
.pw_363:
    s_waitcnt vmcnt(0)
    v_cmp_eq_u32 vcc, -1, v36
    s_cbranch_vccnz .pg_379
    v_smfmac_f32_16x16x64_bf16 v[76:79], v[36:39], v[124:131], v9
    v_smfmac_f32_16x16x64_bf16 v[80:83], v[36:39], v[156:163], v9
    s_xor_b32 s63, s63, 16
    s_cbranch_scc0 .pd_327
    s_branch .pn_372
.pw_362:
    s_waitcnt vmcnt(0)
    v_cmp_eq_u32 vcc, -1, v32
    s_cbranch_vccnz .pg_378
    v_smfmac_f32_16x16x64_bf16 v[76:79], v[32:35], a[216:223], v9
    v_smfmac_f32_16x16x64_bf16 v[80:83], v[32:35], a[248:255], v9
    s_xor_b32 s63, s63, 8
    s_cbranch_scc0 .pd_327
    s_branch .pn_371
.pw_361:
    s_waitcnt vmcnt(0)
    v_cmp_eq_u32 vcc, -1, v28
    s_cbranch_vccnz .pg_377
    v_smfmac_f32_16x16x64_bf16 v[76:79], v[28:31], a[208:215], v9
    v_smfmac_f32_16x16x64_bf16 v[80:83], v[28:31], a[240:247], v9
    s_xor_b32 s63, s63, 4
    s_cbranch_scc0 .pd_327
    s_branch .pn_370
.pw_360:
    s_waitcnt vmcnt(0)
    v_cmp_eq_u32 vcc, -1, v24
    s_cbranch_vccnz .pg_376
    v_smfmac_f32_16x16x64_bf16 v[76:79], v[24:27], a[200:207], v9
    v_smfmac_f32_16x16x64_bf16 v[80:83], v[24:27], a[232:239], v9
    s_xor_b32 s63, s63, 2
    s_cbranch_scc0 .pd_327
    s_branch .pn_369
.pw_359:
    s_waitcnt vmcnt(0)
    v_cmp_eq_u32 vcc, -1, v20
    s_cbranch_vccnz .pg_375
    v_smfmac_f32_16x16x64_bf16 v[76:79], v[20:23], a[192:199], v9
    v_smfmac_f32_16x16x64_bf16 v[80:83], v[20:23], a[224:231], v9
    s_xor_b32 s63, s63, 1
    s_cbranch_scc0 .pd_327
    s_branch .pn_368
.pn_368:
    s_bitcmp1_b32 s63, 1
    s_cbranch_scc0 .pn_369
    v_cmp_eq_u32 vcc, -1, v24
    s_cbranch_vccnz .pg_376
    v_smfmac_f32_16x16x64_bf16 v[76:79], v[24:27], a[200:207], v9
    v_smfmac_f32_16x16x64_bf16 v[80:83], v[24:27], a[232:239], v9
    s_xor_b32 s63, s63, 2
    s_cbranch_scc0 .pd_327
.pn_369:
    s_bitcmp1_b32 s63, 2
    s_cbranch_scc0 .pn_370
    v_cmp_eq_u32 vcc, -1, v28
    s_cbranch_vccnz .pg_377
    v_smfmac_f32_16x16x64_bf16 v[76:79], v[28:31], a[208:215], v9
    v_smfmac_f32_16x16x64_bf16 v[80:83], v[28:31], a[240:247], v9
    s_xor_b32 s63, s63, 4
    s_cbranch_scc0 .pd_327
.pn_370:
    s_bitcmp1_b32 s63, 3
    s_cbranch_scc0 .pn_371
    v_cmp_eq_u32 vcc, -1, v32
    s_cbranch_vccnz .pg_378
    v_smfmac_f32_16x16x64_bf16 v[76:79], v[32:35], a[216:223], v9
    v_smfmac_f32_16x16x64_bf16 v[80:83], v[32:35], a[248:255], v9
    s_xor_b32 s63, s63, 8
    s_cbranch_scc0 .pd_327
.pn_371:
    s_bitcmp1_b32 s63, 4
    s_cbranch_scc0 .pn_372
    v_cmp_eq_u32 vcc, -1, v36
    s_cbranch_vccnz .pg_379
    v_smfmac_f32_16x16x64_bf16 v[76:79], v[36:39], v[124:131], v9
    v_smfmac_f32_16x16x64_bf16 v[80:83], v[36:39], v[156:163], v9
    s_xor_b32 s63, s63, 16
    s_cbranch_scc0 .pd_327
.pn_372:
    s_bitcmp1_b32 s63, 5
    s_cbranch_scc0 .pn_373
    v_cmp_eq_u32 vcc, -1, v40
    s_cbranch_vccnz .pg_380
    v_smfmac_f32_16x16x64_bf16 v[76:79], v[40:43], v[132:139], v9
    v_smfmac_f32_16x16x64_bf16 v[80:83], v[40:43], v[164:171], v9
    s_xor_b32 s63, s63, 32
    s_cbranch_scc0 .pd_327
.pn_373:
    s_bitcmp1_b32 s63, 6
    s_cbranch_scc0 .pn_374
    v_cmp_eq_u32 vcc, -1, v44
    s_cbranch_vccnz .pg_381
    v_smfmac_f32_16x16x64_bf16 v[76:79], v[44:47], v[140:147], v9
    v_smfmac_f32_16x16x64_bf16 v[80:83], v[44:47], v[172:179], v9
    s_xor_b32 s63, s63, 64
    s_cbranch_scc0 .pd_327
.pn_374:
    s_bitcmp1_b32 s63, 7
    s_cbranch_scc0 .ps_328
    v_cmp_eq_u32 vcc, -1, v48
    s_cbranch_vccnz .pg_382
    v_smfmac_f32_16x16x64_bf16 v[76:79], v[48:51], v[148:155], v9
    v_smfmac_f32_16x16x64_bf16 v[80:83], v[48:51], v[180:187], v9
    s_xor_b32 s63, s63, 128
    s_cbranch_scc0 .pd_327
    s_branch .ps_328
.pg_375:
    buffer_load_dwordx4 v[20:23], v246, s[8:11], s32 offen offset:0 sc1
    s_branch .pn_368
.pg_376:
    buffer_load_dwordx4 v[24:27], v246, s[8:11], s32 offen offset:1024 sc1
    s_branch .pn_369
.pg_377:
    buffer_load_dwordx4 v[28:31], v246, s[8:11], s32 offen offset:2048 sc1
    s_branch .pn_370
.pg_378:
    buffer_load_dwordx4 v[32:35], v246, s[8:11], s32 offen offset:3072 sc1
    s_branch .pn_371
.pg_379:
    buffer_load_dwordx4 v[36:39], v246, s[8:11], s33 offen offset:0 sc1
    s_branch .pn_372
.pg_380:
    buffer_load_dwordx4 v[40:43], v246, s[8:11], s33 offen offset:1024 sc1
    s_branch .pn_373
.pg_381:
    buffer_load_dwordx4 v[44:47], v246, s[8:11], s33 offen offset:2048 sc1
    s_branch .pn_374
.pg_382:
    buffer_load_dwordx4 v[48:51], v246, s[8:11], s33 offen offset:3072 sc1
    s_branch .ps_328
.kf_345:
    s_mov_b32 s62, 0
    s_mov_b64 exec, 3
.wf_383:
    buffer_load_dword v4, v253, s[8:11], s89 offen sc1
    s_waitcnt vmcnt(0)
    v_cmp_gt_u32 vcc, s6, v4
    s_cbranch_vccz .wfd_384
    s_sleep 2
    s_add_u32 s62, s62, 1
    s_cmp_gt_u32 s62, 0x400000
    s_cbranch_scc1 .mg_end_1
    s_branch .wf_383

.wfd_384:
    s_mov_b64 exec, -1
    v_readlane_b32 s4, v4, 0
    v_readlane_b32 s93, v4, 1
    s_min_u32 s93, s93, s4
    s_branch .kb_346
.p2align 6
.top2_385:
    buffer_load_dwordx4 v[20:23], v8, s[8:11], s29 offen offset:0 sc1
    s_nop 11
    buffer_load_dwordx4 v[24:27], v8, s[8:11], s29 offen offset:1024 sc1
    s_nop 11
    buffer_load_dwordx4 v[28:31], v8, s[8:11], s29 offen offset:2048 sc1
    s_nop 11
    buffer_load_dwordx4 v[32:35], v8, s[8:11], s29 offen offset:3072 sc1
.ent12_27:
    s_waitcnt vmcnt(3)
    v_max_u32 v4, v20, v22
    v_cmp_eq_u32 vcc, -1, v4
    s_cbranch_vccnz .pf_388
    v_smfmac_f32_16x16x64_bf16 v[52:55], v[20:23], a[0:7], v9
    v_smfmac_f32_16x16x64_bf16 v[56:59], v[20:23], a[32:39], v9
    v_smfmac_f32_16x16x64_bf16 v[60:63], v[20:23], a[64:71], v9
    v_smfmac_f32_16x16x64_bf16 v[64:67], v[20:23], a[96:103], v9
.pr_392:
    s_waitcnt vmcnt(2)
    v_max_u32 v4, v24, v26
    v_cmp_eq_u32 vcc, -1, v4
    s_cbranch_vccnz .pf_389
    v_smfmac_f32_16x16x64_bf16 v[52:55], v[24:27], a[8:15], v9
    v_smfmac_f32_16x16x64_bf16 v[56:59], v[24:27], a[40:47], v9
    v_smfmac_f32_16x16x64_bf16 v[60:63], v[24:27], a[72:79], v9
    v_smfmac_f32_16x16x64_bf16 v[64:67], v[24:27], a[104:111], v9
.pr_393:
    s_waitcnt vmcnt(1)
    v_max_u32 v4, v28, v30
    v_cmp_eq_u32 vcc, -1, v4
    s_cbranch_vccnz .pf_390
    v_smfmac_f32_16x16x64_bf16 v[52:55], v[28:31], a[16:23], v9
    v_smfmac_f32_16x16x64_bf16 v[56:59], v[28:31], a[48:55], v9
    v_smfmac_f32_16x16x64_bf16 v[60:63], v[28:31], a[80:87], v9
    v_smfmac_f32_16x16x64_bf16 v[64:67], v[28:31], a[112:119], v9
.pr_394:
    s_waitcnt vmcnt(0)
    v_max_u32 v4, v32, v34
    v_cmp_eq_u32 vcc, -1, v4
    s_cbranch_vccnz .pf_391
    v_smfmac_f32_16x16x64_bf16 v[52:55], v[32:35], a[24:31], v9
    v_smfmac_f32_16x16x64_bf16 v[56:59], v[32:35], a[56:63], v9
    v_smfmac_f32_16x16x64_bf16 v[60:63], v[32:35], a[88:95], v9
    v_smfmac_f32_16x16x64_bf16 v[64:67], v[32:35], a[120:127], v9
.pr_395:
    s_cmp_lg_u32 s63, 0
    s_cbranch_scc1 .ps_387
.pd_386:
    v_cvt_pk_bf16_f32 v104, v52, v53
    v_cvt_pk_bf16_f32 v105, v54, v55
    v_cvt_pk_bf16_f32 v106, v56, v57
    v_cvt_pk_bf16_f32 v107, v58, v59
    ds_write_b64 v16, v[104:105] offset:4096
    v_cvt_pk_bf16_f32 v108, v60, v61
    v_cvt_pk_bf16_f32 v109, v62, v63
    ds_write_b64 v16, v[106:107] offset:6144
    ds_write_b64 v16, v[108:109] offset:0
    s_nop 0
    v_cvt_pk_bf16_f32 v110, v64, v65
    v_cvt_pk_bf16_f32 v111, v66, v67
    ds_write_b64 v16, v[110:111] offset:2048
    v_smfmac_f32_16x16x64_bf16 v[68:71], v[20:23], a[128:135], v9
    v_smfmac_f32_16x16x64_bf16 v[72:75], v[20:23], a[160:167], v9
    s_waitcnt lgkmcnt(0)
    s_barrier
    ds_read_b128 v[36:39], v14 offset:4096
    ds_read_b128 v[40:43], v14 offset:5120
    v_smfmac_f32_16x16x64_bf16 v[68:71], v[24:27], a[136:143], v9
    v_smfmac_f32_16x16x64_bf16 v[72:75], v[24:27], a[168:175], v9
    s_waitcnt lgkmcnt(1)
    v_mfma_f32_16x16x32_bf16 v[44:47], v[36:39], v[84:87], 0
    s_waitcnt lgkmcnt(0)
    v_mfma_f32_16x16x32_bf16 v[44:47], v[40:43], v[84:87], v[44:47]
    v_smfmac_f32_16x16x64_bf16 v[68:71], v[28:31], a[144:151], v9
    v_smfmac_f32_16x16x64_bf16 v[72:75], v[28:31], a[176:183], v9
    s_mov_b64 exec, s[58:59]
    v_cvt_pk_bf16_f32 v48, v44, v45
    v_cvt_pk_bf16_f32 v49, v46, v47
    v_min_u32 v48, 0xfffffffe, v48
    buffer_store_dwordx2 v[48:49], v10, s[8:11], s29 offen sc1

    ds_write_b64 v18, v[48:49]
    s_mov_b64 exec, -1

    v_smfmac_f32_16x16x64_bf16 v[68:71], v[32:35], a[152:159], v9
    v_smfmac_f32_16x16x64_bf16 v[72:75], v[32:35], a[184:191], v9
    s_nop 3
    v_cvt_pk_bf16_f32 v104, v68, v69
    v_cvt_pk_bf16_f32 v105, v70, v71
    ds_write_b64 v16, v[104:105] offset:8192
    s_nop 0
    v_cvt_pk_bf16_f32 v106, v72, v73
    v_cvt_pk_bf16_f32 v107, v74, v75
    ds_write_b64 v16, v[106:107] offset:10240
    buffer_load_dwordx4 v[92:95], v232, s[8:11], s29 offen sc1
    buffer_load_dwordx4 v[96:99], v233, s[8:11], s29 offen sc1
    buffer_load_dwordx4 v[100:103], v234, s[8:11], s29 offen sc1
    ds_read_b128 v[128:131], v228 offset:0
    ds_read_b128 v[132:135], v229 offset:0
    ds_read_b128 v[136:139], v230 offset:0
    ds_read_b128 v[140:143], v231 offset:0
    ds_read_b128 v[144:147], v228 offset:4096
    ds_read_b128 v[148:151], v229 offset:4096
    ds_read_b128 v[152:155], v230 offset:4096
    ds_read_b128 v[156:159], v231 offset:4096
    ds_read_b128 v[160:163], v19 offset:0
    ds_read_b128 v[164:167], v19 offset:1024
    s_waitcnt lgkmcnt(10)
    s_barrier
    s_cmp_eq_u32 s28, 63
    s_cbranch_scc1 .rec_fin_5
    ds_read_b128 v[88:91], v14 offset:16384
    ds_read_b128 v[36:39], v14 offset:8192
    ds_read_b128 v[40:43], v14 offset:9216
    ds_read_b128 v[44:47], v14 offset:10240
    ds_read_b128 v[48:51], v14 offset:11264
    s_waitcnt lgkmcnt(4)
    v_mfma_f32_16x16x32_bf16 v[208:211], v[128:131], v[88:91], 0
    v_mfma_f32_16x16x32_bf16 v[212:215], v[144:147], v[88:91], 0
    v_mfma_f32_16x16x32_bf16 v[216:219], v[88:91], v[88:91], v[116:119]
    s_waitcnt lgkmcnt(0)
    v_mfma_f32_16x16x32_bf16 v[104:107], v[84:87], v[36:39], 0
    v_mfma_f32_16x16x32_bf16 v[108:111], v[84:87], v[44:47], 0
    v_mfma_f32_16x16x32_bf16 v[104:107], v[84:87], v[40:43], v[104:107]
    v_mfma_f32_16x16x32_bf16 v[108:111], v[84:87], v[48:51], v[108:111]
    s_nop 7
    v_cvt_pk_bf16_f32 v168, v104, v105
    v_cvt_pk_bf16_f32 v169, v106, v107
    v_cvt_pk_bf16_f32 v172, v108, v109
    v_cvt_pk_bf16_f32 v173, v110, v111
    s_waitcnt vmcnt(2)
    v_max_u32 v4, v92, v94
    v_cmp_eq_u32 vcc, -1, v4
    s_cbranch_vccnz .pf_398
    v_mfma_f32_16x16x32_bf16 v[208:211], v[132:135], v[92:95], v[208:211]
    v_mfma_f32_16x16x32_bf16 v[212:215], v[148:151], v[92:95], v[212:215]
    v_mfma_f32_16x16x32_bf16 v[216:219], v[92:95], v[92:95], v[216:219]
.pr_401:
    s_waitcnt vmcnt(1)
    v_max_u32 v4, v96, v98
    v_cmp_eq_u32 vcc, -1, v4
    s_cbranch_vccnz .pf_399
    v_mfma_f32_16x16x32_bf16 v[208:211], v[136:139], v[96:99], v[208:211]
    v_mfma_f32_16x16x32_bf16 v[212:215], v[152:155], v[96:99], v[212:215]
    v_mfma_f32_16x16x32_bf16 v[216:219], v[96:99], v[96:99], v[216:219]
.pr_402:
    s_waitcnt vmcnt(0)
    v_max_u32 v4, v100, v102
    v_cmp_eq_u32 vcc, -1, v4
    s_cbranch_vccnz .pf_400
    v_mfma_f32_16x16x32_bf16 v[208:211], v[140:143], v[100:103], v[208:211]
    v_mfma_f32_16x16x32_bf16 v[212:215], v[156:159], v[100:103], v[212:215]
    v_mfma_f32_16x16x32_bf16 v[216:219], v[100:103], v[100:103], v[216:219]
.pr_403:
    s_cmp_lg_u32 s63, 0
    s_cbranch_scc1 .ps_397
.pd_396:
    s_barrier
    s_nop 2
    v_mov_b32_dpp v208, v212 row_ror:8 row_mask:0xf bank_mask:0xc
    v_mov_b32_dpp v209, v213 row_ror:8 row_mask:0xf bank_mask:0xc
    v_mov_b32_dpp v210, v214 row_ror:8 row_mask:0xf bank_mask:0xc
    v_mov_b32_dpp v211, v215 row_ror:8 row_mask:0xf bank_mask:0xc
    v_mov_b32_dpp v216, v218 row_ror:8 row_mask:0xf bank_mask:0xc
    v_mov_b32_dpp v217, v219 row_ror:8 row_mask:0xf bank_mask:0xc
    v_max3_f32 v4, v208, v209, v210
    v_max3_f32 v5, v211, v216, v217
    v_max_f32 v6, v4, v5
    v_max_f32 v4, v4, v5
    s_nop 1
    v_permlane32_swap_b32 v4, v6
    v_max_f32 v5, v4, v6
    v_max_f32 v4, v4, v6
    s_nop 1
    v_permlane16_swap_b32 v4, v5
    v_max_f32 v4, v4, v5
    s_nop 1
    v_max_f32_dpp v4, v4, v4 row_ror:8 row_mask:0xf bank_mask:0xf
    v_mul_f32 v4, s37, v4

    v_fma_f32 v104, v208, s37, -v4
    v_fma_f32 v105, v209, s37, -v4
    v_fma_f32 v106, v210, s37, -v4
    v_fma_f32 v107, v211, s37, -v4
    v_fma_f32 v108, v216, s37, -v4
    v_fma_f32 v109, v217, s37, -v4
    v_exp_f32 v104, v104
    v_exp_f32 v105, v105
    v_exp_f32 v106, v106
    v_exp_f32 v107, v107
    v_exp_f32 v108, v108
    v_exp_f32 v109, v109
    v_cvt_pk_bf16_f32 v176, v104, v105
    v_cvt_pk_bf16_f32 v177, v106, v107
    v_cvt_pk_bf16_f32 v180, v108, v109
    v_mov_b32_dpp v178, v176 row_ror:8 row_mask:0xf bank_mask:0xf
    v_mov_b32_dpp v179, v177 row_ror:8 row_mask:0xf bank_mask:0xf
    v_mov_b32_dpp v181, v180 row_ror:8 row_mask:0xf bank_mask:0xf
    s_nop 0

    v_mfma_f32_16x16x32_bf16 v[208:211], v[120:123], v[176:179], 0
    v_mfma_f32_16x16x32_bf16 v[208:211], v[120:123], v[180:183], v[208:211]
    v_mfma_f32_16x16x32_bf16 v[212:215], v[160:163], v[176:179], 0
    v_mfma_f32_16x16x32_bf16 v[216:219], v[164:167], v[176:179], 0
    v_mfma_f32_16x16x32_bf16 v[212:215], v[168:171], v[180:183], v[212:215]
    v_rcp_f32 v4, v208
    v_mfma_f32_16x16x32_bf16 v[216:219], v[172:175], v[180:183], v[216:219]
    s_mov_b64 exec, s[58:59]
    s_nop 2
    v_mul_f32 v212, v4, v212
    v_mul_f32 v213, v4, v213
    v_mul_f32 v214, v4, v214
    v_mul_f32 v215, v4, v215
    v_cvt_pk_bf16_f32 v184, v212, v213
    v_cvt_pk_bf16_f32 v185, v214, v215
    v_mul_f32 v216, v4, v216
    v_mul_f32 v217, v4, v217
    v_mul_f32 v218, v4, v218
    v_mul_f32 v219, v4, v219
    v_cvt_pk_bf16_f32 v186, v216, v217
    v_cvt_pk_bf16_f32 v187, v218, v219
    v_min_u32 v184, 0xfffffffe, v184
    buffer_store_dwordx4 v[184:187], v13, s[8:11], s29 offen sc1
    s_mov_b64 exec, -1

    s_barrier
    v_mov_b32 v52, 0
    v_mov_b32 v53, 0
    v_mov_b32 v54, 0
    v_mov_b32 v55, 0
    v_mov_b32 v56, 0
    v_mov_b32 v57, 0
    v_mov_b32 v58, 0
    v_mov_b32 v59, 0
    v_mov_b32 v60, 0
    v_mov_b32 v61, 0
    v_mov_b32 v62, 0
    v_mov_b32 v63, 0
    v_mov_b32 v64, 0
    v_mov_b32 v65, 0
    v_mov_b32 v66, 0
    v_mov_b32 v67, 0
    v_mov_b32 v68, 0
    v_mov_b32 v69, 0
    v_mov_b32 v70, 0
    v_mov_b32 v71, 0
    v_mov_b32 v72, 0
    v_mov_b32 v73, 0
    v_mov_b32 v74, 0
    v_mov_b32 v75, 0
    s_mov_b32 s99, s68
    s_add_u32 s28, s28, 1
    s_add_u32 s36, s36, 196608
    s_add_u32 s38, s38, 262144
    s_add_u32 s39, s39, 262144
    s_mov_b32 s4, s68
    s_mov_b32 s68, s69
    s_mov_b32 s69, s70
    s_mov_b32 s70, s71
    s_mov_b32 s71, s4

    s_and_b32 s4, s28, 3
    s_lshl_b32 s5, s4, 16
    s_add_u32 s29, s5, s34
    s_xor_b32 s6, s5, 0x20000
    s_add_u32 s31, s6, s34
    s_add_u32 s32, s29, 16384
    s_add_u32 s33, s29, 20480

    s_barrier
    ds_read_b128 v[36:39], v248
    s_nop 15
    s_add_u32 s4, s99, 0
    buffer_load_dwordx4 v[192:195], v239, s[8:11], s4 offen sc1
    buffer_load_dwordx4 v[196:199], v249, s[8:11], s4 offen sc1

    s_waitcnt lgkmcnt(0)
    v_mfma_f32_16x16x32_bf16 v[76:79], v[36:39], v[112:115], 0
    s_nop 15
    s_add_u32 s4, s99, 262144
    buffer_load_dwordx4 v[200:203], v239, s[8:11], s4 offen sc1
    buffer_load_dwordx4 v[204:207], v249, s[8:11], s4 offen sc1

    s_nop 15
    s_add_u32 s4, s99, 524288
    buffer_load_dwordx4 v[20:23], v239, s[8:11], s4 offen sc1
    buffer_load_dwordx4 v[24:27], v249, s[8:11], s4 offen sc1

    s_nop 15
    s_add_u32 s4, s99, 786432
    buffer_load_dwordx4 v[28:31], v239, s[8:11], s4 offen sc1
    buffer_load_dwordx4 v[32:35], v249, s[8:11], s4 offen sc1

    s_barrier
.gc_405:
    s_waitcnt vmcnt(6)
    v_max_u32 v4, v192, v196
    v_cmp_eq_u32 vcc, -1, v4
    s_cbranch_vccnz .gc_406

    v_mfma_f32_16x16x32_bf16 v[76:79], v[192:195], v[84:87], v[76:79]
    v_mfma_f32_16x16x32_bf16 v[76:79], v[196:199], v[112:115], v[76:79]
.gd_404:
    s_mov_b64 exec, s[58:59]
    s_nop 6
    v_cvt_pk_bf16_f32 v48, v76, v77
    v_cvt_pk_bf16_f32 v49, v78, v79
    v_min_u32 v48, 0xfffffffe, v48
    buffer_store_dwordx2 v[48:49], v15, s[8:11], s29 offen sc1
    s_mov_b64 exec, -1

    s_waitcnt lgkmcnt(0)
    s_barrier
    s_branch .top2_385
.pf_388:
    buffer_load_dwordx4 v[20:23], v8, s[8:11], s29 offen offset:0 sc1
    s_bitset1_b32 s63, 0
    s_branch .pr_392
.pf_389:
    buffer_load_dwordx4 v[24:27], v8, s[8:11], s29 offen offset:1024 sc1
    s_bitset1_b32 s63, 1
    s_branch .pr_393
.pf_390:
    buffer_load_dwordx4 v[28:31], v8, s[8:11], s29 offen offset:2048 sc1
    s_bitset1_b32 s63, 2
    s_branch .pr_394
.pf_391:
    buffer_load_dwordx4 v[32:35], v8, s[8:11], s29 offen offset:3072 sc1
    s_bitset1_b32 s63, 3
    s_branch .pr_395
.ps_387:
    s_add_u32 s62, s62, 1
    s_cmp_gt_u32 s62, 0x400000
    s_cbranch_scc1 .mg_end_1
    s_bitcmp1_b32 s63, 0
    s_cbranch_scc1 .pw_409
    s_bitcmp1_b32 s63, 1
    s_cbranch_scc1 .pw_410
    s_bitcmp1_b32 s63, 2
    s_cbranch_scc1 .pw_411
.pw_412:
    s_waitcnt vmcnt(0)
    v_max_u32 v4, v32, v34
    v_cmp_eq_u32 vcc, -1, v4
    s_cbranch_vccnz .pg_420
    v_smfmac_f32_16x16x64_bf16 v[52:55], v[32:35], a[24:31], v9
    v_smfmac_f32_16x16x64_bf16 v[56:59], v[32:35], a[56:63], v9
    v_smfmac_f32_16x16x64_bf16 v[60:63], v[32:35], a[88:95], v9
    v_smfmac_f32_16x16x64_bf16 v[64:67], v[32:35], a[120:127], v9
    s_xor_b32 s63, s63, 8
    s_cbranch_scc0 .pd_386
    s_branch .ps_387
.pw_411:
    s_waitcnt vmcnt(0)
    v_max_u32 v4, v28, v30
    v_cmp_eq_u32 vcc, -1, v4
    s_cbranch_vccnz .pg_419
    v_smfmac_f32_16x16x64_bf16 v[52:55], v[28:31], a[16:23], v9
    v_smfmac_f32_16x16x64_bf16 v[56:59], v[28:31], a[48:55], v9
    v_smfmac_f32_16x16x64_bf16 v[60:63], v[28:31], a[80:87], v9
    v_smfmac_f32_16x16x64_bf16 v[64:67], v[28:31], a[112:119], v9
    s_xor_b32 s63, s63, 4
    s_cbranch_scc0 .pd_386
    s_branch .pn_416
.pw_410:
    s_waitcnt vmcnt(0)
    v_max_u32 v4, v24, v26
    v_cmp_eq_u32 vcc, -1, v4
    s_cbranch_vccnz .pg_418
    v_smfmac_f32_16x16x64_bf16 v[52:55], v[24:27], a[8:15], v9
    v_smfmac_f32_16x16x64_bf16 v[56:59], v[24:27], a[40:47], v9
    v_smfmac_f32_16x16x64_bf16 v[60:63], v[24:27], a[72:79], v9
    v_smfmac_f32_16x16x64_bf16 v[64:67], v[24:27], a[104:111], v9
    s_xor_b32 s63, s63, 2
    s_cbranch_scc0 .pd_386
    s_branch .pn_415
.pw_409:
    s_waitcnt vmcnt(0)
    v_max_u32 v4, v20, v22
    v_cmp_eq_u32 vcc, -1, v4
    s_cbranch_vccnz .pg_417
    v_smfmac_f32_16x16x64_bf16 v[52:55], v[20:23], a[0:7], v9
    v_smfmac_f32_16x16x64_bf16 v[56:59], v[20:23], a[32:39], v9
    v_smfmac_f32_16x16x64_bf16 v[60:63], v[20:23], a[64:71], v9
    v_smfmac_f32_16x16x64_bf16 v[64:67], v[20:23], a[96:103], v9
    s_xor_b32 s63, s63, 1
    s_cbranch_scc0 .pd_386
    s_branch .pn_414
.pn_414:
    s_bitcmp1_b32 s63, 1
    s_cbranch_scc0 .pn_415
    v_max_u32 v4, v24, v26
    v_cmp_eq_u32 vcc, -1, v4
    s_cbranch_vccnz .pg_418
    v_smfmac_f32_16x16x64_bf16 v[52:55], v[24:27], a[8:15], v9
    v_smfmac_f32_16x16x64_bf16 v[56:59], v[24:27], a[40:47], v9
    v_smfmac_f32_16x16x64_bf16 v[60:63], v[24:27], a[72:79], v9
    v_smfmac_f32_16x16x64_bf16 v[64:67], v[24:27], a[104:111], v9
    s_xor_b32 s63, s63, 2
    s_cbranch_scc0 .pd_386
.pn_415:
    s_bitcmp1_b32 s63, 2
    s_cbranch_scc0 .pn_416
    v_max_u32 v4, v28, v30
    v_cmp_eq_u32 vcc, -1, v4
    s_cbranch_vccnz .pg_419
    v_smfmac_f32_16x16x64_bf16 v[52:55], v[28:31], a[16:23], v9
    v_smfmac_f32_16x16x64_bf16 v[56:59], v[28:31], a[48:55], v9
    v_smfmac_f32_16x16x64_bf16 v[60:63], v[28:31], a[80:87], v9
    v_smfmac_f32_16x16x64_bf16 v[64:67], v[28:31], a[112:119], v9
    s_xor_b32 s63, s63, 4
    s_cbranch_scc0 .pd_386
.pn_416:
    s_bitcmp1_b32 s63, 3
    s_cbranch_scc0 .ps_387
    v_max_u32 v4, v32, v34
    v_cmp_eq_u32 vcc, -1, v4
    s_cbranch_vccnz .pg_420
    v_smfmac_f32_16x16x64_bf16 v[52:55], v[32:35], a[24:31], v9
    v_smfmac_f32_16x16x64_bf16 v[56:59], v[32:35], a[56:63], v9
    v_smfmac_f32_16x16x64_bf16 v[60:63], v[32:35], a[88:95], v9
    v_smfmac_f32_16x16x64_bf16 v[64:67], v[32:35], a[120:127], v9
    s_xor_b32 s63, s63, 8
    s_cbranch_scc0 .pd_386
    s_branch .ps_387
.pg_417:
    buffer_load_dwordx4 v[20:23], v8, s[8:11], s29 offen offset:0 sc1
    s_branch .pn_414
.pg_418:
    buffer_load_dwordx4 v[24:27], v8, s[8:11], s29 offen offset:1024 sc1
    s_branch .pn_415
.pg_419:
    buffer_load_dwordx4 v[28:31], v8, s[8:11], s29 offen offset:2048 sc1
    s_branch .pn_416
.pg_420:
    buffer_load_dwordx4 v[32:35], v8, s[8:11], s29 offen offset:3072 sc1
    s_branch .ps_387
.pf_398:
    buffer_load_dwordx4 v[92:95], v232, s[8:11], s29 offen sc1
    s_bitset1_b32 s63, 1
    s_branch .pr_401
.pf_399:
    buffer_load_dwordx4 v[96:99], v233, s[8:11], s29 offen sc1
    s_bitset1_b32 s63, 2
    s_branch .pr_402
.pf_400:
    buffer_load_dwordx4 v[100:103], v234, s[8:11], s29 offen sc1
    s_bitset1_b32 s63, 3
    s_branch .pr_403
.ps_397:
    s_add_u32 s62, s62, 1
    s_cmp_gt_u32 s62, 0x400000
    s_cbranch_scc1 .mg_end_1
    s_bitcmp1_b32 s63, 1
    s_cbranch_scc1 .pw_421
    s_bitcmp1_b32 s63, 2
    s_cbranch_scc1 .pw_422
.pw_423:
    s_waitcnt vmcnt(0)
    v_max_u32 v4, v100, v102
    v_cmp_eq_u32 vcc, -1, v4
    s_cbranch_vccnz .pg_429
    v_mfma_f32_16x16x32_bf16 v[208:211], v[140:143], v[100:103], v[208:211]
    v_mfma_f32_16x16x32_bf16 v[212:215], v[156:159], v[100:103], v[212:215]
    v_mfma_f32_16x16x32_bf16 v[216:219], v[100:103], v[100:103], v[216:219]
    s_xor_b32 s63, s63, 8
    s_cbranch_scc0 .pd_396
    s_branch .ps_397
.pw_422:
    s_waitcnt vmcnt(0)
    v_max_u32 v4, v96, v98
    v_cmp_eq_u32 vcc, -1, v4
    s_cbranch_vccnz .pg_428
    v_mfma_f32_16x16x32_bf16 v[208:211], v[136:139], v[96:99], v[208:211]
    v_mfma_f32_16x16x32_bf16 v[212:215], v[152:155], v[96:99], v[212:215]
    v_mfma_f32_16x16x32_bf16 v[216:219], v[96:99], v[96:99], v[216:219]
    s_xor_b32 s63, s63, 4
    s_cbranch_scc0 .pd_396
    s_branch .pn_426
.pw_421:
    s_waitcnt vmcnt(0)
    v_max_u32 v4, v92, v94
    v_cmp_eq_u32 vcc, -1, v4
    s_cbranch_vccnz .pg_427
    v_mfma_f32_16x16x32_bf16 v[208:211], v[132:135], v[92:95], v[208:211]
    v_mfma_f32_16x16x32_bf16 v[212:215], v[148:151], v[92:95], v[212:215]
    v_mfma_f32_16x16x32_bf16 v[216:219], v[92:95], v[92:95], v[216:219]
    s_xor_b32 s63, s63, 2
    s_cbranch_scc0 .pd_396
    s_branch .pn_425
.pn_425:
    s_bitcmp1_b32 s63, 2
    s_cbranch_scc0 .pn_426
    v_max_u32 v4, v96, v98
    v_cmp_eq_u32 vcc, -1, v4
    s_cbranch_vccnz .pg_428
    v_mfma_f32_16x16x32_bf16 v[208:211], v[136:139], v[96:99], v[208:211]
    v_mfma_f32_16x16x32_bf16 v[212:215], v[152:155], v[96:99], v[212:215]
    v_mfma_f32_16x16x32_bf16 v[216:219], v[96:99], v[96:99], v[216:219]
    s_xor_b32 s63, s63, 4
    s_cbranch_scc0 .pd_396
.pn_426:
    s_bitcmp1_b32 s63, 3
    s_cbranch_scc0 .ps_397
    v_max_u32 v4, v100, v102
    v_cmp_eq_u32 vcc, -1, v4
    s_cbranch_vccnz .pg_429
    v_mfma_f32_16x16x32_bf16 v[208:211], v[140:143], v[100:103], v[208:211]
    v_mfma_f32_16x16x32_bf16 v[212:215], v[156:159], v[100:103], v[212:215]
    v_mfma_f32_16x16x32_bf16 v[216:219], v[100:103], v[100:103], v[216:219]
    s_xor_b32 s63, s63, 8
    s_cbranch_scc0 .pd_396
    s_branch .ps_397
.pg_427:
    buffer_load_dwordx4 v[92:95], v232, s[8:11], s29 offen sc1
    s_branch .pn_425
.pg_428:
    buffer_load_dwordx4 v[96:99], v233, s[8:11], s29 offen sc1
    s_branch .pn_426
.pg_429:
    buffer_load_dwordx4 v[100:103], v234, s[8:11], s29 offen sc1
    s_branch .ps_397
.gc_406:
    s_waitcnt vmcnt(4)
    v_max_u32 v4, v200, v204
    v_cmp_eq_u32 vcc, -1, v4
    s_cbranch_vccnz .gc_407

    v_mfma_f32_16x16x32_bf16 v[76:79], v[200:203], v[84:87], v[76:79]
    v_mfma_f32_16x16x32_bf16 v[76:79], v[204:207], v[112:115], v[76:79]
    s_branch .gd_404
.gc_407:
    s_waitcnt vmcnt(2)
    v_max_u32 v4, v20, v24
    v_cmp_eq_u32 vcc, -1, v4
    s_cbranch_vccnz .gc_408

    v_mfma_f32_16x16x32_bf16 v[76:79], v[20:23], v[84:87], v[76:79]
    v_mfma_f32_16x16x32_bf16 v[76:79], v[24:27], v[112:115], v[76:79]
    s_branch .gd_404
.gc_408:
    s_waitcnt vmcnt(0)
    v_max_u32 v4, v28, v32
    v_cmp_eq_u32 vcc, -1, v4
    s_cbranch_vccnz .gr_430

    v_mfma_f32_16x16x32_bf16 v[76:79], v[28:31], v[84:87], v[76:79]
    v_mfma_f32_16x16x32_bf16 v[76:79], v[32:35], v[112:115], v[76:79]
    s_branch .gd_404
.gr_430:
    s_add_u32 s4, s99, 786432
    buffer_load_dwordx4 v[28:31], v239, s[8:11], s4 offen sc1
    buffer_load_dwordx4 v[32:35], v249, s[8:11], s4 offen sc1

    s_add_u32 s62, s62, 1
    s_cmp_gt_u32 s62, 0x400000
    s_cbranch_scc1 .mg_end_1
    s_branch .gc_408

.p2align 6
.top3_431:
    buffer_load_dwordx4 v[20:23], v8, s[8:11], s29 offen offset:0 sc1
    s_nop 11
    buffer_load_dwordx4 v[24:27], v8, s[8:11], s29 offen offset:1024 sc1
    s_nop 11
    buffer_load_dwordx4 v[28:31], v8, s[8:11], s29 offen offset:2048 sc1
    s_nop 11
    buffer_load_dwordx4 v[32:35], v8, s[8:11], s29 offen offset:3072 sc1
.ent13_28:
    s_waitcnt vmcnt(3)
    v_max_u32 v4, v20, v22
    v_cmp_eq_u32 vcc, -1, v4
    s_cbranch_vccnz .pf_434
    v_smfmac_f32_16x16x64_bf16 v[52:55], v[20:23], a[0:7], v9
    v_smfmac_f32_16x16x64_bf16 v[56:59], v[20:23], a[32:39], v9
    v_smfmac_f32_16x16x64_bf16 v[60:63], v[20:23], a[64:71], v9
    v_smfmac_f32_16x16x64_bf16 v[64:67], v[20:23], a[96:103], v9
.pr_438:
    s_waitcnt vmcnt(2)
    v_max_u32 v4, v24, v26
    v_cmp_eq_u32 vcc, -1, v4
    s_cbranch_vccnz .pf_435
    v_smfmac_f32_16x16x64_bf16 v[52:55], v[24:27], a[8:15], v9
    v_smfmac_f32_16x16x64_bf16 v[56:59], v[24:27], a[40:47], v9
    v_smfmac_f32_16x16x64_bf16 v[60:63], v[24:27], a[72:79], v9
    v_smfmac_f32_16x16x64_bf16 v[64:67], v[24:27], a[104:111], v9
.pr_439:
    s_waitcnt vmcnt(1)
    v_max_u32 v4, v28, v30
    v_cmp_eq_u32 vcc, -1, v4
    s_cbranch_vccnz .pf_436
    v_smfmac_f32_16x16x64_bf16 v[52:55], v[28:31], a[16:23], v9
    v_smfmac_f32_16x16x64_bf16 v[56:59], v[28:31], a[48:55], v9
    v_smfmac_f32_16x16x64_bf16 v[60:63], v[28:31], a[80:87], v9
    v_smfmac_f32_16x16x64_bf16 v[64:67], v[28:31], a[112:119], v9
.pr_440:
    s_waitcnt vmcnt(0)
    v_max_u32 v4, v32, v34
    v_cmp_eq_u32 vcc, -1, v4
    s_cbranch_vccnz .pf_437
    v_smfmac_f32_16x16x64_bf16 v[52:55], v[32:35], a[24:31], v9
    v_smfmac_f32_16x16x64_bf16 v[56:59], v[32:35], a[56:63], v9
    v_smfmac_f32_16x16x64_bf16 v[60:63], v[32:35], a[88:95], v9
    v_smfmac_f32_16x16x64_bf16 v[64:67], v[32:35], a[120:127], v9
.pr_441:
    s_cmp_lg_u32 s63, 0
    s_cbranch_scc1 .ps_433
.pd_432:
    v_cvt_pk_bf16_f32 v104, v52, v53
    v_cvt_pk_bf16_f32 v105, v54, v55
    v_cvt_pk_bf16_f32 v106, v56, v57
    v_cvt_pk_bf16_f32 v107, v58, v59
    ds_write_b64 v16, v[104:105] offset:4096
    v_cvt_pk_bf16_f32 v108, v60, v61
    v_cvt_pk_bf16_f32 v109, v62, v63
    ds_write_b64 v16, v[106:107] offset:6144
    ds_write_b64 v16, v[108:109] offset:0
    s_nop 0
    v_cvt_pk_bf16_f32 v110, v64, v65
    v_cvt_pk_bf16_f32 v111, v66, v67
    ds_write_b64 v16, v[110:111] offset:2048
    v_smfmac_f32_16x16x64_bf16 v[68:71], v[20:23], a[128:135], v9
    v_smfmac_f32_16x16x64_bf16 v[72:75], v[20:23], a[160:167], v9
    s_waitcnt lgkmcnt(0)
    s_barrier
    ds_read_b128 v[36:39], v14 offset:6144
    ds_read_b128 v[40:43], v14 offset:7168
    v_smfmac_f32_16x16x64_bf16 v[68:71], v[24:27], a[136:143], v9
    v_smfmac_f32_16x16x64_bf16 v[72:75], v[24:27], a[168:175], v9
    s_waitcnt lgkmcnt(1)
    v_mfma_f32_16x16x32_bf16 v[44:47], v[36:39], v[84:87], 0
    s_waitcnt lgkmcnt(0)
    v_mfma_f32_16x16x32_bf16 v[44:47], v[40:43], v[84:87], v[44:47]
    v_smfmac_f32_16x16x64_bf16 v[68:71], v[28:31], a[144:151], v9
    v_smfmac_f32_16x16x64_bf16 v[72:75], v[28:31], a[176:183], v9
    s_mov_b64 exec, s[58:59]
    v_cvt_pk_bf16_f32 v48, v44, v45
    v_cvt_pk_bf16_f32 v49, v46, v47
    v_min_u32 v48, 0xfffffffe, v48
    buffer_store_dwordx2 v[48:49], v10, s[8:11], s29 offen sc1

    ds_write_b64 v18, v[48:49]
    s_mov_b64 exec, -1

    v_smfmac_f32_16x16x64_bf16 v[68:71], v[32:35], a[152:159], v9
    v_smfmac_f32_16x16x64_bf16 v[72:75], v[32:35], a[184:191], v9
    s_nop 3
    v_cvt_pk_bf16_f32 v104, v68, v69
    v_cvt_pk_bf16_f32 v105, v70, v71
    ds_write_b64 v16, v[104:105] offset:8192
    s_nop 0
    v_cvt_pk_bf16_f32 v106, v72, v73
    v_cvt_pk_bf16_f32 v107, v74, v75
    ds_write_b64 v16, v[106:107] offset:10240
    s_waitcnt lgkmcnt(0)
    s_barrier
    s_cmp_eq_u32 s28, 63
    s_cbranch_scc1 .last_442
    s_barrier
    s_barrier
    v_mov_b32 v52, 0
    v_mov_b32 v53, 0
    v_mov_b32 v54, 0
    v_mov_b32 v55, 0
    v_mov_b32 v56, 0
    v_mov_b32 v57, 0
    v_mov_b32 v58, 0
    v_mov_b32 v59, 0
    v_mov_b32 v60, 0
    v_mov_b32 v61, 0
    v_mov_b32 v62, 0
    v_mov_b32 v63, 0
    v_mov_b32 v64, 0
    v_mov_b32 v65, 0
    v_mov_b32 v66, 0
    v_mov_b32 v67, 0
    v_mov_b32 v68, 0
    v_mov_b32 v69, 0
    v_mov_b32 v70, 0
    v_mov_b32 v71, 0
    v_mov_b32 v72, 0
    v_mov_b32 v73, 0
    v_mov_b32 v74, 0
    v_mov_b32 v75, 0
    s_mov_b32 s99, s68
    s_add_u32 s28, s28, 1
    s_add_u32 s36, s36, 196608
    s_add_u32 s38, s38, 262144
    s_add_u32 s39, s39, 262144
    s_mov_b32 s4, s68
    s_mov_b32 s68, s69
    s_mov_b32 s69, s70
    s_mov_b32 s70, s71
    s_mov_b32 s71, s4

    s_and_b32 s4, s28, 3
    s_lshl_b32 s5, s4, 16
    s_add_u32 s29, s5, s34
    s_xor_b32 s6, s5, 0x20000
    s_add_u32 s31, s6, s34
    s_add_u32 s32, s29, 16384
    s_add_u32 s33, s29, 20480

    s_barrier
    ds_read_b128 v[36:39], v248
    s_nop 15
    s_add_u32 s4, s99, 0
    buffer_load_dwordx4 v[192:195], v239, s[8:11], s4 offen sc1
    buffer_load_dwordx4 v[196:199], v249, s[8:11], s4 offen sc1

    s_waitcnt lgkmcnt(0)
    v_mfma_f32_16x16x32_bf16 v[76:79], v[36:39], v[112:115], 0
    s_nop 15
    s_add_u32 s4, s99, 262144
    buffer_load_dwordx4 v[200:203], v239, s[8:11], s4 offen sc1
    buffer_load_dwordx4 v[204:207], v249, s[8:11], s4 offen sc1

    s_nop 15
    s_add_u32 s4, s99, 524288
    buffer_load_dwordx4 v[20:23], v239, s[8:11], s4 offen sc1
    buffer_load_dwordx4 v[24:27], v249, s[8:11], s4 offen sc1

    s_nop 15
    s_add_u32 s4, s99, 786432
    buffer_load_dwordx4 v[28:31], v239, s[8:11], s4 offen sc1
    buffer_load_dwordx4 v[32:35], v249, s[8:11], s4 offen sc1

    s_barrier
.gc_444:
    s_waitcnt vmcnt(6)
    v_max_u32 v4, v192, v196
    v_cmp_eq_u32 vcc, -1, v4
    s_cbranch_vccnz .gc_445

    v_mfma_f32_16x16x32_bf16 v[76:79], v[192:195], v[84:87], v[76:79]
    v_mfma_f32_16x16x32_bf16 v[76:79], v[196:199], v[112:115], v[76:79]
.gd_443:
    s_mov_b64 exec, s[58:59]
    s_nop 6
    v_cvt_pk_bf16_f32 v48, v76, v77
    v_cvt_pk_bf16_f32 v49, v78, v79
    v_min_u32 v48, 0xfffffffe, v48
    buffer_store_dwordx2 v[48:49], v15, s[8:11], s29 offen sc1
    s_mov_b64 exec, -1

    s_waitcnt lgkmcnt(0)
    s_barrier
    s_branch .top3_431
.pf_434:
    buffer_load_dwordx4 v[20:23], v8, s[8:11], s29 offen offset:0 sc1
    s_bitset1_b32 s63, 0
    s_branch .pr_438
.pf_435:
    buffer_load_dwordx4 v[24:27], v8, s[8:11], s29 offen offset:1024 sc1
    s_bitset1_b32 s63, 1
    s_branch .pr_439
.pf_436:
    buffer_load_dwordx4 v[28:31], v8, s[8:11], s29 offen offset:2048 sc1
    s_bitset1_b32 s63, 2
    s_branch .pr_440
.pf_437:
    buffer_load_dwordx4 v[32:35], v8, s[8:11], s29 offen offset:3072 sc1
    s_bitset1_b32 s63, 3
    s_branch .pr_441
.ps_433:
    s_add_u32 s62, s62, 1
    s_cmp_gt_u32 s62, 0x400000
    s_cbranch_scc1 .mg_end_1
    s_bitcmp1_b32 s63, 0
    s_cbranch_scc1 .pw_448
    s_bitcmp1_b32 s63, 1
    s_cbranch_scc1 .pw_449
    s_bitcmp1_b32 s63, 2
    s_cbranch_scc1 .pw_450
.pw_451:
    s_waitcnt vmcnt(0)
    v_max_u32 v4, v32, v34
    v_cmp_eq_u32 vcc, -1, v4
    s_cbranch_vccnz .pg_459
    v_smfmac_f32_16x16x64_bf16 v[52:55], v[32:35], a[24:31], v9
    v_smfmac_f32_16x16x64_bf16 v[56:59], v[32:35], a[56:63], v9
    v_smfmac_f32_16x16x64_bf16 v[60:63], v[32:35], a[88:95], v9
    v_smfmac_f32_16x16x64_bf16 v[64:67], v[32:35], a[120:127], v9
    s_xor_b32 s63, s63, 8
    s_cbranch_scc0 .pd_432
    s_branch .ps_433
.pw_450:
    s_waitcnt vmcnt(0)
    v_max_u32 v4, v28, v30
    v_cmp_eq_u32 vcc, -1, v4
    s_cbranch_vccnz .pg_458
    v_smfmac_f32_16x16x64_bf16 v[52:55], v[28:31], a[16:23], v9
    v_smfmac_f32_16x16x64_bf16 v[56:59], v[28:31], a[48:55], v9
    v_smfmac_f32_16x16x64_bf16 v[60:63], v[28:31], a[80:87], v9
    v_smfmac_f32_16x16x64_bf16 v[64:67], v[28:31], a[112:119], v9
    s_xor_b32 s63, s63, 4
    s_cbranch_scc0 .pd_432
    s_branch .pn_455
.pw_449:
    s_waitcnt vmcnt(0)
    v_max_u32 v4, v24, v26
    v_cmp_eq_u32 vcc, -1, v4
    s_cbranch_vccnz .pg_457
    v_smfmac_f32_16x16x64_bf16 v[52:55], v[24:27], a[8:15], v9
    v_smfmac_f32_16x16x64_bf16 v[56:59], v[24:27], a[40:47], v9
    v_smfmac_f32_16x16x64_bf16 v[60:63], v[24:27], a[72:79], v9
    v_smfmac_f32_16x16x64_bf16 v[64:67], v[24:27], a[104:111], v9
    s_xor_b32 s63, s63, 2
    s_cbranch_scc0 .pd_432
    s_branch .pn_454
.pw_448:
    s_waitcnt vmcnt(0)
    v_max_u32 v4, v20, v22
    v_cmp_eq_u32 vcc, -1, v4
    s_cbranch_vccnz .pg_456
    v_smfmac_f32_16x16x64_bf16 v[52:55], v[20:23], a[0:7], v9
    v_smfmac_f32_16x16x64_bf16 v[56:59], v[20:23], a[32:39], v9
    v_smfmac_f32_16x16x64_bf16 v[60:63], v[20:23], a[64:71], v9
    v_smfmac_f32_16x16x64_bf16 v[64:67], v[20:23], a[96:103], v9
    s_xor_b32 s63, s63, 1
    s_cbranch_scc0 .pd_432
    s_branch .pn_453
.pn_453:
    s_bitcmp1_b32 s63, 1
    s_cbranch_scc0 .pn_454
    v_max_u32 v4, v24, v26
    v_cmp_eq_u32 vcc, -1, v4
    s_cbranch_vccnz .pg_457
    v_smfmac_f32_16x16x64_bf16 v[52:55], v[24:27], a[8:15], v9
    v_smfmac_f32_16x16x64_bf16 v[56:59], v[24:27], a[40:47], v9
    v_smfmac_f32_16x16x64_bf16 v[60:63], v[24:27], a[72:79], v9
    v_smfmac_f32_16x16x64_bf16 v[64:67], v[24:27], a[104:111], v9
    s_xor_b32 s63, s63, 2
    s_cbranch_scc0 .pd_432
.pn_454:
    s_bitcmp1_b32 s63, 2
    s_cbranch_scc0 .pn_455
    v_max_u32 v4, v28, v30
    v_cmp_eq_u32 vcc, -1, v4
    s_cbranch_vccnz .pg_458
    v_smfmac_f32_16x16x64_bf16 v[52:55], v[28:31], a[16:23], v9
    v_smfmac_f32_16x16x64_bf16 v[56:59], v[28:31], a[48:55], v9
    v_smfmac_f32_16x16x64_bf16 v[60:63], v[28:31], a[80:87], v9
    v_smfmac_f32_16x16x64_bf16 v[64:67], v[28:31], a[112:119], v9
    s_xor_b32 s63, s63, 4
    s_cbranch_scc0 .pd_432
.pn_455:
    s_bitcmp1_b32 s63, 3
    s_cbranch_scc0 .ps_433
    v_max_u32 v4, v32, v34
    v_cmp_eq_u32 vcc, -1, v4
    s_cbranch_vccnz .pg_459
    v_smfmac_f32_16x16x64_bf16 v[52:55], v[32:35], a[24:31], v9
    v_smfmac_f32_16x16x64_bf16 v[56:59], v[32:35], a[56:63], v9
    v_smfmac_f32_16x16x64_bf16 v[60:63], v[32:35], a[88:95], v9
    v_smfmac_f32_16x16x64_bf16 v[64:67], v[32:35], a[120:127], v9
    s_xor_b32 s63, s63, 8
    s_cbranch_scc0 .pd_432
    s_branch .ps_433
.pg_456:
    buffer_load_dwordx4 v[20:23], v8, s[8:11], s29 offen offset:0 sc1
    s_branch .pn_453
.pg_457:
    buffer_load_dwordx4 v[24:27], v8, s[8:11], s29 offen offset:1024 sc1
    s_branch .pn_454
.pg_458:
    buffer_load_dwordx4 v[28:31], v8, s[8:11], s29 offen offset:2048 sc1
    s_branch .pn_455
.pg_459:
    buffer_load_dwordx4 v[32:35], v8, s[8:11], s29 offen offset:3072 sc1
    s_branch .ps_433
.last_442:
    s_branch .rec_fin_5
.gc_445:
    s_waitcnt vmcnt(4)
    v_max_u32 v4, v200, v204
    v_cmp_eq_u32 vcc, -1, v4
    s_cbranch_vccnz .gc_446

    v_mfma_f32_16x16x32_bf16 v[76:79], v[200:203], v[84:87], v[76:79]
    v_mfma_f32_16x16x32_bf16 v[76:79], v[204:207], v[112:115], v[76:79]
    s_branch .gd_443
.gc_446:
    s_waitcnt vmcnt(2)
    v_max_u32 v4, v20, v24
    v_cmp_eq_u32 vcc, -1, v4
    s_cbranch_vccnz .gc_447

    v_mfma_f32_16x16x32_bf16 v[76:79], v[20:23], v[84:87], v[76:79]
    v_mfma_f32_16x16x32_bf16 v[76:79], v[24:27], v[112:115], v[76:79]
    s_branch .gd_443
.gc_447:
    s_waitcnt vmcnt(0)
    v_max_u32 v4, v28, v32
    v_cmp_eq_u32 vcc, -1, v4
    s_cbranch_vccnz .gr_460

    v_mfma_f32_16x16x32_bf16 v[76:79], v[28:31], v[84:87], v[76:79]
    v_mfma_f32_16x16x32_bf16 v[76:79], v[32:35], v[112:115], v[76:79]
    s_branch .gd_443
.gr_460:
    s_add_u32 s4, s99, 786432
    buffer_load_dwordx4 v[28:31], v239, s[8:11], s4 offen sc1
    buffer_load_dwordx4 v[32:35], v249, s[8:11], s4 offen sc1

    s_add_u32 s62, s62, 1
    s_cmp_gt_u32 s62, 0x400000
    s_cbranch_scc1 .mg_end_1
    s_branch .gc_447

.rec_fin_5:
    s_mov_b64 exec, -1
    s_endpgm
.mg_bg_2:
    s_sub_u32 s91, s25, 4
    s_lshl_b32 s90, s91, 5
    s_add_u32 s90, s90, s26
    s_cmp_ge_u32 s26, 24
    s_cbranch_scc1 .cvrole_461
    s_lshr_b32 s30, s26, 3
    s_sub_u32 s30, 2, s30
    s_and_b32 s31, s26, 7
    s_lshl_b32 s4, s91, 3
    s_add_u32 s31, s31, s4

    s_load_dwordx2 s[40:41], s[0:1], 0
    s_load_dwordx4 s[44:47], s[0:1], 64
    s_load_dwordx2 s[42:43], s[0:1], 80

    v_and_b32 v1, 63, v0
    v_and_b32 v2, 15, v1
    v_lshrrev_b32 v3, 4, v1

    s_lshl_b32 s28, s31, 8
    s_waitcnt lgkmcnt(0)
    s_cmp_eq_u32 s30, 0
    s_cselect_b64 s[42:43], s[44:45], s[42:43]
    s_cmp_eq_u32 s30, 1
    s_cselect_b64 s[42:43], s[46:47], s[42:43]

    s_mov_b32 s16, s40
    s_and_b32 s17, s41, 0xffff
    s_mov_b32 s18, 0x400000
    s_mov_b32 s19, 0x00020000

    s_mov_b32 s12, s42
    s_and_b32 s13, s43, 0xffff
    s_mov_b32 s14, 0x800000
    s_mov_b32 s15, 0x00020000

    v_lshrrev_b32 v4, 1, v2
    v_xor_b32 v4, v4, v3
    v_lshlrev_b32 v4, 1, v4
    v_and_b32 v5, 1, v1
    v_or_b32 v4, v4, v5
    v_lshlrev_b32 v4, 4, v4
    v_lshlrev_b32 v5, 13, v3
    v_add_u32 v10, v4, v5
    v_xor_b32 v11, 0x80, v10
    s_lshl_b32 s4, s24, 18
    s_add_u32 s28, s28, s4
    s_lshl_b32 s29, s24, 13
    v_lshrrev_b32 v4, 2, v2
    v_and_b32 v5, 1, v3
    v_lshl_or_b32 v5, v5, 2, v4
    s_lshl_b32 s4, s24, 1
    v_xor_b32 v5, s4, v5
    v_lshlrev_b32 v5, 5, v5
    v_lshl_add_u32 v4, v3, 3, v4
    v_lshl_add_u32 v5, v4, 8, v5
    v_and_b32 v4, 3, v2
    v_lshl_add_u32 v12, v4, 3, v5
    v_xor_b32 v13, 32, v12
    v_add_u32 v14, 0x10000, v12
    v_add_u32 v15, 0x10000, v13

    s_add_u32 m0, s29, 0
    s_add_u32 s4, s28, 0
    buffer_load_dwordx4 v10, s[12:15], s4 offen lds

    s_add_u32 m0, s29, 1024
    s_add_u32 s4, s28, 32768
    buffer_load_dwordx4 v10, s[12:15], s4 offen lds

    s_add_u32 m0, s29, 2048
    s_add_u32 s4, s28, 65536
    buffer_load_dwordx4 v11, s[12:15], s4 offen lds

    s_add_u32 m0, s29, 3072
    s_add_u32 s4, s28, 98304
    buffer_load_dwordx4 v11, s[12:15], s4 offen lds

    s_add_u32 m0, s29, 4096
    s_add_u32 s4, s28, 131072
    buffer_load_dwordx4 v10, s[12:15], s4 offen lds

    s_add_u32 m0, s29, 5120
    s_add_u32 s4, s28, 163840
    buffer_load_dwordx4 v10, s[12:15], s4 offen lds

    s_add_u32 m0, s29, 6144
    s_add_u32 s4, s28, 196608
    buffer_load_dwordx4 v11, s[12:15], s4 offen lds

    s_add_u32 m0, s29, 7168
    s_add_u32 s4, s28, 229376
    buffer_load_dwordx4 v11, s[12:15], s4 offen lds

    s_add_u32 m0, s29, 32768
    s_add_u32 s4, s28, 1048576
    buffer_load_dwordx4 v10, s[12:15], s4 offen lds

    s_add_u32 m0, s29, 33792
    s_add_u32 s4, s28, 1081344
    buffer_load_dwordx4 v10, s[12:15], s4 offen lds

    s_add_u32 m0, s29, 34816
    s_add_u32 s4, s28, 1114112
    buffer_load_dwordx4 v11, s[12:15], s4 offen lds

    s_add_u32 m0, s29, 35840
    s_add_u32 s4, s28, 1146880
    buffer_load_dwordx4 v11, s[12:15], s4 offen lds

    s_add_u32 m0, s29, 36864
    s_add_u32 s4, s28, 1179648
    buffer_load_dwordx4 v10, s[12:15], s4 offen lds

    s_add_u32 m0, s29, 37888
    s_add_u32 s4, s28, 1212416
    buffer_load_dwordx4 v10, s[12:15], s4 offen lds

    s_add_u32 m0, s29, 38912
    s_add_u32 s4, s28, 1245184
    buffer_load_dwordx4 v11, s[12:15], s4 offen lds

    s_add_u32 m0, s29, 39936
    s_add_u32 s4, s28, 1277952
    buffer_load_dwordx4 v11, s[12:15], s4 offen lds

    s_add_u32 m0, s29, 65536
    s_add_u32 s4, s28, 2097152
    buffer_load_dwordx4 v10, s[12:15], s4 offen lds

    s_add_u32 m0, s29, 66560
    s_add_u32 s4, s28, 2129920
    buffer_load_dwordx4 v10, s[12:15], s4 offen lds

    s_add_u32 m0, s29, 67584
    s_add_u32 s4, s28, 2162688
    buffer_load_dwordx4 v11, s[12:15], s4 offen lds

    s_add_u32 m0, s29, 68608
    s_add_u32 s4, s28, 2195456
    buffer_load_dwordx4 v11, s[12:15], s4 offen lds

    s_add_u32 m0, s29, 69632
    s_add_u32 s4, s28, 2228224
    buffer_load_dwordx4 v10, s[12:15], s4 offen lds

    s_add_u32 m0, s29, 70656
    s_add_u32 s4, s28, 2260992
    buffer_load_dwordx4 v10, s[12:15], s4 offen lds

    s_add_u32 m0, s29, 71680
    s_add_u32 s4, s28, 2293760
    buffer_load_dwordx4 v11, s[12:15], s4 offen lds

    s_add_u32 m0, s29, 72704
    s_add_u32 s4, s28, 2326528
    buffer_load_dwordx4 v11, s[12:15], s4 offen lds

    s_add_u32 m0, s29, 98304
    s_add_u32 s4, s28, 3145728
    buffer_load_dwordx4 v10, s[12:15], s4 offen lds

    s_add_u32 m0, s29, 99328
    s_add_u32 s4, s28, 3178496
    buffer_load_dwordx4 v10, s[12:15], s4 offen lds

    s_add_u32 m0, s29, 100352
    s_add_u32 s4, s28, 3211264
    buffer_load_dwordx4 v11, s[12:15], s4 offen lds

    s_add_u32 m0, s29, 101376
    s_add_u32 s4, s28, 3244032
    buffer_load_dwordx4 v11, s[12:15], s4 offen lds

    s_add_u32 m0, s29, 102400
    s_add_u32 s4, s28, 3276800
    buffer_load_dwordx4 v10, s[12:15], s4 offen lds

    s_add_u32 m0, s29, 103424
    s_add_u32 s4, s28, 3309568
    buffer_load_dwordx4 v10, s[12:15], s4 offen lds

    s_add_u32 m0, s29, 104448
    s_add_u32 s4, s28, 3342336
    buffer_load_dwordx4 v11, s[12:15], s4 offen lds

    s_add_u32 m0, s29, 105472
    s_add_u32 s4, s28, 3375104
    buffer_load_dwordx4 v11, s[12:15], s4 offen lds

    s_cmp_lg_u32 s97, 0
    s_cbranch_scc1 .vd_463
    v_and_b32 v243, 7, v0
    v_lshlrev_b32 v243, 2, v243
    s_mov_b32 s62, 0

.vp_462:
    buffer_load_dword v242, v243, s[20:23], 0 offen sc1
    s_waitcnt vmcnt(0)
    v_readlane_b32 s64, v242, 0
    v_readlane_b32 s65, v242, 1
    v_readlane_b32 s66, v242, 2
    v_readlane_b32 s67, v242, 3
    v_readlane_b32 s68, v242, 4
    v_readlane_b32 s69, v242, 5
    v_readlane_b32 s70, v242, 6
    v_readlane_b32 s71, v242, 7
    v_cmp_ne_u32 vcc, 32, v242
    s_add_u32 s4, s64, s65
    s_add_u32 s5, s66, s67
    s_add_u32 s72, s68, s69
    s_add_u32 s73, s70, s71
    s_add_u32 s4, s4, s5
    s_add_u32 s72, s72, s73
    s_add_u32 s4, s4, s72
    s_cmp_eq_u64 vcc, 0
    s_cbranch_scc1 .vd_463
    s_cmp_ge_u32 s4, 256
    s_cbranch_scc1 .vs_464
    s_add_u32 s62, s62, 1
    s_cmp_gt_u32 s62, 0x100000
    s_cbranch_scc1 .mg_end_1
    s_branch .vp_462

.vs_464:
    s_lshr_b32 s25, s2, 5
    s_and_b32 s26, s2, 31
    s_mov_b32 s27, 1
    s_mov_b32 s97, 1
    s_waitcnt vmcnt(0) lgkmcnt(0)
    s_barrier
    s_branch .mg_role_3

.vd_463:
    s_mov_b32 s97, 1
    s_lshl_b32 s4, s30, 5
    s_add_u32 s4, s4, s31
    s_lshl_b32 s4, s4, 8
    s_add_u32 s4, s4, 92274688
    v_mov_b32 v4, 0
    s_mov_b64 exec, 1
    buffer_store_dword v4, v4, s[8:11], s4 offen sc1
    s_mov_b64 exec, -1

    s_waitcnt vmcnt(0) lgkmcnt(0)
    s_barrier
    s_mov_b32 s5, 32
    s_cmp_lg_u32 s24, 0
    s_cbranch_scc1 .sg_465
    s_mov_b64 exec, 1
    v_mov_b32 v4, 1
    v_mov_b32 v5, 0
    buffer_atomic_add v4, v5, s[20:23], s5 offen sc1
    s_mov_b64 exec, -1

.sg_465:
    v_lshrrev_b32 v4, 3, v1
    v_and_b32 v5, 7, v1
    v_xor_b32 v5, v5, v4
    v_lshlrev_b32 v5, 4, v5
    v_lshl_add_u32 v16, v4, 11, v5
    s_lshl_b32 s4, s24, 14
    v_add_u32 v16, s4, v16
    v_and_b32 v4, 7, v2
    v_xor_b32 v5, v4, v3
    v_lshlrev_b32 v5, 4, v5
    v_lshl_add_u32 v5, v4, 7, v5
    v_lshrrev_b32 v4, 3, v2
    v_lshl_add_u32 v17, v4, 13, v5
    v_xor_b32 v18, 64, v17
    v_add_u32 v19, 0x10000, v17
    v_add_u32 v20, 0x10000, v18
    v_lshlrev_b32 v21, 4, v1
    s_lshl_b32 s32, s30, 24
    s_lshl_b32 s4, s31, 13
    s_add_u32 s32, s32, s4
    s_lshr_b32 s5, s30, 1
    s_add_u32 s5, s5, 10
    s_lshl_b32 s4, s24, s5
    s_add_u32 s39, s32, s4
    s_mov_b32 s32, 251658240
    s_mov_b32 s38, s32
    v_mov_b32 v23, -1
    s_lshl_b32 s4, s30, 5
    s_add_u32 s4, s4, s31
    s_lshl_b32 s4, s4, 8
    s_add_u32 s33, s4, 92274688
    s_cmp_eq_u32 s24, 0
    s_cselect_b32 s36, 1, 0
    s_mov_b32 s37, 0
    v_mov_b32 v22, 0
    s_mov_b32 s34, 0
    s_mov_b32 s35, 0

    s_mul_i32 s47, s26, 1441792
    s_lshl_b32 s4, s24, 10
    s_add_u32 s47, s47, s4
    s_add_u32 s47, s47, 184549376
    v_mov_b32 v24, -1
    v_mov_b32 v25, -1
    v_mov_b32 v26, -1
    v_mov_b32 v27, -1

    s_xor_b32 s4, s91, 1
    s_lshl_b32 s5, s4, 14
    s_lshl_b32 s6, s91, 12
    s_add_u32 s5, s5, s6
    v_add_u32 v28, s5, v21
    s_lshl_b32 s5, s91, 14
    s_lshl_b32 s6, s4, 12
    s_add_u32 s5, s5, s6
    v_add_u32 v7, s5, v21

    s_xor_b32 s4, s91, 2
    s_lshl_b32 s5, s4, 14
    s_lshl_b32 s6, s91, 12
    s_add_u32 s5, s5, s6
    v_add_u32 v29, s5, v21
    s_lshl_b32 s5, s91, 14
    s_lshl_b32 s6, s4, 12
    s_add_u32 s5, s5, s6
    v_add_u32 v8, s5, v21

    s_xor_b32 s4, s91, 3
    s_lshl_b32 s5, s4, 14
    s_lshl_b32 s6, s91, 12
    s_add_u32 s5, s5, s6
    v_add_u32 v30, s5, v21
    s_lshl_b32 s5, s91, 14
    s_lshl_b32 s6, s4, 12
    s_add_u32 s5, s5, s6
    v_add_u32 v9, s5, v21

    s_mov_b64 s[44:45], -1
    s_mov_b32 s46, s47
    s_waitcnt vmcnt(24)
    s_barrier
    ds_read_b64_tr_b16 a[0:1], v12 offset:0
    ds_read_b64_tr_b16 a[2:3], v12 offset:1024
    ds_read_b64_tr_b16 a[4:5], v13 offset:0
    ds_read_b64_tr_b16 a[6:7], v13 offset:1024
    ds_read_b64_tr_b16 a[8:9], v12 offset:8192
    ds_read_b64_tr_b16 a[10:11], v12 offset:9216
    ds_read_b64_tr_b16 a[12:13], v13 offset:8192
    ds_read_b64_tr_b16 a[14:15], v13 offset:9216
    ds_read_b64_tr_b16 a[16:17], v12 offset:16384
    ds_read_b64_tr_b16 a[18:19], v12 offset:17408
    ds_read_b64_tr_b16 a[20:21], v13 offset:16384
    ds_read_b64_tr_b16 a[22:23], v13 offset:17408
    ds_read_b64_tr_b16 a[24:25], v12 offset:24576
    ds_read_b64_tr_b16 a[26:27], v12 offset:25600
    ds_read_b64_tr_b16 a[28:29], v13 offset:24576
    ds_read_b64_tr_b16 a[30:31], v13 offset:25600
    s_waitcnt lgkmcnt(0)
    s_barrier
    s_add_u32 m0, s29, 0
    s_add_u32 s4, s28, 4194304
    buffer_load_dwordx4 v10, s[12:15], s4 offen lds

    s_add_u32 m0, s29, 1024
    s_add_u32 s4, s28, 4227072
    buffer_load_dwordx4 v10, s[12:15], s4 offen lds

    s_add_u32 m0, s29, 2048
    s_add_u32 s4, s28, 4259840
    buffer_load_dwordx4 v11, s[12:15], s4 offen lds

    s_add_u32 m0, s29, 3072
    s_add_u32 s4, s28, 4292608
    buffer_load_dwordx4 v11, s[12:15], s4 offen lds

    s_add_u32 m0, s29, 4096
    s_add_u32 s4, s28, 4325376
    buffer_load_dwordx4 v10, s[12:15], s4 offen lds

    s_add_u32 m0, s29, 5120
    s_add_u32 s4, s28, 4358144
    buffer_load_dwordx4 v10, s[12:15], s4 offen lds

    s_add_u32 m0, s29, 6144
    s_add_u32 s4, s28, 4390912
    buffer_load_dwordx4 v11, s[12:15], s4 offen lds

    s_add_u32 m0, s29, 7168
    s_add_u32 s4, s28, 4423680
    buffer_load_dwordx4 v11, s[12:15], s4 offen lds

    s_waitcnt vmcnt(24)
    s_barrier
    ds_read_b64_tr_b16 a[32:33], v12 offset:32768
    ds_read_b64_tr_b16 a[34:35], v12 offset:33792
    ds_read_b64_tr_b16 a[36:37], v13 offset:32768
    ds_read_b64_tr_b16 a[38:39], v13 offset:33792
    ds_read_b64_tr_b16 a[40:41], v12 offset:40960
    ds_read_b64_tr_b16 a[42:43], v12 offset:41984
    ds_read_b64_tr_b16 a[44:45], v13 offset:40960
    ds_read_b64_tr_b16 a[46:47], v13 offset:41984
    ds_read_b64_tr_b16 a[48:49], v12 offset:49152
    ds_read_b64_tr_b16 a[50:51], v12 offset:50176
    ds_read_b64_tr_b16 a[52:53], v13 offset:49152
    ds_read_b64_tr_b16 a[54:55], v13 offset:50176
    ds_read_b64_tr_b16 a[56:57], v12 offset:57344
    ds_read_b64_tr_b16 a[58:59], v12 offset:58368
    ds_read_b64_tr_b16 a[60:61], v13 offset:57344
    ds_read_b64_tr_b16 a[62:63], v13 offset:58368
    s_waitcnt lgkmcnt(0)
    s_barrier
    s_add_u32 m0, s29, 32768
    s_add_u32 s4, s28, 5242880
    buffer_load_dwordx4 v10, s[12:15], s4 offen lds

    s_add_u32 m0, s29, 33792
    s_add_u32 s4, s28, 5275648
    buffer_load_dwordx4 v10, s[12:15], s4 offen lds

    s_add_u32 m0, s29, 34816
    s_add_u32 s4, s28, 5308416
    buffer_load_dwordx4 v11, s[12:15], s4 offen lds

    s_add_u32 m0, s29, 35840
    s_add_u32 s4, s28, 5341184
    buffer_load_dwordx4 v11, s[12:15], s4 offen lds

    s_add_u32 m0, s29, 36864
    s_add_u32 s4, s28, 5373952
    buffer_load_dwordx4 v10, s[12:15], s4 offen lds

    s_add_u32 m0, s29, 37888
    s_add_u32 s4, s28, 5406720
    buffer_load_dwordx4 v10, s[12:15], s4 offen lds

    s_add_u32 m0, s29, 38912
    s_add_u32 s4, s28, 5439488
    buffer_load_dwordx4 v11, s[12:15], s4 offen lds

    s_add_u32 m0, s29, 39936
    s_add_u32 s4, s28, 5472256
    buffer_load_dwordx4 v11, s[12:15], s4 offen lds

    s_waitcnt vmcnt(24)
    s_barrier
    ds_read_b64_tr_b16 a[64:65], v14 offset:0
    ds_read_b64_tr_b16 a[66:67], v14 offset:1024
    ds_read_b64_tr_b16 a[68:69], v15 offset:0
    ds_read_b64_tr_b16 a[70:71], v15 offset:1024
    ds_read_b64_tr_b16 a[72:73], v14 offset:8192
    ds_read_b64_tr_b16 a[74:75], v14 offset:9216
    ds_read_b64_tr_b16 a[76:77], v15 offset:8192
    ds_read_b64_tr_b16 a[78:79], v15 offset:9216
    ds_read_b64_tr_b16 a[80:81], v14 offset:16384
    ds_read_b64_tr_b16 a[82:83], v14 offset:17408
    ds_read_b64_tr_b16 a[84:85], v15 offset:16384
    ds_read_b64_tr_b16 a[86:87], v15 offset:17408
    ds_read_b64_tr_b16 a[88:89], v14 offset:24576
    ds_read_b64_tr_b16 a[90:91], v14 offset:25600
    ds_read_b64_tr_b16 a[92:93], v15 offset:24576
    ds_read_b64_tr_b16 a[94:95], v15 offset:25600
    s_waitcnt lgkmcnt(0)
    s_barrier
    s_add_u32 m0, s29, 65536
    s_add_u32 s4, s28, 6291456
    buffer_load_dwordx4 v10, s[12:15], s4 offen lds

    s_add_u32 m0, s29, 66560
    s_add_u32 s4, s28, 6324224
    buffer_load_dwordx4 v10, s[12:15], s4 offen lds

    s_add_u32 m0, s29, 67584
    s_add_u32 s4, s28, 6356992
    buffer_load_dwordx4 v11, s[12:15], s4 offen lds

    s_add_u32 m0, s29, 68608
    s_add_u32 s4, s28, 6389760
    buffer_load_dwordx4 v11, s[12:15], s4 offen lds

    s_add_u32 m0, s29, 69632
    s_add_u32 s4, s28, 6422528
    buffer_load_dwordx4 v10, s[12:15], s4 offen lds

    s_add_u32 m0, s29, 70656
    s_add_u32 s4, s28, 6455296
    buffer_load_dwordx4 v10, s[12:15], s4 offen lds

    s_add_u32 m0, s29, 71680
    s_add_u32 s4, s28, 6488064
    buffer_load_dwordx4 v11, s[12:15], s4 offen lds

    s_add_u32 m0, s29, 72704
    s_add_u32 s4, s28, 6520832
    buffer_load_dwordx4 v11, s[12:15], s4 offen lds

    s_waitcnt vmcnt(24)
    s_barrier
    ds_read_b64_tr_b16 a[96:97], v14 offset:32768
    ds_read_b64_tr_b16 a[98:99], v14 offset:33792
    ds_read_b64_tr_b16 a[100:101], v15 offset:32768
    ds_read_b64_tr_b16 a[102:103], v15 offset:33792
    ds_read_b64_tr_b16 a[104:105], v14 offset:40960
    ds_read_b64_tr_b16 a[106:107], v14 offset:41984
    ds_read_b64_tr_b16 a[108:109], v15 offset:40960
    ds_read_b64_tr_b16 a[110:111], v15 offset:41984
    ds_read_b64_tr_b16 a[112:113], v14 offset:49152
    ds_read_b64_tr_b16 a[114:115], v14 offset:50176
    ds_read_b64_tr_b16 a[116:117], v15 offset:49152
    ds_read_b64_tr_b16 a[118:119], v15 offset:50176
    ds_read_b64_tr_b16 a[120:121], v14 offset:57344
    ds_read_b64_tr_b16 a[122:123], v14 offset:58368
    ds_read_b64_tr_b16 a[124:125], v15 offset:57344
    ds_read_b64_tr_b16 a[126:127], v15 offset:58368
    s_waitcnt lgkmcnt(0)
    s_barrier
    s_add_u32 m0, s29, 98304
    s_add_u32 s4, s28, 7340032
    buffer_load_dwordx4 v10, s[12:15], s4 offen lds

    s_add_u32 m0, s29, 99328
    s_add_u32 s4, s28, 7372800
    buffer_load_dwordx4 v10, s[12:15], s4 offen lds

    s_add_u32 m0, s29, 100352
    s_add_u32 s4, s28, 7405568
    buffer_load_dwordx4 v11, s[12:15], s4 offen lds

    s_add_u32 m0, s29, 101376
    s_add_u32 s4, s28, 7438336
    buffer_load_dwordx4 v11, s[12:15], s4 offen lds

    s_add_u32 m0, s29, 102400
    s_add_u32 s4, s28, 7471104
    buffer_load_dwordx4 v10, s[12:15], s4 offen lds

    s_add_u32 m0, s29, 103424
    s_add_u32 s4, s28, 7503872
    buffer_load_dwordx4 v10, s[12:15], s4 offen lds

    s_add_u32 m0, s29, 104448
    s_add_u32 s4, s28, 7536640
    buffer_load_dwordx4 v11, s[12:15], s4 offen lds

    s_add_u32 m0, s29, 105472
    s_add_u32 s4, s28, 7569408
    buffer_load_dwordx4 v11, s[12:15], s4 offen lds

    s_waitcnt vmcnt(24)
    s_barrier
    ds_read_b64_tr_b16 a[128:129], v12 offset:0
    ds_read_b64_tr_b16 a[130:131], v12 offset:1024
    ds_read_b64_tr_b16 a[132:133], v13 offset:0
    ds_read_b64_tr_b16 a[134:135], v13 offset:1024
    ds_read_b64_tr_b16 a[136:137], v12 offset:8192
    ds_read_b64_tr_b16 a[138:139], v12 offset:9216
    ds_read_b64_tr_b16 a[140:141], v13 offset:8192
    ds_read_b64_tr_b16 a[142:143], v13 offset:9216
    ds_read_b64_tr_b16 a[144:145], v12 offset:16384
    ds_read_b64_tr_b16 a[146:147], v12 offset:17408
    ds_read_b64_tr_b16 a[148:149], v13 offset:16384
    ds_read_b64_tr_b16 a[150:151], v13 offset:17408
    ds_read_b64_tr_b16 a[152:153], v12 offset:24576
    ds_read_b64_tr_b16 a[154:155], v12 offset:25600
    ds_read_b64_tr_b16 a[156:157], v13 offset:24576
    ds_read_b64_tr_b16 a[158:159], v13 offset:25600
    s_waitcnt lgkmcnt(0)
    s_barrier
    s_add_u32 m0, s29, 0
    s_nop 0
    buffer_load_dwordx4 v16, s[16:19], s34 offen offset:0 lds
    s_add_u32 m0, s29, 896
    s_nop 0
    buffer_load_dwordx4 v16, s[16:19], s34 offen offset:128 lds
    s_add_u32 m0, s29, 1792
    s_nop 0
    buffer_load_dwordx4 v16, s[16:19], s34 offen offset:256 lds
    s_add_u32 m0, s29, 2688
    s_nop 0
    buffer_load_dwordx4 v16, s[16:19], s34 offen offset:384 lds
    s_add_u32 m0, s29, 3584
    s_nop 0
    buffer_load_dwordx4 v16, s[16:19], s34 offen offset:512 lds
    s_add_u32 m0, s29, 4480
    s_nop 0
    buffer_load_dwordx4 v16, s[16:19], s34 offen offset:640 lds
    s_add_u32 m0, s29, 5376
    s_nop 0
    buffer_load_dwordx4 v16, s[16:19], s34 offen offset:768 lds
    s_add_u32 m0, s29, 6272
    s_nop 0
    buffer_load_dwordx4 v16, s[16:19], s34 offen offset:896 lds
    s_add_u32 s34, s34, 1024
    s_waitcnt vmcnt(24)
    s_barrier
    ds_read_b64_tr_b16 a[160:161], v12 offset:32768
    ds_read_b64_tr_b16 a[162:163], v12 offset:33792
    ds_read_b64_tr_b16 a[164:165], v13 offset:32768
    ds_read_b64_tr_b16 a[166:167], v13 offset:33792
    ds_read_b64_tr_b16 a[168:169], v12 offset:40960
    ds_read_b64_tr_b16 a[170:171], v12 offset:41984
    ds_read_b64_tr_b16 a[172:173], v13 offset:40960
    ds_read_b64_tr_b16 a[174:175], v13 offset:41984
    ds_read_b64_tr_b16 a[176:177], v12 offset:49152
    ds_read_b64_tr_b16 a[178:179], v12 offset:50176
    ds_read_b64_tr_b16 a[180:181], v13 offset:49152
    ds_read_b64_tr_b16 a[182:183], v13 offset:50176
    ds_read_b64_tr_b16 a[184:185], v12 offset:57344
    ds_read_b64_tr_b16 a[186:187], v12 offset:58368
    ds_read_b64_tr_b16 a[188:189], v13 offset:57344
    ds_read_b64_tr_b16 a[190:191], v13 offset:58368
    s_waitcnt lgkmcnt(0)
    s_barrier
    s_add_u32 m0, s29, 32768
    s_nop 0
    buffer_load_dwordx4 v16, s[16:19], s34 offen offset:0 lds
    s_add_u32 m0, s29, 33664
    s_nop 0
    buffer_load_dwordx4 v16, s[16:19], s34 offen offset:128 lds
    s_add_u32 m0, s29, 34560
    s_nop 0
    buffer_load_dwordx4 v16, s[16:19], s34 offen offset:256 lds
    s_add_u32 m0, s29, 35456
    s_nop 0
    buffer_load_dwordx4 v16, s[16:19], s34 offen offset:384 lds
    s_add_u32 m0, s29, 36352
    s_nop 0
    buffer_load_dwordx4 v16, s[16:19], s34 offen offset:512 lds
    s_add_u32 m0, s29, 37248
    s_nop 0
    buffer_load_dwordx4 v16, s[16:19], s34 offen offset:640 lds
    s_add_u32 m0, s29, 38144
    s_nop 0
    buffer_load_dwordx4 v16, s[16:19], s34 offen offset:768 lds
    s_add_u32 m0, s29, 39040
    s_nop 0
    buffer_load_dwordx4 v16, s[16:19], s34 offen offset:896 lds
    s_add_u32 s34, s34, 64512
    s_min_u32 s34, s34, 4128768
    s_waitcnt vmcnt(24)
    s_barrier
    ds_read_b64_tr_b16 a[192:193], v14 offset:0
    ds_read_b64_tr_b16 a[194:195], v14 offset:1024
    ds_read_b64_tr_b16 a[196:197], v15 offset:0
    ds_read_b64_tr_b16 a[198:199], v15 offset:1024
    ds_read_b64_tr_b16 a[200:201], v14 offset:8192
    ds_read_b64_tr_b16 a[202:203], v14 offset:9216
    ds_read_b64_tr_b16 a[204:205], v15 offset:8192
    ds_read_b64_tr_b16 a[206:207], v15 offset:9216
    ds_read_b64_tr_b16 a[208:209], v14 offset:16384
    ds_read_b64_tr_b16 a[210:211], v14 offset:17408
    ds_read_b64_tr_b16 a[212:213], v15 offset:16384
    ds_read_b64_tr_b16 a[214:215], v15 offset:17408
    ds_read_b64_tr_b16 a[216:217], v14 offset:24576
    ds_read_b64_tr_b16 a[218:219], v14 offset:25600
    ds_read_b64_tr_b16 a[220:221], v15 offset:24576
    ds_read_b64_tr_b16 a[222:223], v15 offset:25600
    s_waitcnt lgkmcnt(0)
    s_barrier
    s_add_u32 m0, s29, 65536
    s_nop 0
    buffer_load_dwordx4 v16, s[16:19], s34 offen offset:0 lds
    s_add_u32 m0, s29, 66432
    s_nop 0
    buffer_load_dwordx4 v16, s[16:19], s34 offen offset:128 lds
    s_add_u32 m0, s29, 67328
    s_nop 0
    buffer_load_dwordx4 v16, s[16:19], s34 offen offset:256 lds
    s_add_u32 m0, s29, 68224
    s_nop 0
    buffer_load_dwordx4 v16, s[16:19], s34 offen offset:384 lds
    s_add_u32 m0, s29, 69120
    s_nop 0
    buffer_load_dwordx4 v16, s[16:19], s34 offen offset:512 lds
    s_add_u32 m0, s29, 70016
    s_nop 0
    buffer_load_dwordx4 v16, s[16:19], s34 offen offset:640 lds
    s_add_u32 m0, s29, 70912
    s_nop 0
    buffer_load_dwordx4 v16, s[16:19], s34 offen offset:768 lds
    s_add_u32 m0, s29, 71808
    s_nop 0
    buffer_load_dwordx4 v16, s[16:19], s34 offen offset:896 lds
    s_add_u32 s34, s34, 1024
    s_waitcnt vmcnt(24)
    s_barrier
    ds_read_b64_tr_b16 a[224:225], v14 offset:32768
    ds_read_b64_tr_b16 a[226:227], v14 offset:33792
    ds_read_b64_tr_b16 a[228:229], v15 offset:32768
    ds_read_b64_tr_b16 a[230:231], v15 offset:33792
    ds_read_b64_tr_b16 a[232:233], v14 offset:40960
    ds_read_b64_tr_b16 a[234:235], v14 offset:41984
    ds_read_b64_tr_b16 a[236:237], v15 offset:40960
    ds_read_b64_tr_b16 a[238:239], v15 offset:41984
    ds_read_b64_tr_b16 a[240:241], v14 offset:49152
    ds_read_b64_tr_b16 a[242:243], v14 offset:50176
    ds_read_b64_tr_b16 a[244:245], v15 offset:49152
    ds_read_b64_tr_b16 a[246:247], v15 offset:50176
    ds_read_b64_tr_b16 a[248:249], v14 offset:57344
    ds_read_b64_tr_b16 a[250:251], v14 offset:58368
    ds_read_b64_tr_b16 a[252:253], v15 offset:57344
    ds_read_b64_tr_b16 a[254:255], v15 offset:58368
    s_waitcnt lgkmcnt(0)
    s_barrier
    s_cmp_eq_u32 s30, 2
    s_cbranch_scc1 .qv_466
    s_waitcnt vmcnt(16)
    s_barrier
    ds_read_b128 v[32:35], v17 offset:0
    ds_read_b128 v[36:39], v17 offset:16384
    ds_read_b128 v[40:43], v18 offset:0
    ds_read_b128 v[44:47], v18 offset:16384
    s_add_u32 m0, s29, 98304
    s_nop 0
    buffer_load_dwordx4 v16, s[16:19], s34 offen offset:0 lds
    ds_read_b128 v[48:51], v17 offset:1024
    ds_read_b128 v[52:55], v17 offset:17408
    s_branch .qe_469
.p2align 6
.ql_468:
.qe_469:
    s_waitcnt lgkmcnt(4)
    v_mfma_f32_16x16x32_bf16 v[64:67], a[0:3], v[32:35], 0
    ds_read_b128 v[56:59], v18 offset:1024
    s_add_u32 m0, s29, 99200
    v_mfma_f32_16x16x32_bf16 v[68:71], a[4:7], v[32:35], 0
    buffer_load_dwordx4 v16, s[16:19], s34 offen offset:128 lds
    v_mfma_f32_16x16x32_bf16 v[72:75], a[0:3], v[36:39], 0
    ds_read_b128 v[60:63], v18 offset:17408
    v_mfma_f32_16x16x32_bf16 v[76:79], a[4:7], v[36:39], 0
    s_waitcnt lgkmcnt(4)
    v_mfma_f32_16x16x32_bf16 v[64:67], a[8:11], v[40:43], v[64:67]
    ds_read_b128 v[32:35], v17 offset:2048
    v_mfma_f32_16x16x32_bf16 v[68:71], a[12:15], v[40:43], v[68:71]
    v_cvt_pk_bf16_f32 v96, v80, v81
    v_cvt_pk_bf16_f32 v97, v82, v83
    v_mfma_f32_16x16x32_bf16 v[72:75], a[8:11], v[44:47], v[72:75]
    ds_read_b128 v[36:39], v17 offset:18432
    v_mfma_f32_16x16x32_bf16 v[76:79], a[12:15], v[44:47], v[76:79]
    v_cvt_pk_bf16_f32 v98, v84, v85
    v_cvt_pk_bf16_f32 v99, v86, v87
    s_waitcnt lgkmcnt(4)
    v_mfma_f32_16x16x32_bf16 v[64:67], a[16:19], v[48:51], v[64:67]
    ds_read_b128 v[40:43], v18 offset:2048
    s_add_u32 m0, s29, 100096
    v_mfma_f32_16x16x32_bf16 v[68:71], a[20:23], v[48:51], v[68:71]
    buffer_load_dwordx4 v16, s[16:19], s34 offen offset:256 lds
    v_mfma_f32_16x16x32_bf16 v[72:75], a[16:19], v[52:55], v[72:75]
    ds_read_b128 v[44:47], v18 offset:18432
    v_mfma_f32_16x16x32_bf16 v[76:79], a[20:23], v[52:55], v[76:79]
    s_waitcnt lgkmcnt(4)
    v_mfma_f32_16x16x32_bf16 v[64:67], a[24:27], v[56:59], v[64:67]
    ds_read_b128 v[48:51], v17 offset:3072
    v_mfma_f32_16x16x32_bf16 v[68:71], a[28:31], v[56:59], v[68:71]
    buffer_store_dwordx4 v[96:99], v21, s[8:11], s32 offen sc1
    v_mfma_f32_16x16x32_bf16 v[72:75], a[24:27], v[60:63], v[72:75]
    ds_read_b128 v[52:55], v17 offset:19456
    v_mfma_f32_16x16x32_bf16 v[76:79], a[28:31], v[60:63], v[76:79]
    s_waitcnt lgkmcnt(4)
    v_mfma_f32_16x16x32_bf16 v[64:67], a[32:35], v[32:35], v[64:67]
    ds_read_b128 v[56:59], v18 offset:3072
    s_add_u32 m0, s29, 100992
    v_mfma_f32_16x16x32_bf16 v[68:71], a[36:39], v[32:35], v[68:71]
    buffer_load_dwordx4 v16, s[16:19], s34 offen offset:384 lds
    v_mfma_f32_16x16x32_bf16 v[72:75], a[32:35], v[36:39], v[72:75]
    ds_read_b128 v[60:63], v18 offset:19456
    v_mfma_f32_16x16x32_bf16 v[76:79], a[36:39], v[36:39], v[76:79]
    s_waitcnt lgkmcnt(4)
    v_mfma_f32_16x16x32_bf16 v[64:67], a[40:43], v[40:43], v[64:67]
    ds_read_b128 v[32:35], v17 offset:4096
    v_mfma_f32_16x16x32_bf16 v[68:71], a[44:47], v[40:43], v[68:71]
    v_cvt_pk_bf16_f32 v100, v88, v89
    v_cvt_pk_bf16_f32 v101, v90, v91
    v_mfma_f32_16x16x32_bf16 v[72:75], a[40:43], v[44:47], v[72:75]
    ds_read_b128 v[36:39], v17 offset:20480
    v_mfma_f32_16x16x32_bf16 v[76:79], a[44:47], v[44:47], v[76:79]
    v_cvt_pk_bf16_f32 v102, v92, v93
    v_cvt_pk_bf16_f32 v103, v94, v95
    s_waitcnt lgkmcnt(4)
    v_mfma_f32_16x16x32_bf16 v[64:67], a[48:51], v[48:51], v[64:67]
    ds_read_b128 v[40:43], v18 offset:4096
    s_add_u32 m0, s29, 101888
    v_mfma_f32_16x16x32_bf16 v[68:71], a[52:55], v[48:51], v[68:71]
    buffer_load_dwordx4 v16, s[16:19], s34 offen offset:512 lds
    v_mfma_f32_16x16x32_bf16 v[72:75], a[48:51], v[52:55], v[72:75]
    ds_read_b128 v[44:47], v18 offset:20480
    v_mfma_f32_16x16x32_bf16 v[76:79], a[52:55], v[52:55], v[76:79]
    s_waitcnt lgkmcnt(4)
    v_mfma_f32_16x16x32_bf16 v[64:67], a[56:59], v[56:59], v[64:67]
    ds_read_b128 v[48:51], v17 offset:5120
    v_mfma_f32_16x16x32_bf16 v[68:71], a[60:63], v[56:59], v[68:71]
    buffer_store_dwordx4 v[100:103], v21, s[8:11], s38 offen sc1
    v_mfma_f32_16x16x32_bf16 v[72:75], a[56:59], v[60:63], v[72:75]
    ds_read_b128 v[52:55], v17 offset:21504
    v_mfma_f32_16x16x32_bf16 v[76:79], a[60:63], v[60:63], v[76:79]
    s_waitcnt lgkmcnt(4)
    v_mfma_f32_16x16x32_bf16 v[64:67], a[64:67], v[32:35], v[64:67]
    ds_read_b128 v[56:59], v18 offset:5120
    s_add_u32 m0, s29, 102784
    v_mfma_f32_16x16x32_bf16 v[68:71], a[68:71], v[32:35], v[68:71]
    buffer_load_dwordx4 v16, s[16:19], s34 offen offset:640 lds
    v_mfma_f32_16x16x32_bf16 v[72:75], a[64:67], v[36:39], v[72:75]
    ds_read_b128 v[60:63], v18 offset:21504
    v_mfma_f32_16x16x32_bf16 v[76:79], a[68:71], v[36:39], v[76:79]
    s_waitcnt lgkmcnt(4)
    v_mfma_f32_16x16x32_bf16 v[64:67], a[72:75], v[40:43], v[64:67]
    ds_read_b128 v[32:35], v17 offset:6144
    v_mfma_f32_16x16x32_bf16 v[68:71], a[76:79], v[40:43], v[68:71]
    s_mov_b32 s32, s39
    s_add_u32 s38, s39, 4096
    s_add_u32 s39, s39, 262144
    v_mfma_f32_16x16x32_bf16 v[72:75], a[72:75], v[44:47], v[72:75]
    ds_read_b128 v[36:39], v17 offset:22528
    v_mfma_f32_16x16x32_bf16 v[76:79], a[76:79], v[44:47], v[76:79]
    v_add_u32 v23, 1, v23
    s_waitcnt lgkmcnt(4)
    v_mfma_f32_16x16x32_bf16 v[64:67], a[80:83], v[48:51], v[64:67]
    ds_read_b128 v[40:43], v18 offset:6144
    s_add_u32 m0, s29, 103680
    v_mfma_f32_16x16x32_bf16 v[68:71], a[84:87], v[48:51], v[68:71]
    buffer_load_dwordx4 v16, s[16:19], s34 offen offset:768 lds
    v_mfma_f32_16x16x32_bf16 v[72:75], a[80:83], v[52:55], v[72:75]
    ds_read_b128 v[44:47], v18 offset:22528
    v_mfma_f32_16x16x32_bf16 v[76:79], a[84:87], v[52:55], v[76:79]
    s_waitcnt lgkmcnt(4)
    v_mfma_f32_16x16x32_bf16 v[64:67], a[88:91], v[56:59], v[64:67]
    ds_read_b128 v[48:51], v17 offset:7168
    v_mfma_f32_16x16x32_bf16 v[68:71], a[92:95], v[56:59], v[68:71]
    v_mfma_f32_16x16x32_bf16 v[72:75], a[88:91], v[60:63], v[72:75]
    ds_read_b128 v[52:55], v17 offset:23552
    v_mfma_f32_16x16x32_bf16 v[76:79], a[92:95], v[60:63], v[76:79]
    s_mov_b64 exec, s[44:45]
    buffer_store_dwordx4 v[24:27], v28, s[8:11], s46 offen sc1
    s_mov_b64 exec, -1
    s_waitcnt lgkmcnt(4)
    v_mfma_f32_16x16x32_bf16 v[64:67], a[96:99], v[32:35], v[64:67]
    ds_read_b128 v[56:59], v18 offset:7168
    s_add_u32 m0, s29, 104576
    v_mfma_f32_16x16x32_bf16 v[68:71], a[100:103], v[32:35], v[68:71]
    buffer_load_dwordx4 v16, s[16:19], s34 offen offset:896 lds
    v_mfma_f32_16x16x32_bf16 v[72:75], a[96:99], v[36:39], v[72:75]
    ds_read_b128 v[60:63], v18 offset:23552
    v_mfma_f32_16x16x32_bf16 v[76:79], a[100:103], v[36:39], v[76:79]
    s_waitcnt lgkmcnt(4)
    v_mfma_f32_16x16x32_bf16 v[64:67], a[104:107], v[40:43], v[64:67]
    s_add_u32 s34, s34, 64512
    s_min_u32 s34, s34, 4128768
    v_mfma_f32_16x16x32_bf16 v[68:71], a[108:111], v[40:43], v[68:71]
    v_mfma_f32_16x16x32_bf16 v[72:75], a[104:107], v[44:47], v[72:75]
    v_mfma_f32_16x16x32_bf16 v[76:79], a[108:111], v[44:47], v[76:79]
    s_waitcnt lgkmcnt(0)
    s_waitcnt vmcnt(18)
    s_barrier
    ds_read_b128 v[32:35], v17 offset:32768
    ds_read_b128 v[36:39], v17 offset:49152
    v_mfma_f32_16x16x32_bf16 v[64:67], a[112:115], v[48:51], v[64:67]
    ds_read_b128 v[40:43], v18 offset:32768
    s_add_u32 m0, s29, 0
    v_mfma_f32_16x16x32_bf16 v[68:71], a[116:119], v[48:51], v[68:71]
    buffer_load_dwordx4 v16, s[16:19], s34 offen offset:0 lds
    v_mfma_f32_16x16x32_bf16 v[72:75], a[112:115], v[52:55], v[72:75]
    ds_read_b128 v[44:47], v18 offset:49152
    v_mfma_f32_16x16x32_bf16 v[76:79], a[116:119], v[52:55], v[76:79]
    v_mfma_f32_16x16x32_bf16 v[64:67], a[120:123], v[56:59], v[64:67]
    ds_read_b128 v[48:51], v17 offset:33792
    v_mfma_f32_16x16x32_bf16 v[68:71], a[124:127], v[56:59], v[68:71]
    v_mfma_f32_16x16x32_bf16 v[72:75], a[120:123], v[60:63], v[72:75]
    ds_read_b128 v[52:55], v17 offset:50176
    v_mfma_f32_16x16x32_bf16 v[76:79], a[124:127], v[60:63], v[76:79]
    s_waitcnt lgkmcnt(4)
    v_mfma_f32_16x16x32_bf16 v[64:67], a[128:131], v[32:35], v[64:67]
    ds_read_b128 v[56:59], v18 offset:33792
    s_add_u32 m0, s29, 896
    v_mfma_f32_16x16x32_bf16 v[68:71], a[132:135], v[32:35], v[68:71]
    buffer_load_dwordx4 v16, s[16:19], s34 offen offset:128 lds
    v_mfma_f32_16x16x32_bf16 v[72:75], a[128:131], v[36:39], v[72:75]
    ds_read_b128 v[60:63], v18 offset:50176
    v_mfma_f32_16x16x32_bf16 v[76:79], a[132:135], v[36:39], v[76:79]
    s_waitcnt lgkmcnt(4)
    v_mfma_f32_16x16x32_bf16 v[64:67], a[136:139], v[40:43], v[64:67]
    ds_read_b128 v[32:35], v17 offset:34816
    v_mfma_f32_16x16x32_bf16 v[68:71], a[140:143], v[40:43], v[68:71]
    v_mfma_f32_16x16x32_bf16 v[72:75], a[136:139], v[44:47], v[72:75]
    ds_read_b128 v[36:39], v17 offset:51200
    v_mfma_f32_16x16x32_bf16 v[76:79], a[140:143], v[44:47], v[76:79]
    s_waitcnt lgkmcnt(4)
    v_mfma_f32_16x16x32_bf16 v[64:67], a[144:147], v[48:51], v[64:67]
    ds_read_b128 v[40:43], v18 offset:34816
    s_add_u32 m0, s29, 1792
    v_mfma_f32_16x16x32_bf16 v[68:71], a[148:151], v[48:51], v[68:71]
    buffer_load_dwordx4 v16, s[16:19], s34 offen offset:256 lds
    v_mfma_f32_16x16x32_bf16 v[72:75], a[144:147], v[52:55], v[72:75]
    ds_read_b128 v[44:47], v18 offset:51200
    v_mfma_f32_16x16x32_bf16 v[76:79], a[148:151], v[52:55], v[76:79]
    s_waitcnt lgkmcnt(4)
    v_mfma_f32_16x16x32_bf16 v[64:67], a[152:155], v[56:59], v[64:67]
    ds_read_b128 v[48:51], v17 offset:35840
    v_mfma_f32_16x16x32_bf16 v[68:71], a[156:159], v[56:59], v[68:71]
    v_mfma_f32_16x16x32_bf16 v[72:75], a[152:155], v[60:63], v[72:75]
    ds_read_b128 v[52:55], v17 offset:52224
    v_mfma_f32_16x16x32_bf16 v[76:79], a[156:159], v[60:63], v[76:79]
    s_waitcnt lgkmcnt(4)
    v_mfma_f32_16x16x32_bf16 v[64:67], a[160:163], v[32:35], v[64:67]
    ds_read_b128 v[56:59], v18 offset:35840
    s_add_u32 m0, s29, 2688
    v_mfma_f32_16x16x32_bf16 v[68:71], a[164:167], v[32:35], v[68:71]
    buffer_load_dwordx4 v16, s[16:19], s34 offen offset:384 lds
    v_mfma_f32_16x16x32_bf16 v[72:75], a[160:163], v[36:39], v[72:75]
    ds_read_b128 v[60:63], v18 offset:52224
    v_mfma_f32_16x16x32_bf16 v[76:79], a[164:167], v[36:39], v[76:79]
    s_waitcnt lgkmcnt(4)
    v_mfma_f32_16x16x32_bf16 v[64:67], a[168:171], v[40:43], v[64:67]
    ds_read_b128 v[32:35], v17 offset:36864
    v_mfma_f32_16x16x32_bf16 v[68:71], a[172:175], v[40:43], v[68:71]
    v_mfma_f32_16x16x32_bf16 v[72:75], a[168:171], v[44:47], v[72:75]
    ds_read_b128 v[36:39], v17 offset:53248
    v_mfma_f32_16x16x32_bf16 v[76:79], a[172:175], v[44:47], v[76:79]
    s_waitcnt lgkmcnt(4)
    v_mfma_f32_16x16x32_bf16 v[64:67], a[176:179], v[48:51], v[64:67]
    ds_read_b128 v[40:43], v18 offset:36864
    s_add_u32 m0, s29, 3584
    v_mfma_f32_16x16x32_bf16 v[68:71], a[180:183], v[48:51], v[68:71]
    buffer_load_dwordx4 v16, s[16:19], s34 offen offset:512 lds
    v_mfma_f32_16x16x32_bf16 v[72:75], a[176:179], v[52:55], v[72:75]
    ds_read_b128 v[44:47], v18 offset:53248
    v_mfma_f32_16x16x32_bf16 v[76:79], a[180:183], v[52:55], v[76:79]
    s_waitcnt lgkmcnt(4)
    v_mfma_f32_16x16x32_bf16 v[64:67], a[184:187], v[56:59], v[64:67]
    ds_read_b128 v[48:51], v17 offset:37888
    v_mfma_f32_16x16x32_bf16 v[68:71], a[188:191], v[56:59], v[68:71]
    v_mfma_f32_16x16x32_bf16 v[72:75], a[184:187], v[60:63], v[72:75]
    ds_read_b128 v[52:55], v17 offset:54272
    v_mfma_f32_16x16x32_bf16 v[76:79], a[188:191], v[60:63], v[76:79]
    s_waitcnt lgkmcnt(4)
    v_mfma_f32_16x16x32_bf16 v[64:67], a[192:195], v[32:35], v[64:67]
    ds_read_b128 v[56:59], v18 offset:37888
    s_add_u32 m0, s29, 4480
    v_mfma_f32_16x16x32_bf16 v[68:71], a[196:199], v[32:35], v[68:71]
    buffer_load_dwordx4 v16, s[16:19], s34 offen offset:640 lds
    v_mfma_f32_16x16x32_bf16 v[72:75], a[192:195], v[36:39], v[72:75]
    ds_read_b128 v[60:63], v18 offset:54272
    v_mfma_f32_16x16x32_bf16 v[76:79], a[196:199], v[36:39], v[76:79]
    s_waitcnt lgkmcnt(4)
    v_mfma_f32_16x16x32_bf16 v[64:67], a[200:203], v[40:43], v[64:67]
    ds_read_b128 v[32:35], v17 offset:38912
    v_mfma_f32_16x16x32_bf16 v[68:71], a[204:207], v[40:43], v[68:71]
    v_mfma_f32_16x16x32_bf16 v[72:75], a[200:203], v[44:47], v[72:75]
    ds_read_b128 v[36:39], v17 offset:55296
    v_mfma_f32_16x16x32_bf16 v[76:79], a[204:207], v[44:47], v[76:79]
    s_waitcnt lgkmcnt(4)
    v_mfma_f32_16x16x32_bf16 v[64:67], a[208:211], v[48:51], v[64:67]
    ds_read_b128 v[40:43], v18 offset:38912
    s_add_u32 m0, s29, 5376
    v_mfma_f32_16x16x32_bf16 v[68:71], a[212:215], v[48:51], v[68:71]
    buffer_load_dwordx4 v16, s[16:19], s34 offen offset:768 lds
    v_mfma_f32_16x16x32_bf16 v[72:75], a[208:211], v[52:55], v[72:75]
    ds_read_b128 v[44:47], v18 offset:55296
    v_mfma_f32_16x16x32_bf16 v[76:79], a[212:215], v[52:55], v[76:79]
    s_waitcnt lgkmcnt(4)
    v_mfma_f32_16x16x32_bf16 v[64:67], a[216:219], v[56:59], v[64:67]
    ds_read_b128 v[48:51], v17 offset:39936
    v_mfma_f32_16x16x32_bf16 v[68:71], a[220:223], v[56:59], v[68:71]
    v_mfma_f32_16x16x32_bf16 v[72:75], a[216:219], v[60:63], v[72:75]
    ds_read_b128 v[52:55], v17 offset:56320
    v_mfma_f32_16x16x32_bf16 v[76:79], a[220:223], v[60:63], v[76:79]
    s_mov_b64 exec, s[44:45]
    buffer_store_dwordx4 v[24:27], v29, s[8:11], s46 offen sc1
    s_mov_b64 exec, -1
    s_waitcnt lgkmcnt(4)
    v_mfma_f32_16x16x32_bf16 v[64:67], a[224:227], v[32:35], v[64:67]
    ds_read_b128 v[56:59], v18 offset:39936
    s_add_u32 m0, s29, 6272
    v_mfma_f32_16x16x32_bf16 v[68:71], a[228:231], v[32:35], v[68:71]
    buffer_load_dwordx4 v16, s[16:19], s34 offen offset:896 lds
    v_mfma_f32_16x16x32_bf16 v[72:75], a[224:227], v[36:39], v[72:75]
    ds_read_b128 v[60:63], v18 offset:56320
    v_mfma_f32_16x16x32_bf16 v[76:79], a[228:231], v[36:39], v[76:79]
    s_waitcnt lgkmcnt(4)
    v_mfma_f32_16x16x32_bf16 v[64:67], a[232:235], v[40:43], v[64:67]
    s_add_u32 s34, s34, 1024
    v_mfma_f32_16x16x32_bf16 v[68:71], a[236:239], v[40:43], v[68:71]
    v_mfma_f32_16x16x32_bf16 v[72:75], a[232:235], v[44:47], v[72:75]
    v_mfma_f32_16x16x32_bf16 v[76:79], a[236:239], v[44:47], v[76:79]
    s_waitcnt lgkmcnt(0)
    s_waitcnt vmcnt(11)
    s_barrier
    ds_read_b128 v[32:35], v19 offset:0
    ds_read_b128 v[36:39], v19 offset:16384
    v_mfma_f32_16x16x32_bf16 v[64:67], a[240:243], v[48:51], v[64:67]
    ds_read_b128 v[40:43], v20 offset:0
    s_add_u32 m0, s29, 32768
    v_mfma_f32_16x16x32_bf16 v[68:71], a[244:247], v[48:51], v[68:71]
    buffer_load_dwordx4 v16, s[16:19], s34 offen offset:0 lds
    v_mfma_f32_16x16x32_bf16 v[72:75], a[240:243], v[52:55], v[72:75]
    ds_read_b128 v[44:47], v20 offset:16384
    v_mfma_f32_16x16x32_bf16 v[76:79], a[244:247], v[52:55], v[76:79]
    v_mfma_f32_16x16x32_bf16 v[64:67], a[248:251], v[56:59], v[64:67]
    ds_read_b128 v[48:51], v19 offset:1024
    v_mfma_f32_16x16x32_bf16 v[68:71], a[252:255], v[56:59], v[68:71]
    v_mfma_f32_16x16x32_bf16 v[72:75], a[248:251], v[60:63], v[72:75]
    ds_read_b128 v[52:55], v19 offset:17408
    v_mfma_f32_16x16x32_bf16 v[76:79], a[252:255], v[60:63], v[76:79]
    s_mov_b64 exec, s[36:37]
    buffer_store_dword v23, v22, s[8:11], s33 offen sc1
    s_mov_b64 exec, -1

    s_waitcnt lgkmcnt(4)
    v_mfma_f32_16x16x32_bf16 v[80:83], a[0:3], v[32:35], 0
    ds_read_b128 v[56:59], v20 offset:1024
    s_add_u32 m0, s29, 33664
    v_mfma_f32_16x16x32_bf16 v[84:87], a[4:7], v[32:35], 0
    buffer_load_dwordx4 v16, s[16:19], s34 offen offset:128 lds
    v_mfma_f32_16x16x32_bf16 v[88:91], a[0:3], v[36:39], 0
    ds_read_b128 v[60:63], v20 offset:17408
    v_mfma_f32_16x16x32_bf16 v[92:95], a[4:7], v[36:39], 0
    s_waitcnt lgkmcnt(4)
    v_mfma_f32_16x16x32_bf16 v[80:83], a[8:11], v[40:43], v[80:83]
    ds_read_b128 v[32:35], v19 offset:2048
    v_mfma_f32_16x16x32_bf16 v[84:87], a[12:15], v[40:43], v[84:87]
    v_cvt_pk_bf16_f32 v96, v64, v65
    v_cvt_pk_bf16_f32 v97, v66, v67
    v_mfma_f32_16x16x32_bf16 v[88:91], a[8:11], v[44:47], v[88:91]
    ds_read_b128 v[36:39], v19 offset:18432
    v_mfma_f32_16x16x32_bf16 v[92:95], a[12:15], v[44:47], v[92:95]
    v_cvt_pk_bf16_f32 v98, v68, v69
    v_cvt_pk_bf16_f32 v99, v70, v71
    s_waitcnt lgkmcnt(4)
    v_mfma_f32_16x16x32_bf16 v[80:83], a[16:19], v[48:51], v[80:83]
    ds_read_b128 v[40:43], v20 offset:2048
    s_add_u32 m0, s29, 34560
    v_mfma_f32_16x16x32_bf16 v[84:87], a[20:23], v[48:51], v[84:87]
    buffer_load_dwordx4 v16, s[16:19], s34 offen offset:256 lds
    v_mfma_f32_16x16x32_bf16 v[88:91], a[16:19], v[52:55], v[88:91]
    ds_read_b128 v[44:47], v20 offset:18432
    v_mfma_f32_16x16x32_bf16 v[92:95], a[20:23], v[52:55], v[92:95]
    s_waitcnt lgkmcnt(4)
    v_mfma_f32_16x16x32_bf16 v[80:83], a[24:27], v[56:59], v[80:83]
    ds_read_b128 v[48:51], v19 offset:3072
    v_mfma_f32_16x16x32_bf16 v[84:87], a[28:31], v[56:59], v[84:87]
    buffer_store_dwordx4 v[96:99], v21, s[8:11], s32 offen sc1
    v_mfma_f32_16x16x32_bf16 v[88:91], a[24:27], v[60:63], v[88:91]
    ds_read_b128 v[52:55], v19 offset:19456
    v_mfma_f32_16x16x32_bf16 v[92:95], a[28:31], v[60:63], v[92:95]
    s_waitcnt lgkmcnt(4)
    v_mfma_f32_16x16x32_bf16 v[80:83], a[32:35], v[32:35], v[80:83]
    ds_read_b128 v[56:59], v20 offset:3072
    s_add_u32 m0, s29, 35456
    v_mfma_f32_16x16x32_bf16 v[84:87], a[36:39], v[32:35], v[84:87]
    buffer_load_dwordx4 v16, s[16:19], s34 offen offset:384 lds
    v_mfma_f32_16x16x32_bf16 v[88:91], a[32:35], v[36:39], v[88:91]
    ds_read_b128 v[60:63], v20 offset:19456
    v_mfma_f32_16x16x32_bf16 v[92:95], a[36:39], v[36:39], v[92:95]
    s_waitcnt lgkmcnt(4)
    v_mfma_f32_16x16x32_bf16 v[80:83], a[40:43], v[40:43], v[80:83]
    ds_read_b128 v[32:35], v19 offset:4096
    v_mfma_f32_16x16x32_bf16 v[84:87], a[44:47], v[40:43], v[84:87]
    v_cvt_pk_bf16_f32 v100, v72, v73
    v_cvt_pk_bf16_f32 v101, v74, v75
    v_mfma_f32_16x16x32_bf16 v[88:91], a[40:43], v[44:47], v[88:91]
    ds_read_b128 v[36:39], v19 offset:20480
    v_mfma_f32_16x16x32_bf16 v[92:95], a[44:47], v[44:47], v[92:95]
    v_cvt_pk_bf16_f32 v102, v76, v77
    v_cvt_pk_bf16_f32 v103, v78, v79
    s_waitcnt lgkmcnt(4)
    v_mfma_f32_16x16x32_bf16 v[80:83], a[48:51], v[48:51], v[80:83]
    ds_read_b128 v[40:43], v20 offset:4096
    s_add_u32 m0, s29, 36352
    v_mfma_f32_16x16x32_bf16 v[84:87], a[52:55], v[48:51], v[84:87]
    buffer_load_dwordx4 v16, s[16:19], s34 offen offset:512 lds
    v_mfma_f32_16x16x32_bf16 v[88:91], a[48:51], v[52:55], v[88:91]
    ds_read_b128 v[44:47], v20 offset:20480
    v_mfma_f32_16x16x32_bf16 v[92:95], a[52:55], v[52:55], v[92:95]
    s_waitcnt lgkmcnt(4)
    v_mfma_f32_16x16x32_bf16 v[80:83], a[56:59], v[56:59], v[80:83]
    ds_read_b128 v[48:51], v19 offset:5120
    v_mfma_f32_16x16x32_bf16 v[84:87], a[60:63], v[56:59], v[84:87]
    buffer_store_dwordx4 v[100:103], v21, s[8:11], s38 offen sc1
    v_mfma_f32_16x16x32_bf16 v[88:91], a[56:59], v[60:63], v[88:91]
    ds_read_b128 v[52:55], v19 offset:21504
    v_mfma_f32_16x16x32_bf16 v[92:95], a[60:63], v[60:63], v[92:95]
    s_waitcnt lgkmcnt(4)
    v_mfma_f32_16x16x32_bf16 v[80:83], a[64:67], v[32:35], v[80:83]
    ds_read_b128 v[56:59], v20 offset:5120
    s_add_u32 m0, s29, 37248
    v_mfma_f32_16x16x32_bf16 v[84:87], a[68:71], v[32:35], v[84:87]
    buffer_load_dwordx4 v16, s[16:19], s34 offen offset:640 lds
    v_mfma_f32_16x16x32_bf16 v[88:91], a[64:67], v[36:39], v[88:91]
    ds_read_b128 v[60:63], v20 offset:21504
    v_mfma_f32_16x16x32_bf16 v[92:95], a[68:71], v[36:39], v[92:95]
    s_waitcnt lgkmcnt(4)
    v_mfma_f32_16x16x32_bf16 v[80:83], a[72:75], v[40:43], v[80:83]
    ds_read_b128 v[32:35], v19 offset:6144
    v_mfma_f32_16x16x32_bf16 v[84:87], a[76:79], v[40:43], v[84:87]
    s_mov_b32 s32, s39
    s_add_u32 s38, s39, 4096
    s_add_u32 s39, s39, 262144
    v_mfma_f32_16x16x32_bf16 v[88:91], a[72:75], v[44:47], v[88:91]
    ds_read_b128 v[36:39], v19 offset:22528
    v_mfma_f32_16x16x32_bf16 v[92:95], a[76:79], v[44:47], v[92:95]
    v_add_u32 v23, 1, v23
    s_waitcnt lgkmcnt(4)
    v_mfma_f32_16x16x32_bf16 v[80:83], a[80:83], v[48:51], v[80:83]
    ds_read_b128 v[40:43], v20 offset:6144
    s_add_u32 m0, s29, 38144
    v_mfma_f32_16x16x32_bf16 v[84:87], a[84:87], v[48:51], v[84:87]
    buffer_load_dwordx4 v16, s[16:19], s34 offen offset:768 lds
    v_mfma_f32_16x16x32_bf16 v[88:91], a[80:83], v[52:55], v[88:91]
    ds_read_b128 v[44:47], v20 offset:22528
    v_mfma_f32_16x16x32_bf16 v[92:95], a[84:87], v[52:55], v[92:95]
    s_waitcnt lgkmcnt(4)
    v_mfma_f32_16x16x32_bf16 v[80:83], a[88:91], v[56:59], v[80:83]
    ds_read_b128 v[48:51], v19 offset:7168
    v_mfma_f32_16x16x32_bf16 v[84:87], a[92:95], v[56:59], v[84:87]
    v_mfma_f32_16x16x32_bf16 v[88:91], a[88:91], v[60:63], v[88:91]
    ds_read_b128 v[52:55], v19 offset:23552
    v_mfma_f32_16x16x32_bf16 v[92:95], a[92:95], v[60:63], v[92:95]
    s_mov_b64 exec, s[44:45]
    buffer_store_dwordx4 v[24:27], v30, s[8:11], s46 offen sc1
    s_mov_b64 exec, -1
    s_waitcnt lgkmcnt(4)
    v_mfma_f32_16x16x32_bf16 v[80:83], a[96:99], v[32:35], v[80:83]
    ds_read_b128 v[56:59], v20 offset:7168
    s_add_u32 m0, s29, 39040
    v_mfma_f32_16x16x32_bf16 v[84:87], a[100:103], v[32:35], v[84:87]
    buffer_load_dwordx4 v16, s[16:19], s34 offen offset:896 lds
    v_mfma_f32_16x16x32_bf16 v[88:91], a[96:99], v[36:39], v[88:91]
    ds_read_b128 v[60:63], v20 offset:23552
    v_mfma_f32_16x16x32_bf16 v[92:95], a[100:103], v[36:39], v[92:95]
    s_waitcnt lgkmcnt(4)
    v_mfma_f32_16x16x32_bf16 v[80:83], a[104:107], v[40:43], v[80:83]
    s_add_u32 s34, s34, 64512
    s_min_u32 s34, s34, 4128768
    v_mfma_f32_16x16x32_bf16 v[84:87], a[108:111], v[40:43], v[84:87]
    v_mfma_f32_16x16x32_bf16 v[88:91], a[104:107], v[44:47], v[88:91]
    v_mfma_f32_16x16x32_bf16 v[92:95], a[108:111], v[44:47], v[92:95]
    s_waitcnt lgkmcnt(0)
    s_waitcnt vmcnt(18)
    s_barrier
    ds_read_b128 v[32:35], v19 offset:32768
    ds_read_b128 v[36:39], v19 offset:49152
    v_mfma_f32_16x16x32_bf16 v[80:83], a[112:115], v[48:51], v[80:83]
    ds_read_b128 v[40:43], v20 offset:32768
    s_add_u32 m0, s29, 65536
    v_mfma_f32_16x16x32_bf16 v[84:87], a[116:119], v[48:51], v[84:87]
    buffer_load_dwordx4 v16, s[16:19], s34 offen offset:0 lds
    v_mfma_f32_16x16x32_bf16 v[88:91], a[112:115], v[52:55], v[88:91]
    ds_read_b128 v[44:47], v20 offset:49152
    v_mfma_f32_16x16x32_bf16 v[92:95], a[116:119], v[52:55], v[92:95]
    v_mfma_f32_16x16x32_bf16 v[80:83], a[120:123], v[56:59], v[80:83]
    ds_read_b128 v[48:51], v19 offset:33792
    v_mfma_f32_16x16x32_bf16 v[84:87], a[124:127], v[56:59], v[84:87]
    v_mfma_f32_16x16x32_bf16 v[88:91], a[120:123], v[60:63], v[88:91]
    ds_read_b128 v[52:55], v19 offset:50176
    v_mfma_f32_16x16x32_bf16 v[92:95], a[124:127], v[60:63], v[92:95]
    s_waitcnt lgkmcnt(4)
    v_mfma_f32_16x16x32_bf16 v[80:83], a[128:131], v[32:35], v[80:83]
    ds_read_b128 v[56:59], v20 offset:33792
    s_add_u32 m0, s29, 66432
    v_mfma_f32_16x16x32_bf16 v[84:87], a[132:135], v[32:35], v[84:87]
    buffer_load_dwordx4 v16, s[16:19], s34 offen offset:128 lds
    v_mfma_f32_16x16x32_bf16 v[88:91], a[128:131], v[36:39], v[88:91]
    ds_read_b128 v[60:63], v20 offset:50176
    v_mfma_f32_16x16x32_bf16 v[92:95], a[132:135], v[36:39], v[92:95]
    s_waitcnt lgkmcnt(4)
    v_mfma_f32_16x16x32_bf16 v[80:83], a[136:139], v[40:43], v[80:83]
    ds_read_b128 v[32:35], v19 offset:34816
    v_mfma_f32_16x16x32_bf16 v[84:87], a[140:143], v[40:43], v[84:87]
    v_mfma_f32_16x16x32_bf16 v[88:91], a[136:139], v[44:47], v[88:91]
    ds_read_b128 v[36:39], v19 offset:51200
    v_mfma_f32_16x16x32_bf16 v[92:95], a[140:143], v[44:47], v[92:95]
    s_waitcnt lgkmcnt(4)
    v_mfma_f32_16x16x32_bf16 v[80:83], a[144:147], v[48:51], v[80:83]
    ds_read_b128 v[40:43], v20 offset:34816
    s_add_u32 m0, s29, 67328
    v_mfma_f32_16x16x32_bf16 v[84:87], a[148:151], v[48:51], v[84:87]
    buffer_load_dwordx4 v16, s[16:19], s34 offen offset:256 lds
    v_mfma_f32_16x16x32_bf16 v[88:91], a[144:147], v[52:55], v[88:91]
    ds_read_b128 v[44:47], v20 offset:51200
    v_mfma_f32_16x16x32_bf16 v[92:95], a[148:151], v[52:55], v[92:95]
    s_waitcnt lgkmcnt(4)
    v_mfma_f32_16x16x32_bf16 v[80:83], a[152:155], v[56:59], v[80:83]
    ds_read_b128 v[48:51], v19 offset:35840
    v_mfma_f32_16x16x32_bf16 v[84:87], a[156:159], v[56:59], v[84:87]
    v_mfma_f32_16x16x32_bf16 v[88:91], a[152:155], v[60:63], v[88:91]
    ds_read_b128 v[52:55], v19 offset:52224
    v_mfma_f32_16x16x32_bf16 v[92:95], a[156:159], v[60:63], v[92:95]
    s_waitcnt lgkmcnt(4)
    v_mfma_f32_16x16x32_bf16 v[80:83], a[160:163], v[32:35], v[80:83]
    ds_read_b128 v[56:59], v20 offset:35840
    s_add_u32 m0, s29, 68224
    v_mfma_f32_16x16x32_bf16 v[84:87], a[164:167], v[32:35], v[84:87]
    buffer_load_dwordx4 v16, s[16:19], s34 offen offset:384 lds
    v_mfma_f32_16x16x32_bf16 v[88:91], a[160:163], v[36:39], v[88:91]
    ds_read_b128 v[60:63], v20 offset:52224
    v_mfma_f32_16x16x32_bf16 v[92:95], a[164:167], v[36:39], v[92:95]
    s_waitcnt lgkmcnt(4)
    v_mfma_f32_16x16x32_bf16 v[80:83], a[168:171], v[40:43], v[80:83]
    ds_read_b128 v[32:35], v19 offset:36864
    v_mfma_f32_16x16x32_bf16 v[84:87], a[172:175], v[40:43], v[84:87]
    v_mfma_f32_16x16x32_bf16 v[88:91], a[168:171], v[44:47], v[88:91]
    ds_read_b128 v[36:39], v19 offset:53248
    v_mfma_f32_16x16x32_bf16 v[92:95], a[172:175], v[44:47], v[92:95]
    s_waitcnt lgkmcnt(4)
    v_mfma_f32_16x16x32_bf16 v[80:83], a[176:179], v[48:51], v[80:83]
    ds_read_b128 v[40:43], v20 offset:36864
    s_add_u32 m0, s29, 69120
    v_mfma_f32_16x16x32_bf16 v[84:87], a[180:183], v[48:51], v[84:87]
    buffer_load_dwordx4 v16, s[16:19], s34 offen offset:512 lds
    v_mfma_f32_16x16x32_bf16 v[88:91], a[176:179], v[52:55], v[88:91]
    ds_read_b128 v[44:47], v20 offset:53248
    v_mfma_f32_16x16x32_bf16 v[92:95], a[180:183], v[52:55], v[92:95]
    s_waitcnt lgkmcnt(4)
    v_mfma_f32_16x16x32_bf16 v[80:83], a[184:187], v[56:59], v[80:83]
    ds_read_b128 v[48:51], v19 offset:37888
    v_mfma_f32_16x16x32_bf16 v[84:87], a[188:191], v[56:59], v[84:87]
    v_mfma_f32_16x16x32_bf16 v[88:91], a[184:187], v[60:63], v[88:91]
    ds_read_b128 v[52:55], v19 offset:54272
    v_mfma_f32_16x16x32_bf16 v[92:95], a[188:191], v[60:63], v[92:95]
    s_waitcnt lgkmcnt(4)
    v_mfma_f32_16x16x32_bf16 v[80:83], a[192:195], v[32:35], v[80:83]
    ds_read_b128 v[56:59], v20 offset:37888
    s_add_u32 m0, s29, 70016
    v_mfma_f32_16x16x32_bf16 v[84:87], a[196:199], v[32:35], v[84:87]
    buffer_load_dwordx4 v16, s[16:19], s34 offen offset:640 lds
    v_mfma_f32_16x16x32_bf16 v[88:91], a[192:195], v[36:39], v[88:91]
    ds_read_b128 v[60:63], v20 offset:54272
    v_mfma_f32_16x16x32_bf16 v[92:95], a[196:199], v[36:39], v[92:95]
    s_waitcnt lgkmcnt(4)
    v_mfma_f32_16x16x32_bf16 v[80:83], a[200:203], v[40:43], v[80:83]
    ds_read_b128 v[32:35], v19 offset:38912
    v_mfma_f32_16x16x32_bf16 v[84:87], a[204:207], v[40:43], v[84:87]
    v_mfma_f32_16x16x32_bf16 v[88:91], a[200:203], v[44:47], v[88:91]
    ds_read_b128 v[36:39], v19 offset:55296
    v_mfma_f32_16x16x32_bf16 v[92:95], a[204:207], v[44:47], v[92:95]
    s_waitcnt lgkmcnt(4)
    v_mfma_f32_16x16x32_bf16 v[80:83], a[208:211], v[48:51], v[80:83]
    ds_read_b128 v[40:43], v20 offset:38912
    s_add_u32 m0, s29, 70912
    v_mfma_f32_16x16x32_bf16 v[84:87], a[212:215], v[48:51], v[84:87]
    buffer_load_dwordx4 v16, s[16:19], s34 offen offset:768 lds
    v_mfma_f32_16x16x32_bf16 v[88:91], a[208:211], v[52:55], v[88:91]
    ds_read_b128 v[44:47], v20 offset:55296
    v_mfma_f32_16x16x32_bf16 v[92:95], a[212:215], v[52:55], v[92:95]
    s_waitcnt lgkmcnt(4)
    v_mfma_f32_16x16x32_bf16 v[80:83], a[216:219], v[56:59], v[80:83]
    ds_read_b128 v[48:51], v19 offset:39936
    v_mfma_f32_16x16x32_bf16 v[84:87], a[220:223], v[56:59], v[84:87]
    s_cmp_lt_u32 s35, 21
    s_cselect_b64 s[44:45], -1, 0
    v_mfma_f32_16x16x32_bf16 v[88:91], a[216:219], v[60:63], v[88:91]
    ds_read_b128 v[52:55], v19 offset:56320
    v_mfma_f32_16x16x32_bf16 v[92:95], a[220:223], v[60:63], v[92:95]
    s_cselect_b32 s4, 0x10000, 0
    s_add_u32 s46, s46, s4
    s_waitcnt lgkmcnt(4)
    v_mfma_f32_16x16x32_bf16 v[80:83], a[224:227], v[32:35], v[80:83]
    ds_read_b128 v[56:59], v20 offset:39936
    s_add_u32 m0, s29, 71808
    v_mfma_f32_16x16x32_bf16 v[84:87], a[228:231], v[32:35], v[84:87]
    buffer_load_dwordx4 v16, s[16:19], s34 offen offset:896 lds
    v_mfma_f32_16x16x32_bf16 v[88:91], a[224:227], v[36:39], v[88:91]
    ds_read_b128 v[60:63], v20 offset:56320
    v_mfma_f32_16x16x32_bf16 v[92:95], a[228:231], v[36:39], v[92:95]
    s_waitcnt lgkmcnt(4)
    v_mfma_f32_16x16x32_bf16 v[80:83], a[232:235], v[40:43], v[80:83]
    s_add_u32 s34, s34, 1024
    v_mfma_f32_16x16x32_bf16 v[84:87], a[236:239], v[40:43], v[84:87]
    v_mfma_f32_16x16x32_bf16 v[88:91], a[232:235], v[44:47], v[88:91]
    v_mfma_f32_16x16x32_bf16 v[92:95], a[236:239], v[44:47], v[92:95]
    s_waitcnt lgkmcnt(0)
    s_waitcnt vmcnt(11)
    s_barrier
    ds_read_b128 v[32:35], v17 offset:0
    ds_read_b128 v[36:39], v17 offset:16384
    v_mfma_f32_16x16x32_bf16 v[80:83], a[240:243], v[48:51], v[80:83]
    ds_read_b128 v[40:43], v18 offset:0
    s_add_u32 m0, s29, 98304
    v_mfma_f32_16x16x32_bf16 v[84:87], a[244:247], v[48:51], v[84:87]
    buffer_load_dwordx4 v16, s[16:19], s34 offen offset:0 lds
    v_mfma_f32_16x16x32_bf16 v[88:91], a[240:243], v[52:55], v[88:91]
    ds_read_b128 v[44:47], v18 offset:16384
    v_mfma_f32_16x16x32_bf16 v[92:95], a[244:247], v[52:55], v[92:95]
    v_mfma_f32_16x16x32_bf16 v[80:83], a[248:251], v[56:59], v[80:83]
    ds_read_b128 v[48:51], v17 offset:1024
    v_mfma_f32_16x16x32_bf16 v[84:87], a[252:255], v[56:59], v[84:87]
    v_mfma_f32_16x16x32_bf16 v[88:91], a[248:251], v[60:63], v[88:91]
    ds_read_b128 v[52:55], v17 offset:17408
    v_mfma_f32_16x16x32_bf16 v[92:95], a[252:255], v[60:63], v[92:95]
    s_mov_b64 exec, s[36:37]
    buffer_store_dword v23, v22, s[8:11], s33 offen sc1
    s_mov_b64 exec, -1

    s_add_u32 s35, s35, 1
    s_cmp_lt_u32 s35, 32
    s_cbranch_scc1 .ql_468

    s_nop 7
    v_cvt_pk_bf16_f32 v96, v80, v81
    v_cvt_pk_bf16_f32 v97, v82, v83
    v_cvt_pk_bf16_f32 v98, v84, v85
    v_cvt_pk_bf16_f32 v99, v86, v87
    buffer_store_dwordx4 v[96:99], v21, s[8:11], s32 offen sc1
    v_cvt_pk_bf16_f32 v100, v88, v89
    v_cvt_pk_bf16_f32 v101, v90, v91
    v_cvt_pk_bf16_f32 v102, v92, v93
    v_cvt_pk_bf16_f32 v103, v94, v95
    buffer_store_dwordx4 v[100:103], v21, s[8:11], s38 offen sc1
    v_mov_b32 v23, 64
    s_waitcnt vmcnt(0) lgkmcnt(0)
    s_barrier
    s_mov_b64 exec, s[36:37]
    buffer_store_dword v23, v22, s[8:11], s33 offen sc1
    s_mov_b64 exec, -1

    s_branch .qd_467
.qv_466:
    s_waitcnt vmcnt(16)
    s_barrier
    ds_read_b128 v[32:35], v17 offset:0
    ds_read_b128 v[36:39], v17 offset:16384
    ds_read_b128 v[40:43], v18 offset:0
    ds_read_b128 v[44:47], v18 offset:16384
    s_add_u32 m0, s29, 98304
    s_nop 0
    buffer_load_dwordx4 v16, s[16:19], s34 offen offset:0 lds
    ds_read_b128 v[48:51], v17 offset:1024
    ds_read_b128 v[52:55], v17 offset:17408
    s_branch .qe_471
.p2align 6
.ql_470:
.qe_471:
    s_waitcnt lgkmcnt(4)
    v_mfma_f32_16x16x32_bf16 v[64:67], v[32:35], a[0:3], 0
    ds_read_b128 v[56:59], v18 offset:1024
    s_add_u32 m0, s29, 99200
    v_mfma_f32_16x16x32_bf16 v[68:71], v[32:35], a[4:7], 0
    buffer_load_dwordx4 v16, s[16:19], s34 offen offset:128 lds
    v_mfma_f32_16x16x32_bf16 v[72:75], v[36:39], a[0:3], 0
    ds_read_b128 v[60:63], v18 offset:17408
    v_mfma_f32_16x16x32_bf16 v[76:79], v[36:39], a[4:7], 0
    s_waitcnt lgkmcnt(4)
    v_mfma_f32_16x16x32_bf16 v[64:67], v[40:43], a[8:11], v[64:67]
    ds_read_b128 v[32:35], v17 offset:2048
    v_mfma_f32_16x16x32_bf16 v[68:71], v[40:43], a[12:15], v[68:71]
    v_cvt_pk_bf16_f32 v96, v80, v81
    v_cvt_pk_bf16_f32 v97, v82, v83
    v_mfma_f32_16x16x32_bf16 v[72:75], v[44:47], a[8:11], v[72:75]
    ds_read_b128 v[36:39], v17 offset:18432
    v_mfma_f32_16x16x32_bf16 v[76:79], v[44:47], a[12:15], v[76:79]
    v_cvt_pk_bf16_f32 v98, v88, v89
    v_cvt_pk_bf16_f32 v99, v90, v91
    s_waitcnt lgkmcnt(4)
    v_mfma_f32_16x16x32_bf16 v[64:67], v[48:51], a[16:19], v[64:67]
    ds_read_b128 v[40:43], v18 offset:2048
    s_add_u32 m0, s29, 100096
    v_mfma_f32_16x16x32_bf16 v[68:71], v[48:51], a[20:23], v[68:71]
    buffer_load_dwordx4 v16, s[16:19], s34 offen offset:256 lds
    v_mfma_f32_16x16x32_bf16 v[72:75], v[52:55], a[16:19], v[72:75]
    ds_read_b128 v[44:47], v18 offset:18432
    v_mfma_f32_16x16x32_bf16 v[76:79], v[52:55], a[20:23], v[76:79]
    s_waitcnt lgkmcnt(4)
    v_mfma_f32_16x16x32_bf16 v[64:67], v[56:59], a[24:27], v[64:67]
    ds_read_b128 v[48:51], v17 offset:3072
    v_mfma_f32_16x16x32_bf16 v[68:71], v[56:59], a[28:31], v[68:71]
    buffer_store_dwordx4 v[96:99], v21, s[8:11], s32 offen offset:0 sc1
    v_mfma_f32_16x16x32_bf16 v[72:75], v[60:63], a[24:27], v[72:75]
    ds_read_b128 v[52:55], v17 offset:19456
    v_mfma_f32_16x16x32_bf16 v[76:79], v[60:63], a[28:31], v[76:79]
    s_waitcnt lgkmcnt(4)
    v_mfma_f32_16x16x32_bf16 v[64:67], v[32:35], a[32:35], v[64:67]
    ds_read_b128 v[56:59], v18 offset:3072
    s_add_u32 m0, s29, 100992
    v_mfma_f32_16x16x32_bf16 v[68:71], v[32:35], a[36:39], v[68:71]
    buffer_load_dwordx4 v16, s[16:19], s34 offen offset:384 lds
    v_mfma_f32_16x16x32_bf16 v[72:75], v[36:39], a[32:35], v[72:75]
    ds_read_b128 v[60:63], v18 offset:19456
    v_mfma_f32_16x16x32_bf16 v[76:79], v[36:39], a[36:39], v[76:79]
    s_waitcnt lgkmcnt(4)
    v_mfma_f32_16x16x32_bf16 v[64:67], v[40:43], a[40:43], v[64:67]
    ds_read_b128 v[32:35], v17 offset:4096
    v_mfma_f32_16x16x32_bf16 v[68:71], v[40:43], a[44:47], v[68:71]
    v_cvt_pk_bf16_f32 v100, v84, v85
    v_cvt_pk_bf16_f32 v101, v86, v87
    v_mfma_f32_16x16x32_bf16 v[72:75], v[44:47], a[40:43], v[72:75]
    ds_read_b128 v[36:39], v17 offset:20480
    v_mfma_f32_16x16x32_bf16 v[76:79], v[44:47], a[44:47], v[76:79]
    v_cvt_pk_bf16_f32 v102, v92, v93
    v_cvt_pk_bf16_f32 v103, v94, v95
    s_waitcnt lgkmcnt(4)
    v_mfma_f32_16x16x32_bf16 v[64:67], v[48:51], a[48:51], v[64:67]
    ds_read_b128 v[40:43], v18 offset:4096
    s_add_u32 m0, s29, 101888
    v_mfma_f32_16x16x32_bf16 v[68:71], v[48:51], a[52:55], v[68:71]
    buffer_load_dwordx4 v16, s[16:19], s34 offen offset:512 lds
    v_mfma_f32_16x16x32_bf16 v[72:75], v[52:55], a[48:51], v[72:75]
    ds_read_b128 v[44:47], v18 offset:20480
    v_mfma_f32_16x16x32_bf16 v[76:79], v[52:55], a[52:55], v[76:79]
    s_waitcnt lgkmcnt(4)
    v_mfma_f32_16x16x32_bf16 v[64:67], v[56:59], a[56:59], v[64:67]
    ds_read_b128 v[48:51], v17 offset:5120
    v_mfma_f32_16x16x32_bf16 v[68:71], v[56:59], a[60:63], v[68:71]
    buffer_store_dwordx4 v[100:103], v21, s[8:11], s32 offen offset:1024 sc1
    v_mfma_f32_16x16x32_bf16 v[72:75], v[60:63], a[56:59], v[72:75]
    ds_read_b128 v[52:55], v17 offset:21504
    v_mfma_f32_16x16x32_bf16 v[76:79], v[60:63], a[60:63], v[76:79]
    s_waitcnt lgkmcnt(4)
    v_mfma_f32_16x16x32_bf16 v[64:67], v[32:35], a[64:67], v[64:67]
    ds_read_b128 v[56:59], v18 offset:5120
    s_add_u32 m0, s29, 102784
    v_mfma_f32_16x16x32_bf16 v[68:71], v[32:35], a[68:71], v[68:71]
    buffer_load_dwordx4 v16, s[16:19], s34 offen offset:640 lds
    v_mfma_f32_16x16x32_bf16 v[72:75], v[36:39], a[64:67], v[72:75]
    ds_read_b128 v[60:63], v18 offset:21504
    v_mfma_f32_16x16x32_bf16 v[76:79], v[36:39], a[68:71], v[76:79]
    s_waitcnt lgkmcnt(4)
    v_mfma_f32_16x16x32_bf16 v[64:67], v[40:43], a[72:75], v[64:67]
    ds_read_b128 v[32:35], v17 offset:6144
    v_mfma_f32_16x16x32_bf16 v[68:71], v[40:43], a[76:79], v[68:71]
    s_mov_b32 s32, s39
    s_add_u32 s38, s39, 4096
    s_add_u32 s39, s39, 262144
    v_mfma_f32_16x16x32_bf16 v[72:75], v[44:47], a[72:75], v[72:75]
    ds_read_b128 v[36:39], v17 offset:22528
    v_mfma_f32_16x16x32_bf16 v[76:79], v[44:47], a[76:79], v[76:79]
    v_add_u32 v23, 1, v23
    s_waitcnt lgkmcnt(4)
    v_mfma_f32_16x16x32_bf16 v[64:67], v[48:51], a[80:83], v[64:67]
    ds_read_b128 v[40:43], v18 offset:6144
    s_add_u32 m0, s29, 103680
    v_mfma_f32_16x16x32_bf16 v[68:71], v[48:51], a[84:87], v[68:71]
    buffer_load_dwordx4 v16, s[16:19], s34 offen offset:768 lds
    v_mfma_f32_16x16x32_bf16 v[72:75], v[52:55], a[80:83], v[72:75]
    ds_read_b128 v[44:47], v18 offset:22528
    v_mfma_f32_16x16x32_bf16 v[76:79], v[52:55], a[84:87], v[76:79]
    s_waitcnt lgkmcnt(4)
    v_mfma_f32_16x16x32_bf16 v[64:67], v[56:59], a[88:91], v[64:67]
    ds_read_b128 v[48:51], v17 offset:7168
    v_mfma_f32_16x16x32_bf16 v[68:71], v[56:59], a[92:95], v[68:71]
    v_mfma_f32_16x16x32_bf16 v[72:75], v[60:63], a[88:91], v[72:75]
    ds_read_b128 v[52:55], v17 offset:23552
    v_mfma_f32_16x16x32_bf16 v[76:79], v[60:63], a[92:95], v[76:79]
    s_mov_b64 exec, s[44:45]
    buffer_store_dwordx4 v[24:27], v28, s[8:11], s46 offen sc1
    s_mov_b64 exec, -1
    s_waitcnt lgkmcnt(4)
    v_mfma_f32_16x16x32_bf16 v[64:67], v[32:35], a[96:99], v[64:67]
    ds_read_b128 v[56:59], v18 offset:7168
    s_add_u32 m0, s29, 104576
    v_mfma_f32_16x16x32_bf16 v[68:71], v[32:35], a[100:103], v[68:71]
    buffer_load_dwordx4 v16, s[16:19], s34 offen offset:896 lds
    v_mfma_f32_16x16x32_bf16 v[72:75], v[36:39], a[96:99], v[72:75]
    ds_read_b128 v[60:63], v18 offset:23552
    v_mfma_f32_16x16x32_bf16 v[76:79], v[36:39], a[100:103], v[76:79]
    s_waitcnt lgkmcnt(4)
    v_mfma_f32_16x16x32_bf16 v[64:67], v[40:43], a[104:107], v[64:67]
    s_add_u32 s34, s34, 64512
    s_min_u32 s34, s34, 4128768
    v_mfma_f32_16x16x32_bf16 v[68:71], v[40:43], a[108:111], v[68:71]
    v_mfma_f32_16x16x32_bf16 v[72:75], v[44:47], a[104:107], v[72:75]
    v_mfma_f32_16x16x32_bf16 v[76:79], v[44:47], a[108:111], v[76:79]
    s_waitcnt lgkmcnt(0)
    s_waitcnt vmcnt(18)
    s_barrier
    ds_read_b128 v[32:35], v17 offset:32768
    ds_read_b128 v[36:39], v17 offset:49152
    v_mfma_f32_16x16x32_bf16 v[64:67], v[48:51], a[112:115], v[64:67]
    ds_read_b128 v[40:43], v18 offset:32768
    s_add_u32 m0, s29, 0
    v_mfma_f32_16x16x32_bf16 v[68:71], v[48:51], a[116:119], v[68:71]
    buffer_load_dwordx4 v16, s[16:19], s34 offen offset:0 lds
    v_mfma_f32_16x16x32_bf16 v[72:75], v[52:55], a[112:115], v[72:75]
    ds_read_b128 v[44:47], v18 offset:49152
    v_mfma_f32_16x16x32_bf16 v[76:79], v[52:55], a[116:119], v[76:79]
    v_mfma_f32_16x16x32_bf16 v[64:67], v[56:59], a[120:123], v[64:67]
    ds_read_b128 v[48:51], v17 offset:33792
    v_mfma_f32_16x16x32_bf16 v[68:71], v[56:59], a[124:127], v[68:71]
    v_mfma_f32_16x16x32_bf16 v[72:75], v[60:63], a[120:123], v[72:75]
    ds_read_b128 v[52:55], v17 offset:50176
    v_mfma_f32_16x16x32_bf16 v[76:79], v[60:63], a[124:127], v[76:79]
    s_waitcnt lgkmcnt(4)
    v_mfma_f32_16x16x32_bf16 v[64:67], v[32:35], a[128:131], v[64:67]
    ds_read_b128 v[56:59], v18 offset:33792
    s_add_u32 m0, s29, 896
    v_mfma_f32_16x16x32_bf16 v[68:71], v[32:35], a[132:135], v[68:71]
    buffer_load_dwordx4 v16, s[16:19], s34 offen offset:128 lds
    v_mfma_f32_16x16x32_bf16 v[72:75], v[36:39], a[128:131], v[72:75]
    ds_read_b128 v[60:63], v18 offset:50176
    v_mfma_f32_16x16x32_bf16 v[76:79], v[36:39], a[132:135], v[76:79]
    s_waitcnt lgkmcnt(4)
    v_mfma_f32_16x16x32_bf16 v[64:67], v[40:43], a[136:139], v[64:67]
    ds_read_b128 v[32:35], v17 offset:34816
    v_mfma_f32_16x16x32_bf16 v[68:71], v[40:43], a[140:143], v[68:71]
    v_mfma_f32_16x16x32_bf16 v[72:75], v[44:47], a[136:139], v[72:75]
    ds_read_b128 v[36:39], v17 offset:51200
    v_mfma_f32_16x16x32_bf16 v[76:79], v[44:47], a[140:143], v[76:79]
    s_waitcnt lgkmcnt(4)
    v_mfma_f32_16x16x32_bf16 v[64:67], v[48:51], a[144:147], v[64:67]
    ds_read_b128 v[40:43], v18 offset:34816
    s_add_u32 m0, s29, 1792
    v_mfma_f32_16x16x32_bf16 v[68:71], v[48:51], a[148:151], v[68:71]
    buffer_load_dwordx4 v16, s[16:19], s34 offen offset:256 lds
    v_mfma_f32_16x16x32_bf16 v[72:75], v[52:55], a[144:147], v[72:75]
    ds_read_b128 v[44:47], v18 offset:51200
    v_mfma_f32_16x16x32_bf16 v[76:79], v[52:55], a[148:151], v[76:79]
    s_waitcnt lgkmcnt(4)
    v_mfma_f32_16x16x32_bf16 v[64:67], v[56:59], a[152:155], v[64:67]
    ds_read_b128 v[48:51], v17 offset:35840
    v_mfma_f32_16x16x32_bf16 v[68:71], v[56:59], a[156:159], v[68:71]
    v_mfma_f32_16x16x32_bf16 v[72:75], v[60:63], a[152:155], v[72:75]
    ds_read_b128 v[52:55], v17 offset:52224
    v_mfma_f32_16x16x32_bf16 v[76:79], v[60:63], a[156:159], v[76:79]
    s_waitcnt lgkmcnt(4)
    v_mfma_f32_16x16x32_bf16 v[64:67], v[32:35], a[160:163], v[64:67]
    ds_read_b128 v[56:59], v18 offset:35840
    s_add_u32 m0, s29, 2688
    v_mfma_f32_16x16x32_bf16 v[68:71], v[32:35], a[164:167], v[68:71]
    buffer_load_dwordx4 v16, s[16:19], s34 offen offset:384 lds
    v_mfma_f32_16x16x32_bf16 v[72:75], v[36:39], a[160:163], v[72:75]
    ds_read_b128 v[60:63], v18 offset:52224
    v_mfma_f32_16x16x32_bf16 v[76:79], v[36:39], a[164:167], v[76:79]
    s_waitcnt lgkmcnt(4)
    v_mfma_f32_16x16x32_bf16 v[64:67], v[40:43], a[168:171], v[64:67]
    ds_read_b128 v[32:35], v17 offset:36864
    v_mfma_f32_16x16x32_bf16 v[68:71], v[40:43], a[172:175], v[68:71]
    v_mfma_f32_16x16x32_bf16 v[72:75], v[44:47], a[168:171], v[72:75]
    ds_read_b128 v[36:39], v17 offset:53248
    v_mfma_f32_16x16x32_bf16 v[76:79], v[44:47], a[172:175], v[76:79]
    s_waitcnt lgkmcnt(4)
    v_mfma_f32_16x16x32_bf16 v[64:67], v[48:51], a[176:179], v[64:67]
    ds_read_b128 v[40:43], v18 offset:36864
    s_add_u32 m0, s29, 3584
    v_mfma_f32_16x16x32_bf16 v[68:71], v[48:51], a[180:183], v[68:71]
    buffer_load_dwordx4 v16, s[16:19], s34 offen offset:512 lds
    v_mfma_f32_16x16x32_bf16 v[72:75], v[52:55], a[176:179], v[72:75]
    ds_read_b128 v[44:47], v18 offset:53248
    v_mfma_f32_16x16x32_bf16 v[76:79], v[52:55], a[180:183], v[76:79]
    s_waitcnt lgkmcnt(4)
    v_mfma_f32_16x16x32_bf16 v[64:67], v[56:59], a[184:187], v[64:67]
    ds_read_b128 v[48:51], v17 offset:37888
    v_mfma_f32_16x16x32_bf16 v[68:71], v[56:59], a[188:191], v[68:71]
    v_mfma_f32_16x16x32_bf16 v[72:75], v[60:63], a[184:187], v[72:75]
    ds_read_b128 v[52:55], v17 offset:54272
    v_mfma_f32_16x16x32_bf16 v[76:79], v[60:63], a[188:191], v[76:79]
    s_waitcnt lgkmcnt(4)
    v_mfma_f32_16x16x32_bf16 v[64:67], v[32:35], a[192:195], v[64:67]
    ds_read_b128 v[56:59], v18 offset:37888
    s_add_u32 m0, s29, 4480
    v_mfma_f32_16x16x32_bf16 v[68:71], v[32:35], a[196:199], v[68:71]
    buffer_load_dwordx4 v16, s[16:19], s34 offen offset:640 lds
    v_mfma_f32_16x16x32_bf16 v[72:75], v[36:39], a[192:195], v[72:75]
    ds_read_b128 v[60:63], v18 offset:54272
    v_mfma_f32_16x16x32_bf16 v[76:79], v[36:39], a[196:199], v[76:79]
    s_waitcnt lgkmcnt(4)
    v_mfma_f32_16x16x32_bf16 v[64:67], v[40:43], a[200:203], v[64:67]
    ds_read_b128 v[32:35], v17 offset:38912
    v_mfma_f32_16x16x32_bf16 v[68:71], v[40:43], a[204:207], v[68:71]
    v_mfma_f32_16x16x32_bf16 v[72:75], v[44:47], a[200:203], v[72:75]
    ds_read_b128 v[36:39], v17 offset:55296
    v_mfma_f32_16x16x32_bf16 v[76:79], v[44:47], a[204:207], v[76:79]
    s_waitcnt lgkmcnt(4)
    v_mfma_f32_16x16x32_bf16 v[64:67], v[48:51], a[208:211], v[64:67]
    ds_read_b128 v[40:43], v18 offset:38912
    s_add_u32 m0, s29, 5376
    v_mfma_f32_16x16x32_bf16 v[68:71], v[48:51], a[212:215], v[68:71]
    buffer_load_dwordx4 v16, s[16:19], s34 offen offset:768 lds
    v_mfma_f32_16x16x32_bf16 v[72:75], v[52:55], a[208:211], v[72:75]
    ds_read_b128 v[44:47], v18 offset:55296
    v_mfma_f32_16x16x32_bf16 v[76:79], v[52:55], a[212:215], v[76:79]
    s_waitcnt lgkmcnt(4)
    v_mfma_f32_16x16x32_bf16 v[64:67], v[56:59], a[216:219], v[64:67]
    ds_read_b128 v[48:51], v17 offset:39936
    v_mfma_f32_16x16x32_bf16 v[68:71], v[56:59], a[220:223], v[68:71]
    v_mfma_f32_16x16x32_bf16 v[72:75], v[60:63], a[216:219], v[72:75]
    ds_read_b128 v[52:55], v17 offset:56320
    v_mfma_f32_16x16x32_bf16 v[76:79], v[60:63], a[220:223], v[76:79]
    s_mov_b64 exec, s[44:45]
    buffer_store_dwordx4 v[24:27], v29, s[8:11], s46 offen sc1
    s_mov_b64 exec, -1
    s_waitcnt lgkmcnt(4)
    v_mfma_f32_16x16x32_bf16 v[64:67], v[32:35], a[224:227], v[64:67]
    ds_read_b128 v[56:59], v18 offset:39936
    s_add_u32 m0, s29, 6272
    v_mfma_f32_16x16x32_bf16 v[68:71], v[32:35], a[228:231], v[68:71]
    buffer_load_dwordx4 v16, s[16:19], s34 offen offset:896 lds
    v_mfma_f32_16x16x32_bf16 v[72:75], v[36:39], a[224:227], v[72:75]
    ds_read_b128 v[60:63], v18 offset:56320
    v_mfma_f32_16x16x32_bf16 v[76:79], v[36:39], a[228:231], v[76:79]
    s_waitcnt lgkmcnt(4)
    v_mfma_f32_16x16x32_bf16 v[64:67], v[40:43], a[232:235], v[64:67]
    s_add_u32 s34, s34, 1024
    v_mfma_f32_16x16x32_bf16 v[68:71], v[40:43], a[236:239], v[68:71]
    v_mfma_f32_16x16x32_bf16 v[72:75], v[44:47], a[232:235], v[72:75]
    v_mfma_f32_16x16x32_bf16 v[76:79], v[44:47], a[236:239], v[76:79]
    s_waitcnt lgkmcnt(0)
    s_waitcnt vmcnt(11)
    s_barrier
    ds_read_b128 v[32:35], v19 offset:0
    ds_read_b128 v[36:39], v19 offset:16384
    v_mfma_f32_16x16x32_bf16 v[64:67], v[48:51], a[240:243], v[64:67]
    ds_read_b128 v[40:43], v20 offset:0
    s_add_u32 m0, s29, 32768
    v_mfma_f32_16x16x32_bf16 v[68:71], v[48:51], a[244:247], v[68:71]
    buffer_load_dwordx4 v16, s[16:19], s34 offen offset:0 lds
    v_mfma_f32_16x16x32_bf16 v[72:75], v[52:55], a[240:243], v[72:75]
    ds_read_b128 v[44:47], v20 offset:16384
    v_mfma_f32_16x16x32_bf16 v[76:79], v[52:55], a[244:247], v[76:79]
    v_mfma_f32_16x16x32_bf16 v[64:67], v[56:59], a[248:251], v[64:67]
    ds_read_b128 v[48:51], v19 offset:1024
    v_mfma_f32_16x16x32_bf16 v[68:71], v[56:59], a[252:255], v[68:71]
    v_mfma_f32_16x16x32_bf16 v[72:75], v[60:63], a[248:251], v[72:75]
    ds_read_b128 v[52:55], v19 offset:17408
    v_mfma_f32_16x16x32_bf16 v[76:79], v[60:63], a[252:255], v[76:79]
    s_mov_b64 exec, s[36:37]
    buffer_store_dword v23, v22, s[8:11], s33 offen sc1
    s_mov_b64 exec, -1

    s_waitcnt lgkmcnt(4)
    v_mfma_f32_16x16x32_bf16 v[80:83], v[32:35], a[0:3], 0
    ds_read_b128 v[56:59], v20 offset:1024
    s_add_u32 m0, s29, 33664
    v_mfma_f32_16x16x32_bf16 v[84:87], v[32:35], a[4:7], 0
    buffer_load_dwordx4 v16, s[16:19], s34 offen offset:128 lds
    v_mfma_f32_16x16x32_bf16 v[88:91], v[36:39], a[0:3], 0
    ds_read_b128 v[60:63], v20 offset:17408
    v_mfma_f32_16x16x32_bf16 v[92:95], v[36:39], a[4:7], 0
    s_waitcnt lgkmcnt(4)
    v_mfma_f32_16x16x32_bf16 v[80:83], v[40:43], a[8:11], v[80:83]
    ds_read_b128 v[32:35], v19 offset:2048
    v_mfma_f32_16x16x32_bf16 v[84:87], v[40:43], a[12:15], v[84:87]
    v_cvt_pk_bf16_f32 v96, v64, v65
    v_cvt_pk_bf16_f32 v97, v66, v67
    v_mfma_f32_16x16x32_bf16 v[88:91], v[44:47], a[8:11], v[88:91]
    ds_read_b128 v[36:39], v19 offset:18432
    v_mfma_f32_16x16x32_bf16 v[92:95], v[44:47], a[12:15], v[92:95]
    v_cvt_pk_bf16_f32 v98, v72, v73
    v_cvt_pk_bf16_f32 v99, v74, v75
    s_waitcnt lgkmcnt(4)
    v_mfma_f32_16x16x32_bf16 v[80:83], v[48:51], a[16:19], v[80:83]
    ds_read_b128 v[40:43], v20 offset:2048
    s_add_u32 m0, s29, 34560
    v_mfma_f32_16x16x32_bf16 v[84:87], v[48:51], a[20:23], v[84:87]
    buffer_load_dwordx4 v16, s[16:19], s34 offen offset:256 lds
    v_mfma_f32_16x16x32_bf16 v[88:91], v[52:55], a[16:19], v[88:91]
    ds_read_b128 v[44:47], v20 offset:18432
    v_mfma_f32_16x16x32_bf16 v[92:95], v[52:55], a[20:23], v[92:95]
    s_waitcnt lgkmcnt(4)
    v_mfma_f32_16x16x32_bf16 v[80:83], v[56:59], a[24:27], v[80:83]
    ds_read_b128 v[48:51], v19 offset:3072
    v_mfma_f32_16x16x32_bf16 v[84:87], v[56:59], a[28:31], v[84:87]
    buffer_store_dwordx4 v[96:99], v21, s[8:11], s32 offen offset:0 sc1
    v_mfma_f32_16x16x32_bf16 v[88:91], v[60:63], a[24:27], v[88:91]
    ds_read_b128 v[52:55], v19 offset:19456
    v_mfma_f32_16x16x32_bf16 v[92:95], v[60:63], a[28:31], v[92:95]
    s_waitcnt lgkmcnt(4)
    v_mfma_f32_16x16x32_bf16 v[80:83], v[32:35], a[32:35], v[80:83]
    ds_read_b128 v[56:59], v20 offset:3072
    s_add_u32 m0, s29, 35456
    v_mfma_f32_16x16x32_bf16 v[84:87], v[32:35], a[36:39], v[84:87]
    buffer_load_dwordx4 v16, s[16:19], s34 offen offset:384 lds
    v_mfma_f32_16x16x32_bf16 v[88:91], v[36:39], a[32:35], v[88:91]
    ds_read_b128 v[60:63], v20 offset:19456
    v_mfma_f32_16x16x32_bf16 v[92:95], v[36:39], a[36:39], v[92:95]
    s_waitcnt lgkmcnt(4)
    v_mfma_f32_16x16x32_bf16 v[80:83], v[40:43], a[40:43], v[80:83]
    ds_read_b128 v[32:35], v19 offset:4096
    v_mfma_f32_16x16x32_bf16 v[84:87], v[40:43], a[44:47], v[84:87]
    v_cvt_pk_bf16_f32 v100, v68, v69
    v_cvt_pk_bf16_f32 v101, v70, v71
    v_mfma_f32_16x16x32_bf16 v[88:91], v[44:47], a[40:43], v[88:91]
    ds_read_b128 v[36:39], v19 offset:20480
    v_mfma_f32_16x16x32_bf16 v[92:95], v[44:47], a[44:47], v[92:95]
    v_cvt_pk_bf16_f32 v102, v76, v77
    v_cvt_pk_bf16_f32 v103, v78, v79
    s_waitcnt lgkmcnt(4)
    v_mfma_f32_16x16x32_bf16 v[80:83], v[48:51], a[48:51], v[80:83]
    ds_read_b128 v[40:43], v20 offset:4096
    s_add_u32 m0, s29, 36352
    v_mfma_f32_16x16x32_bf16 v[84:87], v[48:51], a[52:55], v[84:87]
    buffer_load_dwordx4 v16, s[16:19], s34 offen offset:512 lds
    v_mfma_f32_16x16x32_bf16 v[88:91], v[52:55], a[48:51], v[88:91]
    ds_read_b128 v[44:47], v20 offset:20480
    v_mfma_f32_16x16x32_bf16 v[92:95], v[52:55], a[52:55], v[92:95]
    s_waitcnt lgkmcnt(4)
    v_mfma_f32_16x16x32_bf16 v[80:83], v[56:59], a[56:59], v[80:83]
    ds_read_b128 v[48:51], v19 offset:5120
    v_mfma_f32_16x16x32_bf16 v[84:87], v[56:59], a[60:63], v[84:87]
    buffer_store_dwordx4 v[100:103], v21, s[8:11], s32 offen offset:1024 sc1
    v_mfma_f32_16x16x32_bf16 v[88:91], v[60:63], a[56:59], v[88:91]
    ds_read_b128 v[52:55], v19 offset:21504
    v_mfma_f32_16x16x32_bf16 v[92:95], v[60:63], a[60:63], v[92:95]
    s_waitcnt lgkmcnt(4)
    v_mfma_f32_16x16x32_bf16 v[80:83], v[32:35], a[64:67], v[80:83]
    ds_read_b128 v[56:59], v20 offset:5120
    s_add_u32 m0, s29, 37248
    v_mfma_f32_16x16x32_bf16 v[84:87], v[32:35], a[68:71], v[84:87]
    buffer_load_dwordx4 v16, s[16:19], s34 offen offset:640 lds
    v_mfma_f32_16x16x32_bf16 v[88:91], v[36:39], a[64:67], v[88:91]
    ds_read_b128 v[60:63], v20 offset:21504
    v_mfma_f32_16x16x32_bf16 v[92:95], v[36:39], a[68:71], v[92:95]
    s_waitcnt lgkmcnt(4)
    v_mfma_f32_16x16x32_bf16 v[80:83], v[40:43], a[72:75], v[80:83]
    ds_read_b128 v[32:35], v19 offset:6144
    v_mfma_f32_16x16x32_bf16 v[84:87], v[40:43], a[76:79], v[84:87]
    s_mov_b32 s32, s39
    s_add_u32 s38, s39, 4096
    s_add_u32 s39, s39, 262144
    v_mfma_f32_16x16x32_bf16 v[88:91], v[44:47], a[72:75], v[88:91]
    ds_read_b128 v[36:39], v19 offset:22528
    v_mfma_f32_16x16x32_bf16 v[92:95], v[44:47], a[76:79], v[92:95]
    v_add_u32 v23, 1, v23
    s_waitcnt lgkmcnt(4)
    v_mfma_f32_16x16x32_bf16 v[80:83], v[48:51], a[80:83], v[80:83]
    ds_read_b128 v[40:43], v20 offset:6144
    s_add_u32 m0, s29, 38144
    v_mfma_f32_16x16x32_bf16 v[84:87], v[48:51], a[84:87], v[84:87]
    buffer_load_dwordx4 v16, s[16:19], s34 offen offset:768 lds
    v_mfma_f32_16x16x32_bf16 v[88:91], v[52:55], a[80:83], v[88:91]
    ds_read_b128 v[44:47], v20 offset:22528
    v_mfma_f32_16x16x32_bf16 v[92:95], v[52:55], a[84:87], v[92:95]
    s_waitcnt lgkmcnt(4)
    v_mfma_f32_16x16x32_bf16 v[80:83], v[56:59], a[88:91], v[80:83]
    ds_read_b128 v[48:51], v19 offset:7168
    v_mfma_f32_16x16x32_bf16 v[84:87], v[56:59], a[92:95], v[84:87]
    v_mfma_f32_16x16x32_bf16 v[88:91], v[60:63], a[88:91], v[88:91]
    ds_read_b128 v[52:55], v19 offset:23552
    v_mfma_f32_16x16x32_bf16 v[92:95], v[60:63], a[92:95], v[92:95]
    s_mov_b64 exec, s[44:45]
    buffer_store_dwordx4 v[24:27], v30, s[8:11], s46 offen sc1
    s_mov_b64 exec, -1
    s_waitcnt lgkmcnt(4)
    v_mfma_f32_16x16x32_bf16 v[80:83], v[32:35], a[96:99], v[80:83]
    ds_read_b128 v[56:59], v20 offset:7168
    s_add_u32 m0, s29, 39040
    v_mfma_f32_16x16x32_bf16 v[84:87], v[32:35], a[100:103], v[84:87]
    buffer_load_dwordx4 v16, s[16:19], s34 offen offset:896 lds
    v_mfma_f32_16x16x32_bf16 v[88:91], v[36:39], a[96:99], v[88:91]
    ds_read_b128 v[60:63], v20 offset:23552
    v_mfma_f32_16x16x32_bf16 v[92:95], v[36:39], a[100:103], v[92:95]
    s_waitcnt lgkmcnt(4)
    v_mfma_f32_16x16x32_bf16 v[80:83], v[40:43], a[104:107], v[80:83]
    s_add_u32 s34, s34, 64512
    s_min_u32 s34, s34, 4128768
    v_mfma_f32_16x16x32_bf16 v[84:87], v[40:43], a[108:111], v[84:87]
    v_mfma_f32_16x16x32_bf16 v[88:91], v[44:47], a[104:107], v[88:91]
    v_mfma_f32_16x16x32_bf16 v[92:95], v[44:47], a[108:111], v[92:95]
    s_waitcnt lgkmcnt(0)
    s_waitcnt vmcnt(18)
    s_barrier
    ds_read_b128 v[32:35], v19 offset:32768
    ds_read_b128 v[36:39], v19 offset:49152
    v_mfma_f32_16x16x32_bf16 v[80:83], v[48:51], a[112:115], v[80:83]
    ds_read_b128 v[40:43], v20 offset:32768
    s_add_u32 m0, s29, 65536
    v_mfma_f32_16x16x32_bf16 v[84:87], v[48:51], a[116:119], v[84:87]
    buffer_load_dwordx4 v16, s[16:19], s34 offen offset:0 lds
    v_mfma_f32_16x16x32_bf16 v[88:91], v[52:55], a[112:115], v[88:91]
    ds_read_b128 v[44:47], v20 offset:49152
    v_mfma_f32_16x16x32_bf16 v[92:95], v[52:55], a[116:119], v[92:95]
    v_mfma_f32_16x16x32_bf16 v[80:83], v[56:59], a[120:123], v[80:83]
    ds_read_b128 v[48:51], v19 offset:33792
    v_mfma_f32_16x16x32_bf16 v[84:87], v[56:59], a[124:127], v[84:87]
    v_mfma_f32_16x16x32_bf16 v[88:91], v[60:63], a[120:123], v[88:91]
    ds_read_b128 v[52:55], v19 offset:50176
    v_mfma_f32_16x16x32_bf16 v[92:95], v[60:63], a[124:127], v[92:95]
    s_waitcnt lgkmcnt(4)
    v_mfma_f32_16x16x32_bf16 v[80:83], v[32:35], a[128:131], v[80:83]
    ds_read_b128 v[56:59], v20 offset:33792
    s_add_u32 m0, s29, 66432
    v_mfma_f32_16x16x32_bf16 v[84:87], v[32:35], a[132:135], v[84:87]
    buffer_load_dwordx4 v16, s[16:19], s34 offen offset:128 lds
    v_mfma_f32_16x16x32_bf16 v[88:91], v[36:39], a[128:131], v[88:91]
    ds_read_b128 v[60:63], v20 offset:50176
    v_mfma_f32_16x16x32_bf16 v[92:95], v[36:39], a[132:135], v[92:95]
    s_waitcnt lgkmcnt(4)
    v_mfma_f32_16x16x32_bf16 v[80:83], v[40:43], a[136:139], v[80:83]
    ds_read_b128 v[32:35], v19 offset:34816
    v_mfma_f32_16x16x32_bf16 v[84:87], v[40:43], a[140:143], v[84:87]
    v_mfma_f32_16x16x32_bf16 v[88:91], v[44:47], a[136:139], v[88:91]
    ds_read_b128 v[36:39], v19 offset:51200
    v_mfma_f32_16x16x32_bf16 v[92:95], v[44:47], a[140:143], v[92:95]
    s_waitcnt lgkmcnt(4)
    v_mfma_f32_16x16x32_bf16 v[80:83], v[48:51], a[144:147], v[80:83]
    ds_read_b128 v[40:43], v20 offset:34816
    s_add_u32 m0, s29, 67328
    v_mfma_f32_16x16x32_bf16 v[84:87], v[48:51], a[148:151], v[84:87]
    buffer_load_dwordx4 v16, s[16:19], s34 offen offset:256 lds
    v_mfma_f32_16x16x32_bf16 v[88:91], v[52:55], a[144:147], v[88:91]
    ds_read_b128 v[44:47], v20 offset:51200
    v_mfma_f32_16x16x32_bf16 v[92:95], v[52:55], a[148:151], v[92:95]
    s_waitcnt lgkmcnt(4)
    v_mfma_f32_16x16x32_bf16 v[80:83], v[56:59], a[152:155], v[80:83]
    ds_read_b128 v[48:51], v19 offset:35840
    v_mfma_f32_16x16x32_bf16 v[84:87], v[56:59], a[156:159], v[84:87]
    v_mfma_f32_16x16x32_bf16 v[88:91], v[60:63], a[152:155], v[88:91]
    ds_read_b128 v[52:55], v19 offset:52224
    v_mfma_f32_16x16x32_bf16 v[92:95], v[60:63], a[156:159], v[92:95]
    s_waitcnt lgkmcnt(4)
    v_mfma_f32_16x16x32_bf16 v[80:83], v[32:35], a[160:163], v[80:83]
    ds_read_b128 v[56:59], v20 offset:35840
    s_add_u32 m0, s29, 68224
    v_mfma_f32_16x16x32_bf16 v[84:87], v[32:35], a[164:167], v[84:87]
    buffer_load_dwordx4 v16, s[16:19], s34 offen offset:384 lds
    v_mfma_f32_16x16x32_bf16 v[88:91], v[36:39], a[160:163], v[88:91]
    ds_read_b128 v[60:63], v20 offset:52224
    v_mfma_f32_16x16x32_bf16 v[92:95], v[36:39], a[164:167], v[92:95]
    s_waitcnt lgkmcnt(4)
    v_mfma_f32_16x16x32_bf16 v[80:83], v[40:43], a[168:171], v[80:83]
    ds_read_b128 v[32:35], v19 offset:36864
    v_mfma_f32_16x16x32_bf16 v[84:87], v[40:43], a[172:175], v[84:87]
    v_mfma_f32_16x16x32_bf16 v[88:91], v[44:47], a[168:171], v[88:91]
    ds_read_b128 v[36:39], v19 offset:53248
    v_mfma_f32_16x16x32_bf16 v[92:95], v[44:47], a[172:175], v[92:95]
    s_waitcnt lgkmcnt(4)
    v_mfma_f32_16x16x32_bf16 v[80:83], v[48:51], a[176:179], v[80:83]
    ds_read_b128 v[40:43], v20 offset:36864
    s_add_u32 m0, s29, 69120
    v_mfma_f32_16x16x32_bf16 v[84:87], v[48:51], a[180:183], v[84:87]
    buffer_load_dwordx4 v16, s[16:19], s34 offen offset:512 lds
    v_mfma_f32_16x16x32_bf16 v[88:91], v[52:55], a[176:179], v[88:91]
    ds_read_b128 v[44:47], v20 offset:53248
    v_mfma_f32_16x16x32_bf16 v[92:95], v[52:55], a[180:183], v[92:95]
    s_waitcnt lgkmcnt(4)
    v_mfma_f32_16x16x32_bf16 v[80:83], v[56:59], a[184:187], v[80:83]
    ds_read_b128 v[48:51], v19 offset:37888
    v_mfma_f32_16x16x32_bf16 v[84:87], v[56:59], a[188:191], v[84:87]
    v_mfma_f32_16x16x32_bf16 v[88:91], v[60:63], a[184:187], v[88:91]
    ds_read_b128 v[52:55], v19 offset:54272
    v_mfma_f32_16x16x32_bf16 v[92:95], v[60:63], a[188:191], v[92:95]
    s_waitcnt lgkmcnt(4)
    v_mfma_f32_16x16x32_bf16 v[80:83], v[32:35], a[192:195], v[80:83]
    ds_read_b128 v[56:59], v20 offset:37888
    s_add_u32 m0, s29, 70016
    v_mfma_f32_16x16x32_bf16 v[84:87], v[32:35], a[196:199], v[84:87]
    buffer_load_dwordx4 v16, s[16:19], s34 offen offset:640 lds
    v_mfma_f32_16x16x32_bf16 v[88:91], v[36:39], a[192:195], v[88:91]
    ds_read_b128 v[60:63], v20 offset:54272
    v_mfma_f32_16x16x32_bf16 v[92:95], v[36:39], a[196:199], v[92:95]
    s_waitcnt lgkmcnt(4)
    v_mfma_f32_16x16x32_bf16 v[80:83], v[40:43], a[200:203], v[80:83]
    ds_read_b128 v[32:35], v19 offset:38912
    v_mfma_f32_16x16x32_bf16 v[84:87], v[40:43], a[204:207], v[84:87]
    v_mfma_f32_16x16x32_bf16 v[88:91], v[44:47], a[200:203], v[88:91]
    ds_read_b128 v[36:39], v19 offset:55296
    v_mfma_f32_16x16x32_bf16 v[92:95], v[44:47], a[204:207], v[92:95]
    s_waitcnt lgkmcnt(4)
    v_mfma_f32_16x16x32_bf16 v[80:83], v[48:51], a[208:211], v[80:83]
    ds_read_b128 v[40:43], v20 offset:38912
    s_add_u32 m0, s29, 70912
    v_mfma_f32_16x16x32_bf16 v[84:87], v[48:51], a[212:215], v[84:87]
    buffer_load_dwordx4 v16, s[16:19], s34 offen offset:768 lds
    v_mfma_f32_16x16x32_bf16 v[88:91], v[52:55], a[208:211], v[88:91]
    ds_read_b128 v[44:47], v20 offset:55296
    v_mfma_f32_16x16x32_bf16 v[92:95], v[52:55], a[212:215], v[92:95]
    s_waitcnt lgkmcnt(4)
    v_mfma_f32_16x16x32_bf16 v[80:83], v[56:59], a[216:219], v[80:83]
    ds_read_b128 v[48:51], v19 offset:39936
    v_mfma_f32_16x16x32_bf16 v[84:87], v[56:59], a[220:223], v[84:87]
    s_cmp_lt_u32 s35, 21
    s_cselect_b64 s[44:45], -1, 0
    v_mfma_f32_16x16x32_bf16 v[88:91], v[60:63], a[216:219], v[88:91]
    ds_read_b128 v[52:55], v19 offset:56320
    v_mfma_f32_16x16x32_bf16 v[92:95], v[60:63], a[220:223], v[92:95]
    s_cselect_b32 s4, 0x10000, 0
    s_add_u32 s46, s46, s4
    s_waitcnt lgkmcnt(4)
    v_mfma_f32_16x16x32_bf16 v[80:83], v[32:35], a[224:227], v[80:83]
    ds_read_b128 v[56:59], v20 offset:39936
    s_add_u32 m0, s29, 71808
    v_mfma_f32_16x16x32_bf16 v[84:87], v[32:35], a[228:231], v[84:87]
    buffer_load_dwordx4 v16, s[16:19], s34 offen offset:896 lds
    v_mfma_f32_16x16x32_bf16 v[88:91], v[36:39], a[224:227], v[88:91]
    ds_read_b128 v[60:63], v20 offset:56320
    v_mfma_f32_16x16x32_bf16 v[92:95], v[36:39], a[228:231], v[92:95]
    s_waitcnt lgkmcnt(4)
    v_mfma_f32_16x16x32_bf16 v[80:83], v[40:43], a[232:235], v[80:83]
    s_add_u32 s34, s34, 1024
    v_mfma_f32_16x16x32_bf16 v[84:87], v[40:43], a[236:239], v[84:87]
    v_mfma_f32_16x16x32_bf16 v[88:91], v[44:47], a[232:235], v[88:91]
    v_mfma_f32_16x16x32_bf16 v[92:95], v[44:47], a[236:239], v[92:95]
    s_waitcnt lgkmcnt(0)
    s_waitcnt vmcnt(11)
    s_barrier
    ds_read_b128 v[32:35], v17 offset:0
    ds_read_b128 v[36:39], v17 offset:16384
    v_mfma_f32_16x16x32_bf16 v[80:83], v[48:51], a[240:243], v[80:83]
    ds_read_b128 v[40:43], v18 offset:0
    s_add_u32 m0, s29, 98304
    v_mfma_f32_16x16x32_bf16 v[84:87], v[48:51], a[244:247], v[84:87]
    buffer_load_dwordx4 v16, s[16:19], s34 offen offset:0 lds
    v_mfma_f32_16x16x32_bf16 v[88:91], v[52:55], a[240:243], v[88:91]
    ds_read_b128 v[44:47], v18 offset:16384
    v_mfma_f32_16x16x32_bf16 v[92:95], v[52:55], a[244:247], v[92:95]
    v_mfma_f32_16x16x32_bf16 v[80:83], v[56:59], a[248:251], v[80:83]
    ds_read_b128 v[48:51], v17 offset:1024
    v_mfma_f32_16x16x32_bf16 v[84:87], v[56:59], a[252:255], v[84:87]
    v_mfma_f32_16x16x32_bf16 v[88:91], v[60:63], a[248:251], v[88:91]
    ds_read_b128 v[52:55], v17 offset:17408
    v_mfma_f32_16x16x32_bf16 v[92:95], v[60:63], a[252:255], v[92:95]
    s_mov_b64 exec, s[36:37]
    buffer_store_dword v23, v22, s[8:11], s33 offen sc1
    s_mov_b64 exec, -1

    s_add_u32 s35, s35, 1
    s_cmp_lt_u32 s35, 32
    s_cbranch_scc1 .ql_470

    s_nop 7
    v_cvt_pk_bf16_f32 v96, v80, v81
    v_cvt_pk_bf16_f32 v97, v82, v83
    v_cvt_pk_bf16_f32 v98, v88, v89
    v_cvt_pk_bf16_f32 v99, v90, v91
    buffer_store_dwordx4 v[96:99], v21, s[8:11], s32 offen offset:0 sc1
    v_cvt_pk_bf16_f32 v100, v84, v85
    v_cvt_pk_bf16_f32 v101, v86, v87
    v_cvt_pk_bf16_f32 v102, v92, v93
    v_cvt_pk_bf16_f32 v103, v94, v95
    buffer_store_dwordx4 v[100:103], v21, s[8:11], s32 offen offset:1024 sc1
    v_mov_b32 v23, 64
    s_waitcnt vmcnt(0) lgkmcnt(0)
    s_barrier
    s_mov_b64 exec, s[36:37]
    buffer_store_dword v23, v22, s[8:11], s33 offen sc1
    s_mov_b64 exec, -1

.qd_467:
    s_load_dwordx2 s[40:41], s[0:1], 88
    s_load_dwordx2 s[42:43], s[0:1], 112
    s_and_b32 s4, s33, 0xffffe7ff
    s_mov_b32 s57, s4
    s_mov_b32 s34, s47
    s_and_b32 s30, s26, 7
    s_lshr_b32 s31, s26, 3
    s_lshl_b32 s28, s91, 21
    s_lshl_b32 s4, s30, 8
    s_add_u32 s28, s28, s4
    s_waitcnt lgkmcnt(0)

    s_mov_b32 s12, s40
    s_and_b32 s13, s41, 0xffff
    s_mov_b32 s14, 0x800000
    s_mov_b32 s15, 0x00020000

    s_mov_b32 s44, s42
    s_and_b32 s45, s43, 0xffff
    s_mov_b32 s46, 0x400000
    s_mov_b32 s47, 0x00020000

    v_lshrrev_b32 v4, 1, v2
    v_xor_b32 v4, v4, v3
    v_lshlrev_b32 v4, 1, v4
    v_and_b32 v5, 1, v1
    v_or_b32 v4, v4, v5
    v_lshlrev_b32 v4, 4, v4
    v_lshlrev_b32 v5, 11, v3
    v_add_u32 v10, v4, v5
    v_xor_b32 v11, 0x80, v10
    s_lshl_b32 s4, s24, 16
    s_add_u32 s28, s28, s4
    s_lshl_b32 s29, s24, 13
    v_lshrrev_b32 v4, 2, v2
    v_and_b32 v5, 1, v3
    v_lshl_or_b32 v5, v5, 2, v4
    s_lshl_b32 s4, s24, 1
    v_xor_b32 v5, s4, v5
    v_lshlrev_b32 v5, 5, v5
    v_lshl_add_u32 v4, v3, 2, v4
    v_lshl_add_u32 v5, v4, 8, v5
    v_and_b32 v4, 3, v2
    v_lshl_add_u32 v12, v4, 3, v5
    v_xor_b32 v13, 32, v12
    v_add_u32 v14, 0x10000, v12
    v_add_u32 v15, 0x10000, v13

    s_and_b32 s4, s91, 1
    s_lshl_b32 s4, s4, 5
    v_xor_b32 v12, s4, v12
    v_xor_b32 v13, s4, v13
    v_xor_b32 v14, s4, v14
    v_xor_b32 v15, s4, v15

    s_add_u32 m0, s29, 0
    s_add_u32 s4, s28, 0
    buffer_load_dwordx4 v10, s[12:15], s4 offen lds

    s_add_u32 m0, s29, 1024
    s_add_u32 s4, s28, 8192
    buffer_load_dwordx4 v11, s[12:15], s4 offen lds

    s_add_u32 m0, s29, 2048
    s_add_u32 s4, s28, 16384
    buffer_load_dwordx4 v10, s[12:15], s4 offen lds

    s_add_u32 m0, s29, 3072
    s_add_u32 s4, s28, 24576
    buffer_load_dwordx4 v11, s[12:15], s4 offen lds

    s_add_u32 m0, s29, 4096
    s_add_u32 s4, s28, 32768
    buffer_load_dwordx4 v10, s[12:15], s4 offen lds

    s_add_u32 m0, s29, 5120
    s_add_u32 s4, s28, 40960
    buffer_load_dwordx4 v11, s[12:15], s4 offen lds

    s_add_u32 m0, s29, 6144
    s_add_u32 s4, s28, 49152
    buffer_load_dwordx4 v10, s[12:15], s4 offen lds

    s_add_u32 m0, s29, 7168
    s_add_u32 s4, s28, 57344
    buffer_load_dwordx4 v11, s[12:15], s4 offen lds

    s_add_u32 m0, s29, 32768
    s_add_u32 s4, s28, 262144
    buffer_load_dwordx4 v10, s[12:15], s4 offen lds

    s_add_u32 m0, s29, 33792
    s_add_u32 s4, s28, 270336
    buffer_load_dwordx4 v11, s[12:15], s4 offen lds

    s_add_u32 m0, s29, 34816
    s_add_u32 s4, s28, 278528
    buffer_load_dwordx4 v10, s[12:15], s4 offen lds

    s_add_u32 m0, s29, 35840
    s_add_u32 s4, s28, 286720
    buffer_load_dwordx4 v11, s[12:15], s4 offen lds

    s_add_u32 m0, s29, 36864
    s_add_u32 s4, s28, 294912
    buffer_load_dwordx4 v10, s[12:15], s4 offen lds

    s_add_u32 m0, s29, 37888
    s_add_u32 s4, s28, 303104
    buffer_load_dwordx4 v11, s[12:15], s4 offen lds

    s_add_u32 m0, s29, 38912
    s_add_u32 s4, s28, 311296
    buffer_load_dwordx4 v10, s[12:15], s4 offen lds

    s_add_u32 m0, s29, 39936
    s_add_u32 s4, s28, 319488
    buffer_load_dwordx4 v11, s[12:15], s4 offen lds

    s_add_u32 m0, s29, 65536
    s_add_u32 s4, s28, 524288
    buffer_load_dwordx4 v10, s[12:15], s4 offen lds

    s_add_u32 m0, s29, 66560
    s_add_u32 s4, s28, 532480
    buffer_load_dwordx4 v11, s[12:15], s4 offen lds

    s_add_u32 m0, s29, 67584
    s_add_u32 s4, s28, 540672
    buffer_load_dwordx4 v10, s[12:15], s4 offen lds

    s_add_u32 m0, s29, 68608
    s_add_u32 s4, s28, 548864
    buffer_load_dwordx4 v11, s[12:15], s4 offen lds

    s_add_u32 m0, s29, 69632
    s_add_u32 s4, s28, 557056
    buffer_load_dwordx4 v10, s[12:15], s4 offen lds

    s_add_u32 m0, s29, 70656
    s_add_u32 s4, s28, 565248
    buffer_load_dwordx4 v11, s[12:15], s4 offen lds

    s_add_u32 m0, s29, 71680
    s_add_u32 s4, s28, 573440
    buffer_load_dwordx4 v10, s[12:15], s4 offen lds

    s_add_u32 m0, s29, 72704
    s_add_u32 s4, s28, 581632
    buffer_load_dwordx4 v11, s[12:15], s4 offen lds

    s_add_u32 m0, s29, 98304
    s_add_u32 s4, s28, 786432
    buffer_load_dwordx4 v10, s[12:15], s4 offen lds

    s_add_u32 m0, s29, 99328
    s_add_u32 s4, s28, 794624
    buffer_load_dwordx4 v11, s[12:15], s4 offen lds

    s_add_u32 m0, s29, 100352
    s_add_u32 s4, s28, 802816
    buffer_load_dwordx4 v10, s[12:15], s4 offen lds

    s_add_u32 m0, s29, 101376
    s_add_u32 s4, s28, 811008
    buffer_load_dwordx4 v11, s[12:15], s4 offen lds

    s_add_u32 m0, s29, 102400
    s_add_u32 s4, s28, 819200
    buffer_load_dwordx4 v10, s[12:15], s4 offen lds

    s_add_u32 m0, s29, 103424
    s_add_u32 s4, s28, 827392
    buffer_load_dwordx4 v11, s[12:15], s4 offen lds

    s_add_u32 m0, s29, 104448
    s_add_u32 s4, s28, 835584
    buffer_load_dwordx4 v10, s[12:15], s4 offen lds

    s_add_u32 m0, s29, 105472
    s_add_u32 s4, s28, 843776
    buffer_load_dwordx4 v11, s[12:15], s4 offen lds

    s_waitcnt vmcnt(24)
    s_barrier
    ds_read_b64_tr_b16 a[0:1], v12 offset:0
    ds_read_b64_tr_b16 a[2:3], v12 offset:4096
    ds_read_b64_tr_b16 a[4:5], v13 offset:0
    ds_read_b64_tr_b16 a[6:7], v13 offset:4096
    ds_read_b64_tr_b16 a[8:9], v12 offset:8192
    ds_read_b64_tr_b16 a[10:11], v12 offset:12288
    ds_read_b64_tr_b16 a[12:13], v13 offset:8192
    ds_read_b64_tr_b16 a[14:15], v13 offset:12288
    ds_read_b64_tr_b16 a[16:17], v12 offset:16384
    ds_read_b64_tr_b16 a[18:19], v12 offset:20480
    ds_read_b64_tr_b16 a[20:21], v13 offset:16384
    ds_read_b64_tr_b16 a[22:23], v13 offset:20480
    ds_read_b64_tr_b16 a[24:25], v12 offset:24576
    ds_read_b64_tr_b16 a[26:27], v12 offset:28672
    ds_read_b64_tr_b16 a[28:29], v13 offset:24576
    ds_read_b64_tr_b16 a[30:31], v13 offset:28672
    s_waitcnt lgkmcnt(0)
    s_barrier
    s_add_u32 m0, s29, 0
    s_add_u32 s4, s28, 1048576
    buffer_load_dwordx4 v10, s[12:15], s4 offen lds

    s_add_u32 m0, s29, 1024
    s_add_u32 s4, s28, 1056768
    buffer_load_dwordx4 v11, s[12:15], s4 offen lds

    s_add_u32 m0, s29, 2048
    s_add_u32 s4, s28, 1064960
    buffer_load_dwordx4 v10, s[12:15], s4 offen lds

    s_add_u32 m0, s29, 3072
    s_add_u32 s4, s28, 1073152
    buffer_load_dwordx4 v11, s[12:15], s4 offen lds

    s_add_u32 m0, s29, 4096
    s_add_u32 s4, s28, 1081344
    buffer_load_dwordx4 v10, s[12:15], s4 offen lds

    s_add_u32 m0, s29, 5120
    s_add_u32 s4, s28, 1089536
    buffer_load_dwordx4 v11, s[12:15], s4 offen lds

    s_add_u32 m0, s29, 6144
    s_add_u32 s4, s28, 1097728
    buffer_load_dwordx4 v10, s[12:15], s4 offen lds

    s_add_u32 m0, s29, 7168
    s_add_u32 s4, s28, 1105920
    buffer_load_dwordx4 v11, s[12:15], s4 offen lds

    s_waitcnt vmcnt(24)
    s_barrier
    ds_read_b64_tr_b16 a[32:33], v12 offset:32768
    ds_read_b64_tr_b16 a[34:35], v12 offset:36864
    ds_read_b64_tr_b16 a[36:37], v13 offset:32768
    ds_read_b64_tr_b16 a[38:39], v13 offset:36864
    ds_read_b64_tr_b16 a[40:41], v12 offset:40960
    ds_read_b64_tr_b16 a[42:43], v12 offset:45056
    ds_read_b64_tr_b16 a[44:45], v13 offset:40960
    ds_read_b64_tr_b16 a[46:47], v13 offset:45056
    ds_read_b64_tr_b16 a[48:49], v12 offset:49152
    ds_read_b64_tr_b16 a[50:51], v12 offset:53248
    ds_read_b64_tr_b16 a[52:53], v13 offset:49152
    ds_read_b64_tr_b16 a[54:55], v13 offset:53248
    ds_read_b64_tr_b16 a[56:57], v12 offset:57344
    ds_read_b64_tr_b16 a[58:59], v12 offset:61440
    ds_read_b64_tr_b16 a[60:61], v13 offset:57344
    ds_read_b64_tr_b16 a[62:63], v13 offset:61440
    s_waitcnt lgkmcnt(0)
    s_barrier
    s_add_u32 m0, s29, 32768
    s_add_u32 s4, s28, 1310720
    buffer_load_dwordx4 v10, s[12:15], s4 offen lds

    s_add_u32 m0, s29, 33792
    s_add_u32 s4, s28, 1318912
    buffer_load_dwordx4 v11, s[12:15], s4 offen lds

    s_add_u32 m0, s29, 34816
    s_add_u32 s4, s28, 1327104
    buffer_load_dwordx4 v10, s[12:15], s4 offen lds

    s_add_u32 m0, s29, 35840
    s_add_u32 s4, s28, 1335296
    buffer_load_dwordx4 v11, s[12:15], s4 offen lds

    s_add_u32 m0, s29, 36864
    s_add_u32 s4, s28, 1343488
    buffer_load_dwordx4 v10, s[12:15], s4 offen lds

    s_add_u32 m0, s29, 37888
    s_add_u32 s4, s28, 1351680
    buffer_load_dwordx4 v11, s[12:15], s4 offen lds

    s_add_u32 m0, s29, 38912
    s_add_u32 s4, s28, 1359872
    buffer_load_dwordx4 v10, s[12:15], s4 offen lds

    s_add_u32 m0, s29, 39936
    s_add_u32 s4, s28, 1368064
    buffer_load_dwordx4 v11, s[12:15], s4 offen lds

    s_waitcnt vmcnt(24)
    s_barrier
    ds_read_b64_tr_b16 a[64:65], v14 offset:0
    ds_read_b64_tr_b16 a[66:67], v14 offset:4096
    ds_read_b64_tr_b16 a[68:69], v15 offset:0
    ds_read_b64_tr_b16 a[70:71], v15 offset:4096
    ds_read_b64_tr_b16 a[72:73], v14 offset:8192
    ds_read_b64_tr_b16 a[74:75], v14 offset:12288
    ds_read_b64_tr_b16 a[76:77], v15 offset:8192
    ds_read_b64_tr_b16 a[78:79], v15 offset:12288
    ds_read_b64_tr_b16 a[80:81], v14 offset:16384
    ds_read_b64_tr_b16 a[82:83], v14 offset:20480
    ds_read_b64_tr_b16 a[84:85], v15 offset:16384
    ds_read_b64_tr_b16 a[86:87], v15 offset:20480
    ds_read_b64_tr_b16 a[88:89], v14 offset:24576
    ds_read_b64_tr_b16 a[90:91], v14 offset:28672
    ds_read_b64_tr_b16 a[92:93], v15 offset:24576
    ds_read_b64_tr_b16 a[94:95], v15 offset:28672
    s_waitcnt lgkmcnt(0)
    s_barrier
    s_add_u32 m0, s29, 65536
    s_add_u32 s4, s28, 1572864
    buffer_load_dwordx4 v10, s[12:15], s4 offen lds

    s_add_u32 m0, s29, 66560
    s_add_u32 s4, s28, 1581056
    buffer_load_dwordx4 v11, s[12:15], s4 offen lds

    s_add_u32 m0, s29, 67584
    s_add_u32 s4, s28, 1589248
    buffer_load_dwordx4 v10, s[12:15], s4 offen lds

    s_add_u32 m0, s29, 68608
    s_add_u32 s4, s28, 1597440
    buffer_load_dwordx4 v11, s[12:15], s4 offen lds

    s_add_u32 m0, s29, 69632
    s_add_u32 s4, s28, 1605632
    buffer_load_dwordx4 v10, s[12:15], s4 offen lds

    s_add_u32 m0, s29, 70656
    s_add_u32 s4, s28, 1613824
    buffer_load_dwordx4 v11, s[12:15], s4 offen lds

    s_add_u32 m0, s29, 71680
    s_add_u32 s4, s28, 1622016
    buffer_load_dwordx4 v10, s[12:15], s4 offen lds

    s_add_u32 m0, s29, 72704
    s_add_u32 s4, s28, 1630208
    buffer_load_dwordx4 v11, s[12:15], s4 offen lds

    s_waitcnt vmcnt(24)
    s_barrier
    ds_read_b64_tr_b16 a[96:97], v14 offset:32768
    ds_read_b64_tr_b16 a[98:99], v14 offset:36864
    ds_read_b64_tr_b16 a[100:101], v15 offset:32768
    ds_read_b64_tr_b16 a[102:103], v15 offset:36864
    ds_read_b64_tr_b16 a[104:105], v14 offset:40960
    ds_read_b64_tr_b16 a[106:107], v14 offset:45056
    ds_read_b64_tr_b16 a[108:109], v15 offset:40960
    ds_read_b64_tr_b16 a[110:111], v15 offset:45056
    ds_read_b64_tr_b16 a[112:113], v14 offset:49152
    ds_read_b64_tr_b16 a[114:115], v14 offset:53248
    ds_read_b64_tr_b16 a[116:117], v15 offset:49152
    ds_read_b64_tr_b16 a[118:119], v15 offset:53248
    ds_read_b64_tr_b16 a[120:121], v14 offset:57344
    ds_read_b64_tr_b16 a[122:123], v14 offset:61440
    ds_read_b64_tr_b16 a[124:125], v15 offset:57344
    ds_read_b64_tr_b16 a[126:127], v15 offset:61440
    s_waitcnt lgkmcnt(0)
    s_barrier
    s_add_u32 m0, s29, 98304
    s_add_u32 s4, s28, 1835008
    buffer_load_dwordx4 v10, s[12:15], s4 offen lds

    s_add_u32 m0, s29, 99328
    s_add_u32 s4, s28, 1843200
    buffer_load_dwordx4 v11, s[12:15], s4 offen lds

    s_add_u32 m0, s29, 100352
    s_add_u32 s4, s28, 1851392
    buffer_load_dwordx4 v10, s[12:15], s4 offen lds

    s_add_u32 m0, s29, 101376
    s_add_u32 s4, s28, 1859584
    buffer_load_dwordx4 v11, s[12:15], s4 offen lds

    s_add_u32 m0, s29, 102400
    s_add_u32 s4, s28, 1867776
    buffer_load_dwordx4 v10, s[12:15], s4 offen lds

    s_add_u32 m0, s29, 103424
    s_add_u32 s4, s28, 1875968
    buffer_load_dwordx4 v11, s[12:15], s4 offen lds

    s_add_u32 m0, s29, 104448
    s_add_u32 s4, s28, 1884160
    buffer_load_dwordx4 v10, s[12:15], s4 offen lds

    s_add_u32 m0, s29, 105472
    s_add_u32 s4, s28, 1892352
    buffer_load_dwordx4 v11, s[12:15], s4 offen lds

    s_waitcnt vmcnt(24)
    s_barrier
    ds_read_b64_tr_b16 a[128:129], v12 offset:0
    ds_read_b64_tr_b16 a[130:131], v12 offset:4096
    ds_read_b64_tr_b16 a[132:133], v13 offset:0
    ds_read_b64_tr_b16 a[134:135], v13 offset:4096
    ds_read_b64_tr_b16 a[136:137], v12 offset:8192
    ds_read_b64_tr_b16 a[138:139], v12 offset:12288
    ds_read_b64_tr_b16 a[140:141], v13 offset:8192
    ds_read_b64_tr_b16 a[142:143], v13 offset:12288
    ds_read_b64_tr_b16 a[144:145], v12 offset:16384
    ds_read_b64_tr_b16 a[146:147], v12 offset:20480
    ds_read_b64_tr_b16 a[148:149], v13 offset:16384
    ds_read_b64_tr_b16 a[150:151], v13 offset:20480
    ds_read_b64_tr_b16 a[152:153], v12 offset:24576
    ds_read_b64_tr_b16 a[154:155], v12 offset:28672
    ds_read_b64_tr_b16 a[156:157], v13 offset:24576
    ds_read_b64_tr_b16 a[158:159], v13 offset:28672
    s_waitcnt lgkmcnt(0)
    s_barrier
    s_waitcnt vmcnt(16)
    s_barrier
    ds_read_b64_tr_b16 a[160:161], v12 offset:32768
    ds_read_b64_tr_b16 a[162:163], v12 offset:36864
    ds_read_b64_tr_b16 a[164:165], v13 offset:32768
    ds_read_b64_tr_b16 a[166:167], v13 offset:36864
    ds_read_b64_tr_b16 a[168:169], v12 offset:40960
    ds_read_b64_tr_b16 a[170:171], v12 offset:45056
    ds_read_b64_tr_b16 a[172:173], v13 offset:40960
    ds_read_b64_tr_b16 a[174:175], v13 offset:45056
    ds_read_b64_tr_b16 a[176:177], v12 offset:49152
    ds_read_b64_tr_b16 a[178:179], v12 offset:53248
    ds_read_b64_tr_b16 a[180:181], v13 offset:49152
    ds_read_b64_tr_b16 a[182:183], v13 offset:53248
    ds_read_b64_tr_b16 a[184:185], v12 offset:57344
    ds_read_b64_tr_b16 a[186:187], v12 offset:61440
    ds_read_b64_tr_b16 a[188:189], v13 offset:57344
    ds_read_b64_tr_b16 a[190:191], v13 offset:61440
    s_waitcnt lgkmcnt(0)
    s_barrier
    s_waitcnt vmcnt(8)
    s_barrier
    ds_read_b64_tr_b16 a[192:193], v14 offset:0
    ds_read_b64_tr_b16 a[194:195], v14 offset:4096
    ds_read_b64_tr_b16 a[196:197], v15 offset:0
    ds_read_b64_tr_b16 a[198:199], v15 offset:4096
    ds_read_b64_tr_b16 a[200:201], v14 offset:8192
    ds_read_b64_tr_b16 a[202:203], v14 offset:12288
    ds_read_b64_tr_b16 a[204:205], v15 offset:8192
    ds_read_b64_tr_b16 a[206:207], v15 offset:12288
    ds_read_b64_tr_b16 a[208:209], v14 offset:16384
    ds_read_b64_tr_b16 a[210:211], v14 offset:20480
    ds_read_b64_tr_b16 a[212:213], v15 offset:16384
    ds_read_b64_tr_b16 a[214:215], v15 offset:20480
    ds_read_b64_tr_b16 a[216:217], v14 offset:24576
    ds_read_b64_tr_b16 a[218:219], v14 offset:28672
    ds_read_b64_tr_b16 a[220:221], v15 offset:24576
    ds_read_b64_tr_b16 a[222:223], v15 offset:28672
    s_waitcnt lgkmcnt(0)
    s_barrier
    s_waitcnt vmcnt(0)
    s_barrier
    ds_read_b64_tr_b16 a[224:225], v14 offset:32768
    ds_read_b64_tr_b16 a[226:227], v14 offset:36864
    ds_read_b64_tr_b16 a[228:229], v15 offset:32768
    ds_read_b64_tr_b16 a[230:231], v15 offset:36864
    ds_read_b64_tr_b16 a[232:233], v14 offset:40960
    ds_read_b64_tr_b16 a[234:235], v14 offset:45056
    ds_read_b64_tr_b16 a[236:237], v15 offset:40960
    ds_read_b64_tr_b16 a[238:239], v15 offset:45056
    ds_read_b64_tr_b16 a[240:241], v14 offset:49152
    ds_read_b64_tr_b16 a[242:243], v14 offset:53248
    ds_read_b64_tr_b16 a[244:245], v15 offset:49152
    ds_read_b64_tr_b16 a[246:247], v15 offset:53248
    ds_read_b64_tr_b16 a[248:249], v14 offset:57344
    ds_read_b64_tr_b16 a[250:251], v14 offset:61440
    ds_read_b64_tr_b16 a[252:253], v15 offset:57344
    ds_read_b64_tr_b16 a[254:255], v15 offset:61440
    s_waitcnt lgkmcnt(0)
    s_barrier
    v_lshlrev_b32 v21, 4, v1
    s_lshr_b32 s4, s91, 1
    s_lshl_b32 s5, s4, 12
    v_add_u32 v17, s5, v21
    v_xor_b32 v18, 0x1000, v17
    s_lshl_b32 s4, s4, 4
    v_add_u32 v4, s4, v2
    s_lshl_b32 s5, s30, 5
    s_lshl_b32 s6, s24, 3
    s_add_u32 s5, s5, s6
    s_and_b32 s6, s91, 1
    s_lshl_b32 s6, s6, 2
    s_add_u32 s5, s5, s6
    v_add_u32 v5, s5, v3
    v_lshlrev_b32 v6, 3, v5
    v_lshl_add_u32 v22, v4, 11, v6
    v_lshlrev_b32 v6, 14, v5
    v_lshl_add_u32 v23, v4, 2, v6
    v_lshlrev_b32 v16, 2, v4
    v_and_b32 v4, 7, v1
    v_lshlrev_b32 v19, 8, v4
    s_lshl_b32 s33, s91, 11
    s_add_u32 s33, s33, 92299264
    s_lshl_b32 s35, s24, 14
    s_lshl_b32 s36, s91, 16
    s_add_u32 s36, s36, s35
    s_add_u32 s36, s36, 50331648
    s_mov_b32 s37, 0
    s_mov_b32 s38, 0
    s_mov_b32 s39, 0
    v_lshlrev_b32 v6, 11, v1

    v_mov_b32 v5, 0
    s_mov_b32 s62, 0
    s_mov_b32 s5, 32
.wc_472:
    buffer_load_dword v4, v5, s[20:23], s5 offen sc1
    s_waitcnt vmcnt(0)
    v_readfirstlane_b32 s4, v4
    s_lshr_b32 s4, s4, 0
    s_and_b32 s4, s4, 0xffff
    s_cmp_ge_u32 s4, 256
    s_cbranch_scc1 .wcd_473
    s_sleep 6
    s_add_u32 s62, s62, 1
    s_cmp_gt_u32 s62, 0x400000
    s_cbranch_scc1 .mg_end_1
    s_branch .wc_472

.wcd_473:
    s_mov_b32 s62, 0
    s_mov_b64 exec, 15
.wf_474:
    buffer_load_dword v4, v6, s[8:11], s57 offen sc1
    s_waitcnt vmcnt(0)
    v_cmp_gt_u32 vcc, 64, v4
    s_cbranch_vccz .wfd_475
    s_sleep 2
    s_add_u32 s62, s62, 1
    s_cmp_gt_u32 s62, 0x400000
    s_cbranch_scc1 .mg_end_1
    s_branch .wf_474

.wfd_475:
    s_mov_b64 exec, -1
    v_mov_b32 v5, 0
    s_mov_b32 s62, 0
    s_mov_b32 s5, 44
.wc_476:
    buffer_load_dword v4, v5, s[20:23], s5 offen sc1
    s_waitcnt vmcnt(0)
    v_readfirstlane_b32 s4, v4
    s_lshr_b32 s4, s4, 0
    s_and_b32 s4, s4, 0xffff
    s_cmp_ge_u32 s4, 32
    s_cbranch_scc1 .wcd_477
    s_sleep 6
    s_add_u32 s62, s62, 1
    s_cmp_gt_u32 s62, 0x400000
    s_cbranch_scc1 .mg_end_1
    s_branch .wc_476

.wcd_477:
.g2blk_478:
    s_mov_b32 s62, 0
.g2bw_487:
    buffer_load_dword v20, v19, s[8:11], s33 offen sc1
    s_waitcnt vmcnt(0)
    s_and_b32 s4, s31, 3
    s_lshl_b32 s4, s4, 1
    s_add_u32 s5, s4, 1
    v_readlane_b32 s4, v20, s4
    v_readlane_b32 s5, v20, s5
    s_lshr_b32 s6, s31, 2
    s_min_u32 s4, s4, s5
    s_cmp_gt_u32 s4, s6

    s_cbranch_scc1 .g2rd_488
    s_sleep 1
    s_add_u32 s62, s62, 1
    s_cmp_gt_u32 s62, 0x400000
    s_cbranch_scc1 .mg_end_1
    s_branch .g2bw_487

.g2rd_488:
    s_lshl_b32 s48, s31, 18
    s_add_u32 s48, s48, s36
    s_add_u32 s49, s39, s35
    s_xor_b32 s39, s39, 0x10000

    s_add_u32 m0, s49, 0
    s_add_u32 s50, s48, 0
    buffer_load_dwordx4 v21, s[8:11], s50 offen offset:0 lds
    buffer_load_dwordx4 v21, s[8:11], s50 offen offset:1024 lds
    buffer_load_dwordx4 v21, s[8:11], s50 offen offset:2048 lds
    buffer_load_dwordx4 v21, s[8:11], s50 offen offset:3072 lds
    s_add_u32 m0, s49, 4096
    s_add_u32 s50, s48, 4096
    buffer_load_dwordx4 v21, s[8:11], s50 offen offset:0 lds
    buffer_load_dwordx4 v21, s[8:11], s50 offen offset:1024 lds
    buffer_load_dwordx4 v21, s[8:11], s50 offen offset:2048 lds
    buffer_load_dwordx4 v21, s[8:11], s50 offen offset:3072 lds
    s_add_u32 m0, s49, 8192
    s_add_u32 s50, s48, 8192
    buffer_load_dwordx4 v21, s[8:11], s50 offen offset:0 lds
    buffer_load_dwordx4 v21, s[8:11], s50 offen offset:1024 lds
    buffer_load_dwordx4 v21, s[8:11], s50 offen offset:2048 lds
    buffer_load_dwordx4 v21, s[8:11], s50 offen offset:3072 lds
    s_add_u32 m0, s49, 12288
    s_add_u32 s50, s48, 12288
    buffer_load_dwordx4 v21, s[8:11], s50 offen offset:0 lds
    buffer_load_dwordx4 v21, s[8:11], s50 offen offset:1024 lds
    buffer_load_dwordx4 v21, s[8:11], s50 offen offset:2048 lds
    buffer_load_dwordx4 v21, s[8:11], s50 offen offset:3072 lds
    s_waitcnt vmcnt(0)
.g2go_479:
    s_barrier
    ds_read_b128 v[32:35], v17 offset:0
    ds_read_b128 v[36:39], v18 offset:0
    ds_read_b128 v[40:43], v17 offset:1024
    ds_read_b128 v[44:47], v18 offset:1024
    ds_read_b128 v[48:51], v17 offset:2048
    ds_read_b128 v[52:55], v18 offset:2048
    s_add_u32 s53, s31, 3
    s_cmp_eq_u32 s38, 0
    s_cbranch_scc1 .g2np_481
    s_sub_u32 s54, s31, 3
    s_sub_u32 s55, s37, 0x10000
    s_add_u32 s51, s34, s55
    s_lshl_b32 s52, s54, 16
    s_lshl_b32 s5, s54, 7
    s_add_u32 s4, s5, 117440512
    s_add_u32 s6, s5, 117448704
    s_add_u32 s5, s5, 121634816
    buffer_load_dwordx2 v[96:97], v22, s[16:19], s52 offen
    buffer_load_dword v98, v23, s[8:11], s4 offen
    buffer_load_dword v99, v23, s[8:11], s6 offen
    buffer_load_dword v100, v16, s[8:11], s5 offen

    buffer_load_dwordx4 v[84:87], v7, s[8:11], s51 offen sc1
    buffer_load_dwordx4 v[88:91], v8, s[8:11], s51 offen sc1
    buffer_load_dwordx4 v[92:95], v9, s[8:11], s51 offen sc1
.g2np_481:
    s_and_b32 s4, s53, 3
    s_lshl_b32 s4, s4, 1
    s_add_u32 s5, s4, 1
    v_readlane_b32 s4, v20, s4
    v_readlane_b32 s5, v20, s5
    s_lshr_b32 s6, s53, 2
    s_min_u32 s4, s4, s5
    s_cmp_gt_u32 s4, s6

    s_cselect_b32 s56, 1, 0
    s_cmp_lt_u32 s53, 64
    s_cselect_b32 s56, s56, 0
    buffer_load_dword v20, v19, s[8:11], s33 offen sc1
    s_cmp_eq_u32 s56, 0
    s_cbranch_scc1 .g2nd_482
    s_lshl_b32 s48, s53, 18
    s_add_u32 s48, s48, s36
    s_add_u32 s49, s39, s35
    s_xor_b32 s39, s39, 0x10000

    s_waitcnt lgkmcnt(4)
    v_mfma_f32_16x16x32_bf16 v[64:67], a[0:3], v[32:35], 0
    ds_read_b128 v[56:59], v17 offset:3072
    s_add_u32 m0, s49, 0
    s_add_u32 s50, s48, 0
    v_mfma_f32_16x16x32_bf16 v[68:71], a[4:7], v[32:35], 0
    buffer_load_dwordx4 v21, s[8:11], s50 offen offset:0 lds
    v_mfma_f32_16x16x32_bf16 v[72:75], a[0:3], v[36:39], 0
    ds_read_b128 v[60:63], v18 offset:3072
    v_mfma_f32_16x16x32_bf16 v[76:79], a[4:7], v[36:39], 0
    s_waitcnt lgkmcnt(4)
    v_mfma_f32_16x16x32_bf16 v[64:67], a[8:11], v[40:43], v[64:67]
    ds_read_b128 v[32:35], v17 offset:8192
    v_mfma_f32_16x16x32_bf16 v[68:71], a[12:15], v[40:43], v[68:71]
    buffer_load_dwordx4 v21, s[8:11], s50 offen offset:1024 lds
    v_mfma_f32_16x16x32_bf16 v[72:75], a[8:11], v[44:47], v[72:75]
    ds_read_b128 v[36:39], v18 offset:8192
    v_mfma_f32_16x16x32_bf16 v[76:79], a[12:15], v[44:47], v[76:79]
    s_waitcnt lgkmcnt(4)
    v_mfma_f32_16x16x32_bf16 v[64:67], a[16:19], v[48:51], v[64:67]
    ds_read_b128 v[40:43], v17 offset:9216
    v_mfma_f32_16x16x32_bf16 v[68:71], a[20:23], v[48:51], v[68:71]
    buffer_load_dwordx4 v21, s[8:11], s50 offen offset:2048 lds
    v_mfma_f32_16x16x32_bf16 v[72:75], a[16:19], v[52:55], v[72:75]
    ds_read_b128 v[44:47], v18 offset:9216
    v_mfma_f32_16x16x32_bf16 v[76:79], a[20:23], v[52:55], v[76:79]
    s_waitcnt lgkmcnt(4)
    v_mfma_f32_16x16x32_bf16 v[64:67], a[24:27], v[56:59], v[64:67]
    ds_read_b128 v[48:51], v17 offset:10240
    v_mfma_f32_16x16x32_bf16 v[68:71], a[28:31], v[56:59], v[68:71]
    buffer_load_dwordx4 v21, s[8:11], s50 offen offset:3072 lds
    v_mfma_f32_16x16x32_bf16 v[72:75], a[24:27], v[60:63], v[72:75]
    ds_read_b128 v[52:55], v18 offset:10240
    v_mfma_f32_16x16x32_bf16 v[76:79], a[28:31], v[60:63], v[76:79]
    s_waitcnt lgkmcnt(4)
    v_mfma_f32_16x16x32_bf16 v[64:67], a[32:35], v[32:35], v[64:67]
    ds_read_b128 v[56:59], v17 offset:11264
    s_add_u32 m0, s49, 4096
    s_add_u32 s50, s48, 4096
    v_mfma_f32_16x16x32_bf16 v[68:71], a[36:39], v[32:35], v[68:71]
    buffer_load_dwordx4 v21, s[8:11], s50 offen offset:0 lds
    v_mfma_f32_16x16x32_bf16 v[72:75], a[32:35], v[36:39], v[72:75]
    ds_read_b128 v[60:63], v18 offset:11264
    v_mfma_f32_16x16x32_bf16 v[76:79], a[36:39], v[36:39], v[76:79]
    s_waitcnt lgkmcnt(4)
    v_mfma_f32_16x16x32_bf16 v[64:67], a[40:43], v[40:43], v[64:67]
    ds_read_b128 v[32:35], v17 offset:16384
    v_mfma_f32_16x16x32_bf16 v[68:71], a[44:47], v[40:43], v[68:71]
    buffer_load_dwordx4 v21, s[8:11], s50 offen offset:1024 lds
    v_mfma_f32_16x16x32_bf16 v[72:75], a[40:43], v[44:47], v[72:75]
    ds_read_b128 v[36:39], v18 offset:16384
    v_mfma_f32_16x16x32_bf16 v[76:79], a[44:47], v[44:47], v[76:79]
    s_waitcnt lgkmcnt(4)
    v_mfma_f32_16x16x32_bf16 v[64:67], a[48:51], v[48:51], v[64:67]
    ds_read_b128 v[40:43], v17 offset:17408
    v_mfma_f32_16x16x32_bf16 v[68:71], a[52:55], v[48:51], v[68:71]
    buffer_load_dwordx4 v21, s[8:11], s50 offen offset:2048 lds
    v_mfma_f32_16x16x32_bf16 v[72:75], a[48:51], v[52:55], v[72:75]
    ds_read_b128 v[44:47], v18 offset:17408
    v_mfma_f32_16x16x32_bf16 v[76:79], a[52:55], v[52:55], v[76:79]
    s_waitcnt lgkmcnt(4)
    v_mfma_f32_16x16x32_bf16 v[64:67], a[56:59], v[56:59], v[64:67]
    ds_read_b128 v[48:51], v17 offset:18432
    v_mfma_f32_16x16x32_bf16 v[68:71], a[60:63], v[56:59], v[68:71]
    buffer_load_dwordx4 v21, s[8:11], s50 offen offset:3072 lds
    v_mfma_f32_16x16x32_bf16 v[72:75], a[56:59], v[60:63], v[72:75]
    ds_read_b128 v[52:55], v18 offset:18432
    v_mfma_f32_16x16x32_bf16 v[76:79], a[60:63], v[60:63], v[76:79]
    s_waitcnt lgkmcnt(4)
    v_mfma_f32_16x16x32_bf16 v[64:67], a[64:67], v[32:35], v[64:67]
    ds_read_b128 v[56:59], v17 offset:19456
    s_add_u32 m0, s49, 8192
    s_add_u32 s50, s48, 8192
    v_mfma_f32_16x16x32_bf16 v[68:71], a[68:71], v[32:35], v[68:71]
    buffer_load_dwordx4 v21, s[8:11], s50 offen offset:0 lds
    v_mfma_f32_16x16x32_bf16 v[72:75], a[64:67], v[36:39], v[72:75]
    ds_read_b128 v[60:63], v18 offset:19456
    v_mfma_f32_16x16x32_bf16 v[76:79], a[68:71], v[36:39], v[76:79]
    s_waitcnt lgkmcnt(4)
    v_mfma_f32_16x16x32_bf16 v[64:67], a[72:75], v[40:43], v[64:67]
    ds_read_b128 v[32:35], v17 offset:24576
    v_mfma_f32_16x16x32_bf16 v[68:71], a[76:79], v[40:43], v[68:71]
    buffer_load_dwordx4 v21, s[8:11], s50 offen offset:1024 lds
    v_mfma_f32_16x16x32_bf16 v[72:75], a[72:75], v[44:47], v[72:75]
    ds_read_b128 v[36:39], v18 offset:24576
    v_mfma_f32_16x16x32_bf16 v[76:79], a[76:79], v[44:47], v[76:79]
    s_waitcnt lgkmcnt(4)
    v_mfma_f32_16x16x32_bf16 v[64:67], a[80:83], v[48:51], v[64:67]
    ds_read_b128 v[40:43], v17 offset:25600
    v_mfma_f32_16x16x32_bf16 v[68:71], a[84:87], v[48:51], v[68:71]
    buffer_load_dwordx4 v21, s[8:11], s50 offen offset:2048 lds
    v_mfma_f32_16x16x32_bf16 v[72:75], a[80:83], v[52:55], v[72:75]
    ds_read_b128 v[44:47], v18 offset:25600
    v_mfma_f32_16x16x32_bf16 v[76:79], a[84:87], v[52:55], v[76:79]
    s_waitcnt lgkmcnt(4)
    v_mfma_f32_16x16x32_bf16 v[64:67], a[88:91], v[56:59], v[64:67]
    ds_read_b128 v[48:51], v17 offset:26624
    v_mfma_f32_16x16x32_bf16 v[68:71], a[92:95], v[56:59], v[68:71]
    buffer_load_dwordx4 v21, s[8:11], s50 offen offset:3072 lds
    v_mfma_f32_16x16x32_bf16 v[72:75], a[88:91], v[60:63], v[72:75]
    ds_read_b128 v[52:55], v18 offset:26624
    v_mfma_f32_16x16x32_bf16 v[76:79], a[92:95], v[60:63], v[76:79]
    s_waitcnt lgkmcnt(4)
    v_mfma_f32_16x16x32_bf16 v[64:67], a[96:99], v[32:35], v[64:67]
    ds_read_b128 v[56:59], v17 offset:27648
    s_add_u32 m0, s49, 12288
    s_add_u32 s50, s48, 12288
    v_mfma_f32_16x16x32_bf16 v[68:71], a[100:103], v[32:35], v[68:71]
    buffer_load_dwordx4 v21, s[8:11], s50 offen offset:0 lds
    v_mfma_f32_16x16x32_bf16 v[72:75], a[96:99], v[36:39], v[72:75]
    ds_read_b128 v[60:63], v18 offset:27648
    v_mfma_f32_16x16x32_bf16 v[76:79], a[100:103], v[36:39], v[76:79]
    s_waitcnt lgkmcnt(4)
    v_mfma_f32_16x16x32_bf16 v[64:67], a[104:107], v[40:43], v[64:67]
    ds_read_b128 v[32:35], v17 offset:32768
    v_mfma_f32_16x16x32_bf16 v[68:71], a[108:111], v[40:43], v[68:71]
    buffer_load_dwordx4 v21, s[8:11], s50 offen offset:1024 lds
    v_mfma_f32_16x16x32_bf16 v[72:75], a[104:107], v[44:47], v[72:75]
    ds_read_b128 v[36:39], v18 offset:32768
    v_mfma_f32_16x16x32_bf16 v[76:79], a[108:111], v[44:47], v[76:79]
    s_waitcnt lgkmcnt(4)
    v_mfma_f32_16x16x32_bf16 v[64:67], a[112:115], v[48:51], v[64:67]
    ds_read_b128 v[40:43], v17 offset:33792
    v_mfma_f32_16x16x32_bf16 v[68:71], a[116:119], v[48:51], v[68:71]
    buffer_load_dwordx4 v21, s[8:11], s50 offen offset:2048 lds
    v_mfma_f32_16x16x32_bf16 v[72:75], a[112:115], v[52:55], v[72:75]
    ds_read_b128 v[44:47], v18 offset:33792
    v_mfma_f32_16x16x32_bf16 v[76:79], a[116:119], v[52:55], v[76:79]
    s_waitcnt lgkmcnt(4)
    v_mfma_f32_16x16x32_bf16 v[64:67], a[120:123], v[56:59], v[64:67]
    ds_read_b128 v[48:51], v17 offset:34816
    v_mfma_f32_16x16x32_bf16 v[68:71], a[124:127], v[56:59], v[68:71]
    buffer_load_dwordx4 v21, s[8:11], s50 offen offset:3072 lds
    v_mfma_f32_16x16x32_bf16 v[72:75], a[120:123], v[60:63], v[72:75]
    ds_read_b128 v[52:55], v18 offset:34816
    v_mfma_f32_16x16x32_bf16 v[76:79], a[124:127], v[60:63], v[76:79]
    s_waitcnt lgkmcnt(4)
    v_mfma_f32_16x16x32_bf16 v[64:67], a[128:131], v[32:35], v[64:67]
    ds_read_b128 v[56:59], v17 offset:35840
    v_mfma_f32_16x16x32_bf16 v[68:71], a[132:135], v[32:35], v[68:71]
    v_mfma_f32_16x16x32_bf16 v[72:75], a[128:131], v[36:39], v[72:75]
    ds_read_b128 v[60:63], v18 offset:35840
    v_mfma_f32_16x16x32_bf16 v[76:79], a[132:135], v[36:39], v[76:79]
    s_waitcnt lgkmcnt(4)
    v_mfma_f32_16x16x32_bf16 v[64:67], a[136:139], v[40:43], v[64:67]
    ds_read_b128 v[32:35], v17 offset:40960
    v_mfma_f32_16x16x32_bf16 v[68:71], a[140:143], v[40:43], v[68:71]
    v_mfma_f32_16x16x32_bf16 v[72:75], a[136:139], v[44:47], v[72:75]
    ds_read_b128 v[36:39], v18 offset:40960
    v_mfma_f32_16x16x32_bf16 v[76:79], a[140:143], v[44:47], v[76:79]
    s_waitcnt lgkmcnt(4)
    v_mfma_f32_16x16x32_bf16 v[64:67], a[144:147], v[48:51], v[64:67]
    ds_read_b128 v[40:43], v17 offset:41984
    v_mfma_f32_16x16x32_bf16 v[68:71], a[148:151], v[48:51], v[68:71]
    v_mfma_f32_16x16x32_bf16 v[72:75], a[144:147], v[52:55], v[72:75]
    ds_read_b128 v[44:47], v18 offset:41984
    v_mfma_f32_16x16x32_bf16 v[76:79], a[148:151], v[52:55], v[76:79]
    s_waitcnt lgkmcnt(4)
    v_mfma_f32_16x16x32_bf16 v[64:67], a[152:155], v[56:59], v[64:67]
    ds_read_b128 v[48:51], v17 offset:43008
    v_mfma_f32_16x16x32_bf16 v[68:71], a[156:159], v[56:59], v[68:71]
    v_mfma_f32_16x16x32_bf16 v[72:75], a[152:155], v[60:63], v[72:75]
    ds_read_b128 v[52:55], v18 offset:43008
    v_mfma_f32_16x16x32_bf16 v[76:79], a[156:159], v[60:63], v[76:79]
    s_waitcnt lgkmcnt(4)
    v_mfma_f32_16x16x32_bf16 v[64:67], a[160:163], v[32:35], v[64:67]
    ds_read_b128 v[56:59], v17 offset:44032
    v_mfma_f32_16x16x32_bf16 v[68:71], a[164:167], v[32:35], v[68:71]
    v_mfma_f32_16x16x32_bf16 v[72:75], a[160:163], v[36:39], v[72:75]
    ds_read_b128 v[60:63], v18 offset:44032
    v_mfma_f32_16x16x32_bf16 v[76:79], a[164:167], v[36:39], v[76:79]
    s_waitcnt lgkmcnt(4)
    v_mfma_f32_16x16x32_bf16 v[64:67], a[168:171], v[40:43], v[64:67]
    ds_read_b128 v[32:35], v17 offset:49152
    v_mfma_f32_16x16x32_bf16 v[68:71], a[172:175], v[40:43], v[68:71]
    v_mfma_f32_16x16x32_bf16 v[72:75], a[168:171], v[44:47], v[72:75]
    ds_read_b128 v[36:39], v18 offset:49152
    v_mfma_f32_16x16x32_bf16 v[76:79], a[172:175], v[44:47], v[76:79]
    s_waitcnt lgkmcnt(4)
    v_mfma_f32_16x16x32_bf16 v[64:67], a[176:179], v[48:51], v[64:67]
    ds_read_b128 v[40:43], v17 offset:50176
    v_mfma_f32_16x16x32_bf16 v[68:71], a[180:183], v[48:51], v[68:71]
    v_mfma_f32_16x16x32_bf16 v[72:75], a[176:179], v[52:55], v[72:75]
    ds_read_b128 v[44:47], v18 offset:50176
    v_mfma_f32_16x16x32_bf16 v[76:79], a[180:183], v[52:55], v[76:79]
    s_waitcnt lgkmcnt(4)
    v_mfma_f32_16x16x32_bf16 v[64:67], a[184:187], v[56:59], v[64:67]
    ds_read_b128 v[48:51], v17 offset:51200
    v_mfma_f32_16x16x32_bf16 v[68:71], a[188:191], v[56:59], v[68:71]
    v_mfma_f32_16x16x32_bf16 v[72:75], a[184:187], v[60:63], v[72:75]
    ds_read_b128 v[52:55], v18 offset:51200
    v_mfma_f32_16x16x32_bf16 v[76:79], a[188:191], v[60:63], v[76:79]
    s_waitcnt lgkmcnt(4)
    v_mfma_f32_16x16x32_bf16 v[64:67], a[192:195], v[32:35], v[64:67]
    ds_read_b128 v[56:59], v17 offset:52224
    v_mfma_f32_16x16x32_bf16 v[68:71], a[196:199], v[32:35], v[68:71]
    v_mfma_f32_16x16x32_bf16 v[72:75], a[192:195], v[36:39], v[72:75]
    ds_read_b128 v[60:63], v18 offset:52224
    v_mfma_f32_16x16x32_bf16 v[76:79], a[196:199], v[36:39], v[76:79]
    s_waitcnt lgkmcnt(4)
    v_mfma_f32_16x16x32_bf16 v[64:67], a[200:203], v[40:43], v[64:67]
    ds_read_b128 v[32:35], v17 offset:57344
    v_mfma_f32_16x16x32_bf16 v[68:71], a[204:207], v[40:43], v[68:71]
    v_mfma_f32_16x16x32_bf16 v[72:75], a[200:203], v[44:47], v[72:75]
    ds_read_b128 v[36:39], v18 offset:57344
    v_mfma_f32_16x16x32_bf16 v[76:79], a[204:207], v[44:47], v[76:79]
    s_waitcnt lgkmcnt(4)
    v_mfma_f32_16x16x32_bf16 v[64:67], a[208:211], v[48:51], v[64:67]
    ds_read_b128 v[40:43], v17 offset:58368
    v_mfma_f32_16x16x32_bf16 v[68:71], a[212:215], v[48:51], v[68:71]
    v_mfma_f32_16x16x32_bf16 v[72:75], a[208:211], v[52:55], v[72:75]
    ds_read_b128 v[44:47], v18 offset:58368
    v_mfma_f32_16x16x32_bf16 v[76:79], a[212:215], v[52:55], v[76:79]
    s_waitcnt lgkmcnt(4)
    v_mfma_f32_16x16x32_bf16 v[64:67], a[216:219], v[56:59], v[64:67]
    ds_read_b128 v[48:51], v17 offset:59392
    v_mfma_f32_16x16x32_bf16 v[68:71], a[220:223], v[56:59], v[68:71]
    v_mfma_f32_16x16x32_bf16 v[72:75], a[216:219], v[60:63], v[72:75]
    ds_read_b128 v[52:55], v18 offset:59392
    v_mfma_f32_16x16x32_bf16 v[76:79], a[220:223], v[60:63], v[76:79]
    s_waitcnt lgkmcnt(4)
    v_mfma_f32_16x16x32_bf16 v[64:67], a[224:227], v[32:35], v[64:67]
    ds_read_b128 v[56:59], v17 offset:60416
    v_mfma_f32_16x16x32_bf16 v[68:71], a[228:231], v[32:35], v[68:71]
    v_mfma_f32_16x16x32_bf16 v[72:75], a[224:227], v[36:39], v[72:75]
    ds_read_b128 v[60:63], v18 offset:60416
    v_mfma_f32_16x16x32_bf16 v[76:79], a[228:231], v[36:39], v[76:79]
    s_waitcnt lgkmcnt(4)
    v_mfma_f32_16x16x32_bf16 v[64:67], a[232:235], v[40:43], v[64:67]
    v_mfma_f32_16x16x32_bf16 v[68:71], a[236:239], v[40:43], v[68:71]
    v_mfma_f32_16x16x32_bf16 v[72:75], a[232:235], v[44:47], v[72:75]
    v_mfma_f32_16x16x32_bf16 v[76:79], a[236:239], v[44:47], v[76:79]
    s_waitcnt lgkmcnt(2)
    v_mfma_f32_16x16x32_bf16 v[64:67], a[240:243], v[48:51], v[64:67]
    v_mfma_f32_16x16x32_bf16 v[68:71], a[244:247], v[48:51], v[68:71]
    v_mfma_f32_16x16x32_bf16 v[72:75], a[240:243], v[52:55], v[72:75]
    v_mfma_f32_16x16x32_bf16 v[76:79], a[244:247], v[52:55], v[76:79]
    s_waitcnt lgkmcnt(0)
    v_mfma_f32_16x16x32_bf16 v[64:67], a[248:251], v[56:59], v[64:67]
    v_mfma_f32_16x16x32_bf16 v[68:71], a[252:255], v[56:59], v[68:71]
    v_mfma_f32_16x16x32_bf16 v[72:75], a[248:251], v[60:63], v[72:75]
    v_mfma_f32_16x16x32_bf16 v[76:79], a[252:255], v[60:63], v[76:79]
    v_xor_b32 v17, 0x10000, v17
    v_xor_b32 v18, 0x10000, v18
    s_add_u32 s4, s34, s37
    s_waitcnt vmcnt(16)

    s_branch .g2st_483
.g2nd_482:
    s_waitcnt lgkmcnt(4)
    v_mfma_f32_16x16x32_bf16 v[64:67], a[0:3], v[32:35], 0
    ds_read_b128 v[56:59], v17 offset:3072
    v_mfma_f32_16x16x32_bf16 v[68:71], a[4:7], v[32:35], 0
    v_mfma_f32_16x16x32_bf16 v[72:75], a[0:3], v[36:39], 0
    ds_read_b128 v[60:63], v18 offset:3072
    v_mfma_f32_16x16x32_bf16 v[76:79], a[4:7], v[36:39], 0
    s_waitcnt lgkmcnt(4)
    v_mfma_f32_16x16x32_bf16 v[64:67], a[8:11], v[40:43], v[64:67]
    ds_read_b128 v[32:35], v17 offset:8192
    v_mfma_f32_16x16x32_bf16 v[68:71], a[12:15], v[40:43], v[68:71]
    v_mfma_f32_16x16x32_bf16 v[72:75], a[8:11], v[44:47], v[72:75]
    ds_read_b128 v[36:39], v18 offset:8192
    v_mfma_f32_16x16x32_bf16 v[76:79], a[12:15], v[44:47], v[76:79]
    s_waitcnt lgkmcnt(4)
    v_mfma_f32_16x16x32_bf16 v[64:67], a[16:19], v[48:51], v[64:67]
    ds_read_b128 v[40:43], v17 offset:9216
    v_mfma_f32_16x16x32_bf16 v[68:71], a[20:23], v[48:51], v[68:71]
    v_mfma_f32_16x16x32_bf16 v[72:75], a[16:19], v[52:55], v[72:75]
    ds_read_b128 v[44:47], v18 offset:9216
    v_mfma_f32_16x16x32_bf16 v[76:79], a[20:23], v[52:55], v[76:79]
    s_waitcnt lgkmcnt(4)
    v_mfma_f32_16x16x32_bf16 v[64:67], a[24:27], v[56:59], v[64:67]
    ds_read_b128 v[48:51], v17 offset:10240
    v_mfma_f32_16x16x32_bf16 v[68:71], a[28:31], v[56:59], v[68:71]
    v_mfma_f32_16x16x32_bf16 v[72:75], a[24:27], v[60:63], v[72:75]
    ds_read_b128 v[52:55], v18 offset:10240
    v_mfma_f32_16x16x32_bf16 v[76:79], a[28:31], v[60:63], v[76:79]
    s_waitcnt lgkmcnt(4)
    v_mfma_f32_16x16x32_bf16 v[64:67], a[32:35], v[32:35], v[64:67]
    ds_read_b128 v[56:59], v17 offset:11264
    v_mfma_f32_16x16x32_bf16 v[68:71], a[36:39], v[32:35], v[68:71]
    v_mfma_f32_16x16x32_bf16 v[72:75], a[32:35], v[36:39], v[72:75]
    ds_read_b128 v[60:63], v18 offset:11264
    v_mfma_f32_16x16x32_bf16 v[76:79], a[36:39], v[36:39], v[76:79]
    s_waitcnt lgkmcnt(4)
    v_mfma_f32_16x16x32_bf16 v[64:67], a[40:43], v[40:43], v[64:67]
    ds_read_b128 v[32:35], v17 offset:16384
    v_mfma_f32_16x16x32_bf16 v[68:71], a[44:47], v[40:43], v[68:71]
    v_mfma_f32_16x16x32_bf16 v[72:75], a[40:43], v[44:47], v[72:75]
    ds_read_b128 v[36:39], v18 offset:16384
    v_mfma_f32_16x16x32_bf16 v[76:79], a[44:47], v[44:47], v[76:79]
    s_waitcnt lgkmcnt(4)
    v_mfma_f32_16x16x32_bf16 v[64:67], a[48:51], v[48:51], v[64:67]
    ds_read_b128 v[40:43], v17 offset:17408
    v_mfma_f32_16x16x32_bf16 v[68:71], a[52:55], v[48:51], v[68:71]
    v_mfma_f32_16x16x32_bf16 v[72:75], a[48:51], v[52:55], v[72:75]
    ds_read_b128 v[44:47], v18 offset:17408
    v_mfma_f32_16x16x32_bf16 v[76:79], a[52:55], v[52:55], v[76:79]
    s_waitcnt lgkmcnt(4)
    v_mfma_f32_16x16x32_bf16 v[64:67], a[56:59], v[56:59], v[64:67]
    ds_read_b128 v[48:51], v17 offset:18432
    v_mfma_f32_16x16x32_bf16 v[68:71], a[60:63], v[56:59], v[68:71]
    v_mfma_f32_16x16x32_bf16 v[72:75], a[56:59], v[60:63], v[72:75]
    ds_read_b128 v[52:55], v18 offset:18432
    v_mfma_f32_16x16x32_bf16 v[76:79], a[60:63], v[60:63], v[76:79]
    s_waitcnt lgkmcnt(4)
    v_mfma_f32_16x16x32_bf16 v[64:67], a[64:67], v[32:35], v[64:67]
    ds_read_b128 v[56:59], v17 offset:19456
    v_mfma_f32_16x16x32_bf16 v[68:71], a[68:71], v[32:35], v[68:71]
    v_mfma_f32_16x16x32_bf16 v[72:75], a[64:67], v[36:39], v[72:75]
    ds_read_b128 v[60:63], v18 offset:19456
    v_mfma_f32_16x16x32_bf16 v[76:79], a[68:71], v[36:39], v[76:79]
    s_waitcnt lgkmcnt(4)
    v_mfma_f32_16x16x32_bf16 v[64:67], a[72:75], v[40:43], v[64:67]
    ds_read_b128 v[32:35], v17 offset:24576
    v_mfma_f32_16x16x32_bf16 v[68:71], a[76:79], v[40:43], v[68:71]
    v_mfma_f32_16x16x32_bf16 v[72:75], a[72:75], v[44:47], v[72:75]
    ds_read_b128 v[36:39], v18 offset:24576
    v_mfma_f32_16x16x32_bf16 v[76:79], a[76:79], v[44:47], v[76:79]
    s_waitcnt lgkmcnt(4)
    v_mfma_f32_16x16x32_bf16 v[64:67], a[80:83], v[48:51], v[64:67]
    ds_read_b128 v[40:43], v17 offset:25600
    v_mfma_f32_16x16x32_bf16 v[68:71], a[84:87], v[48:51], v[68:71]
    v_mfma_f32_16x16x32_bf16 v[72:75], a[80:83], v[52:55], v[72:75]
    ds_read_b128 v[44:47], v18 offset:25600
    v_mfma_f32_16x16x32_bf16 v[76:79], a[84:87], v[52:55], v[76:79]
    s_waitcnt lgkmcnt(4)
    v_mfma_f32_16x16x32_bf16 v[64:67], a[88:91], v[56:59], v[64:67]
    ds_read_b128 v[48:51], v17 offset:26624
    v_mfma_f32_16x16x32_bf16 v[68:71], a[92:95], v[56:59], v[68:71]
    v_mfma_f32_16x16x32_bf16 v[72:75], a[88:91], v[60:63], v[72:75]
    ds_read_b128 v[52:55], v18 offset:26624
    v_mfma_f32_16x16x32_bf16 v[76:79], a[92:95], v[60:63], v[76:79]
    s_waitcnt lgkmcnt(4)
    v_mfma_f32_16x16x32_bf16 v[64:67], a[96:99], v[32:35], v[64:67]
    ds_read_b128 v[56:59], v17 offset:27648
    v_mfma_f32_16x16x32_bf16 v[68:71], a[100:103], v[32:35], v[68:71]
    v_mfma_f32_16x16x32_bf16 v[72:75], a[96:99], v[36:39], v[72:75]
    ds_read_b128 v[60:63], v18 offset:27648
    v_mfma_f32_16x16x32_bf16 v[76:79], a[100:103], v[36:39], v[76:79]
    s_waitcnt lgkmcnt(4)
    v_mfma_f32_16x16x32_bf16 v[64:67], a[104:107], v[40:43], v[64:67]
    ds_read_b128 v[32:35], v17 offset:32768
    v_mfma_f32_16x16x32_bf16 v[68:71], a[108:111], v[40:43], v[68:71]
    v_mfma_f32_16x16x32_bf16 v[72:75], a[104:107], v[44:47], v[72:75]
    ds_read_b128 v[36:39], v18 offset:32768
    v_mfma_f32_16x16x32_bf16 v[76:79], a[108:111], v[44:47], v[76:79]
    s_waitcnt lgkmcnt(4)
    v_mfma_f32_16x16x32_bf16 v[64:67], a[112:115], v[48:51], v[64:67]
    ds_read_b128 v[40:43], v17 offset:33792
    v_mfma_f32_16x16x32_bf16 v[68:71], a[116:119], v[48:51], v[68:71]
    v_mfma_f32_16x16x32_bf16 v[72:75], a[112:115], v[52:55], v[72:75]
    ds_read_b128 v[44:47], v18 offset:33792
    v_mfma_f32_16x16x32_bf16 v[76:79], a[116:119], v[52:55], v[76:79]
    s_waitcnt lgkmcnt(4)
    v_mfma_f32_16x16x32_bf16 v[64:67], a[120:123], v[56:59], v[64:67]
    ds_read_b128 v[48:51], v17 offset:34816
    v_mfma_f32_16x16x32_bf16 v[68:71], a[124:127], v[56:59], v[68:71]
    v_mfma_f32_16x16x32_bf16 v[72:75], a[120:123], v[60:63], v[72:75]
    ds_read_b128 v[52:55], v18 offset:34816
    v_mfma_f32_16x16x32_bf16 v[76:79], a[124:127], v[60:63], v[76:79]
    s_waitcnt lgkmcnt(4)
    v_mfma_f32_16x16x32_bf16 v[64:67], a[128:131], v[32:35], v[64:67]
    ds_read_b128 v[56:59], v17 offset:35840
    v_mfma_f32_16x16x32_bf16 v[68:71], a[132:135], v[32:35], v[68:71]
    v_mfma_f32_16x16x32_bf16 v[72:75], a[128:131], v[36:39], v[72:75]
    ds_read_b128 v[60:63], v18 offset:35840
    v_mfma_f32_16x16x32_bf16 v[76:79], a[132:135], v[36:39], v[76:79]
    s_waitcnt lgkmcnt(4)
    v_mfma_f32_16x16x32_bf16 v[64:67], a[136:139], v[40:43], v[64:67]
    ds_read_b128 v[32:35], v17 offset:40960
    v_mfma_f32_16x16x32_bf16 v[68:71], a[140:143], v[40:43], v[68:71]
    v_mfma_f32_16x16x32_bf16 v[72:75], a[136:139], v[44:47], v[72:75]
    ds_read_b128 v[36:39], v18 offset:40960
    v_mfma_f32_16x16x32_bf16 v[76:79], a[140:143], v[44:47], v[76:79]
    s_waitcnt lgkmcnt(4)
    v_mfma_f32_16x16x32_bf16 v[64:67], a[144:147], v[48:51], v[64:67]
    ds_read_b128 v[40:43], v17 offset:41984
    v_mfma_f32_16x16x32_bf16 v[68:71], a[148:151], v[48:51], v[68:71]
    v_mfma_f32_16x16x32_bf16 v[72:75], a[144:147], v[52:55], v[72:75]
    ds_read_b128 v[44:47], v18 offset:41984
    v_mfma_f32_16x16x32_bf16 v[76:79], a[148:151], v[52:55], v[76:79]
    s_waitcnt lgkmcnt(4)
    v_mfma_f32_16x16x32_bf16 v[64:67], a[152:155], v[56:59], v[64:67]
    ds_read_b128 v[48:51], v17 offset:43008
    v_mfma_f32_16x16x32_bf16 v[68:71], a[156:159], v[56:59], v[68:71]
    v_mfma_f32_16x16x32_bf16 v[72:75], a[152:155], v[60:63], v[72:75]
    ds_read_b128 v[52:55], v18 offset:43008
    v_mfma_f32_16x16x32_bf16 v[76:79], a[156:159], v[60:63], v[76:79]
    s_waitcnt lgkmcnt(4)
    v_mfma_f32_16x16x32_bf16 v[64:67], a[160:163], v[32:35], v[64:67]
    ds_read_b128 v[56:59], v17 offset:44032
    v_mfma_f32_16x16x32_bf16 v[68:71], a[164:167], v[32:35], v[68:71]
    v_mfma_f32_16x16x32_bf16 v[72:75], a[160:163], v[36:39], v[72:75]
    ds_read_b128 v[60:63], v18 offset:44032
    v_mfma_f32_16x16x32_bf16 v[76:79], a[164:167], v[36:39], v[76:79]
    s_waitcnt lgkmcnt(4)
    v_mfma_f32_16x16x32_bf16 v[64:67], a[168:171], v[40:43], v[64:67]
    ds_read_b128 v[32:35], v17 offset:49152
    v_mfma_f32_16x16x32_bf16 v[68:71], a[172:175], v[40:43], v[68:71]
    v_mfma_f32_16x16x32_bf16 v[72:75], a[168:171], v[44:47], v[72:75]
    ds_read_b128 v[36:39], v18 offset:49152
    v_mfma_f32_16x16x32_bf16 v[76:79], a[172:175], v[44:47], v[76:79]
    s_waitcnt lgkmcnt(4)
    v_mfma_f32_16x16x32_bf16 v[64:67], a[176:179], v[48:51], v[64:67]
    ds_read_b128 v[40:43], v17 offset:50176
    v_mfma_f32_16x16x32_bf16 v[68:71], a[180:183], v[48:51], v[68:71]
    v_mfma_f32_16x16x32_bf16 v[72:75], a[176:179], v[52:55], v[72:75]
    ds_read_b128 v[44:47], v18 offset:50176
    v_mfma_f32_16x16x32_bf16 v[76:79], a[180:183], v[52:55], v[76:79]
    s_waitcnt lgkmcnt(4)
    v_mfma_f32_16x16x32_bf16 v[64:67], a[184:187], v[56:59], v[64:67]
    ds_read_b128 v[48:51], v17 offset:51200
    v_mfma_f32_16x16x32_bf16 v[68:71], a[188:191], v[56:59], v[68:71]
    v_mfma_f32_16x16x32_bf16 v[72:75], a[184:187], v[60:63], v[72:75]
    ds_read_b128 v[52:55], v18 offset:51200
    v_mfma_f32_16x16x32_bf16 v[76:79], a[188:191], v[60:63], v[76:79]
    s_waitcnt lgkmcnt(4)
    v_mfma_f32_16x16x32_bf16 v[64:67], a[192:195], v[32:35], v[64:67]
    ds_read_b128 v[56:59], v17 offset:52224
    v_mfma_f32_16x16x32_bf16 v[68:71], a[196:199], v[32:35], v[68:71]
    v_mfma_f32_16x16x32_bf16 v[72:75], a[192:195], v[36:39], v[72:75]
    ds_read_b128 v[60:63], v18 offset:52224
    v_mfma_f32_16x16x32_bf16 v[76:79], a[196:199], v[36:39], v[76:79]
    s_waitcnt lgkmcnt(4)
    v_mfma_f32_16x16x32_bf16 v[64:67], a[200:203], v[40:43], v[64:67]
    ds_read_b128 v[32:35], v17 offset:57344
    v_mfma_f32_16x16x32_bf16 v[68:71], a[204:207], v[40:43], v[68:71]
    v_mfma_f32_16x16x32_bf16 v[72:75], a[200:203], v[44:47], v[72:75]
    ds_read_b128 v[36:39], v18 offset:57344
    v_mfma_f32_16x16x32_bf16 v[76:79], a[204:207], v[44:47], v[76:79]
    s_waitcnt lgkmcnt(4)
    v_mfma_f32_16x16x32_bf16 v[64:67], a[208:211], v[48:51], v[64:67]
    ds_read_b128 v[40:43], v17 offset:58368
    v_mfma_f32_16x16x32_bf16 v[68:71], a[212:215], v[48:51], v[68:71]
    v_mfma_f32_16x16x32_bf16 v[72:75], a[208:211], v[52:55], v[72:75]
    ds_read_b128 v[44:47], v18 offset:58368
    v_mfma_f32_16x16x32_bf16 v[76:79], a[212:215], v[52:55], v[76:79]
    s_waitcnt lgkmcnt(4)
    v_mfma_f32_16x16x32_bf16 v[64:67], a[216:219], v[56:59], v[64:67]
    ds_read_b128 v[48:51], v17 offset:59392
    v_mfma_f32_16x16x32_bf16 v[68:71], a[220:223], v[56:59], v[68:71]
    v_mfma_f32_16x16x32_bf16 v[72:75], a[216:219], v[60:63], v[72:75]
    ds_read_b128 v[52:55], v18 offset:59392
    v_mfma_f32_16x16x32_bf16 v[76:79], a[220:223], v[60:63], v[76:79]
    s_waitcnt lgkmcnt(4)
    v_mfma_f32_16x16x32_bf16 v[64:67], a[224:227], v[32:35], v[64:67]
    ds_read_b128 v[56:59], v17 offset:60416
    v_mfma_f32_16x16x32_bf16 v[68:71], a[228:231], v[32:35], v[68:71]
    v_mfma_f32_16x16x32_bf16 v[72:75], a[224:227], v[36:39], v[72:75]
    ds_read_b128 v[60:63], v18 offset:60416
    v_mfma_f32_16x16x32_bf16 v[76:79], a[228:231], v[36:39], v[76:79]
    s_waitcnt lgkmcnt(4)
    v_mfma_f32_16x16x32_bf16 v[64:67], a[232:235], v[40:43], v[64:67]
    v_mfma_f32_16x16x32_bf16 v[68:71], a[236:239], v[40:43], v[68:71]
    v_mfma_f32_16x16x32_bf16 v[72:75], a[232:235], v[44:47], v[72:75]
    v_mfma_f32_16x16x32_bf16 v[76:79], a[236:239], v[44:47], v[76:79]
    s_waitcnt lgkmcnt(2)
    v_mfma_f32_16x16x32_bf16 v[64:67], a[240:243], v[48:51], v[64:67]
    v_mfma_f32_16x16x32_bf16 v[68:71], a[244:247], v[48:51], v[68:71]
    v_mfma_f32_16x16x32_bf16 v[72:75], a[240:243], v[52:55], v[72:75]
    v_mfma_f32_16x16x32_bf16 v[76:79], a[244:247], v[52:55], v[76:79]
    s_waitcnt lgkmcnt(0)
    v_mfma_f32_16x16x32_bf16 v[64:67], a[248:251], v[56:59], v[64:67]
    v_mfma_f32_16x16x32_bf16 v[68:71], a[252:255], v[56:59], v[68:71]
    v_mfma_f32_16x16x32_bf16 v[72:75], a[248:251], v[60:63], v[72:75]
    v_mfma_f32_16x16x32_bf16 v[76:79], a[252:255], v[60:63], v[76:79]
    v_xor_b32 v17, 0x10000, v17
    v_xor_b32 v18, 0x10000, v18
    s_add_u32 s4, s34, s37
    s_waitcnt vmcnt(0)

.g2st_483:
    s_nop 2
    v_min_u32 v68, 0xfffffffe, v68
    buffer_store_dwordx4 v[68:71], v28, s[8:11], s4 offen sc1
    v_min_u32 v72, 0xfffffffe, v72
    buffer_store_dwordx4 v[72:75], v29, s[8:11], s4 offen sc1
    v_min_u32 v76, 0xfffffffe, v76
    buffer_store_dwordx4 v[76:79], v30, s[8:11], s4 offen sc1
    s_cmp_eq_u32 s38, 0
    s_cbranch_scc1 .g2nc_484
    s_mov_b32 s62, 0
.cc_489:
    v_max3_u32 v4, v84, v88, v92
    v_cmp_eq_u32 vcc, -1, v4
    s_cbranch_vccz .cd_490

    buffer_load_dwordx4 v[84:87], v7, s[8:11], s51 offen sc1
    buffer_load_dwordx4 v[88:91], v8, s[8:11], s51 offen sc1
    buffer_load_dwordx4 v[92:95], v9, s[8:11], s51 offen sc1
    s_add_u32 s62, s62, 1
    s_cmp_gt_u32 s62, 0x400000
    s_cbranch_scc1 .mg_end_1
    s_waitcnt vmcnt(0)
    s_branch .cc_489

.cd_490:
    v_add_f32 v84, v84, v88
    v_add_f32 v80, v80, v92
    v_add_f32 v85, v85, v89
    v_add_f32 v81, v81, v93
    v_add_f32 v86, v86, v90
    v_add_f32 v82, v82, v94
    v_add_f32 v87, v87, v91
    v_add_f32 v83, v83, v95
    v_add_f32 v80, v80, v84
    v_add_f32 v81, v81, v85
    v_add_f32 v82, v82, v86
    v_add_f32 v83, v83, v87
    v_sub_f32 v104, 1.0, v100
    v_cvt_pk_bf16_f32 v104, v104, v104
    v_lshlrev_b32 v104, 16, v104

    v_cvt_pk_bf16_f32 v105, v80, v81
    v_lshlrev_b32 v107, 16, v96
    v_and_b32 v108, 0xffff0000, v96
    v_lshlrev_b32 v109, 16, v98
    v_and_b32 v110, 0xffff0000, v98
    v_and_b32 v106, 0xffff0000, v105
    v_lshlrev_b32 v105, 16, v105
    v_mul_f32 v107, v107, v109
    v_mul_f32 v108, v108, v110
    v_mul_f32 v105, v104, v105
    v_mul_f32 v106, v104, v106
    v_cvt_pk_bf16_f32 v107, v107, v108
    v_cvt_pk_bf16_f32 v105, v105, v106
    v_and_b32 v108, 0xffff0000, v107
    v_lshlrev_b32 v107, 16, v107
    v_and_b32 v106, 0xffff0000, v105
    v_lshlrev_b32 v105, 16, v105
    v_mul_f32 v107, v100, v107
    v_mul_f32 v108, v100, v108
    v_cvt_pk_bf16_f32 v107, v107, v108
    v_and_b32 v108, 0xffff0000, v107
    v_lshlrev_b32 v107, 16, v107
    v_add_f32 v105, v105, v107
    v_add_f32 v106, v106, v108
    v_cvt_pk_bf16_f32 v102, v105, v106

    v_cvt_pk_bf16_f32 v105, v82, v83
    v_lshlrev_b32 v107, 16, v97
    v_and_b32 v108, 0xffff0000, v97
    v_lshlrev_b32 v109, 16, v99
    v_and_b32 v110, 0xffff0000, v99
    v_and_b32 v106, 0xffff0000, v105
    v_lshlrev_b32 v105, 16, v105
    v_mul_f32 v107, v107, v109
    v_mul_f32 v108, v108, v110
    v_mul_f32 v105, v104, v105
    v_mul_f32 v106, v104, v106
    v_cvt_pk_bf16_f32 v107, v107, v108
    v_cvt_pk_bf16_f32 v105, v105, v106
    v_and_b32 v108, 0xffff0000, v107
    v_lshlrev_b32 v107, 16, v107
    v_and_b32 v106, 0xffff0000, v105
    v_lshlrev_b32 v105, 16, v105
    v_mul_f32 v107, v100, v107
    v_mul_f32 v108, v100, v108
    v_cvt_pk_bf16_f32 v107, v107, v108
    v_and_b32 v108, 0xffff0000, v107
    v_lshlrev_b32 v107, 16, v107
    v_add_f32 v105, v105, v107
    v_add_f32 v106, v106, v108
    v_cvt_pk_bf16_f32 v103, v105, v106

    buffer_store_dwordx2 v[102:103], v22, s[44:47], s52 offen
.g2nc_484:
    v_mov_b32 v80, v64
    v_mov_b32 v81, v65
    v_mov_b32 v82, v66
    v_mov_b32 v83, v67
    s_cmp_lg_u32 s56, 0
    s_cbranch_scc1 .g2pf_491
    s_add_u32 s51, s34, s37
    s_lshl_b32 s52, s31, 16
    s_lshl_b32 s5, s31, 7
    s_add_u32 s4, s5, 117440512
    s_add_u32 s6, s5, 117448704
    s_add_u32 s5, s5, 121634816
    buffer_load_dwordx2 v[96:97], v22, s[16:19], s52 offen
    buffer_load_dword v98, v23, s[8:11], s4 offen
    buffer_load_dword v99, v23, s[8:11], s6 offen
    buffer_load_dword v100, v16, s[8:11], s5 offen

    buffer_load_dwordx4 v[84:87], v7, s[8:11], s51 offen sc1
    buffer_load_dwordx4 v[88:91], v8, s[8:11], s51 offen sc1
    buffer_load_dwordx4 v[92:95], v9, s[8:11], s51 offen sc1
    s_waitcnt vmcnt(0)
    s_mov_b32 s62, 0
.cc_492:
    v_max3_u32 v4, v84, v88, v92
    v_cmp_eq_u32 vcc, -1, v4
    s_cbranch_vccz .cd_493

    buffer_load_dwordx4 v[84:87], v7, s[8:11], s51 offen sc1
    buffer_load_dwordx4 v[88:91], v8, s[8:11], s51 offen sc1
    buffer_load_dwordx4 v[92:95], v9, s[8:11], s51 offen sc1
    s_add_u32 s62, s62, 1
    s_cmp_gt_u32 s62, 0x400000
    s_cbranch_scc1 .mg_end_1
    s_waitcnt vmcnt(0)
    s_branch .cc_492

.cd_493:
    v_add_f32 v84, v84, v88
    v_add_f32 v80, v80, v92
    v_add_f32 v85, v85, v89
    v_add_f32 v81, v81, v93
    v_add_f32 v86, v86, v90
    v_add_f32 v82, v82, v94
    v_add_f32 v87, v87, v91
    v_add_f32 v83, v83, v95
    v_add_f32 v80, v80, v84
    v_add_f32 v81, v81, v85
    v_add_f32 v82, v82, v86
    v_add_f32 v83, v83, v87
    v_sub_f32 v104, 1.0, v100
    v_cvt_pk_bf16_f32 v104, v104, v104
    v_lshlrev_b32 v104, 16, v104

    v_cvt_pk_bf16_f32 v105, v80, v81
    v_lshlrev_b32 v107, 16, v96
    v_and_b32 v108, 0xffff0000, v96
    v_lshlrev_b32 v109, 16, v98
    v_and_b32 v110, 0xffff0000, v98
    v_and_b32 v106, 0xffff0000, v105
    v_lshlrev_b32 v105, 16, v105
    v_mul_f32 v107, v107, v109
    v_mul_f32 v108, v108, v110
    v_mul_f32 v105, v104, v105
    v_mul_f32 v106, v104, v106
    v_cvt_pk_bf16_f32 v107, v107, v108
    v_cvt_pk_bf16_f32 v105, v105, v106
    v_and_b32 v108, 0xffff0000, v107
    v_lshlrev_b32 v107, 16, v107
    v_and_b32 v106, 0xffff0000, v105
    v_lshlrev_b32 v105, 16, v105
    v_mul_f32 v107, v100, v107
    v_mul_f32 v108, v100, v108
    v_cvt_pk_bf16_f32 v107, v107, v108
    v_and_b32 v108, 0xffff0000, v107
    v_lshlrev_b32 v107, 16, v107
    v_add_f32 v105, v105, v107
    v_add_f32 v106, v106, v108
    v_cvt_pk_bf16_f32 v102, v105, v106

    v_cvt_pk_bf16_f32 v105, v82, v83
    v_lshlrev_b32 v107, 16, v97
    v_and_b32 v108, 0xffff0000, v97
    v_lshlrev_b32 v109, 16, v99
    v_and_b32 v110, 0xffff0000, v99
    v_and_b32 v106, 0xffff0000, v105
    v_lshlrev_b32 v105, 16, v105
    v_mul_f32 v107, v107, v109
    v_mul_f32 v108, v108, v110
    v_mul_f32 v105, v104, v105
    v_mul_f32 v106, v104, v106
    v_cvt_pk_bf16_f32 v107, v107, v108
    v_cvt_pk_bf16_f32 v105, v105, v106
    v_and_b32 v108, 0xffff0000, v107
    v_lshlrev_b32 v107, 16, v107
    v_and_b32 v106, 0xffff0000, v105
    v_lshlrev_b32 v105, 16, v105
    v_mul_f32 v107, v100, v107
    v_mul_f32 v108, v100, v108
    v_cvt_pk_bf16_f32 v107, v107, v108
    v_and_b32 v108, 0xffff0000, v107
    v_lshlrev_b32 v107, 16, v107
    v_add_f32 v105, v105, v107
    v_add_f32 v106, v106, v108
    v_cvt_pk_bf16_f32 v103, v105, v106

    buffer_store_dwordx2 v[102:103], v22, s[44:47], s52 offen
    s_mov_b32 s38, 0
    s_mov_b32 s31, s53
    s_add_u32 s37, s37, 0x10000
    s_cmp_lt_u32 s31, 64
    s_cbranch_scc1 .g2blk_478
    s_branch .g2fin_486

.g2pf_491:
    s_mov_b32 s31, s53
    s_add_u32 s37, s37, 0x10000
    s_cmp_eq_u32 s38, 0
    s_mov_b32 s38, 1
    s_cbranch_scc1 .g2w3_480
    s_waitcnt vmcnt(4)
    s_branch .g2go_479

.g2w3_480:
    s_waitcnt vmcnt(3)
    s_branch .g2go_479
.g2fin_486:
    s_endpgm
.cvrole_461:
    s_cmp_lg_u32 s97, 0
    s_cbranch_scc1 .vd_495
    v_and_b32 v243, 7, v0
    v_lshlrev_b32 v243, 2, v243
    s_mov_b32 s62, 0

.vp_494:
    buffer_load_dword v242, v243, s[20:23], 0 offen sc1
    s_waitcnt vmcnt(0)
    v_readlane_b32 s64, v242, 0
    v_readlane_b32 s65, v242, 1
    v_readlane_b32 s66, v242, 2
    v_readlane_b32 s67, v242, 3
    v_readlane_b32 s68, v242, 4
    v_readlane_b32 s69, v242, 5
    v_readlane_b32 s70, v242, 6
    v_readlane_b32 s71, v242, 7
    v_cmp_ne_u32 vcc, 32, v242
    s_add_u32 s4, s64, s65
    s_add_u32 s5, s66, s67
    s_add_u32 s72, s68, s69
    s_add_u32 s73, s70, s71
    s_add_u32 s4, s4, s5
    s_add_u32 s72, s72, s73
    s_add_u32 s4, s4, s72
    s_cmp_eq_u64 vcc, 0
    s_cbranch_scc1 .vd_495
    s_cmp_ge_u32 s4, 256
    s_cbranch_scc1 .vs_496
    s_add_u32 s62, s62, 1
    s_cmp_gt_u32 s62, 0x100000
    s_cbranch_scc1 .mg_end_1
    s_branch .vp_494

.vs_496:
    s_lshr_b32 s25, s2, 5
    s_and_b32 s26, s2, 31
    s_mov_b32 s27, 1
    s_mov_b32 s97, 1
    s_waitcnt vmcnt(0) lgkmcnt(0)
    s_barrier
    s_branch .mg_role_3

.vd_495:
    s_mov_b32 s97, 1
    s_lshl_b32 s4, s91, 3
    s_add_u32 s4, s4, s26
    s_add_u32 s4, s4, 72
    s_lshl_b32 s4, s4, 8
    s_add_u32 s92, s4, 92274688
    v_mov_b32 v4, 0
    s_mov_b64 exec, 1
    buffer_store_dword v4, v4, s[8:11], s92 offen sc1
    s_mov_b64 exec, -1

    s_waitcnt vmcnt(0) lgkmcnt(0)
    s_barrier
    s_mov_b32 s5, 32
    s_cmp_lg_u32 s24, 0
    s_cbranch_scc1 .sg_497
    s_mov_b64 exec, 1
    v_mov_b32 v4, 1
    v_mov_b32 v5, 0
    buffer_atomic_add v4, v5, s[20:23], s5 offen sc1
    s_mov_b64 exec, -1

.sg_497:
    s_lshl_b32 s93, s91, 3
    s_add_u32 s93, s93, s26
    s_sub_u32 s93, s93, 24
    s_mov_b32 s94, s93

.kp_498:
    s_mov_b32 s25, s94
    s_load_dwordx4 s[52:55], s[0:1], 8
    s_load_dwordx2 s[56:57], s[0:1], 24
    s_waitcnt lgkmcnt(0)

    s_mov_b32 s60, s52
    s_and_b32 s61, s53, 0xffff
    s_mov_b32 s62, 0x400000
    s_mov_b32 s63, 0x00020000

    s_mov_b32 s64, s54
    s_and_b32 s65, s55, 0xffff
    s_mov_b32 s66, 0x400000
    s_mov_b32 s67, 0x00020000

    s_mov_b32 s68, s56
    s_and_b32 s69, s57, 0xffff
    s_mov_b32 s70, 0x2000
    s_mov_b32 s71, 0x00020000

    s_lshr_b32 s4, s25, 4
    s_and_b32 s5, s25, 15
    v_lshrrev_b32 v10, 4, v0
    v_and_b32 v11, 15, v0
    s_lshl_b32 s6, s4, 7
    v_lshlrev_b32 v12, 3, v10
    v_add_u32 v12, s6, v12
    v_lshlrev_b32 v13, 11, v12
    s_lshl_b32 s7, s5, 7
    v_lshlrev_b32 v14, 3, v11
    v_add_u32 v14, s7, v14
    v_add_u32 v13, v13, v14
    v_subrev_u32 v15, 6144, v13
    v_subrev_u32 v16, 4096, v13
    v_subrev_u32 v17, 2048, v13
    v_lshlrev_b32 v18, 2, v14
    v_lshlrev_b32 v19, 11, v14
    v_lshlrev_b32 v12, 1, v12
    v_add_u32 v19, v19, v12

    v_lshlrev_b32 v19, 11, v14
    v_lshrrev_b32 v12, 6, v12
    v_lshl_add_u32 v19, v12, 4, v19
    v_and_b32 v12, 3, v10
    v_lshl_add_u32 v19, v12, 10, v19

    buffer_load_dwordx4 v[20:23], v18, s[68:71], 0 offen
    buffer_load_dwordx4 v[24:27], v18, s[68:71], 0 offen offset:16

    buffer_load_dwordx2 v[28:29], v15, s[60:63], 0 offen
    buffer_load_dwordx2 v[30:31], v16, s[60:63], 0 offen
    buffer_load_dwordx2 v[32:33], v17, s[60:63], 0 offen
    s_mov_b32 s6, 0
    buffer_load_dwordx2 v[34:35], v13, s[60:63], s6 offen
    s_mov_b32 s6, 2048
    buffer_load_dwordx2 v[36:37], v13, s[60:63], s6 offen
    s_mov_b32 s6, 4096
    buffer_load_dwordx2 v[38:39], v13, s[60:63], s6 offen
    s_mov_b32 s6, 6144
    buffer_load_dwordx2 v[40:41], v13, s[60:63], s6 offen
    s_mov_b32 s6, 8192
    buffer_load_dwordx2 v[42:43], v13, s[60:63], s6 offen
    s_mov_b32 s6, 10240
    buffer_load_dwordx2 v[44:45], v13, s[60:63], s6 offen
    s_mov_b32 s6, 12288
    buffer_load_dwordx2 v[46:47], v13, s[60:63], s6 offen
    s_mov_b32 s6, 14336
    buffer_load_dwordx2 v[48:49], v13, s[60:63], s6 offen
    s_mov_b32 s6, 0
    buffer_load_dwordx2 v[50:51], v13, s[64:67], s6 offen
    s_mov_b32 s6, 2048
    buffer_load_dwordx2 v[52:53], v13, s[64:67], s6 offen
    s_mov_b32 s6, 4096
    buffer_load_dwordx2 v[54:55], v13, s[64:67], s6 offen
    s_mov_b32 s6, 6144
    buffer_load_dwordx2 v[56:57], v13, s[64:67], s6 offen
    s_mov_b32 s6, 8192
    buffer_load_dwordx2 v[58:59], v13, s[64:67], s6 offen
    s_mov_b32 s6, 10240
    buffer_load_dwordx2 v[60:61], v13, s[64:67], s6 offen
    s_mov_b32 s6, 12288
    buffer_load_dwordx2 v[62:63], v13, s[64:67], s6 offen
    s_mov_b32 s6, 14336
    buffer_load_dwordx2 v[64:65], v13, s[64:67], s6 offen
    s_waitcnt vmcnt(0)
    v_lshlrev_b32 v66, 16, v20
    v_and_b32 v67, 0xffff0000, v20
    v_lshlrev_b32 v68, 16, v21
    v_and_b32 v69, 0xffff0000, v21

    v_lshlrev_b32 v70, 16, v22
    v_and_b32 v71, 0xffff0000, v22
    v_lshlrev_b32 v72, 16, v23
    v_and_b32 v73, 0xffff0000, v23

    v_lshlrev_b32 v74, 16, v28
    v_and_b32 v86, 0xffff0000, v28
    v_lshlrev_b32 v75, 16, v30
    v_and_b32 v87, 0xffff0000, v30
    v_lshlrev_b32 v76, 16, v32
    v_and_b32 v88, 0xffff0000, v32
    v_lshlrev_b32 v77, 16, v34
    v_and_b32 v89, 0xffff0000, v34
    v_lshlrev_b32 v78, 16, v36
    v_and_b32 v90, 0xffff0000, v36
    v_lshlrev_b32 v79, 16, v38
    v_and_b32 v91, 0xffff0000, v38
    v_lshlrev_b32 v80, 16, v40
    v_and_b32 v92, 0xffff0000, v40
    v_lshlrev_b32 v81, 16, v42
    v_and_b32 v93, 0xffff0000, v42
    v_lshlrev_b32 v82, 16, v44
    v_and_b32 v94, 0xffff0000, v44
    v_lshlrev_b32 v83, 16, v46
    v_and_b32 v95, 0xffff0000, v46
    v_lshlrev_b32 v84, 16, v48
    v_and_b32 v96, 0xffff0000, v48
    v_mul_f32 v98, v69, v74
    v_mul_f32 v99, v73, v86
    v_cvt_pk_bf16_f32 v98, v98, v99
    v_and_b32 v99, 0xffff0000, v98
    v_lshlrev_b32 v98, 16, v98

    v_mul_f32 v100, v68, v75
    v_mul_f32 v101, v72, v87
    v_cvt_pk_bf16_f32 v100, v100, v101
    v_and_b32 v101, 0xffff0000, v100
    v_lshlrev_b32 v100, 16, v100
    v_add_f32 v98, v98, v100
    v_add_f32 v99, v99, v101
    v_cvt_pk_bf16_f32 v98, v98, v99
    v_and_b32 v99, 0xffff0000, v98
    v_lshlrev_b32 v98, 16, v98

    v_mul_f32 v100, v67, v76
    v_mul_f32 v101, v71, v88
    v_cvt_pk_bf16_f32 v100, v100, v101
    v_and_b32 v101, 0xffff0000, v100
    v_lshlrev_b32 v100, 16, v100
    v_add_f32 v98, v98, v100
    v_add_f32 v99, v99, v101
    v_cvt_pk_bf16_f32 v98, v98, v99
    v_and_b32 v99, 0xffff0000, v98
    v_lshlrev_b32 v98, 16, v98

    v_mul_f32 v100, v66, v77
    v_mul_f32 v101, v70, v89
    v_cvt_pk_bf16_f32 v100, v100, v101
    v_and_b32 v101, 0xffff0000, v100
    v_lshlrev_b32 v100, 16, v100
    v_add_f32 v98, v98, v100
    v_add_f32 v99, v99, v101
    v_cvt_pk_bf16_f32 v98, v98, v99
    v_and_b32 v99, 0xffff0000, v98
    v_lshlrev_b32 v98, 16, v98

    v_lshlrev_b32 v100, 16, v50
    v_and_b32 v101, 0xffff0000, v50
    v_mul_f32 v102, v98, v100
    v_mul_f32 v110, v99, v101
    v_cvt_pk_bf16_f32 v50, v102, v110

    v_mul_f32 v98, v69, v75
    v_mul_f32 v99, v73, v87
    v_cvt_pk_bf16_f32 v98, v98, v99
    v_and_b32 v99, 0xffff0000, v98
    v_lshlrev_b32 v98, 16, v98

    v_mul_f32 v100, v68, v76
    v_mul_f32 v101, v72, v88
    v_cvt_pk_bf16_f32 v100, v100, v101
    v_and_b32 v101, 0xffff0000, v100
    v_lshlrev_b32 v100, 16, v100
    v_add_f32 v98, v98, v100
    v_add_f32 v99, v99, v101
    v_cvt_pk_bf16_f32 v98, v98, v99
    v_and_b32 v99, 0xffff0000, v98
    v_lshlrev_b32 v98, 16, v98

    v_mul_f32 v100, v67, v77
    v_mul_f32 v101, v71, v89
    v_cvt_pk_bf16_f32 v100, v100, v101
    v_and_b32 v101, 0xffff0000, v100
    v_lshlrev_b32 v100, 16, v100
    v_add_f32 v98, v98, v100
    v_add_f32 v99, v99, v101
    v_cvt_pk_bf16_f32 v98, v98, v99
    v_and_b32 v99, 0xffff0000, v98
    v_lshlrev_b32 v98, 16, v98

    v_mul_f32 v100, v66, v78
    v_mul_f32 v101, v70, v90
    v_cvt_pk_bf16_f32 v100, v100, v101
    v_and_b32 v101, 0xffff0000, v100
    v_lshlrev_b32 v100, 16, v100
    v_add_f32 v98, v98, v100
    v_add_f32 v99, v99, v101
    v_cvt_pk_bf16_f32 v98, v98, v99
    v_and_b32 v99, 0xffff0000, v98
    v_lshlrev_b32 v98, 16, v98

    v_lshlrev_b32 v100, 16, v52
    v_and_b32 v101, 0xffff0000, v52
    v_mul_f32 v103, v98, v100
    v_mul_f32 v111, v99, v101
    v_cvt_pk_bf16_f32 v52, v103, v111

    v_mul_f32 v98, v69, v76
    v_mul_f32 v99, v73, v88
    v_cvt_pk_bf16_f32 v98, v98, v99
    v_and_b32 v99, 0xffff0000, v98
    v_lshlrev_b32 v98, 16, v98

    v_mul_f32 v100, v68, v77
    v_mul_f32 v101, v72, v89
    v_cvt_pk_bf16_f32 v100, v100, v101
    v_and_b32 v101, 0xffff0000, v100
    v_lshlrev_b32 v100, 16, v100
    v_add_f32 v98, v98, v100
    v_add_f32 v99, v99, v101
    v_cvt_pk_bf16_f32 v98, v98, v99
    v_and_b32 v99, 0xffff0000, v98
    v_lshlrev_b32 v98, 16, v98

    v_mul_f32 v100, v67, v78
    v_mul_f32 v101, v71, v90
    v_cvt_pk_bf16_f32 v100, v100, v101
    v_and_b32 v101, 0xffff0000, v100
    v_lshlrev_b32 v100, 16, v100
    v_add_f32 v98, v98, v100
    v_add_f32 v99, v99, v101
    v_cvt_pk_bf16_f32 v98, v98, v99
    v_and_b32 v99, 0xffff0000, v98
    v_lshlrev_b32 v98, 16, v98

    v_mul_f32 v100, v66, v79
    v_mul_f32 v101, v70, v91
    v_cvt_pk_bf16_f32 v100, v100, v101
    v_and_b32 v101, 0xffff0000, v100
    v_lshlrev_b32 v100, 16, v100
    v_add_f32 v98, v98, v100
    v_add_f32 v99, v99, v101
    v_cvt_pk_bf16_f32 v98, v98, v99
    v_and_b32 v99, 0xffff0000, v98
    v_lshlrev_b32 v98, 16, v98

    v_lshlrev_b32 v100, 16, v54
    v_and_b32 v101, 0xffff0000, v54
    v_mul_f32 v104, v98, v100
    v_mul_f32 v112, v99, v101
    v_cvt_pk_bf16_f32 v54, v104, v112

    v_mul_f32 v98, v69, v77
    v_mul_f32 v99, v73, v89
    v_cvt_pk_bf16_f32 v98, v98, v99
    v_and_b32 v99, 0xffff0000, v98
    v_lshlrev_b32 v98, 16, v98

    v_mul_f32 v100, v68, v78
    v_mul_f32 v101, v72, v90
    v_cvt_pk_bf16_f32 v100, v100, v101
    v_and_b32 v101, 0xffff0000, v100
    v_lshlrev_b32 v100, 16, v100
    v_add_f32 v98, v98, v100
    v_add_f32 v99, v99, v101
    v_cvt_pk_bf16_f32 v98, v98, v99
    v_and_b32 v99, 0xffff0000, v98
    v_lshlrev_b32 v98, 16, v98

    v_mul_f32 v100, v67, v79
    v_mul_f32 v101, v71, v91
    v_cvt_pk_bf16_f32 v100, v100, v101
    v_and_b32 v101, 0xffff0000, v100
    v_lshlrev_b32 v100, 16, v100
    v_add_f32 v98, v98, v100
    v_add_f32 v99, v99, v101
    v_cvt_pk_bf16_f32 v98, v98, v99
    v_and_b32 v99, 0xffff0000, v98
    v_lshlrev_b32 v98, 16, v98

    v_mul_f32 v100, v66, v80
    v_mul_f32 v101, v70, v92
    v_cvt_pk_bf16_f32 v100, v100, v101
    v_and_b32 v101, 0xffff0000, v100
    v_lshlrev_b32 v100, 16, v100
    v_add_f32 v98, v98, v100
    v_add_f32 v99, v99, v101
    v_cvt_pk_bf16_f32 v98, v98, v99
    v_and_b32 v99, 0xffff0000, v98
    v_lshlrev_b32 v98, 16, v98

    v_lshlrev_b32 v100, 16, v56
    v_and_b32 v101, 0xffff0000, v56
    v_mul_f32 v105, v98, v100
    v_mul_f32 v113, v99, v101
    v_cvt_pk_bf16_f32 v56, v105, v113

    v_mul_f32 v98, v69, v78
    v_mul_f32 v99, v73, v90
    v_cvt_pk_bf16_f32 v98, v98, v99
    v_and_b32 v99, 0xffff0000, v98
    v_lshlrev_b32 v98, 16, v98

    v_mul_f32 v100, v68, v79
    v_mul_f32 v101, v72, v91
    v_cvt_pk_bf16_f32 v100, v100, v101
    v_and_b32 v101, 0xffff0000, v100
    v_lshlrev_b32 v100, 16, v100
    v_add_f32 v98, v98, v100
    v_add_f32 v99, v99, v101
    v_cvt_pk_bf16_f32 v98, v98, v99
    v_and_b32 v99, 0xffff0000, v98
    v_lshlrev_b32 v98, 16, v98

    v_mul_f32 v100, v67, v80
    v_mul_f32 v101, v71, v92
    v_cvt_pk_bf16_f32 v100, v100, v101
    v_and_b32 v101, 0xffff0000, v100
    v_lshlrev_b32 v100, 16, v100
    v_add_f32 v98, v98, v100
    v_add_f32 v99, v99, v101
    v_cvt_pk_bf16_f32 v98, v98, v99
    v_and_b32 v99, 0xffff0000, v98
    v_lshlrev_b32 v98, 16, v98

    v_mul_f32 v100, v66, v81
    v_mul_f32 v101, v70, v93
    v_cvt_pk_bf16_f32 v100, v100, v101
    v_and_b32 v101, 0xffff0000, v100
    v_lshlrev_b32 v100, 16, v100
    v_add_f32 v98, v98, v100
    v_add_f32 v99, v99, v101
    v_cvt_pk_bf16_f32 v98, v98, v99
    v_and_b32 v99, 0xffff0000, v98
    v_lshlrev_b32 v98, 16, v98

    v_lshlrev_b32 v100, 16, v58
    v_and_b32 v101, 0xffff0000, v58
    v_mul_f32 v106, v98, v100
    v_mul_f32 v114, v99, v101
    v_cvt_pk_bf16_f32 v58, v106, v114

    v_mul_f32 v98, v69, v79
    v_mul_f32 v99, v73, v91
    v_cvt_pk_bf16_f32 v98, v98, v99
    v_and_b32 v99, 0xffff0000, v98
    v_lshlrev_b32 v98, 16, v98

    v_mul_f32 v100, v68, v80
    v_mul_f32 v101, v72, v92
    v_cvt_pk_bf16_f32 v100, v100, v101
    v_and_b32 v101, 0xffff0000, v100
    v_lshlrev_b32 v100, 16, v100
    v_add_f32 v98, v98, v100
    v_add_f32 v99, v99, v101
    v_cvt_pk_bf16_f32 v98, v98, v99
    v_and_b32 v99, 0xffff0000, v98
    v_lshlrev_b32 v98, 16, v98

    v_mul_f32 v100, v67, v81
    v_mul_f32 v101, v71, v93
    v_cvt_pk_bf16_f32 v100, v100, v101
    v_and_b32 v101, 0xffff0000, v100
    v_lshlrev_b32 v100, 16, v100
    v_add_f32 v98, v98, v100
    v_add_f32 v99, v99, v101
    v_cvt_pk_bf16_f32 v98, v98, v99
    v_and_b32 v99, 0xffff0000, v98
    v_lshlrev_b32 v98, 16, v98

    v_mul_f32 v100, v66, v82
    v_mul_f32 v101, v70, v94
    v_cvt_pk_bf16_f32 v100, v100, v101
    v_and_b32 v101, 0xffff0000, v100
    v_lshlrev_b32 v100, 16, v100
    v_add_f32 v98, v98, v100
    v_add_f32 v99, v99, v101
    v_cvt_pk_bf16_f32 v98, v98, v99
    v_and_b32 v99, 0xffff0000, v98
    v_lshlrev_b32 v98, 16, v98

    v_lshlrev_b32 v100, 16, v60
    v_and_b32 v101, 0xffff0000, v60
    v_mul_f32 v107, v98, v100
    v_mul_f32 v115, v99, v101
    v_cvt_pk_bf16_f32 v60, v107, v115

    v_mul_f32 v98, v69, v80
    v_mul_f32 v99, v73, v92
    v_cvt_pk_bf16_f32 v98, v98, v99
    v_and_b32 v99, 0xffff0000, v98
    v_lshlrev_b32 v98, 16, v98

    v_mul_f32 v100, v68, v81
    v_mul_f32 v101, v72, v93
    v_cvt_pk_bf16_f32 v100, v100, v101
    v_and_b32 v101, 0xffff0000, v100
    v_lshlrev_b32 v100, 16, v100
    v_add_f32 v98, v98, v100
    v_add_f32 v99, v99, v101
    v_cvt_pk_bf16_f32 v98, v98, v99
    v_and_b32 v99, 0xffff0000, v98
    v_lshlrev_b32 v98, 16, v98

    v_mul_f32 v100, v67, v82
    v_mul_f32 v101, v71, v94
    v_cvt_pk_bf16_f32 v100, v100, v101
    v_and_b32 v101, 0xffff0000, v100
    v_lshlrev_b32 v100, 16, v100
    v_add_f32 v98, v98, v100
    v_add_f32 v99, v99, v101
    v_cvt_pk_bf16_f32 v98, v98, v99
    v_and_b32 v99, 0xffff0000, v98
    v_lshlrev_b32 v98, 16, v98

    v_mul_f32 v100, v66, v83
    v_mul_f32 v101, v70, v95
    v_cvt_pk_bf16_f32 v100, v100, v101
    v_and_b32 v101, 0xffff0000, v100
    v_lshlrev_b32 v100, 16, v100
    v_add_f32 v98, v98, v100
    v_add_f32 v99, v99, v101
    v_cvt_pk_bf16_f32 v98, v98, v99
    v_and_b32 v99, 0xffff0000, v98
    v_lshlrev_b32 v98, 16, v98

    v_lshlrev_b32 v100, 16, v62
    v_and_b32 v101, 0xffff0000, v62
    v_mul_f32 v108, v98, v100
    v_mul_f32 v116, v99, v101
    v_cvt_pk_bf16_f32 v62, v108, v116

    v_mul_f32 v98, v69, v81
    v_mul_f32 v99, v73, v93
    v_cvt_pk_bf16_f32 v98, v98, v99
    v_and_b32 v99, 0xffff0000, v98
    v_lshlrev_b32 v98, 16, v98

    v_mul_f32 v100, v68, v82
    v_mul_f32 v101, v72, v94
    v_cvt_pk_bf16_f32 v100, v100, v101
    v_and_b32 v101, 0xffff0000, v100
    v_lshlrev_b32 v100, 16, v100
    v_add_f32 v98, v98, v100
    v_add_f32 v99, v99, v101
    v_cvt_pk_bf16_f32 v98, v98, v99
    v_and_b32 v99, 0xffff0000, v98
    v_lshlrev_b32 v98, 16, v98

    v_mul_f32 v100, v67, v83
    v_mul_f32 v101, v71, v95
    v_cvt_pk_bf16_f32 v100, v100, v101
    v_and_b32 v101, 0xffff0000, v100
    v_lshlrev_b32 v100, 16, v100
    v_add_f32 v98, v98, v100
    v_add_f32 v99, v99, v101
    v_cvt_pk_bf16_f32 v98, v98, v99
    v_and_b32 v99, 0xffff0000, v98
    v_lshlrev_b32 v98, 16, v98

    v_mul_f32 v100, v66, v84
    v_mul_f32 v101, v70, v96
    v_cvt_pk_bf16_f32 v100, v100, v101
    v_and_b32 v101, 0xffff0000, v100
    v_lshlrev_b32 v100, 16, v100
    v_add_f32 v98, v98, v100
    v_add_f32 v99, v99, v101
    v_cvt_pk_bf16_f32 v98, v98, v99
    v_and_b32 v99, 0xffff0000, v98
    v_lshlrev_b32 v98, 16, v98

    v_lshlrev_b32 v100, 16, v64
    v_and_b32 v101, 0xffff0000, v64
    v_mul_f32 v109, v98, v100
    v_mul_f32 v117, v99, v101
    v_cvt_pk_bf16_f32 v64, v109, v117

    v_cvt_pk_bf16_f32 v118, v109, v108
    v_cvt_pk_bf16_f32 v119, v107, v106
    v_cvt_pk_bf16_f32 v120, v105, v104
    v_cvt_pk_bf16_f32 v121, v103, v102
    s_mov_b32 s6, 125829120
    buffer_store_dwordx4 v[118:121], v19, s[8:11], s6 offen sc1
    v_cvt_pk_bf16_f32 v122, v117, v116
    v_cvt_pk_bf16_f32 v123, v115, v114
    v_cvt_pk_bf16_f32 v124, v113, v112
    v_cvt_pk_bf16_f32 v125, v111, v110
    s_mov_b32 s6, 125833216
    buffer_store_dwordx4 v[122:125], v19, s[8:11], s6 offen sc1
    s_nop 1
    v_lshlrev_b32 v66, 16, v24
    v_and_b32 v67, 0xffff0000, v24
    v_lshlrev_b32 v68, 16, v25
    v_and_b32 v69, 0xffff0000, v25

    v_lshlrev_b32 v70, 16, v26
    v_and_b32 v71, 0xffff0000, v26
    v_lshlrev_b32 v72, 16, v27
    v_and_b32 v73, 0xffff0000, v27

    v_lshlrev_b32 v74, 16, v29
    v_and_b32 v86, 0xffff0000, v29
    v_lshlrev_b32 v75, 16, v31
    v_and_b32 v87, 0xffff0000, v31
    v_lshlrev_b32 v76, 16, v33
    v_and_b32 v88, 0xffff0000, v33
    v_lshlrev_b32 v77, 16, v35
    v_and_b32 v89, 0xffff0000, v35
    v_lshlrev_b32 v78, 16, v37
    v_and_b32 v90, 0xffff0000, v37
    v_lshlrev_b32 v79, 16, v39
    v_and_b32 v91, 0xffff0000, v39
    v_lshlrev_b32 v80, 16, v41
    v_and_b32 v92, 0xffff0000, v41
    v_lshlrev_b32 v81, 16, v43
    v_and_b32 v93, 0xffff0000, v43
    v_lshlrev_b32 v82, 16, v45
    v_and_b32 v94, 0xffff0000, v45
    v_lshlrev_b32 v83, 16, v47
    v_and_b32 v95, 0xffff0000, v47
    v_lshlrev_b32 v84, 16, v49
    v_and_b32 v96, 0xffff0000, v49
    v_mul_f32 v98, v69, v74
    v_mul_f32 v99, v73, v86
    v_cvt_pk_bf16_f32 v98, v98, v99
    v_and_b32 v99, 0xffff0000, v98
    v_lshlrev_b32 v98, 16, v98

    v_mul_f32 v100, v68, v75
    v_mul_f32 v101, v72, v87
    v_cvt_pk_bf16_f32 v100, v100, v101
    v_and_b32 v101, 0xffff0000, v100
    v_lshlrev_b32 v100, 16, v100
    v_add_f32 v98, v98, v100
    v_add_f32 v99, v99, v101
    v_cvt_pk_bf16_f32 v98, v98, v99
    v_and_b32 v99, 0xffff0000, v98
    v_lshlrev_b32 v98, 16, v98

    v_mul_f32 v100, v67, v76
    v_mul_f32 v101, v71, v88
    v_cvt_pk_bf16_f32 v100, v100, v101
    v_and_b32 v101, 0xffff0000, v100
    v_lshlrev_b32 v100, 16, v100
    v_add_f32 v98, v98, v100
    v_add_f32 v99, v99, v101
    v_cvt_pk_bf16_f32 v98, v98, v99
    v_and_b32 v99, 0xffff0000, v98
    v_lshlrev_b32 v98, 16, v98

    v_mul_f32 v100, v66, v77
    v_mul_f32 v101, v70, v89
    v_cvt_pk_bf16_f32 v100, v100, v101
    v_and_b32 v101, 0xffff0000, v100
    v_lshlrev_b32 v100, 16, v100
    v_add_f32 v98, v98, v100
    v_add_f32 v99, v99, v101
    v_cvt_pk_bf16_f32 v98, v98, v99
    v_and_b32 v99, 0xffff0000, v98
    v_lshlrev_b32 v98, 16, v98

    v_lshlrev_b32 v100, 16, v51
    v_and_b32 v101, 0xffff0000, v51
    v_mul_f32 v102, v98, v100
    v_mul_f32 v110, v99, v101
    v_cvt_pk_bf16_f32 v51, v102, v110

    v_mul_f32 v98, v69, v75
    v_mul_f32 v99, v73, v87
    v_cvt_pk_bf16_f32 v98, v98, v99
    v_and_b32 v99, 0xffff0000, v98
    v_lshlrev_b32 v98, 16, v98

    v_mul_f32 v100, v68, v76
    v_mul_f32 v101, v72, v88
    v_cvt_pk_bf16_f32 v100, v100, v101
    v_and_b32 v101, 0xffff0000, v100
    v_lshlrev_b32 v100, 16, v100
    v_add_f32 v98, v98, v100
    v_add_f32 v99, v99, v101
    v_cvt_pk_bf16_f32 v98, v98, v99
    v_and_b32 v99, 0xffff0000, v98
    v_lshlrev_b32 v98, 16, v98

    v_mul_f32 v100, v67, v77
    v_mul_f32 v101, v71, v89
    v_cvt_pk_bf16_f32 v100, v100, v101
    v_and_b32 v101, 0xffff0000, v100
    v_lshlrev_b32 v100, 16, v100
    v_add_f32 v98, v98, v100
    v_add_f32 v99, v99, v101
    v_cvt_pk_bf16_f32 v98, v98, v99
    v_and_b32 v99, 0xffff0000, v98
    v_lshlrev_b32 v98, 16, v98

    v_mul_f32 v100, v66, v78
    v_mul_f32 v101, v70, v90
    v_cvt_pk_bf16_f32 v100, v100, v101
    v_and_b32 v101, 0xffff0000, v100
    v_lshlrev_b32 v100, 16, v100
    v_add_f32 v98, v98, v100
    v_add_f32 v99, v99, v101
    v_cvt_pk_bf16_f32 v98, v98, v99
    v_and_b32 v99, 0xffff0000, v98
    v_lshlrev_b32 v98, 16, v98

    v_lshlrev_b32 v100, 16, v53
    v_and_b32 v101, 0xffff0000, v53
    v_mul_f32 v103, v98, v100
    v_mul_f32 v111, v99, v101
    v_cvt_pk_bf16_f32 v53, v103, v111

    v_mul_f32 v98, v69, v76
    v_mul_f32 v99, v73, v88
    v_cvt_pk_bf16_f32 v98, v98, v99
    v_and_b32 v99, 0xffff0000, v98
    v_lshlrev_b32 v98, 16, v98

    v_mul_f32 v100, v68, v77
    v_mul_f32 v101, v72, v89
    v_cvt_pk_bf16_f32 v100, v100, v101
    v_and_b32 v101, 0xffff0000, v100
    v_lshlrev_b32 v100, 16, v100
    v_add_f32 v98, v98, v100
    v_add_f32 v99, v99, v101
    v_cvt_pk_bf16_f32 v98, v98, v99
    v_and_b32 v99, 0xffff0000, v98
    v_lshlrev_b32 v98, 16, v98

    v_mul_f32 v100, v67, v78
    v_mul_f32 v101, v71, v90
    v_cvt_pk_bf16_f32 v100, v100, v101
    v_and_b32 v101, 0xffff0000, v100
    v_lshlrev_b32 v100, 16, v100
    v_add_f32 v98, v98, v100
    v_add_f32 v99, v99, v101
    v_cvt_pk_bf16_f32 v98, v98, v99
    v_and_b32 v99, 0xffff0000, v98
    v_lshlrev_b32 v98, 16, v98

    v_mul_f32 v100, v66, v79
    v_mul_f32 v101, v70, v91
    v_cvt_pk_bf16_f32 v100, v100, v101
    v_and_b32 v101, 0xffff0000, v100
    v_lshlrev_b32 v100, 16, v100
    v_add_f32 v98, v98, v100
    v_add_f32 v99, v99, v101
    v_cvt_pk_bf16_f32 v98, v98, v99
    v_and_b32 v99, 0xffff0000, v98
    v_lshlrev_b32 v98, 16, v98

    v_lshlrev_b32 v100, 16, v55
    v_and_b32 v101, 0xffff0000, v55
    v_mul_f32 v104, v98, v100
    v_mul_f32 v112, v99, v101
    v_cvt_pk_bf16_f32 v55, v104, v112

    v_mul_f32 v98, v69, v77
    v_mul_f32 v99, v73, v89
    v_cvt_pk_bf16_f32 v98, v98, v99
    v_and_b32 v99, 0xffff0000, v98
    v_lshlrev_b32 v98, 16, v98

    v_mul_f32 v100, v68, v78
    v_mul_f32 v101, v72, v90
    v_cvt_pk_bf16_f32 v100, v100, v101
    v_and_b32 v101, 0xffff0000, v100
    v_lshlrev_b32 v100, 16, v100
    v_add_f32 v98, v98, v100
    v_add_f32 v99, v99, v101
    v_cvt_pk_bf16_f32 v98, v98, v99
    v_and_b32 v99, 0xffff0000, v98
    v_lshlrev_b32 v98, 16, v98

    v_mul_f32 v100, v67, v79
    v_mul_f32 v101, v71, v91
    v_cvt_pk_bf16_f32 v100, v100, v101
    v_and_b32 v101, 0xffff0000, v100
    v_lshlrev_b32 v100, 16, v100
    v_add_f32 v98, v98, v100
    v_add_f32 v99, v99, v101
    v_cvt_pk_bf16_f32 v98, v98, v99
    v_and_b32 v99, 0xffff0000, v98
    v_lshlrev_b32 v98, 16, v98

    v_mul_f32 v100, v66, v80
    v_mul_f32 v101, v70, v92
    v_cvt_pk_bf16_f32 v100, v100, v101
    v_and_b32 v101, 0xffff0000, v100
    v_lshlrev_b32 v100, 16, v100
    v_add_f32 v98, v98, v100
    v_add_f32 v99, v99, v101
    v_cvt_pk_bf16_f32 v98, v98, v99
    v_and_b32 v99, 0xffff0000, v98
    v_lshlrev_b32 v98, 16, v98

    v_lshlrev_b32 v100, 16, v57
    v_and_b32 v101, 0xffff0000, v57
    v_mul_f32 v105, v98, v100
    v_mul_f32 v113, v99, v101
    v_cvt_pk_bf16_f32 v57, v105, v113

    v_mul_f32 v98, v69, v78
    v_mul_f32 v99, v73, v90
    v_cvt_pk_bf16_f32 v98, v98, v99
    v_and_b32 v99, 0xffff0000, v98
    v_lshlrev_b32 v98, 16, v98

    v_mul_f32 v100, v68, v79
    v_mul_f32 v101, v72, v91
    v_cvt_pk_bf16_f32 v100, v100, v101
    v_and_b32 v101, 0xffff0000, v100
    v_lshlrev_b32 v100, 16, v100
    v_add_f32 v98, v98, v100
    v_add_f32 v99, v99, v101
    v_cvt_pk_bf16_f32 v98, v98, v99
    v_and_b32 v99, 0xffff0000, v98
    v_lshlrev_b32 v98, 16, v98

    v_mul_f32 v100, v67, v80
    v_mul_f32 v101, v71, v92
    v_cvt_pk_bf16_f32 v100, v100, v101
    v_and_b32 v101, 0xffff0000, v100
    v_lshlrev_b32 v100, 16, v100
    v_add_f32 v98, v98, v100
    v_add_f32 v99, v99, v101
    v_cvt_pk_bf16_f32 v98, v98, v99
    v_and_b32 v99, 0xffff0000, v98
    v_lshlrev_b32 v98, 16, v98

    v_mul_f32 v100, v66, v81
    v_mul_f32 v101, v70, v93
    v_cvt_pk_bf16_f32 v100, v100, v101
    v_and_b32 v101, 0xffff0000, v100
    v_lshlrev_b32 v100, 16, v100
    v_add_f32 v98, v98, v100
    v_add_f32 v99, v99, v101
    v_cvt_pk_bf16_f32 v98, v98, v99
    v_and_b32 v99, 0xffff0000, v98
    v_lshlrev_b32 v98, 16, v98

    v_lshlrev_b32 v100, 16, v59
    v_and_b32 v101, 0xffff0000, v59
    v_mul_f32 v106, v98, v100
    v_mul_f32 v114, v99, v101
    v_cvt_pk_bf16_f32 v59, v106, v114

    v_mul_f32 v98, v69, v79
    v_mul_f32 v99, v73, v91
    v_cvt_pk_bf16_f32 v98, v98, v99
    v_and_b32 v99, 0xffff0000, v98
    v_lshlrev_b32 v98, 16, v98

    v_mul_f32 v100, v68, v80
    v_mul_f32 v101, v72, v92
    v_cvt_pk_bf16_f32 v100, v100, v101
    v_and_b32 v101, 0xffff0000, v100
    v_lshlrev_b32 v100, 16, v100
    v_add_f32 v98, v98, v100
    v_add_f32 v99, v99, v101
    v_cvt_pk_bf16_f32 v98, v98, v99
    v_and_b32 v99, 0xffff0000, v98
    v_lshlrev_b32 v98, 16, v98

    v_mul_f32 v100, v67, v81
    v_mul_f32 v101, v71, v93
    v_cvt_pk_bf16_f32 v100, v100, v101
    v_and_b32 v101, 0xffff0000, v100
    v_lshlrev_b32 v100, 16, v100
    v_add_f32 v98, v98, v100
    v_add_f32 v99, v99, v101
    v_cvt_pk_bf16_f32 v98, v98, v99
    v_and_b32 v99, 0xffff0000, v98
    v_lshlrev_b32 v98, 16, v98

    v_mul_f32 v100, v66, v82
    v_mul_f32 v101, v70, v94
    v_cvt_pk_bf16_f32 v100, v100, v101
    v_and_b32 v101, 0xffff0000, v100
    v_lshlrev_b32 v100, 16, v100
    v_add_f32 v98, v98, v100
    v_add_f32 v99, v99, v101
    v_cvt_pk_bf16_f32 v98, v98, v99
    v_and_b32 v99, 0xffff0000, v98
    v_lshlrev_b32 v98, 16, v98

    v_lshlrev_b32 v100, 16, v61
    v_and_b32 v101, 0xffff0000, v61
    v_mul_f32 v107, v98, v100
    v_mul_f32 v115, v99, v101
    v_cvt_pk_bf16_f32 v61, v107, v115

    v_mul_f32 v98, v69, v80
    v_mul_f32 v99, v73, v92
    v_cvt_pk_bf16_f32 v98, v98, v99
    v_and_b32 v99, 0xffff0000, v98
    v_lshlrev_b32 v98, 16, v98

    v_mul_f32 v100, v68, v81
    v_mul_f32 v101, v72, v93
    v_cvt_pk_bf16_f32 v100, v100, v101
    v_and_b32 v101, 0xffff0000, v100
    v_lshlrev_b32 v100, 16, v100
    v_add_f32 v98, v98, v100
    v_add_f32 v99, v99, v101
    v_cvt_pk_bf16_f32 v98, v98, v99
    v_and_b32 v99, 0xffff0000, v98
    v_lshlrev_b32 v98, 16, v98

    v_mul_f32 v100, v67, v82
    v_mul_f32 v101, v71, v94
    v_cvt_pk_bf16_f32 v100, v100, v101
    v_and_b32 v101, 0xffff0000, v100
    v_lshlrev_b32 v100, 16, v100
    v_add_f32 v98, v98, v100
    v_add_f32 v99, v99, v101
    v_cvt_pk_bf16_f32 v98, v98, v99
    v_and_b32 v99, 0xffff0000, v98
    v_lshlrev_b32 v98, 16, v98

    v_mul_f32 v100, v66, v83
    v_mul_f32 v101, v70, v95
    v_cvt_pk_bf16_f32 v100, v100, v101
    v_and_b32 v101, 0xffff0000, v100
    v_lshlrev_b32 v100, 16, v100
    v_add_f32 v98, v98, v100
    v_add_f32 v99, v99, v101
    v_cvt_pk_bf16_f32 v98, v98, v99
    v_and_b32 v99, 0xffff0000, v98
    v_lshlrev_b32 v98, 16, v98

    v_lshlrev_b32 v100, 16, v63
    v_and_b32 v101, 0xffff0000, v63
    v_mul_f32 v108, v98, v100
    v_mul_f32 v116, v99, v101
    v_cvt_pk_bf16_f32 v63, v108, v116

    v_mul_f32 v98, v69, v81
    v_mul_f32 v99, v73, v93
    v_cvt_pk_bf16_f32 v98, v98, v99
    v_and_b32 v99, 0xffff0000, v98
    v_lshlrev_b32 v98, 16, v98

    v_mul_f32 v100, v68, v82
    v_mul_f32 v101, v72, v94
    v_cvt_pk_bf16_f32 v100, v100, v101
    v_and_b32 v101, 0xffff0000, v100
    v_lshlrev_b32 v100, 16, v100
    v_add_f32 v98, v98, v100
    v_add_f32 v99, v99, v101
    v_cvt_pk_bf16_f32 v98, v98, v99
    v_and_b32 v99, 0xffff0000, v98
    v_lshlrev_b32 v98, 16, v98

    v_mul_f32 v100, v67, v83
    v_mul_f32 v101, v71, v95
    v_cvt_pk_bf16_f32 v100, v100, v101
    v_and_b32 v101, 0xffff0000, v100
    v_lshlrev_b32 v100, 16, v100
    v_add_f32 v98, v98, v100
    v_add_f32 v99, v99, v101
    v_cvt_pk_bf16_f32 v98, v98, v99
    v_and_b32 v99, 0xffff0000, v98
    v_lshlrev_b32 v98, 16, v98

    v_mul_f32 v100, v66, v84
    v_mul_f32 v101, v70, v96
    v_cvt_pk_bf16_f32 v100, v100, v101
    v_and_b32 v101, 0xffff0000, v100
    v_lshlrev_b32 v100, 16, v100
    v_add_f32 v98, v98, v100
    v_add_f32 v99, v99, v101
    v_cvt_pk_bf16_f32 v98, v98, v99
    v_and_b32 v99, 0xffff0000, v98
    v_lshlrev_b32 v98, 16, v98

    v_lshlrev_b32 v100, 16, v65
    v_and_b32 v101, 0xffff0000, v65
    v_mul_f32 v109, v98, v100
    v_mul_f32 v117, v99, v101
    v_cvt_pk_bf16_f32 v65, v109, v117

    v_cvt_pk_bf16_f32 v118, v109, v108
    v_cvt_pk_bf16_f32 v119, v107, v106
    v_cvt_pk_bf16_f32 v120, v105, v104
    v_cvt_pk_bf16_f32 v121, v103, v102
    s_mov_b32 s6, 125837312
    buffer_store_dwordx4 v[118:121], v19, s[8:11], s6 offen sc1
    v_cvt_pk_bf16_f32 v122, v117, v116
    v_cvt_pk_bf16_f32 v123, v115, v114
    v_cvt_pk_bf16_f32 v124, v113, v112
    v_cvt_pk_bf16_f32 v125, v111, v110
    s_mov_b32 s6, 125841408
    buffer_store_dwordx4 v[122:125], v19, s[8:11], s6 offen sc1
    s_nop 1
    s_add_u32 s94, s94, 32
    s_cmp_lt_u32 s94, 256
    s_cbranch_scc1 .kp_498

    s_waitcnt vmcnt(0) lgkmcnt(0)
    s_barrier
    s_mov_b32 s5, 40
    s_cmp_lg_u32 s24, 0
    s_cbranch_scc1 .sg_499
    s_mov_b64 exec, 1
    v_mov_b32 v4, 1
    v_mov_b32 v5, 0
    buffer_atomic_add v4, v5, s[20:23], s5 offen sc1
    s_mov_b64 exec, -1

.sg_499:
    s_mov_b32 s3, s93
    v_and_b32 v1, 63, v0
    v_and_b32 v2, 15, v1
    v_lshrrev_b32 v3, 4, v1

    s_load_dwordx2 s[40:41], s[0:1], 0
    s_load_dwordx2 s[42:43], s[0:1], 104
    s_waitcnt lgkmcnt(0)

    s_mov_b32 s12, s40
    s_and_b32 s13, s41, 0xffff
    s_mov_b32 s14, 0x400000
    s_mov_b32 s15, 0x00020000

    s_mov_b32 s16, s42
    s_and_b32 s17, s43, 0xffff
    s_mov_b32 s18, 0x800
    s_mov_b32 s19, 0x00020000

    s_lshl_b32 s3, s3, 6
    s_lshl_b32 s4, s24, 4
    s_add_u32 s3, s3, s4
    v_lshlrev_b32 v8, 4, v1
    buffer_load_dwordx4 v[16:19], v8, s[16:19], 0 offen
    buffer_load_dwordx4 v[20:23], v8, s[16:19], 0 offen offset:1024
    s_lshl_b32 s5, s3, 11

    buffer_load_dwordx4 v[64:67], v8, s[12:15], s5 offen
    buffer_load_dwordx4 v[68:71], v8, s[12:15], s5 offen offset:1024
    s_add_u32 s5, s5, 2048

    buffer_load_dwordx4 v[72:75], v8, s[12:15], s5 offen
    buffer_load_dwordx4 v[76:79], v8, s[12:15], s5 offen offset:1024
    s_add_u32 s5, s5, 2048

    buffer_load_dwordx4 v[80:83], v8, s[12:15], s5 offen
    buffer_load_dwordx4 v[84:87], v8, s[12:15], s5 offen offset:1024
    s_add_u32 s5, s5, 2048

    buffer_load_dwordx4 v[88:91], v8, s[12:15], s5 offen
    buffer_load_dwordx4 v[92:95], v8, s[12:15], s5 offen offset:1024
    s_add_u32 s5, s5, 2048

    buffer_load_dwordx4 v[96:99], v8, s[12:15], s5 offen
    buffer_load_dwordx4 v[100:103], v8, s[12:15], s5 offen offset:1024
    s_add_u32 s5, s5, 2048

    buffer_load_dwordx4 v[104:107], v8, s[12:15], s5 offen
    buffer_load_dwordx4 v[108:111], v8, s[12:15], s5 offen offset:1024
    s_add_u32 s5, s5, 2048

    buffer_load_dwordx4 v[112:115], v8, s[12:15], s5 offen
    buffer_load_dwordx4 v[116:119], v8, s[12:15], s5 offen offset:1024
    s_add_u32 s5, s5, 2048

    buffer_load_dwordx4 v[120:123], v8, s[12:15], s5 offen
    buffer_load_dwordx4 v[124:127], v8, s[12:15], s5 offen offset:1024
    s_add_u32 s5, s5, 2048

    buffer_load_dwordx4 v[128:131], v8, s[12:15], s5 offen
    buffer_load_dwordx4 v[132:135], v8, s[12:15], s5 offen offset:1024
    s_add_u32 s5, s5, 2048

    buffer_load_dwordx4 v[136:139], v8, s[12:15], s5 offen
    buffer_load_dwordx4 v[140:143], v8, s[12:15], s5 offen offset:1024
    s_add_u32 s5, s5, 2048

    buffer_load_dwordx4 v[144:147], v8, s[12:15], s5 offen
    buffer_load_dwordx4 v[148:151], v8, s[12:15], s5 offen offset:1024
    s_add_u32 s5, s5, 2048

    buffer_load_dwordx4 v[152:155], v8, s[12:15], s5 offen
    buffer_load_dwordx4 v[156:159], v8, s[12:15], s5 offen offset:1024
    s_add_u32 s5, s5, 2048

    buffer_load_dwordx4 v[160:163], v8, s[12:15], s5 offen
    buffer_load_dwordx4 v[164:167], v8, s[12:15], s5 offen offset:1024
    s_add_u32 s5, s5, 2048

    buffer_load_dwordx4 v[168:171], v8, s[12:15], s5 offen
    buffer_load_dwordx4 v[172:175], v8, s[12:15], s5 offen offset:1024
    s_add_u32 s5, s5, 2048

    buffer_load_dwordx4 v[176:179], v8, s[12:15], s5 offen
    buffer_load_dwordx4 v[180:183], v8, s[12:15], s5 offen offset:1024
    s_add_u32 s5, s5, 2048

    buffer_load_dwordx4 v[184:187], v8, s[12:15], s5 offen
    buffer_load_dwordx4 v[188:191], v8, s[12:15], s5 offen offset:1024
    s_add_u32 s5, s5, 2048

    s_waitcnt vmcnt(32)
    v_lshlrev_b32 v24, 16, v16
    v_and_b32 v25, 0xffff0000, v16
    v_lshlrev_b32 v26, 16, v17
    v_and_b32 v27, 0xffff0000, v17
    v_lshlrev_b32 v28, 16, v18
    v_and_b32 v29, 0xffff0000, v18
    v_lshlrev_b32 v30, 16, v19
    v_and_b32 v31, 0xffff0000, v19
    v_lshlrev_b32 v32, 16, v20
    v_and_b32 v33, 0xffff0000, v20
    v_lshlrev_b32 v34, 16, v21
    v_and_b32 v35, 0xffff0000, v21
    v_lshlrev_b32 v36, 16, v22
    v_and_b32 v37, 0xffff0000, v22
    v_lshlrev_b32 v38, 16, v23
    v_and_b32 v39, 0xffff0000, v23
    s_mov_b32 s38, 0xbfb8aa3b
    v_mov_b32 v60, 0
    s_waitcnt vmcnt(30)
    v_lshlrev_b32 v40, 16, v64
    v_and_b32 v41, 0xffff0000, v64
    v_mul_f32 v40, v40, v24
    v_mul_f32 v41, v41, v25
    v_cvt_pk_bf16_f32 v40, v40, v41
    v_and_b32 v41, 0xffff0000, v40
    v_lshlrev_b32 v40, 16, v40

    v_lshlrev_b32 v42, 16, v65
    v_and_b32 v43, 0xffff0000, v65
    v_mul_f32 v42, v42, v26
    v_mul_f32 v43, v43, v27
    v_cvt_pk_bf16_f32 v42, v42, v43
    v_and_b32 v43, 0xffff0000, v42
    v_lshlrev_b32 v42, 16, v42

    v_lshlrev_b32 v44, 16, v66
    v_and_b32 v45, 0xffff0000, v66
    v_mul_f32 v44, v44, v28
    v_mul_f32 v45, v45, v29
    v_cvt_pk_bf16_f32 v44, v44, v45
    v_and_b32 v45, 0xffff0000, v44
    v_lshlrev_b32 v44, 16, v44

    v_lshlrev_b32 v46, 16, v67
    v_and_b32 v47, 0xffff0000, v67
    v_mul_f32 v46, v46, v30
    v_mul_f32 v47, v47, v31
    v_cvt_pk_bf16_f32 v46, v46, v47
    v_and_b32 v47, 0xffff0000, v46
    v_lshlrev_b32 v46, 16, v46

    v_lshlrev_b32 v48, 16, v68
    v_and_b32 v49, 0xffff0000, v68
    v_mul_f32 v48, v48, v32
    v_mul_f32 v49, v49, v33
    v_cvt_pk_bf16_f32 v48, v48, v49
    v_and_b32 v49, 0xffff0000, v48
    v_lshlrev_b32 v48, 16, v48

    v_lshlrev_b32 v50, 16, v69
    v_and_b32 v51, 0xffff0000, v69
    v_mul_f32 v50, v50, v34
    v_mul_f32 v51, v51, v35
    v_cvt_pk_bf16_f32 v50, v50, v51
    v_and_b32 v51, 0xffff0000, v50
    v_lshlrev_b32 v50, 16, v50

    v_lshlrev_b32 v52, 16, v70
    v_and_b32 v53, 0xffff0000, v70
    v_mul_f32 v52, v52, v36
    v_mul_f32 v53, v53, v37
    v_cvt_pk_bf16_f32 v52, v52, v53
    v_and_b32 v53, 0xffff0000, v52
    v_lshlrev_b32 v52, 16, v52

    v_lshlrev_b32 v54, 16, v71
    v_and_b32 v55, 0xffff0000, v71
    v_mul_f32 v54, v54, v38
    v_mul_f32 v55, v55, v39
    v_cvt_pk_bf16_f32 v54, v54, v55
    v_and_b32 v55, 0xffff0000, v54
    v_lshlrev_b32 v54, 16, v54

    v_add_f32 v40, v40, v48
    v_add_f32 v41, v41, v49
    v_add_f32 v42, v42, v50
    v_add_f32 v43, v43, v51
    v_add_f32 v44, v44, v52
    v_add_f32 v45, v45, v53
    v_add_f32 v46, v46, v54
    v_add_f32 v47, v47, v55
    v_add_f32 v40, v40, v44
    v_add_f32 v41, v41, v45
    v_add_f32 v42, v42, v46
    v_add_f32 v43, v43, v47
    v_add_f32 v40, v40, v42
    v_add_f32 v41, v41, v43
    v_add_f32 v40, v40, v41
    v_mov_b32 v41, v40
    s_nop 1
    v_permlane32_swap_b32 v40, v41
    v_add_f32 v40, v40, v41
    v_mov_b32 v41, v40
    s_nop 1
    v_permlane16_swap_b32 v40, v41
    v_add_f32 v40, v40, v41
    s_nop 1
    v_add_f32_dpp v40, v40, v40 row_ror:8 row_mask:0xf bank_mask:0xf
    s_nop 1
    v_add_f32_dpp v40, v40, v40 row_ror:4 row_mask:0xf bank_mask:0xf
    s_nop 1
    v_add_f32_dpp v40, v40, v40 row_ror:2 row_mask:0xf bank_mask:0xf
    s_nop 1
    v_add_f32_dpp v40, v40, v40 row_ror:1 row_mask:0xf bank_mask:0xf
    v_cvt_pk_bf16_f32 v40, v40, v40
    v_lshlrev_b32 v40, 16, v40
    v_mul_f32 v40, s38, v40
    v_exp_f32 v40, v40
    s_nop 0
    v_add_f32 v40, 1.0, v40
    v_rcp_f32 v40, v40
    s_nop 0
    v_cvt_pk_bf16_f32 v40, v40, v40
    v_lshlrev_b32 v40, 16, v40

    v_cmp_eq_u32 vcc, 0, v1
    s_nop 1
    v_cndmask_b32 v60, v60, v40, vcc
    s_waitcnt vmcnt(28)
    v_lshlrev_b32 v40, 16, v72
    v_and_b32 v41, 0xffff0000, v72
    v_mul_f32 v40, v40, v24
    v_mul_f32 v41, v41, v25
    v_cvt_pk_bf16_f32 v40, v40, v41
    v_and_b32 v41, 0xffff0000, v40
    v_lshlrev_b32 v40, 16, v40

    v_lshlrev_b32 v42, 16, v73
    v_and_b32 v43, 0xffff0000, v73
    v_mul_f32 v42, v42, v26
    v_mul_f32 v43, v43, v27
    v_cvt_pk_bf16_f32 v42, v42, v43
    v_and_b32 v43, 0xffff0000, v42
    v_lshlrev_b32 v42, 16, v42

    v_lshlrev_b32 v44, 16, v74
    v_and_b32 v45, 0xffff0000, v74
    v_mul_f32 v44, v44, v28
    v_mul_f32 v45, v45, v29
    v_cvt_pk_bf16_f32 v44, v44, v45
    v_and_b32 v45, 0xffff0000, v44
    v_lshlrev_b32 v44, 16, v44

    v_lshlrev_b32 v46, 16, v75
    v_and_b32 v47, 0xffff0000, v75
    v_mul_f32 v46, v46, v30
    v_mul_f32 v47, v47, v31
    v_cvt_pk_bf16_f32 v46, v46, v47
    v_and_b32 v47, 0xffff0000, v46
    v_lshlrev_b32 v46, 16, v46

    v_lshlrev_b32 v48, 16, v76
    v_and_b32 v49, 0xffff0000, v76
    v_mul_f32 v48, v48, v32
    v_mul_f32 v49, v49, v33
    v_cvt_pk_bf16_f32 v48, v48, v49
    v_and_b32 v49, 0xffff0000, v48
    v_lshlrev_b32 v48, 16, v48

    v_lshlrev_b32 v50, 16, v77
    v_and_b32 v51, 0xffff0000, v77
    v_mul_f32 v50, v50, v34
    v_mul_f32 v51, v51, v35
    v_cvt_pk_bf16_f32 v50, v50, v51
    v_and_b32 v51, 0xffff0000, v50
    v_lshlrev_b32 v50, 16, v50

    v_lshlrev_b32 v52, 16, v78
    v_and_b32 v53, 0xffff0000, v78
    v_mul_f32 v52, v52, v36
    v_mul_f32 v53, v53, v37
    v_cvt_pk_bf16_f32 v52, v52, v53
    v_and_b32 v53, 0xffff0000, v52
    v_lshlrev_b32 v52, 16, v52

    v_lshlrev_b32 v54, 16, v79
    v_and_b32 v55, 0xffff0000, v79
    v_mul_f32 v54, v54, v38
    v_mul_f32 v55, v55, v39
    v_cvt_pk_bf16_f32 v54, v54, v55
    v_and_b32 v55, 0xffff0000, v54
    v_lshlrev_b32 v54, 16, v54

    v_add_f32 v40, v40, v48
    v_add_f32 v41, v41, v49
    v_add_f32 v42, v42, v50
    v_add_f32 v43, v43, v51
    v_add_f32 v44, v44, v52
    v_add_f32 v45, v45, v53
    v_add_f32 v46, v46, v54
    v_add_f32 v47, v47, v55
    v_add_f32 v40, v40, v44
    v_add_f32 v41, v41, v45
    v_add_f32 v42, v42, v46
    v_add_f32 v43, v43, v47
    v_add_f32 v40, v40, v42
    v_add_f32 v41, v41, v43
    v_add_f32 v40, v40, v41
    v_mov_b32 v41, v40
    s_nop 1
    v_permlane32_swap_b32 v40, v41
    v_add_f32 v40, v40, v41
    v_mov_b32 v41, v40
    s_nop 1
    v_permlane16_swap_b32 v40, v41
    v_add_f32 v40, v40, v41
    s_nop 1
    v_add_f32_dpp v40, v40, v40 row_ror:8 row_mask:0xf bank_mask:0xf
    s_nop 1
    v_add_f32_dpp v40, v40, v40 row_ror:4 row_mask:0xf bank_mask:0xf
    s_nop 1
    v_add_f32_dpp v40, v40, v40 row_ror:2 row_mask:0xf bank_mask:0xf
    s_nop 1
    v_add_f32_dpp v40, v40, v40 row_ror:1 row_mask:0xf bank_mask:0xf
    v_cvt_pk_bf16_f32 v40, v40, v40
    v_lshlrev_b32 v40, 16, v40
    v_mul_f32 v40, s38, v40
    v_exp_f32 v40, v40
    s_nop 0
    v_add_f32 v40, 1.0, v40
    v_rcp_f32 v40, v40
    s_nop 0
    v_cvt_pk_bf16_f32 v40, v40, v40
    v_lshlrev_b32 v40, 16, v40

    v_cmp_eq_u32 vcc, 1, v1
    s_nop 1
    v_cndmask_b32 v60, v60, v40, vcc
    s_waitcnt vmcnt(26)
    v_lshlrev_b32 v40, 16, v80
    v_and_b32 v41, 0xffff0000, v80
    v_mul_f32 v40, v40, v24
    v_mul_f32 v41, v41, v25
    v_cvt_pk_bf16_f32 v40, v40, v41
    v_and_b32 v41, 0xffff0000, v40
    v_lshlrev_b32 v40, 16, v40

    v_lshlrev_b32 v42, 16, v81
    v_and_b32 v43, 0xffff0000, v81
    v_mul_f32 v42, v42, v26
    v_mul_f32 v43, v43, v27
    v_cvt_pk_bf16_f32 v42, v42, v43
    v_and_b32 v43, 0xffff0000, v42
    v_lshlrev_b32 v42, 16, v42

    v_lshlrev_b32 v44, 16, v82
    v_and_b32 v45, 0xffff0000, v82
    v_mul_f32 v44, v44, v28
    v_mul_f32 v45, v45, v29
    v_cvt_pk_bf16_f32 v44, v44, v45
    v_and_b32 v45, 0xffff0000, v44
    v_lshlrev_b32 v44, 16, v44

    v_lshlrev_b32 v46, 16, v83
    v_and_b32 v47, 0xffff0000, v83
    v_mul_f32 v46, v46, v30
    v_mul_f32 v47, v47, v31
    v_cvt_pk_bf16_f32 v46, v46, v47
    v_and_b32 v47, 0xffff0000, v46
    v_lshlrev_b32 v46, 16, v46

    v_lshlrev_b32 v48, 16, v84
    v_and_b32 v49, 0xffff0000, v84
    v_mul_f32 v48, v48, v32
    v_mul_f32 v49, v49, v33
    v_cvt_pk_bf16_f32 v48, v48, v49
    v_and_b32 v49, 0xffff0000, v48
    v_lshlrev_b32 v48, 16, v48

    v_lshlrev_b32 v50, 16, v85
    v_and_b32 v51, 0xffff0000, v85
    v_mul_f32 v50, v50, v34
    v_mul_f32 v51, v51, v35
    v_cvt_pk_bf16_f32 v50, v50, v51
    v_and_b32 v51, 0xffff0000, v50
    v_lshlrev_b32 v50, 16, v50

    v_lshlrev_b32 v52, 16, v86
    v_and_b32 v53, 0xffff0000, v86
    v_mul_f32 v52, v52, v36
    v_mul_f32 v53, v53, v37
    v_cvt_pk_bf16_f32 v52, v52, v53
    v_and_b32 v53, 0xffff0000, v52
    v_lshlrev_b32 v52, 16, v52

    v_lshlrev_b32 v54, 16, v87
    v_and_b32 v55, 0xffff0000, v87
    v_mul_f32 v54, v54, v38
    v_mul_f32 v55, v55, v39
    v_cvt_pk_bf16_f32 v54, v54, v55
    v_and_b32 v55, 0xffff0000, v54
    v_lshlrev_b32 v54, 16, v54

    v_add_f32 v40, v40, v48
    v_add_f32 v41, v41, v49
    v_add_f32 v42, v42, v50
    v_add_f32 v43, v43, v51
    v_add_f32 v44, v44, v52
    v_add_f32 v45, v45, v53
    v_add_f32 v46, v46, v54
    v_add_f32 v47, v47, v55
    v_add_f32 v40, v40, v44
    v_add_f32 v41, v41, v45
    v_add_f32 v42, v42, v46
    v_add_f32 v43, v43, v47
    v_add_f32 v40, v40, v42
    v_add_f32 v41, v41, v43
    v_add_f32 v40, v40, v41
    v_mov_b32 v41, v40
    s_nop 1
    v_permlane32_swap_b32 v40, v41
    v_add_f32 v40, v40, v41
    v_mov_b32 v41, v40
    s_nop 1
    v_permlane16_swap_b32 v40, v41
    v_add_f32 v40, v40, v41
    s_nop 1
    v_add_f32_dpp v40, v40, v40 row_ror:8 row_mask:0xf bank_mask:0xf
    s_nop 1
    v_add_f32_dpp v40, v40, v40 row_ror:4 row_mask:0xf bank_mask:0xf
    s_nop 1
    v_add_f32_dpp v40, v40, v40 row_ror:2 row_mask:0xf bank_mask:0xf
    s_nop 1
    v_add_f32_dpp v40, v40, v40 row_ror:1 row_mask:0xf bank_mask:0xf
    v_cvt_pk_bf16_f32 v40, v40, v40
    v_lshlrev_b32 v40, 16, v40
    v_mul_f32 v40, s38, v40
    v_exp_f32 v40, v40
    s_nop 0
    v_add_f32 v40, 1.0, v40
    v_rcp_f32 v40, v40
    s_nop 0
    v_cvt_pk_bf16_f32 v40, v40, v40
    v_lshlrev_b32 v40, 16, v40

    v_cmp_eq_u32 vcc, 2, v1
    s_nop 1
    v_cndmask_b32 v60, v60, v40, vcc
    s_waitcnt vmcnt(24)
    v_lshlrev_b32 v40, 16, v88
    v_and_b32 v41, 0xffff0000, v88
    v_mul_f32 v40, v40, v24
    v_mul_f32 v41, v41, v25
    v_cvt_pk_bf16_f32 v40, v40, v41
    v_and_b32 v41, 0xffff0000, v40
    v_lshlrev_b32 v40, 16, v40

    v_lshlrev_b32 v42, 16, v89
    v_and_b32 v43, 0xffff0000, v89
    v_mul_f32 v42, v42, v26
    v_mul_f32 v43, v43, v27
    v_cvt_pk_bf16_f32 v42, v42, v43
    v_and_b32 v43, 0xffff0000, v42
    v_lshlrev_b32 v42, 16, v42

    v_lshlrev_b32 v44, 16, v90
    v_and_b32 v45, 0xffff0000, v90
    v_mul_f32 v44, v44, v28
    v_mul_f32 v45, v45, v29
    v_cvt_pk_bf16_f32 v44, v44, v45
    v_and_b32 v45, 0xffff0000, v44
    v_lshlrev_b32 v44, 16, v44

    v_lshlrev_b32 v46, 16, v91
    v_and_b32 v47, 0xffff0000, v91
    v_mul_f32 v46, v46, v30
    v_mul_f32 v47, v47, v31
    v_cvt_pk_bf16_f32 v46, v46, v47
    v_and_b32 v47, 0xffff0000, v46
    v_lshlrev_b32 v46, 16, v46

    v_lshlrev_b32 v48, 16, v92
    v_and_b32 v49, 0xffff0000, v92
    v_mul_f32 v48, v48, v32
    v_mul_f32 v49, v49, v33
    v_cvt_pk_bf16_f32 v48, v48, v49
    v_and_b32 v49, 0xffff0000, v48
    v_lshlrev_b32 v48, 16, v48

    v_lshlrev_b32 v50, 16, v93
    v_and_b32 v51, 0xffff0000, v93
    v_mul_f32 v50, v50, v34
    v_mul_f32 v51, v51, v35
    v_cvt_pk_bf16_f32 v50, v50, v51
    v_and_b32 v51, 0xffff0000, v50
    v_lshlrev_b32 v50, 16, v50

    v_lshlrev_b32 v52, 16, v94
    v_and_b32 v53, 0xffff0000, v94
    v_mul_f32 v52, v52, v36
    v_mul_f32 v53, v53, v37
    v_cvt_pk_bf16_f32 v52, v52, v53
    v_and_b32 v53, 0xffff0000, v52
    v_lshlrev_b32 v52, 16, v52

    v_lshlrev_b32 v54, 16, v95
    v_and_b32 v55, 0xffff0000, v95
    v_mul_f32 v54, v54, v38
    v_mul_f32 v55, v55, v39
    v_cvt_pk_bf16_f32 v54, v54, v55
    v_and_b32 v55, 0xffff0000, v54
    v_lshlrev_b32 v54, 16, v54

    v_add_f32 v40, v40, v48
    v_add_f32 v41, v41, v49
    v_add_f32 v42, v42, v50
    v_add_f32 v43, v43, v51
    v_add_f32 v44, v44, v52
    v_add_f32 v45, v45, v53
    v_add_f32 v46, v46, v54
    v_add_f32 v47, v47, v55
    v_add_f32 v40, v40, v44
    v_add_f32 v41, v41, v45
    v_add_f32 v42, v42, v46
    v_add_f32 v43, v43, v47
    v_add_f32 v40, v40, v42
    v_add_f32 v41, v41, v43
    v_add_f32 v40, v40, v41
    v_mov_b32 v41, v40
    s_nop 1
    v_permlane32_swap_b32 v40, v41
    v_add_f32 v40, v40, v41
    v_mov_b32 v41, v40
    s_nop 1
    v_permlane16_swap_b32 v40, v41
    v_add_f32 v40, v40, v41
    s_nop 1
    v_add_f32_dpp v40, v40, v40 row_ror:8 row_mask:0xf bank_mask:0xf
    s_nop 1
    v_add_f32_dpp v40, v40, v40 row_ror:4 row_mask:0xf bank_mask:0xf
    s_nop 1
    v_add_f32_dpp v40, v40, v40 row_ror:2 row_mask:0xf bank_mask:0xf
    s_nop 1
    v_add_f32_dpp v40, v40, v40 row_ror:1 row_mask:0xf bank_mask:0xf
    v_cvt_pk_bf16_f32 v40, v40, v40
    v_lshlrev_b32 v40, 16, v40
    v_mul_f32 v40, s38, v40
    v_exp_f32 v40, v40
    s_nop 0
    v_add_f32 v40, 1.0, v40
    v_rcp_f32 v40, v40
    s_nop 0
    v_cvt_pk_bf16_f32 v40, v40, v40
    v_lshlrev_b32 v40, 16, v40

    v_cmp_eq_u32 vcc, 3, v1
    s_nop 1
    v_cndmask_b32 v60, v60, v40, vcc
    s_waitcnt vmcnt(22)
    v_lshlrev_b32 v40, 16, v96
    v_and_b32 v41, 0xffff0000, v96
    v_mul_f32 v40, v40, v24
    v_mul_f32 v41, v41, v25
    v_cvt_pk_bf16_f32 v40, v40, v41
    v_and_b32 v41, 0xffff0000, v40
    v_lshlrev_b32 v40, 16, v40

    v_lshlrev_b32 v42, 16, v97
    v_and_b32 v43, 0xffff0000, v97
    v_mul_f32 v42, v42, v26
    v_mul_f32 v43, v43, v27
    v_cvt_pk_bf16_f32 v42, v42, v43
    v_and_b32 v43, 0xffff0000, v42
    v_lshlrev_b32 v42, 16, v42

    v_lshlrev_b32 v44, 16, v98
    v_and_b32 v45, 0xffff0000, v98
    v_mul_f32 v44, v44, v28
    v_mul_f32 v45, v45, v29
    v_cvt_pk_bf16_f32 v44, v44, v45
    v_and_b32 v45, 0xffff0000, v44
    v_lshlrev_b32 v44, 16, v44

    v_lshlrev_b32 v46, 16, v99
    v_and_b32 v47, 0xffff0000, v99
    v_mul_f32 v46, v46, v30
    v_mul_f32 v47, v47, v31
    v_cvt_pk_bf16_f32 v46, v46, v47
    v_and_b32 v47, 0xffff0000, v46
    v_lshlrev_b32 v46, 16, v46

    v_lshlrev_b32 v48, 16, v100
    v_and_b32 v49, 0xffff0000, v100
    v_mul_f32 v48, v48, v32
    v_mul_f32 v49, v49, v33
    v_cvt_pk_bf16_f32 v48, v48, v49
    v_and_b32 v49, 0xffff0000, v48
    v_lshlrev_b32 v48, 16, v48

    v_lshlrev_b32 v50, 16, v101
    v_and_b32 v51, 0xffff0000, v101
    v_mul_f32 v50, v50, v34
    v_mul_f32 v51, v51, v35
    v_cvt_pk_bf16_f32 v50, v50, v51
    v_and_b32 v51, 0xffff0000, v50
    v_lshlrev_b32 v50, 16, v50

    v_lshlrev_b32 v52, 16, v102
    v_and_b32 v53, 0xffff0000, v102
    v_mul_f32 v52, v52, v36
    v_mul_f32 v53, v53, v37
    v_cvt_pk_bf16_f32 v52, v52, v53
    v_and_b32 v53, 0xffff0000, v52
    v_lshlrev_b32 v52, 16, v52

    v_lshlrev_b32 v54, 16, v103
    v_and_b32 v55, 0xffff0000, v103
    v_mul_f32 v54, v54, v38
    v_mul_f32 v55, v55, v39
    v_cvt_pk_bf16_f32 v54, v54, v55
    v_and_b32 v55, 0xffff0000, v54
    v_lshlrev_b32 v54, 16, v54

    v_add_f32 v40, v40, v48
    v_add_f32 v41, v41, v49
    v_add_f32 v42, v42, v50
    v_add_f32 v43, v43, v51
    v_add_f32 v44, v44, v52
    v_add_f32 v45, v45, v53
    v_add_f32 v46, v46, v54
    v_add_f32 v47, v47, v55
    v_add_f32 v40, v40, v44
    v_add_f32 v41, v41, v45
    v_add_f32 v42, v42, v46
    v_add_f32 v43, v43, v47
    v_add_f32 v40, v40, v42
    v_add_f32 v41, v41, v43
    v_add_f32 v40, v40, v41
    v_mov_b32 v41, v40
    s_nop 1
    v_permlane32_swap_b32 v40, v41
    v_add_f32 v40, v40, v41
    v_mov_b32 v41, v40
    s_nop 1
    v_permlane16_swap_b32 v40, v41
    v_add_f32 v40, v40, v41
    s_nop 1
    v_add_f32_dpp v40, v40, v40 row_ror:8 row_mask:0xf bank_mask:0xf
    s_nop 1
    v_add_f32_dpp v40, v40, v40 row_ror:4 row_mask:0xf bank_mask:0xf
    s_nop 1
    v_add_f32_dpp v40, v40, v40 row_ror:2 row_mask:0xf bank_mask:0xf
    s_nop 1
    v_add_f32_dpp v40, v40, v40 row_ror:1 row_mask:0xf bank_mask:0xf
    v_cvt_pk_bf16_f32 v40, v40, v40
    v_lshlrev_b32 v40, 16, v40
    v_mul_f32 v40, s38, v40
    v_exp_f32 v40, v40
    s_nop 0
    v_add_f32 v40, 1.0, v40
    v_rcp_f32 v40, v40
    s_nop 0
    v_cvt_pk_bf16_f32 v40, v40, v40
    v_lshlrev_b32 v40, 16, v40

    v_cmp_eq_u32 vcc, 4, v1
    s_nop 1
    v_cndmask_b32 v60, v60, v40, vcc
    s_waitcnt vmcnt(20)
    v_lshlrev_b32 v40, 16, v104
    v_and_b32 v41, 0xffff0000, v104
    v_mul_f32 v40, v40, v24
    v_mul_f32 v41, v41, v25
    v_cvt_pk_bf16_f32 v40, v40, v41
    v_and_b32 v41, 0xffff0000, v40
    v_lshlrev_b32 v40, 16, v40

    v_lshlrev_b32 v42, 16, v105
    v_and_b32 v43, 0xffff0000, v105
    v_mul_f32 v42, v42, v26
    v_mul_f32 v43, v43, v27
    v_cvt_pk_bf16_f32 v42, v42, v43
    v_and_b32 v43, 0xffff0000, v42
    v_lshlrev_b32 v42, 16, v42

    v_lshlrev_b32 v44, 16, v106
    v_and_b32 v45, 0xffff0000, v106
    v_mul_f32 v44, v44, v28
    v_mul_f32 v45, v45, v29
    v_cvt_pk_bf16_f32 v44, v44, v45
    v_and_b32 v45, 0xffff0000, v44
    v_lshlrev_b32 v44, 16, v44

    v_lshlrev_b32 v46, 16, v107
    v_and_b32 v47, 0xffff0000, v107
    v_mul_f32 v46, v46, v30
    v_mul_f32 v47, v47, v31
    v_cvt_pk_bf16_f32 v46, v46, v47
    v_and_b32 v47, 0xffff0000, v46
    v_lshlrev_b32 v46, 16, v46

    v_lshlrev_b32 v48, 16, v108
    v_and_b32 v49, 0xffff0000, v108
    v_mul_f32 v48, v48, v32
    v_mul_f32 v49, v49, v33
    v_cvt_pk_bf16_f32 v48, v48, v49
    v_and_b32 v49, 0xffff0000, v48
    v_lshlrev_b32 v48, 16, v48

    v_lshlrev_b32 v50, 16, v109
    v_and_b32 v51, 0xffff0000, v109
    v_mul_f32 v50, v50, v34
    v_mul_f32 v51, v51, v35
    v_cvt_pk_bf16_f32 v50, v50, v51
    v_and_b32 v51, 0xffff0000, v50
    v_lshlrev_b32 v50, 16, v50

    v_lshlrev_b32 v52, 16, v110
    v_and_b32 v53, 0xffff0000, v110
    v_mul_f32 v52, v52, v36
    v_mul_f32 v53, v53, v37
    v_cvt_pk_bf16_f32 v52, v52, v53
    v_and_b32 v53, 0xffff0000, v52
    v_lshlrev_b32 v52, 16, v52

    v_lshlrev_b32 v54, 16, v111
    v_and_b32 v55, 0xffff0000, v111
    v_mul_f32 v54, v54, v38
    v_mul_f32 v55, v55, v39
    v_cvt_pk_bf16_f32 v54, v54, v55
    v_and_b32 v55, 0xffff0000, v54
    v_lshlrev_b32 v54, 16, v54

    v_add_f32 v40, v40, v48
    v_add_f32 v41, v41, v49
    v_add_f32 v42, v42, v50
    v_add_f32 v43, v43, v51
    v_add_f32 v44, v44, v52
    v_add_f32 v45, v45, v53
    v_add_f32 v46, v46, v54
    v_add_f32 v47, v47, v55
    v_add_f32 v40, v40, v44
    v_add_f32 v41, v41, v45
    v_add_f32 v42, v42, v46
    v_add_f32 v43, v43, v47
    v_add_f32 v40, v40, v42
    v_add_f32 v41, v41, v43
    v_add_f32 v40, v40, v41
    v_mov_b32 v41, v40
    s_nop 1
    v_permlane32_swap_b32 v40, v41
    v_add_f32 v40, v40, v41
    v_mov_b32 v41, v40
    s_nop 1
    v_permlane16_swap_b32 v40, v41
    v_add_f32 v40, v40, v41
    s_nop 1
    v_add_f32_dpp v40, v40, v40 row_ror:8 row_mask:0xf bank_mask:0xf
    s_nop 1
    v_add_f32_dpp v40, v40, v40 row_ror:4 row_mask:0xf bank_mask:0xf
    s_nop 1
    v_add_f32_dpp v40, v40, v40 row_ror:2 row_mask:0xf bank_mask:0xf
    s_nop 1
    v_add_f32_dpp v40, v40, v40 row_ror:1 row_mask:0xf bank_mask:0xf
    v_cvt_pk_bf16_f32 v40, v40, v40
    v_lshlrev_b32 v40, 16, v40
    v_mul_f32 v40, s38, v40
    v_exp_f32 v40, v40
    s_nop 0
    v_add_f32 v40, 1.0, v40
    v_rcp_f32 v40, v40
    s_nop 0
    v_cvt_pk_bf16_f32 v40, v40, v40
    v_lshlrev_b32 v40, 16, v40

    v_cmp_eq_u32 vcc, 5, v1
    s_nop 1
    v_cndmask_b32 v60, v60, v40, vcc
    s_waitcnt vmcnt(18)
    v_lshlrev_b32 v40, 16, v112
    v_and_b32 v41, 0xffff0000, v112
    v_mul_f32 v40, v40, v24
    v_mul_f32 v41, v41, v25
    v_cvt_pk_bf16_f32 v40, v40, v41
    v_and_b32 v41, 0xffff0000, v40
    v_lshlrev_b32 v40, 16, v40

    v_lshlrev_b32 v42, 16, v113
    v_and_b32 v43, 0xffff0000, v113
    v_mul_f32 v42, v42, v26
    v_mul_f32 v43, v43, v27
    v_cvt_pk_bf16_f32 v42, v42, v43
    v_and_b32 v43, 0xffff0000, v42
    v_lshlrev_b32 v42, 16, v42

    v_lshlrev_b32 v44, 16, v114
    v_and_b32 v45, 0xffff0000, v114
    v_mul_f32 v44, v44, v28
    v_mul_f32 v45, v45, v29
    v_cvt_pk_bf16_f32 v44, v44, v45
    v_and_b32 v45, 0xffff0000, v44
    v_lshlrev_b32 v44, 16, v44

    v_lshlrev_b32 v46, 16, v115
    v_and_b32 v47, 0xffff0000, v115
    v_mul_f32 v46, v46, v30
    v_mul_f32 v47, v47, v31
    v_cvt_pk_bf16_f32 v46, v46, v47
    v_and_b32 v47, 0xffff0000, v46
    v_lshlrev_b32 v46, 16, v46

    v_lshlrev_b32 v48, 16, v116
    v_and_b32 v49, 0xffff0000, v116
    v_mul_f32 v48, v48, v32
    v_mul_f32 v49, v49, v33
    v_cvt_pk_bf16_f32 v48, v48, v49
    v_and_b32 v49, 0xffff0000, v48
    v_lshlrev_b32 v48, 16, v48

    v_lshlrev_b32 v50, 16, v117
    v_and_b32 v51, 0xffff0000, v117
    v_mul_f32 v50, v50, v34
    v_mul_f32 v51, v51, v35
    v_cvt_pk_bf16_f32 v50, v50, v51
    v_and_b32 v51, 0xffff0000, v50
    v_lshlrev_b32 v50, 16, v50

    v_lshlrev_b32 v52, 16, v118
    v_and_b32 v53, 0xffff0000, v118
    v_mul_f32 v52, v52, v36
    v_mul_f32 v53, v53, v37
    v_cvt_pk_bf16_f32 v52, v52, v53
    v_and_b32 v53, 0xffff0000, v52
    v_lshlrev_b32 v52, 16, v52

    v_lshlrev_b32 v54, 16, v119
    v_and_b32 v55, 0xffff0000, v119
    v_mul_f32 v54, v54, v38
    v_mul_f32 v55, v55, v39
    v_cvt_pk_bf16_f32 v54, v54, v55
    v_and_b32 v55, 0xffff0000, v54
    v_lshlrev_b32 v54, 16, v54

    v_add_f32 v40, v40, v48
    v_add_f32 v41, v41, v49
    v_add_f32 v42, v42, v50
    v_add_f32 v43, v43, v51
    v_add_f32 v44, v44, v52
    v_add_f32 v45, v45, v53
    v_add_f32 v46, v46, v54
    v_add_f32 v47, v47, v55
    v_add_f32 v40, v40, v44
    v_add_f32 v41, v41, v45
    v_add_f32 v42, v42, v46
    v_add_f32 v43, v43, v47
    v_add_f32 v40, v40, v42
    v_add_f32 v41, v41, v43
    v_add_f32 v40, v40, v41
    v_mov_b32 v41, v40
    s_nop 1
    v_permlane32_swap_b32 v40, v41
    v_add_f32 v40, v40, v41
    v_mov_b32 v41, v40
    s_nop 1
    v_permlane16_swap_b32 v40, v41
    v_add_f32 v40, v40, v41
    s_nop 1
    v_add_f32_dpp v40, v40, v40 row_ror:8 row_mask:0xf bank_mask:0xf
    s_nop 1
    v_add_f32_dpp v40, v40, v40 row_ror:4 row_mask:0xf bank_mask:0xf
    s_nop 1
    v_add_f32_dpp v40, v40, v40 row_ror:2 row_mask:0xf bank_mask:0xf
    s_nop 1
    v_add_f32_dpp v40, v40, v40 row_ror:1 row_mask:0xf bank_mask:0xf
    v_cvt_pk_bf16_f32 v40, v40, v40
    v_lshlrev_b32 v40, 16, v40
    v_mul_f32 v40, s38, v40
    v_exp_f32 v40, v40
    s_nop 0
    v_add_f32 v40, 1.0, v40
    v_rcp_f32 v40, v40
    s_nop 0
    v_cvt_pk_bf16_f32 v40, v40, v40
    v_lshlrev_b32 v40, 16, v40

    v_cmp_eq_u32 vcc, 6, v1
    s_nop 1
    v_cndmask_b32 v60, v60, v40, vcc
    s_waitcnt vmcnt(16)
    v_lshlrev_b32 v40, 16, v120
    v_and_b32 v41, 0xffff0000, v120
    v_mul_f32 v40, v40, v24
    v_mul_f32 v41, v41, v25
    v_cvt_pk_bf16_f32 v40, v40, v41
    v_and_b32 v41, 0xffff0000, v40
    v_lshlrev_b32 v40, 16, v40

    v_lshlrev_b32 v42, 16, v121
    v_and_b32 v43, 0xffff0000, v121
    v_mul_f32 v42, v42, v26
    v_mul_f32 v43, v43, v27
    v_cvt_pk_bf16_f32 v42, v42, v43
    v_and_b32 v43, 0xffff0000, v42
    v_lshlrev_b32 v42, 16, v42

    v_lshlrev_b32 v44, 16, v122
    v_and_b32 v45, 0xffff0000, v122
    v_mul_f32 v44, v44, v28
    v_mul_f32 v45, v45, v29
    v_cvt_pk_bf16_f32 v44, v44, v45
    v_and_b32 v45, 0xffff0000, v44
    v_lshlrev_b32 v44, 16, v44

    v_lshlrev_b32 v46, 16, v123
    v_and_b32 v47, 0xffff0000, v123
    v_mul_f32 v46, v46, v30
    v_mul_f32 v47, v47, v31
    v_cvt_pk_bf16_f32 v46, v46, v47
    v_and_b32 v47, 0xffff0000, v46
    v_lshlrev_b32 v46, 16, v46

    v_lshlrev_b32 v48, 16, v124
    v_and_b32 v49, 0xffff0000, v124
    v_mul_f32 v48, v48, v32
    v_mul_f32 v49, v49, v33
    v_cvt_pk_bf16_f32 v48, v48, v49
    v_and_b32 v49, 0xffff0000, v48
    v_lshlrev_b32 v48, 16, v48

    v_lshlrev_b32 v50, 16, v125
    v_and_b32 v51, 0xffff0000, v125
    v_mul_f32 v50, v50, v34
    v_mul_f32 v51, v51, v35
    v_cvt_pk_bf16_f32 v50, v50, v51
    v_and_b32 v51, 0xffff0000, v50
    v_lshlrev_b32 v50, 16, v50

    v_lshlrev_b32 v52, 16, v126
    v_and_b32 v53, 0xffff0000, v126
    v_mul_f32 v52, v52, v36
    v_mul_f32 v53, v53, v37
    v_cvt_pk_bf16_f32 v52, v52, v53
    v_and_b32 v53, 0xffff0000, v52
    v_lshlrev_b32 v52, 16, v52

    v_lshlrev_b32 v54, 16, v127
    v_and_b32 v55, 0xffff0000, v127
    v_mul_f32 v54, v54, v38
    v_mul_f32 v55, v55, v39
    v_cvt_pk_bf16_f32 v54, v54, v55
    v_and_b32 v55, 0xffff0000, v54
    v_lshlrev_b32 v54, 16, v54

    v_add_f32 v40, v40, v48
    v_add_f32 v41, v41, v49
    v_add_f32 v42, v42, v50
    v_add_f32 v43, v43, v51
    v_add_f32 v44, v44, v52
    v_add_f32 v45, v45, v53
    v_add_f32 v46, v46, v54
    v_add_f32 v47, v47, v55
    v_add_f32 v40, v40, v44
    v_add_f32 v41, v41, v45
    v_add_f32 v42, v42, v46
    v_add_f32 v43, v43, v47
    v_add_f32 v40, v40, v42
    v_add_f32 v41, v41, v43
    v_add_f32 v40, v40, v41
    v_mov_b32 v41, v40
    s_nop 1
    v_permlane32_swap_b32 v40, v41
    v_add_f32 v40, v40, v41
    v_mov_b32 v41, v40
    s_nop 1
    v_permlane16_swap_b32 v40, v41
    v_add_f32 v40, v40, v41
    s_nop 1
    v_add_f32_dpp v40, v40, v40 row_ror:8 row_mask:0xf bank_mask:0xf
    s_nop 1
    v_add_f32_dpp v40, v40, v40 row_ror:4 row_mask:0xf bank_mask:0xf
    s_nop 1
    v_add_f32_dpp v40, v40, v40 row_ror:2 row_mask:0xf bank_mask:0xf
    s_nop 1
    v_add_f32_dpp v40, v40, v40 row_ror:1 row_mask:0xf bank_mask:0xf
    v_cvt_pk_bf16_f32 v40, v40, v40
    v_lshlrev_b32 v40, 16, v40
    v_mul_f32 v40, s38, v40
    v_exp_f32 v40, v40
    s_nop 0
    v_add_f32 v40, 1.0, v40
    v_rcp_f32 v40, v40
    s_nop 0
    v_cvt_pk_bf16_f32 v40, v40, v40
    v_lshlrev_b32 v40, 16, v40

    v_cmp_eq_u32 vcc, 7, v1
    s_nop 1
    v_cndmask_b32 v60, v60, v40, vcc
    s_waitcnt vmcnt(14)
    v_lshlrev_b32 v40, 16, v128
    v_and_b32 v41, 0xffff0000, v128
    v_mul_f32 v40, v40, v24
    v_mul_f32 v41, v41, v25
    v_cvt_pk_bf16_f32 v40, v40, v41
    v_and_b32 v41, 0xffff0000, v40
    v_lshlrev_b32 v40, 16, v40

    v_lshlrev_b32 v42, 16, v129
    v_and_b32 v43, 0xffff0000, v129
    v_mul_f32 v42, v42, v26
    v_mul_f32 v43, v43, v27
    v_cvt_pk_bf16_f32 v42, v42, v43
    v_and_b32 v43, 0xffff0000, v42
    v_lshlrev_b32 v42, 16, v42

    v_lshlrev_b32 v44, 16, v130
    v_and_b32 v45, 0xffff0000, v130
    v_mul_f32 v44, v44, v28
    v_mul_f32 v45, v45, v29
    v_cvt_pk_bf16_f32 v44, v44, v45
    v_and_b32 v45, 0xffff0000, v44
    v_lshlrev_b32 v44, 16, v44

    v_lshlrev_b32 v46, 16, v131
    v_and_b32 v47, 0xffff0000, v131
    v_mul_f32 v46, v46, v30
    v_mul_f32 v47, v47, v31
    v_cvt_pk_bf16_f32 v46, v46, v47
    v_and_b32 v47, 0xffff0000, v46
    v_lshlrev_b32 v46, 16, v46

    v_lshlrev_b32 v48, 16, v132
    v_and_b32 v49, 0xffff0000, v132
    v_mul_f32 v48, v48, v32
    v_mul_f32 v49, v49, v33
    v_cvt_pk_bf16_f32 v48, v48, v49
    v_and_b32 v49, 0xffff0000, v48
    v_lshlrev_b32 v48, 16, v48

    v_lshlrev_b32 v50, 16, v133
    v_and_b32 v51, 0xffff0000, v133
    v_mul_f32 v50, v50, v34
    v_mul_f32 v51, v51, v35
    v_cvt_pk_bf16_f32 v50, v50, v51
    v_and_b32 v51, 0xffff0000, v50
    v_lshlrev_b32 v50, 16, v50

    v_lshlrev_b32 v52, 16, v134
    v_and_b32 v53, 0xffff0000, v134
    v_mul_f32 v52, v52, v36
    v_mul_f32 v53, v53, v37
    v_cvt_pk_bf16_f32 v52, v52, v53
    v_and_b32 v53, 0xffff0000, v52
    v_lshlrev_b32 v52, 16, v52

    v_lshlrev_b32 v54, 16, v135
    v_and_b32 v55, 0xffff0000, v135
    v_mul_f32 v54, v54, v38
    v_mul_f32 v55, v55, v39
    v_cvt_pk_bf16_f32 v54, v54, v55
    v_and_b32 v55, 0xffff0000, v54
    v_lshlrev_b32 v54, 16, v54

    v_add_f32 v40, v40, v48
    v_add_f32 v41, v41, v49
    v_add_f32 v42, v42, v50
    v_add_f32 v43, v43, v51
    v_add_f32 v44, v44, v52
    v_add_f32 v45, v45, v53
    v_add_f32 v46, v46, v54
    v_add_f32 v47, v47, v55
    v_add_f32 v40, v40, v44
    v_add_f32 v41, v41, v45
    v_add_f32 v42, v42, v46
    v_add_f32 v43, v43, v47
    v_add_f32 v40, v40, v42
    v_add_f32 v41, v41, v43
    v_add_f32 v40, v40, v41
    v_mov_b32 v41, v40
    s_nop 1
    v_permlane32_swap_b32 v40, v41
    v_add_f32 v40, v40, v41
    v_mov_b32 v41, v40
    s_nop 1
    v_permlane16_swap_b32 v40, v41
    v_add_f32 v40, v40, v41
    s_nop 1
    v_add_f32_dpp v40, v40, v40 row_ror:8 row_mask:0xf bank_mask:0xf
    s_nop 1
    v_add_f32_dpp v40, v40, v40 row_ror:4 row_mask:0xf bank_mask:0xf
    s_nop 1
    v_add_f32_dpp v40, v40, v40 row_ror:2 row_mask:0xf bank_mask:0xf
    s_nop 1
    v_add_f32_dpp v40, v40, v40 row_ror:1 row_mask:0xf bank_mask:0xf
    v_cvt_pk_bf16_f32 v40, v40, v40
    v_lshlrev_b32 v40, 16, v40
    v_mul_f32 v40, s38, v40
    v_exp_f32 v40, v40
    s_nop 0
    v_add_f32 v40, 1.0, v40
    v_rcp_f32 v40, v40
    s_nop 0
    v_cvt_pk_bf16_f32 v40, v40, v40
    v_lshlrev_b32 v40, 16, v40

    v_cmp_eq_u32 vcc, 8, v1
    s_nop 1
    v_cndmask_b32 v60, v60, v40, vcc
    s_waitcnt vmcnt(12)
    v_lshlrev_b32 v40, 16, v136
    v_and_b32 v41, 0xffff0000, v136
    v_mul_f32 v40, v40, v24
    v_mul_f32 v41, v41, v25
    v_cvt_pk_bf16_f32 v40, v40, v41
    v_and_b32 v41, 0xffff0000, v40
    v_lshlrev_b32 v40, 16, v40

    v_lshlrev_b32 v42, 16, v137
    v_and_b32 v43, 0xffff0000, v137
    v_mul_f32 v42, v42, v26
    v_mul_f32 v43, v43, v27
    v_cvt_pk_bf16_f32 v42, v42, v43
    v_and_b32 v43, 0xffff0000, v42
    v_lshlrev_b32 v42, 16, v42

    v_lshlrev_b32 v44, 16, v138
    v_and_b32 v45, 0xffff0000, v138
    v_mul_f32 v44, v44, v28
    v_mul_f32 v45, v45, v29
    v_cvt_pk_bf16_f32 v44, v44, v45
    v_and_b32 v45, 0xffff0000, v44
    v_lshlrev_b32 v44, 16, v44

    v_lshlrev_b32 v46, 16, v139
    v_and_b32 v47, 0xffff0000, v139
    v_mul_f32 v46, v46, v30
    v_mul_f32 v47, v47, v31
    v_cvt_pk_bf16_f32 v46, v46, v47
    v_and_b32 v47, 0xffff0000, v46
    v_lshlrev_b32 v46, 16, v46

    v_lshlrev_b32 v48, 16, v140
    v_and_b32 v49, 0xffff0000, v140
    v_mul_f32 v48, v48, v32
    v_mul_f32 v49, v49, v33
    v_cvt_pk_bf16_f32 v48, v48, v49
    v_and_b32 v49, 0xffff0000, v48
    v_lshlrev_b32 v48, 16, v48

    v_lshlrev_b32 v50, 16, v141
    v_and_b32 v51, 0xffff0000, v141
    v_mul_f32 v50, v50, v34
    v_mul_f32 v51, v51, v35
    v_cvt_pk_bf16_f32 v50, v50, v51
    v_and_b32 v51, 0xffff0000, v50
    v_lshlrev_b32 v50, 16, v50

    v_lshlrev_b32 v52, 16, v142
    v_and_b32 v53, 0xffff0000, v142
    v_mul_f32 v52, v52, v36
    v_mul_f32 v53, v53, v37
    v_cvt_pk_bf16_f32 v52, v52, v53
    v_and_b32 v53, 0xffff0000, v52
    v_lshlrev_b32 v52, 16, v52

    v_lshlrev_b32 v54, 16, v143
    v_and_b32 v55, 0xffff0000, v143
    v_mul_f32 v54, v54, v38
    v_mul_f32 v55, v55, v39
    v_cvt_pk_bf16_f32 v54, v54, v55
    v_and_b32 v55, 0xffff0000, v54
    v_lshlrev_b32 v54, 16, v54

    v_add_f32 v40, v40, v48
    v_add_f32 v41, v41, v49
    v_add_f32 v42, v42, v50
    v_add_f32 v43, v43, v51
    v_add_f32 v44, v44, v52
    v_add_f32 v45, v45, v53
    v_add_f32 v46, v46, v54
    v_add_f32 v47, v47, v55
    v_add_f32 v40, v40, v44
    v_add_f32 v41, v41, v45
    v_add_f32 v42, v42, v46
    v_add_f32 v43, v43, v47
    v_add_f32 v40, v40, v42
    v_add_f32 v41, v41, v43
    v_add_f32 v40, v40, v41
    v_mov_b32 v41, v40
    s_nop 1
    v_permlane32_swap_b32 v40, v41
    v_add_f32 v40, v40, v41
    v_mov_b32 v41, v40
    s_nop 1
    v_permlane16_swap_b32 v40, v41
    v_add_f32 v40, v40, v41
    s_nop 1
    v_add_f32_dpp v40, v40, v40 row_ror:8 row_mask:0xf bank_mask:0xf
    s_nop 1
    v_add_f32_dpp v40, v40, v40 row_ror:4 row_mask:0xf bank_mask:0xf
    s_nop 1
    v_add_f32_dpp v40, v40, v40 row_ror:2 row_mask:0xf bank_mask:0xf
    s_nop 1
    v_add_f32_dpp v40, v40, v40 row_ror:1 row_mask:0xf bank_mask:0xf
    v_cvt_pk_bf16_f32 v40, v40, v40
    v_lshlrev_b32 v40, 16, v40
    v_mul_f32 v40, s38, v40
    v_exp_f32 v40, v40
    s_nop 0
    v_add_f32 v40, 1.0, v40
    v_rcp_f32 v40, v40
    s_nop 0
    v_cvt_pk_bf16_f32 v40, v40, v40
    v_lshlrev_b32 v40, 16, v40

    v_cmp_eq_u32 vcc, 9, v1
    s_nop 1
    v_cndmask_b32 v60, v60, v40, vcc
    s_waitcnt vmcnt(10)
    v_lshlrev_b32 v40, 16, v144
    v_and_b32 v41, 0xffff0000, v144
    v_mul_f32 v40, v40, v24
    v_mul_f32 v41, v41, v25
    v_cvt_pk_bf16_f32 v40, v40, v41
    v_and_b32 v41, 0xffff0000, v40
    v_lshlrev_b32 v40, 16, v40

    v_lshlrev_b32 v42, 16, v145
    v_and_b32 v43, 0xffff0000, v145
    v_mul_f32 v42, v42, v26
    v_mul_f32 v43, v43, v27
    v_cvt_pk_bf16_f32 v42, v42, v43
    v_and_b32 v43, 0xffff0000, v42
    v_lshlrev_b32 v42, 16, v42

    v_lshlrev_b32 v44, 16, v146
    v_and_b32 v45, 0xffff0000, v146
    v_mul_f32 v44, v44, v28
    v_mul_f32 v45, v45, v29
    v_cvt_pk_bf16_f32 v44, v44, v45
    v_and_b32 v45, 0xffff0000, v44
    v_lshlrev_b32 v44, 16, v44

    v_lshlrev_b32 v46, 16, v147
    v_and_b32 v47, 0xffff0000, v147
    v_mul_f32 v46, v46, v30
    v_mul_f32 v47, v47, v31
    v_cvt_pk_bf16_f32 v46, v46, v47
    v_and_b32 v47, 0xffff0000, v46
    v_lshlrev_b32 v46, 16, v46

    v_lshlrev_b32 v48, 16, v148
    v_and_b32 v49, 0xffff0000, v148
    v_mul_f32 v48, v48, v32
    v_mul_f32 v49, v49, v33
    v_cvt_pk_bf16_f32 v48, v48, v49
    v_and_b32 v49, 0xffff0000, v48
    v_lshlrev_b32 v48, 16, v48

    v_lshlrev_b32 v50, 16, v149
    v_and_b32 v51, 0xffff0000, v149
    v_mul_f32 v50, v50, v34
    v_mul_f32 v51, v51, v35
    v_cvt_pk_bf16_f32 v50, v50, v51
    v_and_b32 v51, 0xffff0000, v50
    v_lshlrev_b32 v50, 16, v50

    v_lshlrev_b32 v52, 16, v150
    v_and_b32 v53, 0xffff0000, v150
    v_mul_f32 v52, v52, v36
    v_mul_f32 v53, v53, v37
    v_cvt_pk_bf16_f32 v52, v52, v53
    v_and_b32 v53, 0xffff0000, v52
    v_lshlrev_b32 v52, 16, v52

    v_lshlrev_b32 v54, 16, v151
    v_and_b32 v55, 0xffff0000, v151
    v_mul_f32 v54, v54, v38
    v_mul_f32 v55, v55, v39
    v_cvt_pk_bf16_f32 v54, v54, v55
    v_and_b32 v55, 0xffff0000, v54
    v_lshlrev_b32 v54, 16, v54

    v_add_f32 v40, v40, v48
    v_add_f32 v41, v41, v49
    v_add_f32 v42, v42, v50
    v_add_f32 v43, v43, v51
    v_add_f32 v44, v44, v52
    v_add_f32 v45, v45, v53
    v_add_f32 v46, v46, v54
    v_add_f32 v47, v47, v55
    v_add_f32 v40, v40, v44
    v_add_f32 v41, v41, v45
    v_add_f32 v42, v42, v46
    v_add_f32 v43, v43, v47
    v_add_f32 v40, v40, v42
    v_add_f32 v41, v41, v43
    v_add_f32 v40, v40, v41
    v_mov_b32 v41, v40
    s_nop 1
    v_permlane32_swap_b32 v40, v41
    v_add_f32 v40, v40, v41
    v_mov_b32 v41, v40
    s_nop 1
    v_permlane16_swap_b32 v40, v41
    v_add_f32 v40, v40, v41
    s_nop 1
    v_add_f32_dpp v40, v40, v40 row_ror:8 row_mask:0xf bank_mask:0xf
    s_nop 1
    v_add_f32_dpp v40, v40, v40 row_ror:4 row_mask:0xf bank_mask:0xf
    s_nop 1
    v_add_f32_dpp v40, v40, v40 row_ror:2 row_mask:0xf bank_mask:0xf
    s_nop 1
    v_add_f32_dpp v40, v40, v40 row_ror:1 row_mask:0xf bank_mask:0xf
    v_cvt_pk_bf16_f32 v40, v40, v40
    v_lshlrev_b32 v40, 16, v40
    v_mul_f32 v40, s38, v40
    v_exp_f32 v40, v40
    s_nop 0
    v_add_f32 v40, 1.0, v40
    v_rcp_f32 v40, v40
    s_nop 0
    v_cvt_pk_bf16_f32 v40, v40, v40
    v_lshlrev_b32 v40, 16, v40

    v_cmp_eq_u32 vcc, 10, v1
    s_nop 1
    v_cndmask_b32 v60, v60, v40, vcc
    s_waitcnt vmcnt(8)
    v_lshlrev_b32 v40, 16, v152
    v_and_b32 v41, 0xffff0000, v152
    v_mul_f32 v40, v40, v24
    v_mul_f32 v41, v41, v25
    v_cvt_pk_bf16_f32 v40, v40, v41
    v_and_b32 v41, 0xffff0000, v40
    v_lshlrev_b32 v40, 16, v40

    v_lshlrev_b32 v42, 16, v153
    v_and_b32 v43, 0xffff0000, v153
    v_mul_f32 v42, v42, v26
    v_mul_f32 v43, v43, v27
    v_cvt_pk_bf16_f32 v42, v42, v43
    v_and_b32 v43, 0xffff0000, v42
    v_lshlrev_b32 v42, 16, v42

    v_lshlrev_b32 v44, 16, v154
    v_and_b32 v45, 0xffff0000, v154
    v_mul_f32 v44, v44, v28
    v_mul_f32 v45, v45, v29
    v_cvt_pk_bf16_f32 v44, v44, v45
    v_and_b32 v45, 0xffff0000, v44
    v_lshlrev_b32 v44, 16, v44

    v_lshlrev_b32 v46, 16, v155
    v_and_b32 v47, 0xffff0000, v155
    v_mul_f32 v46, v46, v30
    v_mul_f32 v47, v47, v31
    v_cvt_pk_bf16_f32 v46, v46, v47
    v_and_b32 v47, 0xffff0000, v46
    v_lshlrev_b32 v46, 16, v46

    v_lshlrev_b32 v48, 16, v156
    v_and_b32 v49, 0xffff0000, v156
    v_mul_f32 v48, v48, v32
    v_mul_f32 v49, v49, v33
    v_cvt_pk_bf16_f32 v48, v48, v49
    v_and_b32 v49, 0xffff0000, v48
    v_lshlrev_b32 v48, 16, v48

    v_lshlrev_b32 v50, 16, v157
    v_and_b32 v51, 0xffff0000, v157
    v_mul_f32 v50, v50, v34
    v_mul_f32 v51, v51, v35
    v_cvt_pk_bf16_f32 v50, v50, v51
    v_and_b32 v51, 0xffff0000, v50
    v_lshlrev_b32 v50, 16, v50

    v_lshlrev_b32 v52, 16, v158
    v_and_b32 v53, 0xffff0000, v158
    v_mul_f32 v52, v52, v36
    v_mul_f32 v53, v53, v37
    v_cvt_pk_bf16_f32 v52, v52, v53
    v_and_b32 v53, 0xffff0000, v52
    v_lshlrev_b32 v52, 16, v52

    v_lshlrev_b32 v54, 16, v159
    v_and_b32 v55, 0xffff0000, v159
    v_mul_f32 v54, v54, v38
    v_mul_f32 v55, v55, v39
    v_cvt_pk_bf16_f32 v54, v54, v55
    v_and_b32 v55, 0xffff0000, v54
    v_lshlrev_b32 v54, 16, v54

    v_add_f32 v40, v40, v48
    v_add_f32 v41, v41, v49
    v_add_f32 v42, v42, v50
    v_add_f32 v43, v43, v51
    v_add_f32 v44, v44, v52
    v_add_f32 v45, v45, v53
    v_add_f32 v46, v46, v54
    v_add_f32 v47, v47, v55
    v_add_f32 v40, v40, v44
    v_add_f32 v41, v41, v45
    v_add_f32 v42, v42, v46
    v_add_f32 v43, v43, v47
    v_add_f32 v40, v40, v42
    v_add_f32 v41, v41, v43
    v_add_f32 v40, v40, v41
    v_mov_b32 v41, v40
    s_nop 1
    v_permlane32_swap_b32 v40, v41
    v_add_f32 v40, v40, v41
    v_mov_b32 v41, v40
    s_nop 1
    v_permlane16_swap_b32 v40, v41
    v_add_f32 v40, v40, v41
    s_nop 1
    v_add_f32_dpp v40, v40, v40 row_ror:8 row_mask:0xf bank_mask:0xf
    s_nop 1
    v_add_f32_dpp v40, v40, v40 row_ror:4 row_mask:0xf bank_mask:0xf
    s_nop 1
    v_add_f32_dpp v40, v40, v40 row_ror:2 row_mask:0xf bank_mask:0xf
    s_nop 1
    v_add_f32_dpp v40, v40, v40 row_ror:1 row_mask:0xf bank_mask:0xf
    v_cvt_pk_bf16_f32 v40, v40, v40
    v_lshlrev_b32 v40, 16, v40
    v_mul_f32 v40, s38, v40
    v_exp_f32 v40, v40
    s_nop 0
    v_add_f32 v40, 1.0, v40
    v_rcp_f32 v40, v40
    s_nop 0
    v_cvt_pk_bf16_f32 v40, v40, v40
    v_lshlrev_b32 v40, 16, v40

    v_cmp_eq_u32 vcc, 11, v1
    s_nop 1
    v_cndmask_b32 v60, v60, v40, vcc
    s_waitcnt vmcnt(6)
    v_lshlrev_b32 v40, 16, v160
    v_and_b32 v41, 0xffff0000, v160
    v_mul_f32 v40, v40, v24
    v_mul_f32 v41, v41, v25
    v_cvt_pk_bf16_f32 v40, v40, v41
    v_and_b32 v41, 0xffff0000, v40
    v_lshlrev_b32 v40, 16, v40

    v_lshlrev_b32 v42, 16, v161
    v_and_b32 v43, 0xffff0000, v161
    v_mul_f32 v42, v42, v26
    v_mul_f32 v43, v43, v27
    v_cvt_pk_bf16_f32 v42, v42, v43
    v_and_b32 v43, 0xffff0000, v42
    v_lshlrev_b32 v42, 16, v42

    v_lshlrev_b32 v44, 16, v162
    v_and_b32 v45, 0xffff0000, v162
    v_mul_f32 v44, v44, v28
    v_mul_f32 v45, v45, v29
    v_cvt_pk_bf16_f32 v44, v44, v45
    v_and_b32 v45, 0xffff0000, v44
    v_lshlrev_b32 v44, 16, v44

    v_lshlrev_b32 v46, 16, v163
    v_and_b32 v47, 0xffff0000, v163
    v_mul_f32 v46, v46, v30
    v_mul_f32 v47, v47, v31
    v_cvt_pk_bf16_f32 v46, v46, v47
    v_and_b32 v47, 0xffff0000, v46
    v_lshlrev_b32 v46, 16, v46

    v_lshlrev_b32 v48, 16, v164
    v_and_b32 v49, 0xffff0000, v164
    v_mul_f32 v48, v48, v32
    v_mul_f32 v49, v49, v33
    v_cvt_pk_bf16_f32 v48, v48, v49
    v_and_b32 v49, 0xffff0000, v48
    v_lshlrev_b32 v48, 16, v48

    v_lshlrev_b32 v50, 16, v165
    v_and_b32 v51, 0xffff0000, v165
    v_mul_f32 v50, v50, v34
    v_mul_f32 v51, v51, v35
    v_cvt_pk_bf16_f32 v50, v50, v51
    v_and_b32 v51, 0xffff0000, v50
    v_lshlrev_b32 v50, 16, v50

    v_lshlrev_b32 v52, 16, v166
    v_and_b32 v53, 0xffff0000, v166
    v_mul_f32 v52, v52, v36
    v_mul_f32 v53, v53, v37
    v_cvt_pk_bf16_f32 v52, v52, v53
    v_and_b32 v53, 0xffff0000, v52
    v_lshlrev_b32 v52, 16, v52

    v_lshlrev_b32 v54, 16, v167
    v_and_b32 v55, 0xffff0000, v167
    v_mul_f32 v54, v54, v38
    v_mul_f32 v55, v55, v39
    v_cvt_pk_bf16_f32 v54, v54, v55
    v_and_b32 v55, 0xffff0000, v54
    v_lshlrev_b32 v54, 16, v54

    v_add_f32 v40, v40, v48
    v_add_f32 v41, v41, v49
    v_add_f32 v42, v42, v50
    v_add_f32 v43, v43, v51
    v_add_f32 v44, v44, v52
    v_add_f32 v45, v45, v53
    v_add_f32 v46, v46, v54
    v_add_f32 v47, v47, v55
    v_add_f32 v40, v40, v44
    v_add_f32 v41, v41, v45
    v_add_f32 v42, v42, v46
    v_add_f32 v43, v43, v47
    v_add_f32 v40, v40, v42
    v_add_f32 v41, v41, v43
    v_add_f32 v40, v40, v41
    v_mov_b32 v41, v40
    s_nop 1
    v_permlane32_swap_b32 v40, v41
    v_add_f32 v40, v40, v41
    v_mov_b32 v41, v40
    s_nop 1
    v_permlane16_swap_b32 v40, v41
    v_add_f32 v40, v40, v41
    s_nop 1
    v_add_f32_dpp v40, v40, v40 row_ror:8 row_mask:0xf bank_mask:0xf
    s_nop 1
    v_add_f32_dpp v40, v40, v40 row_ror:4 row_mask:0xf bank_mask:0xf
    s_nop 1
    v_add_f32_dpp v40, v40, v40 row_ror:2 row_mask:0xf bank_mask:0xf
    s_nop 1
    v_add_f32_dpp v40, v40, v40 row_ror:1 row_mask:0xf bank_mask:0xf
    v_cvt_pk_bf16_f32 v40, v40, v40
    v_lshlrev_b32 v40, 16, v40
    v_mul_f32 v40, s38, v40
    v_exp_f32 v40, v40
    s_nop 0
    v_add_f32 v40, 1.0, v40
    v_rcp_f32 v40, v40
    s_nop 0
    v_cvt_pk_bf16_f32 v40, v40, v40
    v_lshlrev_b32 v40, 16, v40

    v_cmp_eq_u32 vcc, 12, v1
    s_nop 1
    v_cndmask_b32 v60, v60, v40, vcc
    s_waitcnt vmcnt(4)
    v_lshlrev_b32 v40, 16, v168
    v_and_b32 v41, 0xffff0000, v168
    v_mul_f32 v40, v40, v24
    v_mul_f32 v41, v41, v25
    v_cvt_pk_bf16_f32 v40, v40, v41
    v_and_b32 v41, 0xffff0000, v40
    v_lshlrev_b32 v40, 16, v40

    v_lshlrev_b32 v42, 16, v169
    v_and_b32 v43, 0xffff0000, v169
    v_mul_f32 v42, v42, v26
    v_mul_f32 v43, v43, v27
    v_cvt_pk_bf16_f32 v42, v42, v43
    v_and_b32 v43, 0xffff0000, v42
    v_lshlrev_b32 v42, 16, v42

    v_lshlrev_b32 v44, 16, v170
    v_and_b32 v45, 0xffff0000, v170
    v_mul_f32 v44, v44, v28
    v_mul_f32 v45, v45, v29
    v_cvt_pk_bf16_f32 v44, v44, v45
    v_and_b32 v45, 0xffff0000, v44
    v_lshlrev_b32 v44, 16, v44

    v_lshlrev_b32 v46, 16, v171
    v_and_b32 v47, 0xffff0000, v171
    v_mul_f32 v46, v46, v30
    v_mul_f32 v47, v47, v31
    v_cvt_pk_bf16_f32 v46, v46, v47
    v_and_b32 v47, 0xffff0000, v46
    v_lshlrev_b32 v46, 16, v46

    v_lshlrev_b32 v48, 16, v172
    v_and_b32 v49, 0xffff0000, v172
    v_mul_f32 v48, v48, v32
    v_mul_f32 v49, v49, v33
    v_cvt_pk_bf16_f32 v48, v48, v49
    v_and_b32 v49, 0xffff0000, v48
    v_lshlrev_b32 v48, 16, v48

    v_lshlrev_b32 v50, 16, v173
    v_and_b32 v51, 0xffff0000, v173
    v_mul_f32 v50, v50, v34
    v_mul_f32 v51, v51, v35
    v_cvt_pk_bf16_f32 v50, v50, v51
    v_and_b32 v51, 0xffff0000, v50
    v_lshlrev_b32 v50, 16, v50

    v_lshlrev_b32 v52, 16, v174
    v_and_b32 v53, 0xffff0000, v174
    v_mul_f32 v52, v52, v36
    v_mul_f32 v53, v53, v37
    v_cvt_pk_bf16_f32 v52, v52, v53
    v_and_b32 v53, 0xffff0000, v52
    v_lshlrev_b32 v52, 16, v52

    v_lshlrev_b32 v54, 16, v175
    v_and_b32 v55, 0xffff0000, v175
    v_mul_f32 v54, v54, v38
    v_mul_f32 v55, v55, v39
    v_cvt_pk_bf16_f32 v54, v54, v55
    v_and_b32 v55, 0xffff0000, v54
    v_lshlrev_b32 v54, 16, v54

    v_add_f32 v40, v40, v48
    v_add_f32 v41, v41, v49
    v_add_f32 v42, v42, v50
    v_add_f32 v43, v43, v51
    v_add_f32 v44, v44, v52
    v_add_f32 v45, v45, v53
    v_add_f32 v46, v46, v54
    v_add_f32 v47, v47, v55
    v_add_f32 v40, v40, v44
    v_add_f32 v41, v41, v45
    v_add_f32 v42, v42, v46
    v_add_f32 v43, v43, v47
    v_add_f32 v40, v40, v42
    v_add_f32 v41, v41, v43
    v_add_f32 v40, v40, v41
    v_mov_b32 v41, v40
    s_nop 1
    v_permlane32_swap_b32 v40, v41
    v_add_f32 v40, v40, v41
    v_mov_b32 v41, v40
    s_nop 1
    v_permlane16_swap_b32 v40, v41
    v_add_f32 v40, v40, v41
    s_nop 1
    v_add_f32_dpp v40, v40, v40 row_ror:8 row_mask:0xf bank_mask:0xf
    s_nop 1
    v_add_f32_dpp v40, v40, v40 row_ror:4 row_mask:0xf bank_mask:0xf
    s_nop 1
    v_add_f32_dpp v40, v40, v40 row_ror:2 row_mask:0xf bank_mask:0xf
    s_nop 1
    v_add_f32_dpp v40, v40, v40 row_ror:1 row_mask:0xf bank_mask:0xf
    v_cvt_pk_bf16_f32 v40, v40, v40
    v_lshlrev_b32 v40, 16, v40
    v_mul_f32 v40, s38, v40
    v_exp_f32 v40, v40
    s_nop 0
    v_add_f32 v40, 1.0, v40
    v_rcp_f32 v40, v40
    s_nop 0
    v_cvt_pk_bf16_f32 v40, v40, v40
    v_lshlrev_b32 v40, 16, v40

    v_cmp_eq_u32 vcc, 13, v1
    s_nop 1
    v_cndmask_b32 v60, v60, v40, vcc
    s_waitcnt vmcnt(2)
    v_lshlrev_b32 v40, 16, v176
    v_and_b32 v41, 0xffff0000, v176
    v_mul_f32 v40, v40, v24
    v_mul_f32 v41, v41, v25
    v_cvt_pk_bf16_f32 v40, v40, v41
    v_and_b32 v41, 0xffff0000, v40
    v_lshlrev_b32 v40, 16, v40

    v_lshlrev_b32 v42, 16, v177
    v_and_b32 v43, 0xffff0000, v177
    v_mul_f32 v42, v42, v26
    v_mul_f32 v43, v43, v27
    v_cvt_pk_bf16_f32 v42, v42, v43
    v_and_b32 v43, 0xffff0000, v42
    v_lshlrev_b32 v42, 16, v42

    v_lshlrev_b32 v44, 16, v178
    v_and_b32 v45, 0xffff0000, v178
    v_mul_f32 v44, v44, v28
    v_mul_f32 v45, v45, v29
    v_cvt_pk_bf16_f32 v44, v44, v45
    v_and_b32 v45, 0xffff0000, v44
    v_lshlrev_b32 v44, 16, v44

    v_lshlrev_b32 v46, 16, v179
    v_and_b32 v47, 0xffff0000, v179
    v_mul_f32 v46, v46, v30
    v_mul_f32 v47, v47, v31
    v_cvt_pk_bf16_f32 v46, v46, v47
    v_and_b32 v47, 0xffff0000, v46
    v_lshlrev_b32 v46, 16, v46

    v_lshlrev_b32 v48, 16, v180
    v_and_b32 v49, 0xffff0000, v180
    v_mul_f32 v48, v48, v32
    v_mul_f32 v49, v49, v33
    v_cvt_pk_bf16_f32 v48, v48, v49
    v_and_b32 v49, 0xffff0000, v48
    v_lshlrev_b32 v48, 16, v48

    v_lshlrev_b32 v50, 16, v181
    v_and_b32 v51, 0xffff0000, v181
    v_mul_f32 v50, v50, v34
    v_mul_f32 v51, v51, v35
    v_cvt_pk_bf16_f32 v50, v50, v51
    v_and_b32 v51, 0xffff0000, v50
    v_lshlrev_b32 v50, 16, v50

    v_lshlrev_b32 v52, 16, v182
    v_and_b32 v53, 0xffff0000, v182
    v_mul_f32 v52, v52, v36
    v_mul_f32 v53, v53, v37
    v_cvt_pk_bf16_f32 v52, v52, v53
    v_and_b32 v53, 0xffff0000, v52
    v_lshlrev_b32 v52, 16, v52

    v_lshlrev_b32 v54, 16, v183
    v_and_b32 v55, 0xffff0000, v183
    v_mul_f32 v54, v54, v38
    v_mul_f32 v55, v55, v39
    v_cvt_pk_bf16_f32 v54, v54, v55
    v_and_b32 v55, 0xffff0000, v54
    v_lshlrev_b32 v54, 16, v54

    v_add_f32 v40, v40, v48
    v_add_f32 v41, v41, v49
    v_add_f32 v42, v42, v50
    v_add_f32 v43, v43, v51
    v_add_f32 v44, v44, v52
    v_add_f32 v45, v45, v53
    v_add_f32 v46, v46, v54
    v_add_f32 v47, v47, v55
    v_add_f32 v40, v40, v44
    v_add_f32 v41, v41, v45
    v_add_f32 v42, v42, v46
    v_add_f32 v43, v43, v47
    v_add_f32 v40, v40, v42
    v_add_f32 v41, v41, v43
    v_add_f32 v40, v40, v41
    v_mov_b32 v41, v40
    s_nop 1
    v_permlane32_swap_b32 v40, v41
    v_add_f32 v40, v40, v41
    v_mov_b32 v41, v40
    s_nop 1
    v_permlane16_swap_b32 v40, v41
    v_add_f32 v40, v40, v41
    s_nop 1
    v_add_f32_dpp v40, v40, v40 row_ror:8 row_mask:0xf bank_mask:0xf
    s_nop 1
    v_add_f32_dpp v40, v40, v40 row_ror:4 row_mask:0xf bank_mask:0xf
    s_nop 1
    v_add_f32_dpp v40, v40, v40 row_ror:2 row_mask:0xf bank_mask:0xf
    s_nop 1
    v_add_f32_dpp v40, v40, v40 row_ror:1 row_mask:0xf bank_mask:0xf
    v_cvt_pk_bf16_f32 v40, v40, v40
    v_lshlrev_b32 v40, 16, v40
    v_mul_f32 v40, s38, v40
    v_exp_f32 v40, v40
    s_nop 0
    v_add_f32 v40, 1.0, v40
    v_rcp_f32 v40, v40
    s_nop 0
    v_cvt_pk_bf16_f32 v40, v40, v40
    v_lshlrev_b32 v40, 16, v40

    v_cmp_eq_u32 vcc, 14, v1
    s_nop 1
    v_cndmask_b32 v60, v60, v40, vcc
    s_waitcnt vmcnt(0)
    v_lshlrev_b32 v40, 16, v184
    v_and_b32 v41, 0xffff0000, v184
    v_mul_f32 v40, v40, v24
    v_mul_f32 v41, v41, v25
    v_cvt_pk_bf16_f32 v40, v40, v41
    v_and_b32 v41, 0xffff0000, v40
    v_lshlrev_b32 v40, 16, v40

    v_lshlrev_b32 v42, 16, v185
    v_and_b32 v43, 0xffff0000, v185
    v_mul_f32 v42, v42, v26
    v_mul_f32 v43, v43, v27
    v_cvt_pk_bf16_f32 v42, v42, v43
    v_and_b32 v43, 0xffff0000, v42
    v_lshlrev_b32 v42, 16, v42

    v_lshlrev_b32 v44, 16, v186
    v_and_b32 v45, 0xffff0000, v186
    v_mul_f32 v44, v44, v28
    v_mul_f32 v45, v45, v29
    v_cvt_pk_bf16_f32 v44, v44, v45
    v_and_b32 v45, 0xffff0000, v44
    v_lshlrev_b32 v44, 16, v44

    v_lshlrev_b32 v46, 16, v187
    v_and_b32 v47, 0xffff0000, v187
    v_mul_f32 v46, v46, v30
    v_mul_f32 v47, v47, v31
    v_cvt_pk_bf16_f32 v46, v46, v47
    v_and_b32 v47, 0xffff0000, v46
    v_lshlrev_b32 v46, 16, v46

    v_lshlrev_b32 v48, 16, v188
    v_and_b32 v49, 0xffff0000, v188
    v_mul_f32 v48, v48, v32
    v_mul_f32 v49, v49, v33
    v_cvt_pk_bf16_f32 v48, v48, v49
    v_and_b32 v49, 0xffff0000, v48
    v_lshlrev_b32 v48, 16, v48

    v_lshlrev_b32 v50, 16, v189
    v_and_b32 v51, 0xffff0000, v189
    v_mul_f32 v50, v50, v34
    v_mul_f32 v51, v51, v35
    v_cvt_pk_bf16_f32 v50, v50, v51
    v_and_b32 v51, 0xffff0000, v50
    v_lshlrev_b32 v50, 16, v50

    v_lshlrev_b32 v52, 16, v190
    v_and_b32 v53, 0xffff0000, v190
    v_mul_f32 v52, v52, v36
    v_mul_f32 v53, v53, v37
    v_cvt_pk_bf16_f32 v52, v52, v53
    v_and_b32 v53, 0xffff0000, v52
    v_lshlrev_b32 v52, 16, v52

    v_lshlrev_b32 v54, 16, v191
    v_and_b32 v55, 0xffff0000, v191
    v_mul_f32 v54, v54, v38
    v_mul_f32 v55, v55, v39
    v_cvt_pk_bf16_f32 v54, v54, v55
    v_and_b32 v55, 0xffff0000, v54
    v_lshlrev_b32 v54, 16, v54

    v_add_f32 v40, v40, v48
    v_add_f32 v41, v41, v49
    v_add_f32 v42, v42, v50
    v_add_f32 v43, v43, v51
    v_add_f32 v44, v44, v52
    v_add_f32 v45, v45, v53
    v_add_f32 v46, v46, v54
    v_add_f32 v47, v47, v55
    v_add_f32 v40, v40, v44
    v_add_f32 v41, v41, v45
    v_add_f32 v42, v42, v46
    v_add_f32 v43, v43, v47
    v_add_f32 v40, v40, v42
    v_add_f32 v41, v41, v43
    v_add_f32 v40, v40, v41
    v_mov_b32 v41, v40
    s_nop 1
    v_permlane32_swap_b32 v40, v41
    v_add_f32 v40, v40, v41
    v_mov_b32 v41, v40
    s_nop 1
    v_permlane16_swap_b32 v40, v41
    v_add_f32 v40, v40, v41
    s_nop 1
    v_add_f32_dpp v40, v40, v40 row_ror:8 row_mask:0xf bank_mask:0xf
    s_nop 1
    v_add_f32_dpp v40, v40, v40 row_ror:4 row_mask:0xf bank_mask:0xf
    s_nop 1
    v_add_f32_dpp v40, v40, v40 row_ror:2 row_mask:0xf bank_mask:0xf
    s_nop 1
    v_add_f32_dpp v40, v40, v40 row_ror:1 row_mask:0xf bank_mask:0xf
    v_cvt_pk_bf16_f32 v40, v40, v40
    v_lshlrev_b32 v40, 16, v40
    v_mul_f32 v40, s38, v40
    v_exp_f32 v40, v40
    s_nop 0
    v_add_f32 v40, 1.0, v40
    v_rcp_f32 v40, v40
    s_nop 0
    v_cvt_pk_bf16_f32 v40, v40, v40
    v_lshlrev_b32 v40, 16, v40

    v_cmp_eq_u32 vcc, 15, v1
    s_nop 1
    v_cndmask_b32 v60, v60, v40, vcc
    s_lshl_b32 s5, s3, 2
    s_add_u32 s5, s5, 121634816
    v_lshlrev_b32 v8, 2, v1
    s_mov_b64 exec, 0xffff
    buffer_store_dword v60, v8, s[8:11], s5 offen sc1
    s_mov_b64 exec, -1

    s_load_dwordx4 s[52:55], s[0:1], 32
    s_lshl_b32 s3, s93, 5
    s_lshl_b32 s4, s24, 3
    s_add_u32 s3, s3, s4
    s_lshl_b32 s4, s3, 1
    s_waitcnt lgkmcnt(0)
    s_load_dwordx4 s[64:67], s[54:55], s4

    s_mov_b32 s28, s52
    s_and_b32 s29, s53, 0xffff
    s_mov_b32 s30, 0x400000
    s_mov_b32 s31, 0x00020000

    v_and_b32 v1, 63, v0
    v_and_b32 v2, 15, v1
    v_lshrrev_b32 v3, 4, v1

    s_lshl_b32 s32, s3, 12
    s_add_u32 s33, s32, 28672
    s_mul_i32 s34, s24, 38400
    s_add_u32 s35, s34, 33536
    s_add_u32 s38, s32, 117440512
    v_lshlrev_b32 v4, 4, v1
    v_add_u32 v5, s34, v4
    v_add_u32 v5, 64, v5
    v_sub_u32 v6, 7, v2
    v_and_b32 v6, 7, v6
    v_mul_u32_u24 v6, 4160, v6
    v_lshrrev_b32 v7, 3, v2
    v_sub_u32 v7, v7, v3
    v_add_u32 v7, 4, v7
    v_lshl_add_u32 v6, v7, 4, v6
    v_add_u32 v6, s34, v6
    v_mul_u32_u24 v7, 80, v3
    v_add_u32 v7, v7, v2
    v_lshlrev_b32 v7, 4, v7
    v_add_u32 v7, s34, v7
    v_add_u32 v7, 33296, v7
    v_lshlrev_b32 v228, 7, v2
    v_lshl_add_u32 v228, v3, 4, v228
    v_subrev_u32 v229, 16, v4
    v_max_i32 v230, 0, v229
    v_sub_u32 v232, 7, v2
    v_and_b32 v232, 7, v232
    v_and_b32 v233, 1, v232
    v_lshlrev_b32 v233, 4, v233
    v_mov_b32 v234, 0xffff
    v_lshlrev_b32 v233, v233, v234
    v_lshrrev_b32 v232, 1, v232
    v_lshrrev_b32 v234, 3, v2
    v_sub_u32 v234, v3, v234
    v_lshl_add_u32 v232, v234, 1, v232
    v_and_b32 v234, 1, v234
    v_lshl_add_u32 v232, v234, 8, v232

    v_cmp_eq_u32 vcc, 0, v232
    s_nop 1
    v_cndmask_b32 v8, 0, v233, vcc
    v_cmp_eq_u32 vcc, 1, v232
    s_nop 1
    v_cndmask_b32 v9, 0, v233, vcc
    v_cmp_eq_u32 vcc, 2, v232
    s_nop 1
    v_cndmask_b32 v10, 0, v233, vcc
    v_cmp_eq_u32 vcc, 3, v232
    s_nop 1
    v_cndmask_b32 v11, 0, v233, vcc
    v_cmp_eq_u32 vcc, 4, v232
    s_nop 1
    v_cndmask_b32 v12, 0, v233, vcc
    v_cmp_eq_u32 vcc, 5, v232
    s_nop 1
    v_cndmask_b32 v13, 0, v233, vcc
    v_cmp_eq_u32 vcc, 6, v232
    s_nop 1
    v_cndmask_b32 v14, 0, v233, vcc
    v_cmp_eq_u32 vcc, 7, v232
    s_nop 1
    v_cndmask_b32 v15, 0, v233, vcc
    v_mov_b32 v208, 0
    v_mov_b32 v209, 0
    v_mov_b32 v210, 0
    v_mov_b32 v211, 0
    v_lshrrev_b32 v232, 2, v1
    v_and_b32 v232, 7, v232
    v_mul_u32_u24 v232, 4160, v232
    v_and_b32 v233, 3, v1
    v_lshl_add_u32 v232, v233, 4, v232
    v_add_u32 v232, s34, v232
    ds_write_b128 v232, v[208:211]
    v_subrev_u32 v233, 16, v7
    ds_write_b128 v233, v[208:211]

    v_mov_b32 v5, 0
    s_mov_b32 s62, 0
    s_mov_b32 s5, 40
.wc_500:
    buffer_load_dword v4, v5, s[20:23], s5 offen sc1
    s_waitcnt vmcnt(0)
    v_readfirstlane_b32 s4, v4
    s_lshr_b32 s4, s4, 0
    s_and_b32 s4, s4, 0xffff
    s_cmp_ge_u32 s4, 32
    s_cbranch_scc1 .wcd_501
    s_sleep 6
    s_add_u32 s62, s62, 1
    s_cmp_gt_u32 s62, 0x400000
    s_cbranch_scc1 .mg_end_1
    s_branch .wc_500

.wcd_501:
    v_lshlrev_b32 v4, 4, v1
    v_add_u32 v5, s34, v4
    v_add_u32 v5, 64, v5

    s_add_u32 s39, s32, 125829120
    buffer_load_dwordx4 v[176:179], v230, s[28:31], s32 offen offset:0
    buffer_load_dwordx4 v[180:183], v4, s[28:31], s32 offen offset:0
    buffer_load_dwordx4 v[184:187], v4, s[28:31], s32 offen offset:1008
    buffer_load_dwordx4 v[188:191], v4, s[28:31], s32 offen offset:1024
    buffer_load_dwordx4 v[192:195], v4, s[28:31], s32 offen offset:2032
    buffer_load_dwordx4 v[196:199], v4, s[28:31], s32 offen offset:2048
    buffer_load_dwordx4 v[200:203], v4, s[28:31], s32 offen offset:3056
    buffer_load_dwordx4 v[204:207], v4, s[28:31], s32 offen offset:3072
    s_add_u32 m0, s35, 0
    s_nop 0
    buffer_load_dwordx4 v4, s[8:11], s39 offen offset:0 lds
    s_add_u32 m0, s35, 256
    s_nop 0
    buffer_load_dwordx4 v4, s[8:11], s39 offen offset:1024 lds
    s_add_u32 m0, s35, 512
    s_nop 0
    buffer_load_dwordx4 v4, s[8:11], s39 offen offset:2048 lds
    s_add_u32 m0, s35, 768
    s_nop 0
    buffer_load_dwordx4 v4, s[8:11], s39 offen offset:3072 lds
    s_waitcnt vmcnt(0) lgkmcnt(0)
    s_pack_ll_b32_b16 s40, s64, s64
    s_add_u32 s36, s32, 4096
    s_add_u32 s37, s32, 8192
    s_add_u32 s39, s36, 125829120
    s_mov_b64 exec, 1
    v_mov_b32 v176, 0
    v_mov_b32 v177, 0
    v_mov_b32 v178, 0
    v_mov_b32 v179, 0
    s_mov_b64 exec, -1
    ds_write_b128 v5, v[180:183] offset:0
    ds_write_b128 v5, v[178:181] offset:16640
    v_mov_b32 v208, v177
    v_mov_b32 v209, v178
    v_mov_b32 v210, v179
    v_mov_b32 v211, v180
    ds_write_b128 v5, v[208:211] offset:24960
    v_mov_b32 v212, v181
    v_mov_b32 v213, v182
    ds_write_b128 v5, v[210:213] offset:8320
    v_alignbit_b32 v214, v177, v176, 16
    v_alignbit_b32 v215, v178, v177, 16
    v_alignbit_b32 v216, v179, v178, 16
    v_alignbit_b32 v217, v180, v179, 16
    ds_write_b128 v5, v[214:217] offset:29120
    v_alignbit_b32 v218, v181, v180, 16
    v_alignbit_b32 v219, v182, v181, 16
    ds_write_b128 v5, v[216:219] offset:12480
    v_alignbit_b32 v220, v178, v177, 16
    v_alignbit_b32 v221, v179, v178, 16
    v_alignbit_b32 v222, v180, v179, 16
    v_alignbit_b32 v223, v181, v180, 16
    ds_write_b128 v5, v[220:223] offset:20800
    v_alignbit_b32 v224, v182, v181, 16
    v_alignbit_b32 v225, v183, v182, 16
    ds_write_b128 v5, v[222:225] offset:4160
    buffer_load_dwordx4 v[176:179], v230, s[28:31], s36 offen offset:0
    buffer_load_dwordx4 v[180:183], v4, s[28:31], s36 offen offset:0
    ds_write_b128 v5, v[188:191] offset:1024
    ds_write_b128 v5, v[186:189] offset:17664
    v_mov_b32 v208, v185
    v_mov_b32 v209, v186
    v_mov_b32 v210, v187
    v_mov_b32 v211, v188
    ds_write_b128 v5, v[208:211] offset:25984
    v_mov_b32 v212, v189
    v_mov_b32 v213, v190
    ds_write_b128 v5, v[210:213] offset:9344
    v_alignbit_b32 v214, v185, v184, 16
    v_alignbit_b32 v215, v186, v185, 16
    v_alignbit_b32 v216, v187, v186, 16
    v_alignbit_b32 v217, v188, v187, 16
    ds_write_b128 v5, v[214:217] offset:30144
    v_alignbit_b32 v218, v189, v188, 16
    v_alignbit_b32 v219, v190, v189, 16
    ds_write_b128 v5, v[216:219] offset:13504
    v_alignbit_b32 v220, v186, v185, 16
    v_alignbit_b32 v221, v187, v186, 16
    v_alignbit_b32 v222, v188, v187, 16
    v_alignbit_b32 v223, v189, v188, 16
    ds_write_b128 v5, v[220:223] offset:21824
    v_alignbit_b32 v224, v190, v189, 16
    v_alignbit_b32 v225, v191, v190, 16
    ds_write_b128 v5, v[222:225] offset:5184
    buffer_load_dwordx4 v[184:187], v4, s[28:31], s36 offen offset:1008
    buffer_load_dwordx4 v[188:191], v4, s[28:31], s36 offen offset:1024
    v_and_b32 v236, s40, v8
    v_and_b32 v237, s40, v9
    v_and_b32 v238, s40, v10
    v_and_b32 v239, s40, v11
    v_and_b32 v240, s40, v12
    v_and_b32 v241, s40, v13
    v_and_b32 v242, s40, v14
    v_and_b32 v243, s40, v15
    ds_read_b128 a[60:63], v7 offset:240
    ds_read_b128 a[124:127], v7 offset:496
    ds_read_b128 a[188:191], v7 offset:752
    ds_read_b128 a[252:255], v7 offset:1008
    ds_read_b128 v[168:171], v6 offset:0
    ds_read_b128 v[172:175], v6 offset:32
    s_waitcnt vmcnt(0) lgkmcnt(0)
    s_mov_b32 s42, 0
.cvl_502:
    s_waitcnt lgkmcnt(5)
    v_mfma_f32_16x16x32_bf16 v[16:19], v[236:239], a[60:63], 0
    v_mfma_f32_16x16x32_bf16 v[32:35], v[240:243], a[60:63], 0
    s_waitcnt lgkmcnt(4)
    v_mfma_f32_16x16x32_bf16 v[20:23], v[236:239], a[124:127], 0
    v_mfma_f32_16x16x32_bf16 v[36:39], v[240:243], a[124:127], 0
    s_waitcnt lgkmcnt(3)
    v_mfma_f32_16x16x32_bf16 v[24:27], v[236:239], a[188:191], 0
    v_mfma_f32_16x16x32_bf16 v[40:43], v[240:243], a[188:191], 0
    ds_read_b128 a[56:59], v7 offset:224
    s_waitcnt lgkmcnt(3)
    v_mfma_f32_16x16x32_bf16 v[28:31], v[236:239], a[252:255], 0
    ds_read_b128 v[112:115], v6 offset:64
    v_mfma_f32_16x16x32_bf16 v[44:47], v[240:243], a[252:255], 0
    ds_read_b128 v[116:119], v6 offset:96
    s_waitcnt lgkmcnt(4)
    v_mfma_f32_16x16x32_bf16 v[16:19], v[168:171], a[60:63], v[16:19]
    ds_read_b128 a[120:123], v7 offset:480
    s_waitcnt lgkmcnt(4)
    v_mfma_f32_16x16x32_bf16 v[32:35], v[172:175], a[60:63], v[32:35]
    s_waitcnt vmcnt(18)
    v_mfma_f32_16x16x32_bf16 v[20:23], v[168:171], a[124:127], v[20:23]
    ds_read_b128 a[184:187], v7 offset:736
    v_mfma_f32_16x16x32_bf16 v[36:39], v[172:175], a[124:127], v[36:39]
    ds_write_b128 v5, v[196:199] offset:2048
    v_mfma_f32_16x16x32_bf16 v[24:27], v[168:171], a[188:191], v[24:27]
    ds_read_b128 a[248:251], v7 offset:992
    v_mfma_f32_16x16x32_bf16 v[40:43], v[172:175], a[188:191], v[40:43]
    ds_read_b128 a[52:55], v7 offset:208
    v_mfma_f32_16x16x32_bf16 v[28:31], v[168:171], a[252:255], v[28:31]
    ds_read_b128 v[120:123], v6 offset:128
    v_mfma_f32_16x16x32_bf16 v[44:47], v[172:175], a[252:255], v[44:47]
    ds_read_b128 v[124:127], v6 offset:160
    s_waitcnt lgkmcnt(8)
    v_mfma_f32_16x16x32_bf16 v[16:19], v[112:115], a[56:59], v[16:19]
    ds_read_b128 a[116:119], v7 offset:464
    s_waitcnt lgkmcnt(8)
    v_mfma_f32_16x16x32_bf16 v[32:35], v[116:119], a[56:59], v[32:35]
    ds_write_b128 v5, v[194:197] offset:18688
    s_waitcnt lgkmcnt(8)
    v_mfma_f32_16x16x32_bf16 v[20:23], v[112:115], a[120:123], v[20:23]
    ds_read_b128 a[180:183], v7 offset:720
    v_mfma_f32_16x16x32_bf16 v[36:39], v[116:119], a[120:123], v[36:39]
    v_mov_b32 v208, v193
    v_mov_b32 v209, v194
    s_waitcnt lgkmcnt(8)
    v_mfma_f32_16x16x32_bf16 v[24:27], v[112:115], a[184:187], v[24:27]
    ds_read_b128 a[244:247], v7 offset:976
    v_mfma_f32_16x16x32_bf16 v[40:43], v[116:119], a[184:187], v[40:43]
    ds_read_b128 a[48:51], v7 offset:192
    s_waitcnt lgkmcnt(8)
    v_mfma_f32_16x16x32_bf16 v[28:31], v[112:115], a[248:251], v[28:31]
    ds_read_b128 v[128:131], v6 offset:192
    v_mfma_f32_16x16x32_bf16 v[44:47], v[116:119], a[248:251], v[44:47]
    ds_read_b128 v[132:135], v6 offset:224
    s_waitcnt lgkmcnt(8)
    v_mfma_f32_16x16x32_bf16 v[16:19], v[120:123], a[52:55], v[16:19]
    ds_read_b128 a[112:115], v7 offset:448
    s_waitcnt lgkmcnt(8)
    v_mfma_f32_16x16x32_bf16 v[32:35], v[124:127], a[52:55], v[32:35]
    v_mov_b32 v210, v195
    v_mov_b32 v211, v196
    s_waitcnt lgkmcnt(7)
    v_mfma_f32_16x16x32_bf16 v[20:23], v[120:123], a[116:119], v[20:23]
    ds_read_b128 a[176:179], v7 offset:704
    v_mfma_f32_16x16x32_bf16 v[36:39], v[124:127], a[116:119], v[36:39]
    ds_write_b128 v5, v[208:211] offset:27008
    s_waitcnt lgkmcnt(7)
    v_mfma_f32_16x16x32_bf16 v[24:27], v[120:123], a[180:183], v[24:27]
    ds_read_b128 a[240:243], v7 offset:960
    v_mfma_f32_16x16x32_bf16 v[40:43], v[124:127], a[180:183], v[40:43]
    ds_read_b128 a[44:47], v7 offset:176
    s_waitcnt lgkmcnt(8)
    v_mfma_f32_16x16x32_bf16 v[28:31], v[120:123], a[244:247], v[28:31]
    ds_read_b128 v[136:139], v6 offset:256
    v_mfma_f32_16x16x32_bf16 v[44:47], v[124:127], a[244:247], v[44:47]
    ds_read_b128 v[140:143], v6 offset:288
    s_waitcnt lgkmcnt(8)
    v_mfma_f32_16x16x32_bf16 v[16:19], v[128:131], a[48:51], v[16:19]
    ds_read_b128 a[108:111], v7 offset:432
    s_waitcnt lgkmcnt(8)
    v_mfma_f32_16x16x32_bf16 v[32:35], v[132:135], a[48:51], v[32:35]
    v_mov_b32 v212, v197
    v_mov_b32 v213, v198
    s_waitcnt lgkmcnt(7)
    v_mfma_f32_16x16x32_bf16 v[20:23], v[128:131], a[112:115], v[20:23]
    ds_read_b128 a[172:175], v7 offset:688
    v_mfma_f32_16x16x32_bf16 v[36:39], v[132:135], a[112:115], v[36:39]
    ds_write_b128 v5, v[210:213] offset:10368
    s_waitcnt lgkmcnt(8)
    v_mfma_f32_16x16x32_bf16 v[24:27], v[128:131], a[176:179], v[24:27]
    ds_read_b128 a[236:239], v7 offset:944
    v_mfma_f32_16x16x32_bf16 v[40:43], v[132:135], a[176:179], v[40:43]
    ds_read_b128 a[40:43], v7 offset:160
    s_waitcnt lgkmcnt(8)
    v_mfma_f32_16x16x32_bf16 v[28:31], v[128:131], a[240:243], v[28:31]
    ds_read_b128 v[144:147], v6 offset:320
    v_mfma_f32_16x16x32_bf16 v[44:47], v[132:135], a[240:243], v[44:47]
    ds_read_b128 v[148:151], v6 offset:352
    s_waitcnt lgkmcnt(8)
    v_mfma_f32_16x16x32_bf16 v[16:19], v[136:139], a[44:47], v[16:19]
    ds_read_b128 a[104:107], v7 offset:416
    s_waitcnt lgkmcnt(8)
    v_mfma_f32_16x16x32_bf16 v[32:35], v[140:143], a[44:47], v[32:35]
    v_alignbit_b32 v214, v193, v192, 16
    v_alignbit_b32 v215, v194, v193, 16
    s_waitcnt lgkmcnt(7)
    v_mfma_f32_16x16x32_bf16 v[20:23], v[136:139], a[108:111], v[20:23]
    ds_read_b128 a[168:171], v7 offset:672
    v_mfma_f32_16x16x32_bf16 v[36:39], v[140:143], a[108:111], v[36:39]
    v_alignbit_b32 v216, v195, v194, 16
    v_alignbit_b32 v217, v196, v195, 16
    s_waitcnt lgkmcnt(7)
    v_mfma_f32_16x16x32_bf16 v[24:27], v[136:139], a[172:175], v[24:27]
    ds_read_b128 a[232:235], v7 offset:928
    v_mfma_f32_16x16x32_bf16 v[40:43], v[140:143], a[172:175], v[40:43]
    ds_read_b128 a[36:39], v7 offset:144
    s_waitcnt lgkmcnt(7)
    v_mfma_f32_16x16x32_bf16 v[28:31], v[136:139], a[236:239], v[28:31]
    ds_read_b128 v[152:155], v6 offset:384
    v_mfma_f32_16x16x32_bf16 v[44:47], v[140:143], a[236:239], v[44:47]
    ds_read_b128 v[156:159], v6 offset:416
    s_waitcnt lgkmcnt(7)
    v_mfma_f32_16x16x32_bf16 v[16:19], v[144:147], a[40:43], v[16:19]
    ds_read_b128 a[100:103], v7 offset:400
    s_waitcnt lgkmcnt(7)
    v_mfma_f32_16x16x32_bf16 v[32:35], v[148:151], a[40:43], v[32:35]
    ds_write_b128 v5, v[214:217] offset:31168
    s_waitcnt lgkmcnt(7)
    v_mfma_f32_16x16x32_bf16 v[20:23], v[144:147], a[104:107], v[20:23]
    ds_read_b128 a[164:167], v7 offset:656
    v_mfma_f32_16x16x32_bf16 v[36:39], v[148:151], a[104:107], v[36:39]
    v_alignbit_b32 v218, v197, v196, 16
    v_alignbit_b32 v219, v198, v197, 16
    s_waitcnt lgkmcnt(7)
    v_mfma_f32_16x16x32_bf16 v[24:27], v[144:147], a[168:171], v[24:27]
    ds_read_b128 a[228:231], v7 offset:912
    v_mfma_f32_16x16x32_bf16 v[40:43], v[148:151], a[168:171], v[40:43]
    ds_read_b128 a[32:35], v7 offset:128
    s_waitcnt lgkmcnt(8)
    v_mfma_f32_16x16x32_bf16 v[28:31], v[144:147], a[232:235], v[28:31]
    ds_read_b128 v[160:163], v6 offset:448
    v_mfma_f32_16x16x32_bf16 v[44:47], v[148:151], a[232:235], v[44:47]
    ds_read_b128 v[164:167], v6 offset:480
    s_waitcnt lgkmcnt(8)
    v_mfma_f32_16x16x32_bf16 v[16:19], v[152:155], a[36:39], v[16:19]
    ds_read_b128 a[96:99], v7 offset:384
    s_waitcnt lgkmcnt(8)
    v_mfma_f32_16x16x32_bf16 v[32:35], v[156:159], a[36:39], v[32:35]
    ds_write_b128 v5, v[216:219] offset:14528
    s_waitcnt lgkmcnt(8)
    v_mfma_f32_16x16x32_bf16 v[20:23], v[152:155], a[100:103], v[20:23]
    ds_read_b128 a[160:163], v7 offset:640
    v_mfma_f32_16x16x32_bf16 v[36:39], v[156:159], a[100:103], v[36:39]
    v_alignbit_b32 v220, v194, v193, 16
    v_alignbit_b32 v221, v195, v194, 16
    s_waitcnt lgkmcnt(7)
    v_mfma_f32_16x16x32_bf16 v[24:27], v[152:155], a[164:167], v[24:27]
    ds_read_b128 a[224:227], v7 offset:896
    v_mfma_f32_16x16x32_bf16 v[40:43], v[156:159], a[164:167], v[40:43]
    ds_read_b128 a[28:31], v7 offset:112
    s_waitcnt lgkmcnt(8)
    v_mfma_f32_16x16x32_bf16 v[28:31], v[152:155], a[228:231], v[28:31]
    ds_read_b128 v[168:171], v6 offset:512
    v_mfma_f32_16x16x32_bf16 v[44:47], v[156:159], a[228:231], v[44:47]
    ds_read_b128 v[172:175], v6 offset:544
    s_waitcnt lgkmcnt(8)
    v_mfma_f32_16x16x32_bf16 v[16:19], v[160:163], a[32:35], v[16:19]
    ds_read_b128 a[92:95], v7 offset:368
    s_waitcnt lgkmcnt(8)
    v_mfma_f32_16x16x32_bf16 v[32:35], v[164:167], a[32:35], v[32:35]
    v_alignbit_b32 v222, v196, v195, 16
    v_alignbit_b32 v223, v197, v196, 16
    s_waitcnt lgkmcnt(7)
    v_mfma_f32_16x16x32_bf16 v[20:23], v[160:163], a[96:99], v[20:23]
    ds_read_b128 a[156:159], v7 offset:624
    v_mfma_f32_16x16x32_bf16 v[36:39], v[164:167], a[96:99], v[36:39]
    ds_write_b128 v5, v[220:223] offset:22848
    s_waitcnt lgkmcnt(7)
    v_mfma_f32_16x16x32_bf16 v[24:27], v[160:163], a[160:163], v[24:27]
    ds_read_b128 a[220:223], v7 offset:880
    v_mfma_f32_16x16x32_bf16 v[40:43], v[164:167], a[160:163], v[40:43]
    ds_read_b128 a[24:27], v7 offset:96
    s_waitcnt lgkmcnt(8)
    v_mfma_f32_16x16x32_bf16 v[28:31], v[160:163], a[224:227], v[28:31]
    ds_read_b128 v[112:115], v6 offset:576
    v_mfma_f32_16x16x32_bf16 v[44:47], v[164:167], a[224:227], v[44:47]
    ds_read_b128 v[116:119], v6 offset:608
    s_waitcnt lgkmcnt(8)
    v_mfma_f32_16x16x32_bf16 v[16:19], v[168:171], a[28:31], v[16:19]
    ds_read_b128 a[88:91], v7 offset:352
    s_waitcnt lgkmcnt(8)
    v_mfma_f32_16x16x32_bf16 v[32:35], v[172:175], a[28:31], v[32:35]
    v_alignbit_b32 v224, v198, v197, 16
    v_alignbit_b32 v225, v199, v198, 16
    s_waitcnt lgkmcnt(7)
    v_mfma_f32_16x16x32_bf16 v[20:23], v[168:171], a[92:95], v[20:23]
    ds_read_b128 a[152:155], v7 offset:608
    v_mfma_f32_16x16x32_bf16 v[36:39], v[172:175], a[92:95], v[36:39]
    ds_write_b128 v5, v[222:225] offset:6208
    s_waitcnt lgkmcnt(8)
    v_mfma_f32_16x16x32_bf16 v[24:27], v[168:171], a[156:159], v[24:27]
    ds_read_b128 a[216:219], v7 offset:864
    v_mfma_f32_16x16x32_bf16 v[40:43], v[172:175], a[156:159], v[40:43]
    ds_read_b128 a[20:23], v7 offset:80
    s_waitcnt lgkmcnt(8)
    v_mfma_f32_16x16x32_bf16 v[28:31], v[168:171], a[220:223], v[28:31]
    ds_read_b128 v[120:123], v6 offset:640
    v_mfma_f32_16x16x32_bf16 v[44:47], v[172:175], a[220:223], v[44:47]
    ds_read_b128 v[124:127], v6 offset:672
    s_waitcnt lgkmcnt(8)
    v_mfma_f32_16x16x32_bf16 v[16:19], v[112:115], a[24:27], v[16:19]
    ds_read_b128 a[84:87], v7 offset:336
    s_waitcnt lgkmcnt(8)
    v_mfma_f32_16x16x32_bf16 v[32:35], v[116:119], a[24:27], v[32:35]
    buffer_load_dwordx4 v[192:195], v4, s[28:31], s36 offen offset:2032
    s_waitcnt lgkmcnt(7)
    v_mfma_f32_16x16x32_bf16 v[20:23], v[112:115], a[88:91], v[20:23]
    ds_read_b128 a[148:151], v7 offset:592
    v_mfma_f32_16x16x32_bf16 v[36:39], v[116:119], a[88:91], v[36:39]
    buffer_load_dwordx4 v[196:199], v4, s[28:31], s36 offen offset:2048
    s_waitcnt lgkmcnt(7)
    v_mfma_f32_16x16x32_bf16 v[24:27], v[112:115], a[152:155], v[24:27]
    ds_read_b128 a[212:215], v7 offset:848
    v_mfma_f32_16x16x32_bf16 v[40:43], v[116:119], a[152:155], v[40:43]
    ds_read_b128 a[16:19], v7 offset:64
    s_waitcnt lgkmcnt(7)
    v_mfma_f32_16x16x32_bf16 v[28:31], v[112:115], a[216:219], v[28:31]
    ds_read_b128 v[128:131], v6 offset:704
    v_mfma_f32_16x16x32_bf16 v[44:47], v[116:119], a[216:219], v[44:47]
    ds_read_b128 v[132:135], v6 offset:736
    s_waitcnt lgkmcnt(7)
    v_mfma_f32_16x16x32_bf16 v[16:19], v[120:123], a[20:23], v[16:19]
    ds_read_b128 a[80:83], v7 offset:320
    s_waitcnt lgkmcnt(7)
    v_mfma_f32_16x16x32_bf16 v[32:35], v[124:127], a[20:23], v[32:35]
    s_waitcnt vmcnt(18)
    s_waitcnt lgkmcnt(6)
    v_mfma_f32_16x16x32_bf16 v[20:23], v[120:123], a[84:87], v[20:23]
    ds_read_b128 a[144:147], v7 offset:576
    v_mfma_f32_16x16x32_bf16 v[36:39], v[124:127], a[84:87], v[36:39]
    ds_write_b128 v5, v[204:207] offset:3072
    s_waitcnt lgkmcnt(7)
    v_mfma_f32_16x16x32_bf16 v[24:27], v[120:123], a[148:151], v[24:27]
    ds_read_b128 a[208:211], v7 offset:832
    v_mfma_f32_16x16x32_bf16 v[40:43], v[124:127], a[148:151], v[40:43]
    ds_read_b128 a[12:15], v7 offset:48
    s_waitcnt lgkmcnt(8)
    v_mfma_f32_16x16x32_bf16 v[28:31], v[120:123], a[212:215], v[28:31]
    ds_read_b128 v[136:139], v6 offset:768
    v_mfma_f32_16x16x32_bf16 v[44:47], v[124:127], a[212:215], v[44:47]
    ds_read_b128 v[140:143], v6 offset:800
    s_waitcnt lgkmcnt(8)
    v_mfma_f32_16x16x32_bf16 v[16:19], v[128:131], a[16:19], v[16:19]
    ds_read_b128 a[76:79], v7 offset:304
    s_waitcnt lgkmcnt(8)
    v_mfma_f32_16x16x32_bf16 v[32:35], v[132:135], a[16:19], v[32:35]
    ds_write_b128 v5, v[202:205] offset:19712
    s_waitcnt lgkmcnt(8)
    v_mfma_f32_16x16x32_bf16 v[20:23], v[128:131], a[80:83], v[20:23]
    ds_read_b128 a[140:143], v7 offset:560
    v_mfma_f32_16x16x32_bf16 v[36:39], v[132:135], a[80:83], v[36:39]
    v_mov_b32 v208, v201
    v_mov_b32 v209, v202
    s_waitcnt lgkmcnt(8)
    v_mfma_f32_16x16x32_bf16 v[24:27], v[128:131], a[144:147], v[24:27]
    ds_read_b128 a[204:207], v7 offset:816
    v_mfma_f32_16x16x32_bf16 v[40:43], v[132:135], a[144:147], v[40:43]
    ds_read_b128 a[8:11], v7 offset:32
    s_waitcnt lgkmcnt(8)
    v_mfma_f32_16x16x32_bf16 v[28:31], v[128:131], a[208:211], v[28:31]
    ds_read_b128 v[144:147], v6 offset:832
    v_mfma_f32_16x16x32_bf16 v[44:47], v[132:135], a[208:211], v[44:47]
    ds_read_b128 v[148:151], v6 offset:864
    s_waitcnt lgkmcnt(8)
    v_mfma_f32_16x16x32_bf16 v[16:19], v[136:139], a[12:15], v[16:19]
    ds_read_b128 a[72:75], v7 offset:288
    s_waitcnt lgkmcnt(8)
    v_mfma_f32_16x16x32_bf16 v[32:35], v[140:143], a[12:15], v[32:35]
    v_mov_b32 v210, v203
    v_mov_b32 v211, v204
    s_waitcnt lgkmcnt(7)
    v_mfma_f32_16x16x32_bf16 v[20:23], v[136:139], a[76:79], v[20:23]
    ds_read_b128 a[136:139], v7 offset:544
    v_mfma_f32_16x16x32_bf16 v[36:39], v[140:143], a[76:79], v[36:39]
    ds_write_b128 v5, v[208:211] offset:28032
    s_waitcnt lgkmcnt(7)
    v_mfma_f32_16x16x32_bf16 v[24:27], v[136:139], a[140:143], v[24:27]
    ds_read_b128 a[200:203], v7 offset:800
    v_mfma_f32_16x16x32_bf16 v[40:43], v[140:143], a[140:143], v[40:43]
    ds_read_b128 a[4:7], v7 offset:16
    s_waitcnt lgkmcnt(8)
    v_mfma_f32_16x16x32_bf16 v[28:31], v[136:139], a[204:207], v[28:31]
    ds_read_b128 v[152:155], v6 offset:896
    v_mfma_f32_16x16x32_bf16 v[44:47], v[140:143], a[204:207], v[44:47]
    ds_read_b128 v[156:159], v6 offset:928
    s_waitcnt lgkmcnt(8)
    v_mfma_f32_16x16x32_bf16 v[16:19], v[144:147], a[8:11], v[16:19]
    ds_read_b128 a[68:71], v7 offset:272
    s_waitcnt lgkmcnt(8)
    v_mfma_f32_16x16x32_bf16 v[32:35], v[148:151], a[8:11], v[32:35]
    v_mov_b32 v212, v205
    v_mov_b32 v213, v206
    s_waitcnt lgkmcnt(7)
    v_mfma_f32_16x16x32_bf16 v[20:23], v[144:147], a[72:75], v[20:23]
    ds_read_b128 a[132:135], v7 offset:528
    v_mfma_f32_16x16x32_bf16 v[36:39], v[148:151], a[72:75], v[36:39]
    ds_write_b128 v5, v[210:213] offset:11392
    s_waitcnt lgkmcnt(8)
    v_mfma_f32_16x16x32_bf16 v[24:27], v[144:147], a[136:139], v[24:27]
    ds_read_b128 a[196:199], v7 offset:784
    v_mfma_f32_16x16x32_bf16 v[40:43], v[148:151], a[136:139], v[40:43]
    ds_read_b128 a[0:3], v7 offset:0
    s_waitcnt lgkmcnt(8)
    v_mfma_f32_16x16x32_bf16 v[28:31], v[144:147], a[200:203], v[28:31]
    ds_read_b128 v[160:163], v6 offset:960
    v_mfma_f32_16x16x32_bf16 v[44:47], v[148:151], a[200:203], v[44:47]
    ds_read_b128 v[164:167], v6 offset:992
    s_waitcnt lgkmcnt(8)
    v_mfma_f32_16x16x32_bf16 v[16:19], v[152:155], a[4:7], v[16:19]
    ds_read_b128 a[64:67], v7 offset:256
    s_waitcnt lgkmcnt(8)
    v_mfma_f32_16x16x32_bf16 v[32:35], v[156:159], a[4:7], v[32:35]
    v_alignbit_b32 v214, v201, v200, 16
    v_alignbit_b32 v215, v202, v201, 16
    s_waitcnt lgkmcnt(7)
    v_mfma_f32_16x16x32_bf16 v[20:23], v[152:155], a[68:71], v[20:23]
    ds_read_b128 a[128:131], v7 offset:512
    v_mfma_f32_16x16x32_bf16 v[36:39], v[156:159], a[68:71], v[36:39]
    v_alignbit_b32 v216, v203, v202, 16
    v_alignbit_b32 v217, v204, v203, 16
    s_waitcnt lgkmcnt(7)
    v_mfma_f32_16x16x32_bf16 v[24:27], v[152:155], a[132:135], v[24:27]
    ds_read_b128 a[192:195], v7 offset:768
    v_mfma_f32_16x16x32_bf16 v[40:43], v[156:159], a[132:135], v[40:43]
    ds_write_b128 v5, v[214:217] offset:32192
    s_waitcnt lgkmcnt(7)
    v_mfma_f32_16x16x32_bf16 v[28:31], v[152:155], a[196:199], v[28:31]
    ds_read_b128 v[168:171], v6 offset:1024
    v_mfma_f32_16x16x32_bf16 v[44:47], v[156:159], a[196:199], v[44:47]
    ds_read_b128 v[172:175], v6 offset:1056
    s_waitcnt lgkmcnt(7)
    v_mfma_f32_16x16x32_bf16 v[16:19], v[160:163], a[0:3], v[16:19]
    v_alignbit_b32 v218, v205, v204, 16
    v_alignbit_b32 v219, v206, v205, 16
    s_waitcnt lgkmcnt(6)
    v_mfma_f32_16x16x32_bf16 v[32:35], v[164:167], a[0:3], v[32:35]
    ds_write_b128 v5, v[216:219] offset:15552
    s_waitcnt lgkmcnt(6)
    v_mfma_f32_16x16x32_bf16 v[20:23], v[160:163], a[64:67], v[20:23]
    v_alignbit_b32 v220, v202, v201, 16
    v_alignbit_b32 v221, v203, v202, 16
    v_mfma_f32_16x16x32_bf16 v[36:39], v[164:167], a[64:67], v[36:39]
    v_alignbit_b32 v222, v204, v203, 16
    v_alignbit_b32 v223, v205, v204, 16
    s_waitcnt lgkmcnt(5)
    v_mfma_f32_16x16x32_bf16 v[24:27], v[160:163], a[128:131], v[24:27]
    ds_read_b128 v[112:115], v6 offset:1088
    v_mfma_f32_16x16x32_bf16 v[40:43], v[164:167], a[128:131], v[40:43]
    ds_read_b128 v[116:119], v6 offset:1120
    s_waitcnt lgkmcnt(6)
    v_mfma_f32_16x16x32_bf16 v[28:31], v[160:163], a[192:195], v[28:31]
    ds_write_b128 v5, v[220:223] offset:23872
    v_mfma_f32_16x16x32_bf16 v[44:47], v[164:167], a[192:195], v[44:47]
    v_alignbit_b32 v224, v206, v205, 16
    v_alignbit_b32 v225, v207, v206, 16
    s_waitcnt lgkmcnt(5)
    v_mfma_f32_16x16x32_bf16 v[20:23], v[168:171], a[60:63], v[20:23]
    ds_write_b128 v5, v[222:225] offset:7232
    s_waitcnt lgkmcnt(5)
    v_mfma_f32_16x16x32_bf16 v[36:39], v[172:175], a[60:63], v[36:39]
    buffer_load_dwordx4 v[200:203], v4, s[28:31], s36 offen offset:3056
    v_mfma_f32_16x16x32_bf16 v[24:27], v[168:171], a[124:127], v[24:27]
    ds_read_b128 v[120:123], v6 offset:1152
    v_mfma_f32_16x16x32_bf16 v[40:43], v[172:175], a[124:127], v[40:43]
    ds_read_b128 v[124:127], v6 offset:1184
    v_mfma_f32_16x16x32_bf16 v[28:31], v[168:171], a[188:191], v[28:31]
    buffer_load_dwordx4 v[204:207], v4, s[28:31], s36 offen offset:3072
    v_mfma_f32_16x16x32_bf16 v[44:47], v[172:175], a[188:191], v[44:47]
    s_waitcnt vmcnt(18)
    s_mov_b64 exec, 1
    v_mov_b32 v176, 0
    v_mov_b32 v177, 0
    v_mov_b32 v178, 0
    v_mov_b32 v179, 0
    s_mov_b64 exec, -1
    s_waitcnt lgkmcnt(5)
    v_mfma_f32_16x16x32_bf16 v[20:23], v[112:115], a[56:59], v[20:23]
    ds_write_b128 v5, v[180:183] offset:0
    s_waitcnt lgkmcnt(5)
    v_mfma_f32_16x16x32_bf16 v[36:39], v[116:119], a[56:59], v[36:39]
    ds_write_b128 v5, v[178:181] offset:16640
    v_mfma_f32_16x16x32_bf16 v[24:27], v[112:115], a[120:123], v[24:27]
    ds_read_b128 v[128:131], v6 offset:1216
    v_mfma_f32_16x16x32_bf16 v[40:43], v[116:119], a[120:123], v[40:43]
    ds_read_b128 v[132:135], v6 offset:1248
    v_mfma_f32_16x16x32_bf16 v[28:31], v[112:115], a[184:187], v[28:31]
    v_mov_b32 v208, v177
    v_mov_b32 v209, v178
    v_mfma_f32_16x16x32_bf16 v[44:47], v[116:119], a[184:187], v[44:47]
    v_mov_b32 v210, v179
    v_mov_b32 v211, v180
    s_waitcnt lgkmcnt(5)
    v_mfma_f32_16x16x32_bf16 v[20:23], v[120:123], a[52:55], v[20:23]
    ds_write_b128 v5, v[208:211] offset:24960
    s_waitcnt lgkmcnt(5)
    v_mfma_f32_16x16x32_bf16 v[36:39], v[124:127], a[52:55], v[36:39]
    v_mov_b32 v212, v181
    v_mov_b32 v213, v182
    v_mfma_f32_16x16x32_bf16 v[24:27], v[120:123], a[116:119], v[24:27]
    ds_read_b128 v[136:139], v6 offset:1280
    v_mfma_f32_16x16x32_bf16 v[40:43], v[124:127], a[116:119], v[40:43]
    ds_read_b128 v[140:143], v6 offset:1312
    v_mfma_f32_16x16x32_bf16 v[28:31], v[120:123], a[180:183], v[28:31]
    ds_write_b128 v5, v[210:213] offset:8320
    v_mfma_f32_16x16x32_bf16 v[44:47], v[124:127], a[180:183], v[44:47]
    v_alignbit_b32 v214, v177, v176, 16
    v_alignbit_b32 v215, v178, v177, 16
    s_waitcnt lgkmcnt(5)
    v_mfma_f32_16x16x32_bf16 v[20:23], v[128:131], a[48:51], v[20:23]
    v_alignbit_b32 v216, v179, v178, 16
    v_alignbit_b32 v217, v180, v179, 16
    s_waitcnt lgkmcnt(4)
    v_mfma_f32_16x16x32_bf16 v[36:39], v[132:135], a[48:51], v[36:39]
    ds_write_b128 v5, v[214:217] offset:29120
    v_mfma_f32_16x16x32_bf16 v[24:27], v[128:131], a[112:115], v[24:27]
    ds_read_b128 v[144:147], v6 offset:1344
    v_mfma_f32_16x16x32_bf16 v[40:43], v[132:135], a[112:115], v[40:43]
    ds_read_b128 v[148:151], v6 offset:1376
    v_mfma_f32_16x16x32_bf16 v[28:31], v[128:131], a[176:179], v[28:31]
    v_alignbit_b32 v218, v181, v180, 16
    v_alignbit_b32 v219, v182, v181, 16
    v_mfma_f32_16x16x32_bf16 v[44:47], v[132:135], a[176:179], v[44:47]
    ds_write_b128 v5, v[216:219] offset:12480
    s_waitcnt lgkmcnt(6)
    v_mfma_f32_16x16x32_bf16 v[20:23], v[136:139], a[44:47], v[20:23]
    v_alignbit_b32 v220, v178, v177, 16
    v_alignbit_b32 v221, v179, v178, 16
    s_waitcnt lgkmcnt(5)
    v_mfma_f32_16x16x32_bf16 v[36:39], v[140:143], a[44:47], v[36:39]
    v_alignbit_b32 v222, v180, v179, 16
    v_alignbit_b32 v223, v181, v180, 16
    v_mfma_f32_16x16x32_bf16 v[24:27], v[136:139], a[108:111], v[24:27]
    ds_read_b128 v[152:155], v6 offset:1408
    v_mfma_f32_16x16x32_bf16 v[40:43], v[140:143], a[108:111], v[40:43]
    ds_read_b128 v[156:159], v6 offset:1440
    v_mfma_f32_16x16x32_bf16 v[28:31], v[136:139], a[172:175], v[28:31]
    ds_write_b128 v5, v[220:223] offset:20800
    v_mfma_f32_16x16x32_bf16 v[44:47], v[140:143], a[172:175], v[44:47]
    v_alignbit_b32 v224, v182, v181, 16
    v_alignbit_b32 v225, v183, v182, 16
    s_waitcnt lgkmcnt(5)
    v_mfma_f32_16x16x32_bf16 v[20:23], v[144:147], a[40:43], v[20:23]
    ds_write_b128 v5, v[222:225] offset:4160
    s_waitcnt lgkmcnt(5)
    v_mfma_f32_16x16x32_bf16 v[36:39], v[148:151], a[40:43], v[36:39]
    buffer_load_dwordx4 v[176:179], v230, s[28:31], s37 offen offset:0
    v_mfma_f32_16x16x32_bf16 v[24:27], v[144:147], a[104:107], v[24:27]
    ds_read_b128 v[160:163], v6 offset:1472
    v_mfma_f32_16x16x32_bf16 v[40:43], v[148:151], a[104:107], v[40:43]
    ds_read_b128 v[164:167], v6 offset:1504
    v_mfma_f32_16x16x32_bf16 v[28:31], v[144:147], a[168:171], v[28:31]
    buffer_load_dwordx4 v[180:183], v4, s[28:31], s37 offen offset:0
    v_mfma_f32_16x16x32_bf16 v[44:47], v[148:151], a[168:171], v[44:47]
    s_add_u32 m0, s35, 0
    s_waitcnt lgkmcnt(5)
    v_mfma_f32_16x16x32_bf16 v[20:23], v[152:155], a[36:39], v[20:23]
    buffer_load_dwordx4 v4, s[8:11], s39 offen offset:0 lds
    s_waitcnt lgkmcnt(4)
    v_mfma_f32_16x16x32_bf16 v[36:39], v[156:159], a[36:39], v[36:39]
    s_add_u32 m0, s35, 256
    v_mfma_f32_16x16x32_bf16 v[24:27], v[152:155], a[100:103], v[24:27]
    ds_read_b128 v[168:171], v6 offset:1536
    v_mfma_f32_16x16x32_bf16 v[40:43], v[156:159], a[100:103], v[40:43]
    ds_read_b128 v[172:175], v6 offset:1568
    v_mfma_f32_16x16x32_bf16 v[28:31], v[152:155], a[164:167], v[28:31]
    buffer_load_dwordx4 v4, s[8:11], s39 offen offset:1024 lds
    v_mfma_f32_16x16x32_bf16 v[44:47], v[156:159], a[164:167], v[44:47]
    s_add_u32 m0, s35, 512
    s_waitcnt lgkmcnt(3)
    v_mfma_f32_16x16x32_bf16 v[20:23], v[160:163], a[32:35], v[20:23]
    buffer_load_dwordx4 v4, s[8:11], s39 offen offset:2048 lds
    s_waitcnt lgkmcnt(2)
    v_mfma_f32_16x16x32_bf16 v[36:39], v[164:167], a[32:35], v[36:39]
    s_add_u32 m0, s35, 768
    v_mfma_f32_16x16x32_bf16 v[24:27], v[160:163], a[96:99], v[24:27]
    ds_read_b128 v[112:115], v6 offset:1600
    v_mfma_f32_16x16x32_bf16 v[40:43], v[164:167], a[96:99], v[40:43]
    ds_read_b128 v[116:119], v6 offset:1632
    v_mfma_f32_16x16x32_bf16 v[28:31], v[160:163], a[160:163], v[28:31]
    buffer_load_dwordx4 v4, s[8:11], s39 offen offset:3072 lds
    v_mfma_f32_16x16x32_bf16 v[44:47], v[164:167], a[160:163], v[44:47]
    s_waitcnt lgkmcnt(3)
    v_mfma_f32_16x16x32_bf16 v[20:23], v[168:171], a[28:31], v[20:23]
    s_waitcnt lgkmcnt(2)
    v_mfma_f32_16x16x32_bf16 v[36:39], v[172:175], a[28:31], v[36:39]
    v_mfma_f32_16x16x32_bf16 v[24:27], v[168:171], a[92:95], v[24:27]
    ds_read_b128 v[120:123], v6 offset:1664
    v_mfma_f32_16x16x32_bf16 v[40:43], v[172:175], a[92:95], v[40:43]
    ds_read_b128 v[124:127], v6 offset:1696
    v_mfma_f32_16x16x32_bf16 v[28:31], v[168:171], a[156:159], v[28:31]
    v_mfma_f32_16x16x32_bf16 v[44:47], v[172:175], a[156:159], v[44:47]
    s_waitcnt lgkmcnt(3)
    v_mfma_f32_16x16x32_bf16 v[20:23], v[112:115], a[24:27], v[20:23]
    s_waitcnt lgkmcnt(2)
    v_mfma_f32_16x16x32_bf16 v[36:39], v[116:119], a[24:27], v[36:39]
    v_mfma_f32_16x16x32_bf16 v[24:27], v[112:115], a[88:91], v[24:27]
    ds_read_b128 v[128:131], v6 offset:1728
    v_mfma_f32_16x16x32_bf16 v[40:43], v[116:119], a[88:91], v[40:43]
    ds_read_b128 v[132:135], v6 offset:1760
    v_mfma_f32_16x16x32_bf16 v[28:31], v[112:115], a[152:155], v[28:31]
    v_mfma_f32_16x16x32_bf16 v[44:47], v[116:119], a[152:155], v[44:47]
    s_waitcnt lgkmcnt(3)
    v_mfma_f32_16x16x32_bf16 v[20:23], v[120:123], a[20:23], v[20:23]
    s_waitcnt lgkmcnt(2)
    v_mfma_f32_16x16x32_bf16 v[36:39], v[124:127], a[20:23], v[36:39]
    v_mfma_f32_16x16x32_bf16 v[24:27], v[120:123], a[84:87], v[24:27]
    ds_read_b128 v[136:139], v6 offset:1792
    v_mfma_f32_16x16x32_bf16 v[40:43], v[124:127], a[84:87], v[40:43]
    ds_read_b128 v[140:143], v6 offset:1824
    v_mfma_f32_16x16x32_bf16 v[28:31], v[120:123], a[148:151], v[28:31]
    v_mfma_f32_16x16x32_bf16 v[44:47], v[124:127], a[148:151], v[44:47]
    s_waitcnt lgkmcnt(3)
    v_mfma_f32_16x16x32_bf16 v[20:23], v[128:131], a[16:19], v[20:23]
    s_waitcnt lgkmcnt(2)
    v_mfma_f32_16x16x32_bf16 v[36:39], v[132:135], a[16:19], v[36:39]
    v_mfma_f32_16x16x32_bf16 v[24:27], v[128:131], a[80:83], v[24:27]
    ds_read_b128 v[144:147], v6 offset:1856
    v_mfma_f32_16x16x32_bf16 v[40:43], v[132:135], a[80:83], v[40:43]
    ds_read_b128 v[148:151], v6 offset:1888
    v_mfma_f32_16x16x32_bf16 v[28:31], v[128:131], a[144:147], v[28:31]
    v_mfma_f32_16x16x32_bf16 v[44:47], v[132:135], a[144:147], v[44:47]
    s_waitcnt lgkmcnt(3)
    v_mfma_f32_16x16x32_bf16 v[20:23], v[136:139], a[12:15], v[20:23]
    s_waitcnt lgkmcnt(2)
    v_mfma_f32_16x16x32_bf16 v[36:39], v[140:143], a[12:15], v[36:39]
    v_mfma_f32_16x16x32_bf16 v[24:27], v[136:139], a[76:79], v[24:27]
    ds_read_b128 v[152:155], v6 offset:1920
    v_mfma_f32_16x16x32_bf16 v[40:43], v[140:143], a[76:79], v[40:43]
    ds_read_b128 v[156:159], v6 offset:1952
    v_mfma_f32_16x16x32_bf16 v[28:31], v[136:139], a[140:143], v[28:31]
    v_mfma_f32_16x16x32_bf16 v[44:47], v[140:143], a[140:143], v[44:47]
    s_waitcnt lgkmcnt(3)
    v_mfma_f32_16x16x32_bf16 v[20:23], v[144:147], a[8:11], v[20:23]
    s_waitcnt lgkmcnt(2)
    v_mfma_f32_16x16x32_bf16 v[36:39], v[148:151], a[8:11], v[36:39]
    v_mfma_f32_16x16x32_bf16 v[24:27], v[144:147], a[72:75], v[24:27]
    ds_read_b128 v[160:163], v6 offset:1984
    v_mfma_f32_16x16x32_bf16 v[40:43], v[148:151], a[72:75], v[40:43]
    ds_read_b128 v[164:167], v6 offset:2016
    v_mfma_f32_16x16x32_bf16 v[28:31], v[144:147], a[136:139], v[28:31]
    v_mfma_f32_16x16x32_bf16 v[44:47], v[148:151], a[136:139], v[44:47]
    s_waitcnt lgkmcnt(3)
    v_mfma_f32_16x16x32_bf16 v[20:23], v[152:155], a[4:7], v[20:23]
    s_waitcnt lgkmcnt(2)
    v_mfma_f32_16x16x32_bf16 v[36:39], v[156:159], a[4:7], v[36:39]
    v_mfma_f32_16x16x32_bf16 v[24:27], v[152:155], a[68:71], v[24:27]
    ds_read_b128 v[168:171], v6 offset:2048
    v_mfma_f32_16x16x32_bf16 v[40:43], v[156:159], a[68:71], v[40:43]
    ds_read_b128 v[172:175], v6 offset:2080
    v_mfma_f32_16x16x32_bf16 v[28:31], v[152:155], a[132:135], v[28:31]
    s_waitcnt vmcnt(18)
    v_mfma_f32_16x16x32_bf16 v[44:47], v[156:159], a[132:135], v[44:47]
    ds_write_b128 v5, v[188:191] offset:1024
    s_waitcnt lgkmcnt(4)
    v_mfma_f32_16x16x32_bf16 v[20:23], v[160:163], a[0:3], v[20:23]
    ds_read_b128 v[112:115], v6 offset:2112
    s_waitcnt lgkmcnt(4)
    v_mfma_f32_16x16x32_bf16 v[36:39], v[164:167], a[0:3], v[36:39]
    ds_read_b128 v[116:119], v6 offset:2144
    v_mfma_f32_16x16x32_bf16 v[24:27], v[160:163], a[64:67], v[24:27]
    ds_write_b128 v5, v[186:189] offset:17664
    v_mfma_f32_16x16x32_bf16 v[40:43], v[164:167], a[64:67], v[40:43]
    v_mov_b32 v208, v185
    v_mov_b32 v209, v186
    v_mfma_f32_16x16x32_bf16 v[28:31], v[160:163], a[128:131], v[28:31]
    ds_read_b128 v[120:123], v6 offset:2176
    v_mfma_f32_16x16x32_bf16 v[44:47], v[164:167], a[128:131], v[44:47]
    ds_read_b128 v[124:127], v6 offset:2208
    s_waitcnt lgkmcnt(7)
    v_mfma_f32_16x16x32_bf16 v[24:27], v[168:171], a[60:63], v[24:27]
    v_mov_b32 v210, v187
    v_mov_b32 v211, v188
    s_waitcnt lgkmcnt(6)
    v_mfma_f32_16x16x32_bf16 v[40:43], v[172:175], a[60:63], v[40:43]
    ds_write_b128 v5, v[208:211] offset:25984
    v_mfma_f32_16x16x32_bf16 v[28:31], v[168:171], a[124:127], v[28:31]
    ds_read_b128 v[128:131], v6 offset:2240
    v_mfma_f32_16x16x32_bf16 v[44:47], v[172:175], a[124:127], v[44:47]
    ds_read_b128 v[132:135], v6 offset:2272
    s_waitcnt lgkmcnt(7)
    v_mfma_f32_16x16x32_bf16 v[24:27], v[112:115], a[56:59], v[24:27]
    v_mov_b32 v212, v189
    v_mov_b32 v213, v190
    s_waitcnt lgkmcnt(6)
    v_mfma_f32_16x16x32_bf16 v[40:43], v[116:119], a[56:59], v[40:43]
    ds_write_b128 v5, v[210:213] offset:9344
    v_mfma_f32_16x16x32_bf16 v[28:31], v[112:115], a[120:123], v[28:31]
    ds_read_b128 v[136:139], v6 offset:2304
    v_mfma_f32_16x16x32_bf16 v[44:47], v[116:119], a[120:123], v[44:47]
    ds_read_b128 v[140:143], v6 offset:2336
    s_waitcnt lgkmcnt(7)
    v_mfma_f32_16x16x32_bf16 v[24:27], v[120:123], a[52:55], v[24:27]
    v_alignbit_b32 v214, v185, v184, 16
    v_alignbit_b32 v215, v186, v185, 16
    s_waitcnt lgkmcnt(6)
    v_mfma_f32_16x16x32_bf16 v[40:43], v[124:127], a[52:55], v[40:43]
    v_alignbit_b32 v216, v187, v186, 16
    v_alignbit_b32 v217, v188, v187, 16
    v_mfma_f32_16x16x32_bf16 v[28:31], v[120:123], a[116:119], v[28:31]
    ds_read_b128 v[144:147], v6 offset:2368
    v_mfma_f32_16x16x32_bf16 v[44:47], v[124:127], a[116:119], v[44:47]
    ds_read_b128 v[148:151], v6 offset:2400
    s_waitcnt lgkmcnt(6)
    v_mfma_f32_16x16x32_bf16 v[24:27], v[128:131], a[48:51], v[24:27]
    ds_write_b128 v5, v[214:217] offset:30144
    s_waitcnt lgkmcnt(6)
    v_mfma_f32_16x16x32_bf16 v[40:43], v[132:135], a[48:51], v[40:43]
    v_alignbit_b32 v218, v189, v188, 16
    v_alignbit_b32 v219, v190, v189, 16
    v_mfma_f32_16x16x32_bf16 v[28:31], v[128:131], a[112:115], v[28:31]
    ds_read_b128 v[152:155], v6 offset:2432
    v_mfma_f32_16x16x32_bf16 v[44:47], v[132:135], a[112:115], v[44:47]
    ds_read_b128 v[156:159], v6 offset:2464
    s_waitcnt lgkmcnt(6)
    v_mfma_f32_16x16x32_bf16 v[24:27], v[136:139], a[44:47], v[24:27]
    ds_write_b128 v5, v[216:219] offset:13504
    s_waitcnt lgkmcnt(6)
    v_mfma_f32_16x16x32_bf16 v[40:43], v[140:143], a[44:47], v[40:43]
    v_alignbit_b32 v220, v186, v185, 16
    v_alignbit_b32 v221, v187, v186, 16
    v_mfma_f32_16x16x32_bf16 v[28:31], v[136:139], a[108:111], v[28:31]
    ds_read_b128 v[160:163], v6 offset:2496
    v_mfma_f32_16x16x32_bf16 v[44:47], v[140:143], a[108:111], v[44:47]
    ds_read_b128 v[164:167], v6 offset:2528
    s_waitcnt lgkmcnt(7)
    v_mfma_f32_16x16x32_bf16 v[24:27], v[144:147], a[40:43], v[24:27]
    v_alignbit_b32 v222, v188, v187, 16
    v_alignbit_b32 v223, v189, v188, 16
    s_waitcnt lgkmcnt(6)
    v_mfma_f32_16x16x32_bf16 v[40:43], v[148:151], a[40:43], v[40:43]
    ds_write_b128 v5, v[220:223] offset:21824
    v_mfma_f32_16x16x32_bf16 v[28:31], v[144:147], a[104:107], v[28:31]
    ds_read_b128 v[168:171], v6 offset:2560
    v_mfma_f32_16x16x32_bf16 v[44:47], v[148:151], a[104:107], v[44:47]
    ds_read_b128 v[172:175], v6 offset:2592
    s_waitcnt lgkmcnt(7)
    v_mfma_f32_16x16x32_bf16 v[24:27], v[152:155], a[36:39], v[24:27]
    v_alignbit_b32 v224, v190, v189, 16
    v_alignbit_b32 v225, v191, v190, 16
    s_waitcnt lgkmcnt(6)
    v_mfma_f32_16x16x32_bf16 v[40:43], v[156:159], a[36:39], v[40:43]
    ds_write_b128 v5, v[222:225] offset:5184
    v_mfma_f32_16x16x32_bf16 v[28:31], v[152:155], a[100:103], v[28:31]
    ds_read_b128 v[112:115], v6 offset:2624
    v_mfma_f32_16x16x32_bf16 v[44:47], v[156:159], a[100:103], v[44:47]
    ds_read_b128 v[116:119], v6 offset:2656
    s_waitcnt lgkmcnt(7)
    v_mfma_f32_16x16x32_bf16 v[24:27], v[160:163], a[32:35], v[24:27]
    buffer_load_dwordx4 v[184:187], v4, s[28:31], s37 offen offset:1008
    s_waitcnt lgkmcnt(6)
    v_mfma_f32_16x16x32_bf16 v[40:43], v[164:167], a[32:35], v[40:43]
    buffer_load_dwordx4 v[188:191], v4, s[28:31], s37 offen offset:1024
    v_mfma_f32_16x16x32_bf16 v[28:31], v[160:163], a[96:99], v[28:31]
    ds_read_b128 v[120:123], v6 offset:2688
    v_mfma_f32_16x16x32_bf16 v[44:47], v[164:167], a[96:99], v[44:47]
    ds_read_b128 v[124:127], v6 offset:2720
    s_waitcnt lgkmcnt(6)
    v_mfma_f32_16x16x32_bf16 v[24:27], v[168:171], a[28:31], v[24:27]
    s_mov_b32 s36, s37
    s_add_u32 s39, s37, 125829120
    s_add_u32 s37, s37, 4096
    s_min_u32 s37, s37, s33

    s_pack_hh_b32_b16 s40, s64, s64
    v_and_b32 v236, s40, v8
    s_waitcnt lgkmcnt(5)
    v_mfma_f32_16x16x32_bf16 v[40:43], v[172:175], a[28:31], v[40:43]
    v_and_b32 v237, s40, v9
    v_and_b32 v238, s40, v10
    v_mfma_f32_16x16x32_bf16 v[28:31], v[168:171], a[92:95], v[28:31]
    ds_read_b128 v[128:131], v6 offset:2752
    v_mfma_f32_16x16x32_bf16 v[44:47], v[172:175], a[92:95], v[44:47]
    ds_read_b128 v[132:135], v6 offset:2784
    s_waitcnt lgkmcnt(5)
    v_mfma_f32_16x16x32_bf16 v[24:27], v[112:115], a[24:27], v[24:27]
    v_and_b32 v239, s40, v11
    v_and_b32 v240, s40, v12
    s_waitcnt lgkmcnt(4)
    v_mfma_f32_16x16x32_bf16 v[40:43], v[116:119], a[24:27], v[40:43]
    v_and_b32 v241, s40, v13
    v_and_b32 v242, s40, v14
    v_mfma_f32_16x16x32_bf16 v[28:31], v[112:115], a[88:91], v[28:31]
    ds_read_b128 v[136:139], v6 offset:2816
    v_mfma_f32_16x16x32_bf16 v[44:47], v[116:119], a[88:91], v[44:47]
    ds_read_b128 v[140:143], v6 offset:2848
    s_waitcnt lgkmcnt(5)
    v_mfma_f32_16x16x32_bf16 v[24:27], v[120:123], a[20:23], v[24:27]
    v_and_b32 v243, s40, v15
    s_waitcnt lgkmcnt(4)
    v_mfma_f32_16x16x32_bf16 v[40:43], v[124:127], a[20:23], v[40:43]
    v_mfma_f32_16x16x32_bf16 v[28:31], v[120:123], a[84:87], v[28:31]
    ds_read_b128 v[144:147], v6 offset:2880
    v_mfma_f32_16x16x32_bf16 v[44:47], v[124:127], a[84:87], v[44:47]
    ds_read_b128 v[148:151], v6 offset:2912
    s_waitcnt lgkmcnt(5)
    v_mfma_f32_16x16x32_bf16 v[24:27], v[128:131], a[16:19], v[24:27]
    s_waitcnt lgkmcnt(4)
    v_mfma_f32_16x16x32_bf16 v[40:43], v[132:135], a[16:19], v[40:43]
    v_mfma_f32_16x16x32_bf16 v[28:31], v[128:131], a[80:83], v[28:31]
    ds_read_b128 v[152:155], v6 offset:2944
    v_mfma_f32_16x16x32_bf16 v[44:47], v[132:135], a[80:83], v[44:47]
    ds_read_b128 v[156:159], v6 offset:2976
    s_waitcnt lgkmcnt(5)
    v_mfma_f32_16x16x32_bf16 v[24:27], v[136:139], a[12:15], v[24:27]
    s_waitcnt lgkmcnt(4)
    v_mfma_f32_16x16x32_bf16 v[40:43], v[140:143], a[12:15], v[40:43]
    v_mfma_f32_16x16x32_bf16 v[28:31], v[136:139], a[76:79], v[28:31]
    ds_read_b128 v[160:163], v6 offset:3008
    v_mfma_f32_16x16x32_bf16 v[44:47], v[140:143], a[76:79], v[44:47]
    ds_read_b128 v[164:167], v6 offset:3040
    s_waitcnt lgkmcnt(5)
    v_mfma_f32_16x16x32_bf16 v[24:27], v[144:147], a[8:11], v[24:27]
    s_waitcnt lgkmcnt(4)
    v_mfma_f32_16x16x32_bf16 v[40:43], v[148:151], a[8:11], v[40:43]
    v_mfma_f32_16x16x32_bf16 v[28:31], v[144:147], a[72:75], v[28:31]
    ds_read_b128 v[168:171], v6 offset:3072
    v_mfma_f32_16x16x32_bf16 v[44:47], v[148:151], a[72:75], v[44:47]
    ds_read_b128 v[172:175], v6 offset:3104
    s_waitcnt lgkmcnt(5)
    v_mfma_f32_16x16x32_bf16 v[24:27], v[152:155], a[4:7], v[24:27]
    ds_read_b128 v[112:115], v6 offset:3136
    s_waitcnt lgkmcnt(5)
    v_mfma_f32_16x16x32_bf16 v[40:43], v[156:159], a[4:7], v[40:43]
    ds_read_b128 v[116:119], v6 offset:3168
    v_mfma_f32_16x16x32_bf16 v[28:31], v[152:155], a[68:71], v[28:31]
    ds_read_b128 v[120:123], v6 offset:3200
    v_mfma_f32_16x16x32_bf16 v[44:47], v[156:159], a[68:71], v[44:47]
    ds_read_b128 v[124:127], v6 offset:3232
    s_waitcnt lgkmcnt(7)
    v_mfma_f32_16x16x32_bf16 v[24:27], v[160:163], a[0:3], v[24:27]
    ds_read_b128 v[128:131], v6 offset:3264
    s_waitcnt lgkmcnt(7)
    v_mfma_f32_16x16x32_bf16 v[40:43], v[164:167], a[0:3], v[40:43]
    ds_read_b128 v[132:135], v6 offset:3296
    v_mfma_f32_16x16x32_bf16 v[28:31], v[160:163], a[64:67], v[28:31]
    ds_read_b128 v[136:139], v6 offset:3328
    v_mfma_f32_16x16x32_bf16 v[44:47], v[164:167], a[64:67], v[44:47]
    ds_read_b128 v[140:143], v6 offset:3360
    s_waitcnt lgkmcnt(9)
    v_mfma_f32_16x16x32_bf16 v[28:31], v[168:171], a[60:63], v[28:31]
    ds_read_b128 v[144:147], v6 offset:3392
    s_waitcnt lgkmcnt(9)
    v_mfma_f32_16x16x32_bf16 v[44:47], v[172:175], a[60:63], v[44:47]
    ds_read_b128 v[148:151], v6 offset:3424
    s_waitcnt lgkmcnt(9)
    v_mfma_f32_16x16x32_bf16 v[28:31], v[112:115], a[56:59], v[28:31]
    ds_read_b128 v[152:155], v6 offset:3456
    s_waitcnt lgkmcnt(9)
    v_mfma_f32_16x16x32_bf16 v[44:47], v[116:119], a[56:59], v[44:47]
    ds_read_b128 v[156:159], v6 offset:3488
    s_waitcnt lgkmcnt(9)
    v_mfma_f32_16x16x32_bf16 v[28:31], v[120:123], a[52:55], v[28:31]
    ds_read_b128 v[160:163], v6 offset:3520
    s_waitcnt lgkmcnt(9)
    v_mfma_f32_16x16x32_bf16 v[44:47], v[124:127], a[52:55], v[44:47]
    ds_read_b128 v[164:167], v6 offset:3552
    s_waitcnt lgkmcnt(9)
    v_mfma_f32_16x16x32_bf16 v[28:31], v[128:131], a[48:51], v[28:31]
    ds_read_b128 v[168:171], v6 offset:3584
    s_waitcnt lgkmcnt(9)
    v_mfma_f32_16x16x32_bf16 v[44:47], v[132:135], a[48:51], v[44:47]
    ds_read_b128 v[172:175], v6 offset:3616
    s_waitcnt lgkmcnt(9)
    v_mfma_f32_16x16x32_bf16 v[28:31], v[136:139], a[44:47], v[28:31]
    ds_read_b128 v[112:115], v6 offset:3648
    s_waitcnt lgkmcnt(9)
    v_mfma_f32_16x16x32_bf16 v[44:47], v[140:143], a[44:47], v[44:47]
    ds_read_b128 v[116:119], v6 offset:3680
    s_waitcnt lgkmcnt(9)
    v_mfma_f32_16x16x32_bf16 v[28:31], v[144:147], a[40:43], v[28:31]
    ds_read_b128 v[120:123], v6 offset:3712
    s_waitcnt lgkmcnt(9)
    v_mfma_f32_16x16x32_bf16 v[44:47], v[148:151], a[40:43], v[44:47]
    ds_read_b128 v[124:127], v6 offset:3744
    s_waitcnt lgkmcnt(9)
    v_mfma_f32_16x16x32_bf16 v[28:31], v[152:155], a[36:39], v[28:31]
    ds_read_b128 v[128:131], v6 offset:3776
    s_waitcnt lgkmcnt(9)
    v_mfma_f32_16x16x32_bf16 v[44:47], v[156:159], a[36:39], v[44:47]
    ds_read_b128 v[132:135], v6 offset:3808
    s_waitcnt lgkmcnt(9)
    v_mfma_f32_16x16x32_bf16 v[28:31], v[160:163], a[32:35], v[28:31]
    ds_read_b128 v[136:139], v6 offset:3840
    s_waitcnt lgkmcnt(9)
    v_mfma_f32_16x16x32_bf16 v[44:47], v[164:167], a[32:35], v[44:47]
    ds_read_b128 v[140:143], v6 offset:3872
    s_waitcnt lgkmcnt(9)
    v_mfma_f32_16x16x32_bf16 v[28:31], v[168:171], a[28:31], v[28:31]
    ds_read_b128 v[144:147], v6 offset:3904
    s_waitcnt lgkmcnt(9)
    v_mfma_f32_16x16x32_bf16 v[44:47], v[172:175], a[28:31], v[44:47]
    ds_read_b128 v[148:151], v6 offset:3936
    s_waitcnt lgkmcnt(9)
    v_mfma_f32_16x16x32_bf16 v[28:31], v[112:115], a[24:27], v[28:31]
    ds_read_b128 v[152:155], v6 offset:3968
    s_waitcnt lgkmcnt(9)
    v_mfma_f32_16x16x32_bf16 v[44:47], v[116:119], a[24:27], v[44:47]
    ds_read_b128 v[156:159], v6 offset:4000
    s_waitcnt lgkmcnt(9)
    v_mfma_f32_16x16x32_bf16 v[28:31], v[120:123], a[20:23], v[28:31]
    ds_read_b128 v[160:163], v6 offset:4032
    s_waitcnt lgkmcnt(9)
    v_mfma_f32_16x16x32_bf16 v[44:47], v[124:127], a[20:23], v[44:47]
    ds_read_b128 v[164:167], v6 offset:4064
    s_waitcnt lgkmcnt(9)
    v_mfma_f32_16x16x32_bf16 v[28:31], v[128:131], a[16:19], v[28:31]
    s_waitcnt vmcnt(2)
    ds_read_b128 a[60:63], v7 offset:240
    s_waitcnt lgkmcnt(9)
    v_mfma_f32_16x16x32_bf16 v[44:47], v[132:135], a[16:19], v[44:47]
    s_waitcnt lgkmcnt(8)
    v_mfma_f32_16x16x32_bf16 v[28:31], v[136:139], a[12:15], v[28:31]
    ds_read_b128 a[124:127], v7 offset:496
    s_waitcnt lgkmcnt(8)
    v_mfma_f32_16x16x32_bf16 v[44:47], v[140:143], a[12:15], v[44:47]
    s_waitcnt lgkmcnt(7)
    v_mfma_f32_16x16x32_bf16 v[28:31], v[144:147], a[8:11], v[28:31]
    ds_read_b128 a[188:191], v7 offset:752
    s_waitcnt lgkmcnt(7)
    v_mfma_f32_16x16x32_bf16 v[44:47], v[148:151], a[8:11], v[44:47]
    s_waitcnt lgkmcnt(6)
    v_mfma_f32_16x16x32_bf16 v[28:31], v[152:155], a[4:7], v[28:31]
    ds_read_b128 a[252:255], v7 offset:1008
    s_waitcnt lgkmcnt(6)
    v_mfma_f32_16x16x32_bf16 v[44:47], v[156:159], a[4:7], v[44:47]
    s_waitcnt lgkmcnt(5)
    v_mfma_f32_16x16x32_bf16 v[28:31], v[160:163], a[0:3], v[28:31]
    ds_read_b128 v[168:171], v6 offset:0
    s_waitcnt lgkmcnt(5)
    v_mfma_f32_16x16x32_bf16 v[44:47], v[164:167], a[0:3], v[44:47]
    ds_read_b128 v[172:175], v6 offset:32
    s_waitcnt lgkmcnt(5)
    v_mfma_f32_16x16x32_bf16 v[48:51], v[236:239], a[60:63], 0
    v_mfma_f32_16x16x32_bf16 v[64:67], v[240:243], a[60:63], 0
    s_waitcnt lgkmcnt(4)
    v_mfma_f32_16x16x32_bf16 v[52:55], v[236:239], a[124:127], 0
    v_mfma_f32_16x16x32_bf16 v[68:71], v[240:243], a[124:127], 0
    s_waitcnt lgkmcnt(3)
    v_mfma_f32_16x16x32_bf16 v[56:59], v[236:239], a[188:191], 0
    v_mfma_f32_16x16x32_bf16 v[72:75], v[240:243], a[188:191], 0
    ds_read_b128 a[56:59], v7 offset:224
    s_waitcnt lgkmcnt(3)
    v_mfma_f32_16x16x32_bf16 v[60:63], v[236:239], a[252:255], 0
    ds_read_b128 v[112:115], v6 offset:64
    v_mfma_f32_16x16x32_bf16 v[76:79], v[240:243], a[252:255], 0
    ds_read_b128 v[116:119], v6 offset:96
    s_waitcnt lgkmcnt(4)
    v_mfma_f32_16x16x32_bf16 v[48:51], v[168:171], a[60:63], v[48:51]
    ds_read_b128 a[120:123], v7 offset:480
    s_waitcnt lgkmcnt(4)
    v_mfma_f32_16x16x32_bf16 v[64:67], v[172:175], a[60:63], v[64:67]
    s_waitcnt vmcnt(10)
    v_mfma_f32_16x16x32_bf16 v[52:55], v[168:171], a[124:127], v[52:55]
    ds_read_b128 a[184:187], v7 offset:736
    v_mfma_f32_16x16x32_bf16 v[68:71], v[172:175], a[124:127], v[68:71]
    ds_write_b128 v5, v[196:199] offset:2048
    v_mfma_f32_16x16x32_bf16 v[56:59], v[168:171], a[188:191], v[56:59]
    ds_read_b128 a[248:251], v7 offset:992
    v_mfma_f32_16x16x32_bf16 v[72:75], v[172:175], a[188:191], v[72:75]
    ds_read_b128 a[52:55], v7 offset:208
    v_mfma_f32_16x16x32_bf16 v[60:63], v[168:171], a[252:255], v[60:63]
    ds_read_b128 v[120:123], v6 offset:128
    v_mfma_f32_16x16x32_bf16 v[76:79], v[172:175], a[252:255], v[76:79]
    ds_read_b128 v[124:127], v6 offset:160
    s_waitcnt lgkmcnt(8)
    v_mfma_f32_16x16x32_bf16 v[48:51], v[112:115], a[56:59], v[48:51]
    ds_read_b128 a[116:119], v7 offset:464
    s_waitcnt lgkmcnt(8)
    v_mfma_f32_16x16x32_bf16 v[64:67], v[116:119], a[56:59], v[64:67]
    ds_write_b128 v5, v[194:197] offset:18688
    s_waitcnt lgkmcnt(8)
    v_mfma_f32_16x16x32_bf16 v[52:55], v[112:115], a[120:123], v[52:55]
    ds_read_b128 a[180:183], v7 offset:720
    v_mfma_f32_16x16x32_bf16 v[68:71], v[116:119], a[120:123], v[68:71]
    v_mov_b32 v208, v193
    v_mov_b32 v209, v194
    s_waitcnt lgkmcnt(8)
    v_mfma_f32_16x16x32_bf16 v[56:59], v[112:115], a[184:187], v[56:59]
    ds_read_b128 a[244:247], v7 offset:976
    v_mfma_f32_16x16x32_bf16 v[72:75], v[116:119], a[184:187], v[72:75]
    ds_read_b128 a[48:51], v7 offset:192
    s_waitcnt lgkmcnt(8)
    v_mfma_f32_16x16x32_bf16 v[60:63], v[112:115], a[248:251], v[60:63]
    ds_read_b128 v[128:131], v6 offset:192
    v_mfma_f32_16x16x32_bf16 v[76:79], v[116:119], a[248:251], v[76:79]
    ds_read_b128 v[132:135], v6 offset:224
    s_waitcnt lgkmcnt(8)
    v_mfma_f32_16x16x32_bf16 v[48:51], v[120:123], a[52:55], v[48:51]
    ds_read_b128 a[112:115], v7 offset:448
    s_waitcnt lgkmcnt(8)
    v_mfma_f32_16x16x32_bf16 v[64:67], v[124:127], a[52:55], v[64:67]
    v_mov_b32 v210, v195
    v_mov_b32 v211, v196
    s_waitcnt lgkmcnt(7)
    v_mfma_f32_16x16x32_bf16 v[52:55], v[120:123], a[116:119], v[52:55]
    ds_read_b128 a[176:179], v7 offset:704
    v_mfma_f32_16x16x32_bf16 v[68:71], v[124:127], a[116:119], v[68:71]
    ds_write_b128 v5, v[208:211] offset:27008
    s_waitcnt lgkmcnt(7)
    v_mfma_f32_16x16x32_bf16 v[56:59], v[120:123], a[180:183], v[56:59]
    ds_read_b128 a[240:243], v7 offset:960
    v_mfma_f32_16x16x32_bf16 v[72:75], v[124:127], a[180:183], v[72:75]
    ds_read_b128 a[44:47], v7 offset:176
    s_waitcnt lgkmcnt(8)
    v_mfma_f32_16x16x32_bf16 v[60:63], v[120:123], a[244:247], v[60:63]
    ds_read_b128 v[136:139], v6 offset:256
    v_mfma_f32_16x16x32_bf16 v[76:79], v[124:127], a[244:247], v[76:79]
    ds_read_b128 v[140:143], v6 offset:288
    s_waitcnt lgkmcnt(8)
    v_mfma_f32_16x16x32_bf16 v[48:51], v[128:131], a[48:51], v[48:51]
    ds_read_b128 a[108:111], v7 offset:432
    s_waitcnt lgkmcnt(8)
    v_mfma_f32_16x16x32_bf16 v[64:67], v[132:135], a[48:51], v[64:67]
    v_mov_b32 v212, v197
    v_mov_b32 v213, v198
    s_waitcnt lgkmcnt(7)
    v_mfma_f32_16x16x32_bf16 v[52:55], v[128:131], a[112:115], v[52:55]
    ds_read_b128 a[172:175], v7 offset:688
    v_mfma_f32_16x16x32_bf16 v[68:71], v[132:135], a[112:115], v[68:71]
    ds_write_b128 v5, v[210:213] offset:10368
    s_waitcnt lgkmcnt(8)
    v_mfma_f32_16x16x32_bf16 v[56:59], v[128:131], a[176:179], v[56:59]
    ds_read_b128 a[236:239], v7 offset:944
    v_mfma_f32_16x16x32_bf16 v[72:75], v[132:135], a[176:179], v[72:75]
    ds_read_b128 a[40:43], v7 offset:160
    s_waitcnt lgkmcnt(8)
    v_mfma_f32_16x16x32_bf16 v[60:63], v[128:131], a[240:243], v[60:63]
    ds_read_b128 v[144:147], v6 offset:320
    v_mfma_f32_16x16x32_bf16 v[76:79], v[132:135], a[240:243], v[76:79]
    ds_read_b128 v[148:151], v6 offset:352
    s_waitcnt lgkmcnt(8)
    v_mfma_f32_16x16x32_bf16 v[48:51], v[136:139], a[44:47], v[48:51]
    ds_read_b128 a[104:107], v7 offset:416
    s_waitcnt lgkmcnt(8)
    v_mfma_f32_16x16x32_bf16 v[64:67], v[140:143], a[44:47], v[64:67]
    v_alignbit_b32 v214, v193, v192, 16
    v_alignbit_b32 v215, v194, v193, 16
    s_waitcnt lgkmcnt(7)
    v_mfma_f32_16x16x32_bf16 v[52:55], v[136:139], a[108:111], v[52:55]
    ds_read_b128 a[168:171], v7 offset:672
    v_mfma_f32_16x16x32_bf16 v[68:71], v[140:143], a[108:111], v[68:71]
    v_alignbit_b32 v216, v195, v194, 16
    v_alignbit_b32 v217, v196, v195, 16
    s_waitcnt lgkmcnt(7)
    v_mfma_f32_16x16x32_bf16 v[56:59], v[136:139], a[172:175], v[56:59]
    ds_read_b128 a[232:235], v7 offset:928
    v_mfma_f32_16x16x32_bf16 v[72:75], v[140:143], a[172:175], v[72:75]
    ds_read_b128 a[36:39], v7 offset:144
    s_waitcnt lgkmcnt(7)
    v_mfma_f32_16x16x32_bf16 v[60:63], v[136:139], a[236:239], v[60:63]
    ds_read_b128 v[152:155], v6 offset:384
    v_mfma_f32_16x16x32_bf16 v[76:79], v[140:143], a[236:239], v[76:79]
    ds_read_b128 v[156:159], v6 offset:416
    s_waitcnt lgkmcnt(7)
    v_mfma_f32_16x16x32_bf16 v[48:51], v[144:147], a[40:43], v[48:51]
    ds_read_b128 a[100:103], v7 offset:400
    s_waitcnt lgkmcnt(7)
    v_mfma_f32_16x16x32_bf16 v[64:67], v[148:151], a[40:43], v[64:67]
    ds_write_b128 v5, v[214:217] offset:31168
    s_waitcnt lgkmcnt(7)
    v_mfma_f32_16x16x32_bf16 v[52:55], v[144:147], a[104:107], v[52:55]
    ds_read_b128 a[164:167], v7 offset:656
    v_mfma_f32_16x16x32_bf16 v[68:71], v[148:151], a[104:107], v[68:71]
    v_alignbit_b32 v218, v197, v196, 16
    v_alignbit_b32 v219, v198, v197, 16
    s_waitcnt lgkmcnt(7)
    v_mfma_f32_16x16x32_bf16 v[56:59], v[144:147], a[168:171], v[56:59]
    ds_read_b128 a[228:231], v7 offset:912
    v_mfma_f32_16x16x32_bf16 v[72:75], v[148:151], a[168:171], v[72:75]
    ds_read_b128 a[32:35], v7 offset:128
    s_waitcnt lgkmcnt(8)
    v_mfma_f32_16x16x32_bf16 v[60:63], v[144:147], a[232:235], v[60:63]
    ds_read_b128 v[160:163], v6 offset:448
    v_mfma_f32_16x16x32_bf16 v[76:79], v[148:151], a[232:235], v[76:79]
    ds_read_b128 v[164:167], v6 offset:480
    s_waitcnt lgkmcnt(8)
    v_mfma_f32_16x16x32_bf16 v[48:51], v[152:155], a[36:39], v[48:51]
    ds_read_b128 a[96:99], v7 offset:384
    s_waitcnt lgkmcnt(8)
    v_mfma_f32_16x16x32_bf16 v[64:67], v[156:159], a[36:39], v[64:67]
    ds_write_b128 v5, v[216:219] offset:14528
    s_waitcnt lgkmcnt(8)
    v_mfma_f32_16x16x32_bf16 v[52:55], v[152:155], a[100:103], v[52:55]
    ds_read_b128 a[160:163], v7 offset:640
    v_mfma_f32_16x16x32_bf16 v[68:71], v[156:159], a[100:103], v[68:71]
    v_alignbit_b32 v220, v194, v193, 16
    v_alignbit_b32 v221, v195, v194, 16
    s_waitcnt lgkmcnt(7)
    v_mfma_f32_16x16x32_bf16 v[56:59], v[152:155], a[164:167], v[56:59]
    ds_read_b128 a[224:227], v7 offset:896
    v_mfma_f32_16x16x32_bf16 v[72:75], v[156:159], a[164:167], v[72:75]
    ds_read_b128 a[28:31], v7 offset:112
    s_waitcnt lgkmcnt(8)
    v_mfma_f32_16x16x32_bf16 v[60:63], v[152:155], a[228:231], v[60:63]
    ds_read_b128 v[168:171], v6 offset:512
    v_mfma_f32_16x16x32_bf16 v[76:79], v[156:159], a[228:231], v[76:79]
    ds_read_b128 v[172:175], v6 offset:544
    s_waitcnt lgkmcnt(8)
    v_mfma_f32_16x16x32_bf16 v[48:51], v[160:163], a[32:35], v[48:51]
    ds_read_b128 a[92:95], v7 offset:368
    s_waitcnt lgkmcnt(8)
    v_mfma_f32_16x16x32_bf16 v[64:67], v[164:167], a[32:35], v[64:67]
    v_alignbit_b32 v222, v196, v195, 16
    v_alignbit_b32 v223, v197, v196, 16
    s_waitcnt lgkmcnt(7)
    v_mfma_f32_16x16x32_bf16 v[52:55], v[160:163], a[96:99], v[52:55]
    ds_read_b128 a[156:159], v7 offset:624
    v_mfma_f32_16x16x32_bf16 v[68:71], v[164:167], a[96:99], v[68:71]
    ds_write_b128 v5, v[220:223] offset:22848
    s_waitcnt lgkmcnt(7)
    v_mfma_f32_16x16x32_bf16 v[56:59], v[160:163], a[160:163], v[56:59]
    ds_read_b128 a[220:223], v7 offset:880
    v_mfma_f32_16x16x32_bf16 v[72:75], v[164:167], a[160:163], v[72:75]
    ds_read_b128 a[24:27], v7 offset:96
    s_waitcnt lgkmcnt(8)
    v_mfma_f32_16x16x32_bf16 v[60:63], v[160:163], a[224:227], v[60:63]
    ds_read_b128 v[112:115], v6 offset:576
    v_mfma_f32_16x16x32_bf16 v[76:79], v[164:167], a[224:227], v[76:79]
    ds_read_b128 v[116:119], v6 offset:608
    s_waitcnt lgkmcnt(8)
    v_mfma_f32_16x16x32_bf16 v[48:51], v[168:171], a[28:31], v[48:51]
    ds_read_b128 a[88:91], v7 offset:352
    s_waitcnt lgkmcnt(8)
    v_mfma_f32_16x16x32_bf16 v[64:67], v[172:175], a[28:31], v[64:67]
    v_alignbit_b32 v224, v198, v197, 16
    v_alignbit_b32 v225, v199, v198, 16
    s_waitcnt lgkmcnt(7)
    v_mfma_f32_16x16x32_bf16 v[52:55], v[168:171], a[92:95], v[52:55]
    ds_read_b128 a[152:155], v7 offset:608
    v_mfma_f32_16x16x32_bf16 v[68:71], v[172:175], a[92:95], v[68:71]
    ds_write_b128 v5, v[222:225] offset:6208
    s_waitcnt lgkmcnt(8)
    v_mfma_f32_16x16x32_bf16 v[56:59], v[168:171], a[156:159], v[56:59]
    ds_read_b128 a[216:219], v7 offset:864
    v_mfma_f32_16x16x32_bf16 v[72:75], v[172:175], a[156:159], v[72:75]
    ds_read_b128 a[20:23], v7 offset:80
    s_waitcnt lgkmcnt(8)
    v_mfma_f32_16x16x32_bf16 v[60:63], v[168:171], a[220:223], v[60:63]
    ds_read_b128 v[120:123], v6 offset:640
    v_mfma_f32_16x16x32_bf16 v[76:79], v[172:175], a[220:223], v[76:79]
    ds_read_b128 v[124:127], v6 offset:672
    s_waitcnt lgkmcnt(8)
    v_mfma_f32_16x16x32_bf16 v[48:51], v[112:115], a[24:27], v[48:51]
    ds_read_b128 a[84:87], v7 offset:336
    s_waitcnt lgkmcnt(8)
    v_mfma_f32_16x16x32_bf16 v[64:67], v[116:119], a[24:27], v[64:67]
    buffer_load_dwordx4 v[192:195], v4, s[28:31], s36 offen offset:2032
    s_waitcnt lgkmcnt(7)
    v_mfma_f32_16x16x32_bf16 v[52:55], v[112:115], a[88:91], v[52:55]
    ds_read_b128 a[148:151], v7 offset:592
    v_mfma_f32_16x16x32_bf16 v[68:71], v[116:119], a[88:91], v[68:71]
    buffer_load_dwordx4 v[196:199], v4, s[28:31], s36 offen offset:2048
    s_waitcnt lgkmcnt(7)
    v_mfma_f32_16x16x32_bf16 v[56:59], v[112:115], a[152:155], v[56:59]
    ds_read_b128 a[212:215], v7 offset:848
    v_mfma_f32_16x16x32_bf16 v[72:75], v[116:119], a[152:155], v[72:75]
    ds_read_b128 a[16:19], v7 offset:64
    s_waitcnt lgkmcnt(7)
    v_mfma_f32_16x16x32_bf16 v[60:63], v[112:115], a[216:219], v[60:63]
    ds_read_b128 v[128:131], v6 offset:704
    v_mfma_f32_16x16x32_bf16 v[76:79], v[116:119], a[216:219], v[76:79]
    ds_read_b128 v[132:135], v6 offset:736
    s_waitcnt lgkmcnt(7)
    v_mfma_f32_16x16x32_bf16 v[48:51], v[120:123], a[20:23], v[48:51]
    ds_read_b128 a[80:83], v7 offset:320
    s_waitcnt lgkmcnt(7)
    v_mfma_f32_16x16x32_bf16 v[64:67], v[124:127], a[20:23], v[64:67]
    s_waitcnt vmcnt(10)
    s_waitcnt lgkmcnt(6)
    v_mfma_f32_16x16x32_bf16 v[52:55], v[120:123], a[84:87], v[52:55]
    ds_read_b128 a[144:147], v7 offset:576
    v_mfma_f32_16x16x32_bf16 v[68:71], v[124:127], a[84:87], v[68:71]
    ds_write_b128 v5, v[204:207] offset:3072
    s_waitcnt lgkmcnt(7)
    v_mfma_f32_16x16x32_bf16 v[56:59], v[120:123], a[148:151], v[56:59]
    ds_read_b128 a[208:211], v7 offset:832
    v_mfma_f32_16x16x32_bf16 v[72:75], v[124:127], a[148:151], v[72:75]
    ds_read_b128 a[12:15], v7 offset:48
    s_waitcnt lgkmcnt(8)
    v_mfma_f32_16x16x32_bf16 v[60:63], v[120:123], a[212:215], v[60:63]
    ds_read_b128 v[136:139], v6 offset:768
    v_mfma_f32_16x16x32_bf16 v[76:79], v[124:127], a[212:215], v[76:79]
    ds_read_b128 v[140:143], v6 offset:800
    s_waitcnt lgkmcnt(8)
    v_mfma_f32_16x16x32_bf16 v[48:51], v[128:131], a[16:19], v[48:51]
    ds_read_b128 a[76:79], v7 offset:304
    s_waitcnt lgkmcnt(8)
    v_mfma_f32_16x16x32_bf16 v[64:67], v[132:135], a[16:19], v[64:67]
    ds_write_b128 v5, v[202:205] offset:19712
    s_waitcnt lgkmcnt(8)
    v_mfma_f32_16x16x32_bf16 v[52:55], v[128:131], a[80:83], v[52:55]
    ds_read_b128 a[140:143], v7 offset:560
    v_mfma_f32_16x16x32_bf16 v[68:71], v[132:135], a[80:83], v[68:71]
    v_mov_b32 v208, v201
    v_mov_b32 v209, v202
    s_waitcnt lgkmcnt(8)
    v_mfma_f32_16x16x32_bf16 v[56:59], v[128:131], a[144:147], v[56:59]
    ds_read_b128 a[204:207], v7 offset:816
    v_mfma_f32_16x16x32_bf16 v[72:75], v[132:135], a[144:147], v[72:75]
    ds_read_b128 a[8:11], v7 offset:32
    s_waitcnt lgkmcnt(8)
    v_mfma_f32_16x16x32_bf16 v[60:63], v[128:131], a[208:211], v[60:63]
    ds_read_b128 v[144:147], v6 offset:832
    v_mfma_f32_16x16x32_bf16 v[76:79], v[132:135], a[208:211], v[76:79]
    ds_read_b128 v[148:151], v6 offset:864
    s_waitcnt lgkmcnt(8)
    v_mfma_f32_16x16x32_bf16 v[48:51], v[136:139], a[12:15], v[48:51]
    ds_read_b128 a[72:75], v7 offset:288
    s_waitcnt lgkmcnt(8)
    v_mfma_f32_16x16x32_bf16 v[64:67], v[140:143], a[12:15], v[64:67]
    v_mov_b32 v210, v203
    v_mov_b32 v211, v204
    s_waitcnt lgkmcnt(7)
    v_mfma_f32_16x16x32_bf16 v[52:55], v[136:139], a[76:79], v[52:55]
    ds_read_b128 a[136:139], v7 offset:544
    v_mfma_f32_16x16x32_bf16 v[68:71], v[140:143], a[76:79], v[68:71]
    ds_write_b128 v5, v[208:211] offset:28032
    s_waitcnt lgkmcnt(7)
    v_mfma_f32_16x16x32_bf16 v[56:59], v[136:139], a[140:143], v[56:59]
    ds_read_b128 a[200:203], v7 offset:800
    v_mfma_f32_16x16x32_bf16 v[72:75], v[140:143], a[140:143], v[72:75]
    ds_read_b128 a[4:7], v7 offset:16
    s_waitcnt lgkmcnt(8)
    v_mfma_f32_16x16x32_bf16 v[60:63], v[136:139], a[204:207], v[60:63]
    ds_read_b128 v[152:155], v6 offset:896
    v_mfma_f32_16x16x32_bf16 v[76:79], v[140:143], a[204:207], v[76:79]
    ds_read_b128 v[156:159], v6 offset:928
    s_waitcnt lgkmcnt(8)
    v_mfma_f32_16x16x32_bf16 v[48:51], v[144:147], a[8:11], v[48:51]
    ds_read_b128 a[68:71], v7 offset:272
    s_waitcnt lgkmcnt(8)
    v_mfma_f32_16x16x32_bf16 v[64:67], v[148:151], a[8:11], v[64:67]
    v_mov_b32 v212, v205
    v_mov_b32 v213, v206
    s_waitcnt lgkmcnt(7)
    v_mfma_f32_16x16x32_bf16 v[52:55], v[144:147], a[72:75], v[52:55]
    ds_read_b128 a[132:135], v7 offset:528
    v_mfma_f32_16x16x32_bf16 v[68:71], v[148:151], a[72:75], v[68:71]
    ds_write_b128 v5, v[210:213] offset:11392
    s_waitcnt lgkmcnt(8)
    v_mfma_f32_16x16x32_bf16 v[56:59], v[144:147], a[136:139], v[56:59]
    ds_read_b128 a[196:199], v7 offset:784
    v_mfma_f32_16x16x32_bf16 v[72:75], v[148:151], a[136:139], v[72:75]
    ds_read_b128 a[0:3], v7 offset:0
    s_waitcnt lgkmcnt(8)
    v_mfma_f32_16x16x32_bf16 v[60:63], v[144:147], a[200:203], v[60:63]
    ds_read_b128 v[160:163], v6 offset:960
    v_mfma_f32_16x16x32_bf16 v[76:79], v[148:151], a[200:203], v[76:79]
    ds_read_b128 v[164:167], v6 offset:992
    s_waitcnt lgkmcnt(8)
    v_mfma_f32_16x16x32_bf16 v[48:51], v[152:155], a[4:7], v[48:51]
    ds_read_b128 a[64:67], v7 offset:256
    s_waitcnt lgkmcnt(8)
    v_mfma_f32_16x16x32_bf16 v[64:67], v[156:159], a[4:7], v[64:67]
    v_alignbit_b32 v214, v201, v200, 16
    v_alignbit_b32 v215, v202, v201, 16
    s_waitcnt lgkmcnt(7)
    v_mfma_f32_16x16x32_bf16 v[52:55], v[152:155], a[68:71], v[52:55]
    ds_read_b128 a[128:131], v7 offset:512
    v_mfma_f32_16x16x32_bf16 v[68:71], v[156:159], a[68:71], v[68:71]
    v_alignbit_b32 v216, v203, v202, 16
    v_alignbit_b32 v217, v204, v203, 16
    s_waitcnt lgkmcnt(7)
    v_mfma_f32_16x16x32_bf16 v[56:59], v[152:155], a[132:135], v[56:59]
    ds_read_b128 a[192:195], v7 offset:768
    v_mfma_f32_16x16x32_bf16 v[72:75], v[156:159], a[132:135], v[72:75]
    ds_write_b128 v5, v[214:217] offset:32192
    s_waitcnt lgkmcnt(7)
    v_mfma_f32_16x16x32_bf16 v[60:63], v[152:155], a[196:199], v[60:63]
    ds_read_b128 v[168:171], v6 offset:1024
    v_mfma_f32_16x16x32_bf16 v[76:79], v[156:159], a[196:199], v[76:79]
    ds_read_b128 v[172:175], v6 offset:1056
    s_waitcnt lgkmcnt(7)
    v_mfma_f32_16x16x32_bf16 v[48:51], v[160:163], a[0:3], v[48:51]
    v_alignbit_b32 v218, v205, v204, 16
    v_alignbit_b32 v219, v206, v205, 16
    s_waitcnt lgkmcnt(6)
    v_mfma_f32_16x16x32_bf16 v[64:67], v[164:167], a[0:3], v[64:67]
    ds_write_b128 v5, v[216:219] offset:15552
    s_waitcnt lgkmcnt(6)
    v_mfma_f32_16x16x32_bf16 v[52:55], v[160:163], a[64:67], v[52:55]
    v_alignbit_b32 v220, v202, v201, 16
    v_alignbit_b32 v221, v203, v202, 16
    v_mfma_f32_16x16x32_bf16 v[68:71], v[164:167], a[64:67], v[68:71]
    v_alignbit_b32 v222, v204, v203, 16
    v_alignbit_b32 v223, v205, v204, 16
    s_waitcnt lgkmcnt(5)
    v_mfma_f32_16x16x32_bf16 v[56:59], v[160:163], a[128:131], v[56:59]
    ds_read_b128 v[112:115], v6 offset:1088
    v_mfma_f32_16x16x32_bf16 v[72:75], v[164:167], a[128:131], v[72:75]
    ds_read_b128 v[116:119], v6 offset:1120
    s_waitcnt lgkmcnt(6)
    v_mfma_f32_16x16x32_bf16 v[60:63], v[160:163], a[192:195], v[60:63]
    ds_write_b128 v5, v[220:223] offset:23872
    v_mfma_f32_16x16x32_bf16 v[76:79], v[164:167], a[192:195], v[76:79]
    v_alignbit_b32 v224, v206, v205, 16
    v_alignbit_b32 v225, v207, v206, 16
    s_waitcnt lgkmcnt(5)
    v_mfma_f32_16x16x32_bf16 v[52:55], v[168:171], a[60:63], v[52:55]
    ds_write_b128 v5, v[222:225] offset:7232
    s_waitcnt lgkmcnt(5)
    v_mfma_f32_16x16x32_bf16 v[68:71], v[172:175], a[60:63], v[68:71]
    buffer_load_dwordx4 v[200:203], v4, s[28:31], s36 offen offset:3056
    v_mfma_f32_16x16x32_bf16 v[56:59], v[168:171], a[124:127], v[56:59]
    ds_read_b128 v[120:123], v6 offset:1152
    v_mfma_f32_16x16x32_bf16 v[72:75], v[172:175], a[124:127], v[72:75]
    ds_read_b128 v[124:127], v6 offset:1184
    v_mfma_f32_16x16x32_bf16 v[60:63], v[168:171], a[188:191], v[60:63]
    buffer_load_dwordx4 v[204:207], v4, s[28:31], s36 offen offset:3072
    v_mfma_f32_16x16x32_bf16 v[76:79], v[172:175], a[188:191], v[76:79]
    s_waitcnt vmcnt(10)
    s_mov_b64 exec, 1
    v_mov_b32 v176, 0
    v_mov_b32 v177, 0
    v_mov_b32 v178, 0
    v_mov_b32 v179, 0
    s_mov_b64 exec, -1
    s_waitcnt lgkmcnt(5)
    v_mfma_f32_16x16x32_bf16 v[52:55], v[112:115], a[56:59], v[52:55]
    ds_write_b128 v5, v[180:183] offset:0
    s_waitcnt lgkmcnt(5)
    v_mfma_f32_16x16x32_bf16 v[68:71], v[116:119], a[56:59], v[68:71]
    ds_write_b128 v5, v[178:181] offset:16640
    v_mfma_f32_16x16x32_bf16 v[56:59], v[112:115], a[120:123], v[56:59]
    ds_read_b128 v[128:131], v6 offset:1216
    v_mfma_f32_16x16x32_bf16 v[72:75], v[116:119], a[120:123], v[72:75]
    ds_read_b128 v[132:135], v6 offset:1248
    v_mfma_f32_16x16x32_bf16 v[60:63], v[112:115], a[184:187], v[60:63]
    v_mov_b32 v208, v177
    v_mov_b32 v209, v178
    v_mfma_f32_16x16x32_bf16 v[76:79], v[116:119], a[184:187], v[76:79]
    v_mov_b32 v210, v179
    v_mov_b32 v211, v180
    s_waitcnt lgkmcnt(5)
    v_mfma_f32_16x16x32_bf16 v[52:55], v[120:123], a[52:55], v[52:55]
    ds_write_b128 v5, v[208:211] offset:24960
    s_waitcnt lgkmcnt(5)
    v_mfma_f32_16x16x32_bf16 v[68:71], v[124:127], a[52:55], v[68:71]
    v_mov_b32 v212, v181
    v_mov_b32 v213, v182
    v_mfma_f32_16x16x32_bf16 v[56:59], v[120:123], a[116:119], v[56:59]
    ds_read_b128 v[136:139], v6 offset:1280
    v_mfma_f32_16x16x32_bf16 v[72:75], v[124:127], a[116:119], v[72:75]
    ds_read_b128 v[140:143], v6 offset:1312
    v_mfma_f32_16x16x32_bf16 v[60:63], v[120:123], a[180:183], v[60:63]
    ds_write_b128 v5, v[210:213] offset:8320
    v_mfma_f32_16x16x32_bf16 v[76:79], v[124:127], a[180:183], v[76:79]
    v_alignbit_b32 v214, v177, v176, 16
    v_alignbit_b32 v215, v178, v177, 16
    s_waitcnt lgkmcnt(5)
    v_mfma_f32_16x16x32_bf16 v[52:55], v[128:131], a[48:51], v[52:55]
    v_alignbit_b32 v216, v179, v178, 16
    v_alignbit_b32 v217, v180, v179, 16
    s_waitcnt lgkmcnt(4)
    v_mfma_f32_16x16x32_bf16 v[68:71], v[132:135], a[48:51], v[68:71]
    ds_write_b128 v5, v[214:217] offset:29120
    v_mfma_f32_16x16x32_bf16 v[56:59], v[128:131], a[112:115], v[56:59]
    ds_read_b128 v[144:147], v6 offset:1344
    v_mfma_f32_16x16x32_bf16 v[72:75], v[132:135], a[112:115], v[72:75]
    ds_read_b128 v[148:151], v6 offset:1376
    v_mfma_f32_16x16x32_bf16 v[60:63], v[128:131], a[176:179], v[60:63]
    v_alignbit_b32 v218, v181, v180, 16
    v_alignbit_b32 v219, v182, v181, 16
    v_mfma_f32_16x16x32_bf16 v[76:79], v[132:135], a[176:179], v[76:79]
    ds_write_b128 v5, v[216:219] offset:12480
    s_waitcnt lgkmcnt(6)
    v_mfma_f32_16x16x32_bf16 v[52:55], v[136:139], a[44:47], v[52:55]
    v_alignbit_b32 v220, v178, v177, 16
    v_alignbit_b32 v221, v179, v178, 16
    s_waitcnt lgkmcnt(5)
    v_mfma_f32_16x16x32_bf16 v[68:71], v[140:143], a[44:47], v[68:71]
    v_alignbit_b32 v222, v180, v179, 16
    v_alignbit_b32 v223, v181, v180, 16
    v_mfma_f32_16x16x32_bf16 v[56:59], v[136:139], a[108:111], v[56:59]
    ds_read_b128 v[152:155], v6 offset:1408
    v_mfma_f32_16x16x32_bf16 v[72:75], v[140:143], a[108:111], v[72:75]
    ds_read_b128 v[156:159], v6 offset:1440
    v_mfma_f32_16x16x32_bf16 v[60:63], v[136:139], a[172:175], v[60:63]
    ds_write_b128 v5, v[220:223] offset:20800
    v_mfma_f32_16x16x32_bf16 v[76:79], v[140:143], a[172:175], v[76:79]
    v_alignbit_b32 v224, v182, v181, 16
    v_alignbit_b32 v225, v183, v182, 16
    s_waitcnt lgkmcnt(5)
    v_mfma_f32_16x16x32_bf16 v[52:55], v[144:147], a[40:43], v[52:55]
    ds_write_b128 v5, v[222:225] offset:4160
    s_waitcnt lgkmcnt(5)
    v_mfma_f32_16x16x32_bf16 v[68:71], v[148:151], a[40:43], v[68:71]
    buffer_load_dwordx4 v[176:179], v230, s[28:31], s37 offen offset:0
    v_mfma_f32_16x16x32_bf16 v[56:59], v[144:147], a[104:107], v[56:59]
    ds_read_b128 v[160:163], v6 offset:1472
    v_mfma_f32_16x16x32_bf16 v[72:75], v[148:151], a[104:107], v[72:75]
    ds_read_b128 v[164:167], v6 offset:1504
    v_mfma_f32_16x16x32_bf16 v[60:63], v[144:147], a[168:171], v[60:63]
    buffer_load_dwordx4 v[180:183], v4, s[28:31], s37 offen offset:0
    v_mfma_f32_16x16x32_bf16 v[76:79], v[148:151], a[168:171], v[76:79]
    s_add_u32 m0, s35, 0
    s_waitcnt lgkmcnt(5)
    v_mfma_f32_16x16x32_bf16 v[52:55], v[152:155], a[36:39], v[52:55]
    buffer_load_dwordx4 v4, s[8:11], s39 offen offset:0 lds
    s_waitcnt lgkmcnt(4)
    v_mfma_f32_16x16x32_bf16 v[68:71], v[156:159], a[36:39], v[68:71]
    s_add_u32 m0, s35, 256
    v_mfma_f32_16x16x32_bf16 v[56:59], v[152:155], a[100:103], v[56:59]
    ds_read_b128 v[168:171], v6 offset:1536
    v_mfma_f32_16x16x32_bf16 v[72:75], v[156:159], a[100:103], v[72:75]
    ds_read_b128 v[172:175], v6 offset:1568
    v_mfma_f32_16x16x32_bf16 v[60:63], v[152:155], a[164:167], v[60:63]
    buffer_load_dwordx4 v4, s[8:11], s39 offen offset:1024 lds
    v_mfma_f32_16x16x32_bf16 v[76:79], v[156:159], a[164:167], v[76:79]
    s_add_u32 m0, s35, 512
    s_waitcnt lgkmcnt(3)
    v_mfma_f32_16x16x32_bf16 v[52:55], v[160:163], a[32:35], v[52:55]
    buffer_load_dwordx4 v4, s[8:11], s39 offen offset:2048 lds
    s_waitcnt lgkmcnt(2)
    v_mfma_f32_16x16x32_bf16 v[68:71], v[164:167], a[32:35], v[68:71]
    s_add_u32 m0, s35, 768
    v_mfma_f32_16x16x32_bf16 v[56:59], v[160:163], a[96:99], v[56:59]
    ds_read_b128 v[112:115], v6 offset:1600
    v_mfma_f32_16x16x32_bf16 v[72:75], v[164:167], a[96:99], v[72:75]
    ds_read_b128 v[116:119], v6 offset:1632
    v_mfma_f32_16x16x32_bf16 v[60:63], v[160:163], a[160:163], v[60:63]
    buffer_load_dwordx4 v4, s[8:11], s39 offen offset:3072 lds
    v_mfma_f32_16x16x32_bf16 v[76:79], v[164:167], a[160:163], v[76:79]
    s_waitcnt lgkmcnt(3)
    v_mfma_f32_16x16x32_bf16 v[52:55], v[168:171], a[28:31], v[52:55]
    s_waitcnt lgkmcnt(2)
    v_mfma_f32_16x16x32_bf16 v[68:71], v[172:175], a[28:31], v[68:71]
    v_mfma_f32_16x16x32_bf16 v[56:59], v[168:171], a[92:95], v[56:59]
    ds_read_b128 v[120:123], v6 offset:1664
    v_mfma_f32_16x16x32_bf16 v[72:75], v[172:175], a[92:95], v[72:75]
    ds_read_b128 v[124:127], v6 offset:1696
    v_mfma_f32_16x16x32_bf16 v[60:63], v[168:171], a[156:159], v[60:63]
    v_mfma_f32_16x16x32_bf16 v[76:79], v[172:175], a[156:159], v[76:79]
    s_waitcnt lgkmcnt(3)
    v_mfma_f32_16x16x32_bf16 v[52:55], v[112:115], a[24:27], v[52:55]
    s_waitcnt lgkmcnt(2)
    v_mfma_f32_16x16x32_bf16 v[68:71], v[116:119], a[24:27], v[68:71]
    v_mfma_f32_16x16x32_bf16 v[56:59], v[112:115], a[88:91], v[56:59]
    ds_read_b128 v[128:131], v6 offset:1728
    v_mfma_f32_16x16x32_bf16 v[72:75], v[116:119], a[88:91], v[72:75]
    ds_read_b128 v[132:135], v6 offset:1760
    v_mfma_f32_16x16x32_bf16 v[60:63], v[112:115], a[152:155], v[60:63]
    v_mfma_f32_16x16x32_bf16 v[76:79], v[116:119], a[152:155], v[76:79]
    s_waitcnt lgkmcnt(3)
    v_mfma_f32_16x16x32_bf16 v[52:55], v[120:123], a[20:23], v[52:55]
    s_waitcnt lgkmcnt(2)
    v_mfma_f32_16x16x32_bf16 v[68:71], v[124:127], a[20:23], v[68:71]
    v_mfma_f32_16x16x32_bf16 v[56:59], v[120:123], a[84:87], v[56:59]
    ds_read_b128 v[136:139], v6 offset:1792
    v_mfma_f32_16x16x32_bf16 v[72:75], v[124:127], a[84:87], v[72:75]
    ds_read_b128 v[140:143], v6 offset:1824
    v_mfma_f32_16x16x32_bf16 v[60:63], v[120:123], a[148:151], v[60:63]
    v_mfma_f32_16x16x32_bf16 v[76:79], v[124:127], a[148:151], v[76:79]
    s_waitcnt lgkmcnt(3)
    v_mfma_f32_16x16x32_bf16 v[52:55], v[128:131], a[16:19], v[52:55]
    s_waitcnt lgkmcnt(2)
    v_mfma_f32_16x16x32_bf16 v[68:71], v[132:135], a[16:19], v[68:71]
    v_mfma_f32_16x16x32_bf16 v[56:59], v[128:131], a[80:83], v[56:59]
    ds_read_b128 v[144:147], v6 offset:1856
    v_mfma_f32_16x16x32_bf16 v[72:75], v[132:135], a[80:83], v[72:75]
    ds_read_b128 v[148:151], v6 offset:1888
    v_mfma_f32_16x16x32_bf16 v[60:63], v[128:131], a[144:147], v[60:63]
    v_mfma_f32_16x16x32_bf16 v[76:79], v[132:135], a[144:147], v[76:79]
    s_waitcnt lgkmcnt(3)
    v_mfma_f32_16x16x32_bf16 v[52:55], v[136:139], a[12:15], v[52:55]
    s_waitcnt lgkmcnt(2)
    v_mfma_f32_16x16x32_bf16 v[68:71], v[140:143], a[12:15], v[68:71]
    v_mfma_f32_16x16x32_bf16 v[56:59], v[136:139], a[76:79], v[56:59]
    ds_read_b128 v[152:155], v6 offset:1920
    v_mfma_f32_16x16x32_bf16 v[72:75], v[140:143], a[76:79], v[72:75]
    ds_read_b128 v[156:159], v6 offset:1952
    v_mfma_f32_16x16x32_bf16 v[60:63], v[136:139], a[140:143], v[60:63]
    v_mfma_f32_16x16x32_bf16 v[76:79], v[140:143], a[140:143], v[76:79]
    s_waitcnt lgkmcnt(3)
    v_mfma_f32_16x16x32_bf16 v[52:55], v[144:147], a[8:11], v[52:55]
    s_waitcnt lgkmcnt(2)
    v_mfma_f32_16x16x32_bf16 v[68:71], v[148:151], a[8:11], v[68:71]
    v_mfma_f32_16x16x32_bf16 v[56:59], v[144:147], a[72:75], v[56:59]
    ds_read_b128 v[160:163], v6 offset:1984
    v_mfma_f32_16x16x32_bf16 v[72:75], v[148:151], a[72:75], v[72:75]
    ds_read_b128 v[164:167], v6 offset:2016
    v_mfma_f32_16x16x32_bf16 v[60:63], v[144:147], a[136:139], v[60:63]
    v_mfma_f32_16x16x32_bf16 v[76:79], v[148:151], a[136:139], v[76:79]
    s_waitcnt lgkmcnt(3)
    v_mfma_f32_16x16x32_bf16 v[52:55], v[152:155], a[4:7], v[52:55]
    s_waitcnt lgkmcnt(2)
    v_mfma_f32_16x16x32_bf16 v[68:71], v[156:159], a[4:7], v[68:71]
    v_mfma_f32_16x16x32_bf16 v[56:59], v[152:155], a[68:71], v[56:59]
    ds_read_b128 v[168:171], v6 offset:2048
    v_mfma_f32_16x16x32_bf16 v[72:75], v[156:159], a[68:71], v[72:75]
    ds_read_b128 v[172:175], v6 offset:2080
    v_mfma_f32_16x16x32_bf16 v[60:63], v[152:155], a[132:135], v[60:63]
    s_waitcnt vmcnt(10)
    v_mfma_f32_16x16x32_bf16 v[76:79], v[156:159], a[132:135], v[76:79]
    ds_write_b128 v5, v[188:191] offset:1024
    s_waitcnt lgkmcnt(4)
    v_mfma_f32_16x16x32_bf16 v[52:55], v[160:163], a[0:3], v[52:55]
    ds_read_b128 v[112:115], v6 offset:2112
    s_waitcnt lgkmcnt(4)
    v_mfma_f32_16x16x32_bf16 v[68:71], v[164:167], a[0:3], v[68:71]
    ds_read_b128 v[116:119], v6 offset:2144
    v_mfma_f32_16x16x32_bf16 v[56:59], v[160:163], a[64:67], v[56:59]
    ds_write_b128 v5, v[186:189] offset:17664
    v_mfma_f32_16x16x32_bf16 v[72:75], v[164:167], a[64:67], v[72:75]
    v_mov_b32 v208, v185
    v_mov_b32 v209, v186
    v_mfma_f32_16x16x32_bf16 v[60:63], v[160:163], a[128:131], v[60:63]
    ds_read_b128 v[120:123], v6 offset:2176
    v_mfma_f32_16x16x32_bf16 v[76:79], v[164:167], a[128:131], v[76:79]
    ds_read_b128 v[124:127], v6 offset:2208
    s_waitcnt lgkmcnt(7)
    v_mfma_f32_16x16x32_bf16 v[56:59], v[168:171], a[60:63], v[56:59]
    v_mov_b32 v210, v187
    v_mov_b32 v211, v188
    s_waitcnt lgkmcnt(6)
    v_mfma_f32_16x16x32_bf16 v[72:75], v[172:175], a[60:63], v[72:75]
    ds_write_b128 v5, v[208:211] offset:25984
    v_mfma_f32_16x16x32_bf16 v[60:63], v[168:171], a[124:127], v[60:63]
    ds_read_b128 v[128:131], v6 offset:2240
    v_mfma_f32_16x16x32_bf16 v[76:79], v[172:175], a[124:127], v[76:79]
    ds_read_b128 v[132:135], v6 offset:2272
    s_waitcnt lgkmcnt(7)
    v_mfma_f32_16x16x32_bf16 v[56:59], v[112:115], a[56:59], v[56:59]
    v_mov_b32 v212, v189
    v_mov_b32 v213, v190
    s_waitcnt lgkmcnt(6)
    v_mfma_f32_16x16x32_bf16 v[72:75], v[116:119], a[56:59], v[72:75]
    ds_write_b128 v5, v[210:213] offset:9344
    v_mfma_f32_16x16x32_bf16 v[60:63], v[112:115], a[120:123], v[60:63]
    ds_read_b128 v[136:139], v6 offset:2304
    v_mfma_f32_16x16x32_bf16 v[76:79], v[116:119], a[120:123], v[76:79]
    ds_read_b128 v[140:143], v6 offset:2336
    s_waitcnt lgkmcnt(7)
    v_mfma_f32_16x16x32_bf16 v[56:59], v[120:123], a[52:55], v[56:59]
    v_alignbit_b32 v214, v185, v184, 16
    v_alignbit_b32 v215, v186, v185, 16
    s_waitcnt lgkmcnt(6)
    v_mfma_f32_16x16x32_bf16 v[72:75], v[124:127], a[52:55], v[72:75]
    v_alignbit_b32 v216, v187, v186, 16
    v_alignbit_b32 v217, v188, v187, 16
    v_mfma_f32_16x16x32_bf16 v[60:63], v[120:123], a[116:119], v[60:63]
    ds_read_b128 v[144:147], v6 offset:2368
    v_mfma_f32_16x16x32_bf16 v[76:79], v[124:127], a[116:119], v[76:79]
    ds_read_b128 v[148:151], v6 offset:2400
    s_waitcnt lgkmcnt(6)
    v_mfma_f32_16x16x32_bf16 v[56:59], v[128:131], a[48:51], v[56:59]
    ds_write_b128 v5, v[214:217] offset:30144
    s_waitcnt lgkmcnt(6)
    v_mfma_f32_16x16x32_bf16 v[72:75], v[132:135], a[48:51], v[72:75]
    v_alignbit_b32 v218, v189, v188, 16
    v_alignbit_b32 v219, v190, v189, 16
    v_mfma_f32_16x16x32_bf16 v[60:63], v[128:131], a[112:115], v[60:63]
    ds_read_b128 v[152:155], v6 offset:2432
    v_mfma_f32_16x16x32_bf16 v[76:79], v[132:135], a[112:115], v[76:79]
    ds_read_b128 v[156:159], v6 offset:2464
    s_waitcnt lgkmcnt(6)
    v_mfma_f32_16x16x32_bf16 v[56:59], v[136:139], a[44:47], v[56:59]
    ds_write_b128 v5, v[216:219] offset:13504
    s_waitcnt lgkmcnt(6)
    v_mfma_f32_16x16x32_bf16 v[72:75], v[140:143], a[44:47], v[72:75]
    v_alignbit_b32 v220, v186, v185, 16
    v_alignbit_b32 v221, v187, v186, 16
    v_mfma_f32_16x16x32_bf16 v[60:63], v[136:139], a[108:111], v[60:63]
    ds_read_b128 v[160:163], v6 offset:2496
    v_mfma_f32_16x16x32_bf16 v[76:79], v[140:143], a[108:111], v[76:79]
    ds_read_b128 v[164:167], v6 offset:2528
    s_waitcnt lgkmcnt(7)
    v_mfma_f32_16x16x32_bf16 v[56:59], v[144:147], a[40:43], v[56:59]
    v_alignbit_b32 v222, v188, v187, 16
    v_alignbit_b32 v223, v189, v188, 16
    s_waitcnt lgkmcnt(6)
    v_mfma_f32_16x16x32_bf16 v[72:75], v[148:151], a[40:43], v[72:75]
    ds_write_b128 v5, v[220:223] offset:21824
    v_mfma_f32_16x16x32_bf16 v[60:63], v[144:147], a[104:107], v[60:63]
    ds_read_b128 v[168:171], v6 offset:2560
    v_mfma_f32_16x16x32_bf16 v[76:79], v[148:151], a[104:107], v[76:79]
    ds_read_b128 v[172:175], v6 offset:2592
    s_waitcnt lgkmcnt(7)
    v_mfma_f32_16x16x32_bf16 v[56:59], v[152:155], a[36:39], v[56:59]
    v_alignbit_b32 v224, v190, v189, 16
    v_alignbit_b32 v225, v191, v190, 16
    s_waitcnt lgkmcnt(6)
    v_mfma_f32_16x16x32_bf16 v[72:75], v[156:159], a[36:39], v[72:75]
    ds_write_b128 v5, v[222:225] offset:5184
    v_mfma_f32_16x16x32_bf16 v[60:63], v[152:155], a[100:103], v[60:63]
    ds_read_b128 v[112:115], v6 offset:2624
    v_mfma_f32_16x16x32_bf16 v[76:79], v[156:159], a[100:103], v[76:79]
    ds_read_b128 v[116:119], v6 offset:2656
    s_waitcnt lgkmcnt(7)
    v_mfma_f32_16x16x32_bf16 v[56:59], v[160:163], a[32:35], v[56:59]
    buffer_load_dwordx4 v[184:187], v4, s[28:31], s37 offen offset:1008
    s_waitcnt lgkmcnt(6)
    v_mfma_f32_16x16x32_bf16 v[72:75], v[164:167], a[32:35], v[72:75]
    buffer_load_dwordx4 v[188:191], v4, s[28:31], s37 offen offset:1024
    v_mfma_f32_16x16x32_bf16 v[60:63], v[160:163], a[96:99], v[60:63]
    ds_read_b128 v[120:123], v6 offset:2688
    v_mfma_f32_16x16x32_bf16 v[76:79], v[164:167], a[96:99], v[76:79]
    ds_read_b128 v[124:127], v6 offset:2720
    s_waitcnt lgkmcnt(6)
    v_mfma_f32_16x16x32_bf16 v[56:59], v[168:171], a[28:31], v[56:59]
    s_mov_b32 s36, s37
    s_add_u32 s39, s37, 125829120
    s_add_u32 s37, s37, 4096
    s_min_u32 s37, s37, s33

    s_pack_ll_b32_b16 s40, s65, s65
    s_mov_b32 s64, s65
    s_mov_b32 s65, s66
    s_mov_b32 s66, s67
    v_and_b32 v236, s40, v8
    s_waitcnt lgkmcnt(5)
    v_mfma_f32_16x16x32_bf16 v[72:75], v[172:175], a[28:31], v[72:75]
    v_and_b32 v237, s40, v9
    v_and_b32 v238, s40, v10
    v_mfma_f32_16x16x32_bf16 v[60:63], v[168:171], a[92:95], v[60:63]
    ds_read_b128 v[128:131], v6 offset:2752
    v_mfma_f32_16x16x32_bf16 v[76:79], v[172:175], a[92:95], v[76:79]
    ds_read_b128 v[132:135], v6 offset:2784
    s_waitcnt lgkmcnt(5)
    v_mfma_f32_16x16x32_bf16 v[56:59], v[112:115], a[24:27], v[56:59]
    v_and_b32 v239, s40, v11
    v_and_b32 v240, s40, v12
    s_waitcnt lgkmcnt(4)
    v_mfma_f32_16x16x32_bf16 v[72:75], v[116:119], a[24:27], v[72:75]
    v_and_b32 v241, s40, v13
    v_and_b32 v242, s40, v14
    v_mfma_f32_16x16x32_bf16 v[60:63], v[112:115], a[88:91], v[60:63]
    ds_read_b128 v[136:139], v6 offset:2816
    v_mfma_f32_16x16x32_bf16 v[76:79], v[116:119], a[88:91], v[76:79]
    ds_read_b128 v[140:143], v6 offset:2848
    s_waitcnt lgkmcnt(5)
    v_mfma_f32_16x16x32_bf16 v[56:59], v[120:123], a[20:23], v[56:59]
    v_and_b32 v243, s40, v15
    s_waitcnt lgkmcnt(4)
    v_mfma_f32_16x16x32_bf16 v[72:75], v[124:127], a[20:23], v[72:75]
    v_mfma_f32_16x16x32_bf16 v[60:63], v[120:123], a[84:87], v[60:63]
    ds_read_b128 v[144:147], v6 offset:2880
    v_mfma_f32_16x16x32_bf16 v[76:79], v[124:127], a[84:87], v[76:79]
    ds_read_b128 v[148:151], v6 offset:2912
    s_waitcnt lgkmcnt(5)
    v_mfma_f32_16x16x32_bf16 v[56:59], v[128:131], a[16:19], v[56:59]
    s_waitcnt lgkmcnt(4)
    v_mfma_f32_16x16x32_bf16 v[72:75], v[132:135], a[16:19], v[72:75]
    v_mfma_f32_16x16x32_bf16 v[60:63], v[128:131], a[80:83], v[60:63]
    ds_read_b128 v[152:155], v6 offset:2944
    v_mfma_f32_16x16x32_bf16 v[76:79], v[132:135], a[80:83], v[76:79]
    ds_read_b128 v[156:159], v6 offset:2976
    s_waitcnt lgkmcnt(5)
    v_mfma_f32_16x16x32_bf16 v[56:59], v[136:139], a[12:15], v[56:59]
    s_waitcnt lgkmcnt(4)
    v_mfma_f32_16x16x32_bf16 v[72:75], v[140:143], a[12:15], v[72:75]
    v_mfma_f32_16x16x32_bf16 v[60:63], v[136:139], a[76:79], v[60:63]
    ds_read_b128 v[160:163], v6 offset:3008
    v_mfma_f32_16x16x32_bf16 v[76:79], v[140:143], a[76:79], v[76:79]
    ds_read_b128 v[164:167], v6 offset:3040
    s_waitcnt lgkmcnt(5)
    v_mfma_f32_16x16x32_bf16 v[56:59], v[144:147], a[8:11], v[56:59]
    s_waitcnt lgkmcnt(4)
    v_mfma_f32_16x16x32_bf16 v[72:75], v[148:151], a[8:11], v[72:75]
    v_mfma_f32_16x16x32_bf16 v[60:63], v[144:147], a[72:75], v[60:63]
    ds_read_b128 v[168:171], v6 offset:3072
    v_mfma_f32_16x16x32_bf16 v[76:79], v[148:151], a[72:75], v[76:79]
    ds_read_b128 v[172:175], v6 offset:3104
    s_waitcnt lgkmcnt(5)
    v_mfma_f32_16x16x32_bf16 v[56:59], v[152:155], a[4:7], v[56:59]
    ds_read_b128 v[112:115], v6 offset:3136
    s_waitcnt lgkmcnt(5)
    v_mfma_f32_16x16x32_bf16 v[72:75], v[156:159], a[4:7], v[72:75]
    ds_read_b128 v[116:119], v6 offset:3168
    v_mfma_f32_16x16x32_bf16 v[60:63], v[152:155], a[68:71], v[60:63]
    ds_read_b128 v[120:123], v6 offset:3200
    v_mfma_f32_16x16x32_bf16 v[76:79], v[156:159], a[68:71], v[76:79]
    ds_read_b128 v[124:127], v6 offset:3232
    s_waitcnt lgkmcnt(7)
    v_mfma_f32_16x16x32_bf16 v[56:59], v[160:163], a[0:3], v[56:59]
    ds_read_b128 v[128:131], v6 offset:3264
    s_waitcnt lgkmcnt(7)
    v_mfma_f32_16x16x32_bf16 v[72:75], v[164:167], a[0:3], v[72:75]
    ds_read_b128 v[132:135], v6 offset:3296
    v_mfma_f32_16x16x32_bf16 v[60:63], v[160:163], a[64:67], v[60:63]
    ds_read_b128 v[136:139], v6 offset:3328
    v_mfma_f32_16x16x32_bf16 v[76:79], v[164:167], a[64:67], v[76:79]
    ds_read_b128 v[140:143], v6 offset:3360
    s_waitcnt lgkmcnt(9)
    v_mfma_f32_16x16x32_bf16 v[60:63], v[168:171], a[60:63], v[60:63]
    ds_read_b128 v[144:147], v6 offset:3392
    s_waitcnt lgkmcnt(9)
    v_mfma_f32_16x16x32_bf16 v[76:79], v[172:175], a[60:63], v[76:79]
    ds_read_b128 v[148:151], v6 offset:3424
    s_waitcnt lgkmcnt(9)
    v_mfma_f32_16x16x32_bf16 v[60:63], v[112:115], a[56:59], v[60:63]
    ds_read_b128 v[152:155], v6 offset:3456
    s_waitcnt lgkmcnt(9)
    v_mfma_f32_16x16x32_bf16 v[76:79], v[116:119], a[56:59], v[76:79]
    ds_read_b128 v[156:159], v6 offset:3488
    s_waitcnt lgkmcnt(9)
    v_mfma_f32_16x16x32_bf16 v[60:63], v[120:123], a[52:55], v[60:63]
    ds_read_b128 v[160:163], v6 offset:3520
    s_waitcnt lgkmcnt(9)
    v_mfma_f32_16x16x32_bf16 v[76:79], v[124:127], a[52:55], v[76:79]
    ds_read_b128 v[164:167], v6 offset:3552
    s_waitcnt lgkmcnt(9)
    v_mfma_f32_16x16x32_bf16 v[60:63], v[128:131], a[48:51], v[60:63]
    ds_read_b128 v[168:171], v6 offset:3584
    s_waitcnt lgkmcnt(9)
    v_mfma_f32_16x16x32_bf16 v[76:79], v[132:135], a[48:51], v[76:79]
    ds_read_b128 v[172:175], v6 offset:3616
    s_waitcnt lgkmcnt(9)
    v_mfma_f32_16x16x32_bf16 v[60:63], v[136:139], a[44:47], v[60:63]
    ds_read_b128 v[112:115], v6 offset:3648
    s_waitcnt lgkmcnt(9)
    v_mfma_f32_16x16x32_bf16 v[76:79], v[140:143], a[44:47], v[76:79]
    ds_read_b128 v[116:119], v6 offset:3680
    s_waitcnt lgkmcnt(9)
    v_mfma_f32_16x16x32_bf16 v[60:63], v[144:147], a[40:43], v[60:63]
    ds_read_b128 v[120:123], v6 offset:3712
    s_waitcnt lgkmcnt(9)
    v_mfma_f32_16x16x32_bf16 v[76:79], v[148:151], a[40:43], v[76:79]
    ds_read_b128 v[124:127], v6 offset:3744
    s_waitcnt lgkmcnt(9)
    v_mfma_f32_16x16x32_bf16 v[60:63], v[152:155], a[36:39], v[60:63]
    ds_read_b128 v[128:131], v6 offset:3776
    s_waitcnt lgkmcnt(9)
    v_mfma_f32_16x16x32_bf16 v[76:79], v[156:159], a[36:39], v[76:79]
    ds_read_b128 v[132:135], v6 offset:3808
    s_waitcnt lgkmcnt(9)
    v_mfma_f32_16x16x32_bf16 v[60:63], v[160:163], a[32:35], v[60:63]
    ds_read_b128 v[136:139], v6 offset:3840
    s_waitcnt lgkmcnt(9)
    v_mfma_f32_16x16x32_bf16 v[76:79], v[164:167], a[32:35], v[76:79]
    ds_read_b128 v[140:143], v6 offset:3872
    s_waitcnt lgkmcnt(9)
    v_mfma_f32_16x16x32_bf16 v[60:63], v[168:171], a[28:31], v[60:63]
    ds_read_b128 v[144:147], v6 offset:3904
    s_waitcnt lgkmcnt(9)
    v_mfma_f32_16x16x32_bf16 v[76:79], v[172:175], a[28:31], v[76:79]
    ds_read_b128 v[148:151], v6 offset:3936
    s_waitcnt lgkmcnt(9)
    v_mfma_f32_16x16x32_bf16 v[60:63], v[112:115], a[24:27], v[60:63]
    ds_read_b128 v[152:155], v6 offset:3968
    s_waitcnt lgkmcnt(9)
    v_mfma_f32_16x16x32_bf16 v[76:79], v[116:119], a[24:27], v[76:79]
    ds_read_b128 v[156:159], v6 offset:4000
    s_waitcnt lgkmcnt(9)
    v_mfma_f32_16x16x32_bf16 v[60:63], v[120:123], a[20:23], v[60:63]
    ds_read_b128 v[160:163], v6 offset:4032
    s_waitcnt lgkmcnt(9)
    v_mfma_f32_16x16x32_bf16 v[76:79], v[124:127], a[20:23], v[76:79]
    ds_read_b128 v[164:167], v6 offset:4064
    s_waitcnt lgkmcnt(9)
    v_mfma_f32_16x16x32_bf16 v[60:63], v[128:131], a[16:19], v[60:63]
    s_waitcnt vmcnt(2)
    ds_read_b128 a[60:63], v7 offset:240
    s_waitcnt lgkmcnt(9)
    v_mfma_f32_16x16x32_bf16 v[76:79], v[132:135], a[16:19], v[76:79]
    s_waitcnt lgkmcnt(8)
    v_mfma_f32_16x16x32_bf16 v[60:63], v[136:139], a[12:15], v[60:63]
    ds_read_b128 a[124:127], v7 offset:496
    s_waitcnt lgkmcnt(8)
    v_mfma_f32_16x16x32_bf16 v[76:79], v[140:143], a[12:15], v[76:79]
    s_waitcnt lgkmcnt(7)
    v_mfma_f32_16x16x32_bf16 v[60:63], v[144:147], a[8:11], v[60:63]
    ds_read_b128 a[188:191], v7 offset:752
    s_waitcnt lgkmcnt(7)
    v_mfma_f32_16x16x32_bf16 v[76:79], v[148:151], a[8:11], v[76:79]
    s_waitcnt lgkmcnt(6)
    v_mfma_f32_16x16x32_bf16 v[60:63], v[152:155], a[4:7], v[60:63]
    ds_read_b128 a[252:255], v7 offset:1008
    s_waitcnt lgkmcnt(6)
    v_mfma_f32_16x16x32_bf16 v[76:79], v[156:159], a[4:7], v[76:79]
    s_waitcnt lgkmcnt(5)
    v_mfma_f32_16x16x32_bf16 v[60:63], v[160:163], a[0:3], v[60:63]
    ds_read_b128 v[168:171], v6 offset:0
    s_waitcnt lgkmcnt(5)
    v_mfma_f32_16x16x32_bf16 v[76:79], v[164:167], a[0:3], v[76:79]
    ds_read_b128 v[172:175], v6 offset:32
    s_add_u32 s41, s38, 4096
    v_cvt_pk_bf16_f32 v80, v16, v48
    v_cvt_pk_bf16_f32 v81, v17, v49
    v_cvt_pk_bf16_f32 v82, v18, v50
    v_cvt_pk_bf16_f32 v83, v19, v51
    buffer_store_dwordx4 v[80:83], v228, s[8:11], s38 offen offset:0 sc1
    v_cvt_pk_bf16_f32 v84, v32, v64
    v_cvt_pk_bf16_f32 v85, v33, v65
    v_cvt_pk_bf16_f32 v86, v34, v66
    v_cvt_pk_bf16_f32 v87, v35, v67
    buffer_store_dwordx4 v[84:87], v228, s[8:11], s38 offen offset:64 sc1
    v_cvt_pk_bf16_f32 v88, v20, v52
    v_cvt_pk_bf16_f32 v89, v21, v53
    v_cvt_pk_bf16_f32 v90, v22, v54
    v_cvt_pk_bf16_f32 v91, v23, v55
    buffer_store_dwordx4 v[88:91], v228, s[8:11], s38 offen offset:2048 sc1
    v_cvt_pk_bf16_f32 v92, v36, v68
    v_cvt_pk_bf16_f32 v93, v37, v69
    v_cvt_pk_bf16_f32 v94, v38, v70
    v_cvt_pk_bf16_f32 v95, v39, v71
    buffer_store_dwordx4 v[92:95], v228, s[8:11], s38 offen offset:2112 sc1
    v_cvt_pk_bf16_f32 v96, v24, v56
    v_cvt_pk_bf16_f32 v97, v25, v57
    v_cvt_pk_bf16_f32 v98, v26, v58
    v_cvt_pk_bf16_f32 v99, v27, v59
    buffer_store_dwordx4 v[96:99], v228, s[8:11], s41 offen offset:0 sc1
    v_cvt_pk_bf16_f32 v100, v40, v72
    v_cvt_pk_bf16_f32 v101, v41, v73
    v_cvt_pk_bf16_f32 v102, v42, v74
    v_cvt_pk_bf16_f32 v103, v43, v75
    buffer_store_dwordx4 v[100:103], v228, s[8:11], s41 offen offset:64 sc1
    v_cvt_pk_bf16_f32 v104, v28, v60
    v_cvt_pk_bf16_f32 v105, v29, v61
    v_cvt_pk_bf16_f32 v106, v30, v62
    v_cvt_pk_bf16_f32 v107, v31, v63
    buffer_store_dwordx4 v[104:107], v228, s[8:11], s41 offen offset:2048 sc1
    v_cvt_pk_bf16_f32 v108, v44, v76
    v_cvt_pk_bf16_f32 v109, v45, v77
    v_cvt_pk_bf16_f32 v110, v46, v78
    v_cvt_pk_bf16_f32 v111, v47, v79
    buffer_store_dwordx4 v[108:111], v228, s[8:11], s41 offen offset:2112 sc1
    s_add_u32 s38, s38, 8192
    s_add_u32 s42, s42, 1
    s_cmp_lt_u32 s42, 4
    s_cbranch_scc1 .cvl_502

    s_waitcnt vmcnt(0) lgkmcnt(0)
    s_barrier
    s_mov_b32 s5, 44
    s_cmp_lg_u32 s24, 0
    s_cbranch_scc1 .sg_503
    s_mov_b64 exec, 1
    v_mov_b32 v4, 1
    v_mov_b32 v5, 0
    buffer_atomic_add v4, v5, s[20:23], s5 offen sc1
    s_mov_b64 exec, -1

.sg_503:
    v_and_b32 v1, 63, v0
    v_and_b32 v2, 15, v1
    v_lshrrev_b32 v3, 4, v1

    v_mov_b32 v5, 0
    s_mov_b32 s62, 0
    s_mov_b32 s5, 32
.wc_504:
    buffer_load_dword v4, v5, s[20:23], s5 offen sc1
    s_waitcnt vmcnt(0)
    v_readfirstlane_b32 s4, v4
    s_lshr_b32 s4, s4, 0
    s_and_b32 s4, s4, 0xffff
    s_cmp_ge_u32 s4, 256
    s_cbranch_scc1 .wcd_505
    s_sleep 6
    s_add_u32 s62, s62, 1
    s_cmp_gt_u32 s62, 0x400000
    s_cbranch_scc1 .mg_end_1
    s_branch .wc_504

.wcd_505:
    s_sub_u32 s4, s26, 24
    s_lshr_b32 s25, s4, 1
    s_and_b32 s4, s4, 1
    s_lshl_b32 s4, s4, 2
    s_lshl_b32 s5, s91, 3
    s_add_u32 s4, s4, s5
    s_add_u32 s26, s4, s24
    s_lshl_b32 s35, s26, 8
    s_add_u32 s35, s35, 92274688
    s_mov_b32 s37, 0x3db504f3
    s_mov_b32 s38, 0x3fb8aa3b
    v_lshlrev_b32 v8, 4, v1
    v_lshlrev_b32 v9, 13, v1
    v_lshlrev_b32 v6, 4, v3
    v_and_b32 v5, 7, v2
    v_add_u32 v10, v6, v5
    v_lshlrev_b32 v10, 4, v10
    v_lshlrev_b32 v11, 4, v2
    v_lshlrev_b32 v5, 3, v3
    v_add_u32 v11, v11, v5
    v_cmp_gt_u32 s[60:61], 32, v1
    v_lshlrev_b32 v5, 2, v3
    v_mov_b32 v12, 0
    v_mov_b32 v13, 0

    v_add_u32 v7, 0, v5
    v_cmp_le_u32 s[40:41], v7, v2
    v_add_u32 v7, 1, v5
    v_cmp_le_u32 s[42:43], v7, v2
    v_add_u32 v7, 2, v5
    v_cmp_le_u32 s[44:45], v7, v2
    v_add_u32 v7, 3, v5
    v_cmp_le_u32 s[46:47], v7, v2
    v_mov_b32 v128, 0
    v_mov_b32 v129, 0
    v_mov_b32 v130, 0
    v_mov_b32 v131, 0
    v_mov_b32 v132, 0
    v_mov_b32 v133, 0
    v_mov_b32 v134, 0
    v_mov_b32 v135, 0
    v_mov_b32 v136, 0
    v_mov_b32 v137, 0
    v_mov_b32 v138, 0
    v_mov_b32 v139, 0
    v_mov_b32 v140, 0
    v_mov_b32 v141, 0
    v_mov_b32 v142, 0
    v_mov_b32 v143, 0
.att_506:
    s_add_u32 s36, s25, 1
    s_lshl_b32 s4, s25, 5
    s_add_u32 s4, s4, s26
    s_lshl_b32 s27, s4, 13
    s_add_u32 s28, s27, 4096
    s_add_u32 s29, s27, 16777216
    s_add_u32 s30, s27, 16781312
    s_add_u32 s31, s27, 33554432
    s_add_u32 s32, s27, 33558528
    s_mul_i32 s33, s4, 6144
    s_add_u32 s33, s33, 67108864
    s_add_u32 s34, s33, 4096

    s_mov_b32 s62, 0
    s_mov_b64 exec, 7
.wf_507:
    buffer_load_dword v4, v9, s[8:11], s35 offen sc1
    s_waitcnt vmcnt(0)
    v_cmp_gt_u32 vcc, s36, v4
    s_cbranch_vccz .wfd_508
    s_sleep 2
    s_add_u32 s62, s62, 1
    s_cmp_gt_u32 s62, 0x400000
    s_cbranch_scc1 .mg_end_1
    s_branch .wf_507

.wfd_508:
    s_mov_b64 exec, -1
    buffer_load_dwordx4 v[16:19], v8, s[8:11], s27 offen offset:0
    buffer_load_dwordx4 v[32:35], v8, s[8:11], s28 offen offset:0
    buffer_load_dwordx4 v[48:51], v8, s[8:11], s29 offen offset:0
    buffer_load_dwordx4 v[64:67], v8, s[8:11], s30 offen offset:0
    buffer_load_dwordx4 v[20:23], v8, s[8:11], s27 offen offset:1024
    buffer_load_dwordx4 v[36:39], v8, s[8:11], s28 offen offset:1024
    buffer_load_dwordx4 v[52:55], v8, s[8:11], s29 offen offset:1024
    buffer_load_dwordx4 v[68:71], v8, s[8:11], s30 offen offset:1024
    buffer_load_dwordx4 v[24:27], v8, s[8:11], s27 offen offset:2048
    buffer_load_dwordx4 v[40:43], v8, s[8:11], s28 offen offset:2048
    buffer_load_dwordx4 v[56:59], v8, s[8:11], s29 offen offset:2048
    buffer_load_dwordx4 v[72:75], v8, s[8:11], s30 offen offset:2048
    buffer_load_dwordx4 v[28:31], v8, s[8:11], s27 offen offset:3072
    buffer_load_dwordx4 v[44:47], v8, s[8:11], s28 offen offset:3072
    buffer_load_dwordx4 v[60:63], v8, s[8:11], s29 offen offset:3072
    buffer_load_dwordx4 v[76:79], v8, s[8:11], s30 offen offset:3072
    buffer_load_dwordx4 v[96:99], v8, s[8:11], s31 offen offset:0
    buffer_load_dwordx4 v[100:103], v8, s[8:11], s31 offen offset:1024
    buffer_load_dwordx4 v[104:107], v8, s[8:11], s31 offen offset:2048
    buffer_load_dwordx4 v[108:111], v8, s[8:11], s31 offen offset:3072
    buffer_load_dwordx4 v[112:115], v8, s[8:11], s32 offen offset:0
    buffer_load_dwordx4 v[116:119], v8, s[8:11], s32 offen offset:1024
    buffer_load_dwordx4 v[120:123], v8, s[8:11], s32 offen offset:2048
    buffer_load_dwordx4 v[124:127], v8, s[8:11], s32 offen offset:3072
    buffer_load_dwordx4 v[80:83], v10, s[8:11], s33 offen offset:2048 sc1
    buffer_load_dwordx4 v[84:87], v10, s[8:11], s33 offen offset:2176 sc1
    buffer_load_dwordx4 v[88:91], v10, s[8:11], s33 offen offset:3072 sc1
    buffer_load_dwordx4 v[92:95], v10, s[8:11], s33 offen offset:3200 sc1
    s_mov_b64 exec, s[60:61]
    buffer_load_dwordx2 v[128:129], v11, s[8:11], s34 offen offset:0 sc1
    buffer_load_dwordx2 v[130:131], v11, s[8:11], s34 offen offset:256 sc1
    buffer_load_dwordx2 v[132:133], v11, s[8:11], s34 offen offset:512 sc1
    buffer_load_dwordx2 v[134:135], v11, s[8:11], s34 offen offset:768 sc1
    buffer_load_dwordx2 v[136:137], v11, s[8:11], s34 offen offset:1024 sc1
    buffer_load_dwordx2 v[138:139], v11, s[8:11], s34 offen offset:1280 sc1
    buffer_load_dwordx2 v[140:141], v11, s[8:11], s34 offen offset:1536 sc1
    buffer_load_dwordx2 v[142:143], v11, s[8:11], s34 offen offset:1792 sc1
    s_mov_b64 exec, -1
    s_waitcnt vmcnt(32)
    v_mfma_f32_16x16x32_bf16 v[144:147], v[48:51], v[16:19], 0
    v_mfma_f32_16x16x32_bf16 v[156:159], v[48:51], v[32:35], 0
    v_mfma_f32_16x16x32_bf16 v[160:163], v[64:67], v[32:35], 0
    s_waitcnt vmcnt(28)
    v_mfma_f32_16x16x32_bf16 v[144:147], v[52:55], v[20:23], v[144:147]
    v_mfma_f32_16x16x32_bf16 v[156:159], v[52:55], v[36:39], v[156:159]
    v_mfma_f32_16x16x32_bf16 v[160:163], v[68:71], v[36:39], v[160:163]
    s_waitcnt vmcnt(24)
    v_mfma_f32_16x16x32_bf16 v[144:147], v[56:59], v[24:27], v[144:147]
    v_mfma_f32_16x16x32_bf16 v[156:159], v[56:59], v[40:43], v[156:159]
    v_mfma_f32_16x16x32_bf16 v[160:163], v[72:75], v[40:43], v[160:163]
    s_waitcnt vmcnt(20)
    v_mfma_f32_16x16x32_bf16 v[144:147], v[60:63], v[28:31], v[144:147]
    v_mfma_f32_16x16x32_bf16 v[156:159], v[60:63], v[44:47], v[156:159]
    v_mfma_f32_16x16x32_bf16 v[160:163], v[76:79], v[44:47], v[160:163]
    s_nop 7
    v_mov_b32 v14, 0xff800000
    v_cvt_pk_bf16_f32 v168, v144, v145
    v_cvt_pk_bf16_f32 v170, v146, v147
    v_and_b32 v169, 0xffff0000, v168
    v_lshlrev_b32 v168, 16, v168
    v_and_b32 v171, 0xffff0000, v170
    v_lshlrev_b32 v170, 16, v170
    v_mul_f32 v168, s37, v168
    v_mul_f32 v169, s37, v169
    v_mul_f32 v170, s37, v170
    v_mul_f32 v171, s37, v171
    v_cvt_pk_bf16_f32 v144, v168, v169
    v_cvt_pk_bf16_f32 v146, v170, v171
    v_and_b32 v145, 0xffff0000, v144
    v_lshlrev_b32 v144, 16, v144
    v_and_b32 v147, 0xffff0000, v146
    v_lshlrev_b32 v146, 16, v146
    v_cvt_pk_bf16_f32 v192, v156, v157
    v_cvt_pk_bf16_f32 v194, v158, v159
    v_cvt_pk_bf16_f32 v196, v160, v161
    v_cvt_pk_bf16_f32 v198, v162, v163
    v_and_b32 v193, 0xffff0000, v192
    v_lshlrev_b32 v192, 16, v192
    v_and_b32 v195, 0xffff0000, v194
    v_lshlrev_b32 v194, 16, v194
    v_and_b32 v197, 0xffff0000, v196
    v_lshlrev_b32 v196, 16, v196
    v_and_b32 v199, 0xffff0000, v198
    v_lshlrev_b32 v198, 16, v198
    v_mul_f32 v192, s37, v192
    v_mul_f32 v193, s37, v193
    v_mul_f32 v194, s37, v194
    v_mul_f32 v195, s37, v195
    v_mul_f32 v196, s37, v196
    v_mul_f32 v197, s37, v197
    v_mul_f32 v198, s37, v198
    v_mul_f32 v199, s37, v199
    v_cvt_pk_bf16_f32 v156, v192, v193
    v_cvt_pk_bf16_f32 v158, v194, v195
    v_cvt_pk_bf16_f32 v160, v196, v197
    v_cvt_pk_bf16_f32 v162, v198, v199
    v_and_b32 v157, 0xffff0000, v156
    v_lshlrev_b32 v156, 16, v156
    v_and_b32 v159, 0xffff0000, v158
    v_lshlrev_b32 v158, 16, v158
    v_and_b32 v161, 0xffff0000, v160
    v_lshlrev_b32 v160, 16, v160
    v_and_b32 v163, 0xffff0000, v162
    v_lshlrev_b32 v162, 16, v162
    v_cndmask_b32 v144, v14, v144, s[40:41]
    v_cndmask_b32 v145, v14, v145, s[42:43]
    v_cndmask_b32 v146, v14, v146, s[44:45]
    v_cndmask_b32 v147, v14, v147, s[46:47]
    v_cndmask_b32 v160, v14, v160, s[40:41]
    v_cndmask_b32 v161, v14, v161, s[42:43]
    v_cndmask_b32 v162, v14, v162, s[44:45]
    v_cndmask_b32 v163, v14, v163, s[46:47]
    s_mov_b32 s62, 0
.kmp_509:
    s_waitcnt vmcnt(0)
    v_max3_u32 v4, v80, v81, v82
    v_max3_u32 v5, v83, v84, v85
    v_max3_u32 v4, v4, v86, v87
    v_max3_u32 v5, v5, v88, v89
    v_max3_u32 v4, v4, v90, v91
    v_max3_u32 v5, v5, v92, v93
    v_max3_u32 v4, v4, v94, v95
    v_max3_u32 v5, v5, v128, v129
    v_max3_u32 v4, v4, v130, v131
    v_max3_u32 v5, v5, v132, v133
    v_max3_u32 v4, v4, v134, v135
    v_max3_u32 v5, v5, v136, v137
    v_max3_u32 v4, v4, v138, v139
    v_max3_u32 v5, v5, v140, v141
    v_max3_u32 v4, v4, v142, v143
    v_max_u32 v4, v4, v5
    v_cmp_eq_u32 vcc, -1, v4
    s_cbranch_vccz .kmd_510
    s_sleep 2

    buffer_load_dwordx4 v[80:83], v10, s[8:11], s33 offen offset:2048 sc1
    buffer_load_dwordx4 v[84:87], v10, s[8:11], s33 offen offset:2176 sc1
    buffer_load_dwordx4 v[88:91], v10, s[8:11], s33 offen offset:3072 sc1
    buffer_load_dwordx4 v[92:95], v10, s[8:11], s33 offen offset:3200 sc1
    s_mov_b64 exec, s[60:61]
    buffer_load_dwordx2 v[128:129], v11, s[8:11], s34 offen offset:0 sc1
    buffer_load_dwordx2 v[130:131], v11, s[8:11], s34 offen offset:256 sc1
    buffer_load_dwordx2 v[132:133], v11, s[8:11], s34 offen offset:512 sc1
    buffer_load_dwordx2 v[134:135], v11, s[8:11], s34 offen offset:768 sc1
    buffer_load_dwordx2 v[136:137], v11, s[8:11], s34 offen offset:1024 sc1
    buffer_load_dwordx2 v[138:139], v11, s[8:11], s34 offen offset:1280 sc1
    buffer_load_dwordx2 v[140:141], v11, s[8:11], s34 offen offset:1536 sc1
    buffer_load_dwordx2 v[142:143], v11, s[8:11], s34 offen offset:1792 sc1
    s_mov_b64 exec, -1
    s_add_u32 s62, s62, 1
    s_cmp_gt_u32 s62, 0x200000
    s_cbranch_scc1 .mg_end_1
    s_branch .kmp_509

.kmd_510:
    v_mfma_f32_16x16x32_bf16 v[152:155], v[80:83], v[16:19], 0
    v_mfma_f32_16x16x32_bf16 v[164:167], v[80:83], v[32:35], 0
    v_mfma_f32_16x16x32_bf16 v[152:155], v[84:87], v[20:23], v[152:155]
    v_mfma_f32_16x16x32_bf16 v[164:167], v[84:87], v[36:39], v[164:167]
    v_mfma_f32_16x16x32_bf16 v[152:155], v[88:91], v[24:27], v[152:155]
    v_mfma_f32_16x16x32_bf16 v[164:167], v[88:91], v[40:43], v[164:167]
    v_mfma_f32_16x16x32_bf16 v[152:155], v[92:95], v[28:31], v[152:155]
    v_mfma_f32_16x16x32_bf16 v[164:167], v[92:95], v[44:47], v[164:167]
    s_nop 5
    v_cvt_pk_bf16_f32 v176, v152, v153
    v_cvt_pk_bf16_f32 v178, v154, v155
    v_and_b32 v177, 0xffff0000, v176
    v_lshlrev_b32 v176, 16, v176
    v_and_b32 v179, 0xffff0000, v178
    v_lshlrev_b32 v178, 16, v178
    v_mul_f32 v176, s37, v176
    v_mul_f32 v177, s37, v177
    v_mul_f32 v178, s37, v178
    v_mul_f32 v179, s37, v179
    v_cvt_pk_bf16_f32 v152, v176, v177
    v_cvt_pk_bf16_f32 v154, v178, v179
    v_and_b32 v153, 0xffff0000, v152
    v_lshlrev_b32 v152, 16, v152
    v_and_b32 v155, 0xffff0000, v154
    v_lshlrev_b32 v154, 16, v154
    v_cndmask_b32 v152, v14, v152, s[60:61]
    v_cndmask_b32 v153, v14, v153, s[60:61]
    v_cndmask_b32 v154, v14, v154, s[60:61]
    v_cndmask_b32 v155, v14, v155, s[60:61]
    v_cvt_pk_bf16_f32 v200, v164, v165
    v_cvt_pk_bf16_f32 v202, v166, v167
    v_and_b32 v201, 0xffff0000, v200
    v_lshlrev_b32 v200, 16, v200
    v_and_b32 v203, 0xffff0000, v202
    v_lshlrev_b32 v202, 16, v202
    v_mul_f32 v200, s37, v200
    v_mul_f32 v201, s37, v201
    v_mul_f32 v202, s37, v202
    v_mul_f32 v203, s37, v203
    v_cvt_pk_bf16_f32 v164, v200, v201
    v_cvt_pk_bf16_f32 v166, v202, v203
    v_and_b32 v165, 0xffff0000, v164
    v_lshlrev_b32 v164, 16, v164
    v_and_b32 v167, 0xffff0000, v166
    v_lshlrev_b32 v166, 16, v166
    v_cndmask_b32 v164, v14, v164, s[60:61]
    v_cndmask_b32 v165, v14, v165, s[60:61]
    v_cndmask_b32 v166, v14, v166, s[60:61]
    v_cndmask_b32 v167, v14, v167, s[60:61]
    v_max3_f32 v4, v144, v145, v146
    v_max3_f32 v5, v147, v152, v153
    v_max3_f32 v4, v4, v154, v155
    v_max_f32 v4, v4, v5

    v_max3_f32 v6, v156, v157, v158
    v_max3_f32 v7, v159, v160, v161
    v_max3_f32 v6, v6, v162, v163
    v_max3_f32 v7, v7, v164, v165
    v_max3_f32 v6, v6, v166, v167
    v_max_f32 v6, v6, v7

    v_mov_b32 v5, v4
    v_mov_b32 v7, v6
    s_nop 0
    v_permlane32_swap_b32 v4, v5
    v_permlane32_swap_b32 v6, v7
    v_max_f32 v4, v4, v5
    v_max_f32 v6, v6, v7

    v_mov_b32 v5, v4
    v_mov_b32 v7, v6
    s_nop 0
    v_permlane16_swap_b32 v4, v5
    v_permlane16_swap_b32 v6, v7
    v_max_f32 v4, v4, v5
    v_max_f32 v6, v6, v7

    v_mul_f32 v4, s38, v4
    v_mul_f32 v6, s38, v6
    v_fma_f32 v168, v144, s38, -v4
    v_fma_f32 v169, v145, s38, -v4
    v_fma_f32 v170, v146, s38, -v4
    v_fma_f32 v171, v147, s38, -v4
    v_fma_f32 v176, v152, s38, -v4
    v_fma_f32 v177, v153, s38, -v4
    v_fma_f32 v178, v154, s38, -v4
    v_fma_f32 v179, v155, s38, -v4
    v_fma_f32 v192, v156, s38, -v6
    v_fma_f32 v193, v157, s38, -v6
    v_fma_f32 v194, v158, s38, -v6
    v_fma_f32 v195, v159, s38, -v6
    v_fma_f32 v196, v160, s38, -v6
    v_fma_f32 v197, v161, s38, -v6
    v_fma_f32 v198, v162, s38, -v6
    v_fma_f32 v199, v163, s38, -v6
    v_fma_f32 v200, v164, s38, -v6
    v_fma_f32 v201, v165, s38, -v6
    v_fma_f32 v202, v166, s38, -v6
    v_fma_f32 v203, v167, s38, -v6
    v_exp_f32 v168, v168
    v_exp_f32 v169, v169
    v_exp_f32 v170, v170
    v_exp_f32 v171, v171
    v_exp_f32 v176, v176
    v_exp_f32 v177, v177
    v_exp_f32 v178, v178
    v_exp_f32 v179, v179
    v_exp_f32 v192, v192
    v_exp_f32 v193, v193
    v_exp_f32 v194, v194
    v_exp_f32 v195, v195
    v_exp_f32 v196, v196
    v_exp_f32 v197, v197
    v_exp_f32 v198, v198
    v_exp_f32 v199, v199
    v_exp_f32 v200, v200
    v_exp_f32 v201, v201
    v_exp_f32 v202, v202
    v_exp_f32 v203, v203
    v_add_f32 v4, v168, v169
    v_add_f32 v5, v170, v171
    v_add_f32 v4, v4, v176
    v_add_f32 v5, v5, v177
    v_add_f32 v4, v4, v178
    v_add_f32 v5, v5, v179
    v_add_f32 v4, v4, v5
    v_add_f32 v6, v192, v193
    v_add_f32 v7, v194, v195
    v_add_f32 v6, v6, v196
    v_add_f32 v7, v7, v197
    v_add_f32 v6, v6, v198
    v_add_f32 v7, v7, v199
    v_add_f32 v6, v6, v200
    v_add_f32 v7, v7, v201
    v_add_f32 v6, v6, v202
    v_add_f32 v7, v7, v203
    v_add_f32 v6, v6, v7
    v_mov_b32 v5, v4
    v_mov_b32 v7, v6
    s_nop 0
    v_permlane32_swap_b32 v4, v5
    v_permlane32_swap_b32 v6, v7
    v_add_f32 v4, v4, v5
    v_add_f32 v6, v6, v7

    v_mov_b32 v5, v4
    v_mov_b32 v7, v6
    s_nop 0
    v_permlane16_swap_b32 v4, v5
    v_permlane16_swap_b32 v6, v7
    v_add_f32 v4, v4, v5
    v_add_f32 v6, v6, v7

    v_rcp_f32 v4, v4
    v_rcp_f32 v6, v6
    v_mov_b32 v182, 0
    v_mov_b32 v183, 0
    v_mul_f32 v168, v4, v168
    v_mul_f32 v169, v4, v169
    v_mul_f32 v170, v4, v170
    v_mul_f32 v171, v4, v171
    v_mul_f32 v176, v4, v176
    v_mul_f32 v177, v4, v177
    v_mul_f32 v178, v4, v178
    v_mul_f32 v179, v4, v179
    v_cvt_pk_bf16_f32 v180, v168, v169
    v_cvt_pk_bf16_f32 v181, v170, v171
    v_cvt_pk_bf16_f32 v184, v176, v177
    v_cvt_pk_bf16_f32 v185, v178, v179
    v_mul_f32 v192, v6, v192
    v_mul_f32 v193, v6, v193
    v_mul_f32 v194, v6, v194
    v_mul_f32 v195, v6, v195
    v_mul_f32 v196, v6, v196
    v_mul_f32 v197, v6, v197
    v_mul_f32 v198, v6, v198
    v_mul_f32 v199, v6, v199
    v_mul_f32 v200, v6, v200
    v_mul_f32 v201, v6, v201
    v_mul_f32 v202, v6, v202
    v_mul_f32 v203, v6, v203
    v_cvt_pk_bf16_f32 v186, v192, v193
    v_cvt_pk_bf16_f32 v187, v194, v195
    v_cvt_pk_bf16_f32 v188, v196, v197
    v_cvt_pk_bf16_f32 v189, v198, v199
    v_cvt_pk_bf16_f32 v190, v200, v201
    v_cvt_pk_bf16_f32 v191, v202, v203
    s_add_u32 s4, s27, 50331648
    s_add_u32 s5, s28, 50331648
    v_add_u32 v12, 1, v12

    v_mfma_f32_16x16x32_bf16 v[16:19], v[96:99], v[180:183], 0
    v_mfma_f32_16x16x32_bf16 v[20:23], v[100:103], v[180:183], 0
    v_mfma_f32_16x16x32_bf16 v[24:27], v[104:107], v[180:183], 0
    v_mfma_f32_16x16x32_bf16 v[28:31], v[108:111], v[180:183], 0
    v_mfma_f32_16x16x32_bf16 v[32:35], v[112:115], v[180:183], 0
    v_mfma_f32_16x16x32_bf16 v[36:39], v[116:119], v[180:183], 0
    v_mfma_f32_16x16x32_bf16 v[40:43], v[120:123], v[180:183], 0
    v_mfma_f32_16x16x32_bf16 v[44:47], v[124:127], v[180:183], 0
    v_mfma_f32_16x16x32_bf16 v[48:51], v[96:99], v[186:189], 0
    v_mfma_f32_16x16x32_bf16 v[52:55], v[100:103], v[186:189], 0
    v_mfma_f32_16x16x32_bf16 v[56:59], v[104:107], v[186:189], 0
    v_mfma_f32_16x16x32_bf16 v[60:63], v[108:111], v[186:189], 0
    v_mfma_f32_16x16x32_bf16 v[64:67], v[112:115], v[186:189], 0
    v_mfma_f32_16x16x32_bf16 v[68:71], v[116:119], v[186:189], 0
    v_mfma_f32_16x16x32_bf16 v[72:75], v[120:123], v[186:189], 0
    v_mfma_f32_16x16x32_bf16 v[76:79], v[124:127], v[186:189], 0
    v_mfma_f32_16x16x16_bf16 v[16:19], v[128:129], v[184:185], v[16:19]
    v_mfma_f32_16x16x16_bf16 v[20:23], v[130:131], v[184:185], v[20:23]
    v_mfma_f32_16x16x16_bf16 v[24:27], v[132:133], v[184:185], v[24:27]
    v_mfma_f32_16x16x16_bf16 v[28:31], v[134:135], v[184:185], v[28:31]
    v_mfma_f32_16x16x16_bf16 v[32:35], v[136:137], v[184:185], v[32:35]
    v_mfma_f32_16x16x16_bf16 v[36:39], v[138:139], v[184:185], v[36:39]
    v_cvt_pk_bf16_f32 v208, v16, v17
    v_cvt_pk_bf16_f32 v209, v18, v19
    v_cvt_pk_bf16_f32 v210, v20, v21
    v_cvt_pk_bf16_f32 v211, v22, v23
    buffer_store_dwordx4 v[208:211], v8, s[8:11], s4 offen offset:0 sc1
    v_mfma_f32_16x16x16_bf16 v[40:43], v[140:141], v[184:185], v[40:43]
    v_mfma_f32_16x16x16_bf16 v[44:47], v[142:143], v[184:185], v[44:47]
    v_cvt_pk_bf16_f32 v212, v24, v25
    v_cvt_pk_bf16_f32 v213, v26, v27
    v_cvt_pk_bf16_f32 v214, v28, v29
    v_cvt_pk_bf16_f32 v215, v30, v31
    buffer_store_dwordx4 v[212:215], v8, s[8:11], s4 offen offset:1024 sc1
    v_mfma_f32_16x16x16_bf16 v[48:51], v[128:129], v[190:191], v[48:51]
    v_mfma_f32_16x16x16_bf16 v[52:55], v[130:131], v[190:191], v[52:55]
    v_cvt_pk_bf16_f32 v216, v32, v33
    v_cvt_pk_bf16_f32 v217, v34, v35
    v_cvt_pk_bf16_f32 v218, v36, v37
    v_cvt_pk_bf16_f32 v219, v38, v39
    buffer_store_dwordx4 v[216:219], v8, s[8:11], s4 offen offset:2048 sc1
    v_mfma_f32_16x16x16_bf16 v[56:59], v[132:133], v[190:191], v[56:59]
    v_mfma_f32_16x16x16_bf16 v[60:63], v[134:135], v[190:191], v[60:63]
    v_cvt_pk_bf16_f32 v220, v40, v41
    v_cvt_pk_bf16_f32 v221, v42, v43
    v_cvt_pk_bf16_f32 v222, v44, v45
    v_cvt_pk_bf16_f32 v223, v46, v47
    buffer_store_dwordx4 v[220:223], v8, s[8:11], s4 offen offset:3072 sc1
    v_mfma_f32_16x16x16_bf16 v[64:67], v[136:137], v[190:191], v[64:67]
    v_mfma_f32_16x16x16_bf16 v[68:71], v[138:139], v[190:191], v[68:71]
    v_cvt_pk_bf16_f32 v224, v48, v49
    v_cvt_pk_bf16_f32 v225, v50, v51
    v_cvt_pk_bf16_f32 v226, v52, v53
    v_cvt_pk_bf16_f32 v227, v54, v55
    buffer_store_dwordx4 v[224:227], v8, s[8:11], s5 offen offset:0 sc1
    v_mfma_f32_16x16x16_bf16 v[72:75], v[140:141], v[190:191], v[72:75]
    v_mfma_f32_16x16x16_bf16 v[76:79], v[142:143], v[190:191], v[76:79]
    v_cvt_pk_bf16_f32 v228, v56, v57
    v_cvt_pk_bf16_f32 v229, v58, v59
    v_cvt_pk_bf16_f32 v230, v60, v61
    v_cvt_pk_bf16_f32 v231, v62, v63
    buffer_store_dwordx4 v[228:231], v8, s[8:11], s5 offen offset:1024 sc1
    s_nop 3
    v_cvt_pk_bf16_f32 v232, v64, v65
    v_cvt_pk_bf16_f32 v233, v66, v67
    v_cvt_pk_bf16_f32 v234, v68, v69
    v_cvt_pk_bf16_f32 v235, v70, v71
    buffer_store_dwordx4 v[232:235], v8, s[8:11], s5 offen offset:2048 sc1
    v_cvt_pk_bf16_f32 v236, v72, v73
    v_cvt_pk_bf16_f32 v237, v74, v75
    v_cvt_pk_bf16_f32 v238, v76, v77
    v_cvt_pk_bf16_f32 v239, v78, v79
    buffer_store_dwordx4 v[236:239], v8, s[8:11], s5 offen offset:3072 sc1
    s_waitcnt vmcnt(0)
    s_barrier
    s_cmp_lg_u32 s24, 0
    s_cbranch_scc1 .ats_511
    s_mov_b64 exec, 1
    buffer_store_dword v12, v13, s[8:11], s92 offen sc1
    s_mov_b64 exec, -1

.ats_511:
    s_add_u32 s25, s25, 4
    s_cmp_lt_u32 s25, 64
    s_cbranch_scc1 .att_506

.mg_end_1:
    s_endpgm
.section .rodata,"a"
.p2align 6
.amdhsa_kernel mega_kernel
  .amdhsa_next_free_vgpr 512
  .amdhsa_next_free_sgpr 102
  .amdhsa_accum_offset 256
  .amdhsa_group_segment_fixed_size 0
  .amdhsa_kernarg_size 136
  .amdhsa_user_sgpr_count 2
  .amdhsa_user_sgpr_kernarg_segment_ptr 1
  .amdhsa_system_sgpr_workgroup_id_x 1
.end_amdhsa_kernel
```

```asm
; @launch kernel=mega_kernel grid=(256,1,1) block=(256,1,1) lds=163840
.amdgcn_target "amdgcn-amd-amdhsa--gfx950"
.text
.globl mega_kernel
.p2align 8
.type mega_kernel,@function
mega_kernel:
    s_cmp_ge_u32 s2, 256
    s_cbranch_scc1 .mg_end_1
    s_load_dwordx4 s[52:55], s[0:1], 120
    s_getreg_b32 s3, hwreg(HW_REG_XCC_ID)
    v_and_b32 v1, 63, v0
    v_lshrrev_b32 v4, 6, v0
    s_and_b32 s3, s3, 7
    v_readfirstlane_b32 s24, v4
    s_waitcnt lgkmcnt(0)

    s_mov_b32 s8, s54
    s_and_b32 s9, s55, 0xffff
    s_mov_b32 s10, 0x10000000
    s_mov_b32 s11, 0x00020000

    s_mov_b32 s20, s52
    s_and_b32 s21, s53, 0xffff
    s_mov_b32 s22, 0x100
    s_mov_b32 s23, 0x00020000

    s_mov_b32 s100, s54
    s_cmp_lg_u32 s24, 0
    s_cbranch_scc1 .noat_4
    s_mov_b64 exec, 1
    v_mov_b32 v5, 1
    s_lshl_b32 s4, s3, 2
    v_mov_b32 v6, s4
    buffer_atomic_add v5, v6, s[20:23], 0 offen sc0 sc1
    v_mov_b32 v7, 163776
    s_waitcnt vmcnt(0)
    ds_write_b32 v7, v5
    s_waitcnt lgkmcnt(0)
    s_mov_b64 exec, -1

.noat_4:
    s_barrier
    v_mov_b32 v7, 163776
    ds_read_b32 v5, v7
    s_waitcnt lgkmcnt(0)
    v_readfirstlane_b32 s26, v5
    s_mov_b32 s25, s3
    s_mov_b32 s27, 0
    s_mov_b32 s97, 0
    s_and_b32 s26, s26, 31

.mg_role_3:
    s_cmp_ge_u32 s25, 4
    s_cbranch_scc1 .mg_bg_2

    s_load_dwordx8 s[44:51], s[0:1], 64
    s_load_dwordx2 s[40:41], s[0:1], 56
    v_and_b32 v1, 63, v0
    v_and_b32 v2, 15, v1
    v_lshrrev_b32 v3, 4, v1

    s_lshl_b32 s4, s25, 11
    s_lshl_b32 s5, s26, 6
    s_add_u32 s4, s4, s5
    s_lshl_b32 s5, s24, 21
    s_add_u32 s4, s4, s5
    v_lshrrev_b32 v4, 2, v1
    v_and_b32 v5, 3, v1
    v_lshlrev_b32 v5, 4, v5
    v_lshlrev_b32 v6, 13, v4
    v_add_u32 v6, v6, v5
    v_add_u32 v240, s4, v6
    s_lshl_b32 s4, s25, 2
    s_and_b32 s5, s24, 1
    s_lshl_b32 s5, s5, 1
    s_add_u32 s4, s4, s5
    s_lshr_b32 s5, s24, 1
    s_add_u32 s4, s4, s5
    s_lshl_b32 s4, s4, 19
    s_lshl_b32 s5, s26, 6
    s_add_u32 s4, s4, s5
    v_lshlrev_b32 v6, 11, v4
    v_add_u32 v6, v6, v5
    v_add_u32 v241, s4, v6
    s_lshl_b32 s98, s24, 15
    s_waitcnt lgkmcnt(0)

    s_mov_b32 s16, s44
    s_and_b32 s17, s45, 0xffff
    s_mov_b32 s18, 0x800000
    s_mov_b32 s19, 0x00020000

    s_add_u32 m0, s98, 0
    s_mov_b32 s5, 0
    buffer_load_dwordx4 v240, s[16:19], s5 offen lds

    s_add_u32 m0, s98, 1024
    s_mov_b32 s5, 131072
    buffer_load_dwordx4 v240, s[16:19], s5 offen lds

    s_add_u32 m0, s98, 2048
    s_mov_b32 s5, 262144
    buffer_load_dwordx4 v240, s[16:19], s5 offen lds

    s_add_u32 m0, s98, 3072
    s_mov_b32 s5, 393216
    buffer_load_dwordx4 v240, s[16:19], s5 offen lds

    s_add_u32 m0, s98, 4096
    s_mov_b32 s5, 524288
    buffer_load_dwordx4 v240, s[16:19], s5 offen lds

    s_add_u32 m0, s98, 5120
    s_mov_b32 s5, 655360
    buffer_load_dwordx4 v240, s[16:19], s5 offen lds

    s_add_u32 m0, s98, 6144
    s_mov_b32 s5, 786432
    buffer_load_dwordx4 v240, s[16:19], s5 offen lds

    s_add_u32 m0, s98, 7168
    s_mov_b32 s5, 917504
    buffer_load_dwordx4 v240, s[16:19], s5 offen lds

    s_add_u32 m0, s98, 8192
    s_mov_b32 s5, 1048576
    buffer_load_dwordx4 v240, s[16:19], s5 offen lds

    s_add_u32 m0, s98, 9216
    s_mov_b32 s5, 1179648
    buffer_load_dwordx4 v240, s[16:19], s5 offen lds

    s_add_u32 m0, s98, 10240
    s_mov_b32 s5, 1310720
    buffer_load_dwordx4 v240, s[16:19], s5 offen lds

    s_add_u32 m0, s98, 11264
    s_mov_b32 s5, 1441792
    buffer_load_dwordx4 v240, s[16:19], s5 offen lds

    s_add_u32 m0, s98, 12288
    s_mov_b32 s5, 1572864
    buffer_load_dwordx4 v240, s[16:19], s5 offen lds

    s_add_u32 m0, s98, 13312
    s_mov_b32 s5, 1703936
    buffer_load_dwordx4 v240, s[16:19], s5 offen lds

    s_add_u32 m0, s98, 14336
    s_mov_b32 s5, 1835008
    buffer_load_dwordx4 v240, s[16:19], s5 offen lds

    s_add_u32 m0, s98, 15360
    s_mov_b32 s5, 1966080
    buffer_load_dwordx4 v240, s[16:19], s5 offen lds

    s_mov_b32 s16, s46
    s_and_b32 s17, s47, 0xffff
    s_mov_b32 s18, 0x800000
    s_mov_b32 s19, 0x00020000

    s_add_u32 m0, s98, 16384
    s_mov_b32 s5, 0
    buffer_load_dwordx4 v240, s[16:19], s5 offen lds

    s_add_u32 m0, s98, 17408
    s_mov_b32 s5, 131072
    buffer_load_dwordx4 v240, s[16:19], s5 offen lds

    s_add_u32 m0, s98, 18432
    s_mov_b32 s5, 262144
    buffer_load_dwordx4 v240, s[16:19], s5 offen lds

    s_add_u32 m0, s98, 19456
    s_mov_b32 s5, 393216
    buffer_load_dwordx4 v240, s[16:19], s5 offen lds

    s_add_u32 m0, s98, 20480
    s_mov_b32 s5, 524288
    buffer_load_dwordx4 v240, s[16:19], s5 offen lds

    s_add_u32 m0, s98, 21504
    s_mov_b32 s5, 655360
    buffer_load_dwordx4 v240, s[16:19], s5 offen lds

    s_add_u32 m0, s98, 22528
    s_mov_b32 s5, 786432
    buffer_load_dwordx4 v240, s[16:19], s5 offen lds

    s_add_u32 m0, s98, 23552
    s_mov_b32 s5, 917504
    buffer_load_dwordx4 v240, s[16:19], s5 offen lds

    s_add_u32 m0, s98, 24576
    s_mov_b32 s5, 1048576
    buffer_load_dwordx4 v240, s[16:19], s5 offen lds

    s_add_u32 m0, s98, 25600
    s_mov_b32 s5, 1179648
    buffer_load_dwordx4 v240, s[16:19], s5 offen lds

    s_add_u32 m0, s98, 26624
    s_mov_b32 s5, 1310720
    buffer_load_dwordx4 v240, s[16:19], s5 offen lds

    s_add_u32 m0, s98, 27648
    s_mov_b32 s5, 1441792
    buffer_load_dwordx4 v240, s[16:19], s5 offen lds

    s_add_u32 m0, s98, 28672
    s_mov_b32 s5, 1572864
    buffer_load_dwordx4 v240, s[16:19], s5 offen lds

    s_add_u32 m0, s98, 29696
    s_mov_b32 s5, 1703936
    buffer_load_dwordx4 v240, s[16:19], s5 offen lds

    s_add_u32 m0, s98, 30720
    s_mov_b32 s5, 1835008
    buffer_load_dwordx4 v240, s[16:19], s5 offen lds

    s_add_u32 m0, s98, 31744
    s_mov_b32 s5, 1966080
    buffer_load_dwordx4 v240, s[16:19], s5 offen lds

    v_and_b32 v243, 7, v0
    v_lshlrev_b32 v243, 2, v243
    buffer_load_dword v242, v243, s[20:23], 0 offen sc1

    s_mov_b32 s12, s40
    s_and_b32 s13, s41, 0xffff
    s_mov_b32 s14, 0x4000
    s_mov_b32 s15, 0x00020000

    v_bfe_u32 v4, v2, 2, 1
    v_lshrrev_b32 v5, 3, v2
    v_lshrrev_b32 v8, 1, v3
    v_and_b32 v9, 1, v3
    v_lshl_add_u32 v6, v5, 3, v4
    v_lshl_add_u32 v6, v8, 4, v6
    v_lshl_add_u32 v6, v9, 2, v6
    v_lshl_add_u32 v7, v5, 2, v4
    v_lshl_add_u32 v7, v8, 3, v7
    v_lshl_add_u32 v7, v9, 4, v7
    v_and_b32 v5, 3, v2
    v_lshlrev_b32 v5, 3, v5
    v_lshl_add_u32 v6, v6, 6, v5
    v_lshl_add_u32 v7, v7, 6, v5
    v_add_u32 v254, s98, v6
    v_add_u32 v255, s98, v7
    v_sub_u32 v252, v254, v5
    v_and_b32 v5, 1, v2
    v_lshl_add_u32 v252, v5, 5, v252
    v_bfe_u32 v5, v2, 1, 1
    v_lshl_add_u32 v252, v5, 3, v252
    s_sub_u32 s101, 0, s100
    s_and_b32 s101, s101, 0x1fffff
    s_add_u32 s101, s101, 100663296

    s_lshr_b32 s79, s26, 2
    s_and_b32 s96, s26, 3
    s_and_b32 s78, s24, 1
    s_lshl_b32 s34, s25, 18
    s_add_u32 s34, s34, 83886080
    v_lshlrev_b32 v14, 4, v1
    s_lshl_b32 s5, s24, 12
    v_add_u32 v8, s5, v14
    v_and_b32 v5, 7, v2
    v_lshrrev_b32 v6, 1, v3
    v_and_b32 v7, 1, v3
    v_lshlrev_b32 v7, 3, v7
    v_lshlrev_b32 v17, 11, v5
    v_lshl_add_u32 v17, v3, 5, v17
    v_lshrrev_b32 v4, 3, v2
    v_lshl_add_u32 v17, v4, 4, v17
    s_lshl_b32 s5, s24, 9
    v_add_u32 v17, s5, v17

    buffer_load_dwordx4 v[20:23], v17, s[12:15], 0 offen offset:0
    buffer_load_dwordx4 v[24:27], v17, s[12:15], 0 offen offset:128
    buffer_load_dwordx4 v[28:31], v17, s[12:15], 0 offen offset:256
    buffer_load_dwordx4 v[32:35], v17, s[12:15], 0 offen offset:384
    v_mov_b32 v188, -1
    v_mov_b32 v189, -1
    v_mov_b32 v190, -1
    v_mov_b32 v191, -1
    s_lshl_b32 s5, s26, 10
    s_add_u32 s5, s5, 32768
    v_add_u32 v235, s5, v14
    s_lshl_b32 s4, s26, 9
    v_and_b32 v4, 31, v1
    v_lshlrev_b32 v236, 4, v4
    v_lshl_add_u32 v236, v6, 14, v236
    v_add_u32 v236, s4, v236
    s_and_b32 s5, s26, 7
    s_lshl_b32 s4, s5, 10
    s_lshr_b32 s5, s26, 3
    s_lshl_b32 s5, s5, 14
    s_add_u32 s4, s4, s5
    s_add_u32 s35, s4, s101
    s_lshl_b32 s5, s25, 16
    v_add_u32 v238, s5, v14
    s_lshl_b32 s4, s25, 3
    s_add_u32 s7, s4, s79
    s_mul_i32 s36, s7, 6144
    s_add_u32 s36, s36, 67108864
    s_cmp_eq_u32 s78, 0
    s_cselect_b64 vcc, -1, 0
    s_lshr_b32 s6, s24, 1
    s_lshl_b32 s4, s6, 16
    s_add_u32 s4, s4, s34
    v_cndmask_b32 v4, v235, v236, vcc
    s_mul_i32 s5, s6, 1048576
    s_lshl_b32 s6, s78, 13
    buffer_store_dwordx4 v[188:191], v4, s[8:11], s4 offen sc1
    s_add_u32 s5, s5, s6
    s_add_u32 s5, s5, s35

    buffer_store_dwordx4 v[188:191], v238, s[8:11], s5 offen sc1
    s_add_u32 s5, s5, 262144
    buffer_store_dwordx4 v[188:191], v238, s[8:11], s5 offen sc1
    s_add_u32 s5, s5, 262144
    s_mul_i32 s4, s96, 3145728
    s_lshl_b32 s5, s24, 10
    s_add_u32 s4, s4, s5
    s_add_u32 s4, s4, s36

    buffer_store_dwordx4 v[188:191], v14, s[8:11], s4 offen offset:2048 sc1
    s_add_u32 s4, s4, 196608
    buffer_store_dwordx4 v[188:191], v14, s[8:11], s4 offen offset:2048 sc1
    s_add_u32 s4, s4, 196608
    buffer_store_dwordx4 v[188:191], v14, s[8:11], s4 offen offset:2048 sc1
    s_add_u32 s4, s4, 196608
    buffer_store_dwordx4 v[188:191], v14, s[8:11], s4 offen offset:2048 sc1
    s_add_u32 s4, s4, 196608
    buffer_store_dwordx4 v[188:191], v14, s[8:11], s4 offen offset:2048 sc1
    s_add_u32 s4, s4, 196608
    buffer_store_dwordx4 v[188:191], v14, s[8:11], s4 offen offset:2048 sc1
    s_add_u32 s4, s4, 196608
    buffer_store_dwordx4 v[188:191], v14, s[8:11], s4 offen offset:2048 sc1
    s_add_u32 s4, s4, 196608
    buffer_store_dwordx4 v[188:191], v14, s[8:11], s4 offen offset:2048 sc1
    s_add_u32 s4, s4, 196608
    buffer_store_dwordx4 v[188:191], v14, s[8:11], s4 offen offset:2048 sc1
    s_add_u32 s4, s4, 196608
    buffer_store_dwordx4 v[188:191], v14, s[8:11], s4 offen offset:2048 sc1
    s_add_u32 s4, s4, 196608
    buffer_store_dwordx4 v[188:191], v14, s[8:11], s4 offen offset:2048 sc1
    s_add_u32 s4, s4, 196608
    buffer_store_dwordx4 v[188:191], v14, s[8:11], s4 offen offset:2048 sc1
    s_add_u32 s4, s4, 196608
    buffer_store_dwordx4 v[188:191], v14, s[8:11], s4 offen offset:2048 sc1
    s_add_u32 s4, s4, 196608
    buffer_store_dwordx4 v[188:191], v14, s[8:11], s4 offen offset:2048 sc1
    s_add_u32 s4, s4, 196608
    buffer_store_dwordx4 v[188:191], v14, s[8:11], s4 offen offset:2048 sc1
    s_add_u32 s4, s4, 196608
    buffer_store_dwordx4 v[188:191], v14, s[8:11], s4 offen offset:2048 sc1
    s_add_u32 s4, s4, 196608
    s_lshl_b32 s4, s79, 12
    s_add_u32 s4, s4, 32768

    s_add_u32 s5, s96, 1
    s_and_b32 s5, s5, 3
    s_lshl_b32 s5, s5, 10
    s_add_u32 s5, s5, s4
    v_add_u32 v232, s5, v14

    s_add_u32 s5, s96, 2
    s_and_b32 s5, s5, 3
    s_lshl_b32 s5, s5, 10
    s_add_u32 s5, s5, s4
    v_add_u32 v233, s5, v14

    s_add_u32 s5, s96, 3
    s_and_b32 s5, s5, 3
    s_lshl_b32 s5, s5, 10
    s_add_u32 s5, s5, s4
    v_add_u32 v234, s5, v14

    s_lshl_b32 s5, s78, 9
    v_lshlrev_b32 v10, 8, v6
    v_lshl_add_u32 v10, v2, 4, v10
    v_add_u32 v10, v10, v7
    v_add_u32 v10, s5, v10
    v_add_u32 v18, 16384, v10
    s_lshl_b32 s5, s26, 10
    s_add_u32 s5, s5, 32768
    v_add_u32 v10, s5, v10
    v_lshlrev_b32 v11, 8, v3
    v_lshl_add_u32 v11, v5, 4, v11
    s_lshr_b32 s4, s96, 1
    s_lshl_b32 s4, s4, 10
    s_and_b32 s5, s96, 1
    s_lshl_b32 s5, s5, 7
    s_add_u32 s4, s4, s5
    s_add_u32 s4, s4, 2048
    v_add_u32 v11, s4, v11
    v_lshlrev_b32 v12, 8, v6
    v_lshl_add_u32 v12, v2, 4, v12
    s_lshl_b32 s4, s96, 9
    s_add_u32 s4, s4, 4096
    v_add_u32 v12, s4, v12
    s_lshl_b32 s4, s26, 9
    v_lshlrev_b32 v13, 7, v3
    v_lshl_add_u32 v13, v5, 4, v13
    v_add_u32 v13, s4, v13
    v_add_u32 v13, 16384, v13
    v_lshlrev_b32 v15, 7, v6
    v_lshl_add_u32 v15, v5, 4, v15
    v_add_u32 v15, v15, v7
    s_lshl_b32 s5, s78, 8
    s_add_u32 s5, s5, s4
    v_add_u32 v15, s5, v15
    v_lshlrev_b32 v16, 8, v6
    v_lshl_add_u32 v16, v2, 4, v16
    v_add_u32 v16, v16, v7
    s_lshl_b32 s5, s24, 9
    v_add_u32 v16, s5, v16
    s_lshl_b32 s5, s24, 11
    v_add_u32 v17, s5, v14
    v_cmp_gt_u32 s[58:59], 8, v2
    v_cmp_gt_u32 s[60:61], 32, v1
    v_mov_b32 v4, 0x4444
    v_mov_b32 v9, 0xeeee
    v_cndmask_b32 v9, v9, v4, s[58:59]
    s_not_b64 s[66:67], s[58:59]
    s_cmp_lt_u32 s24, 2
    s_cselect_b64 s[64:65], s[66:67], s[58:59]
    s_mov_b32 s56, 0x0000ffff
    s_mov_b32 s57, 0x0000ffff
    s_cmp_eq_u32 s24, 1
    s_cselect_b64 vcc, -1, 0
    s_cselect_b64 s[66:67], s[56:57], s[66:67]
    s_lshl_b32 s5, s78, 10
    v_add_u32 v19, s5, v14
    v_cndmask_b32 v11, v11, v12, vcc
    v_cndmask_b32 v235, v235, v236, vcc
    v_mov_b32 v4, 0xff800000
    v_cndmask_b32 v116, 0, v4, s[60:61]
    v_mov_b32 v117, v116
    v_mov_b32 v118, v116
    v_mov_b32 v119, v116
    s_lshl_b32 s5, s78, 13
    v_add_u32 v246, s5, v14
    v_lshlrev_b32 v247, 9, v6
    v_lshl_add_u32 v247, v2, 4, v247
    s_lshl_b32 s5, s78, 8
    s_add_u32 s5, s5, 12288
    v_add_u32 v247, s5, v247
    v_and_b32 v4, 31, v1
    v_lshlrev_b32 v248, 4, v4
    s_lshl_b32 s5, s78, 9
    s_add_u32 s5, s5, 12288
    v_add_u32 v248, s5, v248
    s_lshl_b32 s5, s25, 16
    v_and_b32 v7, 1, v3
    v_lshlrev_b32 v237, 18, v7
    v_lshl_add_u32 v237, v6, 8, v237
    v_lshl_add_u32 v237, v2, 4, v237
    v_add_u32 v237, s5, v237
    s_lshl_b32 s6, s78, 9
    v_add_u32 v237, s6, v237
    s_lshl_b32 s6, s78, 8
    v_lshlrev_b32 v249, 9, v7
    v_lshl_add_u32 v249, v2, 4, v249
    v_add_u32 v249, s6, v249
    v_add_u32 v4, s25, v6
    v_add_u32 v4, 1, v4
    v_and_b32 v4, 3, v4
    v_lshl_add_u32 v239, v4, 16, v249
    s_add_u32 s6, s25, 3
    s_and_b32 s6, s6, 3
    s_lshl_b32 s6, s6, 16
    v_add_u32 v249, s6, v249
    v_and_b32 v4, 1, v5
    v_lshlrev_b32 v4, 4, v4
    v_mov_b32 v6, 0x3f80
    v_lshlrev_b32 v6, v4, v6
    v_lshrrev_b32 v4, 1, v5

    v_cmp_eq_u32 vcc, 0, v4
    s_nop 1
    v_cndmask_b32 v84, 0, v6, vcc
    v_cmp_eq_u32 vcc, 1, v4
    s_nop 1
    v_cndmask_b32 v85, 0, v6, vcc
    v_cmp_eq_u32 vcc, 2, v4
    s_nop 1
    v_cndmask_b32 v86, 0, v6, vcc
    v_cmp_eq_u32 vcc, 3, v4
    s_nop 1
    v_cndmask_b32 v87, 0, v6, vcc
    v_mov_b32 v120, 0x3f803f80
    v_cndmask_b32 v112, 0, v84, s[60:61]
    v_mov_b32 v121, 0x3f803f80
    v_cndmask_b32 v113, 0, v85, s[60:61]
    v_mov_b32 v122, 0x3f803f80
    v_cndmask_b32 v114, 0, v86, s[60:61]
    v_mov_b32 v123, 0x3f803f80
    v_cndmask_b32 v115, 0, v87, s[60:61]
    v_mov_b32 v170, 0
    v_mov_b32 v171, 0
    v_mov_b32 v174, 0
    v_mov_b32 v175, 0
    v_mov_b32 v182, 0
    v_mov_b32 v183, 0
    s_add_u32 s5, s96, 0
    s_and_b32 s5, s5, 3
    s_lshl_b32 s5, s5, 10
    s_add_u32 s5, s5, 20480
    v_add_u32 v228, s5, v14

    s_add_u32 s5, s96, 1
    s_and_b32 s5, s5, 3
    s_lshl_b32 s5, s5, 10
    s_add_u32 s5, s5, 20480
    v_add_u32 v229, s5, v14

    s_add_u32 s5, s96, 2
    s_and_b32 s5, s5, 3
    s_lshl_b32 s5, s5, 10
    s_add_u32 s5, s5, 20480
    v_add_u32 v230, s5, v14

    s_add_u32 s5, s96, 3
    s_and_b32 s5, s5, 3
    s_lshl_b32 s5, s5, 10
    s_add_u32 s5, s5, 20480
    v_add_u32 v231, s5, v14

    s_lshl_b32 s89, s7, 8
    s_add_u32 s89, s89, 92282880
    v_lshlrev_b32 v253, 13, v1
    s_lshl_b32 s4, s7, 13
    s_add_u32 s38, s4, 16777216
    s_lshl_b32 s5, s96, 11
    s_add_u32 s39, s4, s5
    s_add_u32 s30, s39, 17301504
    s_add_u32 s39, s39, 33554432
    s_lshl_b32 s5, s78, 24
    s_add_u32 s30, s30, s5
    s_lshl_b32 s5, s78, 12
    s_add_u32 s38, s38, s5
    s_add_u32 s90, s5, 20480
    s_lshl_b32 s5, s78, 10
    s_add_u32 s39, s39, s5
    s_add_u32 s91, s5, 28672
    s_mov_b32 s37, 0x3e0293ee
    s_mov_b32 s28, 0

    v_mov_b32 v52, 0
    v_mov_b32 v53, 0
    v_mov_b32 v54, 0
    v_mov_b32 v55, 0
    v_mov_b32 v56, 0
    v_mov_b32 v57, 0
    v_mov_b32 v58, 0
    v_mov_b32 v59, 0
    v_mov_b32 v60, 0
    v_mov_b32 v61, 0
    v_mov_b32 v62, 0
    v_mov_b32 v63, 0
    v_mov_b32 v64, 0
    v_mov_b32 v65, 0
    v_mov_b32 v66, 0
    v_mov_b32 v67, 0
    v_mov_b32 v68, 0
    v_mov_b32 v69, 0
    v_mov_b32 v70, 0
    v_mov_b32 v71, 0
    v_mov_b32 v72, 0
    v_mov_b32 v73, 0
    v_mov_b32 v74, 0
    v_mov_b32 v75, 0
    v_mov_b32 v76, 0
    v_mov_b32 v77, 0
    v_mov_b32 v78, 0
    v_mov_b32 v79, 0
    v_mov_b32 v80, 0
    v_mov_b32 v81, 0
    v_mov_b32 v82, 0
    v_mov_b32 v83, 0
    v_mov_b32 v92, -1
    v_mov_b32 v93, -1
    v_mov_b32 v94, -1
    v_mov_b32 v95, -1
    v_mov_b32 v96, -1
    v_mov_b32 v97, -1
    v_mov_b32 v98, -1
    v_mov_b32 v99, -1
    v_mov_b32 v100, -1
    v_mov_b32 v101, -1
    v_mov_b32 v102, -1
    v_mov_b32 v103, -1
    v_mov_b32 v192, -1
    v_mov_b32 v193, -1
    v_mov_b32 v194, -1
    v_mov_b32 v195, -1
    v_mov_b32 v196, -1
    v_mov_b32 v197, -1
    v_mov_b32 v198, -1
    v_mov_b32 v199, -1
    v_mov_b32 v200, -1
    v_mov_b32 v201, -1
    v_mov_b32 v202, -1
    v_mov_b32 v203, -1
    v_mov_b32 v204, -1
    v_mov_b32 v205, -1
    v_mov_b32 v206, -1
    v_mov_b32 v207, -1
    v_mov_b32 v208, -1
    v_mov_b32 v209, -1
    v_mov_b32 v210, -1
    v_mov_b32 v211, -1
    v_mov_b32 v212, -1
    v_mov_b32 v213, -1
    v_mov_b32 v214, -1
    v_mov_b32 v215, -1
    v_mov_b32 v216, -1
    v_mov_b32 v217, -1
    v_mov_b32 v218, -1
    v_mov_b32 v219, -1
    v_mov_b32 v220, -1
    v_mov_b32 v221, -1
    v_mov_b32 v222, -1
    v_mov_b32 v223, -1
    s_waitcnt vmcnt(48)
    ds_read_b64_tr_b16 a[0:1], v252 offset:0
    ds_read_b64_tr_b16 a[2:3], v252 offset:128
    ds_read_b64_tr_b16 a[4:5], v252 offset:2048
    ds_read_b64_tr_b16 a[6:7], v252 offset:2176
    ds_read_b64_tr_b16 a[8:9], v252 offset:4096
    ds_read_b64_tr_b16 a[10:11], v252 offset:4224
    ds_read_b64_tr_b16 a[12:13], v252 offset:6144
    ds_read_b64_tr_b16 a[14:15], v252 offset:6272
    ds_read_b64_tr_b16 a[32:33], v252 offset:16
    ds_read_b64_tr_b16 a[34:35], v252 offset:144
    ds_read_b64_tr_b16 a[36:37], v252 offset:2064
    ds_read_b64_tr_b16 a[38:39], v252 offset:2192
    ds_read_b64_tr_b16 a[40:41], v252 offset:4112
    ds_read_b64_tr_b16 a[42:43], v252 offset:4240
    ds_read_b64_tr_b16 a[44:45], v252 offset:6160
    ds_read_b64_tr_b16 a[46:47], v252 offset:6288
    s_waitcnt lgkmcnt(0)
    s_mov_b32 s16, s48
    s_and_b32 s17, s49, 0xffff
    s_mov_b32 s18, 0x800000
    s_mov_b32 s19, 0x00020000

    s_add_u32 m0, s98, 0
    s_mov_b32 s5, 0
    buffer_load_dwordx4 v240, s[16:19], s5 offen lds

    s_add_u32 m0, s98, 1024
    s_mov_b32 s5, 131072
    buffer_load_dwordx4 v240, s[16:19], s5 offen lds

    s_add_u32 m0, s98, 2048
    s_mov_b32 s5, 262144
    buffer_load_dwordx4 v240, s[16:19], s5 offen lds

    s_add_u32 m0, s98, 3072
    s_mov_b32 s5, 393216
    buffer_load_dwordx4 v240, s[16:19], s5 offen lds

    s_add_u32 m0, s98, 4096
    s_mov_b32 s5, 524288
    buffer_load_dwordx4 v240, s[16:19], s5 offen lds

    s_add_u32 m0, s98, 5120
    s_mov_b32 s5, 655360
    buffer_load_dwordx4 v240, s[16:19], s5 offen lds

    s_add_u32 m0, s98, 6144
    s_mov_b32 s5, 786432
    buffer_load_dwordx4 v240, s[16:19], s5 offen lds

    s_add_u32 m0, s98, 7168
    s_mov_b32 s5, 917504
    buffer_load_dwordx4 v240, s[16:19], s5 offen lds

    s_waitcnt vmcnt(48)
    ds_read_b64_tr_b16 a[16:17], v252 offset:8192
    ds_read_b64_tr_b16 a[18:19], v252 offset:8320
    ds_read_b64_tr_b16 a[20:21], v252 offset:10240
    ds_read_b64_tr_b16 a[22:23], v252 offset:10368
    ds_read_b64_tr_b16 a[24:25], v252 offset:12288
    ds_read_b64_tr_b16 a[26:27], v252 offset:12416
    ds_read_b64_tr_b16 a[28:29], v252 offset:14336
    ds_read_b64_tr_b16 a[30:31], v252 offset:14464
    ds_read_b64_tr_b16 a[48:49], v252 offset:8208
    ds_read_b64_tr_b16 a[50:51], v252 offset:8336
    ds_read_b64_tr_b16 a[52:53], v252 offset:10256
    ds_read_b64_tr_b16 a[54:55], v252 offset:10384
    ds_read_b64_tr_b16 a[56:57], v252 offset:12304
    ds_read_b64_tr_b16 a[58:59], v252 offset:12432
    ds_read_b64_tr_b16 a[60:61], v252 offset:14352
    ds_read_b64_tr_b16 a[62:63], v252 offset:14480
    s_waitcnt lgkmcnt(0)
    s_add_u32 m0, s98, 8192
    s_mov_b32 s5, 1048576
    buffer_load_dwordx4 v240, s[16:19], s5 offen lds

    s_add_u32 m0, s98, 9216
    s_mov_b32 s5, 1179648
    buffer_load_dwordx4 v240, s[16:19], s5 offen lds

    s_add_u32 m0, s98, 10240
    s_mov_b32 s5, 1310720
    buffer_load_dwordx4 v240, s[16:19], s5 offen lds

    s_add_u32 m0, s98, 11264
    s_mov_b32 s5, 1441792
    buffer_load_dwordx4 v240, s[16:19], s5 offen lds

    s_add_u32 m0, s98, 12288
    s_mov_b32 s5, 1572864
    buffer_load_dwordx4 v240, s[16:19], s5 offen lds

    s_add_u32 m0, s98, 13312
    s_mov_b32 s5, 1703936
    buffer_load_dwordx4 v240, s[16:19], s5 offen lds

    s_add_u32 m0, s98, 14336
    s_mov_b32 s5, 1835008
    buffer_load_dwordx4 v240, s[16:19], s5 offen lds

    s_add_u32 m0, s98, 15360
    s_mov_b32 s5, 1966080
    buffer_load_dwordx4 v240, s[16:19], s5 offen lds

    s_waitcnt vmcnt(48)
    ds_read_b64_tr_b16 a[64:65], v252 offset:16384
    ds_read_b64_tr_b16 a[66:67], v252 offset:16512
    ds_read_b64_tr_b16 a[68:69], v252 offset:18432
    ds_read_b64_tr_b16 a[70:71], v252 offset:18560
    ds_read_b64_tr_b16 a[72:73], v252 offset:20480
    ds_read_b64_tr_b16 a[74:75], v252 offset:20608
    ds_read_b64_tr_b16 a[76:77], v252 offset:22528
    ds_read_b64_tr_b16 a[78:79], v252 offset:22656
    ds_read_b64_tr_b16 a[96:97], v252 offset:16400
    ds_read_b64_tr_b16 a[98:99], v252 offset:16528
    ds_read_b64_tr_b16 a[100:101], v252 offset:18448
    ds_read_b64_tr_b16 a[102:103], v252 offset:18576
    ds_read_b64_tr_b16 a[104:105], v252 offset:20496
    ds_read_b64_tr_b16 a[106:107], v252 offset:20624
    ds_read_b64_tr_b16 a[108:109], v252 offset:22544
    ds_read_b64_tr_b16 a[110:111], v252 offset:22672
    s_waitcnt lgkmcnt(0)
    s_mov_b32 s16, s50
    s_and_b32 s17, s51, 0xffff
    s_mov_b32 s18, 0x800000
    s_mov_b32 s19, 0x00020000

    s_add_u32 m0, s98, 16384
    s_mov_b32 s5, 0
    buffer_load_dwordx4 v241, s[16:19], s5 offen lds

    s_add_u32 m0, s98, 17408
    s_mov_b32 s5, 32768
    buffer_load_dwordx4 v241, s[16:19], s5 offen lds

    s_add_u32 m0, s98, 18432
    s_mov_b32 s5, 65536
    buffer_load_dwordx4 v241, s[16:19], s5 offen lds

    s_add_u32 m0, s98, 19456
    s_mov_b32 s5, 98304
    buffer_load_dwordx4 v241, s[16:19], s5 offen lds

    s_add_u32 m0, s98, 20480
    s_mov_b32 s5, 131072
    buffer_load_dwordx4 v241, s[16:19], s5 offen lds

    s_add_u32 m0, s98, 21504
    s_mov_b32 s5, 163840
    buffer_load_dwordx4 v241, s[16:19], s5 offen lds

    s_add_u32 m0, s98, 22528
    s_mov_b32 s5, 196608
    buffer_load_dwordx4 v241, s[16:19], s5 offen lds

    s_add_u32 m0, s98, 23552
    s_mov_b32 s5, 229376
    buffer_load_dwordx4 v241, s[16:19], s5 offen lds

    s_waitcnt vmcnt(48)
    ds_read_b64_tr_b16 a[80:81], v252 offset:24576
    ds_read_b64_tr_b16 a[82:83], v252 offset:24704
    ds_read_b64_tr_b16 a[84:85], v252 offset:26624
    ds_read_b64_tr_b16 a[86:87], v252 offset:26752
    ds_read_b64_tr_b16 a[88:89], v252 offset:28672
    ds_read_b64_tr_b16 a[90:91], v252 offset:28800
    ds_read_b64_tr_b16 a[92:93], v252 offset:30720
    ds_read_b64_tr_b16 a[94:95], v252 offset:30848
    ds_read_b64_tr_b16 a[112:113], v252 offset:24592
    ds_read_b64_tr_b16 a[114:115], v252 offset:24720
    ds_read_b64_tr_b16 a[116:117], v252 offset:26640
    ds_read_b64_tr_b16 a[118:119], v252 offset:26768
    ds_read_b64_tr_b16 a[120:121], v252 offset:28688
    ds_read_b64_tr_b16 a[122:123], v252 offset:28816
    ds_read_b64_tr_b16 a[124:125], v252 offset:30736
    ds_read_b64_tr_b16 a[126:127], v252 offset:30864
    s_waitcnt lgkmcnt(0)
    s_add_u32 m0, s98, 24576
    s_mov_b32 s5, 262144
    buffer_load_dwordx4 v241, s[16:19], s5 offen lds

    s_add_u32 m0, s98, 25600
    s_mov_b32 s5, 294912
    buffer_load_dwordx4 v241, s[16:19], s5 offen lds

    s_add_u32 m0, s98, 26624
    s_mov_b32 s5, 327680
    buffer_load_dwordx4 v241, s[16:19], s5 offen lds

    s_add_u32 m0, s98, 27648
    s_mov_b32 s5, 360448
    buffer_load_dwordx4 v241, s[16:19], s5 offen lds

    s_add_u32 m0, s98, 28672
    s_mov_b32 s5, 393216
    buffer_load_dwordx4 v241, s[16:19], s5 offen lds

    s_add_u32 m0, s98, 29696
    s_mov_b32 s5, 425984
    buffer_load_dwordx4 v241, s[16:19], s5 offen lds

    s_add_u32 m0, s98, 30720
    s_mov_b32 s5, 458752
    buffer_load_dwordx4 v241, s[16:19], s5 offen lds

    s_add_u32 m0, s98, 31744
    s_mov_b32 s5, 491520
    buffer_load_dwordx4 v241, s[16:19], s5 offen lds

    s_waitcnt vmcnt(24)
    ds_read_b64_tr_b16 a[128:129], v254 offset:0
    ds_read_b64_tr_b16 a[130:131], v254 offset:128
    ds_read_b64_tr_b16 a[132:133], v254 offset:2048
    ds_read_b64_tr_b16 a[134:135], v254 offset:2176
    ds_read_b64_tr_b16 a[136:137], v254 offset:4096
    ds_read_b64_tr_b16 a[138:139], v254 offset:4224
    ds_read_b64_tr_b16 a[140:141], v254 offset:6144
    ds_read_b64_tr_b16 a[142:143], v254 offset:6272
    ds_read_b64_tr_b16 a[160:161], v254 offset:32
    ds_read_b64_tr_b16 a[162:163], v254 offset:160
    ds_read_b64_tr_b16 a[164:165], v254 offset:2080
    ds_read_b64_tr_b16 a[166:167], v254 offset:2208
    ds_read_b64_tr_b16 a[168:169], v254 offset:4128
    ds_read_b64_tr_b16 a[170:171], v254 offset:4256
    ds_read_b64_tr_b16 a[172:173], v254 offset:6176
    ds_read_b64_tr_b16 a[174:175], v254 offset:6304
    s_cmp_lg_u32 s97, 0
    s_cbranch_scc1 .vd_7
    s_mov_b32 s62, 0

.vp_6:
    v_cmp_ne_u32 vcc, 32, v242
    s_cbranch_vccz .vd_7
    v_readlane_b32 s4, v242, 0

    v_readlane_b32 s5, v242, 1
    s_add_u32 s4, s4, s5
    v_readlane_b32 s5, v242, 2
    s_add_u32 s4, s4, s5
    v_readlane_b32 s5, v242, 3
    s_add_u32 s4, s4, s5
    v_readlane_b32 s5, v242, 4
    s_add_u32 s4, s4, s5
    v_readlane_b32 s5, v242, 5
    s_add_u32 s4, s4, s5
    v_readlane_b32 s5, v242, 6
    s_add_u32 s4, s4, s5
    v_readlane_b32 s5, v242, 7
    s_add_u32 s4, s4, s5
    s_cmp_ge_u32 s4, 256
    s_cbranch_scc1 .vs_8
    s_add_u32 s62, s62, 1
    s_cmp_gt_u32 s62, 0x100000
    s_cbranch_scc1 .mg_end_1
    s_sleep 4
    buffer_load_dword v242, v243, s[20:23], 0 offen sc1
    s_waitcnt vmcnt(0)
    s_branch .vp_6

.vs_8:
    s_lshr_b32 s25, s2, 5
    s_and_b32 s26, s2, 31
    s_mov_b32 s27, 1
    s_mov_b32 s97, 1
    s_waitcnt vmcnt(0) lgkmcnt(0)
    s_barrier
    s_branch .mg_role_3

.vd_7:
    s_mov_b32 s97, 1
    s_barrier
    s_cmp_lg_u32 s24, 3
    s_cbranch_scc1 .sg_9
    s_mov_b64 exec, 1
    v_mov_b32 v4, 1
    v_mov_b32 v5, 32
    buffer_atomic_add v4, v5, s[20:23], 0 offen sc1
    s_mov_b64 exec, -1

.sg_9:
    v_min_u32 v20, 0xfffffffe, v20
    v_min_u32 v21, 0xfffffffe, v21
    v_min_u32 v22, 0xfffffffe, v22
    v_min_u32 v23, 0xfffffffe, v23
    v_min_u32 v24, 0xfffffffe, v24
    v_min_u32 v25, 0xfffffffe, v25
    v_min_u32 v26, 0xfffffffe, v26
    v_min_u32 v27, 0xfffffffe, v27
    v_min_u32 v28, 0xfffffffe, v28
    v_min_u32 v29, 0xfffffffe, v29
    v_min_u32 v30, 0xfffffffe, v30
    v_min_u32 v31, 0xfffffffe, v31
    v_min_u32 v32, 0xfffffffe, v32
    v_min_u32 v33, 0xfffffffe, v33
    v_min_u32 v34, 0xfffffffe, v34
    v_min_u32 v35, 0xfffffffe, v35
    s_waitcnt vmcnt(16)
    ds_read_b64_tr_b16 a[144:145], v254 offset:8192
    ds_read_b64_tr_b16 a[146:147], v254 offset:8320
    ds_read_b64_tr_b16 a[148:149], v254 offset:10240
    ds_read_b64_tr_b16 a[150:151], v254 offset:10368
    ds_read_b64_tr_b16 a[152:153], v254 offset:12288
    ds_read_b64_tr_b16 a[154:155], v254 offset:12416
    ds_read_b64_tr_b16 a[156:157], v254 offset:14336
    ds_read_b64_tr_b16 a[158:159], v254 offset:14464
    ds_read_b64_tr_b16 a[176:177], v254 offset:8224
    ds_read_b64_tr_b16 a[178:179], v254 offset:8352
    ds_read_b64_tr_b16 a[180:181], v254 offset:10272
    ds_read_b64_tr_b16 a[182:183], v254 offset:10400
    ds_read_b64_tr_b16 a[184:185], v254 offset:12320
    ds_read_b64_tr_b16 a[186:187], v254 offset:12448
    ds_read_b64_tr_b16 a[188:189], v254 offset:14368
    ds_read_b64_tr_b16 a[190:191], v254 offset:14496
    s_waitcnt vmcnt(8)
    ds_read_b64_tr_b16 a[192:193], v255 offset:16384
    ds_read_b64_tr_b16 a[194:195], v255 offset:16512
    ds_read_b64_tr_b16 a[196:197], v255 offset:18432
    ds_read_b64_tr_b16 a[198:199], v255 offset:18560
    ds_read_b64_tr_b16 a[200:201], v255 offset:20480
    ds_read_b64_tr_b16 a[202:203], v255 offset:20608
    ds_read_b64_tr_b16 a[204:205], v255 offset:22528
    ds_read_b64_tr_b16 a[206:207], v255 offset:22656
    ds_read_b64_tr_b16 a[224:225], v255 offset:16416
    ds_read_b64_tr_b16 a[226:227], v255 offset:16544
    ds_read_b64_tr_b16 a[228:229], v255 offset:18464
    ds_read_b64_tr_b16 a[230:231], v255 offset:18592
    ds_read_b64_tr_b16 a[232:233], v255 offset:20512
    ds_read_b64_tr_b16 a[234:235], v255 offset:20640
    ds_read_b64_tr_b16 a[236:237], v255 offset:22560
    ds_read_b64_tr_b16 a[238:239], v255 offset:22688
    s_waitcnt vmcnt(0)
    ds_read_b64_tr_b16 a[208:209], v255 offset:24576
    ds_read_b64_tr_b16 a[210:211], v255 offset:24704
    ds_read_b64_tr_b16 a[212:213], v255 offset:26624
    ds_read_b64_tr_b16 a[214:215], v255 offset:26752
    ds_read_b64_tr_b16 a[216:217], v255 offset:28672
    ds_read_b64_tr_b16 a[218:219], v255 offset:28800
    ds_read_b64_tr_b16 a[220:221], v255 offset:30720
    ds_read_b64_tr_b16 a[222:223], v255 offset:30848
    ds_read_b64_tr_b16 a[240:241], v255 offset:24608
    ds_read_b64_tr_b16 a[242:243], v255 offset:24736
    ds_read_b64_tr_b16 a[244:245], v255 offset:26656
    ds_read_b64_tr_b16 a[246:247], v255 offset:26784
    ds_read_b64_tr_b16 a[248:249], v255 offset:28704
    ds_read_b64_tr_b16 a[250:251], v255 offset:28832
    ds_read_b64_tr_b16 a[252:253], v255 offset:30752
    ds_read_b64_tr_b16 a[254:255], v255 offset:30880
    s_barrier
    s_cmp_ge_u32 s24, 2
    s_cbranch_scc1 .px_10
    v_xor_b32 v255, 0x10000, v255
    ds_read_b64_tr_b16 v[124:125], v255 offset:16384
    ds_read_b64_tr_b16 v[126:127], v255 offset:16512
    ds_read_b64_tr_b16 v[128:129], v255 offset:18432
    ds_read_b64_tr_b16 v[130:131], v255 offset:18560
    ds_read_b64_tr_b16 v[132:133], v255 offset:20480
    ds_read_b64_tr_b16 v[134:135], v255 offset:20608
    ds_read_b64_tr_b16 v[136:137], v255 offset:22528
    ds_read_b64_tr_b16 v[138:139], v255 offset:22656
    ds_read_b64_tr_b16 v[156:157], v255 offset:16416
    ds_read_b64_tr_b16 v[158:159], v255 offset:16544
    ds_read_b64_tr_b16 v[160:161], v255 offset:18464
    ds_read_b64_tr_b16 v[162:163], v255 offset:18592
    ds_read_b64_tr_b16 v[164:165], v255 offset:20512
    ds_read_b64_tr_b16 v[166:167], v255 offset:20640
    ds_read_b64_tr_b16 v[168:169], v255 offset:22560
    ds_read_b64_tr_b16 v[170:171], v255 offset:22688
    ds_read_b64_tr_b16 v[140:141], v255 offset:24576
    ds_read_b64_tr_b16 v[142:143], v255 offset:24704
    ds_read_b64_tr_b16 v[144:145], v255 offset:26624
    ds_read_b64_tr_b16 v[146:147], v255 offset:26752
    ds_read_b64_tr_b16 v[148:149], v255 offset:28672
    ds_read_b64_tr_b16 v[150:151], v255 offset:28800
    ds_read_b64_tr_b16 v[152:153], v255 offset:30720
    ds_read_b64_tr_b16 v[154:155], v255 offset:30848
    ds_read_b64_tr_b16 v[172:173], v255 offset:24608
    ds_read_b64_tr_b16 v[174:175], v255 offset:24736
    ds_read_b64_tr_b16 v[176:177], v255 offset:26656
    ds_read_b64_tr_b16 v[178:179], v255 offset:26784
    ds_read_b64_tr_b16 v[180:181], v255 offset:28704
    ds_read_b64_tr_b16 v[182:183], v255 offset:28832
    ds_read_b64_tr_b16 v[184:185], v255 offset:30752
    ds_read_b64_tr_b16 v[186:187], v255 offset:30880
    s_branch .py_11
.px_10:
    s_cmp_eq_u32 s24, 2
    s_cbranch_scc1 .py_11
    s_mov_b32 s62, 0
    v_mov_b32 v6, 32
.pp_12:
    buffer_load_dwordx2 v[4:5], v6, s[20:23], 0 offen sc1
    s_add_u32 s62, s62, 1
    s_cmp_gt_u32 s62, 0x400000
    s_cbranch_scc1 .mg_end_1
    s_waitcnt vmcnt(0)
    v_readfirstlane_b32 s4, v4
    v_readfirstlane_b32 s5, v5
    s_lshr_b32 s5, s5, 21
    s_min_u32 s4, s4, s5
    s_cmp_lt_u32 s4, 256
    s_cbranch_scc1 .pp_12
    v_mov_b32 v4, 163808
    ds_write_b32 v4, v5

.py_11:
    s_waitcnt lgkmcnt(0)
    s_barrier
    v_mov_b32 v4, 163808
    ds_read_b32 v4, v4
    s_waitcnt lgkmcnt(0)
    v_readfirstlane_b32 s7, v4

    s_bfe_u32 s4, s7, 393216
    s_cmp_gt_u32 s4, 8
    s_cselect_b32 s4, 8192, 0
    s_add_u32 s4, s4, s35
    s_add_u32 s68, s4, 0

    s_bfe_u32 s4, s7, 393216
    s_cmp_gt_u32 s4, 8
    s_cselect_b32 s4, 8192, 0
    s_add_u32 s4, s4, s35
    s_add_u32 s69, s4, 1048576

    s_bfe_u32 s4, s7, 393222
    s_cmp_gt_u32 s4, 8
    s_cselect_b32 s4, 8192, 0
    s_add_u32 s4, s4, s35
    s_add_u32 s70, s4, 2097152

    s_bfe_u32 s4, s7, 393222
    s_cmp_gt_u32 s4, 8
    s_cselect_b32 s4, 8192, 0
    s_add_u32 s4, s4, s35
    s_add_u32 s71, s4, 3145728

    s_mov_b32 s62, 0x1000000
    s_cmp_ge_u32 s24, 2
    s_cbranch_scc1 .nd_13
    s_mov_b32 s62, 0
    s_mov_b64 exec, 3
.wf_14:
    buffer_load_dword v244, v253, s[8:11], s89 offen sc1
    s_waitcnt vmcnt(0)
    v_cmp_gt_u32 vcc, 1, v244
    s_cbranch_vccz .wfd_15
    s_sleep 2
    s_add_u32 s62, s62, 1
    s_cmp_gt_u32 s62, 0x400000
    s_cbranch_scc1 .mg_end_1
    s_branch .wf_14

.wfd_15:
    s_mov_b64 exec, -1
    v_readlane_b32 s4, v244, 0
    v_readlane_b32 s93, v244, 1
    s_min_u32 s93, s93, s4
    s_mov_b32 s62, 0x1000000
    s_mov_b32 m0, s90
    s_nop 0
    buffer_load_dwordx4 v14, s[8:11], s38 offen offset:0 lds
    buffer_load_dwordx4 v14, s[8:11], s38 offen offset:1024 lds
    buffer_load_dwordx4 v14, s[8:11], s38 offen offset:2048 lds
    buffer_load_dwordx4 v14, s[8:11], s38 offen offset:3072 lds
    s_mov_b32 m0, s91
    s_nop 0
    buffer_load_dwordx4 v14, s[8:11], s39 offen lds
    s_waitcnt vmcnt(0)
.nd_13:
    s_add_u32 s38, s38, 262144
    s_add_u32 s39, s39, 262144
    s_and_b32 s4, s28, 3
    s_lshl_b32 s5, s4, 16
    s_add_u32 s29, s5, s34
    s_xor_b32 s6, s5, 0x20000
    s_add_u32 s31, s6, s34
    s_add_u32 s32, s29, 16384
    s_add_u32 s33, s29, 20480
    s_barrier
    s_cmp_lg_u32 s27, 0
    s_cbranch_scc1 .ent1_17
    s_branch .ent0_16
.p2align 6
.top_18:
    s_barrier
    buffer_load_dwordx4 v[20:23], v8, s[8:11], s29 offen offset:0 sc1
    buffer_load_dwordx4 v[24:27], v8, s[8:11], s29 offen offset:1024 sc1
    buffer_load_dwordx4 v[28:31], v8, s[8:11], s29 offen offset:2048 sc1
    buffer_load_dwordx4 v[32:35], v8, s[8:11], s29 offen offset:3072 sc1
.ent0_16:
    s_waitcnt vmcnt(3)
    v_max3_u32 v4, v20, v21, v22
    v_max_u32 v4, v4, v23
    v_cmp_eq_u32 vcc, -1, v4
    s_cbranch_vccnz .A_23
.W_24:
    v_smfmac_f32_16x16x64_bf16 v[52:55], v[20:23], a[0:7], v9
    v_smfmac_f32_16x16x64_bf16 v[56:59], v[20:23], a[32:39], v9
    v_smfmac_f32_16x16x64_bf16 v[60:63], v[20:23], a[64:71], v9
    v_smfmac_f32_16x16x64_bf16 v[64:67], v[20:23], a[96:103], v9
    s_waitcnt vmcnt(2)
    v_max3_u32 v4, v24, v25, v26
    v_max_u32 v4, v4, v27
    v_cmp_eq_u32 vcc, -1, v4
    s_cbranch_vccnz .A_25
.W_26:
    v_smfmac_f32_16x16x64_bf16 v[52:55], v[24:27], a[8:15], v9
    v_smfmac_f32_16x16x64_bf16 v[56:59], v[24:27], a[40:47], v9
    v_smfmac_f32_16x16x64_bf16 v[60:63], v[24:27], a[72:79], v9
    v_smfmac_f32_16x16x64_bf16 v[64:67], v[24:27], a[104:111], v9
    s_waitcnt vmcnt(1)
    v_max3_u32 v4, v28, v29, v30
    v_max_u32 v4, v4, v31
    v_cmp_eq_u32 vcc, -1, v4
    s_cbranch_vccnz .A_27
.W_28:
    v_smfmac_f32_16x16x64_bf16 v[52:55], v[28:31], a[16:23], v9
    v_smfmac_f32_16x16x64_bf16 v[56:59], v[28:31], a[48:55], v9
    v_smfmac_f32_16x16x64_bf16 v[60:63], v[28:31], a[80:87], v9
    v_smfmac_f32_16x16x64_bf16 v[64:67], v[28:31], a[112:119], v9
    s_waitcnt vmcnt(2)
    v_max3_u32 v4, v32, v33, v34
    v_max_u32 v4, v4, v35
    v_cmp_eq_u32 vcc, -1, v4
    s_cbranch_vccnz .A_29
.W_30:
    v_smfmac_f32_16x16x64_bf16 v[52:55], v[32:35], a[24:31], v9
    v_smfmac_f32_16x16x64_bf16 v[56:59], v[32:35], a[56:63], v9
    v_smfmac_f32_16x16x64_bf16 v[60:63], v[32:35], a[88:95], v9
    v_smfmac_f32_16x16x64_bf16 v[64:67], v[32:35], a[120:127], v9
.mj_22:
    v_cvt_pk_bf16_f32 v104, v52, v53
    v_cvt_pk_bf16_f32 v105, v54, v55
    v_cvt_pk_bf16_f32 v106, v56, v57
    v_cvt_pk_bf16_f32 v107, v58, v59
    ds_write_b64 v16, v[104:105] offset:4096
    v_cvt_pk_bf16_f32 v108, v60, v61
    v_cvt_pk_bf16_f32 v109, v62, v63
    ds_write_b64 v16, v[106:107] offset:6144
    ds_write_b64 v16, v[108:109] offset:0
    v_cvt_pk_bf16_f32 v110, v64, v65
    v_cvt_pk_bf16_f32 v111, v66, v67
    ds_write_b64 v16, v[110:111] offset:2048
    v_smfmac_f32_16x16x64_bf16 v[68:71], v[20:23], a[128:135], v9
    v_smfmac_f32_16x16x64_bf16 v[72:75], v[20:23], a[160:167], v9
    s_waitcnt vmcnt(4) lgkmcnt(0)
    s_barrier
    ds_read_b128 v[36:39], v17 offset:0
    ds_read_b128 v[40:43], v17 offset:1024
    v_smfmac_f32_16x16x64_bf16 v[68:71], v[24:27], a[136:143], v9
    v_smfmac_f32_16x16x64_bf16 v[72:75], v[24:27], a[168:175], v9
    s_waitcnt lgkmcnt(1)
    v_mfma_f32_16x16x32_bf16 v[44:47], v[36:39], v[84:87], 0
    s_waitcnt lgkmcnt(0)
    v_mfma_f32_16x16x32_bf16 v[44:47], v[40:43], v[84:87], v[44:47]
    v_smfmac_f32_16x16x64_bf16 v[68:71], v[28:31], a[144:151], v9
    v_smfmac_f32_16x16x64_bf16 v[72:75], v[28:31], a[176:183], v9
    s_mov_b64 exec, s[64:65]
    v_cvt_pk_bf16_f32 v48, v44, v45
    v_cvt_pk_bf16_f32 v49, v46, v47
    v_min_u32 v48, 0xfffffffe, v48
    v_min_u32 v49, 0xfffffffe, v49
    buffer_store_dwordx2 v[48:49], v10, s[8:11], s29 offen

    ds_write_b64 v18, v[48:49]
    s_mov_b64 exec, -1

    v_smfmac_f32_16x16x64_bf16 v[68:71], v[32:35], a[152:159], v9
    v_smfmac_f32_16x16x64_bf16 v[72:75], v[32:35], a[184:191], v9
    s_nop 3
    v_cvt_pk_bf16_f32 v104, v68, v69
    v_cvt_pk_bf16_f32 v105, v70, v71
    ds_write_b64 v16, v[104:105] offset:8192
    s_nop 0
    v_cvt_pk_bf16_f32 v106, v72, v73
    v_cvt_pk_bf16_f32 v107, v74, v75
    ds_write_b64 v16, v[106:107] offset:10240
    s_cmp_lg_u32 s24, 2
    s_waitcnt lgkmcnt(0)
    s_barrier
    s_cbranch_scc1 .oth_19
    buffer_load_dwordx4 v[92:95], v232, s[8:11], s29 offen sc1
    buffer_load_dwordx4 v[96:99], v233, s[8:11], s29 offen sc1
    buffer_load_dwordx4 v[100:103], v234, s[8:11], s29 offen sc1
    ds_read_b128 v[88:91], v14 offset:16384
    ds_read_b128 v[128:131], v228 offset:0
    ds_read_b128 v[144:147], v228 offset:4096
    ds_read_b128 v[132:135], v229 offset:0
    ds_read_b128 v[148:151], v229 offset:4096
    ds_read_b128 v[136:139], v230 offset:0
    ds_read_b128 v[152:155], v230 offset:4096
    ds_read_b128 v[140:143], v231 offset:0
    ds_read_b128 v[156:159], v231 offset:4096
    ds_read_b128 v[160:163], v14 offset:28672
    ds_read_b128 v[164:167], v14 offset:29696
    s_cmp_eq_u32 s28, 63
    s_cbranch_scc1 .rec_fin_5
    s_waitcnt lgkmcnt(0)
    v_mfma_f32_16x16x32_bf16 v[208:211], v[128:131], v[88:91], 0
    v_mfma_f32_16x16x32_bf16 v[212:215], v[144:147], v[88:91], 0
    v_mfma_f32_16x16x32_bf16 v[216:219], v[88:91], v[88:91], v[116:119]
    s_waitcnt vmcnt(2)
    v_max3_u32 v4, v92, v93, v94
    v_max_u32 v4, v4, v95
    v_cmp_eq_u32 vcc, -1, v4
    s_cbranch_vccnz .A_32
.W_33:
    v_mfma_f32_16x16x32_bf16 v[208:211], v[132:135], v[92:95], v[208:211]
    v_mfma_f32_16x16x32_bf16 v[212:215], v[148:151], v[92:95], v[212:215]
    v_mfma_f32_16x16x32_bf16 v[216:219], v[92:95], v[92:95], v[216:219]
    s_waitcnt vmcnt(1)
    v_max3_u32 v4, v96, v97, v98
    v_max_u32 v4, v4, v99
    v_cmp_eq_u32 vcc, -1, v4
    s_cbranch_vccnz .A_34
.W_35:
    v_mfma_f32_16x16x32_bf16 v[208:211], v[136:139], v[96:99], v[208:211]
    v_mfma_f32_16x16x32_bf16 v[212:215], v[152:155], v[96:99], v[212:215]
    v_mfma_f32_16x16x32_bf16 v[216:219], v[96:99], v[96:99], v[216:219]
    s_waitcnt vmcnt(2)
    v_max3_u32 v4, v100, v101, v102
    v_max_u32 v4, v4, v103
    v_cmp_eq_u32 vcc, -1, v4
    s_cbranch_vccnz .A_36
.W_37:
    v_mfma_f32_16x16x32_bf16 v[208:211], v[140:143], v[100:103], v[208:211]
    v_mfma_f32_16x16x32_bf16 v[212:215], v[156:159], v[100:103], v[212:215]
    v_mfma_f32_16x16x32_bf16 v[216:219], v[100:103], v[100:103], v[216:219]
.mj_31:
    s_barrier
    ds_read_b64 v[168:169], v14 offset:18432
    ds_read_b64 v[172:173], v14 offset:18440
    s_nop 0

    v_mov_b32_dpp v208, v212 row_ror:8 row_mask:0xf bank_mask:0xc
    v_mov_b32_dpp v209, v213 row_ror:8 row_mask:0xf bank_mask:0xc
    v_mov_b32_dpp v210, v214 row_ror:8 row_mask:0xf bank_mask:0xc
    v_mov_b32_dpp v211, v215 row_ror:8 row_mask:0xf bank_mask:0xc
    v_mov_b32_dpp v216, v218 row_ror:8 row_mask:0xf bank_mask:0xc
    v_mov_b32_dpp v217, v219 row_ror:8 row_mask:0xf bank_mask:0xc
    v_max3_f32 v4, v208, v209, v210
    v_max3_f32 v5, v211, v216, v217
    v_max_f32 v6, v4, v5
    v_max_f32 v4, v4, v5
    s_nop 1
    v_permlane32_swap_b32 v4, v6
    v_max_f32 v5, v4, v6
    v_max_f32 v4, v4, v6
    s_nop 1
    v_permlane16_swap_b32 v4, v5
    v_max_f32 v4, v4, v5
    s_nop 1
    v_max_f32_dpp v4, v4, v4 row_ror:8 row_mask:0xf bank_mask:0xf
    v_mul_f32 v4, s37, v4

    v_fma_f32 v104, v208, s37, -v4
    v_fma_f32 v105, v209, s37, -v4
    v_fma_f32 v106, v210, s37, -v4
    v_fma_f32 v107, v211, s37, -v4
    v_fma_f32 v108, v216, s37, -v4
    v_fma_f32 v109, v217, s37, -v4
    v_exp_f32 v104, v104
    v_exp_f32 v105, v105
    v_exp_f32 v106, v106
    v_exp_f32 v107, v107
    v_exp_f32 v108, v108
    v_exp_f32 v109, v109
    v_cvt_pk_bf16_f32 v176, v104, v105
    v_cvt_pk_bf16_f32 v177, v106, v107
    v_cvt_pk_bf16_f32 v180, v108, v109
    v_mov_b32_dpp v178, v176 row_ror:8 row_mask:0xf bank_mask:0xf
    v_mov_b32_dpp v179, v177 row_ror:8 row_mask:0xf bank_mask:0xf
    v_mov_b32_dpp v181, v180 row_ror:8 row_mask:0xf bank_mask:0xf
    s_waitcnt lgkmcnt(0)

    v_mfma_f32_16x16x32_bf16 v[208:211], v[120:123], v[176:179], 0
    v_mfma_f32_16x16x32_bf16 v[208:211], v[120:123], v[180:183], v[208:211]
    v_mfma_f32_16x16x32_bf16 v[212:215], v[160:163], v[176:179], 0
    v_mfma_f32_16x16x32_bf16 v[216:219], v[164:167], v[176:179], 0
    v_mfma_f32_16x16x32_bf16 v[212:215], v[168:171], v[180:183], v[212:215]
    v_rcp_f32 v4, v208
    v_mfma_f32_16x16x32_bf16 v[216:219], v[172:175], v[180:183], v[216:219]
    s_mov_b64 exec, s[58:59]
    s_nop 2
    v_mul_f32 v212, v4, v212
    v_mul_f32 v213, v4, v213
    v_mul_f32 v214, v4, v214
    v_mul_f32 v215, v4, v215
    v_cvt_pk_bf16_f32 v184, v212, v213
    v_cvt_pk_bf16_f32 v185, v214, v215
    v_mul_f32 v216, v4, v216
    v_mul_f32 v217, v4, v217
    v_min_u32 v184, 0xfffffffe, v184
    v_min_u32 v185, 0xfffffffe, v185
    v_mul_f32 v218, v4, v218
    v_mul_f32 v219, v4, v219
    v_cvt_pk_bf16_f32 v186, v216, v217
    v_cvt_pk_bf16_f32 v187, v218, v219
    v_min_u32 v186, 0xfffffffe, v186
    v_min_u32 v187, 0xfffffffe, v187
    buffer_store_dwordx4 v[184:187], v13, s[8:11], s29 offen
    s_mov_b64 exec, -1

.gp_21:
    s_barrier
    s_mov_b32 s99, s68
    s_add_u32 s28, s28, 1
    s_add_u32 s36, s36, 196608
    s_add_u32 s38, s38, 262144
    s_add_u32 s39, s39, 262144
    s_add_u32 s30, s30, 262144
    s_mov_b32 s4, s68
    s_mov_b32 s68, s69
    s_mov_b32 s69, s70
    s_mov_b32 s70, s71
    s_mov_b32 s71, s4
    s_and_b32 s4, s28, 3
    s_lshl_b32 s5, s4, 16
    s_add_u32 s29, s5, s34
    s_xor_b32 s6, s5, 0x20000
    s_add_u32 s31, s6, s34
    s_add_u32 s32, s29, 16384
    s_add_u32 s33, s29, 20480
    s_waitcnt vmcnt(0)
    s_barrier
    s_add_u32 s4, s99, 0
    buffer_load_dwordx4 v[192:195], v239, s[8:11], s4 offen sc1
    buffer_load_dwordx4 v[196:199], v249, s[8:11], s4 offen sc1

    s_barrier
    ds_read_b128 v[108:111], v248
    s_add_u32 s4, s99, 262144
    buffer_load_dwordx4 v[200:203], v239, s[8:11], s4 offen sc1
    buffer_load_dwordx4 v[204:207], v249, s[8:11], s4 offen sc1

    v_mov_b32 v52, 0
    v_mov_b32 v53, 0
    v_mov_b32 v54, 0
    v_mov_b32 v55, 0
    v_mov_b32 v56, 0
    v_mov_b32 v57, 0
    v_mov_b32 v58, 0
    v_mov_b32 v59, 0
    v_mov_b32 v60, 0
    v_mov_b32 v61, 0
    v_mov_b32 v62, 0
    v_mov_b32 v63, 0
    v_mov_b32 v64, 0
    v_mov_b32 v65, 0
    v_mov_b32 v66, 0
    v_mov_b32 v67, 0
    v_mov_b32 v68, 0
    v_mov_b32 v69, 0
    v_mov_b32 v70, 0
    v_mov_b32 v71, 0
    v_mov_b32 v72, 0
    v_mov_b32 v73, 0
    v_mov_b32 v74, 0
    v_mov_b32 v75, 0
    v_mov_b32 v20, -1
    v_mov_b32 v21, -1
    v_mov_b32 v22, -1
    v_mov_b32 v23, -1
    v_mov_b32 v24, -1
    v_mov_b32 v25, -1
    v_mov_b32 v26, -1
    v_mov_b32 v27, -1
    v_mov_b32 v28, -1
    v_mov_b32 v29, -1
    v_mov_b32 v30, -1
    v_mov_b32 v31, -1
    v_mov_b32 v32, -1
    v_mov_b32 v33, -1
    v_mov_b32 v34, -1
    v_mov_b32 v35, -1
    v_mov_b32 v92, -1
    v_mov_b32 v93, -1
    v_mov_b32 v94, -1
    v_mov_b32 v95, -1
    v_mov_b32 v96, -1
    v_mov_b32 v97, -1
    v_mov_b32 v98, -1
    v_mov_b32 v99, -1
    v_mov_b32 v100, -1
    v_mov_b32 v101, -1
    v_mov_b32 v102, -1
    v_mov_b32 v103, -1
    s_waitcnt lgkmcnt(0)
    v_mfma_f32_16x16x32_bf16 v[76:79], v[108:111], v[112:115], 0
.gc_38:
    s_waitcnt vmcnt(2)
    v_max_u32 v4, v192, v196
    v_cmp_eq_u32 vcc, -1, v4
    s_cbranch_vccnz .gf_39

    v_mfma_f32_16x16x32_bf16 v[76:79], v[192:195], v[84:87], v[76:79]
    v_mfma_f32_16x16x32_bf16 v[76:79], v[196:199], v[112:115], v[76:79]
    s_mov_b64 exec, s[58:59]
    s_nop 6
    v_cvt_pk_bf16_f32 v104, v76, v77
    v_cvt_pk_bf16_f32 v105, v78, v79
    v_min_u32 v104, 0xfffffffe, v104
    v_min_u32 v105, 0xfffffffe, v105
    buffer_store_dwordx2 v[104:105], v15, s[8:11], s29 offen
    s_mov_b64 exec, -1

    s_branch .top_18
.gf_39:
    s_add_u32 s4, s99, 0
    buffer_load_dwordx4 v[192:195], v239, s[8:11], s4 offen sc1
    buffer_load_dwordx4 v[196:199], v249, s[8:11], s4 offen sc1

    s_waitcnt vmcnt(2)
    v_max_u32 v4, v200, v204
    v_cmp_eq_u32 vcc, -1, v4
    s_cbranch_vccnz .gf_40

    v_mfma_f32_16x16x32_bf16 v[76:79], v[200:203], v[84:87], v[76:79]
    v_mfma_f32_16x16x32_bf16 v[76:79], v[204:207], v[112:115], v[76:79]
    s_mov_b64 exec, s[58:59]
    s_nop 6
    v_cvt_pk_bf16_f32 v104, v76, v77
    v_cvt_pk_bf16_f32 v105, v78, v79
    v_min_u32 v104, 0xfffffffe, v104
    v_min_u32 v105, 0xfffffffe, v105
    buffer_store_dwordx2 v[104:105], v15, s[8:11], s29 offen
    s_mov_b64 exec, -1

    s_branch .top_18
.gf_40:
    s_add_u32 s4, s99, 262144
    buffer_load_dwordx4 v[200:203], v239, s[8:11], s4 offen sc1
    buffer_load_dwordx4 v[204:207], v249, s[8:11], s4 offen sc1

    s_sub_u32 s62, s62, 1
    s_cbranch_scc1 .mg_end_1
    s_branch .gc_38
.oth_19:
    s_cmp_eq_u32 s24, 3
    s_cbranch_scc1 .w3_20
    s_cmp_eq_u32 s28, 63
    s_cbranch_scc1 .rec_fin_5
    s_waitcnt vmcnt(0)
    v_readlane_b32 s4, v244, 0
    v_readlane_b32 s93, v244, 1
    s_min_u32 s93, s93, s4
    v_mov_b32 v20, -1
    v_mov_b32 v21, -1
    v_mov_b32 v22, -1
    v_mov_b32 v23, -1
    v_mov_b32 v24, -1
    v_mov_b32 v25, -1
    v_mov_b32 v26, -1
    v_mov_b32 v27, -1
    v_mov_b32 v28, -1
    v_mov_b32 v29, -1
    v_mov_b32 v30, -1
    v_mov_b32 v31, -1
    v_mov_b32 v32, -1
    v_mov_b32 v33, -1
    v_mov_b32 v34, -1
    v_mov_b32 v35, -1
    v_mov_b32 v52, 0
    v_mov_b32 v53, 0
    v_mov_b32 v54, 0
    v_mov_b32 v55, 0
    v_mov_b32 v56, 0
    v_mov_b32 v57, 0
    v_mov_b32 v58, 0
    v_mov_b32 v59, 0
    v_mov_b32 v60, 0
    v_mov_b32 v61, 0
    v_mov_b32 v62, 0
    v_mov_b32 v63, 0
    v_mov_b32 v64, 0
    v_mov_b32 v65, 0
    v_mov_b32 v66, 0
    v_mov_b32 v67, 0
    v_mov_b32 v68, 0
    v_mov_b32 v69, 0
    v_mov_b32 v70, 0
    v_mov_b32 v71, 0
    v_mov_b32 v72, 0
    v_mov_b32 v73, 0
    v_mov_b32 v74, 0
    v_mov_b32 v75, 0
    s_barrier
    ds_read_b128 v[88:91], v19 offset:16384
    s_barrier
    buffer_load_dwordx4 v[192:195], v246, s[8:11], s32 offen offset:0 sc1
    buffer_load_dwordx4 v[196:199], v246, s[8:11], s32 offen offset:1024 sc1
    buffer_load_dwordx4 v[200:203], v246, s[8:11], s32 offen offset:2048 sc1
    buffer_load_dwordx4 v[204:207], v246, s[8:11], s32 offen offset:3072 sc1
    buffer_load_dwordx4 v[208:211], v246, s[8:11], s33 offen offset:0 sc1
    buffer_load_dwordx4 v[212:215], v246, s[8:11], s33 offen offset:1024 sc1
    buffer_load_dwordx4 v[216:219], v246, s[8:11], s33 offen offset:2048 sc1
    buffer_load_dwordx4 v[220:223], v246, s[8:11], s33 offen offset:3072 sc1
    s_waitcnt vmcnt(6)
    v_max3_u32 v4, v192, v193, v194
    v_max3_u32 v5, v195, v196, v197
    v_max3_u32 v4, v4, v198, v199
    v_max_u32 v4, v4, v5
    v_cmp_eq_u32 vcc, -1, v4

    s_cbranch_vccnz .A_42
.W_43:
    v_smfmac_f32_16x16x64_bf16 v[76:79], v[192:195], a[192:199], v9
    v_smfmac_f32_16x16x64_bf16 v[80:83], v[192:195], a[224:231], v9
    v_smfmac_f32_16x16x64_bf16 v[76:79], v[196:199], a[200:207], v9
    v_smfmac_f32_16x16x64_bf16 v[80:83], v[196:199], a[232:239], v9
    s_waitcnt vmcnt(4)
    v_max3_u32 v4, v200, v201, v202
    v_max3_u32 v5, v203, v204, v205
    v_max3_u32 v4, v4, v206, v207
    v_max_u32 v4, v4, v5
    v_cmp_eq_u32 vcc, -1, v4

    s_cbranch_vccnz .A_44
.W_45:
    v_smfmac_f32_16x16x64_bf16 v[76:79], v[200:203], a[208:215], v9
    v_smfmac_f32_16x16x64_bf16 v[80:83], v[200:203], a[240:247], v9
    v_smfmac_f32_16x16x64_bf16 v[76:79], v[204:207], a[216:223], v9
    v_smfmac_f32_16x16x64_bf16 v[80:83], v[204:207], a[248:255], v9
    s_waitcnt vmcnt(2)
    v_max3_u32 v4, v208, v209, v210
    v_max3_u32 v5, v211, v212, v213
    v_max3_u32 v4, v4, v214, v215
    v_max_u32 v4, v4, v5
    v_cmp_eq_u32 vcc, -1, v4

    s_cbranch_vccnz .A_46
.W_47:
    v_smfmac_f32_16x16x64_bf16 v[76:79], v[208:211], v[124:131], v9
    v_smfmac_f32_16x16x64_bf16 v[80:83], v[208:211], v[156:163], v9
    v_smfmac_f32_16x16x64_bf16 v[76:79], v[212:215], v[132:139], v9
    v_smfmac_f32_16x16x64_bf16 v[80:83], v[212:215], v[164:171], v9
    s_waitcnt vmcnt(4)
    v_max3_u32 v4, v216, v217, v218
    v_max3_u32 v5, v219, v220, v221
    v_max3_u32 v4, v4, v222, v223
    v_max_u32 v4, v4, v5
    v_cmp_eq_u32 vcc, -1, v4

    s_cbranch_vccnz .A_48
.W_49:
    v_smfmac_f32_16x16x64_bf16 v[76:79], v[216:219], v[140:147], v9
    v_smfmac_f32_16x16x64_bf16 v[80:83], v[216:219], v[172:179], v9
    v_smfmac_f32_16x16x64_bf16 v[76:79], v[220:223], v[148:155], v9
    v_smfmac_f32_16x16x64_bf16 v[80:83], v[220:223], v[180:187], v9
.mj_41:
    s_waitcnt vmcnt(8)
    s_barrier
    s_nop 5
    v_permlane32_swap_b32 v76, v80
    v_permlane32_swap_b32 v77, v81
    v_permlane32_swap_b32 v78, v82
    v_permlane32_swap_b32 v79, v83
    v_add_f32 v76, v76, v80
    v_add_f32 v77, v77, v81
    v_add_f32 v78, v78, v82
    v_add_f32 v79, v79, v83
    v_cvt_pk_bf16_f32 v104, v76, v77
    v_cvt_pk_bf16_f32 v106, v76, v77
    v_cvt_pk_bf16_f32 v105, v78, v79
    v_cvt_pk_bf16_f32 v107, v78, v79
    v_permlane16_swap_b32 v104, v106
    s_nop 0
    v_permlane16_swap_b32 v105, v107
    v_min_u32 v104, 0xfffffffe, v104
    buffer_store_dwordx4 v[104:107], v237, s[8:11], s68 offen sc1

    ds_write_b128 v247, v[104:107]
    s_waitcnt lgkmcnt(0)
    s_barrier
    v_mov_b32 v76, 0
    v_mov_b32 v77, 0
    v_mov_b32 v78, 0
    v_mov_b32 v79, 0
    v_mov_b32 v80, 0
    v_mov_b32 v81, 0
    v_mov_b32 v82, 0
    v_mov_b32 v83, 0
    s_waitcnt vmcnt(1)
    v_mov_b32 v192, -1
    v_mov_b32 v193, -1
    v_mov_b32 v194, -1
    v_mov_b32 v195, -1
    v_mov_b32 v196, -1
    v_mov_b32 v197, -1
    v_mov_b32 v198, -1
    v_mov_b32 v199, -1
    v_mov_b32 v200, -1
    v_mov_b32 v201, -1
    v_mov_b32 v202, -1
    v_mov_b32 v203, -1
    v_mov_b32 v204, -1
    v_mov_b32 v205, -1
    v_mov_b32 v206, -1
    v_mov_b32 v207, -1
    v_mov_b32 v208, -1
    v_mov_b32 v209, -1
    v_mov_b32 v210, -1
    v_mov_b32 v211, -1
    v_mov_b32 v212, -1
    v_mov_b32 v213, -1
    v_mov_b32 v214, -1
    v_mov_b32 v215, -1
    v_mov_b32 v216, -1
    v_mov_b32 v217, -1
    v_mov_b32 v218, -1
    v_mov_b32 v219, -1
    v_mov_b32 v220, -1
    v_mov_b32 v221, -1
    v_mov_b32 v222, -1
    v_mov_b32 v223, -1
    s_add_u32 s6, s28, 2
    s_cmp_lt_u32 s93, s6
    s_cbranch_scc1 .kf_50
.kb_51:
    s_mov_b32 m0, s90
    s_nop 0
    buffer_load_dwordx4 v14, s[8:11], s38 offen offset:0 lds
    buffer_load_dwordx4 v14, s[8:11], s38 offen offset:1024 lds
    buffer_load_dwordx4 v14, s[8:11], s38 offen offset:2048 lds
    buffer_load_dwordx4 v14, s[8:11], s38 offen offset:3072 lds
    s_mov_b32 m0, s91
    s_nop 0
    buffer_load_dwordx4 v14, s[8:11], s39 offen lds
    s_mov_b64 exec, 3
    buffer_load_dword v244, v253, s[8:11], s89 offen sc1
    s_mov_b64 exec, -1

    s_lshl_b32 s4, s78, 18
    s_add_u32 s4, s4, s70
    buffer_store_dwordx4 v[188:191], v238, s[8:11], s4 offen sc1
    s_add_u32 s4, s4, 524288
    s_mov_b64 exec, s[66:67]
    buffer_store_dwordx4 v[88:91], v11, s[8:11], s36 offen sc1
    s_mov_b64 exec, -1
    s_add_u32 s6, s28, 3
    s_cmp_lt_u32 s93, s6
    s_cbranch_scc1 .nf_52
    s_buffer_load_dword s98, s[8:11], s30 offset:0
    s_buffer_load_dword s98, s[8:11], s30 offset:128
    s_buffer_load_dword s98, s[8:11], s30 offset:256
    s_buffer_load_dword s98, s[8:11], s30 offset:384
    s_buffer_load_dword s98, s[8:11], s30 offset:512
    s_buffer_load_dword s98, s[8:11], s30 offset:640
    s_buffer_load_dword s98, s[8:11], s30 offset:768
    s_buffer_load_dword s98, s[8:11], s30 offset:896
    s_buffer_load_dword s98, s[8:11], s30 offset:1024
    s_buffer_load_dword s98, s[8:11], s30 offset:1152
    s_buffer_load_dword s98, s[8:11], s30 offset:1280
    s_buffer_load_dword s98, s[8:11], s30 offset:1408
    s_buffer_load_dword s98, s[8:11], s30 offset:1536
    s_buffer_load_dword s98, s[8:11], s30 offset:1664
    s_buffer_load_dword s98, s[8:11], s30 offset:1792
    s_buffer_load_dword s98, s[8:11], s30 offset:1920
.nf_52:
    s_add_u32 s28, s28, 1
    s_add_u32 s36, s36, 196608
    s_add_u32 s38, s38, 262144
    s_add_u32 s39, s39, 262144
    s_add_u32 s30, s30, 262144
    s_mov_b32 s4, s68
    s_mov_b32 s68, s69
    s_mov_b32 s69, s70
    s_mov_b32 s70, s71
    s_mov_b32 s71, s4
    s_and_b32 s4, s28, 3
    s_lshl_b32 s5, s4, 16
    s_add_u32 s29, s5, s34
    s_xor_b32 s6, s5, 0x20000
    s_add_u32 s31, s6, s34
    s_add_u32 s32, s29, 16384
    s_add_u32 s33, s29, 20480
    s_branch .top_18
.w3_20:
    ds_read_b128 v[36:39], v14 offset:8192
    ds_read_b128 v[40:43], v14 offset:9216
    ds_read_b128 v[44:47], v14 offset:10240
    ds_read_b128 v[48:51], v14 offset:11264
    ds_read_b128 v[88:91], v14 offset:16384
    s_waitcnt lgkmcnt(0)
    v_mfma_f32_16x16x32_bf16 v[104:107], v[84:87], v[36:39], 0
    v_mfma_f32_16x16x32_bf16 v[108:111], v[84:87], v[44:47], 0
    v_mfma_f32_16x16x32_bf16 v[104:107], v[84:87], v[40:43], v[104:107]
    v_mfma_f32_16x16x32_bf16 v[108:111], v[84:87], v[48:51], v[108:111]
    s_nop 7
    v_cvt_pk_bf16_f32 v168, v104, v105
    v_cvt_pk_bf16_f32 v169, v106, v107
    v_cvt_pk_bf16_f32 v170, v108, v109
    v_cvt_pk_bf16_f32 v171, v110, v111
    ds_write_b128 v14, v[168:171] offset:18432
    v_cndmask_b32 v172, v170, v168, s[60:61]
    v_cndmask_b32 v173, v171, v169, s[60:61]
    v_min_u32 v172, 0xfffffffe, v172
    v_min_u32 v173, 0xfffffffe, v173
    v_mov_b32 v174, v172
    v_mov_b32 v175, v173
    s_cmp_eq_u32 s28, 63
    s_nop 0
    v_permlane16_swap_b32 v172, v174
    v_permlane16_swap_b32 v173, v175
    ds_write_b128 v14, v[172:175] offset:17408

    s_cbranch_scc1 .sk_53
    s_waitcnt lgkmcnt(0)
    s_barrier
    buffer_store_dwordx4 v[188:191], v235, s[8:11], s31 offen
    buffer_store_dwordx4 v[188:191], v236, s[8:11], s31 offen

    s_branch .gp_21
.A_54:
    buffer_load_dwordx4 v[32:35], v8, s[8:11], s29 offen offset:3072 sc1
    s_sub_u32 s62, s62, 1
    s_cbranch_scc1 .mg_end_1
    s_waitcnt vmcnt(3)
    v_max3_u32 v4, v20, v21, v22
    v_max_u32 v4, v4, v23
    v_cmp_eq_u32 vcc, -1, v4
    s_cbranch_vccz .W_24
.A_23:
    buffer_load_dwordx4 v[20:23], v8, s[8:11], s29 offen offset:0 sc1
    s_waitcnt vmcnt(3)
    v_max3_u32 v4, v24, v25, v26
    v_max_u32 v4, v4, v27
    v_cmp_eq_u32 vcc, -1, v4
    s_cbranch_vccz .W_55
.A_56:
    buffer_load_dwordx4 v[24:27], v8, s[8:11], s29 offen offset:1024 sc1
    s_waitcnt vmcnt(3)
    v_max3_u32 v4, v28, v29, v30
    v_max_u32 v4, v4, v31
    v_cmp_eq_u32 vcc, -1, v4
    s_cbranch_vccz .W_57
.A_58:
    buffer_load_dwordx4 v[28:31], v8, s[8:11], s29 offen offset:2048 sc1
    s_waitcnt vmcnt(3)
    v_max3_u32 v4, v32, v33, v34
    v_max_u32 v4, v4, v35
    v_cmp_eq_u32 vcc, -1, v4
    s_cbranch_vccnz .A_54
.W_59:
    v_smfmac_f32_16x16x64_bf16 v[52:55], v[32:35], a[24:31], v9
    v_smfmac_f32_16x16x64_bf16 v[56:59], v[32:35], a[56:63], v9
    v_smfmac_f32_16x16x64_bf16 v[60:63], v[32:35], a[88:95], v9
    v_smfmac_f32_16x16x64_bf16 v[64:67], v[32:35], a[120:127], v9
    s_waitcnt vmcnt(2)
    v_max3_u32 v4, v20, v21, v22
    v_max_u32 v4, v4, v23
    v_cmp_eq_u32 vcc, -1, v4
    s_cbranch_vccnz .A_60
.W_61:
    v_smfmac_f32_16x16x64_bf16 v[52:55], v[20:23], a[0:7], v9
    v_smfmac_f32_16x16x64_bf16 v[56:59], v[20:23], a[32:39], v9
    v_smfmac_f32_16x16x64_bf16 v[60:63], v[20:23], a[64:71], v9
    v_smfmac_f32_16x16x64_bf16 v[64:67], v[20:23], a[96:103], v9
    s_waitcnt vmcnt(1)
    v_max3_u32 v4, v24, v25, v26
    v_max_u32 v4, v4, v27
    v_cmp_eq_u32 vcc, -1, v4
    s_cbranch_vccnz .A_62
.W_63:
    v_smfmac_f32_16x16x64_bf16 v[52:55], v[24:27], a[8:15], v9
    v_smfmac_f32_16x16x64_bf16 v[56:59], v[24:27], a[40:47], v9
    v_smfmac_f32_16x16x64_bf16 v[60:63], v[24:27], a[72:79], v9
    v_smfmac_f32_16x16x64_bf16 v[64:67], v[24:27], a[104:111], v9
    s_waitcnt vmcnt(2)
    v_max3_u32 v4, v28, v29, v30
    v_max_u32 v4, v4, v31
    v_cmp_eq_u32 vcc, -1, v4
    s_cbranch_vccnz .A_64
.W_65:
    v_smfmac_f32_16x16x64_bf16 v[52:55], v[28:31], a[16:23], v9
    v_smfmac_f32_16x16x64_bf16 v[56:59], v[28:31], a[48:55], v9
    v_smfmac_f32_16x16x64_bf16 v[60:63], v[28:31], a[80:87], v9
    v_smfmac_f32_16x16x64_bf16 v[64:67], v[28:31], a[112:119], v9
    s_branch .mj_22
.W_55:
    v_smfmac_f32_16x16x64_bf16 v[52:55], v[24:27], a[8:15], v9
    v_smfmac_f32_16x16x64_bf16 v[56:59], v[24:27], a[40:47], v9
    v_smfmac_f32_16x16x64_bf16 v[60:63], v[24:27], a[72:79], v9
    v_smfmac_f32_16x16x64_bf16 v[64:67], v[24:27], a[104:111], v9
    s_waitcnt vmcnt(2)
    v_max3_u32 v4, v28, v29, v30
    v_max_u32 v4, v4, v31
    v_cmp_eq_u32 vcc, -1, v4
    s_cbranch_vccnz .A_66
.W_67:
    v_smfmac_f32_16x16x64_bf16 v[52:55], v[28:31], a[16:23], v9
    v_smfmac_f32_16x16x64_bf16 v[56:59], v[28:31], a[48:55], v9
    v_smfmac_f32_16x16x64_bf16 v[60:63], v[28:31], a[80:87], v9
    v_smfmac_f32_16x16x64_bf16 v[64:67], v[28:31], a[112:119], v9
    s_waitcnt vmcnt(1)
    v_max3_u32 v4, v32, v33, v34
    v_max_u32 v4, v4, v35
    v_cmp_eq_u32 vcc, -1, v4
    s_cbranch_vccnz .A_68
.W_69:
    v_smfmac_f32_16x16x64_bf16 v[52:55], v[32:35], a[24:31], v9
    v_smfmac_f32_16x16x64_bf16 v[56:59], v[32:35], a[56:63], v9
    v_smfmac_f32_16x16x64_bf16 v[60:63], v[32:35], a[88:95], v9
    v_smfmac_f32_16x16x64_bf16 v[64:67], v[32:35], a[120:127], v9
    s_waitcnt vmcnt(2)
    v_max3_u32 v4, v20, v21, v22
    v_max_u32 v4, v4, v23
    v_cmp_eq_u32 vcc, -1, v4
    s_cbranch_vccnz .A_70
.W_71:
    v_smfmac_f32_16x16x64_bf16 v[52:55], v[20:23], a[0:7], v9
    v_smfmac_f32_16x16x64_bf16 v[56:59], v[20:23], a[32:39], v9
    v_smfmac_f32_16x16x64_bf16 v[60:63], v[20:23], a[64:71], v9
    v_smfmac_f32_16x16x64_bf16 v[64:67], v[20:23], a[96:103], v9
    s_branch .mj_22
.W_57:
    v_smfmac_f32_16x16x64_bf16 v[52:55], v[28:31], a[16:23], v9
    v_smfmac_f32_16x16x64_bf16 v[56:59], v[28:31], a[48:55], v9
    v_smfmac_f32_16x16x64_bf16 v[60:63], v[28:31], a[80:87], v9
    v_smfmac_f32_16x16x64_bf16 v[64:67], v[28:31], a[112:119], v9
    s_waitcnt vmcnt(2)
    v_max3_u32 v4, v32, v33, v34
    v_max_u32 v4, v4, v35
    v_cmp_eq_u32 vcc, -1, v4
    s_cbranch_vccnz .A_72
.W_73:
    v_smfmac_f32_16x16x64_bf16 v[52:55], v[32:35], a[24:31], v9
    v_smfmac_f32_16x16x64_bf16 v[56:59], v[32:35], a[56:63], v9
    v_smfmac_f32_16x16x64_bf16 v[60:63], v[32:35], a[88:95], v9
    v_smfmac_f32_16x16x64_bf16 v[64:67], v[32:35], a[120:127], v9
    s_waitcnt vmcnt(1)
    v_max3_u32 v4, v20, v21, v22
    v_max_u32 v4, v4, v23
    v_cmp_eq_u32 vcc, -1, v4
    s_cbranch_vccnz .A_74
.W_75:
    v_smfmac_f32_16x16x64_bf16 v[52:55], v[20:23], a[0:7], v9
    v_smfmac_f32_16x16x64_bf16 v[56:59], v[20:23], a[32:39], v9
    v_smfmac_f32_16x16x64_bf16 v[60:63], v[20:23], a[64:71], v9
    v_smfmac_f32_16x16x64_bf16 v[64:67], v[20:23], a[96:103], v9
    s_waitcnt vmcnt(2)
    v_max3_u32 v4, v24, v25, v26
    v_max_u32 v4, v4, v27
    v_cmp_eq_u32 vcc, -1, v4
    s_cbranch_vccnz .A_76
.W_77:
    v_smfmac_f32_16x16x64_bf16 v[52:55], v[24:27], a[8:15], v9
    v_smfmac_f32_16x16x64_bf16 v[56:59], v[24:27], a[40:47], v9
    v_smfmac_f32_16x16x64_bf16 v[60:63], v[24:27], a[72:79], v9
    v_smfmac_f32_16x16x64_bf16 v[64:67], v[24:27], a[104:111], v9
    s_branch .mj_22
.A_78:
    buffer_load_dwordx4 v[28:31], v8, s[8:11], s29 offen offset:2048 sc1
    s_sub_u32 s62, s62, 1
    s_cbranch_scc1 .mg_end_1
    s_waitcnt vmcnt(2)
    v_max3_u32 v4, v20, v21, v22
    v_max_u32 v4, v4, v23
    v_cmp_eq_u32 vcc, -1, v4
    s_cbranch_vccz .W_61
.A_60:
    buffer_load_dwordx4 v[20:23], v8, s[8:11], s29 offen offset:0 sc1
    s_waitcnt vmcnt(2)
    v_max3_u32 v4, v24, v25, v26
    v_max_u32 v4, v4, v27
    v_cmp_eq_u32 vcc, -1, v4
    s_cbranch_vccz .W_79
.A_80:
    buffer_load_dwordx4 v[24:27], v8, s[8:11], s29 offen offset:1024 sc1
    s_waitcnt vmcnt(2)
    v_max3_u32 v4, v28, v29, v30
    v_max_u32 v4, v4, v31
    v_cmp_eq_u32 vcc, -1, v4
    s_cbranch_vccnz .A_78
.W_81:
    v_smfmac_f32_16x16x64_bf16 v[52:55], v[28:31], a[16:23], v9
    v_smfmac_f32_16x16x64_bf16 v[56:59], v[28:31], a[48:55], v9
    v_smfmac_f32_16x16x64_bf16 v[60:63], v[28:31], a[80:87], v9
    v_smfmac_f32_16x16x64_bf16 v[64:67], v[28:31], a[112:119], v9
    s_waitcnt vmcnt(1)
    v_max3_u32 v4, v20, v21, v22
    v_max_u32 v4, v4, v23
    v_cmp_eq_u32 vcc, -1, v4
    s_cbranch_vccz .W_75
    s_branch .A_74
.W_79:
    v_smfmac_f32_16x16x64_bf16 v[52:55], v[24:27], a[8:15], v9
    v_smfmac_f32_16x16x64_bf16 v[56:59], v[24:27], a[40:47], v9
    v_smfmac_f32_16x16x64_bf16 v[60:63], v[24:27], a[72:79], v9
    v_smfmac_f32_16x16x64_bf16 v[64:67], v[24:27], a[104:111], v9
    s_waitcnt vmcnt(1)
    v_max3_u32 v4, v28, v29, v30
    v_max_u32 v4, v4, v31
    v_cmp_eq_u32 vcc, -1, v4
    s_cbranch_vccnz .A_82
.W_83:
    v_smfmac_f32_16x16x64_bf16 v[52:55], v[28:31], a[16:23], v9
    v_smfmac_f32_16x16x64_bf16 v[56:59], v[28:31], a[48:55], v9
    v_smfmac_f32_16x16x64_bf16 v[60:63], v[28:31], a[80:87], v9
    v_smfmac_f32_16x16x64_bf16 v[64:67], v[28:31], a[112:119], v9
    s_waitcnt vmcnt(2)
    v_max3_u32 v4, v20, v21, v22
    v_max_u32 v4, v4, v23
    v_cmp_eq_u32 vcc, -1, v4
    s_cbranch_vccz .W_71
    s_branch .A_70
.A_84:
    buffer_load_dwordx4 v[24:27], v8, s[8:11], s29 offen offset:1024 sc1
    s_sub_u32 s62, s62, 1
    s_cbranch_scc1 .mg_end_1
    s_waitcnt vmcnt(2)
    v_max3_u32 v4, v32, v33, v34
    v_max_u32 v4, v4, v35
    v_cmp_eq_u32 vcc, -1, v4
    s_cbranch_vccz .W_73
.A_72:
    buffer_load_dwordx4 v[32:35], v8, s[8:11], s29 offen offset:3072 sc1
    s_waitcnt vmcnt(2)
    v_max3_u32 v4, v20, v21, v22
    v_max_u32 v4, v4, v23
    v_cmp_eq_u32 vcc, -1, v4
    s_cbranch_vccz .W_85
.A_86:
    buffer_load_dwordx4 v[20:23], v8, s[8:11], s29 offen offset:0 sc1
    s_waitcnt vmcnt(2)
    v_max3_u32 v4, v24, v25, v26
    v_max_u32 v4, v4, v27
    v_cmp_eq_u32 vcc, -1, v4
    s_cbranch_vccnz .A_84
.W_87:
    v_smfmac_f32_16x16x64_bf16 v[52:55], v[24:27], a[8:15], v9
    v_smfmac_f32_16x16x64_bf16 v[56:59], v[24:27], a[40:47], v9
    v_smfmac_f32_16x16x64_bf16 v[60:63], v[24:27], a[72:79], v9
    v_smfmac_f32_16x16x64_bf16 v[64:67], v[24:27], a[104:111], v9
    s_waitcnt vmcnt(1)
    v_max3_u32 v4, v32, v33, v34
    v_max_u32 v4, v4, v35
    v_cmp_eq_u32 vcc, -1, v4
    s_cbranch_vccz .W_69
    s_branch .A_68
.W_85:
    v_smfmac_f32_16x16x64_bf16 v[52:55], v[20:23], a[0:7], v9
    v_smfmac_f32_16x16x64_bf16 v[56:59], v[20:23], a[32:39], v9
    v_smfmac_f32_16x16x64_bf16 v[60:63], v[20:23], a[64:71], v9
    v_smfmac_f32_16x16x64_bf16 v[64:67], v[20:23], a[96:103], v9
    s_waitcnt vmcnt(1)
    v_max3_u32 v4, v24, v25, v26
    v_max_u32 v4, v4, v27
    v_cmp_eq_u32 vcc, -1, v4
    s_cbranch_vccnz .A_88
.W_89:
    v_smfmac_f32_16x16x64_bf16 v[52:55], v[24:27], a[8:15], v9
    v_smfmac_f32_16x16x64_bf16 v[56:59], v[24:27], a[40:47], v9
    v_smfmac_f32_16x16x64_bf16 v[60:63], v[24:27], a[72:79], v9
    v_smfmac_f32_16x16x64_bf16 v[64:67], v[24:27], a[104:111], v9
    s_waitcnt vmcnt(2)
    v_max3_u32 v4, v32, v33, v34
    v_max_u32 v4, v4, v35
    v_cmp_eq_u32 vcc, -1, v4
    s_cbranch_vccz .W_30
    s_branch .A_29
.A_90:
    buffer_load_dwordx4 v[32:35], v8, s[8:11], s29 offen offset:3072 sc1
    s_sub_u32 s62, s62, 1
    s_cbranch_scc1 .mg_end_1
    s_waitcnt vmcnt(2)
    v_max3_u32 v4, v20, v21, v22
    v_max_u32 v4, v4, v23
    v_cmp_eq_u32 vcc, -1, v4
    s_cbranch_vccz .W_91
.A_92:
    buffer_load_dwordx4 v[20:23], v8, s[8:11], s29 offen offset:0 sc1
    s_waitcnt vmcnt(2)
    v_max3_u32 v4, v28, v29, v30
    v_max_u32 v4, v4, v31
    v_cmp_eq_u32 vcc, -1, v4
    s_cbranch_vccz .W_67
.A_66:
    buffer_load_dwordx4 v[28:31], v8, s[8:11], s29 offen offset:2048 sc1
    s_waitcnt vmcnt(2)
    v_max3_u32 v4, v32, v33, v34
    v_max_u32 v4, v4, v35
    v_cmp_eq_u32 vcc, -1, v4
    s_cbranch_vccnz .A_90
.W_93:
    v_smfmac_f32_16x16x64_bf16 v[52:55], v[32:35], a[24:31], v9
    v_smfmac_f32_16x16x64_bf16 v[56:59], v[32:35], a[56:63], v9
    v_smfmac_f32_16x16x64_bf16 v[60:63], v[32:35], a[88:95], v9
    v_smfmac_f32_16x16x64_bf16 v[64:67], v[32:35], a[120:127], v9
    s_waitcnt vmcnt(1)
    v_max3_u32 v4, v20, v21, v22
    v_max_u32 v4, v4, v23
    v_cmp_eq_u32 vcc, -1, v4
    s_cbranch_vccnz .A_94
.W_95:
    v_smfmac_f32_16x16x64_bf16 v[52:55], v[20:23], a[0:7], v9
    v_smfmac_f32_16x16x64_bf16 v[56:59], v[20:23], a[32:39], v9
    v_smfmac_f32_16x16x64_bf16 v[60:63], v[20:23], a[64:71], v9
    v_smfmac_f32_16x16x64_bf16 v[64:67], v[20:23], a[96:103], v9
    s_waitcnt vmcnt(2)
    v_max3_u32 v4, v28, v29, v30
    v_max_u32 v4, v4, v31
    v_cmp_eq_u32 vcc, -1, v4
    s_cbranch_vccz .W_65
    s_branch .A_64
.W_91:
    v_smfmac_f32_16x16x64_bf16 v[52:55], v[20:23], a[0:7], v9
    v_smfmac_f32_16x16x64_bf16 v[56:59], v[20:23], a[32:39], v9
    v_smfmac_f32_16x16x64_bf16 v[60:63], v[20:23], a[64:71], v9
    v_smfmac_f32_16x16x64_bf16 v[64:67], v[20:23], a[96:103], v9
    s_waitcnt vmcnt(1)
    v_max3_u32 v4, v28, v29, v30
    v_max_u32 v4, v4, v31
    v_cmp_eq_u32 vcc, -1, v4
    s_cbranch_vccz .W_28
    s_branch .A_27
.A_96:
    buffer_load_dwordx4 v[32:35], v8, s[8:11], s29 offen offset:3072 sc1
    s_sub_u32 s62, s62, 1
    s_cbranch_scc1 .mg_end_1
    s_waitcnt vmcnt(2)
    v_max3_u32 v4, v24, v25, v26
    v_max_u32 v4, v4, v27
    v_cmp_eq_u32 vcc, -1, v4
    s_cbranch_vccz .W_26
.A_25:
    buffer_load_dwordx4 v[24:27], v8, s[8:11], s29 offen offset:1024 sc1
    s_waitcnt vmcnt(2)
    v_max3_u32 v4, v28, v29, v30
    v_max_u32 v4, v4, v31
    v_cmp_eq_u32 vcc, -1, v4
    s_cbranch_vccz .W_97
.A_98:
    buffer_load_dwordx4 v[28:31], v8, s[8:11], s29 offen offset:2048 sc1
    s_waitcnt vmcnt(2)
    v_max3_u32 v4, v32, v33, v34
    v_max_u32 v4, v4, v35
    v_cmp_eq_u32 vcc, -1, v4
    s_cbranch_vccnz .A_96
.W_99:
    v_smfmac_f32_16x16x64_bf16 v[52:55], v[32:35], a[24:31], v9
    v_smfmac_f32_16x16x64_bf16 v[56:59], v[32:35], a[56:63], v9
    v_smfmac_f32_16x16x64_bf16 v[60:63], v[32:35], a[88:95], v9
    v_smfmac_f32_16x16x64_bf16 v[64:67], v[32:35], a[120:127], v9
    s_waitcnt vmcnt(1)
    v_max3_u32 v4, v24, v25, v26
    v_max_u32 v4, v4, v27
    v_cmp_eq_u32 vcc, -1, v4
    s_cbranch_vccz .W_63
    s_branch .A_62
.W_97:
    v_smfmac_f32_16x16x64_bf16 v[52:55], v[28:31], a[16:23], v9
    v_smfmac_f32_16x16x64_bf16 v[56:59], v[28:31], a[48:55], v9
    v_smfmac_f32_16x16x64_bf16 v[60:63], v[28:31], a[80:87], v9
    v_smfmac_f32_16x16x64_bf16 v[64:67], v[28:31], a[112:119], v9
    s_waitcnt vmcnt(1)
    v_max3_u32 v4, v32, v33, v34
    v_max_u32 v4, v4, v35
    v_cmp_eq_u32 vcc, -1, v4
    s_cbranch_vccnz .A_100
.W_101:
    v_smfmac_f32_16x16x64_bf16 v[52:55], v[32:35], a[24:31], v9
    v_smfmac_f32_16x16x64_bf16 v[56:59], v[32:35], a[56:63], v9
    v_smfmac_f32_16x16x64_bf16 v[60:63], v[32:35], a[88:95], v9
    v_smfmac_f32_16x16x64_bf16 v[64:67], v[32:35], a[120:127], v9
    s_waitcnt vmcnt(2)
    v_max3_u32 v4, v24, v25, v26
    v_max_u32 v4, v4, v27
    v_cmp_eq_u32 vcc, -1, v4
    s_cbranch_vccz .W_77
    s_branch .A_76
.A_102:
    buffer_load_dwordx4 v[24:27], v8, s[8:11], s29 offen offset:1024 sc1
    s_sub_u32 s62, s62, 1
    s_cbranch_scc1 .mg_end_1
    s_waitcnt vmcnt(3)
    v_max3_u32 v4, v20, v21, v22
    v_max_u32 v4, v4, v23
    v_cmp_eq_u32 vcc, -1, v4
    s_cbranch_vccz .W_75
.A_74:
    buffer_load_dwordx4 v[20:23], v8, s[8:11], s29 offen offset:0 sc1
    s_waitcnt vmcnt(3)
    v_max3_u32 v4, v24, v25, v26
    v_max_u32 v4, v4, v27
    v_cmp_eq_u32 vcc, -1, v4
    s_cbranch_vccnz .A_102
.W_103:
    v_smfmac_f32_16x16x64_bf16 v[52:55], v[24:27], a[8:15], v9
    v_smfmac_f32_16x16x64_bf16 v[56:59], v[24:27], a[40:47], v9
    v_smfmac_f32_16x16x64_bf16 v[60:63], v[24:27], a[72:79], v9
    v_smfmac_f32_16x16x64_bf16 v[64:67], v[24:27], a[104:111], v9
    s_waitcnt vmcnt(2)
    v_max3_u32 v4, v20, v21, v22
    v_max_u32 v4, v4, v23
    v_cmp_eq_u32 vcc, -1, v4
    s_cbranch_vccz .W_71
    s_branch .A_70
.A_82:
    buffer_load_dwordx4 v[28:31], v8, s[8:11], s29 offen offset:2048 sc1
    s_sub_u32 s62, s62, 1
    s_cbranch_scc1 .mg_end_1
    s_waitcnt vmcnt(3)
    v_max3_u32 v4, v20, v21, v22
    v_max_u32 v4, v4, v23
    v_cmp_eq_u32 vcc, -1, v4
    s_cbranch_vccz .W_95
.A_94:
    buffer_load_dwordx4 v[20:23], v8, s[8:11], s29 offen offset:0 sc1
    s_waitcnt vmcnt(3)
    v_max3_u32 v4, v28, v29, v30
    v_max_u32 v4, v4, v31
    v_cmp_eq_u32 vcc, -1, v4
    s_cbranch_vccnz .A_82
    s_branch .W_83
.A_104:
    buffer_load_dwordx4 v[20:23], v8, s[8:11], s29 offen offset:0 sc1
    s_sub_u32 s62, s62, 1
    s_cbranch_scc1 .mg_end_1
    s_waitcnt vmcnt(3)
    v_max3_u32 v4, v32, v33, v34
    v_max_u32 v4, v4, v35
    v_cmp_eq_u32 vcc, -1, v4
    s_cbranch_vccz .W_69
.A_68:
    buffer_load_dwordx4 v[32:35], v8, s[8:11], s29 offen offset:3072 sc1
    s_waitcnt vmcnt(3)
    v_max3_u32 v4, v20, v21, v22
    v_max_u32 v4, v4, v23
    v_cmp_eq_u32 vcc, -1, v4
    s_cbranch_vccnz .A_104
.W_105:
    v_smfmac_f32_16x16x64_bf16 v[52:55], v[20:23], a[0:7], v9
    v_smfmac_f32_16x16x64_bf16 v[56:59], v[20:23], a[32:39], v9
    v_smfmac_f32_16x16x64_bf16 v[60:63], v[20:23], a[64:71], v9
    v_smfmac_f32_16x16x64_bf16 v[64:67], v[20:23], a[96:103], v9
    s_waitcnt vmcnt(2)
    v_max3_u32 v4, v32, v33, v34
    v_max_u32 v4, v4, v35
    v_cmp_eq_u32 vcc, -1, v4
    s_cbranch_vccz .W_30
    s_branch .A_29
.A_106:
    buffer_load_dwordx4 v[28:31], v8, s[8:11], s29 offen offset:2048 sc1
    s_sub_u32 s62, s62, 1
    s_cbranch_scc1 .mg_end_1
    s_waitcnt vmcnt(3)
    v_max3_u32 v4, v24, v25, v26
    v_max_u32 v4, v4, v27
    v_cmp_eq_u32 vcc, -1, v4
    s_cbranch_vccz .W_63
.A_62:
    buffer_load_dwordx4 v[24:27], v8, s[8:11], s29 offen offset:1024 sc1
    s_waitcnt vmcnt(3)
    v_max3_u32 v4, v28, v29, v30
    v_max_u32 v4, v4, v31
    v_cmp_eq_u32 vcc, -1, v4
    s_cbranch_vccnz .A_106
.W_107:
    v_smfmac_f32_16x16x64_bf16 v[52:55], v[28:31], a[16:23], v9
    v_smfmac_f32_16x16x64_bf16 v[56:59], v[28:31], a[48:55], v9
    v_smfmac_f32_16x16x64_bf16 v[60:63], v[28:31], a[80:87], v9
    v_smfmac_f32_16x16x64_bf16 v[64:67], v[28:31], a[112:119], v9
    s_waitcnt vmcnt(2)
    v_max3_u32 v4, v24, v25, v26
    v_max_u32 v4, v4, v27
    v_cmp_eq_u32 vcc, -1, v4
    s_cbranch_vccz .W_77
    s_branch .A_76
.A_100:
    buffer_load_dwordx4 v[32:35], v8, s[8:11], s29 offen offset:3072 sc1
    s_sub_u32 s62, s62, 1
    s_cbranch_scc1 .mg_end_1
    s_waitcnt vmcnt(3)
    v_max3_u32 v4, v24, v25, v26
    v_max_u32 v4, v4, v27
    v_cmp_eq_u32 vcc, -1, v4
    s_cbranch_vccz .W_89
.A_88:
    buffer_load_dwordx4 v[24:27], v8, s[8:11], s29 offen offset:1024 sc1
    s_waitcnt vmcnt(3)
    v_max3_u32 v4, v32, v33, v34
    v_max_u32 v4, v4, v35
    v_cmp_eq_u32 vcc, -1, v4
    s_cbranch_vccnz .A_100
    s_branch .W_101
.A_108:
    buffer_load_dwordx4 v[32:35], v8, s[8:11], s29 offen offset:3072 sc1
    s_sub_u32 s62, s62, 1
    s_cbranch_scc1 .mg_end_1
    s_waitcnt vmcnt(3)
    v_max3_u32 v4, v28, v29, v30
    v_max_u32 v4, v4, v31
    v_cmp_eq_u32 vcc, -1, v4
    s_cbranch_vccz .W_28
.A_27:
    buffer_load_dwordx4 v[28:31], v8, s[8:11], s29 offen offset:2048 sc1
    s_waitcnt vmcnt(3)
    v_max3_u32 v4, v32, v33, v34
    v_max_u32 v4, v4, v35
    v_cmp_eq_u32 vcc, -1, v4
    s_cbranch_vccnz .A_108
.W_109:
    v_smfmac_f32_16x16x64_bf16 v[52:55], v[32:35], a[24:31], v9
    v_smfmac_f32_16x16x64_bf16 v[56:59], v[32:35], a[56:63], v9
    v_smfmac_f32_16x16x64_bf16 v[60:63], v[32:35], a[88:95], v9
    v_smfmac_f32_16x16x64_bf16 v[64:67], v[32:35], a[120:127], v9
    s_waitcnt vmcnt(2)
    v_max3_u32 v4, v28, v29, v30
    v_max_u32 v4, v4, v31
    v_cmp_eq_u32 vcc, -1, v4
    s_cbranch_vccz .W_65
    s_branch .A_64
.A_70:
    buffer_load_dwordx4 v[20:23], v8, s[8:11], s29 offen offset:0 sc1
    s_sub_u32 s62, s62, 1
    s_cbranch_scc1 .mg_end_1
    s_waitcnt vmcnt(2)
    v_max3_u32 v4, v20, v21, v22
    v_max_u32 v4, v4, v23
    v_cmp_eq_u32 vcc, -1, v4
    s_cbranch_vccnz .A_70
    v_smfmac_f32_16x16x64_bf16 v[52:55], v[20:23], a[0:7], v9
    v_smfmac_f32_16x16x64_bf16 v[56:59], v[20:23], a[32:39], v9
    v_smfmac_f32_16x16x64_bf16 v[60:63], v[20:23], a[64:71], v9
    v_smfmac_f32_16x16x64_bf16 v[64:67], v[20:23], a[96:103], v9
    s_branch .mj_22
.A_76:
    buffer_load_dwordx4 v[24:27], v8, s[8:11], s29 offen offset:1024 sc1
    s_sub_u32 s62, s62, 1
    s_cbranch_scc1 .mg_end_1
    s_waitcnt vmcnt(2)
    v_max3_u32 v4, v24, v25, v26
    v_max_u32 v4, v4, v27
    v_cmp_eq_u32 vcc, -1, v4
    s_cbranch_vccnz .A_76
    v_smfmac_f32_16x16x64_bf16 v[52:55], v[24:27], a[8:15], v9
    v_smfmac_f32_16x16x64_bf16 v[56:59], v[24:27], a[40:47], v9
    v_smfmac_f32_16x16x64_bf16 v[60:63], v[24:27], a[72:79], v9
    v_smfmac_f32_16x16x64_bf16 v[64:67], v[24:27], a[104:111], v9
    s_branch .mj_22
.A_64:
    buffer_load_dwordx4 v[28:31], v8, s[8:11], s29 offen offset:2048 sc1
    s_sub_u32 s62, s62, 1
    s_cbranch_scc1 .mg_end_1
    s_waitcnt vmcnt(2)
    v_max3_u32 v4, v28, v29, v30
    v_max_u32 v4, v4, v31
    v_cmp_eq_u32 vcc, -1, v4
    s_cbranch_vccnz .A_64
    v_smfmac_f32_16x16x64_bf16 v[52:55], v[28:31], a[16:23], v9
    v_smfmac_f32_16x16x64_bf16 v[56:59], v[28:31], a[48:55], v9
    v_smfmac_f32_16x16x64_bf16 v[60:63], v[28:31], a[80:87], v9
    v_smfmac_f32_16x16x64_bf16 v[64:67], v[28:31], a[112:119], v9
    s_branch .mj_22
.A_29:
    buffer_load_dwordx4 v[32:35], v8, s[8:11], s29 offen offset:3072 sc1
    s_sub_u32 s62, s62, 1
    s_cbranch_scc1 .mg_end_1
    s_waitcnt vmcnt(2)
    v_max3_u32 v4, v32, v33, v34
    v_max_u32 v4, v4, v35
    v_cmp_eq_u32 vcc, -1, v4
    s_cbranch_vccnz .A_29
    v_smfmac_f32_16x16x64_bf16 v[52:55], v[32:35], a[24:31], v9
    v_smfmac_f32_16x16x64_bf16 v[56:59], v[32:35], a[56:63], v9
    v_smfmac_f32_16x16x64_bf16 v[60:63], v[32:35], a[88:95], v9
    v_smfmac_f32_16x16x64_bf16 v[64:67], v[32:35], a[120:127], v9
    s_branch .mj_22
.A_110:
    buffer_load_dwordx4 v[100:103], v234, s[8:11], s29 offen sc1
    s_sub_u32 s62, s62, 1
    s_cbranch_scc1 .mg_end_1
    s_waitcnt vmcnt(2)
    v_max3_u32 v4, v92, v93, v94
    v_max_u32 v4, v4, v95
    v_cmp_eq_u32 vcc, -1, v4
    s_cbranch_vccz .W_33
.A_32:
    buffer_load_dwordx4 v[92:95], v232, s[8:11], s29 offen sc1
    s_waitcnt vmcnt(2)
    v_max3_u32 v4, v96, v97, v98
    v_max_u32 v4, v4, v99
    v_cmp_eq_u32 vcc, -1, v4
    s_cbranch_vccz .W_111
.A_112:
    buffer_load_dwordx4 v[96:99], v233, s[8:11], s29 offen sc1
    s_waitcnt vmcnt(2)
    v_max3_u32 v4, v100, v101, v102
    v_max_u32 v4, v4, v103
    v_cmp_eq_u32 vcc, -1, v4
    s_cbranch_vccnz .A_110
.W_113:
    v_mfma_f32_16x16x32_bf16 v[208:211], v[140:143], v[100:103], v[208:211]
    v_mfma_f32_16x16x32_bf16 v[212:215], v[156:159], v[100:103], v[212:215]
    v_mfma_f32_16x16x32_bf16 v[216:219], v[100:103], v[100:103], v[216:219]
    s_waitcnt vmcnt(1)
    v_max3_u32 v4, v92, v93, v94
    v_max_u32 v4, v4, v95
    v_cmp_eq_u32 vcc, -1, v4
    s_cbranch_vccnz .A_114
.W_115:
    v_mfma_f32_16x16x32_bf16 v[208:211], v[132:135], v[92:95], v[208:211]
    v_mfma_f32_16x16x32_bf16 v[212:215], v[148:151], v[92:95], v[212:215]
    v_mfma_f32_16x16x32_bf16 v[216:219], v[92:95], v[92:95], v[216:219]
    s_waitcnt vmcnt(2)
    v_max3_u32 v4, v96, v97, v98
    v_max_u32 v4, v4, v99
    v_cmp_eq_u32 vcc, -1, v4
    s_cbranch_vccnz .A_116
.W_117:
    v_mfma_f32_16x16x32_bf16 v[208:211], v[136:139], v[96:99], v[208:211]
    v_mfma_f32_16x16x32_bf16 v[212:215], v[152:155], v[96:99], v[212:215]
    v_mfma_f32_16x16x32_bf16 v[216:219], v[96:99], v[96:99], v[216:219]
    s_branch .mj_31
.W_111:
    v_mfma_f32_16x16x32_bf16 v[208:211], v[136:139], v[96:99], v[208:211]
    v_mfma_f32_16x16x32_bf16 v[212:215], v[152:155], v[96:99], v[212:215]
    v_mfma_f32_16x16x32_bf16 v[216:219], v[96:99], v[96:99], v[216:219]
    s_waitcnt vmcnt(1)
    v_max3_u32 v4, v100, v101, v102
    v_max_u32 v4, v4, v103
    v_cmp_eq_u32 vcc, -1, v4
    s_cbranch_vccnz .A_118
.W_119:
    v_mfma_f32_16x16x32_bf16 v[208:211], v[140:143], v[100:103], v[208:211]
    v_mfma_f32_16x16x32_bf16 v[212:215], v[156:159], v[100:103], v[212:215]
    v_mfma_f32_16x16x32_bf16 v[216:219], v[100:103], v[100:103], v[216:219]
    s_waitcnt vmcnt(2)
    v_max3_u32 v4, v92, v93, v94
    v_max_u32 v4, v4, v95
    v_cmp_eq_u32 vcc, -1, v4
    s_cbranch_vccnz .A_120
.W_121:
    v_mfma_f32_16x16x32_bf16 v[208:211], v[132:135], v[92:95], v[208:211]
    v_mfma_f32_16x16x32_bf16 v[212:215], v[148:151], v[92:95], v[212:215]
    v_mfma_f32_16x16x32_bf16 v[216:219], v[92:95], v[92:95], v[216:219]
    s_branch .mj_31
.A_122:
    buffer_load_dwordx4 v[96:99], v233, s[8:11], s29 offen sc1
    s_sub_u32 s62, s62, 1
    s_cbranch_scc1 .mg_end_1
    s_waitcnt vmcnt(3)
    v_max3_u32 v4, v92, v93, v94
    v_max_u32 v4, v4, v95
    v_cmp_eq_u32 vcc, -1, v4
    s_cbranch_vccz .W_115
.A_114:
    buffer_load_dwordx4 v[92:95], v232, s[8:11], s29 offen sc1
    s_waitcnt vmcnt(3)
    v_max3_u32 v4, v96, v97, v98
    v_max_u32 v4, v4, v99
    v_cmp_eq_u32 vcc, -1, v4
    s_cbranch_vccnz .A_122
.W_123:
    v_mfma_f32_16x16x32_bf16 v[208:211], v[136:139], v[96:99], v[208:211]
    v_mfma_f32_16x16x32_bf16 v[212:215], v[152:155], v[96:99], v[212:215]
    v_mfma_f32_16x16x32_bf16 v[216:219], v[96:99], v[96:99], v[216:219]
    s_waitcnt vmcnt(2)
    v_max3_u32 v4, v92, v93, v94
    v_max_u32 v4, v4, v95
    v_cmp_eq_u32 vcc, -1, v4
    s_cbranch_vccz .W_121
    s_branch .A_120
.A_124:
    buffer_load_dwordx4 v[92:95], v232, s[8:11], s29 offen sc1
    s_sub_u32 s62, s62, 1
    s_cbranch_scc1 .mg_end_1
    s_waitcnt vmcnt(3)
    v_max3_u32 v4, v100, v101, v102
    v_max_u32 v4, v4, v103
    v_cmp_eq_u32 vcc, -1, v4
    s_cbranch_vccz .W_119
.A_118:
    buffer_load_dwordx4 v[100:103], v234, s[8:11], s29 offen sc1
    s_waitcnt vmcnt(3)
    v_max3_u32 v4, v92, v93, v94
    v_max_u32 v4, v4, v95
    v_cmp_eq_u32 vcc, -1, v4
    s_cbranch_vccnz .A_124
.W_125:
    v_mfma_f32_16x16x32_bf16 v[208:211], v[132:135], v[92:95], v[208:211]
    v_mfma_f32_16x16x32_bf16 v[212:215], v[148:151], v[92:95], v[212:215]
    v_mfma_f32_16x16x32_bf16 v[216:219], v[92:95], v[92:95], v[216:219]
    s_waitcnt vmcnt(2)
    v_max3_u32 v4, v100, v101, v102
    v_max_u32 v4, v4, v103
    v_cmp_eq_u32 vcc, -1, v4
    s_cbranch_vccz .W_37
    s_branch .A_36
.A_126:
    buffer_load_dwordx4 v[100:103], v234, s[8:11], s29 offen sc1
    s_sub_u32 s62, s62, 1
    s_cbranch_scc1 .mg_end_1
    s_waitcnt vmcnt(3)
    v_max3_u32 v4, v96, v97, v98
    v_max_u32 v4, v4, v99
    v_cmp_eq_u32 vcc, -1, v4
    s_cbranch_vccz .W_35
.A_34:
    buffer_load_dwordx4 v[96:99], v233, s[8:11], s29 offen sc1
    s_waitcnt vmcnt(3)
    v_max3_u32 v4, v100, v101, v102
    v_max_u32 v4, v4, v103
    v_cmp_eq_u32 vcc, -1, v4
    s_cbranch_vccnz .A_126
.W_127:
    v_mfma_f32_16x16x32_bf16 v[208:211], v[140:143], v[100:103], v[208:211]
    v_mfma_f32_16x16x32_bf16 v[212:215], v[156:159], v[100:103], v[212:215]
    v_mfma_f32_16x16x32_bf16 v[216:219], v[100:103], v[100:103], v[216:219]
    s_waitcnt vmcnt(2)
    v_max3_u32 v4, v96, v97, v98
    v_max_u32 v4, v4, v99
    v_cmp_eq_u32 vcc, -1, v4
    s_cbranch_vccz .W_117
    s_branch .A_116
.A_120:
    buffer_load_dwordx4 v[92:95], v232, s[8:11], s29 offen sc1
    s_sub_u32 s62, s62, 1
    s_cbranch_scc1 .mg_end_1
    s_waitcnt vmcnt(2)
    v_max3_u32 v4, v92, v93, v94
    v_max_u32 v4, v4, v95
    v_cmp_eq_u32 vcc, -1, v4
    s_cbranch_vccnz .A_120
    v_mfma_f32_16x16x32_bf16 v[208:211], v[132:135], v[92:95], v[208:211]
    v_mfma_f32_16x16x32_bf16 v[212:215], v[148:151], v[92:95], v[212:215]
    v_mfma_f32_16x16x32_bf16 v[216:219], v[92:95], v[92:95], v[216:219]
    s_branch .mj_31
.A_116:
    buffer_load_dwordx4 v[96:99], v233, s[8:11], s29 offen sc1
    s_sub_u32 s62, s62, 1
    s_cbranch_scc1 .mg_end_1
    s_waitcnt vmcnt(2)
    v_max3_u32 v4, v96, v97, v98
    v_max_u32 v4, v4, v99
    v_cmp_eq_u32 vcc, -1, v4
    s_cbranch_vccnz .A_116
    v_mfma_f32_16x16x32_bf16 v[208:211], v[136:139], v[96:99], v[208:211]
    v_mfma_f32_16x16x32_bf16 v[212:215], v[152:155], v[96:99], v[212:215]
    v_mfma_f32_16x16x32_bf16 v[216:219], v[96:99], v[96:99], v[216:219]
    s_branch .mj_31
.A_36:
    buffer_load_dwordx4 v[100:103], v234, s[8:11], s29 offen sc1
    s_sub_u32 s62, s62, 1
    s_cbranch_scc1 .mg_end_1
    s_waitcnt vmcnt(2)
    v_max3_u32 v4, v100, v101, v102
    v_max_u32 v4, v4, v103
    v_cmp_eq_u32 vcc, -1, v4
    s_cbranch_vccnz .A_36
    v_mfma_f32_16x16x32_bf16 v[208:211], v[140:143], v[100:103], v[208:211]
    v_mfma_f32_16x16x32_bf16 v[212:215], v[156:159], v[100:103], v[212:215]
    v_mfma_f32_16x16x32_bf16 v[216:219], v[100:103], v[100:103], v[216:219]
    s_branch .mj_31
.A_128:
    buffer_load_dwordx4 v[216:219], v246, s[8:11], s33 offen offset:2048 sc1
    buffer_load_dwordx4 v[220:223], v246, s[8:11], s33 offen offset:3072 sc1
    s_sub_u32 s62, s62, 1
    s_cbranch_scc1 .mg_end_1
    s_waitcnt vmcnt(6)
    v_max3_u32 v4, v192, v193, v194
    v_max3_u32 v5, v195, v196, v197
    v_max3_u32 v4, v4, v198, v199
    v_max_u32 v4, v4, v5
    v_cmp_eq_u32 vcc, -1, v4

    s_cbranch_vccz .W_43
.A_42:
    buffer_load_dwordx4 v[192:195], v246, s[8:11], s32 offen offset:0 sc1
    buffer_load_dwordx4 v[196:199], v246, s[8:11], s32 offen offset:1024 sc1
    s_waitcnt vmcnt(6)
    v_max3_u32 v4, v200, v201, v202
    v_max3_u32 v5, v203, v204, v205
    v_max3_u32 v4, v4, v206, v207
    v_max_u32 v4, v4, v5
    v_cmp_eq_u32 vcc, -1, v4

    s_cbranch_vccz .W_129
.A_130:
    buffer_load_dwordx4 v[200:203], v246, s[8:11], s32 offen offset:2048 sc1
    buffer_load_dwordx4 v[204:207], v246, s[8:11], s32 offen offset:3072 sc1
    s_waitcnt vmcnt(6)
    v_max3_u32 v4, v208, v209, v210
    v_max3_u32 v5, v211, v212, v213
    v_max3_u32 v4, v4, v214, v215
    v_max_u32 v4, v4, v5
    v_cmp_eq_u32 vcc, -1, v4

    s_cbranch_vccz .W_131
.A_132:
    buffer_load_dwordx4 v[208:211], v246, s[8:11], s33 offen offset:0 sc1
    buffer_load_dwordx4 v[212:215], v246, s[8:11], s33 offen offset:1024 sc1
    s_waitcnt vmcnt(6)
    v_max3_u32 v4, v216, v217, v218
    v_max3_u32 v5, v219, v220, v221
    v_max3_u32 v4, v4, v222, v223
    v_max_u32 v4, v4, v5
    v_cmp_eq_u32 vcc, -1, v4

    s_cbranch_vccnz .A_128
.W_133:
    v_smfmac_f32_16x16x64_bf16 v[76:79], v[216:219], v[140:147], v9
    v_smfmac_f32_16x16x64_bf16 v[80:83], v[216:219], v[172:179], v9
    v_smfmac_f32_16x16x64_bf16 v[76:79], v[220:223], v[148:155], v9
    v_smfmac_f32_16x16x64_bf16 v[80:83], v[220:223], v[180:187], v9
    s_waitcnt vmcnt(4)
    v_max3_u32 v4, v192, v193, v194
    v_max3_u32 v5, v195, v196, v197
    v_max3_u32 v4, v4, v198, v199
    v_max_u32 v4, v4, v5
    v_cmp_eq_u32 vcc, -1, v4

    s_cbranch_vccnz .A_134
.W_135:
    v_smfmac_f32_16x16x64_bf16 v[76:79], v[192:195], a[192:199], v9
    v_smfmac_f32_16x16x64_bf16 v[80:83], v[192:195], a[224:231], v9
    v_smfmac_f32_16x16x64_bf16 v[76:79], v[196:199], a[200:207], v9
    v_smfmac_f32_16x16x64_bf16 v[80:83], v[196:199], a[232:239], v9
    s_waitcnt vmcnt(2)
    v_max3_u32 v4, v200, v201, v202
    v_max3_u32 v5, v203, v204, v205
    v_max3_u32 v4, v4, v206, v207
    v_max_u32 v4, v4, v5
    v_cmp_eq_u32 vcc, -1, v4

    s_cbranch_vccnz .A_136
.W_137:
    v_smfmac_f32_16x16x64_bf16 v[76:79], v[200:203], a[208:215], v9
    v_smfmac_f32_16x16x64_bf16 v[80:83], v[200:203], a[240:247], v9
    v_smfmac_f32_16x16x64_bf16 v[76:79], v[204:207], a[216:223], v9
    v_smfmac_f32_16x16x64_bf16 v[80:83], v[204:207], a[248:255], v9
    s_waitcnt vmcnt(4)
    v_max3_u32 v4, v208, v209, v210
    v_max3_u32 v5, v211, v212, v213
    v_max3_u32 v4, v4, v214, v215
    v_max_u32 v4, v4, v5
    v_cmp_eq_u32 vcc, -1, v4

    s_cbranch_vccnz .A_138
.W_139:
    v_smfmac_f32_16x16x64_bf16 v[76:79], v[208:211], v[124:131], v9
    v_smfmac_f32_16x16x64_bf16 v[80:83], v[208:211], v[156:163], v9
    v_smfmac_f32_16x16x64_bf16 v[76:79], v[212:215], v[132:139], v9
    v_smfmac_f32_16x16x64_bf16 v[80:83], v[212:215], v[164:171], v9
    s_branch .mj_41
.W_129:
    v_smfmac_f32_16x16x64_bf16 v[76:79], v[200:203], a[208:215], v9
    v_smfmac_f32_16x16x64_bf16 v[80:83], v[200:203], a[240:247], v9
    v_smfmac_f32_16x16x64_bf16 v[76:79], v[204:207], a[216:223], v9
    v_smfmac_f32_16x16x64_bf16 v[80:83], v[204:207], a[248:255], v9
    s_waitcnt vmcnt(4)
    v_max3_u32 v4, v208, v209, v210
    v_max3_u32 v5, v211, v212, v213
    v_max3_u32 v4, v4, v214, v215
    v_max_u32 v4, v4, v5
    v_cmp_eq_u32 vcc, -1, v4

    s_cbranch_vccnz .A_140
.W_141:
    v_smfmac_f32_16x16x64_bf16 v[76:79], v[208:211], v[124:131], v9
    v_smfmac_f32_16x16x64_bf16 v[80:83], v[208:211], v[156:163], v9
    v_smfmac_f32_16x16x64_bf16 v[76:79], v[212:215], v[132:139], v9
    v_smfmac_f32_16x16x64_bf16 v[80:83], v[212:215], v[164:171], v9
    s_waitcnt vmcnt(2)
    v_max3_u32 v4, v216, v217, v218
    v_max3_u32 v5, v219, v220, v221
    v_max3_u32 v4, v4, v222, v223
    v_max_u32 v4, v4, v5
    v_cmp_eq_u32 vcc, -1, v4

    s_cbranch_vccnz .A_142
.W_143:
    v_smfmac_f32_16x16x64_bf16 v[76:79], v[216:219], v[140:147], v9
    v_smfmac_f32_16x16x64_bf16 v[80:83], v[216:219], v[172:179], v9
    v_smfmac_f32_16x16x64_bf16 v[76:79], v[220:223], v[148:155], v9
    v_smfmac_f32_16x16x64_bf16 v[80:83], v[220:223], v[180:187], v9
    s_waitcnt vmcnt(4)
    v_max3_u32 v4, v192, v193, v194
    v_max3_u32 v5, v195, v196, v197
    v_max3_u32 v4, v4, v198, v199
    v_max_u32 v4, v4, v5
    v_cmp_eq_u32 vcc, -1, v4

    s_cbranch_vccnz .A_144
.W_145:
    v_smfmac_f32_16x16x64_bf16 v[76:79], v[192:195], a[192:199], v9
    v_smfmac_f32_16x16x64_bf16 v[80:83], v[192:195], a[224:231], v9
    v_smfmac_f32_16x16x64_bf16 v[76:79], v[196:199], a[200:207], v9
    v_smfmac_f32_16x16x64_bf16 v[80:83], v[196:199], a[232:239], v9
    s_branch .mj_41
.W_131:
    v_smfmac_f32_16x16x64_bf16 v[76:79], v[208:211], v[124:131], v9
    v_smfmac_f32_16x16x64_bf16 v[80:83], v[208:211], v[156:163], v9
    v_smfmac_f32_16x16x64_bf16 v[76:79], v[212:215], v[132:139], v9
    v_smfmac_f32_16x16x64_bf16 v[80:83], v[212:215], v[164:171], v9
    s_waitcnt vmcnt(4)
    v_max3_u32 v4, v216, v217, v218
    v_max3_u32 v5, v219, v220, v221
    v_max3_u32 v4, v4, v222, v223
    v_max_u32 v4, v4, v5
    v_cmp_eq_u32 vcc, -1, v4

    s_cbranch_vccnz .A_146
.W_147:
    v_smfmac_f32_16x16x64_bf16 v[76:79], v[216:219], v[140:147], v9
    v_smfmac_f32_16x16x64_bf16 v[80:83], v[216:219], v[172:179], v9
    v_smfmac_f32_16x16x64_bf16 v[76:79], v[220:223], v[148:155], v9
    v_smfmac_f32_16x16x64_bf16 v[80:83], v[220:223], v[180:187], v9
    s_waitcnt vmcnt(2)
    v_max3_u32 v4, v192, v193, v194
    v_max3_u32 v5, v195, v196, v197
    v_max3_u32 v4, v4, v198, v199
    v_max_u32 v4, v4, v5
    v_cmp_eq_u32 vcc, -1, v4

    s_cbranch_vccnz .A_148
.W_149:
    v_smfmac_f32_16x16x64_bf16 v[76:79], v[192:195], a[192:199], v9
    v_smfmac_f32_16x16x64_bf16 v[80:83], v[192:195], a[224:231], v9
    v_smfmac_f32_16x16x64_bf16 v[76:79], v[196:199], a[200:207], v9
    v_smfmac_f32_16x16x64_bf16 v[80:83], v[196:199], a[232:239], v9
    s_waitcnt vmcnt(4)
    v_max3_u32 v4, v200, v201, v202
    v_max3_u32 v5, v203, v204, v205
    v_max3_u32 v4, v4, v206, v207
    v_max_u32 v4, v4, v5
    v_cmp_eq_u32 vcc, -1, v4

    s_cbranch_vccnz .A_150
.W_151:
    v_smfmac_f32_16x16x64_bf16 v[76:79], v[200:203], a[208:215], v9
    v_smfmac_f32_16x16x64_bf16 v[80:83], v[200:203], a[240:247], v9
    v_smfmac_f32_16x16x64_bf16 v[76:79], v[204:207], a[216:223], v9
    v_smfmac_f32_16x16x64_bf16 v[80:83], v[204:207], a[248:255], v9
    s_branch .mj_41
.A_152:
    buffer_load_dwordx4 v[208:211], v246, s[8:11], s33 offen offset:0 sc1
    buffer_load_dwordx4 v[212:215], v246, s[8:11], s33 offen offset:1024 sc1
    s_sub_u32 s62, s62, 1
    s_cbranch_scc1 .mg_end_1
    s_waitcnt vmcnt(4)
    v_max3_u32 v4, v192, v193, v194
    v_max3_u32 v5, v195, v196, v197
    v_max3_u32 v4, v4, v198, v199
    v_max_u32 v4, v4, v5
    v_cmp_eq_u32 vcc, -1, v4

    s_cbranch_vccz .W_135
.A_134:
    buffer_load_dwordx4 v[192:195], v246, s[8:11], s32 offen offset:0 sc1
    buffer_load_dwordx4 v[196:199], v246, s[8:11], s32 offen offset:1024 sc1
    s_waitcnt vmcnt(4)
    v_max3_u32 v4, v200, v201, v202
    v_max3_u32 v5, v203, v204, v205
    v_max3_u32 v4, v4, v206, v207
    v_max_u32 v4, v4, v5
    v_cmp_eq_u32 vcc, -1, v4

    s_cbranch_vccz .W_153
.A_154:
    buffer_load_dwordx4 v[200:203], v246, s[8:11], s32 offen offset:2048 sc1
    buffer_load_dwordx4 v[204:207], v246, s[8:11], s32 offen offset:3072 sc1
    s_waitcnt vmcnt(4)
    v_max3_u32 v4, v208, v209, v210
    v_max3_u32 v5, v211, v212, v213
    v_max3_u32 v4, v4, v214, v215
    v_max_u32 v4, v4, v5
    v_cmp_eq_u32 vcc, -1, v4

    s_cbranch_vccnz .A_152
.W_155:
    v_smfmac_f32_16x16x64_bf16 v[76:79], v[208:211], v[124:131], v9
    v_smfmac_f32_16x16x64_bf16 v[80:83], v[208:211], v[156:163], v9
    v_smfmac_f32_16x16x64_bf16 v[76:79], v[212:215], v[132:139], v9
    v_smfmac_f32_16x16x64_bf16 v[80:83], v[212:215], v[164:171], v9
    s_waitcnt vmcnt(2)
    v_max3_u32 v4, v192, v193, v194
    v_max3_u32 v5, v195, v196, v197
    v_max3_u32 v4, v4, v198, v199
    v_max_u32 v4, v4, v5
    v_cmp_eq_u32 vcc, -1, v4

    s_cbranch_vccz .W_149
    s_branch .A_148
.W_153:
    v_smfmac_f32_16x16x64_bf16 v[76:79], v[200:203], a[208:215], v9
    v_smfmac_f32_16x16x64_bf16 v[80:83], v[200:203], a[240:247], v9
    v_smfmac_f32_16x16x64_bf16 v[76:79], v[204:207], a[216:223], v9
    v_smfmac_f32_16x16x64_bf16 v[80:83], v[204:207], a[248:255], v9
    s_waitcnt vmcnt(2)
    v_max3_u32 v4, v208, v209, v210
    v_max3_u32 v5, v211, v212, v213
    v_max3_u32 v4, v4, v214, v215
    v_max_u32 v4, v4, v5
    v_cmp_eq_u32 vcc, -1, v4

    s_cbranch_vccnz .A_156
.W_157:
    v_smfmac_f32_16x16x64_bf16 v[76:79], v[208:211], v[124:131], v9
    v_smfmac_f32_16x16x64_bf16 v[80:83], v[208:211], v[156:163], v9
    v_smfmac_f32_16x16x64_bf16 v[76:79], v[212:215], v[132:139], v9
    v_smfmac_f32_16x16x64_bf16 v[80:83], v[212:215], v[164:171], v9
    s_waitcnt vmcnt(4)
    v_max3_u32 v4, v192, v193, v194
    v_max3_u32 v5, v195, v196, v197
    v_max3_u32 v4, v4, v198, v199
    v_max_u32 v4, v4, v5
    v_cmp_eq_u32 vcc, -1, v4

    s_cbranch_vccz .W_145
    s_branch .A_144
.A_158:
    buffer_load_dwordx4 v[200:203], v246, s[8:11], s32 offen offset:2048 sc1
    buffer_load_dwordx4 v[204:207], v246, s[8:11], s32 offen offset:3072 sc1
    s_sub_u32 s62, s62, 1
    s_cbranch_scc1 .mg_end_1
    s_waitcnt vmcnt(4)
    v_max3_u32 v4, v216, v217, v218
    v_max3_u32 v5, v219, v220, v221
    v_max3_u32 v4, v4, v222, v223
    v_max_u32 v4, v4, v5
    v_cmp_eq_u32 vcc, -1, v4

    s_cbranch_vccz .W_147
.A_146:
    buffer_load_dwordx4 v[216:219], v246, s[8:11], s33 offen offset:2048 sc1
    buffer_load_dwordx4 v[220:223], v246, s[8:11], s33 offen offset:3072 sc1
    s_waitcnt vmcnt(4)
    v_max3_u32 v4, v192, v193, v194
    v_max3_u32 v5, v195, v196, v197
    v_max3_u32 v4, v4, v198, v199
    v_max_u32 v4, v4, v5
    v_cmp_eq_u32 vcc, -1, v4

    s_cbranch_vccz .W_159
.A_160:
    buffer_load_dwordx4 v[192:195], v246, s[8:11], s32 offen offset:0 sc1
    buffer_load_dwordx4 v[196:199], v246, s[8:11], s32 offen offset:1024 sc1
    s_waitcnt vmcnt(4)
    v_max3_u32 v4, v200, v201, v202
    v_max3_u32 v5, v203, v204, v205
    v_max3_u32 v4, v4, v206, v207
    v_max_u32 v4, v4, v5
    v_cmp_eq_u32 vcc, -1, v4

    s_cbranch_vccnz .A_158
.W_161:
    v_smfmac_f32_16x16x64_bf16 v[76:79], v[200:203], a[208:215], v9
    v_smfmac_f32_16x16x64_bf16 v[80:83], v[200:203], a[240:247], v9
    v_smfmac_f32_16x16x64_bf16 v[76:79], v[204:207], a[216:223], v9
    v_smfmac_f32_16x16x64_bf16 v[80:83], v[204:207], a[248:255], v9
    s_waitcnt vmcnt(2)
    v_max3_u32 v4, v216, v217, v218
    v_max3_u32 v5, v219, v220, v221
    v_max3_u32 v4, v4, v222, v223
    v_max_u32 v4, v4, v5
    v_cmp_eq_u32 vcc, -1, v4

    s_cbranch_vccz .W_143
    s_branch .A_142
.W_159:
    v_smfmac_f32_16x16x64_bf16 v[76:79], v[192:195], a[192:199], v9
    v_smfmac_f32_16x16x64_bf16 v[80:83], v[192:195], a[224:231], v9
    v_smfmac_f32_16x16x64_bf16 v[76:79], v[196:199], a[200:207], v9
    v_smfmac_f32_16x16x64_bf16 v[80:83], v[196:199], a[232:239], v9
    s_waitcnt vmcnt(2)
    v_max3_u32 v4, v200, v201, v202
    v_max3_u32 v5, v203, v204, v205
    v_max3_u32 v4, v4, v206, v207
    v_max_u32 v4, v4, v5
    v_cmp_eq_u32 vcc, -1, v4

    s_cbranch_vccnz .A_162
.W_163:
    v_smfmac_f32_16x16x64_bf16 v[76:79], v[200:203], a[208:215], v9
    v_smfmac_f32_16x16x64_bf16 v[80:83], v[200:203], a[240:247], v9
    v_smfmac_f32_16x16x64_bf16 v[76:79], v[204:207], a[216:223], v9
    v_smfmac_f32_16x16x64_bf16 v[80:83], v[204:207], a[248:255], v9
    s_waitcnt vmcnt(4)
    v_max3_u32 v4, v216, v217, v218
    v_max3_u32 v5, v219, v220, v221
    v_max3_u32 v4, v4, v222, v223
    v_max_u32 v4, v4, v5
    v_cmp_eq_u32 vcc, -1, v4

    s_cbranch_vccz .W_49
    s_branch .A_48
.A_164:
    buffer_load_dwordx4 v[216:219], v246, s[8:11], s33 offen offset:2048 sc1
    buffer_load_dwordx4 v[220:223], v246, s[8:11], s33 offen offset:3072 sc1
    s_sub_u32 s62, s62, 1
    s_cbranch_scc1 .mg_end_1
    s_waitcnt vmcnt(4)
    v_max3_u32 v4, v192, v193, v194
    v_max3_u32 v5, v195, v196, v197
    v_max3_u32 v4, v4, v198, v199
    v_max_u32 v4, v4, v5
    v_cmp_eq_u32 vcc, -1, v4

    s_cbranch_vccz .W_165
.A_166:
    buffer_load_dwordx4 v[192:195], v246, s[8:11], s32 offen offset:0 sc1
    buffer_load_dwordx4 v[196:199], v246, s[8:11], s32 offen offset:1024 sc1
    s_waitcnt vmcnt(4)
    v_max3_u32 v4, v208, v209, v210
    v_max3_u32 v5, v211, v212, v213
    v_max3_u32 v4, v4, v214, v215
    v_max_u32 v4, v4, v5
    v_cmp_eq_u32 vcc, -1, v4

    s_cbranch_vccz .W_141
.A_140:
    buffer_load_dwordx4 v[208:211], v246, s[8:11], s33 offen offset:0 sc1
    buffer_load_dwordx4 v[212:215], v246, s[8:11], s33 offen offset:1024 sc1
    s_waitcnt vmcnt(4)
    v_max3_u32 v4, v216, v217, v218
    v_max3_u32 v5, v219, v220, v221
    v_max3_u32 v4, v4, v222, v223
    v_max_u32 v4, v4, v5
    v_cmp_eq_u32 vcc, -1, v4

    s_cbranch_vccnz .A_164
.W_167:
    v_smfmac_f32_16x16x64_bf16 v[76:79], v[216:219], v[140:147], v9
    v_smfmac_f32_16x16x64_bf16 v[80:83], v[216:219], v[172:179], v9
    v_smfmac_f32_16x16x64_bf16 v[76:79], v[220:223], v[148:155], v9
    v_smfmac_f32_16x16x64_bf16 v[80:83], v[220:223], v[180:187], v9
    s_waitcnt vmcnt(2)
    v_max3_u32 v4, v192, v193, v194
    v_max3_u32 v5, v195, v196, v197
    v_max3_u32 v4, v4, v198, v199
    v_max_u32 v4, v4, v5
    v_cmp_eq_u32 vcc, -1, v4

    s_cbranch_vccnz .A_168
.W_169:
    v_smfmac_f32_16x16x64_bf16 v[76:79], v[192:195], a[192:199], v9
    v_smfmac_f32_16x16x64_bf16 v[80:83], v[192:195], a[224:231], v9
    v_smfmac_f32_16x16x64_bf16 v[76:79], v[196:199], a[200:207], v9
    v_smfmac_f32_16x16x64_bf16 v[80:83], v[196:199], a[232:239], v9
    s_waitcnt vmcnt(4)
    v_max3_u32 v4, v208, v209, v210
    v_max3_u32 v5, v211, v212, v213
    v_max3_u32 v4, v4, v214, v215
    v_max_u32 v4, v4, v5
    v_cmp_eq_u32 vcc, -1, v4

    s_cbranch_vccz .W_139
    s_branch .A_138
.W_165:
    v_smfmac_f32_16x16x64_bf16 v[76:79], v[192:195], a[192:199], v9
    v_smfmac_f32_16x16x64_bf16 v[80:83], v[192:195], a[224:231], v9
    v_smfmac_f32_16x16x64_bf16 v[76:79], v[196:199], a[200:207], v9
    v_smfmac_f32_16x16x64_bf16 v[80:83], v[196:199], a[232:239], v9
    s_waitcnt vmcnt(2)
    v_max3_u32 v4, v208, v209, v210
    v_max3_u32 v5, v211, v212, v213
    v_max3_u32 v4, v4, v214, v215
    v_max_u32 v4, v4, v5
    v_cmp_eq_u32 vcc, -1, v4

    s_cbranch_vccz .W_47
    s_branch .A_46
.A_170:
    buffer_load_dwordx4 v[216:219], v246, s[8:11], s33 offen offset:2048 sc1
    buffer_load_dwordx4 v[220:223], v246, s[8:11], s33 offen offset:3072 sc1
    s_sub_u32 s62, s62, 1
    s_cbranch_scc1 .mg_end_1
    s_waitcnt vmcnt(4)
    v_max3_u32 v4, v200, v201, v202
    v_max3_u32 v5, v203, v204, v205
    v_max3_u32 v4, v4, v206, v207
    v_max_u32 v4, v4, v5
    v_cmp_eq_u32 vcc, -1, v4

    s_cbranch_vccz .W_45
.A_44:
    buffer_load_dwordx4 v[200:203], v246, s[8:11], s32 offen offset:2048 sc1
    buffer_load_dwordx4 v[204:207], v246, s[8:11], s32 offen offset:3072 sc1
    s_waitcnt vmcnt(4)
    v_max3_u32 v4, v208, v209, v210
    v_max3_u32 v5, v211, v212, v213
    v_max3_u32 v4, v4, v214, v215
    v_max_u32 v4, v4, v5
    v_cmp_eq_u32 vcc, -1, v4

    s_cbranch_vccz .W_171
.A_172:
    buffer_load_dwordx4 v[208:211], v246, s[8:11], s33 offen offset:0 sc1
    buffer_load_dwordx4 v[212:215], v246, s[8:11], s33 offen offset:1024 sc1
    s_waitcnt vmcnt(4)
    v_max3_u32 v4, v216, v217, v218
    v_max3_u32 v5, v219, v220, v221
    v_max3_u32 v4, v4, v222, v223
    v_max_u32 v4, v4, v5
    v_cmp_eq_u32 vcc, -1, v4

    s_cbranch_vccnz .A_170
.W_173:
    v_smfmac_f32_16x16x64_bf16 v[76:79], v[216:219], v[140:147], v9
    v_smfmac_f32_16x16x64_bf16 v[80:83], v[216:219], v[172:179], v9
    v_smfmac_f32_16x16x64_bf16 v[76:79], v[220:223], v[148:155], v9
    v_smfmac_f32_16x16x64_bf16 v[80:83], v[220:223], v[180:187], v9
    s_waitcnt vmcnt(2)
    v_max3_u32 v4, v200, v201, v202
    v_max3_u32 v5, v203, v204, v205
    v_max3_u32 v4, v4, v206, v207
    v_max_u32 v4, v4, v5
    v_cmp_eq_u32 vcc, -1, v4

    s_cbranch_vccz .W_137
    s_branch .A_136
.W_171:
    v_smfmac_f32_16x16x64_bf16 v[76:79], v[208:211], v[124:131], v9
    v_smfmac_f32_16x16x64_bf16 v[80:83], v[208:211], v[156:163], v9
    v_smfmac_f32_16x16x64_bf16 v[76:79], v[212:215], v[132:139], v9
    v_smfmac_f32_16x16x64_bf16 v[80:83], v[212:215], v[164:171], v9
    s_waitcnt vmcnt(2)
    v_max3_u32 v4, v216, v217, v218
    v_max3_u32 v5, v219, v220, v221
    v_max3_u32 v4, v4, v222, v223
    v_max_u32 v4, v4, v5
    v_cmp_eq_u32 vcc, -1, v4

    s_cbranch_vccnz .A_174
.W_175:
    v_smfmac_f32_16x16x64_bf16 v[76:79], v[216:219], v[140:147], v9
    v_smfmac_f32_16x16x64_bf16 v[80:83], v[216:219], v[172:179], v9
    v_smfmac_f32_16x16x64_bf16 v[76:79], v[220:223], v[148:155], v9
    v_smfmac_f32_16x16x64_bf16 v[80:83], v[220:223], v[180:187], v9
    s_waitcnt vmcnt(4)
    v_max3_u32 v4, v200, v201, v202
    v_max3_u32 v5, v203, v204, v205
    v_max3_u32 v4, v4, v206, v207
    v_max_u32 v4, v4, v5
    v_cmp_eq_u32 vcc, -1, v4

    s_cbranch_vccz .W_151
    s_branch .A_150
.A_176:
    buffer_load_dwordx4 v[200:203], v246, s[8:11], s32 offen offset:2048 sc1
    buffer_load_dwordx4 v[204:207], v246, s[8:11], s32 offen offset:3072 sc1
    s_sub_u32 s62, s62, 1
    s_cbranch_scc1 .mg_end_1
    s_waitcnt vmcnt(6)
    v_max3_u32 v4, v192, v193, v194
    v_max3_u32 v5, v195, v196, v197
    v_max3_u32 v4, v4, v198, v199
    v_max_u32 v4, v4, v5
    v_cmp_eq_u32 vcc, -1, v4

    s_cbranch_vccz .W_149
.A_148:
    buffer_load_dwordx4 v[192:195], v246, s[8:11], s32 offen offset:0 sc1
    buffer_load_dwordx4 v[196:199], v246, s[8:11], s32 offen offset:1024 sc1
    s_waitcnt vmcnt(6)
    v_max3_u32 v4, v200, v201, v202
    v_max3_u32 v5, v203, v204, v205
    v_max3_u32 v4, v4, v206, v207
    v_max_u32 v4, v4, v5
    v_cmp_eq_u32 vcc, -1, v4

    s_cbranch_vccnz .A_176
.W_177:
    v_smfmac_f32_16x16x64_bf16 v[76:79], v[200:203], a[208:215], v9
    v_smfmac_f32_16x16x64_bf16 v[80:83], v[200:203], a[240:247], v9
    v_smfmac_f32_16x16x64_bf16 v[76:79], v[204:207], a[216:223], v9
    v_smfmac_f32_16x16x64_bf16 v[80:83], v[204:207], a[248:255], v9
    s_waitcnt vmcnt(4)
    v_max3_u32 v4, v192, v193, v194
    v_max3_u32 v5, v195, v196, v197
    v_max3_u32 v4, v4, v198, v199
    v_max_u32 v4, v4, v5
    v_cmp_eq_u32 vcc, -1, v4

    s_cbranch_vccz .W_145
    s_branch .A_144
.A_156:
    buffer_load_dwordx4 v[208:211], v246, s[8:11], s33 offen offset:0 sc1
    buffer_load_dwordx4 v[212:215], v246, s[8:11], s33 offen offset:1024 sc1
    s_sub_u32 s62, s62, 1
    s_cbranch_scc1 .mg_end_1
    s_waitcnt vmcnt(6)
    v_max3_u32 v4, v192, v193, v194
    v_max3_u32 v5, v195, v196, v197
    v_max3_u32 v4, v4, v198, v199
    v_max_u32 v4, v4, v5
    v_cmp_eq_u32 vcc, -1, v4

    s_cbranch_vccz .W_169
.A_168:
    buffer_load_dwordx4 v[192:195], v246, s[8:11], s32 offen offset:0 sc1
    buffer_load_dwordx4 v[196:199], v246, s[8:11], s32 offen offset:1024 sc1
    s_waitcnt vmcnt(6)
    v_max3_u32 v4, v208, v209, v210
    v_max3_u32 v5, v211, v212, v213
    v_max3_u32 v4, v4, v214, v215
    v_max_u32 v4, v4, v5
    v_cmp_eq_u32 vcc, -1, v4

    s_cbranch_vccnz .A_156
    s_branch .W_157
.A_178:
    buffer_load_dwordx4 v[192:195], v246, s[8:11], s32 offen offset:0 sc1
    buffer_load_dwordx4 v[196:199], v246, s[8:11], s32 offen offset:1024 sc1
    s_sub_u32 s62, s62, 1
    s_cbranch_scc1 .mg_end_1
    s_waitcnt vmcnt(6)
    v_max3_u32 v4, v216, v217, v218
    v_max3_u32 v5, v219, v220, v221
    v_max3_u32 v4, v4, v222, v223
    v_max_u32 v4, v4, v5
    v_cmp_eq_u32 vcc, -1, v4

    s_cbranch_vccz .W_143
.A_142:
    buffer_load_dwordx4 v[216:219], v246, s[8:11], s33 offen offset:2048 sc1
    buffer_load_dwordx4 v[220:223], v246, s[8:11], s33 offen offset:3072 sc1
    s_waitcnt vmcnt(6)
    v_max3_u32 v4, v192, v193, v194
    v_max3_u32 v5, v195, v196, v197
    v_max3_u32 v4, v4, v198, v199
    v_max_u32 v4, v4, v5
    v_cmp_eq_u32 vcc, -1, v4

    s_cbranch_vccnz .A_178
.W_179:
    v_smfmac_f32_16x16x64_bf16 v[76:79], v[192:195], a[192:199], v9
    v_smfmac_f32_16x16x64_bf16 v[80:83], v[192:195], a[224:231], v9
    v_smfmac_f32_16x16x64_bf16 v[76:79], v[196:199], a[200:207], v9
    v_smfmac_f32_16x16x64_bf16 v[80:83], v[196:199], a[232:239], v9
    s_waitcnt vmcnt(4)
    v_max3_u32 v4, v216, v217, v218
    v_max3_u32 v5, v219, v220, v221
    v_max3_u32 v4, v4, v222, v223
    v_max_u32 v4, v4, v5
    v_cmp_eq_u32 vcc, -1, v4

    s_cbranch_vccz .W_49
    s_branch .A_48
.A_180:
    buffer_load_dwordx4 v[208:211], v246, s[8:11], s33 offen offset:0 sc1
    buffer_load_dwordx4 v[212:215], v246, s[8:11], s33 offen offset:1024 sc1
    s_sub_u32 s62, s62, 1
    s_cbranch_scc1 .mg_end_1
    s_waitcnt vmcnt(6)
    v_max3_u32 v4, v200, v201, v202
    v_max3_u32 v5, v203, v204, v205
    v_max3_u32 v4, v4, v206, v207
    v_max_u32 v4, v4, v5
    v_cmp_eq_u32 vcc, -1, v4

    s_cbranch_vccz .W_137
.A_136:
    buffer_load_dwordx4 v[200:203], v246, s[8:11], s32 offen offset:2048 sc1
    buffer_load_dwordx4 v[204:207], v246, s[8:11], s32 offen offset:3072 sc1
    s_waitcnt vmcnt(6)
    v_max3_u32 v4, v208, v209, v210
    v_max3_u32 v5, v211, v212, v213
    v_max3_u32 v4, v4, v214, v215
    v_max_u32 v4, v4, v5
    v_cmp_eq_u32 vcc, -1, v4

    s_cbranch_vccnz .A_180
.W_181:
    v_smfmac_f32_16x16x64_bf16 v[76:79], v[208:211], v[124:131], v9
    v_smfmac_f32_16x16x64_bf16 v[80:83], v[208:211], v[156:163], v9
    v_smfmac_f32_16x16x64_bf16 v[76:79], v[212:215], v[132:139], v9
    v_smfmac_f32_16x16x64_bf16 v[80:83], v[212:215], v[164:171], v9
    s_waitcnt vmcnt(4)
    v_max3_u32 v4, v200, v201, v202
    v_max3_u32 v5, v203, v204, v205
    v_max3_u32 v4, v4, v206, v207
    v_max_u32 v4, v4, v5
    v_cmp_eq_u32 vcc, -1, v4

    s_cbranch_vccz .W_151
    s_branch .A_150
.A_174:
    buffer_load_dwordx4 v[216:219], v246, s[8:11], s33 offen offset:2048 sc1
    buffer_load_dwordx4 v[220:223], v246, s[8:11], s33 offen offset:3072 sc1
    s_sub_u32 s62, s62, 1
    s_cbranch_scc1 .mg_end_1
    s_waitcnt vmcnt(6)
    v_max3_u32 v4, v200, v201, v202
    v_max3_u32 v5, v203, v204, v205
    v_max3_u32 v4, v4, v206, v207
    v_max_u32 v4, v4, v5
    v_cmp_eq_u32 vcc, -1, v4

    s_cbranch_vccz .W_163
.A_162:
    buffer_load_dwordx4 v[200:203], v246, s[8:11], s32 offen offset:2048 sc1
    buffer_load_dwordx4 v[204:207], v246, s[8:11], s32 offen offset:3072 sc1
    s_waitcnt vmcnt(6)
    v_max3_u32 v4, v216, v217, v218
    v_max3_u32 v5, v219, v220, v221
    v_max3_u32 v4, v4, v222, v223
    v_max_u32 v4, v4, v5
    v_cmp_eq_u32 vcc, -1, v4

    s_cbranch_vccnz .A_174
    s_branch .W_175
.A_182:
    buffer_load_dwordx4 v[216:219], v246, s[8:11], s33 offen offset:2048 sc1
    buffer_load_dwordx4 v[220:223], v246, s[8:11], s33 offen offset:3072 sc1
    s_sub_u32 s62, s62, 1
    s_cbranch_scc1 .mg_end_1
    s_waitcnt vmcnt(6)
    v_max3_u32 v4, v208, v209, v210
    v_max3_u32 v5, v211, v212, v213
    v_max3_u32 v4, v4, v214, v215
    v_max_u32 v4, v4, v5
    v_cmp_eq_u32 vcc, -1, v4

    s_cbranch_vccz .W_47
.A_46:
    buffer_load_dwordx4 v[208:211], v246, s[8:11], s33 offen offset:0 sc1
    buffer_load_dwordx4 v[212:215], v246, s[8:11], s33 offen offset:1024 sc1
    s_waitcnt vmcnt(6)
    v_max3_u32 v4, v216, v217, v218
    v_max3_u32 v5, v219, v220, v221
    v_max3_u32 v4, v4, v222, v223
    v_max_u32 v4, v4, v5
    v_cmp_eq_u32 vcc, -1, v4

    s_cbranch_vccnz .A_182
.W_183:
    v_smfmac_f32_16x16x64_bf16 v[76:79], v[216:219], v[140:147], v9
    v_smfmac_f32_16x16x64_bf16 v[80:83], v[216:219], v[172:179], v9
    v_smfmac_f32_16x16x64_bf16 v[76:79], v[220:223], v[148:155], v9
    v_smfmac_f32_16x16x64_bf16 v[80:83], v[220:223], v[180:187], v9
    s_waitcnt vmcnt(4)
    v_max3_u32 v4, v208, v209, v210
    v_max3_u32 v5, v211, v212, v213
    v_max3_u32 v4, v4, v214, v215
    v_max_u32 v4, v4, v5
    v_cmp_eq_u32 vcc, -1, v4

    s_cbranch_vccz .W_139
    s_branch .A_138
.A_144:
    buffer_load_dwordx4 v[192:195], v246, s[8:11], s32 offen offset:0 sc1
    buffer_load_dwordx4 v[196:199], v246, s[8:11], s32 offen offset:1024 sc1
    s_sub_u32 s62, s62, 1
    s_cbranch_scc1 .mg_end_1
    s_waitcnt vmcnt(4)
    v_max3_u32 v4, v192, v193, v194
    v_max3_u32 v5, v195, v196, v197
    v_max3_u32 v4, v4, v198, v199
    v_max_u32 v4, v4, v5
    v_cmp_eq_u32 vcc, -1, v4

    s_cbranch_vccnz .A_144
    v_smfmac_f32_16x16x64_bf16 v[76:79], v[192:195], a[192:199], v9
    v_smfmac_f32_16x16x64_bf16 v[80:83], v[192:195], a[224:231], v9
    v_smfmac_f32_16x16x64_bf16 v[76:79], v[196:199], a[200:207], v9
    v_smfmac_f32_16x16x64_bf16 v[80:83], v[196:199], a[232:239], v9
    s_branch .mj_41
.A_150:
    buffer_load_dwordx4 v[200:203], v246, s[8:11], s32 offen offset:2048 sc1
    buffer_load_dwordx4 v[204:207], v246, s[8:11], s32 offen offset:3072 sc1
    s_sub_u32 s62, s62, 1
    s_cbranch_scc1 .mg_end_1
    s_waitcnt vmcnt(4)
    v_max3_u32 v4, v200, v201, v202
    v_max3_u32 v5, v203, v204, v205
    v_max3_u32 v4, v4, v206, v207
    v_max_u32 v4, v4, v5
    v_cmp_eq_u32 vcc, -1, v4

    s_cbranch_vccnz .A_150
    v_smfmac_f32_16x16x64_bf16 v[76:79], v[200:203], a[208:215], v9
    v_smfmac_f32_16x16x64_bf16 v[80:83], v[200:203], a[240:247], v9
    v_smfmac_f32_16x16x64_bf16 v[76:79], v[204:207], a[216:223], v9
    v_smfmac_f32_16x16x64_bf16 v[80:83], v[204:207], a[248:255], v9
    s_branch .mj_41
.A_138:
    buffer_load_dwordx4 v[208:211], v246, s[8:11], s33 offen offset:0 sc1
    buffer_load_dwordx4 v[212:215], v246, s[8:11], s33 offen offset:1024 sc1
    s_sub_u32 s62, s62, 1
    s_cbranch_scc1 .mg_end_1
    s_waitcnt vmcnt(4)
    v_max3_u32 v4, v208, v209, v210
    v_max3_u32 v5, v211, v212, v213
    v_max3_u32 v4, v4, v214, v215
    v_max_u32 v4, v4, v5
    v_cmp_eq_u32 vcc, -1, v4

    s_cbranch_vccnz .A_138
    v_smfmac_f32_16x16x64_bf16 v[76:79], v[208:211], v[124:131], v9
    v_smfmac_f32_16x16x64_bf16 v[80:83], v[208:211], v[156:163], v9
    v_smfmac_f32_16x16x64_bf16 v[76:79], v[212:215], v[132:139], v9
    v_smfmac_f32_16x16x64_bf16 v[80:83], v[212:215], v[164:171], v9
    s_branch .mj_41
.A_48:
    buffer_load_dwordx4 v[216:219], v246, s[8:11], s33 offen offset:2048 sc1
    buffer_load_dwordx4 v[220:223], v246, s[8:11], s33 offen offset:3072 sc1
    s_sub_u32 s62, s62, 1
    s_cbranch_scc1 .mg_end_1
    s_waitcnt vmcnt(4)
    v_max3_u32 v4, v216, v217, v218
    v_max3_u32 v5, v219, v220, v221
    v_max3_u32 v4, v4, v222, v223
    v_max_u32 v4, v4, v5
    v_cmp_eq_u32 vcc, -1, v4

    s_cbranch_vccnz .A_48
    v_smfmac_f32_16x16x64_bf16 v[76:79], v[216:219], v[140:147], v9
    v_smfmac_f32_16x16x64_bf16 v[80:83], v[216:219], v[172:179], v9
    v_smfmac_f32_16x16x64_bf16 v[76:79], v[220:223], v[148:155], v9
    v_smfmac_f32_16x16x64_bf16 v[80:83], v[220:223], v[180:187], v9
    s_branch .mj_41
.kf_50:
    s_mov_b32 s62, 0
    s_mov_b64 exec, 3
.wf_184:
    buffer_load_dword v244, v253, s[8:11], s89 offen sc1
    s_waitcnt vmcnt(0)
    v_cmp_gt_u32 vcc, s6, v244
    s_cbranch_vccz .wfd_185
    s_sleep 2
    s_add_u32 s62, s62, 1
    s_cmp_gt_u32 s62, 0x400000
    s_cbranch_scc1 .mg_end_1
    s_branch .wf_184

.wfd_185:
    s_mov_b64 exec, -1
    v_readlane_b32 s4, v244, 0
    v_readlane_b32 s93, v244, 1
    s_min_u32 s93, s93, s4
    s_mov_b32 s62, 0x1000000
    s_branch .kb_51
.sk_53:
    s_mov_b64 exec, s[66:67]
    buffer_store_dwordx4 v[88:91], v11, s[8:11], s36 offen sc1
    s_mov_b64 exec, s[56:57]
    buffer_store_dwordx4 v[172:175], v12, s[8:11], s36 offen sc1
    s_mov_b64 exec, -1

    s_branch .rec_fin_5
.p2align 6
.top_186:
    s_barrier
    buffer_load_dwordx4 v[20:23], v8, s[8:11], s29 offen offset:0 sc1
    buffer_load_dwordx4 v[24:27], v8, s[8:11], s29 offen offset:1024 sc1
    buffer_load_dwordx4 v[28:31], v8, s[8:11], s29 offen offset:2048 sc1
    buffer_load_dwordx4 v[32:35], v8, s[8:11], s29 offen offset:3072 sc1
.ent1_17:
    s_waitcnt vmcnt(3)
    v_max3_u32 v4, v20, v21, v22
    v_max_u32 v4, v4, v23
    v_cmp_eq_u32 vcc, -1, v4
    s_cbranch_vccnz .A_191
.W_192:
    v_smfmac_f32_16x16x64_bf16 v[52:55], v[20:23], a[0:7], v9
    v_smfmac_f32_16x16x64_bf16 v[56:59], v[20:23], a[32:39], v9
    v_smfmac_f32_16x16x64_bf16 v[60:63], v[20:23], a[64:71], v9
    v_smfmac_f32_16x16x64_bf16 v[64:67], v[20:23], a[96:103], v9
    s_waitcnt vmcnt(2)
    v_max3_u32 v4, v24, v25, v26
    v_max_u32 v4, v4, v27
    v_cmp_eq_u32 vcc, -1, v4
    s_cbranch_vccnz .A_193
.W_194:
    v_smfmac_f32_16x16x64_bf16 v[52:55], v[24:27], a[8:15], v9
    v_smfmac_f32_16x16x64_bf16 v[56:59], v[24:27], a[40:47], v9
    v_smfmac_f32_16x16x64_bf16 v[60:63], v[24:27], a[72:79], v9
    v_smfmac_f32_16x16x64_bf16 v[64:67], v[24:27], a[104:111], v9
    s_waitcnt vmcnt(1)
    v_max3_u32 v4, v28, v29, v30
    v_max_u32 v4, v4, v31
    v_cmp_eq_u32 vcc, -1, v4
    s_cbranch_vccnz .A_195
.W_196:
    v_smfmac_f32_16x16x64_bf16 v[52:55], v[28:31], a[16:23], v9
    v_smfmac_f32_16x16x64_bf16 v[56:59], v[28:31], a[48:55], v9
    v_smfmac_f32_16x16x64_bf16 v[60:63], v[28:31], a[80:87], v9
    v_smfmac_f32_16x16x64_bf16 v[64:67], v[28:31], a[112:119], v9
    s_waitcnt vmcnt(2)
    v_max3_u32 v4, v32, v33, v34
    v_max_u32 v4, v4, v35
    v_cmp_eq_u32 vcc, -1, v4
    s_cbranch_vccnz .A_197
.W_198:
    v_smfmac_f32_16x16x64_bf16 v[52:55], v[32:35], a[24:31], v9
    v_smfmac_f32_16x16x64_bf16 v[56:59], v[32:35], a[56:63], v9
    v_smfmac_f32_16x16x64_bf16 v[60:63], v[32:35], a[88:95], v9
    v_smfmac_f32_16x16x64_bf16 v[64:67], v[32:35], a[120:127], v9
.mj_190:
    v_cvt_pk_bf16_f32 v104, v52, v53
    v_cvt_pk_bf16_f32 v105, v54, v55
    v_cvt_pk_bf16_f32 v106, v56, v57
    v_cvt_pk_bf16_f32 v107, v58, v59
    ds_write_b64 v16, v[104:105] offset:4096
    v_cvt_pk_bf16_f32 v108, v60, v61
    v_cvt_pk_bf16_f32 v109, v62, v63
    ds_write_b64 v16, v[106:107] offset:6144
    ds_write_b64 v16, v[108:109] offset:0
    v_cvt_pk_bf16_f32 v110, v64, v65
    v_cvt_pk_bf16_f32 v111, v66, v67
    ds_write_b64 v16, v[110:111] offset:2048
    v_smfmac_f32_16x16x64_bf16 v[68:71], v[20:23], a[128:135], v9
    v_smfmac_f32_16x16x64_bf16 v[72:75], v[20:23], a[160:167], v9
    s_waitcnt vmcnt(4) lgkmcnt(0)
    s_barrier
    ds_read_b128 v[36:39], v17 offset:0
    ds_read_b128 v[40:43], v17 offset:1024
    v_smfmac_f32_16x16x64_bf16 v[68:71], v[24:27], a[136:143], v9
    v_smfmac_f32_16x16x64_bf16 v[72:75], v[24:27], a[168:175], v9
    s_waitcnt lgkmcnt(1)
    v_mfma_f32_16x16x32_bf16 v[44:47], v[36:39], v[84:87], 0
    s_waitcnt lgkmcnt(0)
    v_mfma_f32_16x16x32_bf16 v[44:47], v[40:43], v[84:87], v[44:47]
    v_smfmac_f32_16x16x64_bf16 v[68:71], v[28:31], a[144:151], v9
    v_smfmac_f32_16x16x64_bf16 v[72:75], v[28:31], a[176:183], v9
    s_mov_b64 exec, s[64:65]
    v_cvt_pk_bf16_f32 v48, v44, v45
    v_cvt_pk_bf16_f32 v49, v46, v47
    v_min_u32 v48, 0xfffffffe, v48
    v_min_u32 v49, 0xfffffffe, v49
    buffer_store_dwordx2 v[48:49], v10, s[8:11], s29 offen sc1

    ds_write_b64 v18, v[48:49]
    s_mov_b64 exec, -1

    v_smfmac_f32_16x16x64_bf16 v[68:71], v[32:35], a[152:159], v9
    v_smfmac_f32_16x16x64_bf16 v[72:75], v[32:35], a[184:191], v9
    s_nop 3
    v_cvt_pk_bf16_f32 v104, v68, v69
    v_cvt_pk_bf16_f32 v105, v70, v71
    ds_write_b64 v16, v[104:105] offset:8192
    s_nop 0
    v_cvt_pk_bf16_f32 v106, v72, v73
    v_cvt_pk_bf16_f32 v107, v74, v75
    ds_write_b64 v16, v[106:107] offset:10240
    s_cmp_lg_u32 s24, 2
    s_waitcnt lgkmcnt(0)
    s_barrier
    s_cbranch_scc1 .oth_187
    buffer_load_dwordx4 v[92:95], v232, s[8:11], s29 offen sc1
    buffer_load_dwordx4 v[96:99], v233, s[8:11], s29 offen sc1
    buffer_load_dwordx4 v[100:103], v234, s[8:11], s29 offen sc1
    ds_read_b128 v[88:91], v14 offset:16384
    ds_read_b128 v[128:131], v228 offset:0
    ds_read_b128 v[144:147], v228 offset:4096
    ds_read_b128 v[132:135], v229 offset:0
    ds_read_b128 v[148:151], v229 offset:4096
    ds_read_b128 v[136:139], v230 offset:0
    ds_read_b128 v[152:155], v230 offset:4096
    ds_read_b128 v[140:143], v231 offset:0
    ds_read_b128 v[156:159], v231 offset:4096
    ds_read_b128 v[160:163], v14 offset:28672
    ds_read_b128 v[164:167], v14 offset:29696
    s_cmp_eq_u32 s28, 63
    s_cbranch_scc1 .rec_fin_5
    s_waitcnt lgkmcnt(0)
    v_mfma_f32_16x16x32_bf16 v[208:211], v[128:131], v[88:91], 0
    v_mfma_f32_16x16x32_bf16 v[212:215], v[144:147], v[88:91], 0
    v_mfma_f32_16x16x32_bf16 v[216:219], v[88:91], v[88:91], v[116:119]
    s_waitcnt vmcnt(2)
    v_max3_u32 v4, v92, v93, v94
    v_max_u32 v4, v4, v95
    v_cmp_eq_u32 vcc, -1, v4
    s_cbranch_vccnz .A_200
.W_201:
    v_mfma_f32_16x16x32_bf16 v[208:211], v[132:135], v[92:95], v[208:211]
    v_mfma_f32_16x16x32_bf16 v[212:215], v[148:151], v[92:95], v[212:215]
    v_mfma_f32_16x16x32_bf16 v[216:219], v[92:95], v[92:95], v[216:219]
    s_waitcnt vmcnt(1)
    v_max3_u32 v4, v96, v97, v98
    v_max_u32 v4, v4, v99
    v_cmp_eq_u32 vcc, -1, v4
    s_cbranch_vccnz .A_202
.W_203:
    v_mfma_f32_16x16x32_bf16 v[208:211], v[136:139], v[96:99], v[208:211]
    v_mfma_f32_16x16x32_bf16 v[212:215], v[152:155], v[96:99], v[212:215]
    v_mfma_f32_16x16x32_bf16 v[216:219], v[96:99], v[96:99], v[216:219]
    s_waitcnt vmcnt(2)
    v_max3_u32 v4, v100, v101, v102
    v_max_u32 v4, v4, v103
    v_cmp_eq_u32 vcc, -1, v4
    s_cbranch_vccnz .A_204
.W_205:
    v_mfma_f32_16x16x32_bf16 v[208:211], v[140:143], v[100:103], v[208:211]
    v_mfma_f32_16x16x32_bf16 v[212:215], v[156:159], v[100:103], v[212:215]
    v_mfma_f32_16x16x32_bf16 v[216:219], v[100:103], v[100:103], v[216:219]
.mj_199:
    s_barrier
    ds_read_b64 v[168:169], v14 offset:18432
    ds_read_b64 v[172:173], v14 offset:18440
    s_nop 0

    v_mov_b32_dpp v208, v212 row_ror:8 row_mask:0xf bank_mask:0xc
    v_mov_b32_dpp v209, v213 row_ror:8 row_mask:0xf bank_mask:0xc
    v_mov_b32_dpp v210, v214 row_ror:8 row_mask:0xf bank_mask:0xc
    v_mov_b32_dpp v211, v215 row_ror:8 row_mask:0xf bank_mask:0xc
    v_mov_b32_dpp v216, v218 row_ror:8 row_mask:0xf bank_mask:0xc
    v_mov_b32_dpp v217, v219 row_ror:8 row_mask:0xf bank_mask:0xc
    v_max3_f32 v4, v208, v209, v210
    v_max3_f32 v5, v211, v216, v217
    v_max_f32 v6, v4, v5
    v_max_f32 v4, v4, v5
    s_nop 1
    v_permlane32_swap_b32 v4, v6
    v_max_f32 v5, v4, v6
    v_max_f32 v4, v4, v6
    s_nop 1
    v_permlane16_swap_b32 v4, v5
    v_max_f32 v4, v4, v5
    s_nop 1
    v_max_f32_dpp v4, v4, v4 row_ror:8 row_mask:0xf bank_mask:0xf
    v_mul_f32 v4, s37, v4

    v_fma_f32 v104, v208, s37, -v4
    v_fma_f32 v105, v209, s37, -v4
    v_fma_f32 v106, v210, s37, -v4
    v_fma_f32 v107, v211, s37, -v4
    v_fma_f32 v108, v216, s37, -v4
    v_fma_f32 v109, v217, s37, -v4
    v_exp_f32 v104, v104
    v_exp_f32 v105, v105
    v_exp_f32 v106, v106
    v_exp_f32 v107, v107
    v_exp_f32 v108, v108
    v_exp_f32 v109, v109
    v_cvt_pk_bf16_f32 v176, v104, v105
    v_cvt_pk_bf16_f32 v177, v106, v107
    v_cvt_pk_bf16_f32 v180, v108, v109
    v_mov_b32_dpp v178, v176 row_ror:8 row_mask:0xf bank_mask:0xf
    v_mov_b32_dpp v179, v177 row_ror:8 row_mask:0xf bank_mask:0xf
    v_mov_b32_dpp v181, v180 row_ror:8 row_mask:0xf bank_mask:0xf
    s_waitcnt lgkmcnt(0)

    v_mfma_f32_16x16x32_bf16 v[208:211], v[120:123], v[176:179], 0
    v_mfma_f32_16x16x32_bf16 v[208:211], v[120:123], v[180:183], v[208:211]
    v_mfma_f32_16x16x32_bf16 v[212:215], v[160:163], v[176:179], 0
    v_mfma_f32_16x16x32_bf16 v[216:219], v[164:167], v[176:179], 0
    v_mfma_f32_16x16x32_bf16 v[212:215], v[168:171], v[180:183], v[212:215]
    v_rcp_f32 v4, v208
    v_mfma_f32_16x16x32_bf16 v[216:219], v[172:175], v[180:183], v[216:219]
    s_mov_b64 exec, s[58:59]
    s_nop 2
    v_mul_f32 v212, v4, v212
    v_mul_f32 v213, v4, v213
    v_mul_f32 v214, v4, v214
    v_mul_f32 v215, v4, v215
    v_cvt_pk_bf16_f32 v184, v212, v213
    v_cvt_pk_bf16_f32 v185, v214, v215
    v_mul_f32 v216, v4, v216
    v_mul_f32 v217, v4, v217
    v_min_u32 v184, 0xfffffffe, v184
    v_min_u32 v185, 0xfffffffe, v185
    v_mul_f32 v218, v4, v218
    v_mul_f32 v219, v4, v219
    v_cvt_pk_bf16_f32 v186, v216, v217
    v_cvt_pk_bf16_f32 v187, v218, v219
    v_min_u32 v186, 0xfffffffe, v186
    v_min_u32 v187, 0xfffffffe, v187
    buffer_store_dwordx4 v[184:187], v13, s[8:11], s29 offen sc1
    s_mov_b64 exec, -1

.gp_189:
    s_barrier
    s_mov_b32 s99, s68
    s_add_u32 s28, s28, 1
    s_add_u32 s36, s36, 196608
    s_add_u32 s38, s38, 262144
    s_add_u32 s39, s39, 262144
    s_add_u32 s30, s30, 262144
    s_mov_b32 s4, s68
    s_mov_b32 s68, s69
    s_mov_b32 s69, s70
    s_mov_b32 s70, s71
    s_mov_b32 s71, s4
    s_and_b32 s4, s28, 3
    s_lshl_b32 s5, s4, 16
    s_add_u32 s29, s5, s34
    s_xor_b32 s6, s5, 0x20000
    s_add_u32 s31, s6, s34
    s_add_u32 s32, s29, 16384
    s_add_u32 s33, s29, 20480
    s_waitcnt vmcnt(0)
    s_barrier
    s_add_u32 s4, s99, 0
    buffer_load_dwordx4 v[192:195], v239, s[8:11], s4 offen sc1
    buffer_load_dwordx4 v[196:199], v249, s[8:11], s4 offen sc1

    s_barrier
    ds_read_b128 v[108:111], v248
    s_add_u32 s4, s99, 262144
    buffer_load_dwordx4 v[200:203], v239, s[8:11], s4 offen sc1
    buffer_load_dwordx4 v[204:207], v249, s[8:11], s4 offen sc1

    v_mov_b32 v52, 0
    v_mov_b32 v53, 0
    v_mov_b32 v54, 0
    v_mov_b32 v55, 0
    v_mov_b32 v56, 0
    v_mov_b32 v57, 0
    v_mov_b32 v58, 0
    v_mov_b32 v59, 0
    v_mov_b32 v60, 0
    v_mov_b32 v61, 0
    v_mov_b32 v62, 0
    v_mov_b32 v63, 0
    v_mov_b32 v64, 0
    v_mov_b32 v65, 0
    v_mov_b32 v66, 0
    v_mov_b32 v67, 0
    v_mov_b32 v68, 0
    v_mov_b32 v69, 0
    v_mov_b32 v70, 0
    v_mov_b32 v71, 0
    v_mov_b32 v72, 0
    v_mov_b32 v73, 0
    v_mov_b32 v74, 0
    v_mov_b32 v75, 0
    v_mov_b32 v20, -1
    v_mov_b32 v21, -1
    v_mov_b32 v22, -1
    v_mov_b32 v23, -1
    v_mov_b32 v24, -1
    v_mov_b32 v25, -1
    v_mov_b32 v26, -1
    v_mov_b32 v27, -1
    v_mov_b32 v28, -1
    v_mov_b32 v29, -1
    v_mov_b32 v30, -1
    v_mov_b32 v31, -1
    v_mov_b32 v32, -1
    v_mov_b32 v33, -1
    v_mov_b32 v34, -1
    v_mov_b32 v35, -1
    v_mov_b32 v92, -1
    v_mov_b32 v93, -1
    v_mov_b32 v94, -1
    v_mov_b32 v95, -1
    v_mov_b32 v96, -1
    v_mov_b32 v97, -1
    v_mov_b32 v98, -1
    v_mov_b32 v99, -1
    v_mov_b32 v100, -1
    v_mov_b32 v101, -1
    v_mov_b32 v102, -1
    v_mov_b32 v103, -1
    s_waitcnt lgkmcnt(0)
    v_mfma_f32_16x16x32_bf16 v[76:79], v[108:111], v[112:115], 0
.gc_206:
    s_waitcnt vmcnt(2)
    v_max_u32 v4, v192, v196
    v_cmp_eq_u32 vcc, -1, v4
    s_cbranch_vccnz .gf_207

    v_mfma_f32_16x16x32_bf16 v[76:79], v[192:195], v[84:87], v[76:79]
    v_mfma_f32_16x16x32_bf16 v[76:79], v[196:199], v[112:115], v[76:79]
    s_mov_b64 exec, s[58:59]
    s_nop 6
    v_cvt_pk_bf16_f32 v104, v76, v77
    v_cvt_pk_bf16_f32 v105, v78, v79
    v_min_u32 v104, 0xfffffffe, v104
    v_min_u32 v105, 0xfffffffe, v105
    buffer_store_dwordx2 v[104:105], v15, s[8:11], s29 offen sc1
    s_mov_b64 exec, -1

    s_branch .top_186
.gf_207:
    s_add_u32 s4, s99, 0
    buffer_load_dwordx4 v[192:195], v239, s[8:11], s4 offen sc1
    buffer_load_dwordx4 v[196:199], v249, s[8:11], s4 offen sc1

    s_waitcnt vmcnt(2)
    v_max_u32 v4, v200, v204
    v_cmp_eq_u32 vcc, -1, v4
    s_cbranch_vccnz .gf_208

    v_mfma_f32_16x16x32_bf16 v[76:79], v[200:203], v[84:87], v[76:79]
    v_mfma_f32_16x16x32_bf16 v[76:79], v[204:207], v[112:115], v[76:79]
    s_mov_b64 exec, s[58:59]
    s_nop 6
    v_cvt_pk_bf16_f32 v104, v76, v77
    v_cvt_pk_bf16_f32 v105, v78, v79
    v_min_u32 v104, 0xfffffffe, v104
    v_min_u32 v105, 0xfffffffe, v105
    buffer_store_dwordx2 v[104:105], v15, s[8:11], s29 offen sc1
    s_mov_b64 exec, -1

    s_branch .top_186
.gf_208:
    s_add_u32 s4, s99, 262144
    buffer_load_dwordx4 v[200:203], v239, s[8:11], s4 offen sc1
    buffer_load_dwordx4 v[204:207], v249, s[8:11], s4 offen sc1

    s_sub_u32 s62, s62, 1
    s_cbranch_scc1 .mg_end_1
    s_branch .gc_206
.oth_187:
    s_cmp_eq_u32 s24, 3
    s_cbranch_scc1 .w3_188
    s_cmp_eq_u32 s28, 63
    s_cbranch_scc1 .rec_fin_5
    s_waitcnt vmcnt(0)
    v_readlane_b32 s4, v244, 0
    v_readlane_b32 s93, v244, 1
    s_min_u32 s93, s93, s4
    v_mov_b32 v20, -1
    v_mov_b32 v21, -1
    v_mov_b32 v22, -1
    v_mov_b32 v23, -1
    v_mov_b32 v24, -1
    v_mov_b32 v25, -1
    v_mov_b32 v26, -1
    v_mov_b32 v27, -1
    v_mov_b32 v28, -1
    v_mov_b32 v29, -1
    v_mov_b32 v30, -1
    v_mov_b32 v31, -1
    v_mov_b32 v32, -1
    v_mov_b32 v33, -1
    v_mov_b32 v34, -1
    v_mov_b32 v35, -1
    v_mov_b32 v52, 0
    v_mov_b32 v53, 0
    v_mov_b32 v54, 0
    v_mov_b32 v55, 0
    v_mov_b32 v56, 0
    v_mov_b32 v57, 0
    v_mov_b32 v58, 0
    v_mov_b32 v59, 0
    v_mov_b32 v60, 0
    v_mov_b32 v61, 0
    v_mov_b32 v62, 0
    v_mov_b32 v63, 0
    v_mov_b32 v64, 0
    v_mov_b32 v65, 0
    v_mov_b32 v66, 0
    v_mov_b32 v67, 0
    v_mov_b32 v68, 0
    v_mov_b32 v69, 0
    v_mov_b32 v70, 0
    v_mov_b32 v71, 0
    v_mov_b32 v72, 0
    v_mov_b32 v73, 0
    v_mov_b32 v74, 0
    v_mov_b32 v75, 0
    s_barrier
    ds_read_b128 v[88:91], v19 offset:16384
    s_barrier
    buffer_load_dwordx4 v[192:195], v246, s[8:11], s32 offen offset:0 sc1
    buffer_load_dwordx4 v[196:199], v246, s[8:11], s32 offen offset:1024 sc1
    buffer_load_dwordx4 v[200:203], v246, s[8:11], s32 offen offset:2048 sc1
    buffer_load_dwordx4 v[204:207], v246, s[8:11], s32 offen offset:3072 sc1
    buffer_load_dwordx4 v[208:211], v246, s[8:11], s33 offen offset:0 sc1
    buffer_load_dwordx4 v[212:215], v246, s[8:11], s33 offen offset:1024 sc1
    buffer_load_dwordx4 v[216:219], v246, s[8:11], s33 offen offset:2048 sc1
    buffer_load_dwordx4 v[220:223], v246, s[8:11], s33 offen offset:3072 sc1
    s_waitcnt vmcnt(6)
    v_max3_u32 v4, v192, v193, v194
    v_max3_u32 v5, v195, v196, v197
    v_max3_u32 v4, v4, v198, v199
    v_max_u32 v4, v4, v5
    v_cmp_eq_u32 vcc, -1, v4

    s_cbranch_vccnz .A_210
.W_211:
    v_smfmac_f32_16x16x64_bf16 v[76:79], v[192:195], a[192:199], v9
    v_smfmac_f32_16x16x64_bf16 v[80:83], v[192:195], a[224:231], v9
    v_smfmac_f32_16x16x64_bf16 v[76:79], v[196:199], a[200:207], v9
    v_smfmac_f32_16x16x64_bf16 v[80:83], v[196:199], a[232:239], v9
    s_waitcnt vmcnt(4)
    v_max3_u32 v4, v200, v201, v202
    v_max3_u32 v5, v203, v204, v205
    v_max3_u32 v4, v4, v206, v207
    v_max_u32 v4, v4, v5
    v_cmp_eq_u32 vcc, -1, v4

    s_cbranch_vccnz .A_212
.W_213:
    v_smfmac_f32_16x16x64_bf16 v[76:79], v[200:203], a[208:215], v9
    v_smfmac_f32_16x16x64_bf16 v[80:83], v[200:203], a[240:247], v9
    v_smfmac_f32_16x16x64_bf16 v[76:79], v[204:207], a[216:223], v9
    v_smfmac_f32_16x16x64_bf16 v[80:83], v[204:207], a[248:255], v9
    s_waitcnt vmcnt(2)
    v_max3_u32 v4, v208, v209, v210
    v_max3_u32 v5, v211, v212, v213
    v_max3_u32 v4, v4, v214, v215
    v_max_u32 v4, v4, v5
    v_cmp_eq_u32 vcc, -1, v4

    s_cbranch_vccnz .A_214
.W_215:
    v_smfmac_f32_16x16x64_bf16 v[76:79], v[208:211], v[124:131], v9
    v_smfmac_f32_16x16x64_bf16 v[80:83], v[208:211], v[156:163], v9
    v_smfmac_f32_16x16x64_bf16 v[76:79], v[212:215], v[132:139], v9
    v_smfmac_f32_16x16x64_bf16 v[80:83], v[212:215], v[164:171], v9
    s_waitcnt vmcnt(4)
    v_max3_u32 v4, v216, v217, v218
    v_max3_u32 v5, v219, v220, v221
    v_max3_u32 v4, v4, v222, v223
    v_max_u32 v4, v4, v5
    v_cmp_eq_u32 vcc, -1, v4

    s_cbranch_vccnz .A_216
.W_217:
    v_smfmac_f32_16x16x64_bf16 v[76:79], v[216:219], v[140:147], v9
    v_smfmac_f32_16x16x64_bf16 v[80:83], v[216:219], v[172:179], v9
    v_smfmac_f32_16x16x64_bf16 v[76:79], v[220:223], v[148:155], v9
    v_smfmac_f32_16x16x64_bf16 v[80:83], v[220:223], v[180:187], v9
.mj_209:
    s_waitcnt vmcnt(8)
    s_barrier
    s_nop 5
    v_permlane32_swap_b32 v76, v80
    v_permlane32_swap_b32 v77, v81
    v_permlane32_swap_b32 v78, v82
    v_permlane32_swap_b32 v79, v83
    v_add_f32 v76, v76, v80
    v_add_f32 v77, v77, v81
    v_add_f32 v78, v78, v82
    v_add_f32 v79, v79, v83
    v_cvt_pk_bf16_f32 v104, v76, v77
    v_cvt_pk_bf16_f32 v106, v76, v77
    v_cvt_pk_bf16_f32 v105, v78, v79
    v_cvt_pk_bf16_f32 v107, v78, v79
    v_permlane16_swap_b32 v104, v106
    s_nop 0
    v_permlane16_swap_b32 v105, v107
    v_min_u32 v104, 0xfffffffe, v104
    buffer_store_dwordx4 v[104:107], v237, s[8:11], s68 offen sc1

    ds_write_b128 v247, v[104:107]
    s_waitcnt lgkmcnt(0)
    s_barrier
    v_mov_b32 v76, 0
    v_mov_b32 v77, 0
    v_mov_b32 v78, 0
    v_mov_b32 v79, 0
    v_mov_b32 v80, 0
    v_mov_b32 v81, 0
    v_mov_b32 v82, 0
    v_mov_b32 v83, 0
    s_waitcnt vmcnt(1)
    v_mov_b32 v192, -1
    v_mov_b32 v193, -1
    v_mov_b32 v194, -1
    v_mov_b32 v195, -1
    v_mov_b32 v196, -1
    v_mov_b32 v197, -1
    v_mov_b32 v198, -1
    v_mov_b32 v199, -1
    v_mov_b32 v200, -1
    v_mov_b32 v201, -1
    v_mov_b32 v202, -1
    v_mov_b32 v203, -1
    v_mov_b32 v204, -1
    v_mov_b32 v205, -1
    v_mov_b32 v206, -1
    v_mov_b32 v207, -1
    v_mov_b32 v208, -1
    v_mov_b32 v209, -1
    v_mov_b32 v210, -1
    v_mov_b32 v211, -1
    v_mov_b32 v212, -1
    v_mov_b32 v213, -1
    v_mov_b32 v214, -1
    v_mov_b32 v215, -1
    v_mov_b32 v216, -1
    v_mov_b32 v217, -1
    v_mov_b32 v218, -1
    v_mov_b32 v219, -1
    v_mov_b32 v220, -1
    v_mov_b32 v221, -1
    v_mov_b32 v222, -1
    v_mov_b32 v223, -1
    s_add_u32 s6, s28, 2
    s_cmp_lt_u32 s93, s6
    s_cbranch_scc1 .kf_218
.kb_219:
    s_mov_b32 m0, s90
    s_nop 0
    buffer_load_dwordx4 v14, s[8:11], s38 offen offset:0 lds
    buffer_load_dwordx4 v14, s[8:11], s38 offen offset:1024 lds
    buffer_load_dwordx4 v14, s[8:11], s38 offen offset:2048 lds
    buffer_load_dwordx4 v14, s[8:11], s38 offen offset:3072 lds
    s_mov_b32 m0, s91
    s_nop 0
    buffer_load_dwordx4 v14, s[8:11], s39 offen lds
    s_mov_b64 exec, 3
    buffer_load_dword v244, v253, s[8:11], s89 offen sc1
    s_mov_b64 exec, -1

    s_lshl_b32 s4, s78, 18
    s_add_u32 s4, s4, s70
    buffer_store_dwordx4 v[188:191], v238, s[8:11], s4 offen sc1
    s_add_u32 s4, s4, 524288
    s_mov_b64 exec, s[66:67]
    buffer_store_dwordx4 v[88:91], v11, s[8:11], s36 offen sc1
    s_mov_b64 exec, -1
    s_add_u32 s6, s28, 3
    s_cmp_lt_u32 s93, s6
    s_cbranch_scc1 .nf_220
    s_buffer_load_dword s98, s[8:11], s30 offset:0
    s_buffer_load_dword s98, s[8:11], s30 offset:128
    s_buffer_load_dword s98, s[8:11], s30 offset:256
    s_buffer_load_dword s98, s[8:11], s30 offset:384
    s_buffer_load_dword s98, s[8:11], s30 offset:512
    s_buffer_load_dword s98, s[8:11], s30 offset:640
    s_buffer_load_dword s98, s[8:11], s30 offset:768
    s_buffer_load_dword s98, s[8:11], s30 offset:896
    s_buffer_load_dword s98, s[8:11], s30 offset:1024
    s_buffer_load_dword s98, s[8:11], s30 offset:1152
    s_buffer_load_dword s98, s[8:11], s30 offset:1280
    s_buffer_load_dword s98, s[8:11], s30 offset:1408
    s_buffer_load_dword s98, s[8:11], s30 offset:1536
    s_buffer_load_dword s98, s[8:11], s30 offset:1664
    s_buffer_load_dword s98, s[8:11], s30 offset:1792
    s_buffer_load_dword s98, s[8:11], s30 offset:1920
.nf_220:
    s_add_u32 s28, s28, 1
    s_add_u32 s36, s36, 196608
    s_add_u32 s38, s38, 262144
    s_add_u32 s39, s39, 262144
    s_add_u32 s30, s30, 262144
    s_mov_b32 s4, s68
    s_mov_b32 s68, s69
    s_mov_b32 s69, s70
    s_mov_b32 s70, s71
    s_mov_b32 s71, s4
    s_and_b32 s4, s28, 3
    s_lshl_b32 s5, s4, 16
    s_add_u32 s29, s5, s34
    s_xor_b32 s6, s5, 0x20000
    s_add_u32 s31, s6, s34
    s_add_u32 s32, s29, 16384
    s_add_u32 s33, s29, 20480
    s_branch .top_186
.w3_188:
    ds_read_b128 v[36:39], v14 offset:8192
    ds_read_b128 v[40:43], v14 offset:9216
    ds_read_b128 v[44:47], v14 offset:10240
    ds_read_b128 v[48:51], v14 offset:11264
    ds_read_b128 v[88:91], v14 offset:16384
    s_waitcnt lgkmcnt(0)
    v_mfma_f32_16x16x32_bf16 v[104:107], v[84:87], v[36:39], 0
    v_mfma_f32_16x16x32_bf16 v[108:111], v[84:87], v[44:47], 0
    v_mfma_f32_16x16x32_bf16 v[104:107], v[84:87], v[40:43], v[104:107]
    v_mfma_f32_16x16x32_bf16 v[108:111], v[84:87], v[48:51], v[108:111]
    s_nop 7
    v_cvt_pk_bf16_f32 v168, v104, v105
    v_cvt_pk_bf16_f32 v169, v106, v107
    v_cvt_pk_bf16_f32 v170, v108, v109
    v_cvt_pk_bf16_f32 v171, v110, v111
    ds_write_b128 v14, v[168:171] offset:18432
    v_cndmask_b32 v172, v170, v168, s[60:61]
    v_cndmask_b32 v173, v171, v169, s[60:61]
    v_min_u32 v172, 0xfffffffe, v172
    v_min_u32 v173, 0xfffffffe, v173
    v_mov_b32 v174, v172
    v_mov_b32 v175, v173
    s_cmp_eq_u32 s28, 63
    s_nop 0
    v_permlane16_swap_b32 v172, v174
    v_permlane16_swap_b32 v173, v175
    ds_write_b128 v14, v[172:175] offset:17408

    s_cbranch_scc1 .sk_221
    s_waitcnt lgkmcnt(0)
    s_barrier
    buffer_store_dwordx4 v[188:191], v235, s[8:11], s31 offen sc1
    buffer_store_dwordx4 v[188:191], v236, s[8:11], s31 offen sc1

    s_branch .gp_189
.A_222:
    buffer_load_dwordx4 v[32:35], v8, s[8:11], s29 offen offset:3072 sc1
    s_sub_u32 s62, s62, 1
    s_cbranch_scc1 .mg_end_1
    s_waitcnt vmcnt(3)
    v_max3_u32 v4, v20, v21, v22
    v_max_u32 v4, v4, v23
    v_cmp_eq_u32 vcc, -1, v4
    s_cbranch_vccz .W_192
.A_191:
    buffer_load_dwordx4 v[20:23], v8, s[8:11], s29 offen offset:0 sc1
    s_waitcnt vmcnt(3)
    v_max3_u32 v4, v24, v25, v26
    v_max_u32 v4, v4, v27
    v_cmp_eq_u32 vcc, -1, v4
    s_cbranch_vccz .W_223
.A_224:
    buffer_load_dwordx4 v[24:27], v8, s[8:11], s29 offen offset:1024 sc1
    s_waitcnt vmcnt(3)
    v_max3_u32 v4, v28, v29, v30
    v_max_u32 v4, v4, v31
    v_cmp_eq_u32 vcc, -1, v4
    s_cbranch_vccz .W_225
.A_226:
    buffer_load_dwordx4 v[28:31], v8, s[8:11], s29 offen offset:2048 sc1
    s_waitcnt vmcnt(3)
    v_max3_u32 v4, v32, v33, v34
    v_max_u32 v4, v4, v35
    v_cmp_eq_u32 vcc, -1, v4
    s_cbranch_vccnz .A_222
.W_227:
    v_smfmac_f32_16x16x64_bf16 v[52:55], v[32:35], a[24:31], v9
    v_smfmac_f32_16x16x64_bf16 v[56:59], v[32:35], a[56:63], v9
    v_smfmac_f32_16x16x64_bf16 v[60:63], v[32:35], a[88:95], v9
    v_smfmac_f32_16x16x64_bf16 v[64:67], v[32:35], a[120:127], v9
    s_waitcnt vmcnt(2)
    v_max3_u32 v4, v20, v21, v22
    v_max_u32 v4, v4, v23
    v_cmp_eq_u32 vcc, -1, v4
    s_cbranch_vccnz .A_228
.W_229:
    v_smfmac_f32_16x16x64_bf16 v[52:55], v[20:23], a[0:7], v9
    v_smfmac_f32_16x16x64_bf16 v[56:59], v[20:23], a[32:39], v9
    v_smfmac_f32_16x16x64_bf16 v[60:63], v[20:23], a[64:71], v9
    v_smfmac_f32_16x16x64_bf16 v[64:67], v[20:23], a[96:103], v9
    s_waitcnt vmcnt(1)
    v_max3_u32 v4, v24, v25, v26
    v_max_u32 v4, v4, v27
    v_cmp_eq_u32 vcc, -1, v4
    s_cbranch_vccnz .A_230
.W_231:
    v_smfmac_f32_16x16x64_bf16 v[52:55], v[24:27], a[8:15], v9
    v_smfmac_f32_16x16x64_bf16 v[56:59], v[24:27], a[40:47], v9
    v_smfmac_f32_16x16x64_bf16 v[60:63], v[24:27], a[72:79], v9
    v_smfmac_f32_16x16x64_bf16 v[64:67], v[24:27], a[104:111], v9
    s_waitcnt vmcnt(2)
    v_max3_u32 v4, v28, v29, v30
    v_max_u32 v4, v4, v31
    v_cmp_eq_u32 vcc, -1, v4
    s_cbranch_vccnz .A_232
.W_233:
    v_smfmac_f32_16x16x64_bf16 v[52:55], v[28:31], a[16:23], v9
    v_smfmac_f32_16x16x64_bf16 v[56:59], v[28:31], a[48:55], v9
    v_smfmac_f32_16x16x64_bf16 v[60:63], v[28:31], a[80:87], v9
    v_smfmac_f32_16x16x64_bf16 v[64:67], v[28:31], a[112:119], v9
    s_branch .mj_190
.W_223:
    v_smfmac_f32_16x16x64_bf16 v[52:55], v[24:27], a[8:15], v9
    v_smfmac_f32_16x16x64_bf16 v[56:59], v[24:27], a[40:47], v9
    v_smfmac_f32_16x16x64_bf16 v[60:63], v[24:27], a[72:79], v9
    v_smfmac_f32_16x16x64_bf16 v[64:67], v[24:27], a[104:111], v9
    s_waitcnt vmcnt(2)
    v_max3_u32 v4, v28, v29, v30
    v_max_u32 v4, v4, v31
    v_cmp_eq_u32 vcc, -1, v4
    s_cbranch_vccnz .A_234
.W_235:
    v_smfmac_f32_16x16x64_bf16 v[52:55], v[28:31], a[16:23], v9
    v_smfmac_f32_16x16x64_bf16 v[56:59], v[28:31], a[48:55], v9
    v_smfmac_f32_16x16x64_bf16 v[60:63], v[28:31], a[80:87], v9
    v_smfmac_f32_16x16x64_bf16 v[64:67], v[28:31], a[112:119], v9
    s_waitcnt vmcnt(1)
    v_max3_u32 v4, v32, v33, v34
    v_max_u32 v4, v4, v35
    v_cmp_eq_u32 vcc, -1, v4
    s_cbranch_vccnz .A_236
.W_237:
    v_smfmac_f32_16x16x64_bf16 v[52:55], v[32:35], a[24:31], v9
    v_smfmac_f32_16x16x64_bf16 v[56:59], v[32:35], a[56:63], v9
    v_smfmac_f32_16x16x64_bf16 v[60:63], v[32:35], a[88:95], v9
    v_smfmac_f32_16x16x64_bf16 v[64:67], v[32:35], a[120:127], v9
    s_waitcnt vmcnt(2)
    v_max3_u32 v4, v20, v21, v22
    v_max_u32 v4, v4, v23
    v_cmp_eq_u32 vcc, -1, v4
    s_cbranch_vccnz .A_238
.W_239:
    v_smfmac_f32_16x16x64_bf16 v[52:55], v[20:23], a[0:7], v9
    v_smfmac_f32_16x16x64_bf16 v[56:59], v[20:23], a[32:39], v9
    v_smfmac_f32_16x16x64_bf16 v[60:63], v[20:23], a[64:71], v9
    v_smfmac_f32_16x16x64_bf16 v[64:67], v[20:23], a[96:103], v9
    s_branch .mj_190
.W_225:
    v_smfmac_f32_16x16x64_bf16 v[52:55], v[28:31], a[16:23], v9
    v_smfmac_f32_16x16x64_bf16 v[56:59], v[28:31], a[48:55], v9
    v_smfmac_f32_16x16x64_bf16 v[60:63], v[28:31], a[80:87], v9
    v_smfmac_f32_16x16x64_bf16 v[64:67], v[28:31], a[112:119], v9
    s_waitcnt vmcnt(2)
    v_max3_u32 v4, v32, v33, v34
    v_max_u32 v4, v4, v35
    v_cmp_eq_u32 vcc, -1, v4
    s_cbranch_vccnz .A_240
.W_241:
    v_smfmac_f32_16x16x64_bf16 v[52:55], v[32:35], a[24:31], v9
    v_smfmac_f32_16x16x64_bf16 v[56:59], v[32:35], a[56:63], v9
    v_smfmac_f32_16x16x64_bf16 v[60:63], v[32:35], a[88:95], v9
    v_smfmac_f32_16x16x64_bf16 v[64:67], v[32:35], a[120:127], v9
    s_waitcnt vmcnt(1)
    v_max3_u32 v4, v20, v21, v22
    v_max_u32 v4, v4, v23
    v_cmp_eq_u32 vcc, -1, v4
    s_cbranch_vccnz .A_242
.W_243:
    v_smfmac_f32_16x16x64_bf16 v[52:55], v[20:23], a[0:7], v9
    v_smfmac_f32_16x16x64_bf16 v[56:59], v[20:23], a[32:39], v9
    v_smfmac_f32_16x16x64_bf16 v[60:63], v[20:23], a[64:71], v9
    v_smfmac_f32_16x16x64_bf16 v[64:67], v[20:23], a[96:103], v9
    s_waitcnt vmcnt(2)
    v_max3_u32 v4, v24, v25, v26
    v_max_u32 v4, v4, v27
    v_cmp_eq_u32 vcc, -1, v4
    s_cbranch_vccnz .A_244
.W_245:
    v_smfmac_f32_16x16x64_bf16 v[52:55], v[24:27], a[8:15], v9
    v_smfmac_f32_16x16x64_bf16 v[56:59], v[24:27], a[40:47], v9
    v_smfmac_f32_16x16x64_bf16 v[60:63], v[24:27], a[72:79], v9
    v_smfmac_f32_16x16x64_bf16 v[64:67], v[24:27], a[104:111], v9
    s_branch .mj_190
.A_246:
    buffer_load_dwordx4 v[28:31], v8, s[8:11], s29 offen offset:2048 sc1
    s_sub_u32 s62, s62, 1
    s_cbranch_scc1 .mg_end_1
    s_waitcnt vmcnt(2)
    v_max3_u32 v4, v20, v21, v22
    v_max_u32 v4, v4, v23
    v_cmp_eq_u32 vcc, -1, v4
    s_cbranch_vccz .W_229
.A_228:
    buffer_load_dwordx4 v[20:23], v8, s[8:11], s29 offen offset:0 sc1
    s_waitcnt vmcnt(2)
    v_max3_u32 v4, v24, v25, v26
    v_max_u32 v4, v4, v27
    v_cmp_eq_u32 vcc, -1, v4
    s_cbranch_vccz .W_247
.A_248:
    buffer_load_dwordx4 v[24:27], v8, s[8:11], s29 offen offset:1024 sc1
    s_waitcnt vmcnt(2)
    v_max3_u32 v4, v28, v29, v30
    v_max_u32 v4, v4, v31
    v_cmp_eq_u32 vcc, -1, v4
    s_cbranch_vccnz .A_246
.W_249:
    v_smfmac_f32_16x16x64_bf16 v[52:55], v[28:31], a[16:23], v9
    v_smfmac_f32_16x16x64_bf16 v[56:59], v[28:31], a[48:55], v9
    v_smfmac_f32_16x16x64_bf16 v[60:63], v[28:31], a[80:87], v9
    v_smfmac_f32_16x16x64_bf16 v[64:67], v[28:31], a[112:119], v9
    s_waitcnt vmcnt(1)
    v_max3_u32 v4, v20, v21, v22
    v_max_u32 v4, v4, v23
    v_cmp_eq_u32 vcc, -1, v4
    s_cbranch_vccz .W_243
    s_branch .A_242
.W_247:
    v_smfmac_f32_16x16x64_bf16 v[52:55], v[24:27], a[8:15], v9
    v_smfmac_f32_16x16x64_bf16 v[56:59], v[24:27], a[40:47], v9
    v_smfmac_f32_16x16x64_bf16 v[60:63], v[24:27], a[72:79], v9
    v_smfmac_f32_16x16x64_bf16 v[64:67], v[24:27], a[104:111], v9
    s_waitcnt vmcnt(1)
    v_max3_u32 v4, v28, v29, v30
    v_max_u32 v4, v4, v31
    v_cmp_eq_u32 vcc, -1, v4
    s_cbranch_vccnz .A_250
.W_251:
    v_smfmac_f32_16x16x64_bf16 v[52:55], v[28:31], a[16:23], v9
    v_smfmac_f32_16x16x64_bf16 v[56:59], v[28:31], a[48:55], v9
    v_smfmac_f32_16x16x64_bf16 v[60:63], v[28:31], a[80:87], v9
    v_smfmac_f32_16x16x64_bf16 v[64:67], v[28:31], a[112:119], v9
    s_waitcnt vmcnt(2)
    v_max3_u32 v4, v20, v21, v22
    v_max_u32 v4, v4, v23
    v_cmp_eq_u32 vcc, -1, v4
    s_cbranch_vccz .W_239
    s_branch .A_238
.A_252:
    buffer_load_dwordx4 v[24:27], v8, s[8:11], s29 offen offset:1024 sc1
    s_sub_u32 s62, s62, 1
    s_cbranch_scc1 .mg_end_1
    s_waitcnt vmcnt(2)
    v_max3_u32 v4, v32, v33, v34
    v_max_u32 v4, v4, v35
    v_cmp_eq_u32 vcc, -1, v4
    s_cbranch_vccz .W_241
.A_240:
    buffer_load_dwordx4 v[32:35], v8, s[8:11], s29 offen offset:3072 sc1
    s_waitcnt vmcnt(2)
    v_max3_u32 v4, v20, v21, v22
    v_max_u32 v4, v4, v23
    v_cmp_eq_u32 vcc, -1, v4
    s_cbranch_vccz .W_253
.A_254:
    buffer_load_dwordx4 v[20:23], v8, s[8:11], s29 offen offset:0 sc1
    s_waitcnt vmcnt(2)
    v_max3_u32 v4, v24, v25, v26
    v_max_u32 v4, v4, v27
    v_cmp_eq_u32 vcc, -1, v4
    s_cbranch_vccnz .A_252
.W_255:
    v_smfmac_f32_16x16x64_bf16 v[52:55], v[24:27], a[8:15], v9
    v_smfmac_f32_16x16x64_bf16 v[56:59], v[24:27], a[40:47], v9
    v_smfmac_f32_16x16x64_bf16 v[60:63], v[24:27], a[72:79], v9
    v_smfmac_f32_16x16x64_bf16 v[64:67], v[24:27], a[104:111], v9
    s_waitcnt vmcnt(1)
    v_max3_u32 v4, v32, v33, v34
    v_max_u32 v4, v4, v35
    v_cmp_eq_u32 vcc, -1, v4
    s_cbranch_vccz .W_237
    s_branch .A_236
.W_253:
    v_smfmac_f32_16x16x64_bf16 v[52:55], v[20:23], a[0:7], v9
    v_smfmac_f32_16x16x64_bf16 v[56:59], v[20:23], a[32:39], v9
    v_smfmac_f32_16x16x64_bf16 v[60:63], v[20:23], a[64:71], v9
    v_smfmac_f32_16x16x64_bf16 v[64:67], v[20:23], a[96:103], v9
    s_waitcnt vmcnt(1)
    v_max3_u32 v4, v24, v25, v26
    v_max_u32 v4, v4, v27
    v_cmp_eq_u32 vcc, -1, v4
    s_cbranch_vccnz .A_256
.W_257:
    v_smfmac_f32_16x16x64_bf16 v[52:55], v[24:27], a[8:15], v9
    v_smfmac_f32_16x16x64_bf16 v[56:59], v[24:27], a[40:47], v9
    v_smfmac_f32_16x16x64_bf16 v[60:63], v[24:27], a[72:79], v9
    v_smfmac_f32_16x16x64_bf16 v[64:67], v[24:27], a[104:111], v9
    s_waitcnt vmcnt(2)
    v_max3_u32 v4, v32, v33, v34
    v_max_u32 v4, v4, v35
    v_cmp_eq_u32 vcc, -1, v4
    s_cbranch_vccz .W_198
    s_branch .A_197
.A_258:
    buffer_load_dwordx4 v[32:35], v8, s[8:11], s29 offen offset:3072 sc1
    s_sub_u32 s62, s62, 1
    s_cbranch_scc1 .mg_end_1
    s_waitcnt vmcnt(2)
    v_max3_u32 v4, v20, v21, v22
    v_max_u32 v4, v4, v23
    v_cmp_eq_u32 vcc, -1, v4
    s_cbranch_vccz .W_259
.A_260:
    buffer_load_dwordx4 v[20:23], v8, s[8:11], s29 offen offset:0 sc1
    s_waitcnt vmcnt(2)
    v_max3_u32 v4, v28, v29, v30
    v_max_u32 v4, v4, v31
    v_cmp_eq_u32 vcc, -1, v4
    s_cbranch_vccz .W_235
.A_234:
    buffer_load_dwordx4 v[28:31], v8, s[8:11], s29 offen offset:2048 sc1
    s_waitcnt vmcnt(2)
    v_max3_u32 v4, v32, v33, v34
    v_max_u32 v4, v4, v35
    v_cmp_eq_u32 vcc, -1, v4
    s_cbranch_vccnz .A_258
.W_261:
    v_smfmac_f32_16x16x64_bf16 v[52:55], v[32:35], a[24:31], v9
    v_smfmac_f32_16x16x64_bf16 v[56:59], v[32:35], a[56:63], v9
    v_smfmac_f32_16x16x64_bf16 v[60:63], v[32:35], a[88:95], v9
    v_smfmac_f32_16x16x64_bf16 v[64:67], v[32:35], a[120:127], v9
    s_waitcnt vmcnt(1)
    v_max3_u32 v4, v20, v21, v22
    v_max_u32 v4, v4, v23
    v_cmp_eq_u32 vcc, -1, v4
    s_cbranch_vccnz .A_262
.W_263:
    v_smfmac_f32_16x16x64_bf16 v[52:55], v[20:23], a[0:7], v9
    v_smfmac_f32_16x16x64_bf16 v[56:59], v[20:23], a[32:39], v9
    v_smfmac_f32_16x16x64_bf16 v[60:63], v[20:23], a[64:71], v9
    v_smfmac_f32_16x16x64_bf16 v[64:67], v[20:23], a[96:103], v9
    s_waitcnt vmcnt(2)
    v_max3_u32 v4, v28, v29, v30
    v_max_u32 v4, v4, v31
    v_cmp_eq_u32 vcc, -1, v4
    s_cbranch_vccz .W_233
    s_branch .A_232
.W_259:
    v_smfmac_f32_16x16x64_bf16 v[52:55], v[20:23], a[0:7], v9
    v_smfmac_f32_16x16x64_bf16 v[56:59], v[20:23], a[32:39], v9
    v_smfmac_f32_16x16x64_bf16 v[60:63], v[20:23], a[64:71], v9
    v_smfmac_f32_16x16x64_bf16 v[64:67], v[20:23], a[96:103], v9
    s_waitcnt vmcnt(1)
    v_max3_u32 v4, v28, v29, v30
    v_max_u32 v4, v4, v31
    v_cmp_eq_u32 vcc, -1, v4
    s_cbranch_vccz .W_196
    s_branch .A_195
.A_264:
    buffer_load_dwordx4 v[32:35], v8, s[8:11], s29 offen offset:3072 sc1
    s_sub_u32 s62, s62, 1
    s_cbranch_scc1 .mg_end_1
    s_waitcnt vmcnt(2)
    v_max3_u32 v4, v24, v25, v26
    v_max_u32 v4, v4, v27
    v_cmp_eq_u32 vcc, -1, v4
    s_cbranch_vccz .W_194
.A_193:
    buffer_load_dwordx4 v[24:27], v8, s[8:11], s29 offen offset:1024 sc1
    s_waitcnt vmcnt(2)
    v_max3_u32 v4, v28, v29, v30
    v_max_u32 v4, v4, v31
    v_cmp_eq_u32 vcc, -1, v4
    s_cbranch_vccz .W_265
.A_266:
    buffer_load_dwordx4 v[28:31], v8, s[8:11], s29 offen offset:2048 sc1
    s_waitcnt vmcnt(2)
    v_max3_u32 v4, v32, v33, v34
    v_max_u32 v4, v4, v35
    v_cmp_eq_u32 vcc, -1, v4
    s_cbranch_vccnz .A_264
.W_267:
    v_smfmac_f32_16x16x64_bf16 v[52:55], v[32:35], a[24:31], v9
    v_smfmac_f32_16x16x64_bf16 v[56:59], v[32:35], a[56:63], v9
    v_smfmac_f32_16x16x64_bf16 v[60:63], v[32:35], a[88:95], v9
    v_smfmac_f32_16x16x64_bf16 v[64:67], v[32:35], a[120:127], v9
    s_waitcnt vmcnt(1)
    v_max3_u32 v4, v24, v25, v26
    v_max_u32 v4, v4, v27
    v_cmp_eq_u32 vcc, -1, v4
    s_cbranch_vccz .W_231
    s_branch .A_230
.W_265:
    v_smfmac_f32_16x16x64_bf16 v[52:55], v[28:31], a[16:23], v9
    v_smfmac_f32_16x16x64_bf16 v[56:59], v[28:31], a[48:55], v9
    v_smfmac_f32_16x16x64_bf16 v[60:63], v[28:31], a[80:87], v9
    v_smfmac_f32_16x16x64_bf16 v[64:67], v[28:31], a[112:119], v9
    s_waitcnt vmcnt(1)
    v_max3_u32 v4, v32, v33, v34
    v_max_u32 v4, v4, v35
    v_cmp_eq_u32 vcc, -1, v4
    s_cbranch_vccnz .A_268
.W_269:
    v_smfmac_f32_16x16x64_bf16 v[52:55], v[32:35], a[24:31], v9
    v_smfmac_f32_16x16x64_bf16 v[56:59], v[32:35], a[56:63], v9
    v_smfmac_f32_16x16x64_bf16 v[60:63], v[32:35], a[88:95], v9
    v_smfmac_f32_16x16x64_bf16 v[64:67], v[32:35], a[120:127], v9
    s_waitcnt vmcnt(2)
    v_max3_u32 v4, v24, v25, v26
    v_max_u32 v4, v4, v27
    v_cmp_eq_u32 vcc, -1, v4
    s_cbranch_vccz .W_245
    s_branch .A_244
.A_270:
    buffer_load_dwordx4 v[24:27], v8, s[8:11], s29 offen offset:1024 sc1
    s_sub_u32 s62, s62, 1
    s_cbranch_scc1 .mg_end_1
    s_waitcnt vmcnt(3)
    v_max3_u32 v4, v20, v21, v22
    v_max_u32 v4, v4, v23
    v_cmp_eq_u32 vcc, -1, v4
    s_cbranch_vccz .W_243
.A_242:
    buffer_load_dwordx4 v[20:23], v8, s[8:11], s29 offen offset:0 sc1
    s_waitcnt vmcnt(3)
    v_max3_u32 v4, v24, v25, v26
    v_max_u32 v4, v4, v27
    v_cmp_eq_u32 vcc, -1, v4
    s_cbranch_vccnz .A_270
.W_271:
    v_smfmac_f32_16x16x64_bf16 v[52:55], v[24:27], a[8:15], v9
    v_smfmac_f32_16x16x64_bf16 v[56:59], v[24:27], a[40:47], v9
    v_smfmac_f32_16x16x64_bf16 v[60:63], v[24:27], a[72:79], v9
    v_smfmac_f32_16x16x64_bf16 v[64:67], v[24:27], a[104:111], v9
    s_waitcnt vmcnt(2)
    v_max3_u32 v4, v20, v21, v22
    v_max_u32 v4, v4, v23
    v_cmp_eq_u32 vcc, -1, v4
    s_cbranch_vccz .W_239
    s_branch .A_238
.A_250:
    buffer_load_dwordx4 v[28:31], v8, s[8:11], s29 offen offset:2048 sc1
    s_sub_u32 s62, s62, 1
    s_cbranch_scc1 .mg_end_1
    s_waitcnt vmcnt(3)
    v_max3_u32 v4, v20, v21, v22
    v_max_u32 v4, v4, v23
    v_cmp_eq_u32 vcc, -1, v4
    s_cbranch_vccz .W_263
.A_262:
    buffer_load_dwordx4 v[20:23], v8, s[8:11], s29 offen offset:0 sc1
    s_waitcnt vmcnt(3)
    v_max3_u32 v4, v28, v29, v30
    v_max_u32 v4, v4, v31
    v_cmp_eq_u32 vcc, -1, v4
    s_cbranch_vccnz .A_250
    s_branch .W_251
.A_272:
    buffer_load_dwordx4 v[20:23], v8, s[8:11], s29 offen offset:0 sc1
    s_sub_u32 s62, s62, 1
    s_cbranch_scc1 .mg_end_1
    s_waitcnt vmcnt(3)
    v_max3_u32 v4, v32, v33, v34
    v_max_u32 v4, v4, v35
    v_cmp_eq_u32 vcc, -1, v4
    s_cbranch_vccz .W_237
.A_236:
    buffer_load_dwordx4 v[32:35], v8, s[8:11], s29 offen offset:3072 sc1
    s_waitcnt vmcnt(3)
    v_max3_u32 v4, v20, v21, v22
    v_max_u32 v4, v4, v23
    v_cmp_eq_u32 vcc, -1, v4
    s_cbranch_vccnz .A_272
.W_273:
    v_smfmac_f32_16x16x64_bf16 v[52:55], v[20:23], a[0:7], v9
    v_smfmac_f32_16x16x64_bf16 v[56:59], v[20:23], a[32:39], v9
    v_smfmac_f32_16x16x64_bf16 v[60:63], v[20:23], a[64:71], v9
    v_smfmac_f32_16x16x64_bf16 v[64:67], v[20:23], a[96:103], v9
    s_waitcnt vmcnt(2)
    v_max3_u32 v4, v32, v33, v34
    v_max_u32 v4, v4, v35
    v_cmp_eq_u32 vcc, -1, v4
    s_cbranch_vccz .W_198
    s_branch .A_197
.A_274:
    buffer_load_dwordx4 v[28:31], v8, s[8:11], s29 offen offset:2048 sc1
    s_sub_u32 s62, s62, 1
    s_cbranch_scc1 .mg_end_1
    s_waitcnt vmcnt(3)
    v_max3_u32 v4, v24, v25, v26
    v_max_u32 v4, v4, v27
    v_cmp_eq_u32 vcc, -1, v4
    s_cbranch_vccz .W_231
.A_230:
    buffer_load_dwordx4 v[24:27], v8, s[8:11], s29 offen offset:1024 sc1
    s_waitcnt vmcnt(3)
    v_max3_u32 v4, v28, v29, v30
    v_max_u32 v4, v4, v31
    v_cmp_eq_u32 vcc, -1, v4
    s_cbranch_vccnz .A_274
.W_275:
    v_smfmac_f32_16x16x64_bf16 v[52:55], v[28:31], a[16:23], v9
    v_smfmac_f32_16x16x64_bf16 v[56:59], v[28:31], a[48:55], v9
    v_smfmac_f32_16x16x64_bf16 v[60:63], v[28:31], a[80:87], v9
    v_smfmac_f32_16x16x64_bf16 v[64:67], v[28:31], a[112:119], v9
    s_waitcnt vmcnt(2)
    v_max3_u32 v4, v24, v25, v26
    v_max_u32 v4, v4, v27
    v_cmp_eq_u32 vcc, -1, v4
    s_cbranch_vccz .W_245
    s_branch .A_244
.A_268:
    buffer_load_dwordx4 v[32:35], v8, s[8:11], s29 offen offset:3072 sc1
    s_sub_u32 s62, s62, 1
    s_cbranch_scc1 .mg_end_1
    s_waitcnt vmcnt(3)
    v_max3_u32 v4, v24, v25, v26
    v_max_u32 v4, v4, v27
    v_cmp_eq_u32 vcc, -1, v4
    s_cbranch_vccz .W_257
.A_256:
    buffer_load_dwordx4 v[24:27], v8, s[8:11], s29 offen offset:1024 sc1
    s_waitcnt vmcnt(3)
    v_max3_u32 v4, v32, v33, v34
    v_max_u32 v4, v4, v35
    v_cmp_eq_u32 vcc, -1, v4
    s_cbranch_vccnz .A_268
    s_branch .W_269
.A_276:
    buffer_load_dwordx4 v[32:35], v8, s[8:11], s29 offen offset:3072 sc1
    s_sub_u32 s62, s62, 1
    s_cbranch_scc1 .mg_end_1
    s_waitcnt vmcnt(3)
    v_max3_u32 v4, v28, v29, v30
    v_max_u32 v4, v4, v31
    v_cmp_eq_u32 vcc, -1, v4
    s_cbranch_vccz .W_196
.A_195:
    buffer_load_dwordx4 v[28:31], v8, s[8:11], s29 offen offset:2048 sc1
    s_waitcnt vmcnt(3)
    v_max3_u32 v4, v32, v33, v34
    v_max_u32 v4, v4, v35
    v_cmp_eq_u32 vcc, -1, v4
    s_cbranch_vccnz .A_276
.W_277:
    v_smfmac_f32_16x16x64_bf16 v[52:55], v[32:35], a[24:31], v9
    v_smfmac_f32_16x16x64_bf16 v[56:59], v[32:35], a[56:63], v9
    v_smfmac_f32_16x16x64_bf16 v[60:63], v[32:35], a[88:95], v9
    v_smfmac_f32_16x16x64_bf16 v[64:67], v[32:35], a[120:127], v9
    s_waitcnt vmcnt(2)
    v_max3_u32 v4, v28, v29, v30
    v_max_u32 v4, v4, v31
    v_cmp_eq_u32 vcc, -1, v4
    s_cbranch_vccz .W_233
    s_branch .A_232
.A_238:
    buffer_load_dwordx4 v[20:23], v8, s[8:11], s29 offen offset:0 sc1
    s_sub_u32 s62, s62, 1
    s_cbranch_scc1 .mg_end_1
    s_waitcnt vmcnt(2)
    v_max3_u32 v4, v20, v21, v22
    v_max_u32 v4, v4, v23
    v_cmp_eq_u32 vcc, -1, v4
    s_cbranch_vccnz .A_238
    v_smfmac_f32_16x16x64_bf16 v[52:55], v[20:23], a[0:7], v9
    v_smfmac_f32_16x16x64_bf16 v[56:59], v[20:23], a[32:39], v9
    v_smfmac_f32_16x16x64_bf16 v[60:63], v[20:23], a[64:71], v9
    v_smfmac_f32_16x16x64_bf16 v[64:67], v[20:23], a[96:103], v9
    s_branch .mj_190
.A_244:
    buffer_load_dwordx4 v[24:27], v8, s[8:11], s29 offen offset:1024 sc1
    s_sub_u32 s62, s62, 1
    s_cbranch_scc1 .mg_end_1
    s_waitcnt vmcnt(2)
    v_max3_u32 v4, v24, v25, v26
    v_max_u32 v4, v4, v27
    v_cmp_eq_u32 vcc, -1, v4
    s_cbranch_vccnz .A_244
    v_smfmac_f32_16x16x64_bf16 v[52:55], v[24:27], a[8:15], v9
    v_smfmac_f32_16x16x64_bf16 v[56:59], v[24:27], a[40:47], v9
    v_smfmac_f32_16x16x64_bf16 v[60:63], v[24:27], a[72:79], v9
    v_smfmac_f32_16x16x64_bf16 v[64:67], v[24:27], a[104:111], v9
    s_branch .mj_190
.A_232:
    buffer_load_dwordx4 v[28:31], v8, s[8:11], s29 offen offset:2048 sc1
    s_sub_u32 s62, s62, 1
    s_cbranch_scc1 .mg_end_1
    s_waitcnt vmcnt(2)
    v_max3_u32 v4, v28, v29, v30
    v_max_u32 v4, v4, v31
    v_cmp_eq_u32 vcc, -1, v4
    s_cbranch_vccnz .A_232
    v_smfmac_f32_16x16x64_bf16 v[52:55], v[28:31], a[16:23], v9
    v_smfmac_f32_16x16x64_bf16 v[56:59], v[28:31], a[48:55], v9
    v_smfmac_f32_16x16x64_bf16 v[60:63], v[28:31], a[80:87], v9
    v_smfmac_f32_16x16x64_bf16 v[64:67], v[28:31], a[112:119], v9
    s_branch .mj_190
.A_197:
    buffer_load_dwordx4 v[32:35], v8, s[8:11], s29 offen offset:3072 sc1
    s_sub_u32 s62, s62, 1
    s_cbranch_scc1 .mg_end_1
    s_waitcnt vmcnt(2)
    v_max3_u32 v4, v32, v33, v34
    v_max_u32 v4, v4, v35
    v_cmp_eq_u32 vcc, -1, v4
    s_cbranch_vccnz .A_197
    v_smfmac_f32_16x16x64_bf16 v[52:55], v[32:35], a[24:31], v9
    v_smfmac_f32_16x16x64_bf16 v[56:59], v[32:35], a[56:63], v9
    v_smfmac_f32_16x16x64_bf16 v[60:63], v[32:35], a[88:95], v9
    v_smfmac_f32_16x16x64_bf16 v[64:67], v[32:35], a[120:127], v9
    s_branch .mj_190
.A_278:
    buffer_load_dwordx4 v[100:103], v234, s[8:11], s29 offen sc1
    s_sub_u32 s62, s62, 1
    s_cbranch_scc1 .mg_end_1
    s_waitcnt vmcnt(2)
    v_max3_u32 v4, v92, v93, v94
    v_max_u32 v4, v4, v95
    v_cmp_eq_u32 vcc, -1, v4
    s_cbranch_vccz .W_201
.A_200:
    buffer_load_dwordx4 v[92:95], v232, s[8:11], s29 offen sc1
    s_waitcnt vmcnt(2)
    v_max3_u32 v4, v96, v97, v98
    v_max_u32 v4, v4, v99
    v_cmp_eq_u32 vcc, -1, v4
    s_cbranch_vccz .W_279
.A_280:
    buffer_load_dwordx4 v[96:99], v233, s[8:11], s29 offen sc1
    s_waitcnt vmcnt(2)
    v_max3_u32 v4, v100, v101, v102
    v_max_u32 v4, v4, v103
    v_cmp_eq_u32 vcc, -1, v4
    s_cbranch_vccnz .A_278
.W_281:
    v_mfma_f32_16x16x32_bf16 v[208:211], v[140:143], v[100:103], v[208:211]
    v_mfma_f32_16x16x32_bf16 v[212:215], v[156:159], v[100:103], v[212:215]
    v_mfma_f32_16x16x32_bf16 v[216:219], v[100:103], v[100:103], v[216:219]
    s_waitcnt vmcnt(1)
    v_max3_u32 v4, v92, v93, v94
    v_max_u32 v4, v4, v95
    v_cmp_eq_u32 vcc, -1, v4
    s_cbranch_vccnz .A_282
.W_283:
    v_mfma_f32_16x16x32_bf16 v[208:211], v[132:135], v[92:95], v[208:211]
    v_mfma_f32_16x16x32_bf16 v[212:215], v[148:151], v[92:95], v[212:215]
    v_mfma_f32_16x16x32_bf16 v[216:219], v[92:95], v[92:95], v[216:219]
    s_waitcnt vmcnt(2)
    v_max3_u32 v4, v96, v97, v98
    v_max_u32 v4, v4, v99
    v_cmp_eq_u32 vcc, -1, v4
    s_cbranch_vccnz .A_284
.W_285:
    v_mfma_f32_16x16x32_bf16 v[208:211], v[136:139], v[96:99], v[208:211]
    v_mfma_f32_16x16x32_bf16 v[212:215], v[152:155], v[96:99], v[212:215]
    v_mfma_f32_16x16x32_bf16 v[216:219], v[96:99], v[96:99], v[216:219]
    s_branch .mj_199
.W_279:
    v_mfma_f32_16x16x32_bf16 v[208:211], v[136:139], v[96:99], v[208:211]
    v_mfma_f32_16x16x32_bf16 v[212:215], v[152:155], v[96:99], v[212:215]
    v_mfma_f32_16x16x32_bf16 v[216:219], v[96:99], v[96:99], v[216:219]
    s_waitcnt vmcnt(1)
    v_max3_u32 v4, v100, v101, v102
    v_max_u32 v4, v4, v103
    v_cmp_eq_u32 vcc, -1, v4
    s_cbranch_vccnz .A_286
.W_287:
    v_mfma_f32_16x16x32_bf16 v[208:211], v[140:143], v[100:103], v[208:211]
    v_mfma_f32_16x16x32_bf16 v[212:215], v[156:159], v[100:103], v[212:215]
    v_mfma_f32_16x16x32_bf16 v[216:219], v[100:103], v[100:103], v[216:219]
    s_waitcnt vmcnt(2)
    v_max3_u32 v4, v92, v93, v94
    v_max_u32 v4, v4, v95
    v_cmp_eq_u32 vcc, -1, v4
    s_cbranch_vccnz .A_288
.W_289:
    v_mfma_f32_16x16x32_bf16 v[208:211], v[132:135], v[92:95], v[208:211]
    v_mfma_f32_16x16x32_bf16 v[212:215], v[148:151], v[92:95], v[212:215]
    v_mfma_f32_16x16x32_bf16 v[216:219], v[92:95], v[92:95], v[216:219]
    s_branch .mj_199
.A_290:
    buffer_load_dwordx4 v[96:99], v233, s[8:11], s29 offen sc1
    s_sub_u32 s62, s62, 1
    s_cbranch_scc1 .mg_end_1
    s_waitcnt vmcnt(3)
    v_max3_u32 v4, v92, v93, v94
    v_max_u32 v4, v4, v95
    v_cmp_eq_u32 vcc, -1, v4
    s_cbranch_vccz .W_283
.A_282:
    buffer_load_dwordx4 v[92:95], v232, s[8:11], s29 offen sc1
    s_waitcnt vmcnt(3)
    v_max3_u32 v4, v96, v97, v98
    v_max_u32 v4, v4, v99
    v_cmp_eq_u32 vcc, -1, v4
    s_cbranch_vccnz .A_290
.W_291:
    v_mfma_f32_16x16x32_bf16 v[208:211], v[136:139], v[96:99], v[208:211]
    v_mfma_f32_16x16x32_bf16 v[212:215], v[152:155], v[96:99], v[212:215]
    v_mfma_f32_16x16x32_bf16 v[216:219], v[96:99], v[96:99], v[216:219]
    s_waitcnt vmcnt(2)
    v_max3_u32 v4, v92, v93, v94
    v_max_u32 v4, v4, v95
    v_cmp_eq_u32 vcc, -1, v4
    s_cbranch_vccz .W_289
    s_branch .A_288
.A_292:
    buffer_load_dwordx4 v[92:95], v232, s[8:11], s29 offen sc1
    s_sub_u32 s62, s62, 1
    s_cbranch_scc1 .mg_end_1
    s_waitcnt vmcnt(3)
    v_max3_u32 v4, v100, v101, v102
    v_max_u32 v4, v4, v103
    v_cmp_eq_u32 vcc, -1, v4
    s_cbranch_vccz .W_287
.A_286:
    buffer_load_dwordx4 v[100:103], v234, s[8:11], s29 offen sc1
    s_waitcnt vmcnt(3)
    v_max3_u32 v4, v92, v93, v94
    v_max_u32 v4, v4, v95
    v_cmp_eq_u32 vcc, -1, v4
    s_cbranch_vccnz .A_292
.W_293:
    v_mfma_f32_16x16x32_bf16 v[208:211], v[132:135], v[92:95], v[208:211]
    v_mfma_f32_16x16x32_bf16 v[212:215], v[148:151], v[92:95], v[212:215]
    v_mfma_f32_16x16x32_bf16 v[216:219], v[92:95], v[92:95], v[216:219]
    s_waitcnt vmcnt(2)
    v_max3_u32 v4, v100, v101, v102
    v_max_u32 v4, v4, v103
    v_cmp_eq_u32 vcc, -1, v4
    s_cbranch_vccz .W_205
    s_branch .A_204
.A_294:
    buffer_load_dwordx4 v[100:103], v234, s[8:11], s29 offen sc1
    s_sub_u32 s62, s62, 1
    s_cbranch_scc1 .mg_end_1
    s_waitcnt vmcnt(3)
    v_max3_u32 v4, v96, v97, v98
    v_max_u32 v4, v4, v99
    v_cmp_eq_u32 vcc, -1, v4
    s_cbranch_vccz .W_203
.A_202:
    buffer_load_dwordx4 v[96:99], v233, s[8:11], s29 offen sc1
    s_waitcnt vmcnt(3)
    v_max3_u32 v4, v100, v101, v102
    v_max_u32 v4, v4, v103
    v_cmp_eq_u32 vcc, -1, v4
    s_cbranch_vccnz .A_294
.W_295:
    v_mfma_f32_16x16x32_bf16 v[208:211], v[140:143], v[100:103], v[208:211]
    v_mfma_f32_16x16x32_bf16 v[212:215], v[156:159], v[100:103], v[212:215]
    v_mfma_f32_16x16x32_bf16 v[216:219], v[100:103], v[100:103], v[216:219]
    s_waitcnt vmcnt(2)
    v_max3_u32 v4, v96, v97, v98
    v_max_u32 v4, v4, v99
    v_cmp_eq_u32 vcc, -1, v4
    s_cbranch_vccz .W_285
    s_branch .A_284
.A_288:
    buffer_load_dwordx4 v[92:95], v232, s[8:11], s29 offen sc1
    s_sub_u32 s62, s62, 1
    s_cbranch_scc1 .mg_end_1
    s_waitcnt vmcnt(2)
    v_max3_u32 v4, v92, v93, v94
    v_max_u32 v4, v4, v95
    v_cmp_eq_u32 vcc, -1, v4
    s_cbranch_vccnz .A_288
    v_mfma_f32_16x16x32_bf16 v[208:211], v[132:135], v[92:95], v[208:211]
    v_mfma_f32_16x16x32_bf16 v[212:215], v[148:151], v[92:95], v[212:215]
    v_mfma_f32_16x16x32_bf16 v[216:219], v[92:95], v[92:95], v[216:219]
    s_branch .mj_199
.A_284:
    buffer_load_dwordx4 v[96:99], v233, s[8:11], s29 offen sc1
    s_sub_u32 s62, s62, 1
    s_cbranch_scc1 .mg_end_1
    s_waitcnt vmcnt(2)
    v_max3_u32 v4, v96, v97, v98
    v_max_u32 v4, v4, v99
    v_cmp_eq_u32 vcc, -1, v4
    s_cbranch_vccnz .A_284
    v_mfma_f32_16x16x32_bf16 v[208:211], v[136:139], v[96:99], v[208:211]
    v_mfma_f32_16x16x32_bf16 v[212:215], v[152:155], v[96:99], v[212:215]
    v_mfma_f32_16x16x32_bf16 v[216:219], v[96:99], v[96:99], v[216:219]
    s_branch .mj_199
.A_204:
    buffer_load_dwordx4 v[100:103], v234, s[8:11], s29 offen sc1
    s_sub_u32 s62, s62, 1
    s_cbranch_scc1 .mg_end_1
    s_waitcnt vmcnt(2)
    v_max3_u32 v4, v100, v101, v102
    v_max_u32 v4, v4, v103
    v_cmp_eq_u32 vcc, -1, v4
    s_cbranch_vccnz .A_204
    v_mfma_f32_16x16x32_bf16 v[208:211], v[140:143], v[100:103], v[208:211]
    v_mfma_f32_16x16x32_bf16 v[212:215], v[156:159], v[100:103], v[212:215]
    v_mfma_f32_16x16x32_bf16 v[216:219], v[100:103], v[100:103], v[216:219]
    s_branch .mj_199
.A_296:
    buffer_load_dwordx4 v[216:219], v246, s[8:11], s33 offen offset:2048 sc1
    buffer_load_dwordx4 v[220:223], v246, s[8:11], s33 offen offset:3072 sc1
    s_sub_u32 s62, s62, 1
    s_cbranch_scc1 .mg_end_1
    s_waitcnt vmcnt(6)
    v_max3_u32 v4, v192, v193, v194
    v_max3_u32 v5, v195, v196, v197
    v_max3_u32 v4, v4, v198, v199
    v_max_u32 v4, v4, v5
    v_cmp_eq_u32 vcc, -1, v4

    s_cbranch_vccz .W_211
.A_210:
    buffer_load_dwordx4 v[192:195], v246, s[8:11], s32 offen offset:0 sc1
    buffer_load_dwordx4 v[196:199], v246, s[8:11], s32 offen offset:1024 sc1
    s_waitcnt vmcnt(6)
    v_max3_u32 v4, v200, v201, v202
    v_max3_u32 v5, v203, v204, v205
    v_max3_u32 v4, v4, v206, v207
    v_max_u32 v4, v4, v5
    v_cmp_eq_u32 vcc, -1, v4

    s_cbranch_vccz .W_297
.A_298:
    buffer_load_dwordx4 v[200:203], v246, s[8:11], s32 offen offset:2048 sc1
    buffer_load_dwordx4 v[204:207], v246, s[8:11], s32 offen offset:3072 sc1
    s_waitcnt vmcnt(6)
    v_max3_u32 v4, v208, v209, v210
    v_max3_u32 v5, v211, v212, v213
    v_max3_u32 v4, v4, v214, v215
    v_max_u32 v4, v4, v5
    v_cmp_eq_u32 vcc, -1, v4

    s_cbranch_vccz .W_299
.A_300:
    buffer_load_dwordx4 v[208:211], v246, s[8:11], s33 offen offset:0 sc1
    buffer_load_dwordx4 v[212:215], v246, s[8:11], s33 offen offset:1024 sc1
    s_waitcnt vmcnt(6)
    v_max3_u32 v4, v216, v217, v218
    v_max3_u32 v5, v219, v220, v221
    v_max3_u32 v4, v4, v222, v223
    v_max_u32 v4, v4, v5
    v_cmp_eq_u32 vcc, -1, v4

    s_cbranch_vccnz .A_296
.W_301:
    v_smfmac_f32_16x16x64_bf16 v[76:79], v[216:219], v[140:147], v9
    v_smfmac_f32_16x16x64_bf16 v[80:83], v[216:219], v[172:179], v9
    v_smfmac_f32_16x16x64_bf16 v[76:79], v[220:223], v[148:155], v9
    v_smfmac_f32_16x16x64_bf16 v[80:83], v[220:223], v[180:187], v9
    s_waitcnt vmcnt(4)
    v_max3_u32 v4, v192, v193, v194
    v_max3_u32 v5, v195, v196, v197
    v_max3_u32 v4, v4, v198, v199
    v_max_u32 v4, v4, v5
    v_cmp_eq_u32 vcc, -1, v4

    s_cbranch_vccnz .A_302
.W_303:
    v_smfmac_f32_16x16x64_bf16 v[76:79], v[192:195], a[192:199], v9
    v_smfmac_f32_16x16x64_bf16 v[80:83], v[192:195], a[224:231], v9
    v_smfmac_f32_16x16x64_bf16 v[76:79], v[196:199], a[200:207], v9
    v_smfmac_f32_16x16x64_bf16 v[80:83], v[196:199], a[232:239], v9
    s_waitcnt vmcnt(2)
    v_max3_u32 v4, v200, v201, v202
    v_max3_u32 v5, v203, v204, v205
    v_max3_u32 v4, v4, v206, v207
    v_max_u32 v4, v4, v5
    v_cmp_eq_u32 vcc, -1, v4

    s_cbranch_vccnz .A_304
.W_305:
    v_smfmac_f32_16x16x64_bf16 v[76:79], v[200:203], a[208:215], v9
    v_smfmac_f32_16x16x64_bf16 v[80:83], v[200:203], a[240:247], v9
    v_smfmac_f32_16x16x64_bf16 v[76:79], v[204:207], a[216:223], v9
    v_smfmac_f32_16x16x64_bf16 v[80:83], v[204:207], a[248:255], v9
    s_waitcnt vmcnt(4)
    v_max3_u32 v4, v208, v209, v210
    v_max3_u32 v5, v211, v212, v213
    v_max3_u32 v4, v4, v214, v215
    v_max_u32 v4, v4, v5
    v_cmp_eq_u32 vcc, -1, v4

    s_cbranch_vccnz .A_306
.W_307:
    v_smfmac_f32_16x16x64_bf16 v[76:79], v[208:211], v[124:131], v9
    v_smfmac_f32_16x16x64_bf16 v[80:83], v[208:211], v[156:163], v9
    v_smfmac_f32_16x16x64_bf16 v[76:79], v[212:215], v[132:139], v9
    v_smfmac_f32_16x16x64_bf16 v[80:83], v[212:215], v[164:171], v9
    s_branch .mj_209
.W_297:
    v_smfmac_f32_16x16x64_bf16 v[76:79], v[200:203], a[208:215], v9
    v_smfmac_f32_16x16x64_bf16 v[80:83], v[200:203], a[240:247], v9
    v_smfmac_f32_16x16x64_bf16 v[76:79], v[204:207], a[216:223], v9
    v_smfmac_f32_16x16x64_bf16 v[80:83], v[204:207], a[248:255], v9
    s_waitcnt vmcnt(4)
    v_max3_u32 v4, v208, v209, v210
    v_max3_u32 v5, v211, v212, v213
    v_max3_u32 v4, v4, v214, v215
    v_max_u32 v4, v4, v5
    v_cmp_eq_u32 vcc, -1, v4

    s_cbranch_vccnz .A_308
.W_309:
    v_smfmac_f32_16x16x64_bf16 v[76:79], v[208:211], v[124:131], v9
    v_smfmac_f32_16x16x64_bf16 v[80:83], v[208:211], v[156:163], v9
    v_smfmac_f32_16x16x64_bf16 v[76:79], v[212:215], v[132:139], v9
    v_smfmac_f32_16x16x64_bf16 v[80:83], v[212:215], v[164:171], v9
    s_waitcnt vmcnt(2)
    v_max3_u32 v4, v216, v217, v218
    v_max3_u32 v5, v219, v220, v221
    v_max3_u32 v4, v4, v222, v223
    v_max_u32 v4, v4, v5
    v_cmp_eq_u32 vcc, -1, v4

    s_cbranch_vccnz .A_310
.W_311:
    v_smfmac_f32_16x16x64_bf16 v[76:79], v[216:219], v[140:147], v9
    v_smfmac_f32_16x16x64_bf16 v[80:83], v[216:219], v[172:179], v9
    v_smfmac_f32_16x16x64_bf16 v[76:79], v[220:223], v[148:155], v9
    v_smfmac_f32_16x16x64_bf16 v[80:83], v[220:223], v[180:187], v9
    s_waitcnt vmcnt(4)
    v_max3_u32 v4, v192, v193, v194
    v_max3_u32 v5, v195, v196, v197
    v_max3_u32 v4, v4, v198, v199
    v_max_u32 v4, v4, v5
    v_cmp_eq_u32 vcc, -1, v4

    s_cbranch_vccnz .A_312
.W_313:
    v_smfmac_f32_16x16x64_bf16 v[76:79], v[192:195], a[192:199], v9
    v_smfmac_f32_16x16x64_bf16 v[80:83], v[192:195], a[224:231], v9
    v_smfmac_f32_16x16x64_bf16 v[76:79], v[196:199], a[200:207], v9
    v_smfmac_f32_16x16x64_bf16 v[80:83], v[196:199], a[232:239], v9
    s_branch .mj_209
.W_299:
    v_smfmac_f32_16x16x64_bf16 v[76:79], v[208:211], v[124:131], v9
    v_smfmac_f32_16x16x64_bf16 v[80:83], v[208:211], v[156:163], v9
    v_smfmac_f32_16x16x64_bf16 v[76:79], v[212:215], v[132:139], v9
    v_smfmac_f32_16x16x64_bf16 v[80:83], v[212:215], v[164:171], v9
    s_waitcnt vmcnt(4)
    v_max3_u32 v4, v216, v217, v218
    v_max3_u32 v5, v219, v220, v221
    v_max3_u32 v4, v4, v222, v223
    v_max_u32 v4, v4, v5
    v_cmp_eq_u32 vcc, -1, v4

    s_cbranch_vccnz .A_314
.W_315:
    v_smfmac_f32_16x16x64_bf16 v[76:79], v[216:219], v[140:147], v9
    v_smfmac_f32_16x16x64_bf16 v[80:83], v[216:219], v[172:179], v9
    v_smfmac_f32_16x16x64_bf16 v[76:79], v[220:223], v[148:155], v9
    v_smfmac_f32_16x16x64_bf16 v[80:83], v[220:223], v[180:187], v9
    s_waitcnt vmcnt(2)
    v_max3_u32 v4, v192, v193, v194
    v_max3_u32 v5, v195, v196, v197
    v_max3_u32 v4, v4, v198, v199
    v_max_u32 v4, v4, v5
    v_cmp_eq_u32 vcc, -1, v4

    s_cbranch_vccnz .A_316
.W_317:
    v_smfmac_f32_16x16x64_bf16 v[76:79], v[192:195], a[192:199], v9
    v_smfmac_f32_16x16x64_bf16 v[80:83], v[192:195], a[224:231], v9
    v_smfmac_f32_16x16x64_bf16 v[76:79], v[196:199], a[200:207], v9
    v_smfmac_f32_16x16x64_bf16 v[80:83], v[196:199], a[232:239], v9
    s_waitcnt vmcnt(4)
    v_max3_u32 v4, v200, v201, v202
    v_max3_u32 v5, v203, v204, v205
    v_max3_u32 v4, v4, v206, v207
    v_max_u32 v4, v4, v5
    v_cmp_eq_u32 vcc, -1, v4

    s_cbranch_vccnz .A_318
.W_319:
    v_smfmac_f32_16x16x64_bf16 v[76:79], v[200:203], a[208:215], v9
    v_smfmac_f32_16x16x64_bf16 v[80:83], v[200:203], a[240:247], v9
    v_smfmac_f32_16x16x64_bf16 v[76:79], v[204:207], a[216:223], v9
    v_smfmac_f32_16x16x64_bf16 v[80:83], v[204:207], a[248:255], v9
    s_branch .mj_209
.A_320:
    buffer_load_dwordx4 v[208:211], v246, s[8:11], s33 offen offset:0 sc1
    buffer_load_dwordx4 v[212:215], v246, s[8:11], s33 offen offset:1024 sc1
    s_sub_u32 s62, s62, 1
    s_cbranch_scc1 .mg_end_1
    s_waitcnt vmcnt(4)
    v_max3_u32 v4, v192, v193, v194
    v_max3_u32 v5, v195, v196, v197
    v_max3_u32 v4, v4, v198, v199
    v_max_u32 v4, v4, v5
    v_cmp_eq_u32 vcc, -1, v4

    s_cbranch_vccz .W_303
.A_302:
    buffer_load_dwordx4 v[192:195], v246, s[8:11], s32 offen offset:0 sc1
    buffer_load_dwordx4 v[196:199], v246, s[8:11], s32 offen offset:1024 sc1
    s_waitcnt vmcnt(4)
    v_max3_u32 v4, v200, v201, v202
    v_max3_u32 v5, v203, v204, v205
    v_max3_u32 v4, v4, v206, v207
    v_max_u32 v4, v4, v5
    v_cmp_eq_u32 vcc, -1, v4

    s_cbranch_vccz .W_321
.A_322:
    buffer_load_dwordx4 v[200:203], v246, s[8:11], s32 offen offset:2048 sc1
    buffer_load_dwordx4 v[204:207], v246, s[8:11], s32 offen offset:3072 sc1
    s_waitcnt vmcnt(4)
    v_max3_u32 v4, v208, v209, v210
    v_max3_u32 v5, v211, v212, v213
    v_max3_u32 v4, v4, v214, v215
    v_max_u32 v4, v4, v5
    v_cmp_eq_u32 vcc, -1, v4

    s_cbranch_vccnz .A_320
.W_323:
    v_smfmac_f32_16x16x64_bf16 v[76:79], v[208:211], v[124:131], v9
    v_smfmac_f32_16x16x64_bf16 v[80:83], v[208:211], v[156:163], v9
    v_smfmac_f32_16x16x64_bf16 v[76:79], v[212:215], v[132:139], v9
    v_smfmac_f32_16x16x64_bf16 v[80:83], v[212:215], v[164:171], v9
    s_waitcnt vmcnt(2)
    v_max3_u32 v4, v192, v193, v194
    v_max3_u32 v5, v195, v196, v197
    v_max3_u32 v4, v4, v198, v199
    v_max_u32 v4, v4, v5
    v_cmp_eq_u32 vcc, -1, v4

    s_cbranch_vccz .W_317
    s_branch .A_316
.W_321:
    v_smfmac_f32_16x16x64_bf16 v[76:79], v[200:203], a[208:215], v9
    v_smfmac_f32_16x16x64_bf16 v[80:83], v[200:203], a[240:247], v9
    v_smfmac_f32_16x16x64_bf16 v[76:79], v[204:207], a[216:223], v9
    v_smfmac_f32_16x16x64_bf16 v[80:83], v[204:207], a[248:255], v9
    s_waitcnt vmcnt(2)
    v_max3_u32 v4, v208, v209, v210
    v_max3_u32 v5, v211, v212, v213
    v_max3_u32 v4, v4, v214, v215
    v_max_u32 v4, v4, v5
    v_cmp_eq_u32 vcc, -1, v4

    s_cbranch_vccnz .A_324
.W_325:
    v_smfmac_f32_16x16x64_bf16 v[76:79], v[208:211], v[124:131], v9
    v_smfmac_f32_16x16x64_bf16 v[80:83], v[208:211], v[156:163], v9
    v_smfmac_f32_16x16x64_bf16 v[76:79], v[212:215], v[132:139], v9
    v_smfmac_f32_16x16x64_bf16 v[80:83], v[212:215], v[164:171], v9
    s_waitcnt vmcnt(4)
    v_max3_u32 v4, v192, v193, v194
    v_max3_u32 v5, v195, v196, v197
    v_max3_u32 v4, v4, v198, v199
    v_max_u32 v4, v4, v5
    v_cmp_eq_u32 vcc, -1, v4

    s_cbranch_vccz .W_313
    s_branch .A_312
.A_326:
    buffer_load_dwordx4 v[200:203], v246, s[8:11], s32 offen offset:2048 sc1
    buffer_load_dwordx4 v[204:207], v246, s[8:11], s32 offen offset:3072 sc1
    s_sub_u32 s62, s62, 1
    s_cbranch_scc1 .mg_end_1
    s_waitcnt vmcnt(4)
    v_max3_u32 v4, v216, v217, v218
    v_max3_u32 v5, v219, v220, v221
    v_max3_u32 v4, v4, v222, v223
    v_max_u32 v4, v4, v5
    v_cmp_eq_u32 vcc, -1, v4

    s_cbranch_vccz .W_315
.A_314:
    buffer_load_dwordx4 v[216:219], v246, s[8:11], s33 offen offset:2048 sc1
    buffer_load_dwordx4 v[220:223], v246, s[8:11], s33 offen offset:3072 sc1
    s_waitcnt vmcnt(4)
    v_max3_u32 v4, v192, v193, v194
    v_max3_u32 v5, v195, v196, v197
    v_max3_u32 v4, v4, v198, v199
    v_max_u32 v4, v4, v5
    v_cmp_eq_u32 vcc, -1, v4

    s_cbranch_vccz .W_327
.A_328:
    buffer_load_dwordx4 v[192:195], v246, s[8:11], s32 offen offset:0 sc1
    buffer_load_dwordx4 v[196:199], v246, s[8:11], s32 offen offset:1024 sc1
    s_waitcnt vmcnt(4)
    v_max3_u32 v4, v200, v201, v202
    v_max3_u32 v5, v203, v204, v205
    v_max3_u32 v4, v4, v206, v207
    v_max_u32 v4, v4, v5
    v_cmp_eq_u32 vcc, -1, v4

    s_cbranch_vccnz .A_326
.W_329:
    v_smfmac_f32_16x16x64_bf16 v[76:79], v[200:203], a[208:215], v9
    v_smfmac_f32_16x16x64_bf16 v[80:83], v[200:203], a[240:247], v9
    v_smfmac_f32_16x16x64_bf16 v[76:79], v[204:207], a[216:223], v9
    v_smfmac_f32_16x16x64_bf16 v[80:83], v[204:207], a[248:255], v9
    s_waitcnt vmcnt(2)
    v_max3_u32 v4, v216, v217, v218
    v_max3_u32 v5, v219, v220, v221
    v_max3_u32 v4, v4, v222, v223
    v_max_u32 v4, v4, v5
    v_cmp_eq_u32 vcc, -1, v4

    s_cbranch_vccz .W_311
    s_branch .A_310
.W_327:
    v_smfmac_f32_16x16x64_bf16 v[76:79], v[192:195], a[192:199], v9
    v_smfmac_f32_16x16x64_bf16 v[80:83], v[192:195], a[224:231], v9
    v_smfmac_f32_16x16x64_bf16 v[76:79], v[196:199], a[200:207], v9
    v_smfmac_f32_16x16x64_bf16 v[80:83], v[196:199], a[232:239], v9
    s_waitcnt vmcnt(2)
    v_max3_u32 v4, v200, v201, v202
    v_max3_u32 v5, v203, v204, v205
    v_max3_u32 v4, v4, v206, v207
    v_max_u32 v4, v4, v5
    v_cmp_eq_u32 vcc, -1, v4

    s_cbranch_vccnz .A_330
.W_331:
    v_smfmac_f32_16x16x64_bf16 v[76:79], v[200:203], a[208:215], v9
    v_smfmac_f32_16x16x64_bf16 v[80:83], v[200:203], a[240:247], v9
    v_smfmac_f32_16x16x64_bf16 v[76:79], v[204:207], a[216:223], v9
    v_smfmac_f32_16x16x64_bf16 v[80:83], v[204:207], a[248:255], v9
    s_waitcnt vmcnt(4)
    v_max3_u32 v4, v216, v217, v218
    v_max3_u32 v5, v219, v220, v221
    v_max3_u32 v4, v4, v222, v223
    v_max_u32 v4, v4, v5
    v_cmp_eq_u32 vcc, -1, v4

    s_cbranch_vccz .W_217
    s_branch .A_216
.A_332:
    buffer_load_dwordx4 v[216:219], v246, s[8:11], s33 offen offset:2048 sc1
    buffer_load_dwordx4 v[220:223], v246, s[8:11], s33 offen offset:3072 sc1
    s_sub_u32 s62, s62, 1
    s_cbranch_scc1 .mg_end_1
    s_waitcnt vmcnt(4)
    v_max3_u32 v4, v192, v193, v194
    v_max3_u32 v5, v195, v196, v197
    v_max3_u32 v4, v4, v198, v199
    v_max_u32 v4, v4, v5
    v_cmp_eq_u32 vcc, -1, v4

    s_cbranch_vccz .W_333
.A_334:
    buffer_load_dwordx4 v[192:195], v246, s[8:11], s32 offen offset:0 sc1
    buffer_load_dwordx4 v[196:199], v246, s[8:11], s32 offen offset:1024 sc1
    s_waitcnt vmcnt(4)
    v_max3_u32 v4, v208, v209, v210
    v_max3_u32 v5, v211, v212, v213
    v_max3_u32 v4, v4, v214, v215
    v_max_u32 v4, v4, v5
    v_cmp_eq_u32 vcc, -1, v4

    s_cbranch_vccz .W_309
.A_308:
    buffer_load_dwordx4 v[208:211], v246, s[8:11], s33 offen offset:0 sc1
    buffer_load_dwordx4 v[212:215], v246, s[8:11], s33 offen offset:1024 sc1
    s_waitcnt vmcnt(4)
    v_max3_u32 v4, v216, v217, v218
    v_max3_u32 v5, v219, v220, v221
    v_max3_u32 v4, v4, v222, v223
    v_max_u32 v4, v4, v5
    v_cmp_eq_u32 vcc, -1, v4

    s_cbranch_vccnz .A_332
.W_335:
    v_smfmac_f32_16x16x64_bf16 v[76:79], v[216:219], v[140:147], v9
    v_smfmac_f32_16x16x64_bf16 v[80:83], v[216:219], v[172:179], v9
    v_smfmac_f32_16x16x64_bf16 v[76:79], v[220:223], v[148:155], v9
    v_smfmac_f32_16x16x64_bf16 v[80:83], v[220:223], v[180:187], v9
    s_waitcnt vmcnt(2)
    v_max3_u32 v4, v192, v193, v194
    v_max3_u32 v5, v195, v196, v197
    v_max3_u32 v4, v4, v198, v199
    v_max_u32 v4, v4, v5
    v_cmp_eq_u32 vcc, -1, v4

    s_cbranch_vccnz .A_336
.W_337:
    v_smfmac_f32_16x16x64_bf16 v[76:79], v[192:195], a[192:199], v9
    v_smfmac_f32_16x16x64_bf16 v[80:83], v[192:195], a[224:231], v9
    v_smfmac_f32_16x16x64_bf16 v[76:79], v[196:199], a[200:207], v9
    v_smfmac_f32_16x16x64_bf16 v[80:83], v[196:199], a[232:239], v9
    s_waitcnt vmcnt(4)
    v_max3_u32 v4, v208, v209, v210
    v_max3_u32 v5, v211, v212, v213
    v_max3_u32 v4, v4, v214, v215
    v_max_u32 v4, v4, v5
    v_cmp_eq_u32 vcc, -1, v4

    s_cbranch_vccz .W_307
    s_branch .A_306
.W_333:
    v_smfmac_f32_16x16x64_bf16 v[76:79], v[192:195], a[192:199], v9
    v_smfmac_f32_16x16x64_bf16 v[80:83], v[192:195], a[224:231], v9
    v_smfmac_f32_16x16x64_bf16 v[76:79], v[196:199], a[200:207], v9
    v_smfmac_f32_16x16x64_bf16 v[80:83], v[196:199], a[232:239], v9
    s_waitcnt vmcnt(2)
    v_max3_u32 v4, v208, v209, v210
    v_max3_u32 v5, v211, v212, v213
    v_max3_u32 v4, v4, v214, v215
    v_max_u32 v4, v4, v5
    v_cmp_eq_u32 vcc, -1, v4

    s_cbranch_vccz .W_215
    s_branch .A_214
.A_338:
    buffer_load_dwordx4 v[216:219], v246, s[8:11], s33 offen offset:2048 sc1
    buffer_load_dwordx4 v[220:223], v246, s[8:11], s33 offen offset:3072 sc1
    s_sub_u32 s62, s62, 1
    s_cbranch_scc1 .mg_end_1
    s_waitcnt vmcnt(4)
    v_max3_u32 v4, v200, v201, v202
    v_max3_u32 v5, v203, v204, v205
    v_max3_u32 v4, v4, v206, v207
    v_max_u32 v4, v4, v5
    v_cmp_eq_u32 vcc, -1, v4

    s_cbranch_vccz .W_213
.A_212:
    buffer_load_dwordx4 v[200:203], v246, s[8:11], s32 offen offset:2048 sc1
    buffer_load_dwordx4 v[204:207], v246, s[8:11], s32 offen offset:3072 sc1
    s_waitcnt vmcnt(4)
    v_max3_u32 v4, v208, v209, v210
    v_max3_u32 v5, v211, v212, v213
    v_max3_u32 v4, v4, v214, v215
    v_max_u32 v4, v4, v5
    v_cmp_eq_u32 vcc, -1, v4

    s_cbranch_vccz .W_339
.A_340:
    buffer_load_dwordx4 v[208:211], v246, s[8:11], s33 offen offset:0 sc1
    buffer_load_dwordx4 v[212:215], v246, s[8:11], s33 offen offset:1024 sc1
    s_waitcnt vmcnt(4)
    v_max3_u32 v4, v216, v217, v218
    v_max3_u32 v5, v219, v220, v221
    v_max3_u32 v4, v4, v222, v223
    v_max_u32 v4, v4, v5
    v_cmp_eq_u32 vcc, -1, v4

    s_cbranch_vccnz .A_338
.W_341:
    v_smfmac_f32_16x16x64_bf16 v[76:79], v[216:219], v[140:147], v9
    v_smfmac_f32_16x16x64_bf16 v[80:83], v[216:219], v[172:179], v9
    v_smfmac_f32_16x16x64_bf16 v[76:79], v[220:223], v[148:155], v9
    v_smfmac_f32_16x16x64_bf16 v[80:83], v[220:223], v[180:187], v9
    s_waitcnt vmcnt(2)
    v_max3_u32 v4, v200, v201, v202
    v_max3_u32 v5, v203, v204, v205
    v_max3_u32 v4, v4, v206, v207
    v_max_u32 v4, v4, v5
    v_cmp_eq_u32 vcc, -1, v4

    s_cbranch_vccz .W_305
    s_branch .A_304
.W_339:
    v_smfmac_f32_16x16x64_bf16 v[76:79], v[208:211], v[124:131], v9
    v_smfmac_f32_16x16x64_bf16 v[80:83], v[208:211], v[156:163], v9
    v_smfmac_f32_16x16x64_bf16 v[76:79], v[212:215], v[132:139], v9
    v_smfmac_f32_16x16x64_bf16 v[80:83], v[212:215], v[164:171], v9
    s_waitcnt vmcnt(2)
    v_max3_u32 v4, v216, v217, v218
    v_max3_u32 v5, v219, v220, v221
    v_max3_u32 v4, v4, v222, v223
    v_max_u32 v4, v4, v5
    v_cmp_eq_u32 vcc, -1, v4

    s_cbranch_vccnz .A_342
.W_343:
    v_smfmac_f32_16x16x64_bf16 v[76:79], v[216:219], v[140:147], v9
    v_smfmac_f32_16x16x64_bf16 v[80:83], v[216:219], v[172:179], v9
    v_smfmac_f32_16x16x64_bf16 v[76:79], v[220:223], v[148:155], v9
    v_smfmac_f32_16x16x64_bf16 v[80:83], v[220:223], v[180:187], v9
    s_waitcnt vmcnt(4)
    v_max3_u32 v4, v200, v201, v202
    v_max3_u32 v5, v203, v204, v205
    v_max3_u32 v4, v4, v206, v207
    v_max_u32 v4, v4, v5
    v_cmp_eq_u32 vcc, -1, v4

    s_cbranch_vccz .W_319
    s_branch .A_318
.A_344:
    buffer_load_dwordx4 v[200:203], v246, s[8:11], s32 offen offset:2048 sc1
    buffer_load_dwordx4 v[204:207], v246, s[8:11], s32 offen offset:3072 sc1
    s_sub_u32 s62, s62, 1
    s_cbranch_scc1 .mg_end_1
    s_waitcnt vmcnt(6)
    v_max3_u32 v4, v192, v193, v194
    v_max3_u32 v5, v195, v196, v197
    v_max3_u32 v4, v4, v198, v199
    v_max_u32 v4, v4, v5
    v_cmp_eq_u32 vcc, -1, v4

    s_cbranch_vccz .W_317
.A_316:
    buffer_load_dwordx4 v[192:195], v246, s[8:11], s32 offen offset:0 sc1
    buffer_load_dwordx4 v[196:199], v246, s[8:11], s32 offen offset:1024 sc1
    s_waitcnt vmcnt(6)
    v_max3_u32 v4, v200, v201, v202
    v_max3_u32 v5, v203, v204, v205
    v_max3_u32 v4, v4, v206, v207
    v_max_u32 v4, v4, v5
    v_cmp_eq_u32 vcc, -1, v4

    s_cbranch_vccnz .A_344
.W_345:
    v_smfmac_f32_16x16x64_bf16 v[76:79], v[200:203], a[208:215], v9
    v_smfmac_f32_16x16x64_bf16 v[80:83], v[200:203], a[240:247], v9
    v_smfmac_f32_16x16x64_bf16 v[76:79], v[204:207], a[216:223], v9
    v_smfmac_f32_16x16x64_bf16 v[80:83], v[204:207], a[248:255], v9
    s_waitcnt vmcnt(4)
    v_max3_u32 v4, v192, v193, v194
    v_max3_u32 v5, v195, v196, v197
    v_max3_u32 v4, v4, v198, v199
    v_max_u32 v4, v4, v5
    v_cmp_eq_u32 vcc, -1, v4

    s_cbranch_vccz .W_313
    s_branch .A_312
.A_324:
    buffer_load_dwordx4 v[208:211], v246, s[8:11], s33 offen offset:0 sc1
    buffer_load_dwordx4 v[212:215], v246, s[8:11], s33 offen offset:1024 sc1
    s_sub_u32 s62, s62, 1
    s_cbranch_scc1 .mg_end_1
    s_waitcnt vmcnt(6)
    v_max3_u32 v4, v192, v193, v194
    v_max3_u32 v5, v195, v196, v197
    v_max3_u32 v4, v4, v198, v199
    v_max_u32 v4, v4, v5
    v_cmp_eq_u32 vcc, -1, v4

    s_cbranch_vccz .W_337
.A_336:
    buffer_load_dwordx4 v[192:195], v246, s[8:11], s32 offen offset:0 sc1
    buffer_load_dwordx4 v[196:199], v246, s[8:11], s32 offen offset:1024 sc1
    s_waitcnt vmcnt(6)
    v_max3_u32 v4, v208, v209, v210
    v_max3_u32 v5, v211, v212, v213
    v_max3_u32 v4, v4, v214, v215
    v_max_u32 v4, v4, v5
    v_cmp_eq_u32 vcc, -1, v4

    s_cbranch_vccnz .A_324
    s_branch .W_325
.A_346:
    buffer_load_dwordx4 v[192:195], v246, s[8:11], s32 offen offset:0 sc1
    buffer_load_dwordx4 v[196:199], v246, s[8:11], s32 offen offset:1024 sc1
    s_sub_u32 s62, s62, 1
    s_cbranch_scc1 .mg_end_1
    s_waitcnt vmcnt(6)
    v_max3_u32 v4, v216, v217, v218
    v_max3_u32 v5, v219, v220, v221
    v_max3_u32 v4, v4, v222, v223
    v_max_u32 v4, v4, v5
    v_cmp_eq_u32 vcc, -1, v4

    s_cbranch_vccz .W_311
.A_310:
    buffer_load_dwordx4 v[216:219], v246, s[8:11], s33 offen offset:2048 sc1
    buffer_load_dwordx4 v[220:223], v246, s[8:11], s33 offen offset:3072 sc1
    s_waitcnt vmcnt(6)
    v_max3_u32 v4, v192, v193, v194
    v_max3_u32 v5, v195, v196, v197
    v_max3_u32 v4, v4, v198, v199
    v_max_u32 v4, v4, v5
    v_cmp_eq_u32 vcc, -1, v4

    s_cbranch_vccnz .A_346
.W_347:
    v_smfmac_f32_16x16x64_bf16 v[76:79], v[192:195], a[192:199], v9
    v_smfmac_f32_16x16x64_bf16 v[80:83], v[192:195], a[224:231], v9
    v_smfmac_f32_16x16x64_bf16 v[76:79], v[196:199], a[200:207], v9
    v_smfmac_f32_16x16x64_bf16 v[80:83], v[196:199], a[232:239], v9
    s_waitcnt vmcnt(4)
    v_max3_u32 v4, v216, v217, v218
    v_max3_u32 v5, v219, v220, v221
    v_max3_u32 v4, v4, v222, v223
    v_max_u32 v4, v4, v5
    v_cmp_eq_u32 vcc, -1, v4

    s_cbranch_vccz .W_217
    s_branch .A_216
.A_348:
    buffer_load_dwordx4 v[208:211], v246, s[8:11], s33 offen offset:0 sc1
    buffer_load_dwordx4 v[212:215], v246, s[8:11], s33 offen offset:1024 sc1
    s_sub_u32 s62, s62, 1
    s_cbranch_scc1 .mg_end_1
    s_waitcnt vmcnt(6)
    v_max3_u32 v4, v200, v201, v202
    v_max3_u32 v5, v203, v204, v205
    v_max3_u32 v4, v4, v206, v207
    v_max_u32 v4, v4, v5
    v_cmp_eq_u32 vcc, -1, v4

    s_cbranch_vccz .W_305
.A_304:
    buffer_load_dwordx4 v[200:203], v246, s[8:11], s32 offen offset:2048 sc1
    buffer_load_dwordx4 v[204:207], v246, s[8:11], s32 offen offset:3072 sc1
    s_waitcnt vmcnt(6)
    v_max3_u32 v4, v208, v209, v210
    v_max3_u32 v5, v211, v212, v213
    v_max3_u32 v4, v4, v214, v215
    v_max_u32 v4, v4, v5
    v_cmp_eq_u32 vcc, -1, v4

    s_cbranch_vccnz .A_348
.W_349:
    v_smfmac_f32_16x16x64_bf16 v[76:79], v[208:211], v[124:131], v9
    v_smfmac_f32_16x16x64_bf16 v[80:83], v[208:211], v[156:163], v9
    v_smfmac_f32_16x16x64_bf16 v[76:79], v[212:215], v[132:139], v9
    v_smfmac_f32_16x16x64_bf16 v[80:83], v[212:215], v[164:171], v9
    s_waitcnt vmcnt(4)
    v_max3_u32 v4, v200, v201, v202
    v_max3_u32 v5, v203, v204, v205
    v_max3_u32 v4, v4, v206, v207
    v_max_u32 v4, v4, v5
    v_cmp_eq_u32 vcc, -1, v4

    s_cbranch_vccz .W_319
    s_branch .A_318
.A_342:
    buffer_load_dwordx4 v[216:219], v246, s[8:11], s33 offen offset:2048 sc1
    buffer_load_dwordx4 v[220:223], v246, s[8:11], s33 offen offset:3072 sc1
    s_sub_u32 s62, s62, 1
    s_cbranch_scc1 .mg_end_1
    s_waitcnt vmcnt(6)
    v_max3_u32 v4, v200, v201, v202
    v_max3_u32 v5, v203, v204, v205
    v_max3_u32 v4, v4, v206, v207
    v_max_u32 v4, v4, v5
    v_cmp_eq_u32 vcc, -1, v4

    s_cbranch_vccz .W_331
.A_330:
    buffer_load_dwordx4 v[200:203], v246, s[8:11], s32 offen offset:2048 sc1
    buffer_load_dwordx4 v[204:207], v246, s[8:11], s32 offen offset:3072 sc1
    s_waitcnt vmcnt(6)
    v_max3_u32 v4, v216, v217, v218
    v_max3_u32 v5, v219, v220, v221
    v_max3_u32 v4, v4, v222, v223
    v_max_u32 v4, v4, v5
    v_cmp_eq_u32 vcc, -1, v4

    s_cbranch_vccnz .A_342
    s_branch .W_343
.A_350:
    buffer_load_dwordx4 v[216:219], v246, s[8:11], s33 offen offset:2048 sc1
    buffer_load_dwordx4 v[220:223], v246, s[8:11], s33 offen offset:3072 sc1
    s_sub_u32 s62, s62, 1
    s_cbranch_scc1 .mg_end_1
    s_waitcnt vmcnt(6)
    v_max3_u32 v4, v208, v209, v210
    v_max3_u32 v5, v211, v212, v213
    v_max3_u32 v4, v4, v214, v215
    v_max_u32 v4, v4, v5
    v_cmp_eq_u32 vcc, -1, v4

    s_cbranch_vccz .W_215
.A_214:
    buffer_load_dwordx4 v[208:211], v246, s[8:11], s33 offen offset:0 sc1
    buffer_load_dwordx4 v[212:215], v246, s[8:11], s33 offen offset:1024 sc1
    s_waitcnt vmcnt(6)
    v_max3_u32 v4, v216, v217, v218
    v_max3_u32 v5, v219, v220, v221
    v_max3_u32 v4, v4, v222, v223
    v_max_u32 v4, v4, v5
    v_cmp_eq_u32 vcc, -1, v4

    s_cbranch_vccnz .A_350
.W_351:
    v_smfmac_f32_16x16x64_bf16 v[76:79], v[216:219], v[140:147], v9
    v_smfmac_f32_16x16x64_bf16 v[80:83], v[216:219], v[172:179], v9
    v_smfmac_f32_16x16x64_bf16 v[76:79], v[220:223], v[148:155], v9
    v_smfmac_f32_16x16x64_bf16 v[80:83], v[220:223], v[180:187], v9
    s_waitcnt vmcnt(4)
    v_max3_u32 v4, v208, v209, v210
    v_max3_u32 v5, v211, v212, v213
    v_max3_u32 v4, v4, v214, v215
    v_max_u32 v4, v4, v5
    v_cmp_eq_u32 vcc, -1, v4

    s_cbranch_vccz .W_307
    s_branch .A_306
.A_312:
    buffer_load_dwordx4 v[192:195], v246, s[8:11], s32 offen offset:0 sc1
    buffer_load_dwordx4 v[196:199], v246, s[8:11], s32 offen offset:1024 sc1
    s_sub_u32 s62, s62, 1
    s_cbranch_scc1 .mg_end_1
    s_waitcnt vmcnt(4)
    v_max3_u32 v4, v192, v193, v194
    v_max3_u32 v5, v195, v196, v197
    v_max3_u32 v4, v4, v198, v199
    v_max_u32 v4, v4, v5
    v_cmp_eq_u32 vcc, -1, v4

    s_cbranch_vccnz .A_312
    v_smfmac_f32_16x16x64_bf16 v[76:79], v[192:195], a[192:199], v9
    v_smfmac_f32_16x16x64_bf16 v[80:83], v[192:195], a[224:231], v9
    v_smfmac_f32_16x16x64_bf16 v[76:79], v[196:199], a[200:207], v9
    v_smfmac_f32_16x16x64_bf16 v[80:83], v[196:199], a[232:239], v9
    s_branch .mj_209
.A_318:
    buffer_load_dwordx4 v[200:203], v246, s[8:11], s32 offen offset:2048 sc1
    buffer_load_dwordx4 v[204:207], v246, s[8:11], s32 offen offset:3072 sc1
    s_sub_u32 s62, s62, 1
    s_cbranch_scc1 .mg_end_1
    s_waitcnt vmcnt(4)
    v_max3_u32 v4, v200, v201, v202
    v_max3_u32 v5, v203, v204, v205
    v_max3_u32 v4, v4, v206, v207
    v_max_u32 v4, v4, v5
    v_cmp_eq_u32 vcc, -1, v4

    s_cbranch_vccnz .A_318
    v_smfmac_f32_16x16x64_bf16 v[76:79], v[200:203], a[208:215], v9
    v_smfmac_f32_16x16x64_bf16 v[80:83], v[200:203], a[240:247], v9
    v_smfmac_f32_16x16x64_bf16 v[76:79], v[204:207], a[216:223], v9
    v_smfmac_f32_16x16x64_bf16 v[80:83], v[204:207], a[248:255], v9
    s_branch .mj_209
.A_306:
    buffer_load_dwordx4 v[208:211], v246, s[8:11], s33 offen offset:0 sc1
    buffer_load_dwordx4 v[212:215], v246, s[8:11], s33 offen offset:1024 sc1
    s_sub_u32 s62, s62, 1
    s_cbranch_scc1 .mg_end_1
    s_waitcnt vmcnt(4)
    v_max3_u32 v4, v208, v209, v210
    v_max3_u32 v5, v211, v212, v213
    v_max3_u32 v4, v4, v214, v215
    v_max_u32 v4, v4, v5
    v_cmp_eq_u32 vcc, -1, v4

    s_cbranch_vccnz .A_306
    v_smfmac_f32_16x16x64_bf16 v[76:79], v[208:211], v[124:131], v9
    v_smfmac_f32_16x16x64_bf16 v[80:83], v[208:211], v[156:163], v9
    v_smfmac_f32_16x16x64_bf16 v[76:79], v[212:215], v[132:139], v9
    v_smfmac_f32_16x16x64_bf16 v[80:83], v[212:215], v[164:171], v9
    s_branch .mj_209
.A_216:
    buffer_load_dwordx4 v[216:219], v246, s[8:11], s33 offen offset:2048 sc1
    buffer_load_dwordx4 v[220:223], v246, s[8:11], s33 offen offset:3072 sc1
    s_sub_u32 s62, s62, 1
    s_cbranch_scc1 .mg_end_1
    s_waitcnt vmcnt(4)
    v_max3_u32 v4, v216, v217, v218
    v_max3_u32 v5, v219, v220, v221
    v_max3_u32 v4, v4, v222, v223
    v_max_u32 v4, v4, v5
    v_cmp_eq_u32 vcc, -1, v4

    s_cbranch_vccnz .A_216
    v_smfmac_f32_16x16x64_bf16 v[76:79], v[216:219], v[140:147], v9
    v_smfmac_f32_16x16x64_bf16 v[80:83], v[216:219], v[172:179], v9
    v_smfmac_f32_16x16x64_bf16 v[76:79], v[220:223], v[148:155], v9
    v_smfmac_f32_16x16x64_bf16 v[80:83], v[220:223], v[180:187], v9
    s_branch .mj_209
.kf_218:
    s_mov_b32 s62, 0
    s_mov_b64 exec, 3
.wf_352:
    buffer_load_dword v244, v253, s[8:11], s89 offen sc1
    s_waitcnt vmcnt(0)
    v_cmp_gt_u32 vcc, s6, v244
    s_cbranch_vccz .wfd_353
    s_sleep 2
    s_add_u32 s62, s62, 1
    s_cmp_gt_u32 s62, 0x400000
    s_cbranch_scc1 .mg_end_1
    s_branch .wf_352

.wfd_353:
    s_mov_b64 exec, -1
    v_readlane_b32 s4, v244, 0
    v_readlane_b32 s93, v244, 1
    s_min_u32 s93, s93, s4
    s_mov_b32 s62, 0x1000000
    s_branch .kb_219
.sk_221:
    s_mov_b64 exec, s[66:67]
    buffer_store_dwordx4 v[88:91], v11, s[8:11], s36 offen sc1
    s_mov_b64 exec, s[56:57]
    buffer_store_dwordx4 v[172:175], v12, s[8:11], s36 offen sc1
    s_mov_b64 exec, -1

    s_branch .rec_fin_5
.rec_fin_5:
    s_mov_b64 exec, -1
    s_endpgm
.mg_bg_2:
    s_sub_u32 s91, s25, 4
    s_lshl_b32 s90, s91, 5
    s_add_u32 s90, s90, s26
    s_cmp_ge_u32 s26, 24
    s_cbranch_scc1 .cvrole_354
    s_lshr_b32 s30, s26, 3
    s_sub_u32 s30, 2, s30
    s_and_b32 s31, s26, 7
    s_lshl_b32 s4, s91, 3
    s_add_u32 s31, s31, s4

    s_load_dwordx2 s[40:41], s[0:1], 0
    s_load_dwordx4 s[44:47], s[0:1], 64
    s_load_dwordx2 s[42:43], s[0:1], 80

    v_and_b32 v1, 63, v0
    v_and_b32 v2, 15, v1
    v_lshrrev_b32 v3, 4, v1

    s_lshl_b32 s28, s31, 8
    s_waitcnt lgkmcnt(0)
    s_cmp_eq_u32 s30, 0
    s_cselect_b64 s[42:43], s[44:45], s[42:43]
    s_cmp_eq_u32 s30, 1
    s_cselect_b64 s[42:43], s[46:47], s[42:43]

    s_mov_b32 s16, s40
    s_and_b32 s17, s41, 0xffff
    s_mov_b32 s18, 0x400000
    s_mov_b32 s19, 0x00020000

    s_mov_b32 s12, s42
    s_and_b32 s13, s43, 0xffff
    s_mov_b32 s14, 0x800000
    s_mov_b32 s15, 0x00020000

    v_lshrrev_b32 v4, 1, v2
    v_xor_b32 v4, v4, v3
    v_lshlrev_b32 v4, 1, v4
    v_and_b32 v5, 1, v1
    v_or_b32 v4, v4, v5
    v_lshlrev_b32 v4, 4, v4
    v_lshlrev_b32 v5, 13, v3
    v_add_u32 v10, v4, v5
    v_xor_b32 v11, 0x80, v10
    s_lshl_b32 s4, s24, 18
    s_add_u32 s28, s28, s4
    s_lshl_b32 s29, s24, 13
    v_lshrrev_b32 v4, 2, v2
    v_and_b32 v5, 1, v3
    v_lshl_or_b32 v5, v5, 2, v4
    s_lshl_b32 s4, s24, 1
    v_xor_b32 v5, s4, v5
    v_lshlrev_b32 v5, 5, v5
    v_lshl_add_u32 v4, v3, 3, v4
    v_lshl_add_u32 v5, v4, 8, v5
    v_and_b32 v4, 3, v2
    v_lshl_add_u32 v12, v4, 3, v5
    v_xor_b32 v13, 32, v12
    v_add_u32 v14, 0x10000, v12
    v_add_u32 v15, 0x10000, v13

    s_add_u32 m0, s29, 0
    s_add_u32 s4, s28, 0
    buffer_load_dwordx4 v10, s[12:15], s4 offen lds

    s_add_u32 m0, s29, 1024
    s_add_u32 s4, s28, 32768
    buffer_load_dwordx4 v10, s[12:15], s4 offen lds

    s_add_u32 m0, s29, 2048
    s_add_u32 s4, s28, 65536
    buffer_load_dwordx4 v11, s[12:15], s4 offen lds

    s_add_u32 m0, s29, 3072
    s_add_u32 s4, s28, 98304
    buffer_load_dwordx4 v11, s[12:15], s4 offen lds

    s_add_u32 m0, s29, 4096
    s_add_u32 s4, s28, 131072
    buffer_load_dwordx4 v10, s[12:15], s4 offen lds

    s_add_u32 m0, s29, 5120
    s_add_u32 s4, s28, 163840
    buffer_load_dwordx4 v10, s[12:15], s4 offen lds

    s_add_u32 m0, s29, 6144
    s_add_u32 s4, s28, 196608
    buffer_load_dwordx4 v11, s[12:15], s4 offen lds

    s_add_u32 m0, s29, 7168
    s_add_u32 s4, s28, 229376
    buffer_load_dwordx4 v11, s[12:15], s4 offen lds

    s_add_u32 m0, s29, 32768
    s_add_u32 s4, s28, 1048576
    buffer_load_dwordx4 v10, s[12:15], s4 offen lds

    s_add_u32 m0, s29, 33792
    s_add_u32 s4, s28, 1081344
    buffer_load_dwordx4 v10, s[12:15], s4 offen lds

    s_add_u32 m0, s29, 34816
    s_add_u32 s4, s28, 1114112
    buffer_load_dwordx4 v11, s[12:15], s4 offen lds

    s_add_u32 m0, s29, 35840
    s_add_u32 s4, s28, 1146880
    buffer_load_dwordx4 v11, s[12:15], s4 offen lds

    s_add_u32 m0, s29, 36864
    s_add_u32 s4, s28, 1179648
    buffer_load_dwordx4 v10, s[12:15], s4 offen lds

    s_add_u32 m0, s29, 37888
    s_add_u32 s4, s28, 1212416
    buffer_load_dwordx4 v10, s[12:15], s4 offen lds

    s_add_u32 m0, s29, 38912
    s_add_u32 s4, s28, 1245184
    buffer_load_dwordx4 v11, s[12:15], s4 offen lds

    s_add_u32 m0, s29, 39936
    s_add_u32 s4, s28, 1277952
    buffer_load_dwordx4 v11, s[12:15], s4 offen lds

    s_add_u32 m0, s29, 65536
    s_add_u32 s4, s28, 2097152
    buffer_load_dwordx4 v10, s[12:15], s4 offen lds

    s_add_u32 m0, s29, 66560
    s_add_u32 s4, s28, 2129920
    buffer_load_dwordx4 v10, s[12:15], s4 offen lds

    s_add_u32 m0, s29, 67584
    s_add_u32 s4, s28, 2162688
    buffer_load_dwordx4 v11, s[12:15], s4 offen lds

    s_add_u32 m0, s29, 68608
    s_add_u32 s4, s28, 2195456
    buffer_load_dwordx4 v11, s[12:15], s4 offen lds

    s_add_u32 m0, s29, 69632
    s_add_u32 s4, s28, 2228224
    buffer_load_dwordx4 v10, s[12:15], s4 offen lds

    s_add_u32 m0, s29, 70656
    s_add_u32 s4, s28, 2260992
    buffer_load_dwordx4 v10, s[12:15], s4 offen lds

    s_add_u32 m0, s29, 71680
    s_add_u32 s4, s28, 2293760
    buffer_load_dwordx4 v11, s[12:15], s4 offen lds

    s_add_u32 m0, s29, 72704
    s_add_u32 s4, s28, 2326528
    buffer_load_dwordx4 v11, s[12:15], s4 offen lds

    s_add_u32 m0, s29, 98304
    s_add_u32 s4, s28, 3145728
    buffer_load_dwordx4 v10, s[12:15], s4 offen lds

    s_add_u32 m0, s29, 99328
    s_add_u32 s4, s28, 3178496
    buffer_load_dwordx4 v10, s[12:15], s4 offen lds

    s_add_u32 m0, s29, 100352
    s_add_u32 s4, s28, 3211264
    buffer_load_dwordx4 v11, s[12:15], s4 offen lds

    s_add_u32 m0, s29, 101376
    s_add_u32 s4, s28, 3244032
    buffer_load_dwordx4 v11, s[12:15], s4 offen lds

    s_add_u32 m0, s29, 102400
    s_add_u32 s4, s28, 3276800
    buffer_load_dwordx4 v10, s[12:15], s4 offen lds

    s_add_u32 m0, s29, 103424
    s_add_u32 s4, s28, 3309568
    buffer_load_dwordx4 v10, s[12:15], s4 offen lds

    s_add_u32 m0, s29, 104448
    s_add_u32 s4, s28, 3342336
    buffer_load_dwordx4 v11, s[12:15], s4 offen lds

    s_add_u32 m0, s29, 105472
    s_add_u32 s4, s28, 3375104
    buffer_load_dwordx4 v11, s[12:15], s4 offen lds

    v_and_b32 v243, 7, v0
    v_lshlrev_b32 v243, 2, v243
    buffer_load_dword v242, v243, s[20:23], 0 offen sc1

    s_lshl_b32 s4, s30, 5
    s_add_u32 s4, s4, s31
    s_lshl_b32 s4, s4, 8
    s_add_u32 s4, s4, 92274688
    v_mov_b32 v4, 0
    s_mov_b64 exec, 1
    buffer_store_dword v4, v4, s[8:11], s4 offen sc1
    s_mov_b64 exec, -1

    v_lshrrev_b32 v4, 3, v1
    v_and_b32 v5, 7, v1
    v_xor_b32 v5, v5, v4
    v_lshlrev_b32 v5, 4, v5
    v_lshl_add_u32 v16, v4, 11, v5
    s_lshl_b32 s4, s24, 14
    v_add_u32 v16, s4, v16
    v_and_b32 v4, 7, v2
    v_xor_b32 v5, v4, v3
    v_lshlrev_b32 v5, 4, v5
    v_lshl_add_u32 v5, v4, 7, v5
    v_lshrrev_b32 v4, 3, v2
    v_lshl_add_u32 v17, v4, 13, v5
    v_xor_b32 v18, 64, v17
    v_add_u32 v19, 0x10000, v17
    v_add_u32 v20, 0x10000, v18
    v_lshlrev_b32 v21, 4, v1
    s_lshl_b32 s32, s30, 24
    s_lshl_b32 s4, s31, 13
    s_add_u32 s32, s32, s4
    s_lshr_b32 s5, s30, 1
    s_add_u32 s5, s5, 10
    s_lshl_b32 s4, s24, s5
    s_add_u32 s39, s32, s4
    s_mov_b32 s32, 251658240
    s_mov_b32 s38, s32
    v_mov_b32 v23, -1
    s_lshl_b32 s4, s30, 5
    s_add_u32 s4, s4, s31
    s_lshl_b32 s4, s4, 8
    s_add_u32 s33, s4, 92274688
    s_cmp_eq_u32 s24, 0
    s_cselect_b32 s36, 1, 0
    s_mov_b32 s37, 0
    v_mov_b32 v22, 0
    s_mov_b32 s34, 0
    s_mov_b32 s35, 0

    s_mul_i32 s47, s26, 1441792
    s_lshl_b32 s4, s24, 10
    s_add_u32 s47, s47, s4
    s_add_u32 s47, s47, 184549376
    v_mov_b32 v24, -1
    v_mov_b32 v25, -1
    v_mov_b32 v26, -1
    v_mov_b32 v27, -1

    s_xor_b32 s4, s91, 1
    s_lshl_b32 s5, s4, 14
    s_lshl_b32 s6, s91, 12
    s_add_u32 s5, s5, s6
    v_add_u32 v28, s5, v21
    s_lshl_b32 s5, s91, 14
    s_lshl_b32 s6, s4, 12
    s_add_u32 s5, s5, s6
    v_add_u32 v7, s5, v21

    s_xor_b32 s4, s91, 2
    s_lshl_b32 s5, s4, 14
    s_lshl_b32 s6, s91, 12
    s_add_u32 s5, s5, s6
    v_add_u32 v29, s5, v21
    s_lshl_b32 s5, s91, 14
    s_lshl_b32 s6, s4, 12
    s_add_u32 s5, s5, s6
    v_add_u32 v8, s5, v21

    s_xor_b32 s4, s91, 3
    s_lshl_b32 s5, s4, 14
    s_lshl_b32 s6, s91, 12
    s_add_u32 s5, s5, s6
    v_add_u32 v30, s5, v21
    s_lshl_b32 s5, s91, 14
    s_lshl_b32 s6, s4, 12
    s_add_u32 s5, s5, s6
    v_add_u32 v9, s5, v21

    s_mov_b64 s[44:45], -1
    s_mov_b32 s46, s47
    s_waitcnt vmcnt(26)
    s_barrier
    ds_read_b64_tr_b16 a[0:1], v12 offset:0
    ds_read_b64_tr_b16 a[2:3], v12 offset:1024
    ds_read_b64_tr_b16 a[4:5], v13 offset:0
    ds_read_b64_tr_b16 a[6:7], v13 offset:1024
    ds_read_b64_tr_b16 a[8:9], v12 offset:8192
    ds_read_b64_tr_b16 a[10:11], v12 offset:9216
    ds_read_b64_tr_b16 a[12:13], v13 offset:8192
    ds_read_b64_tr_b16 a[14:15], v13 offset:9216
    ds_read_b64_tr_b16 a[16:17], v12 offset:16384
    ds_read_b64_tr_b16 a[18:19], v12 offset:17408
    ds_read_b64_tr_b16 a[20:21], v13 offset:16384
    ds_read_b64_tr_b16 a[22:23], v13 offset:17408
    ds_read_b64_tr_b16 a[24:25], v12 offset:24576
    ds_read_b64_tr_b16 a[26:27], v12 offset:25600
    ds_read_b64_tr_b16 a[28:29], v13 offset:24576
    ds_read_b64_tr_b16 a[30:31], v13 offset:25600
    s_waitcnt lgkmcnt(0)
    s_barrier
    s_add_u32 m0, s29, 0
    s_add_u32 s4, s28, 4194304
    buffer_load_dwordx4 v10, s[12:15], s4 offen lds

    s_add_u32 m0, s29, 1024
    s_add_u32 s4, s28, 4227072
    buffer_load_dwordx4 v10, s[12:15], s4 offen lds

    s_add_u32 m0, s29, 2048
    s_add_u32 s4, s28, 4259840
    buffer_load_dwordx4 v11, s[12:15], s4 offen lds

    s_add_u32 m0, s29, 3072
    s_add_u32 s4, s28, 4292608
    buffer_load_dwordx4 v11, s[12:15], s4 offen lds

    s_add_u32 m0, s29, 4096
    s_add_u32 s4, s28, 4325376
    buffer_load_dwordx4 v10, s[12:15], s4 offen lds

    s_add_u32 m0, s29, 5120
    s_add_u32 s4, s28, 4358144
    buffer_load_dwordx4 v10, s[12:15], s4 offen lds

    s_add_u32 m0, s29, 6144
    s_add_u32 s4, s28, 4390912
    buffer_load_dwordx4 v11, s[12:15], s4 offen lds

    s_add_u32 m0, s29, 7168
    s_add_u32 s4, s28, 4423680
    buffer_load_dwordx4 v11, s[12:15], s4 offen lds

    s_waitcnt vmcnt(26)
    s_barrier
    ds_read_b64_tr_b16 a[32:33], v12 offset:32768
    ds_read_b64_tr_b16 a[34:35], v12 offset:33792
    ds_read_b64_tr_b16 a[36:37], v13 offset:32768
    ds_read_b64_tr_b16 a[38:39], v13 offset:33792
    ds_read_b64_tr_b16 a[40:41], v12 offset:40960
    ds_read_b64_tr_b16 a[42:43], v12 offset:41984
    ds_read_b64_tr_b16 a[44:45], v13 offset:40960
    ds_read_b64_tr_b16 a[46:47], v13 offset:41984
    ds_read_b64_tr_b16 a[48:49], v12 offset:49152
    ds_read_b64_tr_b16 a[50:51], v12 offset:50176
    ds_read_b64_tr_b16 a[52:53], v13 offset:49152
    ds_read_b64_tr_b16 a[54:55], v13 offset:50176
    ds_read_b64_tr_b16 a[56:57], v12 offset:57344
    ds_read_b64_tr_b16 a[58:59], v12 offset:58368
    ds_read_b64_tr_b16 a[60:61], v13 offset:57344
    ds_read_b64_tr_b16 a[62:63], v13 offset:58368
    s_waitcnt lgkmcnt(0)
    s_barrier
    s_add_u32 m0, s29, 32768
    s_add_u32 s4, s28, 5242880
    buffer_load_dwordx4 v10, s[12:15], s4 offen lds

    s_add_u32 m0, s29, 33792
    s_add_u32 s4, s28, 5275648
    buffer_load_dwordx4 v10, s[12:15], s4 offen lds

    s_add_u32 m0, s29, 34816
    s_add_u32 s4, s28, 5308416
    buffer_load_dwordx4 v11, s[12:15], s4 offen lds

    s_add_u32 m0, s29, 35840
    s_add_u32 s4, s28, 5341184
    buffer_load_dwordx4 v11, s[12:15], s4 offen lds

    s_add_u32 m0, s29, 36864
    s_add_u32 s4, s28, 5373952
    buffer_load_dwordx4 v10, s[12:15], s4 offen lds

    s_add_u32 m0, s29, 37888
    s_add_u32 s4, s28, 5406720
    buffer_load_dwordx4 v10, s[12:15], s4 offen lds

    s_add_u32 m0, s29, 38912
    s_add_u32 s4, s28, 5439488
    buffer_load_dwordx4 v11, s[12:15], s4 offen lds

    s_add_u32 m0, s29, 39936
    s_add_u32 s4, s28, 5472256
    buffer_load_dwordx4 v11, s[12:15], s4 offen lds

    s_waitcnt vmcnt(26)
    s_barrier
    ds_read_b64_tr_b16 a[64:65], v14 offset:0
    ds_read_b64_tr_b16 a[66:67], v14 offset:1024
    ds_read_b64_tr_b16 a[68:69], v15 offset:0
    ds_read_b64_tr_b16 a[70:71], v15 offset:1024
    ds_read_b64_tr_b16 a[72:73], v14 offset:8192
    ds_read_b64_tr_b16 a[74:75], v14 offset:9216
    ds_read_b64_tr_b16 a[76:77], v15 offset:8192
    ds_read_b64_tr_b16 a[78:79], v15 offset:9216
    ds_read_b64_tr_b16 a[80:81], v14 offset:16384
    ds_read_b64_tr_b16 a[82:83], v14 offset:17408
    ds_read_b64_tr_b16 a[84:85], v15 offset:16384
    ds_read_b64_tr_b16 a[86:87], v15 offset:17408
    ds_read_b64_tr_b16 a[88:89], v14 offset:24576
    ds_read_b64_tr_b16 a[90:91], v14 offset:25600
    ds_read_b64_tr_b16 a[92:93], v15 offset:24576
    ds_read_b64_tr_b16 a[94:95], v15 offset:25600
    s_waitcnt lgkmcnt(0)
    s_barrier
    s_add_u32 m0, s29, 65536
    s_add_u32 s4, s28, 6291456
    buffer_load_dwordx4 v10, s[12:15], s4 offen lds

    s_add_u32 m0, s29, 66560
    s_add_u32 s4, s28, 6324224
    buffer_load_dwordx4 v10, s[12:15], s4 offen lds

    s_add_u32 m0, s29, 67584
    s_add_u32 s4, s28, 6356992
    buffer_load_dwordx4 v11, s[12:15], s4 offen lds

    s_add_u32 m0, s29, 68608
    s_add_u32 s4, s28, 6389760
    buffer_load_dwordx4 v11, s[12:15], s4 offen lds

    s_add_u32 m0, s29, 69632
    s_add_u32 s4, s28, 6422528
    buffer_load_dwordx4 v10, s[12:15], s4 offen lds

    s_add_u32 m0, s29, 70656
    s_add_u32 s4, s28, 6455296
    buffer_load_dwordx4 v10, s[12:15], s4 offen lds

    s_add_u32 m0, s29, 71680
    s_add_u32 s4, s28, 6488064
    buffer_load_dwordx4 v11, s[12:15], s4 offen lds

    s_add_u32 m0, s29, 72704
    s_add_u32 s4, s28, 6520832
    buffer_load_dwordx4 v11, s[12:15], s4 offen lds

    s_waitcnt vmcnt(26)
    s_barrier
    ds_read_b64_tr_b16 a[96:97], v14 offset:32768
    ds_read_b64_tr_b16 a[98:99], v14 offset:33792
    ds_read_b64_tr_b16 a[100:101], v15 offset:32768
    ds_read_b64_tr_b16 a[102:103], v15 offset:33792
    ds_read_b64_tr_b16 a[104:105], v14 offset:40960
    ds_read_b64_tr_b16 a[106:107], v14 offset:41984
    ds_read_b64_tr_b16 a[108:109], v15 offset:40960
    ds_read_b64_tr_b16 a[110:111], v15 offset:41984
    ds_read_b64_tr_b16 a[112:113], v14 offset:49152
    ds_read_b64_tr_b16 a[114:115], v14 offset:50176
    ds_read_b64_tr_b16 a[116:117], v15 offset:49152
    ds_read_b64_tr_b16 a[118:119], v15 offset:50176
    ds_read_b64_tr_b16 a[120:121], v14 offset:57344
    ds_read_b64_tr_b16 a[122:123], v14 offset:58368
    ds_read_b64_tr_b16 a[124:125], v15 offset:57344
    ds_read_b64_tr_b16 a[126:127], v15 offset:58368
    s_waitcnt lgkmcnt(0)
    s_barrier
    s_add_u32 m0, s29, 98304
    s_add_u32 s4, s28, 7340032
    buffer_load_dwordx4 v10, s[12:15], s4 offen lds

    s_add_u32 m0, s29, 99328
    s_add_u32 s4, s28, 7372800
    buffer_load_dwordx4 v10, s[12:15], s4 offen lds

    s_add_u32 m0, s29, 100352
    s_add_u32 s4, s28, 7405568
    buffer_load_dwordx4 v11, s[12:15], s4 offen lds

    s_add_u32 m0, s29, 101376
    s_add_u32 s4, s28, 7438336
    buffer_load_dwordx4 v11, s[12:15], s4 offen lds

    s_add_u32 m0, s29, 102400
    s_add_u32 s4, s28, 7471104
    buffer_load_dwordx4 v10, s[12:15], s4 offen lds

    s_add_u32 m0, s29, 103424
    s_add_u32 s4, s28, 7503872
    buffer_load_dwordx4 v10, s[12:15], s4 offen lds

    s_add_u32 m0, s29, 104448
    s_add_u32 s4, s28, 7536640
    buffer_load_dwordx4 v11, s[12:15], s4 offen lds

    s_add_u32 m0, s29, 105472
    s_add_u32 s4, s28, 7569408
    buffer_load_dwordx4 v11, s[12:15], s4 offen lds

    s_waitcnt vmcnt(24)
    s_barrier
    ds_read_b64_tr_b16 a[128:129], v12 offset:0
    ds_read_b64_tr_b16 a[130:131], v12 offset:1024
    ds_read_b64_tr_b16 a[132:133], v13 offset:0
    ds_read_b64_tr_b16 a[134:135], v13 offset:1024
    ds_read_b64_tr_b16 a[136:137], v12 offset:8192
    ds_read_b64_tr_b16 a[138:139], v12 offset:9216
    ds_read_b64_tr_b16 a[140:141], v13 offset:8192
    ds_read_b64_tr_b16 a[142:143], v13 offset:9216
    ds_read_b64_tr_b16 a[144:145], v12 offset:16384
    ds_read_b64_tr_b16 a[146:147], v12 offset:17408
    ds_read_b64_tr_b16 a[148:149], v13 offset:16384
    ds_read_b64_tr_b16 a[150:151], v13 offset:17408
    ds_read_b64_tr_b16 a[152:153], v12 offset:24576
    ds_read_b64_tr_b16 a[154:155], v12 offset:25600
    ds_read_b64_tr_b16 a[156:157], v13 offset:24576
    ds_read_b64_tr_b16 a[158:159], v13 offset:25600
    s_cmp_lg_u32 s97, 0
    s_cbranch_scc1 .vd_356
    s_mov_b32 s62, 0

.vp_355:
    v_cmp_ne_u32 vcc, 32, v242
    s_cbranch_vccz .vd_356
    v_readlane_b32 s4, v242, 0

    v_readlane_b32 s5, v242, 1
    s_add_u32 s4, s4, s5
    v_readlane_b32 s5, v242, 2
    s_add_u32 s4, s4, s5
    v_readlane_b32 s5, v242, 3
    s_add_u32 s4, s4, s5
    v_readlane_b32 s5, v242, 4
    s_add_u32 s4, s4, s5
    v_readlane_b32 s5, v242, 5
    s_add_u32 s4, s4, s5
    v_readlane_b32 s5, v242, 6
    s_add_u32 s4, s4, s5
    v_readlane_b32 s5, v242, 7
    s_add_u32 s4, s4, s5
    s_cmp_ge_u32 s4, 256
    s_cbranch_scc1 .vs_357
    s_add_u32 s62, s62, 1
    s_cmp_gt_u32 s62, 0x100000
    s_cbranch_scc1 .mg_end_1
    s_sleep 4
    buffer_load_dword v242, v243, s[20:23], 0 offen sc1
    s_waitcnt vmcnt(0)
    s_branch .vp_355

.vs_357:
    s_lshr_b32 s25, s2, 5
    s_and_b32 s26, s2, 31
    s_mov_b32 s27, 1
    s_mov_b32 s97, 1
    s_waitcnt vmcnt(0) lgkmcnt(0)
    s_barrier
    s_branch .mg_role_3

.vd_356:
    s_mov_b32 s97, 1
    s_cmp_lg_u32 s24, 0
    s_cbranch_scc1 .sg_358
    s_mov_b64 exec, 1
    v_mov_b32 v4, 1
    v_mov_b32 v5, 32
    buffer_atomic_add v4, v5, s[20:23], 0 offen sc1
    s_mov_b64 exec, -1

.sg_358:
    s_waitcnt lgkmcnt(0)
    s_barrier
    s_add_u32 m0, s29, 0
    s_nop 0
    buffer_load_dwordx4 v16, s[16:19], s34 offen offset:0 lds
    s_add_u32 m0, s29, 896
    s_nop 0
    buffer_load_dwordx4 v16, s[16:19], s34 offen offset:128 lds
    s_add_u32 m0, s29, 1792
    s_nop 0
    buffer_load_dwordx4 v16, s[16:19], s34 offen offset:256 lds
    s_add_u32 m0, s29, 2688
    s_nop 0
    buffer_load_dwordx4 v16, s[16:19], s34 offen offset:384 lds
    s_add_u32 m0, s29, 3584
    s_nop 0
    buffer_load_dwordx4 v16, s[16:19], s34 offen offset:512 lds
    s_add_u32 m0, s29, 4480
    s_nop 0
    buffer_load_dwordx4 v16, s[16:19], s34 offen offset:640 lds
    s_add_u32 m0, s29, 5376
    s_nop 0
    buffer_load_dwordx4 v16, s[16:19], s34 offen offset:768 lds
    s_add_u32 m0, s29, 6272
    s_nop 0
    buffer_load_dwordx4 v16, s[16:19], s34 offen offset:896 lds
    s_add_u32 s34, s34, 1024
    s_waitcnt vmcnt(24)
    s_barrier
    ds_read_b64_tr_b16 a[160:161], v12 offset:32768
    ds_read_b64_tr_b16 a[162:163], v12 offset:33792
    ds_read_b64_tr_b16 a[164:165], v13 offset:32768
    ds_read_b64_tr_b16 a[166:167], v13 offset:33792
    ds_read_b64_tr_b16 a[168:169], v12 offset:40960
    ds_read_b64_tr_b16 a[170:171], v12 offset:41984
    ds_read_b64_tr_b16 a[172:173], v13 offset:40960
    ds_read_b64_tr_b16 a[174:175], v13 offset:41984
    ds_read_b64_tr_b16 a[176:177], v12 offset:49152
    ds_read_b64_tr_b16 a[178:179], v12 offset:50176
    ds_read_b64_tr_b16 a[180:181], v13 offset:49152
    ds_read_b64_tr_b16 a[182:183], v13 offset:50176
    ds_read_b64_tr_b16 a[184:185], v12 offset:57344
    ds_read_b64_tr_b16 a[186:187], v12 offset:58368
    ds_read_b64_tr_b16 a[188:189], v13 offset:57344
    ds_read_b64_tr_b16 a[190:191], v13 offset:58368
    s_waitcnt lgkmcnt(0)
    s_barrier
    s_add_u32 m0, s29, 32768
    s_nop 0
    buffer_load_dwordx4 v16, s[16:19], s34 offen offset:0 lds
    s_add_u32 m0, s29, 33664
    s_nop 0
    buffer_load_dwordx4 v16, s[16:19], s34 offen offset:128 lds
    s_add_u32 m0, s29, 34560
    s_nop 0
    buffer_load_dwordx4 v16, s[16:19], s34 offen offset:256 lds
    s_add_u32 m0, s29, 35456
    s_nop 0
    buffer_load_dwordx4 v16, s[16:19], s34 offen offset:384 lds
    s_add_u32 m0, s29, 36352
    s_nop 0
    buffer_load_dwordx4 v16, s[16:19], s34 offen offset:512 lds
    s_add_u32 m0, s29, 37248
    s_nop 0
    buffer_load_dwordx4 v16, s[16:19], s34 offen offset:640 lds
    s_add_u32 m0, s29, 38144
    s_nop 0
    buffer_load_dwordx4 v16, s[16:19], s34 offen offset:768 lds
    s_add_u32 m0, s29, 39040
    s_nop 0
    buffer_load_dwordx4 v16, s[16:19], s34 offen offset:896 lds
    s_add_u32 s34, s34, 64512
    s_min_u32 s34, s34, 4128768
    s_waitcnt vmcnt(24)
    s_barrier
    ds_read_b64_tr_b16 a[192:193], v14 offset:0
    ds_read_b64_tr_b16 a[194:195], v14 offset:1024
    ds_read_b64_tr_b16 a[196:197], v15 offset:0
    ds_read_b64_tr_b16 a[198:199], v15 offset:1024
    ds_read_b64_tr_b16 a[200:201], v14 offset:8192
    ds_read_b64_tr_b16 a[202:203], v14 offset:9216
    ds_read_b64_tr_b16 a[204:205], v15 offset:8192
    ds_read_b64_tr_b16 a[206:207], v15 offset:9216
    ds_read_b64_tr_b16 a[208:209], v14 offset:16384
    ds_read_b64_tr_b16 a[210:211], v14 offset:17408
    ds_read_b64_tr_b16 a[212:213], v15 offset:16384
    ds_read_b64_tr_b16 a[214:215], v15 offset:17408
    ds_read_b64_tr_b16 a[216:217], v14 offset:24576
    ds_read_b64_tr_b16 a[218:219], v14 offset:25600
    ds_read_b64_tr_b16 a[220:221], v15 offset:24576
    ds_read_b64_tr_b16 a[222:223], v15 offset:25600
    s_waitcnt lgkmcnt(0)
    s_barrier
    s_add_u32 m0, s29, 65536
    s_nop 0
    buffer_load_dwordx4 v16, s[16:19], s34 offen offset:0 lds
    s_add_u32 m0, s29, 66432
    s_nop 0
    buffer_load_dwordx4 v16, s[16:19], s34 offen offset:128 lds
    s_add_u32 m0, s29, 67328
    s_nop 0
    buffer_load_dwordx4 v16, s[16:19], s34 offen offset:256 lds
    s_add_u32 m0, s29, 68224
    s_nop 0
    buffer_load_dwordx4 v16, s[16:19], s34 offen offset:384 lds
    s_add_u32 m0, s29, 69120
    s_nop 0
    buffer_load_dwordx4 v16, s[16:19], s34 offen offset:512 lds
    s_add_u32 m0, s29, 70016
    s_nop 0
    buffer_load_dwordx4 v16, s[16:19], s34 offen offset:640 lds
    s_add_u32 m0, s29, 70912
    s_nop 0
    buffer_load_dwordx4 v16, s[16:19], s34 offen offset:768 lds
    s_add_u32 m0, s29, 71808
    s_nop 0
    buffer_load_dwordx4 v16, s[16:19], s34 offen offset:896 lds
    s_add_u32 s34, s34, 1024
    s_waitcnt vmcnt(24)
    s_barrier
    ds_read_b64_tr_b16 a[224:225], v14 offset:32768
    ds_read_b64_tr_b16 a[226:227], v14 offset:33792
    ds_read_b64_tr_b16 a[228:229], v15 offset:32768
    ds_read_b64_tr_b16 a[230:231], v15 offset:33792
    ds_read_b64_tr_b16 a[232:233], v14 offset:40960
    ds_read_b64_tr_b16 a[234:235], v14 offset:41984
    ds_read_b64_tr_b16 a[236:237], v15 offset:40960
    ds_read_b64_tr_b16 a[238:239], v15 offset:41984
    ds_read_b64_tr_b16 a[240:241], v14 offset:49152
    ds_read_b64_tr_b16 a[242:243], v14 offset:50176
    ds_read_b64_tr_b16 a[244:245], v15 offset:49152
    ds_read_b64_tr_b16 a[246:247], v15 offset:50176
    ds_read_b64_tr_b16 a[248:249], v14 offset:57344
    ds_read_b64_tr_b16 a[250:251], v14 offset:58368
    ds_read_b64_tr_b16 a[252:253], v15 offset:57344
    ds_read_b64_tr_b16 a[254:255], v15 offset:58368
    s_waitcnt lgkmcnt(0)
    s_barrier
    s_cmp_eq_u32 s30, 2
    s_cbranch_scc1 .qv_359
    s_waitcnt vmcnt(16)
    s_barrier
    ds_read_b128 v[32:35], v17 offset:0
    ds_read_b128 v[36:39], v17 offset:16384
    ds_read_b128 v[40:43], v18 offset:0
    ds_read_b128 v[44:47], v18 offset:16384
    s_add_u32 m0, s29, 98304
    s_nop 0
    buffer_load_dwordx4 v16, s[16:19], s34 offen offset:0 lds
    ds_read_b128 v[48:51], v17 offset:1024
    ds_read_b128 v[52:55], v17 offset:17408
    s_branch .qe_362
.p2align 6
.ql_361:
.qe_362:
    s_waitcnt lgkmcnt(4)
    v_mfma_f32_16x16x32_bf16 v[64:67], a[0:3], v[32:35], 0
    ds_read_b128 v[56:59], v18 offset:1024
    s_add_u32 m0, s29, 99200
    v_mfma_f32_16x16x32_bf16 v[68:71], a[4:7], v[32:35], 0
    buffer_load_dwordx4 v16, s[16:19], s34 offen offset:128 lds
    v_mfma_f32_16x16x32_bf16 v[72:75], a[0:3], v[36:39], 0
    ds_read_b128 v[60:63], v18 offset:17408
    v_mfma_f32_16x16x32_bf16 v[76:79], a[4:7], v[36:39], 0
    s_waitcnt lgkmcnt(4)
    v_mfma_f32_16x16x32_bf16 v[64:67], a[8:11], v[40:43], v[64:67]
    ds_read_b128 v[32:35], v17 offset:2048
    v_mfma_f32_16x16x32_bf16 v[68:71], a[12:15], v[40:43], v[68:71]
    v_cvt_pk_bf16_f32 v96, v80, v81
    v_cvt_pk_bf16_f32 v97, v82, v83
    v_mfma_f32_16x16x32_bf16 v[72:75], a[8:11], v[44:47], v[72:75]
    ds_read_b128 v[36:39], v17 offset:18432
    v_mfma_f32_16x16x32_bf16 v[76:79], a[12:15], v[44:47], v[76:79]
    v_cvt_pk_bf16_f32 v98, v84, v85
    v_cvt_pk_bf16_f32 v99, v86, v87
    s_waitcnt lgkmcnt(4)
    v_mfma_f32_16x16x32_bf16 v[64:67], a[16:19], v[48:51], v[64:67]
    ds_read_b128 v[40:43], v18 offset:2048
    s_add_u32 m0, s29, 100096
    v_mfma_f32_16x16x32_bf16 v[68:71], a[20:23], v[48:51], v[68:71]
    buffer_load_dwordx4 v16, s[16:19], s34 offen offset:256 lds
    v_mfma_f32_16x16x32_bf16 v[72:75], a[16:19], v[52:55], v[72:75]
    ds_read_b128 v[44:47], v18 offset:18432
    v_mfma_f32_16x16x32_bf16 v[76:79], a[20:23], v[52:55], v[76:79]
    s_waitcnt lgkmcnt(4)
    v_mfma_f32_16x16x32_bf16 v[64:67], a[24:27], v[56:59], v[64:67]
    ds_read_b128 v[48:51], v17 offset:3072
    v_mfma_f32_16x16x32_bf16 v[68:71], a[28:31], v[56:59], v[68:71]
    buffer_store_dwordx4 v[96:99], v21, s[8:11], s32 offen sc1
    v_mfma_f32_16x16x32_bf16 v[72:75], a[24:27], v[60:63], v[72:75]
    ds_read_b128 v[52:55], v17 offset:19456
    v_mfma_f32_16x16x32_bf16 v[76:79], a[28:31], v[60:63], v[76:79]
    s_waitcnt lgkmcnt(4)
    v_mfma_f32_16x16x32_bf16 v[64:67], a[32:35], v[32:35], v[64:67]
    ds_read_b128 v[56:59], v18 offset:3072
    s_add_u32 m0, s29, 100992
    v_mfma_f32_16x16x32_bf16 v[68:71], a[36:39], v[32:35], v[68:71]
    buffer_load_dwordx4 v16, s[16:19], s34 offen offset:384 lds
    v_mfma_f32_16x16x32_bf16 v[72:75], a[32:35], v[36:39], v[72:75]
    ds_read_b128 v[60:63], v18 offset:19456
    v_mfma_f32_16x16x32_bf16 v[76:79], a[36:39], v[36:39], v[76:79]
    s_waitcnt lgkmcnt(4)
    v_mfma_f32_16x16x32_bf16 v[64:67], a[40:43], v[40:43], v[64:67]
    ds_read_b128 v[32:35], v17 offset:4096
    v_mfma_f32_16x16x32_bf16 v[68:71], a[44:47], v[40:43], v[68:71]
    v_cvt_pk_bf16_f32 v100, v88, v89
    v_cvt_pk_bf16_f32 v101, v90, v91
    v_mfma_f32_16x16x32_bf16 v[72:75], a[40:43], v[44:47], v[72:75]
    ds_read_b128 v[36:39], v17 offset:20480
    v_mfma_f32_16x16x32_bf16 v[76:79], a[44:47], v[44:47], v[76:79]
    v_cvt_pk_bf16_f32 v102, v92, v93
    v_cvt_pk_bf16_f32 v103, v94, v95
    s_waitcnt lgkmcnt(4)
    v_mfma_f32_16x16x32_bf16 v[64:67], a[48:51], v[48:51], v[64:67]
    ds_read_b128 v[40:43], v18 offset:4096
    s_add_u32 m0, s29, 101888
    v_mfma_f32_16x16x32_bf16 v[68:71], a[52:55], v[48:51], v[68:71]
    buffer_load_dwordx4 v16, s[16:19], s34 offen offset:512 lds
    v_mfma_f32_16x16x32_bf16 v[72:75], a[48:51], v[52:55], v[72:75]
    ds_read_b128 v[44:47], v18 offset:20480
    v_mfma_f32_16x16x32_bf16 v[76:79], a[52:55], v[52:55], v[76:79]
    s_waitcnt lgkmcnt(4)
    v_mfma_f32_16x16x32_bf16 v[64:67], a[56:59], v[56:59], v[64:67]
    ds_read_b128 v[48:51], v17 offset:5120
    v_mfma_f32_16x16x32_bf16 v[68:71], a[60:63], v[56:59], v[68:71]
    buffer_store_dwordx4 v[100:103], v21, s[8:11], s38 offen sc1
    v_mfma_f32_16x16x32_bf16 v[72:75], a[56:59], v[60:63], v[72:75]
    ds_read_b128 v[52:55], v17 offset:21504
    v_mfma_f32_16x16x32_bf16 v[76:79], a[60:63], v[60:63], v[76:79]
    s_waitcnt lgkmcnt(4)
    v_mfma_f32_16x16x32_bf16 v[64:67], a[64:67], v[32:35], v[64:67]
    ds_read_b128 v[56:59], v18 offset:5120
    s_add_u32 m0, s29, 102784
    v_mfma_f32_16x16x32_bf16 v[68:71], a[68:71], v[32:35], v[68:71]
    buffer_load_dwordx4 v16, s[16:19], s34 offen offset:640 lds
    v_mfma_f32_16x16x32_bf16 v[72:75], a[64:67], v[36:39], v[72:75]
    ds_read_b128 v[60:63], v18 offset:21504
    v_mfma_f32_16x16x32_bf16 v[76:79], a[68:71], v[36:39], v[76:79]
    s_waitcnt lgkmcnt(4)
    v_mfma_f32_16x16x32_bf16 v[64:67], a[72:75], v[40:43], v[64:67]
    ds_read_b128 v[32:35], v17 offset:6144
    v_mfma_f32_16x16x32_bf16 v[68:71], a[76:79], v[40:43], v[68:71]
    s_mov_b32 s32, s39
    s_add_u32 s38, s39, 4096
    s_add_u32 s39, s39, 262144
    v_mfma_f32_16x16x32_bf16 v[72:75], a[72:75], v[44:47], v[72:75]
    ds_read_b128 v[36:39], v17 offset:22528
    v_mfma_f32_16x16x32_bf16 v[76:79], a[76:79], v[44:47], v[76:79]
    v_add_u32 v23, 1, v23
    s_waitcnt lgkmcnt(4)
    v_mfma_f32_16x16x32_bf16 v[64:67], a[80:83], v[48:51], v[64:67]
    ds_read_b128 v[40:43], v18 offset:6144
    s_add_u32 m0, s29, 103680
    v_mfma_f32_16x16x32_bf16 v[68:71], a[84:87], v[48:51], v[68:71]
    buffer_load_dwordx4 v16, s[16:19], s34 offen offset:768 lds
    v_mfma_f32_16x16x32_bf16 v[72:75], a[80:83], v[52:55], v[72:75]
    ds_read_b128 v[44:47], v18 offset:22528
    v_mfma_f32_16x16x32_bf16 v[76:79], a[84:87], v[52:55], v[76:79]
    s_waitcnt lgkmcnt(4)
    v_mfma_f32_16x16x32_bf16 v[64:67], a[88:91], v[56:59], v[64:67]
    ds_read_b128 v[48:51], v17 offset:7168
    v_mfma_f32_16x16x32_bf16 v[68:71], a[92:95], v[56:59], v[68:71]
    v_mfma_f32_16x16x32_bf16 v[72:75], a[88:91], v[60:63], v[72:75]
    ds_read_b128 v[52:55], v17 offset:23552
    v_mfma_f32_16x16x32_bf16 v[76:79], a[92:95], v[60:63], v[76:79]
    s_mov_b64 exec, s[44:45]
    buffer_store_dwordx4 v[24:27], v28, s[8:11], s46 offen sc1
    s_mov_b64 exec, -1
    s_waitcnt lgkmcnt(4)
    v_mfma_f32_16x16x32_bf16 v[64:67], a[96:99], v[32:35], v[64:67]
    ds_read_b128 v[56:59], v18 offset:7168
    s_add_u32 m0, s29, 104576
    v_mfma_f32_16x16x32_bf16 v[68:71], a[100:103], v[32:35], v[68:71]
    buffer_load_dwordx4 v16, s[16:19], s34 offen offset:896 lds
    v_mfma_f32_16x16x32_bf16 v[72:75], a[96:99], v[36:39], v[72:75]
    ds_read_b128 v[60:63], v18 offset:23552
    v_mfma_f32_16x16x32_bf16 v[76:79], a[100:103], v[36:39], v[76:79]
    s_waitcnt lgkmcnt(4)
    v_mfma_f32_16x16x32_bf16 v[64:67], a[104:107], v[40:43], v[64:67]
    s_add_u32 s34, s34, 64512
    s_min_u32 s34, s34, 4128768
    v_mfma_f32_16x16x32_bf16 v[68:71], a[108:111], v[40:43], v[68:71]
    v_mfma_f32_16x16x32_bf16 v[72:75], a[104:107], v[44:47], v[72:75]
    v_mfma_f32_16x16x32_bf16 v[76:79], a[108:111], v[44:47], v[76:79]
    s_waitcnt lgkmcnt(0)
    s_waitcnt vmcnt(18)
    s_barrier
    ds_read_b128 v[32:35], v17 offset:32768
    ds_read_b128 v[36:39], v17 offset:49152
    v_mfma_f32_16x16x32_bf16 v[64:67], a[112:115], v[48:51], v[64:67]
    ds_read_b128 v[40:43], v18 offset:32768
    s_add_u32 m0, s29, 0
    v_mfma_f32_16x16x32_bf16 v[68:71], a[116:119], v[48:51], v[68:71]
    buffer_load_dwordx4 v16, s[16:19], s34 offen offset:0 lds
    v_mfma_f32_16x16x32_bf16 v[72:75], a[112:115], v[52:55], v[72:75]
    ds_read_b128 v[44:47], v18 offset:49152
    v_mfma_f32_16x16x32_bf16 v[76:79], a[116:119], v[52:55], v[76:79]
    v_mfma_f32_16x16x32_bf16 v[64:67], a[120:123], v[56:59], v[64:67]
    ds_read_b128 v[48:51], v17 offset:33792
    v_mfma_f32_16x16x32_bf16 v[68:71], a[124:127], v[56:59], v[68:71]
    v_mfma_f32_16x16x32_bf16 v[72:75], a[120:123], v[60:63], v[72:75]
    ds_read_b128 v[52:55], v17 offset:50176
    v_mfma_f32_16x16x32_bf16 v[76:79], a[124:127], v[60:63], v[76:79]
    s_waitcnt lgkmcnt(4)
    v_mfma_f32_16x16x32_bf16 v[64:67], a[128:131], v[32:35], v[64:67]
    ds_read_b128 v[56:59], v18 offset:33792
    s_add_u32 m0, s29, 896
    v_mfma_f32_16x16x32_bf16 v[68:71], a[132:135], v[32:35], v[68:71]
    buffer_load_dwordx4 v16, s[16:19], s34 offen offset:128 lds
    v_mfma_f32_16x16x32_bf16 v[72:75], a[128:131], v[36:39], v[72:75]
    ds_read_b128 v[60:63], v18 offset:50176
    v_mfma_f32_16x16x32_bf16 v[76:79], a[132:135], v[36:39], v[76:79]
    s_waitcnt lgkmcnt(4)
    v_mfma_f32_16x16x32_bf16 v[64:67], a[136:139], v[40:43], v[64:67]
    ds_read_b128 v[32:35], v17 offset:34816
    v_mfma_f32_16x16x32_bf16 v[68:71], a[140:143], v[40:43], v[68:71]
    v_mfma_f32_16x16x32_bf16 v[72:75], a[136:139], v[44:47], v[72:75]
    ds_read_b128 v[36:39], v17 offset:51200
    v_mfma_f32_16x16x32_bf16 v[76:79], a[140:143], v[44:47], v[76:79]
    s_waitcnt lgkmcnt(4)
    v_mfma_f32_16x16x32_bf16 v[64:67], a[144:147], v[48:51], v[64:67]
    ds_read_b128 v[40:43], v18 offset:34816
    s_add_u32 m0, s29, 1792
    v_mfma_f32_16x16x32_bf16 v[68:71], a[148:151], v[48:51], v[68:71]
    buffer_load_dwordx4 v16, s[16:19], s34 offen offset:256 lds
    v_mfma_f32_16x16x32_bf16 v[72:75], a[144:147], v[52:55], v[72:75]
    ds_read_b128 v[44:47], v18 offset:51200
    v_mfma_f32_16x16x32_bf16 v[76:79], a[148:151], v[52:55], v[76:79]
    s_waitcnt lgkmcnt(4)
    v_mfma_f32_16x16x32_bf16 v[64:67], a[152:155], v[56:59], v[64:67]
    ds_read_b128 v[48:51], v17 offset:35840
    v_mfma_f32_16x16x32_bf16 v[68:71], a[156:159], v[56:59], v[68:71]
    v_mfma_f32_16x16x32_bf16 v[72:75], a[152:155], v[60:63], v[72:75]
    ds_read_b128 v[52:55], v17 offset:52224
    v_mfma_f32_16x16x32_bf16 v[76:79], a[156:159], v[60:63], v[76:79]
    s_waitcnt lgkmcnt(4)
    v_mfma_f32_16x16x32_bf16 v[64:67], a[160:163], v[32:35], v[64:67]
    ds_read_b128 v[56:59], v18 offset:35840
    s_add_u32 m0, s29, 2688
    v_mfma_f32_16x16x32_bf16 v[68:71], a[164:167], v[32:35], v[68:71]
    buffer_load_dwordx4 v16, s[16:19], s34 offen offset:384 lds
    v_mfma_f32_16x16x32_bf16 v[72:75], a[160:163], v[36:39], v[72:75]
    ds_read_b128 v[60:63], v18 offset:52224
    v_mfma_f32_16x16x32_bf16 v[76:79], a[164:167], v[36:39], v[76:79]
    s_waitcnt lgkmcnt(4)
    v_mfma_f32_16x16x32_bf16 v[64:67], a[168:171], v[40:43], v[64:67]
    ds_read_b128 v[32:35], v17 offset:36864
    v_mfma_f32_16x16x32_bf16 v[68:71], a[172:175], v[40:43], v[68:71]
    v_mfma_f32_16x16x32_bf16 v[72:75], a[168:171], v[44:47], v[72:75]
    ds_read_b128 v[36:39], v17 offset:53248
    v_mfma_f32_16x16x32_bf16 v[76:79], a[172:175], v[44:47], v[76:79]
    s_waitcnt lgkmcnt(4)
    v_mfma_f32_16x16x32_bf16 v[64:67], a[176:179], v[48:51], v[64:67]
    ds_read_b128 v[40:43], v18 offset:36864
    s_add_u32 m0, s29, 3584
    v_mfma_f32_16x16x32_bf16 v[68:71], a[180:183], v[48:51], v[68:71]
    buffer_load_dwordx4 v16, s[16:19], s34 offen offset:512 lds
    v_mfma_f32_16x16x32_bf16 v[72:75], a[176:179], v[52:55], v[72:75]
    ds_read_b128 v[44:47], v18 offset:53248
    v_mfma_f32_16x16x32_bf16 v[76:79], a[180:183], v[52:55], v[76:79]
    s_waitcnt lgkmcnt(4)
    v_mfma_f32_16x16x32_bf16 v[64:67], a[184:187], v[56:59], v[64:67]
    ds_read_b128 v[48:51], v17 offset:37888
    v_mfma_f32_16x16x32_bf16 v[68:71], a[188:191], v[56:59], v[68:71]
    v_mfma_f32_16x16x32_bf16 v[72:75], a[184:187], v[60:63], v[72:75]
    ds_read_b128 v[52:55], v17 offset:54272
    v_mfma_f32_16x16x32_bf16 v[76:79], a[188:191], v[60:63], v[76:79]
    s_waitcnt lgkmcnt(4)
    v_mfma_f32_16x16x32_bf16 v[64:67], a[192:195], v[32:35], v[64:67]
    ds_read_b128 v[56:59], v18 offset:37888
    s_add_u32 m0, s29, 4480
    v_mfma_f32_16x16x32_bf16 v[68:71], a[196:199], v[32:35], v[68:71]
    buffer_load_dwordx4 v16, s[16:19], s34 offen offset:640 lds
    v_mfma_f32_16x16x32_bf16 v[72:75], a[192:195], v[36:39], v[72:75]
    ds_read_b128 v[60:63], v18 offset:54272
    v_mfma_f32_16x16x32_bf16 v[76:79], a[196:199], v[36:39], v[76:79]
    s_waitcnt lgkmcnt(4)
    v_mfma_f32_16x16x32_bf16 v[64:67], a[200:203], v[40:43], v[64:67]
    ds_read_b128 v[32:35], v17 offset:38912
    v_mfma_f32_16x16x32_bf16 v[68:71], a[204:207], v[40:43], v[68:71]
    v_mfma_f32_16x16x32_bf16 v[72:75], a[200:203], v[44:47], v[72:75]
    ds_read_b128 v[36:39], v17 offset:55296
    v_mfma_f32_16x16x32_bf16 v[76:79], a[204:207], v[44:47], v[76:79]
    s_waitcnt lgkmcnt(4)
    v_mfma_f32_16x16x32_bf16 v[64:67], a[208:211], v[48:51], v[64:67]
    ds_read_b128 v[40:43], v18 offset:38912
    s_add_u32 m0, s29, 5376
    v_mfma_f32_16x16x32_bf16 v[68:71], a[212:215], v[48:51], v[68:71]
    buffer_load_dwordx4 v16, s[16:19], s34 offen offset:768 lds
    v_mfma_f32_16x16x32_bf16 v[72:75], a[208:211], v[52:55], v[72:75]
    ds_read_b128 v[44:47], v18 offset:55296
    v_mfma_f32_16x16x32_bf16 v[76:79], a[212:215], v[52:55], v[76:79]
    s_waitcnt lgkmcnt(4)
    v_mfma_f32_16x16x32_bf16 v[64:67], a[216:219], v[56:59], v[64:67]
    ds_read_b128 v[48:51], v17 offset:39936
    v_mfma_f32_16x16x32_bf16 v[68:71], a[220:223], v[56:59], v[68:71]
    v_mfma_f32_16x16x32_bf16 v[72:75], a[216:219], v[60:63], v[72:75]
    ds_read_b128 v[52:55], v17 offset:56320
    v_mfma_f32_16x16x32_bf16 v[76:79], a[220:223], v[60:63], v[76:79]
    s_mov_b64 exec, s[44:45]
    buffer_store_dwordx4 v[24:27], v29, s[8:11], s46 offen sc1
    s_mov_b64 exec, -1
    s_waitcnt lgkmcnt(4)
    v_mfma_f32_16x16x32_bf16 v[64:67], a[224:227], v[32:35], v[64:67]
    ds_read_b128 v[56:59], v18 offset:39936
    s_add_u32 m0, s29, 6272
    v_mfma_f32_16x16x32_bf16 v[68:71], a[228:231], v[32:35], v[68:71]
    buffer_load_dwordx4 v16, s[16:19], s34 offen offset:896 lds
    v_mfma_f32_16x16x32_bf16 v[72:75], a[224:227], v[36:39], v[72:75]
    ds_read_b128 v[60:63], v18 offset:56320
    v_mfma_f32_16x16x32_bf16 v[76:79], a[228:231], v[36:39], v[76:79]
    s_waitcnt lgkmcnt(4)
    v_mfma_f32_16x16x32_bf16 v[64:67], a[232:235], v[40:43], v[64:67]
    s_add_u32 s34, s34, 1024
    v_mfma_f32_16x16x32_bf16 v[68:71], a[236:239], v[40:43], v[68:71]
    v_mfma_f32_16x16x32_bf16 v[72:75], a[232:235], v[44:47], v[72:75]
    v_mfma_f32_16x16x32_bf16 v[76:79], a[236:239], v[44:47], v[76:79]
    s_waitcnt lgkmcnt(0)
    s_waitcnt vmcnt(11)
    s_barrier
    ds_read_b128 v[32:35], v19 offset:0
    ds_read_b128 v[36:39], v19 offset:16384
    v_mfma_f32_16x16x32_bf16 v[64:67], a[240:243], v[48:51], v[64:67]
    ds_read_b128 v[40:43], v20 offset:0
    s_add_u32 m0, s29, 32768
    v_mfma_f32_16x16x32_bf16 v[68:71], a[244:247], v[48:51], v[68:71]
    buffer_load_dwordx4 v16, s[16:19], s34 offen offset:0 lds
    v_mfma_f32_16x16x32_bf16 v[72:75], a[240:243], v[52:55], v[72:75]
    ds_read_b128 v[44:47], v20 offset:16384
    v_mfma_f32_16x16x32_bf16 v[76:79], a[244:247], v[52:55], v[76:79]
    v_mfma_f32_16x16x32_bf16 v[64:67], a[248:251], v[56:59], v[64:67]
    ds_read_b128 v[48:51], v19 offset:1024
    v_mfma_f32_16x16x32_bf16 v[68:71], a[252:255], v[56:59], v[68:71]
    v_mfma_f32_16x16x32_bf16 v[72:75], a[248:251], v[60:63], v[72:75]
    ds_read_b128 v[52:55], v19 offset:17408
    v_mfma_f32_16x16x32_bf16 v[76:79], a[252:255], v[60:63], v[76:79]
    s_mov_b64 exec, s[36:37]
    buffer_store_dword v23, v22, s[8:11], s33 offen sc1
    s_mov_b64 exec, -1

    s_waitcnt lgkmcnt(4)
    v_mfma_f32_16x16x32_bf16 v[80:83], a[0:3], v[32:35], 0
    ds_read_b128 v[56:59], v20 offset:1024
    s_add_u32 m0, s29, 33664
    v_mfma_f32_16x16x32_bf16 v[84:87], a[4:7], v[32:35], 0
    buffer_load_dwordx4 v16, s[16:19], s34 offen offset:128 lds
    v_mfma_f32_16x16x32_bf16 v[88:91], a[0:3], v[36:39], 0
    ds_read_b128 v[60:63], v20 offset:17408
    v_mfma_f32_16x16x32_bf16 v[92:95], a[4:7], v[36:39], 0
    s_waitcnt lgkmcnt(4)
    v_mfma_f32_16x16x32_bf16 v[80:83], a[8:11], v[40:43], v[80:83]
    ds_read_b128 v[32:35], v19 offset:2048
    v_mfma_f32_16x16x32_bf16 v[84:87], a[12:15], v[40:43], v[84:87]
    v_cvt_pk_bf16_f32 v96, v64, v65
    v_cvt_pk_bf16_f32 v97, v66, v67
    v_mfma_f32_16x16x32_bf16 v[88:91], a[8:11], v[44:47], v[88:91]
    ds_read_b128 v[36:39], v19 offset:18432
    v_mfma_f32_16x16x32_bf16 v[92:95], a[12:15], v[44:47], v[92:95]
    v_cvt_pk_bf16_f32 v98, v68, v69
    v_cvt_pk_bf16_f32 v99, v70, v71
    s_waitcnt lgkmcnt(4)
    v_mfma_f32_16x16x32_bf16 v[80:83], a[16:19], v[48:51], v[80:83]
    ds_read_b128 v[40:43], v20 offset:2048
    s_add_u32 m0, s29, 34560
    v_mfma_f32_16x16x32_bf16 v[84:87], a[20:23], v[48:51], v[84:87]
    buffer_load_dwordx4 v16, s[16:19], s34 offen offset:256 lds
    v_mfma_f32_16x16x32_bf16 v[88:91], a[16:19], v[52:55], v[88:91]
    ds_read_b128 v[44:47], v20 offset:18432
    v_mfma_f32_16x16x32_bf16 v[92:95], a[20:23], v[52:55], v[92:95]
    s_waitcnt lgkmcnt(4)
    v_mfma_f32_16x16x32_bf16 v[80:83], a[24:27], v[56:59], v[80:83]
    ds_read_b128 v[48:51], v19 offset:3072
    v_mfma_f32_16x16x32_bf16 v[84:87], a[28:31], v[56:59], v[84:87]
    buffer_store_dwordx4 v[96:99], v21, s[8:11], s32 offen sc1
    v_mfma_f32_16x16x32_bf16 v[88:91], a[24:27], v[60:63], v[88:91]
    ds_read_b128 v[52:55], v19 offset:19456
    v_mfma_f32_16x16x32_bf16 v[92:95], a[28:31], v[60:63], v[92:95]
    s_waitcnt lgkmcnt(4)
    v_mfma_f32_16x16x32_bf16 v[80:83], a[32:35], v[32:35], v[80:83]
    ds_read_b128 v[56:59], v20 offset:3072
    s_add_u32 m0, s29, 35456
    v_mfma_f32_16x16x32_bf16 v[84:87], a[36:39], v[32:35], v[84:87]
    buffer_load_dwordx4 v16, s[16:19], s34 offen offset:384 lds
    v_mfma_f32_16x16x32_bf16 v[88:91], a[32:35], v[36:39], v[88:91]
    ds_read_b128 v[60:63], v20 offset:19456
    v_mfma_f32_16x16x32_bf16 v[92:95], a[36:39], v[36:39], v[92:95]
    s_waitcnt lgkmcnt(4)
    v_mfma_f32_16x16x32_bf16 v[80:83], a[40:43], v[40:43], v[80:83]
    ds_read_b128 v[32:35], v19 offset:4096
    v_mfma_f32_16x16x32_bf16 v[84:87], a[44:47], v[40:43], v[84:87]
    v_cvt_pk_bf16_f32 v100, v72, v73
    v_cvt_pk_bf16_f32 v101, v74, v75
    v_mfma_f32_16x16x32_bf16 v[88:91], a[40:43], v[44:47], v[88:91]
    ds_read_b128 v[36:39], v19 offset:20480
    v_mfma_f32_16x16x32_bf16 v[92:95], a[44:47], v[44:47], v[92:95]
    v_cvt_pk_bf16_f32 v102, v76, v77
    v_cvt_pk_bf16_f32 v103, v78, v79
    s_waitcnt lgkmcnt(4)
    v_mfma_f32_16x16x32_bf16 v[80:83], a[48:51], v[48:51], v[80:83]
    ds_read_b128 v[40:43], v20 offset:4096
    s_add_u32 m0, s29, 36352
    v_mfma_f32_16x16x32_bf16 v[84:87], a[52:55], v[48:51], v[84:87]
    buffer_load_dwordx4 v16, s[16:19], s34 offen offset:512 lds
    v_mfma_f32_16x16x32_bf16 v[88:91], a[48:51], v[52:55], v[88:91]
    ds_read_b128 v[44:47], v20 offset:20480
    v_mfma_f32_16x16x32_bf16 v[92:95], a[52:55], v[52:55], v[92:95]
    s_waitcnt lgkmcnt(4)
    v_mfma_f32_16x16x32_bf16 v[80:83], a[56:59], v[56:59], v[80:83]
    ds_read_b128 v[48:51], v19 offset:5120
    v_mfma_f32_16x16x32_bf16 v[84:87], a[60:63], v[56:59], v[84:87]
    buffer_store_dwordx4 v[100:103], v21, s[8:11], s38 offen sc1
    v_mfma_f32_16x16x32_bf16 v[88:91], a[56:59], v[60:63], v[88:91]
    ds_read_b128 v[52:55], v19 offset:21504
    v_mfma_f32_16x16x32_bf16 v[92:95], a[60:63], v[60:63], v[92:95]
    s_waitcnt lgkmcnt(4)
    v_mfma_f32_16x16x32_bf16 v[80:83], a[64:67], v[32:35], v[80:83]
    ds_read_b128 v[56:59], v20 offset:5120
    s_add_u32 m0, s29, 37248
    v_mfma_f32_16x16x32_bf16 v[84:87], a[68:71], v[32:35], v[84:87]
    buffer_load_dwordx4 v16, s[16:19], s34 offen offset:640 lds
    v_mfma_f32_16x16x32_bf16 v[88:91], a[64:67], v[36:39], v[88:91]
    ds_read_b128 v[60:63], v20 offset:21504
    v_mfma_f32_16x16x32_bf16 v[92:95], a[68:71], v[36:39], v[92:95]
    s_waitcnt lgkmcnt(4)
    v_mfma_f32_16x16x32_bf16 v[80:83], a[72:75], v[40:43], v[80:83]
    ds_read_b128 v[32:35], v19 offset:6144
    v_mfma_f32_16x16x32_bf16 v[84:87], a[76:79], v[40:43], v[84:87]
    s_mov_b32 s32, s39
    s_add_u32 s38, s39, 4096
    s_add_u32 s39, s39, 262144
    v_mfma_f32_16x16x32_bf16 v[88:91], a[72:75], v[44:47], v[88:91]
    ds_read_b128 v[36:39], v19 offset:22528
    v_mfma_f32_16x16x32_bf16 v[92:95], a[76:79], v[44:47], v[92:95]
    v_add_u32 v23, 1, v23
    s_waitcnt lgkmcnt(4)
    v_mfma_f32_16x16x32_bf16 v[80:83], a[80:83], v[48:51], v[80:83]
    ds_read_b128 v[40:43], v20 offset:6144
    s_add_u32 m0, s29, 38144
    v_mfma_f32_16x16x32_bf16 v[84:87], a[84:87], v[48:51], v[84:87]
    buffer_load_dwordx4 v16, s[16:19], s34 offen offset:768 lds
    v_mfma_f32_16x16x32_bf16 v[88:91], a[80:83], v[52:55], v[88:91]
    ds_read_b128 v[44:47], v20 offset:22528
    v_mfma_f32_16x16x32_bf16 v[92:95], a[84:87], v[52:55], v[92:95]
    s_waitcnt lgkmcnt(4)
    v_mfma_f32_16x16x32_bf16 v[80:83], a[88:91], v[56:59], v[80:83]
    ds_read_b128 v[48:51], v19 offset:7168
    v_mfma_f32_16x16x32_bf16 v[84:87], a[92:95], v[56:59], v[84:87]
    v_mfma_f32_16x16x32_bf16 v[88:91], a[88:91], v[60:63], v[88:91]
    ds_read_b128 v[52:55], v19 offset:23552
    v_mfma_f32_16x16x32_bf16 v[92:95], a[92:95], v[60:63], v[92:95]
    s_mov_b64 exec, s[44:45]
    buffer_store_dwordx4 v[24:27], v30, s[8:11], s46 offen sc1
    s_mov_b64 exec, -1
    s_waitcnt lgkmcnt(4)
    v_mfma_f32_16x16x32_bf16 v[80:83], a[96:99], v[32:35], v[80:83]
    ds_read_b128 v[56:59], v20 offset:7168
    s_add_u32 m0, s29, 39040
    v_mfma_f32_16x16x32_bf16 v[84:87], a[100:103], v[32:35], v[84:87]
    buffer_load_dwordx4 v16, s[16:19], s34 offen offset:896 lds
    v_mfma_f32_16x16x32_bf16 v[88:91], a[96:99], v[36:39], v[88:91]
    ds_read_b128 v[60:63], v20 offset:23552
    v_mfma_f32_16x16x32_bf16 v[92:95], a[100:103], v[36:39], v[92:95]
    s_waitcnt lgkmcnt(4)
    v_mfma_f32_16x16x32_bf16 v[80:83], a[104:107], v[40:43], v[80:83]
    s_add_u32 s34, s34, 64512
    s_min_u32 s34, s34, 4128768
    v_mfma_f32_16x16x32_bf16 v[84:87], a[108:111], v[40:43], v[84:87]
    v_mfma_f32_16x16x32_bf16 v[88:91], a[104:107], v[44:47], v[88:91]
    v_mfma_f32_16x16x32_bf16 v[92:95], a[108:111], v[44:47], v[92:95]
    s_waitcnt lgkmcnt(0)
    s_waitcnt vmcnt(18)
    s_barrier
    ds_read_b128 v[32:35], v19 offset:32768
    ds_read_b128 v[36:39], v19 offset:49152
    v_mfma_f32_16x16x32_bf16 v[80:83], a[112:115], v[48:51], v[80:83]
    ds_read_b128 v[40:43], v20 offset:32768
    s_add_u32 m0, s29, 65536
    v_mfma_f32_16x16x32_bf16 v[84:87], a[116:119], v[48:51], v[84:87]
    buffer_load_dwordx4 v16, s[16:19], s34 offen offset:0 lds
    v_mfma_f32_16x16x32_bf16 v[88:91], a[112:115], v[52:55], v[88:91]
    ds_read_b128 v[44:47], v20 offset:49152
    v_mfma_f32_16x16x32_bf16 v[92:95], a[116:119], v[52:55], v[92:95]
    v_mfma_f32_16x16x32_bf16 v[80:83], a[120:123], v[56:59], v[80:83]
    ds_read_b128 v[48:51], v19 offset:33792
    v_mfma_f32_16x16x32_bf16 v[84:87], a[124:127], v[56:59], v[84:87]
    v_mfma_f32_16x16x32_bf16 v[88:91], a[120:123], v[60:63], v[88:91]
    ds_read_b128 v[52:55], v19 offset:50176
    v_mfma_f32_16x16x32_bf16 v[92:95], a[124:127], v[60:63], v[92:95]
    s_waitcnt lgkmcnt(4)
    v_mfma_f32_16x16x32_bf16 v[80:83], a[128:131], v[32:35], v[80:83]
    ds_read_b128 v[56:59], v20 offset:33792
    s_add_u32 m0, s29, 66432
    v_mfma_f32_16x16x32_bf16 v[84:87], a[132:135], v[32:35], v[84:87]
    buffer_load_dwordx4 v16, s[16:19], s34 offen offset:128 lds
    v_mfma_f32_16x16x32_bf16 v[88:91], a[128:131], v[36:39], v[88:91]
    ds_read_b128 v[60:63], v20 offset:50176
    v_mfma_f32_16x16x32_bf16 v[92:95], a[132:135], v[36:39], v[92:95]
    s_waitcnt lgkmcnt(4)
    v_mfma_f32_16x16x32_bf16 v[80:83], a[136:139], v[40:43], v[80:83]
    ds_read_b128 v[32:35], v19 offset:34816
    v_mfma_f32_16x16x32_bf16 v[84:87], a[140:143], v[40:43], v[84:87]
    v_mfma_f32_16x16x32_bf16 v[88:91], a[136:139], v[44:47], v[88:91]
    ds_read_b128 v[36:39], v19 offset:51200
    v_mfma_f32_16x16x32_bf16 v[92:95], a[140:143], v[44:47], v[92:95]
    s_waitcnt lgkmcnt(4)
    v_mfma_f32_16x16x32_bf16 v[80:83], a[144:147], v[48:51], v[80:83]
    ds_read_b128 v[40:43], v20 offset:34816
    s_add_u32 m0, s29, 67328
    v_mfma_f32_16x16x32_bf16 v[84:87], a[148:151], v[48:51], v[84:87]
    buffer_load_dwordx4 v16, s[16:19], s34 offen offset:256 lds
    v_mfma_f32_16x16x32_bf16 v[88:91], a[144:147], v[52:55], v[88:91]
    ds_read_b128 v[44:47], v20 offset:51200
    v_mfma_f32_16x16x32_bf16 v[92:95], a[148:151], v[52:55], v[92:95]
    s_waitcnt lgkmcnt(4)
    v_mfma_f32_16x16x32_bf16 v[80:83], a[152:155], v[56:59], v[80:83]
    ds_read_b128 v[48:51], v19 offset:35840
    v_mfma_f32_16x16x32_bf16 v[84:87], a[156:159], v[56:59], v[84:87]
    v_mfma_f32_16x16x32_bf16 v[88:91], a[152:155], v[60:63], v[88:91]
    ds_read_b128 v[52:55], v19 offset:52224
    v_mfma_f32_16x16x32_bf16 v[92:95], a[156:159], v[60:63], v[92:95]
    s_waitcnt lgkmcnt(4)
    v_mfma_f32_16x16x32_bf16 v[80:83], a[160:163], v[32:35], v[80:83]
    ds_read_b128 v[56:59], v20 offset:35840
    s_add_u32 m0, s29, 68224
    v_mfma_f32_16x16x32_bf16 v[84:87], a[164:167], v[32:35], v[84:87]
    buffer_load_dwordx4 v16, s[16:19], s34 offen offset:384 lds
    v_mfma_f32_16x16x32_bf16 v[88:91], a[160:163], v[36:39], v[88:91]
    ds_read_b128 v[60:63], v20 offset:52224
    v_mfma_f32_16x16x32_bf16 v[92:95], a[164:167], v[36:39], v[92:95]
    s_waitcnt lgkmcnt(4)
    v_mfma_f32_16x16x32_bf16 v[80:83], a[168:171], v[40:43], v[80:83]
    ds_read_b128 v[32:35], v19 offset:36864
    v_mfma_f32_16x16x32_bf16 v[84:87], a[172:175], v[40:43], v[84:87]
    v_mfma_f32_16x16x32_bf16 v[88:91], a[168:171], v[44:47], v[88:91]
    ds_read_b128 v[36:39], v19 offset:53248
    v_mfma_f32_16x16x32_bf16 v[92:95], a[172:175], v[44:47], v[92:95]
    s_waitcnt lgkmcnt(4)
    v_mfma_f32_16x16x32_bf16 v[80:83], a[176:179], v[48:51], v[80:83]
    ds_read_b128 v[40:43], v20 offset:36864
    s_add_u32 m0, s29, 69120
    v_mfma_f32_16x16x32_bf16 v[84:87], a[180:183], v[48:51], v[84:87]
    buffer_load_dwordx4 v16, s[16:19], s34 offen offset:512 lds
    v_mfma_f32_16x16x32_bf16 v[88:91], a[176:179], v[52:55], v[88:91]
    ds_read_b128 v[44:47], v20 offset:53248
    v_mfma_f32_16x16x32_bf16 v[92:95], a[180:183], v[52:55], v[92:95]
    s_waitcnt lgkmcnt(4)
    v_mfma_f32_16x16x32_bf16 v[80:83], a[184:187], v[56:59], v[80:83]
    ds_read_b128 v[48:51], v19 offset:37888
    v_mfma_f32_16x16x32_bf16 v[84:87], a[188:191], v[56:59], v[84:87]
    v_mfma_f32_16x16x32_bf16 v[88:91], a[184:187], v[60:63], v[88:91]
    ds_read_b128 v[52:55], v19 offset:54272
    v_mfma_f32_16x16x32_bf16 v[92:95], a[188:191], v[60:63], v[92:95]
    s_waitcnt lgkmcnt(4)
    v_mfma_f32_16x16x32_bf16 v[80:83], a[192:195], v[32:35], v[80:83]
    ds_read_b128 v[56:59], v20 offset:37888
    s_add_u32 m0, s29, 70016
    v_mfma_f32_16x16x32_bf16 v[84:87], a[196:199], v[32:35], v[84:87]
    buffer_load_dwordx4 v16, s[16:19], s34 offen offset:640 lds
    v_mfma_f32_16x16x32_bf16 v[88:91], a[192:195], v[36:39], v[88:91]
    ds_read_b128 v[60:63], v20 offset:54272
    v_mfma_f32_16x16x32_bf16 v[92:95], a[196:199], v[36:39], v[92:95]
    s_waitcnt lgkmcnt(4)
    v_mfma_f32_16x16x32_bf16 v[80:83], a[200:203], v[40:43], v[80:83]
    ds_read_b128 v[32:35], v19 offset:38912
    v_mfma_f32_16x16x32_bf16 v[84:87], a[204:207], v[40:43], v[84:87]
    v_mfma_f32_16x16x32_bf16 v[88:91], a[200:203], v[44:47], v[88:91]
    ds_read_b128 v[36:39], v19 offset:55296
    v_mfma_f32_16x16x32_bf16 v[92:95], a[204:207], v[44:47], v[92:95]
    s_waitcnt lgkmcnt(4)
    v_mfma_f32_16x16x32_bf16 v[80:83], a[208:211], v[48:51], v[80:83]
    ds_read_b128 v[40:43], v20 offset:38912
    s_add_u32 m0, s29, 70912
    v_mfma_f32_16x16x32_bf16 v[84:87], a[212:215], v[48:51], v[84:87]
    buffer_load_dwordx4 v16, s[16:19], s34 offen offset:768 lds
    v_mfma_f32_16x16x32_bf16 v[88:91], a[208:211], v[52:55], v[88:91]
    ds_read_b128 v[44:47], v20 offset:55296
    v_mfma_f32_16x16x32_bf16 v[92:95], a[212:215], v[52:55], v[92:95]
    s_waitcnt lgkmcnt(4)
    v_mfma_f32_16x16x32_bf16 v[80:83], a[216:219], v[56:59], v[80:83]
    ds_read_b128 v[48:51], v19 offset:39936
    v_mfma_f32_16x16x32_bf16 v[84:87], a[220:223], v[56:59], v[84:87]
    s_cmp_lt_u32 s35, 21
    s_cselect_b64 s[44:45], -1, 0
    v_mfma_f32_16x16x32_bf16 v[88:91], a[216:219], v[60:63], v[88:91]
    ds_read_b128 v[52:55], v19 offset:56320
    v_mfma_f32_16x16x32_bf16 v[92:95], a[220:223], v[60:63], v[92:95]
    s_cselect_b32 s4, 0x10000, 0
    s_add_u32 s46, s46, s4
    s_waitcnt lgkmcnt(4)
    v_mfma_f32_16x16x32_bf16 v[80:83], a[224:227], v[32:35], v[80:83]
    ds_read_b128 v[56:59], v20 offset:39936
    s_add_u32 m0, s29, 71808
    v_mfma_f32_16x16x32_bf16 v[84:87], a[228:231], v[32:35], v[84:87]
    buffer_load_dwordx4 v16, s[16:19], s34 offen offset:896 lds
    v_mfma_f32_16x16x32_bf16 v[88:91], a[224:227], v[36:39], v[88:91]
    ds_read_b128 v[60:63], v20 offset:56320
    v_mfma_f32_16x16x32_bf16 v[92:95], a[228:231], v[36:39], v[92:95]
    s_waitcnt lgkmcnt(4)
    v_mfma_f32_16x16x32_bf16 v[80:83], a[232:235], v[40:43], v[80:83]
    s_add_u32 s34, s34, 1024
    v_mfma_f32_16x16x32_bf16 v[84:87], a[236:239], v[40:43], v[84:87]
    v_mfma_f32_16x16x32_bf16 v[88:91], a[232:235], v[44:47], v[88:91]
    v_mfma_f32_16x16x32_bf16 v[92:95], a[236:239], v[44:47], v[92:95]
    s_waitcnt lgkmcnt(0)
    s_waitcnt vmcnt(11)
    s_barrier
    ds_read_b128 v[32:35], v17 offset:0
    ds_read_b128 v[36:39], v17 offset:16384
    v_mfma_f32_16x16x32_bf16 v[80:83], a[240:243], v[48:51], v[80:83]
    ds_read_b128 v[40:43], v18 offset:0
    s_add_u32 m0, s29, 98304
    v_mfma_f32_16x16x32_bf16 v[84:87], a[244:247], v[48:51], v[84:87]
    buffer_load_dwordx4 v16, s[16:19], s34 offen offset:0 lds
    v_mfma_f32_16x16x32_bf16 v[88:91], a[240:243], v[52:55], v[88:91]
    ds_read_b128 v[44:47], v18 offset:16384
    v_mfma_f32_16x16x32_bf16 v[92:95], a[244:247], v[52:55], v[92:95]
    v_mfma_f32_16x16x32_bf16 v[80:83], a[248:251], v[56:59], v[80:83]
    ds_read_b128 v[48:51], v17 offset:1024
    v_mfma_f32_16x16x32_bf16 v[84:87], a[252:255], v[56:59], v[84:87]
    v_mfma_f32_16x16x32_bf16 v[88:91], a[248:251], v[60:63], v[88:91]
    ds_read_b128 v[52:55], v17 offset:17408
    v_mfma_f32_16x16x32_bf16 v[92:95], a[252:255], v[60:63], v[92:95]
    s_mov_b64 exec, s[36:37]
    buffer_store_dword v23, v22, s[8:11], s33 offen sc1
    s_mov_b64 exec, -1

    s_add_u32 s35, s35, 1
    s_cmp_lt_u32 s35, 32
    s_cbranch_scc1 .ql_361

    s_nop 7
    v_cvt_pk_bf16_f32 v96, v80, v81
    v_cvt_pk_bf16_f32 v97, v82, v83
    v_cvt_pk_bf16_f32 v98, v84, v85
    v_cvt_pk_bf16_f32 v99, v86, v87
    buffer_store_dwordx4 v[96:99], v21, s[8:11], s32 offen sc1
    v_cvt_pk_bf16_f32 v100, v88, v89
    v_cvt_pk_bf16_f32 v101, v90, v91
    v_cvt_pk_bf16_f32 v102, v92, v93
    v_cvt_pk_bf16_f32 v103, v94, v95
    buffer_store_dwordx4 v[100:103], v21, s[8:11], s38 offen sc1
    v_mov_b32 v23, 64
    s_waitcnt vmcnt(0) lgkmcnt(0)
    s_barrier
    s_mov_b64 exec, s[36:37]
    buffer_store_dword v23, v22, s[8:11], s33 offen sc1
    s_mov_b64 exec, -1

    s_branch .qd_360
.qv_359:
    s_waitcnt vmcnt(16)
    s_barrier
    ds_read_b128 v[32:35], v17 offset:0
    ds_read_b128 v[36:39], v17 offset:16384
    ds_read_b128 v[40:43], v18 offset:0
    ds_read_b128 v[44:47], v18 offset:16384
    s_add_u32 m0, s29, 98304
    s_nop 0
    buffer_load_dwordx4 v16, s[16:19], s34 offen offset:0 lds
    ds_read_b128 v[48:51], v17 offset:1024
    ds_read_b128 v[52:55], v17 offset:17408
    s_branch .qe_364
.p2align 6
.ql_363:
.qe_364:
    s_waitcnt lgkmcnt(4)
    v_mfma_f32_16x16x32_bf16 v[64:67], v[32:35], a[0:3], 0
    ds_read_b128 v[56:59], v18 offset:1024
    s_add_u32 m0, s29, 99200
    v_mfma_f32_16x16x32_bf16 v[68:71], v[32:35], a[4:7], 0
    buffer_load_dwordx4 v16, s[16:19], s34 offen offset:128 lds
    v_mfma_f32_16x16x32_bf16 v[72:75], v[36:39], a[0:3], 0
    ds_read_b128 v[60:63], v18 offset:17408
    v_mfma_f32_16x16x32_bf16 v[76:79], v[36:39], a[4:7], 0
    s_waitcnt lgkmcnt(4)
    v_mfma_f32_16x16x32_bf16 v[64:67], v[40:43], a[8:11], v[64:67]
    ds_read_b128 v[32:35], v17 offset:2048
    v_mfma_f32_16x16x32_bf16 v[68:71], v[40:43], a[12:15], v[68:71]
    v_cvt_pk_bf16_f32 v96, v80, v81
    v_cvt_pk_bf16_f32 v97, v82, v83
    v_mfma_f32_16x16x32_bf16 v[72:75], v[44:47], a[8:11], v[72:75]
    ds_read_b128 v[36:39], v17 offset:18432
    v_mfma_f32_16x16x32_bf16 v[76:79], v[44:47], a[12:15], v[76:79]
    v_cvt_pk_bf16_f32 v98, v88, v89
    v_cvt_pk_bf16_f32 v99, v90, v91
    s_waitcnt lgkmcnt(4)
    v_mfma_f32_16x16x32_bf16 v[64:67], v[48:51], a[16:19], v[64:67]
    ds_read_b128 v[40:43], v18 offset:2048
    s_add_u32 m0, s29, 100096
    v_mfma_f32_16x16x32_bf16 v[68:71], v[48:51], a[20:23], v[68:71]
    buffer_load_dwordx4 v16, s[16:19], s34 offen offset:256 lds
    v_mfma_f32_16x16x32_bf16 v[72:75], v[52:55], a[16:19], v[72:75]
    ds_read_b128 v[44:47], v18 offset:18432
    v_mfma_f32_16x16x32_bf16 v[76:79], v[52:55], a[20:23], v[76:79]
    s_waitcnt lgkmcnt(4)
    v_mfma_f32_16x16x32_bf16 v[64:67], v[56:59], a[24:27], v[64:67]
    ds_read_b128 v[48:51], v17 offset:3072
    v_mfma_f32_16x16x32_bf16 v[68:71], v[56:59], a[28:31], v[68:71]
    buffer_store_dwordx4 v[96:99], v21, s[8:11], s32 offen offset:0 sc1
    v_mfma_f32_16x16x32_bf16 v[72:75], v[60:63], a[24:27], v[72:75]
    ds_read_b128 v[52:55], v17 offset:19456
    v_mfma_f32_16x16x32_bf16 v[76:79], v[60:63], a[28:31], v[76:79]
    s_waitcnt lgkmcnt(4)
    v_mfma_f32_16x16x32_bf16 v[64:67], v[32:35], a[32:35], v[64:67]
    ds_read_b128 v[56:59], v18 offset:3072
    s_add_u32 m0, s29, 100992
    v_mfma_f32_16x16x32_bf16 v[68:71], v[32:35], a[36:39], v[68:71]
    buffer_load_dwordx4 v16, s[16:19], s34 offen offset:384 lds
    v_mfma_f32_16x16x32_bf16 v[72:75], v[36:39], a[32:35], v[72:75]
    ds_read_b128 v[60:63], v18 offset:19456
    v_mfma_f32_16x16x32_bf16 v[76:79], v[36:39], a[36:39], v[76:79]
    s_waitcnt lgkmcnt(4)
    v_mfma_f32_16x16x32_bf16 v[64:67], v[40:43], a[40:43], v[64:67]
    ds_read_b128 v[32:35], v17 offset:4096
    v_mfma_f32_16x16x32_bf16 v[68:71], v[40:43], a[44:47], v[68:71]
    v_cvt_pk_bf16_f32 v100, v84, v85
    v_cvt_pk_bf16_f32 v101, v86, v87
    v_mfma_f32_16x16x32_bf16 v[72:75], v[44:47], a[40:43], v[72:75]
    ds_read_b128 v[36:39], v17 offset:20480
    v_mfma_f32_16x16x32_bf16 v[76:79], v[44:47], a[44:47], v[76:79]
    v_cvt_pk_bf16_f32 v102, v92, v93
    v_cvt_pk_bf16_f32 v103, v94, v95
    s_waitcnt lgkmcnt(4)
    v_mfma_f32_16x16x32_bf16 v[64:67], v[48:51], a[48:51], v[64:67]
    ds_read_b128 v[40:43], v18 offset:4096
    s_add_u32 m0, s29, 101888
    v_mfma_f32_16x16x32_bf16 v[68:71], v[48:51], a[52:55], v[68:71]
    buffer_load_dwordx4 v16, s[16:19], s34 offen offset:512 lds
    v_mfma_f32_16x16x32_bf16 v[72:75], v[52:55], a[48:51], v[72:75]
    ds_read_b128 v[44:47], v18 offset:20480
    v_mfma_f32_16x16x32_bf16 v[76:79], v[52:55], a[52:55], v[76:79]
    s_waitcnt lgkmcnt(4)
    v_mfma_f32_16x16x32_bf16 v[64:67], v[56:59], a[56:59], v[64:67]
    ds_read_b128 v[48:51], v17 offset:5120
    v_mfma_f32_16x16x32_bf16 v[68:71], v[56:59], a[60:63], v[68:71]
    buffer_store_dwordx4 v[100:103], v21, s[8:11], s32 offen offset:1024 sc1
    v_mfma_f32_16x16x32_bf16 v[72:75], v[60:63], a[56:59], v[72:75]
    ds_read_b128 v[52:55], v17 offset:21504
    v_mfma_f32_16x16x32_bf16 v[76:79], v[60:63], a[60:63], v[76:79]
    s_waitcnt lgkmcnt(4)
    v_mfma_f32_16x16x32_bf16 v[64:67], v[32:35], a[64:67], v[64:67]
    ds_read_b128 v[56:59], v18 offset:5120
    s_add_u32 m0, s29, 102784
    v_mfma_f32_16x16x32_bf16 v[68:71], v[32:35], a[68:71], v[68:71]
    buffer_load_dwordx4 v16, s[16:19], s34 offen offset:640 lds
    v_mfma_f32_16x16x32_bf16 v[72:75], v[36:39], a[64:67], v[72:75]
    ds_read_b128 v[60:63], v18 offset:21504
    v_mfma_f32_16x16x32_bf16 v[76:79], v[36:39], a[68:71], v[76:79]
    s_waitcnt lgkmcnt(4)
    v_mfma_f32_16x16x32_bf16 v[64:67], v[40:43], a[72:75], v[64:67]
    ds_read_b128 v[32:35], v17 offset:6144
    v_mfma_f32_16x16x32_bf16 v[68:71], v[40:43], a[76:79], v[68:71]
    s_mov_b32 s32, s39
    s_add_u32 s38, s39, 4096
    s_add_u32 s39, s39, 262144
    v_mfma_f32_16x16x32_bf16 v[72:75], v[44:47], a[72:75], v[72:75]
    ds_read_b128 v[36:39], v17 offset:22528
    v_mfma_f32_16x16x32_bf16 v[76:79], v[44:47], a[76:79], v[76:79]
    v_add_u32 v23, 1, v23
    s_waitcnt lgkmcnt(4)
    v_mfma_f32_16x16x32_bf16 v[64:67], v[48:51], a[80:83], v[64:67]
    ds_read_b128 v[40:43], v18 offset:6144
    s_add_u32 m0, s29, 103680
    v_mfma_f32_16x16x32_bf16 v[68:71], v[48:51], a[84:87], v[68:71]
    buffer_load_dwordx4 v16, s[16:19], s34 offen offset:768 lds
    v_mfma_f32_16x16x32_bf16 v[72:75], v[52:55], a[80:83], v[72:75]
    ds_read_b128 v[44:47], v18 offset:22528
    v_mfma_f32_16x16x32_bf16 v[76:79], v[52:55], a[84:87], v[76:79]
    s_waitcnt lgkmcnt(4)
    v_mfma_f32_16x16x32_bf16 v[64:67], v[56:59], a[88:91], v[64:67]
    ds_read_b128 v[48:51], v17 offset:7168
    v_mfma_f32_16x16x32_bf16 v[68:71], v[56:59], a[92:95], v[68:71]
    v_mfma_f32_16x16x32_bf16 v[72:75], v[60:63], a[88:91], v[72:75]
    ds_read_b128 v[52:55], v17 offset:23552
    v_mfma_f32_16x16x32_bf16 v[76:79], v[60:63], a[92:95], v[76:79]
    s_mov_b64 exec, s[44:45]
    buffer_store_dwordx4 v[24:27], v28, s[8:11], s46 offen sc1
    s_mov_b64 exec, -1
    s_waitcnt lgkmcnt(4)
    v_mfma_f32_16x16x32_bf16 v[64:67], v[32:35], a[96:99], v[64:67]
    ds_read_b128 v[56:59], v18 offset:7168
    s_add_u32 m0, s29, 104576
    v_mfma_f32_16x16x32_bf16 v[68:71], v[32:35], a[100:103], v[68:71]
    buffer_load_dwordx4 v16, s[16:19], s34 offen offset:896 lds
    v_mfma_f32_16x16x32_bf16 v[72:75], v[36:39], a[96:99], v[72:75]
    ds_read_b128 v[60:63], v18 offset:23552
    v_mfma_f32_16x16x32_bf16 v[76:79], v[36:39], a[100:103], v[76:79]
    s_waitcnt lgkmcnt(4)
    v_mfma_f32_16x16x32_bf16 v[64:67], v[40:43], a[104:107], v[64:67]
    s_add_u32 s34, s34, 64512
    s_min_u32 s34, s34, 4128768
    v_mfma_f32_16x16x32_bf16 v[68:71], v[40:43], a[108:111], v[68:71]
    v_mfma_f32_16x16x32_bf16 v[72:75], v[44:47], a[104:107], v[72:75]
    v_mfma_f32_16x16x32_bf16 v[76:79], v[44:47], a[108:111], v[76:79]
    s_waitcnt lgkmcnt(0)
    s_waitcnt vmcnt(18)
    s_barrier
    ds_read_b128 v[32:35], v17 offset:32768
    ds_read_b128 v[36:39], v17 offset:49152
    v_mfma_f32_16x16x32_bf16 v[64:67], v[48:51], a[112:115], v[64:67]
    ds_read_b128 v[40:43], v18 offset:32768
    s_add_u32 m0, s29, 0
    v_mfma_f32_16x16x32_bf16 v[68:71], v[48:51], a[116:119], v[68:71]
    buffer_load_dwordx4 v16, s[16:19], s34 offen offset:0 lds
    v_mfma_f32_16x16x32_bf16 v[72:75], v[52:55], a[112:115], v[72:75]
    ds_read_b128 v[44:47], v18 offset:49152
    v_mfma_f32_16x16x32_bf16 v[76:79], v[52:55], a[116:119], v[76:79]
    v_mfma_f32_16x16x32_bf16 v[64:67], v[56:59], a[120:123], v[64:67]
    ds_read_b128 v[48:51], v17 offset:33792
    v_mfma_f32_16x16x32_bf16 v[68:71], v[56:59], a[124:127], v[68:71]
    v_mfma_f32_16x16x32_bf16 v[72:75], v[60:63], a[120:123], v[72:75]
    ds_read_b128 v[52:55], v17 offset:50176
    v_mfma_f32_16x16x32_bf16 v[76:79], v[60:63], a[124:127], v[76:79]
    s_waitcnt lgkmcnt(4)
    v_mfma_f32_16x16x32_bf16 v[64:67], v[32:35], a[128:131], v[64:67]
    ds_read_b128 v[56:59], v18 offset:33792
    s_add_u32 m0, s29, 896
    v_mfma_f32_16x16x32_bf16 v[68:71], v[32:35], a[132:135], v[68:71]
    buffer_load_dwordx4 v16, s[16:19], s34 offen offset:128 lds
    v_mfma_f32_16x16x32_bf16 v[72:75], v[36:39], a[128:131], v[72:75]
    ds_read_b128 v[60:63], v18 offset:50176
    v_mfma_f32_16x16x32_bf16 v[76:79], v[36:39], a[132:135], v[76:79]
    s_waitcnt lgkmcnt(4)
    v_mfma_f32_16x16x32_bf16 v[64:67], v[40:43], a[136:139], v[64:67]
    ds_read_b128 v[32:35], v17 offset:34816
    v_mfma_f32_16x16x32_bf16 v[68:71], v[40:43], a[140:143], v[68:71]
    v_mfma_f32_16x16x32_bf16 v[72:75], v[44:47], a[136:139], v[72:75]
    ds_read_b128 v[36:39], v17 offset:51200
    v_mfma_f32_16x16x32_bf16 v[76:79], v[44:47], a[140:143], v[76:79]
    s_waitcnt lgkmcnt(4)
    v_mfma_f32_16x16x32_bf16 v[64:67], v[48:51], a[144:147], v[64:67]
    ds_read_b128 v[40:43], v18 offset:34816
    s_add_u32 m0, s29, 1792
    v_mfma_f32_16x16x32_bf16 v[68:71], v[48:51], a[148:151], v[68:71]
    buffer_load_dwordx4 v16, s[16:19], s34 offen offset:256 lds
    v_mfma_f32_16x16x32_bf16 v[72:75], v[52:55], a[144:147], v[72:75]
    ds_read_b128 v[44:47], v18 offset:51200
    v_mfma_f32_16x16x32_bf16 v[76:79], v[52:55], a[148:151], v[76:79]
    s_waitcnt lgkmcnt(4)
    v_mfma_f32_16x16x32_bf16 v[64:67], v[56:59], a[152:155], v[64:67]
    ds_read_b128 v[48:51], v17 offset:35840
    v_mfma_f32_16x16x32_bf16 v[68:71], v[56:59], a[156:159], v[68:71]
    v_mfma_f32_16x16x32_bf16 v[72:75], v[60:63], a[152:155], v[72:75]
    ds_read_b128 v[52:55], v17 offset:52224
    v_mfma_f32_16x16x32_bf16 v[76:79], v[60:63], a[156:159], v[76:79]
    s_waitcnt lgkmcnt(4)
    v_mfma_f32_16x16x32_bf16 v[64:67], v[32:35], a[160:163], v[64:67]
    ds_read_b128 v[56:59], v18 offset:35840
    s_add_u32 m0, s29, 2688
    v_mfma_f32_16x16x32_bf16 v[68:71], v[32:35], a[164:167], v[68:71]
    buffer_load_dwordx4 v16, s[16:19], s34 offen offset:384 lds
    v_mfma_f32_16x16x32_bf16 v[72:75], v[36:39], a[160:163], v[72:75]
    ds_read_b128 v[60:63], v18 offset:52224
    v_mfma_f32_16x16x32_bf16 v[76:79], v[36:39], a[164:167], v[76:79]
    s_waitcnt lgkmcnt(4)
    v_mfma_f32_16x16x32_bf16 v[64:67], v[40:43], a[168:171], v[64:67]
    ds_read_b128 v[32:35], v17 offset:36864
    v_mfma_f32_16x16x32_bf16 v[68:71], v[40:43], a[172:175], v[68:71]
    v_mfma_f32_16x16x32_bf16 v[72:75], v[44:47], a[168:171], v[72:75]
    ds_read_b128 v[36:39], v17 offset:53248
    v_mfma_f32_16x16x32_bf16 v[76:79], v[44:47], a[172:175], v[76:79]
    s_waitcnt lgkmcnt(4)
    v_mfma_f32_16x16x32_bf16 v[64:67], v[48:51], a[176:179], v[64:67]
    ds_read_b128 v[40:43], v18 offset:36864
    s_add_u32 m0, s29, 3584
    v_mfma_f32_16x16x32_bf16 v[68:71], v[48:51], a[180:183], v[68:71]
    buffer_load_dwordx4 v16, s[16:19], s34 offen offset:512 lds
    v_mfma_f32_16x16x32_bf16 v[72:75], v[52:55], a[176:179], v[72:75]
    ds_read_b128 v[44:47], v18 offset:53248
    v_mfma_f32_16x16x32_bf16 v[76:79], v[52:55], a[180:183], v[76:79]
    s_waitcnt lgkmcnt(4)
    v_mfma_f32_16x16x32_bf16 v[64:67], v[56:59], a[184:187], v[64:67]
    ds_read_b128 v[48:51], v17 offset:37888
    v_mfma_f32_16x16x32_bf16 v[68:71], v[56:59], a[188:191], v[68:71]
    v_mfma_f32_16x16x32_bf16 v[72:75], v[60:63], a[184:187], v[72:75]
    ds_read_b128 v[52:55], v17 offset:54272
    v_mfma_f32_16x16x32_bf16 v[76:79], v[60:63], a[188:191], v[76:79]
    s_waitcnt lgkmcnt(4)
    v_mfma_f32_16x16x32_bf16 v[64:67], v[32:35], a[192:195], v[64:67]
    ds_read_b128 v[56:59], v18 offset:37888
    s_add_u32 m0, s29, 4480
    v_mfma_f32_16x16x32_bf16 v[68:71], v[32:35], a[196:199], v[68:71]
    buffer_load_dwordx4 v16, s[16:19], s34 offen offset:640 lds
    v_mfma_f32_16x16x32_bf16 v[72:75], v[36:39], a[192:195], v[72:75]
    ds_read_b128 v[60:63], v18 offset:54272
    v_mfma_f32_16x16x32_bf16 v[76:79], v[36:39], a[196:199], v[76:79]
    s_waitcnt lgkmcnt(4)
    v_mfma_f32_16x16x32_bf16 v[64:67], v[40:43], a[200:203], v[64:67]
    ds_read_b128 v[32:35], v17 offset:38912
    v_mfma_f32_16x16x32_bf16 v[68:71], v[40:43], a[204:207], v[68:71]
    v_mfma_f32_16x16x32_bf16 v[72:75], v[44:47], a[200:203], v[72:75]
    ds_read_b128 v[36:39], v17 offset:55296
    v_mfma_f32_16x16x32_bf16 v[76:79], v[44:47], a[204:207], v[76:79]
    s_waitcnt lgkmcnt(4)
    v_mfma_f32_16x16x32_bf16 v[64:67], v[48:51], a[208:211], v[64:67]
    ds_read_b128 v[40:43], v18 offset:38912
    s_add_u32 m0, s29, 5376
    v_mfma_f32_16x16x32_bf16 v[68:71], v[48:51], a[212:215], v[68:71]
    buffer_load_dwordx4 v16, s[16:19], s34 offen offset:768 lds
    v_mfma_f32_16x16x32_bf16 v[72:75], v[52:55], a[208:211], v[72:75]
    ds_read_b128 v[44:47], v18 offset:55296
    v_mfma_f32_16x16x32_bf16 v[76:79], v[52:55], a[212:215], v[76:79]
    s_waitcnt lgkmcnt(4)
    v_mfma_f32_16x16x32_bf16 v[64:67], v[56:59], a[216:219], v[64:67]
    ds_read_b128 v[48:51], v17 offset:39936
    v_mfma_f32_16x16x32_bf16 v[68:71], v[56:59], a[220:223], v[68:71]
    v_mfma_f32_16x16x32_bf16 v[72:75], v[60:63], a[216:219], v[72:75]
    ds_read_b128 v[52:55], v17 offset:56320
    v_mfma_f32_16x16x32_bf16 v[76:79], v[60:63], a[220:223], v[76:79]
    s_mov_b64 exec, s[44:45]
    buffer_store_dwordx4 v[24:27], v29, s[8:11], s46 offen sc1
    s_mov_b64 exec, -1
    s_waitcnt lgkmcnt(4)
    v_mfma_f32_16x16x32_bf16 v[64:67], v[32:35], a[224:227], v[64:67]
    ds_read_b128 v[56:59], v18 offset:39936
    s_add_u32 m0, s29, 6272
    v_mfma_f32_16x16x32_bf16 v[68:71], v[32:35], a[228:231], v[68:71]
    buffer_load_dwordx4 v16, s[16:19], s34 offen offset:896 lds
    v_mfma_f32_16x16x32_bf16 v[72:75], v[36:39], a[224:227], v[72:75]
    ds_read_b128 v[60:63], v18 offset:56320
    v_mfma_f32_16x16x32_bf16 v[76:79], v[36:39], a[228:231], v[76:79]
    s_waitcnt lgkmcnt(4)
    v_mfma_f32_16x16x32_bf16 v[64:67], v[40:43], a[232:235], v[64:67]
    s_add_u32 s34, s34, 1024
    v_mfma_f32_16x16x32_bf16 v[68:71], v[40:43], a[236:239], v[68:71]
    v_mfma_f32_16x16x32_bf16 v[72:75], v[44:47], a[232:235], v[72:75]
    v_mfma_f32_16x16x32_bf16 v[76:79], v[44:47], a[236:239], v[76:79]
    s_waitcnt lgkmcnt(0)
    s_waitcnt vmcnt(11)
    s_barrier
    ds_read_b128 v[32:35], v19 offset:0
    ds_read_b128 v[36:39], v19 offset:16384
    v_mfma_f32_16x16x32_bf16 v[64:67], v[48:51], a[240:243], v[64:67]
    ds_read_b128 v[40:43], v20 offset:0
    s_add_u32 m0, s29, 32768
    v_mfma_f32_16x16x32_bf16 v[68:71], v[48:51], a[244:247], v[68:71]
    buffer_load_dwordx4 v16, s[16:19], s34 offen offset:0 lds
    v_mfma_f32_16x16x32_bf16 v[72:75], v[52:55], a[240:243], v[72:75]
    ds_read_b128 v[44:47], v20 offset:16384
    v_mfma_f32_16x16x32_bf16 v[76:79], v[52:55], a[244:247], v[76:79]
    v_mfma_f32_16x16x32_bf16 v[64:67], v[56:59], a[248:251], v[64:67]
    ds_read_b128 v[48:51], v19 offset:1024
    v_mfma_f32_16x16x32_bf16 v[68:71], v[56:59], a[252:255], v[68:71]
    v_mfma_f32_16x16x32_bf16 v[72:75], v[60:63], a[248:251], v[72:75]
    ds_read_b128 v[52:55], v19 offset:17408
    v_mfma_f32_16x16x32_bf16 v[76:79], v[60:63], a[252:255], v[76:79]
    s_mov_b64 exec, s[36:37]
    buffer_store_dword v23, v22, s[8:11], s33 offen sc1
    s_mov_b64 exec, -1

    s_waitcnt lgkmcnt(4)
    v_mfma_f32_16x16x32_bf16 v[80:83], v[32:35], a[0:3], 0
    ds_read_b128 v[56:59], v20 offset:1024
    s_add_u32 m0, s29, 33664
    v_mfma_f32_16x16x32_bf16 v[84:87], v[32:35], a[4:7], 0
    buffer_load_dwordx4 v16, s[16:19], s34 offen offset:128 lds
    v_mfma_f32_16x16x32_bf16 v[88:91], v[36:39], a[0:3], 0
    ds_read_b128 v[60:63], v20 offset:17408
    v_mfma_f32_16x16x32_bf16 v[92:95], v[36:39], a[4:7], 0
    s_waitcnt lgkmcnt(4)
    v_mfma_f32_16x16x32_bf16 v[80:83], v[40:43], a[8:11], v[80:83]
    ds_read_b128 v[32:35], v19 offset:2048
    v_mfma_f32_16x16x32_bf16 v[84:87], v[40:43], a[12:15], v[84:87]
    v_cvt_pk_bf16_f32 v96, v64, v65
    v_cvt_pk_bf16_f32 v97, v66, v67
    v_mfma_f32_16x16x32_bf16 v[88:91], v[44:47], a[8:11], v[88:91]
    ds_read_b128 v[36:39], v19 offset:18432
    v_mfma_f32_16x16x32_bf16 v[92:95], v[44:47], a[12:15], v[92:95]
    v_cvt_pk_bf16_f32 v98, v72, v73
    v_cvt_pk_bf16_f32 v99, v74, v75
    s_waitcnt lgkmcnt(4)
    v_mfma_f32_16x16x32_bf16 v[80:83], v[48:51], a[16:19], v[80:83]
    ds_read_b128 v[40:43], v20 offset:2048
    s_add_u32 m0, s29, 34560
    v_mfma_f32_16x16x32_bf16 v[84:87], v[48:51], a[20:23], v[84:87]
    buffer_load_dwordx4 v16, s[16:19], s34 offen offset:256 lds
    v_mfma_f32_16x16x32_bf16 v[88:91], v[52:55], a[16:19], v[88:91]
    ds_read_b128 v[44:47], v20 offset:18432
    v_mfma_f32_16x16x32_bf16 v[92:95], v[52:55], a[20:23], v[92:95]
    s_waitcnt lgkmcnt(4)
    v_mfma_f32_16x16x32_bf16 v[80:83], v[56:59], a[24:27], v[80:83]
    ds_read_b128 v[48:51], v19 offset:3072
    v_mfma_f32_16x16x32_bf16 v[84:87], v[56:59], a[28:31], v[84:87]
    buffer_store_dwordx4 v[96:99], v21, s[8:11], s32 offen offset:0 sc1
    v_mfma_f32_16x16x32_bf16 v[88:91], v[60:63], a[24:27], v[88:91]
    ds_read_b128 v[52:55], v19 offset:19456
    v_mfma_f32_16x16x32_bf16 v[92:95], v[60:63], a[28:31], v[92:95]
    s_waitcnt lgkmcnt(4)
    v_mfma_f32_16x16x32_bf16 v[80:83], v[32:35], a[32:35], v[80:83]
    ds_read_b128 v[56:59], v20 offset:3072
    s_add_u32 m0, s29, 35456
    v_mfma_f32_16x16x32_bf16 v[84:87], v[32:35], a[36:39], v[84:87]
    buffer_load_dwordx4 v16, s[16:19], s34 offen offset:384 lds
    v_mfma_f32_16x16x32_bf16 v[88:91], v[36:39], a[32:35], v[88:91]
    ds_read_b128 v[60:63], v20 offset:19456
    v_mfma_f32_16x16x32_bf16 v[92:95], v[36:39], a[36:39], v[92:95]
    s_waitcnt lgkmcnt(4)
    v_mfma_f32_16x16x32_bf16 v[80:83], v[40:43], a[40:43], v[80:83]
    ds_read_b128 v[32:35], v19 offset:4096
    v_mfma_f32_16x16x32_bf16 v[84:87], v[40:43], a[44:47], v[84:87]
    v_cvt_pk_bf16_f32 v100, v68, v69
    v_cvt_pk_bf16_f32 v101, v70, v71
    v_mfma_f32_16x16x32_bf16 v[88:91], v[44:47], a[40:43], v[88:91]
    ds_read_b128 v[36:39], v19 offset:20480
    v_mfma_f32_16x16x32_bf16 v[92:95], v[44:47], a[44:47], v[92:95]
    v_cvt_pk_bf16_f32 v102, v76, v77
    v_cvt_pk_bf16_f32 v103, v78, v79
    s_waitcnt lgkmcnt(4)
    v_mfma_f32_16x16x32_bf16 v[80:83], v[48:51], a[48:51], v[80:83]
    ds_read_b128 v[40:43], v20 offset:4096
    s_add_u32 m0, s29, 36352
    v_mfma_f32_16x16x32_bf16 v[84:87], v[48:51], a[52:55], v[84:87]
    buffer_load_dwordx4 v16, s[16:19], s34 offen offset:512 lds
    v_mfma_f32_16x16x32_bf16 v[88:91], v[52:55], a[48:51], v[88:91]
    ds_read_b128 v[44:47], v20 offset:20480
    v_mfma_f32_16x16x32_bf16 v[92:95], v[52:55], a[52:55], v[92:95]
    s_waitcnt lgkmcnt(4)
    v_mfma_f32_16x16x32_bf16 v[80:83], v[56:59], a[56:59], v[80:83]
    ds_read_b128 v[48:51], v19 offset:5120
    v_mfma_f32_16x16x32_bf16 v[84:87], v[56:59], a[60:63], v[84:87]
    buffer_store_dwordx4 v[100:103], v21, s[8:11], s32 offen offset:1024 sc1
    v_mfma_f32_16x16x32_bf16 v[88:91], v[60:63], a[56:59], v[88:91]
    ds_read_b128 v[52:55], v19 offset:21504
    v_mfma_f32_16x16x32_bf16 v[92:95], v[60:63], a[60:63], v[92:95]
    s_waitcnt lgkmcnt(4)
    v_mfma_f32_16x16x32_bf16 v[80:83], v[32:35], a[64:67], v[80:83]
    ds_read_b128 v[56:59], v20 offset:5120
    s_add_u32 m0, s29, 37248
    v_mfma_f32_16x16x32_bf16 v[84:87], v[32:35], a[68:71], v[84:87]
    buffer_load_dwordx4 v16, s[16:19], s34 offen offset:640 lds
    v_mfma_f32_16x16x32_bf16 v[88:91], v[36:39], a[64:67], v[88:91]
    ds_read_b128 v[60:63], v20 offset:21504
    v_mfma_f32_16x16x32_bf16 v[92:95], v[36:39], a[68:71], v[92:95]
    s_waitcnt lgkmcnt(4)
    v_mfma_f32_16x16x32_bf16 v[80:83], v[40:43], a[72:75], v[80:83]
    ds_read_b128 v[32:35], v19 offset:6144
    v_mfma_f32_16x16x32_bf16 v[84:87], v[40:43], a[76:79], v[84:87]
    s_mov_b32 s32, s39
    s_add_u32 s38, s39, 4096
    s_add_u32 s39, s39, 262144
    v_mfma_f32_16x16x32_bf16 v[88:91], v[44:47], a[72:75], v[88:91]
    ds_read_b128 v[36:39], v19 offset:22528
    v_mfma_f32_16x16x32_bf16 v[92:95], v[44:47], a[76:79], v[92:95]
    v_add_u32 v23, 1, v23
    s_waitcnt lgkmcnt(4)
    v_mfma_f32_16x16x32_bf16 v[80:83], v[48:51], a[80:83], v[80:83]
    ds_read_b128 v[40:43], v20 offset:6144
    s_add_u32 m0, s29, 38144
    v_mfma_f32_16x16x32_bf16 v[84:87], v[48:51], a[84:87], v[84:87]
    buffer_load_dwordx4 v16, s[16:19], s34 offen offset:768 lds
    v_mfma_f32_16x16x32_bf16 v[88:91], v[52:55], a[80:83], v[88:91]
    ds_read_b128 v[44:47], v20 offset:22528
    v_mfma_f32_16x16x32_bf16 v[92:95], v[52:55], a[84:87], v[92:95]
    s_waitcnt lgkmcnt(4)
    v_mfma_f32_16x16x32_bf16 v[80:83], v[56:59], a[88:91], v[80:83]
    ds_read_b128 v[48:51], v19 offset:7168
    v_mfma_f32_16x16x32_bf16 v[84:87], v[56:59], a[92:95], v[84:87]
    v_mfma_f32_16x16x32_bf16 v[88:91], v[60:63], a[88:91], v[88:91]
    ds_read_b128 v[52:55], v19 offset:23552
    v_mfma_f32_16x16x32_bf16 v[92:95], v[60:63], a[92:95], v[92:95]
    s_mov_b64 exec, s[44:45]
    buffer_store_dwordx4 v[24:27], v30, s[8:11], s46 offen sc1
    s_mov_b64 exec, -1
    s_waitcnt lgkmcnt(4)
    v_mfma_f32_16x16x32_bf16 v[80:83], v[32:35], a[96:99], v[80:83]
    ds_read_b128 v[56:59], v20 offset:7168
    s_add_u32 m0, s29, 39040
    v_mfma_f32_16x16x32_bf16 v[84:87], v[32:35], a[100:103], v[84:87]
    buffer_load_dwordx4 v16, s[16:19], s34 offen offset:896 lds
    v_mfma_f32_16x16x32_bf16 v[88:91], v[36:39], a[96:99], v[88:91]
    ds_read_b128 v[60:63], v20 offset:23552
    v_mfma_f32_16x16x32_bf16 v[92:95], v[36:39], a[100:103], v[92:95]
    s_waitcnt lgkmcnt(4)
    v_mfma_f32_16x16x32_bf16 v[80:83], v[40:43], a[104:107], v[80:83]
    s_add_u32 s34, s34, 64512
    s_min_u32 s34, s34, 4128768
    v_mfma_f32_16x16x32_bf16 v[84:87], v[40:43], a[108:111], v[84:87]
    v_mfma_f32_16x16x32_bf16 v[88:91], v[44:47], a[104:107], v[88:91]
    v_mfma_f32_16x16x32_bf16 v[92:95], v[44:47], a[108:111], v[92:95]
    s_waitcnt lgkmcnt(0)
    s_waitcnt vmcnt(18)
    s_barrier
    ds_read_b128 v[32:35], v19 offset:32768
    ds_read_b128 v[36:39], v19 offset:49152
    v_mfma_f32_16x16x32_bf16 v[80:83], v[48:51], a[112:115], v[80:83]
    ds_read_b128 v[40:43], v20 offset:32768
    s_add_u32 m0, s29, 65536
    v_mfma_f32_16x16x32_bf16 v[84:87], v[48:51], a[116:119], v[84:87]
    buffer_load_dwordx4 v16, s[16:19], s34 offen offset:0 lds
    v_mfma_f32_16x16x32_bf16 v[88:91], v[52:55], a[112:115], v[88:91]
    ds_read_b128 v[44:47], v20 offset:49152
    v_mfma_f32_16x16x32_bf16 v[92:95], v[52:55], a[116:119], v[92:95]
    v_mfma_f32_16x16x32_bf16 v[80:83], v[56:59], a[120:123], v[80:83]
    ds_read_b128 v[48:51], v19 offset:33792
    v_mfma_f32_16x16x32_bf16 v[84:87], v[56:59], a[124:127], v[84:87]
    v_mfma_f32_16x16x32_bf16 v[88:91], v[60:63], a[120:123], v[88:91]
    ds_read_b128 v[52:55], v19 offset:50176
    v_mfma_f32_16x16x32_bf16 v[92:95], v[60:63], a[124:127], v[92:95]
    s_waitcnt lgkmcnt(4)
    v_mfma_f32_16x16x32_bf16 v[80:83], v[32:35], a[128:131], v[80:83]
    ds_read_b128 v[56:59], v20 offset:33792
    s_add_u32 m0, s29, 66432
    v_mfma_f32_16x16x32_bf16 v[84:87], v[32:35], a[132:135], v[84:87]
    buffer_load_dwordx4 v16, s[16:19], s34 offen offset:128 lds
    v_mfma_f32_16x16x32_bf16 v[88:91], v[36:39], a[128:131], v[88:91]
    ds_read_b128 v[60:63], v20 offset:50176
    v_mfma_f32_16x16x32_bf16 v[92:95], v[36:39], a[132:135], v[92:95]
    s_waitcnt lgkmcnt(4)
    v_mfma_f32_16x16x32_bf16 v[80:83], v[40:43], a[136:139], v[80:83]
    ds_read_b128 v[32:35], v19 offset:34816
    v_mfma_f32_16x16x32_bf16 v[84:87], v[40:43], a[140:143], v[84:87]
    v_mfma_f32_16x16x32_bf16 v[88:91], v[44:47], a[136:139], v[88:91]
    ds_read_b128 v[36:39], v19 offset:51200
    v_mfma_f32_16x16x32_bf16 v[92:95], v[44:47], a[140:143], v[92:95]
    s_waitcnt lgkmcnt(4)
    v_mfma_f32_16x16x32_bf16 v[80:83], v[48:51], a[144:147], v[80:83]
    ds_read_b128 v[40:43], v20 offset:34816
    s_add_u32 m0, s29, 67328
    v_mfma_f32_16x16x32_bf16 v[84:87], v[48:51], a[148:151], v[84:87]
    buffer_load_dwordx4 v16, s[16:19], s34 offen offset:256 lds
    v_mfma_f32_16x16x32_bf16 v[88:91], v[52:55], a[144:147], v[88:91]
    ds_read_b128 v[44:47], v20 offset:51200
    v_mfma_f32_16x16x32_bf16 v[92:95], v[52:55], a[148:151], v[92:95]
    s_waitcnt lgkmcnt(4)
    v_mfma_f32_16x16x32_bf16 v[80:83], v[56:59], a[152:155], v[80:83]
    ds_read_b128 v[48:51], v19 offset:35840
    v_mfma_f32_16x16x32_bf16 v[84:87], v[56:59], a[156:159], v[84:87]
    v_mfma_f32_16x16x32_bf16 v[88:91], v[60:63], a[152:155], v[88:91]
    ds_read_b128 v[52:55], v19 offset:52224
    v_mfma_f32_16x16x32_bf16 v[92:95], v[60:63], a[156:159], v[92:95]
    s_waitcnt lgkmcnt(4)
    v_mfma_f32_16x16x32_bf16 v[80:83], v[32:35], a[160:163], v[80:83]
    ds_read_b128 v[56:59], v20 offset:35840
    s_add_u32 m0, s29, 68224
    v_mfma_f32_16x16x32_bf16 v[84:87], v[32:35], a[164:167], v[84:87]
    buffer_load_dwordx4 v16, s[16:19], s34 offen offset:384 lds
    v_mfma_f32_16x16x32_bf16 v[88:91], v[36:39], a[160:163], v[88:91]
    ds_read_b128 v[60:63], v20 offset:52224
    v_mfma_f32_16x16x32_bf16 v[92:95], v[36:39], a[164:167], v[92:95]
    s_waitcnt lgkmcnt(4)
    v_mfma_f32_16x16x32_bf16 v[80:83], v[40:43], a[168:171], v[80:83]
    ds_read_b128 v[32:35], v19 offset:36864
    v_mfma_f32_16x16x32_bf16 v[84:87], v[40:43], a[172:175], v[84:87]
    v_mfma_f32_16x16x32_bf16 v[88:91], v[44:47], a[168:171], v[88:91]
    ds_read_b128 v[36:39], v19 offset:53248
    v_mfma_f32_16x16x32_bf16 v[92:95], v[44:47], a[172:175], v[92:95]
    s_waitcnt lgkmcnt(4)
    v_mfma_f32_16x16x32_bf16 v[80:83], v[48:51], a[176:179], v[80:83]
    ds_read_b128 v[40:43], v20 offset:36864
    s_add_u32 m0, s29, 69120
    v_mfma_f32_16x16x32_bf16 v[84:87], v[48:51], a[180:183], v[84:87]
    buffer_load_dwordx4 v16, s[16:19], s34 offen offset:512 lds
    v_mfma_f32_16x16x32_bf16 v[88:91], v[52:55], a[176:179], v[88:91]
    ds_read_b128 v[44:47], v20 offset:53248
    v_mfma_f32_16x16x32_bf16 v[92:95], v[52:55], a[180:183], v[92:95]
    s_waitcnt lgkmcnt(4)
    v_mfma_f32_16x16x32_bf16 v[80:83], v[56:59], a[184:187], v[80:83]
    ds_read_b128 v[48:51], v19 offset:37888
    v_mfma_f32_16x16x32_bf16 v[84:87], v[56:59], a[188:191], v[84:87]
    v_mfma_f32_16x16x32_bf16 v[88:91], v[60:63], a[184:187], v[88:91]
    ds_read_b128 v[52:55], v19 offset:54272
    v_mfma_f32_16x16x32_bf16 v[92:95], v[60:63], a[188:191], v[92:95]
    s_waitcnt lgkmcnt(4)
    v_mfma_f32_16x16x32_bf16 v[80:83], v[32:35], a[192:195], v[80:83]
    ds_read_b128 v[56:59], v20 offset:37888
    s_add_u32 m0, s29, 70016
    v_mfma_f32_16x16x32_bf16 v[84:87], v[32:35], a[196:199], v[84:87]
    buffer_load_dwordx4 v16, s[16:19], s34 offen offset:640 lds
    v_mfma_f32_16x16x32_bf16 v[88:91], v[36:39], a[192:195], v[88:91]
    ds_read_b128 v[60:63], v20 offset:54272
    v_mfma_f32_16x16x32_bf16 v[92:95], v[36:39], a[196:199], v[92:95]
    s_waitcnt lgkmcnt(4)
    v_mfma_f32_16x16x32_bf16 v[80:83], v[40:43], a[200:203], v[80:83]
    ds_read_b128 v[32:35], v19 offset:38912
    v_mfma_f32_16x16x32_bf16 v[84:87], v[40:43], a[204:207], v[84:87]
    v_mfma_f32_16x16x32_bf16 v[88:91], v[44:47], a[200:203], v[88:91]
    ds_read_b128 v[36:39], v19 offset:55296
    v_mfma_f32_16x16x32_bf16 v[92:95], v[44:47], a[204:207], v[92:95]
    s_waitcnt lgkmcnt(4)
    v_mfma_f32_16x16x32_bf16 v[80:83], v[48:51], a[208:211], v[80:83]
    ds_read_b128 v[40:43], v20 offset:38912
    s_add_u32 m0, s29, 70912
    v_mfma_f32_16x16x32_bf16 v[84:87], v[48:51], a[212:215], v[84:87]
    buffer_load_dwordx4 v16, s[16:19], s34 offen offset:768 lds
    v_mfma_f32_16x16x32_bf16 v[88:91], v[52:55], a[208:211], v[88:91]
    ds_read_b128 v[44:47], v20 offset:55296
    v_mfma_f32_16x16x32_bf16 v[92:95], v[52:55], a[212:215], v[92:95]
    s_waitcnt lgkmcnt(4)
    v_mfma_f32_16x16x32_bf16 v[80:83], v[56:59], a[216:219], v[80:83]
    ds_read_b128 v[48:51], v19 offset:39936
    v_mfma_f32_16x16x32_bf16 v[84:87], v[56:59], a[220:223], v[84:87]
    s_cmp_lt_u32 s35, 21
    s_cselect_b64 s[44:45], -1, 0
    v_mfma_f32_16x16x32_bf16 v[88:91], v[60:63], a[216:219], v[88:91]
    ds_read_b128 v[52:55], v19 offset:56320
    v_mfma_f32_16x16x32_bf16 v[92:95], v[60:63], a[220:223], v[92:95]
    s_cselect_b32 s4, 0x10000, 0
    s_add_u32 s46, s46, s4
    s_waitcnt lgkmcnt(4)
    v_mfma_f32_16x16x32_bf16 v[80:83], v[32:35], a[224:227], v[80:83]
    ds_read_b128 v[56:59], v20 offset:39936
    s_add_u32 m0, s29, 71808
    v_mfma_f32_16x16x32_bf16 v[84:87], v[32:35], a[228:231], v[84:87]
    buffer_load_dwordx4 v16, s[16:19], s34 offen offset:896 lds
    v_mfma_f32_16x16x32_bf16 v[88:91], v[36:39], a[224:227], v[88:91]
    ds_read_b128 v[60:63], v20 offset:56320
    v_mfma_f32_16x16x32_bf16 v[92:95], v[36:39], a[228:231], v[92:95]
    s_waitcnt lgkmcnt(4)
    v_mfma_f32_16x16x32_bf16 v[80:83], v[40:43], a[232:235], v[80:83]
    s_add_u32 s34, s34, 1024
    v_mfma_f32_16x16x32_bf16 v[84:87], v[40:43], a[236:239], v[84:87]
    v_mfma_f32_16x16x32_bf16 v[88:91], v[44:47], a[232:235], v[88:91]
    v_mfma_f32_16x16x32_bf16 v[92:95], v[44:47], a[236:239], v[92:95]
    s_waitcnt lgkmcnt(0)
    s_waitcnt vmcnt(11)
    s_barrier
    ds_read_b128 v[32:35], v17 offset:0
    ds_read_b128 v[36:39], v17 offset:16384
    v_mfma_f32_16x16x32_bf16 v[80:83], v[48:51], a[240:243], v[80:83]
    ds_read_b128 v[40:43], v18 offset:0
    s_add_u32 m0, s29, 98304
    v_mfma_f32_16x16x32_bf16 v[84:87], v[48:51], a[244:247], v[84:87]
    buffer_load_dwordx4 v16, s[16:19], s34 offen offset:0 lds
    v_mfma_f32_16x16x32_bf16 v[88:91], v[52:55], a[240:243], v[88:91]
    ds_read_b128 v[44:47], v18 offset:16384
    v_mfma_f32_16x16x32_bf16 v[92:95], v[52:55], a[244:247], v[92:95]
    v_mfma_f32_16x16x32_bf16 v[80:83], v[56:59], a[248:251], v[80:83]
    ds_read_b128 v[48:51], v17 offset:1024
    v_mfma_f32_16x16x32_bf16 v[84:87], v[56:59], a[252:255], v[84:87]
    v_mfma_f32_16x16x32_bf16 v[88:91], v[60:63], a[248:251], v[88:91]
    ds_read_b128 v[52:55], v17 offset:17408
    v_mfma_f32_16x16x32_bf16 v[92:95], v[60:63], a[252:255], v[92:95]
    s_mov_b64 exec, s[36:37]
    buffer_store_dword v23, v22, s[8:11], s33 offen sc1
    s_mov_b64 exec, -1

    s_add_u32 s35, s35, 1
    s_cmp_lt_u32 s35, 32
    s_cbranch_scc1 .ql_363

    s_nop 7
    v_cvt_pk_bf16_f32 v96, v80, v81
    v_cvt_pk_bf16_f32 v97, v82, v83
    v_cvt_pk_bf16_f32 v98, v88, v89
    v_cvt_pk_bf16_f32 v99, v90, v91
    buffer_store_dwordx4 v[96:99], v21, s[8:11], s32 offen offset:0 sc1
    v_cvt_pk_bf16_f32 v100, v84, v85
    v_cvt_pk_bf16_f32 v101, v86, v87
    v_cvt_pk_bf16_f32 v102, v92, v93
    v_cvt_pk_bf16_f32 v103, v94, v95
    buffer_store_dwordx4 v[100:103], v21, s[8:11], s32 offen offset:1024 sc1
    v_mov_b32 v23, 64
    s_waitcnt vmcnt(0) lgkmcnt(0)
    s_barrier
    s_mov_b64 exec, s[36:37]
    buffer_store_dword v23, v22, s[8:11], s33 offen sc1
    s_mov_b64 exec, -1

.qd_360:
    s_load_dwordx2 s[40:41], s[0:1], 88
    s_load_dwordx2 s[42:43], s[0:1], 112
    s_and_b32 s4, s33, 0xffffe7ff
    s_mov_b32 s57, s4
    s_mov_b32 s34, s47
    s_and_b32 s30, s26, 7
    s_lshr_b32 s31, s26, 3
    s_lshl_b32 s28, s91, 21
    s_lshl_b32 s4, s30, 8
    s_add_u32 s28, s28, s4
    s_waitcnt lgkmcnt(0)

    s_mov_b32 s12, s40
    s_and_b32 s13, s41, 0xffff
    s_mov_b32 s14, 0x800000
    s_mov_b32 s15, 0x00020000

    s_mov_b32 s44, s42
    s_and_b32 s45, s43, 0xffff
    s_mov_b32 s46, 0x400000
    s_mov_b32 s47, 0x00020000

    v_lshrrev_b32 v4, 1, v2
    v_xor_b32 v4, v4, v3
    v_lshlrev_b32 v4, 1, v4
    v_and_b32 v5, 1, v1
    v_or_b32 v4, v4, v5
    v_lshlrev_b32 v4, 4, v4
    v_lshlrev_b32 v5, 11, v3
    v_add_u32 v10, v4, v5
    v_xor_b32 v11, 0x80, v10
    s_lshl_b32 s4, s24, 16
    s_add_u32 s28, s28, s4
    s_lshl_b32 s29, s24, 13
    v_lshrrev_b32 v4, 2, v2
    v_and_b32 v5, 1, v3
    v_lshl_or_b32 v5, v5, 2, v4
    s_lshl_b32 s4, s24, 1
    v_xor_b32 v5, s4, v5
    v_lshlrev_b32 v5, 5, v5
    v_lshl_add_u32 v4, v3, 2, v4
    v_lshl_add_u32 v5, v4, 8, v5
    v_and_b32 v4, 3, v2
    v_lshl_add_u32 v12, v4, 3, v5
    v_xor_b32 v13, 32, v12
    v_add_u32 v14, 0x10000, v12
    v_add_u32 v15, 0x10000, v13

    s_and_b32 s4, s91, 1
    s_lshl_b32 s4, s4, 5
    v_xor_b32 v12, s4, v12
    v_xor_b32 v13, s4, v13
    v_xor_b32 v14, s4, v14
    v_xor_b32 v15, s4, v15

    s_add_u32 m0, s29, 0
    s_add_u32 s4, s28, 0
    buffer_load_dwordx4 v10, s[12:15], s4 offen lds

    s_add_u32 m0, s29, 1024
    s_add_u32 s4, s28, 8192
    buffer_load_dwordx4 v11, s[12:15], s4 offen lds

    s_add_u32 m0, s29, 2048
    s_add_u32 s4, s28, 16384
    buffer_load_dwordx4 v10, s[12:15], s4 offen lds

    s_add_u32 m0, s29, 3072
    s_add_u32 s4, s28, 24576
    buffer_load_dwordx4 v11, s[12:15], s4 offen lds

    s_add_u32 m0, s29, 4096
    s_add_u32 s4, s28, 32768
    buffer_load_dwordx4 v10, s[12:15], s4 offen lds

    s_add_u32 m0, s29, 5120
    s_add_u32 s4, s28, 40960
    buffer_load_dwordx4 v11, s[12:15], s4 offen lds

    s_add_u32 m0, s29, 6144
    s_add_u32 s4, s28, 49152
    buffer_load_dwordx4 v10, s[12:15], s4 offen lds

    s_add_u32 m0, s29, 7168
    s_add_u32 s4, s28, 57344
    buffer_load_dwordx4 v11, s[12:15], s4 offen lds

    s_add_u32 m0, s29, 32768
    s_add_u32 s4, s28, 262144
    buffer_load_dwordx4 v10, s[12:15], s4 offen lds

    s_add_u32 m0, s29, 33792
    s_add_u32 s4, s28, 270336
    buffer_load_dwordx4 v11, s[12:15], s4 offen lds

    s_add_u32 m0, s29, 34816
    s_add_u32 s4, s28, 278528
    buffer_load_dwordx4 v10, s[12:15], s4 offen lds

    s_add_u32 m0, s29, 35840
    s_add_u32 s4, s28, 286720
    buffer_load_dwordx4 v11, s[12:15], s4 offen lds

    s_add_u32 m0, s29, 36864
    s_add_u32 s4, s28, 294912
    buffer_load_dwordx4 v10, s[12:15], s4 offen lds

    s_add_u32 m0, s29, 37888
    s_add_u32 s4, s28, 303104
    buffer_load_dwordx4 v11, s[12:15], s4 offen lds

    s_add_u32 m0, s29, 38912
    s_add_u32 s4, s28, 311296
    buffer_load_dwordx4 v10, s[12:15], s4 offen lds

    s_add_u32 m0, s29, 39936
    s_add_u32 s4, s28, 319488
    buffer_load_dwordx4 v11, s[12:15], s4 offen lds

    s_add_u32 m0, s29, 65536
    s_add_u32 s4, s28, 524288
    buffer_load_dwordx4 v10, s[12:15], s4 offen lds

    s_add_u32 m0, s29, 66560
    s_add_u32 s4, s28, 532480
    buffer_load_dwordx4 v11, s[12:15], s4 offen lds

    s_add_u32 m0, s29, 67584
    s_add_u32 s4, s28, 540672
    buffer_load_dwordx4 v10, s[12:15], s4 offen lds

    s_add_u32 m0, s29, 68608
    s_add_u32 s4, s28, 548864
    buffer_load_dwordx4 v11, s[12:15], s4 offen lds

    s_add_u32 m0, s29, 69632
    s_add_u32 s4, s28, 557056
    buffer_load_dwordx4 v10, s[12:15], s4 offen lds

    s_add_u32 m0, s29, 70656
    s_add_u32 s4, s28, 565248
    buffer_load_dwordx4 v11, s[12:15], s4 offen lds

    s_add_u32 m0, s29, 71680
    s_add_u32 s4, s28, 573440
    buffer_load_dwordx4 v10, s[12:15], s4 offen lds

    s_add_u32 m0, s29, 72704
    s_add_u32 s4, s28, 581632
    buffer_load_dwordx4 v11, s[12:15], s4 offen lds

    s_add_u32 m0, s29, 98304
    s_add_u32 s4, s28, 786432
    buffer_load_dwordx4 v10, s[12:15], s4 offen lds

    s_add_u32 m0, s29, 99328
    s_add_u32 s4, s28, 794624
    buffer_load_dwordx4 v11, s[12:15], s4 offen lds

    s_add_u32 m0, s29, 100352
    s_add_u32 s4, s28, 802816
    buffer_load_dwordx4 v10, s[12:15], s4 offen lds

    s_add_u32 m0, s29, 101376
    s_add_u32 s4, s28, 811008
    buffer_load_dwordx4 v11, s[12:15], s4 offen lds

    s_add_u32 m0, s29, 102400
    s_add_u32 s4, s28, 819200
    buffer_load_dwordx4 v10, s[12:15], s4 offen lds

    s_add_u32 m0, s29, 103424
    s_add_u32 s4, s28, 827392
    buffer_load_dwordx4 v11, s[12:15], s4 offen lds

    s_add_u32 m0, s29, 104448
    s_add_u32 s4, s28, 835584
    buffer_load_dwordx4 v10, s[12:15], s4 offen lds

    s_add_u32 m0, s29, 105472
    s_add_u32 s4, s28, 843776
    buffer_load_dwordx4 v11, s[12:15], s4 offen lds

    s_waitcnt vmcnt(24)
    s_barrier
    ds_read_b64_tr_b16 a[0:1], v12 offset:0
    ds_read_b64_tr_b16 a[2:3], v12 offset:4096
    ds_read_b64_tr_b16 a[4:5], v13 offset:0
    ds_read_b64_tr_b16 a[6:7], v13 offset:4096
    ds_read_b64_tr_b16 a[8:9], v12 offset:8192
    ds_read_b64_tr_b16 a[10:11], v12 offset:12288
    ds_read_b64_tr_b16 a[12:13], v13 offset:8192
    ds_read_b64_tr_b16 a[14:15], v13 offset:12288
    ds_read_b64_tr_b16 a[16:17], v12 offset:16384
    ds_read_b64_tr_b16 a[18:19], v12 offset:20480
    ds_read_b64_tr_b16 a[20:21], v13 offset:16384
    ds_read_b64_tr_b16 a[22:23], v13 offset:20480
    ds_read_b64_tr_b16 a[24:25], v12 offset:24576
    ds_read_b64_tr_b16 a[26:27], v12 offset:28672
    ds_read_b64_tr_b16 a[28:29], v13 offset:24576
    ds_read_b64_tr_b16 a[30:31], v13 offset:28672
    s_waitcnt lgkmcnt(0)
    s_barrier
    s_add_u32 m0, s29, 0
    s_add_u32 s4, s28, 1048576
    buffer_load_dwordx4 v10, s[12:15], s4 offen lds

    s_add_u32 m0, s29, 1024
    s_add_u32 s4, s28, 1056768
    buffer_load_dwordx4 v11, s[12:15], s4 offen lds

    s_add_u32 m0, s29, 2048
    s_add_u32 s4, s28, 1064960
    buffer_load_dwordx4 v10, s[12:15], s4 offen lds

    s_add_u32 m0, s29, 3072
    s_add_u32 s4, s28, 1073152
    buffer_load_dwordx4 v11, s[12:15], s4 offen lds

    s_add_u32 m0, s29, 4096
    s_add_u32 s4, s28, 1081344
    buffer_load_dwordx4 v10, s[12:15], s4 offen lds

    s_add_u32 m0, s29, 5120
    s_add_u32 s4, s28, 1089536
    buffer_load_dwordx4 v11, s[12:15], s4 offen lds

    s_add_u32 m0, s29, 6144
    s_add_u32 s4, s28, 1097728
    buffer_load_dwordx4 v10, s[12:15], s4 offen lds

    s_add_u32 m0, s29, 7168
    s_add_u32 s4, s28, 1105920
    buffer_load_dwordx4 v11, s[12:15], s4 offen lds

    s_waitcnt vmcnt(24)
    s_barrier
    ds_read_b64_tr_b16 a[32:33], v12 offset:32768
    ds_read_b64_tr_b16 a[34:35], v12 offset:36864
    ds_read_b64_tr_b16 a[36:37], v13 offset:32768
    ds_read_b64_tr_b16 a[38:39], v13 offset:36864
    ds_read_b64_tr_b16 a[40:41], v12 offset:40960
    ds_read_b64_tr_b16 a[42:43], v12 offset:45056
    ds_read_b64_tr_b16 a[44:45], v13 offset:40960
    ds_read_b64_tr_b16 a[46:47], v13 offset:45056
    ds_read_b64_tr_b16 a[48:49], v12 offset:49152
    ds_read_b64_tr_b16 a[50:51], v12 offset:53248
    ds_read_b64_tr_b16 a[52:53], v13 offset:49152
    ds_read_b64_tr_b16 a[54:55], v13 offset:53248
    ds_read_b64_tr_b16 a[56:57], v12 offset:57344
    ds_read_b64_tr_b16 a[58:59], v12 offset:61440
    ds_read_b64_tr_b16 a[60:61], v13 offset:57344
    ds_read_b64_tr_b16 a[62:63], v13 offset:61440
    s_waitcnt lgkmcnt(0)
    s_barrier
    s_add_u32 m0, s29, 32768
    s_add_u32 s4, s28, 1310720
    buffer_load_dwordx4 v10, s[12:15], s4 offen lds

    s_add_u32 m0, s29, 33792
    s_add_u32 s4, s28, 1318912
    buffer_load_dwordx4 v11, s[12:15], s4 offen lds

    s_add_u32 m0, s29, 34816
    s_add_u32 s4, s28, 1327104
    buffer_load_dwordx4 v10, s[12:15], s4 offen lds

    s_add_u32 m0, s29, 35840
    s_add_u32 s4, s28, 1335296
    buffer_load_dwordx4 v11, s[12:15], s4 offen lds

    s_add_u32 m0, s29, 36864
    s_add_u32 s4, s28, 1343488
    buffer_load_dwordx4 v10, s[12:15], s4 offen lds

    s_add_u32 m0, s29, 37888
    s_add_u32 s4, s28, 1351680
    buffer_load_dwordx4 v11, s[12:15], s4 offen lds

    s_add_u32 m0, s29, 38912
    s_add_u32 s4, s28, 1359872
    buffer_load_dwordx4 v10, s[12:15], s4 offen lds

    s_add_u32 m0, s29, 39936
    s_add_u32 s4, s28, 1368064
    buffer_load_dwordx4 v11, s[12:15], s4 offen lds

    s_waitcnt vmcnt(24)
    s_barrier
    ds_read_b64_tr_b16 a[64:65], v14 offset:0
    ds_read_b64_tr_b16 a[66:67], v14 offset:4096
    ds_read_b64_tr_b16 a[68:69], v15 offset:0
    ds_read_b64_tr_b16 a[70:71], v15 offset:4096
    ds_read_b64_tr_b16 a[72:73], v14 offset:8192
    ds_read_b64_tr_b16 a[74:75], v14 offset:12288
    ds_read_b64_tr_b16 a[76:77], v15 offset:8192
    ds_read_b64_tr_b16 a[78:79], v15 offset:12288
    ds_read_b64_tr_b16 a[80:81], v14 offset:16384
    ds_read_b64_tr_b16 a[82:83], v14 offset:20480
    ds_read_b64_tr_b16 a[84:85], v15 offset:16384
    ds_read_b64_tr_b16 a[86:87], v15 offset:20480
    ds_read_b64_tr_b16 a[88:89], v14 offset:24576
    ds_read_b64_tr_b16 a[90:91], v14 offset:28672
    ds_read_b64_tr_b16 a[92:93], v15 offset:24576
    ds_read_b64_tr_b16 a[94:95], v15 offset:28672
    s_waitcnt lgkmcnt(0)
    s_barrier
    s_add_u32 m0, s29, 65536
    s_add_u32 s4, s28, 1572864
    buffer_load_dwordx4 v10, s[12:15], s4 offen lds

    s_add_u32 m0, s29, 66560
    s_add_u32 s4, s28, 1581056
    buffer_load_dwordx4 v11, s[12:15], s4 offen lds

    s_add_u32 m0, s29, 67584
    s_add_u32 s4, s28, 1589248
    buffer_load_dwordx4 v10, s[12:15], s4 offen lds

    s_add_u32 m0, s29, 68608
    s_add_u32 s4, s28, 1597440
    buffer_load_dwordx4 v11, s[12:15], s4 offen lds

    s_add_u32 m0, s29, 69632
    s_add_u32 s4, s28, 1605632
    buffer_load_dwordx4 v10, s[12:15], s4 offen lds

    s_add_u32 m0, s29, 70656
    s_add_u32 s4, s28, 1613824
    buffer_load_dwordx4 v11, s[12:15], s4 offen lds

    s_add_u32 m0, s29, 71680
    s_add_u32 s4, s28, 1622016
    buffer_load_dwordx4 v10, s[12:15], s4 offen lds

    s_add_u32 m0, s29, 72704
    s_add_u32 s4, s28, 1630208
    buffer_load_dwordx4 v11, s[12:15], s4 offen lds

    s_waitcnt vmcnt(24)
    s_barrier
    ds_read_b64_tr_b16 a[96:97], v14 offset:32768
    ds_read_b64_tr_b16 a[98:99], v14 offset:36864
    ds_read_b64_tr_b16 a[100:101], v15 offset:32768
    ds_read_b64_tr_b16 a[102:103], v15 offset:36864
    ds_read_b64_tr_b16 a[104:105], v14 offset:40960
    ds_read_b64_tr_b16 a[106:107], v14 offset:45056
    ds_read_b64_tr_b16 a[108:109], v15 offset:40960
    ds_read_b64_tr_b16 a[110:111], v15 offset:45056
    ds_read_b64_tr_b16 a[112:113], v14 offset:49152
    ds_read_b64_tr_b16 a[114:115], v14 offset:53248
    ds_read_b64_tr_b16 a[116:117], v15 offset:49152
    ds_read_b64_tr_b16 a[118:119], v15 offset:53248
    ds_read_b64_tr_b16 a[120:121], v14 offset:57344
    ds_read_b64_tr_b16 a[122:123], v14 offset:61440
    ds_read_b64_tr_b16 a[124:125], v15 offset:57344
    ds_read_b64_tr_b16 a[126:127], v15 offset:61440
    s_waitcnt lgkmcnt(0)
    s_barrier
    s_add_u32 m0, s29, 98304
    s_add_u32 s4, s28, 1835008
    buffer_load_dwordx4 v10, s[12:15], s4 offen lds

    s_add_u32 m0, s29, 99328
    s_add_u32 s4, s28, 1843200
    buffer_load_dwordx4 v11, s[12:15], s4 offen lds

    s_add_u32 m0, s29, 100352
    s_add_u32 s4, s28, 1851392
    buffer_load_dwordx4 v10, s[12:15], s4 offen lds

    s_add_u32 m0, s29, 101376
    s_add_u32 s4, s28, 1859584
    buffer_load_dwordx4 v11, s[12:15], s4 offen lds

    s_add_u32 m0, s29, 102400
    s_add_u32 s4, s28, 1867776
    buffer_load_dwordx4 v10, s[12:15], s4 offen lds

    s_add_u32 m0, s29, 103424
    s_add_u32 s4, s28, 1875968
    buffer_load_dwordx4 v11, s[12:15], s4 offen lds

    s_add_u32 m0, s29, 104448
    s_add_u32 s4, s28, 1884160
    buffer_load_dwordx4 v10, s[12:15], s4 offen lds

    s_add_u32 m0, s29, 105472
    s_add_u32 s4, s28, 1892352
    buffer_load_dwordx4 v11, s[12:15], s4 offen lds

    s_waitcnt vmcnt(24)
    s_barrier
    ds_read_b64_tr_b16 a[128:129], v12 offset:0
    ds_read_b64_tr_b16 a[130:131], v12 offset:4096
    ds_read_b64_tr_b16 a[132:133], v13 offset:0
    ds_read_b64_tr_b16 a[134:135], v13 offset:4096
    ds_read_b64_tr_b16 a[136:137], v12 offset:8192
    ds_read_b64_tr_b16 a[138:139], v12 offset:12288
    ds_read_b64_tr_b16 a[140:141], v13 offset:8192
    ds_read_b64_tr_b16 a[142:143], v13 offset:12288
    ds_read_b64_tr_b16 a[144:145], v12 offset:16384
    ds_read_b64_tr_b16 a[146:147], v12 offset:20480
    ds_read_b64_tr_b16 a[148:149], v13 offset:16384
    ds_read_b64_tr_b16 a[150:151], v13 offset:20480
    ds_read_b64_tr_b16 a[152:153], v12 offset:24576
    ds_read_b64_tr_b16 a[154:155], v12 offset:28672
    ds_read_b64_tr_b16 a[156:157], v13 offset:24576
    ds_read_b64_tr_b16 a[158:159], v13 offset:28672
    s_waitcnt lgkmcnt(0)
    s_barrier
    s_waitcnt vmcnt(16)
    s_barrier
    ds_read_b64_tr_b16 a[160:161], v12 offset:32768
    ds_read_b64_tr_b16 a[162:163], v12 offset:36864
    ds_read_b64_tr_b16 a[164:165], v13 offset:32768
    ds_read_b64_tr_b16 a[166:167], v13 offset:36864
    ds_read_b64_tr_b16 a[168:169], v12 offset:40960
    ds_read_b64_tr_b16 a[170:171], v12 offset:45056
    ds_read_b64_tr_b16 a[172:173], v13 offset:40960
    ds_read_b64_tr_b16 a[174:175], v13 offset:45056
    ds_read_b64_tr_b16 a[176:177], v12 offset:49152
    ds_read_b64_tr_b16 a[178:179], v12 offset:53248
    ds_read_b64_tr_b16 a[180:181], v13 offset:49152
    ds_read_b64_tr_b16 a[182:183], v13 offset:53248
    ds_read_b64_tr_b16 a[184:185], v12 offset:57344
    ds_read_b64_tr_b16 a[186:187], v12 offset:61440
    ds_read_b64_tr_b16 a[188:189], v13 offset:57344
    ds_read_b64_tr_b16 a[190:191], v13 offset:61440
    s_waitcnt lgkmcnt(0)
    s_barrier
    s_waitcnt vmcnt(8)
    s_barrier
    ds_read_b64_tr_b16 a[192:193], v14 offset:0
    ds_read_b64_tr_b16 a[194:195], v14 offset:4096
    ds_read_b64_tr_b16 a[196:197], v15 offset:0
    ds_read_b64_tr_b16 a[198:199], v15 offset:4096
    ds_read_b64_tr_b16 a[200:201], v14 offset:8192
    ds_read_b64_tr_b16 a[202:203], v14 offset:12288
    ds_read_b64_tr_b16 a[204:205], v15 offset:8192
    ds_read_b64_tr_b16 a[206:207], v15 offset:12288
    ds_read_b64_tr_b16 a[208:209], v14 offset:16384
    ds_read_b64_tr_b16 a[210:211], v14 offset:20480
    ds_read_b64_tr_b16 a[212:213], v15 offset:16384
    ds_read_b64_tr_b16 a[214:215], v15 offset:20480
    ds_read_b64_tr_b16 a[216:217], v14 offset:24576
    ds_read_b64_tr_b16 a[218:219], v14 offset:28672
    ds_read_b64_tr_b16 a[220:221], v15 offset:24576
    ds_read_b64_tr_b16 a[222:223], v15 offset:28672
    s_waitcnt lgkmcnt(0)
    s_barrier
    s_waitcnt vmcnt(0)
    s_barrier
    ds_read_b64_tr_b16 a[224:225], v14 offset:32768
    ds_read_b64_tr_b16 a[226:227], v14 offset:36864
    ds_read_b64_tr_b16 a[228:229], v15 offset:32768
    ds_read_b64_tr_b16 a[230:231], v15 offset:36864
    ds_read_b64_tr_b16 a[232:233], v14 offset:40960
    ds_read_b64_tr_b16 a[234:235], v14 offset:45056
    ds_read_b64_tr_b16 a[236:237], v15 offset:40960
    ds_read_b64_tr_b16 a[238:239], v15 offset:45056
    ds_read_b64_tr_b16 a[240:241], v14 offset:49152
    ds_read_b64_tr_b16 a[242:243], v14 offset:53248
    ds_read_b64_tr_b16 a[244:245], v15 offset:49152
    ds_read_b64_tr_b16 a[246:247], v15 offset:53248
    ds_read_b64_tr_b16 a[248:249], v14 offset:57344
    ds_read_b64_tr_b16 a[250:251], v14 offset:61440
    ds_read_b64_tr_b16 a[252:253], v15 offset:57344
    ds_read_b64_tr_b16 a[254:255], v15 offset:61440
    s_waitcnt lgkmcnt(0)
    s_barrier
    v_lshlrev_b32 v21, 4, v1
    s_lshr_b32 s4, s91, 1
    s_lshl_b32 s5, s4, 12
    v_add_u32 v17, s5, v21
    v_xor_b32 v18, 0x1000, v17
    s_lshl_b32 s4, s4, 4
    v_add_u32 v4, s4, v2
    s_lshl_b32 s5, s30, 5
    s_lshl_b32 s6, s24, 3
    s_add_u32 s5, s5, s6
    s_and_b32 s6, s91, 1
    s_lshl_b32 s6, s6, 2
    s_add_u32 s5, s5, s6
    v_add_u32 v5, s5, v3
    v_lshlrev_b32 v6, 3, v5
    v_lshl_add_u32 v22, v4, 11, v6
    v_lshlrev_b32 v6, 14, v5
    v_lshl_add_u32 v23, v4, 2, v6
    v_lshlrev_b32 v16, 2, v4
    v_and_b32 v4, 7, v1
    v_lshlrev_b32 v19, 8, v4
    s_lshl_b32 s33, s91, 11
    s_add_u32 s33, s33, 92299264
    s_lshl_b32 s35, s24, 14
    s_lshl_b32 s36, s91, 16
    s_add_u32 s36, s36, s35
    s_add_u32 s36, s36, 50331648
    s_mov_b32 s37, 0
    s_mov_b32 s38, 0
    s_mov_b32 s39, 0
    v_lshlrev_b32 v6, 11, v1

    v_mov_b32 v5, 0
    s_mov_b32 s62, 0
    s_mov_b32 s5, 32
.wc_365:
    buffer_load_dword v4, v5, s[20:23], s5 offen sc1
    s_waitcnt vmcnt(0)
    v_readfirstlane_b32 s4, v4
    s_lshr_b32 s4, s4, 0
    s_and_b32 s4, s4, 0xffff
    s_cmp_ge_u32 s4, 256
    s_cbranch_scc1 .wcd_366
    s_sleep 6
    s_add_u32 s62, s62, 1
    s_cmp_gt_u32 s62, 0x400000
    s_cbranch_scc1 .mg_end_1
    s_branch .wc_365

.wcd_366:
    s_mov_b32 s62, 0
    s_mov_b64 exec, 15
.wf_367:
    buffer_load_dword v4, v6, s[8:11], s57 offen sc1
    s_waitcnt vmcnt(0)
    v_cmp_gt_u32 vcc, 64, v4
    s_cbranch_vccz .wfd_368
    s_sleep 2
    s_add_u32 s62, s62, 1
    s_cmp_gt_u32 s62, 0x400000
    s_cbranch_scc1 .mg_end_1
    s_branch .wf_367

.wfd_368:
    s_mov_b64 exec, -1
    v_mov_b32 v5, 0
    s_mov_b32 s62, 0
    s_mov_b32 s5, 44
.wc_369:
    buffer_load_dword v4, v5, s[20:23], s5 offen sc1
    s_waitcnt vmcnt(0)
    v_readfirstlane_b32 s4, v4
    s_lshr_b32 s4, s4, 0
    s_and_b32 s4, s4, 0xffff
    s_cmp_ge_u32 s4, 32
    s_cbranch_scc1 .wcd_370
    s_sleep 6
    s_add_u32 s62, s62, 1
    s_cmp_gt_u32 s62, 0x400000
    s_cbranch_scc1 .mg_end_1
    s_branch .wc_369

.wcd_370:
.g2blk_371:
    s_mov_b32 s62, 0
.g2bw_380:
    buffer_load_dword v20, v19, s[8:11], s33 offen sc1
    s_waitcnt vmcnt(0)
    s_and_b32 s4, s31, 3
    s_lshl_b32 s4, s4, 1
    s_add_u32 s5, s4, 1
    v_readlane_b32 s4, v20, s4
    v_readlane_b32 s5, v20, s5
    s_lshr_b32 s6, s31, 2
    s_min_u32 s4, s4, s5
    s_cmp_gt_u32 s4, s6

    s_cbranch_scc1 .g2rd_381
    s_sleep 1
    s_add_u32 s62, s62, 1
    s_cmp_gt_u32 s62, 0x400000
    s_cbranch_scc1 .mg_end_1
    s_branch .g2bw_380

.g2rd_381:
    s_lshl_b32 s48, s31, 18
    s_add_u32 s48, s48, s36
    s_add_u32 s49, s39, s35
    s_xor_b32 s39, s39, 0x10000

    s_add_u32 m0, s49, 0
    s_add_u32 s50, s48, 0
    buffer_load_dwordx4 v21, s[8:11], s50 offen offset:0 lds
    buffer_load_dwordx4 v21, s[8:11], s50 offen offset:1024 lds
    buffer_load_dwordx4 v21, s[8:11], s50 offen offset:2048 lds
    buffer_load_dwordx4 v21, s[8:11], s50 offen offset:3072 lds
    s_add_u32 m0, s49, 4096
    s_add_u32 s50, s48, 4096
    buffer_load_dwordx4 v21, s[8:11], s50 offen offset:0 lds
    buffer_load_dwordx4 v21, s[8:11], s50 offen offset:1024 lds
    buffer_load_dwordx4 v21, s[8:11], s50 offen offset:2048 lds
    buffer_load_dwordx4 v21, s[8:11], s50 offen offset:3072 lds
    s_add_u32 m0, s49, 8192
    s_add_u32 s50, s48, 8192
    buffer_load_dwordx4 v21, s[8:11], s50 offen offset:0 lds
    buffer_load_dwordx4 v21, s[8:11], s50 offen offset:1024 lds
    buffer_load_dwordx4 v21, s[8:11], s50 offen offset:2048 lds
    buffer_load_dwordx4 v21, s[8:11], s50 offen offset:3072 lds
    s_add_u32 m0, s49, 12288
    s_add_u32 s50, s48, 12288
    buffer_load_dwordx4 v21, s[8:11], s50 offen offset:0 lds
    buffer_load_dwordx4 v21, s[8:11], s50 offen offset:1024 lds
    buffer_load_dwordx4 v21, s[8:11], s50 offen offset:2048 lds
    buffer_load_dwordx4 v21, s[8:11], s50 offen offset:3072 lds
    s_waitcnt vmcnt(0)
.g2go_372:
    s_barrier
    ds_read_b128 v[32:35], v17 offset:0
    ds_read_b128 v[36:39], v18 offset:0
    ds_read_b128 v[40:43], v17 offset:1024
    ds_read_b128 v[44:47], v18 offset:1024
    ds_read_b128 v[48:51], v17 offset:2048
    ds_read_b128 v[52:55], v18 offset:2048
    s_add_u32 s53, s31, 3
    s_cmp_eq_u32 s38, 0
    s_cbranch_scc1 .g2np_374
    s_sub_u32 s54, s31, 3
    s_sub_u32 s55, s37, 0x10000
    s_add_u32 s51, s34, s55
    s_lshl_b32 s52, s54, 16
    s_lshl_b32 s5, s54, 7
    s_add_u32 s4, s5, 117440512
    s_add_u32 s6, s5, 117448704
    s_add_u32 s5, s5, 121634816
    buffer_load_dwordx2 v[96:97], v22, s[16:19], s52 offen
    buffer_load_dword v98, v23, s[8:11], s4 offen
    buffer_load_dword v99, v23, s[8:11], s6 offen
    buffer_load_dword v100, v16, s[8:11], s5 offen

    buffer_load_dwordx4 v[84:87], v7, s[8:11], s51 offen sc1
    buffer_load_dwordx4 v[88:91], v8, s[8:11], s51 offen sc1
    buffer_load_dwordx4 v[92:95], v9, s[8:11], s51 offen sc1
.g2np_374:
    s_and_b32 s4, s53, 3
    s_lshl_b32 s4, s4, 1
    s_add_u32 s5, s4, 1
    v_readlane_b32 s4, v20, s4
    v_readlane_b32 s5, v20, s5
    s_lshr_b32 s6, s53, 2
    s_min_u32 s4, s4, s5
    s_cmp_gt_u32 s4, s6

    s_cselect_b32 s56, 1, 0
    s_cmp_lt_u32 s53, 64
    s_cselect_b32 s56, s56, 0
    buffer_load_dword v20, v19, s[8:11], s33 offen sc1
    s_cmp_eq_u32 s56, 0
    s_cbranch_scc1 .g2nd_375
    s_lshl_b32 s48, s53, 18
    s_add_u32 s48, s48, s36
    s_add_u32 s49, s39, s35
    s_xor_b32 s39, s39, 0x10000

    s_waitcnt lgkmcnt(4)
    v_mfma_f32_16x16x32_bf16 v[64:67], a[0:3], v[32:35], 0
    ds_read_b128 v[56:59], v17 offset:3072
    s_add_u32 m0, s49, 0
    s_add_u32 s50, s48, 0
    v_mfma_f32_16x16x32_bf16 v[68:71], a[4:7], v[32:35], 0
    buffer_load_dwordx4 v21, s[8:11], s50 offen offset:0 lds
    v_mfma_f32_16x16x32_bf16 v[72:75], a[0:3], v[36:39], 0
    ds_read_b128 v[60:63], v18 offset:3072
    v_mfma_f32_16x16x32_bf16 v[76:79], a[4:7], v[36:39], 0
    s_waitcnt lgkmcnt(4)
    v_mfma_f32_16x16x32_bf16 v[64:67], a[8:11], v[40:43], v[64:67]
    ds_read_b128 v[32:35], v17 offset:8192
    v_mfma_f32_16x16x32_bf16 v[68:71], a[12:15], v[40:43], v[68:71]
    buffer_load_dwordx4 v21, s[8:11], s50 offen offset:1024 lds
    v_mfma_f32_16x16x32_bf16 v[72:75], a[8:11], v[44:47], v[72:75]
    ds_read_b128 v[36:39], v18 offset:8192
    v_mfma_f32_16x16x32_bf16 v[76:79], a[12:15], v[44:47], v[76:79]
    s_waitcnt lgkmcnt(4)
    v_mfma_f32_16x16x32_bf16 v[64:67], a[16:19], v[48:51], v[64:67]
    ds_read_b128 v[40:43], v17 offset:9216
    v_mfma_f32_16x16x32_bf16 v[68:71], a[20:23], v[48:51], v[68:71]
    buffer_load_dwordx4 v21, s[8:11], s50 offen offset:2048 lds
    v_mfma_f32_16x16x32_bf16 v[72:75], a[16:19], v[52:55], v[72:75]
    ds_read_b128 v[44:47], v18 offset:9216
    v_mfma_f32_16x16x32_bf16 v[76:79], a[20:23], v[52:55], v[76:79]
    s_waitcnt lgkmcnt(4)
    v_mfma_f32_16x16x32_bf16 v[64:67], a[24:27], v[56:59], v[64:67]
    ds_read_b128 v[48:51], v17 offset:10240
    v_mfma_f32_16x16x32_bf16 v[68:71], a[28:31], v[56:59], v[68:71]
    buffer_load_dwordx4 v21, s[8:11], s50 offen offset:3072 lds
    v_mfma_f32_16x16x32_bf16 v[72:75], a[24:27], v[60:63], v[72:75]
    ds_read_b128 v[52:55], v18 offset:10240
    v_mfma_f32_16x16x32_bf16 v[76:79], a[28:31], v[60:63], v[76:79]
    s_waitcnt lgkmcnt(4)
    v_mfma_f32_16x16x32_bf16 v[64:67], a[32:35], v[32:35], v[64:67]
    ds_read_b128 v[56:59], v17 offset:11264
    s_add_u32 m0, s49, 4096
    s_add_u32 s50, s48, 4096
    v_mfma_f32_16x16x32_bf16 v[68:71], a[36:39], v[32:35], v[68:71]
    buffer_load_dwordx4 v21, s[8:11], s50 offen offset:0 lds
    v_mfma_f32_16x16x32_bf16 v[72:75], a[32:35], v[36:39], v[72:75]
    ds_read_b128 v[60:63], v18 offset:11264
    v_mfma_f32_16x16x32_bf16 v[76:79], a[36:39], v[36:39], v[76:79]
    s_waitcnt lgkmcnt(4)
    v_mfma_f32_16x16x32_bf16 v[64:67], a[40:43], v[40:43], v[64:67]
    ds_read_b128 v[32:35], v17 offset:16384
    v_mfma_f32_16x16x32_bf16 v[68:71], a[44:47], v[40:43], v[68:71]
    buffer_load_dwordx4 v21, s[8:11], s50 offen offset:1024 lds
    v_mfma_f32_16x16x32_bf16 v[72:75], a[40:43], v[44:47], v[72:75]
    ds_read_b128 v[36:39], v18 offset:16384
    v_mfma_f32_16x16x32_bf16 v[76:79], a[44:47], v[44:47], v[76:79]
    s_waitcnt lgkmcnt(4)
    v_mfma_f32_16x16x32_bf16 v[64:67], a[48:51], v[48:51], v[64:67]
    ds_read_b128 v[40:43], v17 offset:17408
    v_mfma_f32_16x16x32_bf16 v[68:71], a[52:55], v[48:51], v[68:71]
    buffer_load_dwordx4 v21, s[8:11], s50 offen offset:2048 lds
    v_mfma_f32_16x16x32_bf16 v[72:75], a[48:51], v[52:55], v[72:75]
    ds_read_b128 v[44:47], v18 offset:17408
    v_mfma_f32_16x16x32_bf16 v[76:79], a[52:55], v[52:55], v[76:79]
    s_waitcnt lgkmcnt(4)
    v_mfma_f32_16x16x32_bf16 v[64:67], a[56:59], v[56:59], v[64:67]
    ds_read_b128 v[48:51], v17 offset:18432
    v_mfma_f32_16x16x32_bf16 v[68:71], a[60:63], v[56:59], v[68:71]
    buffer_load_dwordx4 v21, s[8:11], s50 offen offset:3072 lds
    v_mfma_f32_16x16x32_bf16 v[72:75], a[56:59], v[60:63], v[72:75]
    ds_read_b128 v[52:55], v18 offset:18432
    v_mfma_f32_16x16x32_bf16 v[76:79], a[60:63], v[60:63], v[76:79]
    s_waitcnt lgkmcnt(4)
    v_mfma_f32_16x16x32_bf16 v[64:67], a[64:67], v[32:35], v[64:67]
    ds_read_b128 v[56:59], v17 offset:19456
    s_add_u32 m0, s49, 8192
    s_add_u32 s50, s48, 8192
    v_mfma_f32_16x16x32_bf16 v[68:71], a[68:71], v[32:35], v[68:71]
    buffer_load_dwordx4 v21, s[8:11], s50 offen offset:0 lds
    v_mfma_f32_16x16x32_bf16 v[72:75], a[64:67], v[36:39], v[72:75]
    ds_read_b128 v[60:63], v18 offset:19456
    v_mfma_f32_16x16x32_bf16 v[76:79], a[68:71], v[36:39], v[76:79]
    s_waitcnt lgkmcnt(4)
    v_mfma_f32_16x16x32_bf16 v[64:67], a[72:75], v[40:43], v[64:67]
    ds_read_b128 v[32:35], v17 offset:24576
    v_mfma_f32_16x16x32_bf16 v[68:71], a[76:79], v[40:43], v[68:71]
    buffer_load_dwordx4 v21, s[8:11], s50 offen offset:1024 lds
    v_mfma_f32_16x16x32_bf16 v[72:75], a[72:75], v[44:47], v[72:75]
    ds_read_b128 v[36:39], v18 offset:24576
    v_mfma_f32_16x16x32_bf16 v[76:79], a[76:79], v[44:47], v[76:79]
    s_waitcnt lgkmcnt(4)
    v_mfma_f32_16x16x32_bf16 v[64:67], a[80:83], v[48:51], v[64:67]
    ds_read_b128 v[40:43], v17 offset:25600
    v_mfma_f32_16x16x32_bf16 v[68:71], a[84:87], v[48:51], v[68:71]
    buffer_load_dwordx4 v21, s[8:11], s50 offen offset:2048 lds
    v_mfma_f32_16x16x32_bf16 v[72:75], a[80:83], v[52:55], v[72:75]
    ds_read_b128 v[44:47], v18 offset:25600
    v_mfma_f32_16x16x32_bf16 v[76:79], a[84:87], v[52:55], v[76:79]
    s_waitcnt lgkmcnt(4)
    v_mfma_f32_16x16x32_bf16 v[64:67], a[88:91], v[56:59], v[64:67]
    ds_read_b128 v[48:51], v17 offset:26624
    v_mfma_f32_16x16x32_bf16 v[68:71], a[92:95], v[56:59], v[68:71]
    buffer_load_dwordx4 v21, s[8:11], s50 offen offset:3072 lds
    v_mfma_f32_16x16x32_bf16 v[72:75], a[88:91], v[60:63], v[72:75]
    ds_read_b128 v[52:55], v18 offset:26624
    v_mfma_f32_16x16x32_bf16 v[76:79], a[92:95], v[60:63], v[76:79]
    s_waitcnt lgkmcnt(4)
    v_mfma_f32_16x16x32_bf16 v[64:67], a[96:99], v[32:35], v[64:67]
    ds_read_b128 v[56:59], v17 offset:27648
    s_add_u32 m0, s49, 12288
    s_add_u32 s50, s48, 12288
    v_mfma_f32_16x16x32_bf16 v[68:71], a[100:103], v[32:35], v[68:71]
    buffer_load_dwordx4 v21, s[8:11], s50 offen offset:0 lds
    v_mfma_f32_16x16x32_bf16 v[72:75], a[96:99], v[36:39], v[72:75]
    ds_read_b128 v[60:63], v18 offset:27648
    v_mfma_f32_16x16x32_bf16 v[76:79], a[100:103], v[36:39], v[76:79]
    s_waitcnt lgkmcnt(4)
    v_mfma_f32_16x16x32_bf16 v[64:67], a[104:107], v[40:43], v[64:67]
    ds_read_b128 v[32:35], v17 offset:32768
    v_mfma_f32_16x16x32_bf16 v[68:71], a[108:111], v[40:43], v[68:71]
    buffer_load_dwordx4 v21, s[8:11], s50 offen offset:1024 lds
    v_mfma_f32_16x16x32_bf16 v[72:75], a[104:107], v[44:47], v[72:75]
    ds_read_b128 v[36:39], v18 offset:32768
    v_mfma_f32_16x16x32_bf16 v[76:79], a[108:111], v[44:47], v[76:79]
    s_waitcnt lgkmcnt(4)
    v_mfma_f32_16x16x32_bf16 v[64:67], a[112:115], v[48:51], v[64:67]
    ds_read_b128 v[40:43], v17 offset:33792
    v_mfma_f32_16x16x32_bf16 v[68:71], a[116:119], v[48:51], v[68:71]
    buffer_load_dwordx4 v21, s[8:11], s50 offen offset:2048 lds
    v_mfma_f32_16x16x32_bf16 v[72:75], a[112:115], v[52:55], v[72:75]
    ds_read_b128 v[44:47], v18 offset:33792
    v_mfma_f32_16x16x32_bf16 v[76:79], a[116:119], v[52:55], v[76:79]
    s_waitcnt lgkmcnt(4)
    v_mfma_f32_16x16x32_bf16 v[64:67], a[120:123], v[56:59], v[64:67]
    ds_read_b128 v[48:51], v17 offset:34816
    v_mfma_f32_16x16x32_bf16 v[68:71], a[124:127], v[56:59], v[68:71]
    buffer_load_dwordx4 v21, s[8:11], s50 offen offset:3072 lds
    v_mfma_f32_16x16x32_bf16 v[72:75], a[120:123], v[60:63], v[72:75]
    ds_read_b128 v[52:55], v18 offset:34816
    v_mfma_f32_16x16x32_bf16 v[76:79], a[124:127], v[60:63], v[76:79]
    s_waitcnt lgkmcnt(4)
    v_mfma_f32_16x16x32_bf16 v[64:67], a[128:131], v[32:35], v[64:67]
    ds_read_b128 v[56:59], v17 offset:35840
    v_mfma_f32_16x16x32_bf16 v[68:71], a[132:135], v[32:35], v[68:71]
    v_mfma_f32_16x16x32_bf16 v[72:75], a[128:131], v[36:39], v[72:75]
    ds_read_b128 v[60:63], v18 offset:35840
    v_mfma_f32_16x16x32_bf16 v[76:79], a[132:135], v[36:39], v[76:79]
    s_waitcnt lgkmcnt(4)
    v_mfma_f32_16x16x32_bf16 v[64:67], a[136:139], v[40:43], v[64:67]
    ds_read_b128 v[32:35], v17 offset:40960
    v_mfma_f32_16x16x32_bf16 v[68:71], a[140:143], v[40:43], v[68:71]
    v_mfma_f32_16x16x32_bf16 v[72:75], a[136:139], v[44:47], v[72:75]
    ds_read_b128 v[36:39], v18 offset:40960
    v_mfma_f32_16x16x32_bf16 v[76:79], a[140:143], v[44:47], v[76:79]
    s_waitcnt lgkmcnt(4)
    v_mfma_f32_16x16x32_bf16 v[64:67], a[144:147], v[48:51], v[64:67]
    ds_read_b128 v[40:43], v17 offset:41984
    v_mfma_f32_16x16x32_bf16 v[68:71], a[148:151], v[48:51], v[68:71]
    v_mfma_f32_16x16x32_bf16 v[72:75], a[144:147], v[52:55], v[72:75]
    ds_read_b128 v[44:47], v18 offset:41984
    v_mfma_f32_16x16x32_bf16 v[76:79], a[148:151], v[52:55], v[76:79]
    s_waitcnt lgkmcnt(4)
    v_mfma_f32_16x16x32_bf16 v[64:67], a[152:155], v[56:59], v[64:67]
    ds_read_b128 v[48:51], v17 offset:43008
    v_mfma_f32_16x16x32_bf16 v[68:71], a[156:159], v[56:59], v[68:71]
    v_mfma_f32_16x16x32_bf16 v[72:75], a[152:155], v[60:63], v[72:75]
    ds_read_b128 v[52:55], v18 offset:43008
    v_mfma_f32_16x16x32_bf16 v[76:79], a[156:159], v[60:63], v[76:79]
    s_waitcnt lgkmcnt(4)
    v_mfma_f32_16x16x32_bf16 v[64:67], a[160:163], v[32:35], v[64:67]
    ds_read_b128 v[56:59], v17 offset:44032
    v_mfma_f32_16x16x32_bf16 v[68:71], a[164:167], v[32:35], v[68:71]
    v_mfma_f32_16x16x32_bf16 v[72:75], a[160:163], v[36:39], v[72:75]
    ds_read_b128 v[60:63], v18 offset:44032
    v_mfma_f32_16x16x32_bf16 v[76:79], a[164:167], v[36:39], v[76:79]
    s_waitcnt lgkmcnt(4)
    v_mfma_f32_16x16x32_bf16 v[64:67], a[168:171], v[40:43], v[64:67]
    ds_read_b128 v[32:35], v17 offset:49152
    v_mfma_f32_16x16x32_bf16 v[68:71], a[172:175], v[40:43], v[68:71]
    v_mfma_f32_16x16x32_bf16 v[72:75], a[168:171], v[44:47], v[72:75]
    ds_read_b128 v[36:39], v18 offset:49152
    v_mfma_f32_16x16x32_bf16 v[76:79], a[172:175], v[44:47], v[76:79]
    s_waitcnt lgkmcnt(4)
    v_mfma_f32_16x16x32_bf16 v[64:67], a[176:179], v[48:51], v[64:67]
    ds_read_b128 v[40:43], v17 offset:50176
    v_mfma_f32_16x16x32_bf16 v[68:71], a[180:183], v[48:51], v[68:71]
    v_mfma_f32_16x16x32_bf16 v[72:75], a[176:179], v[52:55], v[72:75]
    ds_read_b128 v[44:47], v18 offset:50176
    v_mfma_f32_16x16x32_bf16 v[76:79], a[180:183], v[52:55], v[76:79]
    s_waitcnt lgkmcnt(4)
    v_mfma_f32_16x16x32_bf16 v[64:67], a[184:187], v[56:59], v[64:67]
    ds_read_b128 v[48:51], v17 offset:51200
    v_mfma_f32_16x16x32_bf16 v[68:71], a[188:191], v[56:59], v[68:71]
    v_mfma_f32_16x16x32_bf16 v[72:75], a[184:187], v[60:63], v[72:75]
    ds_read_b128 v[52:55], v18 offset:51200
    v_mfma_f32_16x16x32_bf16 v[76:79], a[188:191], v[60:63], v[76:79]
    s_waitcnt lgkmcnt(4)
    v_mfma_f32_16x16x32_bf16 v[64:67], a[192:195], v[32:35], v[64:67]
    ds_read_b128 v[56:59], v17 offset:52224
    v_mfma_f32_16x16x32_bf16 v[68:71], a[196:199], v[32:35], v[68:71]
    v_mfma_f32_16x16x32_bf16 v[72:75], a[192:195], v[36:39], v[72:75]
    ds_read_b128 v[60:63], v18 offset:52224
    v_mfma_f32_16x16x32_bf16 v[76:79], a[196:199], v[36:39], v[76:79]
    s_waitcnt lgkmcnt(4)
    v_mfma_f32_16x16x32_bf16 v[64:67], a[200:203], v[40:43], v[64:67]
    ds_read_b128 v[32:35], v17 offset:57344
    v_mfma_f32_16x16x32_bf16 v[68:71], a[204:207], v[40:43], v[68:71]
    v_mfma_f32_16x16x32_bf16 v[72:75], a[200:203], v[44:47], v[72:75]
    ds_read_b128 v[36:39], v18 offset:57344
    v_mfma_f32_16x16x32_bf16 v[76:79], a[204:207], v[44:47], v[76:79]
    s_waitcnt lgkmcnt(4)
    v_mfma_f32_16x16x32_bf16 v[64:67], a[208:211], v[48:51], v[64:67]
    ds_read_b128 v[40:43], v17 offset:58368
    v_mfma_f32_16x16x32_bf16 v[68:71], a[212:215], v[48:51], v[68:71]
    v_mfma_f32_16x16x32_bf16 v[72:75], a[208:211], v[52:55], v[72:75]
    ds_read_b128 v[44:47], v18 offset:58368
    v_mfma_f32_16x16x32_bf16 v[76:79], a[212:215], v[52:55], v[76:79]
    s_waitcnt lgkmcnt(4)
    v_mfma_f32_16x16x32_bf16 v[64:67], a[216:219], v[56:59], v[64:67]
    ds_read_b128 v[48:51], v17 offset:59392
    v_mfma_f32_16x16x32_bf16 v[68:71], a[220:223], v[56:59], v[68:71]
    v_mfma_f32_16x16x32_bf16 v[72:75], a[216:219], v[60:63], v[72:75]
    ds_read_b128 v[52:55], v18 offset:59392
    v_mfma_f32_16x16x32_bf16 v[76:79], a[220:223], v[60:63], v[76:79]
    s_waitcnt lgkmcnt(4)
    v_mfma_f32_16x16x32_bf16 v[64:67], a[224:227], v[32:35], v[64:67]
    ds_read_b128 v[56:59], v17 offset:60416
    v_mfma_f32_16x16x32_bf16 v[68:71], a[228:231], v[32:35], v[68:71]
    v_mfma_f32_16x16x32_bf16 v[72:75], a[224:227], v[36:39], v[72:75]
    ds_read_b128 v[60:63], v18 offset:60416
    v_mfma_f32_16x16x32_bf16 v[76:79], a[228:231], v[36:39], v[76:79]
    s_waitcnt lgkmcnt(4)
    v_mfma_f32_16x16x32_bf16 v[64:67], a[232:235], v[40:43], v[64:67]
    v_mfma_f32_16x16x32_bf16 v[68:71], a[236:239], v[40:43], v[68:71]
    v_mfma_f32_16x16x32_bf16 v[72:75], a[232:235], v[44:47], v[72:75]
    v_mfma_f32_16x16x32_bf16 v[76:79], a[236:239], v[44:47], v[76:79]
    s_waitcnt lgkmcnt(2)
    v_mfma_f32_16x16x32_bf16 v[64:67], a[240:243], v[48:51], v[64:67]
    v_mfma_f32_16x16x32_bf16 v[68:71], a[244:247], v[48:51], v[68:71]
    v_mfma_f32_16x16x32_bf16 v[72:75], a[240:243], v[52:55], v[72:75]
    v_mfma_f32_16x16x32_bf16 v[76:79], a[244:247], v[52:55], v[76:79]
    s_waitcnt lgkmcnt(0)
    v_mfma_f32_16x16x32_bf16 v[64:67], a[248:251], v[56:59], v[64:67]
    v_mfma_f32_16x16x32_bf16 v[68:71], a[252:255], v[56:59], v[68:71]
    v_mfma_f32_16x16x32_bf16 v[72:75], a[248:251], v[60:63], v[72:75]
    v_mfma_f32_16x16x32_bf16 v[76:79], a[252:255], v[60:63], v[76:79]
    v_xor_b32 v17, 0x10000, v17
    v_xor_b32 v18, 0x10000, v18
    s_add_u32 s4, s34, s37
    s_waitcnt vmcnt(16)

    s_branch .g2st_376
.g2nd_375:
    s_waitcnt lgkmcnt(4)
    v_mfma_f32_16x16x32_bf16 v[64:67], a[0:3], v[32:35], 0
    ds_read_b128 v[56:59], v17 offset:3072
    v_mfma_f32_16x16x32_bf16 v[68:71], a[4:7], v[32:35], 0
    v_mfma_f32_16x16x32_bf16 v[72:75], a[0:3], v[36:39], 0
    ds_read_b128 v[60:63], v18 offset:3072
    v_mfma_f32_16x16x32_bf16 v[76:79], a[4:7], v[36:39], 0
    s_waitcnt lgkmcnt(4)
    v_mfma_f32_16x16x32_bf16 v[64:67], a[8:11], v[40:43], v[64:67]
    ds_read_b128 v[32:35], v17 offset:8192
    v_mfma_f32_16x16x32_bf16 v[68:71], a[12:15], v[40:43], v[68:71]
    v_mfma_f32_16x16x32_bf16 v[72:75], a[8:11], v[44:47], v[72:75]
    ds_read_b128 v[36:39], v18 offset:8192
    v_mfma_f32_16x16x32_bf16 v[76:79], a[12:15], v[44:47], v[76:79]
    s_waitcnt lgkmcnt(4)
    v_mfma_f32_16x16x32_bf16 v[64:67], a[16:19], v[48:51], v[64:67]
    ds_read_b128 v[40:43], v17 offset:9216
    v_mfma_f32_16x16x32_bf16 v[68:71], a[20:23], v[48:51], v[68:71]
    v_mfma_f32_16x16x32_bf16 v[72:75], a[16:19], v[52:55], v[72:75]
    ds_read_b128 v[44:47], v18 offset:9216
    v_mfma_f32_16x16x32_bf16 v[76:79], a[20:23], v[52:55], v[76:79]
    s_waitcnt lgkmcnt(4)
    v_mfma_f32_16x16x32_bf16 v[64:67], a[24:27], v[56:59], v[64:67]
    ds_read_b128 v[48:51], v17 offset:10240
    v_mfma_f32_16x16x32_bf16 v[68:71], a[28:31], v[56:59], v[68:71]
    v_mfma_f32_16x16x32_bf16 v[72:75], a[24:27], v[60:63], v[72:75]
    ds_read_b128 v[52:55], v18 offset:10240
    v_mfma_f32_16x16x32_bf16 v[76:79], a[28:31], v[60:63], v[76:79]
    s_waitcnt lgkmcnt(4)
    v_mfma_f32_16x16x32_bf16 v[64:67], a[32:35], v[32:35], v[64:67]
    ds_read_b128 v[56:59], v17 offset:11264
    v_mfma_f32_16x16x32_bf16 v[68:71], a[36:39], v[32:35], v[68:71]
    v_mfma_f32_16x16x32_bf16 v[72:75], a[32:35], v[36:39], v[72:75]
    ds_read_b128 v[60:63], v18 offset:11264
    v_mfma_f32_16x16x32_bf16 v[76:79], a[36:39], v[36:39], v[76:79]
    s_waitcnt lgkmcnt(4)
    v_mfma_f32_16x16x32_bf16 v[64:67], a[40:43], v[40:43], v[64:67]
    ds_read_b128 v[32:35], v17 offset:16384
    v_mfma_f32_16x16x32_bf16 v[68:71], a[44:47], v[40:43], v[68:71]
    v_mfma_f32_16x16x32_bf16 v[72:75], a[40:43], v[44:47], v[72:75]
    ds_read_b128 v[36:39], v18 offset:16384
    v_mfma_f32_16x16x32_bf16 v[76:79], a[44:47], v[44:47], v[76:79]
    s_waitcnt lgkmcnt(4)
    v_mfma_f32_16x16x32_bf16 v[64:67], a[48:51], v[48:51], v[64:67]
    ds_read_b128 v[40:43], v17 offset:17408
    v_mfma_f32_16x16x32_bf16 v[68:71], a[52:55], v[48:51], v[68:71]
    v_mfma_f32_16x16x32_bf16 v[72:75], a[48:51], v[52:55], v[72:75]
    ds_read_b128 v[44:47], v18 offset:17408
    v_mfma_f32_16x16x32_bf16 v[76:79], a[52:55], v[52:55], v[76:79]
    s_waitcnt lgkmcnt(4)
    v_mfma_f32_16x16x32_bf16 v[64:67], a[56:59], v[56:59], v[64:67]
    ds_read_b128 v[48:51], v17 offset:18432
    v_mfma_f32_16x16x32_bf16 v[68:71], a[60:63], v[56:59], v[68:71]
    v_mfma_f32_16x16x32_bf16 v[72:75], a[56:59], v[60:63], v[72:75]
    ds_read_b128 v[52:55], v18 offset:18432
    v_mfma_f32_16x16x32_bf16 v[76:79], a[60:63], v[60:63], v[76:79]
    s_waitcnt lgkmcnt(4)
    v_mfma_f32_16x16x32_bf16 v[64:67], a[64:67], v[32:35], v[64:67]
    ds_read_b128 v[56:59], v17 offset:19456
    v_mfma_f32_16x16x32_bf16 v[68:71], a[68:71], v[32:35], v[68:71]
    v_mfma_f32_16x16x32_bf16 v[72:75], a[64:67], v[36:39], v[72:75]
    ds_read_b128 v[60:63], v18 offset:19456
    v_mfma_f32_16x16x32_bf16 v[76:79], a[68:71], v[36:39], v[76:79]
    s_waitcnt lgkmcnt(4)
    v_mfma_f32_16x16x32_bf16 v[64:67], a[72:75], v[40:43], v[64:67]
    ds_read_b128 v[32:35], v17 offset:24576
    v_mfma_f32_16x16x32_bf16 v[68:71], a[76:79], v[40:43], v[68:71]
    v_mfma_f32_16x16x32_bf16 v[72:75], a[72:75], v[44:47], v[72:75]
    ds_read_b128 v[36:39], v18 offset:24576
    v_mfma_f32_16x16x32_bf16 v[76:79], a[76:79], v[44:47], v[76:79]
    s_waitcnt lgkmcnt(4)
    v_mfma_f32_16x16x32_bf16 v[64:67], a[80:83], v[48:51], v[64:67]
    ds_read_b128 v[40:43], v17 offset:25600
    v_mfma_f32_16x16x32_bf16 v[68:71], a[84:87], v[48:51], v[68:71]
    v_mfma_f32_16x16x32_bf16 v[72:75], a[80:83], v[52:55], v[72:75]
    ds_read_b128 v[44:47], v18 offset:25600
    v_mfma_f32_16x16x32_bf16 v[76:79], a[84:87], v[52:55], v[76:79]
    s_waitcnt lgkmcnt(4)
    v_mfma_f32_16x16x32_bf16 v[64:67], a[88:91], v[56:59], v[64:67]
    ds_read_b128 v[48:51], v17 offset:26624
    v_mfma_f32_16x16x32_bf16 v[68:71], a[92:95], v[56:59], v[68:71]
    v_mfma_f32_16x16x32_bf16 v[72:75], a[88:91], v[60:63], v[72:75]
    ds_read_b128 v[52:55], v18 offset:26624
    v_mfma_f32_16x16x32_bf16 v[76:79], a[92:95], v[60:63], v[76:79]
    s_waitcnt lgkmcnt(4)
    v_mfma_f32_16x16x32_bf16 v[64:67], a[96:99], v[32:35], v[64:67]
    ds_read_b128 v[56:59], v17 offset:27648
    v_mfma_f32_16x16x32_bf16 v[68:71], a[100:103], v[32:35], v[68:71]
    v_mfma_f32_16x16x32_bf16 v[72:75], a[96:99], v[36:39], v[72:75]
    ds_read_b128 v[60:63], v18 offset:27648
    v_mfma_f32_16x16x32_bf16 v[76:79], a[100:103], v[36:39], v[76:79]
    s_waitcnt lgkmcnt(4)
    v_mfma_f32_16x16x32_bf16 v[64:67], a[104:107], v[40:43], v[64:67]
    ds_read_b128 v[32:35], v17 offset:32768
    v_mfma_f32_16x16x32_bf16 v[68:71], a[108:111], v[40:43], v[68:71]
    v_mfma_f32_16x16x32_bf16 v[72:75], a[104:107], v[44:47], v[72:75]
    ds_read_b128 v[36:39], v18 offset:32768
    v_mfma_f32_16x16x32_bf16 v[76:79], a[108:111], v[44:47], v[76:79]
    s_waitcnt lgkmcnt(4)
    v_mfma_f32_16x16x32_bf16 v[64:67], a[112:115], v[48:51], v[64:67]
    ds_read_b128 v[40:43], v17 offset:33792
    v_mfma_f32_16x16x32_bf16 v[68:71], a[116:119], v[48:51], v[68:71]
    v_mfma_f32_16x16x32_bf16 v[72:75], a[112:115], v[52:55], v[72:75]
    ds_read_b128 v[44:47], v18 offset:33792
    v_mfma_f32_16x16x32_bf16 v[76:79], a[116:119], v[52:55], v[76:79]
    s_waitcnt lgkmcnt(4)
    v_mfma_f32_16x16x32_bf16 v[64:67], a[120:123], v[56:59], v[64:67]
    ds_read_b128 v[48:51], v17 offset:34816
    v_mfma_f32_16x16x32_bf16 v[68:71], a[124:127], v[56:59], v[68:71]
    v_mfma_f32_16x16x32_bf16 v[72:75], a[120:123], v[60:63], v[72:75]
    ds_read_b128 v[52:55], v18 offset:34816
    v_mfma_f32_16x16x32_bf16 v[76:79], a[124:127], v[60:63], v[76:79]
    s_waitcnt lgkmcnt(4)
    v_mfma_f32_16x16x32_bf16 v[64:67], a[128:131], v[32:35], v[64:67]
    ds_read_b128 v[56:59], v17 offset:35840
    v_mfma_f32_16x16x32_bf16 v[68:71], a[132:135], v[32:35], v[68:71]
    v_mfma_f32_16x16x32_bf16 v[72:75], a[128:131], v[36:39], v[72:75]
    ds_read_b128 v[60:63], v18 offset:35840
    v_mfma_f32_16x16x32_bf16 v[76:79], a[132:135], v[36:39], v[76:79]
    s_waitcnt lgkmcnt(4)
    v_mfma_f32_16x16x32_bf16 v[64:67], a[136:139], v[40:43], v[64:67]
    ds_read_b128 v[32:35], v17 offset:40960
    v_mfma_f32_16x16x32_bf16 v[68:71], a[140:143], v[40:43], v[68:71]
    v_mfma_f32_16x16x32_bf16 v[72:75], a[136:139], v[44:47], v[72:75]
    ds_read_b128 v[36:39], v18 offset:40960
    v_mfma_f32_16x16x32_bf16 v[76:79], a[140:143], v[44:47], v[76:79]
    s_waitcnt lgkmcnt(4)
    v_mfma_f32_16x16x32_bf16 v[64:67], a[144:147], v[48:51], v[64:67]
    ds_read_b128 v[40:43], v17 offset:41984
    v_mfma_f32_16x16x32_bf16 v[68:71], a[148:151], v[48:51], v[68:71]
    v_mfma_f32_16x16x32_bf16 v[72:75], a[144:147], v[52:55], v[72:75]
    ds_read_b128 v[44:47], v18 offset:41984
    v_mfma_f32_16x16x32_bf16 v[76:79], a[148:151], v[52:55], v[76:79]
    s_waitcnt lgkmcnt(4)
    v_mfma_f32_16x16x32_bf16 v[64:67], a[152:155], v[56:59], v[64:67]
    ds_read_b128 v[48:51], v17 offset:43008
    v_mfma_f32_16x16x32_bf16 v[68:71], a[156:159], v[56:59], v[68:71]
    v_mfma_f32_16x16x32_bf16 v[72:75], a[152:155], v[60:63], v[72:75]
    ds_read_b128 v[52:55], v18 offset:43008
    v_mfma_f32_16x16x32_bf16 v[76:79], a[156:159], v[60:63], v[76:79]
    s_waitcnt lgkmcnt(4)
    v_mfma_f32_16x16x32_bf16 v[64:67], a[160:163], v[32:35], v[64:67]
    ds_read_b128 v[56:59], v17 offset:44032
    v_mfma_f32_16x16x32_bf16 v[68:71], a[164:167], v[32:35], v[68:71]
    v_mfma_f32_16x16x32_bf16 v[72:75], a[160:163], v[36:39], v[72:75]
    ds_read_b128 v[60:63], v18 offset:44032
    v_mfma_f32_16x16x32_bf16 v[76:79], a[164:167], v[36:39], v[76:79]
    s_waitcnt lgkmcnt(4)
    v_mfma_f32_16x16x32_bf16 v[64:67], a[168:171], v[40:43], v[64:67]
    ds_read_b128 v[32:35], v17 offset:49152
    v_mfma_f32_16x16x32_bf16 v[68:71], a[172:175], v[40:43], v[68:71]
    v_mfma_f32_16x16x32_bf16 v[72:75], a[168:171], v[44:47], v[72:75]
    ds_read_b128 v[36:39], v18 offset:49152
    v_mfma_f32_16x16x32_bf16 v[76:79], a[172:175], v[44:47], v[76:79]
    s_waitcnt lgkmcnt(4)
    v_mfma_f32_16x16x32_bf16 v[64:67], a[176:179], v[48:51], v[64:67]
    ds_read_b128 v[40:43], v17 offset:50176
    v_mfma_f32_16x16x32_bf16 v[68:71], a[180:183], v[48:51], v[68:71]
    v_mfma_f32_16x16x32_bf16 v[72:75], a[176:179], v[52:55], v[72:75]
    ds_read_b128 v[44:47], v18 offset:50176
    v_mfma_f32_16x16x32_bf16 v[76:79], a[180:183], v[52:55], v[76:79]
    s_waitcnt lgkmcnt(4)
    v_mfma_f32_16x16x32_bf16 v[64:67], a[184:187], v[56:59], v[64:67]
    ds_read_b128 v[48:51], v17 offset:51200
    v_mfma_f32_16x16x32_bf16 v[68:71], a[188:191], v[56:59], v[68:71]
    v_mfma_f32_16x16x32_bf16 v[72:75], a[184:187], v[60:63], v[72:75]
    ds_read_b128 v[52:55], v18 offset:51200
    v_mfma_f32_16x16x32_bf16 v[76:79], a[188:191], v[60:63], v[76:79]
    s_waitcnt lgkmcnt(4)
    v_mfma_f32_16x16x32_bf16 v[64:67], a[192:195], v[32:35], v[64:67]
    ds_read_b128 v[56:59], v17 offset:52224
    v_mfma_f32_16x16x32_bf16 v[68:71], a[196:199], v[32:35], v[68:71]
    v_mfma_f32_16x16x32_bf16 v[72:75], a[192:195], v[36:39], v[72:75]
    ds_read_b128 v[60:63], v18 offset:52224
    v_mfma_f32_16x16x32_bf16 v[76:79], a[196:199], v[36:39], v[76:79]
    s_waitcnt lgkmcnt(4)
    v_mfma_f32_16x16x32_bf16 v[64:67], a[200:203], v[40:43], v[64:67]
    ds_read_b128 v[32:35], v17 offset:57344
    v_mfma_f32_16x16x32_bf16 v[68:71], a[204:207], v[40:43], v[68:71]
    v_mfma_f32_16x16x32_bf16 v[72:75], a[200:203], v[44:47], v[72:75]
    ds_read_b128 v[36:39], v18 offset:57344
    v_mfma_f32_16x16x32_bf16 v[76:79], a[204:207], v[44:47], v[76:79]
    s_waitcnt lgkmcnt(4)
    v_mfma_f32_16x16x32_bf16 v[64:67], a[208:211], v[48:51], v[64:67]
    ds_read_b128 v[40:43], v17 offset:58368
    v_mfma_f32_16x16x32_bf16 v[68:71], a[212:215], v[48:51], v[68:71]
    v_mfma_f32_16x16x32_bf16 v[72:75], a[208:211], v[52:55], v[72:75]
    ds_read_b128 v[44:47], v18 offset:58368
    v_mfma_f32_16x16x32_bf16 v[76:79], a[212:215], v[52:55], v[76:79]
    s_waitcnt lgkmcnt(4)
    v_mfma_f32_16x16x32_bf16 v[64:67], a[216:219], v[56:59], v[64:67]
    ds_read_b128 v[48:51], v17 offset:59392
    v_mfma_f32_16x16x32_bf16 v[68:71], a[220:223], v[56:59], v[68:71]
    v_mfma_f32_16x16x32_bf16 v[72:75], a[216:219], v[60:63], v[72:75]
    ds_read_b128 v[52:55], v18 offset:59392
    v_mfma_f32_16x16x32_bf16 v[76:79], a[220:223], v[60:63], v[76:79]
    s_waitcnt lgkmcnt(4)
    v_mfma_f32_16x16x32_bf16 v[64:67], a[224:227], v[32:35], v[64:67]
    ds_read_b128 v[56:59], v17 offset:60416
    v_mfma_f32_16x16x32_bf16 v[68:71], a[228:231], v[32:35], v[68:71]
    v_mfma_f32_16x16x32_bf16 v[72:75], a[224:227], v[36:39], v[72:75]
    ds_read_b128 v[60:63], v18 offset:60416
    v_mfma_f32_16x16x32_bf16 v[76:79], a[228:231], v[36:39], v[76:79]
    s_waitcnt lgkmcnt(4)
    v_mfma_f32_16x16x32_bf16 v[64:67], a[232:235], v[40:43], v[64:67]
    v_mfma_f32_16x16x32_bf16 v[68:71], a[236:239], v[40:43], v[68:71]
    v_mfma_f32_16x16x32_bf16 v[72:75], a[232:235], v[44:47], v[72:75]
    v_mfma_f32_16x16x32_bf16 v[76:79], a[236:239], v[44:47], v[76:79]
    s_waitcnt lgkmcnt(2)
    v_mfma_f32_16x16x32_bf16 v[64:67], a[240:243], v[48:51], v[64:67]
    v_mfma_f32_16x16x32_bf16 v[68:71], a[244:247], v[48:51], v[68:71]
    v_mfma_f32_16x16x32_bf16 v[72:75], a[240:243], v[52:55], v[72:75]
    v_mfma_f32_16x16x32_bf16 v[76:79], a[244:247], v[52:55], v[76:79]
    s_waitcnt lgkmcnt(0)
    v_mfma_f32_16x16x32_bf16 v[64:67], a[248:251], v[56:59], v[64:67]
    v_mfma_f32_16x16x32_bf16 v[68:71], a[252:255], v[56:59], v[68:71]
    v_mfma_f32_16x16x32_bf16 v[72:75], a[248:251], v[60:63], v[72:75]
    v_mfma_f32_16x16x32_bf16 v[76:79], a[252:255], v[60:63], v[76:79]
    v_xor_b32 v17, 0x10000, v17
    v_xor_b32 v18, 0x10000, v18
    s_add_u32 s4, s34, s37
    s_waitcnt vmcnt(0)

.g2st_376:
    s_nop 2
    v_min_u32 v68, 0xfffffffe, v68
    buffer_store_dwordx4 v[68:71], v28, s[8:11], s4 offen sc1
    v_min_u32 v72, 0xfffffffe, v72
    buffer_store_dwordx4 v[72:75], v29, s[8:11], s4 offen sc1
    v_min_u32 v76, 0xfffffffe, v76
    buffer_store_dwordx4 v[76:79], v30, s[8:11], s4 offen sc1
    s_cmp_eq_u32 s38, 0
    s_cbranch_scc1 .g2nc_377
    s_mov_b32 s62, 0
.cc_382:
    v_max3_u32 v4, v84, v88, v92
    v_cmp_eq_u32 vcc, -1, v4
    s_cbranch_vccz .cd_383

    buffer_load_dwordx4 v[84:87], v7, s[8:11], s51 offen sc1
    buffer_load_dwordx4 v[88:91], v8, s[8:11], s51 offen sc1
    buffer_load_dwordx4 v[92:95], v9, s[8:11], s51 offen sc1
    s_add_u32 s62, s62, 1
    s_cmp_gt_u32 s62, 0x400000
    s_cbranch_scc1 .mg_end_1
    s_waitcnt vmcnt(0)
    s_branch .cc_382

.cd_383:
    v_add_f32 v84, v84, v88
    v_add_f32 v80, v80, v92
    v_add_f32 v85, v85, v89
    v_add_f32 v81, v81, v93
    v_add_f32 v86, v86, v90
    v_add_f32 v82, v82, v94
    v_add_f32 v87, v87, v91
    v_add_f32 v83, v83, v95
    v_add_f32 v80, v80, v84
    v_add_f32 v81, v81, v85
    v_add_f32 v82, v82, v86
    v_add_f32 v83, v83, v87
    v_sub_f32 v104, 1.0, v100
    v_cvt_pk_bf16_f32 v104, v104, v104
    v_lshlrev_b32 v104, 16, v104

    v_cvt_pk_bf16_f32 v105, v80, v81
    v_lshlrev_b32 v107, 16, v96
    v_and_b32 v108, 0xffff0000, v96
    v_lshlrev_b32 v109, 16, v98
    v_and_b32 v110, 0xffff0000, v98
    v_and_b32 v106, 0xffff0000, v105
    v_lshlrev_b32 v105, 16, v105
    v_mul_f32 v107, v107, v109
    v_mul_f32 v108, v108, v110
    v_mul_f32 v105, v104, v105
    v_mul_f32 v106, v104, v106
    v_cvt_pk_bf16_f32 v107, v107, v108
    v_cvt_pk_bf16_f32 v105, v105, v106
    v_and_b32 v108, 0xffff0000, v107
    v_lshlrev_b32 v107, 16, v107
    v_and_b32 v106, 0xffff0000, v105
    v_lshlrev_b32 v105, 16, v105
    v_mul_f32 v107, v100, v107
    v_mul_f32 v108, v100, v108
    v_cvt_pk_bf16_f32 v107, v107, v108
    v_and_b32 v108, 0xffff0000, v107
    v_lshlrev_b32 v107, 16, v107
    v_add_f32 v105, v105, v107
    v_add_f32 v106, v106, v108
    v_cvt_pk_bf16_f32 v102, v105, v106

    v_cvt_pk_bf16_f32 v105, v82, v83
    v_lshlrev_b32 v107, 16, v97
    v_and_b32 v108, 0xffff0000, v97
    v_lshlrev_b32 v109, 16, v99
    v_and_b32 v110, 0xffff0000, v99
    v_and_b32 v106, 0xffff0000, v105
    v_lshlrev_b32 v105, 16, v105
    v_mul_f32 v107, v107, v109
    v_mul_f32 v108, v108, v110
    v_mul_f32 v105, v104, v105
    v_mul_f32 v106, v104, v106
    v_cvt_pk_bf16_f32 v107, v107, v108
    v_cvt_pk_bf16_f32 v105, v105, v106
    v_and_b32 v108, 0xffff0000, v107
    v_lshlrev_b32 v107, 16, v107
    v_and_b32 v106, 0xffff0000, v105
    v_lshlrev_b32 v105, 16, v105
    v_mul_f32 v107, v100, v107
    v_mul_f32 v108, v100, v108
    v_cvt_pk_bf16_f32 v107, v107, v108
    v_and_b32 v108, 0xffff0000, v107
    v_lshlrev_b32 v107, 16, v107
    v_add_f32 v105, v105, v107
    v_add_f32 v106, v106, v108
    v_cvt_pk_bf16_f32 v103, v105, v106

    buffer_store_dwordx2 v[102:103], v22, s[44:47], s52 offen
.g2nc_377:
    v_mov_b32 v80, v64
    v_mov_b32 v81, v65
    v_mov_b32 v82, v66
    v_mov_b32 v83, v67
    s_cmp_lg_u32 s56, 0
    s_cbranch_scc1 .g2pf_384
    s_add_u32 s51, s34, s37
    s_lshl_b32 s52, s31, 16
    s_lshl_b32 s5, s31, 7
    s_add_u32 s4, s5, 117440512
    s_add_u32 s6, s5, 117448704
    s_add_u32 s5, s5, 121634816
    buffer_load_dwordx2 v[96:97], v22, s[16:19], s52 offen
    buffer_load_dword v98, v23, s[8:11], s4 offen
    buffer_load_dword v99, v23, s[8:11], s6 offen
    buffer_load_dword v100, v16, s[8:11], s5 offen

    buffer_load_dwordx4 v[84:87], v7, s[8:11], s51 offen sc1
    buffer_load_dwordx4 v[88:91], v8, s[8:11], s51 offen sc1
    buffer_load_dwordx4 v[92:95], v9, s[8:11], s51 offen sc1
    s_waitcnt vmcnt(0)
    s_mov_b32 s62, 0
.cc_385:
    v_max3_u32 v4, v84, v88, v92
    v_cmp_eq_u32 vcc, -1, v4
    s_cbranch_vccz .cd_386

    buffer_load_dwordx4 v[84:87], v7, s[8:11], s51 offen sc1
    buffer_load_dwordx4 v[88:91], v8, s[8:11], s51 offen sc1
    buffer_load_dwordx4 v[92:95], v9, s[8:11], s51 offen sc1
    s_add_u32 s62, s62, 1
    s_cmp_gt_u32 s62, 0x400000
    s_cbranch_scc1 .mg_end_1
    s_waitcnt vmcnt(0)
    s_branch .cc_385

.cd_386:
    v_add_f32 v84, v84, v88
    v_add_f32 v80, v80, v92
    v_add_f32 v85, v85, v89
    v_add_f32 v81, v81, v93
    v_add_f32 v86, v86, v90
    v_add_f32 v82, v82, v94
    v_add_f32 v87, v87, v91
    v_add_f32 v83, v83, v95
    v_add_f32 v80, v80, v84
    v_add_f32 v81, v81, v85
    v_add_f32 v82, v82, v86
    v_add_f32 v83, v83, v87
    v_sub_f32 v104, 1.0, v100
    v_cvt_pk_bf16_f32 v104, v104, v104
    v_lshlrev_b32 v104, 16, v104

    v_cvt_pk_bf16_f32 v105, v80, v81
    v_lshlrev_b32 v107, 16, v96
    v_and_b32 v108, 0xffff0000, v96
    v_lshlrev_b32 v109, 16, v98
    v_and_b32 v110, 0xffff0000, v98
    v_and_b32 v106, 0xffff0000, v105
    v_lshlrev_b32 v105, 16, v105
    v_mul_f32 v107, v107, v109
    v_mul_f32 v108, v108, v110
    v_mul_f32 v105, v104, v105
    v_mul_f32 v106, v104, v106
    v_cvt_pk_bf16_f32 v107, v107, v108
    v_cvt_pk_bf16_f32 v105, v105, v106
    v_and_b32 v108, 0xffff0000, v107
    v_lshlrev_b32 v107, 16, v107
    v_and_b32 v106, 0xffff0000, v105
    v_lshlrev_b32 v105, 16, v105
    v_mul_f32 v107, v100, v107
    v_mul_f32 v108, v100, v108
    v_cvt_pk_bf16_f32 v107, v107, v108
    v_and_b32 v108, 0xffff0000, v107
    v_lshlrev_b32 v107, 16, v107
    v_add_f32 v105, v105, v107
    v_add_f32 v106, v106, v108
    v_cvt_pk_bf16_f32 v102, v105, v106

    v_cvt_pk_bf16_f32 v105, v82, v83
    v_lshlrev_b32 v107, 16, v97
    v_and_b32 v108, 0xffff0000, v97
    v_lshlrev_b32 v109, 16, v99
    v_and_b32 v110, 0xffff0000, v99
    v_and_b32 v106, 0xffff0000, v105
    v_lshlrev_b32 v105, 16, v105
    v_mul_f32 v107, v107, v109
    v_mul_f32 v108, v108, v110
    v_mul_f32 v105, v104, v105
    v_mul_f32 v106, v104, v106
    v_cvt_pk_bf16_f32 v107, v107, v108
    v_cvt_pk_bf16_f32 v105, v105, v106
    v_and_b32 v108, 0xffff0000, v107
    v_lshlrev_b32 v107, 16, v107
    v_and_b32 v106, 0xffff0000, v105
    v_lshlrev_b32 v105, 16, v105
    v_mul_f32 v107, v100, v107
    v_mul_f32 v108, v100, v108
    v_cvt_pk_bf16_f32 v107, v107, v108
    v_and_b32 v108, 0xffff0000, v107
    v_lshlrev_b32 v107, 16, v107
    v_add_f32 v105, v105, v107
    v_add_f32 v106, v106, v108
    v_cvt_pk_bf16_f32 v103, v105, v106

    buffer_store_dwordx2 v[102:103], v22, s[44:47], s52 offen
    s_mov_b32 s38, 0
    s_mov_b32 s31, s53
    s_add_u32 s37, s37, 0x10000
    s_cmp_lt_u32 s31, 64
    s_cbranch_scc1 .g2blk_371
    s_branch .g2fin_379

.g2pf_384:
    s_mov_b32 s31, s53
    s_add_u32 s37, s37, 0x10000
    s_cmp_eq_u32 s38, 0
    s_mov_b32 s38, 1
    s_cbranch_scc1 .g2w3_373
    s_waitcnt vmcnt(4)
    s_branch .g2go_372

.g2w3_373:
    s_waitcnt vmcnt(3)
    s_branch .g2go_372
.g2fin_379:
    s_endpgm
.cvrole_354:
    s_cmp_lg_u32 s24, 0
    s_cbranch_scc1 .pm_387
    s_lshl_b32 s93, s91, 3
    s_add_u32 s93, s93, s26
    s_sub_u32 s93, s93, 24
    s_and_b32 s94, s93, 1
    s_sub_u32 s5, 0, s100
    s_and_b32 s5, s5, 0x1fffff
    s_add_u32 s5, s5, 100663296
    s_lshl_b32 s4, s94, 21
    s_add_u32 s5, s5, s4
    s_lshl_b32 s4, s93, 8
    s_add_u32 s5, s5, s4
    s_add_u32 s6, s5, 8192
    v_and_b32 v4, 63, v0
    v_lshlrev_b32 v4, 2, v4
    v_mov_b32 v5, -1
    s_mov_b32 s82, 0x7fffffff
    s_mov_b32 s83, 0x7fffffff
    buffer_store_dword v5, v4, s[8:11], s5 offen sc1
    s_waitcnt vmcnt(0)

    s_memtime s[72:73]
    s_waitcnt lgkmcnt(0)
    buffer_store_dword v5, v4, s[8:11], s6 offen sc1
    s_waitcnt vmcnt(0)
    s_memtime s[84:85]
    s_waitcnt lgkmcnt(0)
    s_sub_u32 s84, s84, s72
    s_min_u32 s83, s83, s84

    s_memtime s[72:73]
    s_waitcnt lgkmcnt(0)
    buffer_store_dword v5, v4, s[8:11], s5 offen sc1
    s_waitcnt vmcnt(0)
    s_memtime s[84:85]
    s_waitcnt lgkmcnt(0)
    s_sub_u32 s84, s84, s72
    s_min_u32 s82, s82, s84

    s_memtime s[72:73]
    s_waitcnt lgkmcnt(0)
    buffer_store_dword v5, v4, s[8:11], s6 offen sc1
    s_waitcnt vmcnt(0)
    s_memtime s[84:85]
    s_waitcnt lgkmcnt(0)
    s_sub_u32 s84, s84, s72
    s_min_u32 s83, s83, s84

    s_memtime s[72:73]
    s_waitcnt lgkmcnt(0)
    buffer_store_dword v5, v4, s[8:11], s5 offen sc1
    s_waitcnt vmcnt(0)
    s_memtime s[84:85]
    s_waitcnt lgkmcnt(0)
    s_sub_u32 s84, s84, s72
    s_min_u32 s82, s82, s84

    s_cmp_lt_u32 s82, s83
    s_cselect_b32 s4, 1, 0
    s_mul_i32 s94, s94, 6
    s_lshl_b32 s4, s4, s94
    s_add_u32 s95, s4, 0x1000000

.pm_387:
    v_and_b32 v243, 7, v0
    v_lshlrev_b32 v243, 2, v243
    buffer_load_dword v242, v243, s[20:23], 0 offen sc1

    s_waitcnt vmcnt(0)
    s_cmp_lg_u32 s97, 0
    s_cbranch_scc1 .vd_389
    s_mov_b32 s62, 0

.vp_388:
    v_cmp_ne_u32 vcc, 32, v242
    s_cbranch_vccz .vd_389
    v_readlane_b32 s4, v242, 0

    v_readlane_b32 s5, v242, 1
    s_add_u32 s4, s4, s5
    v_readlane_b32 s5, v242, 2
    s_add_u32 s4, s4, s5
    v_readlane_b32 s5, v242, 3
    s_add_u32 s4, s4, s5
    v_readlane_b32 s5, v242, 4
    s_add_u32 s4, s4, s5
    v_readlane_b32 s5, v242, 5
    s_add_u32 s4, s4, s5
    v_readlane_b32 s5, v242, 6
    s_add_u32 s4, s4, s5
    v_readlane_b32 s5, v242, 7
    s_add_u32 s4, s4, s5
    s_cmp_ge_u32 s4, 256
    s_cbranch_scc1 .vs_390
    s_add_u32 s62, s62, 1
    s_cmp_gt_u32 s62, 0x100000
    s_cbranch_scc1 .mg_end_1
    s_sleep 4
    buffer_load_dword v242, v243, s[20:23], 0 offen sc1
    s_waitcnt vmcnt(0)
    s_branch .vp_388

.vs_390:
    s_lshr_b32 s25, s2, 5
    s_and_b32 s26, s2, 31
    s_mov_b32 s27, 1
    s_mov_b32 s97, 1
    s_waitcnt vmcnt(0) lgkmcnt(0)
    s_barrier
    s_branch .mg_role_3

.vd_389:
    s_mov_b32 s97, 1
    s_cmp_lg_u32 s24, 0
    s_cbranch_scc1 .pv_391
    s_mov_b64 exec, 1
    v_mov_b32 v4, s95
    v_mov_b32 v5, 36
    buffer_atomic_add v4, v5, s[20:23], 0 offen sc1
    s_mov_b64 exec, -1

.pv_391:
    s_lshl_b32 s4, s91, 3
    s_add_u32 s4, s4, s26
    s_add_u32 s4, s4, 72
    s_lshl_b32 s4, s4, 8
    s_add_u32 s92, s4, 92274688
    v_mov_b32 v4, 0
    s_mov_b64 exec, 1
    buffer_store_dword v4, v4, s[8:11], s92 offen sc1
    s_mov_b64 exec, -1

    s_waitcnt vmcnt(0) lgkmcnt(0)
    s_barrier
    s_mov_b32 s5, 32
    s_cmp_lg_u32 s24, 0
    s_cbranch_scc1 .sg_392
    s_mov_b64 exec, 1
    v_mov_b32 v4, 1
    v_mov_b32 v5, 0
    buffer_atomic_add v4, v5, s[20:23], s5 offen sc1
    s_mov_b64 exec, -1

.sg_392:
    s_lshl_b32 s93, s91, 3
    s_add_u32 s93, s93, s26
    s_sub_u32 s93, s93, 24
    s_mov_b32 s94, s93

.kp_393:
    s_mov_b32 s25, s94
    s_load_dwordx4 s[52:55], s[0:1], 8
    s_load_dwordx2 s[56:57], s[0:1], 24
    s_waitcnt lgkmcnt(0)

    s_mov_b32 s60, s52
    s_and_b32 s61, s53, 0xffff
    s_mov_b32 s62, 0x400000
    s_mov_b32 s63, 0x00020000

    s_mov_b32 s64, s54
    s_and_b32 s65, s55, 0xffff
    s_mov_b32 s66, 0x400000
    s_mov_b32 s67, 0x00020000

    s_mov_b32 s68, s56
    s_and_b32 s69, s57, 0xffff
    s_mov_b32 s70, 0x2000
    s_mov_b32 s71, 0x00020000

    s_lshr_b32 s4, s25, 4
    s_and_b32 s5, s25, 15
    v_lshrrev_b32 v10, 4, v0
    v_and_b32 v11, 15, v0
    s_lshl_b32 s6, s4, 7
    v_lshlrev_b32 v12, 3, v10
    v_add_u32 v12, s6, v12
    v_lshlrev_b32 v13, 11, v12
    s_lshl_b32 s7, s5, 7
    v_lshlrev_b32 v14, 3, v11
    v_add_u32 v14, s7, v14
    v_add_u32 v13, v13, v14
    v_subrev_u32 v15, 6144, v13
    v_subrev_u32 v16, 4096, v13
    v_subrev_u32 v17, 2048, v13
    v_lshlrev_b32 v18, 2, v14
    v_lshlrev_b32 v19, 11, v14
    v_lshlrev_b32 v12, 1, v12
    v_add_u32 v19, v19, v12

    v_lshlrev_b32 v19, 11, v14
    v_lshrrev_b32 v12, 6, v12
    v_lshl_add_u32 v19, v12, 4, v19
    v_and_b32 v12, 3, v10
    v_lshl_add_u32 v19, v12, 10, v19

    buffer_load_dwordx4 v[20:23], v18, s[68:71], 0 offen
    buffer_load_dwordx4 v[24:27], v18, s[68:71], 0 offen offset:16

    buffer_load_dwordx2 v[28:29], v15, s[60:63], 0 offen
    buffer_load_dwordx2 v[30:31], v16, s[60:63], 0 offen
    buffer_load_dwordx2 v[32:33], v17, s[60:63], 0 offen
    s_mov_b32 s6, 0
    buffer_load_dwordx2 v[34:35], v13, s[60:63], s6 offen
    s_mov_b32 s6, 2048
    buffer_load_dwordx2 v[36:37], v13, s[60:63], s6 offen
    s_mov_b32 s6, 4096
    buffer_load_dwordx2 v[38:39], v13, s[60:63], s6 offen
    s_mov_b32 s6, 6144
    buffer_load_dwordx2 v[40:41], v13, s[60:63], s6 offen
    s_mov_b32 s6, 8192
    buffer_load_dwordx2 v[42:43], v13, s[60:63], s6 offen
    s_mov_b32 s6, 10240
    buffer_load_dwordx2 v[44:45], v13, s[60:63], s6 offen
    s_mov_b32 s6, 12288
    buffer_load_dwordx2 v[46:47], v13, s[60:63], s6 offen
    s_mov_b32 s6, 14336
    buffer_load_dwordx2 v[48:49], v13, s[60:63], s6 offen
    s_mov_b32 s6, 0
    buffer_load_dwordx2 v[50:51], v13, s[64:67], s6 offen
    s_mov_b32 s6, 2048
    buffer_load_dwordx2 v[52:53], v13, s[64:67], s6 offen
    s_mov_b32 s6, 4096
    buffer_load_dwordx2 v[54:55], v13, s[64:67], s6 offen
    s_mov_b32 s6, 6144
    buffer_load_dwordx2 v[56:57], v13, s[64:67], s6 offen
    s_mov_b32 s6, 8192
    buffer_load_dwordx2 v[58:59], v13, s[64:67], s6 offen
    s_mov_b32 s6, 10240
    buffer_load_dwordx2 v[60:61], v13, s[64:67], s6 offen
    s_mov_b32 s6, 12288
    buffer_load_dwordx2 v[62:63], v13, s[64:67], s6 offen
    s_mov_b32 s6, 14336
    buffer_load_dwordx2 v[64:65], v13, s[64:67], s6 offen
    s_waitcnt vmcnt(0)
    v_lshlrev_b32 v66, 16, v20
    v_and_b32 v67, 0xffff0000, v20
    v_lshlrev_b32 v68, 16, v21
    v_and_b32 v69, 0xffff0000, v21

    v_lshlrev_b32 v70, 16, v22
    v_and_b32 v71, 0xffff0000, v22
    v_lshlrev_b32 v72, 16, v23
    v_and_b32 v73, 0xffff0000, v23

    v_lshlrev_b32 v74, 16, v28
    v_and_b32 v86, 0xffff0000, v28
    v_lshlrev_b32 v75, 16, v30
    v_and_b32 v87, 0xffff0000, v30
    v_lshlrev_b32 v76, 16, v32
    v_and_b32 v88, 0xffff0000, v32
    v_lshlrev_b32 v77, 16, v34
    v_and_b32 v89, 0xffff0000, v34
    v_lshlrev_b32 v78, 16, v36
    v_and_b32 v90, 0xffff0000, v36
    v_lshlrev_b32 v79, 16, v38
    v_and_b32 v91, 0xffff0000, v38
    v_lshlrev_b32 v80, 16, v40
    v_and_b32 v92, 0xffff0000, v40
    v_lshlrev_b32 v81, 16, v42
    v_and_b32 v93, 0xffff0000, v42
    v_lshlrev_b32 v82, 16, v44
    v_and_b32 v94, 0xffff0000, v44
    v_lshlrev_b32 v83, 16, v46
    v_and_b32 v95, 0xffff0000, v46
    v_lshlrev_b32 v84, 16, v48
    v_and_b32 v96, 0xffff0000, v48
    v_mul_f32 v98, v69, v74
    v_mul_f32 v99, v73, v86
    v_cvt_pk_bf16_f32 v98, v98, v99
    v_and_b32 v99, 0xffff0000, v98
    v_lshlrev_b32 v98, 16, v98

    v_mul_f32 v100, v68, v75
    v_mul_f32 v101, v72, v87
    v_cvt_pk_bf16_f32 v100, v100, v101
    v_and_b32 v101, 0xffff0000, v100
    v_lshlrev_b32 v100, 16, v100
    v_add_f32 v98, v98, v100
    v_add_f32 v99, v99, v101
    v_cvt_pk_bf16_f32 v98, v98, v99
    v_and_b32 v99, 0xffff0000, v98
    v_lshlrev_b32 v98, 16, v98

    v_mul_f32 v100, v67, v76
    v_mul_f32 v101, v71, v88
    v_cvt_pk_bf16_f32 v100, v100, v101
    v_and_b32 v101, 0xffff0000, v100
    v_lshlrev_b32 v100, 16, v100
    v_add_f32 v98, v98, v100
    v_add_f32 v99, v99, v101
    v_cvt_pk_bf16_f32 v98, v98, v99
    v_and_b32 v99, 0xffff0000, v98
    v_lshlrev_b32 v98, 16, v98

    v_mul_f32 v100, v66, v77
    v_mul_f32 v101, v70, v89
    v_cvt_pk_bf16_f32 v100, v100, v101
    v_and_b32 v101, 0xffff0000, v100
    v_lshlrev_b32 v100, 16, v100
    v_add_f32 v98, v98, v100
    v_add_f32 v99, v99, v101
    v_cvt_pk_bf16_f32 v98, v98, v99
    v_and_b32 v99, 0xffff0000, v98
    v_lshlrev_b32 v98, 16, v98

    v_lshlrev_b32 v100, 16, v50
    v_and_b32 v101, 0xffff0000, v50
    v_mul_f32 v102, v98, v100
    v_mul_f32 v110, v99, v101
    v_cvt_pk_bf16_f32 v50, v102, v110

    v_mul_f32 v98, v69, v75
    v_mul_f32 v99, v73, v87
    v_cvt_pk_bf16_f32 v98, v98, v99
    v_and_b32 v99, 0xffff0000, v98
    v_lshlrev_b32 v98, 16, v98

    v_mul_f32 v100, v68, v76
    v_mul_f32 v101, v72, v88
    v_cvt_pk_bf16_f32 v100, v100, v101
    v_and_b32 v101, 0xffff0000, v100
    v_lshlrev_b32 v100, 16, v100
    v_add_f32 v98, v98, v100
    v_add_f32 v99, v99, v101
    v_cvt_pk_bf16_f32 v98, v98, v99
    v_and_b32 v99, 0xffff0000, v98
    v_lshlrev_b32 v98, 16, v98

    v_mul_f32 v100, v67, v77
    v_mul_f32 v101, v71, v89
    v_cvt_pk_bf16_f32 v100, v100, v101
    v_and_b32 v101, 0xffff0000, v100
    v_lshlrev_b32 v100, 16, v100
    v_add_f32 v98, v98, v100
    v_add_f32 v99, v99, v101
    v_cvt_pk_bf16_f32 v98, v98, v99
    v_and_b32 v99, 0xffff0000, v98
    v_lshlrev_b32 v98, 16, v98

    v_mul_f32 v100, v66, v78
    v_mul_f32 v101, v70, v90
    v_cvt_pk_bf16_f32 v100, v100, v101
    v_and_b32 v101, 0xffff0000, v100
    v_lshlrev_b32 v100, 16, v100
    v_add_f32 v98, v98, v100
    v_add_f32 v99, v99, v101
    v_cvt_pk_bf16_f32 v98, v98, v99
    v_and_b32 v99, 0xffff0000, v98
    v_lshlrev_b32 v98, 16, v98

    v_lshlrev_b32 v100, 16, v52
    v_and_b32 v101, 0xffff0000, v52
    v_mul_f32 v103, v98, v100
    v_mul_f32 v111, v99, v101
    v_cvt_pk_bf16_f32 v52, v103, v111

    v_mul_f32 v98, v69, v76
    v_mul_f32 v99, v73, v88
    v_cvt_pk_bf16_f32 v98, v98, v99
    v_and_b32 v99, 0xffff0000, v98
    v_lshlrev_b32 v98, 16, v98

    v_mul_f32 v100, v68, v77
    v_mul_f32 v101, v72, v89
    v_cvt_pk_bf16_f32 v100, v100, v101
    v_and_b32 v101, 0xffff0000, v100
    v_lshlrev_b32 v100, 16, v100
    v_add_f32 v98, v98, v100
    v_add_f32 v99, v99, v101
    v_cvt_pk_bf16_f32 v98, v98, v99
    v_and_b32 v99, 0xffff0000, v98
    v_lshlrev_b32 v98, 16, v98

    v_mul_f32 v100, v67, v78
    v_mul_f32 v101, v71, v90
    v_cvt_pk_bf16_f32 v100, v100, v101
    v_and_b32 v101, 0xffff0000, v100
    v_lshlrev_b32 v100, 16, v100
    v_add_f32 v98, v98, v100
    v_add_f32 v99, v99, v101
    v_cvt_pk_bf16_f32 v98, v98, v99
    v_and_b32 v99, 0xffff0000, v98
    v_lshlrev_b32 v98, 16, v98

    v_mul_f32 v100, v66, v79
    v_mul_f32 v101, v70, v91
    v_cvt_pk_bf16_f32 v100, v100, v101
    v_and_b32 v101, 0xffff0000, v100
    v_lshlrev_b32 v100, 16, v100
    v_add_f32 v98, v98, v100
    v_add_f32 v99, v99, v101
    v_cvt_pk_bf16_f32 v98, v98, v99
    v_and_b32 v99, 0xffff0000, v98
    v_lshlrev_b32 v98, 16, v98

    v_lshlrev_b32 v100, 16, v54
    v_and_b32 v101, 0xffff0000, v54
    v_mul_f32 v104, v98, v100
    v_mul_f32 v112, v99, v101
    v_cvt_pk_bf16_f32 v54, v104, v112

    v_mul_f32 v98, v69, v77
    v_mul_f32 v99, v73, v89
    v_cvt_pk_bf16_f32 v98, v98, v99
    v_and_b32 v99, 0xffff0000, v98
    v_lshlrev_b32 v98, 16, v98

    v_mul_f32 v100, v68, v78
    v_mul_f32 v101, v72, v90
    v_cvt_pk_bf16_f32 v100, v100, v101
    v_and_b32 v101, 0xffff0000, v100
    v_lshlrev_b32 v100, 16, v100
    v_add_f32 v98, v98, v100
    v_add_f32 v99, v99, v101
    v_cvt_pk_bf16_f32 v98, v98, v99
    v_and_b32 v99, 0xffff0000, v98
    v_lshlrev_b32 v98, 16, v98

    v_mul_f32 v100, v67, v79
    v_mul_f32 v101, v71, v91
    v_cvt_pk_bf16_f32 v100, v100, v101
    v_and_b32 v101, 0xffff0000, v100
    v_lshlrev_b32 v100, 16, v100
    v_add_f32 v98, v98, v100
    v_add_f32 v99, v99, v101
    v_cvt_pk_bf16_f32 v98, v98, v99
    v_and_b32 v99, 0xffff0000, v98
    v_lshlrev_b32 v98, 16, v98

    v_mul_f32 v100, v66, v80
    v_mul_f32 v101, v70, v92
    v_cvt_pk_bf16_f32 v100, v100, v101
    v_and_b32 v101, 0xffff0000, v100
    v_lshlrev_b32 v100, 16, v100
    v_add_f32 v98, v98, v100
    v_add_f32 v99, v99, v101
    v_cvt_pk_bf16_f32 v98, v98, v99
    v_and_b32 v99, 0xffff0000, v98
    v_lshlrev_b32 v98, 16, v98

    v_lshlrev_b32 v100, 16, v56
    v_and_b32 v101, 0xffff0000, v56
    v_mul_f32 v105, v98, v100
    v_mul_f32 v113, v99, v101
    v_cvt_pk_bf16_f32 v56, v105, v113

    v_mul_f32 v98, v69, v78
    v_mul_f32 v99, v73, v90
    v_cvt_pk_bf16_f32 v98, v98, v99
    v_and_b32 v99, 0xffff0000, v98
    v_lshlrev_b32 v98, 16, v98

    v_mul_f32 v100, v68, v79
    v_mul_f32 v101, v72, v91
    v_cvt_pk_bf16_f32 v100, v100, v101
    v_and_b32 v101, 0xffff0000, v100
    v_lshlrev_b32 v100, 16, v100
    v_add_f32 v98, v98, v100
    v_add_f32 v99, v99, v101
    v_cvt_pk_bf16_f32 v98, v98, v99
    v_and_b32 v99, 0xffff0000, v98
    v_lshlrev_b32 v98, 16, v98

    v_mul_f32 v100, v67, v80
    v_mul_f32 v101, v71, v92
    v_cvt_pk_bf16_f32 v100, v100, v101
    v_and_b32 v101, 0xffff0000, v100
    v_lshlrev_b32 v100, 16, v100
    v_add_f32 v98, v98, v100
    v_add_f32 v99, v99, v101
    v_cvt_pk_bf16_f32 v98, v98, v99
    v_and_b32 v99, 0xffff0000, v98
    v_lshlrev_b32 v98, 16, v98

    v_mul_f32 v100, v66, v81
    v_mul_f32 v101, v70, v93
    v_cvt_pk_bf16_f32 v100, v100, v101
    v_and_b32 v101, 0xffff0000, v100
    v_lshlrev_b32 v100, 16, v100
    v_add_f32 v98, v98, v100
    v_add_f32 v99, v99, v101
    v_cvt_pk_bf16_f32 v98, v98, v99
    v_and_b32 v99, 0xffff0000, v98
    v_lshlrev_b32 v98, 16, v98

    v_lshlrev_b32 v100, 16, v58
    v_and_b32 v101, 0xffff0000, v58
    v_mul_f32 v106, v98, v100
    v_mul_f32 v114, v99, v101
    v_cvt_pk_bf16_f32 v58, v106, v114

    v_mul_f32 v98, v69, v79
    v_mul_f32 v99, v73, v91
    v_cvt_pk_bf16_f32 v98, v98, v99
    v_and_b32 v99, 0xffff0000, v98
    v_lshlrev_b32 v98, 16, v98

    v_mul_f32 v100, v68, v80
    v_mul_f32 v101, v72, v92
    v_cvt_pk_bf16_f32 v100, v100, v101
    v_and_b32 v101, 0xffff0000, v100
    v_lshlrev_b32 v100, 16, v100
    v_add_f32 v98, v98, v100
    v_add_f32 v99, v99, v101
    v_cvt_pk_bf16_f32 v98, v98, v99
    v_and_b32 v99, 0xffff0000, v98
    v_lshlrev_b32 v98, 16, v98

    v_mul_f32 v100, v67, v81
    v_mul_f32 v101, v71, v93
    v_cvt_pk_bf16_f32 v100, v100, v101
    v_and_b32 v101, 0xffff0000, v100
    v_lshlrev_b32 v100, 16, v100
    v_add_f32 v98, v98, v100
    v_add_f32 v99, v99, v101
    v_cvt_pk_bf16_f32 v98, v98, v99
    v_and_b32 v99, 0xffff0000, v98
    v_lshlrev_b32 v98, 16, v98

    v_mul_f32 v100, v66, v82
    v_mul_f32 v101, v70, v94
    v_cvt_pk_bf16_f32 v100, v100, v101
    v_and_b32 v101, 0xffff0000, v100
    v_lshlrev_b32 v100, 16, v100
    v_add_f32 v98, v98, v100
    v_add_f32 v99, v99, v101
    v_cvt_pk_bf16_f32 v98, v98, v99
    v_and_b32 v99, 0xffff0000, v98
    v_lshlrev_b32 v98, 16, v98

    v_lshlrev_b32 v100, 16, v60
    v_and_b32 v101, 0xffff0000, v60
    v_mul_f32 v107, v98, v100
    v_mul_f32 v115, v99, v101
    v_cvt_pk_bf16_f32 v60, v107, v115

    v_mul_f32 v98, v69, v80
    v_mul_f32 v99, v73, v92
    v_cvt_pk_bf16_f32 v98, v98, v99
    v_and_b32 v99, 0xffff0000, v98
    v_lshlrev_b32 v98, 16, v98

    v_mul_f32 v100, v68, v81
    v_mul_f32 v101, v72, v93
    v_cvt_pk_bf16_f32 v100, v100, v101
    v_and_b32 v101, 0xffff0000, v100
    v_lshlrev_b32 v100, 16, v100
    v_add_f32 v98, v98, v100
    v_add_f32 v99, v99, v101
    v_cvt_pk_bf16_f32 v98, v98, v99
    v_and_b32 v99, 0xffff0000, v98
    v_lshlrev_b32 v98, 16, v98

    v_mul_f32 v100, v67, v82
    v_mul_f32 v101, v71, v94
    v_cvt_pk_bf16_f32 v100, v100, v101
    v_and_b32 v101, 0xffff0000, v100
    v_lshlrev_b32 v100, 16, v100
    v_add_f32 v98, v98, v100
    v_add_f32 v99, v99, v101
    v_cvt_pk_bf16_f32 v98, v98, v99
    v_and_b32 v99, 0xffff0000, v98
    v_lshlrev_b32 v98, 16, v98

    v_mul_f32 v100, v66, v83
    v_mul_f32 v101, v70, v95
    v_cvt_pk_bf16_f32 v100, v100, v101
    v_and_b32 v101, 0xffff0000, v100
    v_lshlrev_b32 v100, 16, v100
    v_add_f32 v98, v98, v100
    v_add_f32 v99, v99, v101
    v_cvt_pk_bf16_f32 v98, v98, v99
    v_and_b32 v99, 0xffff0000, v98
    v_lshlrev_b32 v98, 16, v98

    v_lshlrev_b32 v100, 16, v62
    v_and_b32 v101, 0xffff0000, v62
    v_mul_f32 v108, v98, v100
    v_mul_f32 v116, v99, v101
    v_cvt_pk_bf16_f32 v62, v108, v116

    v_mul_f32 v98, v69, v81
    v_mul_f32 v99, v73, v93
    v_cvt_pk_bf16_f32 v98, v98, v99
    v_and_b32 v99, 0xffff0000, v98
    v_lshlrev_b32 v98, 16, v98

    v_mul_f32 v100, v68, v82
    v_mul_f32 v101, v72, v94
    v_cvt_pk_bf16_f32 v100, v100, v101
    v_and_b32 v101, 0xffff0000, v100
    v_lshlrev_b32 v100, 16, v100
    v_add_f32 v98, v98, v100
    v_add_f32 v99, v99, v101
    v_cvt_pk_bf16_f32 v98, v98, v99
    v_and_b32 v99, 0xffff0000, v98
    v_lshlrev_b32 v98, 16, v98

    v_mul_f32 v100, v67, v83
    v_mul_f32 v101, v71, v95
    v_cvt_pk_bf16_f32 v100, v100, v101
    v_and_b32 v101, 0xffff0000, v100
    v_lshlrev_b32 v100, 16, v100
    v_add_f32 v98, v98, v100
    v_add_f32 v99, v99, v101
    v_cvt_pk_bf16_f32 v98, v98, v99
    v_and_b32 v99, 0xffff0000, v98
    v_lshlrev_b32 v98, 16, v98

    v_mul_f32 v100, v66, v84
    v_mul_f32 v101, v70, v96
    v_cvt_pk_bf16_f32 v100, v100, v101
    v_and_b32 v101, 0xffff0000, v100
    v_lshlrev_b32 v100, 16, v100
    v_add_f32 v98, v98, v100
    v_add_f32 v99, v99, v101
    v_cvt_pk_bf16_f32 v98, v98, v99
    v_and_b32 v99, 0xffff0000, v98
    v_lshlrev_b32 v98, 16, v98

    v_lshlrev_b32 v100, 16, v64
    v_and_b32 v101, 0xffff0000, v64
    v_mul_f32 v109, v98, v100
    v_mul_f32 v117, v99, v101
    v_cvt_pk_bf16_f32 v64, v109, v117

    v_cvt_pk_bf16_f32 v118, v109, v108
    v_cvt_pk_bf16_f32 v119, v107, v106
    v_cvt_pk_bf16_f32 v120, v105, v104
    v_cvt_pk_bf16_f32 v121, v103, v102
    s_mov_b32 s6, 125829120
    buffer_store_dwordx4 v[118:121], v19, s[8:11], s6 offen sc1
    v_cvt_pk_bf16_f32 v122, v117, v116
    v_cvt_pk_bf16_f32 v123, v115, v114
    v_cvt_pk_bf16_f32 v124, v113, v112
    v_cvt_pk_bf16_f32 v125, v111, v110
    s_mov_b32 s6, 125833216
    buffer_store_dwordx4 v[122:125], v19, s[8:11], s6 offen sc1
    s_nop 1
    v_lshlrev_b32 v66, 16, v24
    v_and_b32 v67, 0xffff0000, v24
    v_lshlrev_b32 v68, 16, v25
    v_and_b32 v69, 0xffff0000, v25

    v_lshlrev_b32 v70, 16, v26
    v_and_b32 v71, 0xffff0000, v26
    v_lshlrev_b32 v72, 16, v27
    v_and_b32 v73, 0xffff0000, v27

    v_lshlrev_b32 v74, 16, v29
    v_and_b32 v86, 0xffff0000, v29
    v_lshlrev_b32 v75, 16, v31
    v_and_b32 v87, 0xffff0000, v31
    v_lshlrev_b32 v76, 16, v33
    v_and_b32 v88, 0xffff0000, v33
    v_lshlrev_b32 v77, 16, v35
    v_and_b32 v89, 0xffff0000, v35
    v_lshlrev_b32 v78, 16, v37
    v_and_b32 v90, 0xffff0000, v37
    v_lshlrev_b32 v79, 16, v39
    v_and_b32 v91, 0xffff0000, v39
    v_lshlrev_b32 v80, 16, v41
    v_and_b32 v92, 0xffff0000, v41
    v_lshlrev_b32 v81, 16, v43
    v_and_b32 v93, 0xffff0000, v43
    v_lshlrev_b32 v82, 16, v45
    v_and_b32 v94, 0xffff0000, v45
    v_lshlrev_b32 v83, 16, v47
    v_and_b32 v95, 0xffff0000, v47
    v_lshlrev_b32 v84, 16, v49
    v_and_b32 v96, 0xffff0000, v49
    v_mul_f32 v98, v69, v74
    v_mul_f32 v99, v73, v86
    v_cvt_pk_bf16_f32 v98, v98, v99
    v_and_b32 v99, 0xffff0000, v98
    v_lshlrev_b32 v98, 16, v98

    v_mul_f32 v100, v68, v75
    v_mul_f32 v101, v72, v87
    v_cvt_pk_bf16_f32 v100, v100, v101
    v_and_b32 v101, 0xffff0000, v100
    v_lshlrev_b32 v100, 16, v100
    v_add_f32 v98, v98, v100
    v_add_f32 v99, v99, v101
    v_cvt_pk_bf16_f32 v98, v98, v99
    v_and_b32 v99, 0xffff0000, v98
    v_lshlrev_b32 v98, 16, v98

    v_mul_f32 v100, v67, v76
    v_mul_f32 v101, v71, v88
    v_cvt_pk_bf16_f32 v100, v100, v101
    v_and_b32 v101, 0xffff0000, v100
    v_lshlrev_b32 v100, 16, v100
    v_add_f32 v98, v98, v100
    v_add_f32 v99, v99, v101
    v_cvt_pk_bf16_f32 v98, v98, v99
    v_and_b32 v99, 0xffff0000, v98
    v_lshlrev_b32 v98, 16, v98

    v_mul_f32 v100, v66, v77
    v_mul_f32 v101, v70, v89
    v_cvt_pk_bf16_f32 v100, v100, v101
    v_and_b32 v101, 0xffff0000, v100
    v_lshlrev_b32 v100, 16, v100
    v_add_f32 v98, v98, v100
    v_add_f32 v99, v99, v101
    v_cvt_pk_bf16_f32 v98, v98, v99
    v_and_b32 v99, 0xffff0000, v98
    v_lshlrev_b32 v98, 16, v98

    v_lshlrev_b32 v100, 16, v51
    v_and_b32 v101, 0xffff0000, v51
    v_mul_f32 v102, v98, v100
    v_mul_f32 v110, v99, v101
    v_cvt_pk_bf16_f32 v51, v102, v110

    v_mul_f32 v98, v69, v75
    v_mul_f32 v99, v73, v87
    v_cvt_pk_bf16_f32 v98, v98, v99
    v_and_b32 v99, 0xffff0000, v98
    v_lshlrev_b32 v98, 16, v98

    v_mul_f32 v100, v68, v76
    v_mul_f32 v101, v72, v88
    v_cvt_pk_bf16_f32 v100, v100, v101
    v_and_b32 v101, 0xffff0000, v100
    v_lshlrev_b32 v100, 16, v100
    v_add_f32 v98, v98, v100
    v_add_f32 v99, v99, v101
    v_cvt_pk_bf16_f32 v98, v98, v99
    v_and_b32 v99, 0xffff0000, v98
    v_lshlrev_b32 v98, 16, v98

    v_mul_f32 v100, v67, v77
    v_mul_f32 v101, v71, v89
    v_cvt_pk_bf16_f32 v100, v100, v101
    v_and_b32 v101, 0xffff0000, v100
    v_lshlrev_b32 v100, 16, v100
    v_add_f32 v98, v98, v100
    v_add_f32 v99, v99, v101
    v_cvt_pk_bf16_f32 v98, v98, v99
    v_and_b32 v99, 0xffff0000, v98
    v_lshlrev_b32 v98, 16, v98

    v_mul_f32 v100, v66, v78
    v_mul_f32 v101, v70, v90
    v_cvt_pk_bf16_f32 v100, v100, v101
    v_and_b32 v101, 0xffff0000, v100
    v_lshlrev_b32 v100, 16, v100
    v_add_f32 v98, v98, v100
    v_add_f32 v99, v99, v101
    v_cvt_pk_bf16_f32 v98, v98, v99
    v_and_b32 v99, 0xffff0000, v98
    v_lshlrev_b32 v98, 16, v98

    v_lshlrev_b32 v100, 16, v53
    v_and_b32 v101, 0xffff0000, v53
    v_mul_f32 v103, v98, v100
    v_mul_f32 v111, v99, v101
    v_cvt_pk_bf16_f32 v53, v103, v111

    v_mul_f32 v98, v69, v76
    v_mul_f32 v99, v73, v88
    v_cvt_pk_bf16_f32 v98, v98, v99
    v_and_b32 v99, 0xffff0000, v98
    v_lshlrev_b32 v98, 16, v98

    v_mul_f32 v100, v68, v77
    v_mul_f32 v101, v72, v89
    v_cvt_pk_bf16_f32 v100, v100, v101
    v_and_b32 v101, 0xffff0000, v100
    v_lshlrev_b32 v100, 16, v100
    v_add_f32 v98, v98, v100
    v_add_f32 v99, v99, v101
    v_cvt_pk_bf16_f32 v98, v98, v99
    v_and_b32 v99, 0xffff0000, v98
    v_lshlrev_b32 v98, 16, v98

    v_mul_f32 v100, v67, v78
    v_mul_f32 v101, v71, v90
    v_cvt_pk_bf16_f32 v100, v100, v101
    v_and_b32 v101, 0xffff0000, v100
    v_lshlrev_b32 v100, 16, v100
    v_add_f32 v98, v98, v100
    v_add_f32 v99, v99, v101
    v_cvt_pk_bf16_f32 v98, v98, v99
    v_and_b32 v99, 0xffff0000, v98
    v_lshlrev_b32 v98, 16, v98

    v_mul_f32 v100, v66, v79
    v_mul_f32 v101, v70, v91
    v_cvt_pk_bf16_f32 v100, v100, v101
    v_and_b32 v101, 0xffff0000, v100
    v_lshlrev_b32 v100, 16, v100
    v_add_f32 v98, v98, v100
    v_add_f32 v99, v99, v101
    v_cvt_pk_bf16_f32 v98, v98, v99
    v_and_b32 v99, 0xffff0000, v98
    v_lshlrev_b32 v98, 16, v98

    v_lshlrev_b32 v100, 16, v55
    v_and_b32 v101, 0xffff0000, v55
    v_mul_f32 v104, v98, v100
    v_mul_f32 v112, v99, v101
    v_cvt_pk_bf16_f32 v55, v104, v112

    v_mul_f32 v98, v69, v77
    v_mul_f32 v99, v73, v89
    v_cvt_pk_bf16_f32 v98, v98, v99
    v_and_b32 v99, 0xffff0000, v98
    v_lshlrev_b32 v98, 16, v98

    v_mul_f32 v100, v68, v78
    v_mul_f32 v101, v72, v90
    v_cvt_pk_bf16_f32 v100, v100, v101
    v_and_b32 v101, 0xffff0000, v100
    v_lshlrev_b32 v100, 16, v100
    v_add_f32 v98, v98, v100
    v_add_f32 v99, v99, v101
    v_cvt_pk_bf16_f32 v98, v98, v99
    v_and_b32 v99, 0xffff0000, v98
    v_lshlrev_b32 v98, 16, v98

    v_mul_f32 v100, v67, v79
    v_mul_f32 v101, v71, v91
    v_cvt_pk_bf16_f32 v100, v100, v101
    v_and_b32 v101, 0xffff0000, v100
    v_lshlrev_b32 v100, 16, v100
    v_add_f32 v98, v98, v100
    v_add_f32 v99, v99, v101
    v_cvt_pk_bf16_f32 v98, v98, v99
    v_and_b32 v99, 0xffff0000, v98
    v_lshlrev_b32 v98, 16, v98

    v_mul_f32 v100, v66, v80
    v_mul_f32 v101, v70, v92
    v_cvt_pk_bf16_f32 v100, v100, v101
    v_and_b32 v101, 0xffff0000, v100
    v_lshlrev_b32 v100, 16, v100
    v_add_f32 v98, v98, v100
    v_add_f32 v99, v99, v101
    v_cvt_pk_bf16_f32 v98, v98, v99
    v_and_b32 v99, 0xffff0000, v98
    v_lshlrev_b32 v98, 16, v98

    v_lshlrev_b32 v100, 16, v57
    v_and_b32 v101, 0xffff0000, v57
    v_mul_f32 v105, v98, v100
    v_mul_f32 v113, v99, v101
    v_cvt_pk_bf16_f32 v57, v105, v113

    v_mul_f32 v98, v69, v78
    v_mul_f32 v99, v73, v90
    v_cvt_pk_bf16_f32 v98, v98, v99
    v_and_b32 v99, 0xffff0000, v98
    v_lshlrev_b32 v98, 16, v98

    v_mul_f32 v100, v68, v79
    v_mul_f32 v101, v72, v91
    v_cvt_pk_bf16_f32 v100, v100, v101
    v_and_b32 v101, 0xffff0000, v100
    v_lshlrev_b32 v100, 16, v100
    v_add_f32 v98, v98, v100
    v_add_f32 v99, v99, v101
    v_cvt_pk_bf16_f32 v98, v98, v99
    v_and_b32 v99, 0xffff0000, v98
    v_lshlrev_b32 v98, 16, v98

    v_mul_f32 v100, v67, v80
    v_mul_f32 v101, v71, v92
    v_cvt_pk_bf16_f32 v100, v100, v101
    v_and_b32 v101, 0xffff0000, v100
    v_lshlrev_b32 v100, 16, v100
    v_add_f32 v98, v98, v100
    v_add_f32 v99, v99, v101
    v_cvt_pk_bf16_f32 v98, v98, v99
    v_and_b32 v99, 0xffff0000, v98
    v_lshlrev_b32 v98, 16, v98

    v_mul_f32 v100, v66, v81
    v_mul_f32 v101, v70, v93
    v_cvt_pk_bf16_f32 v100, v100, v101
    v_and_b32 v101, 0xffff0000, v100
    v_lshlrev_b32 v100, 16, v100
    v_add_f32 v98, v98, v100
    v_add_f32 v99, v99, v101
    v_cvt_pk_bf16_f32 v98, v98, v99
    v_and_b32 v99, 0xffff0000, v98
    v_lshlrev_b32 v98, 16, v98

    v_lshlrev_b32 v100, 16, v59
    v_and_b32 v101, 0xffff0000, v59
    v_mul_f32 v106, v98, v100
    v_mul_f32 v114, v99, v101
    v_cvt_pk_bf16_f32 v59, v106, v114

    v_mul_f32 v98, v69, v79
    v_mul_f32 v99, v73, v91
    v_cvt_pk_bf16_f32 v98, v98, v99
    v_and_b32 v99, 0xffff0000, v98
    v_lshlrev_b32 v98, 16, v98

    v_mul_f32 v100, v68, v80
    v_mul_f32 v101, v72, v92
    v_cvt_pk_bf16_f32 v100, v100, v101
    v_and_b32 v101, 0xffff0000, v100
    v_lshlrev_b32 v100, 16, v100
    v_add_f32 v98, v98, v100
    v_add_f32 v99, v99, v101
    v_cvt_pk_bf16_f32 v98, v98, v99
    v_and_b32 v99, 0xffff0000, v98
    v_lshlrev_b32 v98, 16, v98

    v_mul_f32 v100, v67, v81
    v_mul_f32 v101, v71, v93
    v_cvt_pk_bf16_f32 v100, v100, v101
    v_and_b32 v101, 0xffff0000, v100
    v_lshlrev_b32 v100, 16, v100
    v_add_f32 v98, v98, v100
    v_add_f32 v99, v99, v101
    v_cvt_pk_bf16_f32 v98, v98, v99
    v_and_b32 v99, 0xffff0000, v98
    v_lshlrev_b32 v98, 16, v98

    v_mul_f32 v100, v66, v82
    v_mul_f32 v101, v70, v94
    v_cvt_pk_bf16_f32 v100, v100, v101
    v_and_b32 v101, 0xffff0000, v100
    v_lshlrev_b32 v100, 16, v100
    v_add_f32 v98, v98, v100
    v_add_f32 v99, v99, v101
    v_cvt_pk_bf16_f32 v98, v98, v99
    v_and_b32 v99, 0xffff0000, v98
    v_lshlrev_b32 v98, 16, v98

    v_lshlrev_b32 v100, 16, v61
    v_and_b32 v101, 0xffff0000, v61
    v_mul_f32 v107, v98, v100
    v_mul_f32 v115, v99, v101
    v_cvt_pk_bf16_f32 v61, v107, v115

    v_mul_f32 v98, v69, v80
    v_mul_f32 v99, v73, v92
    v_cvt_pk_bf16_f32 v98, v98, v99
    v_and_b32 v99, 0xffff0000, v98
    v_lshlrev_b32 v98, 16, v98

    v_mul_f32 v100, v68, v81
    v_mul_f32 v101, v72, v93
    v_cvt_pk_bf16_f32 v100, v100, v101
    v_and_b32 v101, 0xffff0000, v100
    v_lshlrev_b32 v100, 16, v100
    v_add_f32 v98, v98, v100
    v_add_f32 v99, v99, v101
    v_cvt_pk_bf16_f32 v98, v98, v99
    v_and_b32 v99, 0xffff0000, v98
    v_lshlrev_b32 v98, 16, v98

    v_mul_f32 v100, v67, v82
    v_mul_f32 v101, v71, v94
    v_cvt_pk_bf16_f32 v100, v100, v101
    v_and_b32 v101, 0xffff0000, v100
    v_lshlrev_b32 v100, 16, v100
    v_add_f32 v98, v98, v100
    v_add_f32 v99, v99, v101
    v_cvt_pk_bf16_f32 v98, v98, v99
    v_and_b32 v99, 0xffff0000, v98
    v_lshlrev_b32 v98, 16, v98

    v_mul_f32 v100, v66, v83
    v_mul_f32 v101, v70, v95
    v_cvt_pk_bf16_f32 v100, v100, v101
    v_and_b32 v101, 0xffff0000, v100
    v_lshlrev_b32 v100, 16, v100
    v_add_f32 v98, v98, v100
    v_add_f32 v99, v99, v101
    v_cvt_pk_bf16_f32 v98, v98, v99
    v_and_b32 v99, 0xffff0000, v98
    v_lshlrev_b32 v98, 16, v98

    v_lshlrev_b32 v100, 16, v63
    v_and_b32 v101, 0xffff0000, v63
    v_mul_f32 v108, v98, v100
    v_mul_f32 v116, v99, v101
    v_cvt_pk_bf16_f32 v63, v108, v116

    v_mul_f32 v98, v69, v81
    v_mul_f32 v99, v73, v93
    v_cvt_pk_bf16_f32 v98, v98, v99
    v_and_b32 v99, 0xffff0000, v98
    v_lshlrev_b32 v98, 16, v98

    v_mul_f32 v100, v68, v82
    v_mul_f32 v101, v72, v94
    v_cvt_pk_bf16_f32 v100, v100, v101
    v_and_b32 v101, 0xffff0000, v100
    v_lshlrev_b32 v100, 16, v100
    v_add_f32 v98, v98, v100
    v_add_f32 v99, v99, v101
    v_cvt_pk_bf16_f32 v98, v98, v99
    v_and_b32 v99, 0xffff0000, v98
    v_lshlrev_b32 v98, 16, v98

    v_mul_f32 v100, v67, v83
    v_mul_f32 v101, v71, v95
    v_cvt_pk_bf16_f32 v100, v100, v101
    v_and_b32 v101, 0xffff0000, v100
    v_lshlrev_b32 v100, 16, v100
    v_add_f32 v98, v98, v100
    v_add_f32 v99, v99, v101
    v_cvt_pk_bf16_f32 v98, v98, v99
    v_and_b32 v99, 0xffff0000, v98
    v_lshlrev_b32 v98, 16, v98

    v_mul_f32 v100, v66, v84
    v_mul_f32 v101, v70, v96
    v_cvt_pk_bf16_f32 v100, v100, v101
    v_and_b32 v101, 0xffff0000, v100
    v_lshlrev_b32 v100, 16, v100
    v_add_f32 v98, v98, v100
    v_add_f32 v99, v99, v101
    v_cvt_pk_bf16_f32 v98, v98, v99
    v_and_b32 v99, 0xffff0000, v98
    v_lshlrev_b32 v98, 16, v98

    v_lshlrev_b32 v100, 16, v65
    v_and_b32 v101, 0xffff0000, v65
    v_mul_f32 v109, v98, v100
    v_mul_f32 v117, v99, v101
    v_cvt_pk_bf16_f32 v65, v109, v117

    v_cvt_pk_bf16_f32 v118, v109, v108
    v_cvt_pk_bf16_f32 v119, v107, v106
    v_cvt_pk_bf16_f32 v120, v105, v104
    v_cvt_pk_bf16_f32 v121, v103, v102
    s_mov_b32 s6, 125837312
    buffer_store_dwordx4 v[118:121], v19, s[8:11], s6 offen sc1
    v_cvt_pk_bf16_f32 v122, v117, v116
    v_cvt_pk_bf16_f32 v123, v115, v114
    v_cvt_pk_bf16_f32 v124, v113, v112
    v_cvt_pk_bf16_f32 v125, v111, v110
    s_mov_b32 s6, 125841408
    buffer_store_dwordx4 v[122:125], v19, s[8:11], s6 offen sc1
    s_nop 1
    s_add_u32 s94, s94, 32
    s_cmp_lt_u32 s94, 256
    s_cbranch_scc1 .kp_393

    s_waitcnt vmcnt(0) lgkmcnt(0)
    s_barrier
    s_mov_b32 s5, 40
    s_cmp_lg_u32 s24, 0
    s_cbranch_scc1 .sg_394
    s_mov_b64 exec, 1
    v_mov_b32 v4, 1
    v_mov_b32 v5, 0
    buffer_atomic_add v4, v5, s[20:23], s5 offen sc1
    s_mov_b64 exec, -1

.sg_394:
    s_mov_b32 s3, s93
    v_and_b32 v1, 63, v0
    v_and_b32 v2, 15, v1
    v_lshrrev_b32 v3, 4, v1

    s_load_dwordx2 s[40:41], s[0:1], 0
    s_load_dwordx2 s[42:43], s[0:1], 104
    s_waitcnt lgkmcnt(0)

    s_mov_b32 s12, s40
    s_and_b32 s13, s41, 0xffff
    s_mov_b32 s14, 0x400000
    s_mov_b32 s15, 0x00020000

    s_mov_b32 s16, s42
    s_and_b32 s17, s43, 0xffff
    s_mov_b32 s18, 0x800
    s_mov_b32 s19, 0x00020000

    s_lshl_b32 s3, s3, 6
    s_lshl_b32 s4, s24, 4
    s_add_u32 s3, s3, s4
    v_lshlrev_b32 v8, 4, v1
    buffer_load_dwordx4 v[16:19], v8, s[16:19], 0 offen
    buffer_load_dwordx4 v[20:23], v8, s[16:19], 0 offen offset:1024
    s_lshl_b32 s5, s3, 11

    buffer_load_dwordx4 v[64:67], v8, s[12:15], s5 offen
    buffer_load_dwordx4 v[68:71], v8, s[12:15], s5 offen offset:1024
    s_add_u32 s5, s5, 2048

    buffer_load_dwordx4 v[72:75], v8, s[12:15], s5 offen
    buffer_load_dwordx4 v[76:79], v8, s[12:15], s5 offen offset:1024
    s_add_u32 s5, s5, 2048

    buffer_load_dwordx4 v[80:83], v8, s[12:15], s5 offen
    buffer_load_dwordx4 v[84:87], v8, s[12:15], s5 offen offset:1024
    s_add_u32 s5, s5, 2048

    buffer_load_dwordx4 v[88:91], v8, s[12:15], s5 offen
    buffer_load_dwordx4 v[92:95], v8, s[12:15], s5 offen offset:1024
    s_add_u32 s5, s5, 2048

    buffer_load_dwordx4 v[96:99], v8, s[12:15], s5 offen
    buffer_load_dwordx4 v[100:103], v8, s[12:15], s5 offen offset:1024
    s_add_u32 s5, s5, 2048

    buffer_load_dwordx4 v[104:107], v8, s[12:15], s5 offen
    buffer_load_dwordx4 v[108:111], v8, s[12:15], s5 offen offset:1024
    s_add_u32 s5, s5, 2048

    buffer_load_dwordx4 v[112:115], v8, s[12:15], s5 offen
    buffer_load_dwordx4 v[116:119], v8, s[12:15], s5 offen offset:1024
    s_add_u32 s5, s5, 2048

    buffer_load_dwordx4 v[120:123], v8, s[12:15], s5 offen
    buffer_load_dwordx4 v[124:127], v8, s[12:15], s5 offen offset:1024
    s_add_u32 s5, s5, 2048

    buffer_load_dwordx4 v[128:131], v8, s[12:15], s5 offen
    buffer_load_dwordx4 v[132:135], v8, s[12:15], s5 offen offset:1024
    s_add_u32 s5, s5, 2048

    buffer_load_dwordx4 v[136:139], v8, s[12:15], s5 offen
    buffer_load_dwordx4 v[140:143], v8, s[12:15], s5 offen offset:1024
    s_add_u32 s5, s5, 2048

    buffer_load_dwordx4 v[144:147], v8, s[12:15], s5 offen
    buffer_load_dwordx4 v[148:151], v8, s[12:15], s5 offen offset:1024
    s_add_u32 s5, s5, 2048

    buffer_load_dwordx4 v[152:155], v8, s[12:15], s5 offen
    buffer_load_dwordx4 v[156:159], v8, s[12:15], s5 offen offset:1024
    s_add_u32 s5, s5, 2048

    buffer_load_dwordx4 v[160:163], v8, s[12:15], s5 offen
    buffer_load_dwordx4 v[164:167], v8, s[12:15], s5 offen offset:1024
    s_add_u32 s5, s5, 2048

    buffer_load_dwordx4 v[168:171], v8, s[12:15], s5 offen
    buffer_load_dwordx4 v[172:175], v8, s[12:15], s5 offen offset:1024
    s_add_u32 s5, s5, 2048

    buffer_load_dwordx4 v[176:179], v8, s[12:15], s5 offen
    buffer_load_dwordx4 v[180:183], v8, s[12:15], s5 offen offset:1024
    s_add_u32 s5, s5, 2048

    buffer_load_dwordx4 v[184:187], v8, s[12:15], s5 offen
    buffer_load_dwordx4 v[188:191], v8, s[12:15], s5 offen offset:1024
    s_add_u32 s5, s5, 2048

    s_waitcnt vmcnt(32)
    v_lshlrev_b32 v24, 16, v16
    v_and_b32 v25, 0xffff0000, v16
    v_lshlrev_b32 v26, 16, v17
    v_and_b32 v27, 0xffff0000, v17
    v_lshlrev_b32 v28, 16, v18
    v_and_b32 v29, 0xffff0000, v18
    v_lshlrev_b32 v30, 16, v19
    v_and_b32 v31, 0xffff0000, v19
    v_lshlrev_b32 v32, 16, v20
    v_and_b32 v33, 0xffff0000, v20
    v_lshlrev_b32 v34, 16, v21
    v_and_b32 v35, 0xffff0000, v21
    v_lshlrev_b32 v36, 16, v22
    v_and_b32 v37, 0xffff0000, v22
    v_lshlrev_b32 v38, 16, v23
    v_and_b32 v39, 0xffff0000, v23
    s_mov_b32 s38, 0xbfb8aa3b
    v_mov_b32 v60, 0
    s_waitcnt vmcnt(30)
    v_lshlrev_b32 v40, 16, v64
    v_and_b32 v41, 0xffff0000, v64
    v_mul_f32 v40, v40, v24
    v_mul_f32 v41, v41, v25
    v_cvt_pk_bf16_f32 v40, v40, v41
    v_and_b32 v41, 0xffff0000, v40
    v_lshlrev_b32 v40, 16, v40

    v_lshlrev_b32 v42, 16, v65
    v_and_b32 v43, 0xffff0000, v65
    v_mul_f32 v42, v42, v26
    v_mul_f32 v43, v43, v27
    v_cvt_pk_bf16_f32 v42, v42, v43
    v_and_b32 v43, 0xffff0000, v42
    v_lshlrev_b32 v42, 16, v42

    v_lshlrev_b32 v44, 16, v66
    v_and_b32 v45, 0xffff0000, v66
    v_mul_f32 v44, v44, v28
    v_mul_f32 v45, v45, v29
    v_cvt_pk_bf16_f32 v44, v44, v45
    v_and_b32 v45, 0xffff0000, v44
    v_lshlrev_b32 v44, 16, v44

    v_lshlrev_b32 v46, 16, v67
    v_and_b32 v47, 0xffff0000, v67
    v_mul_f32 v46, v46, v30
    v_mul_f32 v47, v47, v31
    v_cvt_pk_bf16_f32 v46, v46, v47
    v_and_b32 v47, 0xffff0000, v46
    v_lshlrev_b32 v46, 16, v46

    v_lshlrev_b32 v48, 16, v68
    v_and_b32 v49, 0xffff0000, v68
    v_mul_f32 v48, v48, v32
    v_mul_f32 v49, v49, v33
    v_cvt_pk_bf16_f32 v48, v48, v49
    v_and_b32 v49, 0xffff0000, v48
    v_lshlrev_b32 v48, 16, v48

    v_lshlrev_b32 v50, 16, v69
    v_and_b32 v51, 0xffff0000, v69
    v_mul_f32 v50, v50, v34
    v_mul_f32 v51, v51, v35
    v_cvt_pk_bf16_f32 v50, v50, v51
    v_and_b32 v51, 0xffff0000, v50
    v_lshlrev_b32 v50, 16, v50

    v_lshlrev_b32 v52, 16, v70
    v_and_b32 v53, 0xffff0000, v70
    v_mul_f32 v52, v52, v36
    v_mul_f32 v53, v53, v37
    v_cvt_pk_bf16_f32 v52, v52, v53
    v_and_b32 v53, 0xffff0000, v52
    v_lshlrev_b32 v52, 16, v52

    v_lshlrev_b32 v54, 16, v71
    v_and_b32 v55, 0xffff0000, v71
    v_mul_f32 v54, v54, v38
    v_mul_f32 v55, v55, v39
    v_cvt_pk_bf16_f32 v54, v54, v55
    v_and_b32 v55, 0xffff0000, v54
    v_lshlrev_b32 v54, 16, v54

    v_add_f32 v40, v40, v48
    v_add_f32 v41, v41, v49
    v_add_f32 v42, v42, v50
    v_add_f32 v43, v43, v51
    v_add_f32 v44, v44, v52
    v_add_f32 v45, v45, v53
    v_add_f32 v46, v46, v54
    v_add_f32 v47, v47, v55
    v_add_f32 v40, v40, v44
    v_add_f32 v41, v41, v45
    v_add_f32 v42, v42, v46
    v_add_f32 v43, v43, v47
    v_add_f32 v40, v40, v42
    v_add_f32 v41, v41, v43
    v_add_f32 v40, v40, v41
    v_mov_b32 v41, v40
    s_nop 1
    v_permlane32_swap_b32 v40, v41
    v_add_f32 v40, v40, v41
    v_mov_b32 v41, v40
    s_nop 1
    v_permlane16_swap_b32 v40, v41
    v_add_f32 v40, v40, v41
    s_nop 1
    v_add_f32_dpp v40, v40, v40 row_ror:8 row_mask:0xf bank_mask:0xf
    s_nop 1
    v_add_f32_dpp v40, v40, v40 row_ror:4 row_mask:0xf bank_mask:0xf
    s_nop 1
    v_add_f32_dpp v40, v40, v40 row_ror:2 row_mask:0xf bank_mask:0xf
    s_nop 1
    v_add_f32_dpp v40, v40, v40 row_ror:1 row_mask:0xf bank_mask:0xf
    v_cvt_pk_bf16_f32 v40, v40, v40
    v_lshlrev_b32 v40, 16, v40
    v_mul_f32 v40, s38, v40
    v_exp_f32 v40, v40
    s_nop 0
    v_add_f32 v40, 1.0, v40
    v_rcp_f32 v40, v40
    s_nop 0
    v_cvt_pk_bf16_f32 v40, v40, v40
    v_lshlrev_b32 v40, 16, v40

    v_cmp_eq_u32 vcc, 0, v1
    s_nop 1
    v_cndmask_b32 v60, v60, v40, vcc
    s_waitcnt vmcnt(28)
    v_lshlrev_b32 v40, 16, v72
    v_and_b32 v41, 0xffff0000, v72
    v_mul_f32 v40, v40, v24
    v_mul_f32 v41, v41, v25
    v_cvt_pk_bf16_f32 v40, v40, v41
    v_and_b32 v41, 0xffff0000, v40
    v_lshlrev_b32 v40, 16, v40

    v_lshlrev_b32 v42, 16, v73
    v_and_b32 v43, 0xffff0000, v73
    v_mul_f32 v42, v42, v26
    v_mul_f32 v43, v43, v27
    v_cvt_pk_bf16_f32 v42, v42, v43
    v_and_b32 v43, 0xffff0000, v42
    v_lshlrev_b32 v42, 16, v42

    v_lshlrev_b32 v44, 16, v74
    v_and_b32 v45, 0xffff0000, v74
    v_mul_f32 v44, v44, v28
    v_mul_f32 v45, v45, v29
    v_cvt_pk_bf16_f32 v44, v44, v45
    v_and_b32 v45, 0xffff0000, v44
    v_lshlrev_b32 v44, 16, v44

    v_lshlrev_b32 v46, 16, v75
    v_and_b32 v47, 0xffff0000, v75
    v_mul_f32 v46, v46, v30
    v_mul_f32 v47, v47, v31
    v_cvt_pk_bf16_f32 v46, v46, v47
    v_and_b32 v47, 0xffff0000, v46
    v_lshlrev_b32 v46, 16, v46

    v_lshlrev_b32 v48, 16, v76
    v_and_b32 v49, 0xffff0000, v76
    v_mul_f32 v48, v48, v32
    v_mul_f32 v49, v49, v33
    v_cvt_pk_bf16_f32 v48, v48, v49
    v_and_b32 v49, 0xffff0000, v48
    v_lshlrev_b32 v48, 16, v48

    v_lshlrev_b32 v50, 16, v77
    v_and_b32 v51, 0xffff0000, v77
    v_mul_f32 v50, v50, v34
    v_mul_f32 v51, v51, v35
    v_cvt_pk_bf16_f32 v50, v50, v51
    v_and_b32 v51, 0xffff0000, v50
    v_lshlrev_b32 v50, 16, v50

    v_lshlrev_b32 v52, 16, v78
    v_and_b32 v53, 0xffff0000, v78
    v_mul_f32 v52, v52, v36
    v_mul_f32 v53, v53, v37
    v_cvt_pk_bf16_f32 v52, v52, v53
    v_and_b32 v53, 0xffff0000, v52
    v_lshlrev_b32 v52, 16, v52

    v_lshlrev_b32 v54, 16, v79
    v_and_b32 v55, 0xffff0000, v79
    v_mul_f32 v54, v54, v38
    v_mul_f32 v55, v55, v39
    v_cvt_pk_bf16_f32 v54, v54, v55
    v_and_b32 v55, 0xffff0000, v54
    v_lshlrev_b32 v54, 16, v54

    v_add_f32 v40, v40, v48
    v_add_f32 v41, v41, v49
    v_add_f32 v42, v42, v50
    v_add_f32 v43, v43, v51
    v_add_f32 v44, v44, v52
    v_add_f32 v45, v45, v53
    v_add_f32 v46, v46, v54
    v_add_f32 v47, v47, v55
    v_add_f32 v40, v40, v44
    v_add_f32 v41, v41, v45
    v_add_f32 v42, v42, v46
    v_add_f32 v43, v43, v47
    v_add_f32 v40, v40, v42
    v_add_f32 v41, v41, v43
    v_add_f32 v40, v40, v41
    v_mov_b32 v41, v40
    s_nop 1
    v_permlane32_swap_b32 v40, v41
    v_add_f32 v40, v40, v41
    v_mov_b32 v41, v40
    s_nop 1
    v_permlane16_swap_b32 v40, v41
    v_add_f32 v40, v40, v41
    s_nop 1
    v_add_f32_dpp v40, v40, v40 row_ror:8 row_mask:0xf bank_mask:0xf
    s_nop 1
    v_add_f32_dpp v40, v40, v40 row_ror:4 row_mask:0xf bank_mask:0xf
    s_nop 1
    v_add_f32_dpp v40, v40, v40 row_ror:2 row_mask:0xf bank_mask:0xf
    s_nop 1
    v_add_f32_dpp v40, v40, v40 row_ror:1 row_mask:0xf bank_mask:0xf
    v_cvt_pk_bf16_f32 v40, v40, v40
    v_lshlrev_b32 v40, 16, v40
    v_mul_f32 v40, s38, v40
    v_exp_f32 v40, v40
    s_nop 0
    v_add_f32 v40, 1.0, v40
    v_rcp_f32 v40, v40
    s_nop 0
    v_cvt_pk_bf16_f32 v40, v40, v40
    v_lshlrev_b32 v40, 16, v40

    v_cmp_eq_u32 vcc, 1, v1
    s_nop 1
    v_cndmask_b32 v60, v60, v40, vcc
    s_waitcnt vmcnt(26)
    v_lshlrev_b32 v40, 16, v80
    v_and_b32 v41, 0xffff0000, v80
    v_mul_f32 v40, v40, v24
    v_mul_f32 v41, v41, v25
    v_cvt_pk_bf16_f32 v40, v40, v41
    v_and_b32 v41, 0xffff0000, v40
    v_lshlrev_b32 v40, 16, v40

    v_lshlrev_b32 v42, 16, v81
    v_and_b32 v43, 0xffff0000, v81
    v_mul_f32 v42, v42, v26
    v_mul_f32 v43, v43, v27
    v_cvt_pk_bf16_f32 v42, v42, v43
    v_and_b32 v43, 0xffff0000, v42
    v_lshlrev_b32 v42, 16, v42

    v_lshlrev_b32 v44, 16, v82
    v_and_b32 v45, 0xffff0000, v82
    v_mul_f32 v44, v44, v28
    v_mul_f32 v45, v45, v29
    v_cvt_pk_bf16_f32 v44, v44, v45
    v_and_b32 v45, 0xffff0000, v44
    v_lshlrev_b32 v44, 16, v44

    v_lshlrev_b32 v46, 16, v83
    v_and_b32 v47, 0xffff0000, v83
    v_mul_f32 v46, v46, v30
    v_mul_f32 v47, v47, v31
    v_cvt_pk_bf16_f32 v46, v46, v47
    v_and_b32 v47, 0xffff0000, v46
    v_lshlrev_b32 v46, 16, v46

    v_lshlrev_b32 v48, 16, v84
    v_and_b32 v49, 0xffff0000, v84
    v_mul_f32 v48, v48, v32
    v_mul_f32 v49, v49, v33
    v_cvt_pk_bf16_f32 v48, v48, v49
    v_and_b32 v49, 0xffff0000, v48
    v_lshlrev_b32 v48, 16, v48

    v_lshlrev_b32 v50, 16, v85
    v_and_b32 v51, 0xffff0000, v85
    v_mul_f32 v50, v50, v34
    v_mul_f32 v51, v51, v35
    v_cvt_pk_bf16_f32 v50, v50, v51
    v_and_b32 v51, 0xffff0000, v50
    v_lshlrev_b32 v50, 16, v50

    v_lshlrev_b32 v52, 16, v86
    v_and_b32 v53, 0xffff0000, v86
    v_mul_f32 v52, v52, v36
    v_mul_f32 v53, v53, v37
    v_cvt_pk_bf16_f32 v52, v52, v53
    v_and_b32 v53, 0xffff0000, v52
    v_lshlrev_b32 v52, 16, v52

    v_lshlrev_b32 v54, 16, v87
    v_and_b32 v55, 0xffff0000, v87
    v_mul_f32 v54, v54, v38
    v_mul_f32 v55, v55, v39
    v_cvt_pk_bf16_f32 v54, v54, v55
    v_and_b32 v55, 0xffff0000, v54
    v_lshlrev_b32 v54, 16, v54

    v_add_f32 v40, v40, v48
    v_add_f32 v41, v41, v49
    v_add_f32 v42, v42, v50
    v_add_f32 v43, v43, v51
    v_add_f32 v44, v44, v52
    v_add_f32 v45, v45, v53
    v_add_f32 v46, v46, v54
    v_add_f32 v47, v47, v55
    v_add_f32 v40, v40, v44
    v_add_f32 v41, v41, v45
    v_add_f32 v42, v42, v46
    v_add_f32 v43, v43, v47
    v_add_f32 v40, v40, v42
    v_add_f32 v41, v41, v43
    v_add_f32 v40, v40, v41
    v_mov_b32 v41, v40
    s_nop 1
    v_permlane32_swap_b32 v40, v41
    v_add_f32 v40, v40, v41
    v_mov_b32 v41, v40
    s_nop 1
    v_permlane16_swap_b32 v40, v41
    v_add_f32 v40, v40, v41
    s_nop 1
    v_add_f32_dpp v40, v40, v40 row_ror:8 row_mask:0xf bank_mask:0xf
    s_nop 1
    v_add_f32_dpp v40, v40, v40 row_ror:4 row_mask:0xf bank_mask:0xf
    s_nop 1
    v_add_f32_dpp v40, v40, v40 row_ror:2 row_mask:0xf bank_mask:0xf
    s_nop 1
    v_add_f32_dpp v40, v40, v40 row_ror:1 row_mask:0xf bank_mask:0xf
    v_cvt_pk_bf16_f32 v40, v40, v40
    v_lshlrev_b32 v40, 16, v40
    v_mul_f32 v40, s38, v40
    v_exp_f32 v40, v40
    s_nop 0
    v_add_f32 v40, 1.0, v40
    v_rcp_f32 v40, v40
    s_nop 0
    v_cvt_pk_bf16_f32 v40, v40, v40
    v_lshlrev_b32 v40, 16, v40

    v_cmp_eq_u32 vcc, 2, v1
    s_nop 1
    v_cndmask_b32 v60, v60, v40, vcc
    s_waitcnt vmcnt(24)
    v_lshlrev_b32 v40, 16, v88
    v_and_b32 v41, 0xffff0000, v88
    v_mul_f32 v40, v40, v24
    v_mul_f32 v41, v41, v25
    v_cvt_pk_bf16_f32 v40, v40, v41
    v_and_b32 v41, 0xffff0000, v40
    v_lshlrev_b32 v40, 16, v40

    v_lshlrev_b32 v42, 16, v89
    v_and_b32 v43, 0xffff0000, v89
    v_mul_f32 v42, v42, v26
    v_mul_f32 v43, v43, v27
    v_cvt_pk_bf16_f32 v42, v42, v43
    v_and_b32 v43, 0xffff0000, v42
    v_lshlrev_b32 v42, 16, v42

    v_lshlrev_b32 v44, 16, v90
    v_and_b32 v45, 0xffff0000, v90
    v_mul_f32 v44, v44, v28
    v_mul_f32 v45, v45, v29
    v_cvt_pk_bf16_f32 v44, v44, v45
    v_and_b32 v45, 0xffff0000, v44
    v_lshlrev_b32 v44, 16, v44

    v_lshlrev_b32 v46, 16, v91
    v_and_b32 v47, 0xffff0000, v91
    v_mul_f32 v46, v46, v30
    v_mul_f32 v47, v47, v31
    v_cvt_pk_bf16_f32 v46, v46, v47
    v_and_b32 v47, 0xffff0000, v46
    v_lshlrev_b32 v46, 16, v46

    v_lshlrev_b32 v48, 16, v92
    v_and_b32 v49, 0xffff0000, v92
    v_mul_f32 v48, v48, v32
    v_mul_f32 v49, v49, v33
    v_cvt_pk_bf16_f32 v48, v48, v49
    v_and_b32 v49, 0xffff0000, v48
    v_lshlrev_b32 v48, 16, v48

    v_lshlrev_b32 v50, 16, v93
    v_and_b32 v51, 0xffff0000, v93
    v_mul_f32 v50, v50, v34
    v_mul_f32 v51, v51, v35
    v_cvt_pk_bf16_f32 v50, v50, v51
    v_and_b32 v51, 0xffff0000, v50
    v_lshlrev_b32 v50, 16, v50

    v_lshlrev_b32 v52, 16, v94
    v_and_b32 v53, 0xffff0000, v94
    v_mul_f32 v52, v52, v36
    v_mul_f32 v53, v53, v37
    v_cvt_pk_bf16_f32 v52, v52, v53
    v_and_b32 v53, 0xffff0000, v52
    v_lshlrev_b32 v52, 16, v52

    v_lshlrev_b32 v54, 16, v95
    v_and_b32 v55, 0xffff0000, v95
    v_mul_f32 v54, v54, v38
    v_mul_f32 v55, v55, v39
    v_cvt_pk_bf16_f32 v54, v54, v55
    v_and_b32 v55, 0xffff0000, v54
    v_lshlrev_b32 v54, 16, v54

    v_add_f32 v40, v40, v48
    v_add_f32 v41, v41, v49
    v_add_f32 v42, v42, v50
    v_add_f32 v43, v43, v51
    v_add_f32 v44, v44, v52
    v_add_f32 v45, v45, v53
    v_add_f32 v46, v46, v54
    v_add_f32 v47, v47, v55
    v_add_f32 v40, v40, v44
    v_add_f32 v41, v41, v45
    v_add_f32 v42, v42, v46
    v_add_f32 v43, v43, v47
    v_add_f32 v40, v40, v42
    v_add_f32 v41, v41, v43
    v_add_f32 v40, v40, v41
    v_mov_b32 v41, v40
    s_nop 1
    v_permlane32_swap_b32 v40, v41
    v_add_f32 v40, v40, v41
    v_mov_b32 v41, v40
    s_nop 1
    v_permlane16_swap_b32 v40, v41
    v_add_f32 v40, v40, v41
    s_nop 1
    v_add_f32_dpp v40, v40, v40 row_ror:8 row_mask:0xf bank_mask:0xf
    s_nop 1
    v_add_f32_dpp v40, v40, v40 row_ror:4 row_mask:0xf bank_mask:0xf
    s_nop 1
    v_add_f32_dpp v40, v40, v40 row_ror:2 row_mask:0xf bank_mask:0xf
    s_nop 1
    v_add_f32_dpp v40, v40, v40 row_ror:1 row_mask:0xf bank_mask:0xf
    v_cvt_pk_bf16_f32 v40, v40, v40
    v_lshlrev_b32 v40, 16, v40
    v_mul_f32 v40, s38, v40
    v_exp_f32 v40, v40
    s_nop 0
    v_add_f32 v40, 1.0, v40
    v_rcp_f32 v40, v40
    s_nop 0
    v_cvt_pk_bf16_f32 v40, v40, v40
    v_lshlrev_b32 v40, 16, v40

    v_cmp_eq_u32 vcc, 3, v1
    s_nop 1
    v_cndmask_b32 v60, v60, v40, vcc
    s_waitcnt vmcnt(22)
    v_lshlrev_b32 v40, 16, v96
    v_and_b32 v41, 0xffff0000, v96
    v_mul_f32 v40, v40, v24
    v_mul_f32 v41, v41, v25
    v_cvt_pk_bf16_f32 v40, v40, v41
    v_and_b32 v41, 0xffff0000, v40
    v_lshlrev_b32 v40, 16, v40

    v_lshlrev_b32 v42, 16, v97
    v_and_b32 v43, 0xffff0000, v97
    v_mul_f32 v42, v42, v26
    v_mul_f32 v43, v43, v27
    v_cvt_pk_bf16_f32 v42, v42, v43
    v_and_b32 v43, 0xffff0000, v42
    v_lshlrev_b32 v42, 16, v42

    v_lshlrev_b32 v44, 16, v98
    v_and_b32 v45, 0xffff0000, v98
    v_mul_f32 v44, v44, v28
    v_mul_f32 v45, v45, v29
    v_cvt_pk_bf16_f32 v44, v44, v45
    v_and_b32 v45, 0xffff0000, v44
    v_lshlrev_b32 v44, 16, v44

    v_lshlrev_b32 v46, 16, v99
    v_and_b32 v47, 0xffff0000, v99
    v_mul_f32 v46, v46, v30
    v_mul_f32 v47, v47, v31
    v_cvt_pk_bf16_f32 v46, v46, v47
    v_and_b32 v47, 0xffff0000, v46
    v_lshlrev_b32 v46, 16, v46

    v_lshlrev_b32 v48, 16, v100
    v_and_b32 v49, 0xffff0000, v100
    v_mul_f32 v48, v48, v32
    v_mul_f32 v49, v49, v33
    v_cvt_pk_bf16_f32 v48, v48, v49
    v_and_b32 v49, 0xffff0000, v48
    v_lshlrev_b32 v48, 16, v48

    v_lshlrev_b32 v50, 16, v101
    v_and_b32 v51, 0xffff0000, v101
    v_mul_f32 v50, v50, v34
    v_mul_f32 v51, v51, v35
    v_cvt_pk_bf16_f32 v50, v50, v51
    v_and_b32 v51, 0xffff0000, v50
    v_lshlrev_b32 v50, 16, v50

    v_lshlrev_b32 v52, 16, v102
    v_and_b32 v53, 0xffff0000, v102
    v_mul_f32 v52, v52, v36
    v_mul_f32 v53, v53, v37
    v_cvt_pk_bf16_f32 v52, v52, v53
    v_and_b32 v53, 0xffff0000, v52
    v_lshlrev_b32 v52, 16, v52

    v_lshlrev_b32 v54, 16, v103
    v_and_b32 v55, 0xffff0000, v103
    v_mul_f32 v54, v54, v38
    v_mul_f32 v55, v55, v39
    v_cvt_pk_bf16_f32 v54, v54, v55
    v_and_b32 v55, 0xffff0000, v54
    v_lshlrev_b32 v54, 16, v54

    v_add_f32 v40, v40, v48
    v_add_f32 v41, v41, v49
    v_add_f32 v42, v42, v50
    v_add_f32 v43, v43, v51
    v_add_f32 v44, v44, v52
    v_add_f32 v45, v45, v53
    v_add_f32 v46, v46, v54
    v_add_f32 v47, v47, v55
    v_add_f32 v40, v40, v44
    v_add_f32 v41, v41, v45
    v_add_f32 v42, v42, v46
    v_add_f32 v43, v43, v47
    v_add_f32 v40, v40, v42
    v_add_f32 v41, v41, v43
    v_add_f32 v40, v40, v41
    v_mov_b32 v41, v40
    s_nop 1
    v_permlane32_swap_b32 v40, v41
    v_add_f32 v40, v40, v41
    v_mov_b32 v41, v40
    s_nop 1
    v_permlane16_swap_b32 v40, v41
    v_add_f32 v40, v40, v41
    s_nop 1
    v_add_f32_dpp v40, v40, v40 row_ror:8 row_mask:0xf bank_mask:0xf
    s_nop 1
    v_add_f32_dpp v40, v40, v40 row_ror:4 row_mask:0xf bank_mask:0xf
    s_nop 1
    v_add_f32_dpp v40, v40, v40 row_ror:2 row_mask:0xf bank_mask:0xf
    s_nop 1
    v_add_f32_dpp v40, v40, v40 row_ror:1 row_mask:0xf bank_mask:0xf
    v_cvt_pk_bf16_f32 v40, v40, v40
    v_lshlrev_b32 v40, 16, v40
    v_mul_f32 v40, s38, v40
    v_exp_f32 v40, v40
    s_nop 0
    v_add_f32 v40, 1.0, v40
    v_rcp_f32 v40, v40
    s_nop 0
    v_cvt_pk_bf16_f32 v40, v40, v40
    v_lshlrev_b32 v40, 16, v40

    v_cmp_eq_u32 vcc, 4, v1
    s_nop 1
    v_cndmask_b32 v60, v60, v40, vcc
    s_waitcnt vmcnt(20)
    v_lshlrev_b32 v40, 16, v104
    v_and_b32 v41, 0xffff0000, v104
    v_mul_f32 v40, v40, v24
    v_mul_f32 v41, v41, v25
    v_cvt_pk_bf16_f32 v40, v40, v41
    v_and_b32 v41, 0xffff0000, v40
    v_lshlrev_b32 v40, 16, v40

    v_lshlrev_b32 v42, 16, v105
    v_and_b32 v43, 0xffff0000, v105
    v_mul_f32 v42, v42, v26
    v_mul_f32 v43, v43, v27
    v_cvt_pk_bf16_f32 v42, v42, v43
    v_and_b32 v43, 0xffff0000, v42
    v_lshlrev_b32 v42, 16, v42

    v_lshlrev_b32 v44, 16, v106
    v_and_b32 v45, 0xffff0000, v106
    v_mul_f32 v44, v44, v28
    v_mul_f32 v45, v45, v29
    v_cvt_pk_bf16_f32 v44, v44, v45
    v_and_b32 v45, 0xffff0000, v44
    v_lshlrev_b32 v44, 16, v44

    v_lshlrev_b32 v46, 16, v107
    v_and_b32 v47, 0xffff0000, v107
    v_mul_f32 v46, v46, v30
    v_mul_f32 v47, v47, v31
    v_cvt_pk_bf16_f32 v46, v46, v47
    v_and_b32 v47, 0xffff0000, v46
    v_lshlrev_b32 v46, 16, v46

    v_lshlrev_b32 v48, 16, v108
    v_and_b32 v49, 0xffff0000, v108
    v_mul_f32 v48, v48, v32
    v_mul_f32 v49, v49, v33
    v_cvt_pk_bf16_f32 v48, v48, v49
    v_and_b32 v49, 0xffff0000, v48
    v_lshlrev_b32 v48, 16, v48

    v_lshlrev_b32 v50, 16, v109
    v_and_b32 v51, 0xffff0000, v109
    v_mul_f32 v50, v50, v34
    v_mul_f32 v51, v51, v35
    v_cvt_pk_bf16_f32 v50, v50, v51
    v_and_b32 v51, 0xffff0000, v50
    v_lshlrev_b32 v50, 16, v50

    v_lshlrev_b32 v52, 16, v110
    v_and_b32 v53, 0xffff0000, v110
    v_mul_f32 v52, v52, v36
    v_mul_f32 v53, v53, v37
    v_cvt_pk_bf16_f32 v52, v52, v53
    v_and_b32 v53, 0xffff0000, v52
    v_lshlrev_b32 v52, 16, v52

    v_lshlrev_b32 v54, 16, v111
    v_and_b32 v55, 0xffff0000, v111
    v_mul_f32 v54, v54, v38
    v_mul_f32 v55, v55, v39
    v_cvt_pk_bf16_f32 v54, v54, v55
    v_and_b32 v55, 0xffff0000, v54
    v_lshlrev_b32 v54, 16, v54

    v_add_f32 v40, v40, v48
    v_add_f32 v41, v41, v49
    v_add_f32 v42, v42, v50
    v_add_f32 v43, v43, v51
    v_add_f32 v44, v44, v52
    v_add_f32 v45, v45, v53
    v_add_f32 v46, v46, v54
    v_add_f32 v47, v47, v55
    v_add_f32 v40, v40, v44
    v_add_f32 v41, v41, v45
    v_add_f32 v42, v42, v46
    v_add_f32 v43, v43, v47
    v_add_f32 v40, v40, v42
    v_add_f32 v41, v41, v43
    v_add_f32 v40, v40, v41
    v_mov_b32 v41, v40
    s_nop 1
    v_permlane32_swap_b32 v40, v41
    v_add_f32 v40, v40, v41
    v_mov_b32 v41, v40
    s_nop 1
    v_permlane16_swap_b32 v40, v41
    v_add_f32 v40, v40, v41
    s_nop 1
    v_add_f32_dpp v40, v40, v40 row_ror:8 row_mask:0xf bank_mask:0xf
    s_nop 1
    v_add_f32_dpp v40, v40, v40 row_ror:4 row_mask:0xf bank_mask:0xf
    s_nop 1
    v_add_f32_dpp v40, v40, v40 row_ror:2 row_mask:0xf bank_mask:0xf
    s_nop 1
    v_add_f32_dpp v40, v40, v40 row_ror:1 row_mask:0xf bank_mask:0xf
    v_cvt_pk_bf16_f32 v40, v40, v40
    v_lshlrev_b32 v40, 16, v40
    v_mul_f32 v40, s38, v40
    v_exp_f32 v40, v40
    s_nop 0
    v_add_f32 v40, 1.0, v40
    v_rcp_f32 v40, v40
    s_nop 0
    v_cvt_pk_bf16_f32 v40, v40, v40
    v_lshlrev_b32 v40, 16, v40

    v_cmp_eq_u32 vcc, 5, v1
    s_nop 1
    v_cndmask_b32 v60, v60, v40, vcc
    s_waitcnt vmcnt(18)
    v_lshlrev_b32 v40, 16, v112
    v_and_b32 v41, 0xffff0000, v112
    v_mul_f32 v40, v40, v24
    v_mul_f32 v41, v41, v25
    v_cvt_pk_bf16_f32 v40, v40, v41
    v_and_b32 v41, 0xffff0000, v40
    v_lshlrev_b32 v40, 16, v40

    v_lshlrev_b32 v42, 16, v113
    v_and_b32 v43, 0xffff0000, v113
    v_mul_f32 v42, v42, v26
    v_mul_f32 v43, v43, v27
    v_cvt_pk_bf16_f32 v42, v42, v43
    v_and_b32 v43, 0xffff0000, v42
    v_lshlrev_b32 v42, 16, v42

    v_lshlrev_b32 v44, 16, v114
    v_and_b32 v45, 0xffff0000, v114
    v_mul_f32 v44, v44, v28
    v_mul_f32 v45, v45, v29
    v_cvt_pk_bf16_f32 v44, v44, v45
    v_and_b32 v45, 0xffff0000, v44
    v_lshlrev_b32 v44, 16, v44

    v_lshlrev_b32 v46, 16, v115
    v_and_b32 v47, 0xffff0000, v115
    v_mul_f32 v46, v46, v30
    v_mul_f32 v47, v47, v31
    v_cvt_pk_bf16_f32 v46, v46, v47
    v_and_b32 v47, 0xffff0000, v46
    v_lshlrev_b32 v46, 16, v46

    v_lshlrev_b32 v48, 16, v116
    v_and_b32 v49, 0xffff0000, v116
    v_mul_f32 v48, v48, v32
    v_mul_f32 v49, v49, v33
    v_cvt_pk_bf16_f32 v48, v48, v49
    v_and_b32 v49, 0xffff0000, v48
    v_lshlrev_b32 v48, 16, v48

    v_lshlrev_b32 v50, 16, v117
    v_and_b32 v51, 0xffff0000, v117
    v_mul_f32 v50, v50, v34
    v_mul_f32 v51, v51, v35
    v_cvt_pk_bf16_f32 v50, v50, v51
    v_and_b32 v51, 0xffff0000, v50
    v_lshlrev_b32 v50, 16, v50

    v_lshlrev_b32 v52, 16, v118
    v_and_b32 v53, 0xffff0000, v118
    v_mul_f32 v52, v52, v36
    v_mul_f32 v53, v53, v37
    v_cvt_pk_bf16_f32 v52, v52, v53
    v_and_b32 v53, 0xffff0000, v52
    v_lshlrev_b32 v52, 16, v52

    v_lshlrev_b32 v54, 16, v119
    v_and_b32 v55, 0xffff0000, v119
    v_mul_f32 v54, v54, v38
    v_mul_f32 v55, v55, v39
    v_cvt_pk_bf16_f32 v54, v54, v55
    v_and_b32 v55, 0xffff0000, v54
    v_lshlrev_b32 v54, 16, v54

    v_add_f32 v40, v40, v48
    v_add_f32 v41, v41, v49
    v_add_f32 v42, v42, v50
    v_add_f32 v43, v43, v51
    v_add_f32 v44, v44, v52
    v_add_f32 v45, v45, v53
    v_add_f32 v46, v46, v54
    v_add_f32 v47, v47, v55
    v_add_f32 v40, v40, v44
    v_add_f32 v41, v41, v45
    v_add_f32 v42, v42, v46
    v_add_f32 v43, v43, v47
    v_add_f32 v40, v40, v42
    v_add_f32 v41, v41, v43
    v_add_f32 v40, v40, v41
    v_mov_b32 v41, v40
    s_nop 1
    v_permlane32_swap_b32 v40, v41
    v_add_f32 v40, v40, v41
    v_mov_b32 v41, v40
    s_nop 1
    v_permlane16_swap_b32 v40, v41
    v_add_f32 v40, v40, v41
    s_nop 1
    v_add_f32_dpp v40, v40, v40 row_ror:8 row_mask:0xf bank_mask:0xf
    s_nop 1
    v_add_f32_dpp v40, v40, v40 row_ror:4 row_mask:0xf bank_mask:0xf
    s_nop 1
    v_add_f32_dpp v40, v40, v40 row_ror:2 row_mask:0xf bank_mask:0xf
    s_nop 1
    v_add_f32_dpp v40, v40, v40 row_ror:1 row_mask:0xf bank_mask:0xf
    v_cvt_pk_bf16_f32 v40, v40, v40
    v_lshlrev_b32 v40, 16, v40
    v_mul_f32 v40, s38, v40
    v_exp_f32 v40, v40
    s_nop 0
    v_add_f32 v40, 1.0, v40
    v_rcp_f32 v40, v40
    s_nop 0
    v_cvt_pk_bf16_f32 v40, v40, v40
    v_lshlrev_b32 v40, 16, v40

    v_cmp_eq_u32 vcc, 6, v1
    s_nop 1
    v_cndmask_b32 v60, v60, v40, vcc
    s_waitcnt vmcnt(16)
    v_lshlrev_b32 v40, 16, v120
    v_and_b32 v41, 0xffff0000, v120
    v_mul_f32 v40, v40, v24
    v_mul_f32 v41, v41, v25
    v_cvt_pk_bf16_f32 v40, v40, v41
    v_and_b32 v41, 0xffff0000, v40
    v_lshlrev_b32 v40, 16, v40

    v_lshlrev_b32 v42, 16, v121
    v_and_b32 v43, 0xffff0000, v121
    v_mul_f32 v42, v42, v26
    v_mul_f32 v43, v43, v27
    v_cvt_pk_bf16_f32 v42, v42, v43
    v_and_b32 v43, 0xffff0000, v42
    v_lshlrev_b32 v42, 16, v42

    v_lshlrev_b32 v44, 16, v122
    v_and_b32 v45, 0xffff0000, v122
    v_mul_f32 v44, v44, v28
    v_mul_f32 v45, v45, v29
    v_cvt_pk_bf16_f32 v44, v44, v45
    v_and_b32 v45, 0xffff0000, v44
    v_lshlrev_b32 v44, 16, v44

    v_lshlrev_b32 v46, 16, v123
    v_and_b32 v47, 0xffff0000, v123
    v_mul_f32 v46, v46, v30
    v_mul_f32 v47, v47, v31
    v_cvt_pk_bf16_f32 v46, v46, v47
    v_and_b32 v47, 0xffff0000, v46
    v_lshlrev_b32 v46, 16, v46

    v_lshlrev_b32 v48, 16, v124
    v_and_b32 v49, 0xffff0000, v124
    v_mul_f32 v48, v48, v32
    v_mul_f32 v49, v49, v33
    v_cvt_pk_bf16_f32 v48, v48, v49
    v_and_b32 v49, 0xffff0000, v48
    v_lshlrev_b32 v48, 16, v48

    v_lshlrev_b32 v50, 16, v125
    v_and_b32 v51, 0xffff0000, v125
    v_mul_f32 v50, v50, v34
    v_mul_f32 v51, v51, v35
    v_cvt_pk_bf16_f32 v50, v50, v51
    v_and_b32 v51, 0xffff0000, v50
    v_lshlrev_b32 v50, 16, v50

    v_lshlrev_b32 v52, 16, v126
    v_and_b32 v53, 0xffff0000, v126
    v_mul_f32 v52, v52, v36
    v_mul_f32 v53, v53, v37
    v_cvt_pk_bf16_f32 v52, v52, v53
    v_and_b32 v53, 0xffff0000, v52
    v_lshlrev_b32 v52, 16, v52

    v_lshlrev_b32 v54, 16, v127
    v_and_b32 v55, 0xffff0000, v127
    v_mul_f32 v54, v54, v38
    v_mul_f32 v55, v55, v39
    v_cvt_pk_bf16_f32 v54, v54, v55
    v_and_b32 v55, 0xffff0000, v54
    v_lshlrev_b32 v54, 16, v54

    v_add_f32 v40, v40, v48
    v_add_f32 v41, v41, v49
    v_add_f32 v42, v42, v50
    v_add_f32 v43, v43, v51
    v_add_f32 v44, v44, v52
    v_add_f32 v45, v45, v53
    v_add_f32 v46, v46, v54
    v_add_f32 v47, v47, v55
    v_add_f32 v40, v40, v44
    v_add_f32 v41, v41, v45
    v_add_f32 v42, v42, v46
    v_add_f32 v43, v43, v47
    v_add_f32 v40, v40, v42
    v_add_f32 v41, v41, v43
    v_add_f32 v40, v40, v41
    v_mov_b32 v41, v40
    s_nop 1
    v_permlane32_swap_b32 v40, v41
    v_add_f32 v40, v40, v41
    v_mov_b32 v41, v40
    s_nop 1
    v_permlane16_swap_b32 v40, v41
    v_add_f32 v40, v40, v41
    s_nop 1
    v_add_f32_dpp v40, v40, v40 row_ror:8 row_mask:0xf bank_mask:0xf
    s_nop 1
    v_add_f32_dpp v40, v40, v40 row_ror:4 row_mask:0xf bank_mask:0xf
    s_nop 1
    v_add_f32_dpp v40, v40, v40 row_ror:2 row_mask:0xf bank_mask:0xf
    s_nop 1
    v_add_f32_dpp v40, v40, v40 row_ror:1 row_mask:0xf bank_mask:0xf
    v_cvt_pk_bf16_f32 v40, v40, v40
    v_lshlrev_b32 v40, 16, v40
    v_mul_f32 v40, s38, v40
    v_exp_f32 v40, v40
    s_nop 0
    v_add_f32 v40, 1.0, v40
    v_rcp_f32 v40, v40
    s_nop 0
    v_cvt_pk_bf16_f32 v40, v40, v40
    v_lshlrev_b32 v40, 16, v40

    v_cmp_eq_u32 vcc, 7, v1
    s_nop 1
    v_cndmask_b32 v60, v60, v40, vcc
    s_waitcnt vmcnt(14)
    v_lshlrev_b32 v40, 16, v128
    v_and_b32 v41, 0xffff0000, v128
    v_mul_f32 v40, v40, v24
    v_mul_f32 v41, v41, v25
    v_cvt_pk_bf16_f32 v40, v40, v41
    v_and_b32 v41, 0xffff0000, v40
    v_lshlrev_b32 v40, 16, v40

    v_lshlrev_b32 v42, 16, v129
    v_and_b32 v43, 0xffff0000, v129
    v_mul_f32 v42, v42, v26
    v_mul_f32 v43, v43, v27
    v_cvt_pk_bf16_f32 v42, v42, v43
    v_and_b32 v43, 0xffff0000, v42
    v_lshlrev_b32 v42, 16, v42

    v_lshlrev_b32 v44, 16, v130
    v_and_b32 v45, 0xffff0000, v130
    v_mul_f32 v44, v44, v28
    v_mul_f32 v45, v45, v29
    v_cvt_pk_bf16_f32 v44, v44, v45
    v_and_b32 v45, 0xffff0000, v44
    v_lshlrev_b32 v44, 16, v44

    v_lshlrev_b32 v46, 16, v131
    v_and_b32 v47, 0xffff0000, v131
    v_mul_f32 v46, v46, v30
    v_mul_f32 v47, v47, v31
    v_cvt_pk_bf16_f32 v46, v46, v47
    v_and_b32 v47, 0xffff0000, v46
    v_lshlrev_b32 v46, 16, v46

    v_lshlrev_b32 v48, 16, v132
    v_and_b32 v49, 0xffff0000, v132
    v_mul_f32 v48, v48, v32
    v_mul_f32 v49, v49, v33
    v_cvt_pk_bf16_f32 v48, v48, v49
    v_and_b32 v49, 0xffff0000, v48
    v_lshlrev_b32 v48, 16, v48

    v_lshlrev_b32 v50, 16, v133
    v_and_b32 v51, 0xffff0000, v133
    v_mul_f32 v50, v50, v34
    v_mul_f32 v51, v51, v35
    v_cvt_pk_bf16_f32 v50, v50, v51
    v_and_b32 v51, 0xffff0000, v50
    v_lshlrev_b32 v50, 16, v50

    v_lshlrev_b32 v52, 16, v134
    v_and_b32 v53, 0xffff0000, v134
    v_mul_f32 v52, v52, v36
    v_mul_f32 v53, v53, v37
    v_cvt_pk_bf16_f32 v52, v52, v53
    v_and_b32 v53, 0xffff0000, v52
    v_lshlrev_b32 v52, 16, v52

    v_lshlrev_b32 v54, 16, v135
    v_and_b32 v55, 0xffff0000, v135
    v_mul_f32 v54, v54, v38
    v_mul_f32 v55, v55, v39
    v_cvt_pk_bf16_f32 v54, v54, v55
    v_and_b32 v55, 0xffff0000, v54
    v_lshlrev_b32 v54, 16, v54

    v_add_f32 v40, v40, v48
    v_add_f32 v41, v41, v49
    v_add_f32 v42, v42, v50
    v_add_f32 v43, v43, v51
    v_add_f32 v44, v44, v52
    v_add_f32 v45, v45, v53
    v_add_f32 v46, v46, v54
    v_add_f32 v47, v47, v55
    v_add_f32 v40, v40, v44
    v_add_f32 v41, v41, v45
    v_add_f32 v42, v42, v46
    v_add_f32 v43, v43, v47
    v_add_f32 v40, v40, v42
    v_add_f32 v41, v41, v43
    v_add_f32 v40, v40, v41
    v_mov_b32 v41, v40
    s_nop 1
    v_permlane32_swap_b32 v40, v41
    v_add_f32 v40, v40, v41
    v_mov_b32 v41, v40
    s_nop 1
    v_permlane16_swap_b32 v40, v41
    v_add_f32 v40, v40, v41
    s_nop 1
    v_add_f32_dpp v40, v40, v40 row_ror:8 row_mask:0xf bank_mask:0xf
    s_nop 1
    v_add_f32_dpp v40, v40, v40 row_ror:4 row_mask:0xf bank_mask:0xf
    s_nop 1
    v_add_f32_dpp v40, v40, v40 row_ror:2 row_mask:0xf bank_mask:0xf
    s_nop 1
    v_add_f32_dpp v40, v40, v40 row_ror:1 row_mask:0xf bank_mask:0xf
    v_cvt_pk_bf16_f32 v40, v40, v40
    v_lshlrev_b32 v40, 16, v40
    v_mul_f32 v40, s38, v40
    v_exp_f32 v40, v40
    s_nop 0
    v_add_f32 v40, 1.0, v40
    v_rcp_f32 v40, v40
    s_nop 0
    v_cvt_pk_bf16_f32 v40, v40, v40
    v_lshlrev_b32 v40, 16, v40

    v_cmp_eq_u32 vcc, 8, v1
    s_nop 1
    v_cndmask_b32 v60, v60, v40, vcc
    s_waitcnt vmcnt(12)
    v_lshlrev_b32 v40, 16, v136
    v_and_b32 v41, 0xffff0000, v136
    v_mul_f32 v40, v40, v24
    v_mul_f32 v41, v41, v25
    v_cvt_pk_bf16_f32 v40, v40, v41
    v_and_b32 v41, 0xffff0000, v40
    v_lshlrev_b32 v40, 16, v40

    v_lshlrev_b32 v42, 16, v137
    v_and_b32 v43, 0xffff0000, v137
    v_mul_f32 v42, v42, v26
    v_mul_f32 v43, v43, v27
    v_cvt_pk_bf16_f32 v42, v42, v43
    v_and_b32 v43, 0xffff0000, v42
    v_lshlrev_b32 v42, 16, v42

    v_lshlrev_b32 v44, 16, v138
    v_and_b32 v45, 0xffff0000, v138
    v_mul_f32 v44, v44, v28
    v_mul_f32 v45, v45, v29
    v_cvt_pk_bf16_f32 v44, v44, v45
    v_and_b32 v45, 0xffff0000, v44
    v_lshlrev_b32 v44, 16, v44

    v_lshlrev_b32 v46, 16, v139
    v_and_b32 v47, 0xffff0000, v139
    v_mul_f32 v46, v46, v30
    v_mul_f32 v47, v47, v31
    v_cvt_pk_bf16_f32 v46, v46, v47
    v_and_b32 v47, 0xffff0000, v46
    v_lshlrev_b32 v46, 16, v46

    v_lshlrev_b32 v48, 16, v140
    v_and_b32 v49, 0xffff0000, v140
    v_mul_f32 v48, v48, v32
    v_mul_f32 v49, v49, v33
    v_cvt_pk_bf16_f32 v48, v48, v49
    v_and_b32 v49, 0xffff0000, v48
    v_lshlrev_b32 v48, 16, v48

    v_lshlrev_b32 v50, 16, v141
    v_and_b32 v51, 0xffff0000, v141
    v_mul_f32 v50, v50, v34
    v_mul_f32 v51, v51, v35
    v_cvt_pk_bf16_f32 v50, v50, v51
    v_and_b32 v51, 0xffff0000, v50
    v_lshlrev_b32 v50, 16, v50

    v_lshlrev_b32 v52, 16, v142
    v_and_b32 v53, 0xffff0000, v142
    v_mul_f32 v52, v52, v36
    v_mul_f32 v53, v53, v37
    v_cvt_pk_bf16_f32 v52, v52, v53
    v_and_b32 v53, 0xffff0000, v52
    v_lshlrev_b32 v52, 16, v52

    v_lshlrev_b32 v54, 16, v143
    v_and_b32 v55, 0xffff0000, v143
    v_mul_f32 v54, v54, v38
    v_mul_f32 v55, v55, v39
    v_cvt_pk_bf16_f32 v54, v54, v55
    v_and_b32 v55, 0xffff0000, v54
    v_lshlrev_b32 v54, 16, v54

    v_add_f32 v40, v40, v48
    v_add_f32 v41, v41, v49
    v_add_f32 v42, v42, v50
    v_add_f32 v43, v43, v51
    v_add_f32 v44, v44, v52
    v_add_f32 v45, v45, v53
    v_add_f32 v46, v46, v54
    v_add_f32 v47, v47, v55
    v_add_f32 v40, v40, v44
    v_add_f32 v41, v41, v45
    v_add_f32 v42, v42, v46
    v_add_f32 v43, v43, v47
    v_add_f32 v40, v40, v42
    v_add_f32 v41, v41, v43
    v_add_f32 v40, v40, v41
    v_mov_b32 v41, v40
    s_nop 1
    v_permlane32_swap_b32 v40, v41
    v_add_f32 v40, v40, v41
    v_mov_b32 v41, v40
    s_nop 1
    v_permlane16_swap_b32 v40, v41
    v_add_f32 v40, v40, v41
    s_nop 1
    v_add_f32_dpp v40, v40, v40 row_ror:8 row_mask:0xf bank_mask:0xf
    s_nop 1
    v_add_f32_dpp v40, v40, v40 row_ror:4 row_mask:0xf bank_mask:0xf
    s_nop 1
    v_add_f32_dpp v40, v40, v40 row_ror:2 row_mask:0xf bank_mask:0xf
    s_nop 1
    v_add_f32_dpp v40, v40, v40 row_ror:1 row_mask:0xf bank_mask:0xf
    v_cvt_pk_bf16_f32 v40, v40, v40
    v_lshlrev_b32 v40, 16, v40
    v_mul_f32 v40, s38, v40
    v_exp_f32 v40, v40
    s_nop 0
    v_add_f32 v40, 1.0, v40
    v_rcp_f32 v40, v40
    s_nop 0
    v_cvt_pk_bf16_f32 v40, v40, v40
    v_lshlrev_b32 v40, 16, v40

    v_cmp_eq_u32 vcc, 9, v1
    s_nop 1
    v_cndmask_b32 v60, v60, v40, vcc
    s_waitcnt vmcnt(10)
    v_lshlrev_b32 v40, 16, v144
    v_and_b32 v41, 0xffff0000, v144
    v_mul_f32 v40, v40, v24
    v_mul_f32 v41, v41, v25
    v_cvt_pk_bf16_f32 v40, v40, v41
    v_and_b32 v41, 0xffff0000, v40
    v_lshlrev_b32 v40, 16, v40

    v_lshlrev_b32 v42, 16, v145
    v_and_b32 v43, 0xffff0000, v145
    v_mul_f32 v42, v42, v26
    v_mul_f32 v43, v43, v27
    v_cvt_pk_bf16_f32 v42, v42, v43
    v_and_b32 v43, 0xffff0000, v42
    v_lshlrev_b32 v42, 16, v42

    v_lshlrev_b32 v44, 16, v146
    v_and_b32 v45, 0xffff0000, v146
    v_mul_f32 v44, v44, v28
    v_mul_f32 v45, v45, v29
    v_cvt_pk_bf16_f32 v44, v44, v45
    v_and_b32 v45, 0xffff0000, v44
    v_lshlrev_b32 v44, 16, v44

    v_lshlrev_b32 v46, 16, v147
    v_and_b32 v47, 0xffff0000, v147
    v_mul_f32 v46, v46, v30
    v_mul_f32 v47, v47, v31
    v_cvt_pk_bf16_f32 v46, v46, v47
    v_and_b32 v47, 0xffff0000, v46
    v_lshlrev_b32 v46, 16, v46

    v_lshlrev_b32 v48, 16, v148
    v_and_b32 v49, 0xffff0000, v148
    v_mul_f32 v48, v48, v32
    v_mul_f32 v49, v49, v33
    v_cvt_pk_bf16_f32 v48, v48, v49
    v_and_b32 v49, 0xffff0000, v48
    v_lshlrev_b32 v48, 16, v48

    v_lshlrev_b32 v50, 16, v149
    v_and_b32 v51, 0xffff0000, v149
    v_mul_f32 v50, v50, v34
    v_mul_f32 v51, v51, v35
    v_cvt_pk_bf16_f32 v50, v50, v51
    v_and_b32 v51, 0xffff0000, v50
    v_lshlrev_b32 v50, 16, v50

    v_lshlrev_b32 v52, 16, v150
    v_and_b32 v53, 0xffff0000, v150
    v_mul_f32 v52, v52, v36
    v_mul_f32 v53, v53, v37
    v_cvt_pk_bf16_f32 v52, v52, v53
    v_and_b32 v53, 0xffff0000, v52
    v_lshlrev_b32 v52, 16, v52

    v_lshlrev_b32 v54, 16, v151
    v_and_b32 v55, 0xffff0000, v151
    v_mul_f32 v54, v54, v38
    v_mul_f32 v55, v55, v39
    v_cvt_pk_bf16_f32 v54, v54, v55
    v_and_b32 v55, 0xffff0000, v54
    v_lshlrev_b32 v54, 16, v54

    v_add_f32 v40, v40, v48
    v_add_f32 v41, v41, v49
    v_add_f32 v42, v42, v50
    v_add_f32 v43, v43, v51
    v_add_f32 v44, v44, v52
    v_add_f32 v45, v45, v53
    v_add_f32 v46, v46, v54
    v_add_f32 v47, v47, v55
    v_add_f32 v40, v40, v44
    v_add_f32 v41, v41, v45
    v_add_f32 v42, v42, v46
    v_add_f32 v43, v43, v47
    v_add_f32 v40, v40, v42
    v_add_f32 v41, v41, v43
    v_add_f32 v40, v40, v41
    v_mov_b32 v41, v40
    s_nop 1
    v_permlane32_swap_b32 v40, v41
    v_add_f32 v40, v40, v41
    v_mov_b32 v41, v40
    s_nop 1
    v_permlane16_swap_b32 v40, v41
    v_add_f32 v40, v40, v41
    s_nop 1
    v_add_f32_dpp v40, v40, v40 row_ror:8 row_mask:0xf bank_mask:0xf
    s_nop 1
    v_add_f32_dpp v40, v40, v40 row_ror:4 row_mask:0xf bank_mask:0xf
    s_nop 1
    v_add_f32_dpp v40, v40, v40 row_ror:2 row_mask:0xf bank_mask:0xf
    s_nop 1
    v_add_f32_dpp v40, v40, v40 row_ror:1 row_mask:0xf bank_mask:0xf
    v_cvt_pk_bf16_f32 v40, v40, v40
    v_lshlrev_b32 v40, 16, v40
    v_mul_f32 v40, s38, v40
    v_exp_f32 v40, v40
    s_nop 0
    v_add_f32 v40, 1.0, v40
    v_rcp_f32 v40, v40
    s_nop 0
    v_cvt_pk_bf16_f32 v40, v40, v40
    v_lshlrev_b32 v40, 16, v40

    v_cmp_eq_u32 vcc, 10, v1
    s_nop 1
    v_cndmask_b32 v60, v60, v40, vcc
    s_waitcnt vmcnt(8)
    v_lshlrev_b32 v40, 16, v152
    v_and_b32 v41, 0xffff0000, v152
    v_mul_f32 v40, v40, v24
    v_mul_f32 v41, v41, v25
    v_cvt_pk_bf16_f32 v40, v40, v41
    v_and_b32 v41, 0xffff0000, v40
    v_lshlrev_b32 v40, 16, v40

    v_lshlrev_b32 v42, 16, v153
    v_and_b32 v43, 0xffff0000, v153
    v_mul_f32 v42, v42, v26
    v_mul_f32 v43, v43, v27
    v_cvt_pk_bf16_f32 v42, v42, v43
    v_and_b32 v43, 0xffff0000, v42
    v_lshlrev_b32 v42, 16, v42

    v_lshlrev_b32 v44, 16, v154
    v_and_b32 v45, 0xffff0000, v154
    v_mul_f32 v44, v44, v28
    v_mul_f32 v45, v45, v29
    v_cvt_pk_bf16_f32 v44, v44, v45
    v_and_b32 v45, 0xffff0000, v44
    v_lshlrev_b32 v44, 16, v44

    v_lshlrev_b32 v46, 16, v155
    v_and_b32 v47, 0xffff0000, v155
    v_mul_f32 v46, v46, v30
    v_mul_f32 v47, v47, v31
    v_cvt_pk_bf16_f32 v46, v46, v47
    v_and_b32 v47, 0xffff0000, v46
    v_lshlrev_b32 v46, 16, v46

    v_lshlrev_b32 v48, 16, v156
    v_and_b32 v49, 0xffff0000, v156
    v_mul_f32 v48, v48, v32
    v_mul_f32 v49, v49, v33
    v_cvt_pk_bf16_f32 v48, v48, v49
    v_and_b32 v49, 0xffff0000, v48
    v_lshlrev_b32 v48, 16, v48

    v_lshlrev_b32 v50, 16, v157
    v_and_b32 v51, 0xffff0000, v157
    v_mul_f32 v50, v50, v34
    v_mul_f32 v51, v51, v35
    v_cvt_pk_bf16_f32 v50, v50, v51
    v_and_b32 v51, 0xffff0000, v50
    v_lshlrev_b32 v50, 16, v50

    v_lshlrev_b32 v52, 16, v158
    v_and_b32 v53, 0xffff0000, v158
    v_mul_f32 v52, v52, v36
    v_mul_f32 v53, v53, v37
    v_cvt_pk_bf16_f32 v52, v52, v53
    v_and_b32 v53, 0xffff0000, v52
    v_lshlrev_b32 v52, 16, v52

    v_lshlrev_b32 v54, 16, v159
    v_and_b32 v55, 0xffff0000, v159
    v_mul_f32 v54, v54, v38
    v_mul_f32 v55, v55, v39
    v_cvt_pk_bf16_f32 v54, v54, v55
    v_and_b32 v55, 0xffff0000, v54
    v_lshlrev_b32 v54, 16, v54

    v_add_f32 v40, v40, v48
    v_add_f32 v41, v41, v49
    v_add_f32 v42, v42, v50
    v_add_f32 v43, v43, v51
    v_add_f32 v44, v44, v52
    v_add_f32 v45, v45, v53
    v_add_f32 v46, v46, v54
    v_add_f32 v47, v47, v55
    v_add_f32 v40, v40, v44
    v_add_f32 v41, v41, v45
    v_add_f32 v42, v42, v46
    v_add_f32 v43, v43, v47
    v_add_f32 v40, v40, v42
    v_add_f32 v41, v41, v43
    v_add_f32 v40, v40, v41
    v_mov_b32 v41, v40
    s_nop 1
    v_permlane32_swap_b32 v40, v41
    v_add_f32 v40, v40, v41
    v_mov_b32 v41, v40
    s_nop 1
    v_permlane16_swap_b32 v40, v41
    v_add_f32 v40, v40, v41
    s_nop 1
    v_add_f32_dpp v40, v40, v40 row_ror:8 row_mask:0xf bank_mask:0xf
    s_nop 1
    v_add_f32_dpp v40, v40, v40 row_ror:4 row_mask:0xf bank_mask:0xf
    s_nop 1
    v_add_f32_dpp v40, v40, v40 row_ror:2 row_mask:0xf bank_mask:0xf
    s_nop 1
    v_add_f32_dpp v40, v40, v40 row_ror:1 row_mask:0xf bank_mask:0xf
    v_cvt_pk_bf16_f32 v40, v40, v40
    v_lshlrev_b32 v40, 16, v40
    v_mul_f32 v40, s38, v40
    v_exp_f32 v40, v40
    s_nop 0
    v_add_f32 v40, 1.0, v40
    v_rcp_f32 v40, v40
    s_nop 0
    v_cvt_pk_bf16_f32 v40, v40, v40
    v_lshlrev_b32 v40, 16, v40

    v_cmp_eq_u32 vcc, 11, v1
    s_nop 1
    v_cndmask_b32 v60, v60, v40, vcc
    s_waitcnt vmcnt(6)
    v_lshlrev_b32 v40, 16, v160
    v_and_b32 v41, 0xffff0000, v160
    v_mul_f32 v40, v40, v24
    v_mul_f32 v41, v41, v25
    v_cvt_pk_bf16_f32 v40, v40, v41
    v_and_b32 v41, 0xffff0000, v40
    v_lshlrev_b32 v40, 16, v40

    v_lshlrev_b32 v42, 16, v161
    v_and_b32 v43, 0xffff0000, v161
    v_mul_f32 v42, v42, v26
    v_mul_f32 v43, v43, v27
    v_cvt_pk_bf16_f32 v42, v42, v43
    v_and_b32 v43, 0xffff0000, v42
    v_lshlrev_b32 v42, 16, v42

    v_lshlrev_b32 v44, 16, v162
    v_and_b32 v45, 0xffff0000, v162
    v_mul_f32 v44, v44, v28
    v_mul_f32 v45, v45, v29
    v_cvt_pk_bf16_f32 v44, v44, v45
    v_and_b32 v45, 0xffff0000, v44
    v_lshlrev_b32 v44, 16, v44

    v_lshlrev_b32 v46, 16, v163
    v_and_b32 v47, 0xffff0000, v163
    v_mul_f32 v46, v46, v30
    v_mul_f32 v47, v47, v31
    v_cvt_pk_bf16_f32 v46, v46, v47
    v_and_b32 v47, 0xffff0000, v46
    v_lshlrev_b32 v46, 16, v46

    v_lshlrev_b32 v48, 16, v164
    v_and_b32 v49, 0xffff0000, v164
    v_mul_f32 v48, v48, v32
    v_mul_f32 v49, v49, v33
    v_cvt_pk_bf16_f32 v48, v48, v49
    v_and_b32 v49, 0xffff0000, v48
    v_lshlrev_b32 v48, 16, v48

    v_lshlrev_b32 v50, 16, v165
    v_and_b32 v51, 0xffff0000, v165
    v_mul_f32 v50, v50, v34
    v_mul_f32 v51, v51, v35
    v_cvt_pk_bf16_f32 v50, v50, v51
    v_and_b32 v51, 0xffff0000, v50
    v_lshlrev_b32 v50, 16, v50

    v_lshlrev_b32 v52, 16, v166
    v_and_b32 v53, 0xffff0000, v166
    v_mul_f32 v52, v52, v36
    v_mul_f32 v53, v53, v37
    v_cvt_pk_bf16_f32 v52, v52, v53
    v_and_b32 v53, 0xffff0000, v52
    v_lshlrev_b32 v52, 16, v52

    v_lshlrev_b32 v54, 16, v167
    v_and_b32 v55, 0xffff0000, v167
    v_mul_f32 v54, v54, v38
    v_mul_f32 v55, v55, v39
    v_cvt_pk_bf16_f32 v54, v54, v55
    v_and_b32 v55, 0xffff0000, v54
    v_lshlrev_b32 v54, 16, v54

    v_add_f32 v40, v40, v48
    v_add_f32 v41, v41, v49
    v_add_f32 v42, v42, v50
    v_add_f32 v43, v43, v51
    v_add_f32 v44, v44, v52
    v_add_f32 v45, v45, v53
    v_add_f32 v46, v46, v54
    v_add_f32 v47, v47, v55
    v_add_f32 v40, v40, v44
    v_add_f32 v41, v41, v45
    v_add_f32 v42, v42, v46
    v_add_f32 v43, v43, v47
    v_add_f32 v40, v40, v42
    v_add_f32 v41, v41, v43
    v_add_f32 v40, v40, v41
    v_mov_b32 v41, v40
    s_nop 1
    v_permlane32_swap_b32 v40, v41
    v_add_f32 v40, v40, v41
    v_mov_b32 v41, v40
    s_nop 1
    v_permlane16_swap_b32 v40, v41
    v_add_f32 v40, v40, v41
    s_nop 1
    v_add_f32_dpp v40, v40, v40 row_ror:8 row_mask:0xf bank_mask:0xf
    s_nop 1
    v_add_f32_dpp v40, v40, v40 row_ror:4 row_mask:0xf bank_mask:0xf
    s_nop 1
    v_add_f32_dpp v40, v40, v40 row_ror:2 row_mask:0xf bank_mask:0xf
    s_nop 1
    v_add_f32_dpp v40, v40, v40 row_ror:1 row_mask:0xf bank_mask:0xf
    v_cvt_pk_bf16_f32 v40, v40, v40
    v_lshlrev_b32 v40, 16, v40
    v_mul_f32 v40, s38, v40
    v_exp_f32 v40, v40
    s_nop 0
    v_add_f32 v40, 1.0, v40
    v_rcp_f32 v40, v40
    s_nop 0
    v_cvt_pk_bf16_f32 v40, v40, v40
    v_lshlrev_b32 v40, 16, v40

    v_cmp_eq_u32 vcc, 12, v1
    s_nop 1
    v_cndmask_b32 v60, v60, v40, vcc
    s_waitcnt vmcnt(4)
    v_lshlrev_b32 v40, 16, v168
    v_and_b32 v41, 0xffff0000, v168
    v_mul_f32 v40, v40, v24
    v_mul_f32 v41, v41, v25
    v_cvt_pk_bf16_f32 v40, v40, v41
    v_and_b32 v41, 0xffff0000, v40
    v_lshlrev_b32 v40, 16, v40

    v_lshlrev_b32 v42, 16, v169
    v_and_b32 v43, 0xffff0000, v169
    v_mul_f32 v42, v42, v26
    v_mul_f32 v43, v43, v27
    v_cvt_pk_bf16_f32 v42, v42, v43
    v_and_b32 v43, 0xffff0000, v42
    v_lshlrev_b32 v42, 16, v42

    v_lshlrev_b32 v44, 16, v170
    v_and_b32 v45, 0xffff0000, v170
    v_mul_f32 v44, v44, v28
    v_mul_f32 v45, v45, v29
    v_cvt_pk_bf16_f32 v44, v44, v45
    v_and_b32 v45, 0xffff0000, v44
    v_lshlrev_b32 v44, 16, v44

    v_lshlrev_b32 v46, 16, v171
    v_and_b32 v47, 0xffff0000, v171
    v_mul_f32 v46, v46, v30
    v_mul_f32 v47, v47, v31
    v_cvt_pk_bf16_f32 v46, v46, v47
    v_and_b32 v47, 0xffff0000, v46
    v_lshlrev_b32 v46, 16, v46

    v_lshlrev_b32 v48, 16, v172
    v_and_b32 v49, 0xffff0000, v172
    v_mul_f32 v48, v48, v32
    v_mul_f32 v49, v49, v33
    v_cvt_pk_bf16_f32 v48, v48, v49
    v_and_b32 v49, 0xffff0000, v48
    v_lshlrev_b32 v48, 16, v48

    v_lshlrev_b32 v50, 16, v173
    v_and_b32 v51, 0xffff0000, v173
    v_mul_f32 v50, v50, v34
    v_mul_f32 v51, v51, v35
    v_cvt_pk_bf16_f32 v50, v50, v51
    v_and_b32 v51, 0xffff0000, v50
    v_lshlrev_b32 v50, 16, v50

    v_lshlrev_b32 v52, 16, v174
    v_and_b32 v53, 0xffff0000, v174
    v_mul_f32 v52, v52, v36
    v_mul_f32 v53, v53, v37
    v_cvt_pk_bf16_f32 v52, v52, v53
    v_and_b32 v53, 0xffff0000, v52
    v_lshlrev_b32 v52, 16, v52

    v_lshlrev_b32 v54, 16, v175
    v_and_b32 v55, 0xffff0000, v175
    v_mul_f32 v54, v54, v38
    v_mul_f32 v55, v55, v39
    v_cvt_pk_bf16_f32 v54, v54, v55
    v_and_b32 v55, 0xffff0000, v54
    v_lshlrev_b32 v54, 16, v54

    v_add_f32 v40, v40, v48
    v_add_f32 v41, v41, v49
    v_add_f32 v42, v42, v50
    v_add_f32 v43, v43, v51
    v_add_f32 v44, v44, v52
    v_add_f32 v45, v45, v53
    v_add_f32 v46, v46, v54
    v_add_f32 v47, v47, v55
    v_add_f32 v40, v40, v44
    v_add_f32 v41, v41, v45
    v_add_f32 v42, v42, v46
    v_add_f32 v43, v43, v47
    v_add_f32 v40, v40, v42
    v_add_f32 v41, v41, v43
    v_add_f32 v40, v40, v41
    v_mov_b32 v41, v40
    s_nop 1
    v_permlane32_swap_b32 v40, v41
    v_add_f32 v40, v40, v41
    v_mov_b32 v41, v40
    s_nop 1
    v_permlane16_swap_b32 v40, v41
    v_add_f32 v40, v40, v41
    s_nop 1
    v_add_f32_dpp v40, v40, v40 row_ror:8 row_mask:0xf bank_mask:0xf
    s_nop 1
    v_add_f32_dpp v40, v40, v40 row_ror:4 row_mask:0xf bank_mask:0xf
    s_nop 1
    v_add_f32_dpp v40, v40, v40 row_ror:2 row_mask:0xf bank_mask:0xf
    s_nop 1
    v_add_f32_dpp v40, v40, v40 row_ror:1 row_mask:0xf bank_mask:0xf
    v_cvt_pk_bf16_f32 v40, v40, v40
    v_lshlrev_b32 v40, 16, v40
    v_mul_f32 v40, s38, v40
    v_exp_f32 v40, v40
    s_nop 0
    v_add_f32 v40, 1.0, v40
    v_rcp_f32 v40, v40
    s_nop 0
    v_cvt_pk_bf16_f32 v40, v40, v40
    v_lshlrev_b32 v40, 16, v40

    v_cmp_eq_u32 vcc, 13, v1
    s_nop 1
    v_cndmask_b32 v60, v60, v40, vcc
    s_waitcnt vmcnt(2)
    v_lshlrev_b32 v40, 16, v176
    v_and_b32 v41, 0xffff0000, v176
    v_mul_f32 v40, v40, v24
    v_mul_f32 v41, v41, v25
    v_cvt_pk_bf16_f32 v40, v40, v41
    v_and_b32 v41, 0xffff0000, v40
    v_lshlrev_b32 v40, 16, v40

    v_lshlrev_b32 v42, 16, v177
    v_and_b32 v43, 0xffff0000, v177
    v_mul_f32 v42, v42, v26
    v_mul_f32 v43, v43, v27
    v_cvt_pk_bf16_f32 v42, v42, v43
    v_and_b32 v43, 0xffff0000, v42
    v_lshlrev_b32 v42, 16, v42

    v_lshlrev_b32 v44, 16, v178
    v_and_b32 v45, 0xffff0000, v178
    v_mul_f32 v44, v44, v28
    v_mul_f32 v45, v45, v29
    v_cvt_pk_bf16_f32 v44, v44, v45
    v_and_b32 v45, 0xffff0000, v44
    v_lshlrev_b32 v44, 16, v44

    v_lshlrev_b32 v46, 16, v179
    v_and_b32 v47, 0xffff0000, v179
    v_mul_f32 v46, v46, v30
    v_mul_f32 v47, v47, v31
    v_cvt_pk_bf16_f32 v46, v46, v47
    v_and_b32 v47, 0xffff0000, v46
    v_lshlrev_b32 v46, 16, v46

    v_lshlrev_b32 v48, 16, v180
    v_and_b32 v49, 0xffff0000, v180
    v_mul_f32 v48, v48, v32
    v_mul_f32 v49, v49, v33
    v_cvt_pk_bf16_f32 v48, v48, v49
    v_and_b32 v49, 0xffff0000, v48
    v_lshlrev_b32 v48, 16, v48

    v_lshlrev_b32 v50, 16, v181
    v_and_b32 v51, 0xffff0000, v181
    v_mul_f32 v50, v50, v34
    v_mul_f32 v51, v51, v35
    v_cvt_pk_bf16_f32 v50, v50, v51
    v_and_b32 v51, 0xffff0000, v50
    v_lshlrev_b32 v50, 16, v50

    v_lshlrev_b32 v52, 16, v182
    v_and_b32 v53, 0xffff0000, v182
    v_mul_f32 v52, v52, v36
    v_mul_f32 v53, v53, v37
    v_cvt_pk_bf16_f32 v52, v52, v53
    v_and_b32 v53, 0xffff0000, v52
    v_lshlrev_b32 v52, 16, v52

    v_lshlrev_b32 v54, 16, v183
    v_and_b32 v55, 0xffff0000, v183
    v_mul_f32 v54, v54, v38
    v_mul_f32 v55, v55, v39
    v_cvt_pk_bf16_f32 v54, v54, v55
    v_and_b32 v55, 0xffff0000, v54
    v_lshlrev_b32 v54, 16, v54

    v_add_f32 v40, v40, v48
    v_add_f32 v41, v41, v49
    v_add_f32 v42, v42, v50
    v_add_f32 v43, v43, v51
    v_add_f32 v44, v44, v52
    v_add_f32 v45, v45, v53
    v_add_f32 v46, v46, v54
    v_add_f32 v47, v47, v55
    v_add_f32 v40, v40, v44
    v_add_f32 v41, v41, v45
    v_add_f32 v42, v42, v46
    v_add_f32 v43, v43, v47
    v_add_f32 v40, v40, v42
    v_add_f32 v41, v41, v43
    v_add_f32 v40, v40, v41
    v_mov_b32 v41, v40
    s_nop 1
    v_permlane32_swap_b32 v40, v41
    v_add_f32 v40, v40, v41
    v_mov_b32 v41, v40
    s_nop 1
    v_permlane16_swap_b32 v40, v41
    v_add_f32 v40, v40, v41
    s_nop 1
    v_add_f32_dpp v40, v40, v40 row_ror:8 row_mask:0xf bank_mask:0xf
    s_nop 1
    v_add_f32_dpp v40, v40, v40 row_ror:4 row_mask:0xf bank_mask:0xf
    s_nop 1
    v_add_f32_dpp v40, v40, v40 row_ror:2 row_mask:0xf bank_mask:0xf
    s_nop 1
    v_add_f32_dpp v40, v40, v40 row_ror:1 row_mask:0xf bank_mask:0xf
    v_cvt_pk_bf16_f32 v40, v40, v40
    v_lshlrev_b32 v40, 16, v40
    v_mul_f32 v40, s38, v40
    v_exp_f32 v40, v40
    s_nop 0
    v_add_f32 v40, 1.0, v40
    v_rcp_f32 v40, v40
    s_nop 0
    v_cvt_pk_bf16_f32 v40, v40, v40
    v_lshlrev_b32 v40, 16, v40

    v_cmp_eq_u32 vcc, 14, v1
    s_nop 1
    v_cndmask_b32 v60, v60, v40, vcc
    s_waitcnt vmcnt(0)
    v_lshlrev_b32 v40, 16, v184
    v_and_b32 v41, 0xffff0000, v184
    v_mul_f32 v40, v40, v24
    v_mul_f32 v41, v41, v25
    v_cvt_pk_bf16_f32 v40, v40, v41
    v_and_b32 v41, 0xffff0000, v40
    v_lshlrev_b32 v40, 16, v40

    v_lshlrev_b32 v42, 16, v185
    v_and_b32 v43, 0xffff0000, v185
    v_mul_f32 v42, v42, v26
    v_mul_f32 v43, v43, v27
    v_cvt_pk_bf16_f32 v42, v42, v43
    v_and_b32 v43, 0xffff0000, v42
    v_lshlrev_b32 v42, 16, v42

    v_lshlrev_b32 v44, 16, v186
    v_and_b32 v45, 0xffff0000, v186
    v_mul_f32 v44, v44, v28
    v_mul_f32 v45, v45, v29
    v_cvt_pk_bf16_f32 v44, v44, v45
    v_and_b32 v45, 0xffff0000, v44
    v_lshlrev_b32 v44, 16, v44

    v_lshlrev_b32 v46, 16, v187
    v_and_b32 v47, 0xffff0000, v187
    v_mul_f32 v46, v46, v30
    v_mul_f32 v47, v47, v31
    v_cvt_pk_bf16_f32 v46, v46, v47
    v_and_b32 v47, 0xffff0000, v46
    v_lshlrev_b32 v46, 16, v46

    v_lshlrev_b32 v48, 16, v188
    v_and_b32 v49, 0xffff0000, v188
    v_mul_f32 v48, v48, v32
    v_mul_f32 v49, v49, v33
    v_cvt_pk_bf16_f32 v48, v48, v49
    v_and_b32 v49, 0xffff0000, v48
    v_lshlrev_b32 v48, 16, v48

    v_lshlrev_b32 v50, 16, v189
    v_and_b32 v51, 0xffff0000, v189
    v_mul_f32 v50, v50, v34
    v_mul_f32 v51, v51, v35
    v_cvt_pk_bf16_f32 v50, v50, v51
    v_and_b32 v51, 0xffff0000, v50
    v_lshlrev_b32 v50, 16, v50

    v_lshlrev_b32 v52, 16, v190
    v_and_b32 v53, 0xffff0000, v190
    v_mul_f32 v52, v52, v36
    v_mul_f32 v53, v53, v37
    v_cvt_pk_bf16_f32 v52, v52, v53
    v_and_b32 v53, 0xffff0000, v52
    v_lshlrev_b32 v52, 16, v52

    v_lshlrev_b32 v54, 16, v191
    v_and_b32 v55, 0xffff0000, v191
    v_mul_f32 v54, v54, v38
    v_mul_f32 v55, v55, v39
    v_cvt_pk_bf16_f32 v54, v54, v55
    v_and_b32 v55, 0xffff0000, v54
    v_lshlrev_b32 v54, 16, v54

    v_add_f32 v40, v40, v48
    v_add_f32 v41, v41, v49
    v_add_f32 v42, v42, v50
    v_add_f32 v43, v43, v51
    v_add_f32 v44, v44, v52
    v_add_f32 v45, v45, v53
    v_add_f32 v46, v46, v54
    v_add_f32 v47, v47, v55
    v_add_f32 v40, v40, v44
    v_add_f32 v41, v41, v45
    v_add_f32 v42, v42, v46
    v_add_f32 v43, v43, v47
    v_add_f32 v40, v40, v42
    v_add_f32 v41, v41, v43
    v_add_f32 v40, v40, v41
    v_mov_b32 v41, v40
    s_nop 1
    v_permlane32_swap_b32 v40, v41
    v_add_f32 v40, v40, v41
    v_mov_b32 v41, v40
    s_nop 1
    v_permlane16_swap_b32 v40, v41
    v_add_f32 v40, v40, v41
    s_nop 1
    v_add_f32_dpp v40, v40, v40 row_ror:8 row_mask:0xf bank_mask:0xf
    s_nop 1
    v_add_f32_dpp v40, v40, v40 row_ror:4 row_mask:0xf bank_mask:0xf
    s_nop 1
    v_add_f32_dpp v40, v40, v40 row_ror:2 row_mask:0xf bank_mask:0xf
    s_nop 1
    v_add_f32_dpp v40, v40, v40 row_ror:1 row_mask:0xf bank_mask:0xf
    v_cvt_pk_bf16_f32 v40, v40, v40
    v_lshlrev_b32 v40, 16, v40
    v_mul_f32 v40, s38, v40
    v_exp_f32 v40, v40
    s_nop 0
    v_add_f32 v40, 1.0, v40
    v_rcp_f32 v40, v40
    s_nop 0
    v_cvt_pk_bf16_f32 v40, v40, v40
    v_lshlrev_b32 v40, 16, v40

    v_cmp_eq_u32 vcc, 15, v1
    s_nop 1
    v_cndmask_b32 v60, v60, v40, vcc
    s_lshl_b32 s5, s3, 2
    s_add_u32 s5, s5, 121634816
    v_lshlrev_b32 v8, 2, v1
    s_mov_b64 exec, 0xffff
    buffer_store_dword v60, v8, s[8:11], s5 offen sc1
    s_mov_b64 exec, -1

    s_load_dwordx4 s[52:55], s[0:1], 32
    s_lshl_b32 s3, s93, 5
    s_lshl_b32 s4, s24, 3
    s_add_u32 s3, s3, s4
    s_lshl_b32 s4, s3, 1
    s_waitcnt lgkmcnt(0)
    s_load_dwordx4 s[64:67], s[54:55], s4

    s_mov_b32 s28, s52
    s_and_b32 s29, s53, 0xffff
    s_mov_b32 s30, 0x400000
    s_mov_b32 s31, 0x00020000

    v_and_b32 v1, 63, v0
    v_and_b32 v2, 15, v1
    v_lshrrev_b32 v3, 4, v1

    s_lshl_b32 s32, s3, 12
    s_add_u32 s33, s32, 28672
    s_mul_i32 s34, s24, 38400
    s_add_u32 s35, s34, 33536
    s_add_u32 s38, s32, 117440512
    v_lshlrev_b32 v4, 4, v1
    v_add_u32 v5, s34, v4
    v_add_u32 v5, 64, v5
    v_sub_u32 v6, 7, v2
    v_and_b32 v6, 7, v6
    v_mul_u32_u24 v6, 4160, v6
    v_lshrrev_b32 v7, 3, v2
    v_sub_u32 v7, v7, v3
    v_add_u32 v7, 4, v7
    v_lshl_add_u32 v6, v7, 4, v6
    v_add_u32 v6, s34, v6
    v_mul_u32_u24 v7, 80, v3
    v_add_u32 v7, v7, v2
    v_lshlrev_b32 v7, 4, v7
    v_add_u32 v7, s34, v7
    v_add_u32 v7, 33296, v7
    v_lshlrev_b32 v228, 7, v2
    v_lshl_add_u32 v228, v3, 4, v228
    v_subrev_u32 v229, 16, v4
    v_max_i32 v230, 0, v229
    v_sub_u32 v232, 7, v2
    v_and_b32 v232, 7, v232
    v_and_b32 v233, 1, v232
    v_lshlrev_b32 v233, 4, v233
    v_mov_b32 v234, 0xffff
    v_lshlrev_b32 v233, v233, v234
    v_lshrrev_b32 v232, 1, v232
    v_lshrrev_b32 v234, 3, v2
    v_sub_u32 v234, v3, v234
    v_lshl_add_u32 v232, v234, 1, v232
    v_and_b32 v234, 1, v234
    v_lshl_add_u32 v232, v234, 8, v232

    v_cmp_eq_u32 vcc, 0, v232
    s_nop 1
    v_cndmask_b32 v8, 0, v233, vcc
    v_cmp_eq_u32 vcc, 1, v232
    s_nop 1
    v_cndmask_b32 v9, 0, v233, vcc
    v_cmp_eq_u32 vcc, 2, v232
    s_nop 1
    v_cndmask_b32 v10, 0, v233, vcc
    v_cmp_eq_u32 vcc, 3, v232
    s_nop 1
    v_cndmask_b32 v11, 0, v233, vcc
    v_cmp_eq_u32 vcc, 4, v232
    s_nop 1
    v_cndmask_b32 v12, 0, v233, vcc
    v_cmp_eq_u32 vcc, 5, v232
    s_nop 1
    v_cndmask_b32 v13, 0, v233, vcc
    v_cmp_eq_u32 vcc, 6, v232
    s_nop 1
    v_cndmask_b32 v14, 0, v233, vcc
    v_cmp_eq_u32 vcc, 7, v232
    s_nop 1
    v_cndmask_b32 v15, 0, v233, vcc
    v_mov_b32 v208, 0
    v_mov_b32 v209, 0
    v_mov_b32 v210, 0
    v_mov_b32 v211, 0
    v_lshrrev_b32 v232, 2, v1
    v_and_b32 v232, 7, v232
    v_mul_u32_u24 v232, 4160, v232
    v_and_b32 v233, 3, v1
    v_lshl_add_u32 v232, v233, 4, v232
    v_add_u32 v232, s34, v232
    ds_write_b128 v232, v[208:211]
    v_subrev_u32 v233, 16, v7
    ds_write_b128 v233, v[208:211]

    v_mov_b32 v5, 0
    s_mov_b32 s62, 0
    s_mov_b32 s5, 40
.wc_395:
    buffer_load_dword v4, v5, s[20:23], s5 offen sc1
    s_waitcnt vmcnt(0)
    v_readfirstlane_b32 s4, v4
    s_lshr_b32 s4, s4, 0
    s_and_b32 s4, s4, 0xffff
    s_cmp_ge_u32 s4, 32
    s_cbranch_scc1 .wcd_396
    s_sleep 6
    s_add_u32 s62, s62, 1
    s_cmp_gt_u32 s62, 0x400000
    s_cbranch_scc1 .mg_end_1
    s_branch .wc_395

.wcd_396:
    v_lshlrev_b32 v4, 4, v1
    v_add_u32 v5, s34, v4
    v_add_u32 v5, 64, v5

    s_add_u32 s39, s32, 125829120
    buffer_load_dwordx4 v[176:179], v230, s[28:31], s32 offen offset:0
    buffer_load_dwordx4 v[180:183], v4, s[28:31], s32 offen offset:0
    buffer_load_dwordx4 v[184:187], v4, s[28:31], s32 offen offset:1008
    buffer_load_dwordx4 v[188:191], v4, s[28:31], s32 offen offset:1024
    buffer_load_dwordx4 v[192:195], v4, s[28:31], s32 offen offset:2032
    buffer_load_dwordx4 v[196:199], v4, s[28:31], s32 offen offset:2048
    buffer_load_dwordx4 v[200:203], v4, s[28:31], s32 offen offset:3056
    buffer_load_dwordx4 v[204:207], v4, s[28:31], s32 offen offset:3072
    s_add_u32 m0, s35, 0
    s_nop 0
    buffer_load_dwordx4 v4, s[8:11], s39 offen offset:0 lds
    s_add_u32 m0, s35, 256
    s_nop 0
    buffer_load_dwordx4 v4, s[8:11], s39 offen offset:1024 lds
    s_add_u32 m0, s35, 512
    s_nop 0
    buffer_load_dwordx4 v4, s[8:11], s39 offen offset:2048 lds
    s_add_u32 m0, s35, 768
    s_nop 0
    buffer_load_dwordx4 v4, s[8:11], s39 offen offset:3072 lds
    s_waitcnt vmcnt(0) lgkmcnt(0)
    s_pack_ll_b32_b16 s40, s64, s64
    s_add_u32 s36, s32, 4096
    s_add_u32 s37, s32, 8192
    s_add_u32 s39, s36, 125829120
    s_mov_b64 exec, 1
    v_mov_b32 v176, 0
    v_mov_b32 v177, 0
    v_mov_b32 v178, 0
    v_mov_b32 v179, 0
    s_mov_b64 exec, -1
    ds_write_b128 v5, v[180:183] offset:0
    ds_write_b128 v5, v[178:181] offset:16640
    v_mov_b32 v208, v177
    v_mov_b32 v209, v178
    v_mov_b32 v210, v179
    v_mov_b32 v211, v180
    ds_write_b128 v5, v[208:211] offset:24960
    v_mov_b32 v212, v181
    v_mov_b32 v213, v182
    ds_write_b128 v5, v[210:213] offset:8320
    v_alignbit_b32 v214, v177, v176, 16
    v_alignbit_b32 v215, v178, v177, 16
    v_alignbit_b32 v216, v179, v178, 16
    v_alignbit_b32 v217, v180, v179, 16
    ds_write_b128 v5, v[214:217] offset:29120
    v_alignbit_b32 v218, v181, v180, 16
    v_alignbit_b32 v219, v182, v181, 16
    ds_write_b128 v5, v[216:219] offset:12480
    v_alignbit_b32 v220, v178, v177, 16
    v_alignbit_b32 v221, v179, v178, 16
    v_alignbit_b32 v222, v180, v179, 16
    v_alignbit_b32 v223, v181, v180, 16
    ds_write_b128 v5, v[220:223] offset:20800
    v_alignbit_b32 v224, v182, v181, 16
    v_alignbit_b32 v225, v183, v182, 16
    ds_write_b128 v5, v[222:225] offset:4160
    buffer_load_dwordx4 v[176:179], v230, s[28:31], s36 offen offset:0
    buffer_load_dwordx4 v[180:183], v4, s[28:31], s36 offen offset:0
    ds_write_b128 v5, v[188:191] offset:1024
    ds_write_b128 v5, v[186:189] offset:17664
    v_mov_b32 v208, v185
    v_mov_b32 v209, v186
    v_mov_b32 v210, v187
    v_mov_b32 v211, v188
    ds_write_b128 v5, v[208:211] offset:25984
    v_mov_b32 v212, v189
    v_mov_b32 v213, v190
    ds_write_b128 v5, v[210:213] offset:9344
    v_alignbit_b32 v214, v185, v184, 16
    v_alignbit_b32 v215, v186, v185, 16
    v_alignbit_b32 v216, v187, v186, 16
    v_alignbit_b32 v217, v188, v187, 16
    ds_write_b128 v5, v[214:217] offset:30144
    v_alignbit_b32 v218, v189, v188, 16
    v_alignbit_b32 v219, v190, v189, 16
    ds_write_b128 v5, v[216:219] offset:13504
    v_alignbit_b32 v220, v186, v185, 16
    v_alignbit_b32 v221, v187, v186, 16
    v_alignbit_b32 v222, v188, v187, 16
    v_alignbit_b32 v223, v189, v188, 16
    ds_write_b128 v5, v[220:223] offset:21824
    v_alignbit_b32 v224, v190, v189, 16
    v_alignbit_b32 v225, v191, v190, 16
    ds_write_b128 v5, v[222:225] offset:5184
    buffer_load_dwordx4 v[184:187], v4, s[28:31], s36 offen offset:1008
    buffer_load_dwordx4 v[188:191], v4, s[28:31], s36 offen offset:1024
    v_and_b32 v236, s40, v8
    v_and_b32 v237, s40, v9
    v_and_b32 v238, s40, v10
    v_and_b32 v239, s40, v11
    v_and_b32 v240, s40, v12
    v_and_b32 v241, s40, v13
    v_and_b32 v242, s40, v14
    v_and_b32 v243, s40, v15
    ds_read_b128 a[60:63], v7 offset:240
    ds_read_b128 a[124:127], v7 offset:496
    ds_read_b128 a[188:191], v7 offset:752
    ds_read_b128 a[252:255], v7 offset:1008
    ds_read_b128 v[168:171], v6 offset:0
    ds_read_b128 v[172:175], v6 offset:32
    s_waitcnt vmcnt(0) lgkmcnt(0)
    s_mov_b32 s42, 0
.cvl_397:
    s_waitcnt lgkmcnt(5)
    v_mfma_f32_16x16x32_bf16 v[16:19], v[236:239], a[60:63], 0
    v_mfma_f32_16x16x32_bf16 v[32:35], v[240:243], a[60:63], 0
    s_waitcnt lgkmcnt(4)
    v_mfma_f32_16x16x32_bf16 v[20:23], v[236:239], a[124:127], 0
    v_mfma_f32_16x16x32_bf16 v[36:39], v[240:243], a[124:127], 0
    s_waitcnt lgkmcnt(3)
    v_mfma_f32_16x16x32_bf16 v[24:27], v[236:239], a[188:191], 0
    v_mfma_f32_16x16x32_bf16 v[40:43], v[240:243], a[188:191], 0
    ds_read_b128 a[56:59], v7 offset:224
    s_waitcnt lgkmcnt(3)
    v_mfma_f32_16x16x32_bf16 v[28:31], v[236:239], a[252:255], 0
    ds_read_b128 v[112:115], v6 offset:64
    v_mfma_f32_16x16x32_bf16 v[44:47], v[240:243], a[252:255], 0
    ds_read_b128 v[116:119], v6 offset:96
    s_waitcnt lgkmcnt(4)
    v_mfma_f32_16x16x32_bf16 v[16:19], v[168:171], a[60:63], v[16:19]
    ds_read_b128 a[120:123], v7 offset:480
    s_waitcnt lgkmcnt(4)
    v_mfma_f32_16x16x32_bf16 v[32:35], v[172:175], a[60:63], v[32:35]
    s_waitcnt vmcnt(18)
    v_mfma_f32_16x16x32_bf16 v[20:23], v[168:171], a[124:127], v[20:23]
    ds_read_b128 a[184:187], v7 offset:736
    v_mfma_f32_16x16x32_bf16 v[36:39], v[172:175], a[124:127], v[36:39]
    ds_write_b128 v5, v[196:199] offset:2048
    v_mfma_f32_16x16x32_bf16 v[24:27], v[168:171], a[188:191], v[24:27]
    ds_read_b128 a[248:251], v7 offset:992
    v_mfma_f32_16x16x32_bf16 v[40:43], v[172:175], a[188:191], v[40:43]
    ds_read_b128 a[52:55], v7 offset:208
    v_mfma_f32_16x16x32_bf16 v[28:31], v[168:171], a[252:255], v[28:31]
    ds_read_b128 v[120:123], v6 offset:128
    v_mfma_f32_16x16x32_bf16 v[44:47], v[172:175], a[252:255], v[44:47]
    ds_read_b128 v[124:127], v6 offset:160
    s_waitcnt lgkmcnt(8)
    v_mfma_f32_16x16x32_bf16 v[16:19], v[112:115], a[56:59], v[16:19]
    ds_read_b128 a[116:119], v7 offset:464
    s_waitcnt lgkmcnt(8)
    v_mfma_f32_16x16x32_bf16 v[32:35], v[116:119], a[56:59], v[32:35]
    ds_write_b128 v5, v[194:197] offset:18688
    s_waitcnt lgkmcnt(8)
    v_mfma_f32_16x16x32_bf16 v[20:23], v[112:115], a[120:123], v[20:23]
    ds_read_b128 a[180:183], v7 offset:720
    v_mfma_f32_16x16x32_bf16 v[36:39], v[116:119], a[120:123], v[36:39]
    v_mov_b32 v208, v193
    v_mov_b32 v209, v194
    s_waitcnt lgkmcnt(8)
    v_mfma_f32_16x16x32_bf16 v[24:27], v[112:115], a[184:187], v[24:27]
    ds_read_b128 a[244:247], v7 offset:976
    v_mfma_f32_16x16x32_bf16 v[40:43], v[116:119], a[184:187], v[40:43]
    ds_read_b128 a[48:51], v7 offset:192
    s_waitcnt lgkmcnt(8)
    v_mfma_f32_16x16x32_bf16 v[28:31], v[112:115], a[248:251], v[28:31]
    ds_read_b128 v[128:131], v6 offset:192
    v_mfma_f32_16x16x32_bf16 v[44:47], v[116:119], a[248:251], v[44:47]
    ds_read_b128 v[132:135], v6 offset:224
    s_waitcnt lgkmcnt(8)
    v_mfma_f32_16x16x32_bf16 v[16:19], v[120:123], a[52:55], v[16:19]
    ds_read_b128 a[112:115], v7 offset:448
    s_waitcnt lgkmcnt(8)
    v_mfma_f32_16x16x32_bf16 v[32:35], v[124:127], a[52:55], v[32:35]
    v_mov_b32 v210, v195
    v_mov_b32 v211, v196
    s_waitcnt lgkmcnt(7)
    v_mfma_f32_16x16x32_bf16 v[20:23], v[120:123], a[116:119], v[20:23]
    ds_read_b128 a[176:179], v7 offset:704
    v_mfma_f32_16x16x32_bf16 v[36:39], v[124:127], a[116:119], v[36:39]
    ds_write_b128 v5, v[208:211] offset:27008
    s_waitcnt lgkmcnt(7)
    v_mfma_f32_16x16x32_bf16 v[24:27], v[120:123], a[180:183], v[24:27]
    ds_read_b128 a[240:243], v7 offset:960
    v_mfma_f32_16x16x32_bf16 v[40:43], v[124:127], a[180:183], v[40:43]
    ds_read_b128 a[44:47], v7 offset:176
    s_waitcnt lgkmcnt(8)
    v_mfma_f32_16x16x32_bf16 v[28:31], v[120:123], a[244:247], v[28:31]
    ds_read_b128 v[136:139], v6 offset:256
    v_mfma_f32_16x16x32_bf16 v[44:47], v[124:127], a[244:247], v[44:47]
    ds_read_b128 v[140:143], v6 offset:288
    s_waitcnt lgkmcnt(8)
    v_mfma_f32_16x16x32_bf16 v[16:19], v[128:131], a[48:51], v[16:19]
    ds_read_b128 a[108:111], v7 offset:432
    s_waitcnt lgkmcnt(8)
    v_mfma_f32_16x16x32_bf16 v[32:35], v[132:135], a[48:51], v[32:35]
    v_mov_b32 v212, v197
    v_mov_b32 v213, v198
    s_waitcnt lgkmcnt(7)
    v_mfma_f32_16x16x32_bf16 v[20:23], v[128:131], a[112:115], v[20:23]
    ds_read_b128 a[172:175], v7 offset:688
    v_mfma_f32_16x16x32_bf16 v[36:39], v[132:135], a[112:115], v[36:39]
    ds_write_b128 v5, v[210:213] offset:10368
    s_waitcnt lgkmcnt(8)
    v_mfma_f32_16x16x32_bf16 v[24:27], v[128:131], a[176:179], v[24:27]
    ds_read_b128 a[236:239], v7 offset:944
    v_mfma_f32_16x16x32_bf16 v[40:43], v[132:135], a[176:179], v[40:43]
    ds_read_b128 a[40:43], v7 offset:160
    s_waitcnt lgkmcnt(8)
    v_mfma_f32_16x16x32_bf16 v[28:31], v[128:131], a[240:243], v[28:31]
    ds_read_b128 v[144:147], v6 offset:320
    v_mfma_f32_16x16x32_bf16 v[44:47], v[132:135], a[240:243], v[44:47]
    ds_read_b128 v[148:151], v6 offset:352
    s_waitcnt lgkmcnt(8)
    v_mfma_f32_16x16x32_bf16 v[16:19], v[136:139], a[44:47], v[16:19]
    ds_read_b128 a[104:107], v7 offset:416
    s_waitcnt lgkmcnt(8)
    v_mfma_f32_16x16x32_bf16 v[32:35], v[140:143], a[44:47], v[32:35]
    v_alignbit_b32 v214, v193, v192, 16
    v_alignbit_b32 v215, v194, v193, 16
    s_waitcnt lgkmcnt(7)
    v_mfma_f32_16x16x32_bf16 v[20:23], v[136:139], a[108:111], v[20:23]
    ds_read_b128 a[168:171], v7 offset:672
    v_mfma_f32_16x16x32_bf16 v[36:39], v[140:143], a[108:111], v[36:39]
    v_alignbit_b32 v216, v195, v194, 16
    v_alignbit_b32 v217, v196, v195, 16
    s_waitcnt lgkmcnt(7)
    v_mfma_f32_16x16x32_bf16 v[24:27], v[136:139], a[172:175], v[24:27]
    ds_read_b128 a[232:235], v7 offset:928
    v_mfma_f32_16x16x32_bf16 v[40:43], v[140:143], a[172:175], v[40:43]
    ds_read_b128 a[36:39], v7 offset:144
    s_waitcnt lgkmcnt(7)
    v_mfma_f32_16x16x32_bf16 v[28:31], v[136:139], a[236:239], v[28:31]
    ds_read_b128 v[152:155], v6 offset:384
    v_mfma_f32_16x16x32_bf16 v[44:47], v[140:143], a[236:239], v[44:47]
    ds_read_b128 v[156:159], v6 offset:416
    s_waitcnt lgkmcnt(7)
    v_mfma_f32_16x16x32_bf16 v[16:19], v[144:147], a[40:43], v[16:19]
    ds_read_b128 a[100:103], v7 offset:400
    s_waitcnt lgkmcnt(7)
    v_mfma_f32_16x16x32_bf16 v[32:35], v[148:151], a[40:43], v[32:35]
    ds_write_b128 v5, v[214:217] offset:31168
    s_waitcnt lgkmcnt(7)
    v_mfma_f32_16x16x32_bf16 v[20:23], v[144:147], a[104:107], v[20:23]
    ds_read_b128 a[164:167], v7 offset:656
    v_mfma_f32_16x16x32_bf16 v[36:39], v[148:151], a[104:107], v[36:39]
    v_alignbit_b32 v218, v197, v196, 16
    v_alignbit_b32 v219, v198, v197, 16
    s_waitcnt lgkmcnt(7)
    v_mfma_f32_16x16x32_bf16 v[24:27], v[144:147], a[168:171], v[24:27]
    ds_read_b128 a[228:231], v7 offset:912
    v_mfma_f32_16x16x32_bf16 v[40:43], v[148:151], a[168:171], v[40:43]
    ds_read_b128 a[32:35], v7 offset:128
    s_waitcnt lgkmcnt(8)
    v_mfma_f32_16x16x32_bf16 v[28:31], v[144:147], a[232:235], v[28:31]
    ds_read_b128 v[160:163], v6 offset:448
    v_mfma_f32_16x16x32_bf16 v[44:47], v[148:151], a[232:235], v[44:47]
    ds_read_b128 v[164:167], v6 offset:480
    s_waitcnt lgkmcnt(8)
    v_mfma_f32_16x16x32_bf16 v[16:19], v[152:155], a[36:39], v[16:19]
    ds_read_b128 a[96:99], v7 offset:384
    s_waitcnt lgkmcnt(8)
    v_mfma_f32_16x16x32_bf16 v[32:35], v[156:159], a[36:39], v[32:35]
    ds_write_b128 v5, v[216:219] offset:14528
    s_waitcnt lgkmcnt(8)
    v_mfma_f32_16x16x32_bf16 v[20:23], v[152:155], a[100:103], v[20:23]
    ds_read_b128 a[160:163], v7 offset:640
    v_mfma_f32_16x16x32_bf16 v[36:39], v[156:159], a[100:103], v[36:39]
    v_alignbit_b32 v220, v194, v193, 16
    v_alignbit_b32 v221, v195, v194, 16
    s_waitcnt lgkmcnt(7)
    v_mfma_f32_16x16x32_bf16 v[24:27], v[152:155], a[164:167], v[24:27]
    ds_read_b128 a[224:227], v7 offset:896
    v_mfma_f32_16x16x32_bf16 v[40:43], v[156:159], a[164:167], v[40:43]
    ds_read_b128 a[28:31], v7 offset:112
    s_waitcnt lgkmcnt(8)
    v_mfma_f32_16x16x32_bf16 v[28:31], v[152:155], a[228:231], v[28:31]
    ds_read_b128 v[168:171], v6 offset:512
    v_mfma_f32_16x16x32_bf16 v[44:47], v[156:159], a[228:231], v[44:47]
    ds_read_b128 v[172:175], v6 offset:544
    s_waitcnt lgkmcnt(8)
    v_mfma_f32_16x16x32_bf16 v[16:19], v[160:163], a[32:35], v[16:19]
    ds_read_b128 a[92:95], v7 offset:368
    s_waitcnt lgkmcnt(8)
    v_mfma_f32_16x16x32_bf16 v[32:35], v[164:167], a[32:35], v[32:35]
    v_alignbit_b32 v222, v196, v195, 16
    v_alignbit_b32 v223, v197, v196, 16
    s_waitcnt lgkmcnt(7)
    v_mfma_f32_16x16x32_bf16 v[20:23], v[160:163], a[96:99], v[20:23]
    ds_read_b128 a[156:159], v7 offset:624
    v_mfma_f32_16x16x32_bf16 v[36:39], v[164:167], a[96:99], v[36:39]
    ds_write_b128 v5, v[220:223] offset:22848
    s_waitcnt lgkmcnt(7)
    v_mfma_f32_16x16x32_bf16 v[24:27], v[160:163], a[160:163], v[24:27]
    ds_read_b128 a[220:223], v7 offset:880
    v_mfma_f32_16x16x32_bf16 v[40:43], v[164:167], a[160:163], v[40:43]
    ds_read_b128 a[24:27], v7 offset:96
    s_waitcnt lgkmcnt(8)
    v_mfma_f32_16x16x32_bf16 v[28:31], v[160:163], a[224:227], v[28:31]
    ds_read_b128 v[112:115], v6 offset:576
    v_mfma_f32_16x16x32_bf16 v[44:47], v[164:167], a[224:227], v[44:47]
    ds_read_b128 v[116:119], v6 offset:608
    s_waitcnt lgkmcnt(8)
    v_mfma_f32_16x16x32_bf16 v[16:19], v[168:171], a[28:31], v[16:19]
    ds_read_b128 a[88:91], v7 offset:352
    s_waitcnt lgkmcnt(8)
    v_mfma_f32_16x16x32_bf16 v[32:35], v[172:175], a[28:31], v[32:35]
    v_alignbit_b32 v224, v198, v197, 16
    v_alignbit_b32 v225, v199, v198, 16
    s_waitcnt lgkmcnt(7)
    v_mfma_f32_16x16x32_bf16 v[20:23], v[168:171], a[92:95], v[20:23]
    ds_read_b128 a[152:155], v7 offset:608
    v_mfma_f32_16x16x32_bf16 v[36:39], v[172:175], a[92:95], v[36:39]
    ds_write_b128 v5, v[222:225] offset:6208
    s_waitcnt lgkmcnt(8)
    v_mfma_f32_16x16x32_bf16 v[24:27], v[168:171], a[156:159], v[24:27]
    ds_read_b128 a[216:219], v7 offset:864
    v_mfma_f32_16x16x32_bf16 v[40:43], v[172:175], a[156:159], v[40:43]
    ds_read_b128 a[20:23], v7 offset:80
    s_waitcnt lgkmcnt(8)
    v_mfma_f32_16x16x32_bf16 v[28:31], v[168:171], a[220:223], v[28:31]
    ds_read_b128 v[120:123], v6 offset:640
    v_mfma_f32_16x16x32_bf16 v[44:47], v[172:175], a[220:223], v[44:47]
    ds_read_b128 v[124:127], v6 offset:672
    s_waitcnt lgkmcnt(8)
    v_mfma_f32_16x16x32_bf16 v[16:19], v[112:115], a[24:27], v[16:19]
    ds_read_b128 a[84:87], v7 offset:336
    s_waitcnt lgkmcnt(8)
    v_mfma_f32_16x16x32_bf16 v[32:35], v[116:119], a[24:27], v[32:35]
    buffer_load_dwordx4 v[192:195], v4, s[28:31], s36 offen offset:2032
    s_waitcnt lgkmcnt(7)
    v_mfma_f32_16x16x32_bf16 v[20:23], v[112:115], a[88:91], v[20:23]
    ds_read_b128 a[148:151], v7 offset:592
    v_mfma_f32_16x16x32_bf16 v[36:39], v[116:119], a[88:91], v[36:39]
    buffer_load_dwordx4 v[196:199], v4, s[28:31], s36 offen offset:2048
    s_waitcnt lgkmcnt(7)
    v_mfma_f32_16x16x32_bf16 v[24:27], v[112:115], a[152:155], v[24:27]
    ds_read_b128 a[212:215], v7 offset:848
    v_mfma_f32_16x16x32_bf16 v[40:43], v[116:119], a[152:155], v[40:43]
    ds_read_b128 a[16:19], v7 offset:64
    s_waitcnt lgkmcnt(7)
    v_mfma_f32_16x16x32_bf16 v[28:31], v[112:115], a[216:219], v[28:31]
    ds_read_b128 v[128:131], v6 offset:704
    v_mfma_f32_16x16x32_bf16 v[44:47], v[116:119], a[216:219], v[44:47]
    ds_read_b128 v[132:135], v6 offset:736
    s_waitcnt lgkmcnt(7)
    v_mfma_f32_16x16x32_bf16 v[16:19], v[120:123], a[20:23], v[16:19]
    ds_read_b128 a[80:83], v7 offset:320
    s_waitcnt lgkmcnt(7)
    v_mfma_f32_16x16x32_bf16 v[32:35], v[124:127], a[20:23], v[32:35]
    s_waitcnt vmcnt(18)
    s_waitcnt lgkmcnt(6)
    v_mfma_f32_16x16x32_bf16 v[20:23], v[120:123], a[84:87], v[20:23]
    ds_read_b128 a[144:147], v7 offset:576
    v_mfma_f32_16x16x32_bf16 v[36:39], v[124:127], a[84:87], v[36:39]
    ds_write_b128 v5, v[204:207] offset:3072
    s_waitcnt lgkmcnt(7)
    v_mfma_f32_16x16x32_bf16 v[24:27], v[120:123], a[148:151], v[24:27]
    ds_read_b128 a[208:211], v7 offset:832
    v_mfma_f32_16x16x32_bf16 v[40:43], v[124:127], a[148:151], v[40:43]
    ds_read_b128 a[12:15], v7 offset:48
    s_waitcnt lgkmcnt(8)
    v_mfma_f32_16x16x32_bf16 v[28:31], v[120:123], a[212:215], v[28:31]
    ds_read_b128 v[136:139], v6 offset:768
    v_mfma_f32_16x16x32_bf16 v[44:47], v[124:127], a[212:215], v[44:47]
    ds_read_b128 v[140:143], v6 offset:800
    s_waitcnt lgkmcnt(8)
    v_mfma_f32_16x16x32_bf16 v[16:19], v[128:131], a[16:19], v[16:19]
    ds_read_b128 a[76:79], v7 offset:304
    s_waitcnt lgkmcnt(8)
    v_mfma_f32_16x16x32_bf16 v[32:35], v[132:135], a[16:19], v[32:35]
    ds_write_b128 v5, v[202:205] offset:19712
    s_waitcnt lgkmcnt(8)
    v_mfma_f32_16x16x32_bf16 v[20:23], v[128:131], a[80:83], v[20:23]
    ds_read_b128 a[140:143], v7 offset:560
    v_mfma_f32_16x16x32_bf16 v[36:39], v[132:135], a[80:83], v[36:39]
    v_mov_b32 v208, v201
    v_mov_b32 v209, v202
    s_waitcnt lgkmcnt(8)
    v_mfma_f32_16x16x32_bf16 v[24:27], v[128:131], a[144:147], v[24:27]
    ds_read_b128 a[204:207], v7 offset:816
    v_mfma_f32_16x16x32_bf16 v[40:43], v[132:135], a[144:147], v[40:43]
    ds_read_b128 a[8:11], v7 offset:32
    s_waitcnt lgkmcnt(8)
    v_mfma_f32_16x16x32_bf16 v[28:31], v[128:131], a[208:211], v[28:31]
    ds_read_b128 v[144:147], v6 offset:832
    v_mfma_f32_16x16x32_bf16 v[44:47], v[132:135], a[208:211], v[44:47]
    ds_read_b128 v[148:151], v6 offset:864
    s_waitcnt lgkmcnt(8)
    v_mfma_f32_16x16x32_bf16 v[16:19], v[136:139], a[12:15], v[16:19]
    ds_read_b128 a[72:75], v7 offset:288
    s_waitcnt lgkmcnt(8)
    v_mfma_f32_16x16x32_bf16 v[32:35], v[140:143], a[12:15], v[32:35]
    v_mov_b32 v210, v203
    v_mov_b32 v211, v204
    s_waitcnt lgkmcnt(7)
    v_mfma_f32_16x16x32_bf16 v[20:23], v[136:139], a[76:79], v[20:23]
    ds_read_b128 a[136:139], v7 offset:544
    v_mfma_f32_16x16x32_bf16 v[36:39], v[140:143], a[76:79], v[36:39]
    ds_write_b128 v5, v[208:211] offset:28032
    s_waitcnt lgkmcnt(7)
    v_mfma_f32_16x16x32_bf16 v[24:27], v[136:139], a[140:143], v[24:27]
    ds_read_b128 a[200:203], v7 offset:800
    v_mfma_f32_16x16x32_bf16 v[40:43], v[140:143], a[140:143], v[40:43]
    ds_read_b128 a[4:7], v7 offset:16
    s_waitcnt lgkmcnt(8)
    v_mfma_f32_16x16x32_bf16 v[28:31], v[136:139], a[204:207], v[28:31]
    ds_read_b128 v[152:155], v6 offset:896
    v_mfma_f32_16x16x32_bf16 v[44:47], v[140:143], a[204:207], v[44:47]
    ds_read_b128 v[156:159], v6 offset:928
    s_waitcnt lgkmcnt(8)
    v_mfma_f32_16x16x32_bf16 v[16:19], v[144:147], a[8:11], v[16:19]
    ds_read_b128 a[68:71], v7 offset:272
    s_waitcnt lgkmcnt(8)
    v_mfma_f32_16x16x32_bf16 v[32:35], v[148:151], a[8:11], v[32:35]
    v_mov_b32 v212, v205
    v_mov_b32 v213, v206
    s_waitcnt lgkmcnt(7)
    v_mfma_f32_16x16x32_bf16 v[20:23], v[144:147], a[72:75], v[20:23]
    ds_read_b128 a[132:135], v7 offset:528
    v_mfma_f32_16x16x32_bf16 v[36:39], v[148:151], a[72:75], v[36:39]
    ds_write_b128 v5, v[210:213] offset:11392
    s_waitcnt lgkmcnt(8)
    v_mfma_f32_16x16x32_bf16 v[24:27], v[144:147], a[136:139], v[24:27]
    ds_read_b128 a[196:199], v7 offset:784
    v_mfma_f32_16x16x32_bf16 v[40:43], v[148:151], a[136:139], v[40:43]
    ds_read_b128 a[0:3], v7 offset:0
    s_waitcnt lgkmcnt(8)
    v_mfma_f32_16x16x32_bf16 v[28:31], v[144:147], a[200:203], v[28:31]
    ds_read_b128 v[160:163], v6 offset:960
    v_mfma_f32_16x16x32_bf16 v[44:47], v[148:151], a[200:203], v[44:47]
    ds_read_b128 v[164:167], v6 offset:992
    s_waitcnt lgkmcnt(8)
    v_mfma_f32_16x16x32_bf16 v[16:19], v[152:155], a[4:7], v[16:19]
    ds_read_b128 a[64:67], v7 offset:256
    s_waitcnt lgkmcnt(8)
    v_mfma_f32_16x16x32_bf16 v[32:35], v[156:159], a[4:7], v[32:35]
    v_alignbit_b32 v214, v201, v200, 16
    v_alignbit_b32 v215, v202, v201, 16
    s_waitcnt lgkmcnt(7)
    v_mfma_f32_16x16x32_bf16 v[20:23], v[152:155], a[68:71], v[20:23]
    ds_read_b128 a[128:131], v7 offset:512
    v_mfma_f32_16x16x32_bf16 v[36:39], v[156:159], a[68:71], v[36:39]
    v_alignbit_b32 v216, v203, v202, 16
    v_alignbit_b32 v217, v204, v203, 16
    s_waitcnt lgkmcnt(7)
    v_mfma_f32_16x16x32_bf16 v[24:27], v[152:155], a[132:135], v[24:27]
    ds_read_b128 a[192:195], v7 offset:768
    v_mfma_f32_16x16x32_bf16 v[40:43], v[156:159], a[132:135], v[40:43]
    ds_write_b128 v5, v[214:217] offset:32192
    s_waitcnt lgkmcnt(7)
    v_mfma_f32_16x16x32_bf16 v[28:31], v[152:155], a[196:199], v[28:31]
    ds_read_b128 v[168:171], v6 offset:1024
    v_mfma_f32_16x16x32_bf16 v[44:47], v[156:159], a[196:199], v[44:47]
    ds_read_b128 v[172:175], v6 offset:1056
    s_waitcnt lgkmcnt(7)
    v_mfma_f32_16x16x32_bf16 v[16:19], v[160:163], a[0:3], v[16:19]
    v_alignbit_b32 v218, v205, v204, 16
    v_alignbit_b32 v219, v206, v205, 16
    s_waitcnt lgkmcnt(6)
    v_mfma_f32_16x16x32_bf16 v[32:35], v[164:167], a[0:3], v[32:35]
    ds_write_b128 v5, v[216:219] offset:15552
    s_waitcnt lgkmcnt(6)
    v_mfma_f32_16x16x32_bf16 v[20:23], v[160:163], a[64:67], v[20:23]
    v_alignbit_b32 v220, v202, v201, 16
    v_alignbit_b32 v221, v203, v202, 16
    v_mfma_f32_16x16x32_bf16 v[36:39], v[164:167], a[64:67], v[36:39]
    v_alignbit_b32 v222, v204, v203, 16
    v_alignbit_b32 v223, v205, v204, 16
    s_waitcnt lgkmcnt(5)
    v_mfma_f32_16x16x32_bf16 v[24:27], v[160:163], a[128:131], v[24:27]
    ds_read_b128 v[112:115], v6 offset:1088
    v_mfma_f32_16x16x32_bf16 v[40:43], v[164:167], a[128:131], v[40:43]
    ds_read_b128 v[116:119], v6 offset:1120
    s_waitcnt lgkmcnt(6)
    v_mfma_f32_16x16x32_bf16 v[28:31], v[160:163], a[192:195], v[28:31]
    ds_write_b128 v5, v[220:223] offset:23872
    v_mfma_f32_16x16x32_bf16 v[44:47], v[164:167], a[192:195], v[44:47]
    v_alignbit_b32 v224, v206, v205, 16
    v_alignbit_b32 v225, v207, v206, 16
    s_waitcnt lgkmcnt(5)
    v_mfma_f32_16x16x32_bf16 v[20:23], v[168:171], a[60:63], v[20:23]
    ds_write_b128 v5, v[222:225] offset:7232
    s_waitcnt lgkmcnt(5)
    v_mfma_f32_16x16x32_bf16 v[36:39], v[172:175], a[60:63], v[36:39]
    buffer_load_dwordx4 v[200:203], v4, s[28:31], s36 offen offset:3056
    v_mfma_f32_16x16x32_bf16 v[24:27], v[168:171], a[124:127], v[24:27]
    ds_read_b128 v[120:123], v6 offset:1152
    v_mfma_f32_16x16x32_bf16 v[40:43], v[172:175], a[124:127], v[40:43]
    ds_read_b128 v[124:127], v6 offset:1184
    v_mfma_f32_16x16x32_bf16 v[28:31], v[168:171], a[188:191], v[28:31]
    buffer_load_dwordx4 v[204:207], v4, s[28:31], s36 offen offset:3072
    v_mfma_f32_16x16x32_bf16 v[44:47], v[172:175], a[188:191], v[44:47]
    s_waitcnt vmcnt(18)
    s_mov_b64 exec, 1
    v_mov_b32 v176, 0
    v_mov_b32 v177, 0
    v_mov_b32 v178, 0
    v_mov_b32 v179, 0
    s_mov_b64 exec, -1
    s_waitcnt lgkmcnt(5)
    v_mfma_f32_16x16x32_bf16 v[20:23], v[112:115], a[56:59], v[20:23]
    ds_write_b128 v5, v[180:183] offset:0
    s_waitcnt lgkmcnt(5)
    v_mfma_f32_16x16x32_bf16 v[36:39], v[116:119], a[56:59], v[36:39]
    ds_write_b128 v5, v[178:181] offset:16640
    v_mfma_f32_16x16x32_bf16 v[24:27], v[112:115], a[120:123], v[24:27]
    ds_read_b128 v[128:131], v6 offset:1216
    v_mfma_f32_16x16x32_bf16 v[40:43], v[116:119], a[120:123], v[40:43]
    ds_read_b128 v[132:135], v6 offset:1248
    v_mfma_f32_16x16x32_bf16 v[28:31], v[112:115], a[184:187], v[28:31]
    v_mov_b32 v208, v177
    v_mov_b32 v209, v178
    v_mfma_f32_16x16x32_bf16 v[44:47], v[116:119], a[184:187], v[44:47]
    v_mov_b32 v210, v179
    v_mov_b32 v211, v180
    s_waitcnt lgkmcnt(5)
    v_mfma_f32_16x16x32_bf16 v[20:23], v[120:123], a[52:55], v[20:23]
    ds_write_b128 v5, v[208:211] offset:24960
    s_waitcnt lgkmcnt(5)
    v_mfma_f32_16x16x32_bf16 v[36:39], v[124:127], a[52:55], v[36:39]
    v_mov_b32 v212, v181
    v_mov_b32 v213, v182
    v_mfma_f32_16x16x32_bf16 v[24:27], v[120:123], a[116:119], v[24:27]
    ds_read_b128 v[136:139], v6 offset:1280
    v_mfma_f32_16x16x32_bf16 v[40:43], v[124:127], a[116:119], v[40:43]
    ds_read_b128 v[140:143], v6 offset:1312
    v_mfma_f32_16x16x32_bf16 v[28:31], v[120:123], a[180:183], v[28:31]
    ds_write_b128 v5, v[210:213] offset:8320
    v_mfma_f32_16x16x32_bf16 v[44:47], v[124:127], a[180:183], v[44:47]
    v_alignbit_b32 v214, v177, v176, 16
    v_alignbit_b32 v215, v178, v177, 16
    s_waitcnt lgkmcnt(5)
    v_mfma_f32_16x16x32_bf16 v[20:23], v[128:131], a[48:51], v[20:23]
    v_alignbit_b32 v216, v179, v178, 16
    v_alignbit_b32 v217, v180, v179, 16
    s_waitcnt lgkmcnt(4)
    v_mfma_f32_16x16x32_bf16 v[36:39], v[132:135], a[48:51], v[36:39]
    ds_write_b128 v5, v[214:217] offset:29120
    v_mfma_f32_16x16x32_bf16 v[24:27], v[128:131], a[112:115], v[24:27]
    ds_read_b128 v[144:147], v6 offset:1344
    v_mfma_f32_16x16x32_bf16 v[40:43], v[132:135], a[112:115], v[40:43]
    ds_read_b128 v[148:151], v6 offset:1376
    v_mfma_f32_16x16x32_bf16 v[28:31], v[128:131], a[176:179], v[28:31]
    v_alignbit_b32 v218, v181, v180, 16
    v_alignbit_b32 v219, v182, v181, 16
    v_mfma_f32_16x16x32_bf16 v[44:47], v[132:135], a[176:179], v[44:47]
    ds_write_b128 v5, v[216:219] offset:12480
    s_waitcnt lgkmcnt(6)
    v_mfma_f32_16x16x32_bf16 v[20:23], v[136:139], a[44:47], v[20:23]
    v_alignbit_b32 v220, v178, v177, 16
    v_alignbit_b32 v221, v179, v178, 16
    s_waitcnt lgkmcnt(5)
    v_mfma_f32_16x16x32_bf16 v[36:39], v[140:143], a[44:47], v[36:39]
    v_alignbit_b32 v222, v180, v179, 16
    v_alignbit_b32 v223, v181, v180, 16
    v_mfma_f32_16x16x32_bf16 v[24:27], v[136:139], a[108:111], v[24:27]
    ds_read_b128 v[152:155], v6 offset:1408
    v_mfma_f32_16x16x32_bf16 v[40:43], v[140:143], a[108:111], v[40:43]
    ds_read_b128 v[156:159], v6 offset:1440
    v_mfma_f32_16x16x32_bf16 v[28:31], v[136:139], a[172:175], v[28:31]
    ds_write_b128 v5, v[220:223] offset:20800
    v_mfma_f32_16x16x32_bf16 v[44:47], v[140:143], a[172:175], v[44:47]
    v_alignbit_b32 v224, v182, v181, 16
    v_alignbit_b32 v225, v183, v182, 16
    s_waitcnt lgkmcnt(5)
    v_mfma_f32_16x16x32_bf16 v[20:23], v[144:147], a[40:43], v[20:23]
    ds_write_b128 v5, v[222:225] offset:4160
    s_waitcnt lgkmcnt(5)
    v_mfma_f32_16x16x32_bf16 v[36:39], v[148:151], a[40:43], v[36:39]
    buffer_load_dwordx4 v[176:179], v230, s[28:31], s37 offen offset:0
    v_mfma_f32_16x16x32_bf16 v[24:27], v[144:147], a[104:107], v[24:27]
    ds_read_b128 v[160:163], v6 offset:1472
    v_mfma_f32_16x16x32_bf16 v[40:43], v[148:151], a[104:107], v[40:43]
    ds_read_b128 v[164:167], v6 offset:1504
    v_mfma_f32_16x16x32_bf16 v[28:31], v[144:147], a[168:171], v[28:31]
    buffer_load_dwordx4 v[180:183], v4, s[28:31], s37 offen offset:0
    v_mfma_f32_16x16x32_bf16 v[44:47], v[148:151], a[168:171], v[44:47]
    s_add_u32 m0, s35, 0
    s_waitcnt lgkmcnt(5)
    v_mfma_f32_16x16x32_bf16 v[20:23], v[152:155], a[36:39], v[20:23]
    buffer_load_dwordx4 v4, s[8:11], s39 offen offset:0 lds
    s_waitcnt lgkmcnt(4)
    v_mfma_f32_16x16x32_bf16 v[36:39], v[156:159], a[36:39], v[36:39]
    s_add_u32 m0, s35, 256
    v_mfma_f32_16x16x32_bf16 v[24:27], v[152:155], a[100:103], v[24:27]
    ds_read_b128 v[168:171], v6 offset:1536
    v_mfma_f32_16x16x32_bf16 v[40:43], v[156:159], a[100:103], v[40:43]
    ds_read_b128 v[172:175], v6 offset:1568
    v_mfma_f32_16x16x32_bf16 v[28:31], v[152:155], a[164:167], v[28:31]
    buffer_load_dwordx4 v4, s[8:11], s39 offen offset:1024 lds
    v_mfma_f32_16x16x32_bf16 v[44:47], v[156:159], a[164:167], v[44:47]
    s_add_u32 m0, s35, 512
    s_waitcnt lgkmcnt(3)
    v_mfma_f32_16x16x32_bf16 v[20:23], v[160:163], a[32:35], v[20:23]
    buffer_load_dwordx4 v4, s[8:11], s39 offen offset:2048 lds
    s_waitcnt lgkmcnt(2)
    v_mfma_f32_16x16x32_bf16 v[36:39], v[164:167], a[32:35], v[36:39]
    s_add_u32 m0, s35, 768
    v_mfma_f32_16x16x32_bf16 v[24:27], v[160:163], a[96:99], v[24:27]
    ds_read_b128 v[112:115], v6 offset:1600
    v_mfma_f32_16x16x32_bf16 v[40:43], v[164:167], a[96:99], v[40:43]
    ds_read_b128 v[116:119], v6 offset:1632
    v_mfma_f32_16x16x32_bf16 v[28:31], v[160:163], a[160:163], v[28:31]
    buffer_load_dwordx4 v4, s[8:11], s39 offen offset:3072 lds
    v_mfma_f32_16x16x32_bf16 v[44:47], v[164:167], a[160:163], v[44:47]
    s_waitcnt lgkmcnt(3)
    v_mfma_f32_16x16x32_bf16 v[20:23], v[168:171], a[28:31], v[20:23]
    s_waitcnt lgkmcnt(2)
    v_mfma_f32_16x16x32_bf16 v[36:39], v[172:175], a[28:31], v[36:39]
    v_mfma_f32_16x16x32_bf16 v[24:27], v[168:171], a[92:95], v[24:27]
    ds_read_b128 v[120:123], v6 offset:1664
    v_mfma_f32_16x16x32_bf16 v[40:43], v[172:175], a[92:95], v[40:43]
    ds_read_b128 v[124:127], v6 offset:1696
    v_mfma_f32_16x16x32_bf16 v[28:31], v[168:171], a[156:159], v[28:31]
    v_mfma_f32_16x16x32_bf16 v[44:47], v[172:175], a[156:159], v[44:47]
    s_waitcnt lgkmcnt(3)
    v_mfma_f32_16x16x32_bf16 v[20:23], v[112:115], a[24:27], v[20:23]
    s_waitcnt lgkmcnt(2)
    v_mfma_f32_16x16x32_bf16 v[36:39], v[116:119], a[24:27], v[36:39]
    v_mfma_f32_16x16x32_bf16 v[24:27], v[112:115], a[88:91], v[24:27]
    ds_read_b128 v[128:131], v6 offset:1728
    v_mfma_f32_16x16x32_bf16 v[40:43], v[116:119], a[88:91], v[40:43]
    ds_read_b128 v[132:135], v6 offset:1760
    v_mfma_f32_16x16x32_bf16 v[28:31], v[112:115], a[152:155], v[28:31]
    v_mfma_f32_16x16x32_bf16 v[44:47], v[116:119], a[152:155], v[44:47]
    s_waitcnt lgkmcnt(3)
    v_mfma_f32_16x16x32_bf16 v[20:23], v[120:123], a[20:23], v[20:23]
    s_waitcnt lgkmcnt(2)
    v_mfma_f32_16x16x32_bf16 v[36:39], v[124:127], a[20:23], v[36:39]
    v_mfma_f32_16x16x32_bf16 v[24:27], v[120:123], a[84:87], v[24:27]
    ds_read_b128 v[136:139], v6 offset:1792
    v_mfma_f32_16x16x32_bf16 v[40:43], v[124:127], a[84:87], v[40:43]
    ds_read_b128 v[140:143], v6 offset:1824
    v_mfma_f32_16x16x32_bf16 v[28:31], v[120:123], a[148:151], v[28:31]
    v_mfma_f32_16x16x32_bf16 v[44:47], v[124:127], a[148:151], v[44:47]
    s_waitcnt lgkmcnt(3)
    v_mfma_f32_16x16x32_bf16 v[20:23], v[128:131], a[16:19], v[20:23]
    s_waitcnt lgkmcnt(2)
    v_mfma_f32_16x16x32_bf16 v[36:39], v[132:135], a[16:19], v[36:39]
    v_mfma_f32_16x16x32_bf16 v[24:27], v[128:131], a[80:83], v[24:27]
    ds_read_b128 v[144:147], v6 offset:1856
    v_mfma_f32_16x16x32_bf16 v[40:43], v[132:135], a[80:83], v[40:43]
    ds_read_b128 v[148:151], v6 offset:1888
    v_mfma_f32_16x16x32_bf16 v[28:31], v[128:131], a[144:147], v[28:31]
    v_mfma_f32_16x16x32_bf16 v[44:47], v[132:135], a[144:147], v[44:47]
    s_waitcnt lgkmcnt(3)
    v_mfma_f32_16x16x32_bf16 v[20:23], v[136:139], a[12:15], v[20:23]
    s_waitcnt lgkmcnt(2)
    v_mfma_f32_16x16x32_bf16 v[36:39], v[140:143], a[12:15], v[36:39]
    v_mfma_f32_16x16x32_bf16 v[24:27], v[136:139], a[76:79], v[24:27]
    ds_read_b128 v[152:155], v6 offset:1920
    v_mfma_f32_16x16x32_bf16 v[40:43], v[140:143], a[76:79], v[40:43]
    ds_read_b128 v[156:159], v6 offset:1952
    v_mfma_f32_16x16x32_bf16 v[28:31], v[136:139], a[140:143], v[28:31]
    v_mfma_f32_16x16x32_bf16 v[44:47], v[140:143], a[140:143], v[44:47]
    s_waitcnt lgkmcnt(3)
    v_mfma_f32_16x16x32_bf16 v[20:23], v[144:147], a[8:11], v[20:23]
    s_waitcnt lgkmcnt(2)
    v_mfma_f32_16x16x32_bf16 v[36:39], v[148:151], a[8:11], v[36:39]
    v_mfma_f32_16x16x32_bf16 v[24:27], v[144:147], a[72:75], v[24:27]
    ds_read_b128 v[160:163], v6 offset:1984
    v_mfma_f32_16x16x32_bf16 v[40:43], v[148:151], a[72:75], v[40:43]
    ds_read_b128 v[164:167], v6 offset:2016
    v_mfma_f32_16x16x32_bf16 v[28:31], v[144:147], a[136:139], v[28:31]
    v_mfma_f32_16x16x32_bf16 v[44:47], v[148:151], a[136:139], v[44:47]
    s_waitcnt lgkmcnt(3)
    v_mfma_f32_16x16x32_bf16 v[20:23], v[152:155], a[4:7], v[20:23]
    s_waitcnt lgkmcnt(2)
    v_mfma_f32_16x16x32_bf16 v[36:39], v[156:159], a[4:7], v[36:39]
    v_mfma_f32_16x16x32_bf16 v[24:27], v[152:155], a[68:71], v[24:27]
    ds_read_b128 v[168:171], v6 offset:2048
    v_mfma_f32_16x16x32_bf16 v[40:43], v[156:159], a[68:71], v[40:43]
    ds_read_b128 v[172:175], v6 offset:2080
    v_mfma_f32_16x16x32_bf16 v[28:31], v[152:155], a[132:135], v[28:31]
    s_waitcnt vmcnt(18)
    v_mfma_f32_16x16x32_bf16 v[44:47], v[156:159], a[132:135], v[44:47]
    ds_write_b128 v5, v[188:191] offset:1024
    s_waitcnt lgkmcnt(4)
    v_mfma_f32_16x16x32_bf16 v[20:23], v[160:163], a[0:3], v[20:23]
    ds_read_b128 v[112:115], v6 offset:2112
    s_waitcnt lgkmcnt(4)
    v_mfma_f32_16x16x32_bf16 v[36:39], v[164:167], a[0:3], v[36:39]
    ds_read_b128 v[116:119], v6 offset:2144
    v_mfma_f32_16x16x32_bf16 v[24:27], v[160:163], a[64:67], v[24:27]
    ds_write_b128 v5, v[186:189] offset:17664
    v_mfma_f32_16x16x32_bf16 v[40:43], v[164:167], a[64:67], v[40:43]
    v_mov_b32 v208, v185
    v_mov_b32 v209, v186
    v_mfma_f32_16x16x32_bf16 v[28:31], v[160:163], a[128:131], v[28:31]
    ds_read_b128 v[120:123], v6 offset:2176
    v_mfma_f32_16x16x32_bf16 v[44:47], v[164:167], a[128:131], v[44:47]
    ds_read_b128 v[124:127], v6 offset:2208
    s_waitcnt lgkmcnt(7)
    v_mfma_f32_16x16x32_bf16 v[24:27], v[168:171], a[60:63], v[24:27]
    v_mov_b32 v210, v187
    v_mov_b32 v211, v188
    s_waitcnt lgkmcnt(6)
    v_mfma_f32_16x16x32_bf16 v[40:43], v[172:175], a[60:63], v[40:43]
    ds_write_b128 v5, v[208:211] offset:25984
    v_mfma_f32_16x16x32_bf16 v[28:31], v[168:171], a[124:127], v[28:31]
    ds_read_b128 v[128:131], v6 offset:2240
    v_mfma_f32_16x16x32_bf16 v[44:47], v[172:175], a[124:127], v[44:47]
    ds_read_b128 v[132:135], v6 offset:2272
    s_waitcnt lgkmcnt(7)
    v_mfma_f32_16x16x32_bf16 v[24:27], v[112:115], a[56:59], v[24:27]
    v_mov_b32 v212, v189
    v_mov_b32 v213, v190
    s_waitcnt lgkmcnt(6)
    v_mfma_f32_16x16x32_bf16 v[40:43], v[116:119], a[56:59], v[40:43]
    ds_write_b128 v5, v[210:213] offset:9344
    v_mfma_f32_16x16x32_bf16 v[28:31], v[112:115], a[120:123], v[28:31]
    ds_read_b128 v[136:139], v6 offset:2304
    v_mfma_f32_16x16x32_bf16 v[44:47], v[116:119], a[120:123], v[44:47]
    ds_read_b128 v[140:143], v6 offset:2336
    s_waitcnt lgkmcnt(7)
    v_mfma_f32_16x16x32_bf16 v[24:27], v[120:123], a[52:55], v[24:27]
    v_alignbit_b32 v214, v185, v184, 16
    v_alignbit_b32 v215, v186, v185, 16
    s_waitcnt lgkmcnt(6)
    v_mfma_f32_16x16x32_bf16 v[40:43], v[124:127], a[52:55], v[40:43]
    v_alignbit_b32 v216, v187, v186, 16
    v_alignbit_b32 v217, v188, v187, 16
    v_mfma_f32_16x16x32_bf16 v[28:31], v[120:123], a[116:119], v[28:31]
    ds_read_b128 v[144:147], v6 offset:2368
    v_mfma_f32_16x16x32_bf16 v[44:47], v[124:127], a[116:119], v[44:47]
    ds_read_b128 v[148:151], v6 offset:2400
    s_waitcnt lgkmcnt(6)
    v_mfma_f32_16x16x32_bf16 v[24:27], v[128:131], a[48:51], v[24:27]
    ds_write_b128 v5, v[214:217] offset:30144
    s_waitcnt lgkmcnt(6)
    v_mfma_f32_16x16x32_bf16 v[40:43], v[132:135], a[48:51], v[40:43]
    v_alignbit_b32 v218, v189, v188, 16
    v_alignbit_b32 v219, v190, v189, 16
    v_mfma_f32_16x16x32_bf16 v[28:31], v[128:131], a[112:115], v[28:31]
    ds_read_b128 v[152:155], v6 offset:2432
    v_mfma_f32_16x16x32_bf16 v[44:47], v[132:135], a[112:115], v[44:47]
    ds_read_b128 v[156:159], v6 offset:2464
    s_waitcnt lgkmcnt(6)
    v_mfma_f32_16x16x32_bf16 v[24:27], v[136:139], a[44:47], v[24:27]
    ds_write_b128 v5, v[216:219] offset:13504
    s_waitcnt lgkmcnt(6)
    v_mfma_f32_16x16x32_bf16 v[40:43], v[140:143], a[44:47], v[40:43]
    v_alignbit_b32 v220, v186, v185, 16
    v_alignbit_b32 v221, v187, v186, 16
    v_mfma_f32_16x16x32_bf16 v[28:31], v[136:139], a[108:111], v[28:31]
    ds_read_b128 v[160:163], v6 offset:2496
    v_mfma_f32_16x16x32_bf16 v[44:47], v[140:143], a[108:111], v[44:47]
    ds_read_b128 v[164:167], v6 offset:2528
    s_waitcnt lgkmcnt(7)
    v_mfma_f32_16x16x32_bf16 v[24:27], v[144:147], a[40:43], v[24:27]
    v_alignbit_b32 v222, v188, v187, 16
    v_alignbit_b32 v223, v189, v188, 16
    s_waitcnt lgkmcnt(6)
    v_mfma_f32_16x16x32_bf16 v[40:43], v[148:151], a[40:43], v[40:43]
    ds_write_b128 v5, v[220:223] offset:21824
    v_mfma_f32_16x16x32_bf16 v[28:31], v[144:147], a[104:107], v[28:31]
    ds_read_b128 v[168:171], v6 offset:2560
    v_mfma_f32_16x16x32_bf16 v[44:47], v[148:151], a[104:107], v[44:47]
    ds_read_b128 v[172:175], v6 offset:2592
    s_waitcnt lgkmcnt(7)
    v_mfma_f32_16x16x32_bf16 v[24:27], v[152:155], a[36:39], v[24:27]
    v_alignbit_b32 v224, v190, v189, 16
    v_alignbit_b32 v225, v191, v190, 16
    s_waitcnt lgkmcnt(6)
    v_mfma_f32_16x16x32_bf16 v[40:43], v[156:159], a[36:39], v[40:43]
    ds_write_b128 v5, v[222:225] offset:5184
    v_mfma_f32_16x16x32_bf16 v[28:31], v[152:155], a[100:103], v[28:31]
    ds_read_b128 v[112:115], v6 offset:2624
    v_mfma_f32_16x16x32_bf16 v[44:47], v[156:159], a[100:103], v[44:47]
    ds_read_b128 v[116:119], v6 offset:2656
    s_waitcnt lgkmcnt(7)
    v_mfma_f32_16x16x32_bf16 v[24:27], v[160:163], a[32:35], v[24:27]
    buffer_load_dwordx4 v[184:187], v4, s[28:31], s37 offen offset:1008
    s_waitcnt lgkmcnt(6)
    v_mfma_f32_16x16x32_bf16 v[40:43], v[164:167], a[32:35], v[40:43]
    buffer_load_dwordx4 v[188:191], v4, s[28:31], s37 offen offset:1024
    v_mfma_f32_16x16x32_bf16 v[28:31], v[160:163], a[96:99], v[28:31]
    ds_read_b128 v[120:123], v6 offset:2688
    v_mfma_f32_16x16x32_bf16 v[44:47], v[164:167], a[96:99], v[44:47]
    ds_read_b128 v[124:127], v6 offset:2720
    s_waitcnt lgkmcnt(6)
    v_mfma_f32_16x16x32_bf16 v[24:27], v[168:171], a[28:31], v[24:27]
    s_mov_b32 s36, s37
    s_add_u32 s39, s37, 125829120
    s_add_u32 s37, s37, 4096
    s_min_u32 s37, s37, s33

    s_pack_hh_b32_b16 s40, s64, s64
    v_and_b32 v236, s40, v8
    s_waitcnt lgkmcnt(5)
    v_mfma_f32_16x16x32_bf16 v[40:43], v[172:175], a[28:31], v[40:43]
    v_and_b32 v237, s40, v9
    v_and_b32 v238, s40, v10
    v_mfma_f32_16x16x32_bf16 v[28:31], v[168:171], a[92:95], v[28:31]
    ds_read_b128 v[128:131], v6 offset:2752
    v_mfma_f32_16x16x32_bf16 v[44:47], v[172:175], a[92:95], v[44:47]
    ds_read_b128 v[132:135], v6 offset:2784
    s_waitcnt lgkmcnt(5)
    v_mfma_f32_16x16x32_bf16 v[24:27], v[112:115], a[24:27], v[24:27]
    v_and_b32 v239, s40, v11
    v_and_b32 v240, s40, v12
    s_waitcnt lgkmcnt(4)
    v_mfma_f32_16x16x32_bf16 v[40:43], v[116:119], a[24:27], v[40:43]
    v_and_b32 v241, s40, v13
    v_and_b32 v242, s40, v14
    v_mfma_f32_16x16x32_bf16 v[28:31], v[112:115], a[88:91], v[28:31]
    ds_read_b128 v[136:139], v6 offset:2816
    v_mfma_f32_16x16x32_bf16 v[44:47], v[116:119], a[88:91], v[44:47]
    ds_read_b128 v[140:143], v6 offset:2848
    s_waitcnt lgkmcnt(5)
    v_mfma_f32_16x16x32_bf16 v[24:27], v[120:123], a[20:23], v[24:27]
    v_and_b32 v243, s40, v15
    s_waitcnt lgkmcnt(4)
    v_mfma_f32_16x16x32_bf16 v[40:43], v[124:127], a[20:23], v[40:43]
    v_mfma_f32_16x16x32_bf16 v[28:31], v[120:123], a[84:87], v[28:31]
    ds_read_b128 v[144:147], v6 offset:2880
    v_mfma_f32_16x16x32_bf16 v[44:47], v[124:127], a[84:87], v[44:47]
    ds_read_b128 v[148:151], v6 offset:2912
    s_waitcnt lgkmcnt(5)
    v_mfma_f32_16x16x32_bf16 v[24:27], v[128:131], a[16:19], v[24:27]
    s_waitcnt lgkmcnt(4)
    v_mfma_f32_16x16x32_bf16 v[40:43], v[132:135], a[16:19], v[40:43]
    v_mfma_f32_16x16x32_bf16 v[28:31], v[128:131], a[80:83], v[28:31]
    ds_read_b128 v[152:155], v6 offset:2944
    v_mfma_f32_16x16x32_bf16 v[44:47], v[132:135], a[80:83], v[44:47]
    ds_read_b128 v[156:159], v6 offset:2976
    s_waitcnt lgkmcnt(5)
    v_mfma_f32_16x16x32_bf16 v[24:27], v[136:139], a[12:15], v[24:27]
    s_waitcnt lgkmcnt(4)
    v_mfma_f32_16x16x32_bf16 v[40:43], v[140:143], a[12:15], v[40:43]
    v_mfma_f32_16x16x32_bf16 v[28:31], v[136:139], a[76:79], v[28:31]
    ds_read_b128 v[160:163], v6 offset:3008
    v_mfma_f32_16x16x32_bf16 v[44:47], v[140:143], a[76:79], v[44:47]
    ds_read_b128 v[164:167], v6 offset:3040
    s_waitcnt lgkmcnt(5)
    v_mfma_f32_16x16x32_bf16 v[24:27], v[144:147], a[8:11], v[24:27]
    s_waitcnt lgkmcnt(4)
    v_mfma_f32_16x16x32_bf16 v[40:43], v[148:151], a[8:11], v[40:43]
    v_mfma_f32_16x16x32_bf16 v[28:31], v[144:147], a[72:75], v[28:31]
    ds_read_b128 v[168:171], v6 offset:3072
    v_mfma_f32_16x16x32_bf16 v[44:47], v[148:151], a[72:75], v[44:47]
    ds_read_b128 v[172:175], v6 offset:3104
    s_waitcnt lgkmcnt(5)
    v_mfma_f32_16x16x32_bf16 v[24:27], v[152:155], a[4:7], v[24:27]
    ds_read_b128 v[112:115], v6 offset:3136
    s_waitcnt lgkmcnt(5)
    v_mfma_f32_16x16x32_bf16 v[40:43], v[156:159], a[4:7], v[40:43]
    ds_read_b128 v[116:119], v6 offset:3168
    v_mfma_f32_16x16x32_bf16 v[28:31], v[152:155], a[68:71], v[28:31]
    ds_read_b128 v[120:123], v6 offset:3200
    v_mfma_f32_16x16x32_bf16 v[44:47], v[156:159], a[68:71], v[44:47]
    ds_read_b128 v[124:127], v6 offset:3232
    s_waitcnt lgkmcnt(7)
    v_mfma_f32_16x16x32_bf16 v[24:27], v[160:163], a[0:3], v[24:27]
    ds_read_b128 v[128:131], v6 offset:3264
    s_waitcnt lgkmcnt(7)
    v_mfma_f32_16x16x32_bf16 v[40:43], v[164:167], a[0:3], v[40:43]
    ds_read_b128 v[132:135], v6 offset:3296
    v_mfma_f32_16x16x32_bf16 v[28:31], v[160:163], a[64:67], v[28:31]
    ds_read_b128 v[136:139], v6 offset:3328
    v_mfma_f32_16x16x32_bf16 v[44:47], v[164:167], a[64:67], v[44:47]
    ds_read_b128 v[140:143], v6 offset:3360
    s_waitcnt lgkmcnt(9)
    v_mfma_f32_16x16x32_bf16 v[28:31], v[168:171], a[60:63], v[28:31]
    ds_read_b128 v[144:147], v6 offset:3392
    s_waitcnt lgkmcnt(9)
    v_mfma_f32_16x16x32_bf16 v[44:47], v[172:175], a[60:63], v[44:47]
    ds_read_b128 v[148:151], v6 offset:3424
    s_waitcnt lgkmcnt(9)
    v_mfma_f32_16x16x32_bf16 v[28:31], v[112:115], a[56:59], v[28:31]
    ds_read_b128 v[152:155], v6 offset:3456
    s_waitcnt lgkmcnt(9)
    v_mfma_f32_16x16x32_bf16 v[44:47], v[116:119], a[56:59], v[44:47]
    ds_read_b128 v[156:159], v6 offset:3488
    s_waitcnt lgkmcnt(9)
    v_mfma_f32_16x16x32_bf16 v[28:31], v[120:123], a[52:55], v[28:31]
    ds_read_b128 v[160:163], v6 offset:3520
    s_waitcnt lgkmcnt(9)
    v_mfma_f32_16x16x32_bf16 v[44:47], v[124:127], a[52:55], v[44:47]
    ds_read_b128 v[164:167], v6 offset:3552
    s_waitcnt lgkmcnt(9)
    v_mfma_f32_16x16x32_bf16 v[28:31], v[128:131], a[48:51], v[28:31]
    ds_read_b128 v[168:171], v6 offset:3584
    s_waitcnt lgkmcnt(9)
    v_mfma_f32_16x16x32_bf16 v[44:47], v[132:135], a[48:51], v[44:47]
    ds_read_b128 v[172:175], v6 offset:3616
    s_waitcnt lgkmcnt(9)
    v_mfma_f32_16x16x32_bf16 v[28:31], v[136:139], a[44:47], v[28:31]
    ds_read_b128 v[112:115], v6 offset:3648
    s_waitcnt lgkmcnt(9)
    v_mfma_f32_16x16x32_bf16 v[44:47], v[140:143], a[44:47], v[44:47]
    ds_read_b128 v[116:119], v6 offset:3680
    s_waitcnt lgkmcnt(9)
    v_mfma_f32_16x16x32_bf16 v[28:31], v[144:147], a[40:43], v[28:31]
    ds_read_b128 v[120:123], v6 offset:3712
    s_waitcnt lgkmcnt(9)
    v_mfma_f32_16x16x32_bf16 v[44:47], v[148:151], a[40:43], v[44:47]
    ds_read_b128 v[124:127], v6 offset:3744
    s_waitcnt lgkmcnt(9)
    v_mfma_f32_16x16x32_bf16 v[28:31], v[152:155], a[36:39], v[28:31]
    ds_read_b128 v[128:131], v6 offset:3776
    s_waitcnt lgkmcnt(9)
    v_mfma_f32_16x16x32_bf16 v[44:47], v[156:159], a[36:39], v[44:47]
    ds_read_b128 v[132:135], v6 offset:3808
    s_waitcnt lgkmcnt(9)
    v_mfma_f32_16x16x32_bf16 v[28:31], v[160:163], a[32:35], v[28:31]
    ds_read_b128 v[136:139], v6 offset:3840
    s_waitcnt lgkmcnt(9)
    v_mfma_f32_16x16x32_bf16 v[44:47], v[164:167], a[32:35], v[44:47]
    ds_read_b128 v[140:143], v6 offset:3872
    s_waitcnt lgkmcnt(9)
    v_mfma_f32_16x16x32_bf16 v[28:31], v[168:171], a[28:31], v[28:31]
    ds_read_b128 v[144:147], v6 offset:3904
    s_waitcnt lgkmcnt(9)
    v_mfma_f32_16x16x32_bf16 v[44:47], v[172:175], a[28:31], v[44:47]
    ds_read_b128 v[148:151], v6 offset:3936
    s_waitcnt lgkmcnt(9)
    v_mfma_f32_16x16x32_bf16 v[28:31], v[112:115], a[24:27], v[28:31]
    ds_read_b128 v[152:155], v6 offset:3968
    s_waitcnt lgkmcnt(9)
    v_mfma_f32_16x16x32_bf16 v[44:47], v[116:119], a[24:27], v[44:47]
    ds_read_b128 v[156:159], v6 offset:4000
    s_waitcnt lgkmcnt(9)
    v_mfma_f32_16x16x32_bf16 v[28:31], v[120:123], a[20:23], v[28:31]
    ds_read_b128 v[160:163], v6 offset:4032
    s_waitcnt lgkmcnt(9)
    v_mfma_f32_16x16x32_bf16 v[44:47], v[124:127], a[20:23], v[44:47]
    ds_read_b128 v[164:167], v6 offset:4064
    s_waitcnt lgkmcnt(9)
    v_mfma_f32_16x16x32_bf16 v[28:31], v[128:131], a[16:19], v[28:31]
    s_waitcnt vmcnt(2)
    ds_read_b128 a[60:63], v7 offset:240
    s_waitcnt lgkmcnt(9)
    v_mfma_f32_16x16x32_bf16 v[44:47], v[132:135], a[16:19], v[44:47]
    s_waitcnt lgkmcnt(8)
    v_mfma_f32_16x16x32_bf16 v[28:31], v[136:139], a[12:15], v[28:31]
    ds_read_b128 a[124:127], v7 offset:496
    s_waitcnt lgkmcnt(8)
    v_mfma_f32_16x16x32_bf16 v[44:47], v[140:143], a[12:15], v[44:47]
    s_waitcnt lgkmcnt(7)
    v_mfma_f32_16x16x32_bf16 v[28:31], v[144:147], a[8:11], v[28:31]
    ds_read_b128 a[188:191], v7 offset:752
    s_waitcnt lgkmcnt(7)
    v_mfma_f32_16x16x32_bf16 v[44:47], v[148:151], a[8:11], v[44:47]
    s_waitcnt lgkmcnt(6)
    v_mfma_f32_16x16x32_bf16 v[28:31], v[152:155], a[4:7], v[28:31]
    ds_read_b128 a[252:255], v7 offset:1008
    s_waitcnt lgkmcnt(6)
    v_mfma_f32_16x16x32_bf16 v[44:47], v[156:159], a[4:7], v[44:47]
    s_waitcnt lgkmcnt(5)
    v_mfma_f32_16x16x32_bf16 v[28:31], v[160:163], a[0:3], v[28:31]
    ds_read_b128 v[168:171], v6 offset:0
    s_waitcnt lgkmcnt(5)
    v_mfma_f32_16x16x32_bf16 v[44:47], v[164:167], a[0:3], v[44:47]
    ds_read_b128 v[172:175], v6 offset:32
    s_waitcnt lgkmcnt(5)
    v_mfma_f32_16x16x32_bf16 v[48:51], v[236:239], a[60:63], 0
    v_mfma_f32_16x16x32_bf16 v[64:67], v[240:243], a[60:63], 0
    s_waitcnt lgkmcnt(4)
    v_mfma_f32_16x16x32_bf16 v[52:55], v[236:239], a[124:127], 0
    v_mfma_f32_16x16x32_bf16 v[68:71], v[240:243], a[124:127], 0
    s_waitcnt lgkmcnt(3)
    v_mfma_f32_16x16x32_bf16 v[56:59], v[236:239], a[188:191], 0
    v_mfma_f32_16x16x32_bf16 v[72:75], v[240:243], a[188:191], 0
    ds_read_b128 a[56:59], v7 offset:224
    s_waitcnt lgkmcnt(3)
    v_mfma_f32_16x16x32_bf16 v[60:63], v[236:239], a[252:255], 0
    ds_read_b128 v[112:115], v6 offset:64
    v_mfma_f32_16x16x32_bf16 v[76:79], v[240:243], a[252:255], 0
    ds_read_b128 v[116:119], v6 offset:96
    s_waitcnt lgkmcnt(4)
    v_mfma_f32_16x16x32_bf16 v[48:51], v[168:171], a[60:63], v[48:51]
    ds_read_b128 a[120:123], v7 offset:480
    s_waitcnt lgkmcnt(4)
    v_mfma_f32_16x16x32_bf16 v[64:67], v[172:175], a[60:63], v[64:67]
    s_waitcnt vmcnt(10)
    v_mfma_f32_16x16x32_bf16 v[52:55], v[168:171], a[124:127], v[52:55]
    ds_read_b128 a[184:187], v7 offset:736
    v_mfma_f32_16x16x32_bf16 v[68:71], v[172:175], a[124:127], v[68:71]
    ds_write_b128 v5, v[196:199] offset:2048
    v_mfma_f32_16x16x32_bf16 v[56:59], v[168:171], a[188:191], v[56:59]
    ds_read_b128 a[248:251], v7 offset:992
    v_mfma_f32_16x16x32_bf16 v[72:75], v[172:175], a[188:191], v[72:75]
    ds_read_b128 a[52:55], v7 offset:208
    v_mfma_f32_16x16x32_bf16 v[60:63], v[168:171], a[252:255], v[60:63]
    ds_read_b128 v[120:123], v6 offset:128
    v_mfma_f32_16x16x32_bf16 v[76:79], v[172:175], a[252:255], v[76:79]
    ds_read_b128 v[124:127], v6 offset:160
    s_waitcnt lgkmcnt(8)
    v_mfma_f32_16x16x32_bf16 v[48:51], v[112:115], a[56:59], v[48:51]
    ds_read_b128 a[116:119], v7 offset:464
    s_waitcnt lgkmcnt(8)
    v_mfma_f32_16x16x32_bf16 v[64:67], v[116:119], a[56:59], v[64:67]
    ds_write_b128 v5, v[194:197] offset:18688
    s_waitcnt lgkmcnt(8)
    v_mfma_f32_16x16x32_bf16 v[52:55], v[112:115], a[120:123], v[52:55]
    ds_read_b128 a[180:183], v7 offset:720
    v_mfma_f32_16x16x32_bf16 v[68:71], v[116:119], a[120:123], v[68:71]
    v_mov_b32 v208, v193
    v_mov_b32 v209, v194
    s_waitcnt lgkmcnt(8)
    v_mfma_f32_16x16x32_bf16 v[56:59], v[112:115], a[184:187], v[56:59]
    ds_read_b128 a[244:247], v7 offset:976
    v_mfma_f32_16x16x32_bf16 v[72:75], v[116:119], a[184:187], v[72:75]
    ds_read_b128 a[48:51], v7 offset:192
    s_waitcnt lgkmcnt(8)
    v_mfma_f32_16x16x32_bf16 v[60:63], v[112:115], a[248:251], v[60:63]
    ds_read_b128 v[128:131], v6 offset:192
    v_mfma_f32_16x16x32_bf16 v[76:79], v[116:119], a[248:251], v[76:79]
    ds_read_b128 v[132:135], v6 offset:224
    s_waitcnt lgkmcnt(8)
    v_mfma_f32_16x16x32_bf16 v[48:51], v[120:123], a[52:55], v[48:51]
    ds_read_b128 a[112:115], v7 offset:448
    s_waitcnt lgkmcnt(8)
    v_mfma_f32_16x16x32_bf16 v[64:67], v[124:127], a[52:55], v[64:67]
    v_mov_b32 v210, v195
    v_mov_b32 v211, v196
    s_waitcnt lgkmcnt(7)
    v_mfma_f32_16x16x32_bf16 v[52:55], v[120:123], a[116:119], v[52:55]
    ds_read_b128 a[176:179], v7 offset:704
    v_mfma_f32_16x16x32_bf16 v[68:71], v[124:127], a[116:119], v[68:71]
    ds_write_b128 v5, v[208:211] offset:27008
    s_waitcnt lgkmcnt(7)
    v_mfma_f32_16x16x32_bf16 v[56:59], v[120:123], a[180:183], v[56:59]
    ds_read_b128 a[240:243], v7 offset:960
    v_mfma_f32_16x16x32_bf16 v[72:75], v[124:127], a[180:183], v[72:75]
    ds_read_b128 a[44:47], v7 offset:176
    s_waitcnt lgkmcnt(8)
    v_mfma_f32_16x16x32_bf16 v[60:63], v[120:123], a[244:247], v[60:63]
    ds_read_b128 v[136:139], v6 offset:256
    v_mfma_f32_16x16x32_bf16 v[76:79], v[124:127], a[244:247], v[76:79]
    ds_read_b128 v[140:143], v6 offset:288
    s_waitcnt lgkmcnt(8)
    v_mfma_f32_16x16x32_bf16 v[48:51], v[128:131], a[48:51], v[48:51]
    ds_read_b128 a[108:111], v7 offset:432
    s_waitcnt lgkmcnt(8)
    v_mfma_f32_16x16x32_bf16 v[64:67], v[132:135], a[48:51], v[64:67]
    v_mov_b32 v212, v197
    v_mov_b32 v213, v198
    s_waitcnt lgkmcnt(7)
    v_mfma_f32_16x16x32_bf16 v[52:55], v[128:131], a[112:115], v[52:55]
    ds_read_b128 a[172:175], v7 offset:688
    v_mfma_f32_16x16x32_bf16 v[68:71], v[132:135], a[112:115], v[68:71]
    ds_write_b128 v5, v[210:213] offset:10368
    s_waitcnt lgkmcnt(8)
    v_mfma_f32_16x16x32_bf16 v[56:59], v[128:131], a[176:179], v[56:59]
    ds_read_b128 a[236:239], v7 offset:944
    v_mfma_f32_16x16x32_bf16 v[72:75], v[132:135], a[176:179], v[72:75]
    ds_read_b128 a[40:43], v7 offset:160
    s_waitcnt lgkmcnt(8)
    v_mfma_f32_16x16x32_bf16 v[60:63], v[128:131], a[240:243], v[60:63]
    ds_read_b128 v[144:147], v6 offset:320
    v_mfma_f32_16x16x32_bf16 v[76:79], v[132:135], a[240:243], v[76:79]
    ds_read_b128 v[148:151], v6 offset:352
    s_waitcnt lgkmcnt(8)
    v_mfma_f32_16x16x32_bf16 v[48:51], v[136:139], a[44:47], v[48:51]
    ds_read_b128 a[104:107], v7 offset:416
    s_waitcnt lgkmcnt(8)
    v_mfma_f32_16x16x32_bf16 v[64:67], v[140:143], a[44:47], v[64:67]
    v_alignbit_b32 v214, v193, v192, 16
    v_alignbit_b32 v215, v194, v193, 16
    s_waitcnt lgkmcnt(7)
    v_mfma_f32_16x16x32_bf16 v[52:55], v[136:139], a[108:111], v[52:55]
    ds_read_b128 a[168:171], v7 offset:672
    v_mfma_f32_16x16x32_bf16 v[68:71], v[140:143], a[108:111], v[68:71]
    v_alignbit_b32 v216, v195, v194, 16
    v_alignbit_b32 v217, v196, v195, 16
    s_waitcnt lgkmcnt(7)
    v_mfma_f32_16x16x32_bf16 v[56:59], v[136:139], a[172:175], v[56:59]
    ds_read_b128 a[232:235], v7 offset:928
    v_mfma_f32_16x16x32_bf16 v[72:75], v[140:143], a[172:175], v[72:75]
    ds_read_b128 a[36:39], v7 offset:144
    s_waitcnt lgkmcnt(7)
    v_mfma_f32_16x16x32_bf16 v[60:63], v[136:139], a[236:239], v[60:63]
    ds_read_b128 v[152:155], v6 offset:384
    v_mfma_f32_16x16x32_bf16 v[76:79], v[140:143], a[236:239], v[76:79]
    ds_read_b128 v[156:159], v6 offset:416
    s_waitcnt lgkmcnt(7)
    v_mfma_f32_16x16x32_bf16 v[48:51], v[144:147], a[40:43], v[48:51]
    ds_read_b128 a[100:103], v7 offset:400
    s_waitcnt lgkmcnt(7)
    v_mfma_f32_16x16x32_bf16 v[64:67], v[148:151], a[40:43], v[64:67]
    ds_write_b128 v5, v[214:217] offset:31168
    s_waitcnt lgkmcnt(7)
    v_mfma_f32_16x16x32_bf16 v[52:55], v[144:147], a[104:107], v[52:55]
    ds_read_b128 a[164:167], v7 offset:656
    v_mfma_f32_16x16x32_bf16 v[68:71], v[148:151], a[104:107], v[68:71]
    v_alignbit_b32 v218, v197, v196, 16
    v_alignbit_b32 v219, v198, v197, 16
    s_waitcnt lgkmcnt(7)
    v_mfma_f32_16x16x32_bf16 v[56:59], v[144:147], a[168:171], v[56:59]
    ds_read_b128 a[228:231], v7 offset:912
    v_mfma_f32_16x16x32_bf16 v[72:75], v[148:151], a[168:171], v[72:75]
    ds_read_b128 a[32:35], v7 offset:128
    s_waitcnt lgkmcnt(8)
    v_mfma_f32_16x16x32_bf16 v[60:63], v[144:147], a[232:235], v[60:63]
    ds_read_b128 v[160:163], v6 offset:448
    v_mfma_f32_16x16x32_bf16 v[76:79], v[148:151], a[232:235], v[76:79]
    ds_read_b128 v[164:167], v6 offset:480
    s_waitcnt lgkmcnt(8)
    v_mfma_f32_16x16x32_bf16 v[48:51], v[152:155], a[36:39], v[48:51]
    ds_read_b128 a[96:99], v7 offset:384
    s_waitcnt lgkmcnt(8)
    v_mfma_f32_16x16x32_bf16 v[64:67], v[156:159], a[36:39], v[64:67]
    ds_write_b128 v5, v[216:219] offset:14528
    s_waitcnt lgkmcnt(8)
    v_mfma_f32_16x16x32_bf16 v[52:55], v[152:155], a[100:103], v[52:55]
    ds_read_b128 a[160:163], v7 offset:640
    v_mfma_f32_16x16x32_bf16 v[68:71], v[156:159], a[100:103], v[68:71]
    v_alignbit_b32 v220, v194, v193, 16
    v_alignbit_b32 v221, v195, v194, 16
    s_waitcnt lgkmcnt(7)
    v_mfma_f32_16x16x32_bf16 v[56:59], v[152:155], a[164:167], v[56:59]
    ds_read_b128 a[224:227], v7 offset:896
    v_mfma_f32_16x16x32_bf16 v[72:75], v[156:159], a[164:167], v[72:75]
    ds_read_b128 a[28:31], v7 offset:112
    s_waitcnt lgkmcnt(8)
    v_mfma_f32_16x16x32_bf16 v[60:63], v[152:155], a[228:231], v[60:63]
    ds_read_b128 v[168:171], v6 offset:512
    v_mfma_f32_16x16x32_bf16 v[76:79], v[156:159], a[228:231], v[76:79]
    ds_read_b128 v[172:175], v6 offset:544
    s_waitcnt lgkmcnt(8)
    v_mfma_f32_16x16x32_bf16 v[48:51], v[160:163], a[32:35], v[48:51]
    ds_read_b128 a[92:95], v7 offset:368
    s_waitcnt lgkmcnt(8)
    v_mfma_f32_16x16x32_bf16 v[64:67], v[164:167], a[32:35], v[64:67]
    v_alignbit_b32 v222, v196, v195, 16
    v_alignbit_b32 v223, v197, v196, 16
    s_waitcnt lgkmcnt(7)
    v_mfma_f32_16x16x32_bf16 v[52:55], v[160:163], a[96:99], v[52:55]
    ds_read_b128 a[156:159], v7 offset:624
    v_mfma_f32_16x16x32_bf16 v[68:71], v[164:167], a[96:99], v[68:71]
    ds_write_b128 v5, v[220:223] offset:22848
    s_waitcnt lgkmcnt(7)
    v_mfma_f32_16x16x32_bf16 v[56:59], v[160:163], a[160:163], v[56:59]
    ds_read_b128 a[220:223], v7 offset:880
    v_mfma_f32_16x16x32_bf16 v[72:75], v[164:167], a[160:163], v[72:75]
    ds_read_b128 a[24:27], v7 offset:96
    s_waitcnt lgkmcnt(8)
    v_mfma_f32_16x16x32_bf16 v[60:63], v[160:163], a[224:227], v[60:63]
    ds_read_b128 v[112:115], v6 offset:576
    v_mfma_f32_16x16x32_bf16 v[76:79], v[164:167], a[224:227], v[76:79]
    ds_read_b128 v[116:119], v6 offset:608
    s_waitcnt lgkmcnt(8)
    v_mfma_f32_16x16x32_bf16 v[48:51], v[168:171], a[28:31], v[48:51]
    ds_read_b128 a[88:91], v7 offset:352
    s_waitcnt lgkmcnt(8)
    v_mfma_f32_16x16x32_bf16 v[64:67], v[172:175], a[28:31], v[64:67]
    v_alignbit_b32 v224, v198, v197, 16
    v_alignbit_b32 v225, v199, v198, 16
    s_waitcnt lgkmcnt(7)
    v_mfma_f32_16x16x32_bf16 v[52:55], v[168:171], a[92:95], v[52:55]
    ds_read_b128 a[152:155], v7 offset:608
    v_mfma_f32_16x16x32_bf16 v[68:71], v[172:175], a[92:95], v[68:71]
    ds_write_b128 v5, v[222:225] offset:6208
    s_waitcnt lgkmcnt(8)
    v_mfma_f32_16x16x32_bf16 v[56:59], v[168:171], a[156:159], v[56:59]
    ds_read_b128 a[216:219], v7 offset:864
    v_mfma_f32_16x16x32_bf16 v[72:75], v[172:175], a[156:159], v[72:75]
    ds_read_b128 a[20:23], v7 offset:80
    s_waitcnt lgkmcnt(8)
    v_mfma_f32_16x16x32_bf16 v[60:63], v[168:171], a[220:223], v[60:63]
    ds_read_b128 v[120:123], v6 offset:640
    v_mfma_f32_16x16x32_bf16 v[76:79], v[172:175], a[220:223], v[76:79]
    ds_read_b128 v[124:127], v6 offset:672
    s_waitcnt lgkmcnt(8)
    v_mfma_f32_16x16x32_bf16 v[48:51], v[112:115], a[24:27], v[48:51]
    ds_read_b128 a[84:87], v7 offset:336
    s_waitcnt lgkmcnt(8)
    v_mfma_f32_16x16x32_bf16 v[64:67], v[116:119], a[24:27], v[64:67]
    buffer_load_dwordx4 v[192:195], v4, s[28:31], s36 offen offset:2032
    s_waitcnt lgkmcnt(7)
    v_mfma_f32_16x16x32_bf16 v[52:55], v[112:115], a[88:91], v[52:55]
    ds_read_b128 a[148:151], v7 offset:592
    v_mfma_f32_16x16x32_bf16 v[68:71], v[116:119], a[88:91], v[68:71]
    buffer_load_dwordx4 v[196:199], v4, s[28:31], s36 offen offset:2048
    s_waitcnt lgkmcnt(7)
    v_mfma_f32_16x16x32_bf16 v[56:59], v[112:115], a[152:155], v[56:59]
    ds_read_b128 a[212:215], v7 offset:848
    v_mfma_f32_16x16x32_bf16 v[72:75], v[116:119], a[152:155], v[72:75]
    ds_read_b128 a[16:19], v7 offset:64
    s_waitcnt lgkmcnt(7)
    v_mfma_f32_16x16x32_bf16 v[60:63], v[112:115], a[216:219], v[60:63]
    ds_read_b128 v[128:131], v6 offset:704
    v_mfma_f32_16x16x32_bf16 v[76:79], v[116:119], a[216:219], v[76:79]
    ds_read_b128 v[132:135], v6 offset:736
    s_waitcnt lgkmcnt(7)
    v_mfma_f32_16x16x32_bf16 v[48:51], v[120:123], a[20:23], v[48:51]
    ds_read_b128 a[80:83], v7 offset:320
    s_waitcnt lgkmcnt(7)
    v_mfma_f32_16x16x32_bf16 v[64:67], v[124:127], a[20:23], v[64:67]
    s_waitcnt vmcnt(10)
    s_waitcnt lgkmcnt(6)
    v_mfma_f32_16x16x32_bf16 v[52:55], v[120:123], a[84:87], v[52:55]
    ds_read_b128 a[144:147], v7 offset:576
    v_mfma_f32_16x16x32_bf16 v[68:71], v[124:127], a[84:87], v[68:71]
    ds_write_b128 v5, v[204:207] offset:3072
    s_waitcnt lgkmcnt(7)
    v_mfma_f32_16x16x32_bf16 v[56:59], v[120:123], a[148:151], v[56:59]
    ds_read_b128 a[208:211], v7 offset:832
    v_mfma_f32_16x16x32_bf16 v[72:75], v[124:127], a[148:151], v[72:75]
    ds_read_b128 a[12:15], v7 offset:48
    s_waitcnt lgkmcnt(8)
    v_mfma_f32_16x16x32_bf16 v[60:63], v[120:123], a[212:215], v[60:63]
    ds_read_b128 v[136:139], v6 offset:768
    v_mfma_f32_16x16x32_bf16 v[76:79], v[124:127], a[212:215], v[76:79]
    ds_read_b128 v[140:143], v6 offset:800
    s_waitcnt lgkmcnt(8)
    v_mfma_f32_16x16x32_bf16 v[48:51], v[128:131], a[16:19], v[48:51]
    ds_read_b128 a[76:79], v7 offset:304
    s_waitcnt lgkmcnt(8)
    v_mfma_f32_16x16x32_bf16 v[64:67], v[132:135], a[16:19], v[64:67]
    ds_write_b128 v5, v[202:205] offset:19712
    s_waitcnt lgkmcnt(8)
    v_mfma_f32_16x16x32_bf16 v[52:55], v[128:131], a[80:83], v[52:55]
    ds_read_b128 a[140:143], v7 offset:560
    v_mfma_f32_16x16x32_bf16 v[68:71], v[132:135], a[80:83], v[68:71]
    v_mov_b32 v208, v201
    v_mov_b32 v209, v202
    s_waitcnt lgkmcnt(8)
    v_mfma_f32_16x16x32_bf16 v[56:59], v[128:131], a[144:147], v[56:59]
    ds_read_b128 a[204:207], v7 offset:816
    v_mfma_f32_16x16x32_bf16 v[72:75], v[132:135], a[144:147], v[72:75]
    ds_read_b128 a[8:11], v7 offset:32
    s_waitcnt lgkmcnt(8)
    v_mfma_f32_16x16x32_bf16 v[60:63], v[128:131], a[208:211], v[60:63]
    ds_read_b128 v[144:147], v6 offset:832
    v_mfma_f32_16x16x32_bf16 v[76:79], v[132:135], a[208:211], v[76:79]
    ds_read_b128 v[148:151], v6 offset:864
    s_waitcnt lgkmcnt(8)
    v_mfma_f32_16x16x32_bf16 v[48:51], v[136:139], a[12:15], v[48:51]
    ds_read_b128 a[72:75], v7 offset:288
    s_waitcnt lgkmcnt(8)
    v_mfma_f32_16x16x32_bf16 v[64:67], v[140:143], a[12:15], v[64:67]
    v_mov_b32 v210, v203
    v_mov_b32 v211, v204
    s_waitcnt lgkmcnt(7)
    v_mfma_f32_16x16x32_bf16 v[52:55], v[136:139], a[76:79], v[52:55]
    ds_read_b128 a[136:139], v7 offset:544
    v_mfma_f32_16x16x32_bf16 v[68:71], v[140:143], a[76:79], v[68:71]
    ds_write_b128 v5, v[208:211] offset:28032
    s_waitcnt lgkmcnt(7)
    v_mfma_f32_16x16x32_bf16 v[56:59], v[136:139], a[140:143], v[56:59]
    ds_read_b128 a[200:203], v7 offset:800
    v_mfma_f32_16x16x32_bf16 v[72:75], v[140:143], a[140:143], v[72:75]
    ds_read_b128 a[4:7], v7 offset:16
    s_waitcnt lgkmcnt(8)
    v_mfma_f32_16x16x32_bf16 v[60:63], v[136:139], a[204:207], v[60:63]
    ds_read_b128 v[152:155], v6 offset:896
    v_mfma_f32_16x16x32_bf16 v[76:79], v[140:143], a[204:207], v[76:79]
    ds_read_b128 v[156:159], v6 offset:928
    s_waitcnt lgkmcnt(8)
    v_mfma_f32_16x16x32_bf16 v[48:51], v[144:147], a[8:11], v[48:51]
    ds_read_b128 a[68:71], v7 offset:272
    s_waitcnt lgkmcnt(8)
    v_mfma_f32_16x16x32_bf16 v[64:67], v[148:151], a[8:11], v[64:67]
    v_mov_b32 v212, v205
    v_mov_b32 v213, v206
    s_waitcnt lgkmcnt(7)
    v_mfma_f32_16x16x32_bf16 v[52:55], v[144:147], a[72:75], v[52:55]
    ds_read_b128 a[132:135], v7 offset:528
    v_mfma_f32_16x16x32_bf16 v[68:71], v[148:151], a[72:75], v[68:71]
    ds_write_b128 v5, v[210:213] offset:11392
    s_waitcnt lgkmcnt(8)
    v_mfma_f32_16x16x32_bf16 v[56:59], v[144:147], a[136:139], v[56:59]
    ds_read_b128 a[196:199], v7 offset:784
    v_mfma_f32_16x16x32_bf16 v[72:75], v[148:151], a[136:139], v[72:75]
    ds_read_b128 a[0:3], v7 offset:0
    s_waitcnt lgkmcnt(8)
    v_mfma_f32_16x16x32_bf16 v[60:63], v[144:147], a[200:203], v[60:63]
    ds_read_b128 v[160:163], v6 offset:960
    v_mfma_f32_16x16x32_bf16 v[76:79], v[148:151], a[200:203], v[76:79]
    ds_read_b128 v[164:167], v6 offset:992
    s_waitcnt lgkmcnt(8)
    v_mfma_f32_16x16x32_bf16 v[48:51], v[152:155], a[4:7], v[48:51]
    ds_read_b128 a[64:67], v7 offset:256
    s_waitcnt lgkmcnt(8)
    v_mfma_f32_16x16x32_bf16 v[64:67], v[156:159], a[4:7], v[64:67]
    v_alignbit_b32 v214, v201, v200, 16
    v_alignbit_b32 v215, v202, v201, 16
    s_waitcnt lgkmcnt(7)
    v_mfma_f32_16x16x32_bf16 v[52:55], v[152:155], a[68:71], v[52:55]
    ds_read_b128 a[128:131], v7 offset:512
    v_mfma_f32_16x16x32_bf16 v[68:71], v[156:159], a[68:71], v[68:71]
    v_alignbit_b32 v216, v203, v202, 16
    v_alignbit_b32 v217, v204, v203, 16
    s_waitcnt lgkmcnt(7)
    v_mfma_f32_16x16x32_bf16 v[56:59], v[152:155], a[132:135], v[56:59]
    ds_read_b128 a[192:195], v7 offset:768
    v_mfma_f32_16x16x32_bf16 v[72:75], v[156:159], a[132:135], v[72:75]
    ds_write_b128 v5, v[214:217] offset:32192
    s_waitcnt lgkmcnt(7)
    v_mfma_f32_16x16x32_bf16 v[60:63], v[152:155], a[196:199], v[60:63]
    ds_read_b128 v[168:171], v6 offset:1024
    v_mfma_f32_16x16x32_bf16 v[76:79], v[156:159], a[196:199], v[76:79]
    ds_read_b128 v[172:175], v6 offset:1056
    s_waitcnt lgkmcnt(7)
    v_mfma_f32_16x16x32_bf16 v[48:51], v[160:163], a[0:3], v[48:51]
    v_alignbit_b32 v218, v205, v204, 16
    v_alignbit_b32 v219, v206, v205, 16
    s_waitcnt lgkmcnt(6)
    v_mfma_f32_16x16x32_bf16 v[64:67], v[164:167], a[0:3], v[64:67]
    ds_write_b128 v5, v[216:219] offset:15552
    s_waitcnt lgkmcnt(6)
    v_mfma_f32_16x16x32_bf16 v[52:55], v[160:163], a[64:67], v[52:55]
    v_alignbit_b32 v220, v202, v201, 16
    v_alignbit_b32 v221, v203, v202, 16
    v_mfma_f32_16x16x32_bf16 v[68:71], v[164:167], a[64:67], v[68:71]
    v_alignbit_b32 v222, v204, v203, 16
    v_alignbit_b32 v223, v205, v204, 16
    s_waitcnt lgkmcnt(5)
    v_mfma_f32_16x16x32_bf16 v[56:59], v[160:163], a[128:131], v[56:59]
    ds_read_b128 v[112:115], v6 offset:1088
    v_mfma_f32_16x16x32_bf16 v[72:75], v[164:167], a[128:131], v[72:75]
    ds_read_b128 v[116:119], v6 offset:1120
    s_waitcnt lgkmcnt(6)
    v_mfma_f32_16x16x32_bf16 v[60:63], v[160:163], a[192:195], v[60:63]
    ds_write_b128 v5, v[220:223] offset:23872
    v_mfma_f32_16x16x32_bf16 v[76:79], v[164:167], a[192:195], v[76:79]
    v_alignbit_b32 v224, v206, v205, 16
    v_alignbit_b32 v225, v207, v206, 16
    s_waitcnt lgkmcnt(5)
    v_mfma_f32_16x16x32_bf16 v[52:55], v[168:171], a[60:63], v[52:55]
    ds_write_b128 v5, v[222:225] offset:7232
    s_waitcnt lgkmcnt(5)
    v_mfma_f32_16x16x32_bf16 v[68:71], v[172:175], a[60:63], v[68:71]
    buffer_load_dwordx4 v[200:203], v4, s[28:31], s36 offen offset:3056
    v_mfma_f32_16x16x32_bf16 v[56:59], v[168:171], a[124:127], v[56:59]
    ds_read_b128 v[120:123], v6 offset:1152
    v_mfma_f32_16x16x32_bf16 v[72:75], v[172:175], a[124:127], v[72:75]
    ds_read_b128 v[124:127], v6 offset:1184
    v_mfma_f32_16x16x32_bf16 v[60:63], v[168:171], a[188:191], v[60:63]
    buffer_load_dwordx4 v[204:207], v4, s[28:31], s36 offen offset:3072
    v_mfma_f32_16x16x32_bf16 v[76:79], v[172:175], a[188:191], v[76:79]
    s_waitcnt vmcnt(10)
    s_mov_b64 exec, 1
    v_mov_b32 v176, 0
    v_mov_b32 v177, 0
    v_mov_b32 v178, 0
    v_mov_b32 v179, 0
    s_mov_b64 exec, -1
    s_waitcnt lgkmcnt(5)
    v_mfma_f32_16x16x32_bf16 v[52:55], v[112:115], a[56:59], v[52:55]
    ds_write_b128 v5, v[180:183] offset:0
    s_waitcnt lgkmcnt(5)
    v_mfma_f32_16x16x32_bf16 v[68:71], v[116:119], a[56:59], v[68:71]
    ds_write_b128 v5, v[178:181] offset:16640
    v_mfma_f32_16x16x32_bf16 v[56:59], v[112:115], a[120:123], v[56:59]
    ds_read_b128 v[128:131], v6 offset:1216
    v_mfma_f32_16x16x32_bf16 v[72:75], v[116:119], a[120:123], v[72:75]
    ds_read_b128 v[132:135], v6 offset:1248
    v_mfma_f32_16x16x32_bf16 v[60:63], v[112:115], a[184:187], v[60:63]
    v_mov_b32 v208, v177
    v_mov_b32 v209, v178
    v_mfma_f32_16x16x32_bf16 v[76:79], v[116:119], a[184:187], v[76:79]
    v_mov_b32 v210, v179
    v_mov_b32 v211, v180
    s_waitcnt lgkmcnt(5)
    v_mfma_f32_16x16x32_bf16 v[52:55], v[120:123], a[52:55], v[52:55]
    ds_write_b128 v5, v[208:211] offset:24960
    s_waitcnt lgkmcnt(5)
    v_mfma_f32_16x16x32_bf16 v[68:71], v[124:127], a[52:55], v[68:71]
    v_mov_b32 v212, v181
    v_mov_b32 v213, v182
    v_mfma_f32_16x16x32_bf16 v[56:59], v[120:123], a[116:119], v[56:59]
    ds_read_b128 v[136:139], v6 offset:1280
    v_mfma_f32_16x16x32_bf16 v[72:75], v[124:127], a[116:119], v[72:75]
    ds_read_b128 v[140:143], v6 offset:1312
    v_mfma_f32_16x16x32_bf16 v[60:63], v[120:123], a[180:183], v[60:63]
    ds_write_b128 v5, v[210:213] offset:8320
    v_mfma_f32_16x16x32_bf16 v[76:79], v[124:127], a[180:183], v[76:79]
    v_alignbit_b32 v214, v177, v176, 16
    v_alignbit_b32 v215, v178, v177, 16
    s_waitcnt lgkmcnt(5)
    v_mfma_f32_16x16x32_bf16 v[52:55], v[128:131], a[48:51], v[52:55]
    v_alignbit_b32 v216, v179, v178, 16
    v_alignbit_b32 v217, v180, v179, 16
    s_waitcnt lgkmcnt(4)
    v_mfma_f32_16x16x32_bf16 v[68:71], v[132:135], a[48:51], v[68:71]
    ds_write_b128 v5, v[214:217] offset:29120
    v_mfma_f32_16x16x32_bf16 v[56:59], v[128:131], a[112:115], v[56:59]
    ds_read_b128 v[144:147], v6 offset:1344
    v_mfma_f32_16x16x32_bf16 v[72:75], v[132:135], a[112:115], v[72:75]
    ds_read_b128 v[148:151], v6 offset:1376
    v_mfma_f32_16x16x32_bf16 v[60:63], v[128:131], a[176:179], v[60:63]
    v_alignbit_b32 v218, v181, v180, 16
    v_alignbit_b32 v219, v182, v181, 16
    v_mfma_f32_16x16x32_bf16 v[76:79], v[132:135], a[176:179], v[76:79]
    ds_write_b128 v5, v[216:219] offset:12480
    s_waitcnt lgkmcnt(6)
    v_mfma_f32_16x16x32_bf16 v[52:55], v[136:139], a[44:47], v[52:55]
    v_alignbit_b32 v220, v178, v177, 16
    v_alignbit_b32 v221, v179, v178, 16
    s_waitcnt lgkmcnt(5)
    v_mfma_f32_16x16x32_bf16 v[68:71], v[140:143], a[44:47], v[68:71]
    v_alignbit_b32 v222, v180, v179, 16
    v_alignbit_b32 v223, v181, v180, 16
    v_mfma_f32_16x16x32_bf16 v[56:59], v[136:139], a[108:111], v[56:59]
    ds_read_b128 v[152:155], v6 offset:1408
    v_mfma_f32_16x16x32_bf16 v[72:75], v[140:143], a[108:111], v[72:75]
    ds_read_b128 v[156:159], v6 offset:1440
    v_mfma_f32_16x16x32_bf16 v[60:63], v[136:139], a[172:175], v[60:63]
    ds_write_b128 v5, v[220:223] offset:20800
    v_mfma_f32_16x16x32_bf16 v[76:79], v[140:143], a[172:175], v[76:79]
    v_alignbit_b32 v224, v182, v181, 16
    v_alignbit_b32 v225, v183, v182, 16
    s_waitcnt lgkmcnt(5)
    v_mfma_f32_16x16x32_bf16 v[52:55], v[144:147], a[40:43], v[52:55]
    ds_write_b128 v5, v[222:225] offset:4160
    s_waitcnt lgkmcnt(5)
    v_mfma_f32_16x16x32_bf16 v[68:71], v[148:151], a[40:43], v[68:71]
    buffer_load_dwordx4 v[176:179], v230, s[28:31], s37 offen offset:0
    v_mfma_f32_16x16x32_bf16 v[56:59], v[144:147], a[104:107], v[56:59]
    ds_read_b128 v[160:163], v6 offset:1472
    v_mfma_f32_16x16x32_bf16 v[72:75], v[148:151], a[104:107], v[72:75]
    ds_read_b128 v[164:167], v6 offset:1504
    v_mfma_f32_16x16x32_bf16 v[60:63], v[144:147], a[168:171], v[60:63]
    buffer_load_dwordx4 v[180:183], v4, s[28:31], s37 offen offset:0
    v_mfma_f32_16x16x32_bf16 v[76:79], v[148:151], a[168:171], v[76:79]
    s_add_u32 m0, s35, 0
    s_waitcnt lgkmcnt(5)
    v_mfma_f32_16x16x32_bf16 v[52:55], v[152:155], a[36:39], v[52:55]
    buffer_load_dwordx4 v4, s[8:11], s39 offen offset:0 lds
    s_waitcnt lgkmcnt(4)
    v_mfma_f32_16x16x32_bf16 v[68:71], v[156:159], a[36:39], v[68:71]
    s_add_u32 m0, s35, 256
    v_mfma_f32_16x16x32_bf16 v[56:59], v[152:155], a[100:103], v[56:59]
    ds_read_b128 v[168:171], v6 offset:1536
    v_mfma_f32_16x16x32_bf16 v[72:75], v[156:159], a[100:103], v[72:75]
    ds_read_b128 v[172:175], v6 offset:1568
    v_mfma_f32_16x16x32_bf16 v[60:63], v[152:155], a[164:167], v[60:63]
    buffer_load_dwordx4 v4, s[8:11], s39 offen offset:1024 lds
    v_mfma_f32_16x16x32_bf16 v[76:79], v[156:159], a[164:167], v[76:79]
    s_add_u32 m0, s35, 512
    s_waitcnt lgkmcnt(3)
    v_mfma_f32_16x16x32_bf16 v[52:55], v[160:163], a[32:35], v[52:55]
    buffer_load_dwordx4 v4, s[8:11], s39 offen offset:2048 lds
    s_waitcnt lgkmcnt(2)
    v_mfma_f32_16x16x32_bf16 v[68:71], v[164:167], a[32:35], v[68:71]
    s_add_u32 m0, s35, 768
    v_mfma_f32_16x16x32_bf16 v[56:59], v[160:163], a[96:99], v[56:59]
    ds_read_b128 v[112:115], v6 offset:1600
    v_mfma_f32_16x16x32_bf16 v[72:75], v[164:167], a[96:99], v[72:75]
    ds_read_b128 v[116:119], v6 offset:1632
    v_mfma_f32_16x16x32_bf16 v[60:63], v[160:163], a[160:163], v[60:63]
    buffer_load_dwordx4 v4, s[8:11], s39 offen offset:3072 lds
    v_mfma_f32_16x16x32_bf16 v[76:79], v[164:167], a[160:163], v[76:79]
    s_waitcnt lgkmcnt(3)
    v_mfma_f32_16x16x32_bf16 v[52:55], v[168:171], a[28:31], v[52:55]
    s_waitcnt lgkmcnt(2)
    v_mfma_f32_16x16x32_bf16 v[68:71], v[172:175], a[28:31], v[68:71]
    v_mfma_f32_16x16x32_bf16 v[56:59], v[168:171], a[92:95], v[56:59]
    ds_read_b128 v[120:123], v6 offset:1664
    v_mfma_f32_16x16x32_bf16 v[72:75], v[172:175], a[92:95], v[72:75]
    ds_read_b128 v[124:127], v6 offset:1696
    v_mfma_f32_16x16x32_bf16 v[60:63], v[168:171], a[156:159], v[60:63]
    v_mfma_f32_16x16x32_bf16 v[76:79], v[172:175], a[156:159], v[76:79]
    s_waitcnt lgkmcnt(3)
    v_mfma_f32_16x16x32_bf16 v[52:55], v[112:115], a[24:27], v[52:55]
    s_waitcnt lgkmcnt(2)
    v_mfma_f32_16x16x32_bf16 v[68:71], v[116:119], a[24:27], v[68:71]
    v_mfma_f32_16x16x32_bf16 v[56:59], v[112:115], a[88:91], v[56:59]
    ds_read_b128 v[128:131], v6 offset:1728
    v_mfma_f32_16x16x32_bf16 v[72:75], v[116:119], a[88:91], v[72:75]
    ds_read_b128 v[132:135], v6 offset:1760
    v_mfma_f32_16x16x32_bf16 v[60:63], v[112:115], a[152:155], v[60:63]
    v_mfma_f32_16x16x32_bf16 v[76:79], v[116:119], a[152:155], v[76:79]
    s_waitcnt lgkmcnt(3)
    v_mfma_f32_16x16x32_bf16 v[52:55], v[120:123], a[20:23], v[52:55]
    s_waitcnt lgkmcnt(2)
    v_mfma_f32_16x16x32_bf16 v[68:71], v[124:127], a[20:23], v[68:71]
    v_mfma_f32_16x16x32_bf16 v[56:59], v[120:123], a[84:87], v[56:59]
    ds_read_b128 v[136:139], v6 offset:1792
    v_mfma_f32_16x16x32_bf16 v[72:75], v[124:127], a[84:87], v[72:75]
    ds_read_b128 v[140:143], v6 offset:1824
    v_mfma_f32_16x16x32_bf16 v[60:63], v[120:123], a[148:151], v[60:63]
    v_mfma_f32_16x16x32_bf16 v[76:79], v[124:127], a[148:151], v[76:79]
    s_waitcnt lgkmcnt(3)
    v_mfma_f32_16x16x32_bf16 v[52:55], v[128:131], a[16:19], v[52:55]
    s_waitcnt lgkmcnt(2)
    v_mfma_f32_16x16x32_bf16 v[68:71], v[132:135], a[16:19], v[68:71]
    v_mfma_f32_16x16x32_bf16 v[56:59], v[128:131], a[80:83], v[56:59]
    ds_read_b128 v[144:147], v6 offset:1856
    v_mfma_f32_16x16x32_bf16 v[72:75], v[132:135], a[80:83], v[72:75]
    ds_read_b128 v[148:151], v6 offset:1888
    v_mfma_f32_16x16x32_bf16 v[60:63], v[128:131], a[144:147], v[60:63]
    v_mfma_f32_16x16x32_bf16 v[76:79], v[132:135], a[144:147], v[76:79]
    s_waitcnt lgkmcnt(3)
    v_mfma_f32_16x16x32_bf16 v[52:55], v[136:139], a[12:15], v[52:55]
    s_waitcnt lgkmcnt(2)
    v_mfma_f32_16x16x32_bf16 v[68:71], v[140:143], a[12:15], v[68:71]
    v_mfma_f32_16x16x32_bf16 v[56:59], v[136:139], a[76:79], v[56:59]
    ds_read_b128 v[152:155], v6 offset:1920
    v_mfma_f32_16x16x32_bf16 v[72:75], v[140:143], a[76:79], v[72:75]
    ds_read_b128 v[156:159], v6 offset:1952
    v_mfma_f32_16x16x32_bf16 v[60:63], v[136:139], a[140:143], v[60:63]
    v_mfma_f32_16x16x32_bf16 v[76:79], v[140:143], a[140:143], v[76:79]
    s_waitcnt lgkmcnt(3)
    v_mfma_f32_16x16x32_bf16 v[52:55], v[144:147], a[8:11], v[52:55]
    s_waitcnt lgkmcnt(2)
    v_mfma_f32_16x16x32_bf16 v[68:71], v[148:151], a[8:11], v[68:71]
    v_mfma_f32_16x16x32_bf16 v[56:59], v[144:147], a[72:75], v[56:59]
    ds_read_b128 v[160:163], v6 offset:1984
    v_mfma_f32_16x16x32_bf16 v[72:75], v[148:151], a[72:75], v[72:75]
    ds_read_b128 v[164:167], v6 offset:2016
    v_mfma_f32_16x16x32_bf16 v[60:63], v[144:147], a[136:139], v[60:63]
    v_mfma_f32_16x16x32_bf16 v[76:79], v[148:151], a[136:139], v[76:79]
    s_waitcnt lgkmcnt(3)
    v_mfma_f32_16x16x32_bf16 v[52:55], v[152:155], a[4:7], v[52:55]
    s_waitcnt lgkmcnt(2)
    v_mfma_f32_16x16x32_bf16 v[68:71], v[156:159], a[4:7], v[68:71]
    v_mfma_f32_16x16x32_bf16 v[56:59], v[152:155], a[68:71], v[56:59]
    ds_read_b128 v[168:171], v6 offset:2048
    v_mfma_f32_16x16x32_bf16 v[72:75], v[156:159], a[68:71], v[72:75]
    ds_read_b128 v[172:175], v6 offset:2080
    v_mfma_f32_16x16x32_bf16 v[60:63], v[152:155], a[132:135], v[60:63]
    s_waitcnt vmcnt(10)
    v_mfma_f32_16x16x32_bf16 v[76:79], v[156:159], a[132:135], v[76:79]
    ds_write_b128 v5, v[188:191] offset:1024
    s_waitcnt lgkmcnt(4)
    v_mfma_f32_16x16x32_bf16 v[52:55], v[160:163], a[0:3], v[52:55]
    ds_read_b128 v[112:115], v6 offset:2112
    s_waitcnt lgkmcnt(4)
    v_mfma_f32_16x16x32_bf16 v[68:71], v[164:167], a[0:3], v[68:71]
    ds_read_b128 v[116:119], v6 offset:2144
    v_mfma_f32_16x16x32_bf16 v[56:59], v[160:163], a[64:67], v[56:59]
    ds_write_b128 v5, v[186:189] offset:17664
    v_mfma_f32_16x16x32_bf16 v[72:75], v[164:167], a[64:67], v[72:75]
    v_mov_b32 v208, v185
    v_mov_b32 v209, v186
    v_mfma_f32_16x16x32_bf16 v[60:63], v[160:163], a[128:131], v[60:63]
    ds_read_b128 v[120:123], v6 offset:2176
    v_mfma_f32_16x16x32_bf16 v[76:79], v[164:167], a[128:131], v[76:79]
    ds_read_b128 v[124:127], v6 offset:2208
    s_waitcnt lgkmcnt(7)
    v_mfma_f32_16x16x32_bf16 v[56:59], v[168:171], a[60:63], v[56:59]
    v_mov_b32 v210, v187
    v_mov_b32 v211, v188
    s_waitcnt lgkmcnt(6)
    v_mfma_f32_16x16x32_bf16 v[72:75], v[172:175], a[60:63], v[72:75]
    ds_write_b128 v5, v[208:211] offset:25984
    v_mfma_f32_16x16x32_bf16 v[60:63], v[168:171], a[124:127], v[60:63]
    ds_read_b128 v[128:131], v6 offset:2240
    v_mfma_f32_16x16x32_bf16 v[76:79], v[172:175], a[124:127], v[76:79]
    ds_read_b128 v[132:135], v6 offset:2272
    s_waitcnt lgkmcnt(7)
    v_mfma_f32_16x16x32_bf16 v[56:59], v[112:115], a[56:59], v[56:59]
    v_mov_b32 v212, v189
    v_mov_b32 v213, v190
    s_waitcnt lgkmcnt(6)
    v_mfma_f32_16x16x32_bf16 v[72:75], v[116:119], a[56:59], v[72:75]
    ds_write_b128 v5, v[210:213] offset:9344
    v_mfma_f32_16x16x32_bf16 v[60:63], v[112:115], a[120:123], v[60:63]
    ds_read_b128 v[136:139], v6 offset:2304
    v_mfma_f32_16x16x32_bf16 v[76:79], v[116:119], a[120:123], v[76:79]
    ds_read_b128 v[140:143], v6 offset:2336
    s_waitcnt lgkmcnt(7)
    v_mfma_f32_16x16x32_bf16 v[56:59], v[120:123], a[52:55], v[56:59]
    v_alignbit_b32 v214, v185, v184, 16
    v_alignbit_b32 v215, v186, v185, 16
    s_waitcnt lgkmcnt(6)
    v_mfma_f32_16x16x32_bf16 v[72:75], v[124:127], a[52:55], v[72:75]
    v_alignbit_b32 v216, v187, v186, 16
    v_alignbit_b32 v217, v188, v187, 16
    v_mfma_f32_16x16x32_bf16 v[60:63], v[120:123], a[116:119], v[60:63]
    ds_read_b128 v[144:147], v6 offset:2368
    v_mfma_f32_16x16x32_bf16 v[76:79], v[124:127], a[116:119], v[76:79]
    ds_read_b128 v[148:151], v6 offset:2400
    s_waitcnt lgkmcnt(6)
    v_mfma_f32_16x16x32_bf16 v[56:59], v[128:131], a[48:51], v[56:59]
    ds_write_b128 v5, v[214:217] offset:30144
    s_waitcnt lgkmcnt(6)
    v_mfma_f32_16x16x32_bf16 v[72:75], v[132:135], a[48:51], v[72:75]
    v_alignbit_b32 v218, v189, v188, 16
    v_alignbit_b32 v219, v190, v189, 16
    v_mfma_f32_16x16x32_bf16 v[60:63], v[128:131], a[112:115], v[60:63]
    ds_read_b128 v[152:155], v6 offset:2432
    v_mfma_f32_16x16x32_bf16 v[76:79], v[132:135], a[112:115], v[76:79]
    ds_read_b128 v[156:159], v6 offset:2464
    s_waitcnt lgkmcnt(6)
    v_mfma_f32_16x16x32_bf16 v[56:59], v[136:139], a[44:47], v[56:59]
    ds_write_b128 v5, v[216:219] offset:13504
    s_waitcnt lgkmcnt(6)
    v_mfma_f32_16x16x32_bf16 v[72:75], v[140:143], a[44:47], v[72:75]
    v_alignbit_b32 v220, v186, v185, 16
    v_alignbit_b32 v221, v187, v186, 16
    v_mfma_f32_16x16x32_bf16 v[60:63], v[136:139], a[108:111], v[60:63]
    ds_read_b128 v[160:163], v6 offset:2496
    v_mfma_f32_16x16x32_bf16 v[76:79], v[140:143], a[108:111], v[76:79]
    ds_read_b128 v[164:167], v6 offset:2528
    s_waitcnt lgkmcnt(7)
    v_mfma_f32_16x16x32_bf16 v[56:59], v[144:147], a[40:43], v[56:59]
    v_alignbit_b32 v222, v188, v187, 16
    v_alignbit_b32 v223, v189, v188, 16
    s_waitcnt lgkmcnt(6)
    v_mfma_f32_16x16x32_bf16 v[72:75], v[148:151], a[40:43], v[72:75]
    ds_write_b128 v5, v[220:223] offset:21824
    v_mfma_f32_16x16x32_bf16 v[60:63], v[144:147], a[104:107], v[60:63]
    ds_read_b128 v[168:171], v6 offset:2560
    v_mfma_f32_16x16x32_bf16 v[76:79], v[148:151], a[104:107], v[76:79]
    ds_read_b128 v[172:175], v6 offset:2592
    s_waitcnt lgkmcnt(7)
    v_mfma_f32_16x16x32_bf16 v[56:59], v[152:155], a[36:39], v[56:59]
    v_alignbit_b32 v224, v190, v189, 16
    v_alignbit_b32 v225, v191, v190, 16
    s_waitcnt lgkmcnt(6)
    v_mfma_f32_16x16x32_bf16 v[72:75], v[156:159], a[36:39], v[72:75]
    ds_write_b128 v5, v[222:225] offset:5184
    v_mfma_f32_16x16x32_bf16 v[60:63], v[152:155], a[100:103], v[60:63]
    ds_read_b128 v[112:115], v6 offset:2624
    v_mfma_f32_16x16x32_bf16 v[76:79], v[156:159], a[100:103], v[76:79]
    ds_read_b128 v[116:119], v6 offset:2656
    s_waitcnt lgkmcnt(7)
    v_mfma_f32_16x16x32_bf16 v[56:59], v[160:163], a[32:35], v[56:59]
    buffer_load_dwordx4 v[184:187], v4, s[28:31], s37 offen offset:1008
    s_waitcnt lgkmcnt(6)
    v_mfma_f32_16x16x32_bf16 v[72:75], v[164:167], a[32:35], v[72:75]
    buffer_load_dwordx4 v[188:191], v4, s[28:31], s37 offen offset:1024
    v_mfma_f32_16x16x32_bf16 v[60:63], v[160:163], a[96:99], v[60:63]
    ds_read_b128 v[120:123], v6 offset:2688
    v_mfma_f32_16x16x32_bf16 v[76:79], v[164:167], a[96:99], v[76:79]
    ds_read_b128 v[124:127], v6 offset:2720
    s_waitcnt lgkmcnt(6)
    v_mfma_f32_16x16x32_bf16 v[56:59], v[168:171], a[28:31], v[56:59]
    s_mov_b32 s36, s37
    s_add_u32 s39, s37, 125829120
    s_add_u32 s37, s37, 4096
    s_min_u32 s37, s37, s33

    s_pack_ll_b32_b16 s40, s65, s65
    s_mov_b32 s64, s65
    s_mov_b32 s65, s66
    s_mov_b32 s66, s67
    v_and_b32 v236, s40, v8
    s_waitcnt lgkmcnt(5)
    v_mfma_f32_16x16x32_bf16 v[72:75], v[172:175], a[28:31], v[72:75]
    v_and_b32 v237, s40, v9
    v_and_b32 v238, s40, v10
    v_mfma_f32_16x16x32_bf16 v[60:63], v[168:171], a[92:95], v[60:63]
    ds_read_b128 v[128:131], v6 offset:2752
    v_mfma_f32_16x16x32_bf16 v[76:79], v[172:175], a[92:95], v[76:79]
    ds_read_b128 v[132:135], v6 offset:2784
    s_waitcnt lgkmcnt(5)
    v_mfma_f32_16x16x32_bf16 v[56:59], v[112:115], a[24:27], v[56:59]
    v_and_b32 v239, s40, v11
    v_and_b32 v240, s40, v12
    s_waitcnt lgkmcnt(4)
    v_mfma_f32_16x16x32_bf16 v[72:75], v[116:119], a[24:27], v[72:75]
    v_and_b32 v241, s40, v13
    v_and_b32 v242, s40, v14
    v_mfma_f32_16x16x32_bf16 v[60:63], v[112:115], a[88:91], v[60:63]
    ds_read_b128 v[136:139], v6 offset:2816
    v_mfma_f32_16x16x32_bf16 v[76:79], v[116:119], a[88:91], v[76:79]
    ds_read_b128 v[140:143], v6 offset:2848
    s_waitcnt lgkmcnt(5)
    v_mfma_f32_16x16x32_bf16 v[56:59], v[120:123], a[20:23], v[56:59]
    v_and_b32 v243, s40, v15
    s_waitcnt lgkmcnt(4)
    v_mfma_f32_16x16x32_bf16 v[72:75], v[124:127], a[20:23], v[72:75]
    v_mfma_f32_16x16x32_bf16 v[60:63], v[120:123], a[84:87], v[60:63]
    ds_read_b128 v[144:147], v6 offset:2880
    v_mfma_f32_16x16x32_bf16 v[76:79], v[124:127], a[84:87], v[76:79]
    ds_read_b128 v[148:151], v6 offset:2912
    s_waitcnt lgkmcnt(5)
    v_mfma_f32_16x16x32_bf16 v[56:59], v[128:131], a[16:19], v[56:59]
    s_waitcnt lgkmcnt(4)
    v_mfma_f32_16x16x32_bf16 v[72:75], v[132:135], a[16:19], v[72:75]
    v_mfma_f32_16x16x32_bf16 v[60:63], v[128:131], a[80:83], v[60:63]
    ds_read_b128 v[152:155], v6 offset:2944
    v_mfma_f32_16x16x32_bf16 v[76:79], v[132:135], a[80:83], v[76:79]
    ds_read_b128 v[156:159], v6 offset:2976
    s_waitcnt lgkmcnt(5)
    v_mfma_f32_16x16x32_bf16 v[56:59], v[136:139], a[12:15], v[56:59]
    s_waitcnt lgkmcnt(4)
    v_mfma_f32_16x16x32_bf16 v[72:75], v[140:143], a[12:15], v[72:75]
    v_mfma_f32_16x16x32_bf16 v[60:63], v[136:139], a[76:79], v[60:63]
    ds_read_b128 v[160:163], v6 offset:3008
    v_mfma_f32_16x16x32_bf16 v[76:79], v[140:143], a[76:79], v[76:79]
    ds_read_b128 v[164:167], v6 offset:3040
    s_waitcnt lgkmcnt(5)
    v_mfma_f32_16x16x32_bf16 v[56:59], v[144:147], a[8:11], v[56:59]
    s_waitcnt lgkmcnt(4)
    v_mfma_f32_16x16x32_bf16 v[72:75], v[148:151], a[8:11], v[72:75]
    v_mfma_f32_16x16x32_bf16 v[60:63], v[144:147], a[72:75], v[60:63]
    ds_read_b128 v[168:171], v6 offset:3072
    v_mfma_f32_16x16x32_bf16 v[76:79], v[148:151], a[72:75], v[76:79]
    ds_read_b128 v[172:175], v6 offset:3104
    s_waitcnt lgkmcnt(5)
    v_mfma_f32_16x16x32_bf16 v[56:59], v[152:155], a[4:7], v[56:59]
    ds_read_b128 v[112:115], v6 offset:3136
    s_waitcnt lgkmcnt(5)
    v_mfma_f32_16x16x32_bf16 v[72:75], v[156:159], a[4:7], v[72:75]
    ds_read_b128 v[116:119], v6 offset:3168
    v_mfma_f32_16x16x32_bf16 v[60:63], v[152:155], a[68:71], v[60:63]
    ds_read_b128 v[120:123], v6 offset:3200
    v_mfma_f32_16x16x32_bf16 v[76:79], v[156:159], a[68:71], v[76:79]
    ds_read_b128 v[124:127], v6 offset:3232
    s_waitcnt lgkmcnt(7)
    v_mfma_f32_16x16x32_bf16 v[56:59], v[160:163], a[0:3], v[56:59]
    ds_read_b128 v[128:131], v6 offset:3264
    s_waitcnt lgkmcnt(7)
    v_mfma_f32_16x16x32_bf16 v[72:75], v[164:167], a[0:3], v[72:75]
    ds_read_b128 v[132:135], v6 offset:3296
    v_mfma_f32_16x16x32_bf16 v[60:63], v[160:163], a[64:67], v[60:63]
    ds_read_b128 v[136:139], v6 offset:3328
    v_mfma_f32_16x16x32_bf16 v[76:79], v[164:167], a[64:67], v[76:79]
    ds_read_b128 v[140:143], v6 offset:3360
    s_waitcnt lgkmcnt(9)
    v_mfma_f32_16x16x32_bf16 v[60:63], v[168:171], a[60:63], v[60:63]
    ds_read_b128 v[144:147], v6 offset:3392
    s_waitcnt lgkmcnt(9)
    v_mfma_f32_16x16x32_bf16 v[76:79], v[172:175], a[60:63], v[76:79]
    ds_read_b128 v[148:151], v6 offset:3424
    s_waitcnt lgkmcnt(9)
    v_mfma_f32_16x16x32_bf16 v[60:63], v[112:115], a[56:59], v[60:63]
    ds_read_b128 v[152:155], v6 offset:3456
    s_waitcnt lgkmcnt(9)
    v_mfma_f32_16x16x32_bf16 v[76:79], v[116:119], a[56:59], v[76:79]
    ds_read_b128 v[156:159], v6 offset:3488
    s_waitcnt lgkmcnt(9)
    v_mfma_f32_16x16x32_bf16 v[60:63], v[120:123], a[52:55], v[60:63]
    ds_read_b128 v[160:163], v6 offset:3520
    s_waitcnt lgkmcnt(9)
    v_mfma_f32_16x16x32_bf16 v[76:79], v[124:127], a[52:55], v[76:79]
    ds_read_b128 v[164:167], v6 offset:3552
    s_waitcnt lgkmcnt(9)
    v_mfma_f32_16x16x32_bf16 v[60:63], v[128:131], a[48:51], v[60:63]
    ds_read_b128 v[168:171], v6 offset:3584
    s_waitcnt lgkmcnt(9)
    v_mfma_f32_16x16x32_bf16 v[76:79], v[132:135], a[48:51], v[76:79]
    ds_read_b128 v[172:175], v6 offset:3616
    s_waitcnt lgkmcnt(9)
    v_mfma_f32_16x16x32_bf16 v[60:63], v[136:139], a[44:47], v[60:63]
    ds_read_b128 v[112:115], v6 offset:3648
    s_waitcnt lgkmcnt(9)
    v_mfma_f32_16x16x32_bf16 v[76:79], v[140:143], a[44:47], v[76:79]
    ds_read_b128 v[116:119], v6 offset:3680
    s_waitcnt lgkmcnt(9)
    v_mfma_f32_16x16x32_bf16 v[60:63], v[144:147], a[40:43], v[60:63]
    ds_read_b128 v[120:123], v6 offset:3712
    s_waitcnt lgkmcnt(9)
    v_mfma_f32_16x16x32_bf16 v[76:79], v[148:151], a[40:43], v[76:79]
    ds_read_b128 v[124:127], v6 offset:3744
    s_waitcnt lgkmcnt(9)
    v_mfma_f32_16x16x32_bf16 v[60:63], v[152:155], a[36:39], v[60:63]
    ds_read_b128 v[128:131], v6 offset:3776
    s_waitcnt lgkmcnt(9)
    v_mfma_f32_16x16x32_bf16 v[76:79], v[156:159], a[36:39], v[76:79]
    ds_read_b128 v[132:135], v6 offset:3808
    s_waitcnt lgkmcnt(9)
    v_mfma_f32_16x16x32_bf16 v[60:63], v[160:163], a[32:35], v[60:63]
    ds_read_b128 v[136:139], v6 offset:3840
    s_waitcnt lgkmcnt(9)
    v_mfma_f32_16x16x32_bf16 v[76:79], v[164:167], a[32:35], v[76:79]
    ds_read_b128 v[140:143], v6 offset:3872
    s_waitcnt lgkmcnt(9)
    v_mfma_f32_16x16x32_bf16 v[60:63], v[168:171], a[28:31], v[60:63]
    ds_read_b128 v[144:147], v6 offset:3904
    s_waitcnt lgkmcnt(9)
    v_mfma_f32_16x16x32_bf16 v[76:79], v[172:175], a[28:31], v[76:79]
    ds_read_b128 v[148:151], v6 offset:3936
    s_waitcnt lgkmcnt(9)
    v_mfma_f32_16x16x32_bf16 v[60:63], v[112:115], a[24:27], v[60:63]
    ds_read_b128 v[152:155], v6 offset:3968
    s_waitcnt lgkmcnt(9)
    v_mfma_f32_16x16x32_bf16 v[76:79], v[116:119], a[24:27], v[76:79]
    ds_read_b128 v[156:159], v6 offset:4000
    s_waitcnt lgkmcnt(9)
    v_mfma_f32_16x16x32_bf16 v[60:63], v[120:123], a[20:23], v[60:63]
    ds_read_b128 v[160:163], v6 offset:4032
    s_waitcnt lgkmcnt(9)
    v_mfma_f32_16x16x32_bf16 v[76:79], v[124:127], a[20:23], v[76:79]
    ds_read_b128 v[164:167], v6 offset:4064
    s_waitcnt lgkmcnt(9)
    v_mfma_f32_16x16x32_bf16 v[60:63], v[128:131], a[16:19], v[60:63]
    s_waitcnt vmcnt(2)
    ds_read_b128 a[60:63], v7 offset:240
    s_waitcnt lgkmcnt(9)
    v_mfma_f32_16x16x32_bf16 v[76:79], v[132:135], a[16:19], v[76:79]
    s_waitcnt lgkmcnt(8)
    v_mfma_f32_16x16x32_bf16 v[60:63], v[136:139], a[12:15], v[60:63]
    ds_read_b128 a[124:127], v7 offset:496
    s_waitcnt lgkmcnt(8)
    v_mfma_f32_16x16x32_bf16 v[76:79], v[140:143], a[12:15], v[76:79]
    s_waitcnt lgkmcnt(7)
    v_mfma_f32_16x16x32_bf16 v[60:63], v[144:147], a[8:11], v[60:63]
    ds_read_b128 a[188:191], v7 offset:752
    s_waitcnt lgkmcnt(7)
    v_mfma_f32_16x16x32_bf16 v[76:79], v[148:151], a[8:11], v[76:79]
    s_waitcnt lgkmcnt(6)
    v_mfma_f32_16x16x32_bf16 v[60:63], v[152:155], a[4:7], v[60:63]
    ds_read_b128 a[252:255], v7 offset:1008
    s_waitcnt lgkmcnt(6)
    v_mfma_f32_16x16x32_bf16 v[76:79], v[156:159], a[4:7], v[76:79]
    s_waitcnt lgkmcnt(5)
    v_mfma_f32_16x16x32_bf16 v[60:63], v[160:163], a[0:3], v[60:63]
    ds_read_b128 v[168:171], v6 offset:0
    s_waitcnt lgkmcnt(5)
    v_mfma_f32_16x16x32_bf16 v[76:79], v[164:167], a[0:3], v[76:79]
    ds_read_b128 v[172:175], v6 offset:32
    s_add_u32 s41, s38, 4096
    v_cvt_pk_bf16_f32 v80, v16, v48
    v_cvt_pk_bf16_f32 v81, v17, v49
    v_cvt_pk_bf16_f32 v82, v18, v50
    v_cvt_pk_bf16_f32 v83, v19, v51
    buffer_store_dwordx4 v[80:83], v228, s[8:11], s38 offen offset:0 sc1
    v_cvt_pk_bf16_f32 v84, v32, v64
    v_cvt_pk_bf16_f32 v85, v33, v65
    v_cvt_pk_bf16_f32 v86, v34, v66
    v_cvt_pk_bf16_f32 v87, v35, v67
    buffer_store_dwordx4 v[84:87], v228, s[8:11], s38 offen offset:64 sc1
    v_cvt_pk_bf16_f32 v88, v20, v52
    v_cvt_pk_bf16_f32 v89, v21, v53
    v_cvt_pk_bf16_f32 v90, v22, v54
    v_cvt_pk_bf16_f32 v91, v23, v55
    buffer_store_dwordx4 v[88:91], v228, s[8:11], s38 offen offset:2048 sc1
    v_cvt_pk_bf16_f32 v92, v36, v68
    v_cvt_pk_bf16_f32 v93, v37, v69
    v_cvt_pk_bf16_f32 v94, v38, v70
    v_cvt_pk_bf16_f32 v95, v39, v71
    buffer_store_dwordx4 v[92:95], v228, s[8:11], s38 offen offset:2112 sc1
    v_cvt_pk_bf16_f32 v96, v24, v56
    v_cvt_pk_bf16_f32 v97, v25, v57
    v_cvt_pk_bf16_f32 v98, v26, v58
    v_cvt_pk_bf16_f32 v99, v27, v59
    buffer_store_dwordx4 v[96:99], v228, s[8:11], s41 offen offset:0 sc1
    v_cvt_pk_bf16_f32 v100, v40, v72
    v_cvt_pk_bf16_f32 v101, v41, v73
    v_cvt_pk_bf16_f32 v102, v42, v74
    v_cvt_pk_bf16_f32 v103, v43, v75
    buffer_store_dwordx4 v[100:103], v228, s[8:11], s41 offen offset:64 sc1
    v_cvt_pk_bf16_f32 v104, v28, v60
    v_cvt_pk_bf16_f32 v105, v29, v61
    v_cvt_pk_bf16_f32 v106, v30, v62
    v_cvt_pk_bf16_f32 v107, v31, v63
    buffer_store_dwordx4 v[104:107], v228, s[8:11], s41 offen offset:2048 sc1
    v_cvt_pk_bf16_f32 v108, v44, v76
    v_cvt_pk_bf16_f32 v109, v45, v77
    v_cvt_pk_bf16_f32 v110, v46, v78
    v_cvt_pk_bf16_f32 v111, v47, v79
    buffer_store_dwordx4 v[108:111], v228, s[8:11], s41 offen offset:2112 sc1
    s_add_u32 s38, s38, 8192
    s_add_u32 s42, s42, 1
    s_cmp_lt_u32 s42, 4
    s_cbranch_scc1 .cvl_397

    s_waitcnt vmcnt(0) lgkmcnt(0)
    s_barrier
    s_mov_b32 s5, 44
    s_cmp_lg_u32 s24, 0
    s_cbranch_scc1 .sg_398
    s_mov_b64 exec, 1
    v_mov_b32 v4, 1
    v_mov_b32 v5, 0
    buffer_atomic_add v4, v5, s[20:23], s5 offen sc1
    s_mov_b64 exec, -1

.sg_398:
    v_and_b32 v1, 63, v0
    v_and_b32 v2, 15, v1
    v_lshrrev_b32 v3, 4, v1

    v_mov_b32 v5, 0
    s_mov_b32 s62, 0
    s_mov_b32 s5, 32
.wc_399:
    buffer_load_dword v4, v5, s[20:23], s5 offen sc1
    s_waitcnt vmcnt(0)
    v_readfirstlane_b32 s4, v4
    s_lshr_b32 s4, s4, 0
    s_and_b32 s4, s4, 0xffff
    s_cmp_ge_u32 s4, 256
    s_cbranch_scc1 .wcd_400
    s_sleep 6
    s_add_u32 s62, s62, 1
    s_cmp_gt_u32 s62, 0x400000
    s_cbranch_scc1 .mg_end_1
    s_branch .wc_399

.wcd_400:
    s_sub_u32 s4, s26, 24
    s_lshr_b32 s25, s4, 1
    s_and_b32 s4, s4, 1
    s_lshl_b32 s4, s4, 2
    s_lshl_b32 s5, s91, 3
    s_add_u32 s4, s4, s5
    s_add_u32 s26, s4, s24
    s_lshl_b32 s35, s26, 8
    s_add_u32 s35, s35, 92274688
    s_mov_b32 s37, 0x3db504f3
    s_mov_b32 s38, 0x3fb8aa3b
    v_lshlrev_b32 v8, 4, v1
    v_lshlrev_b32 v9, 13, v1
    v_lshlrev_b32 v6, 4, v3
    v_and_b32 v5, 7, v2
    v_add_u32 v10, v6, v5
    v_lshlrev_b32 v10, 4, v10
    v_lshlrev_b32 v11, 4, v2
    v_lshlrev_b32 v5, 3, v3
    v_add_u32 v11, v11, v5
    v_cmp_gt_u32 s[60:61], 32, v1
    v_lshlrev_b32 v5, 2, v3
    v_mov_b32 v12, 0
    v_mov_b32 v13, 0

    v_add_u32 v7, 0, v5
    v_cmp_le_u32 s[40:41], v7, v2
    v_add_u32 v7, 1, v5
    v_cmp_le_u32 s[42:43], v7, v2
    v_add_u32 v7, 2, v5
    v_cmp_le_u32 s[44:45], v7, v2
    v_add_u32 v7, 3, v5
    v_cmp_le_u32 s[46:47], v7, v2
    v_mov_b32 v128, 0
    v_mov_b32 v129, 0
    v_mov_b32 v130, 0
    v_mov_b32 v131, 0
    v_mov_b32 v132, 0
    v_mov_b32 v133, 0
    v_mov_b32 v134, 0
    v_mov_b32 v135, 0
    v_mov_b32 v136, 0
    v_mov_b32 v137, 0
    v_mov_b32 v138, 0
    v_mov_b32 v139, 0
    v_mov_b32 v140, 0
    v_mov_b32 v141, 0
    v_mov_b32 v142, 0
    v_mov_b32 v143, 0
.att_401:
    s_add_u32 s36, s25, 1
    s_lshl_b32 s4, s25, 5
    s_add_u32 s4, s4, s26
    s_lshl_b32 s27, s4, 13
    s_add_u32 s28, s27, 4096
    s_add_u32 s29, s27, 16777216
    s_add_u32 s30, s27, 16781312
    s_add_u32 s31, s27, 33554432
    s_add_u32 s32, s27, 33558528
    s_mul_i32 s33, s4, 6144
    s_add_u32 s33, s33, 67108864
    s_add_u32 s34, s33, 4096

    s_mov_b32 s62, 0
    s_mov_b64 exec, 7
.wf_402:
    buffer_load_dword v4, v9, s[8:11], s35 offen sc1
    s_waitcnt vmcnt(0)
    v_cmp_gt_u32 vcc, s36, v4
    s_cbranch_vccz .wfd_403
    s_sleep 2
    s_add_u32 s62, s62, 1
    s_cmp_gt_u32 s62, 0x400000
    s_cbranch_scc1 .mg_end_1
    s_branch .wf_402

.wfd_403:
    s_mov_b64 exec, -1
    buffer_load_dwordx4 v[16:19], v8, s[8:11], s27 offen offset:0
    buffer_load_dwordx4 v[32:35], v8, s[8:11], s28 offen offset:0
    buffer_load_dwordx4 v[48:51], v8, s[8:11], s29 offen offset:0
    buffer_load_dwordx4 v[64:67], v8, s[8:11], s30 offen offset:0
    buffer_load_dwordx4 v[20:23], v8, s[8:11], s27 offen offset:1024
    buffer_load_dwordx4 v[36:39], v8, s[8:11], s28 offen offset:1024
    buffer_load_dwordx4 v[52:55], v8, s[8:11], s29 offen offset:1024
    buffer_load_dwordx4 v[68:71], v8, s[8:11], s30 offen offset:1024
    buffer_load_dwordx4 v[24:27], v8, s[8:11], s27 offen offset:2048
    buffer_load_dwordx4 v[40:43], v8, s[8:11], s28 offen offset:2048
    buffer_load_dwordx4 v[56:59], v8, s[8:11], s29 offen offset:2048
    buffer_load_dwordx4 v[72:75], v8, s[8:11], s30 offen offset:2048
    buffer_load_dwordx4 v[28:31], v8, s[8:11], s27 offen offset:3072
    buffer_load_dwordx4 v[44:47], v8, s[8:11], s28 offen offset:3072
    buffer_load_dwordx4 v[60:63], v8, s[8:11], s29 offen offset:3072
    buffer_load_dwordx4 v[76:79], v8, s[8:11], s30 offen offset:3072
    buffer_load_dwordx4 v[96:99], v8, s[8:11], s31 offen offset:0
    buffer_load_dwordx4 v[100:103], v8, s[8:11], s31 offen offset:1024
    buffer_load_dwordx4 v[104:107], v8, s[8:11], s31 offen offset:2048
    buffer_load_dwordx4 v[108:111], v8, s[8:11], s31 offen offset:3072
    buffer_load_dwordx4 v[112:115], v8, s[8:11], s32 offen offset:0
    buffer_load_dwordx4 v[116:119], v8, s[8:11], s32 offen offset:1024
    buffer_load_dwordx4 v[120:123], v8, s[8:11], s32 offen offset:2048
    buffer_load_dwordx4 v[124:127], v8, s[8:11], s32 offen offset:3072
    buffer_load_dwordx4 v[80:83], v10, s[8:11], s33 offen offset:2048 sc1
    buffer_load_dwordx4 v[84:87], v10, s[8:11], s33 offen offset:2176 sc1
    buffer_load_dwordx4 v[88:91], v10, s[8:11], s33 offen offset:3072 sc1
    buffer_load_dwordx4 v[92:95], v10, s[8:11], s33 offen offset:3200 sc1
    s_mov_b64 exec, s[60:61]
    buffer_load_dwordx2 v[128:129], v11, s[8:11], s34 offen offset:0 sc1
    buffer_load_dwordx2 v[130:131], v11, s[8:11], s34 offen offset:256 sc1
    buffer_load_dwordx2 v[132:133], v11, s[8:11], s34 offen offset:512 sc1
    buffer_load_dwordx2 v[134:135], v11, s[8:11], s34 offen offset:768 sc1
    buffer_load_dwordx2 v[136:137], v11, s[8:11], s34 offen offset:1024 sc1
    buffer_load_dwordx2 v[138:139], v11, s[8:11], s34 offen offset:1280 sc1
    buffer_load_dwordx2 v[140:141], v11, s[8:11], s34 offen offset:1536 sc1
    buffer_load_dwordx2 v[142:143], v11, s[8:11], s34 offen offset:1792 sc1
    s_mov_b64 exec, -1
    s_waitcnt vmcnt(32)
    v_mfma_f32_16x16x32_bf16 v[144:147], v[48:51], v[16:19], 0
    v_mfma_f32_16x16x32_bf16 v[156:159], v[48:51], v[32:35], 0
    v_mfma_f32_16x16x32_bf16 v[160:163], v[64:67], v[32:35], 0
    s_waitcnt vmcnt(28)
    v_mfma_f32_16x16x32_bf16 v[144:147], v[52:55], v[20:23], v[144:147]
    v_mfma_f32_16x16x32_bf16 v[156:159], v[52:55], v[36:39], v[156:159]
    v_mfma_f32_16x16x32_bf16 v[160:163], v[68:71], v[36:39], v[160:163]
    s_waitcnt vmcnt(24)
    v_mfma_f32_16x16x32_bf16 v[144:147], v[56:59], v[24:27], v[144:147]
    v_mfma_f32_16x16x32_bf16 v[156:159], v[56:59], v[40:43], v[156:159]
    v_mfma_f32_16x16x32_bf16 v[160:163], v[72:75], v[40:43], v[160:163]
    s_waitcnt vmcnt(20)
    v_mfma_f32_16x16x32_bf16 v[144:147], v[60:63], v[28:31], v[144:147]
    v_mfma_f32_16x16x32_bf16 v[156:159], v[60:63], v[44:47], v[156:159]
    v_mfma_f32_16x16x32_bf16 v[160:163], v[76:79], v[44:47], v[160:163]
    s_nop 7
    v_mov_b32 v14, 0xff800000
    v_cvt_pk_bf16_f32 v168, v144, v145
    v_cvt_pk_bf16_f32 v170, v146, v147
    v_and_b32 v169, 0xffff0000, v168
    v_lshlrev_b32 v168, 16, v168
    v_and_b32 v171, 0xffff0000, v170
    v_lshlrev_b32 v170, 16, v170
    v_mul_f32 v168, s37, v168
    v_mul_f32 v169, s37, v169
    v_mul_f32 v170, s37, v170
    v_mul_f32 v171, s37, v171
    v_cvt_pk_bf16_f32 v144, v168, v169
    v_cvt_pk_bf16_f32 v146, v170, v171
    v_and_b32 v145, 0xffff0000, v144
    v_lshlrev_b32 v144, 16, v144
    v_and_b32 v147, 0xffff0000, v146
    v_lshlrev_b32 v146, 16, v146
    v_cvt_pk_bf16_f32 v192, v156, v157
    v_cvt_pk_bf16_f32 v194, v158, v159
    v_cvt_pk_bf16_f32 v196, v160, v161
    v_cvt_pk_bf16_f32 v198, v162, v163
    v_and_b32 v193, 0xffff0000, v192
    v_lshlrev_b32 v192, 16, v192
    v_and_b32 v195, 0xffff0000, v194
    v_lshlrev_b32 v194, 16, v194
    v_and_b32 v197, 0xffff0000, v196
    v_lshlrev_b32 v196, 16, v196
    v_and_b32 v199, 0xffff0000, v198
    v_lshlrev_b32 v198, 16, v198
    v_mul_f32 v192, s37, v192
    v_mul_f32 v193, s37, v193
    v_mul_f32 v194, s37, v194
    v_mul_f32 v195, s37, v195
    v_mul_f32 v196, s37, v196
    v_mul_f32 v197, s37, v197
    v_mul_f32 v198, s37, v198
    v_mul_f32 v199, s37, v199
    v_cvt_pk_bf16_f32 v156, v192, v193
    v_cvt_pk_bf16_f32 v158, v194, v195
    v_cvt_pk_bf16_f32 v160, v196, v197
    v_cvt_pk_bf16_f32 v162, v198, v199
    v_and_b32 v157, 0xffff0000, v156
    v_lshlrev_b32 v156, 16, v156
    v_and_b32 v159, 0xffff0000, v158
    v_lshlrev_b32 v158, 16, v158
    v_and_b32 v161, 0xffff0000, v160
    v_lshlrev_b32 v160, 16, v160
    v_and_b32 v163, 0xffff0000, v162
    v_lshlrev_b32 v162, 16, v162
    v_cndmask_b32 v144, v14, v144, s[40:41]
    v_cndmask_b32 v145, v14, v145, s[42:43]
    v_cndmask_b32 v146, v14, v146, s[44:45]
    v_cndmask_b32 v147, v14, v147, s[46:47]
    v_cndmask_b32 v160, v14, v160, s[40:41]
    v_cndmask_b32 v161, v14, v161, s[42:43]
    v_cndmask_b32 v162, v14, v162, s[44:45]
    v_cndmask_b32 v163, v14, v163, s[46:47]
    s_mov_b32 s62, 0
.kmp_404:
    s_waitcnt vmcnt(0)
    v_max3_u32 v4, v80, v81, v82
    v_max3_u32 v5, v83, v84, v85
    v_max3_u32 v4, v4, v86, v87
    v_max3_u32 v5, v5, v88, v89
    v_max3_u32 v4, v4, v90, v91
    v_max3_u32 v5, v5, v92, v93
    v_max3_u32 v4, v4, v94, v95
    v_max3_u32 v5, v5, v128, v129
    v_max3_u32 v4, v4, v130, v131
    v_max3_u32 v5, v5, v132, v133
    v_max3_u32 v4, v4, v134, v135
    v_max3_u32 v5, v5, v136, v137
    v_max3_u32 v4, v4, v138, v139
    v_max3_u32 v5, v5, v140, v141
    v_max3_u32 v4, v4, v142, v143
    v_max_u32 v4, v4, v5
    v_cmp_eq_u32 vcc, -1, v4
    s_cbranch_vccz .kmd_405
    s_sleep 2

    buffer_load_dwordx4 v[80:83], v10, s[8:11], s33 offen offset:2048 sc1
    buffer_load_dwordx4 v[84:87], v10, s[8:11], s33 offen offset:2176 sc1
    buffer_load_dwordx4 v[88:91], v10, s[8:11], s33 offen offset:3072 sc1
    buffer_load_dwordx4 v[92:95], v10, s[8:11], s33 offen offset:3200 sc1
    s_mov_b64 exec, s[60:61]
    buffer_load_dwordx2 v[128:129], v11, s[8:11], s34 offen offset:0 sc1
    buffer_load_dwordx2 v[130:131], v11, s[8:11], s34 offen offset:256 sc1
    buffer_load_dwordx2 v[132:133], v11, s[8:11], s34 offen offset:512 sc1
    buffer_load_dwordx2 v[134:135], v11, s[8:11], s34 offen offset:768 sc1
    buffer_load_dwordx2 v[136:137], v11, s[8:11], s34 offen offset:1024 sc1
    buffer_load_dwordx2 v[138:139], v11, s[8:11], s34 offen offset:1280 sc1
    buffer_load_dwordx2 v[140:141], v11, s[8:11], s34 offen offset:1536 sc1
    buffer_load_dwordx2 v[142:143], v11, s[8:11], s34 offen offset:1792 sc1
    s_mov_b64 exec, -1
    s_add_u32 s62, s62, 1
    s_cmp_gt_u32 s62, 0x200000
    s_cbranch_scc1 .mg_end_1
    s_branch .kmp_404

.kmd_405:
    v_mfma_f32_16x16x32_bf16 v[152:155], v[80:83], v[16:19], 0
    v_mfma_f32_16x16x32_bf16 v[164:167], v[80:83], v[32:35], 0
    v_mfma_f32_16x16x32_bf16 v[152:155], v[84:87], v[20:23], v[152:155]
    v_mfma_f32_16x16x32_bf16 v[164:167], v[84:87], v[36:39], v[164:167]
    v_mfma_f32_16x16x32_bf16 v[152:155], v[88:91], v[24:27], v[152:155]
    v_mfma_f32_16x16x32_bf16 v[164:167], v[88:91], v[40:43], v[164:167]
    v_mfma_f32_16x16x32_bf16 v[152:155], v[92:95], v[28:31], v[152:155]
    v_mfma_f32_16x16x32_bf16 v[164:167], v[92:95], v[44:47], v[164:167]
    s_nop 5
    v_cvt_pk_bf16_f32 v176, v152, v153
    v_cvt_pk_bf16_f32 v178, v154, v155
    v_and_b32 v177, 0xffff0000, v176
    v_lshlrev_b32 v176, 16, v176
    v_and_b32 v179, 0xffff0000, v178
    v_lshlrev_b32 v178, 16, v178
    v_mul_f32 v176, s37, v176
    v_mul_f32 v177, s37, v177
    v_mul_f32 v178, s37, v178
    v_mul_f32 v179, s37, v179
    v_cvt_pk_bf16_f32 v152, v176, v177
    v_cvt_pk_bf16_f32 v154, v178, v179
    v_and_b32 v153, 0xffff0000, v152
    v_lshlrev_b32 v152, 16, v152
    v_and_b32 v155, 0xffff0000, v154
    v_lshlrev_b32 v154, 16, v154
    v_cndmask_b32 v152, v14, v152, s[60:61]
    v_cndmask_b32 v153, v14, v153, s[60:61]
    v_cndmask_b32 v154, v14, v154, s[60:61]
    v_cndmask_b32 v155, v14, v155, s[60:61]
    v_cvt_pk_bf16_f32 v200, v164, v165
    v_cvt_pk_bf16_f32 v202, v166, v167
    v_and_b32 v201, 0xffff0000, v200
    v_lshlrev_b32 v200, 16, v200
    v_and_b32 v203, 0xffff0000, v202
    v_lshlrev_b32 v202, 16, v202
    v_mul_f32 v200, s37, v200
    v_mul_f32 v201, s37, v201
    v_mul_f32 v202, s37, v202
    v_mul_f32 v203, s37, v203
    v_cvt_pk_bf16_f32 v164, v200, v201
    v_cvt_pk_bf16_f32 v166, v202, v203
    v_and_b32 v165, 0xffff0000, v164
    v_lshlrev_b32 v164, 16, v164
    v_and_b32 v167, 0xffff0000, v166
    v_lshlrev_b32 v166, 16, v166
    v_cndmask_b32 v164, v14, v164, s[60:61]
    v_cndmask_b32 v165, v14, v165, s[60:61]
    v_cndmask_b32 v166, v14, v166, s[60:61]
    v_cndmask_b32 v167, v14, v167, s[60:61]
    v_max3_f32 v4, v144, v145, v146
    v_max3_f32 v5, v147, v152, v153
    v_max3_f32 v4, v4, v154, v155
    v_max_f32 v4, v4, v5

    v_max3_f32 v6, v156, v157, v158
    v_max3_f32 v7, v159, v160, v161
    v_max3_f32 v6, v6, v162, v163
    v_max3_f32 v7, v7, v164, v165
    v_max3_f32 v6, v6, v166, v167
    v_max_f32 v6, v6, v7

    v_mov_b32 v5, v4
    v_mov_b32 v7, v6
    s_nop 0
    v_permlane32_swap_b32 v4, v5
    v_permlane32_swap_b32 v6, v7
    v_max_f32 v4, v4, v5
    v_max_f32 v6, v6, v7

    v_mov_b32 v5, v4
    v_mov_b32 v7, v6
    s_nop 0
    v_permlane16_swap_b32 v4, v5
    v_permlane16_swap_b32 v6, v7
    v_max_f32 v4, v4, v5
    v_max_f32 v6, v6, v7

    v_mul_f32 v4, s38, v4
    v_mul_f32 v6, s38, v6
    v_fma_f32 v168, v144, s38, -v4
    v_fma_f32 v169, v145, s38, -v4
    v_fma_f32 v170, v146, s38, -v4
    v_fma_f32 v171, v147, s38, -v4
    v_fma_f32 v176, v152, s38, -v4
    v_fma_f32 v177, v153, s38, -v4
    v_fma_f32 v178, v154, s38, -v4
    v_fma_f32 v179, v155, s38, -v4
    v_fma_f32 v192, v156, s38, -v6
    v_fma_f32 v193, v157, s38, -v6
    v_fma_f32 v194, v158, s38, -v6
    v_fma_f32 v195, v159, s38, -v6
    v_fma_f32 v196, v160, s38, -v6
    v_fma_f32 v197, v161, s38, -v6
    v_fma_f32 v198, v162, s38, -v6
    v_fma_f32 v199, v163, s38, -v6
    v_fma_f32 v200, v164, s38, -v6
    v_fma_f32 v201, v165, s38, -v6
    v_fma_f32 v202, v166, s38, -v6
    v_fma_f32 v203, v167, s38, -v6
    v_exp_f32 v168, v168
    v_exp_f32 v169, v169
    v_exp_f32 v170, v170
    v_exp_f32 v171, v171
    v_exp_f32 v176, v176
    v_exp_f32 v177, v177
    v_exp_f32 v178, v178
    v_exp_f32 v179, v179
    v_exp_f32 v192, v192
    v_exp_f32 v193, v193
    v_exp_f32 v194, v194
    v_exp_f32 v195, v195
    v_exp_f32 v196, v196
    v_exp_f32 v197, v197
    v_exp_f32 v198, v198
    v_exp_f32 v199, v199
    v_exp_f32 v200, v200
    v_exp_f32 v201, v201
    v_exp_f32 v202, v202
    v_exp_f32 v203, v203
    v_add_f32 v4, v168, v169
    v_add_f32 v5, v170, v171
    v_add_f32 v4, v4, v176
    v_add_f32 v5, v5, v177
    v_add_f32 v4, v4, v178
    v_add_f32 v5, v5, v179
    v_add_f32 v4, v4, v5
    v_add_f32 v6, v192, v193
    v_add_f32 v7, v194, v195
    v_add_f32 v6, v6, v196
    v_add_f32 v7, v7, v197
    v_add_f32 v6, v6, v198
    v_add_f32 v7, v7, v199
    v_add_f32 v6, v6, v200
    v_add_f32 v7, v7, v201
    v_add_f32 v6, v6, v202
    v_add_f32 v7, v7, v203
    v_add_f32 v6, v6, v7
    v_mov_b32 v5, v4
    v_mov_b32 v7, v6
    s_nop 0
    v_permlane32_swap_b32 v4, v5
    v_permlane32_swap_b32 v6, v7
    v_add_f32 v4, v4, v5
    v_add_f32 v6, v6, v7

    v_mov_b32 v5, v4
    v_mov_b32 v7, v6
    s_nop 0
    v_permlane16_swap_b32 v4, v5
    v_permlane16_swap_b32 v6, v7
    v_add_f32 v4, v4, v5
    v_add_f32 v6, v6, v7

    v_rcp_f32 v4, v4
    v_rcp_f32 v6, v6
    v_mov_b32 v182, 0
    v_mov_b32 v183, 0
    v_mul_f32 v168, v4, v168
    v_mul_f32 v169, v4, v169
    v_mul_f32 v170, v4, v170
    v_mul_f32 v171, v4, v171
    v_mul_f32 v176, v4, v176
    v_mul_f32 v177, v4, v177
    v_mul_f32 v178, v4, v178
    v_mul_f32 v179, v4, v179
    v_cvt_pk_bf16_f32 v180, v168, v169
    v_cvt_pk_bf16_f32 v181, v170, v171
    v_cvt_pk_bf16_f32 v184, v176, v177
    v_cvt_pk_bf16_f32 v185, v178, v179
    v_mul_f32 v192, v6, v192
    v_mul_f32 v193, v6, v193
    v_mul_f32 v194, v6, v194
    v_mul_f32 v195, v6, v195
    v_mul_f32 v196, v6, v196
    v_mul_f32 v197, v6, v197
    v_mul_f32 v198, v6, v198
    v_mul_f32 v199, v6, v199
    v_mul_f32 v200, v6, v200
    v_mul_f32 v201, v6, v201
    v_mul_f32 v202, v6, v202
    v_mul_f32 v203, v6, v203
    v_cvt_pk_bf16_f32 v186, v192, v193
    v_cvt_pk_bf16_f32 v187, v194, v195
    v_cvt_pk_bf16_f32 v188, v196, v197
    v_cvt_pk_bf16_f32 v189, v198, v199
    v_cvt_pk_bf16_f32 v190, v200, v201
    v_cvt_pk_bf16_f32 v191, v202, v203
    s_add_u32 s4, s27, 50331648
    s_add_u32 s5, s28, 50331648
    v_add_u32 v12, 1, v12

    v_mfma_f32_16x16x32_bf16 v[16:19], v[96:99], v[180:183], 0
    v_mfma_f32_16x16x32_bf16 v[20:23], v[100:103], v[180:183], 0
    v_mfma_f32_16x16x32_bf16 v[24:27], v[104:107], v[180:183], 0
    v_mfma_f32_16x16x32_bf16 v[28:31], v[108:111], v[180:183], 0
    v_mfma_f32_16x16x32_bf16 v[32:35], v[112:115], v[180:183], 0
    v_mfma_f32_16x16x32_bf16 v[36:39], v[116:119], v[180:183], 0
    v_mfma_f32_16x16x32_bf16 v[40:43], v[120:123], v[180:183], 0
    v_mfma_f32_16x16x32_bf16 v[44:47], v[124:127], v[180:183], 0
    v_mfma_f32_16x16x32_bf16 v[48:51], v[96:99], v[186:189], 0
    v_mfma_f32_16x16x32_bf16 v[52:55], v[100:103], v[186:189], 0
    v_mfma_f32_16x16x32_bf16 v[56:59], v[104:107], v[186:189], 0
    v_mfma_f32_16x16x32_bf16 v[60:63], v[108:111], v[186:189], 0
    v_mfma_f32_16x16x32_bf16 v[64:67], v[112:115], v[186:189], 0
    v_mfma_f32_16x16x32_bf16 v[68:71], v[116:119], v[186:189], 0
    v_mfma_f32_16x16x32_bf16 v[72:75], v[120:123], v[186:189], 0
    v_mfma_f32_16x16x32_bf16 v[76:79], v[124:127], v[186:189], 0
    v_mfma_f32_16x16x16_bf16 v[16:19], v[128:129], v[184:185], v[16:19]
    v_mfma_f32_16x16x16_bf16 v[20:23], v[130:131], v[184:185], v[20:23]
    v_mfma_f32_16x16x16_bf16 v[24:27], v[132:133], v[184:185], v[24:27]
    v_mfma_f32_16x16x16_bf16 v[28:31], v[134:135], v[184:185], v[28:31]
    v_mfma_f32_16x16x16_bf16 v[32:35], v[136:137], v[184:185], v[32:35]
    v_mfma_f32_16x16x16_bf16 v[36:39], v[138:139], v[184:185], v[36:39]
    v_cvt_pk_bf16_f32 v208, v16, v17
    v_cvt_pk_bf16_f32 v209, v18, v19
    v_cvt_pk_bf16_f32 v210, v20, v21
    v_cvt_pk_bf16_f32 v211, v22, v23
    buffer_store_dwordx4 v[208:211], v8, s[8:11], s4 offen offset:0 sc1
    v_mfma_f32_16x16x16_bf16 v[40:43], v[140:141], v[184:185], v[40:43]
    v_mfma_f32_16x16x16_bf16 v[44:47], v[142:143], v[184:185], v[44:47]
    v_cvt_pk_bf16_f32 v212, v24, v25
    v_cvt_pk_bf16_f32 v213, v26, v27
    v_cvt_pk_bf16_f32 v214, v28, v29
    v_cvt_pk_bf16_f32 v215, v30, v31
    buffer_store_dwordx4 v[212:215], v8, s[8:11], s4 offen offset:1024 sc1
    v_mfma_f32_16x16x16_bf16 v[48:51], v[128:129], v[190:191], v[48:51]
    v_mfma_f32_16x16x16_bf16 v[52:55], v[130:131], v[190:191], v[52:55]
    v_cvt_pk_bf16_f32 v216, v32, v33
    v_cvt_pk_bf16_f32 v217, v34, v35
    v_cvt_pk_bf16_f32 v218, v36, v37
    v_cvt_pk_bf16_f32 v219, v38, v39
    buffer_store_dwordx4 v[216:219], v8, s[8:11], s4 offen offset:2048 sc1
    v_mfma_f32_16x16x16_bf16 v[56:59], v[132:133], v[190:191], v[56:59]
    v_mfma_f32_16x16x16_bf16 v[60:63], v[134:135], v[190:191], v[60:63]
    v_cvt_pk_bf16_f32 v220, v40, v41
    v_cvt_pk_bf16_f32 v221, v42, v43
    v_cvt_pk_bf16_f32 v222, v44, v45
    v_cvt_pk_bf16_f32 v223, v46, v47
    buffer_store_dwordx4 v[220:223], v8, s[8:11], s4 offen offset:3072 sc1
    v_mfma_f32_16x16x16_bf16 v[64:67], v[136:137], v[190:191], v[64:67]
    v_mfma_f32_16x16x16_bf16 v[68:71], v[138:139], v[190:191], v[68:71]
    v_cvt_pk_bf16_f32 v224, v48, v49
    v_cvt_pk_bf16_f32 v225, v50, v51
    v_cvt_pk_bf16_f32 v226, v52, v53
    v_cvt_pk_bf16_f32 v227, v54, v55
    buffer_store_dwordx4 v[224:227], v8, s[8:11], s5 offen offset:0 sc1
    v_mfma_f32_16x16x16_bf16 v[72:75], v[140:141], v[190:191], v[72:75]
    v_mfma_f32_16x16x16_bf16 v[76:79], v[142:143], v[190:191], v[76:79]
    v_cvt_pk_bf16_f32 v228, v56, v57
    v_cvt_pk_bf16_f32 v229, v58, v59
    v_cvt_pk_bf16_f32 v230, v60, v61
    v_cvt_pk_bf16_f32 v231, v62, v63
    buffer_store_dwordx4 v[228:231], v8, s[8:11], s5 offen offset:1024 sc1
    s_nop 3
    v_cvt_pk_bf16_f32 v232, v64, v65
    v_cvt_pk_bf16_f32 v233, v66, v67
    v_cvt_pk_bf16_f32 v234, v68, v69
    v_cvt_pk_bf16_f32 v235, v70, v71
    buffer_store_dwordx4 v[232:235], v8, s[8:11], s5 offen offset:2048 sc1
    v_cvt_pk_bf16_f32 v236, v72, v73
    v_cvt_pk_bf16_f32 v237, v74, v75
    v_cvt_pk_bf16_f32 v238, v76, v77
    v_cvt_pk_bf16_f32 v239, v78, v79
    buffer_store_dwordx4 v[236:239], v8, s[8:11], s5 offen offset:3072 sc1
    s_waitcnt vmcnt(0)
    s_barrier
    s_cmp_lg_u32 s24, 0
    s_cbranch_scc1 .ats_406
    s_mov_b64 exec, 1
    buffer_store_dword v12, v13, s[8:11], s92 offen sc1
    s_mov_b64 exec, -1

.ats_406:
    s_add_u32 s25, s25, 4
    s_cmp_lt_u32 s25, 64
    s_cbranch_scc1 .att_401

.mg_end_1:
    s_endpgm
.section .rodata,"a"
.p2align 6
.amdhsa_kernel mega_kernel
  .amdhsa_next_free_vgpr 512
  .amdhsa_next_free_sgpr 102
  .amdhsa_accum_offset 256
  .amdhsa_group_segment_fixed_size 0
  .amdhsa_kernarg_size 136
  .amdhsa_user_sgpr_count 2
  .amdhsa_user_sgpr_kernarg_segment_ptr 1
  .amdhsa_system_sgpr_workgroup_id_x 1
.end_amdhsa_kernel
```

```asm
; @launch kernel=mega_kernel grid=(256,1,1) block=(256,1,1) lds=163840
.amdgcn_target "amdgcn-amd-amdhsa--gfx950"
.text
.globl mega_kernel
.p2align 8
.type mega_kernel,@function
mega_kernel:
    s_cmp_ge_u32 s2, 256
    s_cbranch_scc1 .mg_end_1
    s_load_dwordx4 s[52:55], s[0:1], 120
    s_getreg_b32 s3, hwreg(HW_REG_XCC_ID)
    v_and_b32 v1, 63, v0
    v_lshrrev_b32 v4, 6, v0
    s_and_b32 s3, s3, 7
    v_readfirstlane_b32 s24, v4
    s_waitcnt lgkmcnt(0)

    s_mov_b32 s8, s54
    s_and_b32 s9, s55, 0xffff
    s_mov_b32 s10, 0x10000000
    s_mov_b32 s11, 0x00020000

    s_mov_b32 s20, s52
    s_and_b32 s21, s53, 0xffff
    s_mov_b32 s22, 0x100
    s_mov_b32 s23, 0x00020000

    s_mov_b32 s100, s54
    s_cmp_lg_u32 s24, 0
    s_cbranch_scc1 .noat_4
    s_mov_b64 exec, 1
    v_mov_b32 v5, 1
    s_lshl_b32 s4, s3, 2
    v_mov_b32 v6, s4
    buffer_atomic_add v5, v6, s[20:23], 0 offen sc0 sc1
    v_mov_b32 v7, 163776
    s_waitcnt vmcnt(0)
    ds_write_b32 v7, v5
    s_waitcnt lgkmcnt(0)
    s_mov_b64 exec, -1

.noat_4:
    s_barrier
    v_mov_b32 v7, 163776
    ds_read_b32 v5, v7
    s_waitcnt lgkmcnt(0)
    v_readfirstlane_b32 s26, v5
    s_mov_b32 s25, s3
    s_mov_b32 s27, 0
    s_mov_b32 s97, 0
    s_and_b32 s26, s26, 31

.mg_role_3:
    s_cmp_ge_u32 s25, 4
    s_cbranch_scc1 .mg_bg_2

    s_load_dwordx8 s[44:51], s[0:1], 64
    s_load_dwordx2 s[40:41], s[0:1], 56
    v_and_b32 v1, 63, v0
    v_and_b32 v2, 15, v1
    v_lshrrev_b32 v3, 4, v1

    s_lshl_b32 s4, s25, 11
    s_lshl_b32 s5, s26, 6
    s_add_u32 s4, s4, s5
    s_lshl_b32 s5, s24, 21
    s_add_u32 s4, s4, s5
    v_lshrrev_b32 v4, 2, v1
    v_and_b32 v5, 3, v1
    v_lshlrev_b32 v5, 4, v5
    v_lshlrev_b32 v6, 13, v4
    v_add_u32 v6, v6, v5
    v_add_u32 v240, s4, v6
    s_lshl_b32 s4, s25, 2
    s_and_b32 s5, s24, 1
    s_lshl_b32 s5, s5, 1
    s_add_u32 s4, s4, s5
    s_lshr_b32 s5, s24, 1
    s_add_u32 s4, s4, s5
    s_lshl_b32 s4, s4, 19
    s_lshl_b32 s5, s26, 6
    s_add_u32 s4, s4, s5
    v_lshlrev_b32 v6, 11, v4
    v_add_u32 v6, v6, v5
    v_add_u32 v241, s4, v6
    s_lshl_b32 s98, s24, 15
    s_waitcnt lgkmcnt(0)

    s_mov_b32 s16, s44
    s_and_b32 s17, s45, 0xffff
    s_mov_b32 s18, 0x800000
    s_mov_b32 s19, 0x00020000

    s_add_u32 m0, s98, 0
    s_mov_b32 s5, 0
    buffer_load_dwordx4 v240, s[16:19], s5 offen  lds

    s_add_u32 m0, s98, 1024
    s_mov_b32 s5, 131072
    buffer_load_dwordx4 v240, s[16:19], s5 offen  lds

    s_add_u32 m0, s98, 2048
    s_mov_b32 s5, 262144
    buffer_load_dwordx4 v240, s[16:19], s5 offen  lds

    s_add_u32 m0, s98, 3072
    s_mov_b32 s5, 393216
    buffer_load_dwordx4 v240, s[16:19], s5 offen  lds

    s_add_u32 m0, s98, 4096
    s_mov_b32 s5, 524288
    buffer_load_dwordx4 v240, s[16:19], s5 offen  lds

    s_add_u32 m0, s98, 5120
    s_mov_b32 s5, 655360
    buffer_load_dwordx4 v240, s[16:19], s5 offen  lds

    s_add_u32 m0, s98, 6144
    s_mov_b32 s5, 786432
    buffer_load_dwordx4 v240, s[16:19], s5 offen  lds

    s_add_u32 m0, s98, 7168
    s_mov_b32 s5, 917504
    buffer_load_dwordx4 v240, s[16:19], s5 offen  lds

    s_add_u32 m0, s98, 8192
    s_mov_b32 s5, 1048576
    buffer_load_dwordx4 v240, s[16:19], s5 offen  lds

    s_add_u32 m0, s98, 9216
    s_mov_b32 s5, 1179648
    buffer_load_dwordx4 v240, s[16:19], s5 offen  lds

    s_add_u32 m0, s98, 10240
    s_mov_b32 s5, 1310720
    buffer_load_dwordx4 v240, s[16:19], s5 offen  lds

    s_add_u32 m0, s98, 11264
    s_mov_b32 s5, 1441792
    buffer_load_dwordx4 v240, s[16:19], s5 offen  lds

    s_add_u32 m0, s98, 12288
    s_mov_b32 s5, 1572864
    buffer_load_dwordx4 v240, s[16:19], s5 offen  lds

    s_add_u32 m0, s98, 13312
    s_mov_b32 s5, 1703936
    buffer_load_dwordx4 v240, s[16:19], s5 offen  lds

    s_add_u32 m0, s98, 14336
    s_mov_b32 s5, 1835008
    buffer_load_dwordx4 v240, s[16:19], s5 offen  lds

    s_add_u32 m0, s98, 15360
    s_mov_b32 s5, 1966080
    buffer_load_dwordx4 v240, s[16:19], s5 offen  lds

    s_mov_b32 s16, s46
    s_and_b32 s17, s47, 0xffff
    s_mov_b32 s18, 0x800000
    s_mov_b32 s19, 0x00020000

    s_add_u32 m0, s98, 16384
    s_mov_b32 s5, 0
    buffer_load_dwordx4 v240, s[16:19], s5 offen  lds

    s_add_u32 m0, s98, 17408
    s_mov_b32 s5, 131072
    buffer_load_dwordx4 v240, s[16:19], s5 offen  lds

    s_add_u32 m0, s98, 18432
    s_mov_b32 s5, 262144
    buffer_load_dwordx4 v240, s[16:19], s5 offen  lds

    s_add_u32 m0, s98, 19456
    s_mov_b32 s5, 393216
    buffer_load_dwordx4 v240, s[16:19], s5 offen  lds

    s_add_u32 m0, s98, 20480
    s_mov_b32 s5, 524288
    buffer_load_dwordx4 v240, s[16:19], s5 offen  lds

    s_add_u32 m0, s98, 21504
    s_mov_b32 s5, 655360
    buffer_load_dwordx4 v240, s[16:19], s5 offen  lds

    s_add_u32 m0, s98, 22528
    s_mov_b32 s5, 786432
    buffer_load_dwordx4 v240, s[16:19], s5 offen  lds

    s_add_u32 m0, s98, 23552
    s_mov_b32 s5, 917504
    buffer_load_dwordx4 v240, s[16:19], s5 offen  lds

    s_add_u32 m0, s98, 24576
    s_mov_b32 s5, 1048576
    buffer_load_dwordx4 v240, s[16:19], s5 offen  lds

    s_add_u32 m0, s98, 25600
    s_mov_b32 s5, 1179648
    buffer_load_dwordx4 v240, s[16:19], s5 offen  lds

    s_add_u32 m0, s98, 26624
    s_mov_b32 s5, 1310720
    buffer_load_dwordx4 v240, s[16:19], s5 offen  lds

    s_add_u32 m0, s98, 27648
    s_mov_b32 s5, 1441792
    buffer_load_dwordx4 v240, s[16:19], s5 offen  lds

    s_add_u32 m0, s98, 28672
    s_mov_b32 s5, 1572864
    buffer_load_dwordx4 v240, s[16:19], s5 offen  lds

    s_add_u32 m0, s98, 29696
    s_mov_b32 s5, 1703936
    buffer_load_dwordx4 v240, s[16:19], s5 offen  lds

    s_add_u32 m0, s98, 30720
    s_mov_b32 s5, 1835008
    buffer_load_dwordx4 v240, s[16:19], s5 offen  lds

    s_add_u32 m0, s98, 31744
    s_mov_b32 s5, 1966080
    buffer_load_dwordx4 v240, s[16:19], s5 offen  lds

    v_and_b32 v243, 7, v0
    v_lshlrev_b32 v243, 2, v243
    buffer_load_dword v242, v243, s[20:23], 0 offen sc1

    s_mov_b32 s12, s40
    s_and_b32 s13, s41, 0xffff
    s_mov_b32 s14, 0x4000
    s_mov_b32 s15, 0x00020000

    v_bfe_u32 v4, v2, 2, 1
    v_lshrrev_b32 v5, 3, v2
    v_lshrrev_b32 v8, 1, v3
    v_and_b32 v9, 1, v3
    v_lshl_add_u32 v6, v5, 3, v4
    v_lshl_add_u32 v6, v8, 4, v6
    v_lshl_add_u32 v6, v9, 2, v6
    v_lshl_add_u32 v7, v5, 2, v4
    v_lshl_add_u32 v7, v8, 3, v7
    v_lshl_add_u32 v7, v9, 4, v7
    v_and_b32 v5, 3, v2
    v_lshlrev_b32 v5, 3, v5
    v_lshl_add_u32 v6, v6, 6, v5
    v_lshl_add_u32 v7, v7, 6, v5
    v_add_u32 v254, s98, v6
    v_add_u32 v255, s98, v7
    v_sub_u32 v252, v254, v5
    v_and_b32 v5, 1, v2
    v_lshl_add_u32 v252, v5, 5, v252
    v_bfe_u32 v5, v2, 1, 1
    v_lshl_add_u32 v252, v5, 3, v252
    s_sub_u32 s101, 0, s100
    s_and_b32 s101, s101, 0x1fffff
    s_add_u32 s101, s101, 100663296

    s_lshr_b32 s79, s26, 2
    s_and_b32 s96, s26, 3
    s_and_b32 s78, s24, 1
    s_lshl_b32 s34, s25, 18
    s_add_u32 s34, s34, 83886080
    v_lshlrev_b32 v14, 4, v1
    s_lshl_b32 s5, s24, 12
    v_add_u32 v8, s5, v14
    v_and_b32 v5, 7, v2
    v_lshrrev_b32 v6, 1, v3
    v_and_b32 v7, 1, v3
    v_lshlrev_b32 v7, 3, v7
    v_lshlrev_b32 v17, 11, v5
    v_lshl_add_u32 v17, v3, 5, v17
    v_lshrrev_b32 v4, 3, v2
    v_lshl_add_u32 v17, v4, 4, v17
    s_lshl_b32 s5, s24, 9
    v_add_u32 v17, s5, v17

    buffer_load_dwordx4 v[20:23], v17, s[12:15], 0 offen offset:0
    buffer_load_dwordx4 v[24:27], v17, s[12:15], 0 offen offset:128
    buffer_load_dwordx4 v[28:31], v17, s[12:15], 0 offen offset:256
    buffer_load_dwordx4 v[32:35], v17, s[12:15], 0 offen offset:384
    v_mov_b32 v188, -1
    v_mov_b32 v189, -1
    v_mov_b32 v190, -1
    v_mov_b32 v191, -1
    s_lshl_b32 s5, s26, 10
    s_add_u32 s5, s5, 32768
    v_add_u32 v235, s5, v14
    s_lshl_b32 s4, s26, 9
    v_and_b32 v4, 31, v1
    v_lshlrev_b32 v236, 4, v4
    v_lshl_add_u32 v236, v6, 14, v236
    v_add_u32 v236, s4, v236
    s_and_b32 s5, s26, 7
    s_lshl_b32 s4, s5, 10
    s_lshr_b32 s5, s26, 3
    s_lshl_b32 s5, s5, 14
    s_add_u32 s4, s4, s5
    s_add_u32 s35, s4, s101
    s_lshl_b32 s5, s25, 16
    v_add_u32 v238, s5, v14
    s_lshl_b32 s4, s25, 3
    s_add_u32 s7, s4, s79
    s_mul_i32 s36, s7, 6144
    s_add_u32 s36, s36, 67108864
    s_cmp_eq_u32 s78, 0
    s_cselect_b64 vcc, -1, 0
    s_lshr_b32 s6, s24, 1
    s_lshl_b32 s4, s6, 16
    s_add_u32 s4, s4, s34
    v_cndmask_b32 v4, v235, v236, vcc
    s_mul_i32 s5, s6, 1048576
    s_lshl_b32 s6, s78, 13
    buffer_store_dwordx4 v[188:191], v4, s[8:11], s4 offen sc1
    s_add_u32 s5, s5, s6
    s_add_u32 s5, s5, s35

    buffer_store_dwordx4 v[188:191], v238, s[8:11], s5 offen sc1
    s_add_u32 s5, s5, 262144
    buffer_store_dwordx4 v[188:191], v238, s[8:11], s5 offen sc1
    s_add_u32 s5, s5, 262144
    s_mul_i32 s4, s96, 3145728
    s_lshl_b32 s5, s24, 10
    s_add_u32 s4, s4, s5
    s_add_u32 s4, s4, s36

    buffer_store_dwordx4 v[188:191], v14, s[8:11], s4 offen offset:2048 sc1
    s_add_u32 s4, s4, 196608
    buffer_store_dwordx4 v[188:191], v14, s[8:11], s4 offen offset:2048 sc1
    s_add_u32 s4, s4, 196608
    buffer_store_dwordx4 v[188:191], v14, s[8:11], s4 offen offset:2048 sc1
    s_add_u32 s4, s4, 196608
    buffer_store_dwordx4 v[188:191], v14, s[8:11], s4 offen offset:2048 sc1
    s_add_u32 s4, s4, 196608
    buffer_store_dwordx4 v[188:191], v14, s[8:11], s4 offen offset:2048 sc1
    s_add_u32 s4, s4, 196608
    buffer_store_dwordx4 v[188:191], v14, s[8:11], s4 offen offset:2048 sc1
    s_add_u32 s4, s4, 196608
    buffer_store_dwordx4 v[188:191], v14, s[8:11], s4 offen offset:2048 sc1
    s_add_u32 s4, s4, 196608
    buffer_store_dwordx4 v[188:191], v14, s[8:11], s4 offen offset:2048 sc1
    s_add_u32 s4, s4, 196608
    buffer_store_dwordx4 v[188:191], v14, s[8:11], s4 offen offset:2048 sc1
    s_add_u32 s4, s4, 196608
    buffer_store_dwordx4 v[188:191], v14, s[8:11], s4 offen offset:2048 sc1
    s_add_u32 s4, s4, 196608
    buffer_store_dwordx4 v[188:191], v14, s[8:11], s4 offen offset:2048 sc1
    s_add_u32 s4, s4, 196608
    buffer_store_dwordx4 v[188:191], v14, s[8:11], s4 offen offset:2048 sc1
    s_add_u32 s4, s4, 196608
    buffer_store_dwordx4 v[188:191], v14, s[8:11], s4 offen offset:2048 sc1
    s_add_u32 s4, s4, 196608
    buffer_store_dwordx4 v[188:191], v14, s[8:11], s4 offen offset:2048 sc1
    s_add_u32 s4, s4, 196608
    buffer_store_dwordx4 v[188:191], v14, s[8:11], s4 offen offset:2048 sc1
    s_add_u32 s4, s4, 196608
    buffer_store_dwordx4 v[188:191], v14, s[8:11], s4 offen offset:2048 sc1
    s_add_u32 s4, s4, 196608
    s_lshl_b32 s4, s79, 12
    s_add_u32 s4, s4, 32768

    s_add_u32 s5, s96, 1
    s_and_b32 s5, s5, 3
    s_lshl_b32 s5, s5, 10
    s_add_u32 s5, s5, s4
    v_add_u32 v232, s5, v14

    s_add_u32 s5, s96, 2
    s_and_b32 s5, s5, 3
    s_lshl_b32 s5, s5, 10
    s_add_u32 s5, s5, s4
    v_add_u32 v233, s5, v14

    s_add_u32 s5, s96, 3
    s_and_b32 s5, s5, 3
    s_lshl_b32 s5, s5, 10
    s_add_u32 s5, s5, s4
    v_add_u32 v234, s5, v14

    s_lshl_b32 s5, s78, 9
    v_lshlrev_b32 v10, 8, v6
    v_lshl_add_u32 v10, v2, 4, v10
    v_add_u32 v10, v10, v7
    v_add_u32 v10, s5, v10
    v_add_u32 v18, 16384, v10
    s_lshl_b32 s5, s26, 10
    s_add_u32 s5, s5, 32768
    v_add_u32 v10, s5, v10
    v_lshlrev_b32 v11, 8, v3
    v_lshl_add_u32 v11, v5, 4, v11
    s_lshr_b32 s4, s96, 1
    s_lshl_b32 s4, s4, 10
    s_and_b32 s5, s96, 1
    s_lshl_b32 s5, s5, 7
    s_add_u32 s4, s4, s5
    s_add_u32 s4, s4, 2048
    v_add_u32 v11, s4, v11
    v_lshlrev_b32 v12, 8, v6
    v_lshl_add_u32 v12, v2, 4, v12
    s_lshl_b32 s4, s96, 9
    s_add_u32 s4, s4, 4096
    v_add_u32 v12, s4, v12
    s_lshl_b32 s4, s26, 9
    v_lshlrev_b32 v13, 7, v3
    v_lshl_add_u32 v13, v5, 4, v13
    v_add_u32 v13, s4, v13
    v_add_u32 v13, 16384, v13
    v_lshlrev_b32 v15, 7, v6
    v_lshl_add_u32 v15, v5, 4, v15
    v_add_u32 v15, v15, v7
    s_lshl_b32 s5, s78, 8
    s_add_u32 s5, s5, s4
    v_add_u32 v15, s5, v15
    v_lshlrev_b32 v16, 8, v6
    v_lshl_add_u32 v16, v2, 4, v16
    v_add_u32 v16, v16, v7
    s_lshl_b32 s5, s24, 9
    v_add_u32 v16, s5, v16
    s_lshl_b32 s5, s24, 11
    v_add_u32 v17, s5, v14
    v_cmp_gt_u32 s[58:59], 8, v2
    v_cmp_gt_u32 s[60:61], 32, v1
    v_mov_b32 v4, 0x4444
    v_mov_b32 v9, 0xeeee
    v_cndmask_b32 v9, v9, v4, s[58:59]
    s_not_b64 s[66:67], s[58:59]
    s_cmp_lt_u32 s24, 2
    s_cselect_b64 s[64:65], s[66:67], s[58:59]
    s_mov_b32 s56, 0x0000ffff
    s_mov_b32 s57, 0x0000ffff
    s_cmp_eq_u32 s24, 1
    s_cselect_b64 vcc, -1, 0
    s_cselect_b64 s[66:67], s[56:57], s[66:67]
    s_lshl_b32 s5, s78, 10
    v_add_u32 v19, s5, v14
    v_cndmask_b32 v11, v11, v12, vcc
    v_cndmask_b32 v235, v235, v236, vcc
    v_mov_b32 v4, 0xff800000
    v_cndmask_b32 v116, 0, v4, s[60:61]
    v_mov_b32 v117, v116
    v_mov_b32 v118, v116
    v_mov_b32 v119, v116
    s_lshl_b32 s5, s78, 13
    v_add_u32 v246, s5, v14
    v_lshlrev_b32 v247, 9, v6
    v_lshl_add_u32 v247, v2, 4, v247
    s_lshl_b32 s5, s78, 8
    s_add_u32 s5, s5, 12288
    v_add_u32 v247, s5, v247
    v_and_b32 v4, 31, v1
    v_lshlrev_b32 v248, 4, v4
    s_lshl_b32 s5, s78, 9
    s_add_u32 s5, s5, 12288
    v_add_u32 v248, s5, v248
    s_lshl_b32 s5, s25, 16
    v_and_b32 v7, 1, v3
    v_lshlrev_b32 v237, 18, v7
    v_lshl_add_u32 v237, v6, 8, v237
    v_lshl_add_u32 v237, v2, 4, v237
    v_add_u32 v237, s5, v237
    s_lshl_b32 s6, s78, 9
    v_add_u32 v237, s6, v237
    s_lshl_b32 s6, s78, 8
    v_lshlrev_b32 v249, 9, v7
    v_lshl_add_u32 v249, v2, 4, v249
    v_add_u32 v249, s6, v249
    v_add_u32 v4, s25, v6
    v_add_u32 v4, 1, v4
    v_and_b32 v4, 3, v4
    v_lshl_add_u32 v239, v4, 16, v249
    s_add_u32 s6, s25, 3
    s_and_b32 s6, s6, 3
    s_lshl_b32 s6, s6, 16
    v_add_u32 v249, s6, v249
    v_and_b32 v4, 1, v5
    v_lshlrev_b32 v4, 4, v4
    v_mov_b32 v6, 0x3f80
    v_lshlrev_b32 v6, v4, v6
    v_lshrrev_b32 v4, 1, v5

    v_cmp_eq_u32 vcc, 0, v4
    s_nop 1
    v_cndmask_b32 v84, 0, v6, vcc
    v_cmp_eq_u32 vcc, 1, v4
    s_nop 1
    v_cndmask_b32 v85, 0, v6, vcc
    v_cmp_eq_u32 vcc, 2, v4
    s_nop 1
    v_cndmask_b32 v86, 0, v6, vcc
    v_cmp_eq_u32 vcc, 3, v4
    s_nop 1
    v_cndmask_b32 v87, 0, v6, vcc
    v_mov_b32 v120, 0x3f803f80
    v_cndmask_b32 v112, 0, v84, s[60:61]
    v_mov_b32 v121, 0x3f803f80
    v_cndmask_b32 v113, 0, v85, s[60:61]
    v_mov_b32 v122, 0x3f803f80
    v_cndmask_b32 v114, 0, v86, s[60:61]
    v_mov_b32 v123, 0x3f803f80
    v_cndmask_b32 v115, 0, v87, s[60:61]
    v_mov_b32 v170, 0
    v_mov_b32 v171, 0
    v_mov_b32 v174, 0
    v_mov_b32 v175, 0
    v_mov_b32 v182, 0
    v_mov_b32 v183, 0
    s_add_u32 s5, s96, 0
    s_and_b32 s5, s5, 3
    s_lshl_b32 s5, s5, 10
    s_add_u32 s5, s5, 20480
    v_add_u32 v228, s5, v14

    s_add_u32 s5, s96, 1
    s_and_b32 s5, s5, 3
    s_lshl_b32 s5, s5, 10
    s_add_u32 s5, s5, 20480
    v_add_u32 v229, s5, v14

    s_add_u32 s5, s96, 2
    s_and_b32 s5, s5, 3
    s_lshl_b32 s5, s5, 10
    s_add_u32 s5, s5, 20480
    v_add_u32 v230, s5, v14

    s_add_u32 s5, s96, 3
    s_and_b32 s5, s5, 3
    s_lshl_b32 s5, s5, 10
    s_add_u32 s5, s5, 20480
    v_add_u32 v231, s5, v14

    s_lshl_b32 s89, s7, 8
    s_add_u32 s89, s89, 92282880
    v_lshlrev_b32 v253, 13, v1
    s_lshl_b32 s4, s7, 13
    s_add_u32 s38, s4, 16777216
    s_lshl_b32 s5, s96, 11
    s_add_u32 s39, s4, s5
    s_add_u32 s30, s39, 17039360
    s_add_u32 s39, s39, 33554432
    s_lshl_b32 s5, s78, 24
    s_add_u32 s30, s30, s5
    s_lshl_b32 s5, s78, 12
    s_add_u32 s38, s38, s5
    s_add_u32 s90, s5, 20480
    s_lshl_b32 s5, s78, 10
    s_add_u32 s39, s39, s5
    s_add_u32 s91, s5, 28672
    s_mov_b32 s37, 0x3e0293ee
    s_mov_b32 s28, 0

    v_and_b32 v4, 31, v1
    v_lshlrev_b32 v225, 6, v4
    v_lshrrev_b32 v4, 5, v1
    v_lshl_add_u32 v225, v4, 24, v225

    v_mov_b32 v52, 0
    v_mov_b32 v53, 0
    v_mov_b32 v54, 0
    v_mov_b32 v55, 0
    v_mov_b32 v56, 0
    v_mov_b32 v57, 0
    v_mov_b32 v58, 0
    v_mov_b32 v59, 0
    v_mov_b32 v60, 0
    v_mov_b32 v61, 0
    v_mov_b32 v62, 0
    v_mov_b32 v63, 0
    v_mov_b32 v64, 0
    v_mov_b32 v65, 0
    v_mov_b32 v66, 0
    v_mov_b32 v67, 0
    v_mov_b32 v68, 0
    v_mov_b32 v69, 0
    v_mov_b32 v70, 0
    v_mov_b32 v71, 0
    v_mov_b32 v72, 0
    v_mov_b32 v73, 0
    v_mov_b32 v74, 0
    v_mov_b32 v75, 0
    v_mov_b32 v76, 0
    v_mov_b32 v77, 0
    v_mov_b32 v78, 0
    v_mov_b32 v79, 0
    v_mov_b32 v80, 0
    v_mov_b32 v81, 0
    v_mov_b32 v82, 0
    v_mov_b32 v83, 0
    v_mov_b32 v92, -1
    v_mov_b32 v93, -1
    v_mov_b32 v94, -1
    v_mov_b32 v95, -1
    v_mov_b32 v96, -1
    v_mov_b32 v97, -1
    v_mov_b32 v98, -1
    v_mov_b32 v99, -1
    v_mov_b32 v100, -1
    v_mov_b32 v101, -1
    v_mov_b32 v102, -1
    v_mov_b32 v103, -1
    v_mov_b32 v192, -1
    v_mov_b32 v193, -1
    v_mov_b32 v194, -1
    v_mov_b32 v195, -1
    v_mov_b32 v196, -1
    v_mov_b32 v197, -1
    v_mov_b32 v198, -1
    v_mov_b32 v199, -1
    v_mov_b32 v200, -1
    v_mov_b32 v201, -1
    v_mov_b32 v202, -1
    v_mov_b32 v203, -1
    v_mov_b32 v204, -1
    v_mov_b32 v205, -1
    v_mov_b32 v206, -1
    v_mov_b32 v207, -1
    v_mov_b32 v208, -1
    v_mov_b32 v209, -1
    v_mov_b32 v210, -1
    v_mov_b32 v211, -1
    v_mov_b32 v212, -1
    v_mov_b32 v213, -1
    v_mov_b32 v214, -1
    v_mov_b32 v215, -1
    v_mov_b32 v216, -1
    v_mov_b32 v217, -1
    v_mov_b32 v218, -1
    v_mov_b32 v219, -1
    v_mov_b32 v220, -1
    v_mov_b32 v221, -1
    v_mov_b32 v222, -1
    v_mov_b32 v223, -1
    s_waitcnt vmcnt(48)
    ds_read_b64_tr_b16 a[0:1], v252 offset:0
    ds_read_b64_tr_b16 a[2:3], v252 offset:128
    ds_read_b64_tr_b16 a[4:5], v252 offset:2048
    ds_read_b64_tr_b16 a[6:7], v252 offset:2176
    ds_read_b64_tr_b16 a[8:9], v252 offset:4096
    ds_read_b64_tr_b16 a[10:11], v252 offset:4224
    ds_read_b64_tr_b16 a[12:13], v252 offset:6144
    ds_read_b64_tr_b16 a[14:15], v252 offset:6272
    ds_read_b64_tr_b16 a[32:33], v252 offset:16
    ds_read_b64_tr_b16 a[34:35], v252 offset:144
    ds_read_b64_tr_b16 a[36:37], v252 offset:2064
    ds_read_b64_tr_b16 a[38:39], v252 offset:2192
    ds_read_b64_tr_b16 a[40:41], v252 offset:4112
    ds_read_b64_tr_b16 a[42:43], v252 offset:4240
    ds_read_b64_tr_b16 a[44:45], v252 offset:6160
    ds_read_b64_tr_b16 a[46:47], v252 offset:6288
    s_waitcnt lgkmcnt(0)
    s_mov_b32 s16, s48
    s_and_b32 s17, s49, 0xffff
    s_mov_b32 s18, 0x800000
    s_mov_b32 s19, 0x00020000

    s_add_u32 m0, s98, 0
    s_mov_b32 s5, 0
    buffer_load_dwordx4 v240, s[16:19], s5 offen  lds

    s_add_u32 m0, s98, 1024
    s_mov_b32 s5, 131072
    buffer_load_dwordx4 v240, s[16:19], s5 offen  lds

    s_add_u32 m0, s98, 2048
    s_mov_b32 s5, 262144
    buffer_load_dwordx4 v240, s[16:19], s5 offen  lds

    s_add_u32 m0, s98, 3072
    s_mov_b32 s5, 393216
    buffer_load_dwordx4 v240, s[16:19], s5 offen  lds

    s_add_u32 m0, s98, 4096
    s_mov_b32 s5, 524288
    buffer_load_dwordx4 v240, s[16:19], s5 offen  lds

    s_add_u32 m0, s98, 5120
    s_mov_b32 s5, 655360
    buffer_load_dwordx4 v240, s[16:19], s5 offen  lds

    s_add_u32 m0, s98, 6144
    s_mov_b32 s5, 786432
    buffer_load_dwordx4 v240, s[16:19], s5 offen  lds

    s_add_u32 m0, s98, 7168
    s_mov_b32 s5, 917504
    buffer_load_dwordx4 v240, s[16:19], s5 offen  lds

    s_waitcnt vmcnt(48)
    ds_read_b64_tr_b16 a[16:17], v252 offset:8192
    ds_read_b64_tr_b16 a[18:19], v252 offset:8320
    ds_read_b64_tr_b16 a[20:21], v252 offset:10240
    ds_read_b64_tr_b16 a[22:23], v252 offset:10368
    ds_read_b64_tr_b16 a[24:25], v252 offset:12288
    ds_read_b64_tr_b16 a[26:27], v252 offset:12416
    ds_read_b64_tr_b16 a[28:29], v252 offset:14336
    ds_read_b64_tr_b16 a[30:31], v252 offset:14464
    ds_read_b64_tr_b16 a[48:49], v252 offset:8208
    ds_read_b64_tr_b16 a[50:51], v252 offset:8336
    ds_read_b64_tr_b16 a[52:53], v252 offset:10256
    ds_read_b64_tr_b16 a[54:55], v252 offset:10384
    ds_read_b64_tr_b16 a[56:57], v252 offset:12304
    ds_read_b64_tr_b16 a[58:59], v252 offset:12432
    ds_read_b64_tr_b16 a[60:61], v252 offset:14352
    ds_read_b64_tr_b16 a[62:63], v252 offset:14480
    s_waitcnt lgkmcnt(0)
    s_add_u32 m0, s98, 8192
    s_mov_b32 s5, 1048576
    buffer_load_dwordx4 v240, s[16:19], s5 offen  lds

    s_add_u32 m0, s98, 9216
    s_mov_b32 s5, 1179648
    buffer_load_dwordx4 v240, s[16:19], s5 offen  lds

    s_add_u32 m0, s98, 10240
    s_mov_b32 s5, 1310720
    buffer_load_dwordx4 v240, s[16:19], s5 offen  lds

    s_add_u32 m0, s98, 11264
    s_mov_b32 s5, 1441792
    buffer_load_dwordx4 v240, s[16:19], s5 offen  lds

    s_add_u32 m0, s98, 12288
    s_mov_b32 s5, 1572864
    buffer_load_dwordx4 v240, s[16:19], s5 offen  lds

    s_add_u32 m0, s98, 13312
    s_mov_b32 s5, 1703936
    buffer_load_dwordx4 v240, s[16:19], s5 offen  lds

    s_add_u32 m0, s98, 14336
    s_mov_b32 s5, 1835008
    buffer_load_dwordx4 v240, s[16:19], s5 offen  lds

    s_add_u32 m0, s98, 15360
    s_mov_b32 s5, 1966080
    buffer_load_dwordx4 v240, s[16:19], s5 offen  lds

    s_waitcnt vmcnt(48)
    ds_read_b64_tr_b16 a[64:65], v252 offset:16384
    ds_read_b64_tr_b16 a[66:67], v252 offset:16512
    ds_read_b64_tr_b16 a[68:69], v252 offset:18432
    ds_read_b64_tr_b16 a[70:71], v252 offset:18560
    ds_read_b64_tr_b16 a[72:73], v252 offset:20480
    ds_read_b64_tr_b16 a[74:75], v252 offset:20608
    ds_read_b64_tr_b16 a[76:77], v252 offset:22528
    ds_read_b64_tr_b16 a[78:79], v252 offset:22656
    ds_read_b64_tr_b16 a[96:97], v252 offset:16400
    ds_read_b64_tr_b16 a[98:99], v252 offset:16528
    ds_read_b64_tr_b16 a[100:101], v252 offset:18448
    ds_read_b64_tr_b16 a[102:103], v252 offset:18576
    ds_read_b64_tr_b16 a[104:105], v252 offset:20496
    ds_read_b64_tr_b16 a[106:107], v252 offset:20624
    ds_read_b64_tr_b16 a[108:109], v252 offset:22544
    ds_read_b64_tr_b16 a[110:111], v252 offset:22672
    s_waitcnt lgkmcnt(0)
    s_mov_b32 s16, s50
    s_and_b32 s17, s51, 0xffff
    s_mov_b32 s18, 0x800000
    s_mov_b32 s19, 0x00020000

    s_add_u32 m0, s98, 16384
    s_mov_b32 s5, 0
    buffer_load_dwordx4 v241, s[16:19], s5 offen  lds

    s_add_u32 m0, s98, 17408
    s_mov_b32 s5, 32768
    buffer_load_dwordx4 v241, s[16:19], s5 offen  lds

    s_add_u32 m0, s98, 18432
    s_mov_b32 s5, 65536
    buffer_load_dwordx4 v241, s[16:19], s5 offen  lds

    s_add_u32 m0, s98, 19456
    s_mov_b32 s5, 98304
    buffer_load_dwordx4 v241, s[16:19], s5 offen  lds

    s_add_u32 m0, s98, 20480
    s_mov_b32 s5, 131072
    buffer_load_dwordx4 v241, s[16:19], s5 offen  lds

    s_add_u32 m0, s98, 21504
    s_mov_b32 s5, 163840
    buffer_load_dwordx4 v241, s[16:19], s5 offen  lds

    s_add_u32 m0, s98, 22528
    s_mov_b32 s5, 196608
    buffer_load_dwordx4 v241, s[16:19], s5 offen  lds

    s_add_u32 m0, s98, 23552
    s_mov_b32 s5, 229376
    buffer_load_dwordx4 v241, s[16:19], s5 offen  lds

    s_waitcnt vmcnt(48)
    ds_read_b64_tr_b16 a[80:81], v252 offset:24576
    ds_read_b64_tr_b16 a[82:83], v252 offset:24704
    ds_read_b64_tr_b16 a[84:85], v252 offset:26624
    ds_read_b64_tr_b16 a[86:87], v252 offset:26752
    ds_read_b64_tr_b16 a[88:89], v252 offset:28672
    ds_read_b64_tr_b16 a[90:91], v252 offset:28800
    ds_read_b64_tr_b16 a[92:93], v252 offset:30720
    ds_read_b64_tr_b16 a[94:95], v252 offset:30848
    ds_read_b64_tr_b16 a[112:113], v252 offset:24592
    ds_read_b64_tr_b16 a[114:115], v252 offset:24720
    ds_read_b64_tr_b16 a[116:117], v252 offset:26640
    ds_read_b64_tr_b16 a[118:119], v252 offset:26768
    ds_read_b64_tr_b16 a[120:121], v252 offset:28688
    ds_read_b64_tr_b16 a[122:123], v252 offset:28816
    ds_read_b64_tr_b16 a[124:125], v252 offset:30736
    ds_read_b64_tr_b16 a[126:127], v252 offset:30864
    s_waitcnt lgkmcnt(0)
    s_add_u32 m0, s98, 24576
    s_mov_b32 s5, 262144
    buffer_load_dwordx4 v241, s[16:19], s5 offen  lds

    s_add_u32 m0, s98, 25600
    s_mov_b32 s5, 294912
    buffer_load_dwordx4 v241, s[16:19], s5 offen  lds

    s_add_u32 m0, s98, 26624
    s_mov_b32 s5, 327680
    buffer_load_dwordx4 v241, s[16:19], s5 offen  lds

    s_add_u32 m0, s98, 27648
    s_mov_b32 s5, 360448
    buffer_load_dwordx4 v241, s[16:19], s5 offen  lds

    s_add_u32 m0, s98, 28672
    s_mov_b32 s5, 393216
    buffer_load_dwordx4 v241, s[16:19], s5 offen  lds

    s_add_u32 m0, s98, 29696
    s_mov_b32 s5, 425984
    buffer_load_dwordx4 v241, s[16:19], s5 offen  lds

    s_add_u32 m0, s98, 30720
    s_mov_b32 s5, 458752
    buffer_load_dwordx4 v241, s[16:19], s5 offen  lds

    s_add_u32 m0, s98, 31744
    s_mov_b32 s5, 491520
    buffer_load_dwordx4 v241, s[16:19], s5 offen  lds

    s_waitcnt vmcnt(24)
    ds_read_b64_tr_b16 a[128:129], v254 offset:0
    ds_read_b64_tr_b16 a[130:131], v254 offset:128
    ds_read_b64_tr_b16 a[132:133], v254 offset:2048
    ds_read_b64_tr_b16 a[134:135], v254 offset:2176
    ds_read_b64_tr_b16 a[136:137], v254 offset:4096
    ds_read_b64_tr_b16 a[138:139], v254 offset:4224
    ds_read_b64_tr_b16 a[140:141], v254 offset:6144
    ds_read_b64_tr_b16 a[142:143], v254 offset:6272
    ds_read_b64_tr_b16 a[160:161], v254 offset:32
    ds_read_b64_tr_b16 a[162:163], v254 offset:160
    ds_read_b64_tr_b16 a[164:165], v254 offset:2080
    ds_read_b64_tr_b16 a[166:167], v254 offset:2208
    ds_read_b64_tr_b16 a[168:169], v254 offset:4128
    ds_read_b64_tr_b16 a[170:171], v254 offset:4256
    ds_read_b64_tr_b16 a[172:173], v254 offset:6176
    ds_read_b64_tr_b16 a[174:175], v254 offset:6304
    s_cmp_lg_u32 s97, 0
    s_cbranch_scc1 .vd_7
    s_mov_b32 s62, 0

.vp_6:
    v_cmp_ne_u32 vcc, 32, v242
    s_cbranch_vccz .vd_7
    v_readlane_b32 s4, v242, 0

    v_readlane_b32 s5, v242, 1
    s_add_u32 s4, s4, s5
    v_readlane_b32 s5, v242, 2
    s_add_u32 s4, s4, s5
    v_readlane_b32 s5, v242, 3
    s_add_u32 s4, s4, s5
    v_readlane_b32 s5, v242, 4
    s_add_u32 s4, s4, s5
    v_readlane_b32 s5, v242, 5
    s_add_u32 s4, s4, s5
    v_readlane_b32 s5, v242, 6
    s_add_u32 s4, s4, s5
    v_readlane_b32 s5, v242, 7
    s_add_u32 s4, s4, s5
    s_cmp_ge_u32 s4, 256
    s_cbranch_scc1 .vs_8
    s_add_u32 s62, s62, 1
    s_cmp_gt_u32 s62, 0x100000
    s_cbranch_scc1 .mg_end_1
    s_sleep 4
    buffer_load_dword v242, v243, s[20:23], 0 offen sc1
    s_waitcnt vmcnt(0)
    s_branch .vp_6

.vs_8:
    s_lshr_b32 s25, s2, 5
    s_and_b32 s26, s2, 31
    s_mov_b32 s27, 1
    s_mov_b32 s97, 1
    s_waitcnt vmcnt(0) lgkmcnt(0)
    s_barrier
    s_branch .mg_role_3

.vd_7:
    s_mov_b32 s97, 1
    s_barrier
    s_cmp_lg_u32 s24, 3
    s_cbranch_scc1 .sg_9
    s_mov_b64 exec, 1
    v_mov_b32 v4, 1
    v_mov_b32 v5, 32
    buffer_atomic_add v4, v5, s[20:23], 0 offen sc1
    s_mov_b64 exec, -1

.sg_9:
    v_min_u32 v20, 0xfffffffe, v20
    v_min_u32 v21, 0xfffffffe, v21
    v_min_u32 v22, 0xfffffffe, v22
    v_min_u32 v23, 0xfffffffe, v23
    v_min_u32 v24, 0xfffffffe, v24
    v_min_u32 v25, 0xfffffffe, v25
    v_min_u32 v26, 0xfffffffe, v26
    v_min_u32 v27, 0xfffffffe, v27
    v_min_u32 v28, 0xfffffffe, v28
    v_min_u32 v29, 0xfffffffe, v29
    v_min_u32 v30, 0xfffffffe, v30
    v_min_u32 v31, 0xfffffffe, v31
    v_min_u32 v32, 0xfffffffe, v32
    v_min_u32 v33, 0xfffffffe, v33
    v_min_u32 v34, 0xfffffffe, v34
    v_min_u32 v35, 0xfffffffe, v35
    s_waitcnt vmcnt(16)
    ds_read_b64_tr_b16 a[144:145], v254 offset:8192
    ds_read_b64_tr_b16 a[146:147], v254 offset:8320
    ds_read_b64_tr_b16 a[148:149], v254 offset:10240
    ds_read_b64_tr_b16 a[150:151], v254 offset:10368
    ds_read_b64_tr_b16 a[152:153], v254 offset:12288
    ds_read_b64_tr_b16 a[154:155], v254 offset:12416
    ds_read_b64_tr_b16 a[156:157], v254 offset:14336
    ds_read_b64_tr_b16 a[158:159], v254 offset:14464
    ds_read_b64_tr_b16 a[176:177], v254 offset:8224
    ds_read_b64_tr_b16 a[178:179], v254 offset:8352
    ds_read_b64_tr_b16 a[180:181], v254 offset:10272
    ds_read_b64_tr_b16 a[182:183], v254 offset:10400
    ds_read_b64_tr_b16 a[184:185], v254 offset:12320
    ds_read_b64_tr_b16 a[186:187], v254 offset:12448
    ds_read_b64_tr_b16 a[188:189], v254 offset:14368
    ds_read_b64_tr_b16 a[190:191], v254 offset:14496
    s_waitcnt vmcnt(8)
    ds_read_b64_tr_b16 a[192:193], v255 offset:16384
    ds_read_b64_tr_b16 a[194:195], v255 offset:16512
    ds_read_b64_tr_b16 a[196:197], v255 offset:18432
    ds_read_b64_tr_b16 a[198:199], v255 offset:18560
    ds_read_b64_tr_b16 a[200:201], v255 offset:20480
    ds_read_b64_tr_b16 a[202:203], v255 offset:20608
    ds_read_b64_tr_b16 a[204:205], v255 offset:22528
    ds_read_b64_tr_b16 a[206:207], v255 offset:22656
    ds_read_b64_tr_b16 a[224:225], v255 offset:16416
    ds_read_b64_tr_b16 a[226:227], v255 offset:16544
    ds_read_b64_tr_b16 a[228:229], v255 offset:18464
    ds_read_b64_tr_b16 a[230:231], v255 offset:18592
    ds_read_b64_tr_b16 a[232:233], v255 offset:20512
    ds_read_b64_tr_b16 a[234:235], v255 offset:20640
    ds_read_b64_tr_b16 a[236:237], v255 offset:22560
    ds_read_b64_tr_b16 a[238:239], v255 offset:22688
    s_waitcnt vmcnt(0)
    ds_read_b64_tr_b16 a[208:209], v255 offset:24576
    ds_read_b64_tr_b16 a[210:211], v255 offset:24704
    ds_read_b64_tr_b16 a[212:213], v255 offset:26624
    ds_read_b64_tr_b16 a[214:215], v255 offset:26752
    ds_read_b64_tr_b16 a[216:217], v255 offset:28672
    ds_read_b64_tr_b16 a[218:219], v255 offset:28800
    ds_read_b64_tr_b16 a[220:221], v255 offset:30720
    ds_read_b64_tr_b16 a[222:223], v255 offset:30848
    ds_read_b64_tr_b16 a[240:241], v255 offset:24608
    ds_read_b64_tr_b16 a[242:243], v255 offset:24736
    ds_read_b64_tr_b16 a[244:245], v255 offset:26656
    ds_read_b64_tr_b16 a[246:247], v255 offset:26784
    ds_read_b64_tr_b16 a[248:249], v255 offset:28704
    ds_read_b64_tr_b16 a[250:251], v255 offset:28832
    ds_read_b64_tr_b16 a[252:253], v255 offset:30752
    ds_read_b64_tr_b16 a[254:255], v255 offset:30880
    s_barrier
    s_cmp_ge_u32 s24, 2
    s_cbranch_scc1 .px_10
    v_xor_b32 v255, 0x10000, v255
    ds_read_b64_tr_b16 v[124:125], v255 offset:16384
    ds_read_b64_tr_b16 v[126:127], v255 offset:16512
    ds_read_b64_tr_b16 v[128:129], v255 offset:18432
    ds_read_b64_tr_b16 v[130:131], v255 offset:18560
    ds_read_b64_tr_b16 v[132:133], v255 offset:20480
    ds_read_b64_tr_b16 v[134:135], v255 offset:20608
    ds_read_b64_tr_b16 v[136:137], v255 offset:22528
    ds_read_b64_tr_b16 v[138:139], v255 offset:22656
    ds_read_b64_tr_b16 v[156:157], v255 offset:16416
    ds_read_b64_tr_b16 v[158:159], v255 offset:16544
    ds_read_b64_tr_b16 v[160:161], v255 offset:18464
    ds_read_b64_tr_b16 v[162:163], v255 offset:18592
    ds_read_b64_tr_b16 v[164:165], v255 offset:20512
    ds_read_b64_tr_b16 v[166:167], v255 offset:20640
    ds_read_b64_tr_b16 v[168:169], v255 offset:22560
    ds_read_b64_tr_b16 v[170:171], v255 offset:22688
    ds_read_b64_tr_b16 v[140:141], v255 offset:24576
    ds_read_b64_tr_b16 v[142:143], v255 offset:24704
    ds_read_b64_tr_b16 v[144:145], v255 offset:26624
    ds_read_b64_tr_b16 v[146:147], v255 offset:26752
    ds_read_b64_tr_b16 v[148:149], v255 offset:28672
    ds_read_b64_tr_b16 v[150:151], v255 offset:28800
    ds_read_b64_tr_b16 v[152:153], v255 offset:30720
    ds_read_b64_tr_b16 v[154:155], v255 offset:30848
    ds_read_b64_tr_b16 v[172:173], v255 offset:24608
    ds_read_b64_tr_b16 v[174:175], v255 offset:24736
    ds_read_b64_tr_b16 v[176:177], v255 offset:26656
    ds_read_b64_tr_b16 v[178:179], v255 offset:26784
    ds_read_b64_tr_b16 v[180:181], v255 offset:28704
    ds_read_b64_tr_b16 v[182:183], v255 offset:28832
    ds_read_b64_tr_b16 v[184:185], v255 offset:30752
    ds_read_b64_tr_b16 v[186:187], v255 offset:30880
    s_branch .py_11
.px_10:
    s_cmp_eq_u32 s24, 2
    s_cbranch_scc1 .py_11
    s_mov_b32 s62, 0
    v_mov_b32 v6, 32
.pp_12:
    buffer_load_dwordx2 v[4:5], v6, s[20:23], 0 offen sc1
    s_add_u32 s62, s62, 1
    s_cmp_gt_u32 s62, 0x400000
    s_cbranch_scc1 .mg_end_1
    s_waitcnt vmcnt(0)
    v_readfirstlane_b32 s4, v4
    v_readfirstlane_b32 s5, v5
    s_lshr_b32 s5, s5, 21
    s_min_u32 s4, s4, s5
    s_cmp_lt_u32 s4, 256
    s_cbranch_scc1 .pp_12
    v_mov_b32 v4, 163808
    ds_write_b32 v4, v5

.py_11:
    s_waitcnt lgkmcnt(0)
    s_barrier
    v_mov_b32 v4, 163808
    ds_read_b32 v4, v4
    s_waitcnt lgkmcnt(0)
    v_readfirstlane_b32 s7, v4

    s_bfe_u32 s4, s7, 393216
    s_cmp_gt_u32 s4, 8
    s_cselect_b32 s4, 8192, 0
    s_add_u32 s4, s4, s35
    s_add_u32 s68, s4, 0

    s_bfe_u32 s4, s7, 393216
    s_cmp_gt_u32 s4, 8
    s_cselect_b32 s4, 8192, 0
    s_add_u32 s4, s4, s35
    s_add_u32 s69, s4, 1048576

    s_bfe_u32 s4, s7, 393222
    s_cmp_gt_u32 s4, 8
    s_cselect_b32 s4, 8192, 0
    s_add_u32 s4, s4, s35
    s_add_u32 s70, s4, 2097152

    s_bfe_u32 s4, s7, 393222
    s_cmp_gt_u32 s4, 8
    s_cselect_b32 s4, 8192, 0
    s_add_u32 s4, s4, s35
    s_add_u32 s71, s4, 3145728

    s_mov_b32 s62, 0x1000000
    s_cmp_ge_u32 s24, 2
    s_cbranch_scc1 .nd_13
    s_mov_b32 s62, 0
    s_mov_b64 exec, 3
.wf_14:
    buffer_load_dword v244, v253, s[8:11], s89 offen sc1
    s_waitcnt vmcnt(0)
    v_cmp_gt_u32 vcc, 1, v244
    s_cbranch_vccz .wfd_15
    s_sleep 2
    s_add_u32 s62, s62, 1
    s_cmp_gt_u32 s62, 0x400000
    s_cbranch_scc1 .mg_end_1
    s_branch .wf_14

.wfd_15:
    s_mov_b64 exec, -1
    v_readlane_b32 s4, v244, 0
    v_readlane_b32 s93, v244, 1
    s_min_u32 s93, s93, s4
    s_mov_b32 s62, 0x1000000
    s_mov_b32 m0, s90
    s_nop 0
    buffer_load_dwordx4 v14, s[8:11], s38 offen offset:0 lds
    buffer_load_dwordx4 v14, s[8:11], s38 offen offset:1024 lds
    buffer_load_dwordx4 v14, s[8:11], s38 offen offset:2048 lds
    buffer_load_dwordx4 v14, s[8:11], s38 offen offset:3072 lds
    s_mov_b32 m0, s91
    s_nop 0
    buffer_load_dwordx4 v14, s[8:11], s39 offen lds
    s_waitcnt vmcnt(0)
.nd_13:
    s_add_u32 s38, s38, 262144
    s_add_u32 s39, s39, 262144
    s_and_b32 s4, s28, 3
    s_lshl_b32 s5, s4, 16
    s_add_u32 s29, s5, s34
    s_xor_b32 s6, s5, 0x20000
    s_add_u32 s31, s6, s34
    s_add_u32 s32, s29, 16384
    s_add_u32 s33, s29, 20480
    s_barrier
    s_cmp_lt_u32 s24, 2
    s_cbranch_scc1 .k0_18
    ds_read_b128 v[128:131], v228 offset:0
    ds_read_b128 v[144:147], v228 offset:4096
    ds_read_b128 v[132:135], v229 offset:0
    ds_read_b128 v[148:151], v229 offset:4096
    ds_read_b128 v[136:139], v230 offset:0
    ds_read_b128 v[152:155], v230 offset:4096
    ds_read_b128 v[140:143], v231 offset:0
    ds_read_b128 v[156:159], v231 offset:4096
    ds_read_b128 v[160:163], v14 offset:28672
    ds_read_b128 v[164:167], v14 offset:29696
.k0_18:
    s_cmp_lg_u32 s27, 0
    s_cbranch_scc1 .ent1_17
    s_branch .ent0_16
.p2align 6
.top_19:
    s_barrier
    buffer_load_dwordx4 v[20:23], v8, s[8:11], s29 offen offset:0 sc1
    v_mov_b32 v52, 0
    buffer_load_dwordx4 v[24:27], v8, s[8:11], s29 offen offset:1024 sc1
    v_mov_b32 v53, 0
    buffer_load_dwordx4 v[28:31], v8, s[8:11], s29 offen offset:2048 sc1
    v_mov_b32 v54, 0
    buffer_load_dwordx4 v[32:35], v8, s[8:11], s29 offen offset:3072 sc1
.ent0_16:
    s_waitcnt vmcnt(3)
    v_max3_u32 v4, v20, v21, v22
    v_max_u32 v4, v4, v23
    v_cmp_eq_u32 vcc, -1, v4
    s_cbranch_vccnz .A_24
.W_25:
    v_smfmac_f32_16x16x64_bf16 v[52:55], v[20:23], a[0:7], v9
    v_smfmac_f32_16x16x64_bf16 v[56:59], v[20:23], a[32:39], v9
    s_waitcnt vmcnt(2)
    v_max3_u32 v4, v24, v25, v26
    v_max_u32 v4, v4, v27
    v_smfmac_f32_16x16x64_bf16 v[60:63], v[20:23], a[64:71], v9
    v_cmp_eq_u32 vcc, -1, v4
    v_smfmac_f32_16x16x64_bf16 v[64:67], v[20:23], a[96:103], v9
    s_cbranch_vccnz .A_26
.W_27:
    v_smfmac_f32_16x16x64_bf16 v[52:55], v[24:27], a[8:15], v9
    v_smfmac_f32_16x16x64_bf16 v[56:59], v[24:27], a[40:47], v9
    s_waitcnt vmcnt(1)
    v_max3_u32 v4, v28, v29, v30
    v_max_u32 v4, v4, v31
    v_smfmac_f32_16x16x64_bf16 v[60:63], v[24:27], a[72:79], v9
    v_cmp_eq_u32 vcc, -1, v4
    v_smfmac_f32_16x16x64_bf16 v[64:67], v[24:27], a[104:111], v9
    s_cbranch_vccnz .A_28
.W_29:
    v_smfmac_f32_16x16x64_bf16 v[52:55], v[28:31], a[16:23], v9
    v_smfmac_f32_16x16x64_bf16 v[56:59], v[28:31], a[48:55], v9
    s_waitcnt vmcnt(0)
    v_max3_u32 v4, v32, v33, v34
    v_max_u32 v4, v4, v35
    v_smfmac_f32_16x16x64_bf16 v[60:63], v[28:31], a[80:87], v9
    v_cmp_eq_u32 vcc, -1, v4
    v_smfmac_f32_16x16x64_bf16 v[64:67], v[28:31], a[112:119], v9
    s_cbranch_vccnz .A_30
.W_31:
    v_smfmac_f32_16x16x64_bf16 v[52:55], v[32:35], a[24:31], v9
    v_smfmac_f32_16x16x64_bf16 v[56:59], v[32:35], a[56:63], v9
    v_smfmac_f32_16x16x64_bf16 v[60:63], v[32:35], a[88:95], v9
    v_smfmac_f32_16x16x64_bf16 v[64:67], v[32:35], a[120:127], v9
.mj_23:
    v_cvt_pk_bf16_f32 v104, v52, v53
    v_cvt_pk_bf16_f32 v105, v54, v55
    v_cvt_pk_bf16_f32 v106, v56, v57
    v_cvt_pk_bf16_f32 v107, v58, v59
    ds_write_b64 v16, v[104:105] offset:4096
    v_cvt_pk_bf16_f32 v108, v60, v61
    v_cvt_pk_bf16_f32 v109, v62, v63
    ds_write_b64 v16, v[106:107] offset:6144
    ds_write_b64 v16, v[108:109] offset:0
    v_cvt_pk_bf16_f32 v110, v64, v65
    v_cvt_pk_bf16_f32 v111, v66, v67
    ds_write_b64 v16, v[110:111] offset:2048
    v_smfmac_f32_16x16x64_bf16 v[68:71], v[20:23], a[128:135], v9
    v_smfmac_f32_16x16x64_bf16 v[72:75], v[20:23], a[160:167], v9
    s_waitcnt lgkmcnt(0)
    s_barrier
    ds_read_b128 v[36:39], v17 offset:0
    ds_read_b128 v[40:43], v17 offset:1024
    v_smfmac_f32_16x16x64_bf16 v[68:71], v[24:27], a[136:143], v9
    v_smfmac_f32_16x16x64_bf16 v[72:75], v[24:27], a[168:175], v9
    s_waitcnt lgkmcnt(1)
    v_mfma_f32_16x16x32_bf16 v[44:47], v[36:39], v[84:87], 0
    s_waitcnt lgkmcnt(0)
    v_mfma_f32_16x16x32_bf16 v[44:47], v[40:43], v[84:87], v[44:47]
    v_smfmac_f32_16x16x64_bf16 v[68:71], v[28:31], a[144:151], v9
    v_smfmac_f32_16x16x64_bf16 v[72:75], v[28:31], a[176:183], v9
    s_mov_b64 exec, s[64:65]
    v_cvt_pk_bf16_f32 v48, v44, v45
    v_cvt_pk_bf16_f32 v49, v46, v47
    v_min_u32 v48, 0xfffffffe, v48
    v_min_u32 v49, 0xfffffffe, v49
    buffer_store_dwordx2 v[48:49], v10, s[8:11], s29 offen

    ds_write_b64 v18, v[48:49]
    s_mov_b64 exec, -1

    v_smfmac_f32_16x16x64_bf16 v[68:71], v[32:35], a[152:159], v9
    v_smfmac_f32_16x16x64_bf16 v[72:75], v[32:35], a[184:191], v9
    s_nop 3
    v_cvt_pk_bf16_f32 v104, v68, v69
    v_cvt_pk_bf16_f32 v105, v70, v71
    ds_write_b64 v16, v[104:105] offset:8192
    s_nop 0
    v_cvt_pk_bf16_f32 v106, v72, v73
    v_cvt_pk_bf16_f32 v107, v74, v75
    ds_write_b64 v16, v[106:107] offset:10240
    s_cmp_lg_u32 s24, 2
    s_waitcnt lgkmcnt(0)
    s_barrier
    s_cbranch_scc1 .oth_20
    buffer_load_dwordx4 v[92:95], v232, s[8:11], s29 offen sc1
    buffer_load_dwordx4 v[96:99], v233, s[8:11], s29 offen sc1
    buffer_load_dwordx4 v[100:103], v234, s[8:11], s29 offen sc1
    ds_read_b128 v[88:91], v14 offset:16384
    s_cmp_eq_u32 s28, 63
    s_cbranch_scc1 .rec_fin_5
    s_waitcnt lgkmcnt(0)
    v_mfma_f32_16x16x32_bf16 v[208:211], v[128:131], v[88:91], 0
    v_mfma_f32_16x16x32_bf16 v[212:215], v[144:147], v[88:91], 0
    v_mfma_f32_16x16x32_bf16 v[216:219], v[88:91], v[88:91], v[116:119]
    s_waitcnt vmcnt(2)
    v_max3_u32 v4, v92, v93, v94
    v_max_u32 v4, v4, v95
    v_cmp_eq_u32 vcc, -1, v4
    s_cbranch_vccnz .A_33
.W_34:
    v_mfma_f32_16x16x32_bf16 v[208:211], v[132:135], v[92:95], v[208:211]
    s_waitcnt vmcnt(1)
    v_max3_u32 v4, v96, v97, v98
    v_max_u32 v4, v4, v99
    v_mfma_f32_16x16x32_bf16 v[212:215], v[148:151], v[92:95], v[212:215]
    v_cmp_eq_u32 vcc, -1, v4
    v_mfma_f32_16x16x32_bf16 v[216:219], v[92:95], v[92:95], v[216:219]
    s_cbranch_vccnz .A_35
.W_36:
    v_mfma_f32_16x16x32_bf16 v[208:211], v[136:139], v[96:99], v[208:211]
    s_waitcnt vmcnt(0)
    v_max3_u32 v4, v100, v101, v102
    v_max_u32 v4, v4, v103
    v_mfma_f32_16x16x32_bf16 v[212:215], v[152:155], v[96:99], v[212:215]
    v_cmp_eq_u32 vcc, -1, v4
    v_mfma_f32_16x16x32_bf16 v[216:219], v[96:99], v[96:99], v[216:219]
    s_cbranch_vccnz .A_37
.W_38:
    v_mfma_f32_16x16x32_bf16 v[208:211], v[140:143], v[100:103], v[208:211]
    v_mfma_f32_16x16x32_bf16 v[212:215], v[156:159], v[100:103], v[212:215]
    v_mfma_f32_16x16x32_bf16 v[216:219], v[100:103], v[100:103], v[216:219]
.mj_32:
    s_barrier
    ds_read_b64 v[168:169], v14 offset:18432
    ds_read_b64 v[172:173], v14 offset:18440
    s_nop 0

    v_mov_b32_dpp v208, v212 row_ror:8 row_mask:0xf bank_mask:0xc
    v_mov_b32_dpp v209, v213 row_ror:8 row_mask:0xf bank_mask:0xc
    v_mov_b32_dpp v210, v214 row_ror:8 row_mask:0xf bank_mask:0xc
    v_mov_b32_dpp v211, v215 row_ror:8 row_mask:0xf bank_mask:0xc
    v_mov_b32_dpp v216, v218 row_ror:8 row_mask:0xf bank_mask:0xc
    v_mov_b32_dpp v217, v219 row_ror:8 row_mask:0xf bank_mask:0xc
    v_max3_f32 v4, v208, v209, v210
    v_max3_f32 v5, v211, v216, v217
    v_max_f32 v6, v4, v5
    v_max_f32 v4, v4, v5
    s_nop 1
    v_permlane32_swap_b32 v4, v6
    v_max_f32 v5, v4, v6
    v_max_f32 v4, v4, v6
    s_nop 1
    v_permlane16_swap_b32 v4, v5
    v_max_f32 v4, v4, v5
    s_nop 1
    v_max_f32_dpp v4, v4, v4 row_ror:8 row_mask:0xf bank_mask:0xf
    v_mul_f32 v4, s37, v4

    v_fma_f32 v104, v208, s37, -v4
    v_fma_f32 v105, v209, s37, -v4
    v_fma_f32 v106, v210, s37, -v4
    v_fma_f32 v107, v211, s37, -v4
    v_fma_f32 v108, v216, s37, -v4
    v_fma_f32 v109, v217, s37, -v4
    v_exp_f32 v104, v104
    v_exp_f32 v105, v105
    v_exp_f32 v106, v106
    v_exp_f32 v107, v107
    v_exp_f32 v108, v108
    v_exp_f32 v109, v109
    v_cvt_pk_bf16_f32 v176, v104, v105
    v_cvt_pk_bf16_f32 v177, v106, v107
    v_cvt_pk_bf16_f32 v180, v108, v109
    v_mov_b32_dpp v178, v176 row_ror:8 row_mask:0xf bank_mask:0xf
    v_mov_b32_dpp v179, v177 row_ror:8 row_mask:0xf bank_mask:0xf
    v_mov_b32_dpp v181, v180 row_ror:8 row_mask:0xf bank_mask:0xf
    s_waitcnt lgkmcnt(0)

    v_mfma_f32_16x16x32_bf16 v[208:211], v[120:123], v[176:179], 0
    v_mfma_f32_16x16x32_bf16 v[208:211], v[120:123], v[180:183], v[208:211]
    v_mfma_f32_16x16x32_bf16 v[212:215], v[160:163], v[176:179], 0
    v_mfma_f32_16x16x32_bf16 v[216:219], v[164:167], v[176:179], 0
    v_mfma_f32_16x16x32_bf16 v[212:215], v[168:171], v[180:183], v[212:215]
    v_rcp_f32 v4, v208
    v_mfma_f32_16x16x32_bf16 v[216:219], v[172:175], v[180:183], v[216:219]
    s_mov_b64 exec, s[58:59]
    s_nop 2
    v_mul_f32 v212, v4, v212
    v_mul_f32 v213, v4, v213
    v_mul_f32 v214, v4, v214
    v_mul_f32 v215, v4, v215
    v_cvt_pk_bf16_f32 v184, v212, v213
    v_cvt_pk_bf16_f32 v185, v214, v215
    v_mul_f32 v216, v4, v216
    v_mul_f32 v217, v4, v217
    v_min_u32 v184, 0xfffffffe, v184
    v_min_u32 v185, 0xfffffffe, v185
    v_mul_f32 v218, v4, v218
    v_mul_f32 v219, v4, v219
    v_cvt_pk_bf16_f32 v186, v216, v217
    v_cvt_pk_bf16_f32 v187, v218, v219
    v_min_u32 v186, 0xfffffffe, v186
    v_min_u32 v187, 0xfffffffe, v187
    buffer_store_dwordx4 v[184:187], v13, s[8:11], s29 offen
    s_mov_b64 exec, -1

.gp_22:
    s_barrier
    s_mov_b32 s99, s68
    s_add_u32 s28, s28, 1
    s_add_u32 s36, s36, 196608
    s_cmp_lt_u32 s28, 63
    s_cselect_b32 s4, 262144, 0
    s_add_u32 s38, s38, s4
    s_add_u32 s39, s39, s4
    s_add_u32 s30, s30, s4
    s_mov_b32 s4, s68
    s_mov_b32 s68, s69
    s_mov_b32 s69, s70
    s_mov_b32 s70, s71
    s_mov_b32 s71, s4
    s_and_b32 s4, s28, 3
    s_lshl_b32 s5, s4, 16
    s_add_u32 s29, s5, s34
    s_xor_b32 s6, s5, 0x20000
    s_add_u32 s31, s6, s34
    s_add_u32 s32, s29, 16384
    s_add_u32 s33, s29, 20480
    s_waitcnt vmcnt(0)
    s_cmp_eq_u32 s24, 3
    s_cbranch_scc1 .u3_39
    s_barrier
    buffer_load_dword v226, v225, s[8:11], s30 offen
    s_add_u32 s4, s69, 0
    buffer_store_dwordx4 v[188:191], v238, s[8:11], s4 offen sc1
    s_add_u32 s4, s69, 262144
    buffer_store_dwordx4 v[188:191], v238, s[8:11], s4 offen sc1
    s_branch .u4_40
.u3_39:
    s_sub_u32 s4, s36, 196608
    s_barrier
    s_mov_b64 exec, s[66:67]
    buffer_store_dwordx4 v[88:91], v11, s[8:11], s4 offen sc1
    s_mov_b64 exec, s[56:57]
    buffer_store_dwordx4 v[172:175], v12, s[8:11], s4 offen sc1
    s_mov_b64 exec, -1

.u4_40:
    s_barrier
    ds_read_b128 v[108:111], v248
    ds_read_b128 v[128:131], v228 offset:0
    ds_read_b128 v[144:147], v228 offset:4096
    ds_read_b128 v[132:135], v229 offset:0
    ds_read_b128 v[148:151], v229 offset:4096
    ds_read_b128 v[136:139], v230 offset:0
    ds_read_b128 v[152:155], v230 offset:4096
    ds_read_b128 v[140:143], v231 offset:0
    ds_read_b128 v[156:159], v231 offset:4096
    ds_read_b128 v[160:163], v14 offset:28672
    ds_read_b128 v[164:167], v14 offset:29696
    v_mov_b32 v55, 0
    v_mov_b32 v56, 0
    v_mov_b32 v57, 0
    v_mov_b32 v58, 0
    v_mov_b32 v59, 0
    v_mov_b32 v60, 0
    v_mov_b32 v61, 0
    v_mov_b32 v62, 0
    v_mov_b32 v63, 0
    v_mov_b32 v64, 0
    v_mov_b32 v65, 0
    v_mov_b32 v66, 0
    v_mov_b32 v67, 0
    v_mov_b32 v68, 0
    v_mov_b32 v69, 0
    v_mov_b32 v70, 0
    v_mov_b32 v71, 0
    v_mov_b32 v72, 0
    v_mov_b32 v73, 0
    v_mov_b32 v74, 0
    v_mov_b32 v75, 0
    v_mov_b32 v20, -1
    v_mov_b32 v21, -1
    v_mov_b32 v22, -1
    v_mov_b32 v23, -1
    v_mov_b32 v24, -1
    v_mov_b32 v25, -1
    v_mov_b32 v26, -1
    v_mov_b32 v27, -1
    v_mov_b32 v28, -1
    s_add_u32 s4, s99, 0
    buffer_load_dwordx4 v[192:195], v239, s[8:11], s4 offen sc1
    buffer_load_dwordx4 v[196:199], v249, s[8:11], s4 offen sc1

    v_mov_b32 v29, -1
    v_mov_b32 v30, -1
    v_mov_b32 v31, -1
    v_mov_b32 v32, -1
    v_mov_b32 v33, -1
    v_mov_b32 v34, -1
    v_mov_b32 v35, -1
    v_mov_b32 v92, -1
    v_mov_b32 v93, -1
    v_mov_b32 v94, -1
    v_mov_b32 v95, -1
    v_mov_b32 v96, -1
    v_mov_b32 v97, -1
    v_mov_b32 v98, -1
    v_mov_b32 v99, -1
    v_mov_b32 v100, -1
    v_mov_b32 v101, -1
    v_mov_b32 v102, -1
    v_mov_b32 v103, -1
    s_add_u32 s4, s99, 262144
    buffer_load_dwordx4 v[200:203], v239, s[8:11], s4 offen sc1
    buffer_load_dwordx4 v[204:207], v249, s[8:11], s4 offen sc1

    s_waitcnt lgkmcnt(0)
    v_mfma_f32_16x16x32_bf16 v[76:79], v[108:111], v[112:115], 0
.gc_41:
    s_waitcnt vmcnt(2)

    v_max_u32 v4, v192, v196
    v_cmp_eq_u32 vcc, -1, v4
    s_cbranch_vccnz .gf_42
    v_mfma_f32_16x16x32_bf16 v[76:79], v[192:195], v[84:87], v[76:79]
    v_mfma_f32_16x16x32_bf16 v[76:79], v[196:199], v[112:115], v[76:79]
    s_mov_b64 exec, s[58:59]
    s_nop 6
    v_cvt_pk_bf16_f32 v104, v76, v77
    v_cvt_pk_bf16_f32 v105, v78, v79
    v_min_u32 v104, 0xfffffffe, v104
    v_min_u32 v105, 0xfffffffe, v105
    buffer_store_dwordx2 v[104:105], v15, s[8:11], s29 offen
    s_mov_b64 exec, -1

    s_branch .top_19
.gf_42:
    s_add_u32 s4, s99, 0
    buffer_load_dwordx4 v[192:195], v239, s[8:11], s4 offen sc1
    buffer_load_dwordx4 v[196:199], v249, s[8:11], s4 offen sc1

    s_waitcnt vmcnt(2)

    v_max_u32 v4, v200, v204
    v_cmp_eq_u32 vcc, -1, v4
    s_cbranch_vccnz .gf_43
    v_mfma_f32_16x16x32_bf16 v[76:79], v[200:203], v[84:87], v[76:79]
    v_mfma_f32_16x16x32_bf16 v[76:79], v[204:207], v[112:115], v[76:79]
    s_mov_b64 exec, s[58:59]
    s_nop 6
    v_cvt_pk_bf16_f32 v104, v76, v77
    v_cvt_pk_bf16_f32 v105, v78, v79
    v_min_u32 v104, 0xfffffffe, v104
    v_min_u32 v105, 0xfffffffe, v105
    buffer_store_dwordx2 v[104:105], v15, s[8:11], s29 offen
    s_mov_b64 exec, -1

    s_branch .top_19
.gf_43:
    s_add_u32 s4, s99, 262144
    buffer_load_dwordx4 v[200:203], v239, s[8:11], s4 offen sc1
    buffer_load_dwordx4 v[204:207], v249, s[8:11], s4 offen sc1

    s_sub_u32 s62, s62, 1
    s_cbranch_scc1 .mg_end_1
    s_branch .gc_41
.oth_20:
    s_cmp_eq_u32 s24, 3
    s_cbranch_scc1 .w3_21
    s_cmp_eq_u32 s28, 63
    s_cbranch_scc1 .rec_fin_5
    s_waitcnt vmcnt(0)
    v_readlane_b32 s4, v244, 0
    v_readlane_b32 s93, v244, 1
    s_min_u32 s93, s93, s4
    v_mov_b32 v20, -1
    v_mov_b32 v21, -1
    v_mov_b32 v22, -1
    v_mov_b32 v23, -1
    v_mov_b32 v24, -1
    v_mov_b32 v25, -1
    v_mov_b32 v26, -1
    v_mov_b32 v27, -1
    v_mov_b32 v28, -1
    v_mov_b32 v29, -1
    v_mov_b32 v30, -1
    v_mov_b32 v31, -1
    v_mov_b32 v32, -1
    v_mov_b32 v33, -1
    v_mov_b32 v34, -1
    v_mov_b32 v35, -1
    v_mov_b32 v55, 0
    v_mov_b32 v56, 0
    v_mov_b32 v57, 0
    v_mov_b32 v58, 0
    v_mov_b32 v59, 0
    v_mov_b32 v60, 0
    v_mov_b32 v61, 0
    v_mov_b32 v62, 0
    v_mov_b32 v63, 0
    v_mov_b32 v64, 0
    v_mov_b32 v65, 0
    v_mov_b32 v66, 0
    v_mov_b32 v67, 0
    v_mov_b32 v68, 0
    v_mov_b32 v69, 0
    v_mov_b32 v70, 0
    v_mov_b32 v71, 0
    v_mov_b32 v72, 0
    v_mov_b32 v73, 0
    v_mov_b32 v74, 0
    v_mov_b32 v75, 0
    s_barrier
    s_add_u32 s6, s28, 3
    s_min_u32 s6, s6, 64
    s_cmp_lt_u32 s93, s6
    s_cbranch_scc1 .kf_44
.kb_45:
    s_mov_b32 m0, s90
    s_nop 0
    buffer_load_dwordx4 v14, s[8:11], s38 offen offset:0 lds
    buffer_load_dwordx4 v14, s[8:11], s38 offen offset:1024 lds
    buffer_load_dwordx4 v14, s[8:11], s38 offen offset:2048 lds
    buffer_load_dwordx4 v14, s[8:11], s38 offen offset:3072 lds
    s_mov_b32 m0, s91
    s_nop 0
    buffer_load_dwordx4 v14, s[8:11], s39 offen lds
    s_bfe_u32 s12, s28, 0x10001
    s_add_u32 s6, s28, 6
    s_cmp_ge_u32 s93, s6
    s_cbranch_scc1 .nl_46
    s_mov_b64 exec, 3
    buffer_load_dword v244, v253, s[8:11], s89 offen sc1
    s_mov_b64 exec, -1

.nl_46:
    s_waitcnt lgkmcnt(0)
    s_barrier
    buffer_load_dwordx4 v[192:195], v246, s[8:11], s32 offen offset:0 sc1
    buffer_load_dwordx4 v[196:199], v246, s[8:11], s32 offen offset:1024 sc1
    v_mov_b32 v76, 0
    buffer_load_dwordx4 v[200:203], v246, s[8:11], s32 offen offset:2048 sc1
    buffer_load_dwordx4 v[204:207], v246, s[8:11], s32 offen offset:3072 sc1
    v_mov_b32 v77, 0
    buffer_load_dwordx4 v[208:211], v246, s[8:11], s33 offen offset:0 sc1
    buffer_load_dwordx4 v[212:215], v246, s[8:11], s33 offen offset:1024 sc1
    v_mov_b32 v78, 0
    buffer_load_dwordx4 v[216:219], v246, s[8:11], s33 offen offset:2048 sc1
    buffer_load_dwordx4 v[220:223], v246, s[8:11], s33 offen offset:3072 sc1
    s_waitcnt vmcnt(6)
    v_max3_u32 v4, v192, v193, v194
    v_max3_u32 v5, v195, v196, v197
    v_max3_u32 v4, v4, v198, v199
    v_max_u32 v4, v4, v5
    v_cmp_eq_u32 vcc, -1, v4
    s_cbranch_vccnz .A_48
.W_49:
    v_smfmac_f32_16x16x64_bf16 v[76:79], v[192:195], a[192:199], v9
    v_smfmac_f32_16x16x64_bf16 v[80:83], v[192:195], a[224:231], v9
    s_waitcnt vmcnt(4)
    v_max3_u32 v4, v200, v201, v202
    v_max3_u32 v5, v203, v204, v205
    v_max3_u32 v4, v4, v206, v207
    v_smfmac_f32_16x16x64_bf16 v[76:79], v[196:199], a[200:207], v9
    v_max_u32 v4, v4, v5
    v_cmp_eq_u32 vcc, -1, v4
    v_smfmac_f32_16x16x64_bf16 v[80:83], v[196:199], a[232:239], v9
    s_cbranch_vccnz .A_50
.W_51:
    v_smfmac_f32_16x16x64_bf16 v[76:79], v[200:203], a[208:215], v9
    v_smfmac_f32_16x16x64_bf16 v[80:83], v[200:203], a[240:247], v9
    s_waitcnt vmcnt(2)
    v_max3_u32 v4, v208, v209, v210
    v_max3_u32 v5, v211, v212, v213
    v_max3_u32 v4, v4, v214, v215
    v_smfmac_f32_16x16x64_bf16 v[76:79], v[204:207], a[216:223], v9
    v_max_u32 v4, v4, v5
    v_cmp_eq_u32 vcc, -1, v4
    v_smfmac_f32_16x16x64_bf16 v[80:83], v[204:207], a[248:255], v9
    s_cbranch_vccnz .A_52
.W_53:
    v_smfmac_f32_16x16x64_bf16 v[76:79], v[208:211], v[124:131], v9
    v_smfmac_f32_16x16x64_bf16 v[80:83], v[208:211], v[156:163], v9
    s_waitcnt vmcnt(0)
    v_max3_u32 v4, v216, v217, v218
    v_max3_u32 v5, v219, v220, v221
    v_max3_u32 v4, v4, v222, v223
    v_smfmac_f32_16x16x64_bf16 v[76:79], v[212:215], v[132:139], v9
    v_max_u32 v4, v4, v5
    v_cmp_eq_u32 vcc, -1, v4
    v_smfmac_f32_16x16x64_bf16 v[80:83], v[212:215], v[164:171], v9
    s_cbranch_vccnz .A_54
.W_55:
    v_smfmac_f32_16x16x64_bf16 v[76:79], v[216:219], v[140:147], v9
    v_smfmac_f32_16x16x64_bf16 v[80:83], v[216:219], v[172:179], v9
    v_smfmac_f32_16x16x64_bf16 v[76:79], v[220:223], v[148:155], v9
    v_smfmac_f32_16x16x64_bf16 v[80:83], v[220:223], v[180:187], v9
.mj_47:
    s_barrier
    s_nop 7
    v_permlane32_swap_b32 v76, v80
    v_permlane32_swap_b32 v77, v81
    v_permlane32_swap_b32 v78, v82
    v_permlane32_swap_b32 v79, v83
    v_add_f32 v76, v76, v80
    v_add_f32 v77, v77, v81
    v_add_f32 v78, v78, v82
    v_add_f32 v79, v79, v83
    v_cvt_pk_bf16_f32 v104, v76, v77
    v_cvt_pk_bf16_f32 v106, v76, v77
    v_cvt_pk_bf16_f32 v105, v78, v79
    v_cvt_pk_bf16_f32 v107, v78, v79
    v_permlane16_swap_b32 v104, v106
    s_nop 0
    v_permlane16_swap_b32 v105, v107
    v_min_u32 v104, 0xfffffffe, v104
    buffer_store_dwordx4 v[104:107], v237, s[8:11], s68 offen sc1

    ds_write_b128 v247, v[104:107]
    s_waitcnt lgkmcnt(0)
    s_barrier
    v_mov_b32 v79, 0
    v_mov_b32 v80, 0
    v_mov_b32 v81, 0
    v_mov_b32 v82, 0
    v_mov_b32 v83, 0
    s_waitcnt vmcnt(1)
    v_mov_b32 v192, -1
    v_mov_b32 v193, -1
    v_mov_b32 v194, -1
    v_mov_b32 v195, -1
    v_mov_b32 v196, -1
    v_mov_b32 v197, -1
    v_mov_b32 v198, -1
    v_mov_b32 v199, -1
    v_mov_b32 v200, -1
    v_mov_b32 v201, -1
    v_mov_b32 v202, -1
    v_mov_b32 v203, -1
    v_mov_b32 v204, -1
    v_mov_b32 v205, -1
    v_mov_b32 v206, -1
    v_mov_b32 v207, -1
    v_mov_b32 v208, -1
    v_mov_b32 v209, -1
    v_mov_b32 v210, -1
    v_mov_b32 v211, -1
    v_mov_b32 v212, -1
    v_mov_b32 v213, -1
    v_mov_b32 v214, -1
    v_mov_b32 v215, -1
    v_mov_b32 v216, -1
    v_mov_b32 v217, -1
    v_mov_b32 v218, -1
    v_mov_b32 v219, -1
    v_mov_b32 v220, -1
    v_mov_b32 v221, -1
    v_mov_b32 v222, -1
    v_mov_b32 v223, -1
    s_add_u32 s28, s28, 1
    s_add_u32 s36, s36, 196608
    s_cmp_lt_u32 s28, 63
    s_cselect_b32 s4, 262144, 0
    s_add_u32 s38, s38, s4
    s_add_u32 s39, s39, s4
    s_add_u32 s30, s30, s4
    s_mov_b32 s4, s68
    s_mov_b32 s68, s69
    s_mov_b32 s69, s70
    s_mov_b32 s70, s71
    s_mov_b32 s71, s4
    s_and_b32 s4, s28, 3
    s_lshl_b32 s5, s4, 16
    s_add_u32 s29, s5, s34
    s_xor_b32 s6, s5, 0x20000
    s_add_u32 s31, s6, s34
    s_add_u32 s32, s29, 16384
    s_add_u32 s33, s29, 20480
    s_branch .top_19
.w3_21:
    ds_read_b128 v[36:39], v14 offset:8192
    ds_read_b128 v[40:43], v14 offset:9216
    ds_read_b128 v[44:47], v14 offset:10240
    ds_read_b128 v[48:51], v14 offset:11264
    ds_read_b128 v[88:91], v14 offset:16384
    s_waitcnt lgkmcnt(0)
    v_mfma_f32_16x16x32_bf16 v[104:107], v[84:87], v[36:39], 0
    v_mfma_f32_16x16x32_bf16 v[108:111], v[84:87], v[44:47], 0
    v_mfma_f32_16x16x32_bf16 v[104:107], v[84:87], v[40:43], v[104:107]
    v_mfma_f32_16x16x32_bf16 v[108:111], v[84:87], v[48:51], v[108:111]
    s_nop 7
    v_cvt_pk_bf16_f32 v168, v104, v105
    v_cvt_pk_bf16_f32 v169, v106, v107
    v_cvt_pk_bf16_f32 v170, v108, v109
    v_cvt_pk_bf16_f32 v171, v110, v111
    ds_write_b128 v14, v[168:171] offset:18432
    v_cndmask_b32 v172, v170, v168, s[60:61]
    v_cndmask_b32 v173, v171, v169, s[60:61]
    v_min_u32 v172, 0xfffffffe, v172
    v_min_u32 v173, 0xfffffffe, v173
    v_mov_b32 v174, v172
    v_mov_b32 v175, v173
    s_cmp_eq_u32 s28, 63
    s_nop 0
    v_permlane16_swap_b32 v172, v174
    v_permlane16_swap_b32 v173, v175
    ds_write_b128 v14, v[172:175] offset:17408

    s_cbranch_scc1 .sk_56
    s_waitcnt lgkmcnt(0)
    s_barrier
    buffer_store_dwordx4 v[188:191], v235, s[8:11], s31 offen
    buffer_store_dwordx4 v[188:191], v236, s[8:11], s31 offen

    s_branch .gp_22
.A_57:
    buffer_load_dwordx4 v[32:35], v8, s[8:11], s29 offen offset:3072 sc1
    s_sub_u32 s62, s62, 1
    s_cbranch_scc1 .mg_end_1
    s_waitcnt vmcnt(3)
    v_max3_u32 v4, v20, v21, v22
    v_max_u32 v4, v4, v23
    v_cmp_eq_u32 vcc, -1, v4
    s_cbranch_vccz .W_25
.A_24:
    buffer_load_dwordx4 v[20:23], v8, s[8:11], s29 offen offset:0 sc1
    s_waitcnt vmcnt(3)
    v_max3_u32 v4, v24, v25, v26
    v_max_u32 v4, v4, v27
    v_cmp_eq_u32 vcc, -1, v4
    s_cbranch_vccz .W_58
.A_59:
    buffer_load_dwordx4 v[24:27], v8, s[8:11], s29 offen offset:1024 sc1
    s_waitcnt vmcnt(3)
    v_max3_u32 v4, v28, v29, v30
    v_max_u32 v4, v4, v31
    v_cmp_eq_u32 vcc, -1, v4
    s_cbranch_vccz .W_60
.A_61:
    buffer_load_dwordx4 v[28:31], v8, s[8:11], s29 offen offset:2048 sc1
    s_waitcnt vmcnt(3)
    v_max3_u32 v4, v32, v33, v34
    v_max_u32 v4, v4, v35
    v_cmp_eq_u32 vcc, -1, v4
    s_cbranch_vccnz .A_57
.W_62:
    v_smfmac_f32_16x16x64_bf16 v[52:55], v[32:35], a[24:31], v9
    v_smfmac_f32_16x16x64_bf16 v[56:59], v[32:35], a[56:63], v9
    s_waitcnt vmcnt(2)
    v_max3_u32 v4, v20, v21, v22
    v_max_u32 v4, v4, v23
    v_smfmac_f32_16x16x64_bf16 v[60:63], v[32:35], a[88:95], v9
    v_cmp_eq_u32 vcc, -1, v4
    v_smfmac_f32_16x16x64_bf16 v[64:67], v[32:35], a[120:127], v9
    s_cbranch_vccnz .A_63
.W_64:
    v_smfmac_f32_16x16x64_bf16 v[52:55], v[20:23], a[0:7], v9
    v_smfmac_f32_16x16x64_bf16 v[56:59], v[20:23], a[32:39], v9
    s_waitcnt vmcnt(1)
    v_max3_u32 v4, v24, v25, v26
    v_max_u32 v4, v4, v27
    v_smfmac_f32_16x16x64_bf16 v[60:63], v[20:23], a[64:71], v9
    v_cmp_eq_u32 vcc, -1, v4
    v_smfmac_f32_16x16x64_bf16 v[64:67], v[20:23], a[96:103], v9
    s_cbranch_vccnz .A_65
.W_66:
    v_smfmac_f32_16x16x64_bf16 v[52:55], v[24:27], a[8:15], v9
    v_smfmac_f32_16x16x64_bf16 v[56:59], v[24:27], a[40:47], v9
    s_waitcnt vmcnt(0)
    v_max3_u32 v4, v28, v29, v30
    v_max_u32 v4, v4, v31
    v_smfmac_f32_16x16x64_bf16 v[60:63], v[24:27], a[72:79], v9
    v_cmp_eq_u32 vcc, -1, v4
    v_smfmac_f32_16x16x64_bf16 v[64:67], v[24:27], a[104:111], v9
    s_cbranch_vccnz .A_67
.W_68:
    v_smfmac_f32_16x16x64_bf16 v[52:55], v[28:31], a[16:23], v9
    v_smfmac_f32_16x16x64_bf16 v[56:59], v[28:31], a[48:55], v9
    v_smfmac_f32_16x16x64_bf16 v[60:63], v[28:31], a[80:87], v9
    v_smfmac_f32_16x16x64_bf16 v[64:67], v[28:31], a[112:119], v9
    s_branch .mj_23
.W_58:
    v_smfmac_f32_16x16x64_bf16 v[52:55], v[24:27], a[8:15], v9
    v_smfmac_f32_16x16x64_bf16 v[56:59], v[24:27], a[40:47], v9
    s_waitcnt vmcnt(2)
    v_max3_u32 v4, v28, v29, v30
    v_max_u32 v4, v4, v31
    v_smfmac_f32_16x16x64_bf16 v[60:63], v[24:27], a[72:79], v9
    v_cmp_eq_u32 vcc, -1, v4
    v_smfmac_f32_16x16x64_bf16 v[64:67], v[24:27], a[104:111], v9
    s_cbranch_vccnz .A_69
.W_70:
    v_smfmac_f32_16x16x64_bf16 v[52:55], v[28:31], a[16:23], v9
    v_smfmac_f32_16x16x64_bf16 v[56:59], v[28:31], a[48:55], v9
    s_waitcnt vmcnt(1)
    v_max3_u32 v4, v32, v33, v34
    v_max_u32 v4, v4, v35
    v_smfmac_f32_16x16x64_bf16 v[60:63], v[28:31], a[80:87], v9
    v_cmp_eq_u32 vcc, -1, v4
    v_smfmac_f32_16x16x64_bf16 v[64:67], v[28:31], a[112:119], v9
    s_cbranch_vccnz .A_71
.W_72:
    v_smfmac_f32_16x16x64_bf16 v[52:55], v[32:35], a[24:31], v9
    v_smfmac_f32_16x16x64_bf16 v[56:59], v[32:35], a[56:63], v9
    s_waitcnt vmcnt(0)
    v_max3_u32 v4, v20, v21, v22
    v_max_u32 v4, v4, v23
    v_smfmac_f32_16x16x64_bf16 v[60:63], v[32:35], a[88:95], v9
    v_cmp_eq_u32 vcc, -1, v4
    v_smfmac_f32_16x16x64_bf16 v[64:67], v[32:35], a[120:127], v9
    s_cbranch_vccnz .A_73
.W_74:
    v_smfmac_f32_16x16x64_bf16 v[52:55], v[20:23], a[0:7], v9
    v_smfmac_f32_16x16x64_bf16 v[56:59], v[20:23], a[32:39], v9
    v_smfmac_f32_16x16x64_bf16 v[60:63], v[20:23], a[64:71], v9
    v_smfmac_f32_16x16x64_bf16 v[64:67], v[20:23], a[96:103], v9
    s_branch .mj_23
.W_60:
    v_smfmac_f32_16x16x64_bf16 v[52:55], v[28:31], a[16:23], v9
    v_smfmac_f32_16x16x64_bf16 v[56:59], v[28:31], a[48:55], v9
    s_waitcnt vmcnt(2)
    v_max3_u32 v4, v32, v33, v34
    v_max_u32 v4, v4, v35
    v_smfmac_f32_16x16x64_bf16 v[60:63], v[28:31], a[80:87], v9
    v_cmp_eq_u32 vcc, -1, v4
    v_smfmac_f32_16x16x64_bf16 v[64:67], v[28:31], a[112:119], v9
    s_cbranch_vccnz .A_75
.W_76:
    v_smfmac_f32_16x16x64_bf16 v[52:55], v[32:35], a[24:31], v9
    v_smfmac_f32_16x16x64_bf16 v[56:59], v[32:35], a[56:63], v9
    s_waitcnt vmcnt(1)
    v_max3_u32 v4, v20, v21, v22
    v_max_u32 v4, v4, v23
    v_smfmac_f32_16x16x64_bf16 v[60:63], v[32:35], a[88:95], v9
    v_cmp_eq_u32 vcc, -1, v4
    v_smfmac_f32_16x16x64_bf16 v[64:67], v[32:35], a[120:127], v9
    s_cbranch_vccnz .A_77
.W_78:
    v_smfmac_f32_16x16x64_bf16 v[52:55], v[20:23], a[0:7], v9
    v_smfmac_f32_16x16x64_bf16 v[56:59], v[20:23], a[32:39], v9
    s_waitcnt vmcnt(0)
    v_max3_u32 v4, v24, v25, v26
    v_max_u32 v4, v4, v27
    v_smfmac_f32_16x16x64_bf16 v[60:63], v[20:23], a[64:71], v9
    v_cmp_eq_u32 vcc, -1, v4
    v_smfmac_f32_16x16x64_bf16 v[64:67], v[20:23], a[96:103], v9
    s_cbranch_vccnz .A_79
.W_80:
    v_smfmac_f32_16x16x64_bf16 v[52:55], v[24:27], a[8:15], v9
    v_smfmac_f32_16x16x64_bf16 v[56:59], v[24:27], a[40:47], v9
    v_smfmac_f32_16x16x64_bf16 v[60:63], v[24:27], a[72:79], v9
    v_smfmac_f32_16x16x64_bf16 v[64:67], v[24:27], a[104:111], v9
    s_branch .mj_23
.A_81:
    buffer_load_dwordx4 v[28:31], v8, s[8:11], s29 offen offset:2048 sc1
    s_sub_u32 s62, s62, 1
    s_cbranch_scc1 .mg_end_1
    s_waitcnt vmcnt(2)
    v_max3_u32 v4, v20, v21, v22
    v_max_u32 v4, v4, v23
    v_cmp_eq_u32 vcc, -1, v4
    s_cbranch_vccz .W_64
.A_63:
    buffer_load_dwordx4 v[20:23], v8, s[8:11], s29 offen offset:0 sc1
    s_waitcnt vmcnt(2)
    v_max3_u32 v4, v24, v25, v26
    v_max_u32 v4, v4, v27
    v_cmp_eq_u32 vcc, -1, v4
    s_cbranch_vccz .W_82
.A_83:
    buffer_load_dwordx4 v[24:27], v8, s[8:11], s29 offen offset:1024 sc1
    s_waitcnt vmcnt(2)
    v_max3_u32 v4, v28, v29, v30
    v_max_u32 v4, v4, v31
    v_cmp_eq_u32 vcc, -1, v4
    s_cbranch_vccnz .A_81
.W_84:
    v_smfmac_f32_16x16x64_bf16 v[52:55], v[28:31], a[16:23], v9
    v_smfmac_f32_16x16x64_bf16 v[56:59], v[28:31], a[48:55], v9
    s_waitcnt vmcnt(1)
    v_max3_u32 v4, v20, v21, v22
    v_max_u32 v4, v4, v23
    v_smfmac_f32_16x16x64_bf16 v[60:63], v[28:31], a[80:87], v9
    v_cmp_eq_u32 vcc, -1, v4
    v_smfmac_f32_16x16x64_bf16 v[64:67], v[28:31], a[112:119], v9
    s_cbranch_vccz .W_78
    s_branch .A_77
.W_82:
    v_smfmac_f32_16x16x64_bf16 v[52:55], v[24:27], a[8:15], v9
    v_smfmac_f32_16x16x64_bf16 v[56:59], v[24:27], a[40:47], v9
    s_waitcnt vmcnt(1)
    v_max3_u32 v4, v28, v29, v30
    v_max_u32 v4, v4, v31
    v_smfmac_f32_16x16x64_bf16 v[60:63], v[24:27], a[72:79], v9
    v_cmp_eq_u32 vcc, -1, v4
    v_smfmac_f32_16x16x64_bf16 v[64:67], v[24:27], a[104:111], v9
    s_cbranch_vccnz .A_85
.W_86:
    v_smfmac_f32_16x16x64_bf16 v[52:55], v[28:31], a[16:23], v9
    v_smfmac_f32_16x16x64_bf16 v[56:59], v[28:31], a[48:55], v9
    s_waitcnt vmcnt(0)
    v_max3_u32 v4, v20, v21, v22
    v_max_u32 v4, v4, v23
    v_smfmac_f32_16x16x64_bf16 v[60:63], v[28:31], a[80:87], v9
    v_cmp_eq_u32 vcc, -1, v4
    v_smfmac_f32_16x16x64_bf16 v[64:67], v[28:31], a[112:119], v9
    s_cbranch_vccz .W_74
    s_branch .A_73
.A_87:
    buffer_load_dwordx4 v[24:27], v8, s[8:11], s29 offen offset:1024 sc1
    s_sub_u32 s62, s62, 1
    s_cbranch_scc1 .mg_end_1
    s_waitcnt vmcnt(2)
    v_max3_u32 v4, v32, v33, v34
    v_max_u32 v4, v4, v35
    v_cmp_eq_u32 vcc, -1, v4
    s_cbranch_vccz .W_76
.A_75:
    buffer_load_dwordx4 v[32:35], v8, s[8:11], s29 offen offset:3072 sc1
    s_waitcnt vmcnt(2)
    v_max3_u32 v4, v20, v21, v22
    v_max_u32 v4, v4, v23
    v_cmp_eq_u32 vcc, -1, v4
    s_cbranch_vccz .W_88
.A_89:
    buffer_load_dwordx4 v[20:23], v8, s[8:11], s29 offen offset:0 sc1
    s_waitcnt vmcnt(2)
    v_max3_u32 v4, v24, v25, v26
    v_max_u32 v4, v4, v27
    v_cmp_eq_u32 vcc, -1, v4
    s_cbranch_vccnz .A_87
.W_90:
    v_smfmac_f32_16x16x64_bf16 v[52:55], v[24:27], a[8:15], v9
    v_smfmac_f32_16x16x64_bf16 v[56:59], v[24:27], a[40:47], v9
    s_waitcnt vmcnt(1)
    v_max3_u32 v4, v32, v33, v34
    v_max_u32 v4, v4, v35
    v_smfmac_f32_16x16x64_bf16 v[60:63], v[24:27], a[72:79], v9
    v_cmp_eq_u32 vcc, -1, v4
    v_smfmac_f32_16x16x64_bf16 v[64:67], v[24:27], a[104:111], v9
    s_cbranch_vccz .W_72
    s_branch .A_71
.W_88:
    v_smfmac_f32_16x16x64_bf16 v[52:55], v[20:23], a[0:7], v9
    v_smfmac_f32_16x16x64_bf16 v[56:59], v[20:23], a[32:39], v9
    s_waitcnt vmcnt(1)
    v_max3_u32 v4, v24, v25, v26
    v_max_u32 v4, v4, v27
    v_smfmac_f32_16x16x64_bf16 v[60:63], v[20:23], a[64:71], v9
    v_cmp_eq_u32 vcc, -1, v4
    v_smfmac_f32_16x16x64_bf16 v[64:67], v[20:23], a[96:103], v9
    s_cbranch_vccnz .A_91
.W_92:
    v_smfmac_f32_16x16x64_bf16 v[52:55], v[24:27], a[8:15], v9
    v_smfmac_f32_16x16x64_bf16 v[56:59], v[24:27], a[40:47], v9
    s_waitcnt vmcnt(0)
    v_max3_u32 v4, v32, v33, v34
    v_max_u32 v4, v4, v35
    v_smfmac_f32_16x16x64_bf16 v[60:63], v[24:27], a[72:79], v9
    v_cmp_eq_u32 vcc, -1, v4
    v_smfmac_f32_16x16x64_bf16 v[64:67], v[24:27], a[104:111], v9
    s_cbranch_vccz .W_31
    s_branch .A_30
.A_93:
    buffer_load_dwordx4 v[32:35], v8, s[8:11], s29 offen offset:3072 sc1
    s_sub_u32 s62, s62, 1
    s_cbranch_scc1 .mg_end_1
    s_waitcnt vmcnt(2)
    v_max3_u32 v4, v20, v21, v22
    v_max_u32 v4, v4, v23
    v_cmp_eq_u32 vcc, -1, v4
    s_cbranch_vccz .W_94
.A_95:
    buffer_load_dwordx4 v[20:23], v8, s[8:11], s29 offen offset:0 sc1
    s_waitcnt vmcnt(2)
    v_max3_u32 v4, v28, v29, v30
    v_max_u32 v4, v4, v31
    v_cmp_eq_u32 vcc, -1, v4
    s_cbranch_vccz .W_70
.A_69:
    buffer_load_dwordx4 v[28:31], v8, s[8:11], s29 offen offset:2048 sc1
    s_waitcnt vmcnt(2)
    v_max3_u32 v4, v32, v33, v34
    v_max_u32 v4, v4, v35
    v_cmp_eq_u32 vcc, -1, v4
    s_cbranch_vccnz .A_93
.W_96:
    v_smfmac_f32_16x16x64_bf16 v[52:55], v[32:35], a[24:31], v9
    v_smfmac_f32_16x16x64_bf16 v[56:59], v[32:35], a[56:63], v9
    s_waitcnt vmcnt(1)
    v_max3_u32 v4, v20, v21, v22
    v_max_u32 v4, v4, v23
    v_smfmac_f32_16x16x64_bf16 v[60:63], v[32:35], a[88:95], v9
    v_cmp_eq_u32 vcc, -1, v4
    v_smfmac_f32_16x16x64_bf16 v[64:67], v[32:35], a[120:127], v9
    s_cbranch_vccnz .A_97
.W_98:
    v_smfmac_f32_16x16x64_bf16 v[52:55], v[20:23], a[0:7], v9
    v_smfmac_f32_16x16x64_bf16 v[56:59], v[20:23], a[32:39], v9
    s_waitcnt vmcnt(0)
    v_max3_u32 v4, v28, v29, v30
    v_max_u32 v4, v4, v31
    v_smfmac_f32_16x16x64_bf16 v[60:63], v[20:23], a[64:71], v9
    v_cmp_eq_u32 vcc, -1, v4
    v_smfmac_f32_16x16x64_bf16 v[64:67], v[20:23], a[96:103], v9
    s_cbranch_vccz .W_68
    s_branch .A_67
.W_94:
    v_smfmac_f32_16x16x64_bf16 v[52:55], v[20:23], a[0:7], v9
    v_smfmac_f32_16x16x64_bf16 v[56:59], v[20:23], a[32:39], v9
    s_waitcnt vmcnt(1)
    v_max3_u32 v4, v28, v29, v30
    v_max_u32 v4, v4, v31
    v_smfmac_f32_16x16x64_bf16 v[60:63], v[20:23], a[64:71], v9
    v_cmp_eq_u32 vcc, -1, v4
    v_smfmac_f32_16x16x64_bf16 v[64:67], v[20:23], a[96:103], v9
    s_cbranch_vccz .W_29
    s_branch .A_28
.A_99:
    buffer_load_dwordx4 v[32:35], v8, s[8:11], s29 offen offset:3072 sc1
    s_sub_u32 s62, s62, 1
    s_cbranch_scc1 .mg_end_1
    s_waitcnt vmcnt(2)
    v_max3_u32 v4, v24, v25, v26
    v_max_u32 v4, v4, v27
    v_cmp_eq_u32 vcc, -1, v4
    s_cbranch_vccz .W_27
.A_26:
    buffer_load_dwordx4 v[24:27], v8, s[8:11], s29 offen offset:1024 sc1
    s_waitcnt vmcnt(2)
    v_max3_u32 v4, v28, v29, v30
    v_max_u32 v4, v4, v31
    v_cmp_eq_u32 vcc, -1, v4
    s_cbranch_vccz .W_100
.A_101:
    buffer_load_dwordx4 v[28:31], v8, s[8:11], s29 offen offset:2048 sc1
    s_waitcnt vmcnt(2)
    v_max3_u32 v4, v32, v33, v34
    v_max_u32 v4, v4, v35
    v_cmp_eq_u32 vcc, -1, v4
    s_cbranch_vccnz .A_99
.W_102:
    v_smfmac_f32_16x16x64_bf16 v[52:55], v[32:35], a[24:31], v9
    v_smfmac_f32_16x16x64_bf16 v[56:59], v[32:35], a[56:63], v9
    s_waitcnt vmcnt(1)
    v_max3_u32 v4, v24, v25, v26
    v_max_u32 v4, v4, v27
    v_smfmac_f32_16x16x64_bf16 v[60:63], v[32:35], a[88:95], v9
    v_cmp_eq_u32 vcc, -1, v4
    v_smfmac_f32_16x16x64_bf16 v[64:67], v[32:35], a[120:127], v9
    s_cbranch_vccz .W_66
    s_branch .A_65
.W_100:
    v_smfmac_f32_16x16x64_bf16 v[52:55], v[28:31], a[16:23], v9
    v_smfmac_f32_16x16x64_bf16 v[56:59], v[28:31], a[48:55], v9
    s_waitcnt vmcnt(1)
    v_max3_u32 v4, v32, v33, v34
    v_max_u32 v4, v4, v35
    v_smfmac_f32_16x16x64_bf16 v[60:63], v[28:31], a[80:87], v9
    v_cmp_eq_u32 vcc, -1, v4
    v_smfmac_f32_16x16x64_bf16 v[64:67], v[28:31], a[112:119], v9
    s_cbranch_vccnz .A_103
.W_104:
    v_smfmac_f32_16x16x64_bf16 v[52:55], v[32:35], a[24:31], v9
    v_smfmac_f32_16x16x64_bf16 v[56:59], v[32:35], a[56:63], v9
    s_waitcnt vmcnt(0)
    v_max3_u32 v4, v24, v25, v26
    v_max_u32 v4, v4, v27
    v_smfmac_f32_16x16x64_bf16 v[60:63], v[32:35], a[88:95], v9
    v_cmp_eq_u32 vcc, -1, v4
    v_smfmac_f32_16x16x64_bf16 v[64:67], v[32:35], a[120:127], v9
    s_cbranch_vccz .W_80
    s_branch .A_79
.A_105:
    buffer_load_dwordx4 v[24:27], v8, s[8:11], s29 offen offset:1024 sc1
    s_sub_u32 s62, s62, 1
    s_cbranch_scc1 .mg_end_1
    s_waitcnt vmcnt(1)
    v_max3_u32 v4, v20, v21, v22
    v_max_u32 v4, v4, v23
    v_cmp_eq_u32 vcc, -1, v4
    s_cbranch_vccz .W_78
.A_77:
    buffer_load_dwordx4 v[20:23], v8, s[8:11], s29 offen offset:0 sc1
    s_waitcnt vmcnt(1)
    v_max3_u32 v4, v24, v25, v26
    v_max_u32 v4, v4, v27
    v_cmp_eq_u32 vcc, -1, v4
    s_cbranch_vccnz .A_105
.W_106:
    v_smfmac_f32_16x16x64_bf16 v[52:55], v[24:27], a[8:15], v9
    v_smfmac_f32_16x16x64_bf16 v[56:59], v[24:27], a[40:47], v9
    s_waitcnt vmcnt(0)
    v_max3_u32 v4, v20, v21, v22
    v_max_u32 v4, v4, v23
    v_smfmac_f32_16x16x64_bf16 v[60:63], v[24:27], a[72:79], v9
    v_cmp_eq_u32 vcc, -1, v4
    v_smfmac_f32_16x16x64_bf16 v[64:67], v[24:27], a[104:111], v9
    s_cbranch_vccz .W_74
    s_branch .A_73
.A_85:
    buffer_load_dwordx4 v[28:31], v8, s[8:11], s29 offen offset:2048 sc1
    s_sub_u32 s62, s62, 1
    s_cbranch_scc1 .mg_end_1
    s_waitcnt vmcnt(1)
    v_max3_u32 v4, v20, v21, v22
    v_max_u32 v4, v4, v23
    v_cmp_eq_u32 vcc, -1, v4
    s_cbranch_vccz .W_98
.A_97:
    buffer_load_dwordx4 v[20:23], v8, s[8:11], s29 offen offset:0 sc1
    s_waitcnt vmcnt(1)
    v_max3_u32 v4, v28, v29, v30
    v_max_u32 v4, v4, v31
    v_cmp_eq_u32 vcc, -1, v4
    s_cbranch_vccnz .A_85
    s_branch .W_86
.A_107:
    buffer_load_dwordx4 v[20:23], v8, s[8:11], s29 offen offset:0 sc1
    s_sub_u32 s62, s62, 1
    s_cbranch_scc1 .mg_end_1
    s_waitcnt vmcnt(1)
    v_max3_u32 v4, v32, v33, v34
    v_max_u32 v4, v4, v35
    v_cmp_eq_u32 vcc, -1, v4
    s_cbranch_vccz .W_72
.A_71:
    buffer_load_dwordx4 v[32:35], v8, s[8:11], s29 offen offset:3072 sc1
    s_waitcnt vmcnt(1)
    v_max3_u32 v4, v20, v21, v22
    v_max_u32 v4, v4, v23
    v_cmp_eq_u32 vcc, -1, v4
    s_cbranch_vccnz .A_107
.W_108:
    v_smfmac_f32_16x16x64_bf16 v[52:55], v[20:23], a[0:7], v9
    v_smfmac_f32_16x16x64_bf16 v[56:59], v[20:23], a[32:39], v9
    s_waitcnt vmcnt(0)
    v_max3_u32 v4, v32, v33, v34
    v_max_u32 v4, v4, v35
    v_smfmac_f32_16x16x64_bf16 v[60:63], v[20:23], a[64:71], v9
    v_cmp_eq_u32 vcc, -1, v4
    v_smfmac_f32_16x16x64_bf16 v[64:67], v[20:23], a[96:103], v9
    s_cbranch_vccz .W_31
    s_branch .A_30
.A_109:
    buffer_load_dwordx4 v[28:31], v8, s[8:11], s29 offen offset:2048 sc1
    s_sub_u32 s62, s62, 1
    s_cbranch_scc1 .mg_end_1
    s_waitcnt vmcnt(1)
    v_max3_u32 v4, v24, v25, v26
    v_max_u32 v4, v4, v27
    v_cmp_eq_u32 vcc, -1, v4
    s_cbranch_vccz .W_66
.A_65:
    buffer_load_dwordx4 v[24:27], v8, s[8:11], s29 offen offset:1024 sc1
    s_waitcnt vmcnt(1)
    v_max3_u32 v4, v28, v29, v30
    v_max_u32 v4, v4, v31
    v_cmp_eq_u32 vcc, -1, v4
    s_cbranch_vccnz .A_109
.W_110:
    v_smfmac_f32_16x16x64_bf16 v[52:55], v[28:31], a[16:23], v9
    v_smfmac_f32_16x16x64_bf16 v[56:59], v[28:31], a[48:55], v9
    s_waitcnt vmcnt(0)
    v_max3_u32 v4, v24, v25, v26
    v_max_u32 v4, v4, v27
    v_smfmac_f32_16x16x64_bf16 v[60:63], v[28:31], a[80:87], v9
    v_cmp_eq_u32 vcc, -1, v4
    v_smfmac_f32_16x16x64_bf16 v[64:67], v[28:31], a[112:119], v9
    s_cbranch_vccz .W_80
    s_branch .A_79
.A_103:
    buffer_load_dwordx4 v[32:35], v8, s[8:11], s29 offen offset:3072 sc1
    s_sub_u32 s62, s62, 1
    s_cbranch_scc1 .mg_end_1
    s_waitcnt vmcnt(1)
    v_max3_u32 v4, v24, v25, v26
    v_max_u32 v4, v4, v27
    v_cmp_eq_u32 vcc, -1, v4
    s_cbranch_vccz .W_92
.A_91:
    buffer_load_dwordx4 v[24:27], v8, s[8:11], s29 offen offset:1024 sc1
    s_waitcnt vmcnt(1)
    v_max3_u32 v4, v32, v33, v34
    v_max_u32 v4, v4, v35
    v_cmp_eq_u32 vcc, -1, v4
    s_cbranch_vccnz .A_103
    s_branch .W_104
.A_111:
    buffer_load_dwordx4 v[32:35], v8, s[8:11], s29 offen offset:3072 sc1
    s_sub_u32 s62, s62, 1
    s_cbranch_scc1 .mg_end_1
    s_waitcnt vmcnt(1)
    v_max3_u32 v4, v28, v29, v30
    v_max_u32 v4, v4, v31
    v_cmp_eq_u32 vcc, -1, v4
    s_cbranch_vccz .W_29
.A_28:
    buffer_load_dwordx4 v[28:31], v8, s[8:11], s29 offen offset:2048 sc1
    s_waitcnt vmcnt(1)
    v_max3_u32 v4, v32, v33, v34
    v_max_u32 v4, v4, v35
    v_cmp_eq_u32 vcc, -1, v4
    s_cbranch_vccnz .A_111
.W_112:
    v_smfmac_f32_16x16x64_bf16 v[52:55], v[32:35], a[24:31], v9
    v_smfmac_f32_16x16x64_bf16 v[56:59], v[32:35], a[56:63], v9
    s_waitcnt vmcnt(0)
    v_max3_u32 v4, v28, v29, v30
    v_max_u32 v4, v4, v31
    v_smfmac_f32_16x16x64_bf16 v[60:63], v[32:35], a[88:95], v9
    v_cmp_eq_u32 vcc, -1, v4
    v_smfmac_f32_16x16x64_bf16 v[64:67], v[32:35], a[120:127], v9
    s_cbranch_vccz .W_68
    s_branch .A_67
.A_73:
    buffer_load_dwordx4 v[20:23], v8, s[8:11], s29 offen offset:0 sc1
    s_sub_u32 s62, s62, 1
    s_cbranch_scc1 .mg_end_1
    s_waitcnt vmcnt(1)
    v_max3_u32 v4, v20, v21, v22
    v_max_u32 v4, v4, v23
    v_cmp_eq_u32 vcc, -1, v4
    s_cbranch_vccnz .A_73
    v_smfmac_f32_16x16x64_bf16 v[52:55], v[20:23], a[0:7], v9
    v_smfmac_f32_16x16x64_bf16 v[56:59], v[20:23], a[32:39], v9
    v_smfmac_f32_16x16x64_bf16 v[60:63], v[20:23], a[64:71], v9
    v_smfmac_f32_16x16x64_bf16 v[64:67], v[20:23], a[96:103], v9
    s_branch .mj_23
.A_79:
    buffer_load_dwordx4 v[24:27], v8, s[8:11], s29 offen offset:1024 sc1
    s_sub_u32 s62, s62, 1
    s_cbranch_scc1 .mg_end_1
    s_waitcnt vmcnt(1)
    v_max3_u32 v4, v24, v25, v26
    v_max_u32 v4, v4, v27
    v_cmp_eq_u32 vcc, -1, v4
    s_cbranch_vccnz .A_79
    v_smfmac_f32_16x16x64_bf16 v[52:55], v[24:27], a[8:15], v9
    v_smfmac_f32_16x16x64_bf16 v[56:59], v[24:27], a[40:47], v9
    v_smfmac_f32_16x16x64_bf16 v[60:63], v[24:27], a[72:79], v9
    v_smfmac_f32_16x16x64_bf16 v[64:67], v[24:27], a[104:111], v9
    s_branch .mj_23
.A_67:
    buffer_load_dwordx4 v[28:31], v8, s[8:11], s29 offen offset:2048 sc1
    s_sub_u32 s62, s62, 1
    s_cbranch_scc1 .mg_end_1
    s_waitcnt vmcnt(1)
    v_max3_u32 v4, v28, v29, v30
    v_max_u32 v4, v4, v31
    v_cmp_eq_u32 vcc, -1, v4
    s_cbranch_vccnz .A_67
    v_smfmac_f32_16x16x64_bf16 v[52:55], v[28:31], a[16:23], v9
    v_smfmac_f32_16x16x64_bf16 v[56:59], v[28:31], a[48:55], v9
    v_smfmac_f32_16x16x64_bf16 v[60:63], v[28:31], a[80:87], v9
    v_smfmac_f32_16x16x64_bf16 v[64:67], v[28:31], a[112:119], v9
    s_branch .mj_23
.A_30:
    buffer_load_dwordx4 v[32:35], v8, s[8:11], s29 offen offset:3072 sc1
    s_sub_u32 s62, s62, 1
    s_cbranch_scc1 .mg_end_1
    s_waitcnt vmcnt(1)
    v_max3_u32 v4, v32, v33, v34
    v_max_u32 v4, v4, v35
    v_cmp_eq_u32 vcc, -1, v4
    s_cbranch_vccnz .A_30
    v_smfmac_f32_16x16x64_bf16 v[52:55], v[32:35], a[24:31], v9
    v_smfmac_f32_16x16x64_bf16 v[56:59], v[32:35], a[56:63], v9
    v_smfmac_f32_16x16x64_bf16 v[60:63], v[32:35], a[88:95], v9
    v_smfmac_f32_16x16x64_bf16 v[64:67], v[32:35], a[120:127], v9
    s_branch .mj_23
.A_113:
    buffer_load_dwordx4 v[100:103], v234, s[8:11], s29 offen sc1
    s_sub_u32 s62, s62, 1
    s_cbranch_scc1 .mg_end_1
    s_waitcnt vmcnt(2)
    v_max3_u32 v4, v92, v93, v94
    v_max_u32 v4, v4, v95
    v_cmp_eq_u32 vcc, -1, v4
    s_cbranch_vccz .W_34
.A_33:
    buffer_load_dwordx4 v[92:95], v232, s[8:11], s29 offen sc1
    s_waitcnt vmcnt(2)
    v_max3_u32 v4, v96, v97, v98
    v_max_u32 v4, v4, v99
    v_cmp_eq_u32 vcc, -1, v4
    s_cbranch_vccz .W_114
.A_115:
    buffer_load_dwordx4 v[96:99], v233, s[8:11], s29 offen sc1
    s_waitcnt vmcnt(2)
    v_max3_u32 v4, v100, v101, v102
    v_max_u32 v4, v4, v103
    v_cmp_eq_u32 vcc, -1, v4
    s_cbranch_vccnz .A_113
.W_116:
    v_mfma_f32_16x16x32_bf16 v[208:211], v[140:143], v[100:103], v[208:211]
    s_waitcnt vmcnt(1)
    v_max3_u32 v4, v92, v93, v94
    v_max_u32 v4, v4, v95
    v_mfma_f32_16x16x32_bf16 v[212:215], v[156:159], v[100:103], v[212:215]
    v_cmp_eq_u32 vcc, -1, v4
    v_mfma_f32_16x16x32_bf16 v[216:219], v[100:103], v[100:103], v[216:219]
    s_cbranch_vccnz .A_117
.W_118:
    v_mfma_f32_16x16x32_bf16 v[208:211], v[132:135], v[92:95], v[208:211]
    s_waitcnt vmcnt(0)
    v_max3_u32 v4, v96, v97, v98
    v_max_u32 v4, v4, v99
    v_mfma_f32_16x16x32_bf16 v[212:215], v[148:151], v[92:95], v[212:215]
    v_cmp_eq_u32 vcc, -1, v4
    v_mfma_f32_16x16x32_bf16 v[216:219], v[92:95], v[92:95], v[216:219]
    s_cbranch_vccnz .A_119
.W_120:
    v_mfma_f32_16x16x32_bf16 v[208:211], v[136:139], v[96:99], v[208:211]
    v_mfma_f32_16x16x32_bf16 v[212:215], v[152:155], v[96:99], v[212:215]
    v_mfma_f32_16x16x32_bf16 v[216:219], v[96:99], v[96:99], v[216:219]
    s_branch .mj_32
.W_114:
    v_mfma_f32_16x16x32_bf16 v[208:211], v[136:139], v[96:99], v[208:211]
    s_waitcnt vmcnt(1)
    v_max3_u32 v4, v100, v101, v102
    v_max_u32 v4, v4, v103
    v_mfma_f32_16x16x32_bf16 v[212:215], v[152:155], v[96:99], v[212:215]
    v_cmp_eq_u32 vcc, -1, v4
    v_mfma_f32_16x16x32_bf16 v[216:219], v[96:99], v[96:99], v[216:219]
    s_cbranch_vccnz .A_121
.W_122:
    v_mfma_f32_16x16x32_bf16 v[208:211], v[140:143], v[100:103], v[208:211]
    s_waitcnt vmcnt(0)
    v_max3_u32 v4, v92, v93, v94
    v_max_u32 v4, v4, v95
    v_mfma_f32_16x16x32_bf16 v[212:215], v[156:159], v[100:103], v[212:215]
    v_cmp_eq_u32 vcc, -1, v4
    v_mfma_f32_16x16x32_bf16 v[216:219], v[100:103], v[100:103], v[216:219]
    s_cbranch_vccnz .A_123
.W_124:
    v_mfma_f32_16x16x32_bf16 v[208:211], v[132:135], v[92:95], v[208:211]
    v_mfma_f32_16x16x32_bf16 v[212:215], v[148:151], v[92:95], v[212:215]
    v_mfma_f32_16x16x32_bf16 v[216:219], v[92:95], v[92:95], v[216:219]
    s_branch .mj_32
.A_125:
    buffer_load_dwordx4 v[96:99], v233, s[8:11], s29 offen sc1
    s_sub_u32 s62, s62, 1
    s_cbranch_scc1 .mg_end_1
    s_waitcnt vmcnt(1)
    v_max3_u32 v4, v92, v93, v94
    v_max_u32 v4, v4, v95
    v_cmp_eq_u32 vcc, -1, v4
    s_cbranch_vccz .W_118
.A_117:
    buffer_load_dwordx4 v[92:95], v232, s[8:11], s29 offen sc1
    s_waitcnt vmcnt(1)
    v_max3_u32 v4, v96, v97, v98
    v_max_u32 v4, v4, v99
    v_cmp_eq_u32 vcc, -1, v4
    s_cbranch_vccnz .A_125
.W_126:
    v_mfma_f32_16x16x32_bf16 v[208:211], v[136:139], v[96:99], v[208:211]
    s_waitcnt vmcnt(0)
    v_max3_u32 v4, v92, v93, v94
    v_max_u32 v4, v4, v95
    v_mfma_f32_16x16x32_bf16 v[212:215], v[152:155], v[96:99], v[212:215]
    v_cmp_eq_u32 vcc, -1, v4
    v_mfma_f32_16x16x32_bf16 v[216:219], v[96:99], v[96:99], v[216:219]
    s_cbranch_vccz .W_124
    s_branch .A_123
.A_127:
    buffer_load_dwordx4 v[92:95], v232, s[8:11], s29 offen sc1
    s_sub_u32 s62, s62, 1
    s_cbranch_scc1 .mg_end_1
    s_waitcnt vmcnt(1)
    v_max3_u32 v4, v100, v101, v102
    v_max_u32 v4, v4, v103
    v_cmp_eq_u32 vcc, -1, v4
    s_cbranch_vccz .W_122
.A_121:
    buffer_load_dwordx4 v[100:103], v234, s[8:11], s29 offen sc1
    s_waitcnt vmcnt(1)
    v_max3_u32 v4, v92, v93, v94
    v_max_u32 v4, v4, v95
    v_cmp_eq_u32 vcc, -1, v4
    s_cbranch_vccnz .A_127
.W_128:
    v_mfma_f32_16x16x32_bf16 v[208:211], v[132:135], v[92:95], v[208:211]
    s_waitcnt vmcnt(0)
    v_max3_u32 v4, v100, v101, v102
    v_max_u32 v4, v4, v103
    v_mfma_f32_16x16x32_bf16 v[212:215], v[148:151], v[92:95], v[212:215]
    v_cmp_eq_u32 vcc, -1, v4
    v_mfma_f32_16x16x32_bf16 v[216:219], v[92:95], v[92:95], v[216:219]
    s_cbranch_vccz .W_38
    s_branch .A_37
.A_129:
    buffer_load_dwordx4 v[100:103], v234, s[8:11], s29 offen sc1
    s_sub_u32 s62, s62, 1
    s_cbranch_scc1 .mg_end_1
    s_waitcnt vmcnt(1)
    v_max3_u32 v4, v96, v97, v98
    v_max_u32 v4, v4, v99
    v_cmp_eq_u32 vcc, -1, v4
    s_cbranch_vccz .W_36
.A_35:
    buffer_load_dwordx4 v[96:99], v233, s[8:11], s29 offen sc1
    s_waitcnt vmcnt(1)
    v_max3_u32 v4, v100, v101, v102
    v_max_u32 v4, v4, v103
    v_cmp_eq_u32 vcc, -1, v4
    s_cbranch_vccnz .A_129
.W_130:
    v_mfma_f32_16x16x32_bf16 v[208:211], v[140:143], v[100:103], v[208:211]
    s_waitcnt vmcnt(0)
    v_max3_u32 v4, v96, v97, v98
    v_max_u32 v4, v4, v99
    v_mfma_f32_16x16x32_bf16 v[212:215], v[156:159], v[100:103], v[212:215]
    v_cmp_eq_u32 vcc, -1, v4
    v_mfma_f32_16x16x32_bf16 v[216:219], v[100:103], v[100:103], v[216:219]
    s_cbranch_vccz .W_120
    s_branch .A_119
.A_123:
    buffer_load_dwordx4 v[92:95], v232, s[8:11], s29 offen sc1
    s_sub_u32 s62, s62, 1
    s_cbranch_scc1 .mg_end_1
    s_waitcnt vmcnt(1)
    v_max3_u32 v4, v92, v93, v94
    v_max_u32 v4, v4, v95
    v_cmp_eq_u32 vcc, -1, v4
    s_cbranch_vccnz .A_123
    v_mfma_f32_16x16x32_bf16 v[208:211], v[132:135], v[92:95], v[208:211]
    v_mfma_f32_16x16x32_bf16 v[212:215], v[148:151], v[92:95], v[212:215]
    v_mfma_f32_16x16x32_bf16 v[216:219], v[92:95], v[92:95], v[216:219]
    s_branch .mj_32
.A_119:
    buffer_load_dwordx4 v[96:99], v233, s[8:11], s29 offen sc1
    s_sub_u32 s62, s62, 1
    s_cbranch_scc1 .mg_end_1
    s_waitcnt vmcnt(1)
    v_max3_u32 v4, v96, v97, v98
    v_max_u32 v4, v4, v99
    v_cmp_eq_u32 vcc, -1, v4
    s_cbranch_vccnz .A_119
    v_mfma_f32_16x16x32_bf16 v[208:211], v[136:139], v[96:99], v[208:211]
    v_mfma_f32_16x16x32_bf16 v[212:215], v[152:155], v[96:99], v[212:215]
    v_mfma_f32_16x16x32_bf16 v[216:219], v[96:99], v[96:99], v[216:219]
    s_branch .mj_32
.A_37:
    buffer_load_dwordx4 v[100:103], v234, s[8:11], s29 offen sc1
    s_sub_u32 s62, s62, 1
    s_cbranch_scc1 .mg_end_1
    s_waitcnt vmcnt(1)
    v_max3_u32 v4, v100, v101, v102
    v_max_u32 v4, v4, v103
    v_cmp_eq_u32 vcc, -1, v4
    s_cbranch_vccnz .A_37
    v_mfma_f32_16x16x32_bf16 v[208:211], v[140:143], v[100:103], v[208:211]
    v_mfma_f32_16x16x32_bf16 v[212:215], v[156:159], v[100:103], v[212:215]
    v_mfma_f32_16x16x32_bf16 v[216:219], v[100:103], v[100:103], v[216:219]
    s_branch .mj_32
.kf_44:
    s_mov_b32 s62, 0
    s_mov_b64 exec, 3
.wf_131:
    buffer_load_dword v244, v253, s[8:11], s89 offen sc1
    s_waitcnt vmcnt(0)
    v_cmp_gt_u32 vcc, s6, v244
    s_cbranch_vccz .wfd_132
    s_sleep 2
    s_add_u32 s62, s62, 1
    s_cmp_gt_u32 s62, 0x400000
    s_cbranch_scc1 .mg_end_1
    s_branch .wf_131

.wfd_132:
    s_mov_b64 exec, -1
    v_readlane_b32 s4, v244, 0
    v_readlane_b32 s93, v244, 1
    s_min_u32 s93, s93, s4
    s_mov_b32 s62, 0x1000000
    s_branch .kb_45
.A_133:
    buffer_load_dwordx4 v[216:219], v246, s[8:11], s33 offen offset:2048 sc1
    buffer_load_dwordx4 v[220:223], v246, s[8:11], s33 offen offset:3072 sc1
    s_sub_u32 s62, s62, 1
    s_cbranch_scc1 .mg_end_1
    s_waitcnt vmcnt(6)
    v_max3_u32 v4, v192, v193, v194
    v_max3_u32 v5, v195, v196, v197
    v_max3_u32 v4, v4, v198, v199
    v_max_u32 v4, v4, v5
    v_cmp_eq_u32 vcc, -1, v4
    s_cbranch_vccz .W_49
.A_48:
    buffer_load_dwordx4 v[192:195], v246, s[8:11], s32 offen offset:0 sc1
    buffer_load_dwordx4 v[196:199], v246, s[8:11], s32 offen offset:1024 sc1
    s_waitcnt vmcnt(6)
    v_max3_u32 v4, v200, v201, v202
    v_max3_u32 v5, v203, v204, v205
    v_max3_u32 v4, v4, v206, v207
    v_max_u32 v4, v4, v5
    v_cmp_eq_u32 vcc, -1, v4
    s_cbranch_vccz .W_134
.A_135:
    buffer_load_dwordx4 v[200:203], v246, s[8:11], s32 offen offset:2048 sc1
    buffer_load_dwordx4 v[204:207], v246, s[8:11], s32 offen offset:3072 sc1
    s_waitcnt vmcnt(6)
    v_max3_u32 v4, v208, v209, v210
    v_max3_u32 v5, v211, v212, v213
    v_max3_u32 v4, v4, v214, v215
    v_max_u32 v4, v4, v5
    v_cmp_eq_u32 vcc, -1, v4
    s_cbranch_vccz .W_136
.A_137:
    buffer_load_dwordx4 v[208:211], v246, s[8:11], s33 offen offset:0 sc1
    buffer_load_dwordx4 v[212:215], v246, s[8:11], s33 offen offset:1024 sc1
    s_waitcnt vmcnt(6)
    v_max3_u32 v4, v216, v217, v218
    v_max3_u32 v5, v219, v220, v221
    v_max3_u32 v4, v4, v222, v223
    v_max_u32 v4, v4, v5
    v_cmp_eq_u32 vcc, -1, v4
    s_cbranch_vccnz .A_133
.W_138:
    v_smfmac_f32_16x16x64_bf16 v[76:79], v[216:219], v[140:147], v9
    v_smfmac_f32_16x16x64_bf16 v[80:83], v[216:219], v[172:179], v9
    s_waitcnt vmcnt(4)
    v_max3_u32 v4, v192, v193, v194
    v_max3_u32 v5, v195, v196, v197
    v_max3_u32 v4, v4, v198, v199
    v_smfmac_f32_16x16x64_bf16 v[76:79], v[220:223], v[148:155], v9
    v_max_u32 v4, v4, v5
    v_cmp_eq_u32 vcc, -1, v4
    v_smfmac_f32_16x16x64_bf16 v[80:83], v[220:223], v[180:187], v9
    s_cbranch_vccnz .A_139
.W_140:
    v_smfmac_f32_16x16x64_bf16 v[76:79], v[192:195], a[192:199], v9
    v_smfmac_f32_16x16x64_bf16 v[80:83], v[192:195], a[224:231], v9
    s_waitcnt vmcnt(2)
    v_max3_u32 v4, v200, v201, v202
    v_max3_u32 v5, v203, v204, v205
    v_max3_u32 v4, v4, v206, v207
    v_smfmac_f32_16x16x64_bf16 v[76:79], v[196:199], a[200:207], v9
    v_max_u32 v4, v4, v5
    v_cmp_eq_u32 vcc, -1, v4
    v_smfmac_f32_16x16x64_bf16 v[80:83], v[196:199], a[232:239], v9
    s_cbranch_vccnz .A_141
.W_142:
    v_smfmac_f32_16x16x64_bf16 v[76:79], v[200:203], a[208:215], v9
    v_smfmac_f32_16x16x64_bf16 v[80:83], v[200:203], a[240:247], v9
    s_waitcnt vmcnt(0)
    v_max3_u32 v4, v208, v209, v210
    v_max3_u32 v5, v211, v212, v213
    v_max3_u32 v4, v4, v214, v215
    v_smfmac_f32_16x16x64_bf16 v[76:79], v[204:207], a[216:223], v9
    v_max_u32 v4, v4, v5
    v_cmp_eq_u32 vcc, -1, v4
    v_smfmac_f32_16x16x64_bf16 v[80:83], v[204:207], a[248:255], v9
    s_cbranch_vccnz .A_143
.W_144:
    v_smfmac_f32_16x16x64_bf16 v[76:79], v[208:211], v[124:131], v9
    v_smfmac_f32_16x16x64_bf16 v[80:83], v[208:211], v[156:163], v9
    v_smfmac_f32_16x16x64_bf16 v[76:79], v[212:215], v[132:139], v9
    v_smfmac_f32_16x16x64_bf16 v[80:83], v[212:215], v[164:171], v9
    s_branch .mj_47
.W_134:
    v_smfmac_f32_16x16x64_bf16 v[76:79], v[200:203], a[208:215], v9
    v_smfmac_f32_16x16x64_bf16 v[80:83], v[200:203], a[240:247], v9
    s_waitcnt vmcnt(4)
    v_max3_u32 v4, v208, v209, v210
    v_max3_u32 v5, v211, v212, v213
    v_max3_u32 v4, v4, v214, v215
    v_smfmac_f32_16x16x64_bf16 v[76:79], v[204:207], a[216:223], v9
    v_max_u32 v4, v4, v5
    v_cmp_eq_u32 vcc, -1, v4
    v_smfmac_f32_16x16x64_bf16 v[80:83], v[204:207], a[248:255], v9
    s_cbranch_vccnz .A_145
.W_146:
    v_smfmac_f32_16x16x64_bf16 v[76:79], v[208:211], v[124:131], v9
    v_smfmac_f32_16x16x64_bf16 v[80:83], v[208:211], v[156:163], v9
    s_waitcnt vmcnt(2)
    v_max3_u32 v4, v216, v217, v218
    v_max3_u32 v5, v219, v220, v221
    v_max3_u32 v4, v4, v222, v223
    v_smfmac_f32_16x16x64_bf16 v[76:79], v[212:215], v[132:139], v9
    v_max_u32 v4, v4, v5
    v_cmp_eq_u32 vcc, -1, v4
    v_smfmac_f32_16x16x64_bf16 v[80:83], v[212:215], v[164:171], v9
    s_cbranch_vccnz .A_147
.W_148:
    v_smfmac_f32_16x16x64_bf16 v[76:79], v[216:219], v[140:147], v9
    v_smfmac_f32_16x16x64_bf16 v[80:83], v[216:219], v[172:179], v9
    s_waitcnt vmcnt(0)
    v_max3_u32 v4, v192, v193, v194
    v_max3_u32 v5, v195, v196, v197
    v_max3_u32 v4, v4, v198, v199
    v_smfmac_f32_16x16x64_bf16 v[76:79], v[220:223], v[148:155], v9
    v_max_u32 v4, v4, v5
    v_cmp_eq_u32 vcc, -1, v4
    v_smfmac_f32_16x16x64_bf16 v[80:83], v[220:223], v[180:187], v9
    s_cbranch_vccnz .A_149
.W_150:
    v_smfmac_f32_16x16x64_bf16 v[76:79], v[192:195], a[192:199], v9
    v_smfmac_f32_16x16x64_bf16 v[80:83], v[192:195], a[224:231], v9
    v_smfmac_f32_16x16x64_bf16 v[76:79], v[196:199], a[200:207], v9
    v_smfmac_f32_16x16x64_bf16 v[80:83], v[196:199], a[232:239], v9
    s_branch .mj_47
.W_136:
    v_smfmac_f32_16x16x64_bf16 v[76:79], v[208:211], v[124:131], v9
    v_smfmac_f32_16x16x64_bf16 v[80:83], v[208:211], v[156:163], v9
    s_waitcnt vmcnt(4)
    v_max3_u32 v4, v216, v217, v218
    v_max3_u32 v5, v219, v220, v221
    v_max3_u32 v4, v4, v222, v223
    v_smfmac_f32_16x16x64_bf16 v[76:79], v[212:215], v[132:139], v9
    v_max_u32 v4, v4, v5
    v_cmp_eq_u32 vcc, -1, v4
    v_smfmac_f32_16x16x64_bf16 v[80:83], v[212:215], v[164:171], v9
    s_cbranch_vccnz .A_151
.W_152:
    v_smfmac_f32_16x16x64_bf16 v[76:79], v[216:219], v[140:147], v9
    v_smfmac_f32_16x16x64_bf16 v[80:83], v[216:219], v[172:179], v9
    s_waitcnt vmcnt(2)
    v_max3_u32 v4, v192, v193, v194
    v_max3_u32 v5, v195, v196, v197
    v_max3_u32 v4, v4, v198, v199
    v_smfmac_f32_16x16x64_bf16 v[76:79], v[220:223], v[148:155], v9
    v_max_u32 v4, v4, v5
    v_cmp_eq_u32 vcc, -1, v4
    v_smfmac_f32_16x16x64_bf16 v[80:83], v[220:223], v[180:187], v9
    s_cbranch_vccnz .A_153
.W_154:
    v_smfmac_f32_16x16x64_bf16 v[76:79], v[192:195], a[192:199], v9
    v_smfmac_f32_16x16x64_bf16 v[80:83], v[192:195], a[224:231], v9
    s_waitcnt vmcnt(0)
    v_max3_u32 v4, v200, v201, v202
    v_max3_u32 v5, v203, v204, v205
    v_max3_u32 v4, v4, v206, v207
    v_smfmac_f32_16x16x64_bf16 v[76:79], v[196:199], a[200:207], v9
    v_max_u32 v4, v4, v5
    v_cmp_eq_u32 vcc, -1, v4
    v_smfmac_f32_16x16x64_bf16 v[80:83], v[196:199], a[232:239], v9
    s_cbranch_vccnz .A_155
.W_156:
    v_smfmac_f32_16x16x64_bf16 v[76:79], v[200:203], a[208:215], v9
    v_smfmac_f32_16x16x64_bf16 v[80:83], v[200:203], a[240:247], v9
    v_smfmac_f32_16x16x64_bf16 v[76:79], v[204:207], a[216:223], v9
    v_smfmac_f32_16x16x64_bf16 v[80:83], v[204:207], a[248:255], v9
    s_branch .mj_47
.A_157:
    buffer_load_dwordx4 v[208:211], v246, s[8:11], s33 offen offset:0 sc1
    buffer_load_dwordx4 v[212:215], v246, s[8:11], s33 offen offset:1024 sc1
    s_sub_u32 s62, s62, 1
    s_cbranch_scc1 .mg_end_1
    s_waitcnt vmcnt(4)
    v_max3_u32 v4, v192, v193, v194
    v_max3_u32 v5, v195, v196, v197
    v_max3_u32 v4, v4, v198, v199
    v_max_u32 v4, v4, v5
    v_cmp_eq_u32 vcc, -1, v4
    s_cbranch_vccz .W_140
.A_139:
    buffer_load_dwordx4 v[192:195], v246, s[8:11], s32 offen offset:0 sc1
    buffer_load_dwordx4 v[196:199], v246, s[8:11], s32 offen offset:1024 sc1
    s_waitcnt vmcnt(4)
    v_max3_u32 v4, v200, v201, v202
    v_max3_u32 v5, v203, v204, v205
    v_max3_u32 v4, v4, v206, v207
    v_max_u32 v4, v4, v5
    v_cmp_eq_u32 vcc, -1, v4
    s_cbranch_vccz .W_158
.A_159:
    buffer_load_dwordx4 v[200:203], v246, s[8:11], s32 offen offset:2048 sc1
    buffer_load_dwordx4 v[204:207], v246, s[8:11], s32 offen offset:3072 sc1
    s_waitcnt vmcnt(4)
    v_max3_u32 v4, v208, v209, v210
    v_max3_u32 v5, v211, v212, v213
    v_max3_u32 v4, v4, v214, v215
    v_max_u32 v4, v4, v5
    v_cmp_eq_u32 vcc, -1, v4
    s_cbranch_vccnz .A_157
.W_160:
    v_smfmac_f32_16x16x64_bf16 v[76:79], v[208:211], v[124:131], v9
    v_smfmac_f32_16x16x64_bf16 v[80:83], v[208:211], v[156:163], v9
    s_waitcnt vmcnt(2)
    v_max3_u32 v4, v192, v193, v194
    v_max3_u32 v5, v195, v196, v197
    v_max3_u32 v4, v4, v198, v199
    v_smfmac_f32_16x16x64_bf16 v[76:79], v[212:215], v[132:139], v9
    v_max_u32 v4, v4, v5
    v_cmp_eq_u32 vcc, -1, v4
    v_smfmac_f32_16x16x64_bf16 v[80:83], v[212:215], v[164:171], v9
    s_cbranch_vccz .W_154
    s_branch .A_153
.W_158:
    v_smfmac_f32_16x16x64_bf16 v[76:79], v[200:203], a[208:215], v9
    v_smfmac_f32_16x16x64_bf16 v[80:83], v[200:203], a[240:247], v9
    s_waitcnt vmcnt(2)
    v_max3_u32 v4, v208, v209, v210
    v_max3_u32 v5, v211, v212, v213
    v_max3_u32 v4, v4, v214, v215
    v_smfmac_f32_16x16x64_bf16 v[76:79], v[204:207], a[216:223], v9
    v_max_u32 v4, v4, v5
    v_cmp_eq_u32 vcc, -1, v4
    v_smfmac_f32_16x16x64_bf16 v[80:83], v[204:207], a[248:255], v9
    s_cbranch_vccnz .A_161
.W_162:
    v_smfmac_f32_16x16x64_bf16 v[76:79], v[208:211], v[124:131], v9
    v_smfmac_f32_16x16x64_bf16 v[80:83], v[208:211], v[156:163], v9
    s_waitcnt vmcnt(0)
    v_max3_u32 v4, v192, v193, v194
    v_max3_u32 v5, v195, v196, v197
    v_max3_u32 v4, v4, v198, v199
    v_smfmac_f32_16x16x64_bf16 v[76:79], v[212:215], v[132:139], v9
    v_max_u32 v4, v4, v5
    v_cmp_eq_u32 vcc, -1, v4
    v_smfmac_f32_16x16x64_bf16 v[80:83], v[212:215], v[164:171], v9
    s_cbranch_vccz .W_150
    s_branch .A_149
.A_163:
    buffer_load_dwordx4 v[200:203], v246, s[8:11], s32 offen offset:2048 sc1
    buffer_load_dwordx4 v[204:207], v246, s[8:11], s32 offen offset:3072 sc1
    s_sub_u32 s62, s62, 1
    s_cbranch_scc1 .mg_end_1
    s_waitcnt vmcnt(4)
    v_max3_u32 v4, v216, v217, v218
    v_max3_u32 v5, v219, v220, v221
    v_max3_u32 v4, v4, v222, v223
    v_max_u32 v4, v4, v5
    v_cmp_eq_u32 vcc, -1, v4
    s_cbranch_vccz .W_152
.A_151:
    buffer_load_dwordx4 v[216:219], v246, s[8:11], s33 offen offset:2048 sc1
    buffer_load_dwordx4 v[220:223], v246, s[8:11], s33 offen offset:3072 sc1
    s_waitcnt vmcnt(4)
    v_max3_u32 v4, v192, v193, v194
    v_max3_u32 v5, v195, v196, v197
    v_max3_u32 v4, v4, v198, v199
    v_max_u32 v4, v4, v5
    v_cmp_eq_u32 vcc, -1, v4
    s_cbranch_vccz .W_164
.A_165:
    buffer_load_dwordx4 v[192:195], v246, s[8:11], s32 offen offset:0 sc1
    buffer_load_dwordx4 v[196:199], v246, s[8:11], s32 offen offset:1024 sc1
    s_waitcnt vmcnt(4)
    v_max3_u32 v4, v200, v201, v202
    v_max3_u32 v5, v203, v204, v205
    v_max3_u32 v4, v4, v206, v207
    v_max_u32 v4, v4, v5
    v_cmp_eq_u32 vcc, -1, v4
    s_cbranch_vccnz .A_163
.W_166:
    v_smfmac_f32_16x16x64_bf16 v[76:79], v[200:203], a[208:215], v9
    v_smfmac_f32_16x16x64_bf16 v[80:83], v[200:203], a[240:247], v9
    s_waitcnt vmcnt(2)
    v_max3_u32 v4, v216, v217, v218
    v_max3_u32 v5, v219, v220, v221
    v_max3_u32 v4, v4, v222, v223
    v_smfmac_f32_16x16x64_bf16 v[76:79], v[204:207], a[216:223], v9
    v_max_u32 v4, v4, v5
    v_cmp_eq_u32 vcc, -1, v4
    v_smfmac_f32_16x16x64_bf16 v[80:83], v[204:207], a[248:255], v9
    s_cbranch_vccz .W_148
    s_branch .A_147
.W_164:
    v_smfmac_f32_16x16x64_bf16 v[76:79], v[192:195], a[192:199], v9
    v_smfmac_f32_16x16x64_bf16 v[80:83], v[192:195], a[224:231], v9
    s_waitcnt vmcnt(2)
    v_max3_u32 v4, v200, v201, v202
    v_max3_u32 v5, v203, v204, v205
    v_max3_u32 v4, v4, v206, v207
    v_smfmac_f32_16x16x64_bf16 v[76:79], v[196:199], a[200:207], v9
    v_max_u32 v4, v4, v5
    v_cmp_eq_u32 vcc, -1, v4
    v_smfmac_f32_16x16x64_bf16 v[80:83], v[196:199], a[232:239], v9
    s_cbranch_vccnz .A_167
.W_168:
    v_smfmac_f32_16x16x64_bf16 v[76:79], v[200:203], a[208:215], v9
    v_smfmac_f32_16x16x64_bf16 v[80:83], v[200:203], a[240:247], v9
    s_waitcnt vmcnt(0)
    v_max3_u32 v4, v216, v217, v218
    v_max3_u32 v5, v219, v220, v221
    v_max3_u32 v4, v4, v222, v223
    v_smfmac_f32_16x16x64_bf16 v[76:79], v[204:207], a[216:223], v9
    v_max_u32 v4, v4, v5
    v_cmp_eq_u32 vcc, -1, v4
    v_smfmac_f32_16x16x64_bf16 v[80:83], v[204:207], a[248:255], v9
    s_cbranch_vccz .W_55
    s_branch .A_54
.A_169:
    buffer_load_dwordx4 v[216:219], v246, s[8:11], s33 offen offset:2048 sc1
    buffer_load_dwordx4 v[220:223], v246, s[8:11], s33 offen offset:3072 sc1
    s_sub_u32 s62, s62, 1
    s_cbranch_scc1 .mg_end_1
    s_waitcnt vmcnt(4)
    v_max3_u32 v4, v192, v193, v194
    v_max3_u32 v5, v195, v196, v197
    v_max3_u32 v4, v4, v198, v199
    v_max_u32 v4, v4, v5
    v_cmp_eq_u32 vcc, -1, v4
    s_cbranch_vccz .W_170
.A_171:
    buffer_load_dwordx4 v[192:195], v246, s[8:11], s32 offen offset:0 sc1
    buffer_load_dwordx4 v[196:199], v246, s[8:11], s32 offen offset:1024 sc1
    s_waitcnt vmcnt(4)
    v_max3_u32 v4, v208, v209, v210
    v_max3_u32 v5, v211, v212, v213
    v_max3_u32 v4, v4, v214, v215
    v_max_u32 v4, v4, v5
    v_cmp_eq_u32 vcc, -1, v4
    s_cbranch_vccz .W_146
.A_145:
    buffer_load_dwordx4 v[208:211], v246, s[8:11], s33 offen offset:0 sc1
    buffer_load_dwordx4 v[212:215], v246, s[8:11], s33 offen offset:1024 sc1
    s_waitcnt vmcnt(4)
    v_max3_u32 v4, v216, v217, v218
    v_max3_u32 v5, v219, v220, v221
    v_max3_u32 v4, v4, v222, v223
    v_max_u32 v4, v4, v5
    v_cmp_eq_u32 vcc, -1, v4
    s_cbranch_vccnz .A_169
.W_172:
    v_smfmac_f32_16x16x64_bf16 v[76:79], v[216:219], v[140:147], v9
    v_smfmac_f32_16x16x64_bf16 v[80:83], v[216:219], v[172:179], v9
    s_waitcnt vmcnt(2)
    v_max3_u32 v4, v192, v193, v194
    v_max3_u32 v5, v195, v196, v197
    v_max3_u32 v4, v4, v198, v199
    v_smfmac_f32_16x16x64_bf16 v[76:79], v[220:223], v[148:155], v9
    v_max_u32 v4, v4, v5
    v_cmp_eq_u32 vcc, -1, v4
    v_smfmac_f32_16x16x64_bf16 v[80:83], v[220:223], v[180:187], v9
    s_cbranch_vccnz .A_173
.W_174:
    v_smfmac_f32_16x16x64_bf16 v[76:79], v[192:195], a[192:199], v9
    v_smfmac_f32_16x16x64_bf16 v[80:83], v[192:195], a[224:231], v9
    s_waitcnt vmcnt(0)
    v_max3_u32 v4, v208, v209, v210
    v_max3_u32 v5, v211, v212, v213
    v_max3_u32 v4, v4, v214, v215
    v_smfmac_f32_16x16x64_bf16 v[76:79], v[196:199], a[200:207], v9
    v_max_u32 v4, v4, v5
    v_cmp_eq_u32 vcc, -1, v4
    v_smfmac_f32_16x16x64_bf16 v[80:83], v[196:199], a[232:239], v9
    s_cbranch_vccz .W_144
    s_branch .A_143
.W_170:
    v_smfmac_f32_16x16x64_bf16 v[76:79], v[192:195], a[192:199], v9
    v_smfmac_f32_16x16x64_bf16 v[80:83], v[192:195], a[224:231], v9
    s_waitcnt vmcnt(2)
    v_max3_u32 v4, v208, v209, v210
    v_max3_u32 v5, v211, v212, v213
    v_max3_u32 v4, v4, v214, v215
    v_smfmac_f32_16x16x64_bf16 v[76:79], v[196:199], a[200:207], v9
    v_max_u32 v4, v4, v5
    v_cmp_eq_u32 vcc, -1, v4
    v_smfmac_f32_16x16x64_bf16 v[80:83], v[196:199], a[232:239], v9
    s_cbranch_vccz .W_53
    s_branch .A_52
.A_175:
    buffer_load_dwordx4 v[216:219], v246, s[8:11], s33 offen offset:2048 sc1
    buffer_load_dwordx4 v[220:223], v246, s[8:11], s33 offen offset:3072 sc1
    s_sub_u32 s62, s62, 1
    s_cbranch_scc1 .mg_end_1
    s_waitcnt vmcnt(4)
    v_max3_u32 v4, v200, v201, v202
    v_max3_u32 v5, v203, v204, v205
    v_max3_u32 v4, v4, v206, v207
    v_max_u32 v4, v4, v5
    v_cmp_eq_u32 vcc, -1, v4
    s_cbranch_vccz .W_51
.A_50:
    buffer_load_dwordx4 v[200:203], v246, s[8:11], s32 offen offset:2048 sc1
    buffer_load_dwordx4 v[204:207], v246, s[8:11], s32 offen offset:3072 sc1
    s_waitcnt vmcnt(4)
    v_max3_u32 v4, v208, v209, v210
    v_max3_u32 v5, v211, v212, v213
    v_max3_u32 v4, v4, v214, v215
    v_max_u32 v4, v4, v5
    v_cmp_eq_u32 vcc, -1, v4
    s_cbranch_vccz .W_176
.A_177:
    buffer_load_dwordx4 v[208:211], v246, s[8:11], s33 offen offset:0 sc1
    buffer_load_dwordx4 v[212:215], v246, s[8:11], s33 offen offset:1024 sc1
    s_waitcnt vmcnt(4)
    v_max3_u32 v4, v216, v217, v218
    v_max3_u32 v5, v219, v220, v221
    v_max3_u32 v4, v4, v222, v223
    v_max_u32 v4, v4, v5
    v_cmp_eq_u32 vcc, -1, v4
    s_cbranch_vccnz .A_175
.W_178:
    v_smfmac_f32_16x16x64_bf16 v[76:79], v[216:219], v[140:147], v9
    v_smfmac_f32_16x16x64_bf16 v[80:83], v[216:219], v[172:179], v9
    s_waitcnt vmcnt(2)
    v_max3_u32 v4, v200, v201, v202
    v_max3_u32 v5, v203, v204, v205
    v_max3_u32 v4, v4, v206, v207
    v_smfmac_f32_16x16x64_bf16 v[76:79], v[220:223], v[148:155], v9
    v_max_u32 v4, v4, v5
    v_cmp_eq_u32 vcc, -1, v4
    v_smfmac_f32_16x16x64_bf16 v[80:83], v[220:223], v[180:187], v9
    s_cbranch_vccz .W_142
    s_branch .A_141
.W_176:
    v_smfmac_f32_16x16x64_bf16 v[76:79], v[208:211], v[124:131], v9
    v_smfmac_f32_16x16x64_bf16 v[80:83], v[208:211], v[156:163], v9
    s_waitcnt vmcnt(2)
    v_max3_u32 v4, v216, v217, v218
    v_max3_u32 v5, v219, v220, v221
    v_max3_u32 v4, v4, v222, v223
    v_smfmac_f32_16x16x64_bf16 v[76:79], v[212:215], v[132:139], v9
    v_max_u32 v4, v4, v5
    v_cmp_eq_u32 vcc, -1, v4
    v_smfmac_f32_16x16x64_bf16 v[80:83], v[212:215], v[164:171], v9
    s_cbranch_vccnz .A_179
.W_180:
    v_smfmac_f32_16x16x64_bf16 v[76:79], v[216:219], v[140:147], v9
    v_smfmac_f32_16x16x64_bf16 v[80:83], v[216:219], v[172:179], v9
    s_waitcnt vmcnt(0)
    v_max3_u32 v4, v200, v201, v202
    v_max3_u32 v5, v203, v204, v205
    v_max3_u32 v4, v4, v206, v207
    v_smfmac_f32_16x16x64_bf16 v[76:79], v[220:223], v[148:155], v9
    v_max_u32 v4, v4, v5
    v_cmp_eq_u32 vcc, -1, v4
    v_smfmac_f32_16x16x64_bf16 v[80:83], v[220:223], v[180:187], v9
    s_cbranch_vccz .W_156
    s_branch .A_155
.A_181:
    buffer_load_dwordx4 v[200:203], v246, s[8:11], s32 offen offset:2048 sc1
    buffer_load_dwordx4 v[204:207], v246, s[8:11], s32 offen offset:3072 sc1
    s_sub_u32 s62, s62, 1
    s_cbranch_scc1 .mg_end_1
    s_waitcnt vmcnt(2)
    v_max3_u32 v4, v192, v193, v194
    v_max3_u32 v5, v195, v196, v197
    v_max3_u32 v4, v4, v198, v199
    v_max_u32 v4, v4, v5
    v_cmp_eq_u32 vcc, -1, v4
    s_cbranch_vccz .W_154
.A_153:
    buffer_load_dwordx4 v[192:195], v246, s[8:11], s32 offen offset:0 sc1
    buffer_load_dwordx4 v[196:199], v246, s[8:11], s32 offen offset:1024 sc1
    s_waitcnt vmcnt(2)
    v_max3_u32 v4, v200, v201, v202
    v_max3_u32 v5, v203, v204, v205
    v_max3_u32 v4, v4, v206, v207
    v_max_u32 v4, v4, v5
    v_cmp_eq_u32 vcc, -1, v4
    s_cbranch_vccnz .A_181
.W_182:
    v_smfmac_f32_16x16x64_bf16 v[76:79], v[200:203], a[208:215], v9
    v_smfmac_f32_16x16x64_bf16 v[80:83], v[200:203], a[240:247], v9
    s_waitcnt vmcnt(0)
    v_max3_u32 v4, v192, v193, v194
    v_max3_u32 v5, v195, v196, v197
    v_max3_u32 v4, v4, v198, v199
    v_smfmac_f32_16x16x64_bf16 v[76:79], v[204:207], a[216:223], v9
    v_max_u32 v4, v4, v5
    v_cmp_eq_u32 vcc, -1, v4
    v_smfmac_f32_16x16x64_bf16 v[80:83], v[204:207], a[248:255], v9
    s_cbranch_vccz .W_150
    s_branch .A_149
.A_161:
    buffer_load_dwordx4 v[208:211], v246, s[8:11], s33 offen offset:0 sc1
    buffer_load_dwordx4 v[212:215], v246, s[8:11], s33 offen offset:1024 sc1
    s_sub_u32 s62, s62, 1
    s_cbranch_scc1 .mg_end_1
    s_waitcnt vmcnt(2)
    v_max3_u32 v4, v192, v193, v194
    v_max3_u32 v5, v195, v196, v197
    v_max3_u32 v4, v4, v198, v199
    v_max_u32 v4, v4, v5
    v_cmp_eq_u32 vcc, -1, v4
    s_cbranch_vccz .W_174
.A_173:
    buffer_load_dwordx4 v[192:195], v246, s[8:11], s32 offen offset:0 sc1
    buffer_load_dwordx4 v[196:199], v246, s[8:11], s32 offen offset:1024 sc1
    s_waitcnt vmcnt(2)
    v_max3_u32 v4, v208, v209, v210
    v_max3_u32 v5, v211, v212, v213
    v_max3_u32 v4, v4, v214, v215
    v_max_u32 v4, v4, v5
    v_cmp_eq_u32 vcc, -1, v4
    s_cbranch_vccnz .A_161
    s_branch .W_162
.A_183:
    buffer_load_dwordx4 v[192:195], v246, s[8:11], s32 offen offset:0 sc1
    buffer_load_dwordx4 v[196:199], v246, s[8:11], s32 offen offset:1024 sc1
    s_sub_u32 s62, s62, 1
    s_cbranch_scc1 .mg_end_1
    s_waitcnt vmcnt(2)
    v_max3_u32 v4, v216, v217, v218
    v_max3_u32 v5, v219, v220, v221
    v_max3_u32 v4, v4, v222, v223
    v_max_u32 v4, v4, v5
    v_cmp_eq_u32 vcc, -1, v4
    s_cbranch_vccz .W_148
.A_147:
    buffer_load_dwordx4 v[216:219], v246, s[8:11], s33 offen offset:2048 sc1
    buffer_load_dwordx4 v[220:223], v246, s[8:11], s33 offen offset:3072 sc1
    s_waitcnt vmcnt(2)
    v_max3_u32 v4, v192, v193, v194
    v_max3_u32 v5, v195, v196, v197
    v_max3_u32 v4, v4, v198, v199
    v_max_u32 v4, v4, v5
    v_cmp_eq_u32 vcc, -1, v4
    s_cbranch_vccnz .A_183
.W_184:
    v_smfmac_f32_16x16x64_bf16 v[76:79], v[192:195], a[192:199], v9
    v_smfmac_f32_16x16x64_bf16 v[80:83], v[192:195], a[224:231], v9
    s_waitcnt vmcnt(0)
    v_max3_u32 v4, v216, v217, v218
    v_max3_u32 v5, v219, v220, v221
    v_max3_u32 v4, v4, v222, v223
    v_smfmac_f32_16x16x64_bf16 v[76:79], v[196:199], a[200:207], v9
    v_max_u32 v4, v4, v5
    v_cmp_eq_u32 vcc, -1, v4
    v_smfmac_f32_16x16x64_bf16 v[80:83], v[196:199], a[232:239], v9
    s_cbranch_vccz .W_55
    s_branch .A_54
.A_185:
    buffer_load_dwordx4 v[208:211], v246, s[8:11], s33 offen offset:0 sc1
    buffer_load_dwordx4 v[212:215], v246, s[8:11], s33 offen offset:1024 sc1
    s_sub_u32 s62, s62, 1
    s_cbranch_scc1 .mg_end_1
    s_waitcnt vmcnt(2)
    v_max3_u32 v4, v200, v201, v202
    v_max3_u32 v5, v203, v204, v205
    v_max3_u32 v4, v4, v206, v207
    v_max_u32 v4, v4, v5
    v_cmp_eq_u32 vcc, -1, v4
    s_cbranch_vccz .W_142
.A_141:
    buffer_load_dwordx4 v[200:203], v246, s[8:11], s32 offen offset:2048 sc1
    buffer_load_dwordx4 v[204:207], v246, s[8:11], s32 offen offset:3072 sc1
    s_waitcnt vmcnt(2)
    v_max3_u32 v4, v208, v209, v210
    v_max3_u32 v5, v211, v212, v213
    v_max3_u32 v4, v4, v214, v215
    v_max_u32 v4, v4, v5
    v_cmp_eq_u32 vcc, -1, v4
    s_cbranch_vccnz .A_185
.W_186:
    v_smfmac_f32_16x16x64_bf16 v[76:79], v[208:211], v[124:131], v9
    v_smfmac_f32_16x16x64_bf16 v[80:83], v[208:211], v[156:163], v9
    s_waitcnt vmcnt(0)
    v_max3_u32 v4, v200, v201, v202
    v_max3_u32 v5, v203, v204, v205
    v_max3_u32 v4, v4, v206, v207
    v_smfmac_f32_16x16x64_bf16 v[76:79], v[212:215], v[132:139], v9
    v_max_u32 v4, v4, v5
    v_cmp_eq_u32 vcc, -1, v4
    v_smfmac_f32_16x16x64_bf16 v[80:83], v[212:215], v[164:171], v9
    s_cbranch_vccz .W_156
    s_branch .A_155
.A_179:
    buffer_load_dwordx4 v[216:219], v246, s[8:11], s33 offen offset:2048 sc1
    buffer_load_dwordx4 v[220:223], v246, s[8:11], s33 offen offset:3072 sc1
    s_sub_u32 s62, s62, 1
    s_cbranch_scc1 .mg_end_1
    s_waitcnt vmcnt(2)
    v_max3_u32 v4, v200, v201, v202
    v_max3_u32 v5, v203, v204, v205
    v_max3_u32 v4, v4, v206, v207
    v_max_u32 v4, v4, v5
    v_cmp_eq_u32 vcc, -1, v4
    s_cbranch_vccz .W_168
.A_167:
    buffer_load_dwordx4 v[200:203], v246, s[8:11], s32 offen offset:2048 sc1
    buffer_load_dwordx4 v[204:207], v246, s[8:11], s32 offen offset:3072 sc1
    s_waitcnt vmcnt(2)
    v_max3_u32 v4, v216, v217, v218
    v_max3_u32 v5, v219, v220, v221
    v_max3_u32 v4, v4, v222, v223
    v_max_u32 v4, v4, v5
    v_cmp_eq_u32 vcc, -1, v4
    s_cbranch_vccnz .A_179
    s_branch .W_180
.A_187:
    buffer_load_dwordx4 v[216:219], v246, s[8:11], s33 offen offset:2048 sc1
    buffer_load_dwordx4 v[220:223], v246, s[8:11], s33 offen offset:3072 sc1
    s_sub_u32 s62, s62, 1
    s_cbranch_scc1 .mg_end_1
    s_waitcnt vmcnt(2)
    v_max3_u32 v4, v208, v209, v210
    v_max3_u32 v5, v211, v212, v213
    v_max3_u32 v4, v4, v214, v215
    v_max_u32 v4, v4, v5
    v_cmp_eq_u32 vcc, -1, v4
    s_cbranch_vccz .W_53
.A_52:
    buffer_load_dwordx4 v[208:211], v246, s[8:11], s33 offen offset:0 sc1
    buffer_load_dwordx4 v[212:215], v246, s[8:11], s33 offen offset:1024 sc1
    s_waitcnt vmcnt(2)
    v_max3_u32 v4, v216, v217, v218
    v_max3_u32 v5, v219, v220, v221
    v_max3_u32 v4, v4, v222, v223
    v_max_u32 v4, v4, v5
    v_cmp_eq_u32 vcc, -1, v4
    s_cbranch_vccnz .A_187
.W_188:
    v_smfmac_f32_16x16x64_bf16 v[76:79], v[216:219], v[140:147], v9
    v_smfmac_f32_16x16x64_bf16 v[80:83], v[216:219], v[172:179], v9
    s_waitcnt vmcnt(0)
    v_max3_u32 v4, v208, v209, v210
    v_max3_u32 v5, v211, v212, v213
    v_max3_u32 v4, v4, v214, v215
    v_smfmac_f32_16x16x64_bf16 v[76:79], v[220:223], v[148:155], v9
    v_max_u32 v4, v4, v5
    v_cmp_eq_u32 vcc, -1, v4
    v_smfmac_f32_16x16x64_bf16 v[80:83], v[220:223], v[180:187], v9
    s_cbranch_vccz .W_144
    s_branch .A_143
.A_149:
    buffer_load_dwordx4 v[192:195], v246, s[8:11], s32 offen offset:0 sc1
    buffer_load_dwordx4 v[196:199], v246, s[8:11], s32 offen offset:1024 sc1
    s_sub_u32 s62, s62, 1
    s_cbranch_scc1 .mg_end_1
    s_waitcnt vmcnt(2)
    v_max3_u32 v4, v192, v193, v194
    v_max3_u32 v5, v195, v196, v197
    v_max3_u32 v4, v4, v198, v199
    v_max_u32 v4, v4, v5
    v_cmp_eq_u32 vcc, -1, v4
    s_cbranch_vccnz .A_149
    v_smfmac_f32_16x16x64_bf16 v[76:79], v[192:195], a[192:199], v9
    v_smfmac_f32_16x16x64_bf16 v[80:83], v[192:195], a[224:231], v9
    v_smfmac_f32_16x16x64_bf16 v[76:79], v[196:199], a[200:207], v9
    v_smfmac_f32_16x16x64_bf16 v[80:83], v[196:199], a[232:239], v9
    s_branch .mj_47
.A_155:
    buffer_load_dwordx4 v[200:203], v246, s[8:11], s32 offen offset:2048 sc1
    buffer_load_dwordx4 v[204:207], v246, s[8:11], s32 offen offset:3072 sc1
    s_sub_u32 s62, s62, 1
    s_cbranch_scc1 .mg_end_1
    s_waitcnt vmcnt(2)
    v_max3_u32 v4, v200, v201, v202
    v_max3_u32 v5, v203, v204, v205
    v_max3_u32 v4, v4, v206, v207
    v_max_u32 v4, v4, v5
    v_cmp_eq_u32 vcc, -1, v4
    s_cbranch_vccnz .A_155
    v_smfmac_f32_16x16x64_bf16 v[76:79], v[200:203], a[208:215], v9
    v_smfmac_f32_16x16x64_bf16 v[80:83], v[200:203], a[240:247], v9
    v_smfmac_f32_16x16x64_bf16 v[76:79], v[204:207], a[216:223], v9
    v_smfmac_f32_16x16x64_bf16 v[80:83], v[204:207], a[248:255], v9
    s_branch .mj_47
.A_143:
    buffer_load_dwordx4 v[208:211], v246, s[8:11], s33 offen offset:0 sc1
    buffer_load_dwordx4 v[212:215], v246, s[8:11], s33 offen offset:1024 sc1
    s_sub_u32 s62, s62, 1
    s_cbranch_scc1 .mg_end_1
    s_waitcnt vmcnt(2)
    v_max3_u32 v4, v208, v209, v210
    v_max3_u32 v5, v211, v212, v213
    v_max3_u32 v4, v4, v214, v215
    v_max_u32 v4, v4, v5
    v_cmp_eq_u32 vcc, -1, v4
    s_cbranch_vccnz .A_143
    v_smfmac_f32_16x16x64_bf16 v[76:79], v[208:211], v[124:131], v9
    v_smfmac_f32_16x16x64_bf16 v[80:83], v[208:211], v[156:163], v9
    v_smfmac_f32_16x16x64_bf16 v[76:79], v[212:215], v[132:139], v9
    v_smfmac_f32_16x16x64_bf16 v[80:83], v[212:215], v[164:171], v9
    s_branch .mj_47
.A_54:
    buffer_load_dwordx4 v[216:219], v246, s[8:11], s33 offen offset:2048 sc1
    buffer_load_dwordx4 v[220:223], v246, s[8:11], s33 offen offset:3072 sc1
    s_sub_u32 s62, s62, 1
    s_cbranch_scc1 .mg_end_1
    s_waitcnt vmcnt(2)
    v_max3_u32 v4, v216, v217, v218
    v_max3_u32 v5, v219, v220, v221
    v_max3_u32 v4, v4, v222, v223
    v_max_u32 v4, v4, v5
    v_cmp_eq_u32 vcc, -1, v4
    s_cbranch_vccnz .A_54
    v_smfmac_f32_16x16x64_bf16 v[76:79], v[216:219], v[140:147], v9
    v_smfmac_f32_16x16x64_bf16 v[80:83], v[216:219], v[172:179], v9
    v_smfmac_f32_16x16x64_bf16 v[76:79], v[220:223], v[148:155], v9
    v_smfmac_f32_16x16x64_bf16 v[80:83], v[220:223], v[180:187], v9
    s_branch .mj_47
.sk_56:
    s_mov_b64 exec, s[66:67]
    buffer_store_dwordx4 v[88:91], v11, s[8:11], s36 offen sc1
    s_mov_b64 exec, s[56:57]
    buffer_store_dwordx4 v[172:175], v12, s[8:11], s36 offen sc1
    s_mov_b64 exec, -1

    s_branch .rec_fin_5
.p2align 6
.top_189:
    s_barrier
    buffer_load_dwordx4 v[20:23], v8, s[8:11], s29 offen offset:0 sc1
    v_mov_b32 v52, 0
    buffer_load_dwordx4 v[24:27], v8, s[8:11], s29 offen offset:1024 sc1
    v_mov_b32 v53, 0
    buffer_load_dwordx4 v[28:31], v8, s[8:11], s29 offen offset:2048 sc1
    v_mov_b32 v54, 0
    buffer_load_dwordx4 v[32:35], v8, s[8:11], s29 offen offset:3072 sc1
.ent1_17:
    s_waitcnt vmcnt(3)
    v_max3_u32 v4, v20, v21, v22
    v_max_u32 v4, v4, v23
    v_cmp_eq_u32 vcc, -1, v4
    s_cbranch_vccnz .A_194
.W_195:
    v_smfmac_f32_16x16x64_bf16 v[52:55], v[20:23], a[0:7], v9
    v_smfmac_f32_16x16x64_bf16 v[56:59], v[20:23], a[32:39], v9
    s_waitcnt vmcnt(2)
    v_max3_u32 v4, v24, v25, v26
    v_max_u32 v4, v4, v27
    v_smfmac_f32_16x16x64_bf16 v[60:63], v[20:23], a[64:71], v9
    v_cmp_eq_u32 vcc, -1, v4
    v_smfmac_f32_16x16x64_bf16 v[64:67], v[20:23], a[96:103], v9
    s_cbranch_vccnz .A_196
.W_197:
    v_smfmac_f32_16x16x64_bf16 v[52:55], v[24:27], a[8:15], v9
    v_smfmac_f32_16x16x64_bf16 v[56:59], v[24:27], a[40:47], v9
    s_waitcnt vmcnt(1)
    v_max3_u32 v4, v28, v29, v30
    v_max_u32 v4, v4, v31
    v_smfmac_f32_16x16x64_bf16 v[60:63], v[24:27], a[72:79], v9
    v_cmp_eq_u32 vcc, -1, v4
    v_smfmac_f32_16x16x64_bf16 v[64:67], v[24:27], a[104:111], v9
    s_cbranch_vccnz .A_198
.W_199:
    v_smfmac_f32_16x16x64_bf16 v[52:55], v[28:31], a[16:23], v9
    v_smfmac_f32_16x16x64_bf16 v[56:59], v[28:31], a[48:55], v9
    s_waitcnt vmcnt(0)
    v_max3_u32 v4, v32, v33, v34
    v_max_u32 v4, v4, v35
    v_smfmac_f32_16x16x64_bf16 v[60:63], v[28:31], a[80:87], v9
    v_cmp_eq_u32 vcc, -1, v4
    v_smfmac_f32_16x16x64_bf16 v[64:67], v[28:31], a[112:119], v9
    s_cbranch_vccnz .A_200
.W_201:
    v_smfmac_f32_16x16x64_bf16 v[52:55], v[32:35], a[24:31], v9
    v_smfmac_f32_16x16x64_bf16 v[56:59], v[32:35], a[56:63], v9
    v_smfmac_f32_16x16x64_bf16 v[60:63], v[32:35], a[88:95], v9
    v_smfmac_f32_16x16x64_bf16 v[64:67], v[32:35], a[120:127], v9
.mj_193:
    v_cvt_pk_bf16_f32 v104, v52, v53
    v_cvt_pk_bf16_f32 v105, v54, v55
    v_cvt_pk_bf16_f32 v106, v56, v57
    v_cvt_pk_bf16_f32 v107, v58, v59
    ds_write_b64 v16, v[104:105] offset:4096
    v_cvt_pk_bf16_f32 v108, v60, v61
    v_cvt_pk_bf16_f32 v109, v62, v63
    ds_write_b64 v16, v[106:107] offset:6144
    ds_write_b64 v16, v[108:109] offset:0
    v_cvt_pk_bf16_f32 v110, v64, v65
    v_cvt_pk_bf16_f32 v111, v66, v67
    ds_write_b64 v16, v[110:111] offset:2048
    v_smfmac_f32_16x16x64_bf16 v[68:71], v[20:23], a[128:135], v9
    v_smfmac_f32_16x16x64_bf16 v[72:75], v[20:23], a[160:167], v9
    s_waitcnt lgkmcnt(0)
    s_barrier
    ds_read_b128 v[36:39], v17 offset:0
    ds_read_b128 v[40:43], v17 offset:1024
    v_smfmac_f32_16x16x64_bf16 v[68:71], v[24:27], a[136:143], v9
    v_smfmac_f32_16x16x64_bf16 v[72:75], v[24:27], a[168:175], v9
    s_waitcnt lgkmcnt(1)
    v_mfma_f32_16x16x32_bf16 v[44:47], v[36:39], v[84:87], 0
    s_waitcnt lgkmcnt(0)
    v_mfma_f32_16x16x32_bf16 v[44:47], v[40:43], v[84:87], v[44:47]
    v_smfmac_f32_16x16x64_bf16 v[68:71], v[28:31], a[144:151], v9
    v_smfmac_f32_16x16x64_bf16 v[72:75], v[28:31], a[176:183], v9
    s_mov_b64 exec, s[64:65]
    v_cvt_pk_bf16_f32 v48, v44, v45
    v_cvt_pk_bf16_f32 v49, v46, v47
    v_min_u32 v48, 0xfffffffe, v48
    v_min_u32 v49, 0xfffffffe, v49
    buffer_store_dwordx2 v[48:49], v10, s[8:11], s29 offen sc1

    ds_write_b64 v18, v[48:49]
    s_mov_b64 exec, -1

    v_smfmac_f32_16x16x64_bf16 v[68:71], v[32:35], a[152:159], v9
    v_smfmac_f32_16x16x64_bf16 v[72:75], v[32:35], a[184:191], v9
    s_nop 3
    v_cvt_pk_bf16_f32 v104, v68, v69
    v_cvt_pk_bf16_f32 v105, v70, v71
    ds_write_b64 v16, v[104:105] offset:8192
    s_nop 0
    v_cvt_pk_bf16_f32 v106, v72, v73
    v_cvt_pk_bf16_f32 v107, v74, v75
    ds_write_b64 v16, v[106:107] offset:10240
    s_cmp_lg_u32 s24, 2
    s_waitcnt lgkmcnt(0)
    s_barrier
    s_cbranch_scc1 .oth_190
    buffer_load_dwordx4 v[92:95], v232, s[8:11], s29 offen sc1
    buffer_load_dwordx4 v[96:99], v233, s[8:11], s29 offen sc1
    buffer_load_dwordx4 v[100:103], v234, s[8:11], s29 offen sc1
    ds_read_b128 v[88:91], v14 offset:16384
    s_cmp_eq_u32 s28, 63
    s_cbranch_scc1 .rec_fin_5
    s_waitcnt lgkmcnt(0)
    v_mfma_f32_16x16x32_bf16 v[208:211], v[128:131], v[88:91], 0
    v_mfma_f32_16x16x32_bf16 v[212:215], v[144:147], v[88:91], 0
    v_mfma_f32_16x16x32_bf16 v[216:219], v[88:91], v[88:91], v[116:119]
    s_waitcnt vmcnt(2)
    v_max3_u32 v4, v92, v93, v94
    v_max_u32 v4, v4, v95
    v_cmp_eq_u32 vcc, -1, v4
    s_cbranch_vccnz .A_203
.W_204:
    v_mfma_f32_16x16x32_bf16 v[208:211], v[132:135], v[92:95], v[208:211]
    s_waitcnt vmcnt(1)
    v_max3_u32 v4, v96, v97, v98
    v_max_u32 v4, v4, v99
    v_mfma_f32_16x16x32_bf16 v[212:215], v[148:151], v[92:95], v[212:215]
    v_cmp_eq_u32 vcc, -1, v4
    v_mfma_f32_16x16x32_bf16 v[216:219], v[92:95], v[92:95], v[216:219]
    s_cbranch_vccnz .A_205
.W_206:
    v_mfma_f32_16x16x32_bf16 v[208:211], v[136:139], v[96:99], v[208:211]
    s_waitcnt vmcnt(0)
    v_max3_u32 v4, v100, v101, v102
    v_max_u32 v4, v4, v103
    v_mfma_f32_16x16x32_bf16 v[212:215], v[152:155], v[96:99], v[212:215]
    v_cmp_eq_u32 vcc, -1, v4
    v_mfma_f32_16x16x32_bf16 v[216:219], v[96:99], v[96:99], v[216:219]
    s_cbranch_vccnz .A_207
.W_208:
    v_mfma_f32_16x16x32_bf16 v[208:211], v[140:143], v[100:103], v[208:211]
    v_mfma_f32_16x16x32_bf16 v[212:215], v[156:159], v[100:103], v[212:215]
    v_mfma_f32_16x16x32_bf16 v[216:219], v[100:103], v[100:103], v[216:219]
.mj_202:
    s_barrier
    ds_read_b64 v[168:169], v14 offset:18432
    ds_read_b64 v[172:173], v14 offset:18440
    s_nop 0

    v_mov_b32_dpp v208, v212 row_ror:8 row_mask:0xf bank_mask:0xc
    v_mov_b32_dpp v209, v213 row_ror:8 row_mask:0xf bank_mask:0xc
    v_mov_b32_dpp v210, v214 row_ror:8 row_mask:0xf bank_mask:0xc
    v_mov_b32_dpp v211, v215 row_ror:8 row_mask:0xf bank_mask:0xc
    v_mov_b32_dpp v216, v218 row_ror:8 row_mask:0xf bank_mask:0xc
    v_mov_b32_dpp v217, v219 row_ror:8 row_mask:0xf bank_mask:0xc
    v_max3_f32 v4, v208, v209, v210
    v_max3_f32 v5, v211, v216, v217
    v_max_f32 v6, v4, v5
    v_max_f32 v4, v4, v5
    s_nop 1
    v_permlane32_swap_b32 v4, v6
    v_max_f32 v5, v4, v6
    v_max_f32 v4, v4, v6
    s_nop 1
    v_permlane16_swap_b32 v4, v5
    v_max_f32 v4, v4, v5
    s_nop 1
    v_max_f32_dpp v4, v4, v4 row_ror:8 row_mask:0xf bank_mask:0xf
    v_mul_f32 v4, s37, v4

    v_fma_f32 v104, v208, s37, -v4
    v_fma_f32 v105, v209, s37, -v4
    v_fma_f32 v106, v210, s37, -v4
    v_fma_f32 v107, v211, s37, -v4
    v_fma_f32 v108, v216, s37, -v4
    v_fma_f32 v109, v217, s37, -v4
    v_exp_f32 v104, v104
    v_exp_f32 v105, v105
    v_exp_f32 v106, v106
    v_exp_f32 v107, v107
    v_exp_f32 v108, v108
    v_exp_f32 v109, v109
    v_cvt_pk_bf16_f32 v176, v104, v105
    v_cvt_pk_bf16_f32 v177, v106, v107
    v_cvt_pk_bf16_f32 v180, v108, v109
    v_mov_b32_dpp v178, v176 row_ror:8 row_mask:0xf bank_mask:0xf
    v_mov_b32_dpp v179, v177 row_ror:8 row_mask:0xf bank_mask:0xf
    v_mov_b32_dpp v181, v180 row_ror:8 row_mask:0xf bank_mask:0xf
    s_waitcnt lgkmcnt(0)

    v_mfma_f32_16x16x32_bf16 v[208:211], v[120:123], v[176:179], 0
    v_mfma_f32_16x16x32_bf16 v[208:211], v[120:123], v[180:183], v[208:211]
    v_mfma_f32_16x16x32_bf16 v[212:215], v[160:163], v[176:179], 0
    v_mfma_f32_16x16x32_bf16 v[216:219], v[164:167], v[176:179], 0
    v_mfma_f32_16x16x32_bf16 v[212:215], v[168:171], v[180:183], v[212:215]
    v_rcp_f32 v4, v208
    v_mfma_f32_16x16x32_bf16 v[216:219], v[172:175], v[180:183], v[216:219]
    s_mov_b64 exec, s[58:59]
    s_nop 2
    v_mul_f32 v212, v4, v212
    v_mul_f32 v213, v4, v213
    v_mul_f32 v214, v4, v214
    v_mul_f32 v215, v4, v215
    v_cvt_pk_bf16_f32 v184, v212, v213
    v_cvt_pk_bf16_f32 v185, v214, v215
    v_mul_f32 v216, v4, v216
    v_mul_f32 v217, v4, v217
    v_min_u32 v184, 0xfffffffe, v184
    v_min_u32 v185, 0xfffffffe, v185
    v_mul_f32 v218, v4, v218
    v_mul_f32 v219, v4, v219
    v_cvt_pk_bf16_f32 v186, v216, v217
    v_cvt_pk_bf16_f32 v187, v218, v219
    v_min_u32 v186, 0xfffffffe, v186
    v_min_u32 v187, 0xfffffffe, v187
    buffer_store_dwordx4 v[184:187], v13, s[8:11], s29 offen sc1
    s_mov_b64 exec, -1

.gp_192:
    s_barrier
    s_mov_b32 s99, s68
    s_add_u32 s28, s28, 1
    s_add_u32 s36, s36, 196608
    s_cmp_lt_u32 s28, 63
    s_cselect_b32 s4, 262144, 0
    s_add_u32 s38, s38, s4
    s_add_u32 s39, s39, s4
    s_add_u32 s30, s30, s4
    s_mov_b32 s4, s68
    s_mov_b32 s68, s69
    s_mov_b32 s69, s70
    s_mov_b32 s70, s71
    s_mov_b32 s71, s4
    s_and_b32 s4, s28, 3
    s_lshl_b32 s5, s4, 16
    s_add_u32 s29, s5, s34
    s_xor_b32 s6, s5, 0x20000
    s_add_u32 s31, s6, s34
    s_add_u32 s32, s29, 16384
    s_add_u32 s33, s29, 20480
    s_waitcnt vmcnt(0)
    s_cmp_eq_u32 s24, 3
    s_cbranch_scc1 .u3_209
    s_barrier
    buffer_load_dword v226, v225, s[8:11], s30 offen
    s_add_u32 s4, s69, 0
    buffer_store_dwordx4 v[188:191], v238, s[8:11], s4 offen sc1
    s_add_u32 s4, s69, 262144
    buffer_store_dwordx4 v[188:191], v238, s[8:11], s4 offen sc1
    s_branch .u4_210
.u3_209:
    s_sub_u32 s4, s36, 196608
    s_barrier
    s_mov_b64 exec, s[66:67]
    buffer_store_dwordx4 v[88:91], v11, s[8:11], s4 offen sc1
    s_mov_b64 exec, s[56:57]
    buffer_store_dwordx4 v[172:175], v12, s[8:11], s4 offen sc1
    s_mov_b64 exec, -1

.u4_210:
    s_barrier
    ds_read_b128 v[108:111], v248
    ds_read_b128 v[128:131], v228 offset:0
    ds_read_b128 v[144:147], v228 offset:4096
    ds_read_b128 v[132:135], v229 offset:0
    ds_read_b128 v[148:151], v229 offset:4096
    ds_read_b128 v[136:139], v230 offset:0
    ds_read_b128 v[152:155], v230 offset:4096
    ds_read_b128 v[140:143], v231 offset:0
    ds_read_b128 v[156:159], v231 offset:4096
    ds_read_b128 v[160:163], v14 offset:28672
    ds_read_b128 v[164:167], v14 offset:29696
    v_mov_b32 v55, 0
    v_mov_b32 v56, 0
    v_mov_b32 v57, 0
    v_mov_b32 v58, 0
    v_mov_b32 v59, 0
    v_mov_b32 v60, 0
    v_mov_b32 v61, 0
    v_mov_b32 v62, 0
    v_mov_b32 v63, 0
    v_mov_b32 v64, 0
    v_mov_b32 v65, 0
    v_mov_b32 v66, 0
    v_mov_b32 v67, 0
    v_mov_b32 v68, 0
    v_mov_b32 v69, 0
    v_mov_b32 v70, 0
    v_mov_b32 v71, 0
    v_mov_b32 v72, 0
    v_mov_b32 v73, 0
    v_mov_b32 v74, 0
    v_mov_b32 v75, 0
    v_mov_b32 v20, -1
    v_mov_b32 v21, -1
    v_mov_b32 v22, -1
    v_mov_b32 v23, -1
    v_mov_b32 v24, -1
    v_mov_b32 v25, -1
    v_mov_b32 v26, -1
    v_mov_b32 v27, -1
    v_mov_b32 v28, -1
    s_add_u32 s4, s99, 0
    buffer_load_dwordx4 v[192:195], v239, s[8:11], s4 offen sc1
    buffer_load_dwordx4 v[196:199], v249, s[8:11], s4 offen sc1

    v_mov_b32 v29, -1
    v_mov_b32 v30, -1
    v_mov_b32 v31, -1
    v_mov_b32 v32, -1
    v_mov_b32 v33, -1
    v_mov_b32 v34, -1
    v_mov_b32 v35, -1
    v_mov_b32 v92, -1
    v_mov_b32 v93, -1
    v_mov_b32 v94, -1
    v_mov_b32 v95, -1
    v_mov_b32 v96, -1
    v_mov_b32 v97, -1
    v_mov_b32 v98, -1
    v_mov_b32 v99, -1
    v_mov_b32 v100, -1
    v_mov_b32 v101, -1
    v_mov_b32 v102, -1
    v_mov_b32 v103, -1
    s_add_u32 s4, s99, 262144
    buffer_load_dwordx4 v[200:203], v239, s[8:11], s4 offen sc1
    buffer_load_dwordx4 v[204:207], v249, s[8:11], s4 offen sc1

    s_waitcnt lgkmcnt(0)
    v_mfma_f32_16x16x32_bf16 v[76:79], v[108:111], v[112:115], 0
.gc_211:
    s_waitcnt vmcnt(2)

    v_max_u32 v4, v192, v196
    v_cmp_eq_u32 vcc, -1, v4
    s_cbranch_vccnz .gf_212
    v_mfma_f32_16x16x32_bf16 v[76:79], v[192:195], v[84:87], v[76:79]
    v_mfma_f32_16x16x32_bf16 v[76:79], v[196:199], v[112:115], v[76:79]
    s_mov_b64 exec, s[58:59]
    s_nop 6
    v_cvt_pk_bf16_f32 v104, v76, v77
    v_cvt_pk_bf16_f32 v105, v78, v79
    v_min_u32 v104, 0xfffffffe, v104
    v_min_u32 v105, 0xfffffffe, v105
    buffer_store_dwordx2 v[104:105], v15, s[8:11], s29 offen sc1
    s_mov_b64 exec, -1

    s_branch .top_189
.gf_212:
    s_add_u32 s4, s99, 0
    buffer_load_dwordx4 v[192:195], v239, s[8:11], s4 offen sc1
    buffer_load_dwordx4 v[196:199], v249, s[8:11], s4 offen sc1

    s_waitcnt vmcnt(2)

    v_max_u32 v4, v200, v204
    v_cmp_eq_u32 vcc, -1, v4
    s_cbranch_vccnz .gf_213
    v_mfma_f32_16x16x32_bf16 v[76:79], v[200:203], v[84:87], v[76:79]
    v_mfma_f32_16x16x32_bf16 v[76:79], v[204:207], v[112:115], v[76:79]
    s_mov_b64 exec, s[58:59]
    s_nop 6
    v_cvt_pk_bf16_f32 v104, v76, v77
    v_cvt_pk_bf16_f32 v105, v78, v79
    v_min_u32 v104, 0xfffffffe, v104
    v_min_u32 v105, 0xfffffffe, v105
    buffer_store_dwordx2 v[104:105], v15, s[8:11], s29 offen sc1
    s_mov_b64 exec, -1

    s_branch .top_189
.gf_213:
    s_add_u32 s4, s99, 262144
    buffer_load_dwordx4 v[200:203], v239, s[8:11], s4 offen sc1
    buffer_load_dwordx4 v[204:207], v249, s[8:11], s4 offen sc1

    s_sub_u32 s62, s62, 1
    s_cbranch_scc1 .mg_end_1
    s_branch .gc_211
.oth_190:
    s_cmp_eq_u32 s24, 3
    s_cbranch_scc1 .w3_191
    s_cmp_eq_u32 s28, 63
    s_cbranch_scc1 .rec_fin_5
    s_waitcnt vmcnt(0)
    v_readlane_b32 s4, v244, 0
    v_readlane_b32 s93, v244, 1
    s_min_u32 s93, s93, s4
    v_mov_b32 v20, -1
    v_mov_b32 v21, -1
    v_mov_b32 v22, -1
    v_mov_b32 v23, -1
    v_mov_b32 v24, -1
    v_mov_b32 v25, -1
    v_mov_b32 v26, -1
    v_mov_b32 v27, -1
    v_mov_b32 v28, -1
    v_mov_b32 v29, -1
    v_mov_b32 v30, -1
    v_mov_b32 v31, -1
    v_mov_b32 v32, -1
    v_mov_b32 v33, -1
    v_mov_b32 v34, -1
    v_mov_b32 v35, -1
    v_mov_b32 v55, 0
    v_mov_b32 v56, 0
    v_mov_b32 v57, 0
    v_mov_b32 v58, 0
    v_mov_b32 v59, 0
    v_mov_b32 v60, 0
    v_mov_b32 v61, 0
    v_mov_b32 v62, 0
    v_mov_b32 v63, 0
    v_mov_b32 v64, 0
    v_mov_b32 v65, 0
    v_mov_b32 v66, 0
    v_mov_b32 v67, 0
    v_mov_b32 v68, 0
    v_mov_b32 v69, 0
    v_mov_b32 v70, 0
    v_mov_b32 v71, 0
    v_mov_b32 v72, 0
    v_mov_b32 v73, 0
    v_mov_b32 v74, 0
    v_mov_b32 v75, 0
    s_barrier
    s_add_u32 s6, s28, 3
    s_min_u32 s6, s6, 64
    s_cmp_lt_u32 s93, s6
    s_cbranch_scc1 .kf_214
.kb_215:
    s_mov_b32 m0, s90
    s_nop 0
    buffer_load_dwordx4 v14, s[8:11], s38 offen offset:0 lds
    buffer_load_dwordx4 v14, s[8:11], s38 offen offset:1024 lds
    buffer_load_dwordx4 v14, s[8:11], s38 offen offset:2048 lds
    buffer_load_dwordx4 v14, s[8:11], s38 offen offset:3072 lds
    s_mov_b32 m0, s91
    s_nop 0
    buffer_load_dwordx4 v14, s[8:11], s39 offen lds
    s_bfe_u32 s12, s28, 0x10001
    s_add_u32 s6, s28, 6
    s_cmp_ge_u32 s93, s6
    s_cbranch_scc1 .nl_216
    s_mov_b64 exec, 3
    buffer_load_dword v244, v253, s[8:11], s89 offen sc1
    s_mov_b64 exec, -1

.nl_216:
    s_waitcnt lgkmcnt(0)
    s_barrier
    buffer_load_dwordx4 v[192:195], v246, s[8:11], s32 offen offset:0 sc1
    buffer_load_dwordx4 v[196:199], v246, s[8:11], s32 offen offset:1024 sc1
    v_mov_b32 v76, 0
    buffer_load_dwordx4 v[200:203], v246, s[8:11], s32 offen offset:2048 sc1
    buffer_load_dwordx4 v[204:207], v246, s[8:11], s32 offen offset:3072 sc1
    v_mov_b32 v77, 0
    buffer_load_dwordx4 v[208:211], v246, s[8:11], s33 offen offset:0 sc1
    buffer_load_dwordx4 v[212:215], v246, s[8:11], s33 offen offset:1024 sc1
    v_mov_b32 v78, 0
    buffer_load_dwordx4 v[216:219], v246, s[8:11], s33 offen offset:2048 sc1
    buffer_load_dwordx4 v[220:223], v246, s[8:11], s33 offen offset:3072 sc1
    s_waitcnt vmcnt(6)
    v_max3_u32 v4, v192, v193, v194
    v_max3_u32 v5, v195, v196, v197
    v_max3_u32 v4, v4, v198, v199
    v_max_u32 v4, v4, v5
    v_cmp_eq_u32 vcc, -1, v4
    s_cbranch_vccnz .A_218
.W_219:
    v_smfmac_f32_16x16x64_bf16 v[76:79], v[192:195], a[192:199], v9
    v_smfmac_f32_16x16x64_bf16 v[80:83], v[192:195], a[224:231], v9
    s_waitcnt vmcnt(4)
    v_max3_u32 v4, v200, v201, v202
    v_max3_u32 v5, v203, v204, v205
    v_max3_u32 v4, v4, v206, v207
    v_smfmac_f32_16x16x64_bf16 v[76:79], v[196:199], a[200:207], v9
    v_max_u32 v4, v4, v5
    v_cmp_eq_u32 vcc, -1, v4
    v_smfmac_f32_16x16x64_bf16 v[80:83], v[196:199], a[232:239], v9
    s_cbranch_vccnz .A_220
.W_221:
    v_smfmac_f32_16x16x64_bf16 v[76:79], v[200:203], a[208:215], v9
    v_smfmac_f32_16x16x64_bf16 v[80:83], v[200:203], a[240:247], v9
    s_waitcnt vmcnt(2)
    v_max3_u32 v4, v208, v209, v210
    v_max3_u32 v5, v211, v212, v213
    v_max3_u32 v4, v4, v214, v215
    v_smfmac_f32_16x16x64_bf16 v[76:79], v[204:207], a[216:223], v9
    v_max_u32 v4, v4, v5
    v_cmp_eq_u32 vcc, -1, v4
    v_smfmac_f32_16x16x64_bf16 v[80:83], v[204:207], a[248:255], v9
    s_cbranch_vccnz .A_222
.W_223:
    v_smfmac_f32_16x16x64_bf16 v[76:79], v[208:211], v[124:131], v9
    v_smfmac_f32_16x16x64_bf16 v[80:83], v[208:211], v[156:163], v9
    s_waitcnt vmcnt(0)
    v_max3_u32 v4, v216, v217, v218
    v_max3_u32 v5, v219, v220, v221
    v_max3_u32 v4, v4, v222, v223
    v_smfmac_f32_16x16x64_bf16 v[76:79], v[212:215], v[132:139], v9
    v_max_u32 v4, v4, v5
    v_cmp_eq_u32 vcc, -1, v4
    v_smfmac_f32_16x16x64_bf16 v[80:83], v[212:215], v[164:171], v9
    s_cbranch_vccnz .A_224
.W_225:
    v_smfmac_f32_16x16x64_bf16 v[76:79], v[216:219], v[140:147], v9
    v_smfmac_f32_16x16x64_bf16 v[80:83], v[216:219], v[172:179], v9
    v_smfmac_f32_16x16x64_bf16 v[76:79], v[220:223], v[148:155], v9
    v_smfmac_f32_16x16x64_bf16 v[80:83], v[220:223], v[180:187], v9
.mj_217:
    s_barrier
    s_nop 7
    v_permlane32_swap_b32 v76, v80
    v_permlane32_swap_b32 v77, v81
    v_permlane32_swap_b32 v78, v82
    v_permlane32_swap_b32 v79, v83
    v_add_f32 v76, v76, v80
    v_add_f32 v77, v77, v81
    v_add_f32 v78, v78, v82
    v_add_f32 v79, v79, v83
    v_cvt_pk_bf16_f32 v104, v76, v77
    v_cvt_pk_bf16_f32 v106, v76, v77
    v_cvt_pk_bf16_f32 v105, v78, v79
    v_cvt_pk_bf16_f32 v107, v78, v79
    v_permlane16_swap_b32 v104, v106
    s_nop 0
    v_permlane16_swap_b32 v105, v107
    v_min_u32 v104, 0xfffffffe, v104
    buffer_store_dwordx4 v[104:107], v237, s[8:11], s68 offen sc1

    ds_write_b128 v247, v[104:107]
    s_waitcnt lgkmcnt(0)
    s_barrier
    v_mov_b32 v79, 0
    v_mov_b32 v80, 0
    v_mov_b32 v81, 0
    v_mov_b32 v82, 0
    v_mov_b32 v83, 0
    s_waitcnt vmcnt(1)
    v_mov_b32 v192, -1
    v_mov_b32 v193, -1
    v_mov_b32 v194, -1
    v_mov_b32 v195, -1
    v_mov_b32 v196, -1
    v_mov_b32 v197, -1
    v_mov_b32 v198, -1
    v_mov_b32 v199, -1
    v_mov_b32 v200, -1
    v_mov_b32 v201, -1
    v_mov_b32 v202, -1
    v_mov_b32 v203, -1
    v_mov_b32 v204, -1
    v_mov_b32 v205, -1
    v_mov_b32 v206, -1
    v_mov_b32 v207, -1
    v_mov_b32 v208, -1
    v_mov_b32 v209, -1
    v_mov_b32 v210, -1
    v_mov_b32 v211, -1
    v_mov_b32 v212, -1
    v_mov_b32 v213, -1
    v_mov_b32 v214, -1
    v_mov_b32 v215, -1
    v_mov_b32 v216, -1
    v_mov_b32 v217, -1
    v_mov_b32 v218, -1
    v_mov_b32 v219, -1
    v_mov_b32 v220, -1
    v_mov_b32 v221, -1
    v_mov_b32 v222, -1
    v_mov_b32 v223, -1
    s_add_u32 s28, s28, 1
    s_add_u32 s36, s36, 196608
    s_cmp_lt_u32 s28, 63
    s_cselect_b32 s4, 262144, 0
    s_add_u32 s38, s38, s4
    s_add_u32 s39, s39, s4
    s_add_u32 s30, s30, s4
    s_mov_b32 s4, s68
    s_mov_b32 s68, s69
    s_mov_b32 s69, s70
    s_mov_b32 s70, s71
    s_mov_b32 s71, s4
    s_and_b32 s4, s28, 3
    s_lshl_b32 s5, s4, 16
    s_add_u32 s29, s5, s34
    s_xor_b32 s6, s5, 0x20000
    s_add_u32 s31, s6, s34
    s_add_u32 s32, s29, 16384
    s_add_u32 s33, s29, 20480
    s_branch .top_189
.w3_191:
    ds_read_b128 v[36:39], v14 offset:8192
    ds_read_b128 v[40:43], v14 offset:9216
    ds_read_b128 v[44:47], v14 offset:10240
    ds_read_b128 v[48:51], v14 offset:11264
    ds_read_b128 v[88:91], v14 offset:16384
    s_waitcnt lgkmcnt(0)
    v_mfma_f32_16x16x32_bf16 v[104:107], v[84:87], v[36:39], 0
    v_mfma_f32_16x16x32_bf16 v[108:111], v[84:87], v[44:47], 0
    v_mfma_f32_16x16x32_bf16 v[104:107], v[84:87], v[40:43], v[104:107]
    v_mfma_f32_16x16x32_bf16 v[108:111], v[84:87], v[48:51], v[108:111]
    s_nop 7
    v_cvt_pk_bf16_f32 v168, v104, v105
    v_cvt_pk_bf16_f32 v169, v106, v107
    v_cvt_pk_bf16_f32 v170, v108, v109
    v_cvt_pk_bf16_f32 v171, v110, v111
    ds_write_b128 v14, v[168:171] offset:18432
    v_cndmask_b32 v172, v170, v168, s[60:61]
    v_cndmask_b32 v173, v171, v169, s[60:61]
    v_min_u32 v172, 0xfffffffe, v172
    v_min_u32 v173, 0xfffffffe, v173
    v_mov_b32 v174, v172
    v_mov_b32 v175, v173
    s_cmp_eq_u32 s28, 63
    s_nop 0
    v_permlane16_swap_b32 v172, v174
    v_permlane16_swap_b32 v173, v175
    ds_write_b128 v14, v[172:175] offset:17408

    s_cbranch_scc1 .sk_226
    s_waitcnt lgkmcnt(0)
    s_barrier
    buffer_store_dwordx4 v[188:191], v235, s[8:11], s31 offen sc1
    buffer_store_dwordx4 v[188:191], v236, s[8:11], s31 offen sc1

    s_branch .gp_192
.A_227:
    buffer_load_dwordx4 v[32:35], v8, s[8:11], s29 offen offset:3072 sc1
    s_sub_u32 s62, s62, 1
    s_cbranch_scc1 .mg_end_1
    s_waitcnt vmcnt(3)
    v_max3_u32 v4, v20, v21, v22
    v_max_u32 v4, v4, v23
    v_cmp_eq_u32 vcc, -1, v4
    s_cbranch_vccz .W_195
.A_194:
    buffer_load_dwordx4 v[20:23], v8, s[8:11], s29 offen offset:0 sc1
    s_waitcnt vmcnt(3)
    v_max3_u32 v4, v24, v25, v26
    v_max_u32 v4, v4, v27
    v_cmp_eq_u32 vcc, -1, v4
    s_cbranch_vccz .W_228
.A_229:
    buffer_load_dwordx4 v[24:27], v8, s[8:11], s29 offen offset:1024 sc1
    s_waitcnt vmcnt(3)
    v_max3_u32 v4, v28, v29, v30
    v_max_u32 v4, v4, v31
    v_cmp_eq_u32 vcc, -1, v4
    s_cbranch_vccz .W_230
.A_231:
    buffer_load_dwordx4 v[28:31], v8, s[8:11], s29 offen offset:2048 sc1
    s_waitcnt vmcnt(3)
    v_max3_u32 v4, v32, v33, v34
    v_max_u32 v4, v4, v35
    v_cmp_eq_u32 vcc, -1, v4
    s_cbranch_vccnz .A_227
.W_232:
    v_smfmac_f32_16x16x64_bf16 v[52:55], v[32:35], a[24:31], v9
    v_smfmac_f32_16x16x64_bf16 v[56:59], v[32:35], a[56:63], v9
    s_waitcnt vmcnt(2)
    v_max3_u32 v4, v20, v21, v22
    v_max_u32 v4, v4, v23
    v_smfmac_f32_16x16x64_bf16 v[60:63], v[32:35], a[88:95], v9
    v_cmp_eq_u32 vcc, -1, v4
    v_smfmac_f32_16x16x64_bf16 v[64:67], v[32:35], a[120:127], v9
    s_cbranch_vccnz .A_233
.W_234:
    v_smfmac_f32_16x16x64_bf16 v[52:55], v[20:23], a[0:7], v9
    v_smfmac_f32_16x16x64_bf16 v[56:59], v[20:23], a[32:39], v9
    s_waitcnt vmcnt(1)
    v_max3_u32 v4, v24, v25, v26
    v_max_u32 v4, v4, v27
    v_smfmac_f32_16x16x64_bf16 v[60:63], v[20:23], a[64:71], v9
    v_cmp_eq_u32 vcc, -1, v4
    v_smfmac_f32_16x16x64_bf16 v[64:67], v[20:23], a[96:103], v9
    s_cbranch_vccnz .A_235
.W_236:
    v_smfmac_f32_16x16x64_bf16 v[52:55], v[24:27], a[8:15], v9
    v_smfmac_f32_16x16x64_bf16 v[56:59], v[24:27], a[40:47], v9
    s_waitcnt vmcnt(0)
    v_max3_u32 v4, v28, v29, v30
    v_max_u32 v4, v4, v31
    v_smfmac_f32_16x16x64_bf16 v[60:63], v[24:27], a[72:79], v9
    v_cmp_eq_u32 vcc, -1, v4
    v_smfmac_f32_16x16x64_bf16 v[64:67], v[24:27], a[104:111], v9
    s_cbranch_vccnz .A_237
.W_238:
    v_smfmac_f32_16x16x64_bf16 v[52:55], v[28:31], a[16:23], v9
    v_smfmac_f32_16x16x64_bf16 v[56:59], v[28:31], a[48:55], v9
    v_smfmac_f32_16x16x64_bf16 v[60:63], v[28:31], a[80:87], v9
    v_smfmac_f32_16x16x64_bf16 v[64:67], v[28:31], a[112:119], v9
    s_branch .mj_193
.W_228:
    v_smfmac_f32_16x16x64_bf16 v[52:55], v[24:27], a[8:15], v9
    v_smfmac_f32_16x16x64_bf16 v[56:59], v[24:27], a[40:47], v9
    s_waitcnt vmcnt(2)
    v_max3_u32 v4, v28, v29, v30
    v_max_u32 v4, v4, v31
    v_smfmac_f32_16x16x64_bf16 v[60:63], v[24:27], a[72:79], v9
    v_cmp_eq_u32 vcc, -1, v4
    v_smfmac_f32_16x16x64_bf16 v[64:67], v[24:27], a[104:111], v9
    s_cbranch_vccnz .A_239
.W_240:
    v_smfmac_f32_16x16x64_bf16 v[52:55], v[28:31], a[16:23], v9
    v_smfmac_f32_16x16x64_bf16 v[56:59], v[28:31], a[48:55], v9
    s_waitcnt vmcnt(1)
    v_max3_u32 v4, v32, v33, v34
    v_max_u32 v4, v4, v35
    v_smfmac_f32_16x16x64_bf16 v[60:63], v[28:31], a[80:87], v9
    v_cmp_eq_u32 vcc, -1, v4
    v_smfmac_f32_16x16x64_bf16 v[64:67], v[28:31], a[112:119], v9
    s_cbranch_vccnz .A_241
.W_242:
    v_smfmac_f32_16x16x64_bf16 v[52:55], v[32:35], a[24:31], v9
    v_smfmac_f32_16x16x64_bf16 v[56:59], v[32:35], a[56:63], v9
    s_waitcnt vmcnt(0)
    v_max3_u32 v4, v20, v21, v22
    v_max_u32 v4, v4, v23
    v_smfmac_f32_16x16x64_bf16 v[60:63], v[32:35], a[88:95], v9
    v_cmp_eq_u32 vcc, -1, v4
    v_smfmac_f32_16x16x64_bf16 v[64:67], v[32:35], a[120:127], v9
    s_cbranch_vccnz .A_243
.W_244:
    v_smfmac_f32_16x16x64_bf16 v[52:55], v[20:23], a[0:7], v9
    v_smfmac_f32_16x16x64_bf16 v[56:59], v[20:23], a[32:39], v9
    v_smfmac_f32_16x16x64_bf16 v[60:63], v[20:23], a[64:71], v9
    v_smfmac_f32_16x16x64_bf16 v[64:67], v[20:23], a[96:103], v9
    s_branch .mj_193
.W_230:
    v_smfmac_f32_16x16x64_bf16 v[52:55], v[28:31], a[16:23], v9
    v_smfmac_f32_16x16x64_bf16 v[56:59], v[28:31], a[48:55], v9
    s_waitcnt vmcnt(2)
    v_max3_u32 v4, v32, v33, v34
    v_max_u32 v4, v4, v35
    v_smfmac_f32_16x16x64_bf16 v[60:63], v[28:31], a[80:87], v9
    v_cmp_eq_u32 vcc, -1, v4
    v_smfmac_f32_16x16x64_bf16 v[64:67], v[28:31], a[112:119], v9
    s_cbranch_vccnz .A_245
.W_246:
    v_smfmac_f32_16x16x64_bf16 v[52:55], v[32:35], a[24:31], v9
    v_smfmac_f32_16x16x64_bf16 v[56:59], v[32:35], a[56:63], v9
    s_waitcnt vmcnt(1)
    v_max3_u32 v4, v20, v21, v22
    v_max_u32 v4, v4, v23
    v_smfmac_f32_16x16x64_bf16 v[60:63], v[32:35], a[88:95], v9
    v_cmp_eq_u32 vcc, -1, v4
    v_smfmac_f32_16x16x64_bf16 v[64:67], v[32:35], a[120:127], v9
    s_cbranch_vccnz .A_247
.W_248:
    v_smfmac_f32_16x16x64_bf16 v[52:55], v[20:23], a[0:7], v9
    v_smfmac_f32_16x16x64_bf16 v[56:59], v[20:23], a[32:39], v9
    s_waitcnt vmcnt(0)
    v_max3_u32 v4, v24, v25, v26
    v_max_u32 v4, v4, v27
    v_smfmac_f32_16x16x64_bf16 v[60:63], v[20:23], a[64:71], v9
    v_cmp_eq_u32 vcc, -1, v4
    v_smfmac_f32_16x16x64_bf16 v[64:67], v[20:23], a[96:103], v9
    s_cbranch_vccnz .A_249
.W_250:
    v_smfmac_f32_16x16x64_bf16 v[52:55], v[24:27], a[8:15], v9
    v_smfmac_f32_16x16x64_bf16 v[56:59], v[24:27], a[40:47], v9
    v_smfmac_f32_16x16x64_bf16 v[60:63], v[24:27], a[72:79], v9
    v_smfmac_f32_16x16x64_bf16 v[64:67], v[24:27], a[104:111], v9
    s_branch .mj_193
.A_251:
    buffer_load_dwordx4 v[28:31], v8, s[8:11], s29 offen offset:2048 sc1
    s_sub_u32 s62, s62, 1
    s_cbranch_scc1 .mg_end_1
    s_waitcnt vmcnt(2)
    v_max3_u32 v4, v20, v21, v22
    v_max_u32 v4, v4, v23
    v_cmp_eq_u32 vcc, -1, v4
    s_cbranch_vccz .W_234
.A_233:
    buffer_load_dwordx4 v[20:23], v8, s[8:11], s29 offen offset:0 sc1
    s_waitcnt vmcnt(2)
    v_max3_u32 v4, v24, v25, v26
    v_max_u32 v4, v4, v27
    v_cmp_eq_u32 vcc, -1, v4
    s_cbranch_vccz .W_252
.A_253:
    buffer_load_dwordx4 v[24:27], v8, s[8:11], s29 offen offset:1024 sc1
    s_waitcnt vmcnt(2)
    v_max3_u32 v4, v28, v29, v30
    v_max_u32 v4, v4, v31
    v_cmp_eq_u32 vcc, -1, v4
    s_cbranch_vccnz .A_251
.W_254:
    v_smfmac_f32_16x16x64_bf16 v[52:55], v[28:31], a[16:23], v9
    v_smfmac_f32_16x16x64_bf16 v[56:59], v[28:31], a[48:55], v9
    s_waitcnt vmcnt(1)
    v_max3_u32 v4, v20, v21, v22
    v_max_u32 v4, v4, v23
    v_smfmac_f32_16x16x64_bf16 v[60:63], v[28:31], a[80:87], v9
    v_cmp_eq_u32 vcc, -1, v4
    v_smfmac_f32_16x16x64_bf16 v[64:67], v[28:31], a[112:119], v9
    s_cbranch_vccz .W_248
    s_branch .A_247
.W_252:
    v_smfmac_f32_16x16x64_bf16 v[52:55], v[24:27], a[8:15], v9
    v_smfmac_f32_16x16x64_bf16 v[56:59], v[24:27], a[40:47], v9
    s_waitcnt vmcnt(1)
    v_max3_u32 v4, v28, v29, v30
    v_max_u32 v4, v4, v31
    v_smfmac_f32_16x16x64_bf16 v[60:63], v[24:27], a[72:79], v9
    v_cmp_eq_u32 vcc, -1, v4
    v_smfmac_f32_16x16x64_bf16 v[64:67], v[24:27], a[104:111], v9
    s_cbranch_vccnz .A_255
.W_256:
    v_smfmac_f32_16x16x64_bf16 v[52:55], v[28:31], a[16:23], v9
    v_smfmac_f32_16x16x64_bf16 v[56:59], v[28:31], a[48:55], v9
    s_waitcnt vmcnt(0)
    v_max3_u32 v4, v20, v21, v22
    v_max_u32 v4, v4, v23
    v_smfmac_f32_16x16x64_bf16 v[60:63], v[28:31], a[80:87], v9
    v_cmp_eq_u32 vcc, -1, v4
    v_smfmac_f32_16x16x64_bf16 v[64:67], v[28:31], a[112:119], v9
    s_cbranch_vccz .W_244
    s_branch .A_243
.A_257:
    buffer_load_dwordx4 v[24:27], v8, s[8:11], s29 offen offset:1024 sc1
    s_sub_u32 s62, s62, 1
    s_cbranch_scc1 .mg_end_1
    s_waitcnt vmcnt(2)
    v_max3_u32 v4, v32, v33, v34
    v_max_u32 v4, v4, v35
    v_cmp_eq_u32 vcc, -1, v4
    s_cbranch_vccz .W_246
.A_245:
    buffer_load_dwordx4 v[32:35], v8, s[8:11], s29 offen offset:3072 sc1
    s_waitcnt vmcnt(2)
    v_max3_u32 v4, v20, v21, v22
    v_max_u32 v4, v4, v23
    v_cmp_eq_u32 vcc, -1, v4
    s_cbranch_vccz .W_258
.A_259:
    buffer_load_dwordx4 v[20:23], v8, s[8:11], s29 offen offset:0 sc1
    s_waitcnt vmcnt(2)
    v_max3_u32 v4, v24, v25, v26
    v_max_u32 v4, v4, v27
    v_cmp_eq_u32 vcc, -1, v4
    s_cbranch_vccnz .A_257
.W_260:
    v_smfmac_f32_16x16x64_bf16 v[52:55], v[24:27], a[8:15], v9
    v_smfmac_f32_16x16x64_bf16 v[56:59], v[24:27], a[40:47], v9
    s_waitcnt vmcnt(1)
    v_max3_u32 v4, v32, v33, v34
    v_max_u32 v4, v4, v35
    v_smfmac_f32_16x16x64_bf16 v[60:63], v[24:27], a[72:79], v9
    v_cmp_eq_u32 vcc, -1, v4
    v_smfmac_f32_16x16x64_bf16 v[64:67], v[24:27], a[104:111], v9
    s_cbranch_vccz .W_242
    s_branch .A_241
.W_258:
    v_smfmac_f32_16x16x64_bf16 v[52:55], v[20:23], a[0:7], v9
    v_smfmac_f32_16x16x64_bf16 v[56:59], v[20:23], a[32:39], v9
    s_waitcnt vmcnt(1)
    v_max3_u32 v4, v24, v25, v26
    v_max_u32 v4, v4, v27
    v_smfmac_f32_16x16x64_bf16 v[60:63], v[20:23], a[64:71], v9
    v_cmp_eq_u32 vcc, -1, v4
    v_smfmac_f32_16x16x64_bf16 v[64:67], v[20:23], a[96:103], v9
    s_cbranch_vccnz .A_261
.W_262:
    v_smfmac_f32_16x16x64_bf16 v[52:55], v[24:27], a[8:15], v9
    v_smfmac_f32_16x16x64_bf16 v[56:59], v[24:27], a[40:47], v9
    s_waitcnt vmcnt(0)
    v_max3_u32 v4, v32, v33, v34
    v_max_u32 v4, v4, v35
    v_smfmac_f32_16x16x64_bf16 v[60:63], v[24:27], a[72:79], v9
    v_cmp_eq_u32 vcc, -1, v4
    v_smfmac_f32_16x16x64_bf16 v[64:67], v[24:27], a[104:111], v9
    s_cbranch_vccz .W_201
    s_branch .A_200
.A_263:
    buffer_load_dwordx4 v[32:35], v8, s[8:11], s29 offen offset:3072 sc1
    s_sub_u32 s62, s62, 1
    s_cbranch_scc1 .mg_end_1
    s_waitcnt vmcnt(2)
    v_max3_u32 v4, v20, v21, v22
    v_max_u32 v4, v4, v23
    v_cmp_eq_u32 vcc, -1, v4
    s_cbranch_vccz .W_264
.A_265:
    buffer_load_dwordx4 v[20:23], v8, s[8:11], s29 offen offset:0 sc1
    s_waitcnt vmcnt(2)
    v_max3_u32 v4, v28, v29, v30
    v_max_u32 v4, v4, v31
    v_cmp_eq_u32 vcc, -1, v4
    s_cbranch_vccz .W_240
.A_239:
    buffer_load_dwordx4 v[28:31], v8, s[8:11], s29 offen offset:2048 sc1
    s_waitcnt vmcnt(2)
    v_max3_u32 v4, v32, v33, v34
    v_max_u32 v4, v4, v35
    v_cmp_eq_u32 vcc, -1, v4
    s_cbranch_vccnz .A_263
.W_266:
    v_smfmac_f32_16x16x64_bf16 v[52:55], v[32:35], a[24:31], v9
    v_smfmac_f32_16x16x64_bf16 v[56:59], v[32:35], a[56:63], v9
    s_waitcnt vmcnt(1)
    v_max3_u32 v4, v20, v21, v22
    v_max_u32 v4, v4, v23
    v_smfmac_f32_16x16x64_bf16 v[60:63], v[32:35], a[88:95], v9
    v_cmp_eq_u32 vcc, -1, v4
    v_smfmac_f32_16x16x64_bf16 v[64:67], v[32:35], a[120:127], v9
    s_cbranch_vccnz .A_267
.W_268:
    v_smfmac_f32_16x16x64_bf16 v[52:55], v[20:23], a[0:7], v9
    v_smfmac_f32_16x16x64_bf16 v[56:59], v[20:23], a[32:39], v9
    s_waitcnt vmcnt(0)
    v_max3_u32 v4, v28, v29, v30
    v_max_u32 v4, v4, v31
    v_smfmac_f32_16x16x64_bf16 v[60:63], v[20:23], a[64:71], v9
    v_cmp_eq_u32 vcc, -1, v4
    v_smfmac_f32_16x16x64_bf16 v[64:67], v[20:23], a[96:103], v9
    s_cbranch_vccz .W_238
    s_branch .A_237
.W_264:
    v_smfmac_f32_16x16x64_bf16 v[52:55], v[20:23], a[0:7], v9
    v_smfmac_f32_16x16x64_bf16 v[56:59], v[20:23], a[32:39], v9
    s_waitcnt vmcnt(1)
    v_max3_u32 v4, v28, v29, v30
    v_max_u32 v4, v4, v31
    v_smfmac_f32_16x16x64_bf16 v[60:63], v[20:23], a[64:71], v9
    v_cmp_eq_u32 vcc, -1, v4
    v_smfmac_f32_16x16x64_bf16 v[64:67], v[20:23], a[96:103], v9
    s_cbranch_vccz .W_199
    s_branch .A_198
.A_269:
    buffer_load_dwordx4 v[32:35], v8, s[8:11], s29 offen offset:3072 sc1
    s_sub_u32 s62, s62, 1
    s_cbranch_scc1 .mg_end_1
    s_waitcnt vmcnt(2)
    v_max3_u32 v4, v24, v25, v26
    v_max_u32 v4, v4, v27
    v_cmp_eq_u32 vcc, -1, v4
    s_cbranch_vccz .W_197
.A_196:
    buffer_load_dwordx4 v[24:27], v8, s[8:11], s29 offen offset:1024 sc1
    s_waitcnt vmcnt(2)
    v_max3_u32 v4, v28, v29, v30
    v_max_u32 v4, v4, v31
    v_cmp_eq_u32 vcc, -1, v4
    s_cbranch_vccz .W_270
.A_271:
    buffer_load_dwordx4 v[28:31], v8, s[8:11], s29 offen offset:2048 sc1
    s_waitcnt vmcnt(2)
    v_max3_u32 v4, v32, v33, v34
    v_max_u32 v4, v4, v35
    v_cmp_eq_u32 vcc, -1, v4
    s_cbranch_vccnz .A_269
.W_272:
    v_smfmac_f32_16x16x64_bf16 v[52:55], v[32:35], a[24:31], v9
    v_smfmac_f32_16x16x64_bf16 v[56:59], v[32:35], a[56:63], v9
    s_waitcnt vmcnt(1)
    v_max3_u32 v4, v24, v25, v26
    v_max_u32 v4, v4, v27
    v_smfmac_f32_16x16x64_bf16 v[60:63], v[32:35], a[88:95], v9
    v_cmp_eq_u32 vcc, -1, v4
    v_smfmac_f32_16x16x64_bf16 v[64:67], v[32:35], a[120:127], v9
    s_cbranch_vccz .W_236
    s_branch .A_235
.W_270:
    v_smfmac_f32_16x16x64_bf16 v[52:55], v[28:31], a[16:23], v9
    v_smfmac_f32_16x16x64_bf16 v[56:59], v[28:31], a[48:55], v9
    s_waitcnt vmcnt(1)
    v_max3_u32 v4, v32, v33, v34
    v_max_u32 v4, v4, v35
    v_smfmac_f32_16x16x64_bf16 v[60:63], v[28:31], a[80:87], v9
    v_cmp_eq_u32 vcc, -1, v4
    v_smfmac_f32_16x16x64_bf16 v[64:67], v[28:31], a[112:119], v9
    s_cbranch_vccnz .A_273
.W_274:
    v_smfmac_f32_16x16x64_bf16 v[52:55], v[32:35], a[24:31], v9
    v_smfmac_f32_16x16x64_bf16 v[56:59], v[32:35], a[56:63], v9
    s_waitcnt vmcnt(0)
    v_max3_u32 v4, v24, v25, v26
    v_max_u32 v4, v4, v27
    v_smfmac_f32_16x16x64_bf16 v[60:63], v[32:35], a[88:95], v9
    v_cmp_eq_u32 vcc, -1, v4
    v_smfmac_f32_16x16x64_bf16 v[64:67], v[32:35], a[120:127], v9
    s_cbranch_vccz .W_250
    s_branch .A_249
.A_275:
    buffer_load_dwordx4 v[24:27], v8, s[8:11], s29 offen offset:1024 sc1
    s_sub_u32 s62, s62, 1
    s_cbranch_scc1 .mg_end_1
    s_waitcnt vmcnt(1)
    v_max3_u32 v4, v20, v21, v22
    v_max_u32 v4, v4, v23
    v_cmp_eq_u32 vcc, -1, v4
    s_cbranch_vccz .W_248
.A_247:
    buffer_load_dwordx4 v[20:23], v8, s[8:11], s29 offen offset:0 sc1
    s_waitcnt vmcnt(1)
    v_max3_u32 v4, v24, v25, v26
    v_max_u32 v4, v4, v27
    v_cmp_eq_u32 vcc, -1, v4
    s_cbranch_vccnz .A_275
.W_276:
    v_smfmac_f32_16x16x64_bf16 v[52:55], v[24:27], a[8:15], v9
    v_smfmac_f32_16x16x64_bf16 v[56:59], v[24:27], a[40:47], v9
    s_waitcnt vmcnt(0)
    v_max3_u32 v4, v20, v21, v22
    v_max_u32 v4, v4, v23
    v_smfmac_f32_16x16x64_bf16 v[60:63], v[24:27], a[72:79], v9
    v_cmp_eq_u32 vcc, -1, v4
    v_smfmac_f32_16x16x64_bf16 v[64:67], v[24:27], a[104:111], v9
    s_cbranch_vccz .W_244
    s_branch .A_243
.A_255:
    buffer_load_dwordx4 v[28:31], v8, s[8:11], s29 offen offset:2048 sc1
    s_sub_u32 s62, s62, 1
    s_cbranch_scc1 .mg_end_1
    s_waitcnt vmcnt(1)
    v_max3_u32 v4, v20, v21, v22
    v_max_u32 v4, v4, v23
    v_cmp_eq_u32 vcc, -1, v4
    s_cbranch_vccz .W_268
.A_267:
    buffer_load_dwordx4 v[20:23], v8, s[8:11], s29 offen offset:0 sc1
    s_waitcnt vmcnt(1)
    v_max3_u32 v4, v28, v29, v30
    v_max_u32 v4, v4, v31
    v_cmp_eq_u32 vcc, -1, v4
    s_cbranch_vccnz .A_255
    s_branch .W_256
.A_277:
    buffer_load_dwordx4 v[20:23], v8, s[8:11], s29 offen offset:0 sc1
    s_sub_u32 s62, s62, 1
    s_cbranch_scc1 .mg_end_1
    s_waitcnt vmcnt(1)
    v_max3_u32 v4, v32, v33, v34
    v_max_u32 v4, v4, v35
    v_cmp_eq_u32 vcc, -1, v4
    s_cbranch_vccz .W_242
.A_241:
    buffer_load_dwordx4 v[32:35], v8, s[8:11], s29 offen offset:3072 sc1
    s_waitcnt vmcnt(1)
    v_max3_u32 v4, v20, v21, v22
    v_max_u32 v4, v4, v23
    v_cmp_eq_u32 vcc, -1, v4
    s_cbranch_vccnz .A_277
.W_278:
    v_smfmac_f32_16x16x64_bf16 v[52:55], v[20:23], a[0:7], v9
    v_smfmac_f32_16x16x64_bf16 v[56:59], v[20:23], a[32:39], v9
    s_waitcnt vmcnt(0)
    v_max3_u32 v4, v32, v33, v34
    v_max_u32 v4, v4, v35
    v_smfmac_f32_16x16x64_bf16 v[60:63], v[20:23], a[64:71], v9
    v_cmp_eq_u32 vcc, -1, v4
    v_smfmac_f32_16x16x64_bf16 v[64:67], v[20:23], a[96:103], v9
    s_cbranch_vccz .W_201
    s_branch .A_200
.A_279:
    buffer_load_dwordx4 v[28:31], v8, s[8:11], s29 offen offset:2048 sc1
    s_sub_u32 s62, s62, 1
    s_cbranch_scc1 .mg_end_1
    s_waitcnt vmcnt(1)
    v_max3_u32 v4, v24, v25, v26
    v_max_u32 v4, v4, v27
    v_cmp_eq_u32 vcc, -1, v4
    s_cbranch_vccz .W_236
.A_235:
    buffer_load_dwordx4 v[24:27], v8, s[8:11], s29 offen offset:1024 sc1
    s_waitcnt vmcnt(1)
    v_max3_u32 v4, v28, v29, v30
    v_max_u32 v4, v4, v31
    v_cmp_eq_u32 vcc, -1, v4
    s_cbranch_vccnz .A_279
.W_280:
    v_smfmac_f32_16x16x64_bf16 v[52:55], v[28:31], a[16:23], v9
    v_smfmac_f32_16x16x64_bf16 v[56:59], v[28:31], a[48:55], v9
    s_waitcnt vmcnt(0)
    v_max3_u32 v4, v24, v25, v26
    v_max_u32 v4, v4, v27
    v_smfmac_f32_16x16x64_bf16 v[60:63], v[28:31], a[80:87], v9
    v_cmp_eq_u32 vcc, -1, v4
    v_smfmac_f32_16x16x64_bf16 v[64:67], v[28:31], a[112:119], v9
    s_cbranch_vccz .W_250
    s_branch .A_249
.A_273:
    buffer_load_dwordx4 v[32:35], v8, s[8:11], s29 offen offset:3072 sc1
    s_sub_u32 s62, s62, 1
    s_cbranch_scc1 .mg_end_1
    s_waitcnt vmcnt(1)
    v_max3_u32 v4, v24, v25, v26
    v_max_u32 v4, v4, v27
    v_cmp_eq_u32 vcc, -1, v4
    s_cbranch_vccz .W_262
.A_261:
    buffer_load_dwordx4 v[24:27], v8, s[8:11], s29 offen offset:1024 sc1
    s_waitcnt vmcnt(1)
    v_max3_u32 v4, v32, v33, v34
    v_max_u32 v4, v4, v35
    v_cmp_eq_u32 vcc, -1, v4
    s_cbranch_vccnz .A_273
    s_branch .W_274
.A_281:
    buffer_load_dwordx4 v[32:35], v8, s[8:11], s29 offen offset:3072 sc1
    s_sub_u32 s62, s62, 1
    s_cbranch_scc1 .mg_end_1
    s_waitcnt vmcnt(1)
    v_max3_u32 v4, v28, v29, v30
    v_max_u32 v4, v4, v31
    v_cmp_eq_u32 vcc, -1, v4
    s_cbranch_vccz .W_199
.A_198:
    buffer_load_dwordx4 v[28:31], v8, s[8:11], s29 offen offset:2048 sc1
    s_waitcnt vmcnt(1)
    v_max3_u32 v4, v32, v33, v34
    v_max_u32 v4, v4, v35
    v_cmp_eq_u32 vcc, -1, v4
    s_cbranch_vccnz .A_281
.W_282:
    v_smfmac_f32_16x16x64_bf16 v[52:55], v[32:35], a[24:31], v9
    v_smfmac_f32_16x16x64_bf16 v[56:59], v[32:35], a[56:63], v9
    s_waitcnt vmcnt(0)
    v_max3_u32 v4, v28, v29, v30
    v_max_u32 v4, v4, v31
    v_smfmac_f32_16x16x64_bf16 v[60:63], v[32:35], a[88:95], v9
    v_cmp_eq_u32 vcc, -1, v4
    v_smfmac_f32_16x16x64_bf16 v[64:67], v[32:35], a[120:127], v9
    s_cbranch_vccz .W_238
    s_branch .A_237
.A_243:
    buffer_load_dwordx4 v[20:23], v8, s[8:11], s29 offen offset:0 sc1
    s_sub_u32 s62, s62, 1
    s_cbranch_scc1 .mg_end_1
    s_waitcnt vmcnt(1)
    v_max3_u32 v4, v20, v21, v22
    v_max_u32 v4, v4, v23
    v_cmp_eq_u32 vcc, -1, v4
    s_cbranch_vccnz .A_243
    v_smfmac_f32_16x16x64_bf16 v[52:55], v[20:23], a[0:7], v9
    v_smfmac_f32_16x16x64_bf16 v[56:59], v[20:23], a[32:39], v9
    v_smfmac_f32_16x16x64_bf16 v[60:63], v[20:23], a[64:71], v9
    v_smfmac_f32_16x16x64_bf16 v[64:67], v[20:23], a[96:103], v9
    s_branch .mj_193
.A_249:
    buffer_load_dwordx4 v[24:27], v8, s[8:11], s29 offen offset:1024 sc1
    s_sub_u32 s62, s62, 1
    s_cbranch_scc1 .mg_end_1
    s_waitcnt vmcnt(1)
    v_max3_u32 v4, v24, v25, v26
    v_max_u32 v4, v4, v27
    v_cmp_eq_u32 vcc, -1, v4
    s_cbranch_vccnz .A_249
    v_smfmac_f32_16x16x64_bf16 v[52:55], v[24:27], a[8:15], v9
    v_smfmac_f32_16x16x64_bf16 v[56:59], v[24:27], a[40:47], v9
    v_smfmac_f32_16x16x64_bf16 v[60:63], v[24:27], a[72:79], v9
    v_smfmac_f32_16x16x64_bf16 v[64:67], v[24:27], a[104:111], v9
    s_branch .mj_193
.A_237:
    buffer_load_dwordx4 v[28:31], v8, s[8:11], s29 offen offset:2048 sc1
    s_sub_u32 s62, s62, 1
    s_cbranch_scc1 .mg_end_1
    s_waitcnt vmcnt(1)
    v_max3_u32 v4, v28, v29, v30
    v_max_u32 v4, v4, v31
    v_cmp_eq_u32 vcc, -1, v4
    s_cbranch_vccnz .A_237
    v_smfmac_f32_16x16x64_bf16 v[52:55], v[28:31], a[16:23], v9
    v_smfmac_f32_16x16x64_bf16 v[56:59], v[28:31], a[48:55], v9
    v_smfmac_f32_16x16x64_bf16 v[60:63], v[28:31], a[80:87], v9
    v_smfmac_f32_16x16x64_bf16 v[64:67], v[28:31], a[112:119], v9
    s_branch .mj_193
.A_200:
    buffer_load_dwordx4 v[32:35], v8, s[8:11], s29 offen offset:3072 sc1
    s_sub_u32 s62, s62, 1
    s_cbranch_scc1 .mg_end_1
    s_waitcnt vmcnt(1)
    v_max3_u32 v4, v32, v33, v34
    v_max_u32 v4, v4, v35
    v_cmp_eq_u32 vcc, -1, v4
    s_cbranch_vccnz .A_200
    v_smfmac_f32_16x16x64_bf16 v[52:55], v[32:35], a[24:31], v9
    v_smfmac_f32_16x16x64_bf16 v[56:59], v[32:35], a[56:63], v9
    v_smfmac_f32_16x16x64_bf16 v[60:63], v[32:35], a[88:95], v9
    v_smfmac_f32_16x16x64_bf16 v[64:67], v[32:35], a[120:127], v9
    s_branch .mj_193
.A_283:
    buffer_load_dwordx4 v[100:103], v234, s[8:11], s29 offen sc1
    s_sub_u32 s62, s62, 1
    s_cbranch_scc1 .mg_end_1
    s_waitcnt vmcnt(2)
    v_max3_u32 v4, v92, v93, v94
    v_max_u32 v4, v4, v95
    v_cmp_eq_u32 vcc, -1, v4
    s_cbranch_vccz .W_204
.A_203:
    buffer_load_dwordx4 v[92:95], v232, s[8:11], s29 offen sc1
    s_waitcnt vmcnt(2)
    v_max3_u32 v4, v96, v97, v98
    v_max_u32 v4, v4, v99
    v_cmp_eq_u32 vcc, -1, v4
    s_cbranch_vccz .W_284
.A_285:
    buffer_load_dwordx4 v[96:99], v233, s[8:11], s29 offen sc1
    s_waitcnt vmcnt(2)
    v_max3_u32 v4, v100, v101, v102
    v_max_u32 v4, v4, v103
    v_cmp_eq_u32 vcc, -1, v4
    s_cbranch_vccnz .A_283
.W_286:
    v_mfma_f32_16x16x32_bf16 v[208:211], v[140:143], v[100:103], v[208:211]
    s_waitcnt vmcnt(1)
    v_max3_u32 v4, v92, v93, v94
    v_max_u32 v4, v4, v95
    v_mfma_f32_16x16x32_bf16 v[212:215], v[156:159], v[100:103], v[212:215]
    v_cmp_eq_u32 vcc, -1, v4
    v_mfma_f32_16x16x32_bf16 v[216:219], v[100:103], v[100:103], v[216:219]
    s_cbranch_vccnz .A_287
.W_288:
    v_mfma_f32_16x16x32_bf16 v[208:211], v[132:135], v[92:95], v[208:211]
    s_waitcnt vmcnt(0)
    v_max3_u32 v4, v96, v97, v98
    v_max_u32 v4, v4, v99
    v_mfma_f32_16x16x32_bf16 v[212:215], v[148:151], v[92:95], v[212:215]
    v_cmp_eq_u32 vcc, -1, v4
    v_mfma_f32_16x16x32_bf16 v[216:219], v[92:95], v[92:95], v[216:219]
    s_cbranch_vccnz .A_289
.W_290:
    v_mfma_f32_16x16x32_bf16 v[208:211], v[136:139], v[96:99], v[208:211]
    v_mfma_f32_16x16x32_bf16 v[212:215], v[152:155], v[96:99], v[212:215]
    v_mfma_f32_16x16x32_bf16 v[216:219], v[96:99], v[96:99], v[216:219]
    s_branch .mj_202
.W_284:
    v_mfma_f32_16x16x32_bf16 v[208:211], v[136:139], v[96:99], v[208:211]
    s_waitcnt vmcnt(1)
    v_max3_u32 v4, v100, v101, v102
    v_max_u32 v4, v4, v103
    v_mfma_f32_16x16x32_bf16 v[212:215], v[152:155], v[96:99], v[212:215]
    v_cmp_eq_u32 vcc, -1, v4
    v_mfma_f32_16x16x32_bf16 v[216:219], v[96:99], v[96:99], v[216:219]
    s_cbranch_vccnz .A_291
.W_292:
    v_mfma_f32_16x16x32_bf16 v[208:211], v[140:143], v[100:103], v[208:211]
    s_waitcnt vmcnt(0)
    v_max3_u32 v4, v92, v93, v94
    v_max_u32 v4, v4, v95
    v_mfma_f32_16x16x32_bf16 v[212:215], v[156:159], v[100:103], v[212:215]
    v_cmp_eq_u32 vcc, -1, v4
    v_mfma_f32_16x16x32_bf16 v[216:219], v[100:103], v[100:103], v[216:219]
    s_cbranch_vccnz .A_293
.W_294:
    v_mfma_f32_16x16x32_bf16 v[208:211], v[132:135], v[92:95], v[208:211]
    v_mfma_f32_16x16x32_bf16 v[212:215], v[148:151], v[92:95], v[212:215]
    v_mfma_f32_16x16x32_bf16 v[216:219], v[92:95], v[92:95], v[216:219]
    s_branch .mj_202
.A_295:
    buffer_load_dwordx4 v[96:99], v233, s[8:11], s29 offen sc1
    s_sub_u32 s62, s62, 1
    s_cbranch_scc1 .mg_end_1
    s_waitcnt vmcnt(1)
    v_max3_u32 v4, v92, v93, v94
    v_max_u32 v4, v4, v95
    v_cmp_eq_u32 vcc, -1, v4
    s_cbranch_vccz .W_288
.A_287:
    buffer_load_dwordx4 v[92:95], v232, s[8:11], s29 offen sc1
    s_waitcnt vmcnt(1)
    v_max3_u32 v4, v96, v97, v98
    v_max_u32 v4, v4, v99
    v_cmp_eq_u32 vcc, -1, v4
    s_cbranch_vccnz .A_295
.W_296:
    v_mfma_f32_16x16x32_bf16 v[208:211], v[136:139], v[96:99], v[208:211]
    s_waitcnt vmcnt(0)
    v_max3_u32 v4, v92, v93, v94
    v_max_u32 v4, v4, v95
    v_mfma_f32_16x16x32_bf16 v[212:215], v[152:155], v[96:99], v[212:215]
    v_cmp_eq_u32 vcc, -1, v4
    v_mfma_f32_16x16x32_bf16 v[216:219], v[96:99], v[96:99], v[216:219]
    s_cbranch_vccz .W_294
    s_branch .A_293
.A_297:
    buffer_load_dwordx4 v[92:95], v232, s[8:11], s29 offen sc1
    s_sub_u32 s62, s62, 1
    s_cbranch_scc1 .mg_end_1
    s_waitcnt vmcnt(1)
    v_max3_u32 v4, v100, v101, v102
    v_max_u32 v4, v4, v103
    v_cmp_eq_u32 vcc, -1, v4
    s_cbranch_vccz .W_292
.A_291:
    buffer_load_dwordx4 v[100:103], v234, s[8:11], s29 offen sc1
    s_waitcnt vmcnt(1)
    v_max3_u32 v4, v92, v93, v94
    v_max_u32 v4, v4, v95
    v_cmp_eq_u32 vcc, -1, v4
    s_cbranch_vccnz .A_297
.W_298:
    v_mfma_f32_16x16x32_bf16 v[208:211], v[132:135], v[92:95], v[208:211]
    s_waitcnt vmcnt(0)
    v_max3_u32 v4, v100, v101, v102
    v_max_u32 v4, v4, v103
    v_mfma_f32_16x16x32_bf16 v[212:215], v[148:151], v[92:95], v[212:215]
    v_cmp_eq_u32 vcc, -1, v4
    v_mfma_f32_16x16x32_bf16 v[216:219], v[92:95], v[92:95], v[216:219]
    s_cbranch_vccz .W_208
    s_branch .A_207
.A_299:
    buffer_load_dwordx4 v[100:103], v234, s[8:11], s29 offen sc1
    s_sub_u32 s62, s62, 1
    s_cbranch_scc1 .mg_end_1
    s_waitcnt vmcnt(1)
    v_max3_u32 v4, v96, v97, v98
    v_max_u32 v4, v4, v99
    v_cmp_eq_u32 vcc, -1, v4
    s_cbranch_vccz .W_206
.A_205:
    buffer_load_dwordx4 v[96:99], v233, s[8:11], s29 offen sc1
    s_waitcnt vmcnt(1)
    v_max3_u32 v4, v100, v101, v102
    v_max_u32 v4, v4, v103
    v_cmp_eq_u32 vcc, -1, v4
    s_cbranch_vccnz .A_299
.W_300:
    v_mfma_f32_16x16x32_bf16 v[208:211], v[140:143], v[100:103], v[208:211]
    s_waitcnt vmcnt(0)
    v_max3_u32 v4, v96, v97, v98
    v_max_u32 v4, v4, v99
    v_mfma_f32_16x16x32_bf16 v[212:215], v[156:159], v[100:103], v[212:215]
    v_cmp_eq_u32 vcc, -1, v4
    v_mfma_f32_16x16x32_bf16 v[216:219], v[100:103], v[100:103], v[216:219]
    s_cbranch_vccz .W_290
    s_branch .A_289
.A_293:
    buffer_load_dwordx4 v[92:95], v232, s[8:11], s29 offen sc1
    s_sub_u32 s62, s62, 1
    s_cbranch_scc1 .mg_end_1
    s_waitcnt vmcnt(1)
    v_max3_u32 v4, v92, v93, v94
    v_max_u32 v4, v4, v95
    v_cmp_eq_u32 vcc, -1, v4
    s_cbranch_vccnz .A_293
    v_mfma_f32_16x16x32_bf16 v[208:211], v[132:135], v[92:95], v[208:211]
    v_mfma_f32_16x16x32_bf16 v[212:215], v[148:151], v[92:95], v[212:215]
    v_mfma_f32_16x16x32_bf16 v[216:219], v[92:95], v[92:95], v[216:219]
    s_branch .mj_202
.A_289:
    buffer_load_dwordx4 v[96:99], v233, s[8:11], s29 offen sc1
    s_sub_u32 s62, s62, 1
    s_cbranch_scc1 .mg_end_1
    s_waitcnt vmcnt(1)
    v_max3_u32 v4, v96, v97, v98
    v_max_u32 v4, v4, v99
    v_cmp_eq_u32 vcc, -1, v4
    s_cbranch_vccnz .A_289
    v_mfma_f32_16x16x32_bf16 v[208:211], v[136:139], v[96:99], v[208:211]
    v_mfma_f32_16x16x32_bf16 v[212:215], v[152:155], v[96:99], v[212:215]
    v_mfma_f32_16x16x32_bf16 v[216:219], v[96:99], v[96:99], v[216:219]
    s_branch .mj_202
.A_207:
    buffer_load_dwordx4 v[100:103], v234, s[8:11], s29 offen sc1
    s_sub_u32 s62, s62, 1
    s_cbranch_scc1 .mg_end_1
    s_waitcnt vmcnt(1)
    v_max3_u32 v4, v100, v101, v102
    v_max_u32 v4, v4, v103
    v_cmp_eq_u32 vcc, -1, v4
    s_cbranch_vccnz .A_207
    v_mfma_f32_16x16x32_bf16 v[208:211], v[140:143], v[100:103], v[208:211]
    v_mfma_f32_16x16x32_bf16 v[212:215], v[156:159], v[100:103], v[212:215]
    v_mfma_f32_16x16x32_bf16 v[216:219], v[100:103], v[100:103], v[216:219]
    s_branch .mj_202
.kf_214:
    s_mov_b32 s62, 0
    s_mov_b64 exec, 3
.wf_301:
    buffer_load_dword v244, v253, s[8:11], s89 offen sc1
    s_waitcnt vmcnt(0)
    v_cmp_gt_u32 vcc, s6, v244
    s_cbranch_vccz .wfd_302
    s_sleep 2
    s_add_u32 s62, s62, 1
    s_cmp_gt_u32 s62, 0x400000
    s_cbranch_scc1 .mg_end_1
    s_branch .wf_301

.wfd_302:
    s_mov_b64 exec, -1
    v_readlane_b32 s4, v244, 0
    v_readlane_b32 s93, v244, 1
    s_min_u32 s93, s93, s4
    s_mov_b32 s62, 0x1000000
    s_branch .kb_215
.A_303:
    buffer_load_dwordx4 v[216:219], v246, s[8:11], s33 offen offset:2048 sc1
    buffer_load_dwordx4 v[220:223], v246, s[8:11], s33 offen offset:3072 sc1
    s_sub_u32 s62, s62, 1
    s_cbranch_scc1 .mg_end_1
    s_waitcnt vmcnt(6)
    v_max3_u32 v4, v192, v193, v194
    v_max3_u32 v5, v195, v196, v197
    v_max3_u32 v4, v4, v198, v199
    v_max_u32 v4, v4, v5
    v_cmp_eq_u32 vcc, -1, v4
    s_cbranch_vccz .W_219
.A_218:
    buffer_load_dwordx4 v[192:195], v246, s[8:11], s32 offen offset:0 sc1
    buffer_load_dwordx4 v[196:199], v246, s[8:11], s32 offen offset:1024 sc1
    s_waitcnt vmcnt(6)
    v_max3_u32 v4, v200, v201, v202
    v_max3_u32 v5, v203, v204, v205
    v_max3_u32 v4, v4, v206, v207
    v_max_u32 v4, v4, v5
    v_cmp_eq_u32 vcc, -1, v4
    s_cbranch_vccz .W_304
.A_305:
    buffer_load_dwordx4 v[200:203], v246, s[8:11], s32 offen offset:2048 sc1
    buffer_load_dwordx4 v[204:207], v246, s[8:11], s32 offen offset:3072 sc1
    s_waitcnt vmcnt(6)
    v_max3_u32 v4, v208, v209, v210
    v_max3_u32 v5, v211, v212, v213
    v_max3_u32 v4, v4, v214, v215
    v_max_u32 v4, v4, v5
    v_cmp_eq_u32 vcc, -1, v4
    s_cbranch_vccz .W_306
.A_307:
    buffer_load_dwordx4 v[208:211], v246, s[8:11], s33 offen offset:0 sc1
    buffer_load_dwordx4 v[212:215], v246, s[8:11], s33 offen offset:1024 sc1
    s_waitcnt vmcnt(6)
    v_max3_u32 v4, v216, v217, v218
    v_max3_u32 v5, v219, v220, v221
    v_max3_u32 v4, v4, v222, v223
    v_max_u32 v4, v4, v5
    v_cmp_eq_u32 vcc, -1, v4
    s_cbranch_vccnz .A_303
.W_308:
    v_smfmac_f32_16x16x64_bf16 v[76:79], v[216:219], v[140:147], v9
    v_smfmac_f32_16x16x64_bf16 v[80:83], v[216:219], v[172:179], v9
    s_waitcnt vmcnt(4)
    v_max3_u32 v4, v192, v193, v194
    v_max3_u32 v5, v195, v196, v197
    v_max3_u32 v4, v4, v198, v199
    v_smfmac_f32_16x16x64_bf16 v[76:79], v[220:223], v[148:155], v9
    v_max_u32 v4, v4, v5
    v_cmp_eq_u32 vcc, -1, v4
    v_smfmac_f32_16x16x64_bf16 v[80:83], v[220:223], v[180:187], v9
    s_cbranch_vccnz .A_309
.W_310:
    v_smfmac_f32_16x16x64_bf16 v[76:79], v[192:195], a[192:199], v9
    v_smfmac_f32_16x16x64_bf16 v[80:83], v[192:195], a[224:231], v9
    s_waitcnt vmcnt(2)
    v_max3_u32 v4, v200, v201, v202
    v_max3_u32 v5, v203, v204, v205
    v_max3_u32 v4, v4, v206, v207
    v_smfmac_f32_16x16x64_bf16 v[76:79], v[196:199], a[200:207], v9
    v_max_u32 v4, v4, v5
    v_cmp_eq_u32 vcc, -1, v4
    v_smfmac_f32_16x16x64_bf16 v[80:83], v[196:199], a[232:239], v9
    s_cbranch_vccnz .A_311
.W_312:
    v_smfmac_f32_16x16x64_bf16 v[76:79], v[200:203], a[208:215], v9
    v_smfmac_f32_16x16x64_bf16 v[80:83], v[200:203], a[240:247], v9
    s_waitcnt vmcnt(0)
    v_max3_u32 v4, v208, v209, v210
    v_max3_u32 v5, v211, v212, v213
    v_max3_u32 v4, v4, v214, v215
    v_smfmac_f32_16x16x64_bf16 v[76:79], v[204:207], a[216:223], v9
    v_max_u32 v4, v4, v5
    v_cmp_eq_u32 vcc, -1, v4
    v_smfmac_f32_16x16x64_bf16 v[80:83], v[204:207], a[248:255], v9
    s_cbranch_vccnz .A_313
.W_314:
    v_smfmac_f32_16x16x64_bf16 v[76:79], v[208:211], v[124:131], v9
    v_smfmac_f32_16x16x64_bf16 v[80:83], v[208:211], v[156:163], v9
    v_smfmac_f32_16x16x64_bf16 v[76:79], v[212:215], v[132:139], v9
    v_smfmac_f32_16x16x64_bf16 v[80:83], v[212:215], v[164:171], v9
    s_branch .mj_217
.W_304:
    v_smfmac_f32_16x16x64_bf16 v[76:79], v[200:203], a[208:215], v9
    v_smfmac_f32_16x16x64_bf16 v[80:83], v[200:203], a[240:247], v9
    s_waitcnt vmcnt(4)
    v_max3_u32 v4, v208, v209, v210
    v_max3_u32 v5, v211, v212, v213
    v_max3_u32 v4, v4, v214, v215
    v_smfmac_f32_16x16x64_bf16 v[76:79], v[204:207], a[216:223], v9
    v_max_u32 v4, v4, v5
    v_cmp_eq_u32 vcc, -1, v4
    v_smfmac_f32_16x16x64_bf16 v[80:83], v[204:207], a[248:255], v9
    s_cbranch_vccnz .A_315
.W_316:
    v_smfmac_f32_16x16x64_bf16 v[76:79], v[208:211], v[124:131], v9
    v_smfmac_f32_16x16x64_bf16 v[80:83], v[208:211], v[156:163], v9
    s_waitcnt vmcnt(2)
    v_max3_u32 v4, v216, v217, v218
    v_max3_u32 v5, v219, v220, v221
    v_max3_u32 v4, v4, v222, v223
    v_smfmac_f32_16x16x64_bf16 v[76:79], v[212:215], v[132:139], v9
    v_max_u32 v4, v4, v5
    v_cmp_eq_u32 vcc, -1, v4
    v_smfmac_f32_16x16x64_bf16 v[80:83], v[212:215], v[164:171], v9
    s_cbranch_vccnz .A_317
.W_318:
    v_smfmac_f32_16x16x64_bf16 v[76:79], v[216:219], v[140:147], v9
    v_smfmac_f32_16x16x64_bf16 v[80:83], v[216:219], v[172:179], v9
    s_waitcnt vmcnt(0)
    v_max3_u32 v4, v192, v193, v194
    v_max3_u32 v5, v195, v196, v197
    v_max3_u32 v4, v4, v198, v199
    v_smfmac_f32_16x16x64_bf16 v[76:79], v[220:223], v[148:155], v9
    v_max_u32 v4, v4, v5
    v_cmp_eq_u32 vcc, -1, v4
    v_smfmac_f32_16x16x64_bf16 v[80:83], v[220:223], v[180:187], v9
    s_cbranch_vccnz .A_319
.W_320:
    v_smfmac_f32_16x16x64_bf16 v[76:79], v[192:195], a[192:199], v9
    v_smfmac_f32_16x16x64_bf16 v[80:83], v[192:195], a[224:231], v9
    v_smfmac_f32_16x16x64_bf16 v[76:79], v[196:199], a[200:207], v9
    v_smfmac_f32_16x16x64_bf16 v[80:83], v[196:199], a[232:239], v9
    s_branch .mj_217
.W_306:
    v_smfmac_f32_16x16x64_bf16 v[76:79], v[208:211], v[124:131], v9
    v_smfmac_f32_16x16x64_bf16 v[80:83], v[208:211], v[156:163], v9
    s_waitcnt vmcnt(4)
    v_max3_u32 v4, v216, v217, v218
    v_max3_u32 v5, v219, v220, v221
    v_max3_u32 v4, v4, v222, v223
    v_smfmac_f32_16x16x64_bf16 v[76:79], v[212:215], v[132:139], v9
    v_max_u32 v4, v4, v5
    v_cmp_eq_u32 vcc, -1, v4
    v_smfmac_f32_16x16x64_bf16 v[80:83], v[212:215], v[164:171], v9
    s_cbranch_vccnz .A_321
.W_322:
    v_smfmac_f32_16x16x64_bf16 v[76:79], v[216:219], v[140:147], v9
    v_smfmac_f32_16x16x64_bf16 v[80:83], v[216:219], v[172:179], v9
    s_waitcnt vmcnt(2)
    v_max3_u32 v4, v192, v193, v194
    v_max3_u32 v5, v195, v196, v197
    v_max3_u32 v4, v4, v198, v199
    v_smfmac_f32_16x16x64_bf16 v[76:79], v[220:223], v[148:155], v9
    v_max_u32 v4, v4, v5
    v_cmp_eq_u32 vcc, -1, v4
    v_smfmac_f32_16x16x64_bf16 v[80:83], v[220:223], v[180:187], v9
    s_cbranch_vccnz .A_323
.W_324:
    v_smfmac_f32_16x16x64_bf16 v[76:79], v[192:195], a[192:199], v9
    v_smfmac_f32_16x16x64_bf16 v[80:83], v[192:195], a[224:231], v9
    s_waitcnt vmcnt(0)
    v_max3_u32 v4, v200, v201, v202
    v_max3_u32 v5, v203, v204, v205
    v_max3_u32 v4, v4, v206, v207
    v_smfmac_f32_16x16x64_bf16 v[76:79], v[196:199], a[200:207], v9
    v_max_u32 v4, v4, v5
    v_cmp_eq_u32 vcc, -1, v4
    v_smfmac_f32_16x16x64_bf16 v[80:83], v[196:199], a[232:239], v9
    s_cbranch_vccnz .A_325
.W_326:
    v_smfmac_f32_16x16x64_bf16 v[76:79], v[200:203], a[208:215], v9
    v_smfmac_f32_16x16x64_bf16 v[80:83], v[200:203], a[240:247], v9
    v_smfmac_f32_16x16x64_bf16 v[76:79], v[204:207], a[216:223], v9
    v_smfmac_f32_16x16x64_bf16 v[80:83], v[204:207], a[248:255], v9
    s_branch .mj_217
.A_327:
    buffer_load_dwordx4 v[208:211], v246, s[8:11], s33 offen offset:0 sc1
    buffer_load_dwordx4 v[212:215], v246, s[8:11], s33 offen offset:1024 sc1
    s_sub_u32 s62, s62, 1
    s_cbranch_scc1 .mg_end_1
    s_waitcnt vmcnt(4)
    v_max3_u32 v4, v192, v193, v194
    v_max3_u32 v5, v195, v196, v197
    v_max3_u32 v4, v4, v198, v199
    v_max_u32 v4, v4, v5
    v_cmp_eq_u32 vcc, -1, v4
    s_cbranch_vccz .W_310
.A_309:
    buffer_load_dwordx4 v[192:195], v246, s[8:11], s32 offen offset:0 sc1
    buffer_load_dwordx4 v[196:199], v246, s[8:11], s32 offen offset:1024 sc1
    s_waitcnt vmcnt(4)
    v_max3_u32 v4, v200, v201, v202
    v_max3_u32 v5, v203, v204, v205
    v_max3_u32 v4, v4, v206, v207
    v_max_u32 v4, v4, v5
    v_cmp_eq_u32 vcc, -1, v4
    s_cbranch_vccz .W_328
.A_329:
    buffer_load_dwordx4 v[200:203], v246, s[8:11], s32 offen offset:2048 sc1
    buffer_load_dwordx4 v[204:207], v246, s[8:11], s32 offen offset:3072 sc1
    s_waitcnt vmcnt(4)
    v_max3_u32 v4, v208, v209, v210
    v_max3_u32 v5, v211, v212, v213
    v_max3_u32 v4, v4, v214, v215
    v_max_u32 v4, v4, v5
    v_cmp_eq_u32 vcc, -1, v4
    s_cbranch_vccnz .A_327
.W_330:
    v_smfmac_f32_16x16x64_bf16 v[76:79], v[208:211], v[124:131], v9
    v_smfmac_f32_16x16x64_bf16 v[80:83], v[208:211], v[156:163], v9
    s_waitcnt vmcnt(2)
    v_max3_u32 v4, v192, v193, v194
    v_max3_u32 v5, v195, v196, v197
    v_max3_u32 v4, v4, v198, v199
    v_smfmac_f32_16x16x64_bf16 v[76:79], v[212:215], v[132:139], v9
    v_max_u32 v4, v4, v5
    v_cmp_eq_u32 vcc, -1, v4
    v_smfmac_f32_16x16x64_bf16 v[80:83], v[212:215], v[164:171], v9
    s_cbranch_vccz .W_324
    s_branch .A_323
.W_328:
    v_smfmac_f32_16x16x64_bf16 v[76:79], v[200:203], a[208:215], v9
    v_smfmac_f32_16x16x64_bf16 v[80:83], v[200:203], a[240:247], v9
    s_waitcnt vmcnt(2)
    v_max3_u32 v4, v208, v209, v210
    v_max3_u32 v5, v211, v212, v213
    v_max3_u32 v4, v4, v214, v215
    v_smfmac_f32_16x16x64_bf16 v[76:79], v[204:207], a[216:223], v9
    v_max_u32 v4, v4, v5
    v_cmp_eq_u32 vcc, -1, v4
    v_smfmac_f32_16x16x64_bf16 v[80:83], v[204:207], a[248:255], v9
    s_cbranch_vccnz .A_331
.W_332:
    v_smfmac_f32_16x16x64_bf16 v[76:79], v[208:211], v[124:131], v9
    v_smfmac_f32_16x16x64_bf16 v[80:83], v[208:211], v[156:163], v9
    s_waitcnt vmcnt(0)
    v_max3_u32 v4, v192, v193, v194
    v_max3_u32 v5, v195, v196, v197
    v_max3_u32 v4, v4, v198, v199
    v_smfmac_f32_16x16x64_bf16 v[76:79], v[212:215], v[132:139], v9
    v_max_u32 v4, v4, v5
    v_cmp_eq_u32 vcc, -1, v4
    v_smfmac_f32_16x16x64_bf16 v[80:83], v[212:215], v[164:171], v9
    s_cbranch_vccz .W_320
    s_branch .A_319
.A_333:
    buffer_load_dwordx4 v[200:203], v246, s[8:11], s32 offen offset:2048 sc1
    buffer_load_dwordx4 v[204:207], v246, s[8:11], s32 offen offset:3072 sc1
    s_sub_u32 s62, s62, 1
    s_cbranch_scc1 .mg_end_1
    s_waitcnt vmcnt(4)
    v_max3_u32 v4, v216, v217, v218
    v_max3_u32 v5, v219, v220, v221
    v_max3_u32 v4, v4, v222, v223
    v_max_u32 v4, v4, v5
    v_cmp_eq_u32 vcc, -1, v4
    s_cbranch_vccz .W_322
.A_321:
    buffer_load_dwordx4 v[216:219], v246, s[8:11], s33 offen offset:2048 sc1
    buffer_load_dwordx4 v[220:223], v246, s[8:11], s33 offen offset:3072 sc1
    s_waitcnt vmcnt(4)
    v_max3_u32 v4, v192, v193, v194
    v_max3_u32 v5, v195, v196, v197
    v_max3_u32 v4, v4, v198, v199
    v_max_u32 v4, v4, v5
    v_cmp_eq_u32 vcc, -1, v4
    s_cbranch_vccz .W_334
.A_335:
    buffer_load_dwordx4 v[192:195], v246, s[8:11], s32 offen offset:0 sc1
    buffer_load_dwordx4 v[196:199], v246, s[8:11], s32 offen offset:1024 sc1
    s_waitcnt vmcnt(4)
    v_max3_u32 v4, v200, v201, v202
    v_max3_u32 v5, v203, v204, v205
    v_max3_u32 v4, v4, v206, v207
    v_max_u32 v4, v4, v5
    v_cmp_eq_u32 vcc, -1, v4
    s_cbranch_vccnz .A_333
.W_336:
    v_smfmac_f32_16x16x64_bf16 v[76:79], v[200:203], a[208:215], v9
    v_smfmac_f32_16x16x64_bf16 v[80:83], v[200:203], a[240:247], v9
    s_waitcnt vmcnt(2)
    v_max3_u32 v4, v216, v217, v218
    v_max3_u32 v5, v219, v220, v221
    v_max3_u32 v4, v4, v222, v223
    v_smfmac_f32_16x16x64_bf16 v[76:79], v[204:207], a[216:223], v9
    v_max_u32 v4, v4, v5
    v_cmp_eq_u32 vcc, -1, v4
    v_smfmac_f32_16x16x64_bf16 v[80:83], v[204:207], a[248:255], v9
    s_cbranch_vccz .W_318
    s_branch .A_317
.W_334:
    v_smfmac_f32_16x16x64_bf16 v[76:79], v[192:195], a[192:199], v9
    v_smfmac_f32_16x16x64_bf16 v[80:83], v[192:195], a[224:231], v9
    s_waitcnt vmcnt(2)
    v_max3_u32 v4, v200, v201, v202
    v_max3_u32 v5, v203, v204, v205
    v_max3_u32 v4, v4, v206, v207
    v_smfmac_f32_16x16x64_bf16 v[76:79], v[196:199], a[200:207], v9
    v_max_u32 v4, v4, v5
    v_cmp_eq_u32 vcc, -1, v4
    v_smfmac_f32_16x16x64_bf16 v[80:83], v[196:199], a[232:239], v9
    s_cbranch_vccnz .A_337
.W_338:
    v_smfmac_f32_16x16x64_bf16 v[76:79], v[200:203], a[208:215], v9
    v_smfmac_f32_16x16x64_bf16 v[80:83], v[200:203], a[240:247], v9
    s_waitcnt vmcnt(0)
    v_max3_u32 v4, v216, v217, v218
    v_max3_u32 v5, v219, v220, v221
    v_max3_u32 v4, v4, v222, v223
    v_smfmac_f32_16x16x64_bf16 v[76:79], v[204:207], a[216:223], v9
    v_max_u32 v4, v4, v5
    v_cmp_eq_u32 vcc, -1, v4
    v_smfmac_f32_16x16x64_bf16 v[80:83], v[204:207], a[248:255], v9
    s_cbranch_vccz .W_225
    s_branch .A_224
.A_339:
    buffer_load_dwordx4 v[216:219], v246, s[8:11], s33 offen offset:2048 sc1
    buffer_load_dwordx4 v[220:223], v246, s[8:11], s33 offen offset:3072 sc1
    s_sub_u32 s62, s62, 1
    s_cbranch_scc1 .mg_end_1
    s_waitcnt vmcnt(4)
    v_max3_u32 v4, v192, v193, v194
    v_max3_u32 v5, v195, v196, v197
    v_max3_u32 v4, v4, v198, v199
    v_max_u32 v4, v4, v5
    v_cmp_eq_u32 vcc, -1, v4
    s_cbranch_vccz .W_340
.A_341:
    buffer_load_dwordx4 v[192:195], v246, s[8:11], s32 offen offset:0 sc1
    buffer_load_dwordx4 v[196:199], v246, s[8:11], s32 offen offset:1024 sc1
    s_waitcnt vmcnt(4)
    v_max3_u32 v4, v208, v209, v210
    v_max3_u32 v5, v211, v212, v213
    v_max3_u32 v4, v4, v214, v215
    v_max_u32 v4, v4, v5
    v_cmp_eq_u32 vcc, -1, v4
    s_cbranch_vccz .W_316
.A_315:
    buffer_load_dwordx4 v[208:211], v246, s[8:11], s33 offen offset:0 sc1
    buffer_load_dwordx4 v[212:215], v246, s[8:11], s33 offen offset:1024 sc1
    s_waitcnt vmcnt(4)
    v_max3_u32 v4, v216, v217, v218
    v_max3_u32 v5, v219, v220, v221
    v_max3_u32 v4, v4, v222, v223
    v_max_u32 v4, v4, v5
    v_cmp_eq_u32 vcc, -1, v4
    s_cbranch_vccnz .A_339
.W_342:
    v_smfmac_f32_16x16x64_bf16 v[76:79], v[216:219], v[140:147], v9
    v_smfmac_f32_16x16x64_bf16 v[80:83], v[216:219], v[172:179], v9
    s_waitcnt vmcnt(2)
    v_max3_u32 v4, v192, v193, v194
    v_max3_u32 v5, v195, v196, v197
    v_max3_u32 v4, v4, v198, v199
    v_smfmac_f32_16x16x64_bf16 v[76:79], v[220:223], v[148:155], v9
    v_max_u32 v4, v4, v5
    v_cmp_eq_u32 vcc, -1, v4
    v_smfmac_f32_16x16x64_bf16 v[80:83], v[220:223], v[180:187], v9
    s_cbranch_vccnz .A_343
.W_344:
    v_smfmac_f32_16x16x64_bf16 v[76:79], v[192:195], a[192:199], v9
    v_smfmac_f32_16x16x64_bf16 v[80:83], v[192:195], a[224:231], v9
    s_waitcnt vmcnt(0)
    v_max3_u32 v4, v208, v209, v210
    v_max3_u32 v5, v211, v212, v213
    v_max3_u32 v4, v4, v214, v215
    v_smfmac_f32_16x16x64_bf16 v[76:79], v[196:199], a[200:207], v9
    v_max_u32 v4, v4, v5
    v_cmp_eq_u32 vcc, -1, v4
    v_smfmac_f32_16x16x64_bf16 v[80:83], v[196:199], a[232:239], v9
    s_cbranch_vccz .W_314
    s_branch .A_313
.W_340:
    v_smfmac_f32_16x16x64_bf16 v[76:79], v[192:195], a[192:199], v9
    v_smfmac_f32_16x16x64_bf16 v[80:83], v[192:195], a[224:231], v9
    s_waitcnt vmcnt(2)
    v_max3_u32 v4, v208, v209, v210
    v_max3_u32 v5, v211, v212, v213
    v_max3_u32 v4, v4, v214, v215
    v_smfmac_f32_16x16x64_bf16 v[76:79], v[196:199], a[200:207], v9
    v_max_u32 v4, v4, v5
    v_cmp_eq_u32 vcc, -1, v4
    v_smfmac_f32_16x16x64_bf16 v[80:83], v[196:199], a[232:239], v9
    s_cbranch_vccz .W_223
    s_branch .A_222
.A_345:
    buffer_load_dwordx4 v[216:219], v246, s[8:11], s33 offen offset:2048 sc1
    buffer_load_dwordx4 v[220:223], v246, s[8:11], s33 offen offset:3072 sc1
    s_sub_u32 s62, s62, 1
    s_cbranch_scc1 .mg_end_1
    s_waitcnt vmcnt(4)
    v_max3_u32 v4, v200, v201, v202
    v_max3_u32 v5, v203, v204, v205
    v_max3_u32 v4, v4, v206, v207
    v_max_u32 v4, v4, v5
    v_cmp_eq_u32 vcc, -1, v4
    s_cbranch_vccz .W_221
.A_220:
    buffer_load_dwordx4 v[200:203], v246, s[8:11], s32 offen offset:2048 sc1
    buffer_load_dwordx4 v[204:207], v246, s[8:11], s32 offen offset:3072 sc1
    s_waitcnt vmcnt(4)
    v_max3_u32 v4, v208, v209, v210
    v_max3_u32 v5, v211, v212, v213
    v_max3_u32 v4, v4, v214, v215
    v_max_u32 v4, v4, v5
    v_cmp_eq_u32 vcc, -1, v4
    s_cbranch_vccz .W_346
.A_347:
    buffer_load_dwordx4 v[208:211], v246, s[8:11], s33 offen offset:0 sc1
    buffer_load_dwordx4 v[212:215], v246, s[8:11], s33 offen offset:1024 sc1
    s_waitcnt vmcnt(4)
    v_max3_u32 v4, v216, v217, v218
    v_max3_u32 v5, v219, v220, v221
    v_max3_u32 v4, v4, v222, v223
    v_max_u32 v4, v4, v5
    v_cmp_eq_u32 vcc, -1, v4
    s_cbranch_vccnz .A_345
.W_348:
    v_smfmac_f32_16x16x64_bf16 v[76:79], v[216:219], v[140:147], v9
    v_smfmac_f32_16x16x64_bf16 v[80:83], v[216:219], v[172:179], v9
    s_waitcnt vmcnt(2)
    v_max3_u32 v4, v200, v201, v202
    v_max3_u32 v5, v203, v204, v205
    v_max3_u32 v4, v4, v206, v207
    v_smfmac_f32_16x16x64_bf16 v[76:79], v[220:223], v[148:155], v9
    v_max_u32 v4, v4, v5
    v_cmp_eq_u32 vcc, -1, v4
    v_smfmac_f32_16x16x64_bf16 v[80:83], v[220:223], v[180:187], v9
    s_cbranch_vccz .W_312
    s_branch .A_311
.W_346:
    v_smfmac_f32_16x16x64_bf16 v[76:79], v[208:211], v[124:131], v9
    v_smfmac_f32_16x16x64_bf16 v[80:83], v[208:211], v[156:163], v9
    s_waitcnt vmcnt(2)
    v_max3_u32 v4, v216, v217, v218
    v_max3_u32 v5, v219, v220, v221
    v_max3_u32 v4, v4, v222, v223
    v_smfmac_f32_16x16x64_bf16 v[76:79], v[212:215], v[132:139], v9
    v_max_u32 v4, v4, v5
    v_cmp_eq_u32 vcc, -1, v4
    v_smfmac_f32_16x16x64_bf16 v[80:83], v[212:215], v[164:171], v9
    s_cbranch_vccnz .A_349
.W_350:
    v_smfmac_f32_16x16x64_bf16 v[76:79], v[216:219], v[140:147], v9
    v_smfmac_f32_16x16x64_bf16 v[80:83], v[216:219], v[172:179], v9
    s_waitcnt vmcnt(0)
    v_max3_u32 v4, v200, v201, v202
    v_max3_u32 v5, v203, v204, v205
    v_max3_u32 v4, v4, v206, v207
    v_smfmac_f32_16x16x64_bf16 v[76:79], v[220:223], v[148:155], v9
    v_max_u32 v4, v4, v5
    v_cmp_eq_u32 vcc, -1, v4
    v_smfmac_f32_16x16x64_bf16 v[80:83], v[220:223], v[180:187], v9
    s_cbranch_vccz .W_326
    s_branch .A_325
.A_351:
    buffer_load_dwordx4 v[200:203], v246, s[8:11], s32 offen offset:2048 sc1
    buffer_load_dwordx4 v[204:207], v246, s[8:11], s32 offen offset:3072 sc1
    s_sub_u32 s62, s62, 1
    s_cbranch_scc1 .mg_end_1
    s_waitcnt vmcnt(2)
    v_max3_u32 v4, v192, v193, v194
    v_max3_u32 v5, v195, v196, v197
    v_max3_u32 v4, v4, v198, v199
    v_max_u32 v4, v4, v5
    v_cmp_eq_u32 vcc, -1, v4
    s_cbranch_vccz .W_324
.A_323:
    buffer_load_dwordx4 v[192:195], v246, s[8:11], s32 offen offset:0 sc1
    buffer_load_dwordx4 v[196:199], v246, s[8:11], s32 offen offset:1024 sc1
    s_waitcnt vmcnt(2)
    v_max3_u32 v4, v200, v201, v202
    v_max3_u32 v5, v203, v204, v205
    v_max3_u32 v4, v4, v206, v207
    v_max_u32 v4, v4, v5
    v_cmp_eq_u32 vcc, -1, v4
    s_cbranch_vccnz .A_351
.W_352:
    v_smfmac_f32_16x16x64_bf16 v[76:79], v[200:203], a[208:215], v9
    v_smfmac_f32_16x16x64_bf16 v[80:83], v[200:203], a[240:247], v9
    s_waitcnt vmcnt(0)
    v_max3_u32 v4, v192, v193, v194
    v_max3_u32 v5, v195, v196, v197
    v_max3_u32 v4, v4, v198, v199
    v_smfmac_f32_16x16x64_bf16 v[76:79], v[204:207], a[216:223], v9
    v_max_u32 v4, v4, v5
    v_cmp_eq_u32 vcc, -1, v4
    v_smfmac_f32_16x16x64_bf16 v[80:83], v[204:207], a[248:255], v9
    s_cbranch_vccz .W_320
    s_branch .A_319
.A_331:
    buffer_load_dwordx4 v[208:211], v246, s[8:11], s33 offen offset:0 sc1
    buffer_load_dwordx4 v[212:215], v246, s[8:11], s33 offen offset:1024 sc1
    s_sub_u32 s62, s62, 1
    s_cbranch_scc1 .mg_end_1
    s_waitcnt vmcnt(2)
    v_max3_u32 v4, v192, v193, v194
    v_max3_u32 v5, v195, v196, v197
    v_max3_u32 v4, v4, v198, v199
    v_max_u32 v4, v4, v5
    v_cmp_eq_u32 vcc, -1, v4
    s_cbranch_vccz .W_344
.A_343:
    buffer_load_dwordx4 v[192:195], v246, s[8:11], s32 offen offset:0 sc1
    buffer_load_dwordx4 v[196:199], v246, s[8:11], s32 offen offset:1024 sc1
    s_waitcnt vmcnt(2)
    v_max3_u32 v4, v208, v209, v210
    v_max3_u32 v5, v211, v212, v213
    v_max3_u32 v4, v4, v214, v215
    v_max_u32 v4, v4, v5
    v_cmp_eq_u32 vcc, -1, v4
    s_cbranch_vccnz .A_331
    s_branch .W_332
.A_353:
    buffer_load_dwordx4 v[192:195], v246, s[8:11], s32 offen offset:0 sc1
    buffer_load_dwordx4 v[196:199], v246, s[8:11], s32 offen offset:1024 sc1
    s_sub_u32 s62, s62, 1
    s_cbranch_scc1 .mg_end_1
    s_waitcnt vmcnt(2)
    v_max3_u32 v4, v216, v217, v218
    v_max3_u32 v5, v219, v220, v221
    v_max3_u32 v4, v4, v222, v223
    v_max_u32 v4, v4, v5
    v_cmp_eq_u32 vcc, -1, v4
    s_cbranch_vccz .W_318
.A_317:
    buffer_load_dwordx4 v[216:219], v246, s[8:11], s33 offen offset:2048 sc1
    buffer_load_dwordx4 v[220:223], v246, s[8:11], s33 offen offset:3072 sc1
    s_waitcnt vmcnt(2)
    v_max3_u32 v4, v192, v193, v194
    v_max3_u32 v5, v195, v196, v197
    v_max3_u32 v4, v4, v198, v199
    v_max_u32 v4, v4, v5
    v_cmp_eq_u32 vcc, -1, v4
    s_cbranch_vccnz .A_353
.W_354:
    v_smfmac_f32_16x16x64_bf16 v[76:79], v[192:195], a[192:199], v9
    v_smfmac_f32_16x16x64_bf16 v[80:83], v[192:195], a[224:231], v9
    s_waitcnt vmcnt(0)
    v_max3_u32 v4, v216, v217, v218
    v_max3_u32 v5, v219, v220, v221
    v_max3_u32 v4, v4, v222, v223
    v_smfmac_f32_16x16x64_bf16 v[76:79], v[196:199], a[200:207], v9
    v_max_u32 v4, v4, v5
    v_cmp_eq_u32 vcc, -1, v4
    v_smfmac_f32_16x16x64_bf16 v[80:83], v[196:199], a[232:239], v9
    s_cbranch_vccz .W_225
    s_branch .A_224
.A_355:
    buffer_load_dwordx4 v[208:211], v246, s[8:11], s33 offen offset:0 sc1
    buffer_load_dwordx4 v[212:215], v246, s[8:11], s33 offen offset:1024 sc1
    s_sub_u32 s62, s62, 1
    s_cbranch_scc1 .mg_end_1
    s_waitcnt vmcnt(2)
    v_max3_u32 v4, v200, v201, v202
    v_max3_u32 v5, v203, v204, v205
    v_max3_u32 v4, v4, v206, v207
    v_max_u32 v4, v4, v5
    v_cmp_eq_u32 vcc, -1, v4
    s_cbranch_vccz .W_312
.A_311:
    buffer_load_dwordx4 v[200:203], v246, s[8:11], s32 offen offset:2048 sc1
    buffer_load_dwordx4 v[204:207], v246, s[8:11], s32 offen offset:3072 sc1
    s_waitcnt vmcnt(2)
    v_max3_u32 v4, v208, v209, v210
    v_max3_u32 v5, v211, v212, v213
    v_max3_u32 v4, v4, v214, v215
    v_max_u32 v4, v4, v5
    v_cmp_eq_u32 vcc, -1, v4
    s_cbranch_vccnz .A_355
.W_356:
    v_smfmac_f32_16x16x64_bf16 v[76:79], v[208:211], v[124:131], v9
    v_smfmac_f32_16x16x64_bf16 v[80:83], v[208:211], v[156:163], v9
    s_waitcnt vmcnt(0)
    v_max3_u32 v4, v200, v201, v202
    v_max3_u32 v5, v203, v204, v205
    v_max3_u32 v4, v4, v206, v207
    v_smfmac_f32_16x16x64_bf16 v[76:79], v[212:215], v[132:139], v9
    v_max_u32 v4, v4, v5
    v_cmp_eq_u32 vcc, -1, v4
    v_smfmac_f32_16x16x64_bf16 v[80:83], v[212:215], v[164:171], v9
    s_cbranch_vccz .W_326
    s_branch .A_325
.A_349:
    buffer_load_dwordx4 v[216:219], v246, s[8:11], s33 offen offset:2048 sc1
    buffer_load_dwordx4 v[220:223], v246, s[8:11], s33 offen offset:3072 sc1
    s_sub_u32 s62, s62, 1
    s_cbranch_scc1 .mg_end_1
    s_waitcnt vmcnt(2)
    v_max3_u32 v4, v200, v201, v202
    v_max3_u32 v5, v203, v204, v205
    v_max3_u32 v4, v4, v206, v207
    v_max_u32 v4, v4, v5
    v_cmp_eq_u32 vcc, -1, v4
    s_cbranch_vccz .W_338
.A_337:
    buffer_load_dwordx4 v[200:203], v246, s[8:11], s32 offen offset:2048 sc1
    buffer_load_dwordx4 v[204:207], v246, s[8:11], s32 offen offset:3072 sc1
    s_waitcnt vmcnt(2)
    v_max3_u32 v4, v216, v217, v218
    v_max3_u32 v5, v219, v220, v221
    v_max3_u32 v4, v4, v222, v223
    v_max_u32 v4, v4, v5
    v_cmp_eq_u32 vcc, -1, v4
    s_cbranch_vccnz .A_349
    s_branch .W_350
.A_357:
    buffer_load_dwordx4 v[216:219], v246, s[8:11], s33 offen offset:2048 sc1
    buffer_load_dwordx4 v[220:223], v246, s[8:11], s33 offen offset:3072 sc1
    s_sub_u32 s62, s62, 1
    s_cbranch_scc1 .mg_end_1
    s_waitcnt vmcnt(2)
    v_max3_u32 v4, v208, v209, v210
    v_max3_u32 v5, v211, v212, v213
    v_max3_u32 v4, v4, v214, v215
    v_max_u32 v4, v4, v5
    v_cmp_eq_u32 vcc, -1, v4
    s_cbranch_vccz .W_223
.A_222:
    buffer_load_dwordx4 v[208:211], v246, s[8:11], s33 offen offset:0 sc1
    buffer_load_dwordx4 v[212:215], v246, s[8:11], s33 offen offset:1024 sc1
    s_waitcnt vmcnt(2)
    v_max3_u32 v4, v216, v217, v218
    v_max3_u32 v5, v219, v220, v221
    v_max3_u32 v4, v4, v222, v223
    v_max_u32 v4, v4, v5
    v_cmp_eq_u32 vcc, -1, v4
    s_cbranch_vccnz .A_357
.W_358:
    v_smfmac_f32_16x16x64_bf16 v[76:79], v[216:219], v[140:147], v9
    v_smfmac_f32_16x16x64_bf16 v[80:83], v[216:219], v[172:179], v9
    s_waitcnt vmcnt(0)
    v_max3_u32 v4, v208, v209, v210
    v_max3_u32 v5, v211, v212, v213
    v_max3_u32 v4, v4, v214, v215
    v_smfmac_f32_16x16x64_bf16 v[76:79], v[220:223], v[148:155], v9
    v_max_u32 v4, v4, v5
    v_cmp_eq_u32 vcc, -1, v4
    v_smfmac_f32_16x16x64_bf16 v[80:83], v[220:223], v[180:187], v9
    s_cbranch_vccz .W_314
    s_branch .A_313
.A_319:
    buffer_load_dwordx4 v[192:195], v246, s[8:11], s32 offen offset:0 sc1
    buffer_load_dwordx4 v[196:199], v246, s[8:11], s32 offen offset:1024 sc1
    s_sub_u32 s62, s62, 1
    s_cbranch_scc1 .mg_end_1
    s_waitcnt vmcnt(2)
    v_max3_u32 v4, v192, v193, v194
    v_max3_u32 v5, v195, v196, v197
    v_max3_u32 v4, v4, v198, v199
    v_max_u32 v4, v4, v5
    v_cmp_eq_u32 vcc, -1, v4
    s_cbranch_vccnz .A_319
    v_smfmac_f32_16x16x64_bf16 v[76:79], v[192:195], a[192:199], v9
    v_smfmac_f32_16x16x64_bf16 v[80:83], v[192:195], a[224:231], v9
    v_smfmac_f32_16x16x64_bf16 v[76:79], v[196:199], a[200:207], v9
    v_smfmac_f32_16x16x64_bf16 v[80:83], v[196:199], a[232:239], v9
    s_branch .mj_217
.A_325:
    buffer_load_dwordx4 v[200:203], v246, s[8:11], s32 offen offset:2048 sc1
    buffer_load_dwordx4 v[204:207], v246, s[8:11], s32 offen offset:3072 sc1
    s_sub_u32 s62, s62, 1
    s_cbranch_scc1 .mg_end_1
    s_waitcnt vmcnt(2)
    v_max3_u32 v4, v200, v201, v202
    v_max3_u32 v5, v203, v204, v205
    v_max3_u32 v4, v4, v206, v207
    v_max_u32 v4, v4, v5
    v_cmp_eq_u32 vcc, -1, v4
    s_cbranch_vccnz .A_325
    v_smfmac_f32_16x16x64_bf16 v[76:79], v[200:203], a[208:215], v9
    v_smfmac_f32_16x16x64_bf16 v[80:83], v[200:203], a[240:247], v9
    v_smfmac_f32_16x16x64_bf16 v[76:79], v[204:207], a[216:223], v9
    v_smfmac_f32_16x16x64_bf16 v[80:83], v[204:207], a[248:255], v9
    s_branch .mj_217
.A_313:
    buffer_load_dwordx4 v[208:211], v246, s[8:11], s33 offen offset:0 sc1
    buffer_load_dwordx4 v[212:215], v246, s[8:11], s33 offen offset:1024 sc1
    s_sub_u32 s62, s62, 1
    s_cbranch_scc1 .mg_end_1
    s_waitcnt vmcnt(2)
    v_max3_u32 v4, v208, v209, v210
    v_max3_u32 v5, v211, v212, v213
    v_max3_u32 v4, v4, v214, v215
    v_max_u32 v4, v4, v5
    v_cmp_eq_u32 vcc, -1, v4
    s_cbranch_vccnz .A_313
    v_smfmac_f32_16x16x64_bf16 v[76:79], v[208:211], v[124:131], v9
    v_smfmac_f32_16x16x64_bf16 v[80:83], v[208:211], v[156:163], v9
    v_smfmac_f32_16x16x64_bf16 v[76:79], v[212:215], v[132:139], v9
    v_smfmac_f32_16x16x64_bf16 v[80:83], v[212:215], v[164:171], v9
    s_branch .mj_217
.A_224:
    buffer_load_dwordx4 v[216:219], v246, s[8:11], s33 offen offset:2048 sc1
    buffer_load_dwordx4 v[220:223], v246, s[8:11], s33 offen offset:3072 sc1
    s_sub_u32 s62, s62, 1
    s_cbranch_scc1 .mg_end_1
    s_waitcnt vmcnt(2)
    v_max3_u32 v4, v216, v217, v218
    v_max3_u32 v5, v219, v220, v221
    v_max3_u32 v4, v4, v222, v223
    v_max_u32 v4, v4, v5
    v_cmp_eq_u32 vcc, -1, v4
    s_cbranch_vccnz .A_224
    v_smfmac_f32_16x16x64_bf16 v[76:79], v[216:219], v[140:147], v9
    v_smfmac_f32_16x16x64_bf16 v[80:83], v[216:219], v[172:179], v9
    v_smfmac_f32_16x16x64_bf16 v[76:79], v[220:223], v[148:155], v9
    v_smfmac_f32_16x16x64_bf16 v[80:83], v[220:223], v[180:187], v9
    s_branch .mj_217
.sk_226:
    s_mov_b64 exec, s[66:67]
    buffer_store_dwordx4 v[88:91], v11, s[8:11], s36 offen sc1
    s_mov_b64 exec, s[56:57]
    buffer_store_dwordx4 v[172:175], v12, s[8:11], s36 offen sc1
    s_mov_b64 exec, -1

    s_branch .rec_fin_5
.rec_fin_5:
    s_mov_b64 exec, -1
    s_endpgm
.mg_bg_2:
    s_sub_u32 s91, s25, 4
    s_lshl_b32 s90, s91, 5
    s_add_u32 s90, s90, s26
    s_cmp_ge_u32 s26, 24
    s_cbranch_scc1 .cvrole_359
    s_lshr_b32 s30, s26, 3
    s_sub_u32 s30, 2, s30
    s_and_b32 s31, s26, 7
    s_lshl_b32 s4, s91, 3
    s_add_u32 s31, s31, s4

    s_load_dwordx2 s[40:41], s[0:1], 0
    s_load_dwordx4 s[44:47], s[0:1], 64
    s_load_dwordx2 s[42:43], s[0:1], 80

    v_and_b32 v1, 63, v0
    v_and_b32 v2, 15, v1
    v_lshrrev_b32 v3, 4, v1

    s_lshl_b32 s28, s31, 8
    s_waitcnt lgkmcnt(0)
    s_cmp_eq_u32 s30, 0
    s_cselect_b64 s[42:43], s[44:45], s[42:43]
    s_cmp_eq_u32 s30, 1
    s_cselect_b64 s[42:43], s[46:47], s[42:43]

    s_mov_b32 s16, s40
    s_and_b32 s17, s41, 0xffff
    s_mov_b32 s18, 0x400000
    s_mov_b32 s19, 0x00020000

    s_mov_b32 s12, s42
    s_and_b32 s13, s43, 0xffff
    s_mov_b32 s14, 0x800000
    s_mov_b32 s15, 0x00020000

    v_lshrrev_b32 v4, 1, v2
    v_xor_b32 v4, v4, v3
    v_lshlrev_b32 v4, 1, v4
    v_and_b32 v5, 1, v1
    v_or_b32 v4, v4, v5
    v_lshlrev_b32 v4, 4, v4
    v_lshlrev_b32 v5, 13, v3
    v_add_u32 v10, v4, v5
    v_xor_b32 v11, 0x80, v10
    s_lshl_b32 s4, s24, 18
    s_add_u32 s28, s28, s4
    s_lshl_b32 s29, s24, 13
    v_lshrrev_b32 v4, 2, v2
    v_and_b32 v5, 1, v3
    v_lshl_or_b32 v5, v5, 2, v4
    s_lshl_b32 s4, s24, 1
    v_xor_b32 v5, s4, v5
    v_lshlrev_b32 v5, 5, v5
    v_lshl_add_u32 v4, v3, 3, v4
    v_lshl_add_u32 v5, v4, 8, v5
    v_and_b32 v4, 3, v2
    v_lshl_add_u32 v12, v4, 3, v5
    v_xor_b32 v13, 32, v12
    v_add_u32 v14, 0x10000, v12
    v_add_u32 v15, 0x10000, v13

    s_add_u32 m0, s29, 0
    s_add_u32 s4, s28, 0
    buffer_load_dwordx4 v10, s[12:15], s4 offen lds

    s_add_u32 m0, s29, 1024
    s_add_u32 s4, s28, 32768
    buffer_load_dwordx4 v10, s[12:15], s4 offen lds

    s_add_u32 m0, s29, 2048
    s_add_u32 s4, s28, 65536
    buffer_load_dwordx4 v11, s[12:15], s4 offen lds

    s_add_u32 m0, s29, 3072
    s_add_u32 s4, s28, 98304
    buffer_load_dwordx4 v11, s[12:15], s4 offen lds

    s_add_u32 m0, s29, 4096
    s_add_u32 s4, s28, 131072
    buffer_load_dwordx4 v10, s[12:15], s4 offen lds

    s_add_u32 m0, s29, 5120
    s_add_u32 s4, s28, 163840
    buffer_load_dwordx4 v10, s[12:15], s4 offen lds

    s_add_u32 m0, s29, 6144
    s_add_u32 s4, s28, 196608
    buffer_load_dwordx4 v11, s[12:15], s4 offen lds

    s_add_u32 m0, s29, 7168
    s_add_u32 s4, s28, 229376
    buffer_load_dwordx4 v11, s[12:15], s4 offen lds

    s_add_u32 m0, s29, 32768
    s_add_u32 s4, s28, 1048576
    buffer_load_dwordx4 v10, s[12:15], s4 offen lds

    s_add_u32 m0, s29, 33792
    s_add_u32 s4, s28, 1081344
    buffer_load_dwordx4 v10, s[12:15], s4 offen lds

    s_add_u32 m0, s29, 34816
    s_add_u32 s4, s28, 1114112
    buffer_load_dwordx4 v11, s[12:15], s4 offen lds

    s_add_u32 m0, s29, 35840
    s_add_u32 s4, s28, 1146880
    buffer_load_dwordx4 v11, s[12:15], s4 offen lds

    s_add_u32 m0, s29, 36864
    s_add_u32 s4, s28, 1179648
    buffer_load_dwordx4 v10, s[12:15], s4 offen lds

    s_add_u32 m0, s29, 37888
    s_add_u32 s4, s28, 1212416
    buffer_load_dwordx4 v10, s[12:15], s4 offen lds

    s_add_u32 m0, s29, 38912
    s_add_u32 s4, s28, 1245184
    buffer_load_dwordx4 v11, s[12:15], s4 offen lds

    s_add_u32 m0, s29, 39936
    s_add_u32 s4, s28, 1277952
    buffer_load_dwordx4 v11, s[12:15], s4 offen lds

    s_add_u32 m0, s29, 65536
    s_add_u32 s4, s28, 2097152
    buffer_load_dwordx4 v10, s[12:15], s4 offen lds

    s_add_u32 m0, s29, 66560
    s_add_u32 s4, s28, 2129920
    buffer_load_dwordx4 v10, s[12:15], s4 offen lds

    s_add_u32 m0, s29, 67584
    s_add_u32 s4, s28, 2162688
    buffer_load_dwordx4 v11, s[12:15], s4 offen lds

    s_add_u32 m0, s29, 68608
    s_add_u32 s4, s28, 2195456
    buffer_load_dwordx4 v11, s[12:15], s4 offen lds

    s_add_u32 m0, s29, 69632
    s_add_u32 s4, s28, 2228224
    buffer_load_dwordx4 v10, s[12:15], s4 offen lds

    s_add_u32 m0, s29, 70656
    s_add_u32 s4, s28, 2260992
    buffer_load_dwordx4 v10, s[12:15], s4 offen lds

    s_add_u32 m0, s29, 71680
    s_add_u32 s4, s28, 2293760
    buffer_load_dwordx4 v11, s[12:15], s4 offen lds

    s_add_u32 m0, s29, 72704
    s_add_u32 s4, s28, 2326528
    buffer_load_dwordx4 v11, s[12:15], s4 offen lds

    s_add_u32 m0, s29, 98304
    s_add_u32 s4, s28, 3145728
    buffer_load_dwordx4 v10, s[12:15], s4 offen lds

    s_add_u32 m0, s29, 99328
    s_add_u32 s4, s28, 3178496
    buffer_load_dwordx4 v10, s[12:15], s4 offen lds

    s_add_u32 m0, s29, 100352
    s_add_u32 s4, s28, 3211264
    buffer_load_dwordx4 v11, s[12:15], s4 offen lds

    s_add_u32 m0, s29, 101376
    s_add_u32 s4, s28, 3244032
    buffer_load_dwordx4 v11, s[12:15], s4 offen lds

    s_add_u32 m0, s29, 102400
    s_add_u32 s4, s28, 3276800
    buffer_load_dwordx4 v10, s[12:15], s4 offen lds

    s_add_u32 m0, s29, 103424
    s_add_u32 s4, s28, 3309568
    buffer_load_dwordx4 v10, s[12:15], s4 offen lds

    s_add_u32 m0, s29, 104448
    s_add_u32 s4, s28, 3342336
    buffer_load_dwordx4 v11, s[12:15], s4 offen lds

    s_add_u32 m0, s29, 105472
    s_add_u32 s4, s28, 3375104
    buffer_load_dwordx4 v11, s[12:15], s4 offen lds

    v_and_b32 v243, 7, v0
    v_lshlrev_b32 v243, 2, v243
    buffer_load_dword v242, v243, s[20:23], 0 offen sc1

    s_lshl_b32 s4, s30, 5
    s_add_u32 s4, s4, s31
    s_lshl_b32 s4, s4, 8
    s_add_u32 s4, s4, 92274688
    v_mov_b32 v4, 0
    s_mov_b64 exec, 1
    buffer_store_dword v4, v4, s[8:11], s4 offen sc1
    s_mov_b64 exec, -1

    v_lshrrev_b32 v4, 3, v1
    v_and_b32 v5, 7, v1
    v_xor_b32 v5, v5, v4
    v_lshlrev_b32 v5, 4, v5
    v_lshl_add_u32 v16, v4, 11, v5
    s_lshl_b32 s4, s24, 14
    v_add_u32 v16, s4, v16
    v_and_b32 v4, 7, v2
    v_xor_b32 v5, v4, v3
    v_lshlrev_b32 v5, 4, v5
    v_lshl_add_u32 v5, v4, 7, v5
    v_lshrrev_b32 v4, 3, v2
    v_lshl_add_u32 v17, v4, 13, v5
    v_xor_b32 v18, 64, v17
    v_add_u32 v19, 0x10000, v17
    v_add_u32 v20, 0x10000, v18
    v_lshlrev_b32 v21, 4, v1
    s_lshl_b32 s32, s30, 24
    s_lshl_b32 s4, s31, 13
    s_add_u32 s32, s32, s4
    s_lshr_b32 s5, s30, 1
    s_add_u32 s5, s5, 10
    s_lshl_b32 s4, s24, s5
    s_add_u32 s39, s32, s4
    s_mov_b32 s32, 251658240
    s_mov_b32 s38, s32
    v_mov_b32 v23, -1
    s_lshl_b32 s4, s30, 5
    s_add_u32 s4, s4, s31
    s_lshl_b32 s4, s4, 8
    s_add_u32 s33, s4, 92274688
    s_cmp_eq_u32 s24, 0
    s_cselect_b32 s36, 1, 0
    s_mov_b32 s37, 0
    v_mov_b32 v22, 0
    s_mov_b32 s34, 0
    s_mov_b32 s35, 0

    s_mul_i32 s47, s26, 1441792
    s_lshl_b32 s4, s24, 10
    s_add_u32 s47, s47, s4
    s_add_u32 s47, s47, 184549376
    v_mov_b32 v24, -1
    v_mov_b32 v25, -1
    v_mov_b32 v26, -1
    v_mov_b32 v27, -1

    s_xor_b32 s4, s91, 1
    s_lshl_b32 s5, s4, 14
    s_lshl_b32 s6, s91, 12
    s_add_u32 s5, s5, s6
    v_add_u32 v28, s5, v21
    s_lshl_b32 s5, s91, 14
    s_lshl_b32 s6, s4, 12
    s_add_u32 s5, s5, s6
    v_add_u32 v7, s5, v21

    s_xor_b32 s4, s91, 2
    s_lshl_b32 s5, s4, 14
    s_lshl_b32 s6, s91, 12
    s_add_u32 s5, s5, s6
    v_add_u32 v29, s5, v21
    s_lshl_b32 s5, s91, 14
    s_lshl_b32 s6, s4, 12
    s_add_u32 s5, s5, s6
    v_add_u32 v8, s5, v21

    s_xor_b32 s4, s91, 3
    s_lshl_b32 s5, s4, 14
    s_lshl_b32 s6, s91, 12
    s_add_u32 s5, s5, s6
    v_add_u32 v30, s5, v21
    s_lshl_b32 s5, s91, 14
    s_lshl_b32 s6, s4, 12
    s_add_u32 s5, s5, s6
    v_add_u32 v9, s5, v21

    s_mov_b64 s[44:45], -1
    s_mov_b32 s46, s47
    s_waitcnt vmcnt(26)
    s_barrier
    ds_read_b64_tr_b16 a[0:1], v12 offset:0
    ds_read_b64_tr_b16 a[2:3], v12 offset:1024
    ds_read_b64_tr_b16 a[4:5], v13 offset:0
    ds_read_b64_tr_b16 a[6:7], v13 offset:1024
    ds_read_b64_tr_b16 a[8:9], v12 offset:8192
    ds_read_b64_tr_b16 a[10:11], v12 offset:9216
    ds_read_b64_tr_b16 a[12:13], v13 offset:8192
    ds_read_b64_tr_b16 a[14:15], v13 offset:9216
    ds_read_b64_tr_b16 a[16:17], v12 offset:16384
    ds_read_b64_tr_b16 a[18:19], v12 offset:17408
    ds_read_b64_tr_b16 a[20:21], v13 offset:16384
    ds_read_b64_tr_b16 a[22:23], v13 offset:17408
    ds_read_b64_tr_b16 a[24:25], v12 offset:24576
    ds_read_b64_tr_b16 a[26:27], v12 offset:25600
    ds_read_b64_tr_b16 a[28:29], v13 offset:24576
    ds_read_b64_tr_b16 a[30:31], v13 offset:25600
    s_waitcnt lgkmcnt(0)
    s_barrier
    s_add_u32 m0, s29, 0
    s_add_u32 s4, s28, 4194304
    buffer_load_dwordx4 v10, s[12:15], s4 offen lds

    s_add_u32 m0, s29, 1024
    s_add_u32 s4, s28, 4227072
    buffer_load_dwordx4 v10, s[12:15], s4 offen lds

    s_add_u32 m0, s29, 2048
    s_add_u32 s4, s28, 4259840
    buffer_load_dwordx4 v11, s[12:15], s4 offen lds

    s_add_u32 m0, s29, 3072
    s_add_u32 s4, s28, 4292608
    buffer_load_dwordx4 v11, s[12:15], s4 offen lds

    s_add_u32 m0, s29, 4096
    s_add_u32 s4, s28, 4325376
    buffer_load_dwordx4 v10, s[12:15], s4 offen lds

    s_add_u32 m0, s29, 5120
    s_add_u32 s4, s28, 4358144
    buffer_load_dwordx4 v10, s[12:15], s4 offen lds

    s_add_u32 m0, s29, 6144
    s_add_u32 s4, s28, 4390912
    buffer_load_dwordx4 v11, s[12:15], s4 offen lds

    s_add_u32 m0, s29, 7168
    s_add_u32 s4, s28, 4423680
    buffer_load_dwordx4 v11, s[12:15], s4 offen lds

    s_waitcnt vmcnt(26)
    s_barrier
    ds_read_b64_tr_b16 a[32:33], v12 offset:32768
    ds_read_b64_tr_b16 a[34:35], v12 offset:33792
    ds_read_b64_tr_b16 a[36:37], v13 offset:32768
    ds_read_b64_tr_b16 a[38:39], v13 offset:33792
    ds_read_b64_tr_b16 a[40:41], v12 offset:40960
    ds_read_b64_tr_b16 a[42:43], v12 offset:41984
    ds_read_b64_tr_b16 a[44:45], v13 offset:40960
    ds_read_b64_tr_b16 a[46:47], v13 offset:41984
    ds_read_b64_tr_b16 a[48:49], v12 offset:49152
    ds_read_b64_tr_b16 a[50:51], v12 offset:50176
    ds_read_b64_tr_b16 a[52:53], v13 offset:49152
    ds_read_b64_tr_b16 a[54:55], v13 offset:50176
    ds_read_b64_tr_b16 a[56:57], v12 offset:57344
    ds_read_b64_tr_b16 a[58:59], v12 offset:58368
    ds_read_b64_tr_b16 a[60:61], v13 offset:57344
    ds_read_b64_tr_b16 a[62:63], v13 offset:58368
    s_waitcnt lgkmcnt(0)
    s_barrier
    s_add_u32 m0, s29, 32768
    s_add_u32 s4, s28, 5242880
    buffer_load_dwordx4 v10, s[12:15], s4 offen lds

    s_add_u32 m0, s29, 33792
    s_add_u32 s4, s28, 5275648
    buffer_load_dwordx4 v10, s[12:15], s4 offen lds

    s_add_u32 m0, s29, 34816
    s_add_u32 s4, s28, 5308416
    buffer_load_dwordx4 v11, s[12:15], s4 offen lds

    s_add_u32 m0, s29, 35840
    s_add_u32 s4, s28, 5341184
    buffer_load_dwordx4 v11, s[12:15], s4 offen lds

    s_add_u32 m0, s29, 36864
    s_add_u32 s4, s28, 5373952
    buffer_load_dwordx4 v10, s[12:15], s4 offen lds

    s_add_u32 m0, s29, 37888
    s_add_u32 s4, s28, 5406720
    buffer_load_dwordx4 v10, s[12:15], s4 offen lds

    s_add_u32 m0, s29, 38912
    s_add_u32 s4, s28, 5439488
    buffer_load_dwordx4 v11, s[12:15], s4 offen lds

    s_add_u32 m0, s29, 39936
    s_add_u32 s4, s28, 5472256
    buffer_load_dwordx4 v11, s[12:15], s4 offen lds

    s_waitcnt vmcnt(26)
    s_barrier
    ds_read_b64_tr_b16 a[64:65], v14 offset:0
    ds_read_b64_tr_b16 a[66:67], v14 offset:1024
    ds_read_b64_tr_b16 a[68:69], v15 offset:0
    ds_read_b64_tr_b16 a[70:71], v15 offset:1024
    ds_read_b64_tr_b16 a[72:73], v14 offset:8192
    ds_read_b64_tr_b16 a[74:75], v14 offset:9216
    ds_read_b64_tr_b16 a[76:77], v15 offset:8192
    ds_read_b64_tr_b16 a[78:79], v15 offset:9216
    ds_read_b64_tr_b16 a[80:81], v14 offset:16384
    ds_read_b64_tr_b16 a[82:83], v14 offset:17408
    ds_read_b64_tr_b16 a[84:85], v15 offset:16384
    ds_read_b64_tr_b16 a[86:87], v15 offset:17408
    ds_read_b64_tr_b16 a[88:89], v14 offset:24576
    ds_read_b64_tr_b16 a[90:91], v14 offset:25600
    ds_read_b64_tr_b16 a[92:93], v15 offset:24576
    ds_read_b64_tr_b16 a[94:95], v15 offset:25600
    s_waitcnt lgkmcnt(0)
    s_barrier
    s_add_u32 m0, s29, 65536
    s_add_u32 s4, s28, 6291456
    buffer_load_dwordx4 v10, s[12:15], s4 offen lds

    s_add_u32 m0, s29, 66560
    s_add_u32 s4, s28, 6324224
    buffer_load_dwordx4 v10, s[12:15], s4 offen lds

    s_add_u32 m0, s29, 67584
    s_add_u32 s4, s28, 6356992
    buffer_load_dwordx4 v11, s[12:15], s4 offen lds

    s_add_u32 m0, s29, 68608
    s_add_u32 s4, s28, 6389760
    buffer_load_dwordx4 v11, s[12:15], s4 offen lds

    s_add_u32 m0, s29, 69632
    s_add_u32 s4, s28, 6422528
    buffer_load_dwordx4 v10, s[12:15], s4 offen lds

    s_add_u32 m0, s29, 70656
    s_add_u32 s4, s28, 6455296
    buffer_load_dwordx4 v10, s[12:15], s4 offen lds

    s_add_u32 m0, s29, 71680
    s_add_u32 s4, s28, 6488064
    buffer_load_dwordx4 v11, s[12:15], s4 offen lds

    s_add_u32 m0, s29, 72704
    s_add_u32 s4, s28, 6520832
    buffer_load_dwordx4 v11, s[12:15], s4 offen lds

    s_waitcnt vmcnt(26)
    s_barrier
    ds_read_b64_tr_b16 a[96:97], v14 offset:32768
    ds_read_b64_tr_b16 a[98:99], v14 offset:33792
    ds_read_b64_tr_b16 a[100:101], v15 offset:32768
    ds_read_b64_tr_b16 a[102:103], v15 offset:33792
    ds_read_b64_tr_b16 a[104:105], v14 offset:40960
    ds_read_b64_tr_b16 a[106:107], v14 offset:41984
    ds_read_b64_tr_b16 a[108:109], v15 offset:40960
    ds_read_b64_tr_b16 a[110:111], v15 offset:41984
    ds_read_b64_tr_b16 a[112:113], v14 offset:49152
    ds_read_b64_tr_b16 a[114:115], v14 offset:50176
    ds_read_b64_tr_b16 a[116:117], v15 offset:49152
    ds_read_b64_tr_b16 a[118:119], v15 offset:50176
    ds_read_b64_tr_b16 a[120:121], v14 offset:57344
    ds_read_b64_tr_b16 a[122:123], v14 offset:58368
    ds_read_b64_tr_b16 a[124:125], v15 offset:57344
    ds_read_b64_tr_b16 a[126:127], v15 offset:58368
    s_waitcnt lgkmcnt(0)
    s_barrier
    s_add_u32 m0, s29, 98304
    s_add_u32 s4, s28, 7340032
    buffer_load_dwordx4 v10, s[12:15], s4 offen lds

    s_add_u32 m0, s29, 99328
    s_add_u32 s4, s28, 7372800
    buffer_load_dwordx4 v10, s[12:15], s4 offen lds

    s_add_u32 m0, s29, 100352
    s_add_u32 s4, s28, 7405568
    buffer_load_dwordx4 v11, s[12:15], s4 offen lds

    s_add_u32 m0, s29, 101376
    s_add_u32 s4, s28, 7438336
    buffer_load_dwordx4 v11, s[12:15], s4 offen lds

    s_add_u32 m0, s29, 102400
    s_add_u32 s4, s28, 7471104
    buffer_load_dwordx4 v10, s[12:15], s4 offen lds

    s_add_u32 m0, s29, 103424
    s_add_u32 s4, s28, 7503872
    buffer_load_dwordx4 v10, s[12:15], s4 offen lds

    s_add_u32 m0, s29, 104448
    s_add_u32 s4, s28, 7536640
    buffer_load_dwordx4 v11, s[12:15], s4 offen lds

    s_add_u32 m0, s29, 105472
    s_add_u32 s4, s28, 7569408
    buffer_load_dwordx4 v11, s[12:15], s4 offen lds

    s_waitcnt vmcnt(24)
    s_barrier
    ds_read_b64_tr_b16 a[128:129], v12 offset:0
    ds_read_b64_tr_b16 a[130:131], v12 offset:1024
    ds_read_b64_tr_b16 a[132:133], v13 offset:0
    ds_read_b64_tr_b16 a[134:135], v13 offset:1024
    ds_read_b64_tr_b16 a[136:137], v12 offset:8192
    ds_read_b64_tr_b16 a[138:139], v12 offset:9216
    ds_read_b64_tr_b16 a[140:141], v13 offset:8192
    ds_read_b64_tr_b16 a[142:143], v13 offset:9216
    ds_read_b64_tr_b16 a[144:145], v12 offset:16384
    ds_read_b64_tr_b16 a[146:147], v12 offset:17408
    ds_read_b64_tr_b16 a[148:149], v13 offset:16384
    ds_read_b64_tr_b16 a[150:151], v13 offset:17408
    ds_read_b64_tr_b16 a[152:153], v12 offset:24576
    ds_read_b64_tr_b16 a[154:155], v12 offset:25600
    ds_read_b64_tr_b16 a[156:157], v13 offset:24576
    ds_read_b64_tr_b16 a[158:159], v13 offset:25600
    s_cmp_lg_u32 s97, 0
    s_cbranch_scc1 .vd_361
    s_mov_b32 s62, 0

.vp_360:
    v_cmp_ne_u32 vcc, 32, v242
    s_cbranch_vccz .vd_361
    v_readlane_b32 s4, v242, 0

    v_readlane_b32 s5, v242, 1
    s_add_u32 s4, s4, s5
    v_readlane_b32 s5, v242, 2
    s_add_u32 s4, s4, s5
    v_readlane_b32 s5, v242, 3
    s_add_u32 s4, s4, s5
    v_readlane_b32 s5, v242, 4
    s_add_u32 s4, s4, s5
    v_readlane_b32 s5, v242, 5
    s_add_u32 s4, s4, s5
    v_readlane_b32 s5, v242, 6
    s_add_u32 s4, s4, s5
    v_readlane_b32 s5, v242, 7
    s_add_u32 s4, s4, s5
    s_cmp_ge_u32 s4, 256
    s_cbranch_scc1 .vs_362
    s_add_u32 s62, s62, 1
    s_cmp_gt_u32 s62, 0x100000
    s_cbranch_scc1 .mg_end_1
    s_sleep 4
    buffer_load_dword v242, v243, s[20:23], 0 offen sc1
    s_waitcnt vmcnt(0)
    s_branch .vp_360

.vs_362:
    s_lshr_b32 s25, s2, 5
    s_and_b32 s26, s2, 31
    s_mov_b32 s27, 1
    s_mov_b32 s97, 1
    s_waitcnt vmcnt(0) lgkmcnt(0)
    s_barrier
    s_branch .mg_role_3

.vd_361:
    s_mov_b32 s97, 1
    s_cmp_lg_u32 s24, 0
    s_cbranch_scc1 .sg_363
    s_mov_b64 exec, 1
    v_mov_b32 v4, 1
    v_mov_b32 v5, 32
    buffer_atomic_add v4, v5, s[20:23], 0 offen sc1
    s_mov_b64 exec, -1

.sg_363:
    s_waitcnt lgkmcnt(0)
    s_barrier
    s_add_u32 m0, s29, 0
    s_nop 0
    buffer_load_dwordx4 v16, s[16:19], s34 offen offset:0 lds
    s_add_u32 m0, s29, 896
    s_nop 0
    buffer_load_dwordx4 v16, s[16:19], s34 offen offset:128 lds
    s_add_u32 m0, s29, 1792
    s_nop 0
    buffer_load_dwordx4 v16, s[16:19], s34 offen offset:256 lds
    s_add_u32 m0, s29, 2688
    s_nop 0
    buffer_load_dwordx4 v16, s[16:19], s34 offen offset:384 lds
    s_add_u32 m0, s29, 3584
    s_nop 0
    buffer_load_dwordx4 v16, s[16:19], s34 offen offset:512 lds
    s_add_u32 m0, s29, 4480
    s_nop 0
    buffer_load_dwordx4 v16, s[16:19], s34 offen offset:640 lds
    s_add_u32 m0, s29, 5376
    s_nop 0
    buffer_load_dwordx4 v16, s[16:19], s34 offen offset:768 lds
    s_add_u32 m0, s29, 6272
    s_nop 0
    buffer_load_dwordx4 v16, s[16:19], s34 offen offset:896 lds
    s_add_u32 s34, s34, 1024
    s_waitcnt vmcnt(24)
    s_barrier
    ds_read_b64_tr_b16 a[160:161], v12 offset:32768
    ds_read_b64_tr_b16 a[162:163], v12 offset:33792
    ds_read_b64_tr_b16 a[164:165], v13 offset:32768
    ds_read_b64_tr_b16 a[166:167], v13 offset:33792
    ds_read_b64_tr_b16 a[168:169], v12 offset:40960
    ds_read_b64_tr_b16 a[170:171], v12 offset:41984
    ds_read_b64_tr_b16 a[172:173], v13 offset:40960
    ds_read_b64_tr_b16 a[174:175], v13 offset:41984
    ds_read_b64_tr_b16 a[176:177], v12 offset:49152
    ds_read_b64_tr_b16 a[178:179], v12 offset:50176
    ds_read_b64_tr_b16 a[180:181], v13 offset:49152
    ds_read_b64_tr_b16 a[182:183], v13 offset:50176
    ds_read_b64_tr_b16 a[184:185], v12 offset:57344
    ds_read_b64_tr_b16 a[186:187], v12 offset:58368
    ds_read_b64_tr_b16 a[188:189], v13 offset:57344
    ds_read_b64_tr_b16 a[190:191], v13 offset:58368
    s_waitcnt lgkmcnt(0)
    s_barrier
    s_add_u32 m0, s29, 32768
    s_nop 0
    buffer_load_dwordx4 v16, s[16:19], s34 offen offset:0 lds
    s_add_u32 m0, s29, 33664
    s_nop 0
    buffer_load_dwordx4 v16, s[16:19], s34 offen offset:128 lds
    s_add_u32 m0, s29, 34560
    s_nop 0
    buffer_load_dwordx4 v16, s[16:19], s34 offen offset:256 lds
    s_add_u32 m0, s29, 35456
    s_nop 0
    buffer_load_dwordx4 v16, s[16:19], s34 offen offset:384 lds
    s_add_u32 m0, s29, 36352
    s_nop 0
    buffer_load_dwordx4 v16, s[16:19], s34 offen offset:512 lds
    s_add_u32 m0, s29, 37248
    s_nop 0
    buffer_load_dwordx4 v16, s[16:19], s34 offen offset:640 lds
    s_add_u32 m0, s29, 38144
    s_nop 0
    buffer_load_dwordx4 v16, s[16:19], s34 offen offset:768 lds
    s_add_u32 m0, s29, 39040
    s_nop 0
    buffer_load_dwordx4 v16, s[16:19], s34 offen offset:896 lds
    s_add_u32 s34, s34, 64512
    s_min_u32 s34, s34, 4128768
    s_waitcnt vmcnt(24)
    s_barrier
    ds_read_b64_tr_b16 a[192:193], v14 offset:0
    ds_read_b64_tr_b16 a[194:195], v14 offset:1024
    ds_read_b64_tr_b16 a[196:197], v15 offset:0
    ds_read_b64_tr_b16 a[198:199], v15 offset:1024
    ds_read_b64_tr_b16 a[200:201], v14 offset:8192
    ds_read_b64_tr_b16 a[202:203], v14 offset:9216
    ds_read_b64_tr_b16 a[204:205], v15 offset:8192
    ds_read_b64_tr_b16 a[206:207], v15 offset:9216
    ds_read_b64_tr_b16 a[208:209], v14 offset:16384
    ds_read_b64_tr_b16 a[210:211], v14 offset:17408
    ds_read_b64_tr_b16 a[212:213], v15 offset:16384
    ds_read_b64_tr_b16 a[214:215], v15 offset:17408
    ds_read_b64_tr_b16 a[216:217], v14 offset:24576
    ds_read_b64_tr_b16 a[218:219], v14 offset:25600
    ds_read_b64_tr_b16 a[220:221], v15 offset:24576
    ds_read_b64_tr_b16 a[222:223], v15 offset:25600
    s_waitcnt lgkmcnt(0)
    s_barrier
    s_add_u32 m0, s29, 65536
    s_nop 0
    buffer_load_dwordx4 v16, s[16:19], s34 offen offset:0 lds
    s_add_u32 m0, s29, 66432
    s_nop 0
    buffer_load_dwordx4 v16, s[16:19], s34 offen offset:128 lds
    s_add_u32 m0, s29, 67328
    s_nop 0
    buffer_load_dwordx4 v16, s[16:19], s34 offen offset:256 lds
    s_add_u32 m0, s29, 68224
    s_nop 0
    buffer_load_dwordx4 v16, s[16:19], s34 offen offset:384 lds
    s_add_u32 m0, s29, 69120
    s_nop 0
    buffer_load_dwordx4 v16, s[16:19], s34 offen offset:512 lds
    s_add_u32 m0, s29, 70016
    s_nop 0
    buffer_load_dwordx4 v16, s[16:19], s34 offen offset:640 lds
    s_add_u32 m0, s29, 70912
    s_nop 0
    buffer_load_dwordx4 v16, s[16:19], s34 offen offset:768 lds
    s_add_u32 m0, s29, 71808
    s_nop 0
    buffer_load_dwordx4 v16, s[16:19], s34 offen offset:896 lds
    s_add_u32 s34, s34, 1024
    s_waitcnt vmcnt(24)
    s_barrier
    ds_read_b64_tr_b16 a[224:225], v14 offset:32768
    ds_read_b64_tr_b16 a[226:227], v14 offset:33792
    ds_read_b64_tr_b16 a[228:229], v15 offset:32768
    ds_read_b64_tr_b16 a[230:231], v15 offset:33792
    ds_read_b64_tr_b16 a[232:233], v14 offset:40960
    ds_read_b64_tr_b16 a[234:235], v14 offset:41984
    ds_read_b64_tr_b16 a[236:237], v15 offset:40960
    ds_read_b64_tr_b16 a[238:239], v15 offset:41984
    ds_read_b64_tr_b16 a[240:241], v14 offset:49152
    ds_read_b64_tr_b16 a[242:243], v14 offset:50176
    ds_read_b64_tr_b16 a[244:245], v15 offset:49152
    ds_read_b64_tr_b16 a[246:247], v15 offset:50176
    ds_read_b64_tr_b16 a[248:249], v14 offset:57344
    ds_read_b64_tr_b16 a[250:251], v14 offset:58368
    ds_read_b64_tr_b16 a[252:253], v15 offset:57344
    ds_read_b64_tr_b16 a[254:255], v15 offset:58368
    s_waitcnt lgkmcnt(0)
    s_barrier
    s_cmp_eq_u32 s30, 2
    s_cbranch_scc1 .qv_364
    s_waitcnt vmcnt(16)
    s_barrier
    ds_read_b128 v[32:35], v17 offset:0
    ds_read_b128 v[36:39], v17 offset:16384
    ds_read_b128 v[40:43], v18 offset:0
    ds_read_b128 v[44:47], v18 offset:16384
    s_add_u32 m0, s29, 98304
    s_nop 0
    buffer_load_dwordx4 v16, s[16:19], s34 offen offset:0 lds
    ds_read_b128 v[48:51], v17 offset:1024
    ds_read_b128 v[52:55], v17 offset:17408
    s_branch .qe_367
.p2align 6
.ql_366:
.qe_367:
    s_waitcnt lgkmcnt(4)
    v_mfma_f32_16x16x32_bf16 v[64:67], a[0:3], v[32:35], 0
    ds_read_b128 v[56:59], v18 offset:1024
    s_add_u32 m0, s29, 99200
    v_mfma_f32_16x16x32_bf16 v[68:71], a[4:7], v[32:35], 0
    buffer_load_dwordx4 v16, s[16:19], s34 offen offset:128 lds
    v_mfma_f32_16x16x32_bf16 v[72:75], a[0:3], v[36:39], 0
    ds_read_b128 v[60:63], v18 offset:17408
    v_mfma_f32_16x16x32_bf16 v[76:79], a[4:7], v[36:39], 0
    s_waitcnt lgkmcnt(4)
    v_mfma_f32_16x16x32_bf16 v[64:67], a[8:11], v[40:43], v[64:67]
    ds_read_b128 v[32:35], v17 offset:2048
    v_mfma_f32_16x16x32_bf16 v[68:71], a[12:15], v[40:43], v[68:71]
    v_cvt_pk_bf16_f32 v96, v80, v81
    v_cvt_pk_bf16_f32 v97, v82, v83
    v_mfma_f32_16x16x32_bf16 v[72:75], a[8:11], v[44:47], v[72:75]
    ds_read_b128 v[36:39], v17 offset:18432
    v_mfma_f32_16x16x32_bf16 v[76:79], a[12:15], v[44:47], v[76:79]
    v_cvt_pk_bf16_f32 v98, v84, v85
    v_cvt_pk_bf16_f32 v99, v86, v87
    s_waitcnt lgkmcnt(4)
    v_mfma_f32_16x16x32_bf16 v[64:67], a[16:19], v[48:51], v[64:67]
    ds_read_b128 v[40:43], v18 offset:2048
    s_add_u32 m0, s29, 100096
    v_mfma_f32_16x16x32_bf16 v[68:71], a[20:23], v[48:51], v[68:71]
    buffer_load_dwordx4 v16, s[16:19], s34 offen offset:256 lds
    v_mfma_f32_16x16x32_bf16 v[72:75], a[16:19], v[52:55], v[72:75]
    ds_read_b128 v[44:47], v18 offset:18432
    v_mfma_f32_16x16x32_bf16 v[76:79], a[20:23], v[52:55], v[76:79]
    s_waitcnt lgkmcnt(4)
    v_mfma_f32_16x16x32_bf16 v[64:67], a[24:27], v[56:59], v[64:67]
    ds_read_b128 v[48:51], v17 offset:3072
    v_mfma_f32_16x16x32_bf16 v[68:71], a[28:31], v[56:59], v[68:71]
    buffer_store_dwordx4 v[96:99], v21, s[8:11], s32 offen sc1
    v_mfma_f32_16x16x32_bf16 v[72:75], a[24:27], v[60:63], v[72:75]
    ds_read_b128 v[52:55], v17 offset:19456
    v_mfma_f32_16x16x32_bf16 v[76:79], a[28:31], v[60:63], v[76:79]
    s_waitcnt lgkmcnt(4)
    v_mfma_f32_16x16x32_bf16 v[64:67], a[32:35], v[32:35], v[64:67]
    ds_read_b128 v[56:59], v18 offset:3072
    s_add_u32 m0, s29, 100992
    v_mfma_f32_16x16x32_bf16 v[68:71], a[36:39], v[32:35], v[68:71]
    buffer_load_dwordx4 v16, s[16:19], s34 offen offset:384 lds
    v_mfma_f32_16x16x32_bf16 v[72:75], a[32:35], v[36:39], v[72:75]
    ds_read_b128 v[60:63], v18 offset:19456
    v_mfma_f32_16x16x32_bf16 v[76:79], a[36:39], v[36:39], v[76:79]
    s_waitcnt lgkmcnt(4)
    v_mfma_f32_16x16x32_bf16 v[64:67], a[40:43], v[40:43], v[64:67]
    ds_read_b128 v[32:35], v17 offset:4096
    v_mfma_f32_16x16x32_bf16 v[68:71], a[44:47], v[40:43], v[68:71]
    v_cvt_pk_bf16_f32 v100, v88, v89
    v_cvt_pk_bf16_f32 v101, v90, v91
    v_mfma_f32_16x16x32_bf16 v[72:75], a[40:43], v[44:47], v[72:75]
    ds_read_b128 v[36:39], v17 offset:20480
    v_mfma_f32_16x16x32_bf16 v[76:79], a[44:47], v[44:47], v[76:79]
    v_cvt_pk_bf16_f32 v102, v92, v93
    v_cvt_pk_bf16_f32 v103, v94, v95
    s_waitcnt lgkmcnt(4)
    v_mfma_f32_16x16x32_bf16 v[64:67], a[48:51], v[48:51], v[64:67]
    ds_read_b128 v[40:43], v18 offset:4096
    s_add_u32 m0, s29, 101888
    v_mfma_f32_16x16x32_bf16 v[68:71], a[52:55], v[48:51], v[68:71]
    buffer_load_dwordx4 v16, s[16:19], s34 offen offset:512 lds
    v_mfma_f32_16x16x32_bf16 v[72:75], a[48:51], v[52:55], v[72:75]
    ds_read_b128 v[44:47], v18 offset:20480
    v_mfma_f32_16x16x32_bf16 v[76:79], a[52:55], v[52:55], v[76:79]
    s_waitcnt lgkmcnt(4)
    v_mfma_f32_16x16x32_bf16 v[64:67], a[56:59], v[56:59], v[64:67]
    ds_read_b128 v[48:51], v17 offset:5120
    v_mfma_f32_16x16x32_bf16 v[68:71], a[60:63], v[56:59], v[68:71]
    buffer_store_dwordx4 v[100:103], v21, s[8:11], s38 offen sc1
    v_mfma_f32_16x16x32_bf16 v[72:75], a[56:59], v[60:63], v[72:75]
    ds_read_b128 v[52:55], v17 offset:21504
    v_mfma_f32_16x16x32_bf16 v[76:79], a[60:63], v[60:63], v[76:79]
    s_waitcnt lgkmcnt(4)
    v_mfma_f32_16x16x32_bf16 v[64:67], a[64:67], v[32:35], v[64:67]
    ds_read_b128 v[56:59], v18 offset:5120
    s_add_u32 m0, s29, 102784
    v_mfma_f32_16x16x32_bf16 v[68:71], a[68:71], v[32:35], v[68:71]
    buffer_load_dwordx4 v16, s[16:19], s34 offen offset:640 lds
    v_mfma_f32_16x16x32_bf16 v[72:75], a[64:67], v[36:39], v[72:75]
    ds_read_b128 v[60:63], v18 offset:21504
    v_mfma_f32_16x16x32_bf16 v[76:79], a[68:71], v[36:39], v[76:79]
    s_waitcnt lgkmcnt(4)
    v_mfma_f32_16x16x32_bf16 v[64:67], a[72:75], v[40:43], v[64:67]
    ds_read_b128 v[32:35], v17 offset:6144
    v_mfma_f32_16x16x32_bf16 v[68:71], a[76:79], v[40:43], v[68:71]
    s_mov_b32 s32, s39
    s_add_u32 s38, s39, 4096
    s_add_u32 s39, s39, 262144
    v_mfma_f32_16x16x32_bf16 v[72:75], a[72:75], v[44:47], v[72:75]
    ds_read_b128 v[36:39], v17 offset:22528
    v_mfma_f32_16x16x32_bf16 v[76:79], a[76:79], v[44:47], v[76:79]
    v_add_u32 v23, 1, v23
    s_waitcnt lgkmcnt(4)
    v_mfma_f32_16x16x32_bf16 v[64:67], a[80:83], v[48:51], v[64:67]
    ds_read_b128 v[40:43], v18 offset:6144
    s_add_u32 m0, s29, 103680
    v_mfma_f32_16x16x32_bf16 v[68:71], a[84:87], v[48:51], v[68:71]
    buffer_load_dwordx4 v16, s[16:19], s34 offen offset:768 lds
    v_mfma_f32_16x16x32_bf16 v[72:75], a[80:83], v[52:55], v[72:75]
    ds_read_b128 v[44:47], v18 offset:22528
    v_mfma_f32_16x16x32_bf16 v[76:79], a[84:87], v[52:55], v[76:79]
    s_waitcnt lgkmcnt(4)
    v_mfma_f32_16x16x32_bf16 v[64:67], a[88:91], v[56:59], v[64:67]
    ds_read_b128 v[48:51], v17 offset:7168
    v_mfma_f32_16x16x32_bf16 v[68:71], a[92:95], v[56:59], v[68:71]
    v_mfma_f32_16x16x32_bf16 v[72:75], a[88:91], v[60:63], v[72:75]
    ds_read_b128 v[52:55], v17 offset:23552
    v_mfma_f32_16x16x32_bf16 v[76:79], a[92:95], v[60:63], v[76:79]
    s_mov_b64 exec, s[44:45]
    buffer_store_dwordx4 v[24:27], v28, s[8:11], s46 offen sc1
    s_mov_b64 exec, -1
    s_waitcnt lgkmcnt(4)
    v_mfma_f32_16x16x32_bf16 v[64:67], a[96:99], v[32:35], v[64:67]
    ds_read_b128 v[56:59], v18 offset:7168
    s_add_u32 m0, s29, 104576
    v_mfma_f32_16x16x32_bf16 v[68:71], a[100:103], v[32:35], v[68:71]
    buffer_load_dwordx4 v16, s[16:19], s34 offen offset:896 lds
    v_mfma_f32_16x16x32_bf16 v[72:75], a[96:99], v[36:39], v[72:75]
    ds_read_b128 v[60:63], v18 offset:23552
    v_mfma_f32_16x16x32_bf16 v[76:79], a[100:103], v[36:39], v[76:79]
    s_waitcnt lgkmcnt(4)
    v_mfma_f32_16x16x32_bf16 v[64:67], a[104:107], v[40:43], v[64:67]
    s_add_u32 s34, s34, 64512
    s_min_u32 s34, s34, 4128768
    v_mfma_f32_16x16x32_bf16 v[68:71], a[108:111], v[40:43], v[68:71]
    v_mfma_f32_16x16x32_bf16 v[72:75], a[104:107], v[44:47], v[72:75]
    v_mfma_f32_16x16x32_bf16 v[76:79], a[108:111], v[44:47], v[76:79]
    s_waitcnt lgkmcnt(0)
    s_waitcnt vmcnt(18)
    s_barrier
    ds_read_b128 v[32:35], v17 offset:32768
    ds_read_b128 v[36:39], v17 offset:49152
    v_mfma_f32_16x16x32_bf16 v[64:67], a[112:115], v[48:51], v[64:67]
    ds_read_b128 v[40:43], v18 offset:32768
    s_add_u32 m0, s29, 0
    v_mfma_f32_16x16x32_bf16 v[68:71], a[116:119], v[48:51], v[68:71]
    buffer_load_dwordx4 v16, s[16:19], s34 offen offset:0 lds
    v_mfma_f32_16x16x32_bf16 v[72:75], a[112:115], v[52:55], v[72:75]
    ds_read_b128 v[44:47], v18 offset:49152
    v_mfma_f32_16x16x32_bf16 v[76:79], a[116:119], v[52:55], v[76:79]
    v_mfma_f32_16x16x32_bf16 v[64:67], a[120:123], v[56:59], v[64:67]
    ds_read_b128 v[48:51], v17 offset:33792
    v_mfma_f32_16x16x32_bf16 v[68:71], a[124:127], v[56:59], v[68:71]
    v_mfma_f32_16x16x32_bf16 v[72:75], a[120:123], v[60:63], v[72:75]
    ds_read_b128 v[52:55], v17 offset:50176
    v_mfma_f32_16x16x32_bf16 v[76:79], a[124:127], v[60:63], v[76:79]
    s_waitcnt lgkmcnt(4)
    v_mfma_f32_16x16x32_bf16 v[64:67], a[128:131], v[32:35], v[64:67]
    ds_read_b128 v[56:59], v18 offset:33792
    s_add_u32 m0, s29, 896
    v_mfma_f32_16x16x32_bf16 v[68:71], a[132:135], v[32:35], v[68:71]
    buffer_load_dwordx4 v16, s[16:19], s34 offen offset:128 lds
    v_mfma_f32_16x16x32_bf16 v[72:75], a[128:131], v[36:39], v[72:75]
    ds_read_b128 v[60:63], v18 offset:50176
    v_mfma_f32_16x16x32_bf16 v[76:79], a[132:135], v[36:39], v[76:79]
    s_waitcnt lgkmcnt(4)
    v_mfma_f32_16x16x32_bf16 v[64:67], a[136:139], v[40:43], v[64:67]
    ds_read_b128 v[32:35], v17 offset:34816
    v_mfma_f32_16x16x32_bf16 v[68:71], a[140:143], v[40:43], v[68:71]
    v_mfma_f32_16x16x32_bf16 v[72:75], a[136:139], v[44:47], v[72:75]
    ds_read_b128 v[36:39], v17 offset:51200
    v_mfma_f32_16x16x32_bf16 v[76:79], a[140:143], v[44:47], v[76:79]
    s_waitcnt lgkmcnt(4)
    v_mfma_f32_16x16x32_bf16 v[64:67], a[144:147], v[48:51], v[64:67]
    ds_read_b128 v[40:43], v18 offset:34816
    s_add_u32 m0, s29, 1792
    v_mfma_f32_16x16x32_bf16 v[68:71], a[148:151], v[48:51], v[68:71]
    buffer_load_dwordx4 v16, s[16:19], s34 offen offset:256 lds
    v_mfma_f32_16x16x32_bf16 v[72:75], a[144:147], v[52:55], v[72:75]
    ds_read_b128 v[44:47], v18 offset:51200
    v_mfma_f32_16x16x32_bf16 v[76:79], a[148:151], v[52:55], v[76:79]
    s_waitcnt lgkmcnt(4)
    v_mfma_f32_16x16x32_bf16 v[64:67], a[152:155], v[56:59], v[64:67]
    ds_read_b128 v[48:51], v17 offset:35840
    v_mfma_f32_16x16x32_bf16 v[68:71], a[156:159], v[56:59], v[68:71]
    v_mfma_f32_16x16x32_bf16 v[72:75], a[152:155], v[60:63], v[72:75]
    ds_read_b128 v[52:55], v17 offset:52224
    v_mfma_f32_16x16x32_bf16 v[76:79], a[156:159], v[60:63], v[76:79]
    s_waitcnt lgkmcnt(4)
    v_mfma_f32_16x16x32_bf16 v[64:67], a[160:163], v[32:35], v[64:67]
    ds_read_b128 v[56:59], v18 offset:35840
    s_add_u32 m0, s29, 2688
    v_mfma_f32_16x16x32_bf16 v[68:71], a[164:167], v[32:35], v[68:71]
    buffer_load_dwordx4 v16, s[16:19], s34 offen offset:384 lds
    v_mfma_f32_16x16x32_bf16 v[72:75], a[160:163], v[36:39], v[72:75]
    ds_read_b128 v[60:63], v18 offset:52224
    v_mfma_f32_16x16x32_bf16 v[76:79], a[164:167], v[36:39], v[76:79]
    s_waitcnt lgkmcnt(4)
    v_mfma_f32_16x16x32_bf16 v[64:67], a[168:171], v[40:43], v[64:67]
    ds_read_b128 v[32:35], v17 offset:36864
    v_mfma_f32_16x16x32_bf16 v[68:71], a[172:175], v[40:43], v[68:71]
    v_mfma_f32_16x16x32_bf16 v[72:75], a[168:171], v[44:47], v[72:75]
    ds_read_b128 v[36:39], v17 offset:53248
    v_mfma_f32_16x16x32_bf16 v[76:79], a[172:175], v[44:47], v[76:79]
    s_waitcnt lgkmcnt(4)
    v_mfma_f32_16x16x32_bf16 v[64:67], a[176:179], v[48:51], v[64:67]
    ds_read_b128 v[40:43], v18 offset:36864
    s_add_u32 m0, s29, 3584
    v_mfma_f32_16x16x32_bf16 v[68:71], a[180:183], v[48:51], v[68:71]
    buffer_load_dwordx4 v16, s[16:19], s34 offen offset:512 lds
    v_mfma_f32_16x16x32_bf16 v[72:75], a[176:179], v[52:55], v[72:75]
    ds_read_b128 v[44:47], v18 offset:53248
    v_mfma_f32_16x16x32_bf16 v[76:79], a[180:183], v[52:55], v[76:79]
    s_waitcnt lgkmcnt(4)
    v_mfma_f32_16x16x32_bf16 v[64:67], a[184:187], v[56:59], v[64:67]
    ds_read_b128 v[48:51], v17 offset:37888
    v_mfma_f32_16x16x32_bf16 v[68:71], a[188:191], v[56:59], v[68:71]
    v_mfma_f32_16x16x32_bf16 v[72:75], a[184:187], v[60:63], v[72:75]
    ds_read_b128 v[52:55], v17 offset:54272
    v_mfma_f32_16x16x32_bf16 v[76:79], a[188:191], v[60:63], v[76:79]
    s_waitcnt lgkmcnt(4)
    v_mfma_f32_16x16x32_bf16 v[64:67], a[192:195], v[32:35], v[64:67]
    ds_read_b128 v[56:59], v18 offset:37888
    s_add_u32 m0, s29, 4480
    v_mfma_f32_16x16x32_bf16 v[68:71], a[196:199], v[32:35], v[68:71]
    buffer_load_dwordx4 v16, s[16:19], s34 offen offset:640 lds
    v_mfma_f32_16x16x32_bf16 v[72:75], a[192:195], v[36:39], v[72:75]
    ds_read_b128 v[60:63], v18 offset:54272
    v_mfma_f32_16x16x32_bf16 v[76:79], a[196:199], v[36:39], v[76:79]
    s_waitcnt lgkmcnt(4)
    v_mfma_f32_16x16x32_bf16 v[64:67], a[200:203], v[40:43], v[64:67]
    ds_read_b128 v[32:35], v17 offset:38912
    v_mfma_f32_16x16x32_bf16 v[68:71], a[204:207], v[40:43], v[68:71]
    v_mfma_f32_16x16x32_bf16 v[72:75], a[200:203], v[44:47], v[72:75]
    ds_read_b128 v[36:39], v17 offset:55296
    v_mfma_f32_16x16x32_bf16 v[76:79], a[204:207], v[44:47], v[76:79]
    s_waitcnt lgkmcnt(4)
    v_mfma_f32_16x16x32_bf16 v[64:67], a[208:211], v[48:51], v[64:67]
    ds_read_b128 v[40:43], v18 offset:38912
    s_add_u32 m0, s29, 5376
    v_mfma_f32_16x16x32_bf16 v[68:71], a[212:215], v[48:51], v[68:71]
    buffer_load_dwordx4 v16, s[16:19], s34 offen offset:768 lds
    v_mfma_f32_16x16x32_bf16 v[72:75], a[208:211], v[52:55], v[72:75]
    ds_read_b128 v[44:47], v18 offset:55296
    v_mfma_f32_16x16x32_bf16 v[76:79], a[212:215], v[52:55], v[76:79]
    s_waitcnt lgkmcnt(4)
    v_mfma_f32_16x16x32_bf16 v[64:67], a[216:219], v[56:59], v[64:67]
    ds_read_b128 v[48:51], v17 offset:39936
    v_mfma_f32_16x16x32_bf16 v[68:71], a[220:223], v[56:59], v[68:71]
    v_mfma_f32_16x16x32_bf16 v[72:75], a[216:219], v[60:63], v[72:75]
    ds_read_b128 v[52:55], v17 offset:56320
    v_mfma_f32_16x16x32_bf16 v[76:79], a[220:223], v[60:63], v[76:79]
    s_mov_b64 exec, s[44:45]
    buffer_store_dwordx4 v[24:27], v29, s[8:11], s46 offen sc1
    s_mov_b64 exec, -1
    s_waitcnt lgkmcnt(4)
    v_mfma_f32_16x16x32_bf16 v[64:67], a[224:227], v[32:35], v[64:67]
    ds_read_b128 v[56:59], v18 offset:39936
    s_add_u32 m0, s29, 6272
    v_mfma_f32_16x16x32_bf16 v[68:71], a[228:231], v[32:35], v[68:71]
    buffer_load_dwordx4 v16, s[16:19], s34 offen offset:896 lds
    v_mfma_f32_16x16x32_bf16 v[72:75], a[224:227], v[36:39], v[72:75]
    ds_read_b128 v[60:63], v18 offset:56320
    v_mfma_f32_16x16x32_bf16 v[76:79], a[228:231], v[36:39], v[76:79]
    s_waitcnt lgkmcnt(4)
    v_mfma_f32_16x16x32_bf16 v[64:67], a[232:235], v[40:43], v[64:67]
    s_add_u32 s34, s34, 1024
    v_mfma_f32_16x16x32_bf16 v[68:71], a[236:239], v[40:43], v[68:71]
    v_mfma_f32_16x16x32_bf16 v[72:75], a[232:235], v[44:47], v[72:75]
    v_mfma_f32_16x16x32_bf16 v[76:79], a[236:239], v[44:47], v[76:79]
    s_waitcnt lgkmcnt(0)
    s_waitcnt vmcnt(11)
    s_barrier
    ds_read_b128 v[32:35], v19 offset:0
    ds_read_b128 v[36:39], v19 offset:16384
    v_mfma_f32_16x16x32_bf16 v[64:67], a[240:243], v[48:51], v[64:67]
    ds_read_b128 v[40:43], v20 offset:0
    s_add_u32 m0, s29, 32768
    v_mfma_f32_16x16x32_bf16 v[68:71], a[244:247], v[48:51], v[68:71]
    buffer_load_dwordx4 v16, s[16:19], s34 offen offset:0 lds
    v_mfma_f32_16x16x32_bf16 v[72:75], a[240:243], v[52:55], v[72:75]
    ds_read_b128 v[44:47], v20 offset:16384
    v_mfma_f32_16x16x32_bf16 v[76:79], a[244:247], v[52:55], v[76:79]
    v_mfma_f32_16x16x32_bf16 v[64:67], a[248:251], v[56:59], v[64:67]
    ds_read_b128 v[48:51], v19 offset:1024
    v_mfma_f32_16x16x32_bf16 v[68:71], a[252:255], v[56:59], v[68:71]
    v_mfma_f32_16x16x32_bf16 v[72:75], a[248:251], v[60:63], v[72:75]
    ds_read_b128 v[52:55], v19 offset:17408
    v_mfma_f32_16x16x32_bf16 v[76:79], a[252:255], v[60:63], v[76:79]
    s_mov_b64 exec, s[36:37]
    buffer_store_dword v23, v22, s[8:11], s33 offen sc1
    s_mov_b64 exec, -1

    s_waitcnt lgkmcnt(4)
    v_mfma_f32_16x16x32_bf16 v[80:83], a[0:3], v[32:35], 0
    ds_read_b128 v[56:59], v20 offset:1024
    s_add_u32 m0, s29, 33664
    v_mfma_f32_16x16x32_bf16 v[84:87], a[4:7], v[32:35], 0
    buffer_load_dwordx4 v16, s[16:19], s34 offen offset:128 lds
    v_mfma_f32_16x16x32_bf16 v[88:91], a[0:3], v[36:39], 0
    ds_read_b128 v[60:63], v20 offset:17408
    v_mfma_f32_16x16x32_bf16 v[92:95], a[4:7], v[36:39], 0
    s_waitcnt lgkmcnt(4)
    v_mfma_f32_16x16x32_bf16 v[80:83], a[8:11], v[40:43], v[80:83]
    ds_read_b128 v[32:35], v19 offset:2048
    v_mfma_f32_16x16x32_bf16 v[84:87], a[12:15], v[40:43], v[84:87]
    v_cvt_pk_bf16_f32 v96, v64, v65
    v_cvt_pk_bf16_f32 v97, v66, v67
    v_mfma_f32_16x16x32_bf16 v[88:91], a[8:11], v[44:47], v[88:91]
    ds_read_b128 v[36:39], v19 offset:18432
    v_mfma_f32_16x16x32_bf16 v[92:95], a[12:15], v[44:47], v[92:95]
    v_cvt_pk_bf16_f32 v98, v68, v69
    v_cvt_pk_bf16_f32 v99, v70, v71
    s_waitcnt lgkmcnt(4)
    v_mfma_f32_16x16x32_bf16 v[80:83], a[16:19], v[48:51], v[80:83]
    ds_read_b128 v[40:43], v20 offset:2048
    s_add_u32 m0, s29, 34560
    v_mfma_f32_16x16x32_bf16 v[84:87], a[20:23], v[48:51], v[84:87]
    buffer_load_dwordx4 v16, s[16:19], s34 offen offset:256 lds
    v_mfma_f32_16x16x32_bf16 v[88:91], a[16:19], v[52:55], v[88:91]
    ds_read_b128 v[44:47], v20 offset:18432
    v_mfma_f32_16x16x32_bf16 v[92:95], a[20:23], v[52:55], v[92:95]
    s_waitcnt lgkmcnt(4)
    v_mfma_f32_16x16x32_bf16 v[80:83], a[24:27], v[56:59], v[80:83]
    ds_read_b128 v[48:51], v19 offset:3072
    v_mfma_f32_16x16x32_bf16 v[84:87], a[28:31], v[56:59], v[84:87]
    buffer_store_dwordx4 v[96:99], v21, s[8:11], s32 offen sc1
    v_mfma_f32_16x16x32_bf16 v[88:91], a[24:27], v[60:63], v[88:91]
    ds_read_b128 v[52:55], v19 offset:19456
    v_mfma_f32_16x16x32_bf16 v[92:95], a[28:31], v[60:63], v[92:95]
    s_waitcnt lgkmcnt(4)
    v_mfma_f32_16x16x32_bf16 v[80:83], a[32:35], v[32:35], v[80:83]
    ds_read_b128 v[56:59], v20 offset:3072
    s_add_u32 m0, s29, 35456
    v_mfma_f32_16x16x32_bf16 v[84:87], a[36:39], v[32:35], v[84:87]
    buffer_load_dwordx4 v16, s[16:19], s34 offen offset:384 lds
    v_mfma_f32_16x16x32_bf16 v[88:91], a[32:35], v[36:39], v[88:91]
    ds_read_b128 v[60:63], v20 offset:19456
    v_mfma_f32_16x16x32_bf16 v[92:95], a[36:39], v[36:39], v[92:95]
    s_waitcnt lgkmcnt(4)
    v_mfma_f32_16x16x32_bf16 v[80:83], a[40:43], v[40:43], v[80:83]
    ds_read_b128 v[32:35], v19 offset:4096
    v_mfma_f32_16x16x32_bf16 v[84:87], a[44:47], v[40:43], v[84:87]
    v_cvt_pk_bf16_f32 v100, v72, v73
    v_cvt_pk_bf16_f32 v101, v74, v75
    v_mfma_f32_16x16x32_bf16 v[88:91], a[40:43], v[44:47], v[88:91]
    ds_read_b128 v[36:39], v19 offset:20480
    v_mfma_f32_16x16x32_bf16 v[92:95], a[44:47], v[44:47], v[92:95]
    v_cvt_pk_bf16_f32 v102, v76, v77
    v_cvt_pk_bf16_f32 v103, v78, v79
    s_waitcnt lgkmcnt(4)
    v_mfma_f32_16x16x32_bf16 v[80:83], a[48:51], v[48:51], v[80:83]
    ds_read_b128 v[40:43], v20 offset:4096
    s_add_u32 m0, s29, 36352
    v_mfma_f32_16x16x32_bf16 v[84:87], a[52:55], v[48:51], v[84:87]
    buffer_load_dwordx4 v16, s[16:19], s34 offen offset:512 lds
    v_mfma_f32_16x16x32_bf16 v[88:91], a[48:51], v[52:55], v[88:91]
    ds_read_b128 v[44:47], v20 offset:20480
    v_mfma_f32_16x16x32_bf16 v[92:95], a[52:55], v[52:55], v[92:95]
    s_waitcnt lgkmcnt(4)
    v_mfma_f32_16x16x32_bf16 v[80:83], a[56:59], v[56:59], v[80:83]
    ds_read_b128 v[48:51], v19 offset:5120
    v_mfma_f32_16x16x32_bf16 v[84:87], a[60:63], v[56:59], v[84:87]
    buffer_store_dwordx4 v[100:103], v21, s[8:11], s38 offen sc1
    v_mfma_f32_16x16x32_bf16 v[88:91], a[56:59], v[60:63], v[88:91]
    ds_read_b128 v[52:55], v19 offset:21504
    v_mfma_f32_16x16x32_bf16 v[92:95], a[60:63], v[60:63], v[92:95]
    s_waitcnt lgkmcnt(4)
    v_mfma_f32_16x16x32_bf16 v[80:83], a[64:67], v[32:35], v[80:83]
    ds_read_b128 v[56:59], v20 offset:5120
    s_add_u32 m0, s29, 37248
    v_mfma_f32_16x16x32_bf16 v[84:87], a[68:71], v[32:35], v[84:87]
    buffer_load_dwordx4 v16, s[16:19], s34 offen offset:640 lds
    v_mfma_f32_16x16x32_bf16 v[88:91], a[64:67], v[36:39], v[88:91]
    ds_read_b128 v[60:63], v20 offset:21504
    v_mfma_f32_16x16x32_bf16 v[92:95], a[68:71], v[36:39], v[92:95]
    s_waitcnt lgkmcnt(4)
    v_mfma_f32_16x16x32_bf16 v[80:83], a[72:75], v[40:43], v[80:83]
    ds_read_b128 v[32:35], v19 offset:6144
    v_mfma_f32_16x16x32_bf16 v[84:87], a[76:79], v[40:43], v[84:87]
    s_mov_b32 s32, s39
    s_add_u32 s38, s39, 4096
    s_add_u32 s39, s39, 262144
    v_mfma_f32_16x16x32_bf16 v[88:91], a[72:75], v[44:47], v[88:91]
    ds_read_b128 v[36:39], v19 offset:22528
    v_mfma_f32_16x16x32_bf16 v[92:95], a[76:79], v[44:47], v[92:95]
    v_add_u32 v23, 1, v23
    s_waitcnt lgkmcnt(4)
    v_mfma_f32_16x16x32_bf16 v[80:83], a[80:83], v[48:51], v[80:83]
    ds_read_b128 v[40:43], v20 offset:6144
    s_add_u32 m0, s29, 38144
    v_mfma_f32_16x16x32_bf16 v[84:87], a[84:87], v[48:51], v[84:87]
    buffer_load_dwordx4 v16, s[16:19], s34 offen offset:768 lds
    v_mfma_f32_16x16x32_bf16 v[88:91], a[80:83], v[52:55], v[88:91]
    ds_read_b128 v[44:47], v20 offset:22528
    v_mfma_f32_16x16x32_bf16 v[92:95], a[84:87], v[52:55], v[92:95]
    s_waitcnt lgkmcnt(4)
    v_mfma_f32_16x16x32_bf16 v[80:83], a[88:91], v[56:59], v[80:83]
    ds_read_b128 v[48:51], v19 offset:7168
    v_mfma_f32_16x16x32_bf16 v[84:87], a[92:95], v[56:59], v[84:87]
    v_mfma_f32_16x16x32_bf16 v[88:91], a[88:91], v[60:63], v[88:91]
    ds_read_b128 v[52:55], v19 offset:23552
    v_mfma_f32_16x16x32_bf16 v[92:95], a[92:95], v[60:63], v[92:95]
    s_mov_b64 exec, s[44:45]
    buffer_store_dwordx4 v[24:27], v30, s[8:11], s46 offen sc1
    s_mov_b64 exec, -1
    s_waitcnt lgkmcnt(4)
    v_mfma_f32_16x16x32_bf16 v[80:83], a[96:99], v[32:35], v[80:83]
    ds_read_b128 v[56:59], v20 offset:7168
    s_add_u32 m0, s29, 39040
    v_mfma_f32_16x16x32_bf16 v[84:87], a[100:103], v[32:35], v[84:87]
    buffer_load_dwordx4 v16, s[16:19], s34 offen offset:896 lds
    v_mfma_f32_16x16x32_bf16 v[88:91], a[96:99], v[36:39], v[88:91]
    ds_read_b128 v[60:63], v20 offset:23552
    v_mfma_f32_16x16x32_bf16 v[92:95], a[100:103], v[36:39], v[92:95]
    s_waitcnt lgkmcnt(4)
    v_mfma_f32_16x16x32_bf16 v[80:83], a[104:107], v[40:43], v[80:83]
    s_add_u32 s34, s34, 64512
    s_min_u32 s34, s34, 4128768
    v_mfma_f32_16x16x32_bf16 v[84:87], a[108:111], v[40:43], v[84:87]
    v_mfma_f32_16x16x32_bf16 v[88:91], a[104:107], v[44:47], v[88:91]
    v_mfma_f32_16x16x32_bf16 v[92:95], a[108:111], v[44:47], v[92:95]
    s_waitcnt lgkmcnt(0)
    s_waitcnt vmcnt(18)
    s_barrier
    ds_read_b128 v[32:35], v19 offset:32768
    ds_read_b128 v[36:39], v19 offset:49152
    v_mfma_f32_16x16x32_bf16 v[80:83], a[112:115], v[48:51], v[80:83]
    ds_read_b128 v[40:43], v20 offset:32768
    s_add_u32 m0, s29, 65536
    v_mfma_f32_16x16x32_bf16 v[84:87], a[116:119], v[48:51], v[84:87]
    buffer_load_dwordx4 v16, s[16:19], s34 offen offset:0 lds
    v_mfma_f32_16x16x32_bf16 v[88:91], a[112:115], v[52:55], v[88:91]
    ds_read_b128 v[44:47], v20 offset:49152
    v_mfma_f32_16x16x32_bf16 v[92:95], a[116:119], v[52:55], v[92:95]
    v_mfma_f32_16x16x32_bf16 v[80:83], a[120:123], v[56:59], v[80:83]
    ds_read_b128 v[48:51], v19 offset:33792
    v_mfma_f32_16x16x32_bf16 v[84:87], a[124:127], v[56:59], v[84:87]
    v_mfma_f32_16x16x32_bf16 v[88:91], a[120:123], v[60:63], v[88:91]
    ds_read_b128 v[52:55], v19 offset:50176
    v_mfma_f32_16x16x32_bf16 v[92:95], a[124:127], v[60:63], v[92:95]
    s_waitcnt lgkmcnt(4)
    v_mfma_f32_16x16x32_bf16 v[80:83], a[128:131], v[32:35], v[80:83]
    ds_read_b128 v[56:59], v20 offset:33792
    s_add_u32 m0, s29, 66432
    v_mfma_f32_16x16x32_bf16 v[84:87], a[132:135], v[32:35], v[84:87]
    buffer_load_dwordx4 v16, s[16:19], s34 offen offset:128 lds
    v_mfma_f32_16x16x32_bf16 v[88:91], a[128:131], v[36:39], v[88:91]
    ds_read_b128 v[60:63], v20 offset:50176
    v_mfma_f32_16x16x32_bf16 v[92:95], a[132:135], v[36:39], v[92:95]
    s_waitcnt lgkmcnt(4)
    v_mfma_f32_16x16x32_bf16 v[80:83], a[136:139], v[40:43], v[80:83]
    ds_read_b128 v[32:35], v19 offset:34816
    v_mfma_f32_16x16x32_bf16 v[84:87], a[140:143], v[40:43], v[84:87]
    v_mfma_f32_16x16x32_bf16 v[88:91], a[136:139], v[44:47], v[88:91]
    ds_read_b128 v[36:39], v19 offset:51200
    v_mfma_f32_16x16x32_bf16 v[92:95], a[140:143], v[44:47], v[92:95]
    s_waitcnt lgkmcnt(4)
    v_mfma_f32_16x16x32_bf16 v[80:83], a[144:147], v[48:51], v[80:83]
    ds_read_b128 v[40:43], v20 offset:34816
    s_add_u32 m0, s29, 67328
    v_mfma_f32_16x16x32_bf16 v[84:87], a[148:151], v[48:51], v[84:87]
    buffer_load_dwordx4 v16, s[16:19], s34 offen offset:256 lds
    v_mfma_f32_16x16x32_bf16 v[88:91], a[144:147], v[52:55], v[88:91]
    ds_read_b128 v[44:47], v20 offset:51200
    v_mfma_f32_16x16x32_bf16 v[92:95], a[148:151], v[52:55], v[92:95]
    s_waitcnt lgkmcnt(4)
    v_mfma_f32_16x16x32_bf16 v[80:83], a[152:155], v[56:59], v[80:83]
    ds_read_b128 v[48:51], v19 offset:35840
    v_mfma_f32_16x16x32_bf16 v[84:87], a[156:159], v[56:59], v[84:87]
    v_mfma_f32_16x16x32_bf16 v[88:91], a[152:155], v[60:63], v[88:91]
    ds_read_b128 v[52:55], v19 offset:52224
    v_mfma_f32_16x16x32_bf16 v[92:95], a[156:159], v[60:63], v[92:95]
    s_waitcnt lgkmcnt(4)
    v_mfma_f32_16x16x32_bf16 v[80:83], a[160:163], v[32:35], v[80:83]
    ds_read_b128 v[56:59], v20 offset:35840
    s_add_u32 m0, s29, 68224
    v_mfma_f32_16x16x32_bf16 v[84:87], a[164:167], v[32:35], v[84:87]
    buffer_load_dwordx4 v16, s[16:19], s34 offen offset:384 lds
    v_mfma_f32_16x16x32_bf16 v[88:91], a[160:163], v[36:39], v[88:91]
    ds_read_b128 v[60:63], v20 offset:52224
    v_mfma_f32_16x16x32_bf16 v[92:95], a[164:167], v[36:39], v[92:95]
    s_waitcnt lgkmcnt(4)
    v_mfma_f32_16x16x32_bf16 v[80:83], a[168:171], v[40:43], v[80:83]
    ds_read_b128 v[32:35], v19 offset:36864
    v_mfma_f32_16x16x32_bf16 v[84:87], a[172:175], v[40:43], v[84:87]
    v_mfma_f32_16x16x32_bf16 v[88:91], a[168:171], v[44:47], v[88:91]
    ds_read_b128 v[36:39], v19 offset:53248
    v_mfma_f32_16x16x32_bf16 v[92:95], a[172:175], v[44:47], v[92:95]
    s_waitcnt lgkmcnt(4)
    v_mfma_f32_16x16x32_bf16 v[80:83], a[176:179], v[48:51], v[80:83]
    ds_read_b128 v[40:43], v20 offset:36864
    s_add_u32 m0, s29, 69120
    v_mfma_f32_16x16x32_bf16 v[84:87], a[180:183], v[48:51], v[84:87]
    buffer_load_dwordx4 v16, s[16:19], s34 offen offset:512 lds
    v_mfma_f32_16x16x32_bf16 v[88:91], a[176:179], v[52:55], v[88:91]
    ds_read_b128 v[44:47], v20 offset:53248
    v_mfma_f32_16x16x32_bf16 v[92:95], a[180:183], v[52:55], v[92:95]
    s_waitcnt lgkmcnt(4)
    v_mfma_f32_16x16x32_bf16 v[80:83], a[184:187], v[56:59], v[80:83]
    ds_read_b128 v[48:51], v19 offset:37888
    v_mfma_f32_16x16x32_bf16 v[84:87], a[188:191], v[56:59], v[84:87]
    v_mfma_f32_16x16x32_bf16 v[88:91], a[184:187], v[60:63], v[88:91]
    ds_read_b128 v[52:55], v19 offset:54272
    v_mfma_f32_16x16x32_bf16 v[92:95], a[188:191], v[60:63], v[92:95]
    s_waitcnt lgkmcnt(4)
    v_mfma_f32_16x16x32_bf16 v[80:83], a[192:195], v[32:35], v[80:83]
    ds_read_b128 v[56:59], v20 offset:37888
    s_add_u32 m0, s29, 70016
    v_mfma_f32_16x16x32_bf16 v[84:87], a[196:199], v[32:35], v[84:87]
    buffer_load_dwordx4 v16, s[16:19], s34 offen offset:640 lds
    v_mfma_f32_16x16x32_bf16 v[88:91], a[192:195], v[36:39], v[88:91]
    ds_read_b128 v[60:63], v20 offset:54272
    v_mfma_f32_16x16x32_bf16 v[92:95], a[196:199], v[36:39], v[92:95]
    s_waitcnt lgkmcnt(4)
    v_mfma_f32_16x16x32_bf16 v[80:83], a[200:203], v[40:43], v[80:83]
    ds_read_b128 v[32:35], v19 offset:38912
    v_mfma_f32_16x16x32_bf16 v[84:87], a[204:207], v[40:43], v[84:87]
    v_mfma_f32_16x16x32_bf16 v[88:91], a[200:203], v[44:47], v[88:91]
    ds_read_b128 v[36:39], v19 offset:55296
    v_mfma_f32_16x16x32_bf16 v[92:95], a[204:207], v[44:47], v[92:95]
    s_waitcnt lgkmcnt(4)
    v_mfma_f32_16x16x32_bf16 v[80:83], a[208:211], v[48:51], v[80:83]
    ds_read_b128 v[40:43], v20 offset:38912
    s_add_u32 m0, s29, 70912
    v_mfma_f32_16x16x32_bf16 v[84:87], a[212:215], v[48:51], v[84:87]
    buffer_load_dwordx4 v16, s[16:19], s34 offen offset:768 lds
    v_mfma_f32_16x16x32_bf16 v[88:91], a[208:211], v[52:55], v[88:91]
    ds_read_b128 v[44:47], v20 offset:55296
    v_mfma_f32_16x16x32_bf16 v[92:95], a[212:215], v[52:55], v[92:95]
    s_waitcnt lgkmcnt(4)
    v_mfma_f32_16x16x32_bf16 v[80:83], a[216:219], v[56:59], v[80:83]
    ds_read_b128 v[48:51], v19 offset:39936
    v_mfma_f32_16x16x32_bf16 v[84:87], a[220:223], v[56:59], v[84:87]
    s_cmp_lt_u32 s35, 21
    s_cselect_b64 s[44:45], -1, 0
    v_mfma_f32_16x16x32_bf16 v[88:91], a[216:219], v[60:63], v[88:91]
    ds_read_b128 v[52:55], v19 offset:56320
    v_mfma_f32_16x16x32_bf16 v[92:95], a[220:223], v[60:63], v[92:95]
    s_cselect_b32 s4, 0x10000, 0
    s_add_u32 s46, s46, s4
    s_waitcnt lgkmcnt(4)
    v_mfma_f32_16x16x32_bf16 v[80:83], a[224:227], v[32:35], v[80:83]
    ds_read_b128 v[56:59], v20 offset:39936
    s_add_u32 m0, s29, 71808
    v_mfma_f32_16x16x32_bf16 v[84:87], a[228:231], v[32:35], v[84:87]
    buffer_load_dwordx4 v16, s[16:19], s34 offen offset:896 lds
    v_mfma_f32_16x16x32_bf16 v[88:91], a[224:227], v[36:39], v[88:91]
    ds_read_b128 v[60:63], v20 offset:56320
    v_mfma_f32_16x16x32_bf16 v[92:95], a[228:231], v[36:39], v[92:95]
    s_waitcnt lgkmcnt(4)
    v_mfma_f32_16x16x32_bf16 v[80:83], a[232:235], v[40:43], v[80:83]
    s_add_u32 s34, s34, 1024
    v_mfma_f32_16x16x32_bf16 v[84:87], a[236:239], v[40:43], v[84:87]
    v_mfma_f32_16x16x32_bf16 v[88:91], a[232:235], v[44:47], v[88:91]
    v_mfma_f32_16x16x32_bf16 v[92:95], a[236:239], v[44:47], v[92:95]
    s_waitcnt lgkmcnt(0)
    s_waitcnt vmcnt(11)
    s_barrier
    ds_read_b128 v[32:35], v17 offset:0
    ds_read_b128 v[36:39], v17 offset:16384
    v_mfma_f32_16x16x32_bf16 v[80:83], a[240:243], v[48:51], v[80:83]
    ds_read_b128 v[40:43], v18 offset:0
    s_add_u32 m0, s29, 98304
    v_mfma_f32_16x16x32_bf16 v[84:87], a[244:247], v[48:51], v[84:87]
    buffer_load_dwordx4 v16, s[16:19], s34 offen offset:0 lds
    v_mfma_f32_16x16x32_bf16 v[88:91], a[240:243], v[52:55], v[88:91]
    ds_read_b128 v[44:47], v18 offset:16384
    v_mfma_f32_16x16x32_bf16 v[92:95], a[244:247], v[52:55], v[92:95]
    v_mfma_f32_16x16x32_bf16 v[80:83], a[248:251], v[56:59], v[80:83]
    ds_read_b128 v[48:51], v17 offset:1024
    v_mfma_f32_16x16x32_bf16 v[84:87], a[252:255], v[56:59], v[84:87]
    v_mfma_f32_16x16x32_bf16 v[88:91], a[248:251], v[60:63], v[88:91]
    ds_read_b128 v[52:55], v17 offset:17408
    v_mfma_f32_16x16x32_bf16 v[92:95], a[252:255], v[60:63], v[92:95]
    s_mov_b64 exec, s[36:37]
    buffer_store_dword v23, v22, s[8:11], s33 offen sc1
    s_mov_b64 exec, -1

    s_add_u32 s35, s35, 1
    s_cmp_lt_u32 s35, 32
    s_cbranch_scc1 .ql_366

    s_nop 7
    v_cvt_pk_bf16_f32 v96, v80, v81
    v_cvt_pk_bf16_f32 v97, v82, v83
    v_cvt_pk_bf16_f32 v98, v84, v85
    v_cvt_pk_bf16_f32 v99, v86, v87
    buffer_store_dwordx4 v[96:99], v21, s[8:11], s32 offen sc1
    v_cvt_pk_bf16_f32 v100, v88, v89
    v_cvt_pk_bf16_f32 v101, v90, v91
    v_cvt_pk_bf16_f32 v102, v92, v93
    v_cvt_pk_bf16_f32 v103, v94, v95
    buffer_store_dwordx4 v[100:103], v21, s[8:11], s38 offen sc1
    v_mov_b32 v23, 64
    s_waitcnt vmcnt(0) lgkmcnt(0)
    s_barrier
    s_mov_b64 exec, s[36:37]
    buffer_store_dword v23, v22, s[8:11], s33 offen sc1
    s_mov_b64 exec, -1

    s_branch .qd_365
.qv_364:
    s_waitcnt vmcnt(16)
    s_barrier
    ds_read_b128 v[32:35], v17 offset:0
    ds_read_b128 v[36:39], v17 offset:16384
    ds_read_b128 v[40:43], v18 offset:0
    ds_read_b128 v[44:47], v18 offset:16384
    s_add_u32 m0, s29, 98304
    s_nop 0
    buffer_load_dwordx4 v16, s[16:19], s34 offen offset:0 lds
    ds_read_b128 v[48:51], v17 offset:1024
    ds_read_b128 v[52:55], v17 offset:17408
    s_branch .qe_369
.p2align 6
.ql_368:
.qe_369:
    s_waitcnt lgkmcnt(4)
    v_mfma_f32_16x16x32_bf16 v[64:67], v[32:35], a[0:3], 0
    ds_read_b128 v[56:59], v18 offset:1024
    s_add_u32 m0, s29, 99200
    v_mfma_f32_16x16x32_bf16 v[68:71], v[32:35], a[4:7], 0
    buffer_load_dwordx4 v16, s[16:19], s34 offen offset:128 lds
    v_mfma_f32_16x16x32_bf16 v[72:75], v[36:39], a[0:3], 0
    ds_read_b128 v[60:63], v18 offset:17408
    v_mfma_f32_16x16x32_bf16 v[76:79], v[36:39], a[4:7], 0
    s_waitcnt lgkmcnt(4)
    v_mfma_f32_16x16x32_bf16 v[64:67], v[40:43], a[8:11], v[64:67]
    ds_read_b128 v[32:35], v17 offset:2048
    v_mfma_f32_16x16x32_bf16 v[68:71], v[40:43], a[12:15], v[68:71]
    v_cvt_pk_bf16_f32 v96, v80, v81
    v_cvt_pk_bf16_f32 v97, v82, v83
    v_mfma_f32_16x16x32_bf16 v[72:75], v[44:47], a[8:11], v[72:75]
    ds_read_b128 v[36:39], v17 offset:18432
    v_mfma_f32_16x16x32_bf16 v[76:79], v[44:47], a[12:15], v[76:79]
    v_cvt_pk_bf16_f32 v98, v88, v89
    v_cvt_pk_bf16_f32 v99, v90, v91
    s_waitcnt lgkmcnt(4)
    v_mfma_f32_16x16x32_bf16 v[64:67], v[48:51], a[16:19], v[64:67]
    ds_read_b128 v[40:43], v18 offset:2048
    s_add_u32 m0, s29, 100096
    v_mfma_f32_16x16x32_bf16 v[68:71], v[48:51], a[20:23], v[68:71]
    buffer_load_dwordx4 v16, s[16:19], s34 offen offset:256 lds
    v_mfma_f32_16x16x32_bf16 v[72:75], v[52:55], a[16:19], v[72:75]
    ds_read_b128 v[44:47], v18 offset:18432
    v_mfma_f32_16x16x32_bf16 v[76:79], v[52:55], a[20:23], v[76:79]
    s_waitcnt lgkmcnt(4)
    v_mfma_f32_16x16x32_bf16 v[64:67], v[56:59], a[24:27], v[64:67]
    ds_read_b128 v[48:51], v17 offset:3072
    v_mfma_f32_16x16x32_bf16 v[68:71], v[56:59], a[28:31], v[68:71]
    buffer_store_dwordx4 v[96:99], v21, s[8:11], s32 offen offset:0 sc1
    v_mfma_f32_16x16x32_bf16 v[72:75], v[60:63], a[24:27], v[72:75]
    ds_read_b128 v[52:55], v17 offset:19456
    v_mfma_f32_16x16x32_bf16 v[76:79], v[60:63], a[28:31], v[76:79]
    s_waitcnt lgkmcnt(4)
    v_mfma_f32_16x16x32_bf16 v[64:67], v[32:35], a[32:35], v[64:67]
    ds_read_b128 v[56:59], v18 offset:3072
    s_add_u32 m0, s29, 100992
    v_mfma_f32_16x16x32_bf16 v[68:71], v[32:35], a[36:39], v[68:71]
    buffer_load_dwordx4 v16, s[16:19], s34 offen offset:384 lds
    v_mfma_f32_16x16x32_bf16 v[72:75], v[36:39], a[32:35], v[72:75]
    ds_read_b128 v[60:63], v18 offset:19456
    v_mfma_f32_16x16x32_bf16 v[76:79], v[36:39], a[36:39], v[76:79]
    s_waitcnt lgkmcnt(4)
    v_mfma_f32_16x16x32_bf16 v[64:67], v[40:43], a[40:43], v[64:67]
    ds_read_b128 v[32:35], v17 offset:4096
    v_mfma_f32_16x16x32_bf16 v[68:71], v[40:43], a[44:47], v[68:71]
    v_cvt_pk_bf16_f32 v100, v84, v85
    v_cvt_pk_bf16_f32 v101, v86, v87
    v_mfma_f32_16x16x32_bf16 v[72:75], v[44:47], a[40:43], v[72:75]
    ds_read_b128 v[36:39], v17 offset:20480
    v_mfma_f32_16x16x32_bf16 v[76:79], v[44:47], a[44:47], v[76:79]
    v_cvt_pk_bf16_f32 v102, v92, v93
    v_cvt_pk_bf16_f32 v103, v94, v95
    s_waitcnt lgkmcnt(4)
    v_mfma_f32_16x16x32_bf16 v[64:67], v[48:51], a[48:51], v[64:67]
    ds_read_b128 v[40:43], v18 offset:4096
    s_add_u32 m0, s29, 101888
    v_mfma_f32_16x16x32_bf16 v[68:71], v[48:51], a[52:55], v[68:71]
    buffer_load_dwordx4 v16, s[16:19], s34 offen offset:512 lds
    v_mfma_f32_16x16x32_bf16 v[72:75], v[52:55], a[48:51], v[72:75]
    ds_read_b128 v[44:47], v18 offset:20480
    v_mfma_f32_16x16x32_bf16 v[76:79], v[52:55], a[52:55], v[76:79]
    s_waitcnt lgkmcnt(4)
    v_mfma_f32_16x16x32_bf16 v[64:67], v[56:59], a[56:59], v[64:67]
    ds_read_b128 v[48:51], v17 offset:5120
    v_mfma_f32_16x16x32_bf16 v[68:71], v[56:59], a[60:63], v[68:71]
    buffer_store_dwordx4 v[100:103], v21, s[8:11], s32 offen offset:1024 sc1
    v_mfma_f32_16x16x32_bf16 v[72:75], v[60:63], a[56:59], v[72:75]
    ds_read_b128 v[52:55], v17 offset:21504
    v_mfma_f32_16x16x32_bf16 v[76:79], v[60:63], a[60:63], v[76:79]
    s_waitcnt lgkmcnt(4)
    v_mfma_f32_16x16x32_bf16 v[64:67], v[32:35], a[64:67], v[64:67]
    ds_read_b128 v[56:59], v18 offset:5120
    s_add_u32 m0, s29, 102784
    v_mfma_f32_16x16x32_bf16 v[68:71], v[32:35], a[68:71], v[68:71]
    buffer_load_dwordx4 v16, s[16:19], s34 offen offset:640 lds
    v_mfma_f32_16x16x32_bf16 v[72:75], v[36:39], a[64:67], v[72:75]
    ds_read_b128 v[60:63], v18 offset:21504
    v_mfma_f32_16x16x32_bf16 v[76:79], v[36:39], a[68:71], v[76:79]
    s_waitcnt lgkmcnt(4)
    v_mfma_f32_16x16x32_bf16 v[64:67], v[40:43], a[72:75], v[64:67]
    ds_read_b128 v[32:35], v17 offset:6144
    v_mfma_f32_16x16x32_bf16 v[68:71], v[40:43], a[76:79], v[68:71]
    s_mov_b32 s32, s39
    s_add_u32 s38, s39, 4096
    s_add_u32 s39, s39, 262144
    v_mfma_f32_16x16x32_bf16 v[72:75], v[44:47], a[72:75], v[72:75]
    ds_read_b128 v[36:39], v17 offset:22528
    v_mfma_f32_16x16x32_bf16 v[76:79], v[44:47], a[76:79], v[76:79]
    v_add_u32 v23, 1, v23
    s_waitcnt lgkmcnt(4)
    v_mfma_f32_16x16x32_bf16 v[64:67], v[48:51], a[80:83], v[64:67]
    ds_read_b128 v[40:43], v18 offset:6144
    s_add_u32 m0, s29, 103680
    v_mfma_f32_16x16x32_bf16 v[68:71], v[48:51], a[84:87], v[68:71]
    buffer_load_dwordx4 v16, s[16:19], s34 offen offset:768 lds
    v_mfma_f32_16x16x32_bf16 v[72:75], v[52:55], a[80:83], v[72:75]
    ds_read_b128 v[44:47], v18 offset:22528
    v_mfma_f32_16x16x32_bf16 v[76:79], v[52:55], a[84:87], v[76:79]
    s_waitcnt lgkmcnt(4)
    v_mfma_f32_16x16x32_bf16 v[64:67], v[56:59], a[88:91], v[64:67]
    ds_read_b128 v[48:51], v17 offset:7168
    v_mfma_f32_16x16x32_bf16 v[68:71], v[56:59], a[92:95], v[68:71]
    v_mfma_f32_16x16x32_bf16 v[72:75], v[60:63], a[88:91], v[72:75]
    ds_read_b128 v[52:55], v17 offset:23552
    v_mfma_f32_16x16x32_bf16 v[76:79], v[60:63], a[92:95], v[76:79]
    s_mov_b64 exec, s[44:45]
    buffer_store_dwordx4 v[24:27], v28, s[8:11], s46 offen sc1
    s_mov_b64 exec, -1
    s_waitcnt lgkmcnt(4)
    v_mfma_f32_16x16x32_bf16 v[64:67], v[32:35], a[96:99], v[64:67]
    ds_read_b128 v[56:59], v18 offset:7168
    s_add_u32 m0, s29, 104576
    v_mfma_f32_16x16x32_bf16 v[68:71], v[32:35], a[100:103], v[68:71]
    buffer_load_dwordx4 v16, s[16:19], s34 offen offset:896 lds
    v_mfma_f32_16x16x32_bf16 v[72:75], v[36:39], a[96:99], v[72:75]
    ds_read_b128 v[60:63], v18 offset:23552
    v_mfma_f32_16x16x32_bf16 v[76:79], v[36:39], a[100:103], v[76:79]
    s_waitcnt lgkmcnt(4)
    v_mfma_f32_16x16x32_bf16 v[64:67], v[40:43], a[104:107], v[64:67]
    s_add_u32 s34, s34, 64512
    s_min_u32 s34, s34, 4128768
    v_mfma_f32_16x16x32_bf16 v[68:71], v[40:43], a[108:111], v[68:71]
    v_mfma_f32_16x16x32_bf16 v[72:75], v[44:47], a[104:107], v[72:75]
    v_mfma_f32_16x16x32_bf16 v[76:79], v[44:47], a[108:111], v[76:79]
    s_waitcnt lgkmcnt(0)
    s_waitcnt vmcnt(18)
    s_barrier
    ds_read_b128 v[32:35], v17 offset:32768
    ds_read_b128 v[36:39], v17 offset:49152
    v_mfma_f32_16x16x32_bf16 v[64:67], v[48:51], a[112:115], v[64:67]
    ds_read_b128 v[40:43], v18 offset:32768
    s_add_u32 m0, s29, 0
    v_mfma_f32_16x16x32_bf16 v[68:71], v[48:51], a[116:119], v[68:71]
    buffer_load_dwordx4 v16, s[16:19], s34 offen offset:0 lds
    v_mfma_f32_16x16x32_bf16 v[72:75], v[52:55], a[112:115], v[72:75]
    ds_read_b128 v[44:47], v18 offset:49152
    v_mfma_f32_16x16x32_bf16 v[76:79], v[52:55], a[116:119], v[76:79]
    v_mfma_f32_16x16x32_bf16 v[64:67], v[56:59], a[120:123], v[64:67]
    ds_read_b128 v[48:51], v17 offset:33792
    v_mfma_f32_16x16x32_bf16 v[68:71], v[56:59], a[124:127], v[68:71]
    v_mfma_f32_16x16x32_bf16 v[72:75], v[60:63], a[120:123], v[72:75]
    ds_read_b128 v[52:55], v17 offset:50176
    v_mfma_f32_16x16x32_bf16 v[76:79], v[60:63], a[124:127], v[76:79]
    s_waitcnt lgkmcnt(4)
    v_mfma_f32_16x16x32_bf16 v[64:67], v[32:35], a[128:131], v[64:67]
    ds_read_b128 v[56:59], v18 offset:33792
    s_add_u32 m0, s29, 896
    v_mfma_f32_16x16x32_bf16 v[68:71], v[32:35], a[132:135], v[68:71]
    buffer_load_dwordx4 v16, s[16:19], s34 offen offset:128 lds
    v_mfma_f32_16x16x32_bf16 v[72:75], v[36:39], a[128:131], v[72:75]
    ds_read_b128 v[60:63], v18 offset:50176
    v_mfma_f32_16x16x32_bf16 v[76:79], v[36:39], a[132:135], v[76:79]
    s_waitcnt lgkmcnt(4)
    v_mfma_f32_16x16x32_bf16 v[64:67], v[40:43], a[136:139], v[64:67]
    ds_read_b128 v[32:35], v17 offset:34816
    v_mfma_f32_16x16x32_bf16 v[68:71], v[40:43], a[140:143], v[68:71]
    v_mfma_f32_16x16x32_bf16 v[72:75], v[44:47], a[136:139], v[72:75]
    ds_read_b128 v[36:39], v17 offset:51200
    v_mfma_f32_16x16x32_bf16 v[76:79], v[44:47], a[140:143], v[76:79]
    s_waitcnt lgkmcnt(4)
    v_mfma_f32_16x16x32_bf16 v[64:67], v[48:51], a[144:147], v[64:67]
    ds_read_b128 v[40:43], v18 offset:34816
    s_add_u32 m0, s29, 1792
    v_mfma_f32_16x16x32_bf16 v[68:71], v[48:51], a[148:151], v[68:71]
    buffer_load_dwordx4 v16, s[16:19], s34 offen offset:256 lds
    v_mfma_f32_16x16x32_bf16 v[72:75], v[52:55], a[144:147], v[72:75]
    ds_read_b128 v[44:47], v18 offset:51200
    v_mfma_f32_16x16x32_bf16 v[76:79], v[52:55], a[148:151], v[76:79]
    s_waitcnt lgkmcnt(4)
    v_mfma_f32_16x16x32_bf16 v[64:67], v[56:59], a[152:155], v[64:67]
    ds_read_b128 v[48:51], v17 offset:35840
    v_mfma_f32_16x16x32_bf16 v[68:71], v[56:59], a[156:159], v[68:71]
    v_mfma_f32_16x16x32_bf16 v[72:75], v[60:63], a[152:155], v[72:75]
    ds_read_b128 v[52:55], v17 offset:52224
    v_mfma_f32_16x16x32_bf16 v[76:79], v[60:63], a[156:159], v[76:79]
    s_waitcnt lgkmcnt(4)
    v_mfma_f32_16x16x32_bf16 v[64:67], v[32:35], a[160:163], v[64:67]
    ds_read_b128 v[56:59], v18 offset:35840
    s_add_u32 m0, s29, 2688
    v_mfma_f32_16x16x32_bf16 v[68:71], v[32:35], a[164:167], v[68:71]
    buffer_load_dwordx4 v16, s[16:19], s34 offen offset:384 lds
    v_mfma_f32_16x16x32_bf16 v[72:75], v[36:39], a[160:163], v[72:75]
    ds_read_b128 v[60:63], v18 offset:52224
    v_mfma_f32_16x16x32_bf16 v[76:79], v[36:39], a[164:167], v[76:79]
    s_waitcnt lgkmcnt(4)
    v_mfma_f32_16x16x32_bf16 v[64:67], v[40:43], a[168:171], v[64:67]
    ds_read_b128 v[32:35], v17 offset:36864
    v_mfma_f32_16x16x32_bf16 v[68:71], v[40:43], a[172:175], v[68:71]
    v_mfma_f32_16x16x32_bf16 v[72:75], v[44:47], a[168:171], v[72:75]
    ds_read_b128 v[36:39], v17 offset:53248
    v_mfma_f32_16x16x32_bf16 v[76:79], v[44:47], a[172:175], v[76:79]
    s_waitcnt lgkmcnt(4)
    v_mfma_f32_16x16x32_bf16 v[64:67], v[48:51], a[176:179], v[64:67]
    ds_read_b128 v[40:43], v18 offset:36864
    s_add_u32 m0, s29, 3584
    v_mfma_f32_16x16x32_bf16 v[68:71], v[48:51], a[180:183], v[68:71]
    buffer_load_dwordx4 v16, s[16:19], s34 offen offset:512 lds
    v_mfma_f32_16x16x32_bf16 v[72:75], v[52:55], a[176:179], v[72:75]
    ds_read_b128 v[44:47], v18 offset:53248
    v_mfma_f32_16x16x32_bf16 v[76:79], v[52:55], a[180:183], v[76:79]
    s_waitcnt lgkmcnt(4)
    v_mfma_f32_16x16x32_bf16 v[64:67], v[56:59], a[184:187], v[64:67]
    ds_read_b128 v[48:51], v17 offset:37888
    v_mfma_f32_16x16x32_bf16 v[68:71], v[56:59], a[188:191], v[68:71]
    v_mfma_f32_16x16x32_bf16 v[72:75], v[60:63], a[184:187], v[72:75]
    ds_read_b128 v[52:55], v17 offset:54272
    v_mfma_f32_16x16x32_bf16 v[76:79], v[60:63], a[188:191], v[76:79]
    s_waitcnt lgkmcnt(4)
    v_mfma_f32_16x16x32_bf16 v[64:67], v[32:35], a[192:195], v[64:67]
    ds_read_b128 v[56:59], v18 offset:37888
    s_add_u32 m0, s29, 4480
    v_mfma_f32_16x16x32_bf16 v[68:71], v[32:35], a[196:199], v[68:71]
    buffer_load_dwordx4 v16, s[16:19], s34 offen offset:640 lds
    v_mfma_f32_16x16x32_bf16 v[72:75], v[36:39], a[192:195], v[72:75]
    ds_read_b128 v[60:63], v18 offset:54272
    v_mfma_f32_16x16x32_bf16 v[76:79], v[36:39], a[196:199], v[76:79]
    s_waitcnt lgkmcnt(4)
    v_mfma_f32_16x16x32_bf16 v[64:67], v[40:43], a[200:203], v[64:67]
    ds_read_b128 v[32:35], v17 offset:38912
    v_mfma_f32_16x16x32_bf16 v[68:71], v[40:43], a[204:207], v[68:71]
    v_mfma_f32_16x16x32_bf16 v[72:75], v[44:47], a[200:203], v[72:75]
    ds_read_b128 v[36:39], v17 offset:55296
    v_mfma_f32_16x16x32_bf16 v[76:79], v[44:47], a[204:207], v[76:79]
    s_waitcnt lgkmcnt(4)
    v_mfma_f32_16x16x32_bf16 v[64:67], v[48:51], a[208:211], v[64:67]
    ds_read_b128 v[40:43], v18 offset:38912
    s_add_u32 m0, s29, 5376
    v_mfma_f32_16x16x32_bf16 v[68:71], v[48:51], a[212:215], v[68:71]
    buffer_load_dwordx4 v16, s[16:19], s34 offen offset:768 lds
    v_mfma_f32_16x16x32_bf16 v[72:75], v[52:55], a[208:211], v[72:75]
    ds_read_b128 v[44:47], v18 offset:55296
    v_mfma_f32_16x16x32_bf16 v[76:79], v[52:55], a[212:215], v[76:79]
    s_waitcnt lgkmcnt(4)
    v_mfma_f32_16x16x32_bf16 v[64:67], v[56:59], a[216:219], v[64:67]
    ds_read_b128 v[48:51], v17 offset:39936
    v_mfma_f32_16x16x32_bf16 v[68:71], v[56:59], a[220:223], v[68:71]
    v_mfma_f32_16x16x32_bf16 v[72:75], v[60:63], a[216:219], v[72:75]
    ds_read_b128 v[52:55], v17 offset:56320
    v_mfma_f32_16x16x32_bf16 v[76:79], v[60:63], a[220:223], v[76:79]
    s_mov_b64 exec, s[44:45]
    buffer_store_dwordx4 v[24:27], v29, s[8:11], s46 offen sc1
    s_mov_b64 exec, -1
    s_waitcnt lgkmcnt(4)
    v_mfma_f32_16x16x32_bf16 v[64:67], v[32:35], a[224:227], v[64:67]
    ds_read_b128 v[56:59], v18 offset:39936
    s_add_u32 m0, s29, 6272
    v_mfma_f32_16x16x32_bf16 v[68:71], v[32:35], a[228:231], v[68:71]
    buffer_load_dwordx4 v16, s[16:19], s34 offen offset:896 lds
    v_mfma_f32_16x16x32_bf16 v[72:75], v[36:39], a[224:227], v[72:75]
    ds_read_b128 v[60:63], v18 offset:56320
    v_mfma_f32_16x16x32_bf16 v[76:79], v[36:39], a[228:231], v[76:79]
    s_waitcnt lgkmcnt(4)
    v_mfma_f32_16x16x32_bf16 v[64:67], v[40:43], a[232:235], v[64:67]
    s_add_u32 s34, s34, 1024
    v_mfma_f32_16x16x32_bf16 v[68:71], v[40:43], a[236:239], v[68:71]
    v_mfma_f32_16x16x32_bf16 v[72:75], v[44:47], a[232:235], v[72:75]
    v_mfma_f32_16x16x32_bf16 v[76:79], v[44:47], a[236:239], v[76:79]
    s_waitcnt lgkmcnt(0)
    s_waitcnt vmcnt(11)
    s_barrier
    ds_read_b128 v[32:35], v19 offset:0
    ds_read_b128 v[36:39], v19 offset:16384
    v_mfma_f32_16x16x32_bf16 v[64:67], v[48:51], a[240:243], v[64:67]
    ds_read_b128 v[40:43], v20 offset:0
    s_add_u32 m0, s29, 32768
    v_mfma_f32_16x16x32_bf16 v[68:71], v[48:51], a[244:247], v[68:71]
    buffer_load_dwordx4 v16, s[16:19], s34 offen offset:0 lds
    v_mfma_f32_16x16x32_bf16 v[72:75], v[52:55], a[240:243], v[72:75]
    ds_read_b128 v[44:47], v20 offset:16384
    v_mfma_f32_16x16x32_bf16 v[76:79], v[52:55], a[244:247], v[76:79]
    v_mfma_f32_16x16x32_bf16 v[64:67], v[56:59], a[248:251], v[64:67]
    ds_read_b128 v[48:51], v19 offset:1024
    v_mfma_f32_16x16x32_bf16 v[68:71], v[56:59], a[252:255], v[68:71]
    v_mfma_f32_16x16x32_bf16 v[72:75], v[60:63], a[248:251], v[72:75]
    ds_read_b128 v[52:55], v19 offset:17408
    v_mfma_f32_16x16x32_bf16 v[76:79], v[60:63], a[252:255], v[76:79]
    s_mov_b64 exec, s[36:37]
    buffer_store_dword v23, v22, s[8:11], s33 offen sc1
    s_mov_b64 exec, -1

    s_waitcnt lgkmcnt(4)
    v_mfma_f32_16x16x32_bf16 v[80:83], v[32:35], a[0:3], 0
    ds_read_b128 v[56:59], v20 offset:1024
    s_add_u32 m0, s29, 33664
    v_mfma_f32_16x16x32_bf16 v[84:87], v[32:35], a[4:7], 0
    buffer_load_dwordx4 v16, s[16:19], s34 offen offset:128 lds
    v_mfma_f32_16x16x32_bf16 v[88:91], v[36:39], a[0:3], 0
    ds_read_b128 v[60:63], v20 offset:17408
    v_mfma_f32_16x16x32_bf16 v[92:95], v[36:39], a[4:7], 0
    s_waitcnt lgkmcnt(4)
    v_mfma_f32_16x16x32_bf16 v[80:83], v[40:43], a[8:11], v[80:83]
    ds_read_b128 v[32:35], v19 offset:2048
    v_mfma_f32_16x16x32_bf16 v[84:87], v[40:43], a[12:15], v[84:87]
    v_cvt_pk_bf16_f32 v96, v64, v65
    v_cvt_pk_bf16_f32 v97, v66, v67
    v_mfma_f32_16x16x32_bf16 v[88:91], v[44:47], a[8:11], v[88:91]
    ds_read_b128 v[36:39], v19 offset:18432
    v_mfma_f32_16x16x32_bf16 v[92:95], v[44:47], a[12:15], v[92:95]
    v_cvt_pk_bf16_f32 v98, v72, v73
    v_cvt_pk_bf16_f32 v99, v74, v75
    s_waitcnt lgkmcnt(4)
    v_mfma_f32_16x16x32_bf16 v[80:83], v[48:51], a[16:19], v[80:83]
    ds_read_b128 v[40:43], v20 offset:2048
    s_add_u32 m0, s29, 34560
    v_mfma_f32_16x16x32_bf16 v[84:87], v[48:51], a[20:23], v[84:87]
    buffer_load_dwordx4 v16, s[16:19], s34 offen offset:256 lds
    v_mfma_f32_16x16x32_bf16 v[88:91], v[52:55], a[16:19], v[88:91]
    ds_read_b128 v[44:47], v20 offset:18432
    v_mfma_f32_16x16x32_bf16 v[92:95], v[52:55], a[20:23], v[92:95]
    s_waitcnt lgkmcnt(4)
    v_mfma_f32_16x16x32_bf16 v[80:83], v[56:59], a[24:27], v[80:83]
    ds_read_b128 v[48:51], v19 offset:3072
    v_mfma_f32_16x16x32_bf16 v[84:87], v[56:59], a[28:31], v[84:87]
    buffer_store_dwordx4 v[96:99], v21, s[8:11], s32 offen offset:0 sc1
    v_mfma_f32_16x16x32_bf16 v[88:91], v[60:63], a[24:27], v[88:91]
    ds_read_b128 v[52:55], v19 offset:19456
    v_mfma_f32_16x16x32_bf16 v[92:95], v[60:63], a[28:31], v[92:95]
    s_waitcnt lgkmcnt(4)
    v_mfma_f32_16x16x32_bf16 v[80:83], v[32:35], a[32:35], v[80:83]
    ds_read_b128 v[56:59], v20 offset:3072
    s_add_u32 m0, s29, 35456
    v_mfma_f32_16x16x32_bf16 v[84:87], v[32:35], a[36:39], v[84:87]
    buffer_load_dwordx4 v16, s[16:19], s34 offen offset:384 lds
    v_mfma_f32_16x16x32_bf16 v[88:91], v[36:39], a[32:35], v[88:91]
    ds_read_b128 v[60:63], v20 offset:19456
    v_mfma_f32_16x16x32_bf16 v[92:95], v[36:39], a[36:39], v[92:95]
    s_waitcnt lgkmcnt(4)
    v_mfma_f32_16x16x32_bf16 v[80:83], v[40:43], a[40:43], v[80:83]
    ds_read_b128 v[32:35], v19 offset:4096
    v_mfma_f32_16x16x32_bf16 v[84:87], v[40:43], a[44:47], v[84:87]
    v_cvt_pk_bf16_f32 v100, v68, v69
    v_cvt_pk_bf16_f32 v101, v70, v71
    v_mfma_f32_16x16x32_bf16 v[88:91], v[44:47], a[40:43], v[88:91]
    ds_read_b128 v[36:39], v19 offset:20480
    v_mfma_f32_16x16x32_bf16 v[92:95], v[44:47], a[44:47], v[92:95]
    v_cvt_pk_bf16_f32 v102, v76, v77
    v_cvt_pk_bf16_f32 v103, v78, v79
    s_waitcnt lgkmcnt(4)
    v_mfma_f32_16x16x32_bf16 v[80:83], v[48:51], a[48:51], v[80:83]
    ds_read_b128 v[40:43], v20 offset:4096
    s_add_u32 m0, s29, 36352
    v_mfma_f32_16x16x32_bf16 v[84:87], v[48:51], a[52:55], v[84:87]
    buffer_load_dwordx4 v16, s[16:19], s34 offen offset:512 lds
    v_mfma_f32_16x16x32_bf16 v[88:91], v[52:55], a[48:51], v[88:91]
    ds_read_b128 v[44:47], v20 offset:20480
    v_mfma_f32_16x16x32_bf16 v[92:95], v[52:55], a[52:55], v[92:95]
    s_waitcnt lgkmcnt(4)
    v_mfma_f32_16x16x32_bf16 v[80:83], v[56:59], a[56:59], v[80:83]
    ds_read_b128 v[48:51], v19 offset:5120
    v_mfma_f32_16x16x32_bf16 v[84:87], v[56:59], a[60:63], v[84:87]
    buffer_store_dwordx4 v[100:103], v21, s[8:11], s32 offen offset:1024 sc1
    v_mfma_f32_16x16x32_bf16 v[88:91], v[60:63], a[56:59], v[88:91]
    ds_read_b128 v[52:55], v19 offset:21504
    v_mfma_f32_16x16x32_bf16 v[92:95], v[60:63], a[60:63], v[92:95]
    s_waitcnt lgkmcnt(4)
    v_mfma_f32_16x16x32_bf16 v[80:83], v[32:35], a[64:67], v[80:83]
    ds_read_b128 v[56:59], v20 offset:5120
    s_add_u32 m0, s29, 37248
    v_mfma_f32_16x16x32_bf16 v[84:87], v[32:35], a[68:71], v[84:87]
    buffer_load_dwordx4 v16, s[16:19], s34 offen offset:640 lds
    v_mfma_f32_16x16x32_bf16 v[88:91], v[36:39], a[64:67], v[88:91]
    ds_read_b128 v[60:63], v20 offset:21504
    v_mfma_f32_16x16x32_bf16 v[92:95], v[36:39], a[68:71], v[92:95]
    s_waitcnt lgkmcnt(4)
    v_mfma_f32_16x16x32_bf16 v[80:83], v[40:43], a[72:75], v[80:83]
    ds_read_b128 v[32:35], v19 offset:6144
    v_mfma_f32_16x16x32_bf16 v[84:87], v[40:43], a[76:79], v[84:87]
    s_mov_b32 s32, s39
    s_add_u32 s38, s39, 4096
    s_add_u32 s39, s39, 262144
    v_mfma_f32_16x16x32_bf16 v[88:91], v[44:47], a[72:75], v[88:91]
    ds_read_b128 v[36:39], v19 offset:22528
    v_mfma_f32_16x16x32_bf16 v[92:95], v[44:47], a[76:79], v[92:95]
    v_add_u32 v23, 1, v23
    s_waitcnt lgkmcnt(4)
    v_mfma_f32_16x16x32_bf16 v[80:83], v[48:51], a[80:83], v[80:83]
    ds_read_b128 v[40:43], v20 offset:6144
    s_add_u32 m0, s29, 38144
    v_mfma_f32_16x16x32_bf16 v[84:87], v[48:51], a[84:87], v[84:87]
    buffer_load_dwordx4 v16, s[16:19], s34 offen offset:768 lds
    v_mfma_f32_16x16x32_bf16 v[88:91], v[52:55], a[80:83], v[88:91]
    ds_read_b128 v[44:47], v20 offset:22528
    v_mfma_f32_16x16x32_bf16 v[92:95], v[52:55], a[84:87], v[92:95]
    s_waitcnt lgkmcnt(4)
    v_mfma_f32_16x16x32_bf16 v[80:83], v[56:59], a[88:91], v[80:83]
    ds_read_b128 v[48:51], v19 offset:7168
    v_mfma_f32_16x16x32_bf16 v[84:87], v[56:59], a[92:95], v[84:87]
    v_mfma_f32_16x16x32_bf16 v[88:91], v[60:63], a[88:91], v[88:91]
    ds_read_b128 v[52:55], v19 offset:23552
    v_mfma_f32_16x16x32_bf16 v[92:95], v[60:63], a[92:95], v[92:95]
    s_mov_b64 exec, s[44:45]
    buffer_store_dwordx4 v[24:27], v30, s[8:11], s46 offen sc1
    s_mov_b64 exec, -1
    s_waitcnt lgkmcnt(4)
    v_mfma_f32_16x16x32_bf16 v[80:83], v[32:35], a[96:99], v[80:83]
    ds_read_b128 v[56:59], v20 offset:7168
    s_add_u32 m0, s29, 39040
    v_mfma_f32_16x16x32_bf16 v[84:87], v[32:35], a[100:103], v[84:87]
    buffer_load_dwordx4 v16, s[16:19], s34 offen offset:896 lds
    v_mfma_f32_16x16x32_bf16 v[88:91], v[36:39], a[96:99], v[88:91]
    ds_read_b128 v[60:63], v20 offset:23552
    v_mfma_f32_16x16x32_bf16 v[92:95], v[36:39], a[100:103], v[92:95]
    s_waitcnt lgkmcnt(4)
    v_mfma_f32_16x16x32_bf16 v[80:83], v[40:43], a[104:107], v[80:83]
    s_add_u32 s34, s34, 64512
    s_min_u32 s34, s34, 4128768
    v_mfma_f32_16x16x32_bf16 v[84:87], v[40:43], a[108:111], v[84:87]
    v_mfma_f32_16x16x32_bf16 v[88:91], v[44:47], a[104:107], v[88:91]
    v_mfma_f32_16x16x32_bf16 v[92:95], v[44:47], a[108:111], v[92:95]
    s_waitcnt lgkmcnt(0)
    s_waitcnt vmcnt(18)
    s_barrier
    ds_read_b128 v[32:35], v19 offset:32768
    ds_read_b128 v[36:39], v19 offset:49152
    v_mfma_f32_16x16x32_bf16 v[80:83], v[48:51], a[112:115], v[80:83]
    ds_read_b128 v[40:43], v20 offset:32768
    s_add_u32 m0, s29, 65536
    v_mfma_f32_16x16x32_bf16 v[84:87], v[48:51], a[116:119], v[84:87]
    buffer_load_dwordx4 v16, s[16:19], s34 offen offset:0 lds
    v_mfma_f32_16x16x32_bf16 v[88:91], v[52:55], a[112:115], v[88:91]
    ds_read_b128 v[44:47], v20 offset:49152
    v_mfma_f32_16x16x32_bf16 v[92:95], v[52:55], a[116:119], v[92:95]
    v_mfma_f32_16x16x32_bf16 v[80:83], v[56:59], a[120:123], v[80:83]
    ds_read_b128 v[48:51], v19 offset:33792
    v_mfma_f32_16x16x32_bf16 v[84:87], v[56:59], a[124:127], v[84:87]
    v_mfma_f32_16x16x32_bf16 v[88:91], v[60:63], a[120:123], v[88:91]
    ds_read_b128 v[52:55], v19 offset:50176
    v_mfma_f32_16x16x32_bf16 v[92:95], v[60:63], a[124:127], v[92:95]
    s_waitcnt lgkmcnt(4)
    v_mfma_f32_16x16x32_bf16 v[80:83], v[32:35], a[128:131], v[80:83]
    ds_read_b128 v[56:59], v20 offset:33792
    s_add_u32 m0, s29, 66432
    v_mfma_f32_16x16x32_bf16 v[84:87], v[32:35], a[132:135], v[84:87]
    buffer_load_dwordx4 v16, s[16:19], s34 offen offset:128 lds
    v_mfma_f32_16x16x32_bf16 v[88:91], v[36:39], a[128:131], v[88:91]
    ds_read_b128 v[60:63], v20 offset:50176
    v_mfma_f32_16x16x32_bf16 v[92:95], v[36:39], a[132:135], v[92:95]
    s_waitcnt lgkmcnt(4)
    v_mfma_f32_16x16x32_bf16 v[80:83], v[40:43], a[136:139], v[80:83]
    ds_read_b128 v[32:35], v19 offset:34816
    v_mfma_f32_16x16x32_bf16 v[84:87], v[40:43], a[140:143], v[84:87]
    v_mfma_f32_16x16x32_bf16 v[88:91], v[44:47], a[136:139], v[88:91]
    ds_read_b128 v[36:39], v19 offset:51200
    v_mfma_f32_16x16x32_bf16 v[92:95], v[44:47], a[140:143], v[92:95]
    s_waitcnt lgkmcnt(4)
    v_mfma_f32_16x16x32_bf16 v[80:83], v[48:51], a[144:147], v[80:83]
    ds_read_b128 v[40:43], v20 offset:34816
    s_add_u32 m0, s29, 67328
    v_mfma_f32_16x16x32_bf16 v[84:87], v[48:51], a[148:151], v[84:87]
    buffer_load_dwordx4 v16, s[16:19], s34 offen offset:256 lds
    v_mfma_f32_16x16x32_bf16 v[88:91], v[52:55], a[144:147], v[88:91]
    ds_read_b128 v[44:47], v20 offset:51200
    v_mfma_f32_16x16x32_bf16 v[92:95], v[52:55], a[148:151], v[92:95]
    s_waitcnt lgkmcnt(4)
    v_mfma_f32_16x16x32_bf16 v[80:83], v[56:59], a[152:155], v[80:83]
    ds_read_b128 v[48:51], v19 offset:35840
    v_mfma_f32_16x16x32_bf16 v[84:87], v[56:59], a[156:159], v[84:87]
    v_mfma_f32_16x16x32_bf16 v[88:91], v[60:63], a[152:155], v[88:91]
    ds_read_b128 v[52:55], v19 offset:52224
    v_mfma_f32_16x16x32_bf16 v[92:95], v[60:63], a[156:159], v[92:95]
    s_waitcnt lgkmcnt(4)
    v_mfma_f32_16x16x32_bf16 v[80:83], v[32:35], a[160:163], v[80:83]
    ds_read_b128 v[56:59], v20 offset:35840
    s_add_u32 m0, s29, 68224
    v_mfma_f32_16x16x32_bf16 v[84:87], v[32:35], a[164:167], v[84:87]
    buffer_load_dwordx4 v16, s[16:19], s34 offen offset:384 lds
    v_mfma_f32_16x16x32_bf16 v[88:91], v[36:39], a[160:163], v[88:91]
    ds_read_b128 v[60:63], v20 offset:52224
    v_mfma_f32_16x16x32_bf16 v[92:95], v[36:39], a[164:167], v[92:95]
    s_waitcnt lgkmcnt(4)
    v_mfma_f32_16x16x32_bf16 v[80:83], v[40:43], a[168:171], v[80:83]
    ds_read_b128 v[32:35], v19 offset:36864
    v_mfma_f32_16x16x32_bf16 v[84:87], v[40:43], a[172:175], v[84:87]
    v_mfma_f32_16x16x32_bf16 v[88:91], v[44:47], a[168:171], v[88:91]
    ds_read_b128 v[36:39], v19 offset:53248
    v_mfma_f32_16x16x32_bf16 v[92:95], v[44:47], a[172:175], v[92:95]
    s_waitcnt lgkmcnt(4)
    v_mfma_f32_16x16x32_bf16 v[80:83], v[48:51], a[176:179], v[80:83]
    ds_read_b128 v[40:43], v20 offset:36864
    s_add_u32 m0, s29, 69120
    v_mfma_f32_16x16x32_bf16 v[84:87], v[48:51], a[180:183], v[84:87]
    buffer_load_dwordx4 v16, s[16:19], s34 offen offset:512 lds
    v_mfma_f32_16x16x32_bf16 v[88:91], v[52:55], a[176:179], v[88:91]
    ds_read_b128 v[44:47], v20 offset:53248
    v_mfma_f32_16x16x32_bf16 v[92:95], v[52:55], a[180:183], v[92:95]
    s_waitcnt lgkmcnt(4)
    v_mfma_f32_16x16x32_bf16 v[80:83], v[56:59], a[184:187], v[80:83]
    ds_read_b128 v[48:51], v19 offset:37888
    v_mfma_f32_16x16x32_bf16 v[84:87], v[56:59], a[188:191], v[84:87]
    v_mfma_f32_16x16x32_bf16 v[88:91], v[60:63], a[184:187], v[88:91]
    ds_read_b128 v[52:55], v19 offset:54272
    v_mfma_f32_16x16x32_bf16 v[92:95], v[60:63], a[188:191], v[92:95]
    s_waitcnt lgkmcnt(4)
    v_mfma_f32_16x16x32_bf16 v[80:83], v[32:35], a[192:195], v[80:83]
    ds_read_b128 v[56:59], v20 offset:37888
    s_add_u32 m0, s29, 70016
    v_mfma_f32_16x16x32_bf16 v[84:87], v[32:35], a[196:199], v[84:87]
    buffer_load_dwordx4 v16, s[16:19], s34 offen offset:640 lds
    v_mfma_f32_16x16x32_bf16 v[88:91], v[36:39], a[192:195], v[88:91]
    ds_read_b128 v[60:63], v20 offset:54272
    v_mfma_f32_16x16x32_bf16 v[92:95], v[36:39], a[196:199], v[92:95]
    s_waitcnt lgkmcnt(4)
    v_mfma_f32_16x16x32_bf16 v[80:83], v[40:43], a[200:203], v[80:83]
    ds_read_b128 v[32:35], v19 offset:38912
    v_mfma_f32_16x16x32_bf16 v[84:87], v[40:43], a[204:207], v[84:87]
    v_mfma_f32_16x16x32_bf16 v[88:91], v[44:47], a[200:203], v[88:91]
    ds_read_b128 v[36:39], v19 offset:55296
    v_mfma_f32_16x16x32_bf16 v[92:95], v[44:47], a[204:207], v[92:95]
    s_waitcnt lgkmcnt(4)
    v_mfma_f32_16x16x32_bf16 v[80:83], v[48:51], a[208:211], v[80:83]
    ds_read_b128 v[40:43], v20 offset:38912
    s_add_u32 m0, s29, 70912
    v_mfma_f32_16x16x32_bf16 v[84:87], v[48:51], a[212:215], v[84:87]
    buffer_load_dwordx4 v16, s[16:19], s34 offen offset:768 lds
    v_mfma_f32_16x16x32_bf16 v[88:91], v[52:55], a[208:211], v[88:91]
    ds_read_b128 v[44:47], v20 offset:55296
    v_mfma_f32_16x16x32_bf16 v[92:95], v[52:55], a[212:215], v[92:95]
    s_waitcnt lgkmcnt(4)
    v_mfma_f32_16x16x32_bf16 v[80:83], v[56:59], a[216:219], v[80:83]
    ds_read_b128 v[48:51], v19 offset:39936
    v_mfma_f32_16x16x32_bf16 v[84:87], v[56:59], a[220:223], v[84:87]
    s_cmp_lt_u32 s35, 21
    s_cselect_b64 s[44:45], -1, 0
    v_mfma_f32_16x16x32_bf16 v[88:91], v[60:63], a[216:219], v[88:91]
    ds_read_b128 v[52:55], v19 offset:56320
    v_mfma_f32_16x16x32_bf16 v[92:95], v[60:63], a[220:223], v[92:95]
    s_cselect_b32 s4, 0x10000, 0
    s_add_u32 s46, s46, s4
    s_waitcnt lgkmcnt(4)
    v_mfma_f32_16x16x32_bf16 v[80:83], v[32:35], a[224:227], v[80:83]
    ds_read_b128 v[56:59], v20 offset:39936
    s_add_u32 m0, s29, 71808
    v_mfma_f32_16x16x32_bf16 v[84:87], v[32:35], a[228:231], v[84:87]
    buffer_load_dwordx4 v16, s[16:19], s34 offen offset:896 lds
    v_mfma_f32_16x16x32_bf16 v[88:91], v[36:39], a[224:227], v[88:91]
    ds_read_b128 v[60:63], v20 offset:56320
    v_mfma_f32_16x16x32_bf16 v[92:95], v[36:39], a[228:231], v[92:95]
    s_waitcnt lgkmcnt(4)
    v_mfma_f32_16x16x32_bf16 v[80:83], v[40:43], a[232:235], v[80:83]
    s_add_u32 s34, s34, 1024
    v_mfma_f32_16x16x32_bf16 v[84:87], v[40:43], a[236:239], v[84:87]
    v_mfma_f32_16x16x32_bf16 v[88:91], v[44:47], a[232:235], v[88:91]
    v_mfma_f32_16x16x32_bf16 v[92:95], v[44:47], a[236:239], v[92:95]
    s_waitcnt lgkmcnt(0)
    s_waitcnt vmcnt(11)
    s_barrier
    ds_read_b128 v[32:35], v17 offset:0
    ds_read_b128 v[36:39], v17 offset:16384
    v_mfma_f32_16x16x32_bf16 v[80:83], v[48:51], a[240:243], v[80:83]
    ds_read_b128 v[40:43], v18 offset:0
    s_add_u32 m0, s29, 98304
    v_mfma_f32_16x16x32_bf16 v[84:87], v[48:51], a[244:247], v[84:87]
    buffer_load_dwordx4 v16, s[16:19], s34 offen offset:0 lds
    v_mfma_f32_16x16x32_bf16 v[88:91], v[52:55], a[240:243], v[88:91]
    ds_read_b128 v[44:47], v18 offset:16384
    v_mfma_f32_16x16x32_bf16 v[92:95], v[52:55], a[244:247], v[92:95]
    v_mfma_f32_16x16x32_bf16 v[80:83], v[56:59], a[248:251], v[80:83]
    ds_read_b128 v[48:51], v17 offset:1024
    v_mfma_f32_16x16x32_bf16 v[84:87], v[56:59], a[252:255], v[84:87]
    v_mfma_f32_16x16x32_bf16 v[88:91], v[60:63], a[248:251], v[88:91]
    ds_read_b128 v[52:55], v17 offset:17408
    v_mfma_f32_16x16x32_bf16 v[92:95], v[60:63], a[252:255], v[92:95]
    s_mov_b64 exec, s[36:37]
    buffer_store_dword v23, v22, s[8:11], s33 offen sc1
    s_mov_b64 exec, -1

    s_add_u32 s35, s35, 1
    s_cmp_lt_u32 s35, 32
    s_cbranch_scc1 .ql_368

    s_nop 7
    v_cvt_pk_bf16_f32 v96, v80, v81
    v_cvt_pk_bf16_f32 v97, v82, v83
    v_cvt_pk_bf16_f32 v98, v88, v89
    v_cvt_pk_bf16_f32 v99, v90, v91
    buffer_store_dwordx4 v[96:99], v21, s[8:11], s32 offen offset:0 sc1
    v_cvt_pk_bf16_f32 v100, v84, v85
    v_cvt_pk_bf16_f32 v101, v86, v87
    v_cvt_pk_bf16_f32 v102, v92, v93
    v_cvt_pk_bf16_f32 v103, v94, v95
    buffer_store_dwordx4 v[100:103], v21, s[8:11], s32 offen offset:1024 sc1
    v_mov_b32 v23, 64
    s_waitcnt vmcnt(0) lgkmcnt(0)
    s_barrier
    s_mov_b64 exec, s[36:37]
    buffer_store_dword v23, v22, s[8:11], s33 offen sc1
    s_mov_b64 exec, -1

.qd_365:
    s_load_dwordx2 s[40:41], s[0:1], 88
    s_load_dwordx2 s[42:43], s[0:1], 112
    s_and_b32 s4, s33, 0xffffe7ff
    s_mov_b32 s57, s4
    s_mov_b32 s34, s47
    s_and_b32 s30, s26, 7
    s_lshr_b32 s31, s26, 3
    s_lshl_b32 s28, s91, 21
    s_lshl_b32 s4, s30, 8
    s_add_u32 s28, s28, s4
    s_waitcnt lgkmcnt(0)

    s_mov_b32 s12, s40
    s_and_b32 s13, s41, 0xffff
    s_mov_b32 s14, 0x800000
    s_mov_b32 s15, 0x00020000

    s_mov_b32 s44, s42
    s_and_b32 s45, s43, 0xffff
    s_mov_b32 s46, 0x400000
    s_mov_b32 s47, 0x00020000

    v_lshrrev_b32 v4, 1, v2
    v_xor_b32 v4, v4, v3
    v_lshlrev_b32 v4, 1, v4
    v_and_b32 v5, 1, v1
    v_or_b32 v4, v4, v5
    v_lshlrev_b32 v4, 4, v4
    v_lshlrev_b32 v5, 11, v3
    v_add_u32 v10, v4, v5
    v_xor_b32 v11, 0x80, v10
    s_lshl_b32 s4, s24, 16
    s_add_u32 s28, s28, s4
    s_lshl_b32 s29, s24, 13
    v_lshrrev_b32 v4, 2, v2
    v_and_b32 v5, 1, v3
    v_lshl_or_b32 v5, v5, 2, v4
    s_lshl_b32 s4, s24, 1
    v_xor_b32 v5, s4, v5
    v_lshlrev_b32 v5, 5, v5
    v_lshl_add_u32 v4, v3, 2, v4
    v_lshl_add_u32 v5, v4, 8, v5
    v_and_b32 v4, 3, v2
    v_lshl_add_u32 v12, v4, 3, v5
    v_xor_b32 v13, 32, v12
    v_add_u32 v14, 0x10000, v12
    v_add_u32 v15, 0x10000, v13

    s_and_b32 s4, s91, 1
    s_lshl_b32 s4, s4, 5
    v_xor_b32 v12, s4, v12
    v_xor_b32 v13, s4, v13
    v_xor_b32 v14, s4, v14
    v_xor_b32 v15, s4, v15

    s_add_u32 m0, s29, 0
    s_add_u32 s4, s28, 0
    buffer_load_dwordx4 v10, s[12:15], s4 offen lds

    s_add_u32 m0, s29, 1024
    s_add_u32 s4, s28, 8192
    buffer_load_dwordx4 v11, s[12:15], s4 offen lds

    s_add_u32 m0, s29, 2048
    s_add_u32 s4, s28, 16384
    buffer_load_dwordx4 v10, s[12:15], s4 offen lds

    s_add_u32 m0, s29, 3072
    s_add_u32 s4, s28, 24576
    buffer_load_dwordx4 v11, s[12:15], s4 offen lds

    s_add_u32 m0, s29, 4096
    s_add_u32 s4, s28, 32768
    buffer_load_dwordx4 v10, s[12:15], s4 offen lds

    s_add_u32 m0, s29, 5120
    s_add_u32 s4, s28, 40960
    buffer_load_dwordx4 v11, s[12:15], s4 offen lds

    s_add_u32 m0, s29, 6144
    s_add_u32 s4, s28, 49152
    buffer_load_dwordx4 v10, s[12:15], s4 offen lds

    s_add_u32 m0, s29, 7168
    s_add_u32 s4, s28, 57344
    buffer_load_dwordx4 v11, s[12:15], s4 offen lds

    s_add_u32 m0, s29, 32768
    s_add_u32 s4, s28, 262144
    buffer_load_dwordx4 v10, s[12:15], s4 offen lds

    s_add_u32 m0, s29, 33792
    s_add_u32 s4, s28, 270336
    buffer_load_dwordx4 v11, s[12:15], s4 offen lds

    s_add_u32 m0, s29, 34816
    s_add_u32 s4, s28, 278528
    buffer_load_dwordx4 v10, s[12:15], s4 offen lds

    s_add_u32 m0, s29, 35840
    s_add_u32 s4, s28, 286720
    buffer_load_dwordx4 v11, s[12:15], s4 offen lds

    s_add_u32 m0, s29, 36864
    s_add_u32 s4, s28, 294912
    buffer_load_dwordx4 v10, s[12:15], s4 offen lds

    s_add_u32 m0, s29, 37888
    s_add_u32 s4, s28, 303104
    buffer_load_dwordx4 v11, s[12:15], s4 offen lds

    s_add_u32 m0, s29, 38912
    s_add_u32 s4, s28, 311296
    buffer_load_dwordx4 v10, s[12:15], s4 offen lds

    s_add_u32 m0, s29, 39936
    s_add_u32 s4, s28, 319488
    buffer_load_dwordx4 v11, s[12:15], s4 offen lds

    s_add_u32 m0, s29, 65536
    s_add_u32 s4, s28, 524288
    buffer_load_dwordx4 v10, s[12:15], s4 offen lds

    s_add_u32 m0, s29, 66560
    s_add_u32 s4, s28, 532480
    buffer_load_dwordx4 v11, s[12:15], s4 offen lds

    s_add_u32 m0, s29, 67584
    s_add_u32 s4, s28, 540672
    buffer_load_dwordx4 v10, s[12:15], s4 offen lds

    s_add_u32 m0, s29, 68608
    s_add_u32 s4, s28, 548864
    buffer_load_dwordx4 v11, s[12:15], s4 offen lds

    s_add_u32 m0, s29, 69632
    s_add_u32 s4, s28, 557056
    buffer_load_dwordx4 v10, s[12:15], s4 offen lds

    s_add_u32 m0, s29, 70656
    s_add_u32 s4, s28, 565248
    buffer_load_dwordx4 v11, s[12:15], s4 offen lds

    s_add_u32 m0, s29, 71680
    s_add_u32 s4, s28, 573440
    buffer_load_dwordx4 v10, s[12:15], s4 offen lds

    s_add_u32 m0, s29, 72704
    s_add_u32 s4, s28, 581632
    buffer_load_dwordx4 v11, s[12:15], s4 offen lds

    s_add_u32 m0, s29, 98304
    s_add_u32 s4, s28, 786432
    buffer_load_dwordx4 v10, s[12:15], s4 offen lds

    s_add_u32 m0, s29, 99328
    s_add_u32 s4, s28, 794624
    buffer_load_dwordx4 v11, s[12:15], s4 offen lds

    s_add_u32 m0, s29, 100352
    s_add_u32 s4, s28, 802816
    buffer_load_dwordx4 v10, s[12:15], s4 offen lds

    s_add_u32 m0, s29, 101376
    s_add_u32 s4, s28, 811008
    buffer_load_dwordx4 v11, s[12:15], s4 offen lds

    s_add_u32 m0, s29, 102400
    s_add_u32 s4, s28, 819200
    buffer_load_dwordx4 v10, s[12:15], s4 offen lds

    s_add_u32 m0, s29, 103424
    s_add_u32 s4, s28, 827392
    buffer_load_dwordx4 v11, s[12:15], s4 offen lds

    s_add_u32 m0, s29, 104448
    s_add_u32 s4, s28, 835584
    buffer_load_dwordx4 v10, s[12:15], s4 offen lds

    s_add_u32 m0, s29, 105472
    s_add_u32 s4, s28, 843776
    buffer_load_dwordx4 v11, s[12:15], s4 offen lds

    s_waitcnt vmcnt(24)
    s_barrier
    ds_read_b64_tr_b16 a[0:1], v12 offset:0
    ds_read_b64_tr_b16 a[2:3], v12 offset:4096
    ds_read_b64_tr_b16 a[4:5], v13 offset:0
    ds_read_b64_tr_b16 a[6:7], v13 offset:4096
    ds_read_b64_tr_b16 a[8:9], v12 offset:8192
    ds_read_b64_tr_b16 a[10:11], v12 offset:12288
    ds_read_b64_tr_b16 a[12:13], v13 offset:8192
    ds_read_b64_tr_b16 a[14:15], v13 offset:12288
    ds_read_b64_tr_b16 a[16:17], v12 offset:16384
    ds_read_b64_tr_b16 a[18:19], v12 offset:20480
    ds_read_b64_tr_b16 a[20:21], v13 offset:16384
    ds_read_b64_tr_b16 a[22:23], v13 offset:20480
    ds_read_b64_tr_b16 a[24:25], v12 offset:24576
    ds_read_b64_tr_b16 a[26:27], v12 offset:28672
    ds_read_b64_tr_b16 a[28:29], v13 offset:24576
    ds_read_b64_tr_b16 a[30:31], v13 offset:28672
    s_waitcnt lgkmcnt(0)
    s_barrier
    s_add_u32 m0, s29, 0
    s_add_u32 s4, s28, 1048576
    buffer_load_dwordx4 v10, s[12:15], s4 offen lds

    s_add_u32 m0, s29, 1024
    s_add_u32 s4, s28, 1056768
    buffer_load_dwordx4 v11, s[12:15], s4 offen lds

    s_add_u32 m0, s29, 2048
    s_add_u32 s4, s28, 1064960
    buffer_load_dwordx4 v10, s[12:15], s4 offen lds

    s_add_u32 m0, s29, 3072
    s_add_u32 s4, s28, 1073152
    buffer_load_dwordx4 v11, s[12:15], s4 offen lds

    s_add_u32 m0, s29, 4096
    s_add_u32 s4, s28, 1081344
    buffer_load_dwordx4 v10, s[12:15], s4 offen lds

    s_add_u32 m0, s29, 5120
    s_add_u32 s4, s28, 1089536
    buffer_load_dwordx4 v11, s[12:15], s4 offen lds

    s_add_u32 m0, s29, 6144
    s_add_u32 s4, s28, 1097728
    buffer_load_dwordx4 v10, s[12:15], s4 offen lds

    s_add_u32 m0, s29, 7168
    s_add_u32 s4, s28, 1105920
    buffer_load_dwordx4 v11, s[12:15], s4 offen lds

    s_waitcnt vmcnt(24)
    s_barrier
    ds_read_b64_tr_b16 a[32:33], v12 offset:32768
    ds_read_b64_tr_b16 a[34:35], v12 offset:36864
    ds_read_b64_tr_b16 a[36:37], v13 offset:32768
    ds_read_b64_tr_b16 a[38:39], v13 offset:36864
    ds_read_b64_tr_b16 a[40:41], v12 offset:40960
    ds_read_b64_tr_b16 a[42:43], v12 offset:45056
    ds_read_b64_tr_b16 a[44:45], v13 offset:40960
    ds_read_b64_tr_b16 a[46:47], v13 offset:45056
    ds_read_b64_tr_b16 a[48:49], v12 offset:49152
    ds_read_b64_tr_b16 a[50:51], v12 offset:53248
    ds_read_b64_tr_b16 a[52:53], v13 offset:49152
    ds_read_b64_tr_b16 a[54:55], v13 offset:53248
    ds_read_b64_tr_b16 a[56:57], v12 offset:57344
    ds_read_b64_tr_b16 a[58:59], v12 offset:61440
    ds_read_b64_tr_b16 a[60:61], v13 offset:57344
    ds_read_b64_tr_b16 a[62:63], v13 offset:61440
    s_waitcnt lgkmcnt(0)
    s_barrier
    s_add_u32 m0, s29, 32768
    s_add_u32 s4, s28, 1310720
    buffer_load_dwordx4 v10, s[12:15], s4 offen lds

    s_add_u32 m0, s29, 33792
    s_add_u32 s4, s28, 1318912
    buffer_load_dwordx4 v11, s[12:15], s4 offen lds

    s_add_u32 m0, s29, 34816
    s_add_u32 s4, s28, 1327104
    buffer_load_dwordx4 v10, s[12:15], s4 offen lds

    s_add_u32 m0, s29, 35840
    s_add_u32 s4, s28, 1335296
    buffer_load_dwordx4 v11, s[12:15], s4 offen lds

    s_add_u32 m0, s29, 36864
    s_add_u32 s4, s28, 1343488
    buffer_load_dwordx4 v10, s[12:15], s4 offen lds

    s_add_u32 m0, s29, 37888
    s_add_u32 s4, s28, 1351680
    buffer_load_dwordx4 v11, s[12:15], s4 offen lds

    s_add_u32 m0, s29, 38912
    s_add_u32 s4, s28, 1359872
    buffer_load_dwordx4 v10, s[12:15], s4 offen lds

    s_add_u32 m0, s29, 39936
    s_add_u32 s4, s28, 1368064
    buffer_load_dwordx4 v11, s[12:15], s4 offen lds

    s_waitcnt vmcnt(24)
    s_barrier
    ds_read_b64_tr_b16 a[64:65], v14 offset:0
    ds_read_b64_tr_b16 a[66:67], v14 offset:4096
    ds_read_b64_tr_b16 a[68:69], v15 offset:0
    ds_read_b64_tr_b16 a[70:71], v15 offset:4096
    ds_read_b64_tr_b16 a[72:73], v14 offset:8192
    ds_read_b64_tr_b16 a[74:75], v14 offset:12288
    ds_read_b64_tr_b16 a[76:77], v15 offset:8192
    ds_read_b64_tr_b16 a[78:79], v15 offset:12288
    ds_read_b64_tr_b16 a[80:81], v14 offset:16384
    ds_read_b64_tr_b16 a[82:83], v14 offset:20480
    ds_read_b64_tr_b16 a[84:85], v15 offset:16384
    ds_read_b64_tr_b16 a[86:87], v15 offset:20480
    ds_read_b64_tr_b16 a[88:89], v14 offset:24576
    ds_read_b64_tr_b16 a[90:91], v14 offset:28672
    ds_read_b64_tr_b16 a[92:93], v15 offset:24576
    ds_read_b64_tr_b16 a[94:95], v15 offset:28672
    s_waitcnt lgkmcnt(0)
    s_barrier
    s_add_u32 m0, s29, 65536
    s_add_u32 s4, s28, 1572864
    buffer_load_dwordx4 v10, s[12:15], s4 offen lds

    s_add_u32 m0, s29, 66560
    s_add_u32 s4, s28, 1581056
    buffer_load_dwordx4 v11, s[12:15], s4 offen lds

    s_add_u32 m0, s29, 67584
    s_add_u32 s4, s28, 1589248
    buffer_load_dwordx4 v10, s[12:15], s4 offen lds

    s_add_u32 m0, s29, 68608
    s_add_u32 s4, s28, 1597440
    buffer_load_dwordx4 v11, s[12:15], s4 offen lds

    s_add_u32 m0, s29, 69632
    s_add_u32 s4, s28, 1605632
    buffer_load_dwordx4 v10, s[12:15], s4 offen lds

    s_add_u32 m0, s29, 70656
    s_add_u32 s4, s28, 1613824
    buffer_load_dwordx4 v11, s[12:15], s4 offen lds

    s_add_u32 m0, s29, 71680
    s_add_u32 s4, s28, 1622016
    buffer_load_dwordx4 v10, s[12:15], s4 offen lds

    s_add_u32 m0, s29, 72704
    s_add_u32 s4, s28, 1630208
    buffer_load_dwordx4 v11, s[12:15], s4 offen lds

    s_waitcnt vmcnt(24)
    s_barrier
    ds_read_b64_tr_b16 a[96:97], v14 offset:32768
    ds_read_b64_tr_b16 a[98:99], v14 offset:36864
    ds_read_b64_tr_b16 a[100:101], v15 offset:32768
    ds_read_b64_tr_b16 a[102:103], v15 offset:36864
    ds_read_b64_tr_b16 a[104:105], v14 offset:40960
    ds_read_b64_tr_b16 a[106:107], v14 offset:45056
    ds_read_b64_tr_b16 a[108:109], v15 offset:40960
    ds_read_b64_tr_b16 a[110:111], v15 offset:45056
    ds_read_b64_tr_b16 a[112:113], v14 offset:49152
    ds_read_b64_tr_b16 a[114:115], v14 offset:53248
    ds_read_b64_tr_b16 a[116:117], v15 offset:49152
    ds_read_b64_tr_b16 a[118:119], v15 offset:53248
    ds_read_b64_tr_b16 a[120:121], v14 offset:57344
    ds_read_b64_tr_b16 a[122:123], v14 offset:61440
    ds_read_b64_tr_b16 a[124:125], v15 offset:57344
    ds_read_b64_tr_b16 a[126:127], v15 offset:61440
    s_waitcnt lgkmcnt(0)
    s_barrier
    s_add_u32 m0, s29, 98304
    s_add_u32 s4, s28, 1835008
    buffer_load_dwordx4 v10, s[12:15], s4 offen lds

    s_add_u32 m0, s29, 99328
    s_add_u32 s4, s28, 1843200
    buffer_load_dwordx4 v11, s[12:15], s4 offen lds

    s_add_u32 m0, s29, 100352
    s_add_u32 s4, s28, 1851392
    buffer_load_dwordx4 v10, s[12:15], s4 offen lds

    s_add_u32 m0, s29, 101376
    s_add_u32 s4, s28, 1859584
    buffer_load_dwordx4 v11, s[12:15], s4 offen lds

    s_add_u32 m0, s29, 102400
    s_add_u32 s4, s28, 1867776
    buffer_load_dwordx4 v10, s[12:15], s4 offen lds

    s_add_u32 m0, s29, 103424
    s_add_u32 s4, s28, 1875968
    buffer_load_dwordx4 v11, s[12:15], s4 offen lds

    s_add_u32 m0, s29, 104448
    s_add_u32 s4, s28, 1884160
    buffer_load_dwordx4 v10, s[12:15], s4 offen lds

    s_add_u32 m0, s29, 105472
    s_add_u32 s4, s28, 1892352
    buffer_load_dwordx4 v11, s[12:15], s4 offen lds

    s_waitcnt vmcnt(24)
    s_barrier
    ds_read_b64_tr_b16 a[128:129], v12 offset:0
    ds_read_b64_tr_b16 a[130:131], v12 offset:4096
    ds_read_b64_tr_b16 a[132:133], v13 offset:0
    ds_read_b64_tr_b16 a[134:135], v13 offset:4096
    ds_read_b64_tr_b16 a[136:137], v12 offset:8192
    ds_read_b64_tr_b16 a[138:139], v12 offset:12288
    ds_read_b64_tr_b16 a[140:141], v13 offset:8192
    ds_read_b64_tr_b16 a[142:143], v13 offset:12288
    ds_read_b64_tr_b16 a[144:145], v12 offset:16384
    ds_read_b64_tr_b16 a[146:147], v12 offset:20480
    ds_read_b64_tr_b16 a[148:149], v13 offset:16384
    ds_read_b64_tr_b16 a[150:151], v13 offset:20480
    ds_read_b64_tr_b16 a[152:153], v12 offset:24576
    ds_read_b64_tr_b16 a[154:155], v12 offset:28672
    ds_read_b64_tr_b16 a[156:157], v13 offset:24576
    ds_read_b64_tr_b16 a[158:159], v13 offset:28672
    s_waitcnt lgkmcnt(0)
    s_barrier
    s_waitcnt vmcnt(16)
    s_barrier
    ds_read_b64_tr_b16 a[160:161], v12 offset:32768
    ds_read_b64_tr_b16 a[162:163], v12 offset:36864
    ds_read_b64_tr_b16 a[164:165], v13 offset:32768
    ds_read_b64_tr_b16 a[166:167], v13 offset:36864
    ds_read_b64_tr_b16 a[168:169], v12 offset:40960
    ds_read_b64_tr_b16 a[170:171], v12 offset:45056
    ds_read_b64_tr_b16 a[172:173], v13 offset:40960
    ds_read_b64_tr_b16 a[174:175], v13 offset:45056
    ds_read_b64_tr_b16 a[176:177], v12 offset:49152
    ds_read_b64_tr_b16 a[178:179], v12 offset:53248
    ds_read_b64_tr_b16 a[180:181], v13 offset:49152
    ds_read_b64_tr_b16 a[182:183], v13 offset:53248
    ds_read_b64_tr_b16 a[184:185], v12 offset:57344
    ds_read_b64_tr_b16 a[186:187], v12 offset:61440
    ds_read_b64_tr_b16 a[188:189], v13 offset:57344
    ds_read_b64_tr_b16 a[190:191], v13 offset:61440
    s_waitcnt lgkmcnt(0)
    s_barrier
    s_waitcnt vmcnt(8)
    s_barrier
    ds_read_b64_tr_b16 a[192:193], v14 offset:0
    ds_read_b64_tr_b16 a[194:195], v14 offset:4096
    ds_read_b64_tr_b16 a[196:197], v15 offset:0
    ds_read_b64_tr_b16 a[198:199], v15 offset:4096
    ds_read_b64_tr_b16 a[200:201], v14 offset:8192
    ds_read_b64_tr_b16 a[202:203], v14 offset:12288
    ds_read_b64_tr_b16 a[204:205], v15 offset:8192
    ds_read_b64_tr_b16 a[206:207], v15 offset:12288
    ds_read_b64_tr_b16 a[208:209], v14 offset:16384
    ds_read_b64_tr_b16 a[210:211], v14 offset:20480
    ds_read_b64_tr_b16 a[212:213], v15 offset:16384
    ds_read_b64_tr_b16 a[214:215], v15 offset:20480
    ds_read_b64_tr_b16 a[216:217], v14 offset:24576
    ds_read_b64_tr_b16 a[218:219], v14 offset:28672
    ds_read_b64_tr_b16 a[220:221], v15 offset:24576
    ds_read_b64_tr_b16 a[222:223], v15 offset:28672
    s_waitcnt lgkmcnt(0)
    s_barrier
    s_waitcnt vmcnt(0)
    s_barrier
    ds_read_b64_tr_b16 a[224:225], v14 offset:32768
    ds_read_b64_tr_b16 a[226:227], v14 offset:36864
    ds_read_b64_tr_b16 a[228:229], v15 offset:32768
    ds_read_b64_tr_b16 a[230:231], v15 offset:36864
    ds_read_b64_tr_b16 a[232:233], v14 offset:40960
    ds_read_b64_tr_b16 a[234:235], v14 offset:45056
    ds_read_b64_tr_b16 a[236:237], v15 offset:40960
    ds_read_b64_tr_b16 a[238:239], v15 offset:45056
    ds_read_b64_tr_b16 a[240:241], v14 offset:49152
    ds_read_b64_tr_b16 a[242:243], v14 offset:53248
    ds_read_b64_tr_b16 a[244:245], v15 offset:49152
    ds_read_b64_tr_b16 a[246:247], v15 offset:53248
    ds_read_b64_tr_b16 a[248:249], v14 offset:57344
    ds_read_b64_tr_b16 a[250:251], v14 offset:61440
    ds_read_b64_tr_b16 a[252:253], v15 offset:57344
    ds_read_b64_tr_b16 a[254:255], v15 offset:61440
    s_waitcnt lgkmcnt(0)
    s_barrier
    v_lshlrev_b32 v21, 4, v1
    s_lshr_b32 s4, s91, 1
    s_lshl_b32 s5, s4, 12
    v_add_u32 v17, s5, v21
    v_xor_b32 v18, 0x1000, v17
    s_lshl_b32 s4, s4, 4
    v_add_u32 v4, s4, v2
    s_lshl_b32 s5, s30, 5
    s_lshl_b32 s6, s24, 3
    s_add_u32 s5, s5, s6
    s_and_b32 s6, s91, 1
    s_lshl_b32 s6, s6, 2
    s_add_u32 s5, s5, s6
    v_add_u32 v5, s5, v3
    v_lshlrev_b32 v6, 3, v5
    v_lshl_add_u32 v22, v4, 11, v6
    v_lshlrev_b32 v6, 14, v5
    v_lshl_add_u32 v23, v4, 2, v6
    v_lshlrev_b32 v16, 2, v4
    v_and_b32 v4, 7, v1
    v_lshlrev_b32 v19, 8, v4
    s_lshl_b32 s33, s91, 11
    s_add_u32 s33, s33, 92299264
    s_lshl_b32 s35, s24, 14
    s_lshl_b32 s36, s91, 16
    s_add_u32 s36, s36, s35
    s_add_u32 s36, s36, 50331648
    s_mov_b32 s37, 0
    s_mov_b32 s38, 0
    s_mov_b32 s39, 0
    v_lshlrev_b32 v6, 11, v1

    v_mov_b32 v5, 0
    s_mov_b32 s62, 0
    s_mov_b32 s5, 32
.wc_370:
    buffer_load_dword v4, v5, s[20:23], s5 offen sc1
    s_waitcnt vmcnt(0)
    v_readfirstlane_b32 s4, v4
    s_lshr_b32 s4, s4, 0
    s_and_b32 s4, s4, 0xffff
    s_cmp_ge_u32 s4, 256
    s_cbranch_scc1 .wcd_371
    s_sleep 6
    s_add_u32 s62, s62, 1
    s_cmp_gt_u32 s62, 0x400000
    s_cbranch_scc1 .mg_end_1
    s_branch .wc_370

.wcd_371:
    s_mov_b32 s62, 0
    s_mov_b64 exec, 15
.wf_372:
    buffer_load_dword v4, v6, s[8:11], s57 offen sc1
    s_waitcnt vmcnt(0)
    v_cmp_gt_u32 vcc, 64, v4
    s_cbranch_vccz .wfd_373
    s_sleep 2
    s_add_u32 s62, s62, 1
    s_cmp_gt_u32 s62, 0x400000
    s_cbranch_scc1 .mg_end_1
    s_branch .wf_372

.wfd_373:
    s_mov_b64 exec, -1
    v_mov_b32 v5, 0
    s_mov_b32 s62, 0
    s_mov_b32 s5, 44
.wc_374:
    buffer_load_dword v4, v5, s[20:23], s5 offen sc1
    s_waitcnt vmcnt(0)
    v_readfirstlane_b32 s4, v4
    s_lshr_b32 s4, s4, 0
    s_and_b32 s4, s4, 0xffff
    s_cmp_ge_u32 s4, 32
    s_cbranch_scc1 .wcd_375
    s_sleep 6
    s_add_u32 s62, s62, 1
    s_cmp_gt_u32 s62, 0x400000
    s_cbranch_scc1 .mg_end_1
    s_branch .wc_374

.wcd_375:
.g2blk_376:
    s_mov_b32 s62, 0
.g2bw_385:
    buffer_load_dword v20, v19, s[8:11], s33 offen sc1
    s_waitcnt vmcnt(0)
    s_and_b32 s4, s31, 3
    s_lshl_b32 s4, s4, 1
    s_add_u32 s5, s4, 1
    v_readlane_b32 s4, v20, s4
    v_readlane_b32 s5, v20, s5
    s_lshr_b32 s6, s31, 2
    s_min_u32 s4, s4, s5
    s_cmp_gt_u32 s4, s6

    s_cbranch_scc1 .g2rd_386
    s_sleep 1
    s_add_u32 s62, s62, 1
    s_cmp_gt_u32 s62, 0x400000
    s_cbranch_scc1 .mg_end_1
    s_branch .g2bw_385

.g2rd_386:
    s_lshl_b32 s48, s31, 18
    s_add_u32 s48, s48, s36
    s_add_u32 s49, s39, s35
    s_xor_b32 s39, s39, 0x10000

    s_add_u32 m0, s49, 0
    s_add_u32 s50, s48, 0
    buffer_load_dwordx4 v21, s[8:11], s50 offen offset:0 lds
    buffer_load_dwordx4 v21, s[8:11], s50 offen offset:1024 lds
    buffer_load_dwordx4 v21, s[8:11], s50 offen offset:2048 lds
    buffer_load_dwordx4 v21, s[8:11], s50 offen offset:3072 lds
    s_add_u32 m0, s49, 4096
    s_add_u32 s50, s48, 4096
    buffer_load_dwordx4 v21, s[8:11], s50 offen offset:0 lds
    buffer_load_dwordx4 v21, s[8:11], s50 offen offset:1024 lds
    buffer_load_dwordx4 v21, s[8:11], s50 offen offset:2048 lds
    buffer_load_dwordx4 v21, s[8:11], s50 offen offset:3072 lds
    s_add_u32 m0, s49, 8192
    s_add_u32 s50, s48, 8192
    buffer_load_dwordx4 v21, s[8:11], s50 offen offset:0 lds
    buffer_load_dwordx4 v21, s[8:11], s50 offen offset:1024 lds
    buffer_load_dwordx4 v21, s[8:11], s50 offen offset:2048 lds
    buffer_load_dwordx4 v21, s[8:11], s50 offen offset:3072 lds
    s_add_u32 m0, s49, 12288
    s_add_u32 s50, s48, 12288
    buffer_load_dwordx4 v21, s[8:11], s50 offen offset:0 lds
    buffer_load_dwordx4 v21, s[8:11], s50 offen offset:1024 lds
    buffer_load_dwordx4 v21, s[8:11], s50 offen offset:2048 lds
    buffer_load_dwordx4 v21, s[8:11], s50 offen offset:3072 lds
    s_waitcnt vmcnt(0)
.g2go_377:
    s_barrier
    ds_read_b128 v[32:35], v17 offset:0
    ds_read_b128 v[36:39], v18 offset:0
    ds_read_b128 v[40:43], v17 offset:1024
    ds_read_b128 v[44:47], v18 offset:1024
    ds_read_b128 v[48:51], v17 offset:2048
    ds_read_b128 v[52:55], v18 offset:2048
    s_add_u32 s53, s31, 3
    s_cmp_eq_u32 s38, 0
    s_cbranch_scc1 .g2np_379
    s_sub_u32 s54, s31, 3
    s_sub_u32 s55, s37, 0x10000
    s_add_u32 s51, s34, s55
    s_lshl_b32 s52, s54, 16
    s_lshl_b32 s5, s54, 7
    s_add_u32 s4, s5, 117440512
    s_add_u32 s6, s5, 117448704
    s_add_u32 s5, s5, 121634816
    buffer_load_dwordx2 v[96:97], v22, s[16:19], s52 offen
    buffer_load_dword v98, v23, s[8:11], s4 offen
    buffer_load_dword v99, v23, s[8:11], s6 offen
    buffer_load_dword v100, v16, s[8:11], s5 offen

    buffer_load_dwordx4 v[84:87], v7, s[8:11], s51 offen sc1
    buffer_load_dwordx4 v[88:91], v8, s[8:11], s51 offen sc1
    buffer_load_dwordx4 v[92:95], v9, s[8:11], s51 offen sc1
.g2np_379:
    s_and_b32 s4, s53, 3
    s_lshl_b32 s4, s4, 1
    s_add_u32 s5, s4, 1
    v_readlane_b32 s4, v20, s4
    v_readlane_b32 s5, v20, s5
    s_lshr_b32 s6, s53, 2
    s_min_u32 s4, s4, s5
    s_cmp_gt_u32 s4, s6

    s_cselect_b32 s56, 1, 0
    s_cmp_lt_u32 s53, 64
    s_cselect_b32 s56, s56, 0
    buffer_load_dword v20, v19, s[8:11], s33 offen sc1
    s_cmp_eq_u32 s56, 0
    s_cbranch_scc1 .g2nd_380
    s_lshl_b32 s48, s53, 18
    s_add_u32 s48, s48, s36
    s_add_u32 s49, s39, s35
    s_xor_b32 s39, s39, 0x10000

    s_waitcnt lgkmcnt(4)
    v_mfma_f32_16x16x32_bf16 v[64:67], a[0:3], v[32:35], 0
    ds_read_b128 v[56:59], v17 offset:3072
    s_add_u32 m0, s49, 0
    s_add_u32 s50, s48, 0
    v_mfma_f32_16x16x32_bf16 v[68:71], a[4:7], v[32:35], 0
    buffer_load_dwordx4 v21, s[8:11], s50 offen offset:0 lds
    v_mfma_f32_16x16x32_bf16 v[72:75], a[0:3], v[36:39], 0
    ds_read_b128 v[60:63], v18 offset:3072
    v_mfma_f32_16x16x32_bf16 v[76:79], a[4:7], v[36:39], 0
    s_waitcnt lgkmcnt(4)
    v_mfma_f32_16x16x32_bf16 v[64:67], a[8:11], v[40:43], v[64:67]
    ds_read_b128 v[32:35], v17 offset:8192
    v_mfma_f32_16x16x32_bf16 v[68:71], a[12:15], v[40:43], v[68:71]
    buffer_load_dwordx4 v21, s[8:11], s50 offen offset:1024 lds
    v_mfma_f32_16x16x32_bf16 v[72:75], a[8:11], v[44:47], v[72:75]
    ds_read_b128 v[36:39], v18 offset:8192
    v_mfma_f32_16x16x32_bf16 v[76:79], a[12:15], v[44:47], v[76:79]
    s_waitcnt lgkmcnt(4)
    v_mfma_f32_16x16x32_bf16 v[64:67], a[16:19], v[48:51], v[64:67]
    ds_read_b128 v[40:43], v17 offset:9216
    v_mfma_f32_16x16x32_bf16 v[68:71], a[20:23], v[48:51], v[68:71]
    buffer_load_dwordx4 v21, s[8:11], s50 offen offset:2048 lds
    v_mfma_f32_16x16x32_bf16 v[72:75], a[16:19], v[52:55], v[72:75]
    ds_read_b128 v[44:47], v18 offset:9216
    v_mfma_f32_16x16x32_bf16 v[76:79], a[20:23], v[52:55], v[76:79]
    s_waitcnt lgkmcnt(4)
    v_mfma_f32_16x16x32_bf16 v[64:67], a[24:27], v[56:59], v[64:67]
    ds_read_b128 v[48:51], v17 offset:10240
    v_mfma_f32_16x16x32_bf16 v[68:71], a[28:31], v[56:59], v[68:71]
    buffer_load_dwordx4 v21, s[8:11], s50 offen offset:3072 lds
    v_mfma_f32_16x16x32_bf16 v[72:75], a[24:27], v[60:63], v[72:75]
    ds_read_b128 v[52:55], v18 offset:10240
    v_mfma_f32_16x16x32_bf16 v[76:79], a[28:31], v[60:63], v[76:79]
    s_waitcnt lgkmcnt(4)
    v_mfma_f32_16x16x32_bf16 v[64:67], a[32:35], v[32:35], v[64:67]
    ds_read_b128 v[56:59], v17 offset:11264
    s_add_u32 m0, s49, 4096
    s_add_u32 s50, s48, 4096
    v_mfma_f32_16x16x32_bf16 v[68:71], a[36:39], v[32:35], v[68:71]
    buffer_load_dwordx4 v21, s[8:11], s50 offen offset:0 lds
    v_mfma_f32_16x16x32_bf16 v[72:75], a[32:35], v[36:39], v[72:75]
    ds_read_b128 v[60:63], v18 offset:11264
    v_mfma_f32_16x16x32_bf16 v[76:79], a[36:39], v[36:39], v[76:79]
    s_waitcnt lgkmcnt(4)
    v_mfma_f32_16x16x32_bf16 v[64:67], a[40:43], v[40:43], v[64:67]
    ds_read_b128 v[32:35], v17 offset:16384
    v_mfma_f32_16x16x32_bf16 v[68:71], a[44:47], v[40:43], v[68:71]
    buffer_load_dwordx4 v21, s[8:11], s50 offen offset:1024 lds
    v_mfma_f32_16x16x32_bf16 v[72:75], a[40:43], v[44:47], v[72:75]
    ds_read_b128 v[36:39], v18 offset:16384
    v_mfma_f32_16x16x32_bf16 v[76:79], a[44:47], v[44:47], v[76:79]
    s_waitcnt lgkmcnt(4)
    v_mfma_f32_16x16x32_bf16 v[64:67], a[48:51], v[48:51], v[64:67]
    ds_read_b128 v[40:43], v17 offset:17408
    v_mfma_f32_16x16x32_bf16 v[68:71], a[52:55], v[48:51], v[68:71]
    buffer_load_dwordx4 v21, s[8:11], s50 offen offset:2048 lds
    v_mfma_f32_16x16x32_bf16 v[72:75], a[48:51], v[52:55], v[72:75]
    ds_read_b128 v[44:47], v18 offset:17408
    v_mfma_f32_16x16x32_bf16 v[76:79], a[52:55], v[52:55], v[76:79]
    s_waitcnt lgkmcnt(4)
    v_mfma_f32_16x16x32_bf16 v[64:67], a[56:59], v[56:59], v[64:67]
    ds_read_b128 v[48:51], v17 offset:18432
    v_mfma_f32_16x16x32_bf16 v[68:71], a[60:63], v[56:59], v[68:71]
    buffer_load_dwordx4 v21, s[8:11], s50 offen offset:3072 lds
    v_mfma_f32_16x16x32_bf16 v[72:75], a[56:59], v[60:63], v[72:75]
    ds_read_b128 v[52:55], v18 offset:18432
    v_mfma_f32_16x16x32_bf16 v[76:79], a[60:63], v[60:63], v[76:79]
    s_waitcnt lgkmcnt(4)
    v_mfma_f32_16x16x32_bf16 v[64:67], a[64:67], v[32:35], v[64:67]
    ds_read_b128 v[56:59], v17 offset:19456
    s_add_u32 m0, s49, 8192
    s_add_u32 s50, s48, 8192
    v_mfma_f32_16x16x32_bf16 v[68:71], a[68:71], v[32:35], v[68:71]
    buffer_load_dwordx4 v21, s[8:11], s50 offen offset:0 lds
    v_mfma_f32_16x16x32_bf16 v[72:75], a[64:67], v[36:39], v[72:75]
    ds_read_b128 v[60:63], v18 offset:19456
    v_mfma_f32_16x16x32_bf16 v[76:79], a[68:71], v[36:39], v[76:79]
    s_waitcnt lgkmcnt(4)
    v_mfma_f32_16x16x32_bf16 v[64:67], a[72:75], v[40:43], v[64:67]
    ds_read_b128 v[32:35], v17 offset:24576
    v_mfma_f32_16x16x32_bf16 v[68:71], a[76:79], v[40:43], v[68:71]
    buffer_load_dwordx4 v21, s[8:11], s50 offen offset:1024 lds
    v_mfma_f32_16x16x32_bf16 v[72:75], a[72:75], v[44:47], v[72:75]
    ds_read_b128 v[36:39], v18 offset:24576
    v_mfma_f32_16x16x32_bf16 v[76:79], a[76:79], v[44:47], v[76:79]
    s_waitcnt lgkmcnt(4)
    v_mfma_f32_16x16x32_bf16 v[64:67], a[80:83], v[48:51], v[64:67]
    ds_read_b128 v[40:43], v17 offset:25600
    v_mfma_f32_16x16x32_bf16 v[68:71], a[84:87], v[48:51], v[68:71]
    buffer_load_dwordx4 v21, s[8:11], s50 offen offset:2048 lds
    v_mfma_f32_16x16x32_bf16 v[72:75], a[80:83], v[52:55], v[72:75]
    ds_read_b128 v[44:47], v18 offset:25600
    v_mfma_f32_16x16x32_bf16 v[76:79], a[84:87], v[52:55], v[76:79]
    s_waitcnt lgkmcnt(4)
    v_mfma_f32_16x16x32_bf16 v[64:67], a[88:91], v[56:59], v[64:67]
    ds_read_b128 v[48:51], v17 offset:26624
    v_mfma_f32_16x16x32_bf16 v[68:71], a[92:95], v[56:59], v[68:71]
    buffer_load_dwordx4 v21, s[8:11], s50 offen offset:3072 lds
    v_mfma_f32_16x16x32_bf16 v[72:75], a[88:91], v[60:63], v[72:75]
    ds_read_b128 v[52:55], v18 offset:26624
    v_mfma_f32_16x16x32_bf16 v[76:79], a[92:95], v[60:63], v[76:79]
    s_waitcnt lgkmcnt(4)
    v_mfma_f32_16x16x32_bf16 v[64:67], a[96:99], v[32:35], v[64:67]
    ds_read_b128 v[56:59], v17 offset:27648
    s_add_u32 m0, s49, 12288
    s_add_u32 s50, s48, 12288
    v_mfma_f32_16x16x32_bf16 v[68:71], a[100:103], v[32:35], v[68:71]
    buffer_load_dwordx4 v21, s[8:11], s50 offen offset:0 lds
    v_mfma_f32_16x16x32_bf16 v[72:75], a[96:99], v[36:39], v[72:75]
    ds_read_b128 v[60:63], v18 offset:27648
    v_mfma_f32_16x16x32_bf16 v[76:79], a[100:103], v[36:39], v[76:79]
    s_waitcnt lgkmcnt(4)
    v_mfma_f32_16x16x32_bf16 v[64:67], a[104:107], v[40:43], v[64:67]
    ds_read_b128 v[32:35], v17 offset:32768
    v_mfma_f32_16x16x32_bf16 v[68:71], a[108:111], v[40:43], v[68:71]
    buffer_load_dwordx4 v21, s[8:11], s50 offen offset:1024 lds
    v_mfma_f32_16x16x32_bf16 v[72:75], a[104:107], v[44:47], v[72:75]
    ds_read_b128 v[36:39], v18 offset:32768
    v_mfma_f32_16x16x32_bf16 v[76:79], a[108:111], v[44:47], v[76:79]
    s_waitcnt lgkmcnt(4)
    v_mfma_f32_16x16x32_bf16 v[64:67], a[112:115], v[48:51], v[64:67]
    ds_read_b128 v[40:43], v17 offset:33792
    v_mfma_f32_16x16x32_bf16 v[68:71], a[116:119], v[48:51], v[68:71]
    buffer_load_dwordx4 v21, s[8:11], s50 offen offset:2048 lds
    v_mfma_f32_16x16x32_bf16 v[72:75], a[112:115], v[52:55], v[72:75]
    ds_read_b128 v[44:47], v18 offset:33792
    v_mfma_f32_16x16x32_bf16 v[76:79], a[116:119], v[52:55], v[76:79]
    s_waitcnt lgkmcnt(4)
    v_mfma_f32_16x16x32_bf16 v[64:67], a[120:123], v[56:59], v[64:67]
    ds_read_b128 v[48:51], v17 offset:34816
    v_mfma_f32_16x16x32_bf16 v[68:71], a[124:127], v[56:59], v[68:71]
    buffer_load_dwordx4 v21, s[8:11], s50 offen offset:3072 lds
    v_mfma_f32_16x16x32_bf16 v[72:75], a[120:123], v[60:63], v[72:75]
    ds_read_b128 v[52:55], v18 offset:34816
    v_mfma_f32_16x16x32_bf16 v[76:79], a[124:127], v[60:63], v[76:79]
    s_waitcnt lgkmcnt(4)
    v_mfma_f32_16x16x32_bf16 v[64:67], a[128:131], v[32:35], v[64:67]
    ds_read_b128 v[56:59], v17 offset:35840
    v_mfma_f32_16x16x32_bf16 v[68:71], a[132:135], v[32:35], v[68:71]
    v_mfma_f32_16x16x32_bf16 v[72:75], a[128:131], v[36:39], v[72:75]
    ds_read_b128 v[60:63], v18 offset:35840
    v_mfma_f32_16x16x32_bf16 v[76:79], a[132:135], v[36:39], v[76:79]
    s_waitcnt lgkmcnt(4)
    v_mfma_f32_16x16x32_bf16 v[64:67], a[136:139], v[40:43], v[64:67]
    ds_read_b128 v[32:35], v17 offset:40960
    v_mfma_f32_16x16x32_bf16 v[68:71], a[140:143], v[40:43], v[68:71]
    v_mfma_f32_16x16x32_bf16 v[72:75], a[136:139], v[44:47], v[72:75]
    ds_read_b128 v[36:39], v18 offset:40960
    v_mfma_f32_16x16x32_bf16 v[76:79], a[140:143], v[44:47], v[76:79]
    s_waitcnt lgkmcnt(4)
    v_mfma_f32_16x16x32_bf16 v[64:67], a[144:147], v[48:51], v[64:67]
    ds_read_b128 v[40:43], v17 offset:41984
    v_mfma_f32_16x16x32_bf16 v[68:71], a[148:151], v[48:51], v[68:71]
    v_mfma_f32_16x16x32_bf16 v[72:75], a[144:147], v[52:55], v[72:75]
    ds_read_b128 v[44:47], v18 offset:41984
    v_mfma_f32_16x16x32_bf16 v[76:79], a[148:151], v[52:55], v[76:79]
    s_waitcnt lgkmcnt(4)
    v_mfma_f32_16x16x32_bf16 v[64:67], a[152:155], v[56:59], v[64:67]
    ds_read_b128 v[48:51], v17 offset:43008
    v_mfma_f32_16x16x32_bf16 v[68:71], a[156:159], v[56:59], v[68:71]
    v_mfma_f32_16x16x32_bf16 v[72:75], a[152:155], v[60:63], v[72:75]
    ds_read_b128 v[52:55], v18 offset:43008
    v_mfma_f32_16x16x32_bf16 v[76:79], a[156:159], v[60:63], v[76:79]
    s_waitcnt lgkmcnt(4)
    v_mfma_f32_16x16x32_bf16 v[64:67], a[160:163], v[32:35], v[64:67]
    ds_read_b128 v[56:59], v17 offset:44032
    v_mfma_f32_16x16x32_bf16 v[68:71], a[164:167], v[32:35], v[68:71]
    v_mfma_f32_16x16x32_bf16 v[72:75], a[160:163], v[36:39], v[72:75]
    ds_read_b128 v[60:63], v18 offset:44032
    v_mfma_f32_16x16x32_bf16 v[76:79], a[164:167], v[36:39], v[76:79]
    s_waitcnt lgkmcnt(4)
    v_mfma_f32_16x16x32_bf16 v[64:67], a[168:171], v[40:43], v[64:67]
    ds_read_b128 v[32:35], v17 offset:49152
    v_mfma_f32_16x16x32_bf16 v[68:71], a[172:175], v[40:43], v[68:71]
    v_mfma_f32_16x16x32_bf16 v[72:75], a[168:171], v[44:47], v[72:75]
    ds_read_b128 v[36:39], v18 offset:49152
    v_mfma_f32_16x16x32_bf16 v[76:79], a[172:175], v[44:47], v[76:79]
    s_waitcnt lgkmcnt(4)
    v_mfma_f32_16x16x32_bf16 v[64:67], a[176:179], v[48:51], v[64:67]
    ds_read_b128 v[40:43], v17 offset:50176
    v_mfma_f32_16x16x32_bf16 v[68:71], a[180:183], v[48:51], v[68:71]
    v_mfma_f32_16x16x32_bf16 v[72:75], a[176:179], v[52:55], v[72:75]
    ds_read_b128 v[44:47], v18 offset:50176
    v_mfma_f32_16x16x32_bf16 v[76:79], a[180:183], v[52:55], v[76:79]
    s_waitcnt lgkmcnt(4)
    v_mfma_f32_16x16x32_bf16 v[64:67], a[184:187], v[56:59], v[64:67]
    ds_read_b128 v[48:51], v17 offset:51200
    v_mfma_f32_16x16x32_bf16 v[68:71], a[188:191], v[56:59], v[68:71]
    v_mfma_f32_16x16x32_bf16 v[72:75], a[184:187], v[60:63], v[72:75]
    ds_read_b128 v[52:55], v18 offset:51200
    v_mfma_f32_16x16x32_bf16 v[76:79], a[188:191], v[60:63], v[76:79]
    s_waitcnt lgkmcnt(4)
    v_mfma_f32_16x16x32_bf16 v[64:67], a[192:195], v[32:35], v[64:67]
    ds_read_b128 v[56:59], v17 offset:52224
    v_mfma_f32_16x16x32_bf16 v[68:71], a[196:199], v[32:35], v[68:71]
    v_mfma_f32_16x16x32_bf16 v[72:75], a[192:195], v[36:39], v[72:75]
    ds_read_b128 v[60:63], v18 offset:52224
    v_mfma_f32_16x16x32_bf16 v[76:79], a[196:199], v[36:39], v[76:79]
    s_waitcnt lgkmcnt(4)
    v_mfma_f32_16x16x32_bf16 v[64:67], a[200:203], v[40:43], v[64:67]
    ds_read_b128 v[32:35], v17 offset:57344
    v_mfma_f32_16x16x32_bf16 v[68:71], a[204:207], v[40:43], v[68:71]
    v_mfma_f32_16x16x32_bf16 v[72:75], a[200:203], v[44:47], v[72:75]
    ds_read_b128 v[36:39], v18 offset:57344
    v_mfma_f32_16x16x32_bf16 v[76:79], a[204:207], v[44:47], v[76:79]
    s_waitcnt lgkmcnt(4)
    v_mfma_f32_16x16x32_bf16 v[64:67], a[208:211], v[48:51], v[64:67]
    ds_read_b128 v[40:43], v17 offset:58368
    v_mfma_f32_16x16x32_bf16 v[68:71], a[212:215], v[48:51], v[68:71]
    v_mfma_f32_16x16x32_bf16 v[72:75], a[208:211], v[52:55], v[72:75]
    ds_read_b128 v[44:47], v18 offset:58368
    v_mfma_f32_16x16x32_bf16 v[76:79], a[212:215], v[52:55], v[76:79]
    s_waitcnt lgkmcnt(4)
    v_mfma_f32_16x16x32_bf16 v[64:67], a[216:219], v[56:59], v[64:67]
    ds_read_b128 v[48:51], v17 offset:59392
    v_mfma_f32_16x16x32_bf16 v[68:71], a[220:223], v[56:59], v[68:71]
    v_mfma_f32_16x16x32_bf16 v[72:75], a[216:219], v[60:63], v[72:75]
    ds_read_b128 v[52:55], v18 offset:59392
    v_mfma_f32_16x16x32_bf16 v[76:79], a[220:223], v[60:63], v[76:79]
    s_waitcnt lgkmcnt(4)
    v_mfma_f32_16x16x32_bf16 v[64:67], a[224:227], v[32:35], v[64:67]
    ds_read_b128 v[56:59], v17 offset:60416
    v_mfma_f32_16x16x32_bf16 v[68:71], a[228:231], v[32:35], v[68:71]
    v_mfma_f32_16x16x32_bf16 v[72:75], a[224:227], v[36:39], v[72:75]
    ds_read_b128 v[60:63], v18 offset:60416
    v_mfma_f32_16x16x32_bf16 v[76:79], a[228:231], v[36:39], v[76:79]
    s_waitcnt lgkmcnt(4)
    v_mfma_f32_16x16x32_bf16 v[64:67], a[232:235], v[40:43], v[64:67]
    v_mfma_f32_16x16x32_bf16 v[68:71], a[236:239], v[40:43], v[68:71]
    v_mfma_f32_16x16x32_bf16 v[72:75], a[232:235], v[44:47], v[72:75]
    v_mfma_f32_16x16x32_bf16 v[76:79], a[236:239], v[44:47], v[76:79]
    s_waitcnt lgkmcnt(2)
    v_mfma_f32_16x16x32_bf16 v[64:67], a[240:243], v[48:51], v[64:67]
    v_mfma_f32_16x16x32_bf16 v[68:71], a[244:247], v[48:51], v[68:71]
    v_mfma_f32_16x16x32_bf16 v[72:75], a[240:243], v[52:55], v[72:75]
    v_mfma_f32_16x16x32_bf16 v[76:79], a[244:247], v[52:55], v[76:79]
    s_waitcnt lgkmcnt(0)
    v_mfma_f32_16x16x32_bf16 v[64:67], a[248:251], v[56:59], v[64:67]
    v_mfma_f32_16x16x32_bf16 v[68:71], a[252:255], v[56:59], v[68:71]
    v_mfma_f32_16x16x32_bf16 v[72:75], a[248:251], v[60:63], v[72:75]
    v_mfma_f32_16x16x32_bf16 v[76:79], a[252:255], v[60:63], v[76:79]
    v_xor_b32 v17, 0x10000, v17
    v_xor_b32 v18, 0x10000, v18
    s_add_u32 s4, s34, s37
    s_waitcnt vmcnt(16)

    s_branch .g2st_381
.g2nd_380:
    s_waitcnt lgkmcnt(4)
    v_mfma_f32_16x16x32_bf16 v[64:67], a[0:3], v[32:35], 0
    ds_read_b128 v[56:59], v17 offset:3072
    v_mfma_f32_16x16x32_bf16 v[68:71], a[4:7], v[32:35], 0
    v_mfma_f32_16x16x32_bf16 v[72:75], a[0:3], v[36:39], 0
    ds_read_b128 v[60:63], v18 offset:3072
    v_mfma_f32_16x16x32_bf16 v[76:79], a[4:7], v[36:39], 0
    s_waitcnt lgkmcnt(4)
    v_mfma_f32_16x16x32_bf16 v[64:67], a[8:11], v[40:43], v[64:67]
    ds_read_b128 v[32:35], v17 offset:8192
    v_mfma_f32_16x16x32_bf16 v[68:71], a[12:15], v[40:43], v[68:71]
    v_mfma_f32_16x16x32_bf16 v[72:75], a[8:11], v[44:47], v[72:75]
    ds_read_b128 v[36:39], v18 offset:8192
    v_mfma_f32_16x16x32_bf16 v[76:79], a[12:15], v[44:47], v[76:79]
    s_waitcnt lgkmcnt(4)
    v_mfma_f32_16x16x32_bf16 v[64:67], a[16:19], v[48:51], v[64:67]
    ds_read_b128 v[40:43], v17 offset:9216
    v_mfma_f32_16x16x32_bf16 v[68:71], a[20:23], v[48:51], v[68:71]
    v_mfma_f32_16x16x32_bf16 v[72:75], a[16:19], v[52:55], v[72:75]
    ds_read_b128 v[44:47], v18 offset:9216
    v_mfma_f32_16x16x32_bf16 v[76:79], a[20:23], v[52:55], v[76:79]
    s_waitcnt lgkmcnt(4)
    v_mfma_f32_16x16x32_bf16 v[64:67], a[24:27], v[56:59], v[64:67]
    ds_read_b128 v[48:51], v17 offset:10240
    v_mfma_f32_16x16x32_bf16 v[68:71], a[28:31], v[56:59], v[68:71]
    v_mfma_f32_16x16x32_bf16 v[72:75], a[24:27], v[60:63], v[72:75]
    ds_read_b128 v[52:55], v18 offset:10240
    v_mfma_f32_16x16x32_bf16 v[76:79], a[28:31], v[60:63], v[76:79]
    s_waitcnt lgkmcnt(4)
    v_mfma_f32_16x16x32_bf16 v[64:67], a[32:35], v[32:35], v[64:67]
    ds_read_b128 v[56:59], v17 offset:11264
    v_mfma_f32_16x16x32_bf16 v[68:71], a[36:39], v[32:35], v[68:71]
    v_mfma_f32_16x16x32_bf16 v[72:75], a[32:35], v[36:39], v[72:75]
    ds_read_b128 v[60:63], v18 offset:11264
    v_mfma_f32_16x16x32_bf16 v[76:79], a[36:39], v[36:39], v[76:79]
    s_waitcnt lgkmcnt(4)
    v_mfma_f32_16x16x32_bf16 v[64:67], a[40:43], v[40:43], v[64:67]
    ds_read_b128 v[32:35], v17 offset:16384
    v_mfma_f32_16x16x32_bf16 v[68:71], a[44:47], v[40:43], v[68:71]
    v_mfma_f32_16x16x32_bf16 v[72:75], a[40:43], v[44:47], v[72:75]
    ds_read_b128 v[36:39], v18 offset:16384
    v_mfma_f32_16x16x32_bf16 v[76:79], a[44:47], v[44:47], v[76:79]
    s_waitcnt lgkmcnt(4)
    v_mfma_f32_16x16x32_bf16 v[64:67], a[48:51], v[48:51], v[64:67]
    ds_read_b128 v[40:43], v17 offset:17408
    v_mfma_f32_16x16x32_bf16 v[68:71], a[52:55], v[48:51], v[68:71]
    v_mfma_f32_16x16x32_bf16 v[72:75], a[48:51], v[52:55], v[72:75]
    ds_read_b128 v[44:47], v18 offset:17408
    v_mfma_f32_16x16x32_bf16 v[76:79], a[52:55], v[52:55], v[76:79]
    s_waitcnt lgkmcnt(4)
    v_mfma_f32_16x16x32_bf16 v[64:67], a[56:59], v[56:59], v[64:67]
    ds_read_b128 v[48:51], v17 offset:18432
    v_mfma_f32_16x16x32_bf16 v[68:71], a[60:63], v[56:59], v[68:71]
    v_mfma_f32_16x16x32_bf16 v[72:75], a[56:59], v[60:63], v[72:75]
    ds_read_b128 v[52:55], v18 offset:18432
    v_mfma_f32_16x16x32_bf16 v[76:79], a[60:63], v[60:63], v[76:79]
    s_waitcnt lgkmcnt(4)
    v_mfma_f32_16x16x32_bf16 v[64:67], a[64:67], v[32:35], v[64:67]
    ds_read_b128 v[56:59], v17 offset:19456
    v_mfma_f32_16x16x32_bf16 v[68:71], a[68:71], v[32:35], v[68:71]
    v_mfma_f32_16x16x32_bf16 v[72:75], a[64:67], v[36:39], v[72:75]
    ds_read_b128 v[60:63], v18 offset:19456
    v_mfma_f32_16x16x32_bf16 v[76:79], a[68:71], v[36:39], v[76:79]
    s_waitcnt lgkmcnt(4)
    v_mfma_f32_16x16x32_bf16 v[64:67], a[72:75], v[40:43], v[64:67]
    ds_read_b128 v[32:35], v17 offset:24576
    v_mfma_f32_16x16x32_bf16 v[68:71], a[76:79], v[40:43], v[68:71]
    v_mfma_f32_16x16x32_bf16 v[72:75], a[72:75], v[44:47], v[72:75]
    ds_read_b128 v[36:39], v18 offset:24576
    v_mfma_f32_16x16x32_bf16 v[76:79], a[76:79], v[44:47], v[76:79]
    s_waitcnt lgkmcnt(4)
    v_mfma_f32_16x16x32_bf16 v[64:67], a[80:83], v[48:51], v[64:67]
    ds_read_b128 v[40:43], v17 offset:25600
    v_mfma_f32_16x16x32_bf16 v[68:71], a[84:87], v[48:51], v[68:71]
    v_mfma_f32_16x16x32_bf16 v[72:75], a[80:83], v[52:55], v[72:75]
    ds_read_b128 v[44:47], v18 offset:25600
    v_mfma_f32_16x16x32_bf16 v[76:79], a[84:87], v[52:55], v[76:79]
    s_waitcnt lgkmcnt(4)
    v_mfma_f32_16x16x32_bf16 v[64:67], a[88:91], v[56:59], v[64:67]
    ds_read_b128 v[48:51], v17 offset:26624
    v_mfma_f32_16x16x32_bf16 v[68:71], a[92:95], v[56:59], v[68:71]
    v_mfma_f32_16x16x32_bf16 v[72:75], a[88:91], v[60:63], v[72:75]
    ds_read_b128 v[52:55], v18 offset:26624
    v_mfma_f32_16x16x32_bf16 v[76:79], a[92:95], v[60:63], v[76:79]
    s_waitcnt lgkmcnt(4)
    v_mfma_f32_16x16x32_bf16 v[64:67], a[96:99], v[32:35], v[64:67]
    ds_read_b128 v[56:59], v17 offset:27648
    v_mfma_f32_16x16x32_bf16 v[68:71], a[100:103], v[32:35], v[68:71]
    v_mfma_f32_16x16x32_bf16 v[72:75], a[96:99], v[36:39], v[72:75]
    ds_read_b128 v[60:63], v18 offset:27648
    v_mfma_f32_16x16x32_bf16 v[76:79], a[100:103], v[36:39], v[76:79]
    s_waitcnt lgkmcnt(4)
    v_mfma_f32_16x16x32_bf16 v[64:67], a[104:107], v[40:43], v[64:67]
    ds_read_b128 v[32:35], v17 offset:32768
    v_mfma_f32_16x16x32_bf16 v[68:71], a[108:111], v[40:43], v[68:71]
    v_mfma_f32_16x16x32_bf16 v[72:75], a[104:107], v[44:47], v[72:75]
    ds_read_b128 v[36:39], v18 offset:32768
    v_mfma_f32_16x16x32_bf16 v[76:79], a[108:111], v[44:47], v[76:79]
    s_waitcnt lgkmcnt(4)
    v_mfma_f32_16x16x32_bf16 v[64:67], a[112:115], v[48:51], v[64:67]
    ds_read_b128 v[40:43], v17 offset:33792
    v_mfma_f32_16x16x32_bf16 v[68:71], a[116:119], v[48:51], v[68:71]
    v_mfma_f32_16x16x32_bf16 v[72:75], a[112:115], v[52:55], v[72:75]
    ds_read_b128 v[44:47], v18 offset:33792
    v_mfma_f32_16x16x32_bf16 v[76:79], a[116:119], v[52:55], v[76:79]
    s_waitcnt lgkmcnt(4)
    v_mfma_f32_16x16x32_bf16 v[64:67], a[120:123], v[56:59], v[64:67]
    ds_read_b128 v[48:51], v17 offset:34816
    v_mfma_f32_16x16x32_bf16 v[68:71], a[124:127], v[56:59], v[68:71]
    v_mfma_f32_16x16x32_bf16 v[72:75], a[120:123], v[60:63], v[72:75]
    ds_read_b128 v[52:55], v18 offset:34816
    v_mfma_f32_16x16x32_bf16 v[76:79], a[124:127], v[60:63], v[76:79]
    s_waitcnt lgkmcnt(4)
    v_mfma_f32_16x16x32_bf16 v[64:67], a[128:131], v[32:35], v[64:67]
    ds_read_b128 v[56:59], v17 offset:35840
    v_mfma_f32_16x16x32_bf16 v[68:71], a[132:135], v[32:35], v[68:71]
    v_mfma_f32_16x16x32_bf16 v[72:75], a[128:131], v[36:39], v[72:75]
    ds_read_b128 v[60:63], v18 offset:35840
    v_mfma_f32_16x16x32_bf16 v[76:79], a[132:135], v[36:39], v[76:79]
    s_waitcnt lgkmcnt(4)
    v_mfma_f32_16x16x32_bf16 v[64:67], a[136:139], v[40:43], v[64:67]
    ds_read_b128 v[32:35], v17 offset:40960
    v_mfma_f32_16x16x32_bf16 v[68:71], a[140:143], v[40:43], v[68:71]
    v_mfma_f32_16x16x32_bf16 v[72:75], a[136:139], v[44:47], v[72:75]
    ds_read_b128 v[36:39], v18 offset:40960
    v_mfma_f32_16x16x32_bf16 v[76:79], a[140:143], v[44:47], v[76:79]
    s_waitcnt lgkmcnt(4)
    v_mfma_f32_16x16x32_bf16 v[64:67], a[144:147], v[48:51], v[64:67]
    ds_read_b128 v[40:43], v17 offset:41984
    v_mfma_f32_16x16x32_bf16 v[68:71], a[148:151], v[48:51], v[68:71]
    v_mfma_f32_16x16x32_bf16 v[72:75], a[144:147], v[52:55], v[72:75]
    ds_read_b128 v[44:47], v18 offset:41984
    v_mfma_f32_16x16x32_bf16 v[76:79], a[148:151], v[52:55], v[76:79]
    s_waitcnt lgkmcnt(4)
    v_mfma_f32_16x16x32_bf16 v[64:67], a[152:155], v[56:59], v[64:67]
    ds_read_b128 v[48:51], v17 offset:43008
    v_mfma_f32_16x16x32_bf16 v[68:71], a[156:159], v[56:59], v[68:71]
    v_mfma_f32_16x16x32_bf16 v[72:75], a[152:155], v[60:63], v[72:75]
    ds_read_b128 v[52:55], v18 offset:43008
    v_mfma_f32_16x16x32_bf16 v[76:79], a[156:159], v[60:63], v[76:79]
    s_waitcnt lgkmcnt(4)
    v_mfma_f32_16x16x32_bf16 v[64:67], a[160:163], v[32:35], v[64:67]
    ds_read_b128 v[56:59], v17 offset:44032
    v_mfma_f32_16x16x32_bf16 v[68:71], a[164:167], v[32:35], v[68:71]
    v_mfma_f32_16x16x32_bf16 v[72:75], a[160:163], v[36:39], v[72:75]
    ds_read_b128 v[60:63], v18 offset:44032
    v_mfma_f32_16x16x32_bf16 v[76:79], a[164:167], v[36:39], v[76:79]
    s_waitcnt lgkmcnt(4)
    v_mfma_f32_16x16x32_bf16 v[64:67], a[168:171], v[40:43], v[64:67]
    ds_read_b128 v[32:35], v17 offset:49152
    v_mfma_f32_16x16x32_bf16 v[68:71], a[172:175], v[40:43], v[68:71]
    v_mfma_f32_16x16x32_bf16 v[72:75], a[168:171], v[44:47], v[72:75]
    ds_read_b128 v[36:39], v18 offset:49152
    v_mfma_f32_16x16x32_bf16 v[76:79], a[172:175], v[44:47], v[76:79]
    s_waitcnt lgkmcnt(4)
    v_mfma_f32_16x16x32_bf16 v[64:67], a[176:179], v[48:51], v[64:67]
    ds_read_b128 v[40:43], v17 offset:50176
    v_mfma_f32_16x16x32_bf16 v[68:71], a[180:183], v[48:51], v[68:71]
    v_mfma_f32_16x16x32_bf16 v[72:75], a[176:179], v[52:55], v[72:75]
    ds_read_b128 v[44:47], v18 offset:50176
    v_mfma_f32_16x16x32_bf16 v[76:79], a[180:183], v[52:55], v[76:79]
    s_waitcnt lgkmcnt(4)
    v_mfma_f32_16x16x32_bf16 v[64:67], a[184:187], v[56:59], v[64:67]
    ds_read_b128 v[48:51], v17 offset:51200
    v_mfma_f32_16x16x32_bf16 v[68:71], a[188:191], v[56:59], v[68:71]
    v_mfma_f32_16x16x32_bf16 v[72:75], a[184:187], v[60:63], v[72:75]
    ds_read_b128 v[52:55], v18 offset:51200
    v_mfma_f32_16x16x32_bf16 v[76:79], a[188:191], v[60:63], v[76:79]
    s_waitcnt lgkmcnt(4)
    v_mfma_f32_16x16x32_bf16 v[64:67], a[192:195], v[32:35], v[64:67]
    ds_read_b128 v[56:59], v17 offset:52224
    v_mfma_f32_16x16x32_bf16 v[68:71], a[196:199], v[32:35], v[68:71]
    v_mfma_f32_16x16x32_bf16 v[72:75], a[192:195], v[36:39], v[72:75]
    ds_read_b128 v[60:63], v18 offset:52224
    v_mfma_f32_16x16x32_bf16 v[76:79], a[196:199], v[36:39], v[76:79]
    s_waitcnt lgkmcnt(4)
    v_mfma_f32_16x16x32_bf16 v[64:67], a[200:203], v[40:43], v[64:67]
    ds_read_b128 v[32:35], v17 offset:57344
    v_mfma_f32_16x16x32_bf16 v[68:71], a[204:207], v[40:43], v[68:71]
    v_mfma_f32_16x16x32_bf16 v[72:75], a[200:203], v[44:47], v[72:75]
    ds_read_b128 v[36:39], v18 offset:57344
    v_mfma_f32_16x16x32_bf16 v[76:79], a[204:207], v[44:47], v[76:79]
    s_waitcnt lgkmcnt(4)
    v_mfma_f32_16x16x32_bf16 v[64:67], a[208:211], v[48:51], v[64:67]
    ds_read_b128 v[40:43], v17 offset:58368
    v_mfma_f32_16x16x32_bf16 v[68:71], a[212:215], v[48:51], v[68:71]
    v_mfma_f32_16x16x32_bf16 v[72:75], a[208:211], v[52:55], v[72:75]
    ds_read_b128 v[44:47], v18 offset:58368
    v_mfma_f32_16x16x32_bf16 v[76:79], a[212:215], v[52:55], v[76:79]
    s_waitcnt lgkmcnt(4)
    v_mfma_f32_16x16x32_bf16 v[64:67], a[216:219], v[56:59], v[64:67]
    ds_read_b128 v[48:51], v17 offset:59392
    v_mfma_f32_16x16x32_bf16 v[68:71], a[220:223], v[56:59], v[68:71]
    v_mfma_f32_16x16x32_bf16 v[72:75], a[216:219], v[60:63], v[72:75]
    ds_read_b128 v[52:55], v18 offset:59392
    v_mfma_f32_16x16x32_bf16 v[76:79], a[220:223], v[60:63], v[76:79]
    s_waitcnt lgkmcnt(4)
    v_mfma_f32_16x16x32_bf16 v[64:67], a[224:227], v[32:35], v[64:67]
    ds_read_b128 v[56:59], v17 offset:60416
    v_mfma_f32_16x16x32_bf16 v[68:71], a[228:231], v[32:35], v[68:71]
    v_mfma_f32_16x16x32_bf16 v[72:75], a[224:227], v[36:39], v[72:75]
    ds_read_b128 v[60:63], v18 offset:60416
    v_mfma_f32_16x16x32_bf16 v[76:79], a[228:231], v[36:39], v[76:79]
    s_waitcnt lgkmcnt(4)
    v_mfma_f32_16x16x32_bf16 v[64:67], a[232:235], v[40:43], v[64:67]
    v_mfma_f32_16x16x32_bf16 v[68:71], a[236:239], v[40:43], v[68:71]
    v_mfma_f32_16x16x32_bf16 v[72:75], a[232:235], v[44:47], v[72:75]
    v_mfma_f32_16x16x32_bf16 v[76:79], a[236:239], v[44:47], v[76:79]
    s_waitcnt lgkmcnt(2)
    v_mfma_f32_16x16x32_bf16 v[64:67], a[240:243], v[48:51], v[64:67]
    v_mfma_f32_16x16x32_bf16 v[68:71], a[244:247], v[48:51], v[68:71]
    v_mfma_f32_16x16x32_bf16 v[72:75], a[240:243], v[52:55], v[72:75]
    v_mfma_f32_16x16x32_bf16 v[76:79], a[244:247], v[52:55], v[76:79]
    s_waitcnt lgkmcnt(0)
    v_mfma_f32_16x16x32_bf16 v[64:67], a[248:251], v[56:59], v[64:67]
    v_mfma_f32_16x16x32_bf16 v[68:71], a[252:255], v[56:59], v[68:71]
    v_mfma_f32_16x16x32_bf16 v[72:75], a[248:251], v[60:63], v[72:75]
    v_mfma_f32_16x16x32_bf16 v[76:79], a[252:255], v[60:63], v[76:79]
    v_xor_b32 v17, 0x10000, v17
    v_xor_b32 v18, 0x10000, v18
    s_add_u32 s4, s34, s37
    s_waitcnt vmcnt(0)

.g2st_381:
    s_nop 2
    v_min_u32 v68, 0xfffffffe, v68
    buffer_store_dwordx4 v[68:71], v28, s[8:11], s4 offen sc1
    v_min_u32 v72, 0xfffffffe, v72
    buffer_store_dwordx4 v[72:75], v29, s[8:11], s4 offen sc1
    v_min_u32 v76, 0xfffffffe, v76
    buffer_store_dwordx4 v[76:79], v30, s[8:11], s4 offen sc1
    s_cmp_eq_u32 s38, 0
    s_cbranch_scc1 .g2nc_382
    s_mov_b32 s62, 0
.cc_387:
    v_max3_u32 v4, v84, v88, v92
    v_cmp_eq_u32 vcc, -1, v4
    s_cbranch_vccz .cd_388

    buffer_load_dwordx4 v[84:87], v7, s[8:11], s51 offen sc1
    buffer_load_dwordx4 v[88:91], v8, s[8:11], s51 offen sc1
    buffer_load_dwordx4 v[92:95], v9, s[8:11], s51 offen sc1
    s_add_u32 s62, s62, 1
    s_cmp_gt_u32 s62, 0x400000
    s_cbranch_scc1 .mg_end_1
    s_waitcnt vmcnt(0)
    s_branch .cc_387

.cd_388:
    v_add_f32 v84, v84, v88
    v_add_f32 v80, v80, v92
    v_add_f32 v85, v85, v89
    v_add_f32 v81, v81, v93
    v_add_f32 v86, v86, v90
    v_add_f32 v82, v82, v94
    v_add_f32 v87, v87, v91
    v_add_f32 v83, v83, v95
    v_add_f32 v80, v80, v84
    v_add_f32 v81, v81, v85
    v_add_f32 v82, v82, v86
    v_add_f32 v83, v83, v87
    v_sub_f32 v104, 1.0, v100
    v_cvt_pk_bf16_f32 v104, v104, v104
    v_lshlrev_b32 v104, 16, v104

    v_cvt_pk_bf16_f32 v105, v80, v81
    v_lshlrev_b32 v107, 16, v96
    v_and_b32 v108, 0xffff0000, v96
    v_lshlrev_b32 v109, 16, v98
    v_and_b32 v110, 0xffff0000, v98
    v_and_b32 v106, 0xffff0000, v105
    v_lshlrev_b32 v105, 16, v105
    v_mul_f32 v107, v107, v109
    v_mul_f32 v108, v108, v110
    v_mul_f32 v105, v104, v105
    v_mul_f32 v106, v104, v106
    v_cvt_pk_bf16_f32 v107, v107, v108
    v_cvt_pk_bf16_f32 v105, v105, v106
    v_and_b32 v108, 0xffff0000, v107
    v_lshlrev_b32 v107, 16, v107
    v_and_b32 v106, 0xffff0000, v105
    v_lshlrev_b32 v105, 16, v105
    v_mul_f32 v107, v100, v107
    v_mul_f32 v108, v100, v108
    v_cvt_pk_bf16_f32 v107, v107, v108
    v_and_b32 v108, 0xffff0000, v107
    v_lshlrev_b32 v107, 16, v107
    v_add_f32 v105, v105, v107
    v_add_f32 v106, v106, v108
    v_cvt_pk_bf16_f32 v102, v105, v106

    v_cvt_pk_bf16_f32 v105, v82, v83
    v_lshlrev_b32 v107, 16, v97
    v_and_b32 v108, 0xffff0000, v97
    v_lshlrev_b32 v109, 16, v99
    v_and_b32 v110, 0xffff0000, v99
    v_and_b32 v106, 0xffff0000, v105
    v_lshlrev_b32 v105, 16, v105
    v_mul_f32 v107, v107, v109
    v_mul_f32 v108, v108, v110
    v_mul_f32 v105, v104, v105
    v_mul_f32 v106, v104, v106
    v_cvt_pk_bf16_f32 v107, v107, v108
    v_cvt_pk_bf16_f32 v105, v105, v106
    v_and_b32 v108, 0xffff0000, v107
    v_lshlrev_b32 v107, 16, v107
    v_and_b32 v106, 0xffff0000, v105
    v_lshlrev_b32 v105, 16, v105
    v_mul_f32 v107, v100, v107
    v_mul_f32 v108, v100, v108
    v_cvt_pk_bf16_f32 v107, v107, v108
    v_and_b32 v108, 0xffff0000, v107
    v_lshlrev_b32 v107, 16, v107
    v_add_f32 v105, v105, v107
    v_add_f32 v106, v106, v108
    v_cvt_pk_bf16_f32 v103, v105, v106

    buffer_store_dwordx2 v[102:103], v22, s[44:47], s52 offen
.g2nc_382:
    v_mov_b32 v80, v64
    v_mov_b32 v81, v65
    v_mov_b32 v82, v66
    v_mov_b32 v83, v67
    s_cmp_lg_u32 s56, 0
    s_cbranch_scc1 .g2pf_389
    s_add_u32 s51, s34, s37
    s_lshl_b32 s52, s31, 16
    s_lshl_b32 s5, s31, 7
    s_add_u32 s4, s5, 117440512
    s_add_u32 s6, s5, 117448704
    s_add_u32 s5, s5, 121634816
    buffer_load_dwordx2 v[96:97], v22, s[16:19], s52 offen
    buffer_load_dword v98, v23, s[8:11], s4 offen
    buffer_load_dword v99, v23, s[8:11], s6 offen
    buffer_load_dword v100, v16, s[8:11], s5 offen

    buffer_load_dwordx4 v[84:87], v7, s[8:11], s51 offen sc1
    buffer_load_dwordx4 v[88:91], v8, s[8:11], s51 offen sc1
    buffer_load_dwordx4 v[92:95], v9, s[8:11], s51 offen sc1
    s_waitcnt vmcnt(0)
    s_mov_b32 s62, 0
.cc_390:
    v_max3_u32 v4, v84, v88, v92
    v_cmp_eq_u32 vcc, -1, v4
    s_cbranch_vccz .cd_391

    buffer_load_dwordx4 v[84:87], v7, s[8:11], s51 offen sc1
    buffer_load_dwordx4 v[88:91], v8, s[8:11], s51 offen sc1
    buffer_load_dwordx4 v[92:95], v9, s[8:11], s51 offen sc1
    s_add_u32 s62, s62, 1
    s_cmp_gt_u32 s62, 0x400000
    s_cbranch_scc1 .mg_end_1
    s_waitcnt vmcnt(0)
    s_branch .cc_390

.cd_391:
    v_add_f32 v84, v84, v88
    v_add_f32 v80, v80, v92
    v_add_f32 v85, v85, v89
    v_add_f32 v81, v81, v93
    v_add_f32 v86, v86, v90
    v_add_f32 v82, v82, v94
    v_add_f32 v87, v87, v91
    v_add_f32 v83, v83, v95
    v_add_f32 v80, v80, v84
    v_add_f32 v81, v81, v85
    v_add_f32 v82, v82, v86
    v_add_f32 v83, v83, v87
    v_sub_f32 v104, 1.0, v100
    v_cvt_pk_bf16_f32 v104, v104, v104
    v_lshlrev_b32 v104, 16, v104

    v_cvt_pk_bf16_f32 v105, v80, v81
    v_lshlrev_b32 v107, 16, v96
    v_and_b32 v108, 0xffff0000, v96
    v_lshlrev_b32 v109, 16, v98
    v_and_b32 v110, 0xffff0000, v98
    v_and_b32 v106, 0xffff0000, v105
    v_lshlrev_b32 v105, 16, v105
    v_mul_f32 v107, v107, v109
    v_mul_f32 v108, v108, v110
    v_mul_f32 v105, v104, v105
    v_mul_f32 v106, v104, v106
    v_cvt_pk_bf16_f32 v107, v107, v108
    v_cvt_pk_bf16_f32 v105, v105, v106
    v_and_b32 v108, 0xffff0000, v107
    v_lshlrev_b32 v107, 16, v107
    v_and_b32 v106, 0xffff0000, v105
    v_lshlrev_b32 v105, 16, v105
    v_mul_f32 v107, v100, v107
    v_mul_f32 v108, v100, v108
    v_cvt_pk_bf16_f32 v107, v107, v108
    v_and_b32 v108, 0xffff0000, v107
    v_lshlrev_b32 v107, 16, v107
    v_add_f32 v105, v105, v107
    v_add_f32 v106, v106, v108
    v_cvt_pk_bf16_f32 v102, v105, v106

    v_cvt_pk_bf16_f32 v105, v82, v83
    v_lshlrev_b32 v107, 16, v97
    v_and_b32 v108, 0xffff0000, v97
    v_lshlrev_b32 v109, 16, v99
    v_and_b32 v110, 0xffff0000, v99
    v_and_b32 v106, 0xffff0000, v105
    v_lshlrev_b32 v105, 16, v105
    v_mul_f32 v107, v107, v109
    v_mul_f32 v108, v108, v110
    v_mul_f32 v105, v104, v105
    v_mul_f32 v106, v104, v106
    v_cvt_pk_bf16_f32 v107, v107, v108
    v_cvt_pk_bf16_f32 v105, v105, v106
    v_and_b32 v108, 0xffff0000, v107
    v_lshlrev_b32 v107, 16, v107
    v_and_b32 v106, 0xffff0000, v105
    v_lshlrev_b32 v105, 16, v105
    v_mul_f32 v107, v100, v107
    v_mul_f32 v108, v100, v108
    v_cvt_pk_bf16_f32 v107, v107, v108
    v_and_b32 v108, 0xffff0000, v107
    v_lshlrev_b32 v107, 16, v107
    v_add_f32 v105, v105, v107
    v_add_f32 v106, v106, v108
    v_cvt_pk_bf16_f32 v103, v105, v106

    buffer_store_dwordx2 v[102:103], v22, s[44:47], s52 offen
    s_mov_b32 s38, 0
    s_mov_b32 s31, s53
    s_add_u32 s37, s37, 0x10000
    s_cmp_lt_u32 s31, 64
    s_cbranch_scc1 .g2blk_376
    s_branch .g2fin_384

.g2pf_389:
    s_mov_b32 s31, s53
    s_add_u32 s37, s37, 0x10000
    s_cmp_eq_u32 s38, 0
    s_mov_b32 s38, 1
    s_cbranch_scc1 .g2w3_378
    s_waitcnt vmcnt(4)
    s_branch .g2go_377

.g2w3_378:
    s_waitcnt vmcnt(3)
    s_branch .g2go_377
.g2fin_384:
    s_endpgm
.cvrole_359:
    s_cmp_lg_u32 s24, 0
    s_cbranch_scc1 .pm_392
    s_lshl_b32 s93, s91, 3
    s_add_u32 s93, s93, s26
    s_sub_u32 s93, s93, 24
    s_and_b32 s94, s93, 1
    s_sub_u32 s5, 0, s100
    s_and_b32 s5, s5, 0x1fffff
    s_add_u32 s5, s5, 100663296
    s_lshl_b32 s4, s94, 21
    s_add_u32 s5, s5, s4
    s_lshl_b32 s4, s93, 8
    s_add_u32 s5, s5, s4
    s_add_u32 s6, s5, 8192
    v_and_b32 v4, 63, v0
    v_lshlrev_b32 v4, 2, v4
    v_mov_b32 v5, -1
    s_mov_b32 s82, 0x7fffffff
    s_mov_b32 s83, 0x7fffffff
    buffer_store_dword v5, v4, s[8:11], s5 offen sc1
    s_waitcnt vmcnt(0)

    s_memtime s[72:73]
    s_waitcnt lgkmcnt(0)
    buffer_store_dword v5, v4, s[8:11], s6 offen sc1
    s_waitcnt vmcnt(0)
    s_memtime s[84:85]
    s_waitcnt lgkmcnt(0)
    s_sub_u32 s84, s84, s72
    s_min_u32 s83, s83, s84

    s_memtime s[72:73]
    s_waitcnt lgkmcnt(0)
    buffer_store_dword v5, v4, s[8:11], s5 offen sc1
    s_waitcnt vmcnt(0)
    s_memtime s[84:85]
    s_waitcnt lgkmcnt(0)
    s_sub_u32 s84, s84, s72
    s_min_u32 s82, s82, s84

    s_memtime s[72:73]
    s_waitcnt lgkmcnt(0)
    buffer_store_dword v5, v4, s[8:11], s6 offen sc1
    s_waitcnt vmcnt(0)
    s_memtime s[84:85]
    s_waitcnt lgkmcnt(0)
    s_sub_u32 s84, s84, s72
    s_min_u32 s83, s83, s84

    s_memtime s[72:73]
    s_waitcnt lgkmcnt(0)
    buffer_store_dword v5, v4, s[8:11], s5 offen sc1
    s_waitcnt vmcnt(0)
    s_memtime s[84:85]
    s_waitcnt lgkmcnt(0)
    s_sub_u32 s84, s84, s72
    s_min_u32 s82, s82, s84

    s_cmp_lt_u32 s82, s83
    s_cselect_b32 s4, 1, 0
    s_mul_i32 s94, s94, 6
    s_lshl_b32 s4, s4, s94
    s_add_u32 s95, s4, 0x1000000

.pm_392:
    v_and_b32 v243, 7, v0
    v_lshlrev_b32 v243, 2, v243
    buffer_load_dword v242, v243, s[20:23], 0 offen sc1

    s_waitcnt vmcnt(0)
    s_cmp_lg_u32 s97, 0
    s_cbranch_scc1 .vd_394
    s_mov_b32 s62, 0

.vp_393:
    v_cmp_ne_u32 vcc, 32, v242
    s_cbranch_vccz .vd_394
    v_readlane_b32 s4, v242, 0

    v_readlane_b32 s5, v242, 1
    s_add_u32 s4, s4, s5
    v_readlane_b32 s5, v242, 2
    s_add_u32 s4, s4, s5
    v_readlane_b32 s5, v242, 3
    s_add_u32 s4, s4, s5
    v_readlane_b32 s5, v242, 4
    s_add_u32 s4, s4, s5
    v_readlane_b32 s5, v242, 5
    s_add_u32 s4, s4, s5
    v_readlane_b32 s5, v242, 6
    s_add_u32 s4, s4, s5
    v_readlane_b32 s5, v242, 7
    s_add_u32 s4, s4, s5
    s_cmp_ge_u32 s4, 256
    s_cbranch_scc1 .vs_395
    s_add_u32 s62, s62, 1
    s_cmp_gt_u32 s62, 0x100000
    s_cbranch_scc1 .mg_end_1
    s_sleep 4
    buffer_load_dword v242, v243, s[20:23], 0 offen sc1
    s_waitcnt vmcnt(0)
    s_branch .vp_393

.vs_395:
    s_lshr_b32 s25, s2, 5
    s_and_b32 s26, s2, 31
    s_mov_b32 s27, 1
    s_mov_b32 s97, 1
    s_waitcnt vmcnt(0) lgkmcnt(0)
    s_barrier
    s_branch .mg_role_3

.vd_394:
    s_mov_b32 s97, 1
    s_cmp_lg_u32 s24, 0
    s_cbranch_scc1 .pv_396
    s_mov_b64 exec, 1
    v_mov_b32 v4, s95
    v_mov_b32 v5, 36
    buffer_atomic_add v4, v5, s[20:23], 0 offen sc1
    s_mov_b64 exec, -1

.pv_396:
    s_lshl_b32 s4, s91, 3
    s_add_u32 s4, s4, s26
    s_add_u32 s4, s4, 72
    s_lshl_b32 s4, s4, 8
    s_add_u32 s92, s4, 92274688
    v_mov_b32 v4, 0
    s_mov_b64 exec, 1
    buffer_store_dword v4, v4, s[8:11], s92 offen sc1
    s_mov_b64 exec, -1

    s_waitcnt vmcnt(0) lgkmcnt(0)
    s_barrier
    s_mov_b32 s5, 32
    s_cmp_lg_u32 s24, 0
    s_cbranch_scc1 .sg_397
    s_mov_b64 exec, 1
    v_mov_b32 v4, 1
    v_mov_b32 v5, 0
    buffer_atomic_add v4, v5, s[20:23], s5 offen sc1
    s_mov_b64 exec, -1

.sg_397:
    s_lshl_b32 s93, s91, 3
    s_add_u32 s93, s93, s26
    s_sub_u32 s93, s93, 24
    s_mov_b32 s94, s93

.kp_398:
    s_mov_b32 s25, s94
    s_load_dwordx4 s[52:55], s[0:1], 8
    s_load_dwordx2 s[56:57], s[0:1], 24
    s_waitcnt lgkmcnt(0)

    s_mov_b32 s60, s52
    s_and_b32 s61, s53, 0xffff
    s_mov_b32 s62, 0x400000
    s_mov_b32 s63, 0x00020000

    s_mov_b32 s64, s54
    s_and_b32 s65, s55, 0xffff
    s_mov_b32 s66, 0x400000
    s_mov_b32 s67, 0x00020000

    s_mov_b32 s68, s56
    s_and_b32 s69, s57, 0xffff
    s_mov_b32 s70, 0x2000
    s_mov_b32 s71, 0x00020000

    s_lshr_b32 s4, s25, 4
    s_and_b32 s5, s25, 15
    v_lshrrev_b32 v10, 4, v0
    v_and_b32 v11, 15, v0
    s_lshl_b32 s6, s4, 7
    v_lshlrev_b32 v12, 3, v10
    v_add_u32 v12, s6, v12
    v_lshlrev_b32 v13, 11, v12
    s_lshl_b32 s7, s5, 7
    v_lshlrev_b32 v14, 3, v11
    v_add_u32 v14, s7, v14
    v_add_u32 v13, v13, v14
    v_subrev_u32 v15, 6144, v13
    v_subrev_u32 v16, 4096, v13
    v_subrev_u32 v17, 2048, v13
    v_lshlrev_b32 v18, 2, v14
    v_lshlrev_b32 v19, 11, v14
    v_lshlrev_b32 v12, 1, v12
    v_add_u32 v19, v19, v12

    v_lshlrev_b32 v19, 11, v14
    v_lshrrev_b32 v12, 6, v12
    v_lshl_add_u32 v19, v12, 4, v19
    v_and_b32 v12, 3, v10
    v_lshl_add_u32 v19, v12, 10, v19

    buffer_load_dwordx4 v[20:23], v18, s[68:71], 0 offen
    buffer_load_dwordx4 v[24:27], v18, s[68:71], 0 offen offset:16

    buffer_load_dwordx2 v[28:29], v15, s[60:63], 0 offen
    buffer_load_dwordx2 v[30:31], v16, s[60:63], 0 offen
    buffer_load_dwordx2 v[32:33], v17, s[60:63], 0 offen
    s_mov_b32 s6, 0
    buffer_load_dwordx2 v[34:35], v13, s[60:63], s6 offen
    s_mov_b32 s6, 2048
    buffer_load_dwordx2 v[36:37], v13, s[60:63], s6 offen
    s_mov_b32 s6, 4096
    buffer_load_dwordx2 v[38:39], v13, s[60:63], s6 offen
    s_mov_b32 s6, 6144
    buffer_load_dwordx2 v[40:41], v13, s[60:63], s6 offen
    s_mov_b32 s6, 8192
    buffer_load_dwordx2 v[42:43], v13, s[60:63], s6 offen
    s_mov_b32 s6, 10240
    buffer_load_dwordx2 v[44:45], v13, s[60:63], s6 offen
    s_mov_b32 s6, 12288
    buffer_load_dwordx2 v[46:47], v13, s[60:63], s6 offen
    s_mov_b32 s6, 14336
    buffer_load_dwordx2 v[48:49], v13, s[60:63], s6 offen
    s_mov_b32 s6, 0
    buffer_load_dwordx2 v[50:51], v13, s[64:67], s6 offen
    s_mov_b32 s6, 2048
    buffer_load_dwordx2 v[52:53], v13, s[64:67], s6 offen
    s_mov_b32 s6, 4096
    buffer_load_dwordx2 v[54:55], v13, s[64:67], s6 offen
    s_mov_b32 s6, 6144
    buffer_load_dwordx2 v[56:57], v13, s[64:67], s6 offen
    s_mov_b32 s6, 8192
    buffer_load_dwordx2 v[58:59], v13, s[64:67], s6 offen
    s_mov_b32 s6, 10240
    buffer_load_dwordx2 v[60:61], v13, s[64:67], s6 offen
    s_mov_b32 s6, 12288
    buffer_load_dwordx2 v[62:63], v13, s[64:67], s6 offen
    s_mov_b32 s6, 14336
    buffer_load_dwordx2 v[64:65], v13, s[64:67], s6 offen
    s_waitcnt vmcnt(0)
    v_lshlrev_b32 v66, 16, v20
    v_and_b32 v67, 0xffff0000, v20
    v_lshlrev_b32 v68, 16, v21
    v_and_b32 v69, 0xffff0000, v21

    v_lshlrev_b32 v70, 16, v22
    v_and_b32 v71, 0xffff0000, v22
    v_lshlrev_b32 v72, 16, v23
    v_and_b32 v73, 0xffff0000, v23

    v_lshlrev_b32 v74, 16, v28
    v_and_b32 v86, 0xffff0000, v28
    v_lshlrev_b32 v75, 16, v30
    v_and_b32 v87, 0xffff0000, v30
    v_lshlrev_b32 v76, 16, v32
    v_and_b32 v88, 0xffff0000, v32
    v_lshlrev_b32 v77, 16, v34
    v_and_b32 v89, 0xffff0000, v34
    v_lshlrev_b32 v78, 16, v36
    v_and_b32 v90, 0xffff0000, v36
    v_lshlrev_b32 v79, 16, v38
    v_and_b32 v91, 0xffff0000, v38
    v_lshlrev_b32 v80, 16, v40
    v_and_b32 v92, 0xffff0000, v40
    v_lshlrev_b32 v81, 16, v42
    v_and_b32 v93, 0xffff0000, v42
    v_lshlrev_b32 v82, 16, v44
    v_and_b32 v94, 0xffff0000, v44
    v_lshlrev_b32 v83, 16, v46
    v_and_b32 v95, 0xffff0000, v46
    v_lshlrev_b32 v84, 16, v48
    v_and_b32 v96, 0xffff0000, v48
    v_mul_f32 v98, v69, v74
    v_mul_f32 v99, v73, v86
    v_cvt_pk_bf16_f32 v98, v98, v99
    v_and_b32 v99, 0xffff0000, v98
    v_lshlrev_b32 v98, 16, v98

    v_mul_f32 v100, v68, v75
    v_mul_f32 v101, v72, v87
    v_cvt_pk_bf16_f32 v100, v100, v101
    v_and_b32 v101, 0xffff0000, v100
    v_lshlrev_b32 v100, 16, v100
    v_add_f32 v98, v98, v100
    v_add_f32 v99, v99, v101
    v_cvt_pk_bf16_f32 v98, v98, v99
    v_and_b32 v99, 0xffff0000, v98
    v_lshlrev_b32 v98, 16, v98

    v_mul_f32 v100, v67, v76
    v_mul_f32 v101, v71, v88
    v_cvt_pk_bf16_f32 v100, v100, v101
    v_and_b32 v101, 0xffff0000, v100
    v_lshlrev_b32 v100, 16, v100
    v_add_f32 v98, v98, v100
    v_add_f32 v99, v99, v101
    v_cvt_pk_bf16_f32 v98, v98, v99
    v_and_b32 v99, 0xffff0000, v98
    v_lshlrev_b32 v98, 16, v98

    v_mul_f32 v100, v66, v77
    v_mul_f32 v101, v70, v89
    v_cvt_pk_bf16_f32 v100, v100, v101
    v_and_b32 v101, 0xffff0000, v100
    v_lshlrev_b32 v100, 16, v100
    v_add_f32 v98, v98, v100
    v_add_f32 v99, v99, v101
    v_cvt_pk_bf16_f32 v98, v98, v99
    v_and_b32 v99, 0xffff0000, v98
    v_lshlrev_b32 v98, 16, v98

    v_lshlrev_b32 v100, 16, v50
    v_and_b32 v101, 0xffff0000, v50
    v_mul_f32 v102, v98, v100
    v_mul_f32 v110, v99, v101
    v_cvt_pk_bf16_f32 v50, v102, v110

    v_mul_f32 v98, v69, v75
    v_mul_f32 v99, v73, v87
    v_cvt_pk_bf16_f32 v98, v98, v99
    v_and_b32 v99, 0xffff0000, v98
    v_lshlrev_b32 v98, 16, v98

    v_mul_f32 v100, v68, v76
    v_mul_f32 v101, v72, v88
    v_cvt_pk_bf16_f32 v100, v100, v101
    v_and_b32 v101, 0xffff0000, v100
    v_lshlrev_b32 v100, 16, v100
    v_add_f32 v98, v98, v100
    v_add_f32 v99, v99, v101
    v_cvt_pk_bf16_f32 v98, v98, v99
    v_and_b32 v99, 0xffff0000, v98
    v_lshlrev_b32 v98, 16, v98

    v_mul_f32 v100, v67, v77
    v_mul_f32 v101, v71, v89
    v_cvt_pk_bf16_f32 v100, v100, v101
    v_and_b32 v101, 0xffff0000, v100
    v_lshlrev_b32 v100, 16, v100
    v_add_f32 v98, v98, v100
    v_add_f32 v99, v99, v101
    v_cvt_pk_bf16_f32 v98, v98, v99
    v_and_b32 v99, 0xffff0000, v98
    v_lshlrev_b32 v98, 16, v98

    v_mul_f32 v100, v66, v78
    v_mul_f32 v101, v70, v90
    v_cvt_pk_bf16_f32 v100, v100, v101
    v_and_b32 v101, 0xffff0000, v100
    v_lshlrev_b32 v100, 16, v100
    v_add_f32 v98, v98, v100
    v_add_f32 v99, v99, v101
    v_cvt_pk_bf16_f32 v98, v98, v99
    v_and_b32 v99, 0xffff0000, v98
    v_lshlrev_b32 v98, 16, v98

    v_lshlrev_b32 v100, 16, v52
    v_and_b32 v101, 0xffff0000, v52
    v_mul_f32 v103, v98, v100
    v_mul_f32 v111, v99, v101
    v_cvt_pk_bf16_f32 v52, v103, v111

    v_mul_f32 v98, v69, v76
    v_mul_f32 v99, v73, v88
    v_cvt_pk_bf16_f32 v98, v98, v99
    v_and_b32 v99, 0xffff0000, v98
    v_lshlrev_b32 v98, 16, v98

    v_mul_f32 v100, v68, v77
    v_mul_f32 v101, v72, v89
    v_cvt_pk_bf16_f32 v100, v100, v101
    v_and_b32 v101, 0xffff0000, v100
    v_lshlrev_b32 v100, 16, v100
    v_add_f32 v98, v98, v100
    v_add_f32 v99, v99, v101
    v_cvt_pk_bf16_f32 v98, v98, v99
    v_and_b32 v99, 0xffff0000, v98
    v_lshlrev_b32 v98, 16, v98

    v_mul_f32 v100, v67, v78
    v_mul_f32 v101, v71, v90
    v_cvt_pk_bf16_f32 v100, v100, v101
    v_and_b32 v101, 0xffff0000, v100
    v_lshlrev_b32 v100, 16, v100
    v_add_f32 v98, v98, v100
    v_add_f32 v99, v99, v101
    v_cvt_pk_bf16_f32 v98, v98, v99
    v_and_b32 v99, 0xffff0000, v98
    v_lshlrev_b32 v98, 16, v98

    v_mul_f32 v100, v66, v79
    v_mul_f32 v101, v70, v91
    v_cvt_pk_bf16_f32 v100, v100, v101
    v_and_b32 v101, 0xffff0000, v100
    v_lshlrev_b32 v100, 16, v100
    v_add_f32 v98, v98, v100
    v_add_f32 v99, v99, v101
    v_cvt_pk_bf16_f32 v98, v98, v99
    v_and_b32 v99, 0xffff0000, v98
    v_lshlrev_b32 v98, 16, v98

    v_lshlrev_b32 v100, 16, v54
    v_and_b32 v101, 0xffff0000, v54
    v_mul_f32 v104, v98, v100
    v_mul_f32 v112, v99, v101
    v_cvt_pk_bf16_f32 v54, v104, v112

    v_mul_f32 v98, v69, v77
    v_mul_f32 v99, v73, v89
    v_cvt_pk_bf16_f32 v98, v98, v99
    v_and_b32 v99, 0xffff0000, v98
    v_lshlrev_b32 v98, 16, v98

    v_mul_f32 v100, v68, v78
    v_mul_f32 v101, v72, v90
    v_cvt_pk_bf16_f32 v100, v100, v101
    v_and_b32 v101, 0xffff0000, v100
    v_lshlrev_b32 v100, 16, v100
    v_add_f32 v98, v98, v100
    v_add_f32 v99, v99, v101
    v_cvt_pk_bf16_f32 v98, v98, v99
    v_and_b32 v99, 0xffff0000, v98
    v_lshlrev_b32 v98, 16, v98

    v_mul_f32 v100, v67, v79
    v_mul_f32 v101, v71, v91
    v_cvt_pk_bf16_f32 v100, v100, v101
    v_and_b32 v101, 0xffff0000, v100
    v_lshlrev_b32 v100, 16, v100
    v_add_f32 v98, v98, v100
    v_add_f32 v99, v99, v101
    v_cvt_pk_bf16_f32 v98, v98, v99
    v_and_b32 v99, 0xffff0000, v98
    v_lshlrev_b32 v98, 16, v98

    v_mul_f32 v100, v66, v80
    v_mul_f32 v101, v70, v92
    v_cvt_pk_bf16_f32 v100, v100, v101
    v_and_b32 v101, 0xffff0000, v100
    v_lshlrev_b32 v100, 16, v100
    v_add_f32 v98, v98, v100
    v_add_f32 v99, v99, v101
    v_cvt_pk_bf16_f32 v98, v98, v99
    v_and_b32 v99, 0xffff0000, v98
    v_lshlrev_b32 v98, 16, v98

    v_lshlrev_b32 v100, 16, v56
    v_and_b32 v101, 0xffff0000, v56
    v_mul_f32 v105, v98, v100
    v_mul_f32 v113, v99, v101
    v_cvt_pk_bf16_f32 v56, v105, v113

    v_mul_f32 v98, v69, v78
    v_mul_f32 v99, v73, v90
    v_cvt_pk_bf16_f32 v98, v98, v99
    v_and_b32 v99, 0xffff0000, v98
    v_lshlrev_b32 v98, 16, v98

    v_mul_f32 v100, v68, v79
    v_mul_f32 v101, v72, v91
    v_cvt_pk_bf16_f32 v100, v100, v101
    v_and_b32 v101, 0xffff0000, v100
    v_lshlrev_b32 v100, 16, v100
    v_add_f32 v98, v98, v100
    v_add_f32 v99, v99, v101
    v_cvt_pk_bf16_f32 v98, v98, v99
    v_and_b32 v99, 0xffff0000, v98
    v_lshlrev_b32 v98, 16, v98

    v_mul_f32 v100, v67, v80
    v_mul_f32 v101, v71, v92
    v_cvt_pk_bf16_f32 v100, v100, v101
    v_and_b32 v101, 0xffff0000, v100
    v_lshlrev_b32 v100, 16, v100
    v_add_f32 v98, v98, v100
    v_add_f32 v99, v99, v101
    v_cvt_pk_bf16_f32 v98, v98, v99
    v_and_b32 v99, 0xffff0000, v98
    v_lshlrev_b32 v98, 16, v98

    v_mul_f32 v100, v66, v81
    v_mul_f32 v101, v70, v93
    v_cvt_pk_bf16_f32 v100, v100, v101
    v_and_b32 v101, 0xffff0000, v100
    v_lshlrev_b32 v100, 16, v100
    v_add_f32 v98, v98, v100
    v_add_f32 v99, v99, v101
    v_cvt_pk_bf16_f32 v98, v98, v99
    v_and_b32 v99, 0xffff0000, v98
    v_lshlrev_b32 v98, 16, v98

    v_lshlrev_b32 v100, 16, v58
    v_and_b32 v101, 0xffff0000, v58
    v_mul_f32 v106, v98, v100
    v_mul_f32 v114, v99, v101
    v_cvt_pk_bf16_f32 v58, v106, v114

    v_mul_f32 v98, v69, v79
    v_mul_f32 v99, v73, v91
    v_cvt_pk_bf16_f32 v98, v98, v99
    v_and_b32 v99, 0xffff0000, v98
    v_lshlrev_b32 v98, 16, v98

    v_mul_f32 v100, v68, v80
    v_mul_f32 v101, v72, v92
    v_cvt_pk_bf16_f32 v100, v100, v101
    v_and_b32 v101, 0xffff0000, v100
    v_lshlrev_b32 v100, 16, v100
    v_add_f32 v98, v98, v100
    v_add_f32 v99, v99, v101
    v_cvt_pk_bf16_f32 v98, v98, v99
    v_and_b32 v99, 0xffff0000, v98
    v_lshlrev_b32 v98, 16, v98

    v_mul_f32 v100, v67, v81
    v_mul_f32 v101, v71, v93
    v_cvt_pk_bf16_f32 v100, v100, v101
    v_and_b32 v101, 0xffff0000, v100
    v_lshlrev_b32 v100, 16, v100
    v_add_f32 v98, v98, v100
    v_add_f32 v99, v99, v101
    v_cvt_pk_bf16_f32 v98, v98, v99
    v_and_b32 v99, 0xffff0000, v98
    v_lshlrev_b32 v98, 16, v98

    v_mul_f32 v100, v66, v82
    v_mul_f32 v101, v70, v94
    v_cvt_pk_bf16_f32 v100, v100, v101
    v_and_b32 v101, 0xffff0000, v100
    v_lshlrev_b32 v100, 16, v100
    v_add_f32 v98, v98, v100
    v_add_f32 v99, v99, v101
    v_cvt_pk_bf16_f32 v98, v98, v99
    v_and_b32 v99, 0xffff0000, v98
    v_lshlrev_b32 v98, 16, v98

    v_lshlrev_b32 v100, 16, v60
    v_and_b32 v101, 0xffff0000, v60
    v_mul_f32 v107, v98, v100
    v_mul_f32 v115, v99, v101
    v_cvt_pk_bf16_f32 v60, v107, v115

    v_mul_f32 v98, v69, v80
    v_mul_f32 v99, v73, v92
    v_cvt_pk_bf16_f32 v98, v98, v99
    v_and_b32 v99, 0xffff0000, v98
    v_lshlrev_b32 v98, 16, v98

    v_mul_f32 v100, v68, v81
    v_mul_f32 v101, v72, v93
    v_cvt_pk_bf16_f32 v100, v100, v101
    v_and_b32 v101, 0xffff0000, v100
    v_lshlrev_b32 v100, 16, v100
    v_add_f32 v98, v98, v100
    v_add_f32 v99, v99, v101
    v_cvt_pk_bf16_f32 v98, v98, v99
    v_and_b32 v99, 0xffff0000, v98
    v_lshlrev_b32 v98, 16, v98

    v_mul_f32 v100, v67, v82
    v_mul_f32 v101, v71, v94
    v_cvt_pk_bf16_f32 v100, v100, v101
    v_and_b32 v101, 0xffff0000, v100
    v_lshlrev_b32 v100, 16, v100
    v_add_f32 v98, v98, v100
    v_add_f32 v99, v99, v101
    v_cvt_pk_bf16_f32 v98, v98, v99
    v_and_b32 v99, 0xffff0000, v98
    v_lshlrev_b32 v98, 16, v98

    v_mul_f32 v100, v66, v83
    v_mul_f32 v101, v70, v95
    v_cvt_pk_bf16_f32 v100, v100, v101
    v_and_b32 v101, 0xffff0000, v100
    v_lshlrev_b32 v100, 16, v100
    v_add_f32 v98, v98, v100
    v_add_f32 v99, v99, v101
    v_cvt_pk_bf16_f32 v98, v98, v99
    v_and_b32 v99, 0xffff0000, v98
    v_lshlrev_b32 v98, 16, v98

    v_lshlrev_b32 v100, 16, v62
    v_and_b32 v101, 0xffff0000, v62
    v_mul_f32 v108, v98, v100
    v_mul_f32 v116, v99, v101
    v_cvt_pk_bf16_f32 v62, v108, v116

    v_mul_f32 v98, v69, v81
    v_mul_f32 v99, v73, v93
    v_cvt_pk_bf16_f32 v98, v98, v99
    v_and_b32 v99, 0xffff0000, v98
    v_lshlrev_b32 v98, 16, v98

    v_mul_f32 v100, v68, v82
    v_mul_f32 v101, v72, v94
    v_cvt_pk_bf16_f32 v100, v100, v101
    v_and_b32 v101, 0xffff0000, v100
    v_lshlrev_b32 v100, 16, v100
    v_add_f32 v98, v98, v100
    v_add_f32 v99, v99, v101
    v_cvt_pk_bf16_f32 v98, v98, v99
    v_and_b32 v99, 0xffff0000, v98
    v_lshlrev_b32 v98, 16, v98

    v_mul_f32 v100, v67, v83
    v_mul_f32 v101, v71, v95
    v_cvt_pk_bf16_f32 v100, v100, v101
    v_and_b32 v101, 0xffff0000, v100
    v_lshlrev_b32 v100, 16, v100
    v_add_f32 v98, v98, v100
    v_add_f32 v99, v99, v101
    v_cvt_pk_bf16_f32 v98, v98, v99
    v_and_b32 v99, 0xffff0000, v98
    v_lshlrev_b32 v98, 16, v98

    v_mul_f32 v100, v66, v84
    v_mul_f32 v101, v70, v96
    v_cvt_pk_bf16_f32 v100, v100, v101
    v_and_b32 v101, 0xffff0000, v100
    v_lshlrev_b32 v100, 16, v100
    v_add_f32 v98, v98, v100
    v_add_f32 v99, v99, v101
    v_cvt_pk_bf16_f32 v98, v98, v99
    v_and_b32 v99, 0xffff0000, v98
    v_lshlrev_b32 v98, 16, v98

    v_lshlrev_b32 v100, 16, v64
    v_and_b32 v101, 0xffff0000, v64
    v_mul_f32 v109, v98, v100
    v_mul_f32 v117, v99, v101
    v_cvt_pk_bf16_f32 v64, v109, v117

    v_cvt_pk_bf16_f32 v118, v109, v108
    v_cvt_pk_bf16_f32 v119, v107, v106
    v_cvt_pk_bf16_f32 v120, v105, v104
    v_cvt_pk_bf16_f32 v121, v103, v102
    s_mov_b32 s6, 125829120
    buffer_store_dwordx4 v[118:121], v19, s[8:11], s6 offen sc1
    v_cvt_pk_bf16_f32 v122, v117, v116
    v_cvt_pk_bf16_f32 v123, v115, v114
    v_cvt_pk_bf16_f32 v124, v113, v112
    v_cvt_pk_bf16_f32 v125, v111, v110
    s_mov_b32 s6, 125833216
    buffer_store_dwordx4 v[122:125], v19, s[8:11], s6 offen sc1
    s_nop 1
    v_lshlrev_b32 v66, 16, v24
    v_and_b32 v67, 0xffff0000, v24
    v_lshlrev_b32 v68, 16, v25
    v_and_b32 v69, 0xffff0000, v25

    v_lshlrev_b32 v70, 16, v26
    v_and_b32 v71, 0xffff0000, v26
    v_lshlrev_b32 v72, 16, v27
    v_and_b32 v73, 0xffff0000, v27

    v_lshlrev_b32 v74, 16, v29
    v_and_b32 v86, 0xffff0000, v29
    v_lshlrev_b32 v75, 16, v31
    v_and_b32 v87, 0xffff0000, v31
    v_lshlrev_b32 v76, 16, v33
    v_and_b32 v88, 0xffff0000, v33
    v_lshlrev_b32 v77, 16, v35
    v_and_b32 v89, 0xffff0000, v35
    v_lshlrev_b32 v78, 16, v37
    v_and_b32 v90, 0xffff0000, v37
    v_lshlrev_b32 v79, 16, v39
    v_and_b32 v91, 0xffff0000, v39
    v_lshlrev_b32 v80, 16, v41
    v_and_b32 v92, 0xffff0000, v41
    v_lshlrev_b32 v81, 16, v43
    v_and_b32 v93, 0xffff0000, v43
    v_lshlrev_b32 v82, 16, v45
    v_and_b32 v94, 0xffff0000, v45
    v_lshlrev_b32 v83, 16, v47
    v_and_b32 v95, 0xffff0000, v47
    v_lshlrev_b32 v84, 16, v49
    v_and_b32 v96, 0xffff0000, v49
    v_mul_f32 v98, v69, v74
    v_mul_f32 v99, v73, v86
    v_cvt_pk_bf16_f32 v98, v98, v99
    v_and_b32 v99, 0xffff0000, v98
    v_lshlrev_b32 v98, 16, v98

    v_mul_f32 v100, v68, v75
    v_mul_f32 v101, v72, v87
    v_cvt_pk_bf16_f32 v100, v100, v101
    v_and_b32 v101, 0xffff0000, v100
    v_lshlrev_b32 v100, 16, v100
    v_add_f32 v98, v98, v100
    v_add_f32 v99, v99, v101
    v_cvt_pk_bf16_f32 v98, v98, v99
    v_and_b32 v99, 0xffff0000, v98
    v_lshlrev_b32 v98, 16, v98

    v_mul_f32 v100, v67, v76
    v_mul_f32 v101, v71, v88
    v_cvt_pk_bf16_f32 v100, v100, v101
    v_and_b32 v101, 0xffff0000, v100
    v_lshlrev_b32 v100, 16, v100
    v_add_f32 v98, v98, v100
    v_add_f32 v99, v99, v101
    v_cvt_pk_bf16_f32 v98, v98, v99
    v_and_b32 v99, 0xffff0000, v98
    v_lshlrev_b32 v98, 16, v98

    v_mul_f32 v100, v66, v77
    v_mul_f32 v101, v70, v89
    v_cvt_pk_bf16_f32 v100, v100, v101
    v_and_b32 v101, 0xffff0000, v100
    v_lshlrev_b32 v100, 16, v100
    v_add_f32 v98, v98, v100
    v_add_f32 v99, v99, v101
    v_cvt_pk_bf16_f32 v98, v98, v99
    v_and_b32 v99, 0xffff0000, v98
    v_lshlrev_b32 v98, 16, v98

    v_lshlrev_b32 v100, 16, v51
    v_and_b32 v101, 0xffff0000, v51
    v_mul_f32 v102, v98, v100
    v_mul_f32 v110, v99, v101
    v_cvt_pk_bf16_f32 v51, v102, v110

    v_mul_f32 v98, v69, v75
    v_mul_f32 v99, v73, v87
    v_cvt_pk_bf16_f32 v98, v98, v99
    v_and_b32 v99, 0xffff0000, v98
    v_lshlrev_b32 v98, 16, v98

    v_mul_f32 v100, v68, v76
    v_mul_f32 v101, v72, v88
    v_cvt_pk_bf16_f32 v100, v100, v101
    v_and_b32 v101, 0xffff0000, v100
    v_lshlrev_b32 v100, 16, v100
    v_add_f32 v98, v98, v100
    v_add_f32 v99, v99, v101
    v_cvt_pk_bf16_f32 v98, v98, v99
    v_and_b32 v99, 0xffff0000, v98
    v_lshlrev_b32 v98, 16, v98

    v_mul_f32 v100, v67, v77
    v_mul_f32 v101, v71, v89
    v_cvt_pk_bf16_f32 v100, v100, v101
    v_and_b32 v101, 0xffff0000, v100
    v_lshlrev_b32 v100, 16, v100
    v_add_f32 v98, v98, v100
    v_add_f32 v99, v99, v101
    v_cvt_pk_bf16_f32 v98, v98, v99
    v_and_b32 v99, 0xffff0000, v98
    v_lshlrev_b32 v98, 16, v98

    v_mul_f32 v100, v66, v78
    v_mul_f32 v101, v70, v90
    v_cvt_pk_bf16_f32 v100, v100, v101
    v_and_b32 v101, 0xffff0000, v100
    v_lshlrev_b32 v100, 16, v100
    v_add_f32 v98, v98, v100
    v_add_f32 v99, v99, v101
    v_cvt_pk_bf16_f32 v98, v98, v99
    v_and_b32 v99, 0xffff0000, v98
    v_lshlrev_b32 v98, 16, v98

    v_lshlrev_b32 v100, 16, v53
    v_and_b32 v101, 0xffff0000, v53
    v_mul_f32 v103, v98, v100
    v_mul_f32 v111, v99, v101
    v_cvt_pk_bf16_f32 v53, v103, v111

    v_mul_f32 v98, v69, v76
    v_mul_f32 v99, v73, v88
    v_cvt_pk_bf16_f32 v98, v98, v99
    v_and_b32 v99, 0xffff0000, v98
    v_lshlrev_b32 v98, 16, v98

    v_mul_f32 v100, v68, v77
    v_mul_f32 v101, v72, v89
    v_cvt_pk_bf16_f32 v100, v100, v101
    v_and_b32 v101, 0xffff0000, v100
    v_lshlrev_b32 v100, 16, v100
    v_add_f32 v98, v98, v100
    v_add_f32 v99, v99, v101
    v_cvt_pk_bf16_f32 v98, v98, v99
    v_and_b32 v99, 0xffff0000, v98
    v_lshlrev_b32 v98, 16, v98

    v_mul_f32 v100, v67, v78
    v_mul_f32 v101, v71, v90
    v_cvt_pk_bf16_f32 v100, v100, v101
    v_and_b32 v101, 0xffff0000, v100
    v_lshlrev_b32 v100, 16, v100
    v_add_f32 v98, v98, v100
    v_add_f32 v99, v99, v101
    v_cvt_pk_bf16_f32 v98, v98, v99
    v_and_b32 v99, 0xffff0000, v98
    v_lshlrev_b32 v98, 16, v98

    v_mul_f32 v100, v66, v79
    v_mul_f32 v101, v70, v91
    v_cvt_pk_bf16_f32 v100, v100, v101
    v_and_b32 v101, 0xffff0000, v100
    v_lshlrev_b32 v100, 16, v100
    v_add_f32 v98, v98, v100
    v_add_f32 v99, v99, v101
    v_cvt_pk_bf16_f32 v98, v98, v99
    v_and_b32 v99, 0xffff0000, v98
    v_lshlrev_b32 v98, 16, v98

    v_lshlrev_b32 v100, 16, v55
    v_and_b32 v101, 0xffff0000, v55
    v_mul_f32 v104, v98, v100
    v_mul_f32 v112, v99, v101
    v_cvt_pk_bf16_f32 v55, v104, v112

    v_mul_f32 v98, v69, v77
    v_mul_f32 v99, v73, v89
    v_cvt_pk_bf16_f32 v98, v98, v99
    v_and_b32 v99, 0xffff0000, v98
    v_lshlrev_b32 v98, 16, v98

    v_mul_f32 v100, v68, v78
    v_mul_f32 v101, v72, v90
    v_cvt_pk_bf16_f32 v100, v100, v101
    v_and_b32 v101, 0xffff0000, v100
    v_lshlrev_b32 v100, 16, v100
    v_add_f32 v98, v98, v100
    v_add_f32 v99, v99, v101
    v_cvt_pk_bf16_f32 v98, v98, v99
    v_and_b32 v99, 0xffff0000, v98
    v_lshlrev_b32 v98, 16, v98

    v_mul_f32 v100, v67, v79
    v_mul_f32 v101, v71, v91
    v_cvt_pk_bf16_f32 v100, v100, v101
    v_and_b32 v101, 0xffff0000, v100
    v_lshlrev_b32 v100, 16, v100
    v_add_f32 v98, v98, v100
    v_add_f32 v99, v99, v101
    v_cvt_pk_bf16_f32 v98, v98, v99
    v_and_b32 v99, 0xffff0000, v98
    v_lshlrev_b32 v98, 16, v98

    v_mul_f32 v100, v66, v80
    v_mul_f32 v101, v70, v92
    v_cvt_pk_bf16_f32 v100, v100, v101
    v_and_b32 v101, 0xffff0000, v100
    v_lshlrev_b32 v100, 16, v100
    v_add_f32 v98, v98, v100
    v_add_f32 v99, v99, v101
    v_cvt_pk_bf16_f32 v98, v98, v99
    v_and_b32 v99, 0xffff0000, v98
    v_lshlrev_b32 v98, 16, v98

    v_lshlrev_b32 v100, 16, v57
    v_and_b32 v101, 0xffff0000, v57
    v_mul_f32 v105, v98, v100
    v_mul_f32 v113, v99, v101
    v_cvt_pk_bf16_f32 v57, v105, v113

    v_mul_f32 v98, v69, v78
    v_mul_f32 v99, v73, v90
    v_cvt_pk_bf16_f32 v98, v98, v99
    v_and_b32 v99, 0xffff0000, v98
    v_lshlrev_b32 v98, 16, v98

    v_mul_f32 v100, v68, v79
    v_mul_f32 v101, v72, v91
    v_cvt_pk_bf16_f32 v100, v100, v101
    v_and_b32 v101, 0xffff0000, v100
    v_lshlrev_b32 v100, 16, v100
    v_add_f32 v98, v98, v100
    v_add_f32 v99, v99, v101
    v_cvt_pk_bf16_f32 v98, v98, v99
    v_and_b32 v99, 0xffff0000, v98
    v_lshlrev_b32 v98, 16, v98

    v_mul_f32 v100, v67, v80
    v_mul_f32 v101, v71, v92
    v_cvt_pk_bf16_f32 v100, v100, v101
    v_and_b32 v101, 0xffff0000, v100
    v_lshlrev_b32 v100, 16, v100
    v_add_f32 v98, v98, v100
    v_add_f32 v99, v99, v101
    v_cvt_pk_bf16_f32 v98, v98, v99
    v_and_b32 v99, 0xffff0000, v98
    v_lshlrev_b32 v98, 16, v98

    v_mul_f32 v100, v66, v81
    v_mul_f32 v101, v70, v93
    v_cvt_pk_bf16_f32 v100, v100, v101
    v_and_b32 v101, 0xffff0000, v100
    v_lshlrev_b32 v100, 16, v100
    v_add_f32 v98, v98, v100
    v_add_f32 v99, v99, v101
    v_cvt_pk_bf16_f32 v98, v98, v99
    v_and_b32 v99, 0xffff0000, v98
    v_lshlrev_b32 v98, 16, v98

    v_lshlrev_b32 v100, 16, v59
    v_and_b32 v101, 0xffff0000, v59
    v_mul_f32 v106, v98, v100
    v_mul_f32 v114, v99, v101
    v_cvt_pk_bf16_f32 v59, v106, v114

    v_mul_f32 v98, v69, v79
    v_mul_f32 v99, v73, v91
    v_cvt_pk_bf16_f32 v98, v98, v99
    v_and_b32 v99, 0xffff0000, v98
    v_lshlrev_b32 v98, 16, v98

    v_mul_f32 v100, v68, v80
    v_mul_f32 v101, v72, v92
    v_cvt_pk_bf16_f32 v100, v100, v101
    v_and_b32 v101, 0xffff0000, v100
    v_lshlrev_b32 v100, 16, v100
    v_add_f32 v98, v98, v100
    v_add_f32 v99, v99, v101
    v_cvt_pk_bf16_f32 v98, v98, v99
    v_and_b32 v99, 0xffff0000, v98
    v_lshlrev_b32 v98, 16, v98

    v_mul_f32 v100, v67, v81
    v_mul_f32 v101, v71, v93
    v_cvt_pk_bf16_f32 v100, v100, v101
    v_and_b32 v101, 0xffff0000, v100
    v_lshlrev_b32 v100, 16, v100
    v_add_f32 v98, v98, v100
    v_add_f32 v99, v99, v101
    v_cvt_pk_bf16_f32 v98, v98, v99
    v_and_b32 v99, 0xffff0000, v98
    v_lshlrev_b32 v98, 16, v98

    v_mul_f32 v100, v66, v82
    v_mul_f32 v101, v70, v94
    v_cvt_pk_bf16_f32 v100, v100, v101
    v_and_b32 v101, 0xffff0000, v100
    v_lshlrev_b32 v100, 16, v100
    v_add_f32 v98, v98, v100
    v_add_f32 v99, v99, v101
    v_cvt_pk_bf16_f32 v98, v98, v99
    v_and_b32 v99, 0xffff0000, v98
    v_lshlrev_b32 v98, 16, v98

    v_lshlrev_b32 v100, 16, v61
    v_and_b32 v101, 0xffff0000, v61
    v_mul_f32 v107, v98, v100
    v_mul_f32 v115, v99, v101
    v_cvt_pk_bf16_f32 v61, v107, v115

    v_mul_f32 v98, v69, v80
    v_mul_f32 v99, v73, v92
    v_cvt_pk_bf16_f32 v98, v98, v99
    v_and_b32 v99, 0xffff0000, v98
    v_lshlrev_b32 v98, 16, v98

    v_mul_f32 v100, v68, v81
    v_mul_f32 v101, v72, v93
    v_cvt_pk_bf16_f32 v100, v100, v101
    v_and_b32 v101, 0xffff0000, v100
    v_lshlrev_b32 v100, 16, v100
    v_add_f32 v98, v98, v100
    v_add_f32 v99, v99, v101
    v_cvt_pk_bf16_f32 v98, v98, v99
    v_and_b32 v99, 0xffff0000, v98
    v_lshlrev_b32 v98, 16, v98

    v_mul_f32 v100, v67, v82
    v_mul_f32 v101, v71, v94
    v_cvt_pk_bf16_f32 v100, v100, v101
    v_and_b32 v101, 0xffff0000, v100
    v_lshlrev_b32 v100, 16, v100
    v_add_f32 v98, v98, v100
    v_add_f32 v99, v99, v101
    v_cvt_pk_bf16_f32 v98, v98, v99
    v_and_b32 v99, 0xffff0000, v98
    v_lshlrev_b32 v98, 16, v98

    v_mul_f32 v100, v66, v83
    v_mul_f32 v101, v70, v95
    v_cvt_pk_bf16_f32 v100, v100, v101
    v_and_b32 v101, 0xffff0000, v100
    v_lshlrev_b32 v100, 16, v100
    v_add_f32 v98, v98, v100
    v_add_f32 v99, v99, v101
    v_cvt_pk_bf16_f32 v98, v98, v99
    v_and_b32 v99, 0xffff0000, v98
    v_lshlrev_b32 v98, 16, v98

    v_lshlrev_b32 v100, 16, v63
    v_and_b32 v101, 0xffff0000, v63
    v_mul_f32 v108, v98, v100
    v_mul_f32 v116, v99, v101
    v_cvt_pk_bf16_f32 v63, v108, v116

    v_mul_f32 v98, v69, v81
    v_mul_f32 v99, v73, v93
    v_cvt_pk_bf16_f32 v98, v98, v99
    v_and_b32 v99, 0xffff0000, v98
    v_lshlrev_b32 v98, 16, v98

    v_mul_f32 v100, v68, v82
    v_mul_f32 v101, v72, v94
    v_cvt_pk_bf16_f32 v100, v100, v101
    v_and_b32 v101, 0xffff0000, v100
    v_lshlrev_b32 v100, 16, v100
    v_add_f32 v98, v98, v100
    v_add_f32 v99, v99, v101
    v_cvt_pk_bf16_f32 v98, v98, v99
    v_and_b32 v99, 0xffff0000, v98
    v_lshlrev_b32 v98, 16, v98

    v_mul_f32 v100, v67, v83
    v_mul_f32 v101, v71, v95
    v_cvt_pk_bf16_f32 v100, v100, v101
    v_and_b32 v101, 0xffff0000, v100
    v_lshlrev_b32 v100, 16, v100
    v_add_f32 v98, v98, v100
    v_add_f32 v99, v99, v101
    v_cvt_pk_bf16_f32 v98, v98, v99
    v_and_b32 v99, 0xffff0000, v98
    v_lshlrev_b32 v98, 16, v98

    v_mul_f32 v100, v66, v84
    v_mul_f32 v101, v70, v96
    v_cvt_pk_bf16_f32 v100, v100, v101
    v_and_b32 v101, 0xffff0000, v100
    v_lshlrev_b32 v100, 16, v100
    v_add_f32 v98, v98, v100
    v_add_f32 v99, v99, v101
    v_cvt_pk_bf16_f32 v98, v98, v99
    v_and_b32 v99, 0xffff0000, v98
    v_lshlrev_b32 v98, 16, v98

    v_lshlrev_b32 v100, 16, v65
    v_and_b32 v101, 0xffff0000, v65
    v_mul_f32 v109, v98, v100
    v_mul_f32 v117, v99, v101
    v_cvt_pk_bf16_f32 v65, v109, v117

    v_cvt_pk_bf16_f32 v118, v109, v108
    v_cvt_pk_bf16_f32 v119, v107, v106
    v_cvt_pk_bf16_f32 v120, v105, v104
    v_cvt_pk_bf16_f32 v121, v103, v102
    s_mov_b32 s6, 125837312
    buffer_store_dwordx4 v[118:121], v19, s[8:11], s6 offen sc1
    v_cvt_pk_bf16_f32 v122, v117, v116
    v_cvt_pk_bf16_f32 v123, v115, v114
    v_cvt_pk_bf16_f32 v124, v113, v112
    v_cvt_pk_bf16_f32 v125, v111, v110
    s_mov_b32 s6, 125841408
    buffer_store_dwordx4 v[122:125], v19, s[8:11], s6 offen sc1
    s_nop 1
    s_add_u32 s94, s94, 32
    s_cmp_lt_u32 s94, 256
    s_cbranch_scc1 .kp_398

    s_waitcnt vmcnt(0) lgkmcnt(0)
    s_barrier
    s_mov_b32 s5, 40
    s_cmp_lg_u32 s24, 0
    s_cbranch_scc1 .sg_399
    s_mov_b64 exec, 1
    v_mov_b32 v4, 1
    v_mov_b32 v5, 0
    buffer_atomic_add v4, v5, s[20:23], s5 offen sc1
    s_mov_b64 exec, -1

.sg_399:
    s_mov_b32 s3, s93
    v_and_b32 v1, 63, v0
    v_and_b32 v2, 15, v1
    v_lshrrev_b32 v3, 4, v1

    s_load_dwordx2 s[40:41], s[0:1], 0
    s_load_dwordx2 s[42:43], s[0:1], 104
    s_waitcnt lgkmcnt(0)

    s_mov_b32 s12, s40
    s_and_b32 s13, s41, 0xffff
    s_mov_b32 s14, 0x400000
    s_mov_b32 s15, 0x00020000

    s_mov_b32 s16, s42
    s_and_b32 s17, s43, 0xffff
    s_mov_b32 s18, 0x800
    s_mov_b32 s19, 0x00020000

    s_lshl_b32 s3, s3, 6
    s_lshl_b32 s4, s24, 4
    s_add_u32 s3, s3, s4
    v_lshlrev_b32 v8, 4, v1
    buffer_load_dwordx4 v[16:19], v8, s[16:19], 0 offen
    buffer_load_dwordx4 v[20:23], v8, s[16:19], 0 offen offset:1024
    s_lshl_b32 s5, s3, 11

    buffer_load_dwordx4 v[64:67], v8, s[12:15], s5 offen
    buffer_load_dwordx4 v[68:71], v8, s[12:15], s5 offen offset:1024
    s_add_u32 s5, s5, 2048

    buffer_load_dwordx4 v[72:75], v8, s[12:15], s5 offen
    buffer_load_dwordx4 v[76:79], v8, s[12:15], s5 offen offset:1024
    s_add_u32 s5, s5, 2048

    buffer_load_dwordx4 v[80:83], v8, s[12:15], s5 offen
    buffer_load_dwordx4 v[84:87], v8, s[12:15], s5 offen offset:1024
    s_add_u32 s5, s5, 2048

    buffer_load_dwordx4 v[88:91], v8, s[12:15], s5 offen
    buffer_load_dwordx4 v[92:95], v8, s[12:15], s5 offen offset:1024
    s_add_u32 s5, s5, 2048

    buffer_load_dwordx4 v[96:99], v8, s[12:15], s5 offen
    buffer_load_dwordx4 v[100:103], v8, s[12:15], s5 offen offset:1024
    s_add_u32 s5, s5, 2048

    buffer_load_dwordx4 v[104:107], v8, s[12:15], s5 offen
    buffer_load_dwordx4 v[108:111], v8, s[12:15], s5 offen offset:1024
    s_add_u32 s5, s5, 2048

    buffer_load_dwordx4 v[112:115], v8, s[12:15], s5 offen
    buffer_load_dwordx4 v[116:119], v8, s[12:15], s5 offen offset:1024
    s_add_u32 s5, s5, 2048

    buffer_load_dwordx4 v[120:123], v8, s[12:15], s5 offen
    buffer_load_dwordx4 v[124:127], v8, s[12:15], s5 offen offset:1024
    s_add_u32 s5, s5, 2048

    buffer_load_dwordx4 v[128:131], v8, s[12:15], s5 offen
    buffer_load_dwordx4 v[132:135], v8, s[12:15], s5 offen offset:1024
    s_add_u32 s5, s5, 2048

    buffer_load_dwordx4 v[136:139], v8, s[12:15], s5 offen
    buffer_load_dwordx4 v[140:143], v8, s[12:15], s5 offen offset:1024
    s_add_u32 s5, s5, 2048

    buffer_load_dwordx4 v[144:147], v8, s[12:15], s5 offen
    buffer_load_dwordx4 v[148:151], v8, s[12:15], s5 offen offset:1024
    s_add_u32 s5, s5, 2048

    buffer_load_dwordx4 v[152:155], v8, s[12:15], s5 offen
    buffer_load_dwordx4 v[156:159], v8, s[12:15], s5 offen offset:1024
    s_add_u32 s5, s5, 2048

    buffer_load_dwordx4 v[160:163], v8, s[12:15], s5 offen
    buffer_load_dwordx4 v[164:167], v8, s[12:15], s5 offen offset:1024
    s_add_u32 s5, s5, 2048

    buffer_load_dwordx4 v[168:171], v8, s[12:15], s5 offen
    buffer_load_dwordx4 v[172:175], v8, s[12:15], s5 offen offset:1024
    s_add_u32 s5, s5, 2048

    buffer_load_dwordx4 v[176:179], v8, s[12:15], s5 offen
    buffer_load_dwordx4 v[180:183], v8, s[12:15], s5 offen offset:1024
    s_add_u32 s5, s5, 2048

    buffer_load_dwordx4 v[184:187], v8, s[12:15], s5 offen
    buffer_load_dwordx4 v[188:191], v8, s[12:15], s5 offen offset:1024
    s_add_u32 s5, s5, 2048

    s_waitcnt vmcnt(32)
    v_lshlrev_b32 v24, 16, v16
    v_and_b32 v25, 0xffff0000, v16
    v_lshlrev_b32 v26, 16, v17
    v_and_b32 v27, 0xffff0000, v17
    v_lshlrev_b32 v28, 16, v18
    v_and_b32 v29, 0xffff0000, v18
    v_lshlrev_b32 v30, 16, v19
    v_and_b32 v31, 0xffff0000, v19
    v_lshlrev_b32 v32, 16, v20
    v_and_b32 v33, 0xffff0000, v20
    v_lshlrev_b32 v34, 16, v21
    v_and_b32 v35, 0xffff0000, v21
    v_lshlrev_b32 v36, 16, v22
    v_and_b32 v37, 0xffff0000, v22
    v_lshlrev_b32 v38, 16, v23
    v_and_b32 v39, 0xffff0000, v23
    s_mov_b32 s38, 0xbfb8aa3b
    v_mov_b32 v60, 0
    s_waitcnt vmcnt(30)
    v_lshlrev_b32 v40, 16, v64
    v_and_b32 v41, 0xffff0000, v64
    v_mul_f32 v40, v40, v24
    v_mul_f32 v41, v41, v25
    v_cvt_pk_bf16_f32 v40, v40, v41
    v_and_b32 v41, 0xffff0000, v40
    v_lshlrev_b32 v40, 16, v40

    v_lshlrev_b32 v42, 16, v65
    v_and_b32 v43, 0xffff0000, v65
    v_mul_f32 v42, v42, v26
    v_mul_f32 v43, v43, v27
    v_cvt_pk_bf16_f32 v42, v42, v43
    v_and_b32 v43, 0xffff0000, v42
    v_lshlrev_b32 v42, 16, v42

    v_lshlrev_b32 v44, 16, v66
    v_and_b32 v45, 0xffff0000, v66
    v_mul_f32 v44, v44, v28
    v_mul_f32 v45, v45, v29
    v_cvt_pk_bf16_f32 v44, v44, v45
    v_and_b32 v45, 0xffff0000, v44
    v_lshlrev_b32 v44, 16, v44

    v_lshlrev_b32 v46, 16, v67
    v_and_b32 v47, 0xffff0000, v67
    v_mul_f32 v46, v46, v30
    v_mul_f32 v47, v47, v31
    v_cvt_pk_bf16_f32 v46, v46, v47
    v_and_b32 v47, 0xffff0000, v46
    v_lshlrev_b32 v46, 16, v46

    v_lshlrev_b32 v48, 16, v68
    v_and_b32 v49, 0xffff0000, v68
    v_mul_f32 v48, v48, v32
    v_mul_f32 v49, v49, v33
    v_cvt_pk_bf16_f32 v48, v48, v49
    v_and_b32 v49, 0xffff0000, v48
    v_lshlrev_b32 v48, 16, v48

    v_lshlrev_b32 v50, 16, v69
    v_and_b32 v51, 0xffff0000, v69
    v_mul_f32 v50, v50, v34
    v_mul_f32 v51, v51, v35
    v_cvt_pk_bf16_f32 v50, v50, v51
    v_and_b32 v51, 0xffff0000, v50
    v_lshlrev_b32 v50, 16, v50

    v_lshlrev_b32 v52, 16, v70
    v_and_b32 v53, 0xffff0000, v70
    v_mul_f32 v52, v52, v36
    v_mul_f32 v53, v53, v37
    v_cvt_pk_bf16_f32 v52, v52, v53
    v_and_b32 v53, 0xffff0000, v52
    v_lshlrev_b32 v52, 16, v52

    v_lshlrev_b32 v54, 16, v71
    v_and_b32 v55, 0xffff0000, v71
    v_mul_f32 v54, v54, v38
    v_mul_f32 v55, v55, v39
    v_cvt_pk_bf16_f32 v54, v54, v55
    v_and_b32 v55, 0xffff0000, v54
    v_lshlrev_b32 v54, 16, v54

    v_add_f32 v40, v40, v48
    v_add_f32 v41, v41, v49
    v_add_f32 v42, v42, v50
    v_add_f32 v43, v43, v51
    v_add_f32 v44, v44, v52
    v_add_f32 v45, v45, v53
    v_add_f32 v46, v46, v54
    v_add_f32 v47, v47, v55
    v_add_f32 v40, v40, v44
    v_add_f32 v41, v41, v45
    v_add_f32 v42, v42, v46
    v_add_f32 v43, v43, v47
    v_add_f32 v40, v40, v42
    v_add_f32 v41, v41, v43
    v_add_f32 v40, v40, v41
    v_mov_b32 v41, v40
    s_nop 1
    v_permlane32_swap_b32 v40, v41
    v_add_f32 v40, v40, v41
    v_mov_b32 v41, v40
    s_nop 1
    v_permlane16_swap_b32 v40, v41
    v_add_f32 v40, v40, v41
    s_nop 1
    v_add_f32_dpp v40, v40, v40 row_ror:8 row_mask:0xf bank_mask:0xf
    s_nop 1
    v_add_f32_dpp v40, v40, v40 row_ror:4 row_mask:0xf bank_mask:0xf
    s_nop 1
    v_add_f32_dpp v40, v40, v40 row_ror:2 row_mask:0xf bank_mask:0xf
    s_nop 1
    v_add_f32_dpp v40, v40, v40 row_ror:1 row_mask:0xf bank_mask:0xf
    v_cvt_pk_bf16_f32 v40, v40, v40
    v_lshlrev_b32 v40, 16, v40
    v_mul_f32 v40, s38, v40
    v_exp_f32 v40, v40
    s_nop 0
    v_add_f32 v40, 1.0, v40
    v_rcp_f32 v40, v40
    s_nop 0
    v_cvt_pk_bf16_f32 v40, v40, v40
    v_lshlrev_b32 v40, 16, v40

    v_cmp_eq_u32 vcc, 0, v1
    s_nop 1
    v_cndmask_b32 v60, v60, v40, vcc
    s_waitcnt vmcnt(28)
    v_lshlrev_b32 v40, 16, v72
    v_and_b32 v41, 0xffff0000, v72
    v_mul_f32 v40, v40, v24
    v_mul_f32 v41, v41, v25
    v_cvt_pk_bf16_f32 v40, v40, v41
    v_and_b32 v41, 0xffff0000, v40
    v_lshlrev_b32 v40, 16, v40

    v_lshlrev_b32 v42, 16, v73
    v_and_b32 v43, 0xffff0000, v73
    v_mul_f32 v42, v42, v26
    v_mul_f32 v43, v43, v27
    v_cvt_pk_bf16_f32 v42, v42, v43
    v_and_b32 v43, 0xffff0000, v42
    v_lshlrev_b32 v42, 16, v42

    v_lshlrev_b32 v44, 16, v74
    v_and_b32 v45, 0xffff0000, v74
    v_mul_f32 v44, v44, v28
    v_mul_f32 v45, v45, v29
    v_cvt_pk_bf16_f32 v44, v44, v45
    v_and_b32 v45, 0xffff0000, v44
    v_lshlrev_b32 v44, 16, v44

    v_lshlrev_b32 v46, 16, v75
    v_and_b32 v47, 0xffff0000, v75
    v_mul_f32 v46, v46, v30
    v_mul_f32 v47, v47, v31
    v_cvt_pk_bf16_f32 v46, v46, v47
    v_and_b32 v47, 0xffff0000, v46
    v_lshlrev_b32 v46, 16, v46

    v_lshlrev_b32 v48, 16, v76
    v_and_b32 v49, 0xffff0000, v76
    v_mul_f32 v48, v48, v32
    v_mul_f32 v49, v49, v33
    v_cvt_pk_bf16_f32 v48, v48, v49
    v_and_b32 v49, 0xffff0000, v48
    v_lshlrev_b32 v48, 16, v48

    v_lshlrev_b32 v50, 16, v77
    v_and_b32 v51, 0xffff0000, v77
    v_mul_f32 v50, v50, v34
    v_mul_f32 v51, v51, v35
    v_cvt_pk_bf16_f32 v50, v50, v51
    v_and_b32 v51, 0xffff0000, v50
    v_lshlrev_b32 v50, 16, v50

    v_lshlrev_b32 v52, 16, v78
    v_and_b32 v53, 0xffff0000, v78
    v_mul_f32 v52, v52, v36
    v_mul_f32 v53, v53, v37
    v_cvt_pk_bf16_f32 v52, v52, v53
    v_and_b32 v53, 0xffff0000, v52
    v_lshlrev_b32 v52, 16, v52

    v_lshlrev_b32 v54, 16, v79
    v_and_b32 v55, 0xffff0000, v79
    v_mul_f32 v54, v54, v38
    v_mul_f32 v55, v55, v39
    v_cvt_pk_bf16_f32 v54, v54, v55
    v_and_b32 v55, 0xffff0000, v54
    v_lshlrev_b32 v54, 16, v54

    v_add_f32 v40, v40, v48
    v_add_f32 v41, v41, v49
    v_add_f32 v42, v42, v50
    v_add_f32 v43, v43, v51
    v_add_f32 v44, v44, v52
    v_add_f32 v45, v45, v53
    v_add_f32 v46, v46, v54
    v_add_f32 v47, v47, v55
    v_add_f32 v40, v40, v44
    v_add_f32 v41, v41, v45
    v_add_f32 v42, v42, v46
    v_add_f32 v43, v43, v47
    v_add_f32 v40, v40, v42
    v_add_f32 v41, v41, v43
    v_add_f32 v40, v40, v41
    v_mov_b32 v41, v40
    s_nop 1
    v_permlane32_swap_b32 v40, v41
    v_add_f32 v40, v40, v41
    v_mov_b32 v41, v40
    s_nop 1
    v_permlane16_swap_b32 v40, v41
    v_add_f32 v40, v40, v41
    s_nop 1
    v_add_f32_dpp v40, v40, v40 row_ror:8 row_mask:0xf bank_mask:0xf
    s_nop 1
    v_add_f32_dpp v40, v40, v40 row_ror:4 row_mask:0xf bank_mask:0xf
    s_nop 1
    v_add_f32_dpp v40, v40, v40 row_ror:2 row_mask:0xf bank_mask:0xf
    s_nop 1
    v_add_f32_dpp v40, v40, v40 row_ror:1 row_mask:0xf bank_mask:0xf
    v_cvt_pk_bf16_f32 v40, v40, v40
    v_lshlrev_b32 v40, 16, v40
    v_mul_f32 v40, s38, v40
    v_exp_f32 v40, v40
    s_nop 0
    v_add_f32 v40, 1.0, v40
    v_rcp_f32 v40, v40
    s_nop 0
    v_cvt_pk_bf16_f32 v40, v40, v40
    v_lshlrev_b32 v40, 16, v40

    v_cmp_eq_u32 vcc, 1, v1
    s_nop 1
    v_cndmask_b32 v60, v60, v40, vcc
    s_waitcnt vmcnt(26)
    v_lshlrev_b32 v40, 16, v80
    v_and_b32 v41, 0xffff0000, v80
    v_mul_f32 v40, v40, v24
    v_mul_f32 v41, v41, v25
    v_cvt_pk_bf16_f32 v40, v40, v41
    v_and_b32 v41, 0xffff0000, v40
    v_lshlrev_b32 v40, 16, v40

    v_lshlrev_b32 v42, 16, v81
    v_and_b32 v43, 0xffff0000, v81
    v_mul_f32 v42, v42, v26
    v_mul_f32 v43, v43, v27
    v_cvt_pk_bf16_f32 v42, v42, v43
    v_and_b32 v43, 0xffff0000, v42
    v_lshlrev_b32 v42, 16, v42

    v_lshlrev_b32 v44, 16, v82
    v_and_b32 v45, 0xffff0000, v82
    v_mul_f32 v44, v44, v28
    v_mul_f32 v45, v45, v29
    v_cvt_pk_bf16_f32 v44, v44, v45
    v_and_b32 v45, 0xffff0000, v44
    v_lshlrev_b32 v44, 16, v44

    v_lshlrev_b32 v46, 16, v83
    v_and_b32 v47, 0xffff0000, v83
    v_mul_f32 v46, v46, v30
    v_mul_f32 v47, v47, v31
    v_cvt_pk_bf16_f32 v46, v46, v47
    v_and_b32 v47, 0xffff0000, v46
    v_lshlrev_b32 v46, 16, v46

    v_lshlrev_b32 v48, 16, v84
    v_and_b32 v49, 0xffff0000, v84
    v_mul_f32 v48, v48, v32
    v_mul_f32 v49, v49, v33
    v_cvt_pk_bf16_f32 v48, v48, v49
    v_and_b32 v49, 0xffff0000, v48
    v_lshlrev_b32 v48, 16, v48

    v_lshlrev_b32 v50, 16, v85
    v_and_b32 v51, 0xffff0000, v85
    v_mul_f32 v50, v50, v34
    v_mul_f32 v51, v51, v35
    v_cvt_pk_bf16_f32 v50, v50, v51
    v_and_b32 v51, 0xffff0000, v50
    v_lshlrev_b32 v50, 16, v50

    v_lshlrev_b32 v52, 16, v86
    v_and_b32 v53, 0xffff0000, v86
    v_mul_f32 v52, v52, v36
    v_mul_f32 v53, v53, v37
    v_cvt_pk_bf16_f32 v52, v52, v53
    v_and_b32 v53, 0xffff0000, v52
    v_lshlrev_b32 v52, 16, v52

    v_lshlrev_b32 v54, 16, v87
    v_and_b32 v55, 0xffff0000, v87
    v_mul_f32 v54, v54, v38
    v_mul_f32 v55, v55, v39
    v_cvt_pk_bf16_f32 v54, v54, v55
    v_and_b32 v55, 0xffff0000, v54
    v_lshlrev_b32 v54, 16, v54

    v_add_f32 v40, v40, v48
    v_add_f32 v41, v41, v49
    v_add_f32 v42, v42, v50
    v_add_f32 v43, v43, v51
    v_add_f32 v44, v44, v52
    v_add_f32 v45, v45, v53
    v_add_f32 v46, v46, v54
    v_add_f32 v47, v47, v55
    v_add_f32 v40, v40, v44
    v_add_f32 v41, v41, v45
    v_add_f32 v42, v42, v46
    v_add_f32 v43, v43, v47
    v_add_f32 v40, v40, v42
    v_add_f32 v41, v41, v43
    v_add_f32 v40, v40, v41
    v_mov_b32 v41, v40
    s_nop 1
    v_permlane32_swap_b32 v40, v41
    v_add_f32 v40, v40, v41
    v_mov_b32 v41, v40
    s_nop 1
    v_permlane16_swap_b32 v40, v41
    v_add_f32 v40, v40, v41
    s_nop 1
    v_add_f32_dpp v40, v40, v40 row_ror:8 row_mask:0xf bank_mask:0xf
    s_nop 1
    v_add_f32_dpp v40, v40, v40 row_ror:4 row_mask:0xf bank_mask:0xf
    s_nop 1
    v_add_f32_dpp v40, v40, v40 row_ror:2 row_mask:0xf bank_mask:0xf
    s_nop 1
    v_add_f32_dpp v40, v40, v40 row_ror:1 row_mask:0xf bank_mask:0xf
    v_cvt_pk_bf16_f32 v40, v40, v40
    v_lshlrev_b32 v40, 16, v40
    v_mul_f32 v40, s38, v40
    v_exp_f32 v40, v40
    s_nop 0
    v_add_f32 v40, 1.0, v40
    v_rcp_f32 v40, v40
    s_nop 0
    v_cvt_pk_bf16_f32 v40, v40, v40
    v_lshlrev_b32 v40, 16, v40

    v_cmp_eq_u32 vcc, 2, v1
    s_nop 1
    v_cndmask_b32 v60, v60, v40, vcc
    s_waitcnt vmcnt(24)
    v_lshlrev_b32 v40, 16, v88
    v_and_b32 v41, 0xffff0000, v88
    v_mul_f32 v40, v40, v24
    v_mul_f32 v41, v41, v25
    v_cvt_pk_bf16_f32 v40, v40, v41
    v_and_b32 v41, 0xffff0000, v40
    v_lshlrev_b32 v40, 16, v40

    v_lshlrev_b32 v42, 16, v89
    v_and_b32 v43, 0xffff0000, v89
    v_mul_f32 v42, v42, v26
    v_mul_f32 v43, v43, v27
    v_cvt_pk_bf16_f32 v42, v42, v43
    v_and_b32 v43, 0xffff0000, v42
    v_lshlrev_b32 v42, 16, v42

    v_lshlrev_b32 v44, 16, v90
    v_and_b32 v45, 0xffff0000, v90
    v_mul_f32 v44, v44, v28
    v_mul_f32 v45, v45, v29
    v_cvt_pk_bf16_f32 v44, v44, v45
    v_and_b32 v45, 0xffff0000, v44
    v_lshlrev_b32 v44, 16, v44

    v_lshlrev_b32 v46, 16, v91
    v_and_b32 v47, 0xffff0000, v91
    v_mul_f32 v46, v46, v30
    v_mul_f32 v47, v47, v31
    v_cvt_pk_bf16_f32 v46, v46, v47
    v_and_b32 v47, 0xffff0000, v46
    v_lshlrev_b32 v46, 16, v46

    v_lshlrev_b32 v48, 16, v92
    v_and_b32 v49, 0xffff0000, v92
    v_mul_f32 v48, v48, v32
    v_mul_f32 v49, v49, v33
    v_cvt_pk_bf16_f32 v48, v48, v49
    v_and_b32 v49, 0xffff0000, v48
    v_lshlrev_b32 v48, 16, v48

    v_lshlrev_b32 v50, 16, v93
    v_and_b32 v51, 0xffff0000, v93
    v_mul_f32 v50, v50, v34
    v_mul_f32 v51, v51, v35
    v_cvt_pk_bf16_f32 v50, v50, v51
    v_and_b32 v51, 0xffff0000, v50
    v_lshlrev_b32 v50, 16, v50

    v_lshlrev_b32 v52, 16, v94
    v_and_b32 v53, 0xffff0000, v94
    v_mul_f32 v52, v52, v36
    v_mul_f32 v53, v53, v37
    v_cvt_pk_bf16_f32 v52, v52, v53
    v_and_b32 v53, 0xffff0000, v52
    v_lshlrev_b32 v52, 16, v52

    v_lshlrev_b32 v54, 16, v95
    v_and_b32 v55, 0xffff0000, v95
    v_mul_f32 v54, v54, v38
    v_mul_f32 v55, v55, v39
    v_cvt_pk_bf16_f32 v54, v54, v55
    v_and_b32 v55, 0xffff0000, v54
    v_lshlrev_b32 v54, 16, v54

    v_add_f32 v40, v40, v48
    v_add_f32 v41, v41, v49
    v_add_f32 v42, v42, v50
    v_add_f32 v43, v43, v51
    v_add_f32 v44, v44, v52
    v_add_f32 v45, v45, v53
    v_add_f32 v46, v46, v54
    v_add_f32 v47, v47, v55
    v_add_f32 v40, v40, v44
    v_add_f32 v41, v41, v45
    v_add_f32 v42, v42, v46
    v_add_f32 v43, v43, v47
    v_add_f32 v40, v40, v42
    v_add_f32 v41, v41, v43
    v_add_f32 v40, v40, v41
    v_mov_b32 v41, v40
    s_nop 1
    v_permlane32_swap_b32 v40, v41
    v_add_f32 v40, v40, v41
    v_mov_b32 v41, v40
    s_nop 1
    v_permlane16_swap_b32 v40, v41
    v_add_f32 v40, v40, v41
    s_nop 1
    v_add_f32_dpp v40, v40, v40 row_ror:8 row_mask:0xf bank_mask:0xf
    s_nop 1
    v_add_f32_dpp v40, v40, v40 row_ror:4 row_mask:0xf bank_mask:0xf
    s_nop 1
    v_add_f32_dpp v40, v40, v40 row_ror:2 row_mask:0xf bank_mask:0xf
    s_nop 1
    v_add_f32_dpp v40, v40, v40 row_ror:1 row_mask:0xf bank_mask:0xf
    v_cvt_pk_bf16_f32 v40, v40, v40
    v_lshlrev_b32 v40, 16, v40
    v_mul_f32 v40, s38, v40
    v_exp_f32 v40, v40
    s_nop 0
    v_add_f32 v40, 1.0, v40
    v_rcp_f32 v40, v40
    s_nop 0
    v_cvt_pk_bf16_f32 v40, v40, v40
    v_lshlrev_b32 v40, 16, v40

    v_cmp_eq_u32 vcc, 3, v1
    s_nop 1
    v_cndmask_b32 v60, v60, v40, vcc
    s_waitcnt vmcnt(22)
    v_lshlrev_b32 v40, 16, v96
    v_and_b32 v41, 0xffff0000, v96
    v_mul_f32 v40, v40, v24
    v_mul_f32 v41, v41, v25
    v_cvt_pk_bf16_f32 v40, v40, v41
    v_and_b32 v41, 0xffff0000, v40
    v_lshlrev_b32 v40, 16, v40

    v_lshlrev_b32 v42, 16, v97
    v_and_b32 v43, 0xffff0000, v97
    v_mul_f32 v42, v42, v26
    v_mul_f32 v43, v43, v27
    v_cvt_pk_bf16_f32 v42, v42, v43
    v_and_b32 v43, 0xffff0000, v42
    v_lshlrev_b32 v42, 16, v42

    v_lshlrev_b32 v44, 16, v98
    v_and_b32 v45, 0xffff0000, v98
    v_mul_f32 v44, v44, v28
    v_mul_f32 v45, v45, v29
    v_cvt_pk_bf16_f32 v44, v44, v45
    v_and_b32 v45, 0xffff0000, v44
    v_lshlrev_b32 v44, 16, v44

    v_lshlrev_b32 v46, 16, v99
    v_and_b32 v47, 0xffff0000, v99
    v_mul_f32 v46, v46, v30
    v_mul_f32 v47, v47, v31
    v_cvt_pk_bf16_f32 v46, v46, v47
    v_and_b32 v47, 0xffff0000, v46
    v_lshlrev_b32 v46, 16, v46

    v_lshlrev_b32 v48, 16, v100
    v_and_b32 v49, 0xffff0000, v100
    v_mul_f32 v48, v48, v32
    v_mul_f32 v49, v49, v33
    v_cvt_pk_bf16_f32 v48, v48, v49
    v_and_b32 v49, 0xffff0000, v48
    v_lshlrev_b32 v48, 16, v48

    v_lshlrev_b32 v50, 16, v101
    v_and_b32 v51, 0xffff0000, v101
    v_mul_f32 v50, v50, v34
    v_mul_f32 v51, v51, v35
    v_cvt_pk_bf16_f32 v50, v50, v51
    v_and_b32 v51, 0xffff0000, v50
    v_lshlrev_b32 v50, 16, v50

    v_lshlrev_b32 v52, 16, v102
    v_and_b32 v53, 0xffff0000, v102
    v_mul_f32 v52, v52, v36
    v_mul_f32 v53, v53, v37
    v_cvt_pk_bf16_f32 v52, v52, v53
    v_and_b32 v53, 0xffff0000, v52
    v_lshlrev_b32 v52, 16, v52

    v_lshlrev_b32 v54, 16, v103
    v_and_b32 v55, 0xffff0000, v103
    v_mul_f32 v54, v54, v38
    v_mul_f32 v55, v55, v39
    v_cvt_pk_bf16_f32 v54, v54, v55
    v_and_b32 v55, 0xffff0000, v54
    v_lshlrev_b32 v54, 16, v54

    v_add_f32 v40, v40, v48
    v_add_f32 v41, v41, v49
    v_add_f32 v42, v42, v50
    v_add_f32 v43, v43, v51
    v_add_f32 v44, v44, v52
    v_add_f32 v45, v45, v53
    v_add_f32 v46, v46, v54
    v_add_f32 v47, v47, v55
    v_add_f32 v40, v40, v44
    v_add_f32 v41, v41, v45
    v_add_f32 v42, v42, v46
    v_add_f32 v43, v43, v47
    v_add_f32 v40, v40, v42
    v_add_f32 v41, v41, v43
    v_add_f32 v40, v40, v41
    v_mov_b32 v41, v40
    s_nop 1
    v_permlane32_swap_b32 v40, v41
    v_add_f32 v40, v40, v41
    v_mov_b32 v41, v40
    s_nop 1
    v_permlane16_swap_b32 v40, v41
    v_add_f32 v40, v40, v41
    s_nop 1
    v_add_f32_dpp v40, v40, v40 row_ror:8 row_mask:0xf bank_mask:0xf
    s_nop 1
    v_add_f32_dpp v40, v40, v40 row_ror:4 row_mask:0xf bank_mask:0xf
    s_nop 1
    v_add_f32_dpp v40, v40, v40 row_ror:2 row_mask:0xf bank_mask:0xf
    s_nop 1
    v_add_f32_dpp v40, v40, v40 row_ror:1 row_mask:0xf bank_mask:0xf
    v_cvt_pk_bf16_f32 v40, v40, v40
    v_lshlrev_b32 v40, 16, v40
    v_mul_f32 v40, s38, v40
    v_exp_f32 v40, v40
    s_nop 0
    v_add_f32 v40, 1.0, v40
    v_rcp_f32 v40, v40
    s_nop 0
    v_cvt_pk_bf16_f32 v40, v40, v40
    v_lshlrev_b32 v40, 16, v40

    v_cmp_eq_u32 vcc, 4, v1
    s_nop 1
    v_cndmask_b32 v60, v60, v40, vcc
    s_waitcnt vmcnt(20)
    v_lshlrev_b32 v40, 16, v104
    v_and_b32 v41, 0xffff0000, v104
    v_mul_f32 v40, v40, v24
    v_mul_f32 v41, v41, v25
    v_cvt_pk_bf16_f32 v40, v40, v41
    v_and_b32 v41, 0xffff0000, v40
    v_lshlrev_b32 v40, 16, v40

    v_lshlrev_b32 v42, 16, v105
    v_and_b32 v43, 0xffff0000, v105
    v_mul_f32 v42, v42, v26
    v_mul_f32 v43, v43, v27
    v_cvt_pk_bf16_f32 v42, v42, v43
    v_and_b32 v43, 0xffff0000, v42
    v_lshlrev_b32 v42, 16, v42

    v_lshlrev_b32 v44, 16, v106
    v_and_b32 v45, 0xffff0000, v106
    v_mul_f32 v44, v44, v28
    v_mul_f32 v45, v45, v29
    v_cvt_pk_bf16_f32 v44, v44, v45
    v_and_b32 v45, 0xffff0000, v44
    v_lshlrev_b32 v44, 16, v44

    v_lshlrev_b32 v46, 16, v107
    v_and_b32 v47, 0xffff0000, v107
    v_mul_f32 v46, v46, v30
    v_mul_f32 v47, v47, v31
    v_cvt_pk_bf16_f32 v46, v46, v47
    v_and_b32 v47, 0xffff0000, v46
    v_lshlrev_b32 v46, 16, v46

    v_lshlrev_b32 v48, 16, v108
    v_and_b32 v49, 0xffff0000, v108
    v_mul_f32 v48, v48, v32
    v_mul_f32 v49, v49, v33
    v_cvt_pk_bf16_f32 v48, v48, v49
    v_and_b32 v49, 0xffff0000, v48
    v_lshlrev_b32 v48, 16, v48

    v_lshlrev_b32 v50, 16, v109
    v_and_b32 v51, 0xffff0000, v109
    v_mul_f32 v50, v50, v34
    v_mul_f32 v51, v51, v35
    v_cvt_pk_bf16_f32 v50, v50, v51
    v_and_b32 v51, 0xffff0000, v50
    v_lshlrev_b32 v50, 16, v50

    v_lshlrev_b32 v52, 16, v110
    v_and_b32 v53, 0xffff0000, v110
    v_mul_f32 v52, v52, v36
    v_mul_f32 v53, v53, v37
    v_cvt_pk_bf16_f32 v52, v52, v53
    v_and_b32 v53, 0xffff0000, v52
    v_lshlrev_b32 v52, 16, v52

    v_lshlrev_b32 v54, 16, v111
    v_and_b32 v55, 0xffff0000, v111
    v_mul_f32 v54, v54, v38
    v_mul_f32 v55, v55, v39
    v_cvt_pk_bf16_f32 v54, v54, v55
    v_and_b32 v55, 0xffff0000, v54
    v_lshlrev_b32 v54, 16, v54

    v_add_f32 v40, v40, v48
    v_add_f32 v41, v41, v49
    v_add_f32 v42, v42, v50
    v_add_f32 v43, v43, v51
    v_add_f32 v44, v44, v52
    v_add_f32 v45, v45, v53
    v_add_f32 v46, v46, v54
    v_add_f32 v47, v47, v55
    v_add_f32 v40, v40, v44
    v_add_f32 v41, v41, v45
    v_add_f32 v42, v42, v46
    v_add_f32 v43, v43, v47
    v_add_f32 v40, v40, v42
    v_add_f32 v41, v41, v43
    v_add_f32 v40, v40, v41
    v_mov_b32 v41, v40
    s_nop 1
    v_permlane32_swap_b32 v40, v41
    v_add_f32 v40, v40, v41
    v_mov_b32 v41, v40
    s_nop 1
    v_permlane16_swap_b32 v40, v41
    v_add_f32 v40, v40, v41
    s_nop 1
    v_add_f32_dpp v40, v40, v40 row_ror:8 row_mask:0xf bank_mask:0xf
    s_nop 1
    v_add_f32_dpp v40, v40, v40 row_ror:4 row_mask:0xf bank_mask:0xf
    s_nop 1
    v_add_f32_dpp v40, v40, v40 row_ror:2 row_mask:0xf bank_mask:0xf
    s_nop 1
    v_add_f32_dpp v40, v40, v40 row_ror:1 row_mask:0xf bank_mask:0xf
    v_cvt_pk_bf16_f32 v40, v40, v40
    v_lshlrev_b32 v40, 16, v40
    v_mul_f32 v40, s38, v40
    v_exp_f32 v40, v40
    s_nop 0
    v_add_f32 v40, 1.0, v40
    v_rcp_f32 v40, v40
    s_nop 0
    v_cvt_pk_bf16_f32 v40, v40, v40
    v_lshlrev_b32 v40, 16, v40

    v_cmp_eq_u32 vcc, 5, v1
    s_nop 1
    v_cndmask_b32 v60, v60, v40, vcc
    s_waitcnt vmcnt(18)
    v_lshlrev_b32 v40, 16, v112
    v_and_b32 v41, 0xffff0000, v112
    v_mul_f32 v40, v40, v24
    v_mul_f32 v41, v41, v25
    v_cvt_pk_bf16_f32 v40, v40, v41
    v_and_b32 v41, 0xffff0000, v40
    v_lshlrev_b32 v40, 16, v40

    v_lshlrev_b32 v42, 16, v113
    v_and_b32 v43, 0xffff0000, v113
    v_mul_f32 v42, v42, v26
    v_mul_f32 v43, v43, v27
    v_cvt_pk_bf16_f32 v42, v42, v43
    v_and_b32 v43, 0xffff0000, v42
    v_lshlrev_b32 v42, 16, v42

    v_lshlrev_b32 v44, 16, v114
    v_and_b32 v45, 0xffff0000, v114
    v_mul_f32 v44, v44, v28
    v_mul_f32 v45, v45, v29
    v_cvt_pk_bf16_f32 v44, v44, v45
    v_and_b32 v45, 0xffff0000, v44
    v_lshlrev_b32 v44, 16, v44

    v_lshlrev_b32 v46, 16, v115
    v_and_b32 v47, 0xffff0000, v115
    v_mul_f32 v46, v46, v30
    v_mul_f32 v47, v47, v31
    v_cvt_pk_bf16_f32 v46, v46, v47
    v_and_b32 v47, 0xffff0000, v46
    v_lshlrev_b32 v46, 16, v46

    v_lshlrev_b32 v48, 16, v116
    v_and_b32 v49, 0xffff0000, v116
    v_mul_f32 v48, v48, v32
    v_mul_f32 v49, v49, v33
    v_cvt_pk_bf16_f32 v48, v48, v49
    v_and_b32 v49, 0xffff0000, v48
    v_lshlrev_b32 v48, 16, v48

    v_lshlrev_b32 v50, 16, v117
    v_and_b32 v51, 0xffff0000, v117
    v_mul_f32 v50, v50, v34
    v_mul_f32 v51, v51, v35
    v_cvt_pk_bf16_f32 v50, v50, v51
    v_and_b32 v51, 0xffff0000, v50
    v_lshlrev_b32 v50, 16, v50

    v_lshlrev_b32 v52, 16, v118
    v_and_b32 v53, 0xffff0000, v118
    v_mul_f32 v52, v52, v36
    v_mul_f32 v53, v53, v37
    v_cvt_pk_bf16_f32 v52, v52, v53
    v_and_b32 v53, 0xffff0000, v52
    v_lshlrev_b32 v52, 16, v52

    v_lshlrev_b32 v54, 16, v119
    v_and_b32 v55, 0xffff0000, v119
    v_mul_f32 v54, v54, v38
    v_mul_f32 v55, v55, v39
    v_cvt_pk_bf16_f32 v54, v54, v55
    v_and_b32 v55, 0xffff0000, v54
    v_lshlrev_b32 v54, 16, v54

    v_add_f32 v40, v40, v48
    v_add_f32 v41, v41, v49
    v_add_f32 v42, v42, v50
    v_add_f32 v43, v43, v51
    v_add_f32 v44, v44, v52
    v_add_f32 v45, v45, v53
    v_add_f32 v46, v46, v54
    v_add_f32 v47, v47, v55
    v_add_f32 v40, v40, v44
    v_add_f32 v41, v41, v45
    v_add_f32 v42, v42, v46
    v_add_f32 v43, v43, v47
    v_add_f32 v40, v40, v42
    v_add_f32 v41, v41, v43
    v_add_f32 v40, v40, v41
    v_mov_b32 v41, v40
    s_nop 1
    v_permlane32_swap_b32 v40, v41
    v_add_f32 v40, v40, v41
    v_mov_b32 v41, v40
    s_nop 1
    v_permlane16_swap_b32 v40, v41
    v_add_f32 v40, v40, v41
    s_nop 1
    v_add_f32_dpp v40, v40, v40 row_ror:8 row_mask:0xf bank_mask:0xf
    s_nop 1
    v_add_f32_dpp v40, v40, v40 row_ror:4 row_mask:0xf bank_mask:0xf
    s_nop 1
    v_add_f32_dpp v40, v40, v40 row_ror:2 row_mask:0xf bank_mask:0xf
    s_nop 1
    v_add_f32_dpp v40, v40, v40 row_ror:1 row_mask:0xf bank_mask:0xf
    v_cvt_pk_bf16_f32 v40, v40, v40
    v_lshlrev_b32 v40, 16, v40
    v_mul_f32 v40, s38, v40
    v_exp_f32 v40, v40
    s_nop 0
    v_add_f32 v40, 1.0, v40
    v_rcp_f32 v40, v40
    s_nop 0
    v_cvt_pk_bf16_f32 v40, v40, v40
    v_lshlrev_b32 v40, 16, v40

    v_cmp_eq_u32 vcc, 6, v1
    s_nop 1
    v_cndmask_b32 v60, v60, v40, vcc
    s_waitcnt vmcnt(16)
    v_lshlrev_b32 v40, 16, v120
    v_and_b32 v41, 0xffff0000, v120
    v_mul_f32 v40, v40, v24
    v_mul_f32 v41, v41, v25
    v_cvt_pk_bf16_f32 v40, v40, v41
    v_and_b32 v41, 0xffff0000, v40
    v_lshlrev_b32 v40, 16, v40

    v_lshlrev_b32 v42, 16, v121
    v_and_b32 v43, 0xffff0000, v121
    v_mul_f32 v42, v42, v26
    v_mul_f32 v43, v43, v27
    v_cvt_pk_bf16_f32 v42, v42, v43
    v_and_b32 v43, 0xffff0000, v42
    v_lshlrev_b32 v42, 16, v42

    v_lshlrev_b32 v44, 16, v122
    v_and_b32 v45, 0xffff0000, v122
    v_mul_f32 v44, v44, v28
    v_mul_f32 v45, v45, v29
    v_cvt_pk_bf16_f32 v44, v44, v45
    v_and_b32 v45, 0xffff0000, v44
    v_lshlrev_b32 v44, 16, v44

    v_lshlrev_b32 v46, 16, v123
    v_and_b32 v47, 0xffff0000, v123
    v_mul_f32 v46, v46, v30
    v_mul_f32 v47, v47, v31
    v_cvt_pk_bf16_f32 v46, v46, v47
    v_and_b32 v47, 0xffff0000, v46
    v_lshlrev_b32 v46, 16, v46

    v_lshlrev_b32 v48, 16, v124
    v_and_b32 v49, 0xffff0000, v124
    v_mul_f32 v48, v48, v32
    v_mul_f32 v49, v49, v33
    v_cvt_pk_bf16_f32 v48, v48, v49
    v_and_b32 v49, 0xffff0000, v48
    v_lshlrev_b32 v48, 16, v48

    v_lshlrev_b32 v50, 16, v125
    v_and_b32 v51, 0xffff0000, v125
    v_mul_f32 v50, v50, v34
    v_mul_f32 v51, v51, v35
    v_cvt_pk_bf16_f32 v50, v50, v51
    v_and_b32 v51, 0xffff0000, v50
    v_lshlrev_b32 v50, 16, v50

    v_lshlrev_b32 v52, 16, v126
    v_and_b32 v53, 0xffff0000, v126
    v_mul_f32 v52, v52, v36
    v_mul_f32 v53, v53, v37
    v_cvt_pk_bf16_f32 v52, v52, v53
    v_and_b32 v53, 0xffff0000, v52
    v_lshlrev_b32 v52, 16, v52

    v_lshlrev_b32 v54, 16, v127
    v_and_b32 v55, 0xffff0000, v127
    v_mul_f32 v54, v54, v38
    v_mul_f32 v55, v55, v39
    v_cvt_pk_bf16_f32 v54, v54, v55
    v_and_b32 v55, 0xffff0000, v54
    v_lshlrev_b32 v54, 16, v54

    v_add_f32 v40, v40, v48
    v_add_f32 v41, v41, v49
    v_add_f32 v42, v42, v50
    v_add_f32 v43, v43, v51
    v_add_f32 v44, v44, v52
    v_add_f32 v45, v45, v53
    v_add_f32 v46, v46, v54
    v_add_f32 v47, v47, v55
    v_add_f32 v40, v40, v44
    v_add_f32 v41, v41, v45
    v_add_f32 v42, v42, v46
    v_add_f32 v43, v43, v47
    v_add_f32 v40, v40, v42
    v_add_f32 v41, v41, v43
    v_add_f32 v40, v40, v41
    v_mov_b32 v41, v40
    s_nop 1
    v_permlane32_swap_b32 v40, v41
    v_add_f32 v40, v40, v41
    v_mov_b32 v41, v40
    s_nop 1
    v_permlane16_swap_b32 v40, v41
    v_add_f32 v40, v40, v41
    s_nop 1
    v_add_f32_dpp v40, v40, v40 row_ror:8 row_mask:0xf bank_mask:0xf
    s_nop 1
    v_add_f32_dpp v40, v40, v40 row_ror:4 row_mask:0xf bank_mask:0xf
    s_nop 1
    v_add_f32_dpp v40, v40, v40 row_ror:2 row_mask:0xf bank_mask:0xf
    s_nop 1
    v_add_f32_dpp v40, v40, v40 row_ror:1 row_mask:0xf bank_mask:0xf
    v_cvt_pk_bf16_f32 v40, v40, v40
    v_lshlrev_b32 v40, 16, v40
    v_mul_f32 v40, s38, v40
    v_exp_f32 v40, v40
    s_nop 0
    v_add_f32 v40, 1.0, v40
    v_rcp_f32 v40, v40
    s_nop 0
    v_cvt_pk_bf16_f32 v40, v40, v40
    v_lshlrev_b32 v40, 16, v40

    v_cmp_eq_u32 vcc, 7, v1
    s_nop 1
    v_cndmask_b32 v60, v60, v40, vcc
    s_waitcnt vmcnt(14)
    v_lshlrev_b32 v40, 16, v128
    v_and_b32 v41, 0xffff0000, v128
    v_mul_f32 v40, v40, v24
    v_mul_f32 v41, v41, v25
    v_cvt_pk_bf16_f32 v40, v40, v41
    v_and_b32 v41, 0xffff0000, v40
    v_lshlrev_b32 v40, 16, v40

    v_lshlrev_b32 v42, 16, v129
    v_and_b32 v43, 0xffff0000, v129
    v_mul_f32 v42, v42, v26
    v_mul_f32 v43, v43, v27
    v_cvt_pk_bf16_f32 v42, v42, v43
    v_and_b32 v43, 0xffff0000, v42
    v_lshlrev_b32 v42, 16, v42

    v_lshlrev_b32 v44, 16, v130
    v_and_b32 v45, 0xffff0000, v130
    v_mul_f32 v44, v44, v28
    v_mul_f32 v45, v45, v29
    v_cvt_pk_bf16_f32 v44, v44, v45
    v_and_b32 v45, 0xffff0000, v44
    v_lshlrev_b32 v44, 16, v44

    v_lshlrev_b32 v46, 16, v131
    v_and_b32 v47, 0xffff0000, v131
    v_mul_f32 v46, v46, v30
    v_mul_f32 v47, v47, v31
    v_cvt_pk_bf16_f32 v46, v46, v47
    v_and_b32 v47, 0xffff0000, v46
    v_lshlrev_b32 v46, 16, v46

    v_lshlrev_b32 v48, 16, v132
    v_and_b32 v49, 0xffff0000, v132
    v_mul_f32 v48, v48, v32
    v_mul_f32 v49, v49, v33
    v_cvt_pk_bf16_f32 v48, v48, v49
    v_and_b32 v49, 0xffff0000, v48
    v_lshlrev_b32 v48, 16, v48

    v_lshlrev_b32 v50, 16, v133
    v_and_b32 v51, 0xffff0000, v133
    v_mul_f32 v50, v50, v34
    v_mul_f32 v51, v51, v35
    v_cvt_pk_bf16_f32 v50, v50, v51
    v_and_b32 v51, 0xffff0000, v50
    v_lshlrev_b32 v50, 16, v50

    v_lshlrev_b32 v52, 16, v134
    v_and_b32 v53, 0xffff0000, v134
    v_mul_f32 v52, v52, v36
    v_mul_f32 v53, v53, v37
    v_cvt_pk_bf16_f32 v52, v52, v53
    v_and_b32 v53, 0xffff0000, v52
    v_lshlrev_b32 v52, 16, v52

    v_lshlrev_b32 v54, 16, v135
    v_and_b32 v55, 0xffff0000, v135
    v_mul_f32 v54, v54, v38
    v_mul_f32 v55, v55, v39
    v_cvt_pk_bf16_f32 v54, v54, v55
    v_and_b32 v55, 0xffff0000, v54
    v_lshlrev_b32 v54, 16, v54

    v_add_f32 v40, v40, v48
    v_add_f32 v41, v41, v49
    v_add_f32 v42, v42, v50
    v_add_f32 v43, v43, v51
    v_add_f32 v44, v44, v52
    v_add_f32 v45, v45, v53
    v_add_f32 v46, v46, v54
    v_add_f32 v47, v47, v55
    v_add_f32 v40, v40, v44
    v_add_f32 v41, v41, v45
    v_add_f32 v42, v42, v46
    v_add_f32 v43, v43, v47
    v_add_f32 v40, v40, v42
    v_add_f32 v41, v41, v43
    v_add_f32 v40, v40, v41
    v_mov_b32 v41, v40
    s_nop 1
    v_permlane32_swap_b32 v40, v41
    v_add_f32 v40, v40, v41
    v_mov_b32 v41, v40
    s_nop 1
    v_permlane16_swap_b32 v40, v41
    v_add_f32 v40, v40, v41
    s_nop 1
    v_add_f32_dpp v40, v40, v40 row_ror:8 row_mask:0xf bank_mask:0xf
    s_nop 1
    v_add_f32_dpp v40, v40, v40 row_ror:4 row_mask:0xf bank_mask:0xf
    s_nop 1
    v_add_f32_dpp v40, v40, v40 row_ror:2 row_mask:0xf bank_mask:0xf
    s_nop 1
    v_add_f32_dpp v40, v40, v40 row_ror:1 row_mask:0xf bank_mask:0xf
    v_cvt_pk_bf16_f32 v40, v40, v40
    v_lshlrev_b32 v40, 16, v40
    v_mul_f32 v40, s38, v40
    v_exp_f32 v40, v40
    s_nop 0
    v_add_f32 v40, 1.0, v40
    v_rcp_f32 v40, v40
    s_nop 0
    v_cvt_pk_bf16_f32 v40, v40, v40
    v_lshlrev_b32 v40, 16, v40

    v_cmp_eq_u32 vcc, 8, v1
    s_nop 1
    v_cndmask_b32 v60, v60, v40, vcc
    s_waitcnt vmcnt(12)
    v_lshlrev_b32 v40, 16, v136
    v_and_b32 v41, 0xffff0000, v136
    v_mul_f32 v40, v40, v24
    v_mul_f32 v41, v41, v25
    v_cvt_pk_bf16_f32 v40, v40, v41
    v_and_b32 v41, 0xffff0000, v40
    v_lshlrev_b32 v40, 16, v40

    v_lshlrev_b32 v42, 16, v137
    v_and_b32 v43, 0xffff0000, v137
    v_mul_f32 v42, v42, v26
    v_mul_f32 v43, v43, v27
    v_cvt_pk_bf16_f32 v42, v42, v43
    v_and_b32 v43, 0xffff0000, v42
    v_lshlrev_b32 v42, 16, v42

    v_lshlrev_b32 v44, 16, v138
    v_and_b32 v45, 0xffff0000, v138
    v_mul_f32 v44, v44, v28
    v_mul_f32 v45, v45, v29
    v_cvt_pk_bf16_f32 v44, v44, v45
    v_and_b32 v45, 0xffff0000, v44
    v_lshlrev_b32 v44, 16, v44

    v_lshlrev_b32 v46, 16, v139
    v_and_b32 v47, 0xffff0000, v139
    v_mul_f32 v46, v46, v30
    v_mul_f32 v47, v47, v31
    v_cvt_pk_bf16_f32 v46, v46, v47
    v_and_b32 v47, 0xffff0000, v46
    v_lshlrev_b32 v46, 16, v46

    v_lshlrev_b32 v48, 16, v140
    v_and_b32 v49, 0xffff0000, v140
    v_mul_f32 v48, v48, v32
    v_mul_f32 v49, v49, v33
    v_cvt_pk_bf16_f32 v48, v48, v49
    v_and_b32 v49, 0xffff0000, v48
    v_lshlrev_b32 v48, 16, v48

    v_lshlrev_b32 v50, 16, v141
    v_and_b32 v51, 0xffff0000, v141
    v_mul_f32 v50, v50, v34
    v_mul_f32 v51, v51, v35
    v_cvt_pk_bf16_f32 v50, v50, v51
    v_and_b32 v51, 0xffff0000, v50
    v_lshlrev_b32 v50, 16, v50

    v_lshlrev_b32 v52, 16, v142
    v_and_b32 v53, 0xffff0000, v142
    v_mul_f32 v52, v52, v36
    v_mul_f32 v53, v53, v37
    v_cvt_pk_bf16_f32 v52, v52, v53
    v_and_b32 v53, 0xffff0000, v52
    v_lshlrev_b32 v52, 16, v52

    v_lshlrev_b32 v54, 16, v143
    v_and_b32 v55, 0xffff0000, v143
    v_mul_f32 v54, v54, v38
    v_mul_f32 v55, v55, v39
    v_cvt_pk_bf16_f32 v54, v54, v55
    v_and_b32 v55, 0xffff0000, v54
    v_lshlrev_b32 v54, 16, v54

    v_add_f32 v40, v40, v48
    v_add_f32 v41, v41, v49
    v_add_f32 v42, v42, v50
    v_add_f32 v43, v43, v51
    v_add_f32 v44, v44, v52
    v_add_f32 v45, v45, v53
    v_add_f32 v46, v46, v54
    v_add_f32 v47, v47, v55
    v_add_f32 v40, v40, v44
    v_add_f32 v41, v41, v45
    v_add_f32 v42, v42, v46
    v_add_f32 v43, v43, v47
    v_add_f32 v40, v40, v42
    v_add_f32 v41, v41, v43
    v_add_f32 v40, v40, v41
    v_mov_b32 v41, v40
    s_nop 1
    v_permlane32_swap_b32 v40, v41
    v_add_f32 v40, v40, v41
    v_mov_b32 v41, v40
    s_nop 1
    v_permlane16_swap_b32 v40, v41
    v_add_f32 v40, v40, v41
    s_nop 1
    v_add_f32_dpp v40, v40, v40 row_ror:8 row_mask:0xf bank_mask:0xf
    s_nop 1
    v_add_f32_dpp v40, v40, v40 row_ror:4 row_mask:0xf bank_mask:0xf
    s_nop 1
    v_add_f32_dpp v40, v40, v40 row_ror:2 row_mask:0xf bank_mask:0xf
    s_nop 1
    v_add_f32_dpp v40, v40, v40 row_ror:1 row_mask:0xf bank_mask:0xf
    v_cvt_pk_bf16_f32 v40, v40, v40
    v_lshlrev_b32 v40, 16, v40
    v_mul_f32 v40, s38, v40
    v_exp_f32 v40, v40
    s_nop 0
    v_add_f32 v40, 1.0, v40
    v_rcp_f32 v40, v40
    s_nop 0
    v_cvt_pk_bf16_f32 v40, v40, v40
    v_lshlrev_b32 v40, 16, v40

    v_cmp_eq_u32 vcc, 9, v1
    s_nop 1
    v_cndmask_b32 v60, v60, v40, vcc
    s_waitcnt vmcnt(10)
    v_lshlrev_b32 v40, 16, v144
    v_and_b32 v41, 0xffff0000, v144
    v_mul_f32 v40, v40, v24
    v_mul_f32 v41, v41, v25
    v_cvt_pk_bf16_f32 v40, v40, v41
    v_and_b32 v41, 0xffff0000, v40
    v_lshlrev_b32 v40, 16, v40

    v_lshlrev_b32 v42, 16, v145
    v_and_b32 v43, 0xffff0000, v145
    v_mul_f32 v42, v42, v26
    v_mul_f32 v43, v43, v27
    v_cvt_pk_bf16_f32 v42, v42, v43
    v_and_b32 v43, 0xffff0000, v42
    v_lshlrev_b32 v42, 16, v42

    v_lshlrev_b32 v44, 16, v146
    v_and_b32 v45, 0xffff0000, v146
    v_mul_f32 v44, v44, v28
    v_mul_f32 v45, v45, v29
    v_cvt_pk_bf16_f32 v44, v44, v45
    v_and_b32 v45, 0xffff0000, v44
    v_lshlrev_b32 v44, 16, v44

    v_lshlrev_b32 v46, 16, v147
    v_and_b32 v47, 0xffff0000, v147
    v_mul_f32 v46, v46, v30
    v_mul_f32 v47, v47, v31
    v_cvt_pk_bf16_f32 v46, v46, v47
    v_and_b32 v47, 0xffff0000, v46
    v_lshlrev_b32 v46, 16, v46

    v_lshlrev_b32 v48, 16, v148
    v_and_b32 v49, 0xffff0000, v148
    v_mul_f32 v48, v48, v32
    v_mul_f32 v49, v49, v33
    v_cvt_pk_bf16_f32 v48, v48, v49
    v_and_b32 v49, 0xffff0000, v48
    v_lshlrev_b32 v48, 16, v48

    v_lshlrev_b32 v50, 16, v149
    v_and_b32 v51, 0xffff0000, v149
    v_mul_f32 v50, v50, v34
    v_mul_f32 v51, v51, v35
    v_cvt_pk_bf16_f32 v50, v50, v51
    v_and_b32 v51, 0xffff0000, v50
    v_lshlrev_b32 v50, 16, v50

    v_lshlrev_b32 v52, 16, v150
    v_and_b32 v53, 0xffff0000, v150
    v_mul_f32 v52, v52, v36
    v_mul_f32 v53, v53, v37
    v_cvt_pk_bf16_f32 v52, v52, v53
    v_and_b32 v53, 0xffff0000, v52
    v_lshlrev_b32 v52, 16, v52

    v_lshlrev_b32 v54, 16, v151
    v_and_b32 v55, 0xffff0000, v151
    v_mul_f32 v54, v54, v38
    v_mul_f32 v55, v55, v39
    v_cvt_pk_bf16_f32 v54, v54, v55
    v_and_b32 v55, 0xffff0000, v54
    v_lshlrev_b32 v54, 16, v54

    v_add_f32 v40, v40, v48
    v_add_f32 v41, v41, v49
    v_add_f32 v42, v42, v50
    v_add_f32 v43, v43, v51
    v_add_f32 v44, v44, v52
    v_add_f32 v45, v45, v53
    v_add_f32 v46, v46, v54
    v_add_f32 v47, v47, v55
    v_add_f32 v40, v40, v44
    v_add_f32 v41, v41, v45
    v_add_f32 v42, v42, v46
    v_add_f32 v43, v43, v47
    v_add_f32 v40, v40, v42
    v_add_f32 v41, v41, v43
    v_add_f32 v40, v40, v41
    v_mov_b32 v41, v40
    s_nop 1
    v_permlane32_swap_b32 v40, v41
    v_add_f32 v40, v40, v41
    v_mov_b32 v41, v40
    s_nop 1
    v_permlane16_swap_b32 v40, v41
    v_add_f32 v40, v40, v41
    s_nop 1
    v_add_f32_dpp v40, v40, v40 row_ror:8 row_mask:0xf bank_mask:0xf
    s_nop 1
    v_add_f32_dpp v40, v40, v40 row_ror:4 row_mask:0xf bank_mask:0xf
    s_nop 1
    v_add_f32_dpp v40, v40, v40 row_ror:2 row_mask:0xf bank_mask:0xf
    s_nop 1
    v_add_f32_dpp v40, v40, v40 row_ror:1 row_mask:0xf bank_mask:0xf
    v_cvt_pk_bf16_f32 v40, v40, v40
    v_lshlrev_b32 v40, 16, v40
    v_mul_f32 v40, s38, v40
    v_exp_f32 v40, v40
    s_nop 0
    v_add_f32 v40, 1.0, v40
    v_rcp_f32 v40, v40
    s_nop 0
    v_cvt_pk_bf16_f32 v40, v40, v40
    v_lshlrev_b32 v40, 16, v40

    v_cmp_eq_u32 vcc, 10, v1
    s_nop 1
    v_cndmask_b32 v60, v60, v40, vcc
    s_waitcnt vmcnt(8)
    v_lshlrev_b32 v40, 16, v152
    v_and_b32 v41, 0xffff0000, v152
    v_mul_f32 v40, v40, v24
    v_mul_f32 v41, v41, v25
    v_cvt_pk_bf16_f32 v40, v40, v41
    v_and_b32 v41, 0xffff0000, v40
    v_lshlrev_b32 v40, 16, v40

    v_lshlrev_b32 v42, 16, v153
    v_and_b32 v43, 0xffff0000, v153
    v_mul_f32 v42, v42, v26
    v_mul_f32 v43, v43, v27
    v_cvt_pk_bf16_f32 v42, v42, v43
    v_and_b32 v43, 0xffff0000, v42
    v_lshlrev_b32 v42, 16, v42

    v_lshlrev_b32 v44, 16, v154
    v_and_b32 v45, 0xffff0000, v154
    v_mul_f32 v44, v44, v28
    v_mul_f32 v45, v45, v29
    v_cvt_pk_bf16_f32 v44, v44, v45
    v_and_b32 v45, 0xffff0000, v44
    v_lshlrev_b32 v44, 16, v44

    v_lshlrev_b32 v46, 16, v155
    v_and_b32 v47, 0xffff0000, v155
    v_mul_f32 v46, v46, v30
    v_mul_f32 v47, v47, v31
    v_cvt_pk_bf16_f32 v46, v46, v47
    v_and_b32 v47, 0xffff0000, v46
    v_lshlrev_b32 v46, 16, v46

    v_lshlrev_b32 v48, 16, v156
    v_and_b32 v49, 0xffff0000, v156
    v_mul_f32 v48, v48, v32
    v_mul_f32 v49, v49, v33
    v_cvt_pk_bf16_f32 v48, v48, v49
    v_and_b32 v49, 0xffff0000, v48
    v_lshlrev_b32 v48, 16, v48

    v_lshlrev_b32 v50, 16, v157
    v_and_b32 v51, 0xffff0000, v157
    v_mul_f32 v50, v50, v34
    v_mul_f32 v51, v51, v35
    v_cvt_pk_bf16_f32 v50, v50, v51
    v_and_b32 v51, 0xffff0000, v50
    v_lshlrev_b32 v50, 16, v50

    v_lshlrev_b32 v52, 16, v158
    v_and_b32 v53, 0xffff0000, v158
    v_mul_f32 v52, v52, v36
    v_mul_f32 v53, v53, v37
    v_cvt_pk_bf16_f32 v52, v52, v53
    v_and_b32 v53, 0xffff0000, v52
    v_lshlrev_b32 v52, 16, v52

    v_lshlrev_b32 v54, 16, v159
    v_and_b32 v55, 0xffff0000, v159
    v_mul_f32 v54, v54, v38
    v_mul_f32 v55, v55, v39
    v_cvt_pk_bf16_f32 v54, v54, v55
    v_and_b32 v55, 0xffff0000, v54
    v_lshlrev_b32 v54, 16, v54

    v_add_f32 v40, v40, v48
    v_add_f32 v41, v41, v49
    v_add_f32 v42, v42, v50
    v_add_f32 v43, v43, v51
    v_add_f32 v44, v44, v52
    v_add_f32 v45, v45, v53
    v_add_f32 v46, v46, v54
    v_add_f32 v47, v47, v55
    v_add_f32 v40, v40, v44
    v_add_f32 v41, v41, v45
    v_add_f32 v42, v42, v46
    v_add_f32 v43, v43, v47
    v_add_f32 v40, v40, v42
    v_add_f32 v41, v41, v43
    v_add_f32 v40, v40, v41
    v_mov_b32 v41, v40
    s_nop 1
    v_permlane32_swap_b32 v40, v41
    v_add_f32 v40, v40, v41
    v_mov_b32 v41, v40
    s_nop 1
    v_permlane16_swap_b32 v40, v41
    v_add_f32 v40, v40, v41
    s_nop 1
    v_add_f32_dpp v40, v40, v40 row_ror:8 row_mask:0xf bank_mask:0xf
    s_nop 1
    v_add_f32_dpp v40, v40, v40 row_ror:4 row_mask:0xf bank_mask:0xf
    s_nop 1
    v_add_f32_dpp v40, v40, v40 row_ror:2 row_mask:0xf bank_mask:0xf
    s_nop 1
    v_add_f32_dpp v40, v40, v40 row_ror:1 row_mask:0xf bank_mask:0xf
    v_cvt_pk_bf16_f32 v40, v40, v40
    v_lshlrev_b32 v40, 16, v40
    v_mul_f32 v40, s38, v40
    v_exp_f32 v40, v40
    s_nop 0
    v_add_f32 v40, 1.0, v40
    v_rcp_f32 v40, v40
    s_nop 0
    v_cvt_pk_bf16_f32 v40, v40, v40
    v_lshlrev_b32 v40, 16, v40

    v_cmp_eq_u32 vcc, 11, v1
    s_nop 1
    v_cndmask_b32 v60, v60, v40, vcc
    s_waitcnt vmcnt(6)
    v_lshlrev_b32 v40, 16, v160
    v_and_b32 v41, 0xffff0000, v160
    v_mul_f32 v40, v40, v24
    v_mul_f32 v41, v41, v25
    v_cvt_pk_bf16_f32 v40, v40, v41
    v_and_b32 v41, 0xffff0000, v40
    v_lshlrev_b32 v40, 16, v40

    v_lshlrev_b32 v42, 16, v161
    v_and_b32 v43, 0xffff0000, v161
    v_mul_f32 v42, v42, v26
    v_mul_f32 v43, v43, v27
    v_cvt_pk_bf16_f32 v42, v42, v43
    v_and_b32 v43, 0xffff0000, v42
    v_lshlrev_b32 v42, 16, v42

    v_lshlrev_b32 v44, 16, v162
    v_and_b32 v45, 0xffff0000, v162
    v_mul_f32 v44, v44, v28
    v_mul_f32 v45, v45, v29
    v_cvt_pk_bf16_f32 v44, v44, v45
    v_and_b32 v45, 0xffff0000, v44
    v_lshlrev_b32 v44, 16, v44

    v_lshlrev_b32 v46, 16, v163
    v_and_b32 v47, 0xffff0000, v163
    v_mul_f32 v46, v46, v30
    v_mul_f32 v47, v47, v31
    v_cvt_pk_bf16_f32 v46, v46, v47
    v_and_b32 v47, 0xffff0000, v46
    v_lshlrev_b32 v46, 16, v46

    v_lshlrev_b32 v48, 16, v164
    v_and_b32 v49, 0xffff0000, v164
    v_mul_f32 v48, v48, v32
    v_mul_f32 v49, v49, v33
    v_cvt_pk_bf16_f32 v48, v48, v49
    v_and_b32 v49, 0xffff0000, v48
    v_lshlrev_b32 v48, 16, v48

    v_lshlrev_b32 v50, 16, v165
    v_and_b32 v51, 0xffff0000, v165
    v_mul_f32 v50, v50, v34
    v_mul_f32 v51, v51, v35
    v_cvt_pk_bf16_f32 v50, v50, v51
    v_and_b32 v51, 0xffff0000, v50
    v_lshlrev_b32 v50, 16, v50

    v_lshlrev_b32 v52, 16, v166
    v_and_b32 v53, 0xffff0000, v166
    v_mul_f32 v52, v52, v36
    v_mul_f32 v53, v53, v37
    v_cvt_pk_bf16_f32 v52, v52, v53
    v_and_b32 v53, 0xffff0000, v52
    v_lshlrev_b32 v52, 16, v52

    v_lshlrev_b32 v54, 16, v167
    v_and_b32 v55, 0xffff0000, v167
    v_mul_f32 v54, v54, v38
    v_mul_f32 v55, v55, v39
    v_cvt_pk_bf16_f32 v54, v54, v55
    v_and_b32 v55, 0xffff0000, v54
    v_lshlrev_b32 v54, 16, v54

    v_add_f32 v40, v40, v48
    v_add_f32 v41, v41, v49
    v_add_f32 v42, v42, v50
    v_add_f32 v43, v43, v51
    v_add_f32 v44, v44, v52
    v_add_f32 v45, v45, v53
    v_add_f32 v46, v46, v54
    v_add_f32 v47, v47, v55
    v_add_f32 v40, v40, v44
    v_add_f32 v41, v41, v45
    v_add_f32 v42, v42, v46
    v_add_f32 v43, v43, v47
    v_add_f32 v40, v40, v42
    v_add_f32 v41, v41, v43
    v_add_f32 v40, v40, v41
    v_mov_b32 v41, v40
    s_nop 1
    v_permlane32_swap_b32 v40, v41
    v_add_f32 v40, v40, v41
    v_mov_b32 v41, v40
    s_nop 1
    v_permlane16_swap_b32 v40, v41
    v_add_f32 v40, v40, v41
    s_nop 1
    v_add_f32_dpp v40, v40, v40 row_ror:8 row_mask:0xf bank_mask:0xf
    s_nop 1
    v_add_f32_dpp v40, v40, v40 row_ror:4 row_mask:0xf bank_mask:0xf
    s_nop 1
    v_add_f32_dpp v40, v40, v40 row_ror:2 row_mask:0xf bank_mask:0xf
    s_nop 1
    v_add_f32_dpp v40, v40, v40 row_ror:1 row_mask:0xf bank_mask:0xf
    v_cvt_pk_bf16_f32 v40, v40, v40
    v_lshlrev_b32 v40, 16, v40
    v_mul_f32 v40, s38, v40
    v_exp_f32 v40, v40
    s_nop 0
    v_add_f32 v40, 1.0, v40
    v_rcp_f32 v40, v40
    s_nop 0
    v_cvt_pk_bf16_f32 v40, v40, v40
    v_lshlrev_b32 v40, 16, v40

    v_cmp_eq_u32 vcc, 12, v1
    s_nop 1
    v_cndmask_b32 v60, v60, v40, vcc
    s_waitcnt vmcnt(4)
    v_lshlrev_b32 v40, 16, v168
    v_and_b32 v41, 0xffff0000, v168
    v_mul_f32 v40, v40, v24
    v_mul_f32 v41, v41, v25
    v_cvt_pk_bf16_f32 v40, v40, v41
    v_and_b32 v41, 0xffff0000, v40
    v_lshlrev_b32 v40, 16, v40

    v_lshlrev_b32 v42, 16, v169
    v_and_b32 v43, 0xffff0000, v169
    v_mul_f32 v42, v42, v26
    v_mul_f32 v43, v43, v27
    v_cvt_pk_bf16_f32 v42, v42, v43
    v_and_b32 v43, 0xffff0000, v42
    v_lshlrev_b32 v42, 16, v42

    v_lshlrev_b32 v44, 16, v170
    v_and_b32 v45, 0xffff0000, v170
    v_mul_f32 v44, v44, v28
    v_mul_f32 v45, v45, v29
    v_cvt_pk_bf16_f32 v44, v44, v45
    v_and_b32 v45, 0xffff0000, v44
    v_lshlrev_b32 v44, 16, v44

    v_lshlrev_b32 v46, 16, v171
    v_and_b32 v47, 0xffff0000, v171
    v_mul_f32 v46, v46, v30
    v_mul_f32 v47, v47, v31
    v_cvt_pk_bf16_f32 v46, v46, v47
    v_and_b32 v47, 0xffff0000, v46
    v_lshlrev_b32 v46, 16, v46

    v_lshlrev_b32 v48, 16, v172
    v_and_b32 v49, 0xffff0000, v172
    v_mul_f32 v48, v48, v32
    v_mul_f32 v49, v49, v33
    v_cvt_pk_bf16_f32 v48, v48, v49
    v_and_b32 v49, 0xffff0000, v48
    v_lshlrev_b32 v48, 16, v48

    v_lshlrev_b32 v50, 16, v173
    v_and_b32 v51, 0xffff0000, v173
    v_mul_f32 v50, v50, v34
    v_mul_f32 v51, v51, v35
    v_cvt_pk_bf16_f32 v50, v50, v51
    v_and_b32 v51, 0xffff0000, v50
    v_lshlrev_b32 v50, 16, v50

    v_lshlrev_b32 v52, 16, v174
    v_and_b32 v53, 0xffff0000, v174
    v_mul_f32 v52, v52, v36
    v_mul_f32 v53, v53, v37
    v_cvt_pk_bf16_f32 v52, v52, v53
    v_and_b32 v53, 0xffff0000, v52
    v_lshlrev_b32 v52, 16, v52

    v_lshlrev_b32 v54, 16, v175
    v_and_b32 v55, 0xffff0000, v175
    v_mul_f32 v54, v54, v38
    v_mul_f32 v55, v55, v39
    v_cvt_pk_bf16_f32 v54, v54, v55
    v_and_b32 v55, 0xffff0000, v54
    v_lshlrev_b32 v54, 16, v54

    v_add_f32 v40, v40, v48
    v_add_f32 v41, v41, v49
    v_add_f32 v42, v42, v50
    v_add_f32 v43, v43, v51
    v_add_f32 v44, v44, v52
    v_add_f32 v45, v45, v53
    v_add_f32 v46, v46, v54
    v_add_f32 v47, v47, v55
    v_add_f32 v40, v40, v44
    v_add_f32 v41, v41, v45
    v_add_f32 v42, v42, v46
    v_add_f32 v43, v43, v47
    v_add_f32 v40, v40, v42
    v_add_f32 v41, v41, v43
    v_add_f32 v40, v40, v41
    v_mov_b32 v41, v40
    s_nop 1
    v_permlane32_swap_b32 v40, v41
    v_add_f32 v40, v40, v41
    v_mov_b32 v41, v40
    s_nop 1
    v_permlane16_swap_b32 v40, v41
    v_add_f32 v40, v40, v41
    s_nop 1
    v_add_f32_dpp v40, v40, v40 row_ror:8 row_mask:0xf bank_mask:0xf
    s_nop 1
    v_add_f32_dpp v40, v40, v40 row_ror:4 row_mask:0xf bank_mask:0xf
    s_nop 1
    v_add_f32_dpp v40, v40, v40 row_ror:2 row_mask:0xf bank_mask:0xf
    s_nop 1
    v_add_f32_dpp v40, v40, v40 row_ror:1 row_mask:0xf bank_mask:0xf
    v_cvt_pk_bf16_f32 v40, v40, v40
    v_lshlrev_b32 v40, 16, v40
    v_mul_f32 v40, s38, v40
    v_exp_f32 v40, v40
    s_nop 0
    v_add_f32 v40, 1.0, v40
    v_rcp_f32 v40, v40
    s_nop 0
    v_cvt_pk_bf16_f32 v40, v40, v40
    v_lshlrev_b32 v40, 16, v40

    v_cmp_eq_u32 vcc, 13, v1
    s_nop 1
    v_cndmask_b32 v60, v60, v40, vcc
    s_waitcnt vmcnt(2)
    v_lshlrev_b32 v40, 16, v176
    v_and_b32 v41, 0xffff0000, v176
    v_mul_f32 v40, v40, v24
    v_mul_f32 v41, v41, v25
    v_cvt_pk_bf16_f32 v40, v40, v41
    v_and_b32 v41, 0xffff0000, v40
    v_lshlrev_b32 v40, 16, v40

    v_lshlrev_b32 v42, 16, v177
    v_and_b32 v43, 0xffff0000, v177
    v_mul_f32 v42, v42, v26
    v_mul_f32 v43, v43, v27
    v_cvt_pk_bf16_f32 v42, v42, v43
    v_and_b32 v43, 0xffff0000, v42
    v_lshlrev_b32 v42, 16, v42

    v_lshlrev_b32 v44, 16, v178
    v_and_b32 v45, 0xffff0000, v178
    v_mul_f32 v44, v44, v28
    v_mul_f32 v45, v45, v29
    v_cvt_pk_bf16_f32 v44, v44, v45
    v_and_b32 v45, 0xffff0000, v44
    v_lshlrev_b32 v44, 16, v44

    v_lshlrev_b32 v46, 16, v179
    v_and_b32 v47, 0xffff0000, v179
    v_mul_f32 v46, v46, v30
    v_mul_f32 v47, v47, v31
    v_cvt_pk_bf16_f32 v46, v46, v47
    v_and_b32 v47, 0xffff0000, v46
    v_lshlrev_b32 v46, 16, v46

    v_lshlrev_b32 v48, 16, v180
    v_and_b32 v49, 0xffff0000, v180
    v_mul_f32 v48, v48, v32
    v_mul_f32 v49, v49, v33
    v_cvt_pk_bf16_f32 v48, v48, v49
    v_and_b32 v49, 0xffff0000, v48
    v_lshlrev_b32 v48, 16, v48

    v_lshlrev_b32 v50, 16, v181
    v_and_b32 v51, 0xffff0000, v181
    v_mul_f32 v50, v50, v34
    v_mul_f32 v51, v51, v35
    v_cvt_pk_bf16_f32 v50, v50, v51
    v_and_b32 v51, 0xffff0000, v50
    v_lshlrev_b32 v50, 16, v50

    v_lshlrev_b32 v52, 16, v182
    v_and_b32 v53, 0xffff0000, v182
    v_mul_f32 v52, v52, v36
    v_mul_f32 v53, v53, v37
    v_cvt_pk_bf16_f32 v52, v52, v53
    v_and_b32 v53, 0xffff0000, v52
    v_lshlrev_b32 v52, 16, v52

    v_lshlrev_b32 v54, 16, v183
    v_and_b32 v55, 0xffff0000, v183
    v_mul_f32 v54, v54, v38
    v_mul_f32 v55, v55, v39
    v_cvt_pk_bf16_f32 v54, v54, v55
    v_and_b32 v55, 0xffff0000, v54
    v_lshlrev_b32 v54, 16, v54

    v_add_f32 v40, v40, v48
    v_add_f32 v41, v41, v49
    v_add_f32 v42, v42, v50
    v_add_f32 v43, v43, v51
    v_add_f32 v44, v44, v52
    v_add_f32 v45, v45, v53
    v_add_f32 v46, v46, v54
    v_add_f32 v47, v47, v55
    v_add_f32 v40, v40, v44
    v_add_f32 v41, v41, v45
    v_add_f32 v42, v42, v46
    v_add_f32 v43, v43, v47
    v_add_f32 v40, v40, v42
    v_add_f32 v41, v41, v43
    v_add_f32 v40, v40, v41
    v_mov_b32 v41, v40
    s_nop 1
    v_permlane32_swap_b32 v40, v41
    v_add_f32 v40, v40, v41
    v_mov_b32 v41, v40
    s_nop 1
    v_permlane16_swap_b32 v40, v41
    v_add_f32 v40, v40, v41
    s_nop 1
    v_add_f32_dpp v40, v40, v40 row_ror:8 row_mask:0xf bank_mask:0xf
    s_nop 1
    v_add_f32_dpp v40, v40, v40 row_ror:4 row_mask:0xf bank_mask:0xf
    s_nop 1
    v_add_f32_dpp v40, v40, v40 row_ror:2 row_mask:0xf bank_mask:0xf
    s_nop 1
    v_add_f32_dpp v40, v40, v40 row_ror:1 row_mask:0xf bank_mask:0xf
    v_cvt_pk_bf16_f32 v40, v40, v40
    v_lshlrev_b32 v40, 16, v40
    v_mul_f32 v40, s38, v40
    v_exp_f32 v40, v40
    s_nop 0
    v_add_f32 v40, 1.0, v40
    v_rcp_f32 v40, v40
    s_nop 0
    v_cvt_pk_bf16_f32 v40, v40, v40
    v_lshlrev_b32 v40, 16, v40

    v_cmp_eq_u32 vcc, 14, v1
    s_nop 1
    v_cndmask_b32 v60, v60, v40, vcc
    s_waitcnt vmcnt(0)
    v_lshlrev_b32 v40, 16, v184
    v_and_b32 v41, 0xffff0000, v184
    v_mul_f32 v40, v40, v24
    v_mul_f32 v41, v41, v25
    v_cvt_pk_bf16_f32 v40, v40, v41
    v_and_b32 v41, 0xffff0000, v40
    v_lshlrev_b32 v40, 16, v40

    v_lshlrev_b32 v42, 16, v185
    v_and_b32 v43, 0xffff0000, v185
    v_mul_f32 v42, v42, v26
    v_mul_f32 v43, v43, v27
    v_cvt_pk_bf16_f32 v42, v42, v43
    v_and_b32 v43, 0xffff0000, v42
    v_lshlrev_b32 v42, 16, v42

    v_lshlrev_b32 v44, 16, v186
    v_and_b32 v45, 0xffff0000, v186
    v_mul_f32 v44, v44, v28
    v_mul_f32 v45, v45, v29
    v_cvt_pk_bf16_f32 v44, v44, v45
    v_and_b32 v45, 0xffff0000, v44
    v_lshlrev_b32 v44, 16, v44

    v_lshlrev_b32 v46, 16, v187
    v_and_b32 v47, 0xffff0000, v187
    v_mul_f32 v46, v46, v30
    v_mul_f32 v47, v47, v31
    v_cvt_pk_bf16_f32 v46, v46, v47
    v_and_b32 v47, 0xffff0000, v46
    v_lshlrev_b32 v46, 16, v46

    v_lshlrev_b32 v48, 16, v188
    v_and_b32 v49, 0xffff0000, v188
    v_mul_f32 v48, v48, v32
    v_mul_f32 v49, v49, v33
    v_cvt_pk_bf16_f32 v48, v48, v49
    v_and_b32 v49, 0xffff0000, v48
    v_lshlrev_b32 v48, 16, v48

    v_lshlrev_b32 v50, 16, v189
    v_and_b32 v51, 0xffff0000, v189
    v_mul_f32 v50, v50, v34
    v_mul_f32 v51, v51, v35
    v_cvt_pk_bf16_f32 v50, v50, v51
    v_and_b32 v51, 0xffff0000, v50
    v_lshlrev_b32 v50, 16, v50

    v_lshlrev_b32 v52, 16, v190
    v_and_b32 v53, 0xffff0000, v190
    v_mul_f32 v52, v52, v36
    v_mul_f32 v53, v53, v37
    v_cvt_pk_bf16_f32 v52, v52, v53
    v_and_b32 v53, 0xffff0000, v52
    v_lshlrev_b32 v52, 16, v52

    v_lshlrev_b32 v54, 16, v191
    v_and_b32 v55, 0xffff0000, v191
    v_mul_f32 v54, v54, v38
    v_mul_f32 v55, v55, v39
    v_cvt_pk_bf16_f32 v54, v54, v55
    v_and_b32 v55, 0xffff0000, v54
    v_lshlrev_b32 v54, 16, v54

    v_add_f32 v40, v40, v48
    v_add_f32 v41, v41, v49
    v_add_f32 v42, v42, v50
    v_add_f32 v43, v43, v51
    v_add_f32 v44, v44, v52
    v_add_f32 v45, v45, v53
    v_add_f32 v46, v46, v54
    v_add_f32 v47, v47, v55
    v_add_f32 v40, v40, v44
    v_add_f32 v41, v41, v45
    v_add_f32 v42, v42, v46
    v_add_f32 v43, v43, v47
    v_add_f32 v40, v40, v42
    v_add_f32 v41, v41, v43
    v_add_f32 v40, v40, v41
    v_mov_b32 v41, v40
    s_nop 1
    v_permlane32_swap_b32 v40, v41
    v_add_f32 v40, v40, v41
    v_mov_b32 v41, v40
    s_nop 1
    v_permlane16_swap_b32 v40, v41
    v_add_f32 v40, v40, v41
    s_nop 1
    v_add_f32_dpp v40, v40, v40 row_ror:8 row_mask:0xf bank_mask:0xf
    s_nop 1
    v_add_f32_dpp v40, v40, v40 row_ror:4 row_mask:0xf bank_mask:0xf
    s_nop 1
    v_add_f32_dpp v40, v40, v40 row_ror:2 row_mask:0xf bank_mask:0xf
    s_nop 1
    v_add_f32_dpp v40, v40, v40 row_ror:1 row_mask:0xf bank_mask:0xf
    v_cvt_pk_bf16_f32 v40, v40, v40
    v_lshlrev_b32 v40, 16, v40
    v_mul_f32 v40, s38, v40
    v_exp_f32 v40, v40
    s_nop 0
    v_add_f32 v40, 1.0, v40
    v_rcp_f32 v40, v40
    s_nop 0
    v_cvt_pk_bf16_f32 v40, v40, v40
    v_lshlrev_b32 v40, 16, v40

    v_cmp_eq_u32 vcc, 15, v1
    s_nop 1
    v_cndmask_b32 v60, v60, v40, vcc
    s_lshl_b32 s5, s3, 2
    s_add_u32 s5, s5, 121634816
    v_lshlrev_b32 v8, 2, v1
    s_mov_b64 exec, 0xffff
    buffer_store_dword v60, v8, s[8:11], s5 offen sc1
    s_mov_b64 exec, -1

    s_load_dwordx4 s[52:55], s[0:1], 32
    s_lshl_b32 s3, s93, 5
    s_lshl_b32 s4, s24, 3
    s_add_u32 s3, s3, s4
    s_lshl_b32 s4, s3, 1
    s_waitcnt lgkmcnt(0)
    s_load_dwordx4 s[64:67], s[54:55], s4

    s_mov_b32 s28, s52
    s_and_b32 s29, s53, 0xffff
    s_mov_b32 s30, 0x400000
    s_mov_b32 s31, 0x00020000

    v_and_b32 v1, 63, v0
    v_and_b32 v2, 15, v1
    v_lshrrev_b32 v3, 4, v1

    s_lshl_b32 s32, s3, 12
    s_add_u32 s33, s32, 28672
    s_mul_i32 s34, s24, 38400
    s_add_u32 s35, s34, 33536
    s_add_u32 s38, s32, 117440512
    v_lshlrev_b32 v4, 4, v1
    v_add_u32 v5, s34, v4
    v_add_u32 v5, 64, v5
    v_sub_u32 v6, 7, v2
    v_and_b32 v6, 7, v6
    v_mul_u32_u24 v6, 4160, v6
    v_lshrrev_b32 v7, 3, v2
    v_sub_u32 v7, v7, v3
    v_add_u32 v7, 4, v7
    v_lshl_add_u32 v6, v7, 4, v6
    v_add_u32 v6, s34, v6
    v_mul_u32_u24 v7, 80, v3
    v_add_u32 v7, v7, v2
    v_lshlrev_b32 v7, 4, v7
    v_add_u32 v7, s34, v7
    v_add_u32 v7, 33296, v7
    v_lshlrev_b32 v228, 7, v2
    v_lshl_add_u32 v228, v3, 4, v228
    v_subrev_u32 v229, 16, v4
    v_max_i32 v230, 0, v229
    v_sub_u32 v232, 7, v2
    v_and_b32 v232, 7, v232
    v_and_b32 v233, 1, v232
    v_lshlrev_b32 v233, 4, v233
    v_mov_b32 v234, 0xffff
    v_lshlrev_b32 v233, v233, v234
    v_lshrrev_b32 v232, 1, v232
    v_lshrrev_b32 v234, 3, v2
    v_sub_u32 v234, v3, v234
    v_lshl_add_u32 v232, v234, 1, v232
    v_and_b32 v234, 1, v234
    v_lshl_add_u32 v232, v234, 8, v232

    v_cmp_eq_u32 vcc, 0, v232
    s_nop 1
    v_cndmask_b32 v8, 0, v233, vcc
    v_cmp_eq_u32 vcc, 1, v232
    s_nop 1
    v_cndmask_b32 v9, 0, v233, vcc
    v_cmp_eq_u32 vcc, 2, v232
    s_nop 1
    v_cndmask_b32 v10, 0, v233, vcc
    v_cmp_eq_u32 vcc, 3, v232
    s_nop 1
    v_cndmask_b32 v11, 0, v233, vcc
    v_cmp_eq_u32 vcc, 4, v232
    s_nop 1
    v_cndmask_b32 v12, 0, v233, vcc
    v_cmp_eq_u32 vcc, 5, v232
    s_nop 1
    v_cndmask_b32 v13, 0, v233, vcc
    v_cmp_eq_u32 vcc, 6, v232
    s_nop 1
    v_cndmask_b32 v14, 0, v233, vcc
    v_cmp_eq_u32 vcc, 7, v232
    s_nop 1
    v_cndmask_b32 v15, 0, v233, vcc
    v_mov_b32 v208, 0
    v_mov_b32 v209, 0
    v_mov_b32 v210, 0
    v_mov_b32 v211, 0
    v_lshrrev_b32 v232, 2, v1
    v_and_b32 v232, 7, v232
    v_mul_u32_u24 v232, 4160, v232
    v_and_b32 v233, 3, v1
    v_lshl_add_u32 v232, v233, 4, v232
    v_add_u32 v232, s34, v232
    ds_write_b128 v232, v[208:211]
    v_subrev_u32 v233, 16, v7
    ds_write_b128 v233, v[208:211]

    v_mov_b32 v5, 0
    s_mov_b32 s62, 0
    s_mov_b32 s5, 40
.wc_400:
    buffer_load_dword v4, v5, s[20:23], s5 offen sc1
    s_waitcnt vmcnt(0)
    v_readfirstlane_b32 s4, v4
    s_lshr_b32 s4, s4, 0
    s_and_b32 s4, s4, 0xffff
    s_cmp_ge_u32 s4, 32
    s_cbranch_scc1 .wcd_401
    s_sleep 6
    s_add_u32 s62, s62, 1
    s_cmp_gt_u32 s62, 0x400000
    s_cbranch_scc1 .mg_end_1
    s_branch .wc_400

.wcd_401:
    v_lshlrev_b32 v4, 4, v1
    v_add_u32 v5, s34, v4
    v_add_u32 v5, 64, v5

    s_add_u32 s39, s32, 125829120
    buffer_load_dwordx4 v[176:179], v230, s[28:31], s32 offen offset:0
    buffer_load_dwordx4 v[180:183], v4, s[28:31], s32 offen offset:0
    buffer_load_dwordx4 v[184:187], v4, s[28:31], s32 offen offset:1008
    buffer_load_dwordx4 v[188:191], v4, s[28:31], s32 offen offset:1024
    buffer_load_dwordx4 v[192:195], v4, s[28:31], s32 offen offset:2032
    buffer_load_dwordx4 v[196:199], v4, s[28:31], s32 offen offset:2048
    buffer_load_dwordx4 v[200:203], v4, s[28:31], s32 offen offset:3056
    buffer_load_dwordx4 v[204:207], v4, s[28:31], s32 offen offset:3072
    s_add_u32 m0, s35, 0
    s_nop 0
    buffer_load_dwordx4 v4, s[8:11], s39 offen offset:0 lds
    s_add_u32 m0, s35, 256
    s_nop 0
    buffer_load_dwordx4 v4, s[8:11], s39 offen offset:1024 lds
    s_add_u32 m0, s35, 512
    s_nop 0
    buffer_load_dwordx4 v4, s[8:11], s39 offen offset:2048 lds
    s_add_u32 m0, s35, 768
    s_nop 0
    buffer_load_dwordx4 v4, s[8:11], s39 offen offset:3072 lds
    s_waitcnt vmcnt(0) lgkmcnt(0)
    s_pack_ll_b32_b16 s40, s64, s64
    s_add_u32 s36, s32, 4096
    s_add_u32 s37, s32, 8192
    s_add_u32 s39, s36, 125829120
    s_mov_b64 exec, 1
    v_mov_b32 v176, 0
    v_mov_b32 v177, 0
    v_mov_b32 v178, 0
    v_mov_b32 v179, 0
    s_mov_b64 exec, -1
    ds_write_b128 v5, v[180:183] offset:0
    ds_write_b128 v5, v[178:181] offset:16640
    v_mov_b32 v208, v177
    v_mov_b32 v209, v178
    v_mov_b32 v210, v179
    v_mov_b32 v211, v180
    ds_write_b128 v5, v[208:211] offset:24960
    v_mov_b32 v212, v181
    v_mov_b32 v213, v182
    ds_write_b128 v5, v[210:213] offset:8320
    v_alignbit_b32 v214, v177, v176, 16
    v_alignbit_b32 v215, v178, v177, 16
    v_alignbit_b32 v216, v179, v178, 16
    v_alignbit_b32 v217, v180, v179, 16
    ds_write_b128 v5, v[214:217] offset:29120
    v_alignbit_b32 v218, v181, v180, 16
    v_alignbit_b32 v219, v182, v181, 16
    ds_write_b128 v5, v[216:219] offset:12480
    v_alignbit_b32 v220, v178, v177, 16
    v_alignbit_b32 v221, v179, v178, 16
    v_alignbit_b32 v222, v180, v179, 16
    v_alignbit_b32 v223, v181, v180, 16
    ds_write_b128 v5, v[220:223] offset:20800
    v_alignbit_b32 v224, v182, v181, 16
    v_alignbit_b32 v225, v183, v182, 16
    ds_write_b128 v5, v[222:225] offset:4160
    buffer_load_dwordx4 v[176:179], v230, s[28:31], s36 offen offset:0
    buffer_load_dwordx4 v[180:183], v4, s[28:31], s36 offen offset:0
    ds_write_b128 v5, v[188:191] offset:1024
    ds_write_b128 v5, v[186:189] offset:17664
    v_mov_b32 v208, v185
    v_mov_b32 v209, v186
    v_mov_b32 v210, v187
    v_mov_b32 v211, v188
    ds_write_b128 v5, v[208:211] offset:25984
    v_mov_b32 v212, v189
    v_mov_b32 v213, v190
    ds_write_b128 v5, v[210:213] offset:9344
    v_alignbit_b32 v214, v185, v184, 16
    v_alignbit_b32 v215, v186, v185, 16
    v_alignbit_b32 v216, v187, v186, 16
    v_alignbit_b32 v217, v188, v187, 16
    ds_write_b128 v5, v[214:217] offset:30144
    v_alignbit_b32 v218, v189, v188, 16
    v_alignbit_b32 v219, v190, v189, 16
    ds_write_b128 v5, v[216:219] offset:13504
    v_alignbit_b32 v220, v186, v185, 16
    v_alignbit_b32 v221, v187, v186, 16
    v_alignbit_b32 v222, v188, v187, 16
    v_alignbit_b32 v223, v189, v188, 16
    ds_write_b128 v5, v[220:223] offset:21824
    v_alignbit_b32 v224, v190, v189, 16
    v_alignbit_b32 v225, v191, v190, 16
    ds_write_b128 v5, v[222:225] offset:5184
    buffer_load_dwordx4 v[184:187], v4, s[28:31], s36 offen offset:1008
    buffer_load_dwordx4 v[188:191], v4, s[28:31], s36 offen offset:1024
    v_and_b32 v236, s40, v8
    v_and_b32 v237, s40, v9
    v_and_b32 v238, s40, v10
    v_and_b32 v239, s40, v11
    v_and_b32 v240, s40, v12
    v_and_b32 v241, s40, v13
    v_and_b32 v242, s40, v14
    v_and_b32 v243, s40, v15
    ds_read_b128 a[60:63], v7 offset:240
    ds_read_b128 a[124:127], v7 offset:496
    ds_read_b128 a[188:191], v7 offset:752
    ds_read_b128 a[252:255], v7 offset:1008
    ds_read_b128 v[168:171], v6 offset:0
    ds_read_b128 v[172:175], v6 offset:32
    s_waitcnt vmcnt(0) lgkmcnt(0)
    s_mov_b32 s42, 0
.cvl_402:
    s_waitcnt lgkmcnt(5)
    v_mfma_f32_16x16x32_bf16 v[16:19], v[236:239], a[60:63], 0
    v_mfma_f32_16x16x32_bf16 v[32:35], v[240:243], a[60:63], 0
    s_waitcnt lgkmcnt(4)
    v_mfma_f32_16x16x32_bf16 v[20:23], v[236:239], a[124:127], 0
    v_mfma_f32_16x16x32_bf16 v[36:39], v[240:243], a[124:127], 0
    s_waitcnt lgkmcnt(3)
    v_mfma_f32_16x16x32_bf16 v[24:27], v[236:239], a[188:191], 0
    v_mfma_f32_16x16x32_bf16 v[40:43], v[240:243], a[188:191], 0
    ds_read_b128 a[56:59], v7 offset:224
    s_waitcnt lgkmcnt(3)
    v_mfma_f32_16x16x32_bf16 v[28:31], v[236:239], a[252:255], 0
    ds_read_b128 v[112:115], v6 offset:64
    v_mfma_f32_16x16x32_bf16 v[44:47], v[240:243], a[252:255], 0
    ds_read_b128 v[116:119], v6 offset:96
    s_waitcnt lgkmcnt(4)
    v_mfma_f32_16x16x32_bf16 v[16:19], v[168:171], a[60:63], v[16:19]
    ds_read_b128 a[120:123], v7 offset:480
    s_waitcnt lgkmcnt(4)
    v_mfma_f32_16x16x32_bf16 v[32:35], v[172:175], a[60:63], v[32:35]
    s_waitcnt vmcnt(18)
    v_mfma_f32_16x16x32_bf16 v[20:23], v[168:171], a[124:127], v[20:23]
    ds_read_b128 a[184:187], v7 offset:736
    v_mfma_f32_16x16x32_bf16 v[36:39], v[172:175], a[124:127], v[36:39]
    ds_write_b128 v5, v[196:199] offset:2048
    v_mfma_f32_16x16x32_bf16 v[24:27], v[168:171], a[188:191], v[24:27]
    ds_read_b128 a[248:251], v7 offset:992
    v_mfma_f32_16x16x32_bf16 v[40:43], v[172:175], a[188:191], v[40:43]
    ds_read_b128 a[52:55], v7 offset:208
    v_mfma_f32_16x16x32_bf16 v[28:31], v[168:171], a[252:255], v[28:31]
    ds_read_b128 v[120:123], v6 offset:128
    v_mfma_f32_16x16x32_bf16 v[44:47], v[172:175], a[252:255], v[44:47]
    ds_read_b128 v[124:127], v6 offset:160
    s_waitcnt lgkmcnt(8)
    v_mfma_f32_16x16x32_bf16 v[16:19], v[112:115], a[56:59], v[16:19]
    ds_read_b128 a[116:119], v7 offset:464
    s_waitcnt lgkmcnt(8)
    v_mfma_f32_16x16x32_bf16 v[32:35], v[116:119], a[56:59], v[32:35]
    ds_write_b128 v5, v[194:197] offset:18688
    s_waitcnt lgkmcnt(8)
    v_mfma_f32_16x16x32_bf16 v[20:23], v[112:115], a[120:123], v[20:23]
    ds_read_b128 a[180:183], v7 offset:720
    v_mfma_f32_16x16x32_bf16 v[36:39], v[116:119], a[120:123], v[36:39]
    v_mov_b32 v208, v193
    v_mov_b32 v209, v194
    s_waitcnt lgkmcnt(8)
    v_mfma_f32_16x16x32_bf16 v[24:27], v[112:115], a[184:187], v[24:27]
    ds_read_b128 a[244:247], v7 offset:976
    v_mfma_f32_16x16x32_bf16 v[40:43], v[116:119], a[184:187], v[40:43]
    ds_read_b128 a[48:51], v7 offset:192
    s_waitcnt lgkmcnt(8)
    v_mfma_f32_16x16x32_bf16 v[28:31], v[112:115], a[248:251], v[28:31]
    ds_read_b128 v[128:131], v6 offset:192
    v_mfma_f32_16x16x32_bf16 v[44:47], v[116:119], a[248:251], v[44:47]
    ds_read_b128 v[132:135], v6 offset:224
    s_waitcnt lgkmcnt(8)
    v_mfma_f32_16x16x32_bf16 v[16:19], v[120:123], a[52:55], v[16:19]
    ds_read_b128 a[112:115], v7 offset:448
    s_waitcnt lgkmcnt(8)
    v_mfma_f32_16x16x32_bf16 v[32:35], v[124:127], a[52:55], v[32:35]
    v_mov_b32 v210, v195
    v_mov_b32 v211, v196
    s_waitcnt lgkmcnt(7)
    v_mfma_f32_16x16x32_bf16 v[20:23], v[120:123], a[116:119], v[20:23]
    ds_read_b128 a[176:179], v7 offset:704
    v_mfma_f32_16x16x32_bf16 v[36:39], v[124:127], a[116:119], v[36:39]
    ds_write_b128 v5, v[208:211] offset:27008
    s_waitcnt lgkmcnt(7)
    v_mfma_f32_16x16x32_bf16 v[24:27], v[120:123], a[180:183], v[24:27]
    ds_read_b128 a[240:243], v7 offset:960
    v_mfma_f32_16x16x32_bf16 v[40:43], v[124:127], a[180:183], v[40:43]
    ds_read_b128 a[44:47], v7 offset:176
    s_waitcnt lgkmcnt(8)
    v_mfma_f32_16x16x32_bf16 v[28:31], v[120:123], a[244:247], v[28:31]
    ds_read_b128 v[136:139], v6 offset:256
    v_mfma_f32_16x16x32_bf16 v[44:47], v[124:127], a[244:247], v[44:47]
    ds_read_b128 v[140:143], v6 offset:288
    s_waitcnt lgkmcnt(8)
    v_mfma_f32_16x16x32_bf16 v[16:19], v[128:131], a[48:51], v[16:19]
    ds_read_b128 a[108:111], v7 offset:432
    s_waitcnt lgkmcnt(8)
    v_mfma_f32_16x16x32_bf16 v[32:35], v[132:135], a[48:51], v[32:35]
    v_mov_b32 v212, v197
    v_mov_b32 v213, v198
    s_waitcnt lgkmcnt(7)
    v_mfma_f32_16x16x32_bf16 v[20:23], v[128:131], a[112:115], v[20:23]
    ds_read_b128 a[172:175], v7 offset:688
    v_mfma_f32_16x16x32_bf16 v[36:39], v[132:135], a[112:115], v[36:39]
    ds_write_b128 v5, v[210:213] offset:10368
    s_waitcnt lgkmcnt(8)
    v_mfma_f32_16x16x32_bf16 v[24:27], v[128:131], a[176:179], v[24:27]
    ds_read_b128 a[236:239], v7 offset:944
    v_mfma_f32_16x16x32_bf16 v[40:43], v[132:135], a[176:179], v[40:43]
    ds_read_b128 a[40:43], v7 offset:160
    s_waitcnt lgkmcnt(8)
    v_mfma_f32_16x16x32_bf16 v[28:31], v[128:131], a[240:243], v[28:31]
    ds_read_b128 v[144:147], v6 offset:320
    v_mfma_f32_16x16x32_bf16 v[44:47], v[132:135], a[240:243], v[44:47]
    ds_read_b128 v[148:151], v6 offset:352
    s_waitcnt lgkmcnt(8)
    v_mfma_f32_16x16x32_bf16 v[16:19], v[136:139], a[44:47], v[16:19]
    ds_read_b128 a[104:107], v7 offset:416
    s_waitcnt lgkmcnt(8)
    v_mfma_f32_16x16x32_bf16 v[32:35], v[140:143], a[44:47], v[32:35]
    v_alignbit_b32 v214, v193, v192, 16
    v_alignbit_b32 v215, v194, v193, 16
    s_waitcnt lgkmcnt(7)
    v_mfma_f32_16x16x32_bf16 v[20:23], v[136:139], a[108:111], v[20:23]
    ds_read_b128 a[168:171], v7 offset:672
    v_mfma_f32_16x16x32_bf16 v[36:39], v[140:143], a[108:111], v[36:39]
    v_alignbit_b32 v216, v195, v194, 16
    v_alignbit_b32 v217, v196, v195, 16
    s_waitcnt lgkmcnt(7)
    v_mfma_f32_16x16x32_bf16 v[24:27], v[136:139], a[172:175], v[24:27]
    ds_read_b128 a[232:235], v7 offset:928
    v_mfma_f32_16x16x32_bf16 v[40:43], v[140:143], a[172:175], v[40:43]
    ds_read_b128 a[36:39], v7 offset:144
    s_waitcnt lgkmcnt(7)
    v_mfma_f32_16x16x32_bf16 v[28:31], v[136:139], a[236:239], v[28:31]
    ds_read_b128 v[152:155], v6 offset:384
    v_mfma_f32_16x16x32_bf16 v[44:47], v[140:143], a[236:239], v[44:47]
    ds_read_b128 v[156:159], v6 offset:416
    s_waitcnt lgkmcnt(7)
    v_mfma_f32_16x16x32_bf16 v[16:19], v[144:147], a[40:43], v[16:19]
    ds_read_b128 a[100:103], v7 offset:400
    s_waitcnt lgkmcnt(7)
    v_mfma_f32_16x16x32_bf16 v[32:35], v[148:151], a[40:43], v[32:35]
    ds_write_b128 v5, v[214:217] offset:31168
    s_waitcnt lgkmcnt(7)
    v_mfma_f32_16x16x32_bf16 v[20:23], v[144:147], a[104:107], v[20:23]
    ds_read_b128 a[164:167], v7 offset:656
    v_mfma_f32_16x16x32_bf16 v[36:39], v[148:151], a[104:107], v[36:39]
    v_alignbit_b32 v218, v197, v196, 16
    v_alignbit_b32 v219, v198, v197, 16
    s_waitcnt lgkmcnt(7)
    v_mfma_f32_16x16x32_bf16 v[24:27], v[144:147], a[168:171], v[24:27]
    ds_read_b128 a[228:231], v7 offset:912
    v_mfma_f32_16x16x32_bf16 v[40:43], v[148:151], a[168:171], v[40:43]
    ds_read_b128 a[32:35], v7 offset:128
    s_waitcnt lgkmcnt(8)
    v_mfma_f32_16x16x32_bf16 v[28:31], v[144:147], a[232:235], v[28:31]
    ds_read_b128 v[160:163], v6 offset:448
    v_mfma_f32_16x16x32_bf16 v[44:47], v[148:151], a[232:235], v[44:47]
    ds_read_b128 v[164:167], v6 offset:480
    s_waitcnt lgkmcnt(8)
    v_mfma_f32_16x16x32_bf16 v[16:19], v[152:155], a[36:39], v[16:19]
    ds_read_b128 a[96:99], v7 offset:384
    s_waitcnt lgkmcnt(8)
    v_mfma_f32_16x16x32_bf16 v[32:35], v[156:159], a[36:39], v[32:35]
    ds_write_b128 v5, v[216:219] offset:14528
    s_waitcnt lgkmcnt(8)
    v_mfma_f32_16x16x32_bf16 v[20:23], v[152:155], a[100:103], v[20:23]
    ds_read_b128 a[160:163], v7 offset:640
    v_mfma_f32_16x16x32_bf16 v[36:39], v[156:159], a[100:103], v[36:39]
    v_alignbit_b32 v220, v194, v193, 16
    v_alignbit_b32 v221, v195, v194, 16
    s_waitcnt lgkmcnt(7)
    v_mfma_f32_16x16x32_bf16 v[24:27], v[152:155], a[164:167], v[24:27]
    ds_read_b128 a[224:227], v7 offset:896
    v_mfma_f32_16x16x32_bf16 v[40:43], v[156:159], a[164:167], v[40:43]
    ds_read_b128 a[28:31], v7 offset:112
    s_waitcnt lgkmcnt(8)
    v_mfma_f32_16x16x32_bf16 v[28:31], v[152:155], a[228:231], v[28:31]
    ds_read_b128 v[168:171], v6 offset:512
    v_mfma_f32_16x16x32_bf16 v[44:47], v[156:159], a[228:231], v[44:47]
    ds_read_b128 v[172:175], v6 offset:544
    s_waitcnt lgkmcnt(8)
    v_mfma_f32_16x16x32_bf16 v[16:19], v[160:163], a[32:35], v[16:19]
    ds_read_b128 a[92:95], v7 offset:368
    s_waitcnt lgkmcnt(8)
    v_mfma_f32_16x16x32_bf16 v[32:35], v[164:167], a[32:35], v[32:35]
    v_alignbit_b32 v222, v196, v195, 16
    v_alignbit_b32 v223, v197, v196, 16
    s_waitcnt lgkmcnt(7)
    v_mfma_f32_16x16x32_bf16 v[20:23], v[160:163], a[96:99], v[20:23]
    ds_read_b128 a[156:159], v7 offset:624
    v_mfma_f32_16x16x32_bf16 v[36:39], v[164:167], a[96:99], v[36:39]
    ds_write_b128 v5, v[220:223] offset:22848
    s_waitcnt lgkmcnt(7)
    v_mfma_f32_16x16x32_bf16 v[24:27], v[160:163], a[160:163], v[24:27]
    ds_read_b128 a[220:223], v7 offset:880
    v_mfma_f32_16x16x32_bf16 v[40:43], v[164:167], a[160:163], v[40:43]
    ds_read_b128 a[24:27], v7 offset:96
    s_waitcnt lgkmcnt(8)
    v_mfma_f32_16x16x32_bf16 v[28:31], v[160:163], a[224:227], v[28:31]
    ds_read_b128 v[112:115], v6 offset:576
    v_mfma_f32_16x16x32_bf16 v[44:47], v[164:167], a[224:227], v[44:47]
    ds_read_b128 v[116:119], v6 offset:608
    s_waitcnt lgkmcnt(8)
    v_mfma_f32_16x16x32_bf16 v[16:19], v[168:171], a[28:31], v[16:19]
    ds_read_b128 a[88:91], v7 offset:352
    s_waitcnt lgkmcnt(8)
    v_mfma_f32_16x16x32_bf16 v[32:35], v[172:175], a[28:31], v[32:35]
    v_alignbit_b32 v224, v198, v197, 16
    v_alignbit_b32 v225, v199, v198, 16
    s_waitcnt lgkmcnt(7)
    v_mfma_f32_16x16x32_bf16 v[20:23], v[168:171], a[92:95], v[20:23]
    ds_read_b128 a[152:155], v7 offset:608
    v_mfma_f32_16x16x32_bf16 v[36:39], v[172:175], a[92:95], v[36:39]
    ds_write_b128 v5, v[222:225] offset:6208
    s_waitcnt lgkmcnt(8)
    v_mfma_f32_16x16x32_bf16 v[24:27], v[168:171], a[156:159], v[24:27]
    ds_read_b128 a[216:219], v7 offset:864
    v_mfma_f32_16x16x32_bf16 v[40:43], v[172:175], a[156:159], v[40:43]
    ds_read_b128 a[20:23], v7 offset:80
    s_waitcnt lgkmcnt(8)
    v_mfma_f32_16x16x32_bf16 v[28:31], v[168:171], a[220:223], v[28:31]
    ds_read_b128 v[120:123], v6 offset:640
    v_mfma_f32_16x16x32_bf16 v[44:47], v[172:175], a[220:223], v[44:47]
    ds_read_b128 v[124:127], v6 offset:672
    s_waitcnt lgkmcnt(8)
    v_mfma_f32_16x16x32_bf16 v[16:19], v[112:115], a[24:27], v[16:19]
    ds_read_b128 a[84:87], v7 offset:336
    s_waitcnt lgkmcnt(8)
    v_mfma_f32_16x16x32_bf16 v[32:35], v[116:119], a[24:27], v[32:35]
    buffer_load_dwordx4 v[192:195], v4, s[28:31], s36 offen offset:2032
    s_waitcnt lgkmcnt(7)
    v_mfma_f32_16x16x32_bf16 v[20:23], v[112:115], a[88:91], v[20:23]
    ds_read_b128 a[148:151], v7 offset:592
    v_mfma_f32_16x16x32_bf16 v[36:39], v[116:119], a[88:91], v[36:39]
    buffer_load_dwordx4 v[196:199], v4, s[28:31], s36 offen offset:2048
    s_waitcnt lgkmcnt(7)
    v_mfma_f32_16x16x32_bf16 v[24:27], v[112:115], a[152:155], v[24:27]
    ds_read_b128 a[212:215], v7 offset:848
    v_mfma_f32_16x16x32_bf16 v[40:43], v[116:119], a[152:155], v[40:43]
    ds_read_b128 a[16:19], v7 offset:64
    s_waitcnt lgkmcnt(7)
    v_mfma_f32_16x16x32_bf16 v[28:31], v[112:115], a[216:219], v[28:31]
    ds_read_b128 v[128:131], v6 offset:704
    v_mfma_f32_16x16x32_bf16 v[44:47], v[116:119], a[216:219], v[44:47]
    ds_read_b128 v[132:135], v6 offset:736
    s_waitcnt lgkmcnt(7)
    v_mfma_f32_16x16x32_bf16 v[16:19], v[120:123], a[20:23], v[16:19]
    ds_read_b128 a[80:83], v7 offset:320
    s_waitcnt lgkmcnt(7)
    v_mfma_f32_16x16x32_bf16 v[32:35], v[124:127], a[20:23], v[32:35]
    s_waitcnt vmcnt(18)
    s_waitcnt lgkmcnt(6)
    v_mfma_f32_16x16x32_bf16 v[20:23], v[120:123], a[84:87], v[20:23]
    ds_read_b128 a[144:147], v7 offset:576
    v_mfma_f32_16x16x32_bf16 v[36:39], v[124:127], a[84:87], v[36:39]
    ds_write_b128 v5, v[204:207] offset:3072
    s_waitcnt lgkmcnt(7)
    v_mfma_f32_16x16x32_bf16 v[24:27], v[120:123], a[148:151], v[24:27]
    ds_read_b128 a[208:211], v7 offset:832
    v_mfma_f32_16x16x32_bf16 v[40:43], v[124:127], a[148:151], v[40:43]
    ds_read_b128 a[12:15], v7 offset:48
    s_waitcnt lgkmcnt(8)
    v_mfma_f32_16x16x32_bf16 v[28:31], v[120:123], a[212:215], v[28:31]
    ds_read_b128 v[136:139], v6 offset:768
    v_mfma_f32_16x16x32_bf16 v[44:47], v[124:127], a[212:215], v[44:47]
    ds_read_b128 v[140:143], v6 offset:800
    s_waitcnt lgkmcnt(8)
    v_mfma_f32_16x16x32_bf16 v[16:19], v[128:131], a[16:19], v[16:19]
    ds_read_b128 a[76:79], v7 offset:304
    s_waitcnt lgkmcnt(8)
    v_mfma_f32_16x16x32_bf16 v[32:35], v[132:135], a[16:19], v[32:35]
    ds_write_b128 v5, v[202:205] offset:19712
    s_waitcnt lgkmcnt(8)
    v_mfma_f32_16x16x32_bf16 v[20:23], v[128:131], a[80:83], v[20:23]
    ds_read_b128 a[140:143], v7 offset:560
    v_mfma_f32_16x16x32_bf16 v[36:39], v[132:135], a[80:83], v[36:39]
    v_mov_b32 v208, v201
    v_mov_b32 v209, v202
    s_waitcnt lgkmcnt(8)
    v_mfma_f32_16x16x32_bf16 v[24:27], v[128:131], a[144:147], v[24:27]
    ds_read_b128 a[204:207], v7 offset:816
    v_mfma_f32_16x16x32_bf16 v[40:43], v[132:135], a[144:147], v[40:43]
    ds_read_b128 a[8:11], v7 offset:32
    s_waitcnt lgkmcnt(8)
    v_mfma_f32_16x16x32_bf16 v[28:31], v[128:131], a[208:211], v[28:31]
    ds_read_b128 v[144:147], v6 offset:832
    v_mfma_f32_16x16x32_bf16 v[44:47], v[132:135], a[208:211], v[44:47]
    ds_read_b128 v[148:151], v6 offset:864
    s_waitcnt lgkmcnt(8)
    v_mfma_f32_16x16x32_bf16 v[16:19], v[136:139], a[12:15], v[16:19]
    ds_read_b128 a[72:75], v7 offset:288
    s_waitcnt lgkmcnt(8)
    v_mfma_f32_16x16x32_bf16 v[32:35], v[140:143], a[12:15], v[32:35]
    v_mov_b32 v210, v203
    v_mov_b32 v211, v204
    s_waitcnt lgkmcnt(7)
    v_mfma_f32_16x16x32_bf16 v[20:23], v[136:139], a[76:79], v[20:23]
    ds_read_b128 a[136:139], v7 offset:544
    v_mfma_f32_16x16x32_bf16 v[36:39], v[140:143], a[76:79], v[36:39]
    ds_write_b128 v5, v[208:211] offset:28032
    s_waitcnt lgkmcnt(7)
    v_mfma_f32_16x16x32_bf16 v[24:27], v[136:139], a[140:143], v[24:27]
    ds_read_b128 a[200:203], v7 offset:800
    v_mfma_f32_16x16x32_bf16 v[40:43], v[140:143], a[140:143], v[40:43]
    ds_read_b128 a[4:7], v7 offset:16
    s_waitcnt lgkmcnt(8)
    v_mfma_f32_16x16x32_bf16 v[28:31], v[136:139], a[204:207], v[28:31]
    ds_read_b128 v[152:155], v6 offset:896
    v_mfma_f32_16x16x32_bf16 v[44:47], v[140:143], a[204:207], v[44:47]
    ds_read_b128 v[156:159], v6 offset:928
    s_waitcnt lgkmcnt(8)
    v_mfma_f32_16x16x32_bf16 v[16:19], v[144:147], a[8:11], v[16:19]
    ds_read_b128 a[68:71], v7 offset:272
    s_waitcnt lgkmcnt(8)
    v_mfma_f32_16x16x32_bf16 v[32:35], v[148:151], a[8:11], v[32:35]
    v_mov_b32 v212, v205
    v_mov_b32 v213, v206
    s_waitcnt lgkmcnt(7)
    v_mfma_f32_16x16x32_bf16 v[20:23], v[144:147], a[72:75], v[20:23]
    ds_read_b128 a[132:135], v7 offset:528
    v_mfma_f32_16x16x32_bf16 v[36:39], v[148:151], a[72:75], v[36:39]
    ds_write_b128 v5, v[210:213] offset:11392
    s_waitcnt lgkmcnt(8)
    v_mfma_f32_16x16x32_bf16 v[24:27], v[144:147], a[136:139], v[24:27]
    ds_read_b128 a[196:199], v7 offset:784
    v_mfma_f32_16x16x32_bf16 v[40:43], v[148:151], a[136:139], v[40:43]
    ds_read_b128 a[0:3], v7 offset:0
    s_waitcnt lgkmcnt(8)
    v_mfma_f32_16x16x32_bf16 v[28:31], v[144:147], a[200:203], v[28:31]
    ds_read_b128 v[160:163], v6 offset:960
    v_mfma_f32_16x16x32_bf16 v[44:47], v[148:151], a[200:203], v[44:47]
    ds_read_b128 v[164:167], v6 offset:992
    s_waitcnt lgkmcnt(8)
    v_mfma_f32_16x16x32_bf16 v[16:19], v[152:155], a[4:7], v[16:19]
    ds_read_b128 a[64:67], v7 offset:256
    s_waitcnt lgkmcnt(8)
    v_mfma_f32_16x16x32_bf16 v[32:35], v[156:159], a[4:7], v[32:35]
    v_alignbit_b32 v214, v201, v200, 16
    v_alignbit_b32 v215, v202, v201, 16
    s_waitcnt lgkmcnt(7)
    v_mfma_f32_16x16x32_bf16 v[20:23], v[152:155], a[68:71], v[20:23]
    ds_read_b128 a[128:131], v7 offset:512
    v_mfma_f32_16x16x32_bf16 v[36:39], v[156:159], a[68:71], v[36:39]
    v_alignbit_b32 v216, v203, v202, 16
    v_alignbit_b32 v217, v204, v203, 16
    s_waitcnt lgkmcnt(7)
    v_mfma_f32_16x16x32_bf16 v[24:27], v[152:155], a[132:135], v[24:27]
    ds_read_b128 a[192:195], v7 offset:768
    v_mfma_f32_16x16x32_bf16 v[40:43], v[156:159], a[132:135], v[40:43]
    ds_write_b128 v5, v[214:217] offset:32192
    s_waitcnt lgkmcnt(7)
    v_mfma_f32_16x16x32_bf16 v[28:31], v[152:155], a[196:199], v[28:31]
    ds_read_b128 v[168:171], v6 offset:1024
    v_mfma_f32_16x16x32_bf16 v[44:47], v[156:159], a[196:199], v[44:47]
    ds_read_b128 v[172:175], v6 offset:1056
    s_waitcnt lgkmcnt(7)
    v_mfma_f32_16x16x32_bf16 v[16:19], v[160:163], a[0:3], v[16:19]
    v_alignbit_b32 v218, v205, v204, 16
    v_alignbit_b32 v219, v206, v205, 16
    s_waitcnt lgkmcnt(6)
    v_mfma_f32_16x16x32_bf16 v[32:35], v[164:167], a[0:3], v[32:35]
    ds_write_b128 v5, v[216:219] offset:15552
    s_waitcnt lgkmcnt(6)
    v_mfma_f32_16x16x32_bf16 v[20:23], v[160:163], a[64:67], v[20:23]
    v_alignbit_b32 v220, v202, v201, 16
    v_alignbit_b32 v221, v203, v202, 16
    v_mfma_f32_16x16x32_bf16 v[36:39], v[164:167], a[64:67], v[36:39]
    v_alignbit_b32 v222, v204, v203, 16
    v_alignbit_b32 v223, v205, v204, 16
    s_waitcnt lgkmcnt(5)
    v_mfma_f32_16x16x32_bf16 v[24:27], v[160:163], a[128:131], v[24:27]
    ds_read_b128 v[112:115], v6 offset:1088
    v_mfma_f32_16x16x32_bf16 v[40:43], v[164:167], a[128:131], v[40:43]
    ds_read_b128 v[116:119], v6 offset:1120
    s_waitcnt lgkmcnt(6)
    v_mfma_f32_16x16x32_bf16 v[28:31], v[160:163], a[192:195], v[28:31]
    ds_write_b128 v5, v[220:223] offset:23872
    v_mfma_f32_16x16x32_bf16 v[44:47], v[164:167], a[192:195], v[44:47]
    v_alignbit_b32 v224, v206, v205, 16
    v_alignbit_b32 v225, v207, v206, 16
    s_waitcnt lgkmcnt(5)
    v_mfma_f32_16x16x32_bf16 v[20:23], v[168:171], a[60:63], v[20:23]
    ds_write_b128 v5, v[222:225] offset:7232
    s_waitcnt lgkmcnt(5)
    v_mfma_f32_16x16x32_bf16 v[36:39], v[172:175], a[60:63], v[36:39]
    buffer_load_dwordx4 v[200:203], v4, s[28:31], s36 offen offset:3056
    v_mfma_f32_16x16x32_bf16 v[24:27], v[168:171], a[124:127], v[24:27]
    ds_read_b128 v[120:123], v6 offset:1152
    v_mfma_f32_16x16x32_bf16 v[40:43], v[172:175], a[124:127], v[40:43]
    ds_read_b128 v[124:127], v6 offset:1184
    v_mfma_f32_16x16x32_bf16 v[28:31], v[168:171], a[188:191], v[28:31]
    buffer_load_dwordx4 v[204:207], v4, s[28:31], s36 offen offset:3072
    v_mfma_f32_16x16x32_bf16 v[44:47], v[172:175], a[188:191], v[44:47]
    s_waitcnt vmcnt(18)
    s_mov_b64 exec, 1
    v_mov_b32 v176, 0
    v_mov_b32 v177, 0
    v_mov_b32 v178, 0
    v_mov_b32 v179, 0
    s_mov_b64 exec, -1
    s_waitcnt lgkmcnt(5)
    v_mfma_f32_16x16x32_bf16 v[20:23], v[112:115], a[56:59], v[20:23]
    ds_write_b128 v5, v[180:183] offset:0
    s_waitcnt lgkmcnt(5)
    v_mfma_f32_16x16x32_bf16 v[36:39], v[116:119], a[56:59], v[36:39]
    ds_write_b128 v5, v[178:181] offset:16640
    v_mfma_f32_16x16x32_bf16 v[24:27], v[112:115], a[120:123], v[24:27]
    ds_read_b128 v[128:131], v6 offset:1216
    v_mfma_f32_16x16x32_bf16 v[40:43], v[116:119], a[120:123], v[40:43]
    ds_read_b128 v[132:135], v6 offset:1248
    v_mfma_f32_16x16x32_bf16 v[28:31], v[112:115], a[184:187], v[28:31]
    v_mov_b32 v208, v177
    v_mov_b32 v209, v178
    v_mfma_f32_16x16x32_bf16 v[44:47], v[116:119], a[184:187], v[44:47]
    v_mov_b32 v210, v179
    v_mov_b32 v211, v180
    s_waitcnt lgkmcnt(5)
    v_mfma_f32_16x16x32_bf16 v[20:23], v[120:123], a[52:55], v[20:23]
    ds_write_b128 v5, v[208:211] offset:24960
    s_waitcnt lgkmcnt(5)
    v_mfma_f32_16x16x32_bf16 v[36:39], v[124:127], a[52:55], v[36:39]
    v_mov_b32 v212, v181
    v_mov_b32 v213, v182
    v_mfma_f32_16x16x32_bf16 v[24:27], v[120:123], a[116:119], v[24:27]
    ds_read_b128 v[136:139], v6 offset:1280
    v_mfma_f32_16x16x32_bf16 v[40:43], v[124:127], a[116:119], v[40:43]
    ds_read_b128 v[140:143], v6 offset:1312
    v_mfma_f32_16x16x32_bf16 v[28:31], v[120:123], a[180:183], v[28:31]
    ds_write_b128 v5, v[210:213] offset:8320
    v_mfma_f32_16x16x32_bf16 v[44:47], v[124:127], a[180:183], v[44:47]
    v_alignbit_b32 v214, v177, v176, 16
    v_alignbit_b32 v215, v178, v177, 16
    s_waitcnt lgkmcnt(5)
    v_mfma_f32_16x16x32_bf16 v[20:23], v[128:131], a[48:51], v[20:23]
    v_alignbit_b32 v216, v179, v178, 16
    v_alignbit_b32 v217, v180, v179, 16
    s_waitcnt lgkmcnt(4)
    v_mfma_f32_16x16x32_bf16 v[36:39], v[132:135], a[48:51], v[36:39]
    ds_write_b128 v5, v[214:217] offset:29120
    v_mfma_f32_16x16x32_bf16 v[24:27], v[128:131], a[112:115], v[24:27]
    ds_read_b128 v[144:147], v6 offset:1344
    v_mfma_f32_16x16x32_bf16 v[40:43], v[132:135], a[112:115], v[40:43]
    ds_read_b128 v[148:151], v6 offset:1376
    v_mfma_f32_16x16x32_bf16 v[28:31], v[128:131], a[176:179], v[28:31]
    v_alignbit_b32 v218, v181, v180, 16
    v_alignbit_b32 v219, v182, v181, 16
    v_mfma_f32_16x16x32_bf16 v[44:47], v[132:135], a[176:179], v[44:47]
    ds_write_b128 v5, v[216:219] offset:12480
    s_waitcnt lgkmcnt(6)
    v_mfma_f32_16x16x32_bf16 v[20:23], v[136:139], a[44:47], v[20:23]
    v_alignbit_b32 v220, v178, v177, 16
    v_alignbit_b32 v221, v179, v178, 16
    s_waitcnt lgkmcnt(5)
    v_mfma_f32_16x16x32_bf16 v[36:39], v[140:143], a[44:47], v[36:39]
    v_alignbit_b32 v222, v180, v179, 16
    v_alignbit_b32 v223, v181, v180, 16
    v_mfma_f32_16x16x32_bf16 v[24:27], v[136:139], a[108:111], v[24:27]
    ds_read_b128 v[152:155], v6 offset:1408
    v_mfma_f32_16x16x32_bf16 v[40:43], v[140:143], a[108:111], v[40:43]
    ds_read_b128 v[156:159], v6 offset:1440
    v_mfma_f32_16x16x32_bf16 v[28:31], v[136:139], a[172:175], v[28:31]
    ds_write_b128 v5, v[220:223] offset:20800
    v_mfma_f32_16x16x32_bf16 v[44:47], v[140:143], a[172:175], v[44:47]
    v_alignbit_b32 v224, v182, v181, 16
    v_alignbit_b32 v225, v183, v182, 16
    s_waitcnt lgkmcnt(5)
    v_mfma_f32_16x16x32_bf16 v[20:23], v[144:147], a[40:43], v[20:23]
    ds_write_b128 v5, v[222:225] offset:4160
    s_waitcnt lgkmcnt(5)
    v_mfma_f32_16x16x32_bf16 v[36:39], v[148:151], a[40:43], v[36:39]
    buffer_load_dwordx4 v[176:179], v230, s[28:31], s37 offen offset:0
    v_mfma_f32_16x16x32_bf16 v[24:27], v[144:147], a[104:107], v[24:27]
    ds_read_b128 v[160:163], v6 offset:1472
    v_mfma_f32_16x16x32_bf16 v[40:43], v[148:151], a[104:107], v[40:43]
    ds_read_b128 v[164:167], v6 offset:1504
    v_mfma_f32_16x16x32_bf16 v[28:31], v[144:147], a[168:171], v[28:31]
    buffer_load_dwordx4 v[180:183], v4, s[28:31], s37 offen offset:0
    v_mfma_f32_16x16x32_bf16 v[44:47], v[148:151], a[168:171], v[44:47]
    s_add_u32 m0, s35, 0
    s_waitcnt lgkmcnt(5)
    v_mfma_f32_16x16x32_bf16 v[20:23], v[152:155], a[36:39], v[20:23]
    buffer_load_dwordx4 v4, s[8:11], s39 offen offset:0 lds
    s_waitcnt lgkmcnt(4)
    v_mfma_f32_16x16x32_bf16 v[36:39], v[156:159], a[36:39], v[36:39]
    s_add_u32 m0, s35, 256
    v_mfma_f32_16x16x32_bf16 v[24:27], v[152:155], a[100:103], v[24:27]
    ds_read_b128 v[168:171], v6 offset:1536
    v_mfma_f32_16x16x32_bf16 v[40:43], v[156:159], a[100:103], v[40:43]
    ds_read_b128 v[172:175], v6 offset:1568
    v_mfma_f32_16x16x32_bf16 v[28:31], v[152:155], a[164:167], v[28:31]
    buffer_load_dwordx4 v4, s[8:11], s39 offen offset:1024 lds
    v_mfma_f32_16x16x32_bf16 v[44:47], v[156:159], a[164:167], v[44:47]
    s_add_u32 m0, s35, 512
    s_waitcnt lgkmcnt(3)
    v_mfma_f32_16x16x32_bf16 v[20:23], v[160:163], a[32:35], v[20:23]
    buffer_load_dwordx4 v4, s[8:11], s39 offen offset:2048 lds
    s_waitcnt lgkmcnt(2)
    v_mfma_f32_16x16x32_bf16 v[36:39], v[164:167], a[32:35], v[36:39]
    s_add_u32 m0, s35, 768
    v_mfma_f32_16x16x32_bf16 v[24:27], v[160:163], a[96:99], v[24:27]
    ds_read_b128 v[112:115], v6 offset:1600
    v_mfma_f32_16x16x32_bf16 v[40:43], v[164:167], a[96:99], v[40:43]
    ds_read_b128 v[116:119], v6 offset:1632
    v_mfma_f32_16x16x32_bf16 v[28:31], v[160:163], a[160:163], v[28:31]
    buffer_load_dwordx4 v4, s[8:11], s39 offen offset:3072 lds
    v_mfma_f32_16x16x32_bf16 v[44:47], v[164:167], a[160:163], v[44:47]
    s_waitcnt lgkmcnt(3)
    v_mfma_f32_16x16x32_bf16 v[20:23], v[168:171], a[28:31], v[20:23]
    s_waitcnt lgkmcnt(2)
    v_mfma_f32_16x16x32_bf16 v[36:39], v[172:175], a[28:31], v[36:39]
    v_mfma_f32_16x16x32_bf16 v[24:27], v[168:171], a[92:95], v[24:27]
    ds_read_b128 v[120:123], v6 offset:1664
    v_mfma_f32_16x16x32_bf16 v[40:43], v[172:175], a[92:95], v[40:43]
    ds_read_b128 v[124:127], v6 offset:1696
    v_mfma_f32_16x16x32_bf16 v[28:31], v[168:171], a[156:159], v[28:31]
    v_mfma_f32_16x16x32_bf16 v[44:47], v[172:175], a[156:159], v[44:47]
    s_waitcnt lgkmcnt(3)
    v_mfma_f32_16x16x32_bf16 v[20:23], v[112:115], a[24:27], v[20:23]
    s_waitcnt lgkmcnt(2)
    v_mfma_f32_16x16x32_bf16 v[36:39], v[116:119], a[24:27], v[36:39]
    v_mfma_f32_16x16x32_bf16 v[24:27], v[112:115], a[88:91], v[24:27]
    ds_read_b128 v[128:131], v6 offset:1728
    v_mfma_f32_16x16x32_bf16 v[40:43], v[116:119], a[88:91], v[40:43]
    ds_read_b128 v[132:135], v6 offset:1760
    v_mfma_f32_16x16x32_bf16 v[28:31], v[112:115], a[152:155], v[28:31]
    v_mfma_f32_16x16x32_bf16 v[44:47], v[116:119], a[152:155], v[44:47]
    s_waitcnt lgkmcnt(3)
    v_mfma_f32_16x16x32_bf16 v[20:23], v[120:123], a[20:23], v[20:23]
    s_waitcnt lgkmcnt(2)
    v_mfma_f32_16x16x32_bf16 v[36:39], v[124:127], a[20:23], v[36:39]
    v_mfma_f32_16x16x32_bf16 v[24:27], v[120:123], a[84:87], v[24:27]
    ds_read_b128 v[136:139], v6 offset:1792
    v_mfma_f32_16x16x32_bf16 v[40:43], v[124:127], a[84:87], v[40:43]
    ds_read_b128 v[140:143], v6 offset:1824
    v_mfma_f32_16x16x32_bf16 v[28:31], v[120:123], a[148:151], v[28:31]
    v_mfma_f32_16x16x32_bf16 v[44:47], v[124:127], a[148:151], v[44:47]
    s_waitcnt lgkmcnt(3)
    v_mfma_f32_16x16x32_bf16 v[20:23], v[128:131], a[16:19], v[20:23]
    s_waitcnt lgkmcnt(2)
    v_mfma_f32_16x16x32_bf16 v[36:39], v[132:135], a[16:19], v[36:39]
    v_mfma_f32_16x16x32_bf16 v[24:27], v[128:131], a[80:83], v[24:27]
    ds_read_b128 v[144:147], v6 offset:1856
    v_mfma_f32_16x16x32_bf16 v[40:43], v[132:135], a[80:83], v[40:43]
    ds_read_b128 v[148:151], v6 offset:1888
    v_mfma_f32_16x16x32_bf16 v[28:31], v[128:131], a[144:147], v[28:31]
    v_mfma_f32_16x16x32_bf16 v[44:47], v[132:135], a[144:147], v[44:47]
    s_waitcnt lgkmcnt(3)
    v_mfma_f32_16x16x32_bf16 v[20:23], v[136:139], a[12:15], v[20:23]
    s_waitcnt lgkmcnt(2)
    v_mfma_f32_16x16x32_bf16 v[36:39], v[140:143], a[12:15], v[36:39]
    v_mfma_f32_16x16x32_bf16 v[24:27], v[136:139], a[76:79], v[24:27]
    ds_read_b128 v[152:155], v6 offset:1920
    v_mfma_f32_16x16x32_bf16 v[40:43], v[140:143], a[76:79], v[40:43]
    ds_read_b128 v[156:159], v6 offset:1952
    v_mfma_f32_16x16x32_bf16 v[28:31], v[136:139], a[140:143], v[28:31]
    v_mfma_f32_16x16x32_bf16 v[44:47], v[140:143], a[140:143], v[44:47]
    s_waitcnt lgkmcnt(3)
    v_mfma_f32_16x16x32_bf16 v[20:23], v[144:147], a[8:11], v[20:23]
    s_waitcnt lgkmcnt(2)
    v_mfma_f32_16x16x32_bf16 v[36:39], v[148:151], a[8:11], v[36:39]
    v_mfma_f32_16x16x32_bf16 v[24:27], v[144:147], a[72:75], v[24:27]
    ds_read_b128 v[160:163], v6 offset:1984
    v_mfma_f32_16x16x32_bf16 v[40:43], v[148:151], a[72:75], v[40:43]
    ds_read_b128 v[164:167], v6 offset:2016
    v_mfma_f32_16x16x32_bf16 v[28:31], v[144:147], a[136:139], v[28:31]
    v_mfma_f32_16x16x32_bf16 v[44:47], v[148:151], a[136:139], v[44:47]
    s_waitcnt lgkmcnt(3)
    v_mfma_f32_16x16x32_bf16 v[20:23], v[152:155], a[4:7], v[20:23]
    s_waitcnt lgkmcnt(2)
    v_mfma_f32_16x16x32_bf16 v[36:39], v[156:159], a[4:7], v[36:39]
    v_mfma_f32_16x16x32_bf16 v[24:27], v[152:155], a[68:71], v[24:27]
    ds_read_b128 v[168:171], v6 offset:2048
    v_mfma_f32_16x16x32_bf16 v[40:43], v[156:159], a[68:71], v[40:43]
    ds_read_b128 v[172:175], v6 offset:2080
    v_mfma_f32_16x16x32_bf16 v[28:31], v[152:155], a[132:135], v[28:31]
    s_waitcnt vmcnt(18)
    v_mfma_f32_16x16x32_bf16 v[44:47], v[156:159], a[132:135], v[44:47]
    ds_write_b128 v5, v[188:191] offset:1024
    s_waitcnt lgkmcnt(4)
    v_mfma_f32_16x16x32_bf16 v[20:23], v[160:163], a[0:3], v[20:23]
    ds_read_b128 v[112:115], v6 offset:2112
    s_waitcnt lgkmcnt(4)
    v_mfma_f32_16x16x32_bf16 v[36:39], v[164:167], a[0:3], v[36:39]
    ds_read_b128 v[116:119], v6 offset:2144
    v_mfma_f32_16x16x32_bf16 v[24:27], v[160:163], a[64:67], v[24:27]
    ds_write_b128 v5, v[186:189] offset:17664
    v_mfma_f32_16x16x32_bf16 v[40:43], v[164:167], a[64:67], v[40:43]
    v_mov_b32 v208, v185
    v_mov_b32 v209, v186
    v_mfma_f32_16x16x32_bf16 v[28:31], v[160:163], a[128:131], v[28:31]
    ds_read_b128 v[120:123], v6 offset:2176
    v_mfma_f32_16x16x32_bf16 v[44:47], v[164:167], a[128:131], v[44:47]
    ds_read_b128 v[124:127], v6 offset:2208
    s_waitcnt lgkmcnt(7)
    v_mfma_f32_16x16x32_bf16 v[24:27], v[168:171], a[60:63], v[24:27]
    v_mov_b32 v210, v187
    v_mov_b32 v211, v188
    s_waitcnt lgkmcnt(6)
    v_mfma_f32_16x16x32_bf16 v[40:43], v[172:175], a[60:63], v[40:43]
    ds_write_b128 v5, v[208:211] offset:25984
    v_mfma_f32_16x16x32_bf16 v[28:31], v[168:171], a[124:127], v[28:31]
    ds_read_b128 v[128:131], v6 offset:2240
    v_mfma_f32_16x16x32_bf16 v[44:47], v[172:175], a[124:127], v[44:47]
    ds_read_b128 v[132:135], v6 offset:2272
    s_waitcnt lgkmcnt(7)
    v_mfma_f32_16x16x32_bf16 v[24:27], v[112:115], a[56:59], v[24:27]
    v_mov_b32 v212, v189
    v_mov_b32 v213, v190
    s_waitcnt lgkmcnt(6)
    v_mfma_f32_16x16x32_bf16 v[40:43], v[116:119], a[56:59], v[40:43]
    ds_write_b128 v5, v[210:213] offset:9344
    v_mfma_f32_16x16x32_bf16 v[28:31], v[112:115], a[120:123], v[28:31]
    ds_read_b128 v[136:139], v6 offset:2304
    v_mfma_f32_16x16x32_bf16 v[44:47], v[116:119], a[120:123], v[44:47]
    ds_read_b128 v[140:143], v6 offset:2336
    s_waitcnt lgkmcnt(7)
    v_mfma_f32_16x16x32_bf16 v[24:27], v[120:123], a[52:55], v[24:27]
    v_alignbit_b32 v214, v185, v184, 16
    v_alignbit_b32 v215, v186, v185, 16
    s_waitcnt lgkmcnt(6)
    v_mfma_f32_16x16x32_bf16 v[40:43], v[124:127], a[52:55], v[40:43]
    v_alignbit_b32 v216, v187, v186, 16
    v_alignbit_b32 v217, v188, v187, 16
    v_mfma_f32_16x16x32_bf16 v[28:31], v[120:123], a[116:119], v[28:31]
    ds_read_b128 v[144:147], v6 offset:2368
    v_mfma_f32_16x16x32_bf16 v[44:47], v[124:127], a[116:119], v[44:47]
    ds_read_b128 v[148:151], v6 offset:2400
    s_waitcnt lgkmcnt(6)
    v_mfma_f32_16x16x32_bf16 v[24:27], v[128:131], a[48:51], v[24:27]
    ds_write_b128 v5, v[214:217] offset:30144
    s_waitcnt lgkmcnt(6)
    v_mfma_f32_16x16x32_bf16 v[40:43], v[132:135], a[48:51], v[40:43]
    v_alignbit_b32 v218, v189, v188, 16
    v_alignbit_b32 v219, v190, v189, 16
    v_mfma_f32_16x16x32_bf16 v[28:31], v[128:131], a[112:115], v[28:31]
    ds_read_b128 v[152:155], v6 offset:2432
    v_mfma_f32_16x16x32_bf16 v[44:47], v[132:135], a[112:115], v[44:47]
    ds_read_b128 v[156:159], v6 offset:2464
    s_waitcnt lgkmcnt(6)
    v_mfma_f32_16x16x32_bf16 v[24:27], v[136:139], a[44:47], v[24:27]
    ds_write_b128 v5, v[216:219] offset:13504
    s_waitcnt lgkmcnt(6)
    v_mfma_f32_16x16x32_bf16 v[40:43], v[140:143], a[44:47], v[40:43]
    v_alignbit_b32 v220, v186, v185, 16
    v_alignbit_b32 v221, v187, v186, 16
    v_mfma_f32_16x16x32_bf16 v[28:31], v[136:139], a[108:111], v[28:31]
    ds_read_b128 v[160:163], v6 offset:2496
    v_mfma_f32_16x16x32_bf16 v[44:47], v[140:143], a[108:111], v[44:47]
    ds_read_b128 v[164:167], v6 offset:2528
    s_waitcnt lgkmcnt(7)
    v_mfma_f32_16x16x32_bf16 v[24:27], v[144:147], a[40:43], v[24:27]
    v_alignbit_b32 v222, v188, v187, 16
    v_alignbit_b32 v223, v189, v188, 16
    s_waitcnt lgkmcnt(6)
    v_mfma_f32_16x16x32_bf16 v[40:43], v[148:151], a[40:43], v[40:43]
    ds_write_b128 v5, v[220:223] offset:21824
    v_mfma_f32_16x16x32_bf16 v[28:31], v[144:147], a[104:107], v[28:31]
    ds_read_b128 v[168:171], v6 offset:2560
    v_mfma_f32_16x16x32_bf16 v[44:47], v[148:151], a[104:107], v[44:47]
    ds_read_b128 v[172:175], v6 offset:2592
    s_waitcnt lgkmcnt(7)
    v_mfma_f32_16x16x32_bf16 v[24:27], v[152:155], a[36:39], v[24:27]
    v_alignbit_b32 v224, v190, v189, 16
    v_alignbit_b32 v225, v191, v190, 16
    s_waitcnt lgkmcnt(6)
    v_mfma_f32_16x16x32_bf16 v[40:43], v[156:159], a[36:39], v[40:43]
    ds_write_b128 v5, v[222:225] offset:5184
    v_mfma_f32_16x16x32_bf16 v[28:31], v[152:155], a[100:103], v[28:31]
    ds_read_b128 v[112:115], v6 offset:2624
    v_mfma_f32_16x16x32_bf16 v[44:47], v[156:159], a[100:103], v[44:47]
    ds_read_b128 v[116:119], v6 offset:2656
    s_waitcnt lgkmcnt(7)
    v_mfma_f32_16x16x32_bf16 v[24:27], v[160:163], a[32:35], v[24:27]
    buffer_load_dwordx4 v[184:187], v4, s[28:31], s37 offen offset:1008
    s_waitcnt lgkmcnt(6)
    v_mfma_f32_16x16x32_bf16 v[40:43], v[164:167], a[32:35], v[40:43]
    buffer_load_dwordx4 v[188:191], v4, s[28:31], s37 offen offset:1024
    v_mfma_f32_16x16x32_bf16 v[28:31], v[160:163], a[96:99], v[28:31]
    ds_read_b128 v[120:123], v6 offset:2688
    v_mfma_f32_16x16x32_bf16 v[44:47], v[164:167], a[96:99], v[44:47]
    ds_read_b128 v[124:127], v6 offset:2720
    s_waitcnt lgkmcnt(6)
    v_mfma_f32_16x16x32_bf16 v[24:27], v[168:171], a[28:31], v[24:27]
    s_mov_b32 s36, s37
    s_add_u32 s39, s37, 125829120
    s_add_u32 s37, s37, 4096
    s_min_u32 s37, s37, s33

    s_pack_hh_b32_b16 s40, s64, s64
    v_and_b32 v236, s40, v8
    s_waitcnt lgkmcnt(5)
    v_mfma_f32_16x16x32_bf16 v[40:43], v[172:175], a[28:31], v[40:43]
    v_and_b32 v237, s40, v9
    v_and_b32 v238, s40, v10
    v_mfma_f32_16x16x32_bf16 v[28:31], v[168:171], a[92:95], v[28:31]
    ds_read_b128 v[128:131], v6 offset:2752
    v_mfma_f32_16x16x32_bf16 v[44:47], v[172:175], a[92:95], v[44:47]
    ds_read_b128 v[132:135], v6 offset:2784
    s_waitcnt lgkmcnt(5)
    v_mfma_f32_16x16x32_bf16 v[24:27], v[112:115], a[24:27], v[24:27]
    v_and_b32 v239, s40, v11
    v_and_b32 v240, s40, v12
    s_waitcnt lgkmcnt(4)
    v_mfma_f32_16x16x32_bf16 v[40:43], v[116:119], a[24:27], v[40:43]
    v_and_b32 v241, s40, v13
    v_and_b32 v242, s40, v14
    v_mfma_f32_16x16x32_bf16 v[28:31], v[112:115], a[88:91], v[28:31]
    ds_read_b128 v[136:139], v6 offset:2816
    v_mfma_f32_16x16x32_bf16 v[44:47], v[116:119], a[88:91], v[44:47]
    ds_read_b128 v[140:143], v6 offset:2848
    s_waitcnt lgkmcnt(5)
    v_mfma_f32_16x16x32_bf16 v[24:27], v[120:123], a[20:23], v[24:27]
    v_and_b32 v243, s40, v15
    s_waitcnt lgkmcnt(4)
    v_mfma_f32_16x16x32_bf16 v[40:43], v[124:127], a[20:23], v[40:43]
    v_mfma_f32_16x16x32_bf16 v[28:31], v[120:123], a[84:87], v[28:31]
    ds_read_b128 v[144:147], v6 offset:2880
    v_mfma_f32_16x16x32_bf16 v[44:47], v[124:127], a[84:87], v[44:47]
    ds_read_b128 v[148:151], v6 offset:2912
    s_waitcnt lgkmcnt(5)
    v_mfma_f32_16x16x32_bf16 v[24:27], v[128:131], a[16:19], v[24:27]
    s_waitcnt lgkmcnt(4)
    v_mfma_f32_16x16x32_bf16 v[40:43], v[132:135], a[16:19], v[40:43]
    v_mfma_f32_16x16x32_bf16 v[28:31], v[128:131], a[80:83], v[28:31]
    ds_read_b128 v[152:155], v6 offset:2944
    v_mfma_f32_16x16x32_bf16 v[44:47], v[132:135], a[80:83], v[44:47]
    ds_read_b128 v[156:159], v6 offset:2976
    s_waitcnt lgkmcnt(5)
    v_mfma_f32_16x16x32_bf16 v[24:27], v[136:139], a[12:15], v[24:27]
    s_waitcnt lgkmcnt(4)
    v_mfma_f32_16x16x32_bf16 v[40:43], v[140:143], a[12:15], v[40:43]
    v_mfma_f32_16x16x32_bf16 v[28:31], v[136:139], a[76:79], v[28:31]
    ds_read_b128 v[160:163], v6 offset:3008
    v_mfma_f32_16x16x32_bf16 v[44:47], v[140:143], a[76:79], v[44:47]
    ds_read_b128 v[164:167], v6 offset:3040
    s_waitcnt lgkmcnt(5)
    v_mfma_f32_16x16x32_bf16 v[24:27], v[144:147], a[8:11], v[24:27]
    s_waitcnt lgkmcnt(4)
    v_mfma_f32_16x16x32_bf16 v[40:43], v[148:151], a[8:11], v[40:43]
    v_mfma_f32_16x16x32_bf16 v[28:31], v[144:147], a[72:75], v[28:31]
    ds_read_b128 v[168:171], v6 offset:3072
    v_mfma_f32_16x16x32_bf16 v[44:47], v[148:151], a[72:75], v[44:47]
    ds_read_b128 v[172:175], v6 offset:3104
    s_waitcnt lgkmcnt(5)
    v_mfma_f32_16x16x32_bf16 v[24:27], v[152:155], a[4:7], v[24:27]
    ds_read_b128 v[112:115], v6 offset:3136
    s_waitcnt lgkmcnt(5)
    v_mfma_f32_16x16x32_bf16 v[40:43], v[156:159], a[4:7], v[40:43]
    ds_read_b128 v[116:119], v6 offset:3168
    v_mfma_f32_16x16x32_bf16 v[28:31], v[152:155], a[68:71], v[28:31]
    ds_read_b128 v[120:123], v6 offset:3200
    v_mfma_f32_16x16x32_bf16 v[44:47], v[156:159], a[68:71], v[44:47]
    ds_read_b128 v[124:127], v6 offset:3232
    s_waitcnt lgkmcnt(7)
    v_mfma_f32_16x16x32_bf16 v[24:27], v[160:163], a[0:3], v[24:27]
    ds_read_b128 v[128:131], v6 offset:3264
    s_waitcnt lgkmcnt(7)
    v_mfma_f32_16x16x32_bf16 v[40:43], v[164:167], a[0:3], v[40:43]
    ds_read_b128 v[132:135], v6 offset:3296
    v_mfma_f32_16x16x32_bf16 v[28:31], v[160:163], a[64:67], v[28:31]
    ds_read_b128 v[136:139], v6 offset:3328
    v_mfma_f32_16x16x32_bf16 v[44:47], v[164:167], a[64:67], v[44:47]
    ds_read_b128 v[140:143], v6 offset:3360
    s_waitcnt lgkmcnt(9)
    v_mfma_f32_16x16x32_bf16 v[28:31], v[168:171], a[60:63], v[28:31]
    ds_read_b128 v[144:147], v6 offset:3392
    s_waitcnt lgkmcnt(9)
    v_mfma_f32_16x16x32_bf16 v[44:47], v[172:175], a[60:63], v[44:47]
    ds_read_b128 v[148:151], v6 offset:3424
    s_waitcnt lgkmcnt(9)
    v_mfma_f32_16x16x32_bf16 v[28:31], v[112:115], a[56:59], v[28:31]
    ds_read_b128 v[152:155], v6 offset:3456
    s_waitcnt lgkmcnt(9)
    v_mfma_f32_16x16x32_bf16 v[44:47], v[116:119], a[56:59], v[44:47]
    ds_read_b128 v[156:159], v6 offset:3488
    s_waitcnt lgkmcnt(9)
    v_mfma_f32_16x16x32_bf16 v[28:31], v[120:123], a[52:55], v[28:31]
    ds_read_b128 v[160:163], v6 offset:3520
    s_waitcnt lgkmcnt(9)
    v_mfma_f32_16x16x32_bf16 v[44:47], v[124:127], a[52:55], v[44:47]
    ds_read_b128 v[164:167], v6 offset:3552
    s_waitcnt lgkmcnt(9)
    v_mfma_f32_16x16x32_bf16 v[28:31], v[128:131], a[48:51], v[28:31]
    ds_read_b128 v[168:171], v6 offset:3584
    s_waitcnt lgkmcnt(9)
    v_mfma_f32_16x16x32_bf16 v[44:47], v[132:135], a[48:51], v[44:47]
    ds_read_b128 v[172:175], v6 offset:3616
    s_waitcnt lgkmcnt(9)
    v_mfma_f32_16x16x32_bf16 v[28:31], v[136:139], a[44:47], v[28:31]
    ds_read_b128 v[112:115], v6 offset:3648
    s_waitcnt lgkmcnt(9)
    v_mfma_f32_16x16x32_bf16 v[44:47], v[140:143], a[44:47], v[44:47]
    ds_read_b128 v[116:119], v6 offset:3680
    s_waitcnt lgkmcnt(9)
    v_mfma_f32_16x16x32_bf16 v[28:31], v[144:147], a[40:43], v[28:31]
    ds_read_b128 v[120:123], v6 offset:3712
    s_waitcnt lgkmcnt(9)
    v_mfma_f32_16x16x32_bf16 v[44:47], v[148:151], a[40:43], v[44:47]
    ds_read_b128 v[124:127], v6 offset:3744
    s_waitcnt lgkmcnt(9)
    v_mfma_f32_16x16x32_bf16 v[28:31], v[152:155], a[36:39], v[28:31]
    ds_read_b128 v[128:131], v6 offset:3776
    s_waitcnt lgkmcnt(9)
    v_mfma_f32_16x16x32_bf16 v[44:47], v[156:159], a[36:39], v[44:47]
    ds_read_b128 v[132:135], v6 offset:3808
    s_waitcnt lgkmcnt(9)
    v_mfma_f32_16x16x32_bf16 v[28:31], v[160:163], a[32:35], v[28:31]
    ds_read_b128 v[136:139], v6 offset:3840
    s_waitcnt lgkmcnt(9)
    v_mfma_f32_16x16x32_bf16 v[44:47], v[164:167], a[32:35], v[44:47]
    ds_read_b128 v[140:143], v6 offset:3872
    s_waitcnt lgkmcnt(9)
    v_mfma_f32_16x16x32_bf16 v[28:31], v[168:171], a[28:31], v[28:31]
    ds_read_b128 v[144:147], v6 offset:3904
    s_waitcnt lgkmcnt(9)
    v_mfma_f32_16x16x32_bf16 v[44:47], v[172:175], a[28:31], v[44:47]
    ds_read_b128 v[148:151], v6 offset:3936
    s_waitcnt lgkmcnt(9)
    v_mfma_f32_16x16x32_bf16 v[28:31], v[112:115], a[24:27], v[28:31]
    ds_read_b128 v[152:155], v6 offset:3968
    s_waitcnt lgkmcnt(9)
    v_mfma_f32_16x16x32_bf16 v[44:47], v[116:119], a[24:27], v[44:47]
    ds_read_b128 v[156:159], v6 offset:4000
    s_waitcnt lgkmcnt(9)
    v_mfma_f32_16x16x32_bf16 v[28:31], v[120:123], a[20:23], v[28:31]
    ds_read_b128 v[160:163], v6 offset:4032
    s_waitcnt lgkmcnt(9)
    v_mfma_f32_16x16x32_bf16 v[44:47], v[124:127], a[20:23], v[44:47]
    ds_read_b128 v[164:167], v6 offset:4064
    s_waitcnt lgkmcnt(9)
    v_mfma_f32_16x16x32_bf16 v[28:31], v[128:131], a[16:19], v[28:31]
    s_waitcnt vmcnt(2)
    ds_read_b128 a[60:63], v7 offset:240
    s_waitcnt lgkmcnt(9)
    v_mfma_f32_16x16x32_bf16 v[44:47], v[132:135], a[16:19], v[44:47]
    s_waitcnt lgkmcnt(8)
    v_mfma_f32_16x16x32_bf16 v[28:31], v[136:139], a[12:15], v[28:31]
    ds_read_b128 a[124:127], v7 offset:496
    s_waitcnt lgkmcnt(8)
    v_mfma_f32_16x16x32_bf16 v[44:47], v[140:143], a[12:15], v[44:47]
    s_waitcnt lgkmcnt(7)
    v_mfma_f32_16x16x32_bf16 v[28:31], v[144:147], a[8:11], v[28:31]
    ds_read_b128 a[188:191], v7 offset:752
    s_waitcnt lgkmcnt(7)
    v_mfma_f32_16x16x32_bf16 v[44:47], v[148:151], a[8:11], v[44:47]
    s_waitcnt lgkmcnt(6)
    v_mfma_f32_16x16x32_bf16 v[28:31], v[152:155], a[4:7], v[28:31]
    ds_read_b128 a[252:255], v7 offset:1008
    s_waitcnt lgkmcnt(6)
    v_mfma_f32_16x16x32_bf16 v[44:47], v[156:159], a[4:7], v[44:47]
    s_waitcnt lgkmcnt(5)
    v_mfma_f32_16x16x32_bf16 v[28:31], v[160:163], a[0:3], v[28:31]
    ds_read_b128 v[168:171], v6 offset:0
    s_waitcnt lgkmcnt(5)
    v_mfma_f32_16x16x32_bf16 v[44:47], v[164:167], a[0:3], v[44:47]
    ds_read_b128 v[172:175], v6 offset:32
    s_waitcnt lgkmcnt(5)
    v_mfma_f32_16x16x32_bf16 v[48:51], v[236:239], a[60:63], 0
    v_mfma_f32_16x16x32_bf16 v[64:67], v[240:243], a[60:63], 0
    s_waitcnt lgkmcnt(4)
    v_mfma_f32_16x16x32_bf16 v[52:55], v[236:239], a[124:127], 0
    v_mfma_f32_16x16x32_bf16 v[68:71], v[240:243], a[124:127], 0
    s_waitcnt lgkmcnt(3)
    v_mfma_f32_16x16x32_bf16 v[56:59], v[236:239], a[188:191], 0
    v_mfma_f32_16x16x32_bf16 v[72:75], v[240:243], a[188:191], 0
    ds_read_b128 a[56:59], v7 offset:224
    s_waitcnt lgkmcnt(3)
    v_mfma_f32_16x16x32_bf16 v[60:63], v[236:239], a[252:255], 0
    ds_read_b128 v[112:115], v6 offset:64
    v_mfma_f32_16x16x32_bf16 v[76:79], v[240:243], a[252:255], 0
    ds_read_b128 v[116:119], v6 offset:96
    s_waitcnt lgkmcnt(4)
    v_mfma_f32_16x16x32_bf16 v[48:51], v[168:171], a[60:63], v[48:51]
    ds_read_b128 a[120:123], v7 offset:480
    s_waitcnt lgkmcnt(4)
    v_mfma_f32_16x16x32_bf16 v[64:67], v[172:175], a[60:63], v[64:67]
    s_waitcnt vmcnt(10)
    v_mfma_f32_16x16x32_bf16 v[52:55], v[168:171], a[124:127], v[52:55]
    ds_read_b128 a[184:187], v7 offset:736
    v_mfma_f32_16x16x32_bf16 v[68:71], v[172:175], a[124:127], v[68:71]
    ds_write_b128 v5, v[196:199] offset:2048
    v_mfma_f32_16x16x32_bf16 v[56:59], v[168:171], a[188:191], v[56:59]
    ds_read_b128 a[248:251], v7 offset:992
    v_mfma_f32_16x16x32_bf16 v[72:75], v[172:175], a[188:191], v[72:75]
    ds_read_b128 a[52:55], v7 offset:208
    v_mfma_f32_16x16x32_bf16 v[60:63], v[168:171], a[252:255], v[60:63]
    ds_read_b128 v[120:123], v6 offset:128
    v_mfma_f32_16x16x32_bf16 v[76:79], v[172:175], a[252:255], v[76:79]
    ds_read_b128 v[124:127], v6 offset:160
    s_waitcnt lgkmcnt(8)
    v_mfma_f32_16x16x32_bf16 v[48:51], v[112:115], a[56:59], v[48:51]
    ds_read_b128 a[116:119], v7 offset:464
    s_waitcnt lgkmcnt(8)
    v_mfma_f32_16x16x32_bf16 v[64:67], v[116:119], a[56:59], v[64:67]
    ds_write_b128 v5, v[194:197] offset:18688
    s_waitcnt lgkmcnt(8)
    v_mfma_f32_16x16x32_bf16 v[52:55], v[112:115], a[120:123], v[52:55]
    ds_read_b128 a[180:183], v7 offset:720
    v_mfma_f32_16x16x32_bf16 v[68:71], v[116:119], a[120:123], v[68:71]
    v_mov_b32 v208, v193
    v_mov_b32 v209, v194
    s_waitcnt lgkmcnt(8)
    v_mfma_f32_16x16x32_bf16 v[56:59], v[112:115], a[184:187], v[56:59]
    ds_read_b128 a[244:247], v7 offset:976
    v_mfma_f32_16x16x32_bf16 v[72:75], v[116:119], a[184:187], v[72:75]
    ds_read_b128 a[48:51], v7 offset:192
    s_waitcnt lgkmcnt(8)
    v_mfma_f32_16x16x32_bf16 v[60:63], v[112:115], a[248:251], v[60:63]
    ds_read_b128 v[128:131], v6 offset:192
    v_mfma_f32_16x16x32_bf16 v[76:79], v[116:119], a[248:251], v[76:79]
    ds_read_b128 v[132:135], v6 offset:224
    s_waitcnt lgkmcnt(8)
    v_mfma_f32_16x16x32_bf16 v[48:51], v[120:123], a[52:55], v[48:51]
    ds_read_b128 a[112:115], v7 offset:448
    s_waitcnt lgkmcnt(8)
    v_mfma_f32_16x16x32_bf16 v[64:67], v[124:127], a[52:55], v[64:67]
    v_mov_b32 v210, v195
    v_mov_b32 v211, v196
    s_waitcnt lgkmcnt(7)
    v_mfma_f32_16x16x32_bf16 v[52:55], v[120:123], a[116:119], v[52:55]
    ds_read_b128 a[176:179], v7 offset:704
    v_mfma_f32_16x16x32_bf16 v[68:71], v[124:127], a[116:119], v[68:71]
    ds_write_b128 v5, v[208:211] offset:27008
    s_waitcnt lgkmcnt(7)
    v_mfma_f32_16x16x32_bf16 v[56:59], v[120:123], a[180:183], v[56:59]
    ds_read_b128 a[240:243], v7 offset:960
    v_mfma_f32_16x16x32_bf16 v[72:75], v[124:127], a[180:183], v[72:75]
    ds_read_b128 a[44:47], v7 offset:176
    s_waitcnt lgkmcnt(8)
    v_mfma_f32_16x16x32_bf16 v[60:63], v[120:123], a[244:247], v[60:63]
    ds_read_b128 v[136:139], v6 offset:256
    v_mfma_f32_16x16x32_bf16 v[76:79], v[124:127], a[244:247], v[76:79]
    ds_read_b128 v[140:143], v6 offset:288
    s_waitcnt lgkmcnt(8)
    v_mfma_f32_16x16x32_bf16 v[48:51], v[128:131], a[48:51], v[48:51]
    ds_read_b128 a[108:111], v7 offset:432
    s_waitcnt lgkmcnt(8)
    v_mfma_f32_16x16x32_bf16 v[64:67], v[132:135], a[48:51], v[64:67]
    v_mov_b32 v212, v197
    v_mov_b32 v213, v198
    s_waitcnt lgkmcnt(7)
    v_mfma_f32_16x16x32_bf16 v[52:55], v[128:131], a[112:115], v[52:55]
    ds_read_b128 a[172:175], v7 offset:688
    v_mfma_f32_16x16x32_bf16 v[68:71], v[132:135], a[112:115], v[68:71]
    ds_write_b128 v5, v[210:213] offset:10368
    s_waitcnt lgkmcnt(8)
    v_mfma_f32_16x16x32_bf16 v[56:59], v[128:131], a[176:179], v[56:59]
    ds_read_b128 a[236:239], v7 offset:944
    v_mfma_f32_16x16x32_bf16 v[72:75], v[132:135], a[176:179], v[72:75]
    ds_read_b128 a[40:43], v7 offset:160
    s_waitcnt lgkmcnt(8)
    v_mfma_f32_16x16x32_bf16 v[60:63], v[128:131], a[240:243], v[60:63]
    ds_read_b128 v[144:147], v6 offset:320
    v_mfma_f32_16x16x32_bf16 v[76:79], v[132:135], a[240:243], v[76:79]
    ds_read_b128 v[148:151], v6 offset:352
    s_waitcnt lgkmcnt(8)
    v_mfma_f32_16x16x32_bf16 v[48:51], v[136:139], a[44:47], v[48:51]
    ds_read_b128 a[104:107], v7 offset:416
    s_waitcnt lgkmcnt(8)
    v_mfma_f32_16x16x32_bf16 v[64:67], v[140:143], a[44:47], v[64:67]
    v_alignbit_b32 v214, v193, v192, 16
    v_alignbit_b32 v215, v194, v193, 16
    s_waitcnt lgkmcnt(7)
    v_mfma_f32_16x16x32_bf16 v[52:55], v[136:139], a[108:111], v[52:55]
    ds_read_b128 a[168:171], v7 offset:672
    v_mfma_f32_16x16x32_bf16 v[68:71], v[140:143], a[108:111], v[68:71]
    v_alignbit_b32 v216, v195, v194, 16
    v_alignbit_b32 v217, v196, v195, 16
    s_waitcnt lgkmcnt(7)
    v_mfma_f32_16x16x32_bf16 v[56:59], v[136:139], a[172:175], v[56:59]
    ds_read_b128 a[232:235], v7 offset:928
    v_mfma_f32_16x16x32_bf16 v[72:75], v[140:143], a[172:175], v[72:75]
    ds_read_b128 a[36:39], v7 offset:144
    s_waitcnt lgkmcnt(7)
    v_mfma_f32_16x16x32_bf16 v[60:63], v[136:139], a[236:239], v[60:63]
    ds_read_b128 v[152:155], v6 offset:384
    v_mfma_f32_16x16x32_bf16 v[76:79], v[140:143], a[236:239], v[76:79]
    ds_read_b128 v[156:159], v6 offset:416
    s_waitcnt lgkmcnt(7)
    v_mfma_f32_16x16x32_bf16 v[48:51], v[144:147], a[40:43], v[48:51]
    ds_read_b128 a[100:103], v7 offset:400
    s_waitcnt lgkmcnt(7)
    v_mfma_f32_16x16x32_bf16 v[64:67], v[148:151], a[40:43], v[64:67]
    ds_write_b128 v5, v[214:217] offset:31168
    s_waitcnt lgkmcnt(7)
    v_mfma_f32_16x16x32_bf16 v[52:55], v[144:147], a[104:107], v[52:55]
    ds_read_b128 a[164:167], v7 offset:656
    v_mfma_f32_16x16x32_bf16 v[68:71], v[148:151], a[104:107], v[68:71]
    v_alignbit_b32 v218, v197, v196, 16
    v_alignbit_b32 v219, v198, v197, 16
    s_waitcnt lgkmcnt(7)
    v_mfma_f32_16x16x32_bf16 v[56:59], v[144:147], a[168:171], v[56:59]
    ds_read_b128 a[228:231], v7 offset:912
    v_mfma_f32_16x16x32_bf16 v[72:75], v[148:151], a[168:171], v[72:75]
    ds_read_b128 a[32:35], v7 offset:128
    s_waitcnt lgkmcnt(8)
    v_mfma_f32_16x16x32_bf16 v[60:63], v[144:147], a[232:235], v[60:63]
    ds_read_b128 v[160:163], v6 offset:448
    v_mfma_f32_16x16x32_bf16 v[76:79], v[148:151], a[232:235], v[76:79]
    ds_read_b128 v[164:167], v6 offset:480
    s_waitcnt lgkmcnt(8)
    v_mfma_f32_16x16x32_bf16 v[48:51], v[152:155], a[36:39], v[48:51]
    ds_read_b128 a[96:99], v7 offset:384
    s_waitcnt lgkmcnt(8)
    v_mfma_f32_16x16x32_bf16 v[64:67], v[156:159], a[36:39], v[64:67]
    ds_write_b128 v5, v[216:219] offset:14528
    s_waitcnt lgkmcnt(8)
    v_mfma_f32_16x16x32_bf16 v[52:55], v[152:155], a[100:103], v[52:55]
    ds_read_b128 a[160:163], v7 offset:640
    v_mfma_f32_16x16x32_bf16 v[68:71], v[156:159], a[100:103], v[68:71]
    v_alignbit_b32 v220, v194, v193, 16
    v_alignbit_b32 v221, v195, v194, 16
    s_waitcnt lgkmcnt(7)
    v_mfma_f32_16x16x32_bf16 v[56:59], v[152:155], a[164:167], v[56:59]
    ds_read_b128 a[224:227], v7 offset:896
    v_mfma_f32_16x16x32_bf16 v[72:75], v[156:159], a[164:167], v[72:75]
    ds_read_b128 a[28:31], v7 offset:112
    s_waitcnt lgkmcnt(8)
    v_mfma_f32_16x16x32_bf16 v[60:63], v[152:155], a[228:231], v[60:63]
    ds_read_b128 v[168:171], v6 offset:512
    v_mfma_f32_16x16x32_bf16 v[76:79], v[156:159], a[228:231], v[76:79]
    ds_read_b128 v[172:175], v6 offset:544
    s_waitcnt lgkmcnt(8)
    v_mfma_f32_16x16x32_bf16 v[48:51], v[160:163], a[32:35], v[48:51]
    ds_read_b128 a[92:95], v7 offset:368
    s_waitcnt lgkmcnt(8)
    v_mfma_f32_16x16x32_bf16 v[64:67], v[164:167], a[32:35], v[64:67]
    v_alignbit_b32 v222, v196, v195, 16
    v_alignbit_b32 v223, v197, v196, 16
    s_waitcnt lgkmcnt(7)
    v_mfma_f32_16x16x32_bf16 v[52:55], v[160:163], a[96:99], v[52:55]
    ds_read_b128 a[156:159], v7 offset:624
    v_mfma_f32_16x16x32_bf16 v[68:71], v[164:167], a[96:99], v[68:71]
    ds_write_b128 v5, v[220:223] offset:22848
    s_waitcnt lgkmcnt(7)
    v_mfma_f32_16x16x32_bf16 v[56:59], v[160:163], a[160:163], v[56:59]
    ds_read_b128 a[220:223], v7 offset:880
    v_mfma_f32_16x16x32_bf16 v[72:75], v[164:167], a[160:163], v[72:75]
    ds_read_b128 a[24:27], v7 offset:96
    s_waitcnt lgkmcnt(8)
    v_mfma_f32_16x16x32_bf16 v[60:63], v[160:163], a[224:227], v[60:63]
    ds_read_b128 v[112:115], v6 offset:576
    v_mfma_f32_16x16x32_bf16 v[76:79], v[164:167], a[224:227], v[76:79]
    ds_read_b128 v[116:119], v6 offset:608
    s_waitcnt lgkmcnt(8)
    v_mfma_f32_16x16x32_bf16 v[48:51], v[168:171], a[28:31], v[48:51]
    ds_read_b128 a[88:91], v7 offset:352
    s_waitcnt lgkmcnt(8)
    v_mfma_f32_16x16x32_bf16 v[64:67], v[172:175], a[28:31], v[64:67]
    v_alignbit_b32 v224, v198, v197, 16
    v_alignbit_b32 v225, v199, v198, 16
    s_waitcnt lgkmcnt(7)
    v_mfma_f32_16x16x32_bf16 v[52:55], v[168:171], a[92:95], v[52:55]
    ds_read_b128 a[152:155], v7 offset:608
    v_mfma_f32_16x16x32_bf16 v[68:71], v[172:175], a[92:95], v[68:71]
    ds_write_b128 v5, v[222:225] offset:6208
    s_waitcnt lgkmcnt(8)
    v_mfma_f32_16x16x32_bf16 v[56:59], v[168:171], a[156:159], v[56:59]
    ds_read_b128 a[216:219], v7 offset:864
    v_mfma_f32_16x16x32_bf16 v[72:75], v[172:175], a[156:159], v[72:75]
    ds_read_b128 a[20:23], v7 offset:80
    s_waitcnt lgkmcnt(8)
    v_mfma_f32_16x16x32_bf16 v[60:63], v[168:171], a[220:223], v[60:63]
    ds_read_b128 v[120:123], v6 offset:640
    v_mfma_f32_16x16x32_bf16 v[76:79], v[172:175], a[220:223], v[76:79]
    ds_read_b128 v[124:127], v6 offset:672
    s_waitcnt lgkmcnt(8)
    v_mfma_f32_16x16x32_bf16 v[48:51], v[112:115], a[24:27], v[48:51]
    ds_read_b128 a[84:87], v7 offset:336
    s_waitcnt lgkmcnt(8)
    v_mfma_f32_16x16x32_bf16 v[64:67], v[116:119], a[24:27], v[64:67]
    buffer_load_dwordx4 v[192:195], v4, s[28:31], s36 offen offset:2032
    s_waitcnt lgkmcnt(7)
    v_mfma_f32_16x16x32_bf16 v[52:55], v[112:115], a[88:91], v[52:55]
    ds_read_b128 a[148:151], v7 offset:592
    v_mfma_f32_16x16x32_bf16 v[68:71], v[116:119], a[88:91], v[68:71]
    buffer_load_dwordx4 v[196:199], v4, s[28:31], s36 offen offset:2048
    s_waitcnt lgkmcnt(7)
    v_mfma_f32_16x16x32_bf16 v[56:59], v[112:115], a[152:155], v[56:59]
    ds_read_b128 a[212:215], v7 offset:848
    v_mfma_f32_16x16x32_bf16 v[72:75], v[116:119], a[152:155], v[72:75]
    ds_read_b128 a[16:19], v7 offset:64
    s_waitcnt lgkmcnt(7)
    v_mfma_f32_16x16x32_bf16 v[60:63], v[112:115], a[216:219], v[60:63]
    ds_read_b128 v[128:131], v6 offset:704
    v_mfma_f32_16x16x32_bf16 v[76:79], v[116:119], a[216:219], v[76:79]
    ds_read_b128 v[132:135], v6 offset:736
    s_waitcnt lgkmcnt(7)
    v_mfma_f32_16x16x32_bf16 v[48:51], v[120:123], a[20:23], v[48:51]
    ds_read_b128 a[80:83], v7 offset:320
    s_waitcnt lgkmcnt(7)
    v_mfma_f32_16x16x32_bf16 v[64:67], v[124:127], a[20:23], v[64:67]
    s_waitcnt vmcnt(10)
    s_waitcnt lgkmcnt(6)
    v_mfma_f32_16x16x32_bf16 v[52:55], v[120:123], a[84:87], v[52:55]
    ds_read_b128 a[144:147], v7 offset:576
    v_mfma_f32_16x16x32_bf16 v[68:71], v[124:127], a[84:87], v[68:71]
    ds_write_b128 v5, v[204:207] offset:3072
    s_waitcnt lgkmcnt(7)
    v_mfma_f32_16x16x32_bf16 v[56:59], v[120:123], a[148:151], v[56:59]
    ds_read_b128 a[208:211], v7 offset:832
    v_mfma_f32_16x16x32_bf16 v[72:75], v[124:127], a[148:151], v[72:75]
    ds_read_b128 a[12:15], v7 offset:48
    s_waitcnt lgkmcnt(8)
    v_mfma_f32_16x16x32_bf16 v[60:63], v[120:123], a[212:215], v[60:63]
    ds_read_b128 v[136:139], v6 offset:768
    v_mfma_f32_16x16x32_bf16 v[76:79], v[124:127], a[212:215], v[76:79]
    ds_read_b128 v[140:143], v6 offset:800
    s_waitcnt lgkmcnt(8)
    v_mfma_f32_16x16x32_bf16 v[48:51], v[128:131], a[16:19], v[48:51]
    ds_read_b128 a[76:79], v7 offset:304
    s_waitcnt lgkmcnt(8)
    v_mfma_f32_16x16x32_bf16 v[64:67], v[132:135], a[16:19], v[64:67]
    ds_write_b128 v5, v[202:205] offset:19712
    s_waitcnt lgkmcnt(8)
    v_mfma_f32_16x16x32_bf16 v[52:55], v[128:131], a[80:83], v[52:55]
    ds_read_b128 a[140:143], v7 offset:560
    v_mfma_f32_16x16x32_bf16 v[68:71], v[132:135], a[80:83], v[68:71]
    v_mov_b32 v208, v201
    v_mov_b32 v209, v202
    s_waitcnt lgkmcnt(8)
    v_mfma_f32_16x16x32_bf16 v[56:59], v[128:131], a[144:147], v[56:59]
    ds_read_b128 a[204:207], v7 offset:816
    v_mfma_f32_16x16x32_bf16 v[72:75], v[132:135], a[144:147], v[72:75]
    ds_read_b128 a[8:11], v7 offset:32
    s_waitcnt lgkmcnt(8)
    v_mfma_f32_16x16x32_bf16 v[60:63], v[128:131], a[208:211], v[60:63]
    ds_read_b128 v[144:147], v6 offset:832
    v_mfma_f32_16x16x32_bf16 v[76:79], v[132:135], a[208:211], v[76:79]
    ds_read_b128 v[148:151], v6 offset:864
    s_waitcnt lgkmcnt(8)
    v_mfma_f32_16x16x32_bf16 v[48:51], v[136:139], a[12:15], v[48:51]
    ds_read_b128 a[72:75], v7 offset:288
    s_waitcnt lgkmcnt(8)
    v_mfma_f32_16x16x32_bf16 v[64:67], v[140:143], a[12:15], v[64:67]
    v_mov_b32 v210, v203
    v_mov_b32 v211, v204
    s_waitcnt lgkmcnt(7)
    v_mfma_f32_16x16x32_bf16 v[52:55], v[136:139], a[76:79], v[52:55]
    ds_read_b128 a[136:139], v7 offset:544
    v_mfma_f32_16x16x32_bf16 v[68:71], v[140:143], a[76:79], v[68:71]
    ds_write_b128 v5, v[208:211] offset:28032
    s_waitcnt lgkmcnt(7)
    v_mfma_f32_16x16x32_bf16 v[56:59], v[136:139], a[140:143], v[56:59]
    ds_read_b128 a[200:203], v7 offset:800
    v_mfma_f32_16x16x32_bf16 v[72:75], v[140:143], a[140:143], v[72:75]
    ds_read_b128 a[4:7], v7 offset:16
    s_waitcnt lgkmcnt(8)
    v_mfma_f32_16x16x32_bf16 v[60:63], v[136:139], a[204:207], v[60:63]
    ds_read_b128 v[152:155], v6 offset:896
    v_mfma_f32_16x16x32_bf16 v[76:79], v[140:143], a[204:207], v[76:79]
    ds_read_b128 v[156:159], v6 offset:928
    s_waitcnt lgkmcnt(8)
    v_mfma_f32_16x16x32_bf16 v[48:51], v[144:147], a[8:11], v[48:51]
    ds_read_b128 a[68:71], v7 offset:272
    s_waitcnt lgkmcnt(8)
    v_mfma_f32_16x16x32_bf16 v[64:67], v[148:151], a[8:11], v[64:67]
    v_mov_b32 v212, v205
    v_mov_b32 v213, v206
    s_waitcnt lgkmcnt(7)
    v_mfma_f32_16x16x32_bf16 v[52:55], v[144:147], a[72:75], v[52:55]
    ds_read_b128 a[132:135], v7 offset:528
    v_mfma_f32_16x16x32_bf16 v[68:71], v[148:151], a[72:75], v[68:71]
    ds_write_b128 v5, v[210:213] offset:11392
    s_waitcnt lgkmcnt(8)
    v_mfma_f32_16x16x32_bf16 v[56:59], v[144:147], a[136:139], v[56:59]
    ds_read_b128 a[196:199], v7 offset:784
    v_mfma_f32_16x16x32_bf16 v[72:75], v[148:151], a[136:139], v[72:75]
    ds_read_b128 a[0:3], v7 offset:0
    s_waitcnt lgkmcnt(8)
    v_mfma_f32_16x16x32_bf16 v[60:63], v[144:147], a[200:203], v[60:63]
    ds_read_b128 v[160:163], v6 offset:960
    v_mfma_f32_16x16x32_bf16 v[76:79], v[148:151], a[200:203], v[76:79]
    ds_read_b128 v[164:167], v6 offset:992
    s_waitcnt lgkmcnt(8)
    v_mfma_f32_16x16x32_bf16 v[48:51], v[152:155], a[4:7], v[48:51]
    ds_read_b128 a[64:67], v7 offset:256
    s_waitcnt lgkmcnt(8)
    v_mfma_f32_16x16x32_bf16 v[64:67], v[156:159], a[4:7], v[64:67]
    v_alignbit_b32 v214, v201, v200, 16
    v_alignbit_b32 v215, v202, v201, 16
    s_waitcnt lgkmcnt(7)
    v_mfma_f32_16x16x32_bf16 v[52:55], v[152:155], a[68:71], v[52:55]
    ds_read_b128 a[128:131], v7 offset:512
    v_mfma_f32_16x16x32_bf16 v[68:71], v[156:159], a[68:71], v[68:71]
    v_alignbit_b32 v216, v203, v202, 16
    v_alignbit_b32 v217, v204, v203, 16
    s_waitcnt lgkmcnt(7)
    v_mfma_f32_16x16x32_bf16 v[56:59], v[152:155], a[132:135], v[56:59]
    ds_read_b128 a[192:195], v7 offset:768
    v_mfma_f32_16x16x32_bf16 v[72:75], v[156:159], a[132:135], v[72:75]
    ds_write_b128 v5, v[214:217] offset:32192
    s_waitcnt lgkmcnt(7)
    v_mfma_f32_16x16x32_bf16 v[60:63], v[152:155], a[196:199], v[60:63]
    ds_read_b128 v[168:171], v6 offset:1024
    v_mfma_f32_16x16x32_bf16 v[76:79], v[156:159], a[196:199], v[76:79]
    ds_read_b128 v[172:175], v6 offset:1056
    s_waitcnt lgkmcnt(7)
    v_mfma_f32_16x16x32_bf16 v[48:51], v[160:163], a[0:3], v[48:51]
    v_alignbit_b32 v218, v205, v204, 16
    v_alignbit_b32 v219, v206, v205, 16
    s_waitcnt lgkmcnt(6)
    v_mfma_f32_16x16x32_bf16 v[64:67], v[164:167], a[0:3], v[64:67]
    ds_write_b128 v5, v[216:219] offset:15552
    s_waitcnt lgkmcnt(6)
    v_mfma_f32_16x16x32_bf16 v[52:55], v[160:163], a[64:67], v[52:55]
    v_alignbit_b32 v220, v202, v201, 16
    v_alignbit_b32 v221, v203, v202, 16
    v_mfma_f32_16x16x32_bf16 v[68:71], v[164:167], a[64:67], v[68:71]
    v_alignbit_b32 v222, v204, v203, 16
    v_alignbit_b32 v223, v205, v204, 16
    s_waitcnt lgkmcnt(5)
    v_mfma_f32_16x16x32_bf16 v[56:59], v[160:163], a[128:131], v[56:59]
    ds_read_b128 v[112:115], v6 offset:1088
    v_mfma_f32_16x16x32_bf16 v[72:75], v[164:167], a[128:131], v[72:75]
    ds_read_b128 v[116:119], v6 offset:1120
    s_waitcnt lgkmcnt(6)
    v_mfma_f32_16x16x32_bf16 v[60:63], v[160:163], a[192:195], v[60:63]
    ds_write_b128 v5, v[220:223] offset:23872
    v_mfma_f32_16x16x32_bf16 v[76:79], v[164:167], a[192:195], v[76:79]
    v_alignbit_b32 v224, v206, v205, 16
    v_alignbit_b32 v225, v207, v206, 16
    s_waitcnt lgkmcnt(5)
    v_mfma_f32_16x16x32_bf16 v[52:55], v[168:171], a[60:63], v[52:55]
    ds_write_b128 v5, v[222:225] offset:7232
    s_waitcnt lgkmcnt(5)
    v_mfma_f32_16x16x32_bf16 v[68:71], v[172:175], a[60:63], v[68:71]
    buffer_load_dwordx4 v[200:203], v4, s[28:31], s36 offen offset:3056
    v_mfma_f32_16x16x32_bf16 v[56:59], v[168:171], a[124:127], v[56:59]
    ds_read_b128 v[120:123], v6 offset:1152
    v_mfma_f32_16x16x32_bf16 v[72:75], v[172:175], a[124:127], v[72:75]
    ds_read_b128 v[124:127], v6 offset:1184
    v_mfma_f32_16x16x32_bf16 v[60:63], v[168:171], a[188:191], v[60:63]
    buffer_load_dwordx4 v[204:207], v4, s[28:31], s36 offen offset:3072
    v_mfma_f32_16x16x32_bf16 v[76:79], v[172:175], a[188:191], v[76:79]
    s_waitcnt vmcnt(10)
    s_mov_b64 exec, 1
    v_mov_b32 v176, 0
    v_mov_b32 v177, 0
    v_mov_b32 v178, 0
    v_mov_b32 v179, 0
    s_mov_b64 exec, -1
    s_waitcnt lgkmcnt(5)
    v_mfma_f32_16x16x32_bf16 v[52:55], v[112:115], a[56:59], v[52:55]
    ds_write_b128 v5, v[180:183] offset:0
    s_waitcnt lgkmcnt(5)
    v_mfma_f32_16x16x32_bf16 v[68:71], v[116:119], a[56:59], v[68:71]
    ds_write_b128 v5, v[178:181] offset:16640
    v_mfma_f32_16x16x32_bf16 v[56:59], v[112:115], a[120:123], v[56:59]
    ds_read_b128 v[128:131], v6 offset:1216
    v_mfma_f32_16x16x32_bf16 v[72:75], v[116:119], a[120:123], v[72:75]
    ds_read_b128 v[132:135], v6 offset:1248
    v_mfma_f32_16x16x32_bf16 v[60:63], v[112:115], a[184:187], v[60:63]
    v_mov_b32 v208, v177
    v_mov_b32 v209, v178
    v_mfma_f32_16x16x32_bf16 v[76:79], v[116:119], a[184:187], v[76:79]
    v_mov_b32 v210, v179
    v_mov_b32 v211, v180
    s_waitcnt lgkmcnt(5)
    v_mfma_f32_16x16x32_bf16 v[52:55], v[120:123], a[52:55], v[52:55]
    ds_write_b128 v5, v[208:211] offset:24960
    s_waitcnt lgkmcnt(5)
    v_mfma_f32_16x16x32_bf16 v[68:71], v[124:127], a[52:55], v[68:71]
    v_mov_b32 v212, v181
    v_mov_b32 v213, v182
    v_mfma_f32_16x16x32_bf16 v[56:59], v[120:123], a[116:119], v[56:59]
    ds_read_b128 v[136:139], v6 offset:1280
    v_mfma_f32_16x16x32_bf16 v[72:75], v[124:127], a[116:119], v[72:75]
    ds_read_b128 v[140:143], v6 offset:1312
    v_mfma_f32_16x16x32_bf16 v[60:63], v[120:123], a[180:183], v[60:63]
    ds_write_b128 v5, v[210:213] offset:8320
    v_mfma_f32_16x16x32_bf16 v[76:79], v[124:127], a[180:183], v[76:79]
    v_alignbit_b32 v214, v177, v176, 16
    v_alignbit_b32 v215, v178, v177, 16
    s_waitcnt lgkmcnt(5)
    v_mfma_f32_16x16x32_bf16 v[52:55], v[128:131], a[48:51], v[52:55]
    v_alignbit_b32 v216, v179, v178, 16
    v_alignbit_b32 v217, v180, v179, 16
    s_waitcnt lgkmcnt(4)
    v_mfma_f32_16x16x32_bf16 v[68:71], v[132:135], a[48:51], v[68:71]
    ds_write_b128 v5, v[214:217] offset:29120
    v_mfma_f32_16x16x32_bf16 v[56:59], v[128:131], a[112:115], v[56:59]
    ds_read_b128 v[144:147], v6 offset:1344
    v_mfma_f32_16x16x32_bf16 v[72:75], v[132:135], a[112:115], v[72:75]
    ds_read_b128 v[148:151], v6 offset:1376
    v_mfma_f32_16x16x32_bf16 v[60:63], v[128:131], a[176:179], v[60:63]
    v_alignbit_b32 v218, v181, v180, 16
    v_alignbit_b32 v219, v182, v181, 16
    v_mfma_f32_16x16x32_bf16 v[76:79], v[132:135], a[176:179], v[76:79]
    ds_write_b128 v5, v[216:219] offset:12480
    s_waitcnt lgkmcnt(6)
    v_mfma_f32_16x16x32_bf16 v[52:55], v[136:139], a[44:47], v[52:55]
    v_alignbit_b32 v220, v178, v177, 16
    v_alignbit_b32 v221, v179, v178, 16
    s_waitcnt lgkmcnt(5)
    v_mfma_f32_16x16x32_bf16 v[68:71], v[140:143], a[44:47], v[68:71]
    v_alignbit_b32 v222, v180, v179, 16
    v_alignbit_b32 v223, v181, v180, 16
    v_mfma_f32_16x16x32_bf16 v[56:59], v[136:139], a[108:111], v[56:59]
    ds_read_b128 v[152:155], v6 offset:1408
    v_mfma_f32_16x16x32_bf16 v[72:75], v[140:143], a[108:111], v[72:75]
    ds_read_b128 v[156:159], v6 offset:1440
    v_mfma_f32_16x16x32_bf16 v[60:63], v[136:139], a[172:175], v[60:63]
    ds_write_b128 v5, v[220:223] offset:20800
    v_mfma_f32_16x16x32_bf16 v[76:79], v[140:143], a[172:175], v[76:79]
    v_alignbit_b32 v224, v182, v181, 16
    v_alignbit_b32 v225, v183, v182, 16
    s_waitcnt lgkmcnt(5)
    v_mfma_f32_16x16x32_bf16 v[52:55], v[144:147], a[40:43], v[52:55]
    ds_write_b128 v5, v[222:225] offset:4160
    s_waitcnt lgkmcnt(5)
    v_mfma_f32_16x16x32_bf16 v[68:71], v[148:151], a[40:43], v[68:71]
    buffer_load_dwordx4 v[176:179], v230, s[28:31], s37 offen offset:0
    v_mfma_f32_16x16x32_bf16 v[56:59], v[144:147], a[104:107], v[56:59]
    ds_read_b128 v[160:163], v6 offset:1472
    v_mfma_f32_16x16x32_bf16 v[72:75], v[148:151], a[104:107], v[72:75]
    ds_read_b128 v[164:167], v6 offset:1504
    v_mfma_f32_16x16x32_bf16 v[60:63], v[144:147], a[168:171], v[60:63]
    buffer_load_dwordx4 v[180:183], v4, s[28:31], s37 offen offset:0
    v_mfma_f32_16x16x32_bf16 v[76:79], v[148:151], a[168:171], v[76:79]
    s_add_u32 m0, s35, 0
    s_waitcnt lgkmcnt(5)
    v_mfma_f32_16x16x32_bf16 v[52:55], v[152:155], a[36:39], v[52:55]
    buffer_load_dwordx4 v4, s[8:11], s39 offen offset:0 lds
    s_waitcnt lgkmcnt(4)
    v_mfma_f32_16x16x32_bf16 v[68:71], v[156:159], a[36:39], v[68:71]
    s_add_u32 m0, s35, 256
    v_mfma_f32_16x16x32_bf16 v[56:59], v[152:155], a[100:103], v[56:59]
    ds_read_b128 v[168:171], v6 offset:1536
    v_mfma_f32_16x16x32_bf16 v[72:75], v[156:159], a[100:103], v[72:75]
    ds_read_b128 v[172:175], v6 offset:1568
    v_mfma_f32_16x16x32_bf16 v[60:63], v[152:155], a[164:167], v[60:63]
    buffer_load_dwordx4 v4, s[8:11], s39 offen offset:1024 lds
    v_mfma_f32_16x16x32_bf16 v[76:79], v[156:159], a[164:167], v[76:79]
    s_add_u32 m0, s35, 512
    s_waitcnt lgkmcnt(3)
    v_mfma_f32_16x16x32_bf16 v[52:55], v[160:163], a[32:35], v[52:55]
    buffer_load_dwordx4 v4, s[8:11], s39 offen offset:2048 lds
    s_waitcnt lgkmcnt(2)
    v_mfma_f32_16x16x32_bf16 v[68:71], v[164:167], a[32:35], v[68:71]
    s_add_u32 m0, s35, 768
    v_mfma_f32_16x16x32_bf16 v[56:59], v[160:163], a[96:99], v[56:59]
    ds_read_b128 v[112:115], v6 offset:1600
    v_mfma_f32_16x16x32_bf16 v[72:75], v[164:167], a[96:99], v[72:75]
    ds_read_b128 v[116:119], v6 offset:1632
    v_mfma_f32_16x16x32_bf16 v[60:63], v[160:163], a[160:163], v[60:63]
    buffer_load_dwordx4 v4, s[8:11], s39 offen offset:3072 lds
    v_mfma_f32_16x16x32_bf16 v[76:79], v[164:167], a[160:163], v[76:79]
    s_waitcnt lgkmcnt(3)
    v_mfma_f32_16x16x32_bf16 v[52:55], v[168:171], a[28:31], v[52:55]
    s_waitcnt lgkmcnt(2)
    v_mfma_f32_16x16x32_bf16 v[68:71], v[172:175], a[28:31], v[68:71]
    v_mfma_f32_16x16x32_bf16 v[56:59], v[168:171], a[92:95], v[56:59]
    ds_read_b128 v[120:123], v6 offset:1664
    v_mfma_f32_16x16x32_bf16 v[72:75], v[172:175], a[92:95], v[72:75]
    ds_read_b128 v[124:127], v6 offset:1696
    v_mfma_f32_16x16x32_bf16 v[60:63], v[168:171], a[156:159], v[60:63]
    v_mfma_f32_16x16x32_bf16 v[76:79], v[172:175], a[156:159], v[76:79]
    s_waitcnt lgkmcnt(3)
    v_mfma_f32_16x16x32_bf16 v[52:55], v[112:115], a[24:27], v[52:55]
    s_waitcnt lgkmcnt(2)
    v_mfma_f32_16x16x32_bf16 v[68:71], v[116:119], a[24:27], v[68:71]
    v_mfma_f32_16x16x32_bf16 v[56:59], v[112:115], a[88:91], v[56:59]
    ds_read_b128 v[128:131], v6 offset:1728
    v_mfma_f32_16x16x32_bf16 v[72:75], v[116:119], a[88:91], v[72:75]
    ds_read_b128 v[132:135], v6 offset:1760
    v_mfma_f32_16x16x32_bf16 v[60:63], v[112:115], a[152:155], v[60:63]
    v_mfma_f32_16x16x32_bf16 v[76:79], v[116:119], a[152:155], v[76:79]
    s_waitcnt lgkmcnt(3)
    v_mfma_f32_16x16x32_bf16 v[52:55], v[120:123], a[20:23], v[52:55]
    s_waitcnt lgkmcnt(2)
    v_mfma_f32_16x16x32_bf16 v[68:71], v[124:127], a[20:23], v[68:71]
    v_mfma_f32_16x16x32_bf16 v[56:59], v[120:123], a[84:87], v[56:59]
    ds_read_b128 v[136:139], v6 offset:1792
    v_mfma_f32_16x16x32_bf16 v[72:75], v[124:127], a[84:87], v[72:75]
    ds_read_b128 v[140:143], v6 offset:1824
    v_mfma_f32_16x16x32_bf16 v[60:63], v[120:123], a[148:151], v[60:63]
    v_mfma_f32_16x16x32_bf16 v[76:79], v[124:127], a[148:151], v[76:79]
    s_waitcnt lgkmcnt(3)
    v_mfma_f32_16x16x32_bf16 v[52:55], v[128:131], a[16:19], v[52:55]
    s_waitcnt lgkmcnt(2)
    v_mfma_f32_16x16x32_bf16 v[68:71], v[132:135], a[16:19], v[68:71]
    v_mfma_f32_16x16x32_bf16 v[56:59], v[128:131], a[80:83], v[56:59]
    ds_read_b128 v[144:147], v6 offset:1856
    v_mfma_f32_16x16x32_bf16 v[72:75], v[132:135], a[80:83], v[72:75]
    ds_read_b128 v[148:151], v6 offset:1888
    v_mfma_f32_16x16x32_bf16 v[60:63], v[128:131], a[144:147], v[60:63]
    v_mfma_f32_16x16x32_bf16 v[76:79], v[132:135], a[144:147], v[76:79]
    s_waitcnt lgkmcnt(3)
    v_mfma_f32_16x16x32_bf16 v[52:55], v[136:139], a[12:15], v[52:55]
    s_waitcnt lgkmcnt(2)
    v_mfma_f32_16x16x32_bf16 v[68:71], v[140:143], a[12:15], v[68:71]
    v_mfma_f32_16x16x32_bf16 v[56:59], v[136:139], a[76:79], v[56:59]
    ds_read_b128 v[152:155], v6 offset:1920
    v_mfma_f32_16x16x32_bf16 v[72:75], v[140:143], a[76:79], v[72:75]
    ds_read_b128 v[156:159], v6 offset:1952
    v_mfma_f32_16x16x32_bf16 v[60:63], v[136:139], a[140:143], v[60:63]
    v_mfma_f32_16x16x32_bf16 v[76:79], v[140:143], a[140:143], v[76:79]
    s_waitcnt lgkmcnt(3)
    v_mfma_f32_16x16x32_bf16 v[52:55], v[144:147], a[8:11], v[52:55]
    s_waitcnt lgkmcnt(2)
    v_mfma_f32_16x16x32_bf16 v[68:71], v[148:151], a[8:11], v[68:71]
    v_mfma_f32_16x16x32_bf16 v[56:59], v[144:147], a[72:75], v[56:59]
    ds_read_b128 v[160:163], v6 offset:1984
    v_mfma_f32_16x16x32_bf16 v[72:75], v[148:151], a[72:75], v[72:75]
    ds_read_b128 v[164:167], v6 offset:2016
    v_mfma_f32_16x16x32_bf16 v[60:63], v[144:147], a[136:139], v[60:63]
    v_mfma_f32_16x16x32_bf16 v[76:79], v[148:151], a[136:139], v[76:79]
    s_waitcnt lgkmcnt(3)
    v_mfma_f32_16x16x32_bf16 v[52:55], v[152:155], a[4:7], v[52:55]
    s_waitcnt lgkmcnt(2)
    v_mfma_f32_16x16x32_bf16 v[68:71], v[156:159], a[4:7], v[68:71]
    v_mfma_f32_16x16x32_bf16 v[56:59], v[152:155], a[68:71], v[56:59]
    ds_read_b128 v[168:171], v6 offset:2048
    v_mfma_f32_16x16x32_bf16 v[72:75], v[156:159], a[68:71], v[72:75]
    ds_read_b128 v[172:175], v6 offset:2080
    v_mfma_f32_16x16x32_bf16 v[60:63], v[152:155], a[132:135], v[60:63]
    s_waitcnt vmcnt(10)
    v_mfma_f32_16x16x32_bf16 v[76:79], v[156:159], a[132:135], v[76:79]
    ds_write_b128 v5, v[188:191] offset:1024
    s_waitcnt lgkmcnt(4)
    v_mfma_f32_16x16x32_bf16 v[52:55], v[160:163], a[0:3], v[52:55]
    ds_read_b128 v[112:115], v6 offset:2112
    s_waitcnt lgkmcnt(4)
    v_mfma_f32_16x16x32_bf16 v[68:71], v[164:167], a[0:3], v[68:71]
    ds_read_b128 v[116:119], v6 offset:2144
    v_mfma_f32_16x16x32_bf16 v[56:59], v[160:163], a[64:67], v[56:59]
    ds_write_b128 v5, v[186:189] offset:17664
    v_mfma_f32_16x16x32_bf16 v[72:75], v[164:167], a[64:67], v[72:75]
    v_mov_b32 v208, v185
    v_mov_b32 v209, v186
    v_mfma_f32_16x16x32_bf16 v[60:63], v[160:163], a[128:131], v[60:63]
    ds_read_b128 v[120:123], v6 offset:2176
    v_mfma_f32_16x16x32_bf16 v[76:79], v[164:167], a[128:131], v[76:79]
    ds_read_b128 v[124:127], v6 offset:2208
    s_waitcnt lgkmcnt(7)
    v_mfma_f32_16x16x32_bf16 v[56:59], v[168:171], a[60:63], v[56:59]
    v_mov_b32 v210, v187
    v_mov_b32 v211, v188
    s_waitcnt lgkmcnt(6)
    v_mfma_f32_16x16x32_bf16 v[72:75], v[172:175], a[60:63], v[72:75]
    ds_write_b128 v5, v[208:211] offset:25984
    v_mfma_f32_16x16x32_bf16 v[60:63], v[168:171], a[124:127], v[60:63]
    ds_read_b128 v[128:131], v6 offset:2240
    v_mfma_f32_16x16x32_bf16 v[76:79], v[172:175], a[124:127], v[76:79]
    ds_read_b128 v[132:135], v6 offset:2272
    s_waitcnt lgkmcnt(7)
    v_mfma_f32_16x16x32_bf16 v[56:59], v[112:115], a[56:59], v[56:59]
    v_mov_b32 v212, v189
    v_mov_b32 v213, v190
    s_waitcnt lgkmcnt(6)
    v_mfma_f32_16x16x32_bf16 v[72:75], v[116:119], a[56:59], v[72:75]
    ds_write_b128 v5, v[210:213] offset:9344
    v_mfma_f32_16x16x32_bf16 v[60:63], v[112:115], a[120:123], v[60:63]
    ds_read_b128 v[136:139], v6 offset:2304
    v_mfma_f32_16x16x32_bf16 v[76:79], v[116:119], a[120:123], v[76:79]
    ds_read_b128 v[140:143], v6 offset:2336
    s_waitcnt lgkmcnt(7)
    v_mfma_f32_16x16x32_bf16 v[56:59], v[120:123], a[52:55], v[56:59]
    v_alignbit_b32 v214, v185, v184, 16
    v_alignbit_b32 v215, v186, v185, 16
    s_waitcnt lgkmcnt(6)
    v_mfma_f32_16x16x32_bf16 v[72:75], v[124:127], a[52:55], v[72:75]
    v_alignbit_b32 v216, v187, v186, 16
    v_alignbit_b32 v217, v188, v187, 16
    v_mfma_f32_16x16x32_bf16 v[60:63], v[120:123], a[116:119], v[60:63]
    ds_read_b128 v[144:147], v6 offset:2368
    v_mfma_f32_16x16x32_bf16 v[76:79], v[124:127], a[116:119], v[76:79]
    ds_read_b128 v[148:151], v6 offset:2400
    s_waitcnt lgkmcnt(6)
    v_mfma_f32_16x16x32_bf16 v[56:59], v[128:131], a[48:51], v[56:59]
    ds_write_b128 v5, v[214:217] offset:30144
    s_waitcnt lgkmcnt(6)
    v_mfma_f32_16x16x32_bf16 v[72:75], v[132:135], a[48:51], v[72:75]
    v_alignbit_b32 v218, v189, v188, 16
    v_alignbit_b32 v219, v190, v189, 16
    v_mfma_f32_16x16x32_bf16 v[60:63], v[128:131], a[112:115], v[60:63]
    ds_read_b128 v[152:155], v6 offset:2432
    v_mfma_f32_16x16x32_bf16 v[76:79], v[132:135], a[112:115], v[76:79]
    ds_read_b128 v[156:159], v6 offset:2464
    s_waitcnt lgkmcnt(6)
    v_mfma_f32_16x16x32_bf16 v[56:59], v[136:139], a[44:47], v[56:59]
    ds_write_b128 v5, v[216:219] offset:13504
    s_waitcnt lgkmcnt(6)
    v_mfma_f32_16x16x32_bf16 v[72:75], v[140:143], a[44:47], v[72:75]
    v_alignbit_b32 v220, v186, v185, 16
    v_alignbit_b32 v221, v187, v186, 16
    v_mfma_f32_16x16x32_bf16 v[60:63], v[136:139], a[108:111], v[60:63]
    ds_read_b128 v[160:163], v6 offset:2496
    v_mfma_f32_16x16x32_bf16 v[76:79], v[140:143], a[108:111], v[76:79]
    ds_read_b128 v[164:167], v6 offset:2528
    s_waitcnt lgkmcnt(7)
    v_mfma_f32_16x16x32_bf16 v[56:59], v[144:147], a[40:43], v[56:59]
    v_alignbit_b32 v222, v188, v187, 16
    v_alignbit_b32 v223, v189, v188, 16
    s_waitcnt lgkmcnt(6)
    v_mfma_f32_16x16x32_bf16 v[72:75], v[148:151], a[40:43], v[72:75]
    ds_write_b128 v5, v[220:223] offset:21824
    v_mfma_f32_16x16x32_bf16 v[60:63], v[144:147], a[104:107], v[60:63]
    ds_read_b128 v[168:171], v6 offset:2560
    v_mfma_f32_16x16x32_bf16 v[76:79], v[148:151], a[104:107], v[76:79]
    ds_read_b128 v[172:175], v6 offset:2592
    s_waitcnt lgkmcnt(7)
    v_mfma_f32_16x16x32_bf16 v[56:59], v[152:155], a[36:39], v[56:59]
    v_alignbit_b32 v224, v190, v189, 16
    v_alignbit_b32 v225, v191, v190, 16
    s_waitcnt lgkmcnt(6)
    v_mfma_f32_16x16x32_bf16 v[72:75], v[156:159], a[36:39], v[72:75]
    ds_write_b128 v5, v[222:225] offset:5184
    v_mfma_f32_16x16x32_bf16 v[60:63], v[152:155], a[100:103], v[60:63]
    ds_read_b128 v[112:115], v6 offset:2624
    v_mfma_f32_16x16x32_bf16 v[76:79], v[156:159], a[100:103], v[76:79]
    ds_read_b128 v[116:119], v6 offset:2656
    s_waitcnt lgkmcnt(7)
    v_mfma_f32_16x16x32_bf16 v[56:59], v[160:163], a[32:35], v[56:59]
    buffer_load_dwordx4 v[184:187], v4, s[28:31], s37 offen offset:1008
    s_waitcnt lgkmcnt(6)
    v_mfma_f32_16x16x32_bf16 v[72:75], v[164:167], a[32:35], v[72:75]
    buffer_load_dwordx4 v[188:191], v4, s[28:31], s37 offen offset:1024
    v_mfma_f32_16x16x32_bf16 v[60:63], v[160:163], a[96:99], v[60:63]
    ds_read_b128 v[120:123], v6 offset:2688
    v_mfma_f32_16x16x32_bf16 v[76:79], v[164:167], a[96:99], v[76:79]
    ds_read_b128 v[124:127], v6 offset:2720
    s_waitcnt lgkmcnt(6)
    v_mfma_f32_16x16x32_bf16 v[56:59], v[168:171], a[28:31], v[56:59]
    s_mov_b32 s36, s37
    s_add_u32 s39, s37, 125829120
    s_add_u32 s37, s37, 4096
    s_min_u32 s37, s37, s33

    s_pack_ll_b32_b16 s40, s65, s65
    s_mov_b32 s64, s65
    s_mov_b32 s65, s66
    s_mov_b32 s66, s67
    v_and_b32 v236, s40, v8
    s_waitcnt lgkmcnt(5)
    v_mfma_f32_16x16x32_bf16 v[72:75], v[172:175], a[28:31], v[72:75]
    v_and_b32 v237, s40, v9
    v_and_b32 v238, s40, v10
    v_mfma_f32_16x16x32_bf16 v[60:63], v[168:171], a[92:95], v[60:63]
    ds_read_b128 v[128:131], v6 offset:2752
    v_mfma_f32_16x16x32_bf16 v[76:79], v[172:175], a[92:95], v[76:79]
    ds_read_b128 v[132:135], v6 offset:2784
    s_waitcnt lgkmcnt(5)
    v_mfma_f32_16x16x32_bf16 v[56:59], v[112:115], a[24:27], v[56:59]
    v_and_b32 v239, s40, v11
    v_and_b32 v240, s40, v12
    s_waitcnt lgkmcnt(4)
    v_mfma_f32_16x16x32_bf16 v[72:75], v[116:119], a[24:27], v[72:75]
    v_and_b32 v241, s40, v13
    v_and_b32 v242, s40, v14
    v_mfma_f32_16x16x32_bf16 v[60:63], v[112:115], a[88:91], v[60:63]
    ds_read_b128 v[136:139], v6 offset:2816
    v_mfma_f32_16x16x32_bf16 v[76:79], v[116:119], a[88:91], v[76:79]
    ds_read_b128 v[140:143], v6 offset:2848
    s_waitcnt lgkmcnt(5)
    v_mfma_f32_16x16x32_bf16 v[56:59], v[120:123], a[20:23], v[56:59]
    v_and_b32 v243, s40, v15
    s_waitcnt lgkmcnt(4)
    v_mfma_f32_16x16x32_bf16 v[72:75], v[124:127], a[20:23], v[72:75]
    v_mfma_f32_16x16x32_bf16 v[60:63], v[120:123], a[84:87], v[60:63]
    ds_read_b128 v[144:147], v6 offset:2880
    v_mfma_f32_16x16x32_bf16 v[76:79], v[124:127], a[84:87], v[76:79]
    ds_read_b128 v[148:151], v6 offset:2912
    s_waitcnt lgkmcnt(5)
    v_mfma_f32_16x16x32_bf16 v[56:59], v[128:131], a[16:19], v[56:59]
    s_waitcnt lgkmcnt(4)
    v_mfma_f32_16x16x32_bf16 v[72:75], v[132:135], a[16:19], v[72:75]
    v_mfma_f32_16x16x32_bf16 v[60:63], v[128:131], a[80:83], v[60:63]
    ds_read_b128 v[152:155], v6 offset:2944
    v_mfma_f32_16x16x32_bf16 v[76:79], v[132:135], a[80:83], v[76:79]
    ds_read_b128 v[156:159], v6 offset:2976
    s_waitcnt lgkmcnt(5)
    v_mfma_f32_16x16x32_bf16 v[56:59], v[136:139], a[12:15], v[56:59]
    s_waitcnt lgkmcnt(4)
    v_mfma_f32_16x16x32_bf16 v[72:75], v[140:143], a[12:15], v[72:75]
    v_mfma_f32_16x16x32_bf16 v[60:63], v[136:139], a[76:79], v[60:63]
    ds_read_b128 v[160:163], v6 offset:3008
    v_mfma_f32_16x16x32_bf16 v[76:79], v[140:143], a[76:79], v[76:79]
    ds_read_b128 v[164:167], v6 offset:3040
    s_waitcnt lgkmcnt(5)
    v_mfma_f32_16x16x32_bf16 v[56:59], v[144:147], a[8:11], v[56:59]
    s_waitcnt lgkmcnt(4)
    v_mfma_f32_16x16x32_bf16 v[72:75], v[148:151], a[8:11], v[72:75]
    v_mfma_f32_16x16x32_bf16 v[60:63], v[144:147], a[72:75], v[60:63]
    ds_read_b128 v[168:171], v6 offset:3072
    v_mfma_f32_16x16x32_bf16 v[76:79], v[148:151], a[72:75], v[76:79]
    ds_read_b128 v[172:175], v6 offset:3104
    s_waitcnt lgkmcnt(5)
    v_mfma_f32_16x16x32_bf16 v[56:59], v[152:155], a[4:7], v[56:59]
    ds_read_b128 v[112:115], v6 offset:3136
    s_waitcnt lgkmcnt(5)
    v_mfma_f32_16x16x32_bf16 v[72:75], v[156:159], a[4:7], v[72:75]
    ds_read_b128 v[116:119], v6 offset:3168
    v_mfma_f32_16x16x32_bf16 v[60:63], v[152:155], a[68:71], v[60:63]
    ds_read_b128 v[120:123], v6 offset:3200
    v_mfma_f32_16x16x32_bf16 v[76:79], v[156:159], a[68:71], v[76:79]
    ds_read_b128 v[124:127], v6 offset:3232
    s_waitcnt lgkmcnt(7)
    v_mfma_f32_16x16x32_bf16 v[56:59], v[160:163], a[0:3], v[56:59]
    ds_read_b128 v[128:131], v6 offset:3264
    s_waitcnt lgkmcnt(7)
    v_mfma_f32_16x16x32_bf16 v[72:75], v[164:167], a[0:3], v[72:75]
    ds_read_b128 v[132:135], v6 offset:3296
    v_mfma_f32_16x16x32_bf16 v[60:63], v[160:163], a[64:67], v[60:63]
    ds_read_b128 v[136:139], v6 offset:3328
    v_mfma_f32_16x16x32_bf16 v[76:79], v[164:167], a[64:67], v[76:79]
    ds_read_b128 v[140:143], v6 offset:3360
    s_waitcnt lgkmcnt(9)
    v_mfma_f32_16x16x32_bf16 v[60:63], v[168:171], a[60:63], v[60:63]
    ds_read_b128 v[144:147], v6 offset:3392
    s_waitcnt lgkmcnt(9)
    v_mfma_f32_16x16x32_bf16 v[76:79], v[172:175], a[60:63], v[76:79]
    ds_read_b128 v[148:151], v6 offset:3424
    s_waitcnt lgkmcnt(9)
    v_mfma_f32_16x16x32_bf16 v[60:63], v[112:115], a[56:59], v[60:63]
    ds_read_b128 v[152:155], v6 offset:3456
    s_waitcnt lgkmcnt(9)
    v_mfma_f32_16x16x32_bf16 v[76:79], v[116:119], a[56:59], v[76:79]
    ds_read_b128 v[156:159], v6 offset:3488
    s_waitcnt lgkmcnt(9)
    v_mfma_f32_16x16x32_bf16 v[60:63], v[120:123], a[52:55], v[60:63]
    ds_read_b128 v[160:163], v6 offset:3520
    s_waitcnt lgkmcnt(9)
    v_mfma_f32_16x16x32_bf16 v[76:79], v[124:127], a[52:55], v[76:79]
    ds_read_b128 v[164:167], v6 offset:3552
    s_waitcnt lgkmcnt(9)
    v_mfma_f32_16x16x32_bf16 v[60:63], v[128:131], a[48:51], v[60:63]
    ds_read_b128 v[168:171], v6 offset:3584
    s_waitcnt lgkmcnt(9)
    v_mfma_f32_16x16x32_bf16 v[76:79], v[132:135], a[48:51], v[76:79]
    ds_read_b128 v[172:175], v6 offset:3616
    s_waitcnt lgkmcnt(9)
    v_mfma_f32_16x16x32_bf16 v[60:63], v[136:139], a[44:47], v[60:63]
    ds_read_b128 v[112:115], v6 offset:3648
    s_waitcnt lgkmcnt(9)
    v_mfma_f32_16x16x32_bf16 v[76:79], v[140:143], a[44:47], v[76:79]
    ds_read_b128 v[116:119], v6 offset:3680
    s_waitcnt lgkmcnt(9)
    v_mfma_f32_16x16x32_bf16 v[60:63], v[144:147], a[40:43], v[60:63]
    ds_read_b128 v[120:123], v6 offset:3712
    s_waitcnt lgkmcnt(9)
    v_mfma_f32_16x16x32_bf16 v[76:79], v[148:151], a[40:43], v[76:79]
    ds_read_b128 v[124:127], v6 offset:3744
    s_waitcnt lgkmcnt(9)
    v_mfma_f32_16x16x32_bf16 v[60:63], v[152:155], a[36:39], v[60:63]
    ds_read_b128 v[128:131], v6 offset:3776
    s_waitcnt lgkmcnt(9)
    v_mfma_f32_16x16x32_bf16 v[76:79], v[156:159], a[36:39], v[76:79]
    ds_read_b128 v[132:135], v6 offset:3808
    s_waitcnt lgkmcnt(9)
    v_mfma_f32_16x16x32_bf16 v[60:63], v[160:163], a[32:35], v[60:63]
    ds_read_b128 v[136:139], v6 offset:3840
    s_waitcnt lgkmcnt(9)
    v_mfma_f32_16x16x32_bf16 v[76:79], v[164:167], a[32:35], v[76:79]
    ds_read_b128 v[140:143], v6 offset:3872
    s_waitcnt lgkmcnt(9)
    v_mfma_f32_16x16x32_bf16 v[60:63], v[168:171], a[28:31], v[60:63]
    ds_read_b128 v[144:147], v6 offset:3904
    s_waitcnt lgkmcnt(9)
    v_mfma_f32_16x16x32_bf16 v[76:79], v[172:175], a[28:31], v[76:79]
    ds_read_b128 v[148:151], v6 offset:3936
    s_waitcnt lgkmcnt(9)
    v_mfma_f32_16x16x32_bf16 v[60:63], v[112:115], a[24:27], v[60:63]
    ds_read_b128 v[152:155], v6 offset:3968
    s_waitcnt lgkmcnt(9)
    v_mfma_f32_16x16x32_bf16 v[76:79], v[116:119], a[24:27], v[76:79]
    ds_read_b128 v[156:159], v6 offset:4000
    s_waitcnt lgkmcnt(9)
    v_mfma_f32_16x16x32_bf16 v[60:63], v[120:123], a[20:23], v[60:63]
    ds_read_b128 v[160:163], v6 offset:4032
    s_waitcnt lgkmcnt(9)
    v_mfma_f32_16x16x32_bf16 v[76:79], v[124:127], a[20:23], v[76:79]
    ds_read_b128 v[164:167], v6 offset:4064
    s_waitcnt lgkmcnt(9)
    v_mfma_f32_16x16x32_bf16 v[60:63], v[128:131], a[16:19], v[60:63]
    s_waitcnt vmcnt(2)
    ds_read_b128 a[60:63], v7 offset:240
    s_waitcnt lgkmcnt(9)
    v_mfma_f32_16x16x32_bf16 v[76:79], v[132:135], a[16:19], v[76:79]
    s_waitcnt lgkmcnt(8)
    v_mfma_f32_16x16x32_bf16 v[60:63], v[136:139], a[12:15], v[60:63]
    ds_read_b128 a[124:127], v7 offset:496
    s_waitcnt lgkmcnt(8)
    v_mfma_f32_16x16x32_bf16 v[76:79], v[140:143], a[12:15], v[76:79]
    s_waitcnt lgkmcnt(7)
    v_mfma_f32_16x16x32_bf16 v[60:63], v[144:147], a[8:11], v[60:63]
    ds_read_b128 a[188:191], v7 offset:752
    s_waitcnt lgkmcnt(7)
    v_mfma_f32_16x16x32_bf16 v[76:79], v[148:151], a[8:11], v[76:79]
    s_waitcnt lgkmcnt(6)
    v_mfma_f32_16x16x32_bf16 v[60:63], v[152:155], a[4:7], v[60:63]
    ds_read_b128 a[252:255], v7 offset:1008
    s_waitcnt lgkmcnt(6)
    v_mfma_f32_16x16x32_bf16 v[76:79], v[156:159], a[4:7], v[76:79]
    s_waitcnt lgkmcnt(5)
    v_mfma_f32_16x16x32_bf16 v[60:63], v[160:163], a[0:3], v[60:63]
    ds_read_b128 v[168:171], v6 offset:0
    s_waitcnt lgkmcnt(5)
    v_mfma_f32_16x16x32_bf16 v[76:79], v[164:167], a[0:3], v[76:79]
    ds_read_b128 v[172:175], v6 offset:32
    s_add_u32 s41, s38, 4096
    v_cvt_pk_bf16_f32 v80, v16, v48
    v_cvt_pk_bf16_f32 v81, v17, v49
    v_cvt_pk_bf16_f32 v82, v18, v50
    v_cvt_pk_bf16_f32 v83, v19, v51
    buffer_store_dwordx4 v[80:83], v228, s[8:11], s38 offen offset:0 sc1
    v_cvt_pk_bf16_f32 v84, v32, v64
    v_cvt_pk_bf16_f32 v85, v33, v65
    v_cvt_pk_bf16_f32 v86, v34, v66
    v_cvt_pk_bf16_f32 v87, v35, v67
    buffer_store_dwordx4 v[84:87], v228, s[8:11], s38 offen offset:64 sc1
    v_cvt_pk_bf16_f32 v88, v20, v52
    v_cvt_pk_bf16_f32 v89, v21, v53
    v_cvt_pk_bf16_f32 v90, v22, v54
    v_cvt_pk_bf16_f32 v91, v23, v55
    buffer_store_dwordx4 v[88:91], v228, s[8:11], s38 offen offset:2048 sc1
    v_cvt_pk_bf16_f32 v92, v36, v68
    v_cvt_pk_bf16_f32 v93, v37, v69
    v_cvt_pk_bf16_f32 v94, v38, v70
    v_cvt_pk_bf16_f32 v95, v39, v71
    buffer_store_dwordx4 v[92:95], v228, s[8:11], s38 offen offset:2112 sc1
    v_cvt_pk_bf16_f32 v96, v24, v56
    v_cvt_pk_bf16_f32 v97, v25, v57
    v_cvt_pk_bf16_f32 v98, v26, v58
    v_cvt_pk_bf16_f32 v99, v27, v59
    buffer_store_dwordx4 v[96:99], v228, s[8:11], s41 offen offset:0 sc1
    v_cvt_pk_bf16_f32 v100, v40, v72
    v_cvt_pk_bf16_f32 v101, v41, v73
    v_cvt_pk_bf16_f32 v102, v42, v74
    v_cvt_pk_bf16_f32 v103, v43, v75
    buffer_store_dwordx4 v[100:103], v228, s[8:11], s41 offen offset:64 sc1
    v_cvt_pk_bf16_f32 v104, v28, v60
    v_cvt_pk_bf16_f32 v105, v29, v61
    v_cvt_pk_bf16_f32 v106, v30, v62
    v_cvt_pk_bf16_f32 v107, v31, v63
    buffer_store_dwordx4 v[104:107], v228, s[8:11], s41 offen offset:2048 sc1
    v_cvt_pk_bf16_f32 v108, v44, v76
    v_cvt_pk_bf16_f32 v109, v45, v77
    v_cvt_pk_bf16_f32 v110, v46, v78
    v_cvt_pk_bf16_f32 v111, v47, v79
    buffer_store_dwordx4 v[108:111], v228, s[8:11], s41 offen offset:2112 sc1
    s_add_u32 s38, s38, 8192
    s_add_u32 s42, s42, 1
    s_cmp_lt_u32 s42, 4
    s_cbranch_scc1 .cvl_402

    s_waitcnt vmcnt(0) lgkmcnt(0)
    s_barrier
    s_mov_b32 s5, 44
    s_cmp_lg_u32 s24, 0
    s_cbranch_scc1 .sg_403
    s_mov_b64 exec, 1
    v_mov_b32 v4, 1
    v_mov_b32 v5, 0
    buffer_atomic_add v4, v5, s[20:23], s5 offen sc1
    s_mov_b64 exec, -1

.sg_403:
    v_and_b32 v1, 63, v0
    v_and_b32 v2, 15, v1
    v_lshrrev_b32 v3, 4, v1

    v_mov_b32 v5, 0
    s_mov_b32 s62, 0
    s_mov_b32 s5, 32
.wc_404:
    buffer_load_dword v4, v5, s[20:23], s5 offen sc1
    s_waitcnt vmcnt(0)
    v_readfirstlane_b32 s4, v4
    s_lshr_b32 s4, s4, 0
    s_and_b32 s4, s4, 0xffff
    s_cmp_ge_u32 s4, 256
    s_cbranch_scc1 .wcd_405
    s_sleep 6
    s_add_u32 s62, s62, 1
    s_cmp_gt_u32 s62, 0x400000
    s_cbranch_scc1 .mg_end_1
    s_branch .wc_404

.wcd_405:
    s_sub_u32 s4, s26, 24
    s_lshr_b32 s25, s4, 1
    s_and_b32 s4, s4, 1
    s_lshl_b32 s4, s4, 2
    s_lshl_b32 s5, s91, 3
    s_add_u32 s4, s4, s5
    s_add_u32 s26, s4, s24
    s_lshl_b32 s35, s26, 8
    s_add_u32 s35, s35, 92274688
    s_mov_b32 s37, 0x3db504f3
    s_mov_b32 s38, 0x3fb8aa3b
    v_lshlrev_b32 v8, 4, v1
    v_lshlrev_b32 v9, 13, v1
    v_lshlrev_b32 v6, 4, v3
    v_and_b32 v5, 7, v2
    v_add_u32 v10, v6, v5
    v_lshlrev_b32 v10, 4, v10
    v_lshlrev_b32 v11, 4, v2
    v_lshlrev_b32 v5, 3, v3
    v_add_u32 v11, v11, v5
    v_cmp_gt_u32 s[60:61], 32, v1
    v_lshlrev_b32 v5, 2, v3
    v_mov_b32 v12, 0
    v_mov_b32 v13, 0

    v_add_u32 v7, 0, v5
    v_cmp_le_u32 s[40:41], v7, v2
    v_add_u32 v7, 1, v5
    v_cmp_le_u32 s[42:43], v7, v2
    v_add_u32 v7, 2, v5
    v_cmp_le_u32 s[44:45], v7, v2
    v_add_u32 v7, 3, v5
    v_cmp_le_u32 s[46:47], v7, v2
    v_mov_b32 v128, 0
    v_mov_b32 v129, 0
    v_mov_b32 v130, 0
    v_mov_b32 v131, 0
    v_mov_b32 v132, 0
    v_mov_b32 v133, 0
    v_mov_b32 v134, 0
    v_mov_b32 v135, 0
    v_mov_b32 v136, 0
    v_mov_b32 v137, 0
    v_mov_b32 v138, 0
    v_mov_b32 v139, 0
    v_mov_b32 v140, 0
    v_mov_b32 v141, 0
    v_mov_b32 v142, 0
    v_mov_b32 v143, 0
.att_406:
    s_add_u32 s36, s25, 1
    s_lshl_b32 s4, s25, 5
    s_add_u32 s4, s4, s26
    s_lshl_b32 s27, s4, 13
    s_add_u32 s28, s27, 4096
    s_add_u32 s29, s27, 16777216
    s_add_u32 s30, s27, 16781312
    s_add_u32 s31, s27, 33554432
    s_add_u32 s32, s27, 33558528
    s_mul_i32 s33, s4, 6144
    s_add_u32 s33, s33, 67108864
    s_add_u32 s34, s33, 4096

    s_mov_b32 s62, 0
    s_mov_b64 exec, 7
.wf_407:
    buffer_load_dword v4, v9, s[8:11], s35 offen sc1
    s_waitcnt vmcnt(0)
    v_cmp_gt_u32 vcc, s36, v4
    s_cbranch_vccz .wfd_408
    s_sleep 2
    s_add_u32 s62, s62, 1
    s_cmp_gt_u32 s62, 0x400000
    s_cbranch_scc1 .mg_end_1
    s_branch .wf_407

.wfd_408:
    s_mov_b64 exec, -1
    buffer_load_dwordx4 v[16:19], v8, s[8:11], s27 offen offset:0
    buffer_load_dwordx4 v[32:35], v8, s[8:11], s28 offen offset:0
    buffer_load_dwordx4 v[48:51], v8, s[8:11], s29 offen offset:0
    buffer_load_dwordx4 v[64:67], v8, s[8:11], s30 offen offset:0
    buffer_load_dwordx4 v[20:23], v8, s[8:11], s27 offen offset:1024
    buffer_load_dwordx4 v[36:39], v8, s[8:11], s28 offen offset:1024
    buffer_load_dwordx4 v[52:55], v8, s[8:11], s29 offen offset:1024
    buffer_load_dwordx4 v[68:71], v8, s[8:11], s30 offen offset:1024
    buffer_load_dwordx4 v[24:27], v8, s[8:11], s27 offen offset:2048
    buffer_load_dwordx4 v[40:43], v8, s[8:11], s28 offen offset:2048
    buffer_load_dwordx4 v[56:59], v8, s[8:11], s29 offen offset:2048
    buffer_load_dwordx4 v[72:75], v8, s[8:11], s30 offen offset:2048
    buffer_load_dwordx4 v[28:31], v8, s[8:11], s27 offen offset:3072
    buffer_load_dwordx4 v[44:47], v8, s[8:11], s28 offen offset:3072
    buffer_load_dwordx4 v[60:63], v8, s[8:11], s29 offen offset:3072
    buffer_load_dwordx4 v[76:79], v8, s[8:11], s30 offen offset:3072
    buffer_load_dwordx4 v[96:99], v8, s[8:11], s31 offen offset:0
    buffer_load_dwordx4 v[100:103], v8, s[8:11], s31 offen offset:1024
    buffer_load_dwordx4 v[104:107], v8, s[8:11], s31 offen offset:2048
    buffer_load_dwordx4 v[108:111], v8, s[8:11], s31 offen offset:3072
    buffer_load_dwordx4 v[112:115], v8, s[8:11], s32 offen offset:0
    buffer_load_dwordx4 v[116:119], v8, s[8:11], s32 offen offset:1024
    buffer_load_dwordx4 v[120:123], v8, s[8:11], s32 offen offset:2048
    buffer_load_dwordx4 v[124:127], v8, s[8:11], s32 offen offset:3072
    buffer_load_dwordx4 v[80:83], v10, s[8:11], s33 offen offset:2048 sc1
    buffer_load_dwordx4 v[84:87], v10, s[8:11], s33 offen offset:2176 sc1
    buffer_load_dwordx4 v[88:91], v10, s[8:11], s33 offen offset:3072 sc1
    buffer_load_dwordx4 v[92:95], v10, s[8:11], s33 offen offset:3200 sc1
    s_mov_b64 exec, s[60:61]
    buffer_load_dwordx2 v[128:129], v11, s[8:11], s34 offen offset:0 sc1
    buffer_load_dwordx2 v[130:131], v11, s[8:11], s34 offen offset:256 sc1
    buffer_load_dwordx2 v[132:133], v11, s[8:11], s34 offen offset:512 sc1
    buffer_load_dwordx2 v[134:135], v11, s[8:11], s34 offen offset:768 sc1
    buffer_load_dwordx2 v[136:137], v11, s[8:11], s34 offen offset:1024 sc1
    buffer_load_dwordx2 v[138:139], v11, s[8:11], s34 offen offset:1280 sc1
    buffer_load_dwordx2 v[140:141], v11, s[8:11], s34 offen offset:1536 sc1
    buffer_load_dwordx2 v[142:143], v11, s[8:11], s34 offen offset:1792 sc1
    s_mov_b64 exec, -1
    s_waitcnt vmcnt(32)
    v_mfma_f32_16x16x32_bf16 v[144:147], v[48:51], v[16:19], 0
    v_mfma_f32_16x16x32_bf16 v[156:159], v[48:51], v[32:35], 0
    v_mfma_f32_16x16x32_bf16 v[160:163], v[64:67], v[32:35], 0
    s_waitcnt vmcnt(28)
    v_mfma_f32_16x16x32_bf16 v[144:147], v[52:55], v[20:23], v[144:147]
    v_mfma_f32_16x16x32_bf16 v[156:159], v[52:55], v[36:39], v[156:159]
    v_mfma_f32_16x16x32_bf16 v[160:163], v[68:71], v[36:39], v[160:163]
    s_waitcnt vmcnt(24)
    v_mfma_f32_16x16x32_bf16 v[144:147], v[56:59], v[24:27], v[144:147]
    v_mfma_f32_16x16x32_bf16 v[156:159], v[56:59], v[40:43], v[156:159]
    v_mfma_f32_16x16x32_bf16 v[160:163], v[72:75], v[40:43], v[160:163]
    s_waitcnt vmcnt(20)
    v_mfma_f32_16x16x32_bf16 v[144:147], v[60:63], v[28:31], v[144:147]
    v_mfma_f32_16x16x32_bf16 v[156:159], v[60:63], v[44:47], v[156:159]
    v_mfma_f32_16x16x32_bf16 v[160:163], v[76:79], v[44:47], v[160:163]
    s_nop 7
    v_mov_b32 v14, 0xff800000
    v_cvt_pk_bf16_f32 v168, v144, v145
    v_cvt_pk_bf16_f32 v170, v146, v147
    v_and_b32 v169, 0xffff0000, v168
    v_lshlrev_b32 v168, 16, v168
    v_and_b32 v171, 0xffff0000, v170
    v_lshlrev_b32 v170, 16, v170
    v_mul_f32 v168, s37, v168
    v_mul_f32 v169, s37, v169
    v_mul_f32 v170, s37, v170
    v_mul_f32 v171, s37, v171
    v_cvt_pk_bf16_f32 v144, v168, v169
    v_cvt_pk_bf16_f32 v146, v170, v171
    v_and_b32 v145, 0xffff0000, v144
    v_lshlrev_b32 v144, 16, v144
    v_and_b32 v147, 0xffff0000, v146
    v_lshlrev_b32 v146, 16, v146
    v_cvt_pk_bf16_f32 v192, v156, v157
    v_cvt_pk_bf16_f32 v194, v158, v159
    v_cvt_pk_bf16_f32 v196, v160, v161
    v_cvt_pk_bf16_f32 v198, v162, v163
    v_and_b32 v193, 0xffff0000, v192
    v_lshlrev_b32 v192, 16, v192
    v_and_b32 v195, 0xffff0000, v194
    v_lshlrev_b32 v194, 16, v194
    v_and_b32 v197, 0xffff0000, v196
    v_lshlrev_b32 v196, 16, v196
    v_and_b32 v199, 0xffff0000, v198
    v_lshlrev_b32 v198, 16, v198
    v_mul_f32 v192, s37, v192
    v_mul_f32 v193, s37, v193
    v_mul_f32 v194, s37, v194
    v_mul_f32 v195, s37, v195
    v_mul_f32 v196, s37, v196
    v_mul_f32 v197, s37, v197
    v_mul_f32 v198, s37, v198
    v_mul_f32 v199, s37, v199
    v_cvt_pk_bf16_f32 v156, v192, v193
    v_cvt_pk_bf16_f32 v158, v194, v195
    v_cvt_pk_bf16_f32 v160, v196, v197
    v_cvt_pk_bf16_f32 v162, v198, v199
    v_and_b32 v157, 0xffff0000, v156
    v_lshlrev_b32 v156, 16, v156
    v_and_b32 v159, 0xffff0000, v158
    v_lshlrev_b32 v158, 16, v158
    v_and_b32 v161, 0xffff0000, v160
    v_lshlrev_b32 v160, 16, v160
    v_and_b32 v163, 0xffff0000, v162
    v_lshlrev_b32 v162, 16, v162
    v_cndmask_b32 v144, v14, v144, s[40:41]
    v_cndmask_b32 v145, v14, v145, s[42:43]
    v_cndmask_b32 v146, v14, v146, s[44:45]
    v_cndmask_b32 v147, v14, v147, s[46:47]
    v_cndmask_b32 v160, v14, v160, s[40:41]
    v_cndmask_b32 v161, v14, v161, s[42:43]
    v_cndmask_b32 v162, v14, v162, s[44:45]
    v_cndmask_b32 v163, v14, v163, s[46:47]
    s_mov_b32 s62, 0
.kmp_409:
    s_waitcnt vmcnt(0)
    v_max3_u32 v4, v80, v81, v82
    v_max3_u32 v5, v83, v84, v85
    v_max3_u32 v4, v4, v86, v87
    v_max3_u32 v5, v5, v88, v89
    v_max3_u32 v4, v4, v90, v91
    v_max3_u32 v5, v5, v92, v93
    v_max3_u32 v4, v4, v94, v95
    v_max3_u32 v5, v5, v128, v129
    v_max3_u32 v4, v4, v130, v131
    v_max3_u32 v5, v5, v132, v133
    v_max3_u32 v4, v4, v134, v135
    v_max3_u32 v5, v5, v136, v137
    v_max3_u32 v4, v4, v138, v139
    v_max3_u32 v5, v5, v140, v141
    v_max3_u32 v4, v4, v142, v143
    v_max_u32 v4, v4, v5
    v_cmp_eq_u32 vcc, -1, v4
    s_cbranch_vccz .kmd_410
    s_sleep 2

    buffer_load_dwordx4 v[80:83], v10, s[8:11], s33 offen offset:2048 sc1
    buffer_load_dwordx4 v[84:87], v10, s[8:11], s33 offen offset:2176 sc1
    buffer_load_dwordx4 v[88:91], v10, s[8:11], s33 offen offset:3072 sc1
    buffer_load_dwordx4 v[92:95], v10, s[8:11], s33 offen offset:3200 sc1
    s_mov_b64 exec, s[60:61]
    buffer_load_dwordx2 v[128:129], v11, s[8:11], s34 offen offset:0 sc1
    buffer_load_dwordx2 v[130:131], v11, s[8:11], s34 offen offset:256 sc1
    buffer_load_dwordx2 v[132:133], v11, s[8:11], s34 offen offset:512 sc1
    buffer_load_dwordx2 v[134:135], v11, s[8:11], s34 offen offset:768 sc1
    buffer_load_dwordx2 v[136:137], v11, s[8:11], s34 offen offset:1024 sc1
    buffer_load_dwordx2 v[138:139], v11, s[8:11], s34 offen offset:1280 sc1
    buffer_load_dwordx2 v[140:141], v11, s[8:11], s34 offen offset:1536 sc1
    buffer_load_dwordx2 v[142:143], v11, s[8:11], s34 offen offset:1792 sc1
    s_mov_b64 exec, -1
    s_add_u32 s62, s62, 1
    s_cmp_gt_u32 s62, 0x200000
    s_cbranch_scc1 .mg_end_1
    s_branch .kmp_409

.kmd_410:
    v_mfma_f32_16x16x32_bf16 v[152:155], v[80:83], v[16:19], 0
    v_mfma_f32_16x16x32_bf16 v[164:167], v[80:83], v[32:35], 0
    v_mfma_f32_16x16x32_bf16 v[152:155], v[84:87], v[20:23], v[152:155]
    v_mfma_f32_16x16x32_bf16 v[164:167], v[84:87], v[36:39], v[164:167]
    v_mfma_f32_16x16x32_bf16 v[152:155], v[88:91], v[24:27], v[152:155]
    v_mfma_f32_16x16x32_bf16 v[164:167], v[88:91], v[40:43], v[164:167]
    v_mfma_f32_16x16x32_bf16 v[152:155], v[92:95], v[28:31], v[152:155]
    v_mfma_f32_16x16x32_bf16 v[164:167], v[92:95], v[44:47], v[164:167]
    s_nop 5
    v_cvt_pk_bf16_f32 v176, v152, v153
    v_cvt_pk_bf16_f32 v178, v154, v155
    v_and_b32 v177, 0xffff0000, v176
    v_lshlrev_b32 v176, 16, v176
    v_and_b32 v179, 0xffff0000, v178
    v_lshlrev_b32 v178, 16, v178
    v_mul_f32 v176, s37, v176
    v_mul_f32 v177, s37, v177
    v_mul_f32 v178, s37, v178
    v_mul_f32 v179, s37, v179
    v_cvt_pk_bf16_f32 v152, v176, v177
    v_cvt_pk_bf16_f32 v154, v178, v179
    v_and_b32 v153, 0xffff0000, v152
    v_lshlrev_b32 v152, 16, v152
    v_and_b32 v155, 0xffff0000, v154
    v_lshlrev_b32 v154, 16, v154
    v_cndmask_b32 v152, v14, v152, s[60:61]
    v_cndmask_b32 v153, v14, v153, s[60:61]
    v_cndmask_b32 v154, v14, v154, s[60:61]
    v_cndmask_b32 v155, v14, v155, s[60:61]
    v_cvt_pk_bf16_f32 v200, v164, v165
    v_cvt_pk_bf16_f32 v202, v166, v167
    v_and_b32 v201, 0xffff0000, v200
    v_lshlrev_b32 v200, 16, v200
    v_and_b32 v203, 0xffff0000, v202
    v_lshlrev_b32 v202, 16, v202
    v_mul_f32 v200, s37, v200
    v_mul_f32 v201, s37, v201
    v_mul_f32 v202, s37, v202
    v_mul_f32 v203, s37, v203
    v_cvt_pk_bf16_f32 v164, v200, v201
    v_cvt_pk_bf16_f32 v166, v202, v203
    v_and_b32 v165, 0xffff0000, v164
    v_lshlrev_b32 v164, 16, v164
    v_and_b32 v167, 0xffff0000, v166
    v_lshlrev_b32 v166, 16, v166
    v_cndmask_b32 v164, v14, v164, s[60:61]
    v_cndmask_b32 v165, v14, v165, s[60:61]
    v_cndmask_b32 v166, v14, v166, s[60:61]
    v_cndmask_b32 v167, v14, v167, s[60:61]
    v_max3_f32 v4, v144, v145, v146
    v_max3_f32 v5, v147, v152, v153
    v_max3_f32 v4, v4, v154, v155
    v_max_f32 v4, v4, v5

    v_max3_f32 v6, v156, v157, v158
    v_max3_f32 v7, v159, v160, v161
    v_max3_f32 v6, v6, v162, v163
    v_max3_f32 v7, v7, v164, v165
    v_max3_f32 v6, v6, v166, v167
    v_max_f32 v6, v6, v7

    v_mov_b32 v5, v4
    v_mov_b32 v7, v6
    s_nop 0
    v_permlane32_swap_b32 v4, v5
    v_permlane32_swap_b32 v6, v7
    v_max_f32 v4, v4, v5
    v_max_f32 v6, v6, v7

    v_mov_b32 v5, v4
    v_mov_b32 v7, v6
    s_nop 0
    v_permlane16_swap_b32 v4, v5
    v_permlane16_swap_b32 v6, v7
    v_max_f32 v4, v4, v5
    v_max_f32 v6, v6, v7

    v_mul_f32 v4, s38, v4
    v_mul_f32 v6, s38, v6
    v_fma_f32 v168, v144, s38, -v4
    v_fma_f32 v169, v145, s38, -v4
    v_fma_f32 v170, v146, s38, -v4
    v_fma_f32 v171, v147, s38, -v4
    v_fma_f32 v176, v152, s38, -v4
    v_fma_f32 v177, v153, s38, -v4
    v_fma_f32 v178, v154, s38, -v4
    v_fma_f32 v179, v155, s38, -v4
    v_fma_f32 v192, v156, s38, -v6
    v_fma_f32 v193, v157, s38, -v6
    v_fma_f32 v194, v158, s38, -v6
    v_fma_f32 v195, v159, s38, -v6
    v_fma_f32 v196, v160, s38, -v6
    v_fma_f32 v197, v161, s38, -v6
    v_fma_f32 v198, v162, s38, -v6
    v_fma_f32 v199, v163, s38, -v6
    v_fma_f32 v200, v164, s38, -v6
    v_fma_f32 v201, v165, s38, -v6
    v_fma_f32 v202, v166, s38, -v6
    v_fma_f32 v203, v167, s38, -v6
    v_exp_f32 v168, v168
    v_exp_f32 v169, v169
    v_exp_f32 v170, v170
    v_exp_f32 v171, v171
    v_exp_f32 v176, v176
    v_exp_f32 v177, v177
    v_exp_f32 v178, v178
    v_exp_f32 v179, v179
    v_exp_f32 v192, v192
    v_exp_f32 v193, v193
    v_exp_f32 v194, v194
    v_exp_f32 v195, v195
    v_exp_f32 v196, v196
    v_exp_f32 v197, v197
    v_exp_f32 v198, v198
    v_exp_f32 v199, v199
    v_exp_f32 v200, v200
    v_exp_f32 v201, v201
    v_exp_f32 v202, v202
    v_exp_f32 v203, v203
    v_add_f32 v4, v168, v169
    v_add_f32 v5, v170, v171
    v_add_f32 v4, v4, v176
    v_add_f32 v5, v5, v177
    v_add_f32 v4, v4, v178
    v_add_f32 v5, v5, v179
    v_add_f32 v4, v4, v5
    v_add_f32 v6, v192, v193
    v_add_f32 v7, v194, v195
    v_add_f32 v6, v6, v196
    v_add_f32 v7, v7, v197
    v_add_f32 v6, v6, v198
    v_add_f32 v7, v7, v199
    v_add_f32 v6, v6, v200
    v_add_f32 v7, v7, v201
    v_add_f32 v6, v6, v202
    v_add_f32 v7, v7, v203
    v_add_f32 v6, v6, v7
    v_mov_b32 v5, v4
    v_mov_b32 v7, v6
    s_nop 0
    v_permlane32_swap_b32 v4, v5
    v_permlane32_swap_b32 v6, v7
    v_add_f32 v4, v4, v5
    v_add_f32 v6, v6, v7

    v_mov_b32 v5, v4
    v_mov_b32 v7, v6
    s_nop 0
    v_permlane16_swap_b32 v4, v5
    v_permlane16_swap_b32 v6, v7
    v_add_f32 v4, v4, v5
    v_add_f32 v6, v6, v7

    v_rcp_f32 v4, v4
    v_rcp_f32 v6, v6
    v_mov_b32 v182, 0
    v_mov_b32 v183, 0
    v_mul_f32 v168, v4, v168
    v_mul_f32 v169, v4, v169
    v_mul_f32 v170, v4, v170
    v_mul_f32 v171, v4, v171
    v_mul_f32 v176, v4, v176
    v_mul_f32 v177, v4, v177
    v_mul_f32 v178, v4, v178
    v_mul_f32 v179, v4, v179
    v_cvt_pk_bf16_f32 v180, v168, v169
    v_cvt_pk_bf16_f32 v181, v170, v171
    v_cvt_pk_bf16_f32 v184, v176, v177
    v_cvt_pk_bf16_f32 v185, v178, v179
    v_mul_f32 v192, v6, v192
    v_mul_f32 v193, v6, v193
    v_mul_f32 v194, v6, v194
    v_mul_f32 v195, v6, v195
    v_mul_f32 v196, v6, v196
    v_mul_f32 v197, v6, v197
    v_mul_f32 v198, v6, v198
    v_mul_f32 v199, v6, v199
    v_mul_f32 v200, v6, v200
    v_mul_f32 v201, v6, v201
    v_mul_f32 v202, v6, v202
    v_mul_f32 v203, v6, v203
    v_cvt_pk_bf16_f32 v186, v192, v193
    v_cvt_pk_bf16_f32 v187, v194, v195
    v_cvt_pk_bf16_f32 v188, v196, v197
    v_cvt_pk_bf16_f32 v189, v198, v199
    v_cvt_pk_bf16_f32 v190, v200, v201
    v_cvt_pk_bf16_f32 v191, v202, v203
    s_add_u32 s4, s27, 50331648
    s_add_u32 s5, s28, 50331648
    v_add_u32 v12, 1, v12

    v_mfma_f32_16x16x32_bf16 v[16:19], v[96:99], v[180:183], 0
    v_mfma_f32_16x16x32_bf16 v[20:23], v[100:103], v[180:183], 0
    v_mfma_f32_16x16x32_bf16 v[24:27], v[104:107], v[180:183], 0
    v_mfma_f32_16x16x32_bf16 v[28:31], v[108:111], v[180:183], 0
    v_mfma_f32_16x16x32_bf16 v[32:35], v[112:115], v[180:183], 0
    v_mfma_f32_16x16x32_bf16 v[36:39], v[116:119], v[180:183], 0
    v_mfma_f32_16x16x32_bf16 v[40:43], v[120:123], v[180:183], 0
    v_mfma_f32_16x16x32_bf16 v[44:47], v[124:127], v[180:183], 0
    v_mfma_f32_16x16x32_bf16 v[48:51], v[96:99], v[186:189], 0
    v_mfma_f32_16x16x32_bf16 v[52:55], v[100:103], v[186:189], 0
    v_mfma_f32_16x16x32_bf16 v[56:59], v[104:107], v[186:189], 0
    v_mfma_f32_16x16x32_bf16 v[60:63], v[108:111], v[186:189], 0
    v_mfma_f32_16x16x32_bf16 v[64:67], v[112:115], v[186:189], 0
    v_mfma_f32_16x16x32_bf16 v[68:71], v[116:119], v[186:189], 0
    v_mfma_f32_16x16x32_bf16 v[72:75], v[120:123], v[186:189], 0
    v_mfma_f32_16x16x32_bf16 v[76:79], v[124:127], v[186:189], 0
    v_mfma_f32_16x16x16_bf16 v[16:19], v[128:129], v[184:185], v[16:19]
    v_mfma_f32_16x16x16_bf16 v[20:23], v[130:131], v[184:185], v[20:23]
    v_mfma_f32_16x16x16_bf16 v[24:27], v[132:133], v[184:185], v[24:27]
    v_mfma_f32_16x16x16_bf16 v[28:31], v[134:135], v[184:185], v[28:31]
    v_mfma_f32_16x16x16_bf16 v[32:35], v[136:137], v[184:185], v[32:35]
    v_mfma_f32_16x16x16_bf16 v[36:39], v[138:139], v[184:185], v[36:39]
    v_cvt_pk_bf16_f32 v208, v16, v17
    v_cvt_pk_bf16_f32 v209, v18, v19
    v_cvt_pk_bf16_f32 v210, v20, v21
    v_cvt_pk_bf16_f32 v211, v22, v23
    buffer_store_dwordx4 v[208:211], v8, s[8:11], s4 offen offset:0 sc1
    v_mfma_f32_16x16x16_bf16 v[40:43], v[140:141], v[184:185], v[40:43]
    v_mfma_f32_16x16x16_bf16 v[44:47], v[142:143], v[184:185], v[44:47]
    v_cvt_pk_bf16_f32 v212, v24, v25
    v_cvt_pk_bf16_f32 v213, v26, v27
    v_cvt_pk_bf16_f32 v214, v28, v29
    v_cvt_pk_bf16_f32 v215, v30, v31
    buffer_store_dwordx4 v[212:215], v8, s[8:11], s4 offen offset:1024 sc1
    v_mfma_f32_16x16x16_bf16 v[48:51], v[128:129], v[190:191], v[48:51]
    v_mfma_f32_16x16x16_bf16 v[52:55], v[130:131], v[190:191], v[52:55]
    v_cvt_pk_bf16_f32 v216, v32, v33
    v_cvt_pk_bf16_f32 v217, v34, v35
    v_cvt_pk_bf16_f32 v218, v36, v37
    v_cvt_pk_bf16_f32 v219, v38, v39
    buffer_store_dwordx4 v[216:219], v8, s[8:11], s4 offen offset:2048 sc1
    v_mfma_f32_16x16x16_bf16 v[56:59], v[132:133], v[190:191], v[56:59]
    v_mfma_f32_16x16x16_bf16 v[60:63], v[134:135], v[190:191], v[60:63]
    v_cvt_pk_bf16_f32 v220, v40, v41
    v_cvt_pk_bf16_f32 v221, v42, v43
    v_cvt_pk_bf16_f32 v222, v44, v45
    v_cvt_pk_bf16_f32 v223, v46, v47
    buffer_store_dwordx4 v[220:223], v8, s[8:11], s4 offen offset:3072 sc1
    v_mfma_f32_16x16x16_bf16 v[64:67], v[136:137], v[190:191], v[64:67]
    v_mfma_f32_16x16x16_bf16 v[68:71], v[138:139], v[190:191], v[68:71]
    v_cvt_pk_bf16_f32 v224, v48, v49
    v_cvt_pk_bf16_f32 v225, v50, v51
    v_cvt_pk_bf16_f32 v226, v52, v53
    v_cvt_pk_bf16_f32 v227, v54, v55
    buffer_store_dwordx4 v[224:227], v8, s[8:11], s5 offen offset:0 sc1
    v_mfma_f32_16x16x16_bf16 v[72:75], v[140:141], v[190:191], v[72:75]
    v_mfma_f32_16x16x16_bf16 v[76:79], v[142:143], v[190:191], v[76:79]
    v_cvt_pk_bf16_f32 v228, v56, v57
    v_cvt_pk_bf16_f32 v229, v58, v59
    v_cvt_pk_bf16_f32 v230, v60, v61
    v_cvt_pk_bf16_f32 v231, v62, v63
    buffer_store_dwordx4 v[228:231], v8, s[8:11], s5 offen offset:1024 sc1
    s_nop 3
    v_cvt_pk_bf16_f32 v232, v64, v65
    v_cvt_pk_bf16_f32 v233, v66, v67
    v_cvt_pk_bf16_f32 v234, v68, v69
    v_cvt_pk_bf16_f32 v235, v70, v71
    buffer_store_dwordx4 v[232:235], v8, s[8:11], s5 offen offset:2048 sc1
    v_cvt_pk_bf16_f32 v236, v72, v73
    v_cvt_pk_bf16_f32 v237, v74, v75
    v_cvt_pk_bf16_f32 v238, v76, v77
    v_cvt_pk_bf16_f32 v239, v78, v79
    buffer_store_dwordx4 v[236:239], v8, s[8:11], s5 offen offset:3072 sc1
    s_waitcnt vmcnt(0)
    s_barrier
    s_cmp_lg_u32 s24, 0
    s_cbranch_scc1 .ats_411
    s_mov_b64 exec, 1
    buffer_store_dword v12, v13, s[8:11], s92 offen sc1
    s_mov_b64 exec, -1

.ats_411:
    s_add_u32 s25, s25, 4
    s_cmp_lt_u32 s25, 64
    s_cbranch_scc1 .att_406

.mg_end_1:
    s_endpgm
.section .rodata,"a"
.p2align 6
.amdhsa_kernel mega_kernel
  .amdhsa_next_free_vgpr 512
  .amdhsa_next_free_sgpr 102
  .amdhsa_accum_offset 256
  .amdhsa_group_segment_fixed_size 0
  .amdhsa_kernarg_size 136
  .amdhsa_user_sgpr_count 2
  .amdhsa_user_sgpr_kernarg_segment_ptr 1
  .amdhsa_system_sgpr_workgroup_id_x 1
.end_amdhsa_kernel
```

```asm
; @launch kernel=mega_kernel grid=(256,1,1) block=(256,1,1) lds=163840
.amdgcn_target "amdgcn-amd-amdhsa--gfx950"
.text
.globl mega_kernel
.p2align 8
.type mega_kernel,@function
mega_kernel:
    s_cmp_ge_u32 s2, 256
    s_cbranch_scc1 .mg_end_1
    s_load_dwordx4 s[52:55], s[0:1], 120
    s_load_dwordx2 s[40:41], s[0:1], 56
    s_getreg_b32 s3, hwreg(HW_REG_XCC_ID)
    v_and_b32 v1, 63, v0
    v_lshrrev_b32 v4, 6, v0
    s_and_b32 s3, s3, 7
    v_readfirstlane_b32 s24, v4
    s_waitcnt lgkmcnt(0)

    s_mov_b32 s8, s54
    s_and_b32 s9, s55, 0xffff
    s_mov_b32 s10, 0x10000000
    s_mov_b32 s11, 0x00020000

    s_mov_b32 s20, s52
    s_and_b32 s21, s53, 0xffff
    s_mov_b32 s22, 0x100
    s_mov_b32 s23, 0x00020000

    s_mov_b32 s100, s54
    s_cmp_lg_u32 s24, 0
    s_cbranch_scc1 .noat_4
    s_mov_b64 exec, 1
    v_mov_b32 v5, 1
    s_lshl_b32 s4, s3, 2
    v_mov_b32 v6, s4
    buffer_atomic_add v5, v6, s[20:23], 0 offen sc0 sc1
    v_mov_b32 v7, 163776
    s_waitcnt vmcnt(0)
    ds_write_b32 v7, v5
    v_cmp_lt_u32 vcc, 31, v5
    s_cbranch_vccz .nb_5
    v_mov_b32 v6, 136
    buffer_store_dword v7, v6, s[20:23], 0 offen sc1

.nb_5:
    s_waitcnt lgkmcnt(0)
    s_mov_b64 exec, -1

.noat_4:
    s_barrier
    v_mov_b32 v7, 163776
    ds_read_b32 v5, v7
    s_waitcnt lgkmcnt(0)
    v_readfirstlane_b32 s26, v5
    s_mov_b32 s25, s3
    s_mov_b32 s27, 0
    s_mov_b32 s97, 128
    s_and_b32 s26, s26, 31

.mg_role_3:
    s_cmp_ge_u32 s25, 4
    s_cbranch_scc1 .mg_bg_2

    s_load_dwordx8 s[44:51], s[0:1], 64
    s_load_dwordx2 s[40:41], s[0:1], 56
    v_and_b32 v1, 63, v0
    v_and_b32 v2, 15, v1
    v_lshrrev_b32 v3, 4, v1

    s_lshr_b32 s79, s26, 2
    s_and_b32 s78, s24, 1
    s_lshl_b32 s34, s25, 18
    s_add_u32 s34, s34, 83886080
    v_lshlrev_b32 v14, 4, v1
    v_lshrrev_b32 v6, 1, v3
    s_sub_u32 s101, 0, s100
    s_and_b32 s101, s101, 0x1fffff
    s_add_u32 s101, s101, 100663296

    v_mov_b32 v188, -1
    v_mov_b32 v189, -1
    v_mov_b32 v190, -1
    v_mov_b32 v191, -1
    s_lshl_b32 s5, s26, 10
    s_add_u32 s5, s5, 32768
    v_add_u32 v235, s5, v14
    s_lshl_b32 s4, s26, 9
    v_and_b32 v4, 31, v1
    v_lshlrev_b32 v236, 4, v4
    v_lshl_add_u32 v236, v6, 14, v236
    v_add_u32 v236, s4, v236
    s_and_b32 s5, s26, 7
    s_lshl_b32 s4, s5, 10
    s_lshr_b32 s5, s26, 3
    s_lshl_b32 s5, s5, 14
    s_add_u32 s4, s4, s5
    s_add_u32 s35, s4, s101
    s_lshl_b32 s5, s25, 16
    v_add_u32 v238, s5, v14
    s_lshl_b32 s4, s25, 3
    s_add_u32 s7, s4, s79
    s_mul_i32 s36, s7, 6144
    s_add_u32 s36, s36, 67108864
    s_cmp_eq_u32 s78, 0
    s_cselect_b64 vcc, -1, 0
    s_lshr_b32 s6, s24, 1
    s_lshl_b32 s4, s6, 16
    s_add_u32 s4, s4, s34
    v_cndmask_b32 v4, v235, v236, vcc
    s_mul_i32 s5, s6, 1048576
    s_lshl_b32 s6, s78, 13
    buffer_store_dwordx4 v[188:191], v4, s[8:11], s4 offen sc1
    s_add_u32 s5, s5, s6
    s_add_u32 s5, s5, s35

    buffer_store_dwordx4 v[188:191], v238, s[8:11], s5 offen sc1
    s_add_u32 s5, s5, 262144
    buffer_store_dwordx4 v[188:191], v238, s[8:11], s5 offen sc1
    s_add_u32 s5, s5, 262144
    s_lshl_b32 s4, s25, 11
    s_lshl_b32 s5, s26, 6
    s_add_u32 s4, s4, s5
    s_lshl_b32 s5, s24, 21
    s_add_u32 s4, s4, s5
    v_lshrrev_b32 v4, 2, v1
    v_and_b32 v5, 3, v1
    v_lshlrev_b32 v5, 4, v5
    v_lshlrev_b32 v6, 13, v4
    v_add_u32 v6, v6, v5
    v_add_u32 v240, s4, v6
    s_lshl_b32 s4, s25, 2
    s_and_b32 s5, s24, 1
    s_lshl_b32 s5, s5, 1
    s_add_u32 s4, s4, s5
    s_lshr_b32 s5, s24, 1
    s_add_u32 s4, s4, s5
    s_lshl_b32 s4, s4, 19
    s_lshl_b32 s5, s26, 6
    s_add_u32 s4, s4, s5
    v_lshlrev_b32 v6, 11, v4
    v_add_u32 v6, v6, v5
    v_add_u32 v241, s4, v6
    s_lshl_b32 s98, s24, 15
    s_waitcnt lgkmcnt(0)

    s_cmp_eq_u32 s24, 1
    s_cselect_b64 s[42:43], s[46:47], s[44:45]
    s_cmp_eq_u32 s24, 2
    s_cselect_b64 s[42:43], s[48:49], s[42:43]
    s_cmp_eq_u32 s24, 3
    s_cselect_b64 s[42:43], s[50:51], s[42:43]
    s_cselect_b32 s6, 11, 13
    s_cselect_b32 s7, 21, 11

    s_mov_b32 s16, s42
    s_and_b32 s17, s43, 0xffff
    s_mov_b32 s18, 0x800000
    s_mov_b32 s19, 0x00020000

    s_lshl_b32 s7, s25, s7
    s_lshr_b32 s4, s26, 1
    s_lshl_b32 s4, s4, 6
    v_add_u32 v4, s4, v1
    v_lshlrev_b32 v4, s6, v4
    s_and_b32 s4, s26, 1
    s_lshl_b32 s4, s4, 10
    s_add_u32 s7, s7, s4
    buffer_load_dword v226, v4, s[16:19], s7 offen offset:384

    s_bitcmp1_b32 s26, 0
    s_cbranch_scc1 .po_7
    s_mov_b32 s16, s44
    s_and_b32 s17, s45, 0xffff
    s_mov_b32 s18, 0x800000
    s_mov_b32 s19, 0x00020000

    s_add_u32 m0, s98, 0
    s_mov_b32 s5, 0
    buffer_load_dwordx4 v240, s[16:19], s5 offen  lds

    s_add_u32 m0, s98, 1024
    s_mov_b32 s5, 131072
    buffer_load_dwordx4 v240, s[16:19], s5 offen  lds

    s_add_u32 m0, s98, 2048
    s_mov_b32 s5, 262144
    buffer_load_dwordx4 v240, s[16:19], s5 offen  lds

    s_add_u32 m0, s98, 3072
    s_mov_b32 s5, 393216
    buffer_load_dwordx4 v240, s[16:19], s5 offen  lds

    s_add_u32 m0, s98, 4096
    s_mov_b32 s5, 524288
    buffer_load_dwordx4 v240, s[16:19], s5 offen  lds

    s_add_u32 m0, s98, 5120
    s_mov_b32 s5, 655360
    buffer_load_dwordx4 v240, s[16:19], s5 offen  lds

    s_add_u32 m0, s98, 6144
    s_mov_b32 s5, 786432
    buffer_load_dwordx4 v240, s[16:19], s5 offen  lds

    s_add_u32 m0, s98, 7168
    s_mov_b32 s5, 917504
    buffer_load_dwordx4 v240, s[16:19], s5 offen  lds

    s_branch .pj_8
.po_7:
    s_mov_b32 s16, s44
    s_and_b32 s17, s45, 0xffff
    s_mov_b32 s18, 0x800000
    s_mov_b32 s19, 0x00020000

    s_add_u32 m0, s98, 8192
    s_mov_b32 s5, 1048576
    buffer_load_dwordx4 v240, s[16:19], s5 offen  lds

    s_add_u32 m0, s98, 9216
    s_mov_b32 s5, 1179648
    buffer_load_dwordx4 v240, s[16:19], s5 offen  lds

    s_add_u32 m0, s98, 10240
    s_mov_b32 s5, 1310720
    buffer_load_dwordx4 v240, s[16:19], s5 offen  lds

    s_add_u32 m0, s98, 11264
    s_mov_b32 s5, 1441792
    buffer_load_dwordx4 v240, s[16:19], s5 offen  lds

    s_add_u32 m0, s98, 12288
    s_mov_b32 s5, 1572864
    buffer_load_dwordx4 v240, s[16:19], s5 offen  lds

    s_add_u32 m0, s98, 13312
    s_mov_b32 s5, 1703936
    buffer_load_dwordx4 v240, s[16:19], s5 offen  lds

    s_add_u32 m0, s98, 14336
    s_mov_b32 s5, 1835008
    buffer_load_dwordx4 v240, s[16:19], s5 offen  lds

    s_add_u32 m0, s98, 15360
    s_mov_b32 s5, 1966080
    buffer_load_dwordx4 v240, s[16:19], s5 offen  lds

.pj_8:
    s_waitcnt vmcnt(9)
    s_barrier
    v_mov_b32 v243, 1
    v_mov_b32 v242, 0
    s_cmp_lg_u32 s24, 3
    s_cbranch_scc1 .a1_9
    s_mov_b64 exec, 1
    s_cmp_lg_u32 s27, 0
    s_cbranch_scc1 .a1s_10
    s_lshl_b32 s4, s25, 2
    buffer_atomic_add v243, v242, s[20:23], s4 offen offset:32 sc0 sc1
    s_branch .a1_9

.a1s_10:
    buffer_atomic_add v243, v242, s[20:23], s97 offen sc1
.a1_9:
    s_mov_b64 exec, -1
    s_bitcmp1_b32 s26, 0
    s_cbranch_scc1 .po_11
    s_add_u32 m0, s98, 8192
    s_mov_b32 s5, 1048576
    buffer_load_dwordx4 v240, s[16:19], s5 offen  lds

    s_add_u32 m0, s98, 9216
    s_mov_b32 s5, 1179648
    buffer_load_dwordx4 v240, s[16:19], s5 offen  lds

    s_add_u32 m0, s98, 10240
    s_mov_b32 s5, 1310720
    buffer_load_dwordx4 v240, s[16:19], s5 offen  lds

    s_add_u32 m0, s98, 11264
    s_mov_b32 s5, 1441792
    buffer_load_dwordx4 v240, s[16:19], s5 offen  lds

    s_add_u32 m0, s98, 12288
    s_mov_b32 s5, 1572864
    buffer_load_dwordx4 v240, s[16:19], s5 offen  lds

    s_add_u32 m0, s98, 13312
    s_mov_b32 s5, 1703936
    buffer_load_dwordx4 v240, s[16:19], s5 offen  lds

    s_add_u32 m0, s98, 14336
    s_mov_b32 s5, 1835008
    buffer_load_dwordx4 v240, s[16:19], s5 offen  lds

    s_add_u32 m0, s98, 15360
    s_mov_b32 s5, 1966080
    buffer_load_dwordx4 v240, s[16:19], s5 offen  lds

    s_mov_b32 s16, s46
    s_and_b32 s17, s47, 0xffff
    s_mov_b32 s18, 0x800000
    s_mov_b32 s19, 0x00020000

    s_add_u32 m0, s98, 16384
    s_mov_b32 s5, 0
    buffer_load_dwordx4 v240, s[16:19], s5 offen  lds

    s_add_u32 m0, s98, 17408
    s_mov_b32 s5, 131072
    buffer_load_dwordx4 v240, s[16:19], s5 offen  lds

    s_add_u32 m0, s98, 18432
    s_mov_b32 s5, 262144
    buffer_load_dwordx4 v240, s[16:19], s5 offen  lds

    s_add_u32 m0, s98, 19456
    s_mov_b32 s5, 393216
    buffer_load_dwordx4 v240, s[16:19], s5 offen  lds

    s_add_u32 m0, s98, 20480
    s_mov_b32 s5, 524288
    buffer_load_dwordx4 v240, s[16:19], s5 offen  lds

    s_add_u32 m0, s98, 21504
    s_mov_b32 s5, 655360
    buffer_load_dwordx4 v240, s[16:19], s5 offen  lds

    s_add_u32 m0, s98, 22528
    s_mov_b32 s5, 786432
    buffer_load_dwordx4 v240, s[16:19], s5 offen  lds

    s_add_u32 m0, s98, 23552
    s_mov_b32 s5, 917504
    buffer_load_dwordx4 v240, s[16:19], s5 offen  lds

    s_add_u32 m0, s98, 24576
    s_mov_b32 s5, 1048576
    buffer_load_dwordx4 v240, s[16:19], s5 offen  lds

    s_add_u32 m0, s98, 25600
    s_mov_b32 s5, 1179648
    buffer_load_dwordx4 v240, s[16:19], s5 offen  lds

    s_add_u32 m0, s98, 26624
    s_mov_b32 s5, 1310720
    buffer_load_dwordx4 v240, s[16:19], s5 offen  lds

    s_add_u32 m0, s98, 27648
    s_mov_b32 s5, 1441792
    buffer_load_dwordx4 v240, s[16:19], s5 offen  lds

    s_add_u32 m0, s98, 28672
    s_mov_b32 s5, 1572864
    buffer_load_dwordx4 v240, s[16:19], s5 offen  lds

    s_add_u32 m0, s98, 29696
    s_mov_b32 s5, 1703936
    buffer_load_dwordx4 v240, s[16:19], s5 offen  lds

    s_add_u32 m0, s98, 30720
    s_mov_b32 s5, 1835008
    buffer_load_dwordx4 v240, s[16:19], s5 offen  lds

    s_add_u32 m0, s98, 31744
    s_mov_b32 s5, 1966080
    buffer_load_dwordx4 v240, s[16:19], s5 offen  lds

    s_branch .pj_12
.po_11:
    s_add_u32 m0, s98, 0
    s_mov_b32 s5, 0
    buffer_load_dwordx4 v240, s[16:19], s5 offen  lds

    s_add_u32 m0, s98, 1024
    s_mov_b32 s5, 131072
    buffer_load_dwordx4 v240, s[16:19], s5 offen  lds

    s_add_u32 m0, s98, 2048
    s_mov_b32 s5, 262144
    buffer_load_dwordx4 v240, s[16:19], s5 offen  lds

    s_add_u32 m0, s98, 3072
    s_mov_b32 s5, 393216
    buffer_load_dwordx4 v240, s[16:19], s5 offen  lds

    s_add_u32 m0, s98, 4096
    s_mov_b32 s5, 524288
    buffer_load_dwordx4 v240, s[16:19], s5 offen  lds

    s_add_u32 m0, s98, 5120
    s_mov_b32 s5, 655360
    buffer_load_dwordx4 v240, s[16:19], s5 offen  lds

    s_add_u32 m0, s98, 6144
    s_mov_b32 s5, 786432
    buffer_load_dwordx4 v240, s[16:19], s5 offen  lds

    s_add_u32 m0, s98, 7168
    s_mov_b32 s5, 917504
    buffer_load_dwordx4 v240, s[16:19], s5 offen  lds

    s_mov_b32 s16, s46
    s_and_b32 s17, s47, 0xffff
    s_mov_b32 s18, 0x800000
    s_mov_b32 s19, 0x00020000

    s_add_u32 m0, s98, 24576
    s_mov_b32 s5, 1048576
    buffer_load_dwordx4 v240, s[16:19], s5 offen  lds

    s_add_u32 m0, s98, 25600
    s_mov_b32 s5, 1179648
    buffer_load_dwordx4 v240, s[16:19], s5 offen  lds

    s_add_u32 m0, s98, 26624
    s_mov_b32 s5, 1310720
    buffer_load_dwordx4 v240, s[16:19], s5 offen  lds

    s_add_u32 m0, s98, 27648
    s_mov_b32 s5, 1441792
    buffer_load_dwordx4 v240, s[16:19], s5 offen  lds

    s_add_u32 m0, s98, 28672
    s_mov_b32 s5, 1572864
    buffer_load_dwordx4 v240, s[16:19], s5 offen  lds

    s_add_u32 m0, s98, 29696
    s_mov_b32 s5, 1703936
    buffer_load_dwordx4 v240, s[16:19], s5 offen  lds

    s_add_u32 m0, s98, 30720
    s_mov_b32 s5, 1835008
    buffer_load_dwordx4 v240, s[16:19], s5 offen  lds

    s_add_u32 m0, s98, 31744
    s_mov_b32 s5, 1966080
    buffer_load_dwordx4 v240, s[16:19], s5 offen  lds

    s_add_u32 m0, s98, 16384
    s_mov_b32 s5, 0
    buffer_load_dwordx4 v240, s[16:19], s5 offen  lds

    s_add_u32 m0, s98, 17408
    s_mov_b32 s5, 131072
    buffer_load_dwordx4 v240, s[16:19], s5 offen  lds

    s_add_u32 m0, s98, 18432
    s_mov_b32 s5, 262144
    buffer_load_dwordx4 v240, s[16:19], s5 offen  lds

    s_add_u32 m0, s98, 19456
    s_mov_b32 s5, 393216
    buffer_load_dwordx4 v240, s[16:19], s5 offen  lds

    s_add_u32 m0, s98, 20480
    s_mov_b32 s5, 524288
    buffer_load_dwordx4 v240, s[16:19], s5 offen  lds

    s_add_u32 m0, s98, 21504
    s_mov_b32 s5, 655360
    buffer_load_dwordx4 v240, s[16:19], s5 offen  lds

    s_add_u32 m0, s98, 22528
    s_mov_b32 s5, 786432
    buffer_load_dwordx4 v240, s[16:19], s5 offen  lds

    s_add_u32 m0, s98, 23552
    s_mov_b32 s5, 917504
    buffer_load_dwordx4 v240, s[16:19], s5 offen  lds

.pj_12:
    s_waitcnt vmcnt(24)
    v_readfirstlane_b32 s4, v243
    s_lshl_b32 s5, s24, 8
    s_add_u32 s4, s4, s5
    s_cmp_lg_u32 s4, 799
    s_cbranch_scc1 .a2_13
    s_mov_b64 exec, 1
    v_mov_b32 v243, 32
    buffer_atomic_add v243, v242, s[20:23], s97 offen sc1
    s_mov_b64 exec, -1

.a2_13:
    s_mov_b32 s12, s40
    s_and_b32 s13, s41, 0xffff
    s_mov_b32 s14, 0x4000
    s_mov_b32 s15, 0x00020000

    v_bfe_u32 v4, v2, 2, 1
    v_lshrrev_b32 v5, 3, v2
    v_lshrrev_b32 v8, 1, v3
    v_and_b32 v9, 1, v3
    v_lshl_add_u32 v6, v5, 3, v4
    v_lshl_add_u32 v6, v8, 4, v6
    v_lshl_add_u32 v6, v9, 2, v6
    v_lshl_add_u32 v7, v5, 2, v4
    v_lshl_add_u32 v7, v8, 3, v7
    v_lshl_add_u32 v7, v9, 4, v7
    v_and_b32 v5, 3, v2
    v_lshlrev_b32 v5, 3, v5
    v_lshl_add_u32 v6, v6, 6, v5
    v_lshl_add_u32 v7, v7, 6, v5
    v_add_u32 v254, s98, v6
    v_add_u32 v255, s98, v7
    v_sub_u32 v252, v254, v5
    v_and_b32 v5, 1, v2
    v_lshl_add_u32 v252, v5, 5, v252
    v_bfe_u32 v5, v2, 1, 1
    v_lshl_add_u32 v252, v5, 3, v252

    s_and_b32 s96, s26, 3
    s_lshl_b32 s4, s25, 3
    s_add_u32 s7, s4, s79
    s_lshl_b32 s5, s24, 12
    v_add_u32 v8, s5, v14
    v_and_b32 v5, 7, v2
    v_lshrrev_b32 v6, 1, v3
    v_and_b32 v7, 1, v3
    v_lshlrev_b32 v7, 3, v7
    v_lshlrev_b32 v17, 11, v5
    v_lshl_add_u32 v17, v3, 5, v17
    v_lshrrev_b32 v4, 3, v2
    v_lshl_add_u32 v17, v4, 4, v17
    s_lshl_b32 s5, s24, 9
    v_add_u32 v17, s5, v17

    buffer_load_dwordx4 v[20:23], v17, s[12:15], 0 offen offset:0
    buffer_load_dwordx4 v[24:27], v17, s[12:15], 0 offen offset:128
    buffer_load_dwordx4 v[28:31], v17, s[12:15], 0 offen offset:256
    buffer_load_dwordx4 v[32:35], v17, s[12:15], 0 offen offset:384
    s_lshl_b32 s4, s79, 12
    s_add_u32 s4, s4, 32768

    s_add_u32 s5, s96, 1
    s_and_b32 s5, s5, 3
    s_lshl_b32 s5, s5, 10
    s_add_u32 s5, s5, s4
    v_add_u32 v232, s5, v14

    s_add_u32 s5, s96, 2
    s_and_b32 s5, s5, 3
    s_lshl_b32 s5, s5, 10
    s_add_u32 s5, s5, s4
    v_add_u32 v233, s5, v14

    s_add_u32 s5, s96, 3
    s_and_b32 s5, s5, 3
    s_lshl_b32 s5, s5, 10
    s_add_u32 s5, s5, s4
    v_add_u32 v234, s5, v14

    s_lshl_b32 s5, s78, 9
    v_lshlrev_b32 v10, 8, v6
    v_lshl_add_u32 v10, v2, 4, v10
    v_add_u32 v10, v10, v7
    v_add_u32 v10, s5, v10
    v_add_u32 v18, 16384, v10
    s_lshl_b32 s5, s26, 10
    s_add_u32 s5, s5, 32768
    v_add_u32 v10, s5, v10
    v_lshlrev_b32 v11, 8, v3
    v_lshl_add_u32 v11, v5, 4, v11
    s_lshr_b32 s4, s96, 1
    s_lshl_b32 s4, s4, 10
    s_and_b32 s5, s96, 1
    s_lshl_b32 s5, s5, 7
    s_add_u32 s4, s4, s5
    s_add_u32 s4, s4, 2048
    v_add_u32 v11, s4, v11
    v_lshlrev_b32 v12, 8, v6
    v_lshl_add_u32 v12, v2, 4, v12
    s_lshl_b32 s4, s96, 9
    s_add_u32 s4, s4, 4096
    v_add_u32 v12, s4, v12
    s_lshl_b32 s4, s26, 9
    v_lshlrev_b32 v13, 7, v3
    v_lshl_add_u32 v13, v5, 4, v13
    v_add_u32 v13, s4, v13
    v_add_u32 v13, 16384, v13
    v_lshlrev_b32 v15, 7, v6
    v_lshl_add_u32 v15, v5, 4, v15
    v_add_u32 v15, v15, v7
    s_lshl_b32 s5, s78, 8
    s_add_u32 s5, s5, s4
    v_add_u32 v15, s5, v15
    v_lshlrev_b32 v16, 8, v6
    v_lshl_add_u32 v16, v2, 4, v16
    v_add_u32 v16, v16, v7
    s_lshl_b32 s5, s24, 9
    v_add_u32 v16, s5, v16
    s_lshl_b32 s5, s24, 11
    v_add_u32 v17, s5, v14
    v_cmp_gt_u32 s[58:59], 8, v2
    v_cmp_gt_u32 s[60:61], 32, v1
    v_mov_b32 v4, 0x4444
    v_mov_b32 v9, 0xeeee
    v_cndmask_b32 v9, v9, v4, s[58:59]
    s_not_b64 s[66:67], s[58:59]
    s_cmp_lt_u32 s24, 2
    s_cselect_b64 s[64:65], s[66:67], s[58:59]
    s_mov_b32 s56, 0x0000ffff
    s_mov_b32 s57, 0x0000ffff
    s_cmp_eq_u32 s24, 1
    s_cselect_b64 vcc, -1, 0
    s_cselect_b64 s[66:67], s[56:57], s[66:67]
    s_lshl_b32 s5, s78, 10
    v_add_u32 v19, s5, v14
    v_cndmask_b32 v11, v11, v12, vcc
    v_cndmask_b32 v235, v235, v236, vcc
    v_mov_b32 v4, 0xff800000
    v_cndmask_b32 v116, 0, v4, s[60:61]
    v_mov_b32 v117, v116
    v_mov_b32 v118, v116
    v_mov_b32 v119, v116
    s_lshl_b32 s5, s78, 13
    v_add_u32 v246, s5, v14
    v_lshlrev_b32 v247, 9, v6
    v_lshl_add_u32 v247, v2, 4, v247
    s_lshl_b32 s5, s78, 8
    s_add_u32 s5, s5, 12288
    v_add_u32 v247, s5, v247
    v_and_b32 v4, 31, v1
    v_lshlrev_b32 v248, 4, v4
    s_lshl_b32 s5, s78, 9
    s_add_u32 s5, s5, 12288
    v_add_u32 v248, s5, v248
    s_lshl_b32 s5, s25, 16
    v_and_b32 v7, 1, v3
    v_lshlrev_b32 v237, 18, v7
    v_lshl_add_u32 v237, v6, 8, v237
    v_lshl_add_u32 v237, v2, 4, v237
    v_add_u32 v237, s5, v237
    s_lshl_b32 s6, s78, 9
    v_add_u32 v237, s6, v237
    s_lshl_b32 s6, s78, 8
    v_lshlrev_b32 v249, 9, v7
    v_lshl_add_u32 v249, v2, 4, v249
    v_add_u32 v249, s6, v249
    v_add_u32 v4, s25, v6
    v_add_u32 v4, 1, v4
    v_and_b32 v4, 3, v4
    v_lshl_add_u32 v239, v4, 16, v249
    s_add_u32 s6, s25, 3
    s_and_b32 s6, s6, 3
    s_lshl_b32 s6, s6, 16
    v_add_u32 v249, s6, v249
    v_and_b32 v4, 1, v5
    v_lshlrev_b32 v4, 4, v4
    v_mov_b32 v6, 0x3f80
    v_lshlrev_b32 v6, v4, v6
    v_lshrrev_b32 v4, 1, v5

    v_cmp_eq_u32 vcc, 0, v4
    s_nop 1
    v_cndmask_b32 v84, 0, v6, vcc
    v_cmp_eq_u32 vcc, 1, v4
    s_nop 1
    v_cndmask_b32 v85, 0, v6, vcc
    v_cmp_eq_u32 vcc, 2, v4
    s_nop 1
    v_cndmask_b32 v86, 0, v6, vcc
    v_cmp_eq_u32 vcc, 3, v4
    s_nop 1
    v_cndmask_b32 v87, 0, v6, vcc
    v_mov_b32 v120, 0x3f803f80
    v_cndmask_b32 v112, 0, v84, s[60:61]
    v_mov_b32 v121, 0x3f803f80
    v_cndmask_b32 v113, 0, v85, s[60:61]
    v_mov_b32 v122, 0x3f803f80
    v_cndmask_b32 v114, 0, v86, s[60:61]
    v_mov_b32 v123, 0x3f803f80
    v_cndmask_b32 v115, 0, v87, s[60:61]
    v_mov_b32 v170, 0
    v_mov_b32 v171, 0
    v_mov_b32 v174, 0
    v_mov_b32 v175, 0
    v_mov_b32 v182, 0
    v_mov_b32 v183, 0
    s_add_u32 s5, s96, 0
    s_and_b32 s5, s5, 3
    s_lshl_b32 s5, s5, 10
    s_add_u32 s5, s5, 20480
    v_add_u32 v228, s5, v14

    s_add_u32 s5, s96, 1
    s_and_b32 s5, s5, 3
    s_lshl_b32 s5, s5, 10
    s_add_u32 s5, s5, 20480
    v_add_u32 v229, s5, v14

    s_add_u32 s5, s96, 2
    s_and_b32 s5, s5, 3
    s_lshl_b32 s5, s5, 10
    s_add_u32 s5, s5, 20480
    v_add_u32 v230, s5, v14

    s_add_u32 s5, s96, 3
    s_and_b32 s5, s5, 3
    s_lshl_b32 s5, s5, 10
    s_add_u32 s5, s5, 20480
    v_add_u32 v231, s5, v14

    s_lshl_b32 s89, s7, 8
    s_add_u32 s89, s89, 92282880
    v_lshlrev_b32 v253, 13, v1
    s_lshl_b32 s4, s7, 13
    s_add_u32 s38, s4, 16777216
    s_lshl_b32 s5, s96, 11
    s_add_u32 s39, s4, s5
    s_add_u32 s30, s39, 17039360
    s_add_u32 s39, s39, 33554432
    s_lshl_b32 s5, s78, 24
    s_add_u32 s30, s30, s5
    s_lshl_b32 s5, s78, 12
    s_add_u32 s38, s38, s5
    s_add_u32 s90, s5, 20480
    s_lshl_b32 s5, s78, 10
    s_add_u32 s39, s39, s5
    s_add_u32 s91, s5, 28672
    s_mov_b32 s37, 0x3e0293ee
    s_mov_b32 s28, 0

    v_and_b32 v4, 31, v1
    v_lshlrev_b32 v225, 6, v4
    v_lshrrev_b32 v4, 5, v1
    v_lshl_add_u32 v225, v4, 24, v225

    v_mov_b32 v52, 0
    v_mov_b32 v53, 0
    v_mov_b32 v54, 0
    v_mov_b32 v55, 0
    v_mov_b32 v56, 0
    v_mov_b32 v57, 0
    v_mov_b32 v58, 0
    v_mov_b32 v59, 0
    v_mov_b32 v60, 0
    v_mov_b32 v61, 0
    v_mov_b32 v62, 0
    v_mov_b32 v63, 0
    v_mov_b32 v64, 0
    v_mov_b32 v65, 0
    v_mov_b32 v66, 0
    v_mov_b32 v67, 0
    v_mov_b32 v68, 0
    v_mov_b32 v69, 0
    v_mov_b32 v70, 0
    v_mov_b32 v71, 0
    v_mov_b32 v72, 0
    v_mov_b32 v73, 0
    v_mov_b32 v74, 0
    v_mov_b32 v75, 0
    v_mov_b32 v76, 0
    v_mov_b32 v77, 0
    v_mov_b32 v78, 0
    v_mov_b32 v79, 0
    v_mov_b32 v80, 0
    v_mov_b32 v81, 0
    v_mov_b32 v82, 0
    v_mov_b32 v83, 0
    v_mov_b32 v92, -1
    v_mov_b32 v93, -1
    v_mov_b32 v94, -1
    v_mov_b32 v95, -1
    v_mov_b32 v96, -1
    v_mov_b32 v97, -1
    v_mov_b32 v98, -1
    v_mov_b32 v99, -1
    v_mov_b32 v100, -1
    v_mov_b32 v101, -1
    v_mov_b32 v102, -1
    v_mov_b32 v103, -1
    v_mov_b32 v192, -1
    v_mov_b32 v193, -1
    v_mov_b32 v194, -1
    v_mov_b32 v195, -1
    v_mov_b32 v196, -1
    v_mov_b32 v197, -1
    v_mov_b32 v198, -1
    v_mov_b32 v199, -1
    v_mov_b32 v200, -1
    v_mov_b32 v201, -1
    v_mov_b32 v202, -1
    v_mov_b32 v203, -1
    v_mov_b32 v204, -1
    v_mov_b32 v205, -1
    v_mov_b32 v206, -1
    v_mov_b32 v207, -1
    v_mov_b32 v208, -1
    v_mov_b32 v209, -1
    v_mov_b32 v210, -1
    v_mov_b32 v211, -1
    v_mov_b32 v212, -1
    v_mov_b32 v213, -1
    v_mov_b32 v214, -1
    v_mov_b32 v215, -1
    v_mov_b32 v216, -1
    v_mov_b32 v217, -1
    v_mov_b32 v218, -1
    v_mov_b32 v219, -1
    v_mov_b32 v220, -1
    v_mov_b32 v221, -1
    v_mov_b32 v222, -1
    v_mov_b32 v223, -1
    s_bitcmp1_b32 s26, 0
    s_cbranch_scc1 .po_14
    s_waitcnt vmcnt(28)
    ds_read_b64_tr_b16 a[0:1], v252 offset:0
    ds_read_b64_tr_b16 a[2:3], v252 offset:128
    ds_read_b64_tr_b16 a[4:5], v252 offset:2048
    ds_read_b64_tr_b16 a[6:7], v252 offset:2176
    ds_read_b64_tr_b16 a[8:9], v252 offset:4096
    ds_read_b64_tr_b16 a[10:11], v252 offset:4224
    ds_read_b64_tr_b16 a[12:13], v252 offset:6144
    ds_read_b64_tr_b16 a[14:15], v252 offset:6272
    ds_read_b64_tr_b16 a[32:33], v252 offset:16
    ds_read_b64_tr_b16 a[34:35], v252 offset:144
    ds_read_b64_tr_b16 a[36:37], v252 offset:2064
    ds_read_b64_tr_b16 a[38:39], v252 offset:2192
    ds_read_b64_tr_b16 a[40:41], v252 offset:4112
    ds_read_b64_tr_b16 a[42:43], v252 offset:4240
    ds_read_b64_tr_b16 a[44:45], v252 offset:6160
    ds_read_b64_tr_b16 a[46:47], v252 offset:6288
    s_waitcnt lgkmcnt(0)
    s_mov_b32 s16, s48
    s_and_b32 s17, s49, 0xffff
    s_mov_b32 s18, 0x800000
    s_mov_b32 s19, 0x00020000

    s_add_u32 m0, s98, 0
    s_mov_b32 s5, 0
    buffer_load_dwordx4 v240, s[16:19], s5 offen  lds

    s_add_u32 m0, s98, 1024
    s_mov_b32 s5, 131072
    buffer_load_dwordx4 v240, s[16:19], s5 offen  lds

    s_add_u32 m0, s98, 2048
    s_mov_b32 s5, 262144
    buffer_load_dwordx4 v240, s[16:19], s5 offen  lds

    s_add_u32 m0, s98, 3072
    s_mov_b32 s5, 393216
    buffer_load_dwordx4 v240, s[16:19], s5 offen  lds

    s_add_u32 m0, s98, 4096
    s_mov_b32 s5, 524288
    buffer_load_dwordx4 v240, s[16:19], s5 offen  lds

    s_add_u32 m0, s98, 5120
    s_mov_b32 s5, 655360
    buffer_load_dwordx4 v240, s[16:19], s5 offen  lds

    s_add_u32 m0, s98, 6144
    s_mov_b32 s5, 786432
    buffer_load_dwordx4 v240, s[16:19], s5 offen  lds

    s_add_u32 m0, s98, 7168
    s_mov_b32 s5, 917504
    buffer_load_dwordx4 v240, s[16:19], s5 offen  lds

    s_waitcnt vmcnt(28)
    ds_read_b64_tr_b16 a[16:17], v252 offset:8192
    ds_read_b64_tr_b16 a[18:19], v252 offset:8320
    ds_read_b64_tr_b16 a[20:21], v252 offset:10240
    ds_read_b64_tr_b16 a[22:23], v252 offset:10368
    ds_read_b64_tr_b16 a[24:25], v252 offset:12288
    ds_read_b64_tr_b16 a[26:27], v252 offset:12416
    ds_read_b64_tr_b16 a[28:29], v252 offset:14336
    ds_read_b64_tr_b16 a[30:31], v252 offset:14464
    ds_read_b64_tr_b16 a[48:49], v252 offset:8208
    ds_read_b64_tr_b16 a[50:51], v252 offset:8336
    ds_read_b64_tr_b16 a[52:53], v252 offset:10256
    ds_read_b64_tr_b16 a[54:55], v252 offset:10384
    ds_read_b64_tr_b16 a[56:57], v252 offset:12304
    ds_read_b64_tr_b16 a[58:59], v252 offset:12432
    ds_read_b64_tr_b16 a[60:61], v252 offset:14352
    ds_read_b64_tr_b16 a[62:63], v252 offset:14480
    s_waitcnt lgkmcnt(0)
    s_add_u32 m0, s98, 8192
    s_mov_b32 s5, 1048576
    buffer_load_dwordx4 v240, s[16:19], s5 offen  lds

    s_add_u32 m0, s98, 9216
    s_mov_b32 s5, 1179648
    buffer_load_dwordx4 v240, s[16:19], s5 offen  lds

    s_add_u32 m0, s98, 10240
    s_mov_b32 s5, 1310720
    buffer_load_dwordx4 v240, s[16:19], s5 offen  lds

    s_add_u32 m0, s98, 11264
    s_mov_b32 s5, 1441792
    buffer_load_dwordx4 v240, s[16:19], s5 offen  lds

    s_add_u32 m0, s98, 12288
    s_mov_b32 s5, 1572864
    buffer_load_dwordx4 v240, s[16:19], s5 offen  lds

    s_add_u32 m0, s98, 13312
    s_mov_b32 s5, 1703936
    buffer_load_dwordx4 v240, s[16:19], s5 offen  lds

    s_add_u32 m0, s98, 14336
    s_mov_b32 s5, 1835008
    buffer_load_dwordx4 v240, s[16:19], s5 offen  lds

    s_add_u32 m0, s98, 15360
    s_mov_b32 s5, 1966080
    buffer_load_dwordx4 v240, s[16:19], s5 offen  lds

    s_waitcnt vmcnt(28)
    ds_read_b64_tr_b16 a[64:65], v252 offset:16384
    ds_read_b64_tr_b16 a[66:67], v252 offset:16512
    ds_read_b64_tr_b16 a[68:69], v252 offset:18432
    ds_read_b64_tr_b16 a[70:71], v252 offset:18560
    ds_read_b64_tr_b16 a[72:73], v252 offset:20480
    ds_read_b64_tr_b16 a[74:75], v252 offset:20608
    ds_read_b64_tr_b16 a[76:77], v252 offset:22528
    ds_read_b64_tr_b16 a[78:79], v252 offset:22656
    ds_read_b64_tr_b16 a[96:97], v252 offset:16400
    ds_read_b64_tr_b16 a[98:99], v252 offset:16528
    ds_read_b64_tr_b16 a[100:101], v252 offset:18448
    ds_read_b64_tr_b16 a[102:103], v252 offset:18576
    ds_read_b64_tr_b16 a[104:105], v252 offset:20496
    ds_read_b64_tr_b16 a[106:107], v252 offset:20624
    ds_read_b64_tr_b16 a[108:109], v252 offset:22544
    ds_read_b64_tr_b16 a[110:111], v252 offset:22672
    s_waitcnt lgkmcnt(0)
    s_mov_b32 s16, s50
    s_and_b32 s17, s51, 0xffff
    s_mov_b32 s18, 0x800000
    s_mov_b32 s19, 0x00020000

    s_add_u32 m0, s98, 16384
    s_mov_b32 s5, 0
    buffer_load_dwordx4 v241, s[16:19], s5 offen  lds

    s_add_u32 m0, s98, 17408
    s_mov_b32 s5, 32768
    buffer_load_dwordx4 v241, s[16:19], s5 offen  lds

    s_add_u32 m0, s98, 18432
    s_mov_b32 s5, 65536
    buffer_load_dwordx4 v241, s[16:19], s5 offen  lds

    s_add_u32 m0, s98, 19456
    s_mov_b32 s5, 98304
    buffer_load_dwordx4 v241, s[16:19], s5 offen  lds

    s_add_u32 m0, s98, 20480
    s_mov_b32 s5, 131072
    buffer_load_dwordx4 v241, s[16:19], s5 offen  lds

    s_add_u32 m0, s98, 21504
    s_mov_b32 s5, 163840
    buffer_load_dwordx4 v241, s[16:19], s5 offen  lds

    s_add_u32 m0, s98, 22528
    s_mov_b32 s5, 196608
    buffer_load_dwordx4 v241, s[16:19], s5 offen  lds

    s_add_u32 m0, s98, 23552
    s_mov_b32 s5, 229376
    buffer_load_dwordx4 v241, s[16:19], s5 offen  lds

    s_waitcnt vmcnt(28)
    ds_read_b64_tr_b16 a[80:81], v252 offset:24576
    ds_read_b64_tr_b16 a[82:83], v252 offset:24704
    ds_read_b64_tr_b16 a[84:85], v252 offset:26624
    ds_read_b64_tr_b16 a[86:87], v252 offset:26752
    ds_read_b64_tr_b16 a[88:89], v252 offset:28672
    ds_read_b64_tr_b16 a[90:91], v252 offset:28800
    ds_read_b64_tr_b16 a[92:93], v252 offset:30720
    ds_read_b64_tr_b16 a[94:95], v252 offset:30848
    ds_read_b64_tr_b16 a[112:113], v252 offset:24592
    ds_read_b64_tr_b16 a[114:115], v252 offset:24720
    ds_read_b64_tr_b16 a[116:117], v252 offset:26640
    ds_read_b64_tr_b16 a[118:119], v252 offset:26768
    ds_read_b64_tr_b16 a[120:121], v252 offset:28688
    ds_read_b64_tr_b16 a[122:123], v252 offset:28816
    ds_read_b64_tr_b16 a[124:125], v252 offset:30736
    ds_read_b64_tr_b16 a[126:127], v252 offset:30864
    s_waitcnt lgkmcnt(0)
    s_add_u32 m0, s98, 24576
    s_mov_b32 s5, 262144
    buffer_load_dwordx4 v241, s[16:19], s5 offen  lds

    s_add_u32 m0, s98, 25600
    s_mov_b32 s5, 294912
    buffer_load_dwordx4 v241, s[16:19], s5 offen  lds

    s_add_u32 m0, s98, 26624
    s_mov_b32 s5, 327680
    buffer_load_dwordx4 v241, s[16:19], s5 offen  lds

    s_add_u32 m0, s98, 27648
    s_mov_b32 s5, 360448
    buffer_load_dwordx4 v241, s[16:19], s5 offen  lds

    s_add_u32 m0, s98, 28672
    s_mov_b32 s5, 393216
    buffer_load_dwordx4 v241, s[16:19], s5 offen  lds

    s_add_u32 m0, s98, 29696
    s_mov_b32 s5, 425984
    buffer_load_dwordx4 v241, s[16:19], s5 offen  lds

    s_add_u32 m0, s98, 30720
    s_mov_b32 s5, 458752
    buffer_load_dwordx4 v241, s[16:19], s5 offen  lds

    s_add_u32 m0, s98, 31744
    s_mov_b32 s5, 491520
    buffer_load_dwordx4 v241, s[16:19], s5 offen  lds

    v_and_b32 v241, 3, v0
    v_lshlrev_b32 v241, 2, v241
    buffer_load_dword v240, v241, s[20:23], s97 offen sc1

    s_waitcnt vmcnt(25)
    ds_read_b64_tr_b16 a[128:129], v254 offset:0
    ds_read_b64_tr_b16 a[130:131], v254 offset:128
    ds_read_b64_tr_b16 a[132:133], v254 offset:2048
    ds_read_b64_tr_b16 a[134:135], v254 offset:2176
    ds_read_b64_tr_b16 a[136:137], v254 offset:4096
    ds_read_b64_tr_b16 a[138:139], v254 offset:4224
    ds_read_b64_tr_b16 a[140:141], v254 offset:6144
    ds_read_b64_tr_b16 a[142:143], v254 offset:6272
    ds_read_b64_tr_b16 a[160:161], v254 offset:32
    ds_read_b64_tr_b16 a[162:163], v254 offset:160
    ds_read_b64_tr_b16 a[164:165], v254 offset:2080
    ds_read_b64_tr_b16 a[166:167], v254 offset:2208
    ds_read_b64_tr_b16 a[168:169], v254 offset:4128
    ds_read_b64_tr_b16 a[170:171], v254 offset:4256
    ds_read_b64_tr_b16 a[172:173], v254 offset:6176
    ds_read_b64_tr_b16 a[174:175], v254 offset:6304
    s_waitcnt vmcnt(17)
    ds_read_b64_tr_b16 a[144:145], v254 offset:8192
    ds_read_b64_tr_b16 a[146:147], v254 offset:8320
    ds_read_b64_tr_b16 a[148:149], v254 offset:10240
    ds_read_b64_tr_b16 a[150:151], v254 offset:10368
    ds_read_b64_tr_b16 a[152:153], v254 offset:12288
    ds_read_b64_tr_b16 a[154:155], v254 offset:12416
    ds_read_b64_tr_b16 a[156:157], v254 offset:14336
    ds_read_b64_tr_b16 a[158:159], v254 offset:14464
    ds_read_b64_tr_b16 a[176:177], v254 offset:8224
    ds_read_b64_tr_b16 a[178:179], v254 offset:8352
    ds_read_b64_tr_b16 a[180:181], v254 offset:10272
    ds_read_b64_tr_b16 a[182:183], v254 offset:10400
    ds_read_b64_tr_b16 a[184:185], v254 offset:12320
    ds_read_b64_tr_b16 a[186:187], v254 offset:12448
    ds_read_b64_tr_b16 a[188:189], v254 offset:14368
    ds_read_b64_tr_b16 a[190:191], v254 offset:14496
    s_waitcnt vmcnt(9)
    ds_read_b64_tr_b16 a[192:193], v255 offset:16384
    ds_read_b64_tr_b16 a[194:195], v255 offset:16512
    ds_read_b64_tr_b16 a[196:197], v255 offset:18432
    ds_read_b64_tr_b16 a[198:199], v255 offset:18560
    ds_read_b64_tr_b16 a[200:201], v255 offset:20480
    ds_read_b64_tr_b16 a[202:203], v255 offset:20608
    ds_read_b64_tr_b16 a[204:205], v255 offset:22528
    ds_read_b64_tr_b16 a[206:207], v255 offset:22656
    ds_read_b64_tr_b16 a[224:225], v255 offset:16416
    ds_read_b64_tr_b16 a[226:227], v255 offset:16544
    ds_read_b64_tr_b16 a[228:229], v255 offset:18464
    ds_read_b64_tr_b16 a[230:231], v255 offset:18592
    ds_read_b64_tr_b16 a[232:233], v255 offset:20512
    ds_read_b64_tr_b16 a[234:235], v255 offset:20640
    ds_read_b64_tr_b16 a[236:237], v255 offset:22560
    ds_read_b64_tr_b16 a[238:239], v255 offset:22688
    s_waitcnt vmcnt(1)
    ds_read_b64_tr_b16 a[208:209], v255 offset:24576
    ds_read_b64_tr_b16 a[210:211], v255 offset:24704
    ds_read_b64_tr_b16 a[212:213], v255 offset:26624
    ds_read_b64_tr_b16 a[214:215], v255 offset:26752
    ds_read_b64_tr_b16 a[216:217], v255 offset:28672
    ds_read_b64_tr_b16 a[218:219], v255 offset:28800
    ds_read_b64_tr_b16 a[220:221], v255 offset:30720
    ds_read_b64_tr_b16 a[222:223], v255 offset:30848
    ds_read_b64_tr_b16 a[240:241], v255 offset:24608
    ds_read_b64_tr_b16 a[242:243], v255 offset:24736
    ds_read_b64_tr_b16 a[244:245], v255 offset:26656
    ds_read_b64_tr_b16 a[246:247], v255 offset:26784
    ds_read_b64_tr_b16 a[248:249], v255 offset:28704
    ds_read_b64_tr_b16 a[250:251], v255 offset:28832
    ds_read_b64_tr_b16 a[252:253], v255 offset:30752
    ds_read_b64_tr_b16 a[254:255], v255 offset:30880
    s_branch .pj_15
.po_14:
    s_waitcnt vmcnt(28)
    ds_read_b64_tr_b16 a[16:17], v252 offset:8192
    ds_read_b64_tr_b16 a[18:19], v252 offset:8320
    ds_read_b64_tr_b16 a[20:21], v252 offset:10240
    ds_read_b64_tr_b16 a[22:23], v252 offset:10368
    ds_read_b64_tr_b16 a[24:25], v252 offset:12288
    ds_read_b64_tr_b16 a[26:27], v252 offset:12416
    ds_read_b64_tr_b16 a[28:29], v252 offset:14336
    ds_read_b64_tr_b16 a[30:31], v252 offset:14464
    ds_read_b64_tr_b16 a[48:49], v252 offset:8208
    ds_read_b64_tr_b16 a[50:51], v252 offset:8336
    ds_read_b64_tr_b16 a[52:53], v252 offset:10256
    ds_read_b64_tr_b16 a[54:55], v252 offset:10384
    ds_read_b64_tr_b16 a[56:57], v252 offset:12304
    ds_read_b64_tr_b16 a[58:59], v252 offset:12432
    ds_read_b64_tr_b16 a[60:61], v252 offset:14352
    ds_read_b64_tr_b16 a[62:63], v252 offset:14480
    s_waitcnt lgkmcnt(0)
    s_mov_b32 s16, s48
    s_and_b32 s17, s49, 0xffff
    s_mov_b32 s18, 0x800000
    s_mov_b32 s19, 0x00020000

    s_add_u32 m0, s98, 8192
    s_mov_b32 s5, 1048576
    buffer_load_dwordx4 v240, s[16:19], s5 offen  lds

    s_add_u32 m0, s98, 9216
    s_mov_b32 s5, 1179648
    buffer_load_dwordx4 v240, s[16:19], s5 offen  lds

    s_add_u32 m0, s98, 10240
    s_mov_b32 s5, 1310720
    buffer_load_dwordx4 v240, s[16:19], s5 offen  lds

    s_add_u32 m0, s98, 11264
    s_mov_b32 s5, 1441792
    buffer_load_dwordx4 v240, s[16:19], s5 offen  lds

    s_add_u32 m0, s98, 12288
    s_mov_b32 s5, 1572864
    buffer_load_dwordx4 v240, s[16:19], s5 offen  lds

    s_add_u32 m0, s98, 13312
    s_mov_b32 s5, 1703936
    buffer_load_dwordx4 v240, s[16:19], s5 offen  lds

    s_add_u32 m0, s98, 14336
    s_mov_b32 s5, 1835008
    buffer_load_dwordx4 v240, s[16:19], s5 offen  lds

    s_add_u32 m0, s98, 15360
    s_mov_b32 s5, 1966080
    buffer_load_dwordx4 v240, s[16:19], s5 offen  lds

    s_waitcnt vmcnt(28)
    ds_read_b64_tr_b16 a[0:1], v252 offset:0
    ds_read_b64_tr_b16 a[2:3], v252 offset:128
    ds_read_b64_tr_b16 a[4:5], v252 offset:2048
    ds_read_b64_tr_b16 a[6:7], v252 offset:2176
    ds_read_b64_tr_b16 a[8:9], v252 offset:4096
    ds_read_b64_tr_b16 a[10:11], v252 offset:4224
    ds_read_b64_tr_b16 a[12:13], v252 offset:6144
    ds_read_b64_tr_b16 a[14:15], v252 offset:6272
    ds_read_b64_tr_b16 a[32:33], v252 offset:16
    ds_read_b64_tr_b16 a[34:35], v252 offset:144
    ds_read_b64_tr_b16 a[36:37], v252 offset:2064
    ds_read_b64_tr_b16 a[38:39], v252 offset:2192
    ds_read_b64_tr_b16 a[40:41], v252 offset:4112
    ds_read_b64_tr_b16 a[42:43], v252 offset:4240
    ds_read_b64_tr_b16 a[44:45], v252 offset:6160
    ds_read_b64_tr_b16 a[46:47], v252 offset:6288
    s_waitcnt lgkmcnt(0)
    s_add_u32 m0, s98, 0
    s_mov_b32 s5, 0
    buffer_load_dwordx4 v240, s[16:19], s5 offen  lds

    s_add_u32 m0, s98, 1024
    s_mov_b32 s5, 131072
    buffer_load_dwordx4 v240, s[16:19], s5 offen  lds

    s_add_u32 m0, s98, 2048
    s_mov_b32 s5, 262144
    buffer_load_dwordx4 v240, s[16:19], s5 offen  lds

    s_add_u32 m0, s98, 3072
    s_mov_b32 s5, 393216
    buffer_load_dwordx4 v240, s[16:19], s5 offen  lds

    s_add_u32 m0, s98, 4096
    s_mov_b32 s5, 524288
    buffer_load_dwordx4 v240, s[16:19], s5 offen  lds

    s_add_u32 m0, s98, 5120
    s_mov_b32 s5, 655360
    buffer_load_dwordx4 v240, s[16:19], s5 offen  lds

    s_add_u32 m0, s98, 6144
    s_mov_b32 s5, 786432
    buffer_load_dwordx4 v240, s[16:19], s5 offen  lds

    s_add_u32 m0, s98, 7168
    s_mov_b32 s5, 917504
    buffer_load_dwordx4 v240, s[16:19], s5 offen  lds

    s_waitcnt vmcnt(28)
    ds_read_b64_tr_b16 a[80:81], v252 offset:24576
    ds_read_b64_tr_b16 a[82:83], v252 offset:24704
    ds_read_b64_tr_b16 a[84:85], v252 offset:26624
    ds_read_b64_tr_b16 a[86:87], v252 offset:26752
    ds_read_b64_tr_b16 a[88:89], v252 offset:28672
    ds_read_b64_tr_b16 a[90:91], v252 offset:28800
    ds_read_b64_tr_b16 a[92:93], v252 offset:30720
    ds_read_b64_tr_b16 a[94:95], v252 offset:30848
    ds_read_b64_tr_b16 a[112:113], v252 offset:24592
    ds_read_b64_tr_b16 a[114:115], v252 offset:24720
    ds_read_b64_tr_b16 a[116:117], v252 offset:26640
    ds_read_b64_tr_b16 a[118:119], v252 offset:26768
    ds_read_b64_tr_b16 a[120:121], v252 offset:28688
    ds_read_b64_tr_b16 a[122:123], v252 offset:28816
    ds_read_b64_tr_b16 a[124:125], v252 offset:30736
    ds_read_b64_tr_b16 a[126:127], v252 offset:30864
    s_waitcnt lgkmcnt(0)
    s_mov_b32 s16, s50
    s_and_b32 s17, s51, 0xffff
    s_mov_b32 s18, 0x800000
    s_mov_b32 s19, 0x00020000

    s_add_u32 m0, s98, 24576
    s_mov_b32 s5, 262144
    buffer_load_dwordx4 v241, s[16:19], s5 offen  lds

    s_add_u32 m0, s98, 25600
    s_mov_b32 s5, 294912
    buffer_load_dwordx4 v241, s[16:19], s5 offen  lds

    s_add_u32 m0, s98, 26624
    s_mov_b32 s5, 327680
    buffer_load_dwordx4 v241, s[16:19], s5 offen  lds

    s_add_u32 m0, s98, 27648
    s_mov_b32 s5, 360448
    buffer_load_dwordx4 v241, s[16:19], s5 offen  lds

    s_add_u32 m0, s98, 28672
    s_mov_b32 s5, 393216
    buffer_load_dwordx4 v241, s[16:19], s5 offen  lds

    s_add_u32 m0, s98, 29696
    s_mov_b32 s5, 425984
    buffer_load_dwordx4 v241, s[16:19], s5 offen  lds

    s_add_u32 m0, s98, 30720
    s_mov_b32 s5, 458752
    buffer_load_dwordx4 v241, s[16:19], s5 offen  lds

    s_add_u32 m0, s98, 31744
    s_mov_b32 s5, 491520
    buffer_load_dwordx4 v241, s[16:19], s5 offen  lds

    s_waitcnt vmcnt(28)
    ds_read_b64_tr_b16 a[64:65], v252 offset:16384
    ds_read_b64_tr_b16 a[66:67], v252 offset:16512
    ds_read_b64_tr_b16 a[68:69], v252 offset:18432
    ds_read_b64_tr_b16 a[70:71], v252 offset:18560
    ds_read_b64_tr_b16 a[72:73], v252 offset:20480
    ds_read_b64_tr_b16 a[74:75], v252 offset:20608
    ds_read_b64_tr_b16 a[76:77], v252 offset:22528
    ds_read_b64_tr_b16 a[78:79], v252 offset:22656
    ds_read_b64_tr_b16 a[96:97], v252 offset:16400
    ds_read_b64_tr_b16 a[98:99], v252 offset:16528
    ds_read_b64_tr_b16 a[100:101], v252 offset:18448
    ds_read_b64_tr_b16 a[102:103], v252 offset:18576
    ds_read_b64_tr_b16 a[104:105], v252 offset:20496
    ds_read_b64_tr_b16 a[106:107], v252 offset:20624
    ds_read_b64_tr_b16 a[108:109], v252 offset:22544
    ds_read_b64_tr_b16 a[110:111], v252 offset:22672
    s_waitcnt lgkmcnt(0)
    s_add_u32 m0, s98, 16384
    s_mov_b32 s5, 0
    buffer_load_dwordx4 v241, s[16:19], s5 offen  lds

    s_add_u32 m0, s98, 17408
    s_mov_b32 s5, 32768
    buffer_load_dwordx4 v241, s[16:19], s5 offen  lds

    s_add_u32 m0, s98, 18432
    s_mov_b32 s5, 65536
    buffer_load_dwordx4 v241, s[16:19], s5 offen  lds

    s_add_u32 m0, s98, 19456
    s_mov_b32 s5, 98304
    buffer_load_dwordx4 v241, s[16:19], s5 offen  lds

    s_add_u32 m0, s98, 20480
    s_mov_b32 s5, 131072
    buffer_load_dwordx4 v241, s[16:19], s5 offen  lds

    s_add_u32 m0, s98, 21504
    s_mov_b32 s5, 163840
    buffer_load_dwordx4 v241, s[16:19], s5 offen  lds

    s_add_u32 m0, s98, 22528
    s_mov_b32 s5, 196608
    buffer_load_dwordx4 v241, s[16:19], s5 offen  lds

    s_add_u32 m0, s98, 23552
    s_mov_b32 s5, 229376
    buffer_load_dwordx4 v241, s[16:19], s5 offen  lds

    v_and_b32 v241, 3, v0
    v_lshlrev_b32 v241, 2, v241
    buffer_load_dword v240, v241, s[20:23], s97 offen sc1

    s_waitcnt vmcnt(25)
    ds_read_b64_tr_b16 a[144:145], v254 offset:8192
    ds_read_b64_tr_b16 a[146:147], v254 offset:8320
    ds_read_b64_tr_b16 a[148:149], v254 offset:10240
    ds_read_b64_tr_b16 a[150:151], v254 offset:10368
    ds_read_b64_tr_b16 a[152:153], v254 offset:12288
    ds_read_b64_tr_b16 a[154:155], v254 offset:12416
    ds_read_b64_tr_b16 a[156:157], v254 offset:14336
    ds_read_b64_tr_b16 a[158:159], v254 offset:14464
    ds_read_b64_tr_b16 a[176:177], v254 offset:8224
    ds_read_b64_tr_b16 a[178:179], v254 offset:8352
    ds_read_b64_tr_b16 a[180:181], v254 offset:10272
    ds_read_b64_tr_b16 a[182:183], v254 offset:10400
    ds_read_b64_tr_b16 a[184:185], v254 offset:12320
    ds_read_b64_tr_b16 a[186:187], v254 offset:12448
    ds_read_b64_tr_b16 a[188:189], v254 offset:14368
    ds_read_b64_tr_b16 a[190:191], v254 offset:14496
    s_waitcnt vmcnt(17)
    ds_read_b64_tr_b16 a[128:129], v254 offset:0
    ds_read_b64_tr_b16 a[130:131], v254 offset:128
    ds_read_b64_tr_b16 a[132:133], v254 offset:2048
    ds_read_b64_tr_b16 a[134:135], v254 offset:2176
    ds_read_b64_tr_b16 a[136:137], v254 offset:4096
    ds_read_b64_tr_b16 a[138:139], v254 offset:4224
    ds_read_b64_tr_b16 a[140:141], v254 offset:6144
    ds_read_b64_tr_b16 a[142:143], v254 offset:6272
    ds_read_b64_tr_b16 a[160:161], v254 offset:32
    ds_read_b64_tr_b16 a[162:163], v254 offset:160
    ds_read_b64_tr_b16 a[164:165], v254 offset:2080
    ds_read_b64_tr_b16 a[166:167], v254 offset:2208
    ds_read_b64_tr_b16 a[168:169], v254 offset:4128
    ds_read_b64_tr_b16 a[170:171], v254 offset:4256
    ds_read_b64_tr_b16 a[172:173], v254 offset:6176
    ds_read_b64_tr_b16 a[174:175], v254 offset:6304
    s_waitcnt vmcnt(9)
    ds_read_b64_tr_b16 a[208:209], v255 offset:24576
    ds_read_b64_tr_b16 a[210:211], v255 offset:24704
    ds_read_b64_tr_b16 a[212:213], v255 offset:26624
    ds_read_b64_tr_b16 a[214:215], v255 offset:26752
    ds_read_b64_tr_b16 a[216:217], v255 offset:28672
    ds_read_b64_tr_b16 a[218:219], v255 offset:28800
    ds_read_b64_tr_b16 a[220:221], v255 offset:30720
    ds_read_b64_tr_b16 a[222:223], v255 offset:30848
    ds_read_b64_tr_b16 a[240:241], v255 offset:24608
    ds_read_b64_tr_b16 a[242:243], v255 offset:24736
    ds_read_b64_tr_b16 a[244:245], v255 offset:26656
    ds_read_b64_tr_b16 a[246:247], v255 offset:26784
    ds_read_b64_tr_b16 a[248:249], v255 offset:28704
    ds_read_b64_tr_b16 a[250:251], v255 offset:28832
    ds_read_b64_tr_b16 a[252:253], v255 offset:30752
    ds_read_b64_tr_b16 a[254:255], v255 offset:30880
    s_waitcnt vmcnt(1)
    ds_read_b64_tr_b16 a[192:193], v255 offset:16384
    ds_read_b64_tr_b16 a[194:195], v255 offset:16512
    ds_read_b64_tr_b16 a[196:197], v255 offset:18432
    ds_read_b64_tr_b16 a[198:199], v255 offset:18560
    ds_read_b64_tr_b16 a[200:201], v255 offset:20480
    ds_read_b64_tr_b16 a[202:203], v255 offset:20608
    ds_read_b64_tr_b16 a[204:205], v255 offset:22528
    ds_read_b64_tr_b16 a[206:207], v255 offset:22656
    ds_read_b64_tr_b16 a[224:225], v255 offset:16416
    ds_read_b64_tr_b16 a[226:227], v255 offset:16544
    ds_read_b64_tr_b16 a[228:229], v255 offset:18464
    ds_read_b64_tr_b16 a[230:231], v255 offset:18592
    ds_read_b64_tr_b16 a[232:233], v255 offset:20512
    ds_read_b64_tr_b16 a[234:235], v255 offset:20640
    ds_read_b64_tr_b16 a[236:237], v255 offset:22560
    ds_read_b64_tr_b16 a[238:239], v255 offset:22688
.pj_15:
    v_min_u32 v20, 0xfffffffe, v20
    v_min_u32 v21, 0xfffffffe, v21
    v_min_u32 v22, 0xfffffffe, v22
    v_min_u32 v23, 0xfffffffe, v23
    v_min_u32 v24, 0xfffffffe, v24
    v_min_u32 v25, 0xfffffffe, v25
    v_min_u32 v26, 0xfffffffe, v26
    v_min_u32 v27, 0xfffffffe, v27
    v_min_u32 v28, 0xfffffffe, v28
    v_min_u32 v29, 0xfffffffe, v29
    v_min_u32 v30, 0xfffffffe, v30
    v_min_u32 v31, 0xfffffffe, v31
    v_min_u32 v32, 0xfffffffe, v32
    v_min_u32 v33, 0xfffffffe, v33
    v_min_u32 v34, 0xfffffffe, v34
    v_min_u32 v35, 0xfffffffe, v35
    s_barrier
    s_cmp_ge_u32 s24, 2
    s_cbranch_scc1 .px_16
    v_xor_b32 v255, 0x10000, v255
    ds_read_b64_tr_b16 v[124:125], v255 offset:16384
    ds_read_b64_tr_b16 v[126:127], v255 offset:16512
    ds_read_b64_tr_b16 v[128:129], v255 offset:18432
    ds_read_b64_tr_b16 v[130:131], v255 offset:18560
    ds_read_b64_tr_b16 v[132:133], v255 offset:20480
    ds_read_b64_tr_b16 v[134:135], v255 offset:20608
    ds_read_b64_tr_b16 v[136:137], v255 offset:22528
    ds_read_b64_tr_b16 v[138:139], v255 offset:22656
    ds_read_b64_tr_b16 v[156:157], v255 offset:16416
    ds_read_b64_tr_b16 v[158:159], v255 offset:16544
    ds_read_b64_tr_b16 v[160:161], v255 offset:18464
    ds_read_b64_tr_b16 v[162:163], v255 offset:18592
    ds_read_b64_tr_b16 v[164:165], v255 offset:20512
    ds_read_b64_tr_b16 v[166:167], v255 offset:20640
    ds_read_b64_tr_b16 v[168:169], v255 offset:22560
    ds_read_b64_tr_b16 v[170:171], v255 offset:22688
    ds_read_b64_tr_b16 v[140:141], v255 offset:24576
    ds_read_b64_tr_b16 v[142:143], v255 offset:24704
    ds_read_b64_tr_b16 v[144:145], v255 offset:26624
    ds_read_b64_tr_b16 v[146:147], v255 offset:26752
    ds_read_b64_tr_b16 v[148:149], v255 offset:28672
    ds_read_b64_tr_b16 v[150:151], v255 offset:28800
    ds_read_b64_tr_b16 v[152:153], v255 offset:30720
    ds_read_b64_tr_b16 v[154:155], v255 offset:30848
    ds_read_b64_tr_b16 v[172:173], v255 offset:24608
    ds_read_b64_tr_b16 v[174:175], v255 offset:24736
    ds_read_b64_tr_b16 v[176:177], v255 offset:26656
    ds_read_b64_tr_b16 v[178:179], v255 offset:26784
    ds_read_b64_tr_b16 v[180:181], v255 offset:28704
    ds_read_b64_tr_b16 v[182:183], v255 offset:28832
    ds_read_b64_tr_b16 v[184:185], v255 offset:30752
    ds_read_b64_tr_b16 v[186:187], v255 offset:30880
.px_16:
    s_waitcnt vmcnt(0)
    s_mov_b32 s62, 0
.vp_19:
    v_readlane_b32 s4, v240, 0
    v_readlane_b32 s7, v240, 1
    v_readlane_b32 s6, v240, 2

    s_lshr_b32 s5, s7, 21
    s_min_u32 s4, s4, s5
    s_cmp_ge_u32 s4, 256
    s_cbranch_scc1 .vd_20
    s_cmp_lg_u32 s6, 0
    s_cbranch_scc1 .vs_21
    s_add_u32 s62, s62, 1
    s_cmp_gt_u32 s62, 0x100000
    s_cbranch_scc1 .mg_end_1
    s_sleep 8
    buffer_load_dword v240, v241, s[20:23], s97 offen sc1
    s_waitcnt vmcnt(0)
    s_branch .vp_19

.vs_21:
    s_lshr_b32 s25, s2, 5
    s_and_b32 s26, s2, 31
    s_mov_b32 s27, 1
    s_mov_b32 s97, 144
    s_waitcnt vmcnt(0) lgkmcnt(0)
    s_barrier
    s_branch .mg_role_3

.vd_20:
    s_waitcnt lgkmcnt(0)
    s_barrier
    s_bfe_u32 s4, s7, 393216
    s_cmp_gt_u32 s4, 8
    s_cselect_b32 s4, 8192, 0
    s_add_u32 s4, s4, s35
    s_add_u32 s68, s4, 0

    s_bfe_u32 s4, s7, 393216
    s_cmp_gt_u32 s4, 8
    s_cselect_b32 s4, 8192, 0
    s_add_u32 s4, s4, s35
    s_add_u32 s69, s4, 1048576

    s_bfe_u32 s4, s7, 393222
    s_cmp_gt_u32 s4, 8
    s_cselect_b32 s4, 8192, 0
    s_add_u32 s4, s4, s35
    s_add_u32 s70, s4, 2097152

    s_bfe_u32 s4, s7, 393222
    s_cmp_gt_u32 s4, 8
    s_cselect_b32 s4, 8192, 0
    s_add_u32 s4, s4, s35
    s_add_u32 s71, s4, 3145728

    s_mov_b32 s62, 0x1000000
    s_cmp_ge_u32 s24, 2
    s_cbranch_scc1 .nd_22
    s_mov_b32 s62, 0
    s_mov_b64 exec, 3
.wf_23:
    buffer_load_dword v244, v253, s[8:11], s89 offen sc1
    s_waitcnt vmcnt(0)
    v_cmp_gt_u32 vcc, 1, v244
    s_cbranch_vccz .wfd_24
    s_sleep 2
    s_add_u32 s62, s62, 1
    s_cmp_gt_u32 s62, 0x400000
    s_cbranch_scc1 .mg_end_1
    s_branch .wf_23

.wfd_24:
    s_mov_b64 exec, -1
    v_readlane_b32 s4, v244, 0
    v_readlane_b32 s93, v244, 1
    s_min_u32 s93, s93, s4
    s_mov_b32 s62, 0x1000000
    s_mov_b32 m0, s90
    s_nop 0
    buffer_load_dwordx4 v14, s[8:11], s38 offen offset:0 lds
    buffer_load_dwordx4 v14, s[8:11], s38 offen offset:1024 lds
    buffer_load_dwordx4 v14, s[8:11], s38 offen offset:2048 lds
    buffer_load_dwordx4 v14, s[8:11], s38 offen offset:3072 lds
    s_mov_b32 m0, s91
    s_nop 0
    buffer_load_dwordx4 v14, s[8:11], s39 offen lds
    s_waitcnt vmcnt(0)
.nd_22:
    s_add_u32 s38, s38, 262144
    s_add_u32 s39, s39, 262144
    s_and_b32 s4, s28, 3
    s_lshl_b32 s5, s4, 16
    s_add_u32 s29, s5, s34
    s_xor_b32 s6, s5, 0x20000
    s_add_u32 s31, s6, s34
    s_add_u32 s32, s29, 16384
    s_add_u32 s33, s29, 20480
    s_barrier
    s_cmp_lt_u32 s24, 2
    s_cbranch_scc1 .k0_27
    ds_read_b128 v[128:131], v228 offset:0
    ds_read_b128 v[144:147], v228 offset:4096
    ds_read_b128 v[132:135], v229 offset:0
    ds_read_b128 v[148:151], v229 offset:4096
    ds_read_b128 v[136:139], v230 offset:0
    ds_read_b128 v[152:155], v230 offset:4096
    ds_read_b128 v[140:143], v231 offset:0
    ds_read_b128 v[156:159], v231 offset:4096
    ds_read_b128 v[160:163], v14 offset:28672
    ds_read_b128 v[164:167], v14 offset:29696
.k0_27:
    s_cmp_lg_u32 s27, 0
    s_cbranch_scc1 .ent1_26
    s_branch .ent0_25
.p2align 6
.top_28:
    s_barrier
    buffer_load_dwordx4 v[20:23], v8, s[8:11], s29 offen offset:0 sc1
    v_mov_b32 v52, 0
    buffer_load_dwordx4 v[24:27], v8, s[8:11], s29 offen offset:1024 sc1
    v_mov_b32 v53, 0
    buffer_load_dwordx4 v[28:31], v8, s[8:11], s29 offen offset:2048 sc1
    v_mov_b32 v54, 0
    buffer_load_dwordx4 v[32:35], v8, s[8:11], s29 offen offset:3072 sc1
.ent0_25:
    s_waitcnt vmcnt(3)
    v_max3_u32 v4, v20, v21, v22
    v_max_u32 v4, v4, v23
    v_cmp_eq_u32 vcc, -1, v4
    s_cbranch_vccnz .A_33
.W_34:
    v_smfmac_f32_16x16x64_bf16 v[52:55], v[20:23], a[0:7], v9
    v_smfmac_f32_16x16x64_bf16 v[56:59], v[20:23], a[32:39], v9
    s_waitcnt vmcnt(2)
    v_max3_u32 v4, v24, v25, v26
    v_max_u32 v4, v4, v27
    v_smfmac_f32_16x16x64_bf16 v[60:63], v[20:23], a[64:71], v9
    v_cmp_eq_u32 vcc, -1, v4
    v_smfmac_f32_16x16x64_bf16 v[64:67], v[20:23], a[96:103], v9
    s_cbranch_vccnz .A_35
.W_36:
    v_smfmac_f32_16x16x64_bf16 v[52:55], v[24:27], a[8:15], v9
    v_smfmac_f32_16x16x64_bf16 v[56:59], v[24:27], a[40:47], v9
    s_waitcnt vmcnt(1)
    v_max3_u32 v4, v28, v29, v30
    v_max_u32 v4, v4, v31
    v_smfmac_f32_16x16x64_bf16 v[60:63], v[24:27], a[72:79], v9
    v_cmp_eq_u32 vcc, -1, v4
    v_smfmac_f32_16x16x64_bf16 v[64:67], v[24:27], a[104:111], v9
    s_cbranch_vccnz .A_37
.W_38:
    v_smfmac_f32_16x16x64_bf16 v[52:55], v[28:31], a[16:23], v9
    v_smfmac_f32_16x16x64_bf16 v[56:59], v[28:31], a[48:55], v9
    s_waitcnt vmcnt(0)
    v_max3_u32 v4, v32, v33, v34
    v_max_u32 v4, v4, v35
    v_smfmac_f32_16x16x64_bf16 v[60:63], v[28:31], a[80:87], v9
    v_cmp_eq_u32 vcc, -1, v4
    v_smfmac_f32_16x16x64_bf16 v[64:67], v[28:31], a[112:119], v9
    s_cbranch_vccnz .A_39
.W_40:
    v_smfmac_f32_16x16x64_bf16 v[52:55], v[32:35], a[24:31], v9
    v_smfmac_f32_16x16x64_bf16 v[56:59], v[32:35], a[56:63], v9
    v_smfmac_f32_16x16x64_bf16 v[60:63], v[32:35], a[88:95], v9
    v_smfmac_f32_16x16x64_bf16 v[64:67], v[32:35], a[120:127], v9
.mj_32:
    v_cvt_pk_bf16_f32 v104, v52, v53
    v_cvt_pk_bf16_f32 v105, v54, v55
    v_cvt_pk_bf16_f32 v106, v56, v57
    v_cvt_pk_bf16_f32 v107, v58, v59
    ds_write_b64 v16, v[104:105] offset:4096
    v_cvt_pk_bf16_f32 v108, v60, v61
    v_cvt_pk_bf16_f32 v109, v62, v63
    ds_write_b64 v16, v[106:107] offset:6144
    ds_write_b64 v16, v[108:109] offset:0
    v_cvt_pk_bf16_f32 v110, v64, v65
    v_cvt_pk_bf16_f32 v111, v66, v67
    ds_write_b64 v16, v[110:111] offset:2048
    v_smfmac_f32_16x16x64_bf16 v[68:71], v[20:23], a[128:135], v9
    v_smfmac_f32_16x16x64_bf16 v[72:75], v[20:23], a[160:167], v9
    s_waitcnt lgkmcnt(0)
    s_barrier
    ds_read_b128 v[36:39], v17 offset:0
    ds_read_b128 v[40:43], v17 offset:1024
    v_smfmac_f32_16x16x64_bf16 v[68:71], v[24:27], a[136:143], v9
    v_smfmac_f32_16x16x64_bf16 v[72:75], v[24:27], a[168:175], v9
    s_waitcnt lgkmcnt(1)
    v_mfma_f32_16x16x32_bf16 v[44:47], v[36:39], v[84:87], 0
    s_waitcnt lgkmcnt(0)
    v_mfma_f32_16x16x32_bf16 v[44:47], v[40:43], v[84:87], v[44:47]
    v_smfmac_f32_16x16x64_bf16 v[68:71], v[28:31], a[144:151], v9
    v_smfmac_f32_16x16x64_bf16 v[72:75], v[28:31], a[176:183], v9
    s_mov_b64 exec, s[64:65]
    v_cvt_pk_bf16_f32 v48, v44, v45
    v_cvt_pk_bf16_f32 v49, v46, v47
    v_min_u32 v48, 0xfffffffe, v48
    v_min_u32 v49, 0xfffffffe, v49
    buffer_store_dwordx2 v[48:49], v10, s[8:11], s29 offen

    ds_write_b64 v18, v[48:49]
    s_mov_b64 exec, -1

    v_smfmac_f32_16x16x64_bf16 v[68:71], v[32:35], a[152:159], v9
    v_smfmac_f32_16x16x64_bf16 v[72:75], v[32:35], a[184:191], v9
    s_nop 3
    v_cvt_pk_bf16_f32 v104, v68, v69
    v_cvt_pk_bf16_f32 v105, v70, v71
    ds_write_b64 v16, v[104:105] offset:8192
    s_nop 0
    v_cvt_pk_bf16_f32 v106, v72, v73
    v_cvt_pk_bf16_f32 v107, v74, v75
    ds_write_b64 v16, v[106:107] offset:10240
    s_cmp_lg_u32 s24, 2
    s_waitcnt lgkmcnt(0)
    s_barrier
    s_cbranch_scc1 .oth_29
    buffer_load_dwordx4 v[92:95], v232, s[8:11], s29 offen sc1
    buffer_load_dwordx4 v[96:99], v233, s[8:11], s29 offen sc1
    buffer_load_dwordx4 v[100:103], v234, s[8:11], s29 offen sc1
    ds_read_b128 v[88:91], v14 offset:16384
    s_cmp_eq_u32 s28, 63
    s_cbranch_scc1 .rec_fin_6
    s_waitcnt lgkmcnt(0)
    v_mfma_f32_16x16x32_bf16 v[208:211], v[128:131], v[88:91], 0
    v_mfma_f32_16x16x32_bf16 v[212:215], v[144:147], v[88:91], 0
    v_mfma_f32_16x16x32_bf16 v[216:219], v[88:91], v[88:91], v[116:119]
    s_waitcnt vmcnt(2)
    v_max3_u32 v4, v92, v93, v94
    v_max_u32 v4, v4, v95
    v_cmp_eq_u32 vcc, -1, v4
    s_cbranch_vccnz .A_42
.W_43:
    v_mfma_f32_16x16x32_bf16 v[208:211], v[132:135], v[92:95], v[208:211]
    s_waitcnt vmcnt(1)
    v_max3_u32 v4, v96, v97, v98
    v_max_u32 v4, v4, v99
    v_mfma_f32_16x16x32_bf16 v[212:215], v[148:151], v[92:95], v[212:215]
    v_cmp_eq_u32 vcc, -1, v4
    v_mfma_f32_16x16x32_bf16 v[216:219], v[92:95], v[92:95], v[216:219]
    s_cbranch_vccnz .A_44
.W_45:
    v_mfma_f32_16x16x32_bf16 v[208:211], v[136:139], v[96:99], v[208:211]
    s_waitcnt vmcnt(0)
    v_max3_u32 v4, v100, v101, v102
    v_max_u32 v4, v4, v103
    v_mfma_f32_16x16x32_bf16 v[212:215], v[152:155], v[96:99], v[212:215]
    v_cmp_eq_u32 vcc, -1, v4
    v_mfma_f32_16x16x32_bf16 v[216:219], v[96:99], v[96:99], v[216:219]
    s_cbranch_vccnz .A_46
.W_47:
    v_mfma_f32_16x16x32_bf16 v[208:211], v[140:143], v[100:103], v[208:211]
    v_mfma_f32_16x16x32_bf16 v[212:215], v[156:159], v[100:103], v[212:215]
    v_mfma_f32_16x16x32_bf16 v[216:219], v[100:103], v[100:103], v[216:219]
.mj_41:
    s_barrier
    ds_read_b64 v[168:169], v14 offset:18432
    ds_read_b64 v[172:173], v14 offset:18440
    s_nop 0

    v_mov_b32_dpp v208, v212 row_ror:8 row_mask:0xf bank_mask:0xc
    v_mov_b32_dpp v209, v213 row_ror:8 row_mask:0xf bank_mask:0xc
    v_mov_b32_dpp v210, v214 row_ror:8 row_mask:0xf bank_mask:0xc
    v_mov_b32_dpp v211, v215 row_ror:8 row_mask:0xf bank_mask:0xc
    v_mov_b32_dpp v216, v218 row_ror:8 row_mask:0xf bank_mask:0xc
    v_mov_b32_dpp v217, v219 row_ror:8 row_mask:0xf bank_mask:0xc
    v_max3_f32 v4, v208, v209, v210
    v_max3_f32 v5, v211, v216, v217
    v_max_f32 v6, v4, v5
    v_max_f32 v4, v4, v5
    s_nop 1
    v_permlane32_swap_b32 v4, v6
    v_max_f32 v5, v4, v6
    v_max_f32 v4, v4, v6
    s_nop 1
    v_permlane16_swap_b32 v4, v5
    v_max_f32 v4, v4, v5
    s_nop 1
    v_max_f32_dpp v4, v4, v4 row_ror:8 row_mask:0xf bank_mask:0xf
    v_mul_f32 v4, s37, v4

    v_fma_f32 v104, v208, s37, -v4
    v_fma_f32 v105, v209, s37, -v4
    v_fma_f32 v106, v210, s37, -v4
    v_fma_f32 v107, v211, s37, -v4
    v_fma_f32 v108, v216, s37, -v4
    v_fma_f32 v109, v217, s37, -v4
    v_exp_f32 v104, v104
    v_exp_f32 v105, v105
    v_exp_f32 v106, v106
    v_exp_f32 v107, v107
    v_exp_f32 v108, v108
    v_exp_f32 v109, v109
    v_cvt_pk_bf16_f32 v176, v104, v105
    v_cvt_pk_bf16_f32 v177, v106, v107
    v_cvt_pk_bf16_f32 v180, v108, v109
    v_mov_b32_dpp v178, v176 row_ror:8 row_mask:0xf bank_mask:0xf
    v_mov_b32_dpp v179, v177 row_ror:8 row_mask:0xf bank_mask:0xf
    v_mov_b32_dpp v181, v180 row_ror:8 row_mask:0xf bank_mask:0xf
    s_waitcnt lgkmcnt(0)

    v_mfma_f32_16x16x32_bf16 v[208:211], v[120:123], v[176:179], 0
    v_mfma_f32_16x16x32_bf16 v[208:211], v[120:123], v[180:183], v[208:211]
    v_mfma_f32_16x16x32_bf16 v[212:215], v[160:163], v[176:179], 0
    v_mfma_f32_16x16x32_bf16 v[216:219], v[164:167], v[176:179], 0
    v_mfma_f32_16x16x32_bf16 v[212:215], v[168:171], v[180:183], v[212:215]
    v_rcp_f32 v4, v208
    v_mfma_f32_16x16x32_bf16 v[216:219], v[172:175], v[180:183], v[216:219]
    s_mov_b64 exec, s[58:59]
    s_nop 2
    v_mul_f32 v212, v4, v212
    v_mul_f32 v213, v4, v213
    v_mul_f32 v214, v4, v214
    v_mul_f32 v215, v4, v215
    v_cvt_pk_bf16_f32 v184, v212, v213
    v_cvt_pk_bf16_f32 v185, v214, v215
    v_mul_f32 v216, v4, v216
    v_mul_f32 v217, v4, v217
    v_min_u32 v184, 0xfffffffe, v184
    v_min_u32 v185, 0xfffffffe, v185
    v_mul_f32 v218, v4, v218
    v_mul_f32 v219, v4, v219
    v_cvt_pk_bf16_f32 v186, v216, v217
    v_cvt_pk_bf16_f32 v187, v218, v219
    v_min_u32 v186, 0xfffffffe, v186
    v_min_u32 v187, 0xfffffffe, v187
    buffer_store_dwordx4 v[184:187], v13, s[8:11], s29 offen
    s_mov_b64 exec, -1

.gp_31:
    s_barrier
    s_mov_b32 s99, s68
    s_add_u32 s28, s28, 1
    s_add_u32 s36, s36, 196608
    s_cmp_lt_u32 s28, 63
    s_cselect_b32 s4, 262144, 0
    s_add_u32 s38, s38, s4
    s_add_u32 s39, s39, s4
    s_add_u32 s30, s30, s4
    s_mov_b32 s4, s68
    s_mov_b32 s68, s69
    s_mov_b32 s69, s70
    s_mov_b32 s70, s71
    s_mov_b32 s71, s4
    s_and_b32 s4, s28, 3
    s_lshl_b32 s5, s4, 16
    s_add_u32 s29, s5, s34
    s_xor_b32 s6, s5, 0x20000
    s_add_u32 s31, s6, s34
    s_add_u32 s32, s29, 16384
    s_add_u32 s33, s29, 20480
    s_waitcnt vmcnt(0)
    s_cmp_eq_u32 s24, 3
    s_cbranch_scc1 .u3_48
    s_barrier
    buffer_load_dword v226, v225, s[8:11], s30 offen
    s_add_u32 s4, s69, 0
    buffer_store_dwordx4 v[188:191], v238, s[8:11], s4 offen sc1
    s_add_u32 s4, s69, 262144
    buffer_store_dwordx4 v[188:191], v238, s[8:11], s4 offen sc1
    s_branch .u4_49
.u3_48:
    s_sub_u32 s4, s36, 196608
    s_barrier
    s_mov_b64 exec, s[66:67]
    buffer_store_dwordx4 v[88:91], v11, s[8:11], s4 offen sc1
    s_mov_b64 exec, s[56:57]
    buffer_store_dwordx4 v[172:175], v12, s[8:11], s4 offen sc1
    s_mov_b64 exec, -1

.u4_49:
    s_barrier
    ds_read_b128 v[108:111], v248
    ds_read_b128 v[128:131], v228 offset:0
    ds_read_b128 v[144:147], v228 offset:4096
    ds_read_b128 v[132:135], v229 offset:0
    ds_read_b128 v[148:151], v229 offset:4096
    ds_read_b128 v[136:139], v230 offset:0
    ds_read_b128 v[152:155], v230 offset:4096
    ds_read_b128 v[140:143], v231 offset:0
    ds_read_b128 v[156:159], v231 offset:4096
    ds_read_b128 v[160:163], v14 offset:28672
    ds_read_b128 v[164:167], v14 offset:29696
    v_mov_b32 v55, 0
    v_mov_b32 v56, 0
    v_mov_b32 v57, 0
    v_mov_b32 v58, 0
    v_mov_b32 v59, 0
    v_mov_b32 v60, 0
    v_mov_b32 v61, 0
    v_mov_b32 v62, 0
    v_mov_b32 v63, 0
    v_mov_b32 v64, 0
    v_mov_b32 v65, 0
    v_mov_b32 v66, 0
    v_mov_b32 v67, 0
    v_mov_b32 v68, 0
    v_mov_b32 v69, 0
    v_mov_b32 v70, 0
    v_mov_b32 v71, 0
    v_mov_b32 v72, 0
    v_mov_b32 v73, 0
    v_mov_b32 v74, 0
    v_mov_b32 v75, 0
    v_mov_b32 v20, -1
    v_mov_b32 v21, -1
    v_mov_b32 v22, -1
    v_mov_b32 v23, -1
    v_mov_b32 v24, -1
    v_mov_b32 v25, -1
    v_mov_b32 v26, -1
    v_mov_b32 v27, -1
    v_mov_b32 v28, -1
    s_add_u32 s4, s99, 0
    buffer_load_dwordx4 v[192:195], v239, s[8:11], s4 offen sc1
    buffer_load_dwordx4 v[196:199], v249, s[8:11], s4 offen sc1

    v_mov_b32 v29, -1
    v_mov_b32 v30, -1
    v_mov_b32 v31, -1
    v_mov_b32 v32, -1
    v_mov_b32 v33, -1
    v_mov_b32 v34, -1
    v_mov_b32 v35, -1
    v_mov_b32 v92, -1
    v_mov_b32 v93, -1
    v_mov_b32 v94, -1
    v_mov_b32 v95, -1
    v_mov_b32 v96, -1
    v_mov_b32 v97, -1
    v_mov_b32 v98, -1
    v_mov_b32 v99, -1
    v_mov_b32 v100, -1
    v_mov_b32 v101, -1
    v_mov_b32 v102, -1
    v_mov_b32 v103, -1
    s_add_u32 s4, s99, 262144
    buffer_load_dwordx4 v[200:203], v239, s[8:11], s4 offen sc1
    buffer_load_dwordx4 v[204:207], v249, s[8:11], s4 offen sc1

    s_waitcnt lgkmcnt(0)
    v_mfma_f32_16x16x32_bf16 v[76:79], v[108:111], v[112:115], 0
.gc_50:
    s_waitcnt vmcnt(2)

    v_max_u32 v4, v192, v196
    v_cmp_eq_u32 vcc, -1, v4
    s_cbranch_vccnz .gf_51
    v_mfma_f32_16x16x32_bf16 v[76:79], v[192:195], v[84:87], v[76:79]
    v_mfma_f32_16x16x32_bf16 v[76:79], v[196:199], v[112:115], v[76:79]
    s_mov_b64 exec, s[58:59]
    s_nop 6
    v_cvt_pk_bf16_f32 v104, v76, v77
    v_cvt_pk_bf16_f32 v105, v78, v79
    v_min_u32 v104, 0xfffffffe, v104
    v_min_u32 v105, 0xfffffffe, v105
    buffer_store_dwordx2 v[104:105], v15, s[8:11], s29 offen
    s_mov_b64 exec, -1

    s_branch .top_28
.gf_51:
    s_add_u32 s4, s99, 0
    buffer_load_dwordx4 v[192:195], v239, s[8:11], s4 offen sc1
    buffer_load_dwordx4 v[196:199], v249, s[8:11], s4 offen sc1

    s_waitcnt vmcnt(2)

    v_max_u32 v4, v200, v204
    v_cmp_eq_u32 vcc, -1, v4
    s_cbranch_vccnz .gf_52
    v_mfma_f32_16x16x32_bf16 v[76:79], v[200:203], v[84:87], v[76:79]
    v_mfma_f32_16x16x32_bf16 v[76:79], v[204:207], v[112:115], v[76:79]
    s_mov_b64 exec, s[58:59]
    s_nop 6
    v_cvt_pk_bf16_f32 v104, v76, v77
    v_cvt_pk_bf16_f32 v105, v78, v79
    v_min_u32 v104, 0xfffffffe, v104
    v_min_u32 v105, 0xfffffffe, v105
    buffer_store_dwordx2 v[104:105], v15, s[8:11], s29 offen
    s_mov_b64 exec, -1

    s_branch .top_28
.gf_52:
    s_add_u32 s4, s99, 262144
    buffer_load_dwordx4 v[200:203], v239, s[8:11], s4 offen sc1
    buffer_load_dwordx4 v[204:207], v249, s[8:11], s4 offen sc1

    s_sub_u32 s62, s62, 1
    s_cbranch_scc1 .mg_end_1
    s_branch .gc_50
.oth_29:
    s_cmp_eq_u32 s24, 3
    s_cbranch_scc1 .w3_30
    s_cmp_eq_u32 s28, 63
    s_cbranch_scc1 .rec_fin_6
    s_waitcnt vmcnt(0)
    v_readlane_b32 s4, v244, 0
    v_readlane_b32 s93, v244, 1
    s_min_u32 s93, s93, s4
    v_mov_b32 v20, -1
    v_mov_b32 v21, -1
    v_mov_b32 v22, -1
    v_mov_b32 v23, -1
    v_mov_b32 v24, -1
    v_mov_b32 v25, -1
    v_mov_b32 v26, -1
    v_mov_b32 v27, -1
    v_mov_b32 v28, -1
    v_mov_b32 v29, -1
    v_mov_b32 v30, -1
    v_mov_b32 v31, -1
    v_mov_b32 v32, -1
    v_mov_b32 v33, -1
    v_mov_b32 v34, -1
    v_mov_b32 v35, -1
    v_mov_b32 v55, 0
    v_mov_b32 v56, 0
    v_mov_b32 v57, 0
    v_mov_b32 v58, 0
    v_mov_b32 v59, 0
    v_mov_b32 v60, 0
    v_mov_b32 v61, 0
    v_mov_b32 v62, 0
    v_mov_b32 v63, 0
    v_mov_b32 v64, 0
    v_mov_b32 v65, 0
    v_mov_b32 v66, 0
    v_mov_b32 v67, 0
    v_mov_b32 v68, 0
    v_mov_b32 v69, 0
    v_mov_b32 v70, 0
    v_mov_b32 v71, 0
    v_mov_b32 v72, 0
    v_mov_b32 v73, 0
    v_mov_b32 v74, 0
    v_mov_b32 v75, 0
    s_barrier
    s_add_u32 s6, s28, 3
    s_min_u32 s6, s6, 64
    s_cmp_lt_u32 s93, s6
    s_cbranch_scc1 .kf_53
.kb_54:
    s_mov_b32 m0, s90
    s_nop 0
    buffer_load_dwordx4 v14, s[8:11], s38 offen offset:0 lds
    buffer_load_dwordx4 v14, s[8:11], s38 offen offset:1024 lds
    buffer_load_dwordx4 v14, s[8:11], s38 offen offset:2048 lds
    buffer_load_dwordx4 v14, s[8:11], s38 offen offset:3072 lds
    s_mov_b32 m0, s91
    s_nop 0
    buffer_load_dwordx4 v14, s[8:11], s39 offen lds
    s_bfe_u32 s12, s28, 0x10001
    s_add_u32 s6, s28, 6
    s_cmp_ge_u32 s93, s6
    s_cbranch_scc1 .nl_55
    s_mov_b64 exec, 3
    buffer_load_dword v244, v253, s[8:11], s89 offen sc1
    s_mov_b64 exec, -1

.nl_55:
    s_waitcnt lgkmcnt(0)
    s_barrier
    buffer_load_dwordx4 v[192:195], v246, s[8:11], s32 offen offset:0 sc1
    buffer_load_dwordx4 v[196:199], v246, s[8:11], s32 offen offset:1024 sc1
    v_mov_b32 v76, 0
    buffer_load_dwordx4 v[200:203], v246, s[8:11], s32 offen offset:2048 sc1
    buffer_load_dwordx4 v[204:207], v246, s[8:11], s32 offen offset:3072 sc1
    v_mov_b32 v77, 0
    buffer_load_dwordx4 v[208:211], v246, s[8:11], s33 offen offset:0 sc1
    buffer_load_dwordx4 v[212:215], v246, s[8:11], s33 offen offset:1024 sc1
    v_mov_b32 v78, 0
    buffer_load_dwordx4 v[216:219], v246, s[8:11], s33 offen offset:2048 sc1
    buffer_load_dwordx4 v[220:223], v246, s[8:11], s33 offen offset:3072 sc1
    s_waitcnt vmcnt(6)
    v_max3_u32 v4, v192, v193, v194
    v_max3_u32 v5, v195, v196, v197
    v_max3_u32 v4, v4, v198, v199
    v_max_u32 v4, v4, v5
    v_cmp_eq_u32 vcc, -1, v4
    s_cbranch_vccnz .A_57
.W_58:
    v_smfmac_f32_16x16x64_bf16 v[76:79], v[192:195], a[192:199], v9
    v_smfmac_f32_16x16x64_bf16 v[80:83], v[192:195], a[224:231], v9
    s_waitcnt vmcnt(4)
    v_max3_u32 v4, v200, v201, v202
    v_max3_u32 v5, v203, v204, v205
    v_max3_u32 v4, v4, v206, v207
    v_smfmac_f32_16x16x64_bf16 v[76:79], v[196:199], a[200:207], v9
    v_max_u32 v4, v4, v5
    v_cmp_eq_u32 vcc, -1, v4
    v_smfmac_f32_16x16x64_bf16 v[80:83], v[196:199], a[232:239], v9
    s_cbranch_vccnz .A_59
.W_60:
    v_smfmac_f32_16x16x64_bf16 v[76:79], v[200:203], a[208:215], v9
    v_smfmac_f32_16x16x64_bf16 v[80:83], v[200:203], a[240:247], v9
    s_waitcnt vmcnt(2)
    v_max3_u32 v4, v208, v209, v210
    v_max3_u32 v5, v211, v212, v213
    v_max3_u32 v4, v4, v214, v215
    v_smfmac_f32_16x16x64_bf16 v[76:79], v[204:207], a[216:223], v9
    v_max_u32 v4, v4, v5
    v_cmp_eq_u32 vcc, -1, v4
    v_smfmac_f32_16x16x64_bf16 v[80:83], v[204:207], a[248:255], v9
    s_cbranch_vccnz .A_61
.W_62:
    v_smfmac_f32_16x16x64_bf16 v[76:79], v[208:211], v[124:131], v9
    v_smfmac_f32_16x16x64_bf16 v[80:83], v[208:211], v[156:163], v9
    s_waitcnt vmcnt(0)
    v_max3_u32 v4, v216, v217, v218
    v_max3_u32 v5, v219, v220, v221
    v_max3_u32 v4, v4, v222, v223
    v_smfmac_f32_16x16x64_bf16 v[76:79], v[212:215], v[132:139], v9
    v_max_u32 v4, v4, v5
    v_cmp_eq_u32 vcc, -1, v4
    v_smfmac_f32_16x16x64_bf16 v[80:83], v[212:215], v[164:171], v9
    s_cbranch_vccnz .A_63
.W_64:
    v_smfmac_f32_16x16x64_bf16 v[76:79], v[216:219], v[140:147], v9
    v_smfmac_f32_16x16x64_bf16 v[80:83], v[216:219], v[172:179], v9
    v_smfmac_f32_16x16x64_bf16 v[76:79], v[220:223], v[148:155], v9
    v_smfmac_f32_16x16x64_bf16 v[80:83], v[220:223], v[180:187], v9
.mj_56:
    s_barrier
    s_nop 7
    v_permlane32_swap_b32 v76, v80
    v_permlane32_swap_b32 v77, v81
    v_permlane32_swap_b32 v78, v82
    v_permlane32_swap_b32 v79, v83
    v_add_f32 v76, v76, v80
    v_add_f32 v77, v77, v81
    v_add_f32 v78, v78, v82
    v_add_f32 v79, v79, v83
    v_cvt_pk_bf16_f32 v104, v76, v77
    v_cvt_pk_bf16_f32 v106, v76, v77
    v_cvt_pk_bf16_f32 v105, v78, v79
    v_cvt_pk_bf16_f32 v107, v78, v79
    v_permlane16_swap_b32 v104, v106
    s_nop 0
    v_permlane16_swap_b32 v105, v107
    v_min_u32 v104, 0xfffffffe, v104
    buffer_store_dwordx4 v[104:107], v237, s[8:11], s68 offen sc1

    ds_write_b128 v247, v[104:107]
    s_waitcnt lgkmcnt(0)
    s_barrier
    v_mov_b32 v79, 0
    v_mov_b32 v80, 0
    v_mov_b32 v81, 0
    v_mov_b32 v82, 0
    v_mov_b32 v83, 0
    s_waitcnt vmcnt(1)
    v_mov_b32 v192, -1
    v_mov_b32 v193, -1
    v_mov_b32 v194, -1
    v_mov_b32 v195, -1
    v_mov_b32 v196, -1
    v_mov_b32 v197, -1
    v_mov_b32 v198, -1
    v_mov_b32 v199, -1
    v_mov_b32 v200, -1
    v_mov_b32 v201, -1
    v_mov_b32 v202, -1
    v_mov_b32 v203, -1
    v_mov_b32 v204, -1
    v_mov_b32 v205, -1
    v_mov_b32 v206, -1
    v_mov_b32 v207, -1
    v_mov_b32 v208, -1
    v_mov_b32 v209, -1
    v_mov_b32 v210, -1
    v_mov_b32 v211, -1
    v_mov_b32 v212, -1
    v_mov_b32 v213, -1
    v_mov_b32 v214, -1
    v_mov_b32 v215, -1
    v_mov_b32 v216, -1
    v_mov_b32 v217, -1
    v_mov_b32 v218, -1
    v_mov_b32 v219, -1
    v_mov_b32 v220, -1
    v_mov_b32 v221, -1
    v_mov_b32 v222, -1
    v_mov_b32 v223, -1
    s_add_u32 s28, s28, 1
    s_add_u32 s36, s36, 196608
    s_cmp_lt_u32 s28, 63
    s_cselect_b32 s4, 262144, 0
    s_add_u32 s38, s38, s4
    s_add_u32 s39, s39, s4
    s_add_u32 s30, s30, s4
    s_mov_b32 s4, s68
    s_mov_b32 s68, s69
    s_mov_b32 s69, s70
    s_mov_b32 s70, s71
    s_mov_b32 s71, s4
    s_and_b32 s4, s28, 3
    s_lshl_b32 s5, s4, 16
    s_add_u32 s29, s5, s34
    s_xor_b32 s6, s5, 0x20000
    s_add_u32 s31, s6, s34
    s_add_u32 s32, s29, 16384
    s_add_u32 s33, s29, 20480
    s_branch .top_28
.w3_30:
    ds_read_b128 v[36:39], v14 offset:8192
    ds_read_b128 v[40:43], v14 offset:9216
    ds_read_b128 v[44:47], v14 offset:10240
    ds_read_b128 v[48:51], v14 offset:11264
    ds_read_b128 v[88:91], v14 offset:16384
    s_waitcnt lgkmcnt(0)
    v_mfma_f32_16x16x32_bf16 v[104:107], v[84:87], v[36:39], 0
    v_mfma_f32_16x16x32_bf16 v[108:111], v[84:87], v[44:47], 0
    v_mfma_f32_16x16x32_bf16 v[104:107], v[84:87], v[40:43], v[104:107]
    v_mfma_f32_16x16x32_bf16 v[108:111], v[84:87], v[48:51], v[108:111]
    s_nop 7
    v_cvt_pk_bf16_f32 v168, v104, v105
    v_cvt_pk_bf16_f32 v169, v106, v107
    v_cvt_pk_bf16_f32 v170, v108, v109
    v_cvt_pk_bf16_f32 v171, v110, v111
    ds_write_b128 v14, v[168:171] offset:18432
    v_cndmask_b32 v172, v170, v168, s[60:61]
    v_cndmask_b32 v173, v171, v169, s[60:61]
    v_min_u32 v172, 0xfffffffe, v172
    v_min_u32 v173, 0xfffffffe, v173
    v_mov_b32 v174, v172
    v_mov_b32 v175, v173
    s_cmp_eq_u32 s28, 63
    s_nop 0
    v_permlane16_swap_b32 v172, v174
    v_permlane16_swap_b32 v173, v175
    ds_write_b128 v14, v[172:175] offset:17408

    s_cbranch_scc1 .sk_65
    s_waitcnt lgkmcnt(0)
    s_barrier
    buffer_store_dwordx4 v[188:191], v235, s[8:11], s31 offen
    buffer_store_dwordx4 v[188:191], v236, s[8:11], s31 offen

    s_branch .gp_31
.A_66:
    buffer_load_dwordx4 v[32:35], v8, s[8:11], s29 offen offset:3072 sc1
    s_sub_u32 s62, s62, 1
    s_cbranch_scc1 .mg_end_1
    s_waitcnt vmcnt(3)
    v_max3_u32 v4, v20, v21, v22
    v_max_u32 v4, v4, v23
    v_cmp_eq_u32 vcc, -1, v4
    s_cbranch_vccz .W_34
.A_33:
    buffer_load_dwordx4 v[20:23], v8, s[8:11], s29 offen offset:0 sc1
    s_waitcnt vmcnt(3)
    v_max3_u32 v4, v24, v25, v26
    v_max_u32 v4, v4, v27
    v_cmp_eq_u32 vcc, -1, v4
    s_cbranch_vccz .W_67
.A_68:
    buffer_load_dwordx4 v[24:27], v8, s[8:11], s29 offen offset:1024 sc1
    s_waitcnt vmcnt(3)
    v_max3_u32 v4, v28, v29, v30
    v_max_u32 v4, v4, v31
    v_cmp_eq_u32 vcc, -1, v4
    s_cbranch_vccz .W_69
.A_70:
    buffer_load_dwordx4 v[28:31], v8, s[8:11], s29 offen offset:2048 sc1
    s_waitcnt vmcnt(3)
    v_max3_u32 v4, v32, v33, v34
    v_max_u32 v4, v4, v35
    v_cmp_eq_u32 vcc, -1, v4
    s_cbranch_vccnz .A_66
.W_71:
    v_smfmac_f32_16x16x64_bf16 v[52:55], v[32:35], a[24:31], v9
    v_smfmac_f32_16x16x64_bf16 v[56:59], v[32:35], a[56:63], v9
    s_waitcnt vmcnt(2)
    v_max3_u32 v4, v20, v21, v22
    v_max_u32 v4, v4, v23
    v_smfmac_f32_16x16x64_bf16 v[60:63], v[32:35], a[88:95], v9
    v_cmp_eq_u32 vcc, -1, v4
    v_smfmac_f32_16x16x64_bf16 v[64:67], v[32:35], a[120:127], v9
    s_cbranch_vccnz .A_72
.W_73:
    v_smfmac_f32_16x16x64_bf16 v[52:55], v[20:23], a[0:7], v9
    v_smfmac_f32_16x16x64_bf16 v[56:59], v[20:23], a[32:39], v9
    s_waitcnt vmcnt(1)
    v_max3_u32 v4, v24, v25, v26
    v_max_u32 v4, v4, v27
    v_smfmac_f32_16x16x64_bf16 v[60:63], v[20:23], a[64:71], v9
    v_cmp_eq_u32 vcc, -1, v4
    v_smfmac_f32_16x16x64_bf16 v[64:67], v[20:23], a[96:103], v9
    s_cbranch_vccnz .A_74
.W_75:
    v_smfmac_f32_16x16x64_bf16 v[52:55], v[24:27], a[8:15], v9
    v_smfmac_f32_16x16x64_bf16 v[56:59], v[24:27], a[40:47], v9
    s_waitcnt vmcnt(0)
    v_max3_u32 v4, v28, v29, v30
    v_max_u32 v4, v4, v31
    v_smfmac_f32_16x16x64_bf16 v[60:63], v[24:27], a[72:79], v9
    v_cmp_eq_u32 vcc, -1, v4
    v_smfmac_f32_16x16x64_bf16 v[64:67], v[24:27], a[104:111], v9
    s_cbranch_vccnz .A_76
.W_77:
    v_smfmac_f32_16x16x64_bf16 v[52:55], v[28:31], a[16:23], v9
    v_smfmac_f32_16x16x64_bf16 v[56:59], v[28:31], a[48:55], v9
    v_smfmac_f32_16x16x64_bf16 v[60:63], v[28:31], a[80:87], v9
    v_smfmac_f32_16x16x64_bf16 v[64:67], v[28:31], a[112:119], v9
    s_branch .mj_32
.W_67:
    v_smfmac_f32_16x16x64_bf16 v[52:55], v[24:27], a[8:15], v9
    v_smfmac_f32_16x16x64_bf16 v[56:59], v[24:27], a[40:47], v9
    s_waitcnt vmcnt(2)
    v_max3_u32 v4, v28, v29, v30
    v_max_u32 v4, v4, v31
    v_smfmac_f32_16x16x64_bf16 v[60:63], v[24:27], a[72:79], v9
    v_cmp_eq_u32 vcc, -1, v4
    v_smfmac_f32_16x16x64_bf16 v[64:67], v[24:27], a[104:111], v9
    s_cbranch_vccnz .A_78
.W_79:
    v_smfmac_f32_16x16x64_bf16 v[52:55], v[28:31], a[16:23], v9
    v_smfmac_f32_16x16x64_bf16 v[56:59], v[28:31], a[48:55], v9
    s_waitcnt vmcnt(1)
    v_max3_u32 v4, v32, v33, v34
    v_max_u32 v4, v4, v35
    v_smfmac_f32_16x16x64_bf16 v[60:63], v[28:31], a[80:87], v9
    v_cmp_eq_u32 vcc, -1, v4
    v_smfmac_f32_16x16x64_bf16 v[64:67], v[28:31], a[112:119], v9
    s_cbranch_vccnz .A_80
.W_81:
    v_smfmac_f32_16x16x64_bf16 v[52:55], v[32:35], a[24:31], v9
    v_smfmac_f32_16x16x64_bf16 v[56:59], v[32:35], a[56:63], v9
    s_waitcnt vmcnt(0)
    v_max3_u32 v4, v20, v21, v22
    v_max_u32 v4, v4, v23
    v_smfmac_f32_16x16x64_bf16 v[60:63], v[32:35], a[88:95], v9
    v_cmp_eq_u32 vcc, -1, v4
    v_smfmac_f32_16x16x64_bf16 v[64:67], v[32:35], a[120:127], v9
    s_cbranch_vccnz .A_82
.W_83:
    v_smfmac_f32_16x16x64_bf16 v[52:55], v[20:23], a[0:7], v9
    v_smfmac_f32_16x16x64_bf16 v[56:59], v[20:23], a[32:39], v9
    v_smfmac_f32_16x16x64_bf16 v[60:63], v[20:23], a[64:71], v9
    v_smfmac_f32_16x16x64_bf16 v[64:67], v[20:23], a[96:103], v9
    s_branch .mj_32
.W_69:
    v_smfmac_f32_16x16x64_bf16 v[52:55], v[28:31], a[16:23], v9
    v_smfmac_f32_16x16x64_bf16 v[56:59], v[28:31], a[48:55], v9
    s_waitcnt vmcnt(2)
    v_max3_u32 v4, v32, v33, v34
    v_max_u32 v4, v4, v35
    v_smfmac_f32_16x16x64_bf16 v[60:63], v[28:31], a[80:87], v9
    v_cmp_eq_u32 vcc, -1, v4
    v_smfmac_f32_16x16x64_bf16 v[64:67], v[28:31], a[112:119], v9
    s_cbranch_vccnz .A_84
.W_85:
    v_smfmac_f32_16x16x64_bf16 v[52:55], v[32:35], a[24:31], v9
    v_smfmac_f32_16x16x64_bf16 v[56:59], v[32:35], a[56:63], v9
    s_waitcnt vmcnt(1)
    v_max3_u32 v4, v20, v21, v22
    v_max_u32 v4, v4, v23
    v_smfmac_f32_16x16x64_bf16 v[60:63], v[32:35], a[88:95], v9
    v_cmp_eq_u32 vcc, -1, v4
    v_smfmac_f32_16x16x64_bf16 v[64:67], v[32:35], a[120:127], v9
    s_cbranch_vccnz .A_86
.W_87:
    v_smfmac_f32_16x16x64_bf16 v[52:55], v[20:23], a[0:7], v9
    v_smfmac_f32_16x16x64_bf16 v[56:59], v[20:23], a[32:39], v9
    s_waitcnt vmcnt(0)
    v_max3_u32 v4, v24, v25, v26
    v_max_u32 v4, v4, v27
    v_smfmac_f32_16x16x64_bf16 v[60:63], v[20:23], a[64:71], v9
    v_cmp_eq_u32 vcc, -1, v4
    v_smfmac_f32_16x16x64_bf16 v[64:67], v[20:23], a[96:103], v9
    s_cbranch_vccnz .A_88
.W_89:
    v_smfmac_f32_16x16x64_bf16 v[52:55], v[24:27], a[8:15], v9
    v_smfmac_f32_16x16x64_bf16 v[56:59], v[24:27], a[40:47], v9
    v_smfmac_f32_16x16x64_bf16 v[60:63], v[24:27], a[72:79], v9
    v_smfmac_f32_16x16x64_bf16 v[64:67], v[24:27], a[104:111], v9
    s_branch .mj_32
.A_90:
    buffer_load_dwordx4 v[28:31], v8, s[8:11], s29 offen offset:2048 sc1
    s_sub_u32 s62, s62, 1
    s_cbranch_scc1 .mg_end_1
    s_waitcnt vmcnt(2)
    v_max3_u32 v4, v20, v21, v22
    v_max_u32 v4, v4, v23
    v_cmp_eq_u32 vcc, -1, v4
    s_cbranch_vccz .W_73
.A_72:
    buffer_load_dwordx4 v[20:23], v8, s[8:11], s29 offen offset:0 sc1
    s_waitcnt vmcnt(2)
    v_max3_u32 v4, v24, v25, v26
    v_max_u32 v4, v4, v27
    v_cmp_eq_u32 vcc, -1, v4
    s_cbranch_vccz .W_91
.A_92:
    buffer_load_dwordx4 v[24:27], v8, s[8:11], s29 offen offset:1024 sc1
    s_waitcnt vmcnt(2)
    v_max3_u32 v4, v28, v29, v30
    v_max_u32 v4, v4, v31
    v_cmp_eq_u32 vcc, -1, v4
    s_cbranch_vccnz .A_90
.W_93:
    v_smfmac_f32_16x16x64_bf16 v[52:55], v[28:31], a[16:23], v9
    v_smfmac_f32_16x16x64_bf16 v[56:59], v[28:31], a[48:55], v9
    s_waitcnt vmcnt(1)
    v_max3_u32 v4, v20, v21, v22
    v_max_u32 v4, v4, v23
    v_smfmac_f32_16x16x64_bf16 v[60:63], v[28:31], a[80:87], v9
    v_cmp_eq_u32 vcc, -1, v4
    v_smfmac_f32_16x16x64_bf16 v[64:67], v[28:31], a[112:119], v9
    s_cbranch_vccz .W_87
    s_branch .A_86
.W_91:
    v_smfmac_f32_16x16x64_bf16 v[52:55], v[24:27], a[8:15], v9
    v_smfmac_f32_16x16x64_bf16 v[56:59], v[24:27], a[40:47], v9
    s_waitcnt vmcnt(1)
    v_max3_u32 v4, v28, v29, v30
    v_max_u32 v4, v4, v31
    v_smfmac_f32_16x16x64_bf16 v[60:63], v[24:27], a[72:79], v9
    v_cmp_eq_u32 vcc, -1, v4
    v_smfmac_f32_16x16x64_bf16 v[64:67], v[24:27], a[104:111], v9
    s_cbranch_vccnz .A_94
.W_95:
    v_smfmac_f32_16x16x64_bf16 v[52:55], v[28:31], a[16:23], v9
    v_smfmac_f32_16x16x64_bf16 v[56:59], v[28:31], a[48:55], v9
    s_waitcnt vmcnt(0)
    v_max3_u32 v4, v20, v21, v22
    v_max_u32 v4, v4, v23
    v_smfmac_f32_16x16x64_bf16 v[60:63], v[28:31], a[80:87], v9
    v_cmp_eq_u32 vcc, -1, v4
    v_smfmac_f32_16x16x64_bf16 v[64:67], v[28:31], a[112:119], v9
    s_cbranch_vccz .W_83
    s_branch .A_82
.A_96:
    buffer_load_dwordx4 v[24:27], v8, s[8:11], s29 offen offset:1024 sc1
    s_sub_u32 s62, s62, 1
    s_cbranch_scc1 .mg_end_1
    s_waitcnt vmcnt(2)
    v_max3_u32 v4, v32, v33, v34
    v_max_u32 v4, v4, v35
    v_cmp_eq_u32 vcc, -1, v4
    s_cbranch_vccz .W_85
.A_84:
    buffer_load_dwordx4 v[32:35], v8, s[8:11], s29 offen offset:3072 sc1
    s_waitcnt vmcnt(2)
    v_max3_u32 v4, v20, v21, v22
    v_max_u32 v4, v4, v23
    v_cmp_eq_u32 vcc, -1, v4
    s_cbranch_vccz .W_97
.A_98:
    buffer_load_dwordx4 v[20:23], v8, s[8:11], s29 offen offset:0 sc1
    s_waitcnt vmcnt(2)
    v_max3_u32 v4, v24, v25, v26
    v_max_u32 v4, v4, v27
    v_cmp_eq_u32 vcc, -1, v4
    s_cbranch_vccnz .A_96
.W_99:
    v_smfmac_f32_16x16x64_bf16 v[52:55], v[24:27], a[8:15], v9
    v_smfmac_f32_16x16x64_bf16 v[56:59], v[24:27], a[40:47], v9
    s_waitcnt vmcnt(1)
    v_max3_u32 v4, v32, v33, v34
    v_max_u32 v4, v4, v35
    v_smfmac_f32_16x16x64_bf16 v[60:63], v[24:27], a[72:79], v9
    v_cmp_eq_u32 vcc, -1, v4
    v_smfmac_f32_16x16x64_bf16 v[64:67], v[24:27], a[104:111], v9
    s_cbranch_vccz .W_81
    s_branch .A_80
.W_97:
    v_smfmac_f32_16x16x64_bf16 v[52:55], v[20:23], a[0:7], v9
    v_smfmac_f32_16x16x64_bf16 v[56:59], v[20:23], a[32:39], v9
    s_waitcnt vmcnt(1)
    v_max3_u32 v4, v24, v25, v26
    v_max_u32 v4, v4, v27
    v_smfmac_f32_16x16x64_bf16 v[60:63], v[20:23], a[64:71], v9
    v_cmp_eq_u32 vcc, -1, v4
    v_smfmac_f32_16x16x64_bf16 v[64:67], v[20:23], a[96:103], v9
    s_cbranch_vccnz .A_100
.W_101:
    v_smfmac_f32_16x16x64_bf16 v[52:55], v[24:27], a[8:15], v9
    v_smfmac_f32_16x16x64_bf16 v[56:59], v[24:27], a[40:47], v9
    s_waitcnt vmcnt(0)
    v_max3_u32 v4, v32, v33, v34
    v_max_u32 v4, v4, v35
    v_smfmac_f32_16x16x64_bf16 v[60:63], v[24:27], a[72:79], v9
    v_cmp_eq_u32 vcc, -1, v4
    v_smfmac_f32_16x16x64_bf16 v[64:67], v[24:27], a[104:111], v9
    s_cbranch_vccz .W_40
    s_branch .A_39
.A_102:
    buffer_load_dwordx4 v[32:35], v8, s[8:11], s29 offen offset:3072 sc1
    s_sub_u32 s62, s62, 1
    s_cbranch_scc1 .mg_end_1
    s_waitcnt vmcnt(2)
    v_max3_u32 v4, v20, v21, v22
    v_max_u32 v4, v4, v23
    v_cmp_eq_u32 vcc, -1, v4
    s_cbranch_vccz .W_103
.A_104:
    buffer_load_dwordx4 v[20:23], v8, s[8:11], s29 offen offset:0 sc1
    s_waitcnt vmcnt(2)
    v_max3_u32 v4, v28, v29, v30
    v_max_u32 v4, v4, v31
    v_cmp_eq_u32 vcc, -1, v4
    s_cbranch_vccz .W_79
.A_78:
    buffer_load_dwordx4 v[28:31], v8, s[8:11], s29 offen offset:2048 sc1
    s_waitcnt vmcnt(2)
    v_max3_u32 v4, v32, v33, v34
    v_max_u32 v4, v4, v35
    v_cmp_eq_u32 vcc, -1, v4
    s_cbranch_vccnz .A_102
.W_105:
    v_smfmac_f32_16x16x64_bf16 v[52:55], v[32:35], a[24:31], v9
    v_smfmac_f32_16x16x64_bf16 v[56:59], v[32:35], a[56:63], v9
    s_waitcnt vmcnt(1)
    v_max3_u32 v4, v20, v21, v22
    v_max_u32 v4, v4, v23
    v_smfmac_f32_16x16x64_bf16 v[60:63], v[32:35], a[88:95], v9
    v_cmp_eq_u32 vcc, -1, v4
    v_smfmac_f32_16x16x64_bf16 v[64:67], v[32:35], a[120:127], v9
    s_cbranch_vccnz .A_106
.W_107:
    v_smfmac_f32_16x16x64_bf16 v[52:55], v[20:23], a[0:7], v9
    v_smfmac_f32_16x16x64_bf16 v[56:59], v[20:23], a[32:39], v9
    s_waitcnt vmcnt(0)
    v_max3_u32 v4, v28, v29, v30
    v_max_u32 v4, v4, v31
    v_smfmac_f32_16x16x64_bf16 v[60:63], v[20:23], a[64:71], v9
    v_cmp_eq_u32 vcc, -1, v4
    v_smfmac_f32_16x16x64_bf16 v[64:67], v[20:23], a[96:103], v9
    s_cbranch_vccz .W_77
    s_branch .A_76
.W_103:
    v_smfmac_f32_16x16x64_bf16 v[52:55], v[20:23], a[0:7], v9
    v_smfmac_f32_16x16x64_bf16 v[56:59], v[20:23], a[32:39], v9
    s_waitcnt vmcnt(1)
    v_max3_u32 v4, v28, v29, v30
    v_max_u32 v4, v4, v31
    v_smfmac_f32_16x16x64_bf16 v[60:63], v[20:23], a[64:71], v9
    v_cmp_eq_u32 vcc, -1, v4
    v_smfmac_f32_16x16x64_bf16 v[64:67], v[20:23], a[96:103], v9
    s_cbranch_vccz .W_38
    s_branch .A_37
.A_108:
    buffer_load_dwordx4 v[32:35], v8, s[8:11], s29 offen offset:3072 sc1
    s_sub_u32 s62, s62, 1
    s_cbranch_scc1 .mg_end_1
    s_waitcnt vmcnt(2)
    v_max3_u32 v4, v24, v25, v26
    v_max_u32 v4, v4, v27
    v_cmp_eq_u32 vcc, -1, v4
    s_cbranch_vccz .W_36
.A_35:
    buffer_load_dwordx4 v[24:27], v8, s[8:11], s29 offen offset:1024 sc1
    s_waitcnt vmcnt(2)
    v_max3_u32 v4, v28, v29, v30
    v_max_u32 v4, v4, v31
    v_cmp_eq_u32 vcc, -1, v4
    s_cbranch_vccz .W_109
.A_110:
    buffer_load_dwordx4 v[28:31], v8, s[8:11], s29 offen offset:2048 sc1
    s_waitcnt vmcnt(2)
    v_max3_u32 v4, v32, v33, v34
    v_max_u32 v4, v4, v35
    v_cmp_eq_u32 vcc, -1, v4
    s_cbranch_vccnz .A_108
.W_111:
    v_smfmac_f32_16x16x64_bf16 v[52:55], v[32:35], a[24:31], v9
    v_smfmac_f32_16x16x64_bf16 v[56:59], v[32:35], a[56:63], v9
    s_waitcnt vmcnt(1)
    v_max3_u32 v4, v24, v25, v26
    v_max_u32 v4, v4, v27
    v_smfmac_f32_16x16x64_bf16 v[60:63], v[32:35], a[88:95], v9
    v_cmp_eq_u32 vcc, -1, v4
    v_smfmac_f32_16x16x64_bf16 v[64:67], v[32:35], a[120:127], v9
    s_cbranch_vccz .W_75
    s_branch .A_74
.W_109:
    v_smfmac_f32_16x16x64_bf16 v[52:55], v[28:31], a[16:23], v9
    v_smfmac_f32_16x16x64_bf16 v[56:59], v[28:31], a[48:55], v9
    s_waitcnt vmcnt(1)
    v_max3_u32 v4, v32, v33, v34
    v_max_u32 v4, v4, v35
    v_smfmac_f32_16x16x64_bf16 v[60:63], v[28:31], a[80:87], v9
    v_cmp_eq_u32 vcc, -1, v4
    v_smfmac_f32_16x16x64_bf16 v[64:67], v[28:31], a[112:119], v9
    s_cbranch_vccnz .A_112
.W_113:
    v_smfmac_f32_16x16x64_bf16 v[52:55], v[32:35], a[24:31], v9
    v_smfmac_f32_16x16x64_bf16 v[56:59], v[32:35], a[56:63], v9
    s_waitcnt vmcnt(0)
    v_max3_u32 v4, v24, v25, v26
    v_max_u32 v4, v4, v27
    v_smfmac_f32_16x16x64_bf16 v[60:63], v[32:35], a[88:95], v9
    v_cmp_eq_u32 vcc, -1, v4
    v_smfmac_f32_16x16x64_bf16 v[64:67], v[32:35], a[120:127], v9
    s_cbranch_vccz .W_89
    s_branch .A_88
.A_114:
    buffer_load_dwordx4 v[24:27], v8, s[8:11], s29 offen offset:1024 sc1
    s_sub_u32 s62, s62, 1
    s_cbranch_scc1 .mg_end_1
    s_waitcnt vmcnt(1)
    v_max3_u32 v4, v20, v21, v22
    v_max_u32 v4, v4, v23
    v_cmp_eq_u32 vcc, -1, v4
    s_cbranch_vccz .W_87
.A_86:
    buffer_load_dwordx4 v[20:23], v8, s[8:11], s29 offen offset:0 sc1
    s_waitcnt vmcnt(1)
    v_max3_u32 v4, v24, v25, v26
    v_max_u32 v4, v4, v27
    v_cmp_eq_u32 vcc, -1, v4
    s_cbranch_vccnz .A_114
.W_115:
    v_smfmac_f32_16x16x64_bf16 v[52:55], v[24:27], a[8:15], v9
    v_smfmac_f32_16x16x64_bf16 v[56:59], v[24:27], a[40:47], v9
    s_waitcnt vmcnt(0)
    v_max3_u32 v4, v20, v21, v22
    v_max_u32 v4, v4, v23
    v_smfmac_f32_16x16x64_bf16 v[60:63], v[24:27], a[72:79], v9
    v_cmp_eq_u32 vcc, -1, v4
    v_smfmac_f32_16x16x64_bf16 v[64:67], v[24:27], a[104:111], v9
    s_cbranch_vccz .W_83
    s_branch .A_82
.A_94:
    buffer_load_dwordx4 v[28:31], v8, s[8:11], s29 offen offset:2048 sc1
    s_sub_u32 s62, s62, 1
    s_cbranch_scc1 .mg_end_1
    s_waitcnt vmcnt(1)
    v_max3_u32 v4, v20, v21, v22
    v_max_u32 v4, v4, v23
    v_cmp_eq_u32 vcc, -1, v4
    s_cbranch_vccz .W_107
.A_106:
    buffer_load_dwordx4 v[20:23], v8, s[8:11], s29 offen offset:0 sc1
    s_waitcnt vmcnt(1)
    v_max3_u32 v4, v28, v29, v30
    v_max_u32 v4, v4, v31
    v_cmp_eq_u32 vcc, -1, v4
    s_cbranch_vccnz .A_94
    s_branch .W_95
.A_116:
    buffer_load_dwordx4 v[20:23], v8, s[8:11], s29 offen offset:0 sc1
    s_sub_u32 s62, s62, 1
    s_cbranch_scc1 .mg_end_1
    s_waitcnt vmcnt(1)
    v_max3_u32 v4, v32, v33, v34
    v_max_u32 v4, v4, v35
    v_cmp_eq_u32 vcc, -1, v4
    s_cbranch_vccz .W_81
.A_80:
    buffer_load_dwordx4 v[32:35], v8, s[8:11], s29 offen offset:3072 sc1
    s_waitcnt vmcnt(1)
    v_max3_u32 v4, v20, v21, v22
    v_max_u32 v4, v4, v23
    v_cmp_eq_u32 vcc, -1, v4
    s_cbranch_vccnz .A_116
.W_117:
    v_smfmac_f32_16x16x64_bf16 v[52:55], v[20:23], a[0:7], v9
    v_smfmac_f32_16x16x64_bf16 v[56:59], v[20:23], a[32:39], v9
    s_waitcnt vmcnt(0)
    v_max3_u32 v4, v32, v33, v34
    v_max_u32 v4, v4, v35
    v_smfmac_f32_16x16x64_bf16 v[60:63], v[20:23], a[64:71], v9
    v_cmp_eq_u32 vcc, -1, v4
    v_smfmac_f32_16x16x64_bf16 v[64:67], v[20:23], a[96:103], v9
    s_cbranch_vccz .W_40
    s_branch .A_39
.A_118:
    buffer_load_dwordx4 v[28:31], v8, s[8:11], s29 offen offset:2048 sc1
    s_sub_u32 s62, s62, 1
    s_cbranch_scc1 .mg_end_1
    s_waitcnt vmcnt(1)
    v_max3_u32 v4, v24, v25, v26
    v_max_u32 v4, v4, v27
    v_cmp_eq_u32 vcc, -1, v4
    s_cbranch_vccz .W_75
.A_74:
    buffer_load_dwordx4 v[24:27], v8, s[8:11], s29 offen offset:1024 sc1
    s_waitcnt vmcnt(1)
    v_max3_u32 v4, v28, v29, v30
    v_max_u32 v4, v4, v31
    v_cmp_eq_u32 vcc, -1, v4
    s_cbranch_vccnz .A_118
.W_119:
    v_smfmac_f32_16x16x64_bf16 v[52:55], v[28:31], a[16:23], v9
    v_smfmac_f32_16x16x64_bf16 v[56:59], v[28:31], a[48:55], v9
    s_waitcnt vmcnt(0)
    v_max3_u32 v4, v24, v25, v26
    v_max_u32 v4, v4, v27
    v_smfmac_f32_16x16x64_bf16 v[60:63], v[28:31], a[80:87], v9
    v_cmp_eq_u32 vcc, -1, v4
    v_smfmac_f32_16x16x64_bf16 v[64:67], v[28:31], a[112:119], v9
    s_cbranch_vccz .W_89
    s_branch .A_88
.A_112:
    buffer_load_dwordx4 v[32:35], v8, s[8:11], s29 offen offset:3072 sc1
    s_sub_u32 s62, s62, 1
    s_cbranch_scc1 .mg_end_1
    s_waitcnt vmcnt(1)
    v_max3_u32 v4, v24, v25, v26
    v_max_u32 v4, v4, v27
    v_cmp_eq_u32 vcc, -1, v4
    s_cbranch_vccz .W_101
.A_100:
    buffer_load_dwordx4 v[24:27], v8, s[8:11], s29 offen offset:1024 sc1
    s_waitcnt vmcnt(1)
    v_max3_u32 v4, v32, v33, v34
    v_max_u32 v4, v4, v35
    v_cmp_eq_u32 vcc, -1, v4
    s_cbranch_vccnz .A_112
    s_branch .W_113
.A_120:
    buffer_load_dwordx4 v[32:35], v8, s[8:11], s29 offen offset:3072 sc1
    s_sub_u32 s62, s62, 1
    s_cbranch_scc1 .mg_end_1
    s_waitcnt vmcnt(1)
    v_max3_u32 v4, v28, v29, v30
    v_max_u32 v4, v4, v31
    v_cmp_eq_u32 vcc, -1, v4
    s_cbranch_vccz .W_38
.A_37:
    buffer_load_dwordx4 v[28:31], v8, s[8:11], s29 offen offset:2048 sc1
    s_waitcnt vmcnt(1)
    v_max3_u32 v4, v32, v33, v34
    v_max_u32 v4, v4, v35
    v_cmp_eq_u32 vcc, -1, v4
    s_cbranch_vccnz .A_120
.W_121:
    v_smfmac_f32_16x16x64_bf16 v[52:55], v[32:35], a[24:31], v9
    v_smfmac_f32_16x16x64_bf16 v[56:59], v[32:35], a[56:63], v9
    s_waitcnt vmcnt(0)
    v_max3_u32 v4, v28, v29, v30
    v_max_u32 v4, v4, v31
    v_smfmac_f32_16x16x64_bf16 v[60:63], v[32:35], a[88:95], v9
    v_cmp_eq_u32 vcc, -1, v4
    v_smfmac_f32_16x16x64_bf16 v[64:67], v[32:35], a[120:127], v9
    s_cbranch_vccz .W_77
    s_branch .A_76
.A_82:
    buffer_load_dwordx4 v[20:23], v8, s[8:11], s29 offen offset:0 sc1
    s_sub_u32 s62, s62, 1
    s_cbranch_scc1 .mg_end_1
    s_waitcnt vmcnt(1)
    v_max3_u32 v4, v20, v21, v22
    v_max_u32 v4, v4, v23
    v_cmp_eq_u32 vcc, -1, v4
    s_cbranch_vccnz .A_82
    v_smfmac_f32_16x16x64_bf16 v[52:55], v[20:23], a[0:7], v9
    v_smfmac_f32_16x16x64_bf16 v[56:59], v[20:23], a[32:39], v9
    v_smfmac_f32_16x16x64_bf16 v[60:63], v[20:23], a[64:71], v9
    v_smfmac_f32_16x16x64_bf16 v[64:67], v[20:23], a[96:103], v9
    s_branch .mj_32
.A_88:
    buffer_load_dwordx4 v[24:27], v8, s[8:11], s29 offen offset:1024 sc1
    s_sub_u32 s62, s62, 1
    s_cbranch_scc1 .mg_end_1
    s_waitcnt vmcnt(1)
    v_max3_u32 v4, v24, v25, v26
    v_max_u32 v4, v4, v27
    v_cmp_eq_u32 vcc, -1, v4
    s_cbranch_vccnz .A_88
    v_smfmac_f32_16x16x64_bf16 v[52:55], v[24:27], a[8:15], v9
    v_smfmac_f32_16x16x64_bf16 v[56:59], v[24:27], a[40:47], v9
    v_smfmac_f32_16x16x64_bf16 v[60:63], v[24:27], a[72:79], v9
    v_smfmac_f32_16x16x64_bf16 v[64:67], v[24:27], a[104:111], v9
    s_branch .mj_32
.A_76:
    buffer_load_dwordx4 v[28:31], v8, s[8:11], s29 offen offset:2048 sc1
    s_sub_u32 s62, s62, 1
    s_cbranch_scc1 .mg_end_1
    s_waitcnt vmcnt(1)
    v_max3_u32 v4, v28, v29, v30
    v_max_u32 v4, v4, v31
    v_cmp_eq_u32 vcc, -1, v4
    s_cbranch_vccnz .A_76
    v_smfmac_f32_16x16x64_bf16 v[52:55], v[28:31], a[16:23], v9
    v_smfmac_f32_16x16x64_bf16 v[56:59], v[28:31], a[48:55], v9
    v_smfmac_f32_16x16x64_bf16 v[60:63], v[28:31], a[80:87], v9
    v_smfmac_f32_16x16x64_bf16 v[64:67], v[28:31], a[112:119], v9
    s_branch .mj_32
.A_39:
    buffer_load_dwordx4 v[32:35], v8, s[8:11], s29 offen offset:3072 sc1
    s_sub_u32 s62, s62, 1
    s_cbranch_scc1 .mg_end_1
    s_waitcnt vmcnt(1)
    v_max3_u32 v4, v32, v33, v34
    v_max_u32 v4, v4, v35
    v_cmp_eq_u32 vcc, -1, v4
    s_cbranch_vccnz .A_39
    v_smfmac_f32_16x16x64_bf16 v[52:55], v[32:35], a[24:31], v9
    v_smfmac_f32_16x16x64_bf16 v[56:59], v[32:35], a[56:63], v9
    v_smfmac_f32_16x16x64_bf16 v[60:63], v[32:35], a[88:95], v9
    v_smfmac_f32_16x16x64_bf16 v[64:67], v[32:35], a[120:127], v9
    s_branch .mj_32
.A_122:
    buffer_load_dwordx4 v[100:103], v234, s[8:11], s29 offen sc1
    s_sub_u32 s62, s62, 1
    s_cbranch_scc1 .mg_end_1
    s_waitcnt vmcnt(2)
    v_max3_u32 v4, v92, v93, v94
    v_max_u32 v4, v4, v95
    v_cmp_eq_u32 vcc, -1, v4
    s_cbranch_vccz .W_43
.A_42:
    buffer_load_dwordx4 v[92:95], v232, s[8:11], s29 offen sc1
    s_waitcnt vmcnt(2)
    v_max3_u32 v4, v96, v97, v98
    v_max_u32 v4, v4, v99
    v_cmp_eq_u32 vcc, -1, v4
    s_cbranch_vccz .W_123
.A_124:
    buffer_load_dwordx4 v[96:99], v233, s[8:11], s29 offen sc1
    s_waitcnt vmcnt(2)
    v_max3_u32 v4, v100, v101, v102
    v_max_u32 v4, v4, v103
    v_cmp_eq_u32 vcc, -1, v4
    s_cbranch_vccnz .A_122
.W_125:
    v_mfma_f32_16x16x32_bf16 v[208:211], v[140:143], v[100:103], v[208:211]
    s_waitcnt vmcnt(1)
    v_max3_u32 v4, v92, v93, v94
    v_max_u32 v4, v4, v95
    v_mfma_f32_16x16x32_bf16 v[212:215], v[156:159], v[100:103], v[212:215]
    v_cmp_eq_u32 vcc, -1, v4
    v_mfma_f32_16x16x32_bf16 v[216:219], v[100:103], v[100:103], v[216:219]
    s_cbranch_vccnz .A_126
.W_127:
    v_mfma_f32_16x16x32_bf16 v[208:211], v[132:135], v[92:95], v[208:211]
    s_waitcnt vmcnt(0)
    v_max3_u32 v4, v96, v97, v98
    v_max_u32 v4, v4, v99
    v_mfma_f32_16x16x32_bf16 v[212:215], v[148:151], v[92:95], v[212:215]
    v_cmp_eq_u32 vcc, -1, v4
    v_mfma_f32_16x16x32_bf16 v[216:219], v[92:95], v[92:95], v[216:219]
    s_cbranch_vccnz .A_128
.W_129:
    v_mfma_f32_16x16x32_bf16 v[208:211], v[136:139], v[96:99], v[208:211]
    v_mfma_f32_16x16x32_bf16 v[212:215], v[152:155], v[96:99], v[212:215]
    v_mfma_f32_16x16x32_bf16 v[216:219], v[96:99], v[96:99], v[216:219]
    s_branch .mj_41
.W_123:
    v_mfma_f32_16x16x32_bf16 v[208:211], v[136:139], v[96:99], v[208:211]
    s_waitcnt vmcnt(1)
    v_max3_u32 v4, v100, v101, v102
    v_max_u32 v4, v4, v103
    v_mfma_f32_16x16x32_bf16 v[212:215], v[152:155], v[96:99], v[212:215]
    v_cmp_eq_u32 vcc, -1, v4
    v_mfma_f32_16x16x32_bf16 v[216:219], v[96:99], v[96:99], v[216:219]
    s_cbranch_vccnz .A_130
.W_131:
    v_mfma_f32_16x16x32_bf16 v[208:211], v[140:143], v[100:103], v[208:211]
    s_waitcnt vmcnt(0)
    v_max3_u32 v4, v92, v93, v94
    v_max_u32 v4, v4, v95
    v_mfma_f32_16x16x32_bf16 v[212:215], v[156:159], v[100:103], v[212:215]
    v_cmp_eq_u32 vcc, -1, v4
    v_mfma_f32_16x16x32_bf16 v[216:219], v[100:103], v[100:103], v[216:219]
    s_cbranch_vccnz .A_132
.W_133:
    v_mfma_f32_16x16x32_bf16 v[208:211], v[132:135], v[92:95], v[208:211]
    v_mfma_f32_16x16x32_bf16 v[212:215], v[148:151], v[92:95], v[212:215]
    v_mfma_f32_16x16x32_bf16 v[216:219], v[92:95], v[92:95], v[216:219]
    s_branch .mj_41
.A_134:
    buffer_load_dwordx4 v[96:99], v233, s[8:11], s29 offen sc1
    s_sub_u32 s62, s62, 1
    s_cbranch_scc1 .mg_end_1
    s_waitcnt vmcnt(1)
    v_max3_u32 v4, v92, v93, v94
    v_max_u32 v4, v4, v95
    v_cmp_eq_u32 vcc, -1, v4
    s_cbranch_vccz .W_127
.A_126:
    buffer_load_dwordx4 v[92:95], v232, s[8:11], s29 offen sc1
    s_waitcnt vmcnt(1)
    v_max3_u32 v4, v96, v97, v98
    v_max_u32 v4, v4, v99
    v_cmp_eq_u32 vcc, -1, v4
    s_cbranch_vccnz .A_134
.W_135:
    v_mfma_f32_16x16x32_bf16 v[208:211], v[136:139], v[96:99], v[208:211]
    s_waitcnt vmcnt(0)
    v_max3_u32 v4, v92, v93, v94
    v_max_u32 v4, v4, v95
    v_mfma_f32_16x16x32_bf16 v[212:215], v[152:155], v[96:99], v[212:215]
    v_cmp_eq_u32 vcc, -1, v4
    v_mfma_f32_16x16x32_bf16 v[216:219], v[96:99], v[96:99], v[216:219]
    s_cbranch_vccz .W_133
    s_branch .A_132
.A_136:
    buffer_load_dwordx4 v[92:95], v232, s[8:11], s29 offen sc1
    s_sub_u32 s62, s62, 1
    s_cbranch_scc1 .mg_end_1
    s_waitcnt vmcnt(1)
    v_max3_u32 v4, v100, v101, v102
    v_max_u32 v4, v4, v103
    v_cmp_eq_u32 vcc, -1, v4
    s_cbranch_vccz .W_131
.A_130:
    buffer_load_dwordx4 v[100:103], v234, s[8:11], s29 offen sc1
    s_waitcnt vmcnt(1)
    v_max3_u32 v4, v92, v93, v94
    v_max_u32 v4, v4, v95
    v_cmp_eq_u32 vcc, -1, v4
    s_cbranch_vccnz .A_136
.W_137:
    v_mfma_f32_16x16x32_bf16 v[208:211], v[132:135], v[92:95], v[208:211]
    s_waitcnt vmcnt(0)
    v_max3_u32 v4, v100, v101, v102
    v_max_u32 v4, v4, v103
    v_mfma_f32_16x16x32_bf16 v[212:215], v[148:151], v[92:95], v[212:215]
    v_cmp_eq_u32 vcc, -1, v4
    v_mfma_f32_16x16x32_bf16 v[216:219], v[92:95], v[92:95], v[216:219]
    s_cbranch_vccz .W_47
    s_branch .A_46
.A_138:
    buffer_load_dwordx4 v[100:103], v234, s[8:11], s29 offen sc1
    s_sub_u32 s62, s62, 1
    s_cbranch_scc1 .mg_end_1
    s_waitcnt vmcnt(1)
    v_max3_u32 v4, v96, v97, v98
    v_max_u32 v4, v4, v99
    v_cmp_eq_u32 vcc, -1, v4
    s_cbranch_vccz .W_45
.A_44:
    buffer_load_dwordx4 v[96:99], v233, s[8:11], s29 offen sc1
    s_waitcnt vmcnt(1)
    v_max3_u32 v4, v100, v101, v102
    v_max_u32 v4, v4, v103
    v_cmp_eq_u32 vcc, -1, v4
    s_cbranch_vccnz .A_138
.W_139:
    v_mfma_f32_16x16x32_bf16 v[208:211], v[140:143], v[100:103], v[208:211]
    s_waitcnt vmcnt(0)
    v_max3_u32 v4, v96, v97, v98
    v_max_u32 v4, v4, v99
    v_mfma_f32_16x16x32_bf16 v[212:215], v[156:159], v[100:103], v[212:215]
    v_cmp_eq_u32 vcc, -1, v4
    v_mfma_f32_16x16x32_bf16 v[216:219], v[100:103], v[100:103], v[216:219]
    s_cbranch_vccz .W_129
    s_branch .A_128
.A_132:
    buffer_load_dwordx4 v[92:95], v232, s[8:11], s29 offen sc1
    s_sub_u32 s62, s62, 1
    s_cbranch_scc1 .mg_end_1
    s_waitcnt vmcnt(1)
    v_max3_u32 v4, v92, v93, v94
    v_max_u32 v4, v4, v95
    v_cmp_eq_u32 vcc, -1, v4
    s_cbranch_vccnz .A_132
    v_mfma_f32_16x16x32_bf16 v[208:211], v[132:135], v[92:95], v[208:211]
    v_mfma_f32_16x16x32_bf16 v[212:215], v[148:151], v[92:95], v[212:215]
    v_mfma_f32_16x16x32_bf16 v[216:219], v[92:95], v[92:95], v[216:219]
    s_branch .mj_41
.A_128:
    buffer_load_dwordx4 v[96:99], v233, s[8:11], s29 offen sc1
    s_sub_u32 s62, s62, 1
    s_cbranch_scc1 .mg_end_1
    s_waitcnt vmcnt(1)
    v_max3_u32 v4, v96, v97, v98
    v_max_u32 v4, v4, v99
    v_cmp_eq_u32 vcc, -1, v4
    s_cbranch_vccnz .A_128
    v_mfma_f32_16x16x32_bf16 v[208:211], v[136:139], v[96:99], v[208:211]
    v_mfma_f32_16x16x32_bf16 v[212:215], v[152:155], v[96:99], v[212:215]
    v_mfma_f32_16x16x32_bf16 v[216:219], v[96:99], v[96:99], v[216:219]
    s_branch .mj_41
.A_46:
    buffer_load_dwordx4 v[100:103], v234, s[8:11], s29 offen sc1
    s_sub_u32 s62, s62, 1
    s_cbranch_scc1 .mg_end_1
    s_waitcnt vmcnt(1)
    v_max3_u32 v4, v100, v101, v102
    v_max_u32 v4, v4, v103
    v_cmp_eq_u32 vcc, -1, v4
    s_cbranch_vccnz .A_46
    v_mfma_f32_16x16x32_bf16 v[208:211], v[140:143], v[100:103], v[208:211]
    v_mfma_f32_16x16x32_bf16 v[212:215], v[156:159], v[100:103], v[212:215]
    v_mfma_f32_16x16x32_bf16 v[216:219], v[100:103], v[100:103], v[216:219]
    s_branch .mj_41
.kf_53:
    s_mov_b32 s62, 0
    s_mov_b64 exec, 3
.wf_140:
    buffer_load_dword v244, v253, s[8:11], s89 offen sc1
    s_waitcnt vmcnt(0)
    v_cmp_gt_u32 vcc, s6, v244
    s_cbranch_vccz .wfd_141
    s_sleep 2
    s_add_u32 s62, s62, 1
    s_cmp_gt_u32 s62, 0x400000
    s_cbranch_scc1 .mg_end_1
    s_branch .wf_140

.wfd_141:
    s_mov_b64 exec, -1
    v_readlane_b32 s4, v244, 0
    v_readlane_b32 s93, v244, 1
    s_min_u32 s93, s93, s4
    s_mov_b32 s62, 0x1000000
    s_branch .kb_54
.A_142:
    buffer_load_dwordx4 v[216:219], v246, s[8:11], s33 offen offset:2048 sc1
    buffer_load_dwordx4 v[220:223], v246, s[8:11], s33 offen offset:3072 sc1
    s_sub_u32 s62, s62, 1
    s_cbranch_scc1 .mg_end_1
    s_waitcnt vmcnt(6)
    v_max3_u32 v4, v192, v193, v194
    v_max3_u32 v5, v195, v196, v197
    v_max3_u32 v4, v4, v198, v199
    v_max_u32 v4, v4, v5
    v_cmp_eq_u32 vcc, -1, v4
    s_cbranch_vccz .W_58
.A_57:
    buffer_load_dwordx4 v[192:195], v246, s[8:11], s32 offen offset:0 sc1
    buffer_load_dwordx4 v[196:199], v246, s[8:11], s32 offen offset:1024 sc1
    s_waitcnt vmcnt(6)
    v_max3_u32 v4, v200, v201, v202
    v_max3_u32 v5, v203, v204, v205
    v_max3_u32 v4, v4, v206, v207
    v_max_u32 v4, v4, v5
    v_cmp_eq_u32 vcc, -1, v4
    s_cbranch_vccz .W_143
.A_144:
    buffer_load_dwordx4 v[200:203], v246, s[8:11], s32 offen offset:2048 sc1
    buffer_load_dwordx4 v[204:207], v246, s[8:11], s32 offen offset:3072 sc1
    s_waitcnt vmcnt(6)
    v_max3_u32 v4, v208, v209, v210
    v_max3_u32 v5, v211, v212, v213
    v_max3_u32 v4, v4, v214, v215
    v_max_u32 v4, v4, v5
    v_cmp_eq_u32 vcc, -1, v4
    s_cbranch_vccz .W_145
.A_146:
    buffer_load_dwordx4 v[208:211], v246, s[8:11], s33 offen offset:0 sc1
    buffer_load_dwordx4 v[212:215], v246, s[8:11], s33 offen offset:1024 sc1
    s_waitcnt vmcnt(6)
    v_max3_u32 v4, v216, v217, v218
    v_max3_u32 v5, v219, v220, v221
    v_max3_u32 v4, v4, v222, v223
    v_max_u32 v4, v4, v5
    v_cmp_eq_u32 vcc, -1, v4
    s_cbranch_vccnz .A_142
.W_147:
    v_smfmac_f32_16x16x64_bf16 v[76:79], v[216:219], v[140:147], v9
    v_smfmac_f32_16x16x64_bf16 v[80:83], v[216:219], v[172:179], v9
    s_waitcnt vmcnt(4)
    v_max3_u32 v4, v192, v193, v194
    v_max3_u32 v5, v195, v196, v197
    v_max3_u32 v4, v4, v198, v199
    v_smfmac_f32_16x16x64_bf16 v[76:79], v[220:223], v[148:155], v9
    v_max_u32 v4, v4, v5
    v_cmp_eq_u32 vcc, -1, v4
    v_smfmac_f32_16x16x64_bf16 v[80:83], v[220:223], v[180:187], v9
    s_cbranch_vccnz .A_148
.W_149:
    v_smfmac_f32_16x16x64_bf16 v[76:79], v[192:195], a[192:199], v9
    v_smfmac_f32_16x16x64_bf16 v[80:83], v[192:195], a[224:231], v9
    s_waitcnt vmcnt(2)
    v_max3_u32 v4, v200, v201, v202
    v_max3_u32 v5, v203, v204, v205
    v_max3_u32 v4, v4, v206, v207
    v_smfmac_f32_16x16x64_bf16 v[76:79], v[196:199], a[200:207], v9
    v_max_u32 v4, v4, v5
    v_cmp_eq_u32 vcc, -1, v4
    v_smfmac_f32_16x16x64_bf16 v[80:83], v[196:199], a[232:239], v9
    s_cbranch_vccnz .A_150
.W_151:
    v_smfmac_f32_16x16x64_bf16 v[76:79], v[200:203], a[208:215], v9
    v_smfmac_f32_16x16x64_bf16 v[80:83], v[200:203], a[240:247], v9
    s_waitcnt vmcnt(0)
    v_max3_u32 v4, v208, v209, v210
    v_max3_u32 v5, v211, v212, v213
    v_max3_u32 v4, v4, v214, v215
    v_smfmac_f32_16x16x64_bf16 v[76:79], v[204:207], a[216:223], v9
    v_max_u32 v4, v4, v5
    v_cmp_eq_u32 vcc, -1, v4
    v_smfmac_f32_16x16x64_bf16 v[80:83], v[204:207], a[248:255], v9
    s_cbranch_vccnz .A_152
.W_153:
    v_smfmac_f32_16x16x64_bf16 v[76:79], v[208:211], v[124:131], v9
    v_smfmac_f32_16x16x64_bf16 v[80:83], v[208:211], v[156:163], v9
    v_smfmac_f32_16x16x64_bf16 v[76:79], v[212:215], v[132:139], v9
    v_smfmac_f32_16x16x64_bf16 v[80:83], v[212:215], v[164:171], v9
    s_branch .mj_56
.W_143:
    v_smfmac_f32_16x16x64_bf16 v[76:79], v[200:203], a[208:215], v9
    v_smfmac_f32_16x16x64_bf16 v[80:83], v[200:203], a[240:247], v9
    s_waitcnt vmcnt(4)
    v_max3_u32 v4, v208, v209, v210
    v_max3_u32 v5, v211, v212, v213
    v_max3_u32 v4, v4, v214, v215
    v_smfmac_f32_16x16x64_bf16 v[76:79], v[204:207], a[216:223], v9
    v_max_u32 v4, v4, v5
    v_cmp_eq_u32 vcc, -1, v4
    v_smfmac_f32_16x16x64_bf16 v[80:83], v[204:207], a[248:255], v9
    s_cbranch_vccnz .A_154
.W_155:
    v_smfmac_f32_16x16x64_bf16 v[76:79], v[208:211], v[124:131], v9
    v_smfmac_f32_16x16x64_bf16 v[80:83], v[208:211], v[156:163], v9
    s_waitcnt vmcnt(2)
    v_max3_u32 v4, v216, v217, v218
    v_max3_u32 v5, v219, v220, v221
    v_max3_u32 v4, v4, v222, v223
    v_smfmac_f32_16x16x64_bf16 v[76:79], v[212:215], v[132:139], v9
    v_max_u32 v4, v4, v5
    v_cmp_eq_u32 vcc, -1, v4
    v_smfmac_f32_16x16x64_bf16 v[80:83], v[212:215], v[164:171], v9
    s_cbranch_vccnz .A_156
.W_157:
    v_smfmac_f32_16x16x64_bf16 v[76:79], v[216:219], v[140:147], v9
    v_smfmac_f32_16x16x64_bf16 v[80:83], v[216:219], v[172:179], v9
    s_waitcnt vmcnt(0)
    v_max3_u32 v4, v192, v193, v194
    v_max3_u32 v5, v195, v196, v197
    v_max3_u32 v4, v4, v198, v199
    v_smfmac_f32_16x16x64_bf16 v[76:79], v[220:223], v[148:155], v9
    v_max_u32 v4, v4, v5
    v_cmp_eq_u32 vcc, -1, v4
    v_smfmac_f32_16x16x64_bf16 v[80:83], v[220:223], v[180:187], v9
    s_cbranch_vccnz .A_158
.W_159:
    v_smfmac_f32_16x16x64_bf16 v[76:79], v[192:195], a[192:199], v9
    v_smfmac_f32_16x16x64_bf16 v[80:83], v[192:195], a[224:231], v9
    v_smfmac_f32_16x16x64_bf16 v[76:79], v[196:199], a[200:207], v9
    v_smfmac_f32_16x16x64_bf16 v[80:83], v[196:199], a[232:239], v9
    s_branch .mj_56
.W_145:
    v_smfmac_f32_16x16x64_bf16 v[76:79], v[208:211], v[124:131], v9
    v_smfmac_f32_16x16x64_bf16 v[80:83], v[208:211], v[156:163], v9
    s_waitcnt vmcnt(4)
    v_max3_u32 v4, v216, v217, v218
    v_max3_u32 v5, v219, v220, v221
    v_max3_u32 v4, v4, v222, v223
    v_smfmac_f32_16x16x64_bf16 v[76:79], v[212:215], v[132:139], v9
    v_max_u32 v4, v4, v5
    v_cmp_eq_u32 vcc, -1, v4
    v_smfmac_f32_16x16x64_bf16 v[80:83], v[212:215], v[164:171], v9
    s_cbranch_vccnz .A_160
.W_161:
    v_smfmac_f32_16x16x64_bf16 v[76:79], v[216:219], v[140:147], v9
    v_smfmac_f32_16x16x64_bf16 v[80:83], v[216:219], v[172:179], v9
    s_waitcnt vmcnt(2)
    v_max3_u32 v4, v192, v193, v194
    v_max3_u32 v5, v195, v196, v197
    v_max3_u32 v4, v4, v198, v199
    v_smfmac_f32_16x16x64_bf16 v[76:79], v[220:223], v[148:155], v9
    v_max_u32 v4, v4, v5
    v_cmp_eq_u32 vcc, -1, v4
    v_smfmac_f32_16x16x64_bf16 v[80:83], v[220:223], v[180:187], v9
    s_cbranch_vccnz .A_162
.W_163:
    v_smfmac_f32_16x16x64_bf16 v[76:79], v[192:195], a[192:199], v9
    v_smfmac_f32_16x16x64_bf16 v[80:83], v[192:195], a[224:231], v9
    s_waitcnt vmcnt(0)
    v_max3_u32 v4, v200, v201, v202
    v_max3_u32 v5, v203, v204, v205
    v_max3_u32 v4, v4, v206, v207
    v_smfmac_f32_16x16x64_bf16 v[76:79], v[196:199], a[200:207], v9
    v_max_u32 v4, v4, v5
    v_cmp_eq_u32 vcc, -1, v4
    v_smfmac_f32_16x16x64_bf16 v[80:83], v[196:199], a[232:239], v9
    s_cbranch_vccnz .A_164
.W_165:
    v_smfmac_f32_16x16x64_bf16 v[76:79], v[200:203], a[208:215], v9
    v_smfmac_f32_16x16x64_bf16 v[80:83], v[200:203], a[240:247], v9
    v_smfmac_f32_16x16x64_bf16 v[76:79], v[204:207], a[216:223], v9
    v_smfmac_f32_16x16x64_bf16 v[80:83], v[204:207], a[248:255], v9
    s_branch .mj_56
.A_166:
    buffer_load_dwordx4 v[208:211], v246, s[8:11], s33 offen offset:0 sc1
    buffer_load_dwordx4 v[212:215], v246, s[8:11], s33 offen offset:1024 sc1
    s_sub_u32 s62, s62, 1
    s_cbranch_scc1 .mg_end_1
    s_waitcnt vmcnt(4)
    v_max3_u32 v4, v192, v193, v194
    v_max3_u32 v5, v195, v196, v197
    v_max3_u32 v4, v4, v198, v199
    v_max_u32 v4, v4, v5
    v_cmp_eq_u32 vcc, -1, v4
    s_cbranch_vccz .W_149
.A_148:
    buffer_load_dwordx4 v[192:195], v246, s[8:11], s32 offen offset:0 sc1
    buffer_load_dwordx4 v[196:199], v246, s[8:11], s32 offen offset:1024 sc1
    s_waitcnt vmcnt(4)
    v_max3_u32 v4, v200, v201, v202
    v_max3_u32 v5, v203, v204, v205
    v_max3_u32 v4, v4, v206, v207
    v_max_u32 v4, v4, v5
    v_cmp_eq_u32 vcc, -1, v4
    s_cbranch_vccz .W_167
.A_168:
    buffer_load_dwordx4 v[200:203], v246, s[8:11], s32 offen offset:2048 sc1
    buffer_load_dwordx4 v[204:207], v246, s[8:11], s32 offen offset:3072 sc1
    s_waitcnt vmcnt(4)
    v_max3_u32 v4, v208, v209, v210
    v_max3_u32 v5, v211, v212, v213
    v_max3_u32 v4, v4, v214, v215
    v_max_u32 v4, v4, v5
    v_cmp_eq_u32 vcc, -1, v4
    s_cbranch_vccnz .A_166
.W_169:
    v_smfmac_f32_16x16x64_bf16 v[76:79], v[208:211], v[124:131], v9
    v_smfmac_f32_16x16x64_bf16 v[80:83], v[208:211], v[156:163], v9
    s_waitcnt vmcnt(2)
    v_max3_u32 v4, v192, v193, v194
    v_max3_u32 v5, v195, v196, v197
    v_max3_u32 v4, v4, v198, v199
    v_smfmac_f32_16x16x64_bf16 v[76:79], v[212:215], v[132:139], v9
    v_max_u32 v4, v4, v5
    v_cmp_eq_u32 vcc, -1, v4
    v_smfmac_f32_16x16x64_bf16 v[80:83], v[212:215], v[164:171], v9
    s_cbranch_vccz .W_163
    s_branch .A_162
.W_167:
    v_smfmac_f32_16x16x64_bf16 v[76:79], v[200:203], a[208:215], v9
    v_smfmac_f32_16x16x64_bf16 v[80:83], v[200:203], a[240:247], v9
    s_waitcnt vmcnt(2)
    v_max3_u32 v4, v208, v209, v210
    v_max3_u32 v5, v211, v212, v213
    v_max3_u32 v4, v4, v214, v215
    v_smfmac_f32_16x16x64_bf16 v[76:79], v[204:207], a[216:223], v9
    v_max_u32 v4, v4, v5
    v_cmp_eq_u32 vcc, -1, v4
    v_smfmac_f32_16x16x64_bf16 v[80:83], v[204:207], a[248:255], v9
    s_cbranch_vccnz .A_170
.W_171:
    v_smfmac_f32_16x16x64_bf16 v[76:79], v[208:211], v[124:131], v9
    v_smfmac_f32_16x16x64_bf16 v[80:83], v[208:211], v[156:163], v9
    s_waitcnt vmcnt(0)
    v_max3_u32 v4, v192, v193, v194
    v_max3_u32 v5, v195, v196, v197
    v_max3_u32 v4, v4, v198, v199
    v_smfmac_f32_16x16x64_bf16 v[76:79], v[212:215], v[132:139], v9
    v_max_u32 v4, v4, v5
    v_cmp_eq_u32 vcc, -1, v4
    v_smfmac_f32_16x16x64_bf16 v[80:83], v[212:215], v[164:171], v9
    s_cbranch_vccz .W_159
    s_branch .A_158
.A_172:
    buffer_load_dwordx4 v[200:203], v246, s[8:11], s32 offen offset:2048 sc1
    buffer_load_dwordx4 v[204:207], v246, s[8:11], s32 offen offset:3072 sc1
    s_sub_u32 s62, s62, 1
    s_cbranch_scc1 .mg_end_1
    s_waitcnt vmcnt(4)
    v_max3_u32 v4, v216, v217, v218
    v_max3_u32 v5, v219, v220, v221
    v_max3_u32 v4, v4, v222, v223
    v_max_u32 v4, v4, v5
    v_cmp_eq_u32 vcc, -1, v4
    s_cbranch_vccz .W_161
.A_160:
    buffer_load_dwordx4 v[216:219], v246, s[8:11], s33 offen offset:2048 sc1
    buffer_load_dwordx4 v[220:223], v246, s[8:11], s33 offen offset:3072 sc1
    s_waitcnt vmcnt(4)
    v_max3_u32 v4, v192, v193, v194
    v_max3_u32 v5, v195, v196, v197
    v_max3_u32 v4, v4, v198, v199
    v_max_u32 v4, v4, v5
    v_cmp_eq_u32 vcc, -1, v4
    s_cbranch_vccz .W_173
.A_174:
    buffer_load_dwordx4 v[192:195], v246, s[8:11], s32 offen offset:0 sc1
    buffer_load_dwordx4 v[196:199], v246, s[8:11], s32 offen offset:1024 sc1
    s_waitcnt vmcnt(4)
    v_max3_u32 v4, v200, v201, v202
    v_max3_u32 v5, v203, v204, v205
    v_max3_u32 v4, v4, v206, v207
    v_max_u32 v4, v4, v5
    v_cmp_eq_u32 vcc, -1, v4
    s_cbranch_vccnz .A_172
.W_175:
    v_smfmac_f32_16x16x64_bf16 v[76:79], v[200:203], a[208:215], v9
    v_smfmac_f32_16x16x64_bf16 v[80:83], v[200:203], a[240:247], v9
    s_waitcnt vmcnt(2)
    v_max3_u32 v4, v216, v217, v218
    v_max3_u32 v5, v219, v220, v221
    v_max3_u32 v4, v4, v222, v223
    v_smfmac_f32_16x16x64_bf16 v[76:79], v[204:207], a[216:223], v9
    v_max_u32 v4, v4, v5
    v_cmp_eq_u32 vcc, -1, v4
    v_smfmac_f32_16x16x64_bf16 v[80:83], v[204:207], a[248:255], v9
    s_cbranch_vccz .W_157
    s_branch .A_156
.W_173:
    v_smfmac_f32_16x16x64_bf16 v[76:79], v[192:195], a[192:199], v9
    v_smfmac_f32_16x16x64_bf16 v[80:83], v[192:195], a[224:231], v9
    s_waitcnt vmcnt(2)
    v_max3_u32 v4, v200, v201, v202
    v_max3_u32 v5, v203, v204, v205
    v_max3_u32 v4, v4, v206, v207
    v_smfmac_f32_16x16x64_bf16 v[76:79], v[196:199], a[200:207], v9
    v_max_u32 v4, v4, v5
    v_cmp_eq_u32 vcc, -1, v4
    v_smfmac_f32_16x16x64_bf16 v[80:83], v[196:199], a[232:239], v9
    s_cbranch_vccnz .A_176
.W_177:
    v_smfmac_f32_16x16x64_bf16 v[76:79], v[200:203], a[208:215], v9
    v_smfmac_f32_16x16x64_bf16 v[80:83], v[200:203], a[240:247], v9
    s_waitcnt vmcnt(0)
    v_max3_u32 v4, v216, v217, v218
    v_max3_u32 v5, v219, v220, v221
    v_max3_u32 v4, v4, v222, v223
    v_smfmac_f32_16x16x64_bf16 v[76:79], v[204:207], a[216:223], v9
    v_max_u32 v4, v4, v5
    v_cmp_eq_u32 vcc, -1, v4
    v_smfmac_f32_16x16x64_bf16 v[80:83], v[204:207], a[248:255], v9
    s_cbranch_vccz .W_64
    s_branch .A_63
.A_178:
    buffer_load_dwordx4 v[216:219], v246, s[8:11], s33 offen offset:2048 sc1
    buffer_load_dwordx4 v[220:223], v246, s[8:11], s33 offen offset:3072 sc1
    s_sub_u32 s62, s62, 1
    s_cbranch_scc1 .mg_end_1
    s_waitcnt vmcnt(4)
    v_max3_u32 v4, v192, v193, v194
    v_max3_u32 v5, v195, v196, v197
    v_max3_u32 v4, v4, v198, v199
    v_max_u32 v4, v4, v5
    v_cmp_eq_u32 vcc, -1, v4
    s_cbranch_vccz .W_179
.A_180:
    buffer_load_dwordx4 v[192:195], v246, s[8:11], s32 offen offset:0 sc1
    buffer_load_dwordx4 v[196:199], v246, s[8:11], s32 offen offset:1024 sc1
    s_waitcnt vmcnt(4)
    v_max3_u32 v4, v208, v209, v210
    v_max3_u32 v5, v211, v212, v213
    v_max3_u32 v4, v4, v214, v215
    v_max_u32 v4, v4, v5
    v_cmp_eq_u32 vcc, -1, v4
    s_cbranch_vccz .W_155
.A_154:
    buffer_load_dwordx4 v[208:211], v246, s[8:11], s33 offen offset:0 sc1
    buffer_load_dwordx4 v[212:215], v246, s[8:11], s33 offen offset:1024 sc1
    s_waitcnt vmcnt(4)
    v_max3_u32 v4, v216, v217, v218
    v_max3_u32 v5, v219, v220, v221
    v_max3_u32 v4, v4, v222, v223
    v_max_u32 v4, v4, v5
    v_cmp_eq_u32 vcc, -1, v4
    s_cbranch_vccnz .A_178
.W_181:
    v_smfmac_f32_16x16x64_bf16 v[76:79], v[216:219], v[140:147], v9
    v_smfmac_f32_16x16x64_bf16 v[80:83], v[216:219], v[172:179], v9
    s_waitcnt vmcnt(2)
    v_max3_u32 v4, v192, v193, v194
    v_max3_u32 v5, v195, v196, v197
    v_max3_u32 v4, v4, v198, v199
    v_smfmac_f32_16x16x64_bf16 v[76:79], v[220:223], v[148:155], v9
    v_max_u32 v4, v4, v5
    v_cmp_eq_u32 vcc, -1, v4
    v_smfmac_f32_16x16x64_bf16 v[80:83], v[220:223], v[180:187], v9
    s_cbranch_vccnz .A_182
.W_183:
    v_smfmac_f32_16x16x64_bf16 v[76:79], v[192:195], a[192:199], v9
    v_smfmac_f32_16x16x64_bf16 v[80:83], v[192:195], a[224:231], v9
    s_waitcnt vmcnt(0)
    v_max3_u32 v4, v208, v209, v210
    v_max3_u32 v5, v211, v212, v213
    v_max3_u32 v4, v4, v214, v215
    v_smfmac_f32_16x16x64_bf16 v[76:79], v[196:199], a[200:207], v9
    v_max_u32 v4, v4, v5
    v_cmp_eq_u32 vcc, -1, v4
    v_smfmac_f32_16x16x64_bf16 v[80:83], v[196:199], a[232:239], v9
    s_cbranch_vccz .W_153
    s_branch .A_152
.W_179:
    v_smfmac_f32_16x16x64_bf16 v[76:79], v[192:195], a[192:199], v9
    v_smfmac_f32_16x16x64_bf16 v[80:83], v[192:195], a[224:231], v9
    s_waitcnt vmcnt(2)
    v_max3_u32 v4, v208, v209, v210
    v_max3_u32 v5, v211, v212, v213
    v_max3_u32 v4, v4, v214, v215
    v_smfmac_f32_16x16x64_bf16 v[76:79], v[196:199], a[200:207], v9
    v_max_u32 v4, v4, v5
    v_cmp_eq_u32 vcc, -1, v4
    v_smfmac_f32_16x16x64_bf16 v[80:83], v[196:199], a[232:239], v9
    s_cbranch_vccz .W_62
    s_branch .A_61
.A_184:
    buffer_load_dwordx4 v[216:219], v246, s[8:11], s33 offen offset:2048 sc1
    buffer_load_dwordx4 v[220:223], v246, s[8:11], s33 offen offset:3072 sc1
    s_sub_u32 s62, s62, 1
    s_cbranch_scc1 .mg_end_1
    s_waitcnt vmcnt(4)
    v_max3_u32 v4, v200, v201, v202
    v_max3_u32 v5, v203, v204, v205
    v_max3_u32 v4, v4, v206, v207
    v_max_u32 v4, v4, v5
    v_cmp_eq_u32 vcc, -1, v4
    s_cbranch_vccz .W_60
.A_59:
    buffer_load_dwordx4 v[200:203], v246, s[8:11], s32 offen offset:2048 sc1
    buffer_load_dwordx4 v[204:207], v246, s[8:11], s32 offen offset:3072 sc1
    s_waitcnt vmcnt(4)
    v_max3_u32 v4, v208, v209, v210
    v_max3_u32 v5, v211, v212, v213
    v_max3_u32 v4, v4, v214, v215
    v_max_u32 v4, v4, v5
    v_cmp_eq_u32 vcc, -1, v4
    s_cbranch_vccz .W_185
.A_186:
    buffer_load_dwordx4 v[208:211], v246, s[8:11], s33 offen offset:0 sc1
    buffer_load_dwordx4 v[212:215], v246, s[8:11], s33 offen offset:1024 sc1
    s_waitcnt vmcnt(4)
    v_max3_u32 v4, v216, v217, v218
    v_max3_u32 v5, v219, v220, v221
    v_max3_u32 v4, v4, v222, v223
    v_max_u32 v4, v4, v5
    v_cmp_eq_u32 vcc, -1, v4
    s_cbranch_vccnz .A_184
.W_187:
    v_smfmac_f32_16x16x64_bf16 v[76:79], v[216:219], v[140:147], v9
    v_smfmac_f32_16x16x64_bf16 v[80:83], v[216:219], v[172:179], v9
    s_waitcnt vmcnt(2)
    v_max3_u32 v4, v200, v201, v202
    v_max3_u32 v5, v203, v204, v205
    v_max3_u32 v4, v4, v206, v207
    v_smfmac_f32_16x16x64_bf16 v[76:79], v[220:223], v[148:155], v9
    v_max_u32 v4, v4, v5
    v_cmp_eq_u32 vcc, -1, v4
    v_smfmac_f32_16x16x64_bf16 v[80:83], v[220:223], v[180:187], v9
    s_cbranch_vccz .W_151
    s_branch .A_150
.W_185:
    v_smfmac_f32_16x16x64_bf16 v[76:79], v[208:211], v[124:131], v9
    v_smfmac_f32_16x16x64_bf16 v[80:83], v[208:211], v[156:163], v9
    s_waitcnt vmcnt(2)
    v_max3_u32 v4, v216, v217, v218
    v_max3_u32 v5, v219, v220, v221
    v_max3_u32 v4, v4, v222, v223
    v_smfmac_f32_16x16x64_bf16 v[76:79], v[212:215], v[132:139], v9
    v_max_u32 v4, v4, v5
    v_cmp_eq_u32 vcc, -1, v4
    v_smfmac_f32_16x16x64_bf16 v[80:83], v[212:215], v[164:171], v9
    s_cbranch_vccnz .A_188
.W_189:
    v_smfmac_f32_16x16x64_bf16 v[76:79], v[216:219], v[140:147], v9
    v_smfmac_f32_16x16x64_bf16 v[80:83], v[216:219], v[172:179], v9
    s_waitcnt vmcnt(0)
    v_max3_u32 v4, v200, v201, v202
    v_max3_u32 v5, v203, v204, v205
    v_max3_u32 v4, v4, v206, v207
    v_smfmac_f32_16x16x64_bf16 v[76:79], v[220:223], v[148:155], v9
    v_max_u32 v4, v4, v5
    v_cmp_eq_u32 vcc, -1, v4
    v_smfmac_f32_16x16x64_bf16 v[80:83], v[220:223], v[180:187], v9
    s_cbranch_vccz .W_165
    s_branch .A_164
.A_190:
    buffer_load_dwordx4 v[200:203], v246, s[8:11], s32 offen offset:2048 sc1
    buffer_load_dwordx4 v[204:207], v246, s[8:11], s32 offen offset:3072 sc1
    s_sub_u32 s62, s62, 1
    s_cbranch_scc1 .mg_end_1
    s_waitcnt vmcnt(2)
    v_max3_u32 v4, v192, v193, v194
    v_max3_u32 v5, v195, v196, v197
    v_max3_u32 v4, v4, v198, v199
    v_max_u32 v4, v4, v5
    v_cmp_eq_u32 vcc, -1, v4
    s_cbranch_vccz .W_163
.A_162:
    buffer_load_dwordx4 v[192:195], v246, s[8:11], s32 offen offset:0 sc1
    buffer_load_dwordx4 v[196:199], v246, s[8:11], s32 offen offset:1024 sc1
    s_waitcnt vmcnt(2)
    v_max3_u32 v4, v200, v201, v202
    v_max3_u32 v5, v203, v204, v205
    v_max3_u32 v4, v4, v206, v207
    v_max_u32 v4, v4, v5
    v_cmp_eq_u32 vcc, -1, v4
    s_cbranch_vccnz .A_190
.W_191:
    v_smfmac_f32_16x16x64_bf16 v[76:79], v[200:203], a[208:215], v9
    v_smfmac_f32_16x16x64_bf16 v[80:83], v[200:203], a[240:247], v9
    s_waitcnt vmcnt(0)
    v_max3_u32 v4, v192, v193, v194
    v_max3_u32 v5, v195, v196, v197
    v_max3_u32 v4, v4, v198, v199
    v_smfmac_f32_16x16x64_bf16 v[76:79], v[204:207], a[216:223], v9
    v_max_u32 v4, v4, v5
    v_cmp_eq_u32 vcc, -1, v4
    v_smfmac_f32_16x16x64_bf16 v[80:83], v[204:207], a[248:255], v9
    s_cbranch_vccz .W_159
    s_branch .A_158
.A_170:
    buffer_load_dwordx4 v[208:211], v246, s[8:11], s33 offen offset:0 sc1
    buffer_load_dwordx4 v[212:215], v246, s[8:11], s33 offen offset:1024 sc1
    s_sub_u32 s62, s62, 1
    s_cbranch_scc1 .mg_end_1
    s_waitcnt vmcnt(2)
    v_max3_u32 v4, v192, v193, v194
    v_max3_u32 v5, v195, v196, v197
    v_max3_u32 v4, v4, v198, v199
    v_max_u32 v4, v4, v5
    v_cmp_eq_u32 vcc, -1, v4
    s_cbranch_vccz .W_183
.A_182:
    buffer_load_dwordx4 v[192:195], v246, s[8:11], s32 offen offset:0 sc1
    buffer_load_dwordx4 v[196:199], v246, s[8:11], s32 offen offset:1024 sc1
    s_waitcnt vmcnt(2)
    v_max3_u32 v4, v208, v209, v210
    v_max3_u32 v5, v211, v212, v213
    v_max3_u32 v4, v4, v214, v215
    v_max_u32 v4, v4, v5
    v_cmp_eq_u32 vcc, -1, v4
    s_cbranch_vccnz .A_170
    s_branch .W_171
.A_192:
    buffer_load_dwordx4 v[192:195], v246, s[8:11], s32 offen offset:0 sc1
    buffer_load_dwordx4 v[196:199], v246, s[8:11], s32 offen offset:1024 sc1
    s_sub_u32 s62, s62, 1
    s_cbranch_scc1 .mg_end_1
    s_waitcnt vmcnt(2)
    v_max3_u32 v4, v216, v217, v218
    v_max3_u32 v5, v219, v220, v221
    v_max3_u32 v4, v4, v222, v223
    v_max_u32 v4, v4, v5
    v_cmp_eq_u32 vcc, -1, v4
    s_cbranch_vccz .W_157
.A_156:
    buffer_load_dwordx4 v[216:219], v246, s[8:11], s33 offen offset:2048 sc1
    buffer_load_dwordx4 v[220:223], v246, s[8:11], s33 offen offset:3072 sc1
    s_waitcnt vmcnt(2)
    v_max3_u32 v4, v192, v193, v194
    v_max3_u32 v5, v195, v196, v197
    v_max3_u32 v4, v4, v198, v199
    v_max_u32 v4, v4, v5
    v_cmp_eq_u32 vcc, -1, v4
    s_cbranch_vccnz .A_192
.W_193:
    v_smfmac_f32_16x16x64_bf16 v[76:79], v[192:195], a[192:199], v9
    v_smfmac_f32_16x16x64_bf16 v[80:83], v[192:195], a[224:231], v9
    s_waitcnt vmcnt(0)
    v_max3_u32 v4, v216, v217, v218
    v_max3_u32 v5, v219, v220, v221
    v_max3_u32 v4, v4, v222, v223
    v_smfmac_f32_16x16x64_bf16 v[76:79], v[196:199], a[200:207], v9
    v_max_u32 v4, v4, v5
    v_cmp_eq_u32 vcc, -1, v4
    v_smfmac_f32_16x16x64_bf16 v[80:83], v[196:199], a[232:239], v9
    s_cbranch_vccz .W_64
    s_branch .A_63
.A_194:
    buffer_load_dwordx4 v[208:211], v246, s[8:11], s33 offen offset:0 sc1
    buffer_load_dwordx4 v[212:215], v246, s[8:11], s33 offen offset:1024 sc1
    s_sub_u32 s62, s62, 1
    s_cbranch_scc1 .mg_end_1
    s_waitcnt vmcnt(2)
    v_max3_u32 v4, v200, v201, v202
    v_max3_u32 v5, v203, v204, v205
    v_max3_u32 v4, v4, v206, v207
    v_max_u32 v4, v4, v5
    v_cmp_eq_u32 vcc, -1, v4
    s_cbranch_vccz .W_151
.A_150:
    buffer_load_dwordx4 v[200:203], v246, s[8:11], s32 offen offset:2048 sc1
    buffer_load_dwordx4 v[204:207], v246, s[8:11], s32 offen offset:3072 sc1
    s_waitcnt vmcnt(2)
    v_max3_u32 v4, v208, v209, v210
    v_max3_u32 v5, v211, v212, v213
    v_max3_u32 v4, v4, v214, v215
    v_max_u32 v4, v4, v5
    v_cmp_eq_u32 vcc, -1, v4
    s_cbranch_vccnz .A_194
.W_195:
    v_smfmac_f32_16x16x64_bf16 v[76:79], v[208:211], v[124:131], v9
    v_smfmac_f32_16x16x64_bf16 v[80:83], v[208:211], v[156:163], v9
    s_waitcnt vmcnt(0)
    v_max3_u32 v4, v200, v201, v202
    v_max3_u32 v5, v203, v204, v205
    v_max3_u32 v4, v4, v206, v207
    v_smfmac_f32_16x16x64_bf16 v[76:79], v[212:215], v[132:139], v9
    v_max_u32 v4, v4, v5
    v_cmp_eq_u32 vcc, -1, v4
    v_smfmac_f32_16x16x64_bf16 v[80:83], v[212:215], v[164:171], v9
    s_cbranch_vccz .W_165
    s_branch .A_164
.A_188:
    buffer_load_dwordx4 v[216:219], v246, s[8:11], s33 offen offset:2048 sc1
    buffer_load_dwordx4 v[220:223], v246, s[8:11], s33 offen offset:3072 sc1
    s_sub_u32 s62, s62, 1
    s_cbranch_scc1 .mg_end_1
    s_waitcnt vmcnt(2)
    v_max3_u32 v4, v200, v201, v202
    v_max3_u32 v5, v203, v204, v205
    v_max3_u32 v4, v4, v206, v207
    v_max_u32 v4, v4, v5
    v_cmp_eq_u32 vcc, -1, v4
    s_cbranch_vccz .W_177
.A_176:
    buffer_load_dwordx4 v[200:203], v246, s[8:11], s32 offen offset:2048 sc1
    buffer_load_dwordx4 v[204:207], v246, s[8:11], s32 offen offset:3072 sc1
    s_waitcnt vmcnt(2)
    v_max3_u32 v4, v216, v217, v218
    v_max3_u32 v5, v219, v220, v221
    v_max3_u32 v4, v4, v222, v223
    v_max_u32 v4, v4, v5
    v_cmp_eq_u32 vcc, -1, v4
    s_cbranch_vccnz .A_188
    s_branch .W_189
.A_196:
    buffer_load_dwordx4 v[216:219], v246, s[8:11], s33 offen offset:2048 sc1
    buffer_load_dwordx4 v[220:223], v246, s[8:11], s33 offen offset:3072 sc1
    s_sub_u32 s62, s62, 1
    s_cbranch_scc1 .mg_end_1
    s_waitcnt vmcnt(2)
    v_max3_u32 v4, v208, v209, v210
    v_max3_u32 v5, v211, v212, v213
    v_max3_u32 v4, v4, v214, v215
    v_max_u32 v4, v4, v5
    v_cmp_eq_u32 vcc, -1, v4
    s_cbranch_vccz .W_62
.A_61:
    buffer_load_dwordx4 v[208:211], v246, s[8:11], s33 offen offset:0 sc1
    buffer_load_dwordx4 v[212:215], v246, s[8:11], s33 offen offset:1024 sc1
    s_waitcnt vmcnt(2)
    v_max3_u32 v4, v216, v217, v218
    v_max3_u32 v5, v219, v220, v221
    v_max3_u32 v4, v4, v222, v223
    v_max_u32 v4, v4, v5
    v_cmp_eq_u32 vcc, -1, v4
    s_cbranch_vccnz .A_196
.W_197:
    v_smfmac_f32_16x16x64_bf16 v[76:79], v[216:219], v[140:147], v9
    v_smfmac_f32_16x16x64_bf16 v[80:83], v[216:219], v[172:179], v9
    s_waitcnt vmcnt(0)
    v_max3_u32 v4, v208, v209, v210
    v_max3_u32 v5, v211, v212, v213
    v_max3_u32 v4, v4, v214, v215
    v_smfmac_f32_16x16x64_bf16 v[76:79], v[220:223], v[148:155], v9
    v_max_u32 v4, v4, v5
    v_cmp_eq_u32 vcc, -1, v4
    v_smfmac_f32_16x16x64_bf16 v[80:83], v[220:223], v[180:187], v9
    s_cbranch_vccz .W_153
    s_branch .A_152
.A_158:
    buffer_load_dwordx4 v[192:195], v246, s[8:11], s32 offen offset:0 sc1
    buffer_load_dwordx4 v[196:199], v246, s[8:11], s32 offen offset:1024 sc1
    s_sub_u32 s62, s62, 1
    s_cbranch_scc1 .mg_end_1
    s_waitcnt vmcnt(2)
    v_max3_u32 v4, v192, v193, v194
    v_max3_u32 v5, v195, v196, v197
    v_max3_u32 v4, v4, v198, v199
    v_max_u32 v4, v4, v5
    v_cmp_eq_u32 vcc, -1, v4
    s_cbranch_vccnz .A_158
    v_smfmac_f32_16x16x64_bf16 v[76:79], v[192:195], a[192:199], v9
    v_smfmac_f32_16x16x64_bf16 v[80:83], v[192:195], a[224:231], v9
    v_smfmac_f32_16x16x64_bf16 v[76:79], v[196:199], a[200:207], v9
    v_smfmac_f32_16x16x64_bf16 v[80:83], v[196:199], a[232:239], v9
    s_branch .mj_56
.A_164:
    buffer_load_dwordx4 v[200:203], v246, s[8:11], s32 offen offset:2048 sc1
    buffer_load_dwordx4 v[204:207], v246, s[8:11], s32 offen offset:3072 sc1
    s_sub_u32 s62, s62, 1
    s_cbranch_scc1 .mg_end_1
    s_waitcnt vmcnt(2)
    v_max3_u32 v4, v200, v201, v202
    v_max3_u32 v5, v203, v204, v205
    v_max3_u32 v4, v4, v206, v207
    v_max_u32 v4, v4, v5
    v_cmp_eq_u32 vcc, -1, v4
    s_cbranch_vccnz .A_164
    v_smfmac_f32_16x16x64_bf16 v[76:79], v[200:203], a[208:215], v9
    v_smfmac_f32_16x16x64_bf16 v[80:83], v[200:203], a[240:247], v9
    v_smfmac_f32_16x16x64_bf16 v[76:79], v[204:207], a[216:223], v9
    v_smfmac_f32_16x16x64_bf16 v[80:83], v[204:207], a[248:255], v9
    s_branch .mj_56
.A_152:
    buffer_load_dwordx4 v[208:211], v246, s[8:11], s33 offen offset:0 sc1
    buffer_load_dwordx4 v[212:215], v246, s[8:11], s33 offen offset:1024 sc1
    s_sub_u32 s62, s62, 1
    s_cbranch_scc1 .mg_end_1
    s_waitcnt vmcnt(2)
    v_max3_u32 v4, v208, v209, v210
    v_max3_u32 v5, v211, v212, v213
    v_max3_u32 v4, v4, v214, v215
    v_max_u32 v4, v4, v5
    v_cmp_eq_u32 vcc, -1, v4
    s_cbranch_vccnz .A_152
    v_smfmac_f32_16x16x64_bf16 v[76:79], v[208:211], v[124:131], v9
    v_smfmac_f32_16x16x64_bf16 v[80:83], v[208:211], v[156:163], v9
    v_smfmac_f32_16x16x64_bf16 v[76:79], v[212:215], v[132:139], v9
    v_smfmac_f32_16x16x64_bf16 v[80:83], v[212:215], v[164:171], v9
    s_branch .mj_56
.A_63:
    buffer_load_dwordx4 v[216:219], v246, s[8:11], s33 offen offset:2048 sc1
    buffer_load_dwordx4 v[220:223], v246, s[8:11], s33 offen offset:3072 sc1
    s_sub_u32 s62, s62, 1
    s_cbranch_scc1 .mg_end_1
    s_waitcnt vmcnt(2)
    v_max3_u32 v4, v216, v217, v218
    v_max3_u32 v5, v219, v220, v221
    v_max3_u32 v4, v4, v222, v223
    v_max_u32 v4, v4, v5
    v_cmp_eq_u32 vcc, -1, v4
    s_cbranch_vccnz .A_63
    v_smfmac_f32_16x16x64_bf16 v[76:79], v[216:219], v[140:147], v9
    v_smfmac_f32_16x16x64_bf16 v[80:83], v[216:219], v[172:179], v9
    v_smfmac_f32_16x16x64_bf16 v[76:79], v[220:223], v[148:155], v9
    v_smfmac_f32_16x16x64_bf16 v[80:83], v[220:223], v[180:187], v9
    s_branch .mj_56
.sk_65:
    s_mov_b64 exec, s[66:67]
    buffer_store_dwordx4 v[88:91], v11, s[8:11], s36 offen sc1
    s_mov_b64 exec, s[56:57]
    buffer_store_dwordx4 v[172:175], v12, s[8:11], s36 offen sc1
    s_mov_b64 exec, -1

    s_branch .rec_fin_6
.p2align 6
.top_198:
    s_barrier
    buffer_load_dwordx4 v[20:23], v8, s[8:11], s29 offen offset:0 sc1
    v_mov_b32 v52, 0
    buffer_load_dwordx4 v[24:27], v8, s[8:11], s29 offen offset:1024 sc1
    v_mov_b32 v53, 0
    buffer_load_dwordx4 v[28:31], v8, s[8:11], s29 offen offset:2048 sc1
    v_mov_b32 v54, 0
    buffer_load_dwordx4 v[32:35], v8, s[8:11], s29 offen offset:3072 sc1
.ent1_26:
    s_waitcnt vmcnt(3)
    v_max3_u32 v4, v20, v21, v22
    v_max_u32 v4, v4, v23
    v_cmp_eq_u32 vcc, -1, v4
    s_cbranch_vccnz .A_203
.W_204:
    v_smfmac_f32_16x16x64_bf16 v[52:55], v[20:23], a[0:7], v9
    v_smfmac_f32_16x16x64_bf16 v[56:59], v[20:23], a[32:39], v9
    s_waitcnt vmcnt(2)
    v_max3_u32 v4, v24, v25, v26
    v_max_u32 v4, v4, v27
    v_smfmac_f32_16x16x64_bf16 v[60:63], v[20:23], a[64:71], v9
    v_cmp_eq_u32 vcc, -1, v4
    v_smfmac_f32_16x16x64_bf16 v[64:67], v[20:23], a[96:103], v9
    s_cbranch_vccnz .A_205
.W_206:
    v_smfmac_f32_16x16x64_bf16 v[52:55], v[24:27], a[8:15], v9
    v_smfmac_f32_16x16x64_bf16 v[56:59], v[24:27], a[40:47], v9
    s_waitcnt vmcnt(1)
    v_max3_u32 v4, v28, v29, v30
    v_max_u32 v4, v4, v31
    v_smfmac_f32_16x16x64_bf16 v[60:63], v[24:27], a[72:79], v9
    v_cmp_eq_u32 vcc, -1, v4
    v_smfmac_f32_16x16x64_bf16 v[64:67], v[24:27], a[104:111], v9
    s_cbranch_vccnz .A_207
.W_208:
    v_smfmac_f32_16x16x64_bf16 v[52:55], v[28:31], a[16:23], v9
    v_smfmac_f32_16x16x64_bf16 v[56:59], v[28:31], a[48:55], v9
    s_waitcnt vmcnt(0)
    v_max3_u32 v4, v32, v33, v34
    v_max_u32 v4, v4, v35
    v_smfmac_f32_16x16x64_bf16 v[60:63], v[28:31], a[80:87], v9
    v_cmp_eq_u32 vcc, -1, v4
    v_smfmac_f32_16x16x64_bf16 v[64:67], v[28:31], a[112:119], v9
    s_cbranch_vccnz .A_209
.W_210:
    v_smfmac_f32_16x16x64_bf16 v[52:55], v[32:35], a[24:31], v9
    v_smfmac_f32_16x16x64_bf16 v[56:59], v[32:35], a[56:63], v9
    v_smfmac_f32_16x16x64_bf16 v[60:63], v[32:35], a[88:95], v9
    v_smfmac_f32_16x16x64_bf16 v[64:67], v[32:35], a[120:127], v9
.mj_202:
    v_cvt_pk_bf16_f32 v104, v52, v53
    v_cvt_pk_bf16_f32 v105, v54, v55
    v_cvt_pk_bf16_f32 v106, v56, v57
    v_cvt_pk_bf16_f32 v107, v58, v59
    ds_write_b64 v16, v[104:105] offset:4096
    v_cvt_pk_bf16_f32 v108, v60, v61
    v_cvt_pk_bf16_f32 v109, v62, v63
    ds_write_b64 v16, v[106:107] offset:6144
    ds_write_b64 v16, v[108:109] offset:0
    v_cvt_pk_bf16_f32 v110, v64, v65
    v_cvt_pk_bf16_f32 v111, v66, v67
    ds_write_b64 v16, v[110:111] offset:2048
    v_smfmac_f32_16x16x64_bf16 v[68:71], v[20:23], a[128:135], v9
    v_smfmac_f32_16x16x64_bf16 v[72:75], v[20:23], a[160:167], v9
    s_waitcnt lgkmcnt(0)
    s_barrier
    ds_read_b128 v[36:39], v17 offset:0
    ds_read_b128 v[40:43], v17 offset:1024
    v_smfmac_f32_16x16x64_bf16 v[68:71], v[24:27], a[136:143], v9
    v_smfmac_f32_16x16x64_bf16 v[72:75], v[24:27], a[168:175], v9
    s_waitcnt lgkmcnt(1)
    v_mfma_f32_16x16x32_bf16 v[44:47], v[36:39], v[84:87], 0
    s_waitcnt lgkmcnt(0)
    v_mfma_f32_16x16x32_bf16 v[44:47], v[40:43], v[84:87], v[44:47]
    v_smfmac_f32_16x16x64_bf16 v[68:71], v[28:31], a[144:151], v9
    v_smfmac_f32_16x16x64_bf16 v[72:75], v[28:31], a[176:183], v9
    s_mov_b64 exec, s[64:65]
    v_cvt_pk_bf16_f32 v48, v44, v45
    v_cvt_pk_bf16_f32 v49, v46, v47
    v_min_u32 v48, 0xfffffffe, v48
    v_min_u32 v49, 0xfffffffe, v49
    buffer_store_dwordx2 v[48:49], v10, s[8:11], s29 offen sc1

    ds_write_b64 v18, v[48:49]
    s_mov_b64 exec, -1

    v_smfmac_f32_16x16x64_bf16 v[68:71], v[32:35], a[152:159], v9
    v_smfmac_f32_16x16x64_bf16 v[72:75], v[32:35], a[184:191], v9
    s_nop 3
    v_cvt_pk_bf16_f32 v104, v68, v69
    v_cvt_pk_bf16_f32 v105, v70, v71
    ds_write_b64 v16, v[104:105] offset:8192
    s_nop 0
    v_cvt_pk_bf16_f32 v106, v72, v73
    v_cvt_pk_bf16_f32 v107, v74, v75
    ds_write_b64 v16, v[106:107] offset:10240
    s_cmp_lg_u32 s24, 2
    s_waitcnt lgkmcnt(0)
    s_barrier
    s_cbranch_scc1 .oth_199
    buffer_load_dwordx4 v[92:95], v232, s[8:11], s29 offen sc1
    buffer_load_dwordx4 v[96:99], v233, s[8:11], s29 offen sc1
    buffer_load_dwordx4 v[100:103], v234, s[8:11], s29 offen sc1
    ds_read_b128 v[88:91], v14 offset:16384
    s_cmp_eq_u32 s28, 63
    s_cbranch_scc1 .rec_fin_6
    s_waitcnt lgkmcnt(0)
    v_mfma_f32_16x16x32_bf16 v[208:211], v[128:131], v[88:91], 0
    v_mfma_f32_16x16x32_bf16 v[212:215], v[144:147], v[88:91], 0
    v_mfma_f32_16x16x32_bf16 v[216:219], v[88:91], v[88:91], v[116:119]
    s_waitcnt vmcnt(2)
    v_max3_u32 v4, v92, v93, v94
    v_max_u32 v4, v4, v95
    v_cmp_eq_u32 vcc, -1, v4
    s_cbranch_vccnz .A_212
.W_213:
    v_mfma_f32_16x16x32_bf16 v[208:211], v[132:135], v[92:95], v[208:211]
    s_waitcnt vmcnt(1)
    v_max3_u32 v4, v96, v97, v98
    v_max_u32 v4, v4, v99
    v_mfma_f32_16x16x32_bf16 v[212:215], v[148:151], v[92:95], v[212:215]
    v_cmp_eq_u32 vcc, -1, v4
    v_mfma_f32_16x16x32_bf16 v[216:219], v[92:95], v[92:95], v[216:219]
    s_cbranch_vccnz .A_214
.W_215:
    v_mfma_f32_16x16x32_bf16 v[208:211], v[136:139], v[96:99], v[208:211]
    s_waitcnt vmcnt(0)
    v_max3_u32 v4, v100, v101, v102
    v_max_u32 v4, v4, v103
    v_mfma_f32_16x16x32_bf16 v[212:215], v[152:155], v[96:99], v[212:215]
    v_cmp_eq_u32 vcc, -1, v4
    v_mfma_f32_16x16x32_bf16 v[216:219], v[96:99], v[96:99], v[216:219]
    s_cbranch_vccnz .A_216
.W_217:
    v_mfma_f32_16x16x32_bf16 v[208:211], v[140:143], v[100:103], v[208:211]
    v_mfma_f32_16x16x32_bf16 v[212:215], v[156:159], v[100:103], v[212:215]
    v_mfma_f32_16x16x32_bf16 v[216:219], v[100:103], v[100:103], v[216:219]
.mj_211:
    s_barrier
    ds_read_b64 v[168:169], v14 offset:18432
    ds_read_b64 v[172:173], v14 offset:18440
    s_nop 0

    v_mov_b32_dpp v208, v212 row_ror:8 row_mask:0xf bank_mask:0xc
    v_mov_b32_dpp v209, v213 row_ror:8 row_mask:0xf bank_mask:0xc
    v_mov_b32_dpp v210, v214 row_ror:8 row_mask:0xf bank_mask:0xc
    v_mov_b32_dpp v211, v215 row_ror:8 row_mask:0xf bank_mask:0xc
    v_mov_b32_dpp v216, v218 row_ror:8 row_mask:0xf bank_mask:0xc
    v_mov_b32_dpp v217, v219 row_ror:8 row_mask:0xf bank_mask:0xc
    v_max3_f32 v4, v208, v209, v210
    v_max3_f32 v5, v211, v216, v217
    v_max_f32 v6, v4, v5
    v_max_f32 v4, v4, v5
    s_nop 1
    v_permlane32_swap_b32 v4, v6
    v_max_f32 v5, v4, v6
    v_max_f32 v4, v4, v6
    s_nop 1
    v_permlane16_swap_b32 v4, v5
    v_max_f32 v4, v4, v5
    s_nop 1
    v_max_f32_dpp v4, v4, v4 row_ror:8 row_mask:0xf bank_mask:0xf
    v_mul_f32 v4, s37, v4

    v_fma_f32 v104, v208, s37, -v4
    v_fma_f32 v105, v209, s37, -v4
    v_fma_f32 v106, v210, s37, -v4
    v_fma_f32 v107, v211, s37, -v4
    v_fma_f32 v108, v216, s37, -v4
    v_fma_f32 v109, v217, s37, -v4
    v_exp_f32 v104, v104
    v_exp_f32 v105, v105
    v_exp_f32 v106, v106
    v_exp_f32 v107, v107
    v_exp_f32 v108, v108
    v_exp_f32 v109, v109
    v_cvt_pk_bf16_f32 v176, v104, v105
    v_cvt_pk_bf16_f32 v177, v106, v107
    v_cvt_pk_bf16_f32 v180, v108, v109
    v_mov_b32_dpp v178, v176 row_ror:8 row_mask:0xf bank_mask:0xf
    v_mov_b32_dpp v179, v177 row_ror:8 row_mask:0xf bank_mask:0xf
    v_mov_b32_dpp v181, v180 row_ror:8 row_mask:0xf bank_mask:0xf
    s_waitcnt lgkmcnt(0)

    v_mfma_f32_16x16x32_bf16 v[208:211], v[120:123], v[176:179], 0
    v_mfma_f32_16x16x32_bf16 v[208:211], v[120:123], v[180:183], v[208:211]
    v_mfma_f32_16x16x32_bf16 v[212:215], v[160:163], v[176:179], 0
    v_mfma_f32_16x16x32_bf16 v[216:219], v[164:167], v[176:179], 0
    v_mfma_f32_16x16x32_bf16 v[212:215], v[168:171], v[180:183], v[212:215]
    v_rcp_f32 v4, v208
    v_mfma_f32_16x16x32_bf16 v[216:219], v[172:175], v[180:183], v[216:219]
    s_mov_b64 exec, s[58:59]
    s_nop 2
    v_mul_f32 v212, v4, v212
    v_mul_f32 v213, v4, v213
    v_mul_f32 v214, v4, v214
    v_mul_f32 v215, v4, v215
    v_cvt_pk_bf16_f32 v184, v212, v213
    v_cvt_pk_bf16_f32 v185, v214, v215
    v_mul_f32 v216, v4, v216
    v_mul_f32 v217, v4, v217
    v_min_u32 v184, 0xfffffffe, v184
    v_min_u32 v185, 0xfffffffe, v185
    v_mul_f32 v218, v4, v218
    v_mul_f32 v219, v4, v219
    v_cvt_pk_bf16_f32 v186, v216, v217
    v_cvt_pk_bf16_f32 v187, v218, v219
    v_min_u32 v186, 0xfffffffe, v186
    v_min_u32 v187, 0xfffffffe, v187
    buffer_store_dwordx4 v[184:187], v13, s[8:11], s29 offen sc1
    s_mov_b64 exec, -1

.gp_201:
    s_barrier
    s_mov_b32 s99, s68
    s_add_u32 s28, s28, 1
    s_add_u32 s36, s36, 196608
    s_cmp_lt_u32 s28, 63
    s_cselect_b32 s4, 262144, 0
    s_add_u32 s38, s38, s4
    s_add_u32 s39, s39, s4
    s_add_u32 s30, s30, s4
    s_mov_b32 s4, s68
    s_mov_b32 s68, s69
    s_mov_b32 s69, s70
    s_mov_b32 s70, s71
    s_mov_b32 s71, s4
    s_and_b32 s4, s28, 3
    s_lshl_b32 s5, s4, 16
    s_add_u32 s29, s5, s34
    s_xor_b32 s6, s5, 0x20000
    s_add_u32 s31, s6, s34
    s_add_u32 s32, s29, 16384
    s_add_u32 s33, s29, 20480
    s_waitcnt vmcnt(0)
    s_cmp_eq_u32 s24, 3
    s_cbranch_scc1 .u3_218
    s_barrier
    buffer_load_dword v226, v225, s[8:11], s30 offen
    s_add_u32 s4, s69, 0
    buffer_store_dwordx4 v[188:191], v238, s[8:11], s4 offen sc1
    s_add_u32 s4, s69, 262144
    buffer_store_dwordx4 v[188:191], v238, s[8:11], s4 offen sc1
    s_branch .u4_219
.u3_218:
    s_sub_u32 s4, s36, 196608
    s_barrier
    s_mov_b64 exec, s[66:67]
    buffer_store_dwordx4 v[88:91], v11, s[8:11], s4 offen sc1
    s_mov_b64 exec, s[56:57]
    buffer_store_dwordx4 v[172:175], v12, s[8:11], s4 offen sc1
    s_mov_b64 exec, -1

.u4_219:
    s_barrier
    ds_read_b128 v[108:111], v248
    ds_read_b128 v[128:131], v228 offset:0
    ds_read_b128 v[144:147], v228 offset:4096
    ds_read_b128 v[132:135], v229 offset:0
    ds_read_b128 v[148:151], v229 offset:4096
    ds_read_b128 v[136:139], v230 offset:0
    ds_read_b128 v[152:155], v230 offset:4096
    ds_read_b128 v[140:143], v231 offset:0
    ds_read_b128 v[156:159], v231 offset:4096
    ds_read_b128 v[160:163], v14 offset:28672
    ds_read_b128 v[164:167], v14 offset:29696
    v_mov_b32 v55, 0
    v_mov_b32 v56, 0
    v_mov_b32 v57, 0
    v_mov_b32 v58, 0
    v_mov_b32 v59, 0
    v_mov_b32 v60, 0
    v_mov_b32 v61, 0
    v_mov_b32 v62, 0
    v_mov_b32 v63, 0
    v_mov_b32 v64, 0
    v_mov_b32 v65, 0
    v_mov_b32 v66, 0
    v_mov_b32 v67, 0
    v_mov_b32 v68, 0
    v_mov_b32 v69, 0
    v_mov_b32 v70, 0
    v_mov_b32 v71, 0
    v_mov_b32 v72, 0
    v_mov_b32 v73, 0
    v_mov_b32 v74, 0
    v_mov_b32 v75, 0
    v_mov_b32 v20, -1
    v_mov_b32 v21, -1
    v_mov_b32 v22, -1
    v_mov_b32 v23, -1
    v_mov_b32 v24, -1
    v_mov_b32 v25, -1
    v_mov_b32 v26, -1
    v_mov_b32 v27, -1
    v_mov_b32 v28, -1
    s_add_u32 s4, s99, 0
    buffer_load_dwordx4 v[192:195], v239, s[8:11], s4 offen sc1
    buffer_load_dwordx4 v[196:199], v249, s[8:11], s4 offen sc1

    v_mov_b32 v29, -1
    v_mov_b32 v30, -1
    v_mov_b32 v31, -1
    v_mov_b32 v32, -1
    v_mov_b32 v33, -1
    v_mov_b32 v34, -1
    v_mov_b32 v35, -1
    v_mov_b32 v92, -1
    v_mov_b32 v93, -1
    v_mov_b32 v94, -1
    v_mov_b32 v95, -1
    v_mov_b32 v96, -1
    v_mov_b32 v97, -1
    v_mov_b32 v98, -1
    v_mov_b32 v99, -1
    v_mov_b32 v100, -1
    v_mov_b32 v101, -1
    v_mov_b32 v102, -1
    v_mov_b32 v103, -1
    s_add_u32 s4, s99, 262144
    buffer_load_dwordx4 v[200:203], v239, s[8:11], s4 offen sc1
    buffer_load_dwordx4 v[204:207], v249, s[8:11], s4 offen sc1

    s_waitcnt lgkmcnt(0)
    v_mfma_f32_16x16x32_bf16 v[76:79], v[108:111], v[112:115], 0
.gc_220:
    s_waitcnt vmcnt(2)

    v_max_u32 v4, v192, v196
    v_cmp_eq_u32 vcc, -1, v4
    s_cbranch_vccnz .gf_221
    v_mfma_f32_16x16x32_bf16 v[76:79], v[192:195], v[84:87], v[76:79]
    v_mfma_f32_16x16x32_bf16 v[76:79], v[196:199], v[112:115], v[76:79]
    s_mov_b64 exec, s[58:59]
    s_nop 6
    v_cvt_pk_bf16_f32 v104, v76, v77
    v_cvt_pk_bf16_f32 v105, v78, v79
    v_min_u32 v104, 0xfffffffe, v104
    v_min_u32 v105, 0xfffffffe, v105
    buffer_store_dwordx2 v[104:105], v15, s[8:11], s29 offen sc1
    s_mov_b64 exec, -1

    s_branch .top_198
.gf_221:
    s_add_u32 s4, s99, 0
    buffer_load_dwordx4 v[192:195], v239, s[8:11], s4 offen sc1
    buffer_load_dwordx4 v[196:199], v249, s[8:11], s4 offen sc1

    s_waitcnt vmcnt(2)

    v_max_u32 v4, v200, v204
    v_cmp_eq_u32 vcc, -1, v4
    s_cbranch_vccnz .gf_222
    v_mfma_f32_16x16x32_bf16 v[76:79], v[200:203], v[84:87], v[76:79]
    v_mfma_f32_16x16x32_bf16 v[76:79], v[204:207], v[112:115], v[76:79]
    s_mov_b64 exec, s[58:59]
    s_nop 6
    v_cvt_pk_bf16_f32 v104, v76, v77
    v_cvt_pk_bf16_f32 v105, v78, v79
    v_min_u32 v104, 0xfffffffe, v104
    v_min_u32 v105, 0xfffffffe, v105
    buffer_store_dwordx2 v[104:105], v15, s[8:11], s29 offen sc1
    s_mov_b64 exec, -1

    s_branch .top_198
.gf_222:
    s_add_u32 s4, s99, 262144
    buffer_load_dwordx4 v[200:203], v239, s[8:11], s4 offen sc1
    buffer_load_dwordx4 v[204:207], v249, s[8:11], s4 offen sc1

    s_sub_u32 s62, s62, 1
    s_cbranch_scc1 .mg_end_1
    s_branch .gc_220
.oth_199:
    s_cmp_eq_u32 s24, 3
    s_cbranch_scc1 .w3_200
    s_cmp_eq_u32 s28, 63
    s_cbranch_scc1 .rec_fin_6
    s_waitcnt vmcnt(0)
    v_readlane_b32 s4, v244, 0
    v_readlane_b32 s93, v244, 1
    s_min_u32 s93, s93, s4
    v_mov_b32 v20, -1
    v_mov_b32 v21, -1
    v_mov_b32 v22, -1
    v_mov_b32 v23, -1
    v_mov_b32 v24, -1
    v_mov_b32 v25, -1
    v_mov_b32 v26, -1
    v_mov_b32 v27, -1
    v_mov_b32 v28, -1
    v_mov_b32 v29, -1
    v_mov_b32 v30, -1
    v_mov_b32 v31, -1
    v_mov_b32 v32, -1
    v_mov_b32 v33, -1
    v_mov_b32 v34, -1
    v_mov_b32 v35, -1
    v_mov_b32 v55, 0
    v_mov_b32 v56, 0
    v_mov_b32 v57, 0
    v_mov_b32 v58, 0
    v_mov_b32 v59, 0
    v_mov_b32 v60, 0
    v_mov_b32 v61, 0
    v_mov_b32 v62, 0
    v_mov_b32 v63, 0
    v_mov_b32 v64, 0
    v_mov_b32 v65, 0
    v_mov_b32 v66, 0
    v_mov_b32 v67, 0
    v_mov_b32 v68, 0
    v_mov_b32 v69, 0
    v_mov_b32 v70, 0
    v_mov_b32 v71, 0
    v_mov_b32 v72, 0
    v_mov_b32 v73, 0
    v_mov_b32 v74, 0
    v_mov_b32 v75, 0
    s_barrier
    s_add_u32 s6, s28, 3
    s_min_u32 s6, s6, 64
    s_cmp_lt_u32 s93, s6
    s_cbranch_scc1 .kf_223
.kb_224:
    s_mov_b32 m0, s90
    s_nop 0
    buffer_load_dwordx4 v14, s[8:11], s38 offen offset:0 lds
    buffer_load_dwordx4 v14, s[8:11], s38 offen offset:1024 lds
    buffer_load_dwordx4 v14, s[8:11], s38 offen offset:2048 lds
    buffer_load_dwordx4 v14, s[8:11], s38 offen offset:3072 lds
    s_mov_b32 m0, s91
    s_nop 0
    buffer_load_dwordx4 v14, s[8:11], s39 offen lds
    s_bfe_u32 s12, s28, 0x10001
    s_add_u32 s6, s28, 6
    s_cmp_ge_u32 s93, s6
    s_cbranch_scc1 .nl_225
    s_mov_b64 exec, 3
    buffer_load_dword v244, v253, s[8:11], s89 offen sc1
    s_mov_b64 exec, -1

.nl_225:
    s_waitcnt lgkmcnt(0)
    s_barrier
    buffer_load_dwordx4 v[192:195], v246, s[8:11], s32 offen offset:0 sc1
    buffer_load_dwordx4 v[196:199], v246, s[8:11], s32 offen offset:1024 sc1
    v_mov_b32 v76, 0
    buffer_load_dwordx4 v[200:203], v246, s[8:11], s32 offen offset:2048 sc1
    buffer_load_dwordx4 v[204:207], v246, s[8:11], s32 offen offset:3072 sc1
    v_mov_b32 v77, 0
    buffer_load_dwordx4 v[208:211], v246, s[8:11], s33 offen offset:0 sc1
    buffer_load_dwordx4 v[212:215], v246, s[8:11], s33 offen offset:1024 sc1
    v_mov_b32 v78, 0
    buffer_load_dwordx4 v[216:219], v246, s[8:11], s33 offen offset:2048 sc1
    buffer_load_dwordx4 v[220:223], v246, s[8:11], s33 offen offset:3072 sc1
    s_waitcnt vmcnt(6)
    v_max3_u32 v4, v192, v193, v194
    v_max3_u32 v5, v195, v196, v197
    v_max3_u32 v4, v4, v198, v199
    v_max_u32 v4, v4, v5
    v_cmp_eq_u32 vcc, -1, v4
    s_cbranch_vccnz .A_227
.W_228:
    v_smfmac_f32_16x16x64_bf16 v[76:79], v[192:195], a[192:199], v9
    v_smfmac_f32_16x16x64_bf16 v[80:83], v[192:195], a[224:231], v9
    s_waitcnt vmcnt(4)
    v_max3_u32 v4, v200, v201, v202
    v_max3_u32 v5, v203, v204, v205
    v_max3_u32 v4, v4, v206, v207
    v_smfmac_f32_16x16x64_bf16 v[76:79], v[196:199], a[200:207], v9
    v_max_u32 v4, v4, v5
    v_cmp_eq_u32 vcc, -1, v4
    v_smfmac_f32_16x16x64_bf16 v[80:83], v[196:199], a[232:239], v9
    s_cbranch_vccnz .A_229
.W_230:
    v_smfmac_f32_16x16x64_bf16 v[76:79], v[200:203], a[208:215], v9
    v_smfmac_f32_16x16x64_bf16 v[80:83], v[200:203], a[240:247], v9
    s_waitcnt vmcnt(2)
    v_max3_u32 v4, v208, v209, v210
    v_max3_u32 v5, v211, v212, v213
    v_max3_u32 v4, v4, v214, v215
    v_smfmac_f32_16x16x64_bf16 v[76:79], v[204:207], a[216:223], v9
    v_max_u32 v4, v4, v5
    v_cmp_eq_u32 vcc, -1, v4
    v_smfmac_f32_16x16x64_bf16 v[80:83], v[204:207], a[248:255], v9
    s_cbranch_vccnz .A_231
.W_232:
    v_smfmac_f32_16x16x64_bf16 v[76:79], v[208:211], v[124:131], v9
    v_smfmac_f32_16x16x64_bf16 v[80:83], v[208:211], v[156:163], v9
    s_waitcnt vmcnt(0)
    v_max3_u32 v4, v216, v217, v218
    v_max3_u32 v5, v219, v220, v221
    v_max3_u32 v4, v4, v222, v223
    v_smfmac_f32_16x16x64_bf16 v[76:79], v[212:215], v[132:139], v9
    v_max_u32 v4, v4, v5
    v_cmp_eq_u32 vcc, -1, v4
    v_smfmac_f32_16x16x64_bf16 v[80:83], v[212:215], v[164:171], v9
    s_cbranch_vccnz .A_233
.W_234:
    v_smfmac_f32_16x16x64_bf16 v[76:79], v[216:219], v[140:147], v9
    v_smfmac_f32_16x16x64_bf16 v[80:83], v[216:219], v[172:179], v9
    v_smfmac_f32_16x16x64_bf16 v[76:79], v[220:223], v[148:155], v9
    v_smfmac_f32_16x16x64_bf16 v[80:83], v[220:223], v[180:187], v9
.mj_226:
    s_barrier
    s_nop 7
    v_permlane32_swap_b32 v76, v80
    v_permlane32_swap_b32 v77, v81
    v_permlane32_swap_b32 v78, v82
    v_permlane32_swap_b32 v79, v83
    v_add_f32 v76, v76, v80
    v_add_f32 v77, v77, v81
    v_add_f32 v78, v78, v82
    v_add_f32 v79, v79, v83
    v_cvt_pk_bf16_f32 v104, v76, v77
    v_cvt_pk_bf16_f32 v106, v76, v77
    v_cvt_pk_bf16_f32 v105, v78, v79
    v_cvt_pk_bf16_f32 v107, v78, v79
    v_permlane16_swap_b32 v104, v106
    s_nop 0
    v_permlane16_swap_b32 v105, v107
    v_min_u32 v104, 0xfffffffe, v104
    buffer_store_dwordx4 v[104:107], v237, s[8:11], s68 offen sc1

    ds_write_b128 v247, v[104:107]
    s_waitcnt lgkmcnt(0)
    s_barrier
    v_mov_b32 v79, 0
    v_mov_b32 v80, 0
    v_mov_b32 v81, 0
    v_mov_b32 v82, 0
    v_mov_b32 v83, 0
    s_waitcnt vmcnt(1)
    v_mov_b32 v192, -1
    v_mov_b32 v193, -1
    v_mov_b32 v194, -1
    v_mov_b32 v195, -1
    v_mov_b32 v196, -1
    v_mov_b32 v197, -1
    v_mov_b32 v198, -1
    v_mov_b32 v199, -1
    v_mov_b32 v200, -1
    v_mov_b32 v201, -1
    v_mov_b32 v202, -1
    v_mov_b32 v203, -1
    v_mov_b32 v204, -1
    v_mov_b32 v205, -1
    v_mov_b32 v206, -1
    v_mov_b32 v207, -1
    v_mov_b32 v208, -1
    v_mov_b32 v209, -1
    v_mov_b32 v210, -1
    v_mov_b32 v211, -1
    v_mov_b32 v212, -1
    v_mov_b32 v213, -1
    v_mov_b32 v214, -1
    v_mov_b32 v215, -1
    v_mov_b32 v216, -1
    v_mov_b32 v217, -1
    v_mov_b32 v218, -1
    v_mov_b32 v219, -1
    v_mov_b32 v220, -1
    v_mov_b32 v221, -1
    v_mov_b32 v222, -1
    v_mov_b32 v223, -1
    s_add_u32 s28, s28, 1
    s_add_u32 s36, s36, 196608
    s_cmp_lt_u32 s28, 63
    s_cselect_b32 s4, 262144, 0
    s_add_u32 s38, s38, s4
    s_add_u32 s39, s39, s4
    s_add_u32 s30, s30, s4
    s_mov_b32 s4, s68
    s_mov_b32 s68, s69
    s_mov_b32 s69, s70
    s_mov_b32 s70, s71
    s_mov_b32 s71, s4
    s_and_b32 s4, s28, 3
    s_lshl_b32 s5, s4, 16
    s_add_u32 s29, s5, s34
    s_xor_b32 s6, s5, 0x20000
    s_add_u32 s31, s6, s34
    s_add_u32 s32, s29, 16384
    s_add_u32 s33, s29, 20480
    s_branch .top_198
.w3_200:
    ds_read_b128 v[36:39], v14 offset:8192
    ds_read_b128 v[40:43], v14 offset:9216
    ds_read_b128 v[44:47], v14 offset:10240
    ds_read_b128 v[48:51], v14 offset:11264
    ds_read_b128 v[88:91], v14 offset:16384
    s_waitcnt lgkmcnt(0)
    v_mfma_f32_16x16x32_bf16 v[104:107], v[84:87], v[36:39], 0
    v_mfma_f32_16x16x32_bf16 v[108:111], v[84:87], v[44:47], 0
    v_mfma_f32_16x16x32_bf16 v[104:107], v[84:87], v[40:43], v[104:107]
    v_mfma_f32_16x16x32_bf16 v[108:111], v[84:87], v[48:51], v[108:111]
    s_nop 7
    v_cvt_pk_bf16_f32 v168, v104, v105
    v_cvt_pk_bf16_f32 v169, v106, v107
    v_cvt_pk_bf16_f32 v170, v108, v109
    v_cvt_pk_bf16_f32 v171, v110, v111
    ds_write_b128 v14, v[168:171] offset:18432
    v_cndmask_b32 v172, v170, v168, s[60:61]
    v_cndmask_b32 v173, v171, v169, s[60:61]
    v_min_u32 v172, 0xfffffffe, v172
    v_min_u32 v173, 0xfffffffe, v173
    v_mov_b32 v174, v172
    v_mov_b32 v175, v173
    s_cmp_eq_u32 s28, 63
    s_nop 0
    v_permlane16_swap_b32 v172, v174
    v_permlane16_swap_b32 v173, v175
    ds_write_b128 v14, v[172:175] offset:17408

    s_cbranch_scc1 .sk_235
    s_waitcnt lgkmcnt(0)
    s_barrier
    buffer_store_dwordx4 v[188:191], v235, s[8:11], s31 offen sc1
    buffer_store_dwordx4 v[188:191], v236, s[8:11], s31 offen sc1

    s_branch .gp_201
.A_236:
    buffer_load_dwordx4 v[32:35], v8, s[8:11], s29 offen offset:3072 sc1
    s_sub_u32 s62, s62, 1
    s_cbranch_scc1 .mg_end_1
    s_waitcnt vmcnt(3)
    v_max3_u32 v4, v20, v21, v22
    v_max_u32 v4, v4, v23
    v_cmp_eq_u32 vcc, -1, v4
    s_cbranch_vccz .W_204
.A_203:
    buffer_load_dwordx4 v[20:23], v8, s[8:11], s29 offen offset:0 sc1
    s_waitcnt vmcnt(3)
    v_max3_u32 v4, v24, v25, v26
    v_max_u32 v4, v4, v27
    v_cmp_eq_u32 vcc, -1, v4
    s_cbranch_vccz .W_237
.A_238:
    buffer_load_dwordx4 v[24:27], v8, s[8:11], s29 offen offset:1024 sc1
    s_waitcnt vmcnt(3)
    v_max3_u32 v4, v28, v29, v30
    v_max_u32 v4, v4, v31
    v_cmp_eq_u32 vcc, -1, v4
    s_cbranch_vccz .W_239
.A_240:
    buffer_load_dwordx4 v[28:31], v8, s[8:11], s29 offen offset:2048 sc1
    s_waitcnt vmcnt(3)
    v_max3_u32 v4, v32, v33, v34
    v_max_u32 v4, v4, v35
    v_cmp_eq_u32 vcc, -1, v4
    s_cbranch_vccnz .A_236
.W_241:
    v_smfmac_f32_16x16x64_bf16 v[52:55], v[32:35], a[24:31], v9
    v_smfmac_f32_16x16x64_bf16 v[56:59], v[32:35], a[56:63], v9
    s_waitcnt vmcnt(2)
    v_max3_u32 v4, v20, v21, v22
    v_max_u32 v4, v4, v23
    v_smfmac_f32_16x16x64_bf16 v[60:63], v[32:35], a[88:95], v9
    v_cmp_eq_u32 vcc, -1, v4
    v_smfmac_f32_16x16x64_bf16 v[64:67], v[32:35], a[120:127], v9
    s_cbranch_vccnz .A_242
.W_243:
    v_smfmac_f32_16x16x64_bf16 v[52:55], v[20:23], a[0:7], v9
    v_smfmac_f32_16x16x64_bf16 v[56:59], v[20:23], a[32:39], v9
    s_waitcnt vmcnt(1)
    v_max3_u32 v4, v24, v25, v26
    v_max_u32 v4, v4, v27
    v_smfmac_f32_16x16x64_bf16 v[60:63], v[20:23], a[64:71], v9
    v_cmp_eq_u32 vcc, -1, v4
    v_smfmac_f32_16x16x64_bf16 v[64:67], v[20:23], a[96:103], v9
    s_cbranch_vccnz .A_244
.W_245:
    v_smfmac_f32_16x16x64_bf16 v[52:55], v[24:27], a[8:15], v9
    v_smfmac_f32_16x16x64_bf16 v[56:59], v[24:27], a[40:47], v9
    s_waitcnt vmcnt(0)
    v_max3_u32 v4, v28, v29, v30
    v_max_u32 v4, v4, v31
    v_smfmac_f32_16x16x64_bf16 v[60:63], v[24:27], a[72:79], v9
    v_cmp_eq_u32 vcc, -1, v4
    v_smfmac_f32_16x16x64_bf16 v[64:67], v[24:27], a[104:111], v9
    s_cbranch_vccnz .A_246
.W_247:
    v_smfmac_f32_16x16x64_bf16 v[52:55], v[28:31], a[16:23], v9
    v_smfmac_f32_16x16x64_bf16 v[56:59], v[28:31], a[48:55], v9
    v_smfmac_f32_16x16x64_bf16 v[60:63], v[28:31], a[80:87], v9
    v_smfmac_f32_16x16x64_bf16 v[64:67], v[28:31], a[112:119], v9
    s_branch .mj_202
.W_237:
    v_smfmac_f32_16x16x64_bf16 v[52:55], v[24:27], a[8:15], v9
    v_smfmac_f32_16x16x64_bf16 v[56:59], v[24:27], a[40:47], v9
    s_waitcnt vmcnt(2)
    v_max3_u32 v4, v28, v29, v30
    v_max_u32 v4, v4, v31
    v_smfmac_f32_16x16x64_bf16 v[60:63], v[24:27], a[72:79], v9
    v_cmp_eq_u32 vcc, -1, v4
    v_smfmac_f32_16x16x64_bf16 v[64:67], v[24:27], a[104:111], v9
    s_cbranch_vccnz .A_248
.W_249:
    v_smfmac_f32_16x16x64_bf16 v[52:55], v[28:31], a[16:23], v9
    v_smfmac_f32_16x16x64_bf16 v[56:59], v[28:31], a[48:55], v9
    s_waitcnt vmcnt(1)
    v_max3_u32 v4, v32, v33, v34
    v_max_u32 v4, v4, v35
    v_smfmac_f32_16x16x64_bf16 v[60:63], v[28:31], a[80:87], v9
    v_cmp_eq_u32 vcc, -1, v4
    v_smfmac_f32_16x16x64_bf16 v[64:67], v[28:31], a[112:119], v9
    s_cbranch_vccnz .A_250
.W_251:
    v_smfmac_f32_16x16x64_bf16 v[52:55], v[32:35], a[24:31], v9
    v_smfmac_f32_16x16x64_bf16 v[56:59], v[32:35], a[56:63], v9
    s_waitcnt vmcnt(0)
    v_max3_u32 v4, v20, v21, v22
    v_max_u32 v4, v4, v23
    v_smfmac_f32_16x16x64_bf16 v[60:63], v[32:35], a[88:95], v9
    v_cmp_eq_u32 vcc, -1, v4
    v_smfmac_f32_16x16x64_bf16 v[64:67], v[32:35], a[120:127], v9
    s_cbranch_vccnz .A_252
.W_253:
    v_smfmac_f32_16x16x64_bf16 v[52:55], v[20:23], a[0:7], v9
    v_smfmac_f32_16x16x64_bf16 v[56:59], v[20:23], a[32:39], v9
    v_smfmac_f32_16x16x64_bf16 v[60:63], v[20:23], a[64:71], v9
    v_smfmac_f32_16x16x64_bf16 v[64:67], v[20:23], a[96:103], v9
    s_branch .mj_202
.W_239:
    v_smfmac_f32_16x16x64_bf16 v[52:55], v[28:31], a[16:23], v9
    v_smfmac_f32_16x16x64_bf16 v[56:59], v[28:31], a[48:55], v9
    s_waitcnt vmcnt(2)
    v_max3_u32 v4, v32, v33, v34
    v_max_u32 v4, v4, v35
    v_smfmac_f32_16x16x64_bf16 v[60:63], v[28:31], a[80:87], v9
    v_cmp_eq_u32 vcc, -1, v4
    v_smfmac_f32_16x16x64_bf16 v[64:67], v[28:31], a[112:119], v9
    s_cbranch_vccnz .A_254
.W_255:
    v_smfmac_f32_16x16x64_bf16 v[52:55], v[32:35], a[24:31], v9
    v_smfmac_f32_16x16x64_bf16 v[56:59], v[32:35], a[56:63], v9
    s_waitcnt vmcnt(1)
    v_max3_u32 v4, v20, v21, v22
    v_max_u32 v4, v4, v23
    v_smfmac_f32_16x16x64_bf16 v[60:63], v[32:35], a[88:95], v9
    v_cmp_eq_u32 vcc, -1, v4
    v_smfmac_f32_16x16x64_bf16 v[64:67], v[32:35], a[120:127], v9
    s_cbranch_vccnz .A_256
.W_257:
    v_smfmac_f32_16x16x64_bf16 v[52:55], v[20:23], a[0:7], v9
    v_smfmac_f32_16x16x64_bf16 v[56:59], v[20:23], a[32:39], v9
    s_waitcnt vmcnt(0)
    v_max3_u32 v4, v24, v25, v26
    v_max_u32 v4, v4, v27
    v_smfmac_f32_16x16x64_bf16 v[60:63], v[20:23], a[64:71], v9
    v_cmp_eq_u32 vcc, -1, v4
    v_smfmac_f32_16x16x64_bf16 v[64:67], v[20:23], a[96:103], v9
    s_cbranch_vccnz .A_258
.W_259:
    v_smfmac_f32_16x16x64_bf16 v[52:55], v[24:27], a[8:15], v9
    v_smfmac_f32_16x16x64_bf16 v[56:59], v[24:27], a[40:47], v9
    v_smfmac_f32_16x16x64_bf16 v[60:63], v[24:27], a[72:79], v9
    v_smfmac_f32_16x16x64_bf16 v[64:67], v[24:27], a[104:111], v9
    s_branch .mj_202
.A_260:
    buffer_load_dwordx4 v[28:31], v8, s[8:11], s29 offen offset:2048 sc1
    s_sub_u32 s62, s62, 1
    s_cbranch_scc1 .mg_end_1
    s_waitcnt vmcnt(2)
    v_max3_u32 v4, v20, v21, v22
    v_max_u32 v4, v4, v23
    v_cmp_eq_u32 vcc, -1, v4
    s_cbranch_vccz .W_243
.A_242:
    buffer_load_dwordx4 v[20:23], v8, s[8:11], s29 offen offset:0 sc1
    s_waitcnt vmcnt(2)
    v_max3_u32 v4, v24, v25, v26
    v_max_u32 v4, v4, v27
    v_cmp_eq_u32 vcc, -1, v4
    s_cbranch_vccz .W_261
.A_262:
    buffer_load_dwordx4 v[24:27], v8, s[8:11], s29 offen offset:1024 sc1
    s_waitcnt vmcnt(2)
    v_max3_u32 v4, v28, v29, v30
    v_max_u32 v4, v4, v31
    v_cmp_eq_u32 vcc, -1, v4
    s_cbranch_vccnz .A_260
.W_263:
    v_smfmac_f32_16x16x64_bf16 v[52:55], v[28:31], a[16:23], v9
    v_smfmac_f32_16x16x64_bf16 v[56:59], v[28:31], a[48:55], v9
    s_waitcnt vmcnt(1)
    v_max3_u32 v4, v20, v21, v22
    v_max_u32 v4, v4, v23
    v_smfmac_f32_16x16x64_bf16 v[60:63], v[28:31], a[80:87], v9
    v_cmp_eq_u32 vcc, -1, v4
    v_smfmac_f32_16x16x64_bf16 v[64:67], v[28:31], a[112:119], v9
    s_cbranch_vccz .W_257
    s_branch .A_256
.W_261:
    v_smfmac_f32_16x16x64_bf16 v[52:55], v[24:27], a[8:15], v9
    v_smfmac_f32_16x16x64_bf16 v[56:59], v[24:27], a[40:47], v9
    s_waitcnt vmcnt(1)
    v_max3_u32 v4, v28, v29, v30
    v_max_u32 v4, v4, v31
    v_smfmac_f32_16x16x64_bf16 v[60:63], v[24:27], a[72:79], v9
    v_cmp_eq_u32 vcc, -1, v4
    v_smfmac_f32_16x16x64_bf16 v[64:67], v[24:27], a[104:111], v9
    s_cbranch_vccnz .A_264
.W_265:
    v_smfmac_f32_16x16x64_bf16 v[52:55], v[28:31], a[16:23], v9
    v_smfmac_f32_16x16x64_bf16 v[56:59], v[28:31], a[48:55], v9
    s_waitcnt vmcnt(0)
    v_max3_u32 v4, v20, v21, v22
    v_max_u32 v4, v4, v23
    v_smfmac_f32_16x16x64_bf16 v[60:63], v[28:31], a[80:87], v9
    v_cmp_eq_u32 vcc, -1, v4
    v_smfmac_f32_16x16x64_bf16 v[64:67], v[28:31], a[112:119], v9
    s_cbranch_vccz .W_253
    s_branch .A_252
.A_266:
    buffer_load_dwordx4 v[24:27], v8, s[8:11], s29 offen offset:1024 sc1
    s_sub_u32 s62, s62, 1
    s_cbranch_scc1 .mg_end_1
    s_waitcnt vmcnt(2)
    v_max3_u32 v4, v32, v33, v34
    v_max_u32 v4, v4, v35
    v_cmp_eq_u32 vcc, -1, v4
    s_cbranch_vccz .W_255
.A_254:
    buffer_load_dwordx4 v[32:35], v8, s[8:11], s29 offen offset:3072 sc1
    s_waitcnt vmcnt(2)
    v_max3_u32 v4, v20, v21, v22
    v_max_u32 v4, v4, v23
    v_cmp_eq_u32 vcc, -1, v4
    s_cbranch_vccz .W_267
.A_268:
    buffer_load_dwordx4 v[20:23], v8, s[8:11], s29 offen offset:0 sc1
    s_waitcnt vmcnt(2)
    v_max3_u32 v4, v24, v25, v26
    v_max_u32 v4, v4, v27
    v_cmp_eq_u32 vcc, -1, v4
    s_cbranch_vccnz .A_266
.W_269:
    v_smfmac_f32_16x16x64_bf16 v[52:55], v[24:27], a[8:15], v9
    v_smfmac_f32_16x16x64_bf16 v[56:59], v[24:27], a[40:47], v9
    s_waitcnt vmcnt(1)
    v_max3_u32 v4, v32, v33, v34
    v_max_u32 v4, v4, v35
    v_smfmac_f32_16x16x64_bf16 v[60:63], v[24:27], a[72:79], v9
    v_cmp_eq_u32 vcc, -1, v4
    v_smfmac_f32_16x16x64_bf16 v[64:67], v[24:27], a[104:111], v9
    s_cbranch_vccz .W_251
    s_branch .A_250
.W_267:
    v_smfmac_f32_16x16x64_bf16 v[52:55], v[20:23], a[0:7], v9
    v_smfmac_f32_16x16x64_bf16 v[56:59], v[20:23], a[32:39], v9
    s_waitcnt vmcnt(1)
    v_max3_u32 v4, v24, v25, v26
    v_max_u32 v4, v4, v27
    v_smfmac_f32_16x16x64_bf16 v[60:63], v[20:23], a[64:71], v9
    v_cmp_eq_u32 vcc, -1, v4
    v_smfmac_f32_16x16x64_bf16 v[64:67], v[20:23], a[96:103], v9
    s_cbranch_vccnz .A_270
.W_271:
    v_smfmac_f32_16x16x64_bf16 v[52:55], v[24:27], a[8:15], v9
    v_smfmac_f32_16x16x64_bf16 v[56:59], v[24:27], a[40:47], v9
    s_waitcnt vmcnt(0)
    v_max3_u32 v4, v32, v33, v34
    v_max_u32 v4, v4, v35
    v_smfmac_f32_16x16x64_bf16 v[60:63], v[24:27], a[72:79], v9
    v_cmp_eq_u32 vcc, -1, v4
    v_smfmac_f32_16x16x64_bf16 v[64:67], v[24:27], a[104:111], v9
    s_cbranch_vccz .W_210
    s_branch .A_209
.A_272:
    buffer_load_dwordx4 v[32:35], v8, s[8:11], s29 offen offset:3072 sc1
    s_sub_u32 s62, s62, 1
    s_cbranch_scc1 .mg_end_1
    s_waitcnt vmcnt(2)
    v_max3_u32 v4, v20, v21, v22
    v_max_u32 v4, v4, v23
    v_cmp_eq_u32 vcc, -1, v4
    s_cbranch_vccz .W_273
.A_274:
    buffer_load_dwordx4 v[20:23], v8, s[8:11], s29 offen offset:0 sc1
    s_waitcnt vmcnt(2)
    v_max3_u32 v4, v28, v29, v30
    v_max_u32 v4, v4, v31
    v_cmp_eq_u32 vcc, -1, v4
    s_cbranch_vccz .W_249
.A_248:
    buffer_load_dwordx4 v[28:31], v8, s[8:11], s29 offen offset:2048 sc1
    s_waitcnt vmcnt(2)
    v_max3_u32 v4, v32, v33, v34
    v_max_u32 v4, v4, v35
    v_cmp_eq_u32 vcc, -1, v4
    s_cbranch_vccnz .A_272
.W_275:
    v_smfmac_f32_16x16x64_bf16 v[52:55], v[32:35], a[24:31], v9
    v_smfmac_f32_16x16x64_bf16 v[56:59], v[32:35], a[56:63], v9
    s_waitcnt vmcnt(1)
    v_max3_u32 v4, v20, v21, v22
    v_max_u32 v4, v4, v23
    v_smfmac_f32_16x16x64_bf16 v[60:63], v[32:35], a[88:95], v9
    v_cmp_eq_u32 vcc, -1, v4
    v_smfmac_f32_16x16x64_bf16 v[64:67], v[32:35], a[120:127], v9
    s_cbranch_vccnz .A_276
.W_277:
    v_smfmac_f32_16x16x64_bf16 v[52:55], v[20:23], a[0:7], v9
    v_smfmac_f32_16x16x64_bf16 v[56:59], v[20:23], a[32:39], v9
    s_waitcnt vmcnt(0)
    v_max3_u32 v4, v28, v29, v30
    v_max_u32 v4, v4, v31
    v_smfmac_f32_16x16x64_bf16 v[60:63], v[20:23], a[64:71], v9
    v_cmp_eq_u32 vcc, -1, v4
    v_smfmac_f32_16x16x64_bf16 v[64:67], v[20:23], a[96:103], v9
    s_cbranch_vccz .W_247
    s_branch .A_246
.W_273:
    v_smfmac_f32_16x16x64_bf16 v[52:55], v[20:23], a[0:7], v9
    v_smfmac_f32_16x16x64_bf16 v[56:59], v[20:23], a[32:39], v9
    s_waitcnt vmcnt(1)
    v_max3_u32 v4, v28, v29, v30
    v_max_u32 v4, v4, v31
    v_smfmac_f32_16x16x64_bf16 v[60:63], v[20:23], a[64:71], v9
    v_cmp_eq_u32 vcc, -1, v4
    v_smfmac_f32_16x16x64_bf16 v[64:67], v[20:23], a[96:103], v9
    s_cbranch_vccz .W_208
    s_branch .A_207
.A_278:
    buffer_load_dwordx4 v[32:35], v8, s[8:11], s29 offen offset:3072 sc1
    s_sub_u32 s62, s62, 1
    s_cbranch_scc1 .mg_end_1
    s_waitcnt vmcnt(2)
    v_max3_u32 v4, v24, v25, v26
    v_max_u32 v4, v4, v27
    v_cmp_eq_u32 vcc, -1, v4
    s_cbranch_vccz .W_206
.A_205:
    buffer_load_dwordx4 v[24:27], v8, s[8:11], s29 offen offset:1024 sc1
    s_waitcnt vmcnt(2)
    v_max3_u32 v4, v28, v29, v30
    v_max_u32 v4, v4, v31
    v_cmp_eq_u32 vcc, -1, v4
    s_cbranch_vccz .W_279
.A_280:
    buffer_load_dwordx4 v[28:31], v8, s[8:11], s29 offen offset:2048 sc1
    s_waitcnt vmcnt(2)
    v_max3_u32 v4, v32, v33, v34
    v_max_u32 v4, v4, v35
    v_cmp_eq_u32 vcc, -1, v4
    s_cbranch_vccnz .A_278
.W_281:
    v_smfmac_f32_16x16x64_bf16 v[52:55], v[32:35], a[24:31], v9
    v_smfmac_f32_16x16x64_bf16 v[56:59], v[32:35], a[56:63], v9
    s_waitcnt vmcnt(1)
    v_max3_u32 v4, v24, v25, v26
    v_max_u32 v4, v4, v27
    v_smfmac_f32_16x16x64_bf16 v[60:63], v[32:35], a[88:95], v9
    v_cmp_eq_u32 vcc, -1, v4
    v_smfmac_f32_16x16x64_bf16 v[64:67], v[32:35], a[120:127], v9
    s_cbranch_vccz .W_245
    s_branch .A_244
.W_279:
    v_smfmac_f32_16x16x64_bf16 v[52:55], v[28:31], a[16:23], v9
    v_smfmac_f32_16x16x64_bf16 v[56:59], v[28:31], a[48:55], v9
    s_waitcnt vmcnt(1)
    v_max3_u32 v4, v32, v33, v34
    v_max_u32 v4, v4, v35
    v_smfmac_f32_16x16x64_bf16 v[60:63], v[28:31], a[80:87], v9
    v_cmp_eq_u32 vcc, -1, v4
    v_smfmac_f32_16x16x64_bf16 v[64:67], v[28:31], a[112:119], v9
    s_cbranch_vccnz .A_282
.W_283:
    v_smfmac_f32_16x16x64_bf16 v[52:55], v[32:35], a[24:31], v9
    v_smfmac_f32_16x16x64_bf16 v[56:59], v[32:35], a[56:63], v9
    s_waitcnt vmcnt(0)
    v_max3_u32 v4, v24, v25, v26
    v_max_u32 v4, v4, v27
    v_smfmac_f32_16x16x64_bf16 v[60:63], v[32:35], a[88:95], v9
    v_cmp_eq_u32 vcc, -1, v4
    v_smfmac_f32_16x16x64_bf16 v[64:67], v[32:35], a[120:127], v9
    s_cbranch_vccz .W_259
    s_branch .A_258
.A_284:
    buffer_load_dwordx4 v[24:27], v8, s[8:11], s29 offen offset:1024 sc1
    s_sub_u32 s62, s62, 1
    s_cbranch_scc1 .mg_end_1
    s_waitcnt vmcnt(1)
    v_max3_u32 v4, v20, v21, v22
    v_max_u32 v4, v4, v23
    v_cmp_eq_u32 vcc, -1, v4
    s_cbranch_vccz .W_257
.A_256:
    buffer_load_dwordx4 v[20:23], v8, s[8:11], s29 offen offset:0 sc1
    s_waitcnt vmcnt(1)
    v_max3_u32 v4, v24, v25, v26
    v_max_u32 v4, v4, v27
    v_cmp_eq_u32 vcc, -1, v4
    s_cbranch_vccnz .A_284
.W_285:
    v_smfmac_f32_16x16x64_bf16 v[52:55], v[24:27], a[8:15], v9
    v_smfmac_f32_16x16x64_bf16 v[56:59], v[24:27], a[40:47], v9
    s_waitcnt vmcnt(0)
    v_max3_u32 v4, v20, v21, v22
    v_max_u32 v4, v4, v23
    v_smfmac_f32_16x16x64_bf16 v[60:63], v[24:27], a[72:79], v9
    v_cmp_eq_u32 vcc, -1, v4
    v_smfmac_f32_16x16x64_bf16 v[64:67], v[24:27], a[104:111], v9
    s_cbranch_vccz .W_253
    s_branch .A_252
.A_264:
    buffer_load_dwordx4 v[28:31], v8, s[8:11], s29 offen offset:2048 sc1
    s_sub_u32 s62, s62, 1
    s_cbranch_scc1 .mg_end_1
    s_waitcnt vmcnt(1)
    v_max3_u32 v4, v20, v21, v22
    v_max_u32 v4, v4, v23
    v_cmp_eq_u32 vcc, -1, v4
    s_cbranch_vccz .W_277
.A_276:
    buffer_load_dwordx4 v[20:23], v8, s[8:11], s29 offen offset:0 sc1
    s_waitcnt vmcnt(1)
    v_max3_u32 v4, v28, v29, v30
    v_max_u32 v4, v4, v31
    v_cmp_eq_u32 vcc, -1, v4
    s_cbranch_vccnz .A_264
    s_branch .W_265
.A_286:
    buffer_load_dwordx4 v[20:23], v8, s[8:11], s29 offen offset:0 sc1
    s_sub_u32 s62, s62, 1
    s_cbranch_scc1 .mg_end_1
    s_waitcnt vmcnt(1)
    v_max3_u32 v4, v32, v33, v34
    v_max_u32 v4, v4, v35
    v_cmp_eq_u32 vcc, -1, v4
    s_cbranch_vccz .W_251
.A_250:
    buffer_load_dwordx4 v[32:35], v8, s[8:11], s29 offen offset:3072 sc1
    s_waitcnt vmcnt(1)
    v_max3_u32 v4, v20, v21, v22
    v_max_u32 v4, v4, v23
    v_cmp_eq_u32 vcc, -1, v4
    s_cbranch_vccnz .A_286
.W_287:
    v_smfmac_f32_16x16x64_bf16 v[52:55], v[20:23], a[0:7], v9
    v_smfmac_f32_16x16x64_bf16 v[56:59], v[20:23], a[32:39], v9
    s_waitcnt vmcnt(0)
    v_max3_u32 v4, v32, v33, v34
    v_max_u32 v4, v4, v35
    v_smfmac_f32_16x16x64_bf16 v[60:63], v[20:23], a[64:71], v9
    v_cmp_eq_u32 vcc, -1, v4
    v_smfmac_f32_16x16x64_bf16 v[64:67], v[20:23], a[96:103], v9
    s_cbranch_vccz .W_210
    s_branch .A_209
.A_288:
    buffer_load_dwordx4 v[28:31], v8, s[8:11], s29 offen offset:2048 sc1
    s_sub_u32 s62, s62, 1
    s_cbranch_scc1 .mg_end_1
    s_waitcnt vmcnt(1)
    v_max3_u32 v4, v24, v25, v26
    v_max_u32 v4, v4, v27
    v_cmp_eq_u32 vcc, -1, v4
    s_cbranch_vccz .W_245
.A_244:
    buffer_load_dwordx4 v[24:27], v8, s[8:11], s29 offen offset:1024 sc1
    s_waitcnt vmcnt(1)
    v_max3_u32 v4, v28, v29, v30
    v_max_u32 v4, v4, v31
    v_cmp_eq_u32 vcc, -1, v4
    s_cbranch_vccnz .A_288
.W_289:
    v_smfmac_f32_16x16x64_bf16 v[52:55], v[28:31], a[16:23], v9
    v_smfmac_f32_16x16x64_bf16 v[56:59], v[28:31], a[48:55], v9
    s_waitcnt vmcnt(0)
    v_max3_u32 v4, v24, v25, v26
    v_max_u32 v4, v4, v27
    v_smfmac_f32_16x16x64_bf16 v[60:63], v[28:31], a[80:87], v9
    v_cmp_eq_u32 vcc, -1, v4
    v_smfmac_f32_16x16x64_bf16 v[64:67], v[28:31], a[112:119], v9
    s_cbranch_vccz .W_259
    s_branch .A_258
.A_282:
    buffer_load_dwordx4 v[32:35], v8, s[8:11], s29 offen offset:3072 sc1
    s_sub_u32 s62, s62, 1
    s_cbranch_scc1 .mg_end_1
    s_waitcnt vmcnt(1)
    v_max3_u32 v4, v24, v25, v26
    v_max_u32 v4, v4, v27
    v_cmp_eq_u32 vcc, -1, v4
    s_cbranch_vccz .W_271
.A_270:
    buffer_load_dwordx4 v[24:27], v8, s[8:11], s29 offen offset:1024 sc1
    s_waitcnt vmcnt(1)
    v_max3_u32 v4, v32, v33, v34
    v_max_u32 v4, v4, v35
    v_cmp_eq_u32 vcc, -1, v4
    s_cbranch_vccnz .A_282
    s_branch .W_283
.A_290:
    buffer_load_dwordx4 v[32:35], v8, s[8:11], s29 offen offset:3072 sc1
    s_sub_u32 s62, s62, 1
    s_cbranch_scc1 .mg_end_1
    s_waitcnt vmcnt(1)
    v_max3_u32 v4, v28, v29, v30
    v_max_u32 v4, v4, v31
    v_cmp_eq_u32 vcc, -1, v4
    s_cbranch_vccz .W_208
.A_207:
    buffer_load_dwordx4 v[28:31], v8, s[8:11], s29 offen offset:2048 sc1
    s_waitcnt vmcnt(1)
    v_max3_u32 v4, v32, v33, v34
    v_max_u32 v4, v4, v35
    v_cmp_eq_u32 vcc, -1, v4
    s_cbranch_vccnz .A_290
.W_291:
    v_smfmac_f32_16x16x64_bf16 v[52:55], v[32:35], a[24:31], v9
    v_smfmac_f32_16x16x64_bf16 v[56:59], v[32:35], a[56:63], v9
    s_waitcnt vmcnt(0)
    v_max3_u32 v4, v28, v29, v30
    v_max_u32 v4, v4, v31
    v_smfmac_f32_16x16x64_bf16 v[60:63], v[32:35], a[88:95], v9
    v_cmp_eq_u32 vcc, -1, v4
    v_smfmac_f32_16x16x64_bf16 v[64:67], v[32:35], a[120:127], v9
    s_cbranch_vccz .W_247
    s_branch .A_246
.A_252:
    buffer_load_dwordx4 v[20:23], v8, s[8:11], s29 offen offset:0 sc1
    s_sub_u32 s62, s62, 1
    s_cbranch_scc1 .mg_end_1
    s_waitcnt vmcnt(1)
    v_max3_u32 v4, v20, v21, v22
    v_max_u32 v4, v4, v23
    v_cmp_eq_u32 vcc, -1, v4
    s_cbranch_vccnz .A_252
    v_smfmac_f32_16x16x64_bf16 v[52:55], v[20:23], a[0:7], v9
    v_smfmac_f32_16x16x64_bf16 v[56:59], v[20:23], a[32:39], v9
    v_smfmac_f32_16x16x64_bf16 v[60:63], v[20:23], a[64:71], v9
    v_smfmac_f32_16x16x64_bf16 v[64:67], v[20:23], a[96:103], v9
    s_branch .mj_202
.A_258:
    buffer_load_dwordx4 v[24:27], v8, s[8:11], s29 offen offset:1024 sc1
    s_sub_u32 s62, s62, 1
    s_cbranch_scc1 .mg_end_1
    s_waitcnt vmcnt(1)
    v_max3_u32 v4, v24, v25, v26
    v_max_u32 v4, v4, v27
    v_cmp_eq_u32 vcc, -1, v4
    s_cbranch_vccnz .A_258
    v_smfmac_f32_16x16x64_bf16 v[52:55], v[24:27], a[8:15], v9
    v_smfmac_f32_16x16x64_bf16 v[56:59], v[24:27], a[40:47], v9
    v_smfmac_f32_16x16x64_bf16 v[60:63], v[24:27], a[72:79], v9
    v_smfmac_f32_16x16x64_bf16 v[64:67], v[24:27], a[104:111], v9
    s_branch .mj_202
.A_246:
    buffer_load_dwordx4 v[28:31], v8, s[8:11], s29 offen offset:2048 sc1
    s_sub_u32 s62, s62, 1
    s_cbranch_scc1 .mg_end_1
    s_waitcnt vmcnt(1)
    v_max3_u32 v4, v28, v29, v30
    v_max_u32 v4, v4, v31
    v_cmp_eq_u32 vcc, -1, v4
    s_cbranch_vccnz .A_246
    v_smfmac_f32_16x16x64_bf16 v[52:55], v[28:31], a[16:23], v9
    v_smfmac_f32_16x16x64_bf16 v[56:59], v[28:31], a[48:55], v9
    v_smfmac_f32_16x16x64_bf16 v[60:63], v[28:31], a[80:87], v9
    v_smfmac_f32_16x16x64_bf16 v[64:67], v[28:31], a[112:119], v9
    s_branch .mj_202
.A_209:
    buffer_load_dwordx4 v[32:35], v8, s[8:11], s29 offen offset:3072 sc1
    s_sub_u32 s62, s62, 1
    s_cbranch_scc1 .mg_end_1
    s_waitcnt vmcnt(1)
    v_max3_u32 v4, v32, v33, v34
    v_max_u32 v4, v4, v35
    v_cmp_eq_u32 vcc, -1, v4
    s_cbranch_vccnz .A_209
    v_smfmac_f32_16x16x64_bf16 v[52:55], v[32:35], a[24:31], v9
    v_smfmac_f32_16x16x64_bf16 v[56:59], v[32:35], a[56:63], v9
    v_smfmac_f32_16x16x64_bf16 v[60:63], v[32:35], a[88:95], v9
    v_smfmac_f32_16x16x64_bf16 v[64:67], v[32:35], a[120:127], v9
    s_branch .mj_202
.A_292:
    buffer_load_dwordx4 v[100:103], v234, s[8:11], s29 offen sc1
    s_sub_u32 s62, s62, 1
    s_cbranch_scc1 .mg_end_1
    s_waitcnt vmcnt(2)
    v_max3_u32 v4, v92, v93, v94
    v_max_u32 v4, v4, v95
    v_cmp_eq_u32 vcc, -1, v4
    s_cbranch_vccz .W_213
.A_212:
    buffer_load_dwordx4 v[92:95], v232, s[8:11], s29 offen sc1
    s_waitcnt vmcnt(2)
    v_max3_u32 v4, v96, v97, v98
    v_max_u32 v4, v4, v99
    v_cmp_eq_u32 vcc, -1, v4
    s_cbranch_vccz .W_293
.A_294:
    buffer_load_dwordx4 v[96:99], v233, s[8:11], s29 offen sc1
    s_waitcnt vmcnt(2)
    v_max3_u32 v4, v100, v101, v102
    v_max_u32 v4, v4, v103
    v_cmp_eq_u32 vcc, -1, v4
    s_cbranch_vccnz .A_292
.W_295:
    v_mfma_f32_16x16x32_bf16 v[208:211], v[140:143], v[100:103], v[208:211]
    s_waitcnt vmcnt(1)
    v_max3_u32 v4, v92, v93, v94
    v_max_u32 v4, v4, v95
    v_mfma_f32_16x16x32_bf16 v[212:215], v[156:159], v[100:103], v[212:215]
    v_cmp_eq_u32 vcc, -1, v4
    v_mfma_f32_16x16x32_bf16 v[216:219], v[100:103], v[100:103], v[216:219]
    s_cbranch_vccnz .A_296
.W_297:
    v_mfma_f32_16x16x32_bf16 v[208:211], v[132:135], v[92:95], v[208:211]
    s_waitcnt vmcnt(0)
    v_max3_u32 v4, v96, v97, v98
    v_max_u32 v4, v4, v99
    v_mfma_f32_16x16x32_bf16 v[212:215], v[148:151], v[92:95], v[212:215]
    v_cmp_eq_u32 vcc, -1, v4
    v_mfma_f32_16x16x32_bf16 v[216:219], v[92:95], v[92:95], v[216:219]
    s_cbranch_vccnz .A_298
.W_299:
    v_mfma_f32_16x16x32_bf16 v[208:211], v[136:139], v[96:99], v[208:211]
    v_mfma_f32_16x16x32_bf16 v[212:215], v[152:155], v[96:99], v[212:215]
    v_mfma_f32_16x16x32_bf16 v[216:219], v[96:99], v[96:99], v[216:219]
    s_branch .mj_211
.W_293:
    v_mfma_f32_16x16x32_bf16 v[208:211], v[136:139], v[96:99], v[208:211]
    s_waitcnt vmcnt(1)
    v_max3_u32 v4, v100, v101, v102
    v_max_u32 v4, v4, v103
    v_mfma_f32_16x16x32_bf16 v[212:215], v[152:155], v[96:99], v[212:215]
    v_cmp_eq_u32 vcc, -1, v4
    v_mfma_f32_16x16x32_bf16 v[216:219], v[96:99], v[96:99], v[216:219]
    s_cbranch_vccnz .A_300
.W_301:
    v_mfma_f32_16x16x32_bf16 v[208:211], v[140:143], v[100:103], v[208:211]
    s_waitcnt vmcnt(0)
    v_max3_u32 v4, v92, v93, v94
    v_max_u32 v4, v4, v95
    v_mfma_f32_16x16x32_bf16 v[212:215], v[156:159], v[100:103], v[212:215]
    v_cmp_eq_u32 vcc, -1, v4
    v_mfma_f32_16x16x32_bf16 v[216:219], v[100:103], v[100:103], v[216:219]
    s_cbranch_vccnz .A_302
.W_303:
    v_mfma_f32_16x16x32_bf16 v[208:211], v[132:135], v[92:95], v[208:211]
    v_mfma_f32_16x16x32_bf16 v[212:215], v[148:151], v[92:95], v[212:215]
    v_mfma_f32_16x16x32_bf16 v[216:219], v[92:95], v[92:95], v[216:219]
    s_branch .mj_211
.A_304:
    buffer_load_dwordx4 v[96:99], v233, s[8:11], s29 offen sc1
    s_sub_u32 s62, s62, 1
    s_cbranch_scc1 .mg_end_1
    s_waitcnt vmcnt(1)
    v_max3_u32 v4, v92, v93, v94
    v_max_u32 v4, v4, v95
    v_cmp_eq_u32 vcc, -1, v4
    s_cbranch_vccz .W_297
.A_296:
    buffer_load_dwordx4 v[92:95], v232, s[8:11], s29 offen sc1
    s_waitcnt vmcnt(1)
    v_max3_u32 v4, v96, v97, v98
    v_max_u32 v4, v4, v99
    v_cmp_eq_u32 vcc, -1, v4
    s_cbranch_vccnz .A_304
.W_305:
    v_mfma_f32_16x16x32_bf16 v[208:211], v[136:139], v[96:99], v[208:211]
    s_waitcnt vmcnt(0)
    v_max3_u32 v4, v92, v93, v94
    v_max_u32 v4, v4, v95
    v_mfma_f32_16x16x32_bf16 v[212:215], v[152:155], v[96:99], v[212:215]
    v_cmp_eq_u32 vcc, -1, v4
    v_mfma_f32_16x16x32_bf16 v[216:219], v[96:99], v[96:99], v[216:219]
    s_cbranch_vccz .W_303
    s_branch .A_302
.A_306:
    buffer_load_dwordx4 v[92:95], v232, s[8:11], s29 offen sc1
    s_sub_u32 s62, s62, 1
    s_cbranch_scc1 .mg_end_1
    s_waitcnt vmcnt(1)
    v_max3_u32 v4, v100, v101, v102
    v_max_u32 v4, v4, v103
    v_cmp_eq_u32 vcc, -1, v4
    s_cbranch_vccz .W_301
.A_300:
    buffer_load_dwordx4 v[100:103], v234, s[8:11], s29 offen sc1
    s_waitcnt vmcnt(1)
    v_max3_u32 v4, v92, v93, v94
    v_max_u32 v4, v4, v95
    v_cmp_eq_u32 vcc, -1, v4
    s_cbranch_vccnz .A_306
.W_307:
    v_mfma_f32_16x16x32_bf16 v[208:211], v[132:135], v[92:95], v[208:211]
    s_waitcnt vmcnt(0)
    v_max3_u32 v4, v100, v101, v102
    v_max_u32 v4, v4, v103
    v_mfma_f32_16x16x32_bf16 v[212:215], v[148:151], v[92:95], v[212:215]
    v_cmp_eq_u32 vcc, -1, v4
    v_mfma_f32_16x16x32_bf16 v[216:219], v[92:95], v[92:95], v[216:219]
    s_cbranch_vccz .W_217
    s_branch .A_216
.A_308:
    buffer_load_dwordx4 v[100:103], v234, s[8:11], s29 offen sc1
    s_sub_u32 s62, s62, 1
    s_cbranch_scc1 .mg_end_1
    s_waitcnt vmcnt(1)
    v_max3_u32 v4, v96, v97, v98
    v_max_u32 v4, v4, v99
    v_cmp_eq_u32 vcc, -1, v4
    s_cbranch_vccz .W_215
.A_214:
    buffer_load_dwordx4 v[96:99], v233, s[8:11], s29 offen sc1
    s_waitcnt vmcnt(1)
    v_max3_u32 v4, v100, v101, v102
    v_max_u32 v4, v4, v103
    v_cmp_eq_u32 vcc, -1, v4
    s_cbranch_vccnz .A_308
.W_309:
    v_mfma_f32_16x16x32_bf16 v[208:211], v[140:143], v[100:103], v[208:211]
    s_waitcnt vmcnt(0)
    v_max3_u32 v4, v96, v97, v98
    v_max_u32 v4, v4, v99
    v_mfma_f32_16x16x32_bf16 v[212:215], v[156:159], v[100:103], v[212:215]
    v_cmp_eq_u32 vcc, -1, v4
    v_mfma_f32_16x16x32_bf16 v[216:219], v[100:103], v[100:103], v[216:219]
    s_cbranch_vccz .W_299
    s_branch .A_298
.A_302:
    buffer_load_dwordx4 v[92:95], v232, s[8:11], s29 offen sc1
    s_sub_u32 s62, s62, 1
    s_cbranch_scc1 .mg_end_1
    s_waitcnt vmcnt(1)
    v_max3_u32 v4, v92, v93, v94
    v_max_u32 v4, v4, v95
    v_cmp_eq_u32 vcc, -1, v4
    s_cbranch_vccnz .A_302
    v_mfma_f32_16x16x32_bf16 v[208:211], v[132:135], v[92:95], v[208:211]
    v_mfma_f32_16x16x32_bf16 v[212:215], v[148:151], v[92:95], v[212:215]
    v_mfma_f32_16x16x32_bf16 v[216:219], v[92:95], v[92:95], v[216:219]
    s_branch .mj_211
.A_298:
    buffer_load_dwordx4 v[96:99], v233, s[8:11], s29 offen sc1
    s_sub_u32 s62, s62, 1
    s_cbranch_scc1 .mg_end_1
    s_waitcnt vmcnt(1)
    v_max3_u32 v4, v96, v97, v98
    v_max_u32 v4, v4, v99
    v_cmp_eq_u32 vcc, -1, v4
    s_cbranch_vccnz .A_298
    v_mfma_f32_16x16x32_bf16 v[208:211], v[136:139], v[96:99], v[208:211]
    v_mfma_f32_16x16x32_bf16 v[212:215], v[152:155], v[96:99], v[212:215]
    v_mfma_f32_16x16x32_bf16 v[216:219], v[96:99], v[96:99], v[216:219]
    s_branch .mj_211
.A_216:
    buffer_load_dwordx4 v[100:103], v234, s[8:11], s29 offen sc1
    s_sub_u32 s62, s62, 1
    s_cbranch_scc1 .mg_end_1
    s_waitcnt vmcnt(1)
    v_max3_u32 v4, v100, v101, v102
    v_max_u32 v4, v4, v103
    v_cmp_eq_u32 vcc, -1, v4
    s_cbranch_vccnz .A_216
    v_mfma_f32_16x16x32_bf16 v[208:211], v[140:143], v[100:103], v[208:211]
    v_mfma_f32_16x16x32_bf16 v[212:215], v[156:159], v[100:103], v[212:215]
    v_mfma_f32_16x16x32_bf16 v[216:219], v[100:103], v[100:103], v[216:219]
    s_branch .mj_211
.kf_223:
    s_mov_b32 s62, 0
    s_mov_b64 exec, 3
.wf_310:
    buffer_load_dword v244, v253, s[8:11], s89 offen sc1
    s_waitcnt vmcnt(0)
    v_cmp_gt_u32 vcc, s6, v244
    s_cbranch_vccz .wfd_311
    s_sleep 2
    s_add_u32 s62, s62, 1
    s_cmp_gt_u32 s62, 0x400000
    s_cbranch_scc1 .mg_end_1
    s_branch .wf_310

.wfd_311:
    s_mov_b64 exec, -1
    v_readlane_b32 s4, v244, 0
    v_readlane_b32 s93, v244, 1
    s_min_u32 s93, s93, s4
    s_mov_b32 s62, 0x1000000
    s_branch .kb_224
.A_312:
    buffer_load_dwordx4 v[216:219], v246, s[8:11], s33 offen offset:2048 sc1
    buffer_load_dwordx4 v[220:223], v246, s[8:11], s33 offen offset:3072 sc1
    s_sub_u32 s62, s62, 1
    s_cbranch_scc1 .mg_end_1
    s_waitcnt vmcnt(6)
    v_max3_u32 v4, v192, v193, v194
    v_max3_u32 v5, v195, v196, v197
    v_max3_u32 v4, v4, v198, v199
    v_max_u32 v4, v4, v5
    v_cmp_eq_u32 vcc, -1, v4
    s_cbranch_vccz .W_228
.A_227:
    buffer_load_dwordx4 v[192:195], v246, s[8:11], s32 offen offset:0 sc1
    buffer_load_dwordx4 v[196:199], v246, s[8:11], s32 offen offset:1024 sc1
    s_waitcnt vmcnt(6)
    v_max3_u32 v4, v200, v201, v202
    v_max3_u32 v5, v203, v204, v205
    v_max3_u32 v4, v4, v206, v207
    v_max_u32 v4, v4, v5
    v_cmp_eq_u32 vcc, -1, v4
    s_cbranch_vccz .W_313
.A_314:
    buffer_load_dwordx4 v[200:203], v246, s[8:11], s32 offen offset:2048 sc1
    buffer_load_dwordx4 v[204:207], v246, s[8:11], s32 offen offset:3072 sc1
    s_waitcnt vmcnt(6)
    v_max3_u32 v4, v208, v209, v210
    v_max3_u32 v5, v211, v212, v213
    v_max3_u32 v4, v4, v214, v215
    v_max_u32 v4, v4, v5
    v_cmp_eq_u32 vcc, -1, v4
    s_cbranch_vccz .W_315
.A_316:
    buffer_load_dwordx4 v[208:211], v246, s[8:11], s33 offen offset:0 sc1
    buffer_load_dwordx4 v[212:215], v246, s[8:11], s33 offen offset:1024 sc1
    s_waitcnt vmcnt(6)
    v_max3_u32 v4, v216, v217, v218
    v_max3_u32 v5, v219, v220, v221
    v_max3_u32 v4, v4, v222, v223
    v_max_u32 v4, v4, v5
    v_cmp_eq_u32 vcc, -1, v4
    s_cbranch_vccnz .A_312
.W_317:
    v_smfmac_f32_16x16x64_bf16 v[76:79], v[216:219], v[140:147], v9
    v_smfmac_f32_16x16x64_bf16 v[80:83], v[216:219], v[172:179], v9
    s_waitcnt vmcnt(4)
    v_max3_u32 v4, v192, v193, v194
    v_max3_u32 v5, v195, v196, v197
    v_max3_u32 v4, v4, v198, v199
    v_smfmac_f32_16x16x64_bf16 v[76:79], v[220:223], v[148:155], v9
    v_max_u32 v4, v4, v5
    v_cmp_eq_u32 vcc, -1, v4
    v_smfmac_f32_16x16x64_bf16 v[80:83], v[220:223], v[180:187], v9
    s_cbranch_vccnz .A_318
.W_319:
    v_smfmac_f32_16x16x64_bf16 v[76:79], v[192:195], a[192:199], v9
    v_smfmac_f32_16x16x64_bf16 v[80:83], v[192:195], a[224:231], v9
    s_waitcnt vmcnt(2)
    v_max3_u32 v4, v200, v201, v202
    v_max3_u32 v5, v203, v204, v205
    v_max3_u32 v4, v4, v206, v207
    v_smfmac_f32_16x16x64_bf16 v[76:79], v[196:199], a[200:207], v9
    v_max_u32 v4, v4, v5
    v_cmp_eq_u32 vcc, -1, v4
    v_smfmac_f32_16x16x64_bf16 v[80:83], v[196:199], a[232:239], v9
    s_cbranch_vccnz .A_320
.W_321:
    v_smfmac_f32_16x16x64_bf16 v[76:79], v[200:203], a[208:215], v9
    v_smfmac_f32_16x16x64_bf16 v[80:83], v[200:203], a[240:247], v9
    s_waitcnt vmcnt(0)
    v_max3_u32 v4, v208, v209, v210
    v_max3_u32 v5, v211, v212, v213
    v_max3_u32 v4, v4, v214, v215
    v_smfmac_f32_16x16x64_bf16 v[76:79], v[204:207], a[216:223], v9
    v_max_u32 v4, v4, v5
    v_cmp_eq_u32 vcc, -1, v4
    v_smfmac_f32_16x16x64_bf16 v[80:83], v[204:207], a[248:255], v9
    s_cbranch_vccnz .A_322
.W_323:
    v_smfmac_f32_16x16x64_bf16 v[76:79], v[208:211], v[124:131], v9
    v_smfmac_f32_16x16x64_bf16 v[80:83], v[208:211], v[156:163], v9
    v_smfmac_f32_16x16x64_bf16 v[76:79], v[212:215], v[132:139], v9
    v_smfmac_f32_16x16x64_bf16 v[80:83], v[212:215], v[164:171], v9
    s_branch .mj_226
.W_313:
    v_smfmac_f32_16x16x64_bf16 v[76:79], v[200:203], a[208:215], v9
    v_smfmac_f32_16x16x64_bf16 v[80:83], v[200:203], a[240:247], v9
    s_waitcnt vmcnt(4)
    v_max3_u32 v4, v208, v209, v210
    v_max3_u32 v5, v211, v212, v213
    v_max3_u32 v4, v4, v214, v215
    v_smfmac_f32_16x16x64_bf16 v[76:79], v[204:207], a[216:223], v9
    v_max_u32 v4, v4, v5
    v_cmp_eq_u32 vcc, -1, v4
    v_smfmac_f32_16x16x64_bf16 v[80:83], v[204:207], a[248:255], v9
    s_cbranch_vccnz .A_324
.W_325:
    v_smfmac_f32_16x16x64_bf16 v[76:79], v[208:211], v[124:131], v9
    v_smfmac_f32_16x16x64_bf16 v[80:83], v[208:211], v[156:163], v9
    s_waitcnt vmcnt(2)
    v_max3_u32 v4, v216, v217, v218
    v_max3_u32 v5, v219, v220, v221
    v_max3_u32 v4, v4, v222, v223
    v_smfmac_f32_16x16x64_bf16 v[76:79], v[212:215], v[132:139], v9
    v_max_u32 v4, v4, v5
    v_cmp_eq_u32 vcc, -1, v4
    v_smfmac_f32_16x16x64_bf16 v[80:83], v[212:215], v[164:171], v9
    s_cbranch_vccnz .A_326
.W_327:
    v_smfmac_f32_16x16x64_bf16 v[76:79], v[216:219], v[140:147], v9
    v_smfmac_f32_16x16x64_bf16 v[80:83], v[216:219], v[172:179], v9
    s_waitcnt vmcnt(0)
    v_max3_u32 v4, v192, v193, v194
    v_max3_u32 v5, v195, v196, v197
    v_max3_u32 v4, v4, v198, v199
    v_smfmac_f32_16x16x64_bf16 v[76:79], v[220:223], v[148:155], v9
    v_max_u32 v4, v4, v5
    v_cmp_eq_u32 vcc, -1, v4
    v_smfmac_f32_16x16x64_bf16 v[80:83], v[220:223], v[180:187], v9
    s_cbranch_vccnz .A_328
.W_329:
    v_smfmac_f32_16x16x64_bf16 v[76:79], v[192:195], a[192:199], v9
    v_smfmac_f32_16x16x64_bf16 v[80:83], v[192:195], a[224:231], v9
    v_smfmac_f32_16x16x64_bf16 v[76:79], v[196:199], a[200:207], v9
    v_smfmac_f32_16x16x64_bf16 v[80:83], v[196:199], a[232:239], v9
    s_branch .mj_226
.W_315:
    v_smfmac_f32_16x16x64_bf16 v[76:79], v[208:211], v[124:131], v9
    v_smfmac_f32_16x16x64_bf16 v[80:83], v[208:211], v[156:163], v9
    s_waitcnt vmcnt(4)
    v_max3_u32 v4, v216, v217, v218
    v_max3_u32 v5, v219, v220, v221
    v_max3_u32 v4, v4, v222, v223
    v_smfmac_f32_16x16x64_bf16 v[76:79], v[212:215], v[132:139], v9
    v_max_u32 v4, v4, v5
    v_cmp_eq_u32 vcc, -1, v4
    v_smfmac_f32_16x16x64_bf16 v[80:83], v[212:215], v[164:171], v9
    s_cbranch_vccnz .A_330
.W_331:
    v_smfmac_f32_16x16x64_bf16 v[76:79], v[216:219], v[140:147], v9
    v_smfmac_f32_16x16x64_bf16 v[80:83], v[216:219], v[172:179], v9
    s_waitcnt vmcnt(2)
    v_max3_u32 v4, v192, v193, v194
    v_max3_u32 v5, v195, v196, v197
    v_max3_u32 v4, v4, v198, v199
    v_smfmac_f32_16x16x64_bf16 v[76:79], v[220:223], v[148:155], v9
    v_max_u32 v4, v4, v5
    v_cmp_eq_u32 vcc, -1, v4
    v_smfmac_f32_16x16x64_bf16 v[80:83], v[220:223], v[180:187], v9
    s_cbranch_vccnz .A_332
.W_333:
    v_smfmac_f32_16x16x64_bf16 v[76:79], v[192:195], a[192:199], v9
    v_smfmac_f32_16x16x64_bf16 v[80:83], v[192:195], a[224:231], v9
    s_waitcnt vmcnt(0)
    v_max3_u32 v4, v200, v201, v202
    v_max3_u32 v5, v203, v204, v205
    v_max3_u32 v4, v4, v206, v207
    v_smfmac_f32_16x16x64_bf16 v[76:79], v[196:199], a[200:207], v9
    v_max_u32 v4, v4, v5
    v_cmp_eq_u32 vcc, -1, v4
    v_smfmac_f32_16x16x64_bf16 v[80:83], v[196:199], a[232:239], v9
    s_cbranch_vccnz .A_334
.W_335:
    v_smfmac_f32_16x16x64_bf16 v[76:79], v[200:203], a[208:215], v9
    v_smfmac_f32_16x16x64_bf16 v[80:83], v[200:203], a[240:247], v9
    v_smfmac_f32_16x16x64_bf16 v[76:79], v[204:207], a[216:223], v9
    v_smfmac_f32_16x16x64_bf16 v[80:83], v[204:207], a[248:255], v9
    s_branch .mj_226
.A_336:
    buffer_load_dwordx4 v[208:211], v246, s[8:11], s33 offen offset:0 sc1
    buffer_load_dwordx4 v[212:215], v246, s[8:11], s33 offen offset:1024 sc1
    s_sub_u32 s62, s62, 1
    s_cbranch_scc1 .mg_end_1
    s_waitcnt vmcnt(4)
    v_max3_u32 v4, v192, v193, v194
    v_max3_u32 v5, v195, v196, v197
    v_max3_u32 v4, v4, v198, v199
    v_max_u32 v4, v4, v5
    v_cmp_eq_u32 vcc, -1, v4
    s_cbranch_vccz .W_319
.A_318:
    buffer_load_dwordx4 v[192:195], v246, s[8:11], s32 offen offset:0 sc1
    buffer_load_dwordx4 v[196:199], v246, s[8:11], s32 offen offset:1024 sc1
    s_waitcnt vmcnt(4)
    v_max3_u32 v4, v200, v201, v202
    v_max3_u32 v5, v203, v204, v205
    v_max3_u32 v4, v4, v206, v207
    v_max_u32 v4, v4, v5
    v_cmp_eq_u32 vcc, -1, v4
    s_cbranch_vccz .W_337
.A_338:
    buffer_load_dwordx4 v[200:203], v246, s[8:11], s32 offen offset:2048 sc1
    buffer_load_dwordx4 v[204:207], v246, s[8:11], s32 offen offset:3072 sc1
    s_waitcnt vmcnt(4)
    v_max3_u32 v4, v208, v209, v210
    v_max3_u32 v5, v211, v212, v213
    v_max3_u32 v4, v4, v214, v215
    v_max_u32 v4, v4, v5
    v_cmp_eq_u32 vcc, -1, v4
    s_cbranch_vccnz .A_336
.W_339:
    v_smfmac_f32_16x16x64_bf16 v[76:79], v[208:211], v[124:131], v9
    v_smfmac_f32_16x16x64_bf16 v[80:83], v[208:211], v[156:163], v9
    s_waitcnt vmcnt(2)
    v_max3_u32 v4, v192, v193, v194
    v_max3_u32 v5, v195, v196, v197
    v_max3_u32 v4, v4, v198, v199
    v_smfmac_f32_16x16x64_bf16 v[76:79], v[212:215], v[132:139], v9
    v_max_u32 v4, v4, v5
    v_cmp_eq_u32 vcc, -1, v4
    v_smfmac_f32_16x16x64_bf16 v[80:83], v[212:215], v[164:171], v9
    s_cbranch_vccz .W_333
    s_branch .A_332
.W_337:
    v_smfmac_f32_16x16x64_bf16 v[76:79], v[200:203], a[208:215], v9
    v_smfmac_f32_16x16x64_bf16 v[80:83], v[200:203], a[240:247], v9
    s_waitcnt vmcnt(2)
    v_max3_u32 v4, v208, v209, v210
    v_max3_u32 v5, v211, v212, v213
    v_max3_u32 v4, v4, v214, v215
    v_smfmac_f32_16x16x64_bf16 v[76:79], v[204:207], a[216:223], v9
    v_max_u32 v4, v4, v5
    v_cmp_eq_u32 vcc, -1, v4
    v_smfmac_f32_16x16x64_bf16 v[80:83], v[204:207], a[248:255], v9
    s_cbranch_vccnz .A_340
.W_341:
    v_smfmac_f32_16x16x64_bf16 v[76:79], v[208:211], v[124:131], v9
    v_smfmac_f32_16x16x64_bf16 v[80:83], v[208:211], v[156:163], v9
    s_waitcnt vmcnt(0)
    v_max3_u32 v4, v192, v193, v194
    v_max3_u32 v5, v195, v196, v197
    v_max3_u32 v4, v4, v198, v199
    v_smfmac_f32_16x16x64_bf16 v[76:79], v[212:215], v[132:139], v9
    v_max_u32 v4, v4, v5
    v_cmp_eq_u32 vcc, -1, v4
    v_smfmac_f32_16x16x64_bf16 v[80:83], v[212:215], v[164:171], v9
    s_cbranch_vccz .W_329
    s_branch .A_328
.A_342:
    buffer_load_dwordx4 v[200:203], v246, s[8:11], s32 offen offset:2048 sc1
    buffer_load_dwordx4 v[204:207], v246, s[8:11], s32 offen offset:3072 sc1
    s_sub_u32 s62, s62, 1
    s_cbranch_scc1 .mg_end_1
    s_waitcnt vmcnt(4)
    v_max3_u32 v4, v216, v217, v218
    v_max3_u32 v5, v219, v220, v221
    v_max3_u32 v4, v4, v222, v223
    v_max_u32 v4, v4, v5
    v_cmp_eq_u32 vcc, -1, v4
    s_cbranch_vccz .W_331
.A_330:
    buffer_load_dwordx4 v[216:219], v246, s[8:11], s33 offen offset:2048 sc1
    buffer_load_dwordx4 v[220:223], v246, s[8:11], s33 offen offset:3072 sc1
    s_waitcnt vmcnt(4)
    v_max3_u32 v4, v192, v193, v194
    v_max3_u32 v5, v195, v196, v197
    v_max3_u32 v4, v4, v198, v199
    v_max_u32 v4, v4, v5
    v_cmp_eq_u32 vcc, -1, v4
    s_cbranch_vccz .W_343
.A_344:
    buffer_load_dwordx4 v[192:195], v246, s[8:11], s32 offen offset:0 sc1
    buffer_load_dwordx4 v[196:199], v246, s[8:11], s32 offen offset:1024 sc1
    s_waitcnt vmcnt(4)
    v_max3_u32 v4, v200, v201, v202
    v_max3_u32 v5, v203, v204, v205
    v_max3_u32 v4, v4, v206, v207
    v_max_u32 v4, v4, v5
    v_cmp_eq_u32 vcc, -1, v4
    s_cbranch_vccnz .A_342
.W_345:
    v_smfmac_f32_16x16x64_bf16 v[76:79], v[200:203], a[208:215], v9
    v_smfmac_f32_16x16x64_bf16 v[80:83], v[200:203], a[240:247], v9
    s_waitcnt vmcnt(2)
    v_max3_u32 v4, v216, v217, v218
    v_max3_u32 v5, v219, v220, v221
    v_max3_u32 v4, v4, v222, v223
    v_smfmac_f32_16x16x64_bf16 v[76:79], v[204:207], a[216:223], v9
    v_max_u32 v4, v4, v5
    v_cmp_eq_u32 vcc, -1, v4
    v_smfmac_f32_16x16x64_bf16 v[80:83], v[204:207], a[248:255], v9
    s_cbranch_vccz .W_327
    s_branch .A_326
.W_343:
    v_smfmac_f32_16x16x64_bf16 v[76:79], v[192:195], a[192:199], v9
    v_smfmac_f32_16x16x64_bf16 v[80:83], v[192:195], a[224:231], v9
    s_waitcnt vmcnt(2)
    v_max3_u32 v4, v200, v201, v202
    v_max3_u32 v5, v203, v204, v205
    v_max3_u32 v4, v4, v206, v207
    v_smfmac_f32_16x16x64_bf16 v[76:79], v[196:199], a[200:207], v9
    v_max_u32 v4, v4, v5
    v_cmp_eq_u32 vcc, -1, v4
    v_smfmac_f32_16x16x64_bf16 v[80:83], v[196:199], a[232:239], v9
    s_cbranch_vccnz .A_346
.W_347:
    v_smfmac_f32_16x16x64_bf16 v[76:79], v[200:203], a[208:215], v9
    v_smfmac_f32_16x16x64_bf16 v[80:83], v[200:203], a[240:247], v9
    s_waitcnt vmcnt(0)
    v_max3_u32 v4, v216, v217, v218
    v_max3_u32 v5, v219, v220, v221
    v_max3_u32 v4, v4, v222, v223
    v_smfmac_f32_16x16x64_bf16 v[76:79], v[204:207], a[216:223], v9
    v_max_u32 v4, v4, v5
    v_cmp_eq_u32 vcc, -1, v4
    v_smfmac_f32_16x16x64_bf16 v[80:83], v[204:207], a[248:255], v9
    s_cbranch_vccz .W_234
    s_branch .A_233
.A_348:
    buffer_load_dwordx4 v[216:219], v246, s[8:11], s33 offen offset:2048 sc1
    buffer_load_dwordx4 v[220:223], v246, s[8:11], s33 offen offset:3072 sc1
    s_sub_u32 s62, s62, 1
    s_cbranch_scc1 .mg_end_1
    s_waitcnt vmcnt(4)
    v_max3_u32 v4, v192, v193, v194
    v_max3_u32 v5, v195, v196, v197
    v_max3_u32 v4, v4, v198, v199
    v_max_u32 v4, v4, v5
    v_cmp_eq_u32 vcc, -1, v4
    s_cbranch_vccz .W_349
.A_350:
    buffer_load_dwordx4 v[192:195], v246, s[8:11], s32 offen offset:0 sc1
    buffer_load_dwordx4 v[196:199], v246, s[8:11], s32 offen offset:1024 sc1
    s_waitcnt vmcnt(4)
    v_max3_u32 v4, v208, v209, v210
    v_max3_u32 v5, v211, v212, v213
    v_max3_u32 v4, v4, v214, v215
    v_max_u32 v4, v4, v5
    v_cmp_eq_u32 vcc, -1, v4
    s_cbranch_vccz .W_325
.A_324:
    buffer_load_dwordx4 v[208:211], v246, s[8:11], s33 offen offset:0 sc1
    buffer_load_dwordx4 v[212:215], v246, s[8:11], s33 offen offset:1024 sc1
    s_waitcnt vmcnt(4)
    v_max3_u32 v4, v216, v217, v218
    v_max3_u32 v5, v219, v220, v221
    v_max3_u32 v4, v4, v222, v223
    v_max_u32 v4, v4, v5
    v_cmp_eq_u32 vcc, -1, v4
    s_cbranch_vccnz .A_348
.W_351:
    v_smfmac_f32_16x16x64_bf16 v[76:79], v[216:219], v[140:147], v9
    v_smfmac_f32_16x16x64_bf16 v[80:83], v[216:219], v[172:179], v9
    s_waitcnt vmcnt(2)
    v_max3_u32 v4, v192, v193, v194
    v_max3_u32 v5, v195, v196, v197
    v_max3_u32 v4, v4, v198, v199
    v_smfmac_f32_16x16x64_bf16 v[76:79], v[220:223], v[148:155], v9
    v_max_u32 v4, v4, v5
    v_cmp_eq_u32 vcc, -1, v4
    v_smfmac_f32_16x16x64_bf16 v[80:83], v[220:223], v[180:187], v9
    s_cbranch_vccnz .A_352
.W_353:
    v_smfmac_f32_16x16x64_bf16 v[76:79], v[192:195], a[192:199], v9
    v_smfmac_f32_16x16x64_bf16 v[80:83], v[192:195], a[224:231], v9
    s_waitcnt vmcnt(0)
    v_max3_u32 v4, v208, v209, v210
    v_max3_u32 v5, v211, v212, v213
    v_max3_u32 v4, v4, v214, v215
    v_smfmac_f32_16x16x64_bf16 v[76:79], v[196:199], a[200:207], v9
    v_max_u32 v4, v4, v5
    v_cmp_eq_u32 vcc, -1, v4
    v_smfmac_f32_16x16x64_bf16 v[80:83], v[196:199], a[232:239], v9
    s_cbranch_vccz .W_323
    s_branch .A_322
.W_349:
    v_smfmac_f32_16x16x64_bf16 v[76:79], v[192:195], a[192:199], v9
    v_smfmac_f32_16x16x64_bf16 v[80:83], v[192:195], a[224:231], v9
    s_waitcnt vmcnt(2)
    v_max3_u32 v4, v208, v209, v210
    v_max3_u32 v5, v211, v212, v213
    v_max3_u32 v4, v4, v214, v215
    v_smfmac_f32_16x16x64_bf16 v[76:79], v[196:199], a[200:207], v9
    v_max_u32 v4, v4, v5
    v_cmp_eq_u32 vcc, -1, v4
    v_smfmac_f32_16x16x64_bf16 v[80:83], v[196:199], a[232:239], v9
    s_cbranch_vccz .W_232
    s_branch .A_231
.A_354:
    buffer_load_dwordx4 v[216:219], v246, s[8:11], s33 offen offset:2048 sc1
    buffer_load_dwordx4 v[220:223], v246, s[8:11], s33 offen offset:3072 sc1
    s_sub_u32 s62, s62, 1
    s_cbranch_scc1 .mg_end_1
    s_waitcnt vmcnt(4)
    v_max3_u32 v4, v200, v201, v202
    v_max3_u32 v5, v203, v204, v205
    v_max3_u32 v4, v4, v206, v207
    v_max_u32 v4, v4, v5
    v_cmp_eq_u32 vcc, -1, v4
    s_cbranch_vccz .W_230
.A_229:
    buffer_load_dwordx4 v[200:203], v246, s[8:11], s32 offen offset:2048 sc1
    buffer_load_dwordx4 v[204:207], v246, s[8:11], s32 offen offset:3072 sc1
    s_waitcnt vmcnt(4)
    v_max3_u32 v4, v208, v209, v210
    v_max3_u32 v5, v211, v212, v213
    v_max3_u32 v4, v4, v214, v215
    v_max_u32 v4, v4, v5
    v_cmp_eq_u32 vcc, -1, v4
    s_cbranch_vccz .W_355
.A_356:
    buffer_load_dwordx4 v[208:211], v246, s[8:11], s33 offen offset:0 sc1
    buffer_load_dwordx4 v[212:215], v246, s[8:11], s33 offen offset:1024 sc1
    s_waitcnt vmcnt(4)
    v_max3_u32 v4, v216, v217, v218
    v_max3_u32 v5, v219, v220, v221
    v_max3_u32 v4, v4, v222, v223
    v_max_u32 v4, v4, v5
    v_cmp_eq_u32 vcc, -1, v4
    s_cbranch_vccnz .A_354
.W_357:
    v_smfmac_f32_16x16x64_bf16 v[76:79], v[216:219], v[140:147], v9
    v_smfmac_f32_16x16x64_bf16 v[80:83], v[216:219], v[172:179], v9
    s_waitcnt vmcnt(2)
    v_max3_u32 v4, v200, v201, v202
    v_max3_u32 v5, v203, v204, v205
    v_max3_u32 v4, v4, v206, v207
    v_smfmac_f32_16x16x64_bf16 v[76:79], v[220:223], v[148:155], v9
    v_max_u32 v4, v4, v5
    v_cmp_eq_u32 vcc, -1, v4
    v_smfmac_f32_16x16x64_bf16 v[80:83], v[220:223], v[180:187], v9
    s_cbranch_vccz .W_321
    s_branch .A_320
.W_355:
    v_smfmac_f32_16x16x64_bf16 v[76:79], v[208:211], v[124:131], v9
    v_smfmac_f32_16x16x64_bf16 v[80:83], v[208:211], v[156:163], v9
    s_waitcnt vmcnt(2)
    v_max3_u32 v4, v216, v217, v218
    v_max3_u32 v5, v219, v220, v221
    v_max3_u32 v4, v4, v222, v223
    v_smfmac_f32_16x16x64_bf16 v[76:79], v[212:215], v[132:139], v9
    v_max_u32 v4, v4, v5
    v_cmp_eq_u32 vcc, -1, v4
    v_smfmac_f32_16x16x64_bf16 v[80:83], v[212:215], v[164:171], v9
    s_cbranch_vccnz .A_358
.W_359:
    v_smfmac_f32_16x16x64_bf16 v[76:79], v[216:219], v[140:147], v9
    v_smfmac_f32_16x16x64_bf16 v[80:83], v[216:219], v[172:179], v9
    s_waitcnt vmcnt(0)
    v_max3_u32 v4, v200, v201, v202
    v_max3_u32 v5, v203, v204, v205
    v_max3_u32 v4, v4, v206, v207
    v_smfmac_f32_16x16x64_bf16 v[76:79], v[220:223], v[148:155], v9
    v_max_u32 v4, v4, v5
    v_cmp_eq_u32 vcc, -1, v4
    v_smfmac_f32_16x16x64_bf16 v[80:83], v[220:223], v[180:187], v9
    s_cbranch_vccz .W_335
    s_branch .A_334
.A_360:
    buffer_load_dwordx4 v[200:203], v246, s[8:11], s32 offen offset:2048 sc1
    buffer_load_dwordx4 v[204:207], v246, s[8:11], s32 offen offset:3072 sc1
    s_sub_u32 s62, s62, 1
    s_cbranch_scc1 .mg_end_1
    s_waitcnt vmcnt(2)
    v_max3_u32 v4, v192, v193, v194
    v_max3_u32 v5, v195, v196, v197
    v_max3_u32 v4, v4, v198, v199
    v_max_u32 v4, v4, v5
    v_cmp_eq_u32 vcc, -1, v4
    s_cbranch_vccz .W_333
.A_332:
    buffer_load_dwordx4 v[192:195], v246, s[8:11], s32 offen offset:0 sc1
    buffer_load_dwordx4 v[196:199], v246, s[8:11], s32 offen offset:1024 sc1
    s_waitcnt vmcnt(2)
    v_max3_u32 v4, v200, v201, v202
    v_max3_u32 v5, v203, v204, v205
    v_max3_u32 v4, v4, v206, v207
    v_max_u32 v4, v4, v5
    v_cmp_eq_u32 vcc, -1, v4
    s_cbranch_vccnz .A_360
.W_361:
    v_smfmac_f32_16x16x64_bf16 v[76:79], v[200:203], a[208:215], v9
    v_smfmac_f32_16x16x64_bf16 v[80:83], v[200:203], a[240:247], v9
    s_waitcnt vmcnt(0)
    v_max3_u32 v4, v192, v193, v194
    v_max3_u32 v5, v195, v196, v197
    v_max3_u32 v4, v4, v198, v199
    v_smfmac_f32_16x16x64_bf16 v[76:79], v[204:207], a[216:223], v9
    v_max_u32 v4, v4, v5
    v_cmp_eq_u32 vcc, -1, v4
    v_smfmac_f32_16x16x64_bf16 v[80:83], v[204:207], a[248:255], v9
    s_cbranch_vccz .W_329
    s_branch .A_328
.A_340:
    buffer_load_dwordx4 v[208:211], v246, s[8:11], s33 offen offset:0 sc1
    buffer_load_dwordx4 v[212:215], v246, s[8:11], s33 offen offset:1024 sc1
    s_sub_u32 s62, s62, 1
    s_cbranch_scc1 .mg_end_1
    s_waitcnt vmcnt(2)
    v_max3_u32 v4, v192, v193, v194
    v_max3_u32 v5, v195, v196, v197
    v_max3_u32 v4, v4, v198, v199
    v_max_u32 v4, v4, v5
    v_cmp_eq_u32 vcc, -1, v4
    s_cbranch_vccz .W_353
.A_352:
    buffer_load_dwordx4 v[192:195], v246, s[8:11], s32 offen offset:0 sc1
    buffer_load_dwordx4 v[196:199], v246, s[8:11], s32 offen offset:1024 sc1
    s_waitcnt vmcnt(2)
    v_max3_u32 v4, v208, v209, v210
    v_max3_u32 v5, v211, v212, v213
    v_max3_u32 v4, v4, v214, v215
    v_max_u32 v4, v4, v5
    v_cmp_eq_u32 vcc, -1, v4
    s_cbranch_vccnz .A_340
    s_branch .W_341
.A_362:
    buffer_load_dwordx4 v[192:195], v246, s[8:11], s32 offen offset:0 sc1
    buffer_load_dwordx4 v[196:199], v246, s[8:11], s32 offen offset:1024 sc1
    s_sub_u32 s62, s62, 1
    s_cbranch_scc1 .mg_end_1
    s_waitcnt vmcnt(2)
    v_max3_u32 v4, v216, v217, v218
    v_max3_u32 v5, v219, v220, v221
    v_max3_u32 v4, v4, v222, v223
    v_max_u32 v4, v4, v5
    v_cmp_eq_u32 vcc, -1, v4
    s_cbranch_vccz .W_327
.A_326:
    buffer_load_dwordx4 v[216:219], v246, s[8:11], s33 offen offset:2048 sc1
    buffer_load_dwordx4 v[220:223], v246, s[8:11], s33 offen offset:3072 sc1
    s_waitcnt vmcnt(2)
    v_max3_u32 v4, v192, v193, v194
    v_max3_u32 v5, v195, v196, v197
    v_max3_u32 v4, v4, v198, v199
    v_max_u32 v4, v4, v5
    v_cmp_eq_u32 vcc, -1, v4
    s_cbranch_vccnz .A_362
.W_363:
    v_smfmac_f32_16x16x64_bf16 v[76:79], v[192:195], a[192:199], v9
    v_smfmac_f32_16x16x64_bf16 v[80:83], v[192:195], a[224:231], v9
    s_waitcnt vmcnt(0)
    v_max3_u32 v4, v216, v217, v218
    v_max3_u32 v5, v219, v220, v221
    v_max3_u32 v4, v4, v222, v223
    v_smfmac_f32_16x16x64_bf16 v[76:79], v[196:199], a[200:207], v9
    v_max_u32 v4, v4, v5
    v_cmp_eq_u32 vcc, -1, v4
    v_smfmac_f32_16x16x64_bf16 v[80:83], v[196:199], a[232:239], v9
    s_cbranch_vccz .W_234
    s_branch .A_233
.A_364:
    buffer_load_dwordx4 v[208:211], v246, s[8:11], s33 offen offset:0 sc1
    buffer_load_dwordx4 v[212:215], v246, s[8:11], s33 offen offset:1024 sc1
    s_sub_u32 s62, s62, 1
    s_cbranch_scc1 .mg_end_1
    s_waitcnt vmcnt(2)
    v_max3_u32 v4, v200, v201, v202
    v_max3_u32 v5, v203, v204, v205
    v_max3_u32 v4, v4, v206, v207
    v_max_u32 v4, v4, v5
    v_cmp_eq_u32 vcc, -1, v4
    s_cbranch_vccz .W_321
.A_320:
    buffer_load_dwordx4 v[200:203], v246, s[8:11], s32 offen offset:2048 sc1
    buffer_load_dwordx4 v[204:207], v246, s[8:11], s32 offen offset:3072 sc1
    s_waitcnt vmcnt(2)
    v_max3_u32 v4, v208, v209, v210
    v_max3_u32 v5, v211, v212, v213
    v_max3_u32 v4, v4, v214, v215
    v_max_u32 v4, v4, v5
    v_cmp_eq_u32 vcc, -1, v4
    s_cbranch_vccnz .A_364
.W_365:
    v_smfmac_f32_16x16x64_bf16 v[76:79], v[208:211], v[124:131], v9
    v_smfmac_f32_16x16x64_bf16 v[80:83], v[208:211], v[156:163], v9
    s_waitcnt vmcnt(0)
    v_max3_u32 v4, v200, v201, v202
    v_max3_u32 v5, v203, v204, v205
    v_max3_u32 v4, v4, v206, v207
    v_smfmac_f32_16x16x64_bf16 v[76:79], v[212:215], v[132:139], v9
    v_max_u32 v4, v4, v5
    v_cmp_eq_u32 vcc, -1, v4
    v_smfmac_f32_16x16x64_bf16 v[80:83], v[212:215], v[164:171], v9
    s_cbranch_vccz .W_335
    s_branch .A_334
.A_358:
    buffer_load_dwordx4 v[216:219], v246, s[8:11], s33 offen offset:2048 sc1
    buffer_load_dwordx4 v[220:223], v246, s[8:11], s33 offen offset:3072 sc1
    s_sub_u32 s62, s62, 1
    s_cbranch_scc1 .mg_end_1
    s_waitcnt vmcnt(2)
    v_max3_u32 v4, v200, v201, v202
    v_max3_u32 v5, v203, v204, v205
    v_max3_u32 v4, v4, v206, v207
    v_max_u32 v4, v4, v5
    v_cmp_eq_u32 vcc, -1, v4
    s_cbranch_vccz .W_347
.A_346:
    buffer_load_dwordx4 v[200:203], v246, s[8:11], s32 offen offset:2048 sc1
    buffer_load_dwordx4 v[204:207], v246, s[8:11], s32 offen offset:3072 sc1
    s_waitcnt vmcnt(2)
    v_max3_u32 v4, v216, v217, v218
    v_max3_u32 v5, v219, v220, v221
    v_max3_u32 v4, v4, v222, v223
    v_max_u32 v4, v4, v5
    v_cmp_eq_u32 vcc, -1, v4
    s_cbranch_vccnz .A_358
    s_branch .W_359
.A_366:
    buffer_load_dwordx4 v[216:219], v246, s[8:11], s33 offen offset:2048 sc1
    buffer_load_dwordx4 v[220:223], v246, s[8:11], s33 offen offset:3072 sc1
    s_sub_u32 s62, s62, 1
    s_cbranch_scc1 .mg_end_1
    s_waitcnt vmcnt(2)
    v_max3_u32 v4, v208, v209, v210
    v_max3_u32 v5, v211, v212, v213
    v_max3_u32 v4, v4, v214, v215
    v_max_u32 v4, v4, v5
    v_cmp_eq_u32 vcc, -1, v4
    s_cbranch_vccz .W_232
.A_231:
    buffer_load_dwordx4 v[208:211], v246, s[8:11], s33 offen offset:0 sc1
    buffer_load_dwordx4 v[212:215], v246, s[8:11], s33 offen offset:1024 sc1
    s_waitcnt vmcnt(2)
    v_max3_u32 v4, v216, v217, v218
    v_max3_u32 v5, v219, v220, v221
    v_max3_u32 v4, v4, v222, v223
    v_max_u32 v4, v4, v5
    v_cmp_eq_u32 vcc, -1, v4
    s_cbranch_vccnz .A_366
.W_367:
    v_smfmac_f32_16x16x64_bf16 v[76:79], v[216:219], v[140:147], v9
    v_smfmac_f32_16x16x64_bf16 v[80:83], v[216:219], v[172:179], v9
    s_waitcnt vmcnt(0)
    v_max3_u32 v4, v208, v209, v210
    v_max3_u32 v5, v211, v212, v213
    v_max3_u32 v4, v4, v214, v215
    v_smfmac_f32_16x16x64_bf16 v[76:79], v[220:223], v[148:155], v9
    v_max_u32 v4, v4, v5
    v_cmp_eq_u32 vcc, -1, v4
    v_smfmac_f32_16x16x64_bf16 v[80:83], v[220:223], v[180:187], v9
    s_cbranch_vccz .W_323
    s_branch .A_322
.A_328:
    buffer_load_dwordx4 v[192:195], v246, s[8:11], s32 offen offset:0 sc1
    buffer_load_dwordx4 v[196:199], v246, s[8:11], s32 offen offset:1024 sc1
    s_sub_u32 s62, s62, 1
    s_cbranch_scc1 .mg_end_1
    s_waitcnt vmcnt(2)
    v_max3_u32 v4, v192, v193, v194
    v_max3_u32 v5, v195, v196, v197
    v_max3_u32 v4, v4, v198, v199
    v_max_u32 v4, v4, v5
    v_cmp_eq_u32 vcc, -1, v4
    s_cbranch_vccnz .A_328
    v_smfmac_f32_16x16x64_bf16 v[76:79], v[192:195], a[192:199], v9
    v_smfmac_f32_16x16x64_bf16 v[80:83], v[192:195], a[224:231], v9
    v_smfmac_f32_16x16x64_bf16 v[76:79], v[196:199], a[200:207], v9
    v_smfmac_f32_16x16x64_bf16 v[80:83], v[196:199], a[232:239], v9
    s_branch .mj_226
.A_334:
    buffer_load_dwordx4 v[200:203], v246, s[8:11], s32 offen offset:2048 sc1
    buffer_load_dwordx4 v[204:207], v246, s[8:11], s32 offen offset:3072 sc1
    s_sub_u32 s62, s62, 1
    s_cbranch_scc1 .mg_end_1
    s_waitcnt vmcnt(2)
    v_max3_u32 v4, v200, v201, v202
    v_max3_u32 v5, v203, v204, v205
    v_max3_u32 v4, v4, v206, v207
    v_max_u32 v4, v4, v5
    v_cmp_eq_u32 vcc, -1, v4
    s_cbranch_vccnz .A_334
    v_smfmac_f32_16x16x64_bf16 v[76:79], v[200:203], a[208:215], v9
    v_smfmac_f32_16x16x64_bf16 v[80:83], v[200:203], a[240:247], v9
    v_smfmac_f32_16x16x64_bf16 v[76:79], v[204:207], a[216:223], v9
    v_smfmac_f32_16x16x64_bf16 v[80:83], v[204:207], a[248:255], v9
    s_branch .mj_226
.A_322:
    buffer_load_dwordx4 v[208:211], v246, s[8:11], s33 offen offset:0 sc1
    buffer_load_dwordx4 v[212:215], v246, s[8:11], s33 offen offset:1024 sc1
    s_sub_u32 s62, s62, 1
    s_cbranch_scc1 .mg_end_1
    s_waitcnt vmcnt(2)
    v_max3_u32 v4, v208, v209, v210
    v_max3_u32 v5, v211, v212, v213
    v_max3_u32 v4, v4, v214, v215
    v_max_u32 v4, v4, v5
    v_cmp_eq_u32 vcc, -1, v4
    s_cbranch_vccnz .A_322
    v_smfmac_f32_16x16x64_bf16 v[76:79], v[208:211], v[124:131], v9
    v_smfmac_f32_16x16x64_bf16 v[80:83], v[208:211], v[156:163], v9
    v_smfmac_f32_16x16x64_bf16 v[76:79], v[212:215], v[132:139], v9
    v_smfmac_f32_16x16x64_bf16 v[80:83], v[212:215], v[164:171], v9
    s_branch .mj_226
.A_233:
    buffer_load_dwordx4 v[216:219], v246, s[8:11], s33 offen offset:2048 sc1
    buffer_load_dwordx4 v[220:223], v246, s[8:11], s33 offen offset:3072 sc1
    s_sub_u32 s62, s62, 1
    s_cbranch_scc1 .mg_end_1
    s_waitcnt vmcnt(2)
    v_max3_u32 v4, v216, v217, v218
    v_max3_u32 v5, v219, v220, v221
    v_max3_u32 v4, v4, v222, v223
    v_max_u32 v4, v4, v5
    v_cmp_eq_u32 vcc, -1, v4
    s_cbranch_vccnz .A_233
    v_smfmac_f32_16x16x64_bf16 v[76:79], v[216:219], v[140:147], v9
    v_smfmac_f32_16x16x64_bf16 v[80:83], v[216:219], v[172:179], v9
    v_smfmac_f32_16x16x64_bf16 v[76:79], v[220:223], v[148:155], v9
    v_smfmac_f32_16x16x64_bf16 v[80:83], v[220:223], v[180:187], v9
    s_branch .mj_226
.sk_235:
    s_mov_b64 exec, s[66:67]
    buffer_store_dwordx4 v[88:91], v11, s[8:11], s36 offen sc1
    s_mov_b64 exec, s[56:57]
    buffer_store_dwordx4 v[172:175], v12, s[8:11], s36 offen sc1
    s_mov_b64 exec, -1

    s_branch .rec_fin_6
.rec_fin_6:
    s_mov_b64 exec, -1
    s_endpgm
.mg_bg_2:
    s_sub_u32 s91, s25, 4
    s_lshl_b32 s90, s91, 5
    s_add_u32 s90, s90, s26
    s_cmp_ge_u32 s26, 24
    s_cbranch_scc1 .cvrole_368
    s_lshr_b32 s30, s26, 3
    s_sub_u32 s30, 2, s30
    s_and_b32 s31, s26, 7
    s_lshl_b32 s4, s91, 3
    s_add_u32 s31, s31, s4

    s_lshl_b32 s4, s30, 5
    s_add_u32 s4, s4, s31
    s_lshl_b32 s4, s4, 8
    s_add_u32 s4, s4, 92274688
    v_mov_b32 v4, 0
    s_mov_b64 exec, 1
    buffer_store_dword v4, v4, s[8:11], s4 offen sc1
    s_mov_b64 exec, -1

    s_load_dwordx2 s[40:41], s[0:1], 0
    s_load_dwordx4 s[44:47], s[0:1], 64
    s_load_dwordx2 s[42:43], s[0:1], 80

    v_and_b32 v1, 63, v0
    v_and_b32 v2, 15, v1
    v_lshrrev_b32 v3, 4, v1

    s_lshl_b32 s28, s31, 8
    s_waitcnt lgkmcnt(0)
    s_cmp_eq_u32 s30, 0
    s_cselect_b64 s[42:43], s[44:45], s[42:43]
    s_cmp_eq_u32 s30, 1
    s_cselect_b64 s[42:43], s[46:47], s[42:43]

    s_mov_b32 s16, s40
    s_and_b32 s17, s41, 0xffff
    s_mov_b32 s18, 0x400000
    s_mov_b32 s19, 0x00020000

    s_mov_b32 s12, s42
    s_and_b32 s13, s43, 0xffff
    s_mov_b32 s14, 0x800000
    s_mov_b32 s15, 0x00020000

    v_lshrrev_b32 v4, 1, v2
    v_xor_b32 v4, v4, v3
    v_lshlrev_b32 v4, 1, v4
    v_and_b32 v5, 1, v1
    v_or_b32 v4, v4, v5
    v_lshlrev_b32 v4, 4, v4
    v_lshlrev_b32 v5, 13, v3
    v_add_u32 v10, v4, v5
    v_xor_b32 v11, 0x80, v10
    s_lshl_b32 s4, s24, 18
    s_add_u32 s28, s28, s4
    s_lshl_b32 s29, s24, 13
    v_lshrrev_b32 v4, 2, v2
    v_and_b32 v5, 1, v3
    v_lshl_or_b32 v5, v5, 2, v4
    s_lshl_b32 s4, s24, 1
    v_xor_b32 v5, s4, v5
    v_lshlrev_b32 v5, 5, v5
    v_lshl_add_u32 v4, v3, 3, v4
    v_lshl_add_u32 v5, v4, 8, v5
    v_and_b32 v4, 3, v2
    v_lshl_add_u32 v12, v4, 3, v5
    v_xor_b32 v13, 32, v12
    v_add_u32 v14, 0x10000, v12
    v_add_u32 v15, 0x10000, v13

    s_and_b32 s4, s26, 7
    s_lshl_b32 s4, s4, 1
    s_lshr_b32 s5, s24, 1
    s_add_u32 s4, s4, s5
    s_lshl_b32 s4, s4, 6
    v_add_u32 v4, s4, v1
    v_lshlrev_b32 v4, 13, v4
    s_and_b32 s4, s24, 1
    s_lshl_b32 s4, s4, 10
    s_lshl_b32 s5, s91, 11
    s_add_u32 s4, s4, s5
    buffer_load_dword v31, v4, s[12:15], s4 offen offset:384

    s_add_u32 m0, s29, 0
    s_add_u32 s4, s28, 0
    buffer_load_dwordx4 v10, s[12:15], s4 offen lds

    s_add_u32 m0, s29, 1024
    s_add_u32 s4, s28, 32768
    buffer_load_dwordx4 v10, s[12:15], s4 offen lds

    s_add_u32 m0, s29, 2048
    s_add_u32 s4, s28, 65536
    buffer_load_dwordx4 v11, s[12:15], s4 offen lds

    s_add_u32 m0, s29, 3072
    s_add_u32 s4, s28, 98304
    buffer_load_dwordx4 v11, s[12:15], s4 offen lds

    s_add_u32 m0, s29, 4096
    s_add_u32 s4, s28, 131072
    buffer_load_dwordx4 v10, s[12:15], s4 offen lds

    s_add_u32 m0, s29, 5120
    s_add_u32 s4, s28, 163840
    buffer_load_dwordx4 v10, s[12:15], s4 offen lds

    s_add_u32 m0, s29, 6144
    s_add_u32 s4, s28, 196608
    buffer_load_dwordx4 v11, s[12:15], s4 offen lds

    s_add_u32 m0, s29, 7168
    s_add_u32 s4, s28, 229376
    buffer_load_dwordx4 v11, s[12:15], s4 offen lds

    s_waitcnt vmcnt(9)
    v_mov_b32 v243, 1
    v_mov_b32 v242, 0
    s_cmp_lg_u32 s24, 0
    s_cbranch_scc1 .a1_369
    s_mov_b64 exec, 1
    s_cmp_lg_u32 s27, 0
    s_cbranch_scc1 .a1s_370
    s_lshl_b32 s4, s25, 2
    buffer_atomic_add v243, v242, s[20:23], s4 offen offset:32 sc0 sc1
    s_branch .a1_369

.a1s_370:
    buffer_atomic_add v243, v242, s[20:23], s97 offen sc1
.a1_369:
    s_mov_b64 exec, -1
    s_add_u32 m0, s29, 32768
    s_add_u32 s4, s28, 1048576
    buffer_load_dwordx4 v10, s[12:15], s4 offen lds

    s_add_u32 m0, s29, 33792
    s_add_u32 s4, s28, 1081344
    buffer_load_dwordx4 v10, s[12:15], s4 offen lds

    s_add_u32 m0, s29, 34816
    s_add_u32 s4, s28, 1114112
    buffer_load_dwordx4 v11, s[12:15], s4 offen lds

    s_add_u32 m0, s29, 35840
    s_add_u32 s4, s28, 1146880
    buffer_load_dwordx4 v11, s[12:15], s4 offen lds

    s_add_u32 m0, s29, 36864
    s_add_u32 s4, s28, 1179648
    buffer_load_dwordx4 v10, s[12:15], s4 offen lds

    s_add_u32 m0, s29, 37888
    s_add_u32 s4, s28, 1212416
    buffer_load_dwordx4 v10, s[12:15], s4 offen lds

    s_add_u32 m0, s29, 38912
    s_add_u32 s4, s28, 1245184
    buffer_load_dwordx4 v11, s[12:15], s4 offen lds

    s_add_u32 m0, s29, 39936
    s_add_u32 s4, s28, 1277952
    buffer_load_dwordx4 v11, s[12:15], s4 offen lds

    s_add_u32 m0, s29, 65536
    s_add_u32 s4, s28, 2097152
    buffer_load_dwordx4 v10, s[12:15], s4 offen lds

    s_add_u32 m0, s29, 66560
    s_add_u32 s4, s28, 2129920
    buffer_load_dwordx4 v10, s[12:15], s4 offen lds

    s_add_u32 m0, s29, 67584
    s_add_u32 s4, s28, 2162688
    buffer_load_dwordx4 v11, s[12:15], s4 offen lds

    s_add_u32 m0, s29, 68608
    s_add_u32 s4, s28, 2195456
    buffer_load_dwordx4 v11, s[12:15], s4 offen lds

    s_add_u32 m0, s29, 69632
    s_add_u32 s4, s28, 2228224
    buffer_load_dwordx4 v10, s[12:15], s4 offen lds

    s_add_u32 m0, s29, 70656
    s_add_u32 s4, s28, 2260992
    buffer_load_dwordx4 v10, s[12:15], s4 offen lds

    s_add_u32 m0, s29, 71680
    s_add_u32 s4, s28, 2293760
    buffer_load_dwordx4 v11, s[12:15], s4 offen lds

    s_add_u32 m0, s29, 72704
    s_add_u32 s4, s28, 2326528
    buffer_load_dwordx4 v11, s[12:15], s4 offen lds

    s_add_u32 m0, s29, 98304
    s_add_u32 s4, s28, 3145728
    buffer_load_dwordx4 v10, s[12:15], s4 offen lds

    s_add_u32 m0, s29, 99328
    s_add_u32 s4, s28, 3178496
    buffer_load_dwordx4 v10, s[12:15], s4 offen lds

    s_add_u32 m0, s29, 100352
    s_add_u32 s4, s28, 3211264
    buffer_load_dwordx4 v11, s[12:15], s4 offen lds

    s_add_u32 m0, s29, 101376
    s_add_u32 s4, s28, 3244032
    buffer_load_dwordx4 v11, s[12:15], s4 offen lds

    s_add_u32 m0, s29, 102400
    s_add_u32 s4, s28, 3276800
    buffer_load_dwordx4 v10, s[12:15], s4 offen lds

    s_add_u32 m0, s29, 103424
    s_add_u32 s4, s28, 3309568
    buffer_load_dwordx4 v10, s[12:15], s4 offen lds

    s_add_u32 m0, s29, 104448
    s_add_u32 s4, s28, 3342336
    buffer_load_dwordx4 v11, s[12:15], s4 offen lds

    s_add_u32 m0, s29, 105472
    s_add_u32 s4, s28, 3375104
    buffer_load_dwordx4 v11, s[12:15], s4 offen lds

    s_waitcnt vmcnt(24)
    v_readfirstlane_b32 s4, v243
    s_lshl_b32 s5, s24, 8
    s_add_u32 s4, s4, s5
    s_cmp_lg_u32 s4, 31
    s_cbranch_scc1 .a2_371
    s_mov_b64 exec, 1
    v_mov_b32 v243, 32
    buffer_atomic_add v243, v242, s[20:23], s97 offen sc1
    s_mov_b64 exec, -1

.a2_371:
    v_lshrrev_b32 v4, 3, v1
    v_and_b32 v5, 7, v1
    v_xor_b32 v5, v5, v4
    v_lshlrev_b32 v5, 4, v5
    v_lshl_add_u32 v16, v4, 11, v5
    s_lshl_b32 s4, s24, 14
    v_add_u32 v16, s4, v16
    v_and_b32 v4, 7, v2
    v_xor_b32 v5, v4, v3
    v_lshlrev_b32 v5, 4, v5
    v_lshl_add_u32 v5, v4, 7, v5
    v_lshrrev_b32 v4, 3, v2
    v_lshl_add_u32 v17, v4, 13, v5
    v_xor_b32 v18, 64, v17
    v_add_u32 v19, 0x10000, v17
    v_add_u32 v20, 0x10000, v18
    v_lshlrev_b32 v21, 4, v1
    s_lshl_b32 s32, s30, 24
    s_lshl_b32 s4, s31, 13
    s_add_u32 s32, s32, s4
    s_lshr_b32 s5, s30, 1
    s_add_u32 s5, s5, 10
    s_lshl_b32 s4, s24, s5
    s_add_u32 s39, s32, s4
    s_mov_b32 s32, s39
    s_add_u32 s38, s39, 4096
    s_mul_i32 s49, s31, 6144
    s_lshl_b32 s4, s30, 11
    s_add_u32 s49, s49, s4
    s_lshl_b32 s4, s24, 9
    s_add_u32 s49, s49, s4
    s_add_u32 s49, s49, 67108864
    s_mov_b32 s48, s49
    v_mov_b32 v23, -1
    s_lshl_b32 s4, s30, 5
    s_add_u32 s4, s4, s31
    s_lshl_b32 s4, s4, 8
    s_add_u32 s33, s4, 92274688
    s_cmp_eq_u32 s24, 0
    s_cselect_b32 s36, 1, 0
    s_mov_b32 s37, 0
    v_mov_b32 v22, 0
    s_mov_b32 s34, 0
    s_mov_b32 s35, 0
    s_and_b32 s4, s26, 7
    s_lshl_b32 s4, s4, 2
    s_add_u32 s4, s4, s24
    s_lshl_b32 s4, s4, 11
    v_lshlrev_b32 v111, 5, v1
    v_add_u32 v111, s4, v111

    s_mul_i32 s47, s26, 1441792
    s_lshl_b32 s4, s24, 10
    s_add_u32 s47, s47, s4
    s_add_u32 s47, s47, 184549376
    v_mov_b32 v24, -1
    v_mov_b32 v25, -1
    v_mov_b32 v26, -1
    v_mov_b32 v27, -1

    s_xor_b32 s4, s91, 1
    s_lshl_b32 s5, s4, 14
    s_lshl_b32 s6, s91, 12
    s_add_u32 s5, s5, s6
    v_add_u32 v28, s5, v21
    s_lshl_b32 s5, s91, 14
    s_lshl_b32 s6, s4, 12
    s_add_u32 s5, s5, s6
    v_add_u32 v7, s5, v21

    s_xor_b32 s4, s91, 2
    s_lshl_b32 s5, s4, 14
    s_lshl_b32 s6, s91, 12
    s_add_u32 s5, s5, s6
    v_add_u32 v29, s5, v21
    s_lshl_b32 s5, s91, 14
    s_lshl_b32 s6, s4, 12
    s_add_u32 s5, s5, s6
    v_add_u32 v8, s5, v21

    s_xor_b32 s4, s91, 3
    s_lshl_b32 s5, s4, 14
    s_lshl_b32 s6, s91, 12
    s_add_u32 s5, s5, s6
    v_add_u32 v30, s5, v21
    s_lshl_b32 s5, s91, 14
    s_lshl_b32 s6, s4, 12
    s_add_u32 s5, s5, s6
    v_add_u32 v9, s5, v21

    s_mov_b64 s[44:45], -1
    s_mov_b32 s46, s47
    s_waitcnt vmcnt(24)
    s_barrier
    ds_read_b64_tr_b16 a[0:1], v12 offset:0
    ds_read_b64_tr_b16 a[2:3], v12 offset:1024
    ds_read_b64_tr_b16 a[4:5], v13 offset:0
    ds_read_b64_tr_b16 a[6:7], v13 offset:1024
    ds_read_b64_tr_b16 a[8:9], v12 offset:8192
    ds_read_b64_tr_b16 a[10:11], v12 offset:9216
    ds_read_b64_tr_b16 a[12:13], v13 offset:8192
    ds_read_b64_tr_b16 a[14:15], v13 offset:9216
    ds_read_b64_tr_b16 a[16:17], v12 offset:16384
    ds_read_b64_tr_b16 a[18:19], v12 offset:17408
    ds_read_b64_tr_b16 a[20:21], v13 offset:16384
    ds_read_b64_tr_b16 a[22:23], v13 offset:17408
    ds_read_b64_tr_b16 a[24:25], v12 offset:24576
    ds_read_b64_tr_b16 a[26:27], v12 offset:25600
    ds_read_b64_tr_b16 a[28:29], v13 offset:24576
    ds_read_b64_tr_b16 a[30:31], v13 offset:25600
    s_waitcnt lgkmcnt(0)
    s_barrier
    s_add_u32 m0, s29, 0
    s_add_u32 s4, s28, 4194304
    buffer_load_dwordx4 v10, s[12:15], s4 offen lds

    s_add_u32 m0, s29, 1024
    s_add_u32 s4, s28, 4227072
    buffer_load_dwordx4 v10, s[12:15], s4 offen lds

    s_add_u32 m0, s29, 2048
    s_add_u32 s4, s28, 4259840
    buffer_load_dwordx4 v11, s[12:15], s4 offen lds

    s_add_u32 m0, s29, 3072
    s_add_u32 s4, s28, 4292608
    buffer_load_dwordx4 v11, s[12:15], s4 offen lds

    s_add_u32 m0, s29, 4096
    s_add_u32 s4, s28, 4325376
    buffer_load_dwordx4 v10, s[12:15], s4 offen lds

    s_add_u32 m0, s29, 5120
    s_add_u32 s4, s28, 4358144
    buffer_load_dwordx4 v10, s[12:15], s4 offen lds

    s_add_u32 m0, s29, 6144
    s_add_u32 s4, s28, 4390912
    buffer_load_dwordx4 v11, s[12:15], s4 offen lds

    s_add_u32 m0, s29, 7168
    s_add_u32 s4, s28, 4423680
    buffer_load_dwordx4 v11, s[12:15], s4 offen lds

    s_waitcnt vmcnt(24)
    s_barrier
    ds_read_b64_tr_b16 a[32:33], v12 offset:32768
    ds_read_b64_tr_b16 a[34:35], v12 offset:33792
    ds_read_b64_tr_b16 a[36:37], v13 offset:32768
    ds_read_b64_tr_b16 a[38:39], v13 offset:33792
    ds_read_b64_tr_b16 a[40:41], v12 offset:40960
    ds_read_b64_tr_b16 a[42:43], v12 offset:41984
    ds_read_b64_tr_b16 a[44:45], v13 offset:40960
    ds_read_b64_tr_b16 a[46:47], v13 offset:41984
    ds_read_b64_tr_b16 a[48:49], v12 offset:49152
    ds_read_b64_tr_b16 a[50:51], v12 offset:50176
    ds_read_b64_tr_b16 a[52:53], v13 offset:49152
    ds_read_b64_tr_b16 a[54:55], v13 offset:50176
    ds_read_b64_tr_b16 a[56:57], v12 offset:57344
    ds_read_b64_tr_b16 a[58:59], v12 offset:58368
    ds_read_b64_tr_b16 a[60:61], v13 offset:57344
    ds_read_b64_tr_b16 a[62:63], v13 offset:58368
    s_waitcnt lgkmcnt(0)
    s_barrier
    s_add_u32 m0, s29, 32768
    s_add_u32 s4, s28, 5242880
    buffer_load_dwordx4 v10, s[12:15], s4 offen lds

    s_add_u32 m0, s29, 33792
    s_add_u32 s4, s28, 5275648
    buffer_load_dwordx4 v10, s[12:15], s4 offen lds

    s_add_u32 m0, s29, 34816
    s_add_u32 s4, s28, 5308416
    buffer_load_dwordx4 v11, s[12:15], s4 offen lds

    s_add_u32 m0, s29, 35840
    s_add_u32 s4, s28, 5341184
    buffer_load_dwordx4 v11, s[12:15], s4 offen lds

    s_add_u32 m0, s29, 36864
    s_add_u32 s4, s28, 5373952
    buffer_load_dwordx4 v10, s[12:15], s4 offen lds

    s_add_u32 m0, s29, 37888
    s_add_u32 s4, s28, 5406720
    buffer_load_dwordx4 v10, s[12:15], s4 offen lds

    s_add_u32 m0, s29, 38912
    s_add_u32 s4, s28, 5439488
    buffer_load_dwordx4 v11, s[12:15], s4 offen lds

    s_add_u32 m0, s29, 39936
    s_add_u32 s4, s28, 5472256
    buffer_load_dwordx4 v11, s[12:15], s4 offen lds

    s_waitcnt vmcnt(24)
    s_barrier
    ds_read_b64_tr_b16 a[64:65], v14 offset:0
    ds_read_b64_tr_b16 a[66:67], v14 offset:1024
    ds_read_b64_tr_b16 a[68:69], v15 offset:0
    ds_read_b64_tr_b16 a[70:71], v15 offset:1024
    ds_read_b64_tr_b16 a[72:73], v14 offset:8192
    ds_read_b64_tr_b16 a[74:75], v14 offset:9216
    ds_read_b64_tr_b16 a[76:77], v15 offset:8192
    ds_read_b64_tr_b16 a[78:79], v15 offset:9216
    ds_read_b64_tr_b16 a[80:81], v14 offset:16384
    ds_read_b64_tr_b16 a[82:83], v14 offset:17408
    ds_read_b64_tr_b16 a[84:85], v15 offset:16384
    ds_read_b64_tr_b16 a[86:87], v15 offset:17408
    ds_read_b64_tr_b16 a[88:89], v14 offset:24576
    ds_read_b64_tr_b16 a[90:91], v14 offset:25600
    ds_read_b64_tr_b16 a[92:93], v15 offset:24576
    ds_read_b64_tr_b16 a[94:95], v15 offset:25600
    s_waitcnt lgkmcnt(0)
    s_barrier
    s_add_u32 m0, s29, 65536
    s_add_u32 s4, s28, 6291456
    buffer_load_dwordx4 v10, s[12:15], s4 offen lds

    s_add_u32 m0, s29, 66560
    s_add_u32 s4, s28, 6324224
    buffer_load_dwordx4 v10, s[12:15], s4 offen lds

    s_add_u32 m0, s29, 67584
    s_add_u32 s4, s28, 6356992
    buffer_load_dwordx4 v11, s[12:15], s4 offen lds

    s_add_u32 m0, s29, 68608
    s_add_u32 s4, s28, 6389760
    buffer_load_dwordx4 v11, s[12:15], s4 offen lds

    s_add_u32 m0, s29, 69632
    s_add_u32 s4, s28, 6422528
    buffer_load_dwordx4 v10, s[12:15], s4 offen lds

    s_add_u32 m0, s29, 70656
    s_add_u32 s4, s28, 6455296
    buffer_load_dwordx4 v10, s[12:15], s4 offen lds

    s_add_u32 m0, s29, 71680
    s_add_u32 s4, s28, 6488064
    buffer_load_dwordx4 v11, s[12:15], s4 offen lds

    s_add_u32 m0, s29, 72704
    s_add_u32 s4, s28, 6520832
    buffer_load_dwordx4 v11, s[12:15], s4 offen lds

    s_waitcnt vmcnt(24)
    s_barrier
    ds_read_b64_tr_b16 a[96:97], v14 offset:32768
    ds_read_b64_tr_b16 a[98:99], v14 offset:33792
    ds_read_b64_tr_b16 a[100:101], v15 offset:32768
    ds_read_b64_tr_b16 a[102:103], v15 offset:33792
    ds_read_b64_tr_b16 a[104:105], v14 offset:40960
    ds_read_b64_tr_b16 a[106:107], v14 offset:41984
    ds_read_b64_tr_b16 a[108:109], v15 offset:40960
    ds_read_b64_tr_b16 a[110:111], v15 offset:41984
    ds_read_b64_tr_b16 a[112:113], v14 offset:49152
    ds_read_b64_tr_b16 a[114:115], v14 offset:50176
    ds_read_b64_tr_b16 a[116:117], v15 offset:49152
    ds_read_b64_tr_b16 a[118:119], v15 offset:50176
    ds_read_b64_tr_b16 a[120:121], v14 offset:57344
    ds_read_b64_tr_b16 a[122:123], v14 offset:58368
    ds_read_b64_tr_b16 a[124:125], v15 offset:57344
    ds_read_b64_tr_b16 a[126:127], v15 offset:58368
    s_waitcnt lgkmcnt(0)
    s_barrier
    s_add_u32 m0, s29, 98304
    s_add_u32 s4, s28, 7340032
    buffer_load_dwordx4 v10, s[12:15], s4 offen lds

    s_add_u32 m0, s29, 99328
    s_add_u32 s4, s28, 7372800
    buffer_load_dwordx4 v10, s[12:15], s4 offen lds

    s_add_u32 m0, s29, 100352
    s_add_u32 s4, s28, 7405568
    buffer_load_dwordx4 v11, s[12:15], s4 offen lds

    s_add_u32 m0, s29, 101376
    s_add_u32 s4, s28, 7438336
    buffer_load_dwordx4 v11, s[12:15], s4 offen lds

    s_add_u32 m0, s29, 102400
    s_add_u32 s4, s28, 7471104
    buffer_load_dwordx4 v10, s[12:15], s4 offen lds

    s_add_u32 m0, s29, 103424
    s_add_u32 s4, s28, 7503872
    buffer_load_dwordx4 v10, s[12:15], s4 offen lds

    s_add_u32 m0, s29, 104448
    s_add_u32 s4, s28, 7536640
    buffer_load_dwordx4 v11, s[12:15], s4 offen lds

    s_add_u32 m0, s29, 105472
    s_add_u32 s4, s28, 7569408
    buffer_load_dwordx4 v11, s[12:15], s4 offen lds

    v_and_b32 v241, 3, v0
    v_lshlrev_b32 v241, 2, v241
    buffer_load_dword v240, v241, s[20:23], s97 offen sc1

    s_waitcnt vmcnt(25)
    s_barrier
    ds_read_b64_tr_b16 a[128:129], v12 offset:0
    ds_read_b64_tr_b16 a[130:131], v12 offset:1024
    ds_read_b64_tr_b16 a[132:133], v13 offset:0
    ds_read_b64_tr_b16 a[134:135], v13 offset:1024
    ds_read_b64_tr_b16 a[136:137], v12 offset:8192
    ds_read_b64_tr_b16 a[138:139], v12 offset:9216
    ds_read_b64_tr_b16 a[140:141], v13 offset:8192
    ds_read_b64_tr_b16 a[142:143], v13 offset:9216
    ds_read_b64_tr_b16 a[144:145], v12 offset:16384
    ds_read_b64_tr_b16 a[146:147], v12 offset:17408
    ds_read_b64_tr_b16 a[148:149], v13 offset:16384
    ds_read_b64_tr_b16 a[150:151], v13 offset:17408
    ds_read_b64_tr_b16 a[152:153], v12 offset:24576
    ds_read_b64_tr_b16 a[154:155], v12 offset:25600
    ds_read_b64_tr_b16 a[156:157], v13 offset:24576
    ds_read_b64_tr_b16 a[158:159], v13 offset:25600
    s_waitcnt lgkmcnt(0)
    s_barrier
    s_add_u32 m0, s29, 0
    s_nop 0
    buffer_load_dwordx4 v16, s[16:19], s34 offen offset:0 lds
    s_add_u32 m0, s29, 896
    s_nop 0
    buffer_load_dwordx4 v16, s[16:19], s34 offen offset:128 lds
    s_add_u32 m0, s29, 1792
    s_nop 0
    buffer_load_dwordx4 v16, s[16:19], s34 offen offset:256 lds
    s_add_u32 m0, s29, 2688
    s_nop 0
    buffer_load_dwordx4 v16, s[16:19], s34 offen offset:384 lds
    s_add_u32 m0, s29, 3584
    s_nop 0
    buffer_load_dwordx4 v16, s[16:19], s34 offen offset:512 lds
    s_add_u32 m0, s29, 4480
    s_nop 0
    buffer_load_dwordx4 v16, s[16:19], s34 offen offset:640 lds
    s_add_u32 m0, s29, 5376
    s_nop 0
    buffer_load_dwordx4 v16, s[16:19], s34 offen offset:768 lds
    s_add_u32 m0, s29, 6272
    s_nop 0
    buffer_load_dwordx4 v16, s[16:19], s34 offen offset:896 lds
    s_add_u32 s34, s34, 1024
    s_waitcnt vmcnt(25)
    s_barrier
    ds_read_b64_tr_b16 a[160:161], v12 offset:32768
    ds_read_b64_tr_b16 a[162:163], v12 offset:33792
    ds_read_b64_tr_b16 a[164:165], v13 offset:32768
    ds_read_b64_tr_b16 a[166:167], v13 offset:33792
    ds_read_b64_tr_b16 a[168:169], v12 offset:40960
    ds_read_b64_tr_b16 a[170:171], v12 offset:41984
    ds_read_b64_tr_b16 a[172:173], v13 offset:40960
    ds_read_b64_tr_b16 a[174:175], v13 offset:41984
    ds_read_b64_tr_b16 a[176:177], v12 offset:49152
    ds_read_b64_tr_b16 a[178:179], v12 offset:50176
    ds_read_b64_tr_b16 a[180:181], v13 offset:49152
    ds_read_b64_tr_b16 a[182:183], v13 offset:50176
    ds_read_b64_tr_b16 a[184:185], v12 offset:57344
    ds_read_b64_tr_b16 a[186:187], v12 offset:58368
    ds_read_b64_tr_b16 a[188:189], v13 offset:57344
    ds_read_b64_tr_b16 a[190:191], v13 offset:58368
    s_waitcnt lgkmcnt(0)
    s_barrier
    s_add_u32 m0, s29, 32768
    s_nop 0
    buffer_load_dwordx4 v16, s[16:19], s34 offen offset:0 lds
    s_add_u32 m0, s29, 33664
    s_nop 0
    buffer_load_dwordx4 v16, s[16:19], s34 offen offset:128 lds
    s_add_u32 m0, s29, 34560
    s_nop 0
    buffer_load_dwordx4 v16, s[16:19], s34 offen offset:256 lds
    s_add_u32 m0, s29, 35456
    s_nop 0
    buffer_load_dwordx4 v16, s[16:19], s34 offen offset:384 lds
    s_add_u32 m0, s29, 36352
    s_nop 0
    buffer_load_dwordx4 v16, s[16:19], s34 offen offset:512 lds
    s_add_u32 m0, s29, 37248
    s_nop 0
    buffer_load_dwordx4 v16, s[16:19], s34 offen offset:640 lds
    s_add_u32 m0, s29, 38144
    s_nop 0
    buffer_load_dwordx4 v16, s[16:19], s34 offen offset:768 lds
    s_add_u32 m0, s29, 39040
    s_nop 0
    buffer_load_dwordx4 v16, s[16:19], s34 offen offset:896 lds
    s_add_u32 s34, s34, 64512
    s_min_u32 s34, s34, 4128768
    s_waitcnt vmcnt(25)
    s_barrier
    ds_read_b64_tr_b16 a[192:193], v14 offset:0
    ds_read_b64_tr_b16 a[194:195], v14 offset:1024
    ds_read_b64_tr_b16 a[196:197], v15 offset:0
    ds_read_b64_tr_b16 a[198:199], v15 offset:1024
    ds_read_b64_tr_b16 a[200:201], v14 offset:8192
    ds_read_b64_tr_b16 a[202:203], v14 offset:9216
    ds_read_b64_tr_b16 a[204:205], v15 offset:8192
    ds_read_b64_tr_b16 a[206:207], v15 offset:9216
    ds_read_b64_tr_b16 a[208:209], v14 offset:16384
    ds_read_b64_tr_b16 a[210:211], v14 offset:17408
    ds_read_b64_tr_b16 a[212:213], v15 offset:16384
    ds_read_b64_tr_b16 a[214:215], v15 offset:17408
    ds_read_b64_tr_b16 a[216:217], v14 offset:24576
    ds_read_b64_tr_b16 a[218:219], v14 offset:25600
    ds_read_b64_tr_b16 a[220:221], v15 offset:24576
    ds_read_b64_tr_b16 a[222:223], v15 offset:25600
    s_waitcnt lgkmcnt(0)
    s_barrier
    s_add_u32 m0, s29, 65536
    s_nop 0
    buffer_load_dwordx4 v16, s[16:19], s34 offen offset:0 lds
    s_add_u32 m0, s29, 66432
    s_nop 0
    buffer_load_dwordx4 v16, s[16:19], s34 offen offset:128 lds
    s_add_u32 m0, s29, 67328
    s_nop 0
    buffer_load_dwordx4 v16, s[16:19], s34 offen offset:256 lds
    s_add_u32 m0, s29, 68224
    s_nop 0
    buffer_load_dwordx4 v16, s[16:19], s34 offen offset:384 lds
    s_add_u32 m0, s29, 69120
    s_nop 0
    buffer_load_dwordx4 v16, s[16:19], s34 offen offset:512 lds
    s_add_u32 m0, s29, 70016
    s_nop 0
    buffer_load_dwordx4 v16, s[16:19], s34 offen offset:640 lds
    s_add_u32 m0, s29, 70912
    s_nop 0
    buffer_load_dwordx4 v16, s[16:19], s34 offen offset:768 lds
    s_add_u32 m0, s29, 71808
    s_nop 0
    buffer_load_dwordx4 v16, s[16:19], s34 offen offset:896 lds
    s_add_u32 s34, s34, 1024
    s_waitcnt vmcnt(24)
    s_barrier
    ds_read_b64_tr_b16 a[224:225], v14 offset:32768
    ds_read_b64_tr_b16 a[226:227], v14 offset:33792
    ds_read_b64_tr_b16 a[228:229], v15 offset:32768
    ds_read_b64_tr_b16 a[230:231], v15 offset:33792
    ds_read_b64_tr_b16 a[232:233], v14 offset:40960
    ds_read_b64_tr_b16 a[234:235], v14 offset:41984
    ds_read_b64_tr_b16 a[236:237], v15 offset:40960
    ds_read_b64_tr_b16 a[238:239], v15 offset:41984
    ds_read_b64_tr_b16 a[240:241], v14 offset:49152
    ds_read_b64_tr_b16 a[242:243], v14 offset:50176
    ds_read_b64_tr_b16 a[244:245], v15 offset:49152
    ds_read_b64_tr_b16 a[246:247], v15 offset:50176
    ds_read_b64_tr_b16 a[248:249], v14 offset:57344
    ds_read_b64_tr_b16 a[250:251], v14 offset:58368
    ds_read_b64_tr_b16 a[252:253], v15 offset:57344
    ds_read_b64_tr_b16 a[254:255], v15 offset:58368
    s_mov_b32 s62, 0
.vp_372:
    v_readlane_b32 s4, v240, 0
    v_readlane_b32 s7, v240, 1
    v_readlane_b32 s6, v240, 2

    s_cmp_ge_u32 s4, 256
    s_cbranch_scc1 .vd_373
    s_cmp_lg_u32 s6, 0
    s_cbranch_scc1 .vs_374
    s_add_u32 s62, s62, 1
    s_cmp_gt_u32 s62, 0x100000
    s_cbranch_scc1 .mg_end_1
    s_sleep 8
    buffer_load_dword v240, v241, s[20:23], s97 offen sc1
    s_waitcnt vmcnt(0)
    s_branch .vp_372

.vs_374:
    s_lshr_b32 s25, s2, 5
    s_and_b32 s26, s2, 31
    s_mov_b32 s27, 1
    s_mov_b32 s97, 144
    s_waitcnt vmcnt(0) lgkmcnt(0)
    s_barrier
    s_branch .mg_role_3

.vd_373:
    s_waitcnt lgkmcnt(0)
    s_barrier
    s_cmp_eq_u32 s30, 2
    s_cbranch_scc1 .qv_375
    s_waitcnt vmcnt(16)
    s_barrier
    ds_read_b128 v[32:35], v17 offset:0
    ds_read_b128 v[36:39], v17 offset:16384
    ds_read_b128 v[40:43], v18 offset:0
    ds_read_b128 v[44:47], v18 offset:16384
    s_add_u32 m0, s29, 98304
    s_nop 0
    buffer_load_dwordx4 v16, s[16:19], s34 offen offset:0 lds
    ds_read_b128 v[48:51], v17 offset:1024
    ds_read_b128 v[52:55], v17 offset:17408
    s_branch .qe_378
.p2align 6
.ql_377:
.qe_378:
    s_waitcnt lgkmcnt(4)
    v_mfma_f32_16x16x32_bf16 v[64:67], a[0:3], v[32:35], 0
    ds_read_b128 v[56:59], v18 offset:1024
    s_add_u32 m0, s29, 99200
    v_mfma_f32_16x16x32_bf16 v[68:71], a[4:7], v[32:35], 0
    buffer_load_dwordx4 v16, s[16:19], s34 offen offset:128 lds
    v_mfma_f32_16x16x32_bf16 v[72:75], a[0:3], v[36:39], 0
    ds_read_b128 v[60:63], v18 offset:17408
    v_mfma_f32_16x16x32_bf16 v[76:79], a[4:7], v[36:39], 0
    s_waitcnt lgkmcnt(4)
    v_mfma_f32_16x16x32_bf16 v[64:67], a[8:11], v[40:43], v[64:67]
    ds_read_b128 v[32:35], v17 offset:2048
    v_mfma_f32_16x16x32_bf16 v[68:71], a[12:15], v[40:43], v[68:71]
    v_cvt_pk_bf16_f32 v96, v80, v81
    v_cvt_pk_bf16_f32 v97, v82, v83
    v_mfma_f32_16x16x32_bf16 v[72:75], a[8:11], v[44:47], v[72:75]
    ds_read_b128 v[36:39], v17 offset:18432
    v_mfma_f32_16x16x32_bf16 v[76:79], a[12:15], v[44:47], v[76:79]
    v_cvt_pk_bf16_f32 v98, v84, v85
    v_cvt_pk_bf16_f32 v99, v86, v87
    s_waitcnt lgkmcnt(4)
    v_mfma_f32_16x16x32_bf16 v[64:67], a[16:19], v[48:51], v[64:67]
    ds_read_b128 v[40:43], v18 offset:2048
    s_add_u32 m0, s29, 100096
    v_mfma_f32_16x16x32_bf16 v[68:71], a[20:23], v[48:51], v[68:71]
    buffer_load_dwordx4 v16, s[16:19], s34 offen offset:256 lds
    v_mfma_f32_16x16x32_bf16 v[72:75], a[16:19], v[52:55], v[72:75]
    ds_read_b128 v[44:47], v18 offset:18432
    v_mfma_f32_16x16x32_bf16 v[76:79], a[20:23], v[52:55], v[76:79]
    s_waitcnt lgkmcnt(4)
    v_mfma_f32_16x16x32_bf16 v[64:67], a[24:27], v[56:59], v[64:67]
    ds_read_b128 v[48:51], v17 offset:3072
    v_mfma_f32_16x16x32_bf16 v[68:71], a[28:31], v[56:59], v[68:71]
    buffer_store_dwordx4 v[96:99], v21, s[8:11], s32 offen sc1
    v_mfma_f32_16x16x32_bf16 v[72:75], a[24:27], v[60:63], v[72:75]
    ds_read_b128 v[52:55], v17 offset:19456
    v_mfma_f32_16x16x32_bf16 v[76:79], a[28:31], v[60:63], v[76:79]
    s_waitcnt lgkmcnt(4)
    v_mfma_f32_16x16x32_bf16 v[64:67], a[32:35], v[32:35], v[64:67]
    ds_read_b128 v[56:59], v18 offset:3072
    s_add_u32 m0, s29, 100992
    v_mfma_f32_16x16x32_bf16 v[68:71], a[36:39], v[32:35], v[68:71]
    buffer_load_dwordx4 v16, s[16:19], s34 offen offset:384 lds
    v_mfma_f32_16x16x32_bf16 v[72:75], a[32:35], v[36:39], v[72:75]
    ds_read_b128 v[60:63], v18 offset:19456
    v_mfma_f32_16x16x32_bf16 v[76:79], a[36:39], v[36:39], v[76:79]
    s_waitcnt lgkmcnt(4)
    v_mfma_f32_16x16x32_bf16 v[64:67], a[40:43], v[40:43], v[64:67]
    ds_read_b128 v[32:35], v17 offset:4096
    v_mfma_f32_16x16x32_bf16 v[68:71], a[44:47], v[40:43], v[68:71]
    v_cvt_pk_bf16_f32 v100, v88, v89
    v_cvt_pk_bf16_f32 v101, v90, v91
    v_mfma_f32_16x16x32_bf16 v[72:75], a[40:43], v[44:47], v[72:75]
    ds_read_b128 v[36:39], v17 offset:20480
    v_mfma_f32_16x16x32_bf16 v[76:79], a[44:47], v[44:47], v[76:79]
    v_cvt_pk_bf16_f32 v102, v92, v93
    v_cvt_pk_bf16_f32 v103, v94, v95
    s_waitcnt lgkmcnt(4)
    v_mfma_f32_16x16x32_bf16 v[64:67], a[48:51], v[48:51], v[64:67]
    ds_read_b128 v[40:43], v18 offset:4096
    s_add_u32 m0, s29, 101888
    v_mfma_f32_16x16x32_bf16 v[68:71], a[52:55], v[48:51], v[68:71]
    buffer_load_dwordx4 v16, s[16:19], s34 offen offset:512 lds
    v_mfma_f32_16x16x32_bf16 v[72:75], a[48:51], v[52:55], v[72:75]
    ds_read_b128 v[44:47], v18 offset:20480
    v_mfma_f32_16x16x32_bf16 v[76:79], a[52:55], v[52:55], v[76:79]
    s_waitcnt lgkmcnt(4)
    v_mfma_f32_16x16x32_bf16 v[64:67], a[56:59], v[56:59], v[64:67]
    ds_read_b128 v[48:51], v17 offset:5120
    v_mfma_f32_16x16x32_bf16 v[68:71], a[60:63], v[56:59], v[68:71]
    buffer_store_dwordx4 v[100:103], v21, s[8:11], s38 offen sc1
    v_mfma_f32_16x16x32_bf16 v[72:75], a[56:59], v[60:63], v[72:75]
    ds_read_b128 v[52:55], v17 offset:21504
    v_mfma_f32_16x16x32_bf16 v[76:79], a[60:63], v[60:63], v[76:79]
    s_waitcnt lgkmcnt(4)
    v_mfma_f32_16x16x32_bf16 v[64:67], a[64:67], v[32:35], v[64:67]
    ds_read_b128 v[56:59], v18 offset:5120
    s_add_u32 m0, s29, 102784
    v_mfma_f32_16x16x32_bf16 v[68:71], a[68:71], v[32:35], v[68:71]
    buffer_load_dwordx4 v16, s[16:19], s34 offen offset:640 lds
    v_mfma_f32_16x16x32_bf16 v[72:75], a[64:67], v[36:39], v[72:75]
    ds_read_b128 v[60:63], v18 offset:21504
    v_mfma_f32_16x16x32_bf16 v[76:79], a[68:71], v[36:39], v[76:79]
    s_mov_b32 exec_hi, 0
    buffer_store_dwordx4 v[24:27], v21, s[8:11], s48 offen sc1
    s_mov_b32 exec_hi, -1

    s_waitcnt lgkmcnt(4)
    v_mfma_f32_16x16x32_bf16 v[64:67], a[72:75], v[40:43], v[64:67]
    ds_read_b128 v[32:35], v17 offset:6144
    v_mfma_f32_16x16x32_bf16 v[68:71], a[76:79], v[40:43], v[68:71]
    s_mov_b32 s32, s39
    s_add_u32 s38, s39, 4096
    s_add_u32 s39, s39, 262144
    s_mov_b32 s48, s49
    s_add_u32 s49, s49, 196608
    v_mfma_f32_16x16x32_bf16 v[72:75], a[72:75], v[44:47], v[72:75]
    ds_read_b128 v[36:39], v17 offset:22528
    v_mfma_f32_16x16x32_bf16 v[76:79], a[76:79], v[44:47], v[76:79]
    v_add_u32 v23, 1, v23
    s_waitcnt lgkmcnt(4)
    v_mfma_f32_16x16x32_bf16 v[64:67], a[80:83], v[48:51], v[64:67]
    ds_read_b128 v[40:43], v18 offset:6144
    s_add_u32 m0, s29, 103680
    v_mfma_f32_16x16x32_bf16 v[68:71], a[84:87], v[48:51], v[68:71]
    buffer_load_dwordx4 v16, s[16:19], s34 offen offset:768 lds
    v_mfma_f32_16x16x32_bf16 v[72:75], a[80:83], v[52:55], v[72:75]
    ds_read_b128 v[44:47], v18 offset:22528
    v_mfma_f32_16x16x32_bf16 v[76:79], a[84:87], v[52:55], v[76:79]
    s_waitcnt lgkmcnt(4)
    v_mfma_f32_16x16x32_bf16 v[64:67], a[88:91], v[56:59], v[64:67]
    ds_read_b128 v[48:51], v17 offset:7168
    v_mfma_f32_16x16x32_bf16 v[68:71], a[92:95], v[56:59], v[68:71]
    v_mfma_f32_16x16x32_bf16 v[72:75], a[88:91], v[60:63], v[72:75]
    ds_read_b128 v[52:55], v17 offset:23552
    v_mfma_f32_16x16x32_bf16 v[76:79], a[92:95], v[60:63], v[76:79]
    s_mov_b64 exec, s[44:45]
    buffer_store_dwordx4 v[24:27], v28, s[8:11], s46 offen sc1
    s_mov_b64 exec, -1
    s_waitcnt lgkmcnt(4)
    v_mfma_f32_16x16x32_bf16 v[64:67], a[96:99], v[32:35], v[64:67]
    ds_read_b128 v[56:59], v18 offset:7168
    s_add_u32 m0, s29, 104576
    v_mfma_f32_16x16x32_bf16 v[68:71], a[100:103], v[32:35], v[68:71]
    buffer_load_dwordx4 v16, s[16:19], s34 offen offset:896 lds
    v_mfma_f32_16x16x32_bf16 v[72:75], a[96:99], v[36:39], v[72:75]
    ds_read_b128 v[60:63], v18 offset:23552
    v_mfma_f32_16x16x32_bf16 v[76:79], a[100:103], v[36:39], v[76:79]
    s_waitcnt lgkmcnt(4)
    v_mfma_f32_16x16x32_bf16 v[64:67], a[104:107], v[40:43], v[64:67]
    s_add_u32 s34, s34, 64512
    s_min_u32 s34, s34, 4128768
    v_mfma_f32_16x16x32_bf16 v[68:71], a[108:111], v[40:43], v[68:71]
    v_mfma_f32_16x16x32_bf16 v[72:75], a[104:107], v[44:47], v[72:75]
    v_mfma_f32_16x16x32_bf16 v[76:79], a[108:111], v[44:47], v[76:79]
    s_waitcnt lgkmcnt(0)
    s_waitcnt vmcnt(19)
    s_barrier
    ds_read_b128 v[32:35], v17 offset:32768
    ds_read_b128 v[36:39], v17 offset:49152
    v_mfma_f32_16x16x32_bf16 v[64:67], a[112:115], v[48:51], v[64:67]
    ds_read_b128 v[40:43], v18 offset:32768
    s_add_u32 m0, s29, 0
    v_mfma_f32_16x16x32_bf16 v[68:71], a[116:119], v[48:51], v[68:71]
    buffer_load_dwordx4 v16, s[16:19], s34 offen offset:0 lds
    v_mfma_f32_16x16x32_bf16 v[72:75], a[112:115], v[52:55], v[72:75]
    ds_read_b128 v[44:47], v18 offset:49152
    v_mfma_f32_16x16x32_bf16 v[76:79], a[116:119], v[52:55], v[76:79]
    v_mfma_f32_16x16x32_bf16 v[64:67], a[120:123], v[56:59], v[64:67]
    ds_read_b128 v[48:51], v17 offset:33792
    v_mfma_f32_16x16x32_bf16 v[68:71], a[124:127], v[56:59], v[68:71]
    v_mfma_f32_16x16x32_bf16 v[72:75], a[120:123], v[60:63], v[72:75]
    ds_read_b128 v[52:55], v17 offset:50176
    v_mfma_f32_16x16x32_bf16 v[76:79], a[124:127], v[60:63], v[76:79]
    s_waitcnt lgkmcnt(4)
    v_mfma_f32_16x16x32_bf16 v[64:67], a[128:131], v[32:35], v[64:67]
    ds_read_b128 v[56:59], v18 offset:33792
    s_add_u32 m0, s29, 896
    v_mfma_f32_16x16x32_bf16 v[68:71], a[132:135], v[32:35], v[68:71]
    buffer_load_dwordx4 v16, s[16:19], s34 offen offset:128 lds
    v_mfma_f32_16x16x32_bf16 v[72:75], a[128:131], v[36:39], v[72:75]
    ds_read_b128 v[60:63], v18 offset:50176
    v_mfma_f32_16x16x32_bf16 v[76:79], a[132:135], v[36:39], v[76:79]
    s_waitcnt lgkmcnt(4)
    v_mfma_f32_16x16x32_bf16 v[64:67], a[136:139], v[40:43], v[64:67]
    ds_read_b128 v[32:35], v17 offset:34816
    v_mfma_f32_16x16x32_bf16 v[68:71], a[140:143], v[40:43], v[68:71]
    v_mfma_f32_16x16x32_bf16 v[72:75], a[136:139], v[44:47], v[72:75]
    ds_read_b128 v[36:39], v17 offset:51200
    v_mfma_f32_16x16x32_bf16 v[76:79], a[140:143], v[44:47], v[76:79]
    s_waitcnt lgkmcnt(4)
    v_mfma_f32_16x16x32_bf16 v[64:67], a[144:147], v[48:51], v[64:67]
    ds_read_b128 v[40:43], v18 offset:34816
    s_add_u32 m0, s29, 1792
    v_mfma_f32_16x16x32_bf16 v[68:71], a[148:151], v[48:51], v[68:71]
    buffer_load_dwordx4 v16, s[16:19], s34 offen offset:256 lds
    v_mfma_f32_16x16x32_bf16 v[72:75], a[144:147], v[52:55], v[72:75]
    ds_read_b128 v[44:47], v18 offset:51200
    v_mfma_f32_16x16x32_bf16 v[76:79], a[148:151], v[52:55], v[76:79]
    s_waitcnt lgkmcnt(4)
    v_mfma_f32_16x16x32_bf16 v[64:67], a[152:155], v[56:59], v[64:67]
    ds_read_b128 v[48:51], v17 offset:35840
    v_mfma_f32_16x16x32_bf16 v[68:71], a[156:159], v[56:59], v[68:71]
    v_mfma_f32_16x16x32_bf16 v[72:75], a[152:155], v[60:63], v[72:75]
    ds_read_b128 v[52:55], v17 offset:52224
    v_mfma_f32_16x16x32_bf16 v[76:79], a[156:159], v[60:63], v[76:79]
    s_waitcnt lgkmcnt(4)
    v_mfma_f32_16x16x32_bf16 v[64:67], a[160:163], v[32:35], v[64:67]
    ds_read_b128 v[56:59], v18 offset:35840
    s_add_u32 m0, s29, 2688
    v_mfma_f32_16x16x32_bf16 v[68:71], a[164:167], v[32:35], v[68:71]
    buffer_load_dwordx4 v16, s[16:19], s34 offen offset:384 lds
    v_mfma_f32_16x16x32_bf16 v[72:75], a[160:163], v[36:39], v[72:75]
    ds_read_b128 v[60:63], v18 offset:52224
    v_mfma_f32_16x16x32_bf16 v[76:79], a[164:167], v[36:39], v[76:79]
    s_waitcnt lgkmcnt(4)
    v_mfma_f32_16x16x32_bf16 v[64:67], a[168:171], v[40:43], v[64:67]
    ds_read_b128 v[32:35], v17 offset:36864
    v_mfma_f32_16x16x32_bf16 v[68:71], a[172:175], v[40:43], v[68:71]
    v_mfma_f32_16x16x32_bf16 v[72:75], a[168:171], v[44:47], v[72:75]
    ds_read_b128 v[36:39], v17 offset:53248
    v_mfma_f32_16x16x32_bf16 v[76:79], a[172:175], v[44:47], v[76:79]
    s_waitcnt lgkmcnt(4)
    v_mfma_f32_16x16x32_bf16 v[64:67], a[176:179], v[48:51], v[64:67]
    ds_read_b128 v[40:43], v18 offset:36864
    s_add_u32 m0, s29, 3584
    v_mfma_f32_16x16x32_bf16 v[68:71], a[180:183], v[48:51], v[68:71]
    buffer_load_dwordx4 v16, s[16:19], s34 offen offset:512 lds
    v_mfma_f32_16x16x32_bf16 v[72:75], a[176:179], v[52:55], v[72:75]
    ds_read_b128 v[44:47], v18 offset:53248
    v_mfma_f32_16x16x32_bf16 v[76:79], a[180:183], v[52:55], v[76:79]
    s_waitcnt lgkmcnt(4)
    v_mfma_f32_16x16x32_bf16 v[64:67], a[184:187], v[56:59], v[64:67]
    ds_read_b128 v[48:51], v17 offset:37888
    v_mfma_f32_16x16x32_bf16 v[68:71], a[188:191], v[56:59], v[68:71]
    v_mfma_f32_16x16x32_bf16 v[72:75], a[184:187], v[60:63], v[72:75]
    ds_read_b128 v[52:55], v17 offset:54272
    v_mfma_f32_16x16x32_bf16 v[76:79], a[188:191], v[60:63], v[76:79]
    s_waitcnt lgkmcnt(4)
    v_mfma_f32_16x16x32_bf16 v[64:67], a[192:195], v[32:35], v[64:67]
    ds_read_b128 v[56:59], v18 offset:37888
    s_add_u32 m0, s29, 4480
    v_mfma_f32_16x16x32_bf16 v[68:71], a[196:199], v[32:35], v[68:71]
    buffer_load_dwordx4 v16, s[16:19], s34 offen offset:640 lds
    v_mfma_f32_16x16x32_bf16 v[72:75], a[192:195], v[36:39], v[72:75]
    ds_read_b128 v[60:63], v18 offset:54272
    v_mfma_f32_16x16x32_bf16 v[76:79], a[196:199], v[36:39], v[76:79]
    s_waitcnt lgkmcnt(4)
    v_mfma_f32_16x16x32_bf16 v[64:67], a[200:203], v[40:43], v[64:67]
    ds_read_b128 v[32:35], v17 offset:38912
    v_mfma_f32_16x16x32_bf16 v[68:71], a[204:207], v[40:43], v[68:71]
    v_mfma_f32_16x16x32_bf16 v[72:75], a[200:203], v[44:47], v[72:75]
    ds_read_b128 v[36:39], v17 offset:55296
    v_mfma_f32_16x16x32_bf16 v[76:79], a[204:207], v[44:47], v[76:79]
    s_waitcnt lgkmcnt(4)
    v_mfma_f32_16x16x32_bf16 v[64:67], a[208:211], v[48:51], v[64:67]
    ds_read_b128 v[40:43], v18 offset:38912
    s_add_u32 m0, s29, 5376
    v_mfma_f32_16x16x32_bf16 v[68:71], a[212:215], v[48:51], v[68:71]
    buffer_load_dwordx4 v16, s[16:19], s34 offen offset:768 lds
    v_mfma_f32_16x16x32_bf16 v[72:75], a[208:211], v[52:55], v[72:75]
    ds_read_b128 v[44:47], v18 offset:55296
    v_mfma_f32_16x16x32_bf16 v[76:79], a[212:215], v[52:55], v[76:79]
    s_waitcnt lgkmcnt(4)
    v_mfma_f32_16x16x32_bf16 v[64:67], a[216:219], v[56:59], v[64:67]
    ds_read_b128 v[48:51], v17 offset:39936
    v_mfma_f32_16x16x32_bf16 v[68:71], a[220:223], v[56:59], v[68:71]
    v_mfma_f32_16x16x32_bf16 v[72:75], a[216:219], v[60:63], v[72:75]
    ds_read_b128 v[52:55], v17 offset:56320
    v_mfma_f32_16x16x32_bf16 v[76:79], a[220:223], v[60:63], v[76:79]
    s_mov_b64 exec, s[44:45]
    buffer_store_dwordx4 v[24:27], v29, s[8:11], s46 offen sc1
    s_mov_b64 exec, -1
    s_waitcnt lgkmcnt(4)
    v_mfma_f32_16x16x32_bf16 v[64:67], a[224:227], v[32:35], v[64:67]
    ds_read_b128 v[56:59], v18 offset:39936
    s_add_u32 m0, s29, 6272
    v_mfma_f32_16x16x32_bf16 v[68:71], a[228:231], v[32:35], v[68:71]
    buffer_load_dwordx4 v16, s[16:19], s34 offen offset:896 lds
    v_mfma_f32_16x16x32_bf16 v[72:75], a[224:227], v[36:39], v[72:75]
    ds_read_b128 v[60:63], v18 offset:56320
    v_mfma_f32_16x16x32_bf16 v[76:79], a[228:231], v[36:39], v[76:79]
    s_waitcnt lgkmcnt(4)
    v_mfma_f32_16x16x32_bf16 v[64:67], a[232:235], v[40:43], v[64:67]
    s_add_u32 s34, s34, 1024
    v_mfma_f32_16x16x32_bf16 v[68:71], a[236:239], v[40:43], v[68:71]
    v_mfma_f32_16x16x32_bf16 v[72:75], a[232:235], v[44:47], v[72:75]
    v_mfma_f32_16x16x32_bf16 v[76:79], a[236:239], v[44:47], v[76:79]
    s_waitcnt lgkmcnt(0)
    s_waitcnt vmcnt(10)
    s_barrier
    ds_read_b128 v[32:35], v19 offset:0
    ds_read_b128 v[36:39], v19 offset:16384
    v_mfma_f32_16x16x32_bf16 v[64:67], a[240:243], v[48:51], v[64:67]
    ds_read_b128 v[40:43], v20 offset:0
    s_add_u32 m0, s29, 32768
    v_mfma_f32_16x16x32_bf16 v[68:71], a[244:247], v[48:51], v[68:71]
    buffer_load_dwordx4 v16, s[16:19], s34 offen offset:0 lds
    v_mfma_f32_16x16x32_bf16 v[72:75], a[240:243], v[52:55], v[72:75]
    ds_read_b128 v[44:47], v20 offset:16384
    v_mfma_f32_16x16x32_bf16 v[76:79], a[244:247], v[52:55], v[76:79]
    v_mfma_f32_16x16x32_bf16 v[64:67], a[248:251], v[56:59], v[64:67]
    ds_read_b128 v[48:51], v19 offset:1024
    v_mfma_f32_16x16x32_bf16 v[68:71], a[252:255], v[56:59], v[68:71]
    v_mfma_f32_16x16x32_bf16 v[72:75], a[248:251], v[60:63], v[72:75]
    ds_read_b128 v[52:55], v19 offset:17408
    v_mfma_f32_16x16x32_bf16 v[76:79], a[252:255], v[60:63], v[76:79]
    s_mov_b64 exec, s[36:37]
    buffer_store_dword v23, v22, s[8:11], s33 offen sc1
    s_mov_b64 exec, -1

    s_waitcnt lgkmcnt(4)
    v_mfma_f32_16x16x32_bf16 v[80:83], a[0:3], v[32:35], 0
    ds_read_b128 v[56:59], v20 offset:1024
    s_add_u32 m0, s29, 33664
    v_mfma_f32_16x16x32_bf16 v[84:87], a[4:7], v[32:35], 0
    buffer_load_dwordx4 v16, s[16:19], s34 offen offset:128 lds
    v_mfma_f32_16x16x32_bf16 v[88:91], a[0:3], v[36:39], 0
    ds_read_b128 v[60:63], v20 offset:17408
    v_mfma_f32_16x16x32_bf16 v[92:95], a[4:7], v[36:39], 0
    s_waitcnt lgkmcnt(4)
    v_mfma_f32_16x16x32_bf16 v[80:83], a[8:11], v[40:43], v[80:83]
    ds_read_b128 v[32:35], v19 offset:2048
    v_mfma_f32_16x16x32_bf16 v[84:87], a[12:15], v[40:43], v[84:87]
    v_cvt_pk_bf16_f32 v96, v64, v65
    v_cvt_pk_bf16_f32 v97, v66, v67
    v_mfma_f32_16x16x32_bf16 v[88:91], a[8:11], v[44:47], v[88:91]
    ds_read_b128 v[36:39], v19 offset:18432
    v_mfma_f32_16x16x32_bf16 v[92:95], a[12:15], v[44:47], v[92:95]
    v_cvt_pk_bf16_f32 v98, v68, v69
    v_cvt_pk_bf16_f32 v99, v70, v71
    s_waitcnt lgkmcnt(4)
    v_mfma_f32_16x16x32_bf16 v[80:83], a[16:19], v[48:51], v[80:83]
    ds_read_b128 v[40:43], v20 offset:2048
    s_add_u32 m0, s29, 34560
    v_mfma_f32_16x16x32_bf16 v[84:87], a[20:23], v[48:51], v[84:87]
    buffer_load_dwordx4 v16, s[16:19], s34 offen offset:256 lds
    v_mfma_f32_16x16x32_bf16 v[88:91], a[16:19], v[52:55], v[88:91]
    ds_read_b128 v[44:47], v20 offset:18432
    v_mfma_f32_16x16x32_bf16 v[92:95], a[20:23], v[52:55], v[92:95]
    s_waitcnt lgkmcnt(4)
    v_mfma_f32_16x16x32_bf16 v[80:83], a[24:27], v[56:59], v[80:83]
    ds_read_b128 v[48:51], v19 offset:3072
    v_mfma_f32_16x16x32_bf16 v[84:87], a[28:31], v[56:59], v[84:87]
    buffer_store_dwordx4 v[96:99], v21, s[8:11], s32 offen sc1
    v_mfma_f32_16x16x32_bf16 v[88:91], a[24:27], v[60:63], v[88:91]
    ds_read_b128 v[52:55], v19 offset:19456
    v_mfma_f32_16x16x32_bf16 v[92:95], a[28:31], v[60:63], v[92:95]
    s_waitcnt lgkmcnt(4)
    v_mfma_f32_16x16x32_bf16 v[80:83], a[32:35], v[32:35], v[80:83]
    ds_read_b128 v[56:59], v20 offset:3072
    s_add_u32 m0, s29, 35456
    v_mfma_f32_16x16x32_bf16 v[84:87], a[36:39], v[32:35], v[84:87]
    buffer_load_dwordx4 v16, s[16:19], s34 offen offset:384 lds
    v_mfma_f32_16x16x32_bf16 v[88:91], a[32:35], v[36:39], v[88:91]
    ds_read_b128 v[60:63], v20 offset:19456
    v_mfma_f32_16x16x32_bf16 v[92:95], a[36:39], v[36:39], v[92:95]
    s_waitcnt lgkmcnt(4)
    v_mfma_f32_16x16x32_bf16 v[80:83], a[40:43], v[40:43], v[80:83]
    ds_read_b128 v[32:35], v19 offset:4096
    v_mfma_f32_16x16x32_bf16 v[84:87], a[44:47], v[40:43], v[84:87]
    v_cvt_pk_bf16_f32 v100, v72, v73
    v_cvt_pk_bf16_f32 v101, v74, v75
    v_mfma_f32_16x16x32_bf16 v[88:91], a[40:43], v[44:47], v[88:91]
    ds_read_b128 v[36:39], v19 offset:20480
    v_mfma_f32_16x16x32_bf16 v[92:95], a[44:47], v[44:47], v[92:95]
    v_cvt_pk_bf16_f32 v102, v76, v77
    v_cvt_pk_bf16_f32 v103, v78, v79
    s_waitcnt lgkmcnt(4)
    v_mfma_f32_16x16x32_bf16 v[80:83], a[48:51], v[48:51], v[80:83]
    ds_read_b128 v[40:43], v20 offset:4096
    s_add_u32 m0, s29, 36352
    v_mfma_f32_16x16x32_bf16 v[84:87], a[52:55], v[48:51], v[84:87]
    buffer_load_dwordx4 v16, s[16:19], s34 offen offset:512 lds
    v_mfma_f32_16x16x32_bf16 v[88:91], a[48:51], v[52:55], v[88:91]
    ds_read_b128 v[44:47], v20 offset:20480
    v_mfma_f32_16x16x32_bf16 v[92:95], a[52:55], v[52:55], v[92:95]
    s_waitcnt lgkmcnt(4)
    v_mfma_f32_16x16x32_bf16 v[80:83], a[56:59], v[56:59], v[80:83]
    ds_read_b128 v[48:51], v19 offset:5120
    v_mfma_f32_16x16x32_bf16 v[84:87], a[60:63], v[56:59], v[84:87]
    buffer_store_dwordx4 v[100:103], v21, s[8:11], s38 offen sc1
    v_mfma_f32_16x16x32_bf16 v[88:91], a[56:59], v[60:63], v[88:91]
    ds_read_b128 v[52:55], v19 offset:21504
    v_mfma_f32_16x16x32_bf16 v[92:95], a[60:63], v[60:63], v[92:95]
    s_waitcnt lgkmcnt(4)
    v_mfma_f32_16x16x32_bf16 v[80:83], a[64:67], v[32:35], v[80:83]
    ds_read_b128 v[56:59], v20 offset:5120
    s_add_u32 m0, s29, 37248
    v_mfma_f32_16x16x32_bf16 v[84:87], a[68:71], v[32:35], v[84:87]
    buffer_load_dwordx4 v16, s[16:19], s34 offen offset:640 lds
    v_mfma_f32_16x16x32_bf16 v[88:91], a[64:67], v[36:39], v[88:91]
    ds_read_b128 v[60:63], v20 offset:21504
    v_mfma_f32_16x16x32_bf16 v[92:95], a[68:71], v[36:39], v[92:95]
    s_mov_b32 exec_hi, 0
    buffer_store_dwordx4 v[24:27], v21, s[8:11], s48 offen sc1
    s_mov_b32 exec_hi, -1

    s_waitcnt lgkmcnt(4)
    v_mfma_f32_16x16x32_bf16 v[80:83], a[72:75], v[40:43], v[80:83]
    ds_read_b128 v[32:35], v19 offset:6144
    v_mfma_f32_16x16x32_bf16 v[84:87], a[76:79], v[40:43], v[84:87]
    s_mov_b32 s32, s39
    s_add_u32 s38, s39, 4096
    s_add_u32 s39, s39, 262144
    s_mov_b32 s48, s49
    s_add_u32 s49, s49, 196608
    v_mfma_f32_16x16x32_bf16 v[88:91], a[72:75], v[44:47], v[88:91]
    ds_read_b128 v[36:39], v19 offset:22528
    v_mfma_f32_16x16x32_bf16 v[92:95], a[76:79], v[44:47], v[92:95]
    v_add_u32 v23, 1, v23
    s_waitcnt lgkmcnt(4)
    v_mfma_f32_16x16x32_bf16 v[80:83], a[80:83], v[48:51], v[80:83]
    ds_read_b128 v[40:43], v20 offset:6144
    s_add_u32 m0, s29, 38144
    v_mfma_f32_16x16x32_bf16 v[84:87], a[84:87], v[48:51], v[84:87]
    buffer_load_dwordx4 v16, s[16:19], s34 offen offset:768 lds
    v_mfma_f32_16x16x32_bf16 v[88:91], a[80:83], v[52:55], v[88:91]
    ds_read_b128 v[44:47], v20 offset:22528
    v_mfma_f32_16x16x32_bf16 v[92:95], a[84:87], v[52:55], v[92:95]
    s_waitcnt lgkmcnt(4)
    v_mfma_f32_16x16x32_bf16 v[80:83], a[88:91], v[56:59], v[80:83]
    ds_read_b128 v[48:51], v19 offset:7168
    v_mfma_f32_16x16x32_bf16 v[84:87], a[92:95], v[56:59], v[84:87]
    v_mfma_f32_16x16x32_bf16 v[88:91], a[88:91], v[60:63], v[88:91]
    ds_read_b128 v[52:55], v19 offset:23552
    v_mfma_f32_16x16x32_bf16 v[92:95], a[92:95], v[60:63], v[92:95]
    s_mov_b64 exec, s[44:45]
    buffer_store_dwordx4 v[24:27], v30, s[8:11], s46 offen sc1
    s_mov_b64 exec, -1
    s_waitcnt lgkmcnt(4)
    v_mfma_f32_16x16x32_bf16 v[80:83], a[96:99], v[32:35], v[80:83]
    ds_read_b128 v[56:59], v20 offset:7168
    s_add_u32 m0, s29, 39040
    v_mfma_f32_16x16x32_bf16 v[84:87], a[100:103], v[32:35], v[84:87]
    buffer_load_dwordx4 v16, s[16:19], s34 offen offset:896 lds
    v_mfma_f32_16x16x32_bf16 v[88:91], a[96:99], v[36:39], v[88:91]
    ds_read_b128 v[60:63], v20 offset:23552
    v_mfma_f32_16x16x32_bf16 v[92:95], a[100:103], v[36:39], v[92:95]
    s_waitcnt lgkmcnt(4)
    v_mfma_f32_16x16x32_bf16 v[80:83], a[104:107], v[40:43], v[80:83]
    s_add_u32 s34, s34, 64512
    s_min_u32 s34, s34, 4128768
    v_mfma_f32_16x16x32_bf16 v[84:87], a[108:111], v[40:43], v[84:87]
    v_mfma_f32_16x16x32_bf16 v[88:91], a[104:107], v[44:47], v[88:91]
    v_mfma_f32_16x16x32_bf16 v[92:95], a[108:111], v[44:47], v[92:95]
    s_waitcnt lgkmcnt(0)
    s_waitcnt vmcnt(19)
    s_barrier
    ds_read_b128 v[32:35], v19 offset:32768
    ds_read_b128 v[36:39], v19 offset:49152
    v_mfma_f32_16x16x32_bf16 v[80:83], a[112:115], v[48:51], v[80:83]
    ds_read_b128 v[40:43], v20 offset:32768
    s_add_u32 m0, s29, 65536
    v_mfma_f32_16x16x32_bf16 v[84:87], a[116:119], v[48:51], v[84:87]
    buffer_load_dwordx4 v16, s[16:19], s34 offen offset:0 lds
    v_mfma_f32_16x16x32_bf16 v[88:91], a[112:115], v[52:55], v[88:91]
    ds_read_b128 v[44:47], v20 offset:49152
    v_mfma_f32_16x16x32_bf16 v[92:95], a[116:119], v[52:55], v[92:95]
    v_mfma_f32_16x16x32_bf16 v[80:83], a[120:123], v[56:59], v[80:83]
    ds_read_b128 v[48:51], v19 offset:33792
    v_mfma_f32_16x16x32_bf16 v[84:87], a[124:127], v[56:59], v[84:87]
    v_mfma_f32_16x16x32_bf16 v[88:91], a[120:123], v[60:63], v[88:91]
    ds_read_b128 v[52:55], v19 offset:50176
    v_mfma_f32_16x16x32_bf16 v[92:95], a[124:127], v[60:63], v[92:95]
    s_waitcnt lgkmcnt(4)
    v_mfma_f32_16x16x32_bf16 v[80:83], a[128:131], v[32:35], v[80:83]
    ds_read_b128 v[56:59], v20 offset:33792
    s_add_u32 m0, s29, 66432
    v_mfma_f32_16x16x32_bf16 v[84:87], a[132:135], v[32:35], v[84:87]
    buffer_load_dwordx4 v16, s[16:19], s34 offen offset:128 lds
    v_mfma_f32_16x16x32_bf16 v[88:91], a[128:131], v[36:39], v[88:91]
    ds_read_b128 v[60:63], v20 offset:50176
    v_mfma_f32_16x16x32_bf16 v[92:95], a[132:135], v[36:39], v[92:95]
    s_waitcnt lgkmcnt(4)
    v_mfma_f32_16x16x32_bf16 v[80:83], a[136:139], v[40:43], v[80:83]
    ds_read_b128 v[32:35], v19 offset:34816
    v_mfma_f32_16x16x32_bf16 v[84:87], a[140:143], v[40:43], v[84:87]
    v_mfma_f32_16x16x32_bf16 v[88:91], a[136:139], v[44:47], v[88:91]
    ds_read_b128 v[36:39], v19 offset:51200
    v_mfma_f32_16x16x32_bf16 v[92:95], a[140:143], v[44:47], v[92:95]
    s_waitcnt lgkmcnt(4)
    v_mfma_f32_16x16x32_bf16 v[80:83], a[144:147], v[48:51], v[80:83]
    ds_read_b128 v[40:43], v20 offset:34816
    s_add_u32 m0, s29, 67328
    v_mfma_f32_16x16x32_bf16 v[84:87], a[148:151], v[48:51], v[84:87]
    buffer_load_dwordx4 v16, s[16:19], s34 offen offset:256 lds
    v_mfma_f32_16x16x32_bf16 v[88:91], a[144:147], v[52:55], v[88:91]
    ds_read_b128 v[44:47], v20 offset:51200
    v_mfma_f32_16x16x32_bf16 v[92:95], a[148:151], v[52:55], v[92:95]
    s_waitcnt lgkmcnt(4)
    v_mfma_f32_16x16x32_bf16 v[80:83], a[152:155], v[56:59], v[80:83]
    ds_read_b128 v[48:51], v19 offset:35840
    v_mfma_f32_16x16x32_bf16 v[84:87], a[156:159], v[56:59], v[84:87]
    v_mfma_f32_16x16x32_bf16 v[88:91], a[152:155], v[60:63], v[88:91]
    ds_read_b128 v[52:55], v19 offset:52224
    v_mfma_f32_16x16x32_bf16 v[92:95], a[156:159], v[60:63], v[92:95]
    s_waitcnt lgkmcnt(4)
    v_mfma_f32_16x16x32_bf16 v[80:83], a[160:163], v[32:35], v[80:83]
    ds_read_b128 v[56:59], v20 offset:35840
    s_add_u32 m0, s29, 68224
    v_mfma_f32_16x16x32_bf16 v[84:87], a[164:167], v[32:35], v[84:87]
    buffer_load_dwordx4 v16, s[16:19], s34 offen offset:384 lds
    v_mfma_f32_16x16x32_bf16 v[88:91], a[160:163], v[36:39], v[88:91]
    ds_read_b128 v[60:63], v20 offset:52224
    v_mfma_f32_16x16x32_bf16 v[92:95], a[164:167], v[36:39], v[92:95]
    s_waitcnt lgkmcnt(4)
    v_mfma_f32_16x16x32_bf16 v[80:83], a[168:171], v[40:43], v[80:83]
    ds_read_b128 v[32:35], v19 offset:36864
    v_mfma_f32_16x16x32_bf16 v[84:87], a[172:175], v[40:43], v[84:87]
    v_mfma_f32_16x16x32_bf16 v[88:91], a[168:171], v[44:47], v[88:91]
    ds_read_b128 v[36:39], v19 offset:53248
    v_mfma_f32_16x16x32_bf16 v[92:95], a[172:175], v[44:47], v[92:95]
    s_waitcnt lgkmcnt(4)
    v_mfma_f32_16x16x32_bf16 v[80:83], a[176:179], v[48:51], v[80:83]
    ds_read_b128 v[40:43], v20 offset:36864
    s_add_u32 m0, s29, 69120
    v_mfma_f32_16x16x32_bf16 v[84:87], a[180:183], v[48:51], v[84:87]
    buffer_load_dwordx4 v16, s[16:19], s34 offen offset:512 lds
    v_mfma_f32_16x16x32_bf16 v[88:91], a[176:179], v[52:55], v[88:91]
    ds_read_b128 v[44:47], v20 offset:53248
    v_mfma_f32_16x16x32_bf16 v[92:95], a[180:183], v[52:55], v[92:95]
    s_waitcnt lgkmcnt(4)
    v_mfma_f32_16x16x32_bf16 v[80:83], a[184:187], v[56:59], v[80:83]
    ds_read_b128 v[48:51], v19 offset:37888
    v_mfma_f32_16x16x32_bf16 v[84:87], a[188:191], v[56:59], v[84:87]
    v_mfma_f32_16x16x32_bf16 v[88:91], a[184:187], v[60:63], v[88:91]
    ds_read_b128 v[52:55], v19 offset:54272
    v_mfma_f32_16x16x32_bf16 v[92:95], a[188:191], v[60:63], v[92:95]
    s_waitcnt lgkmcnt(4)
    v_mfma_f32_16x16x32_bf16 v[80:83], a[192:195], v[32:35], v[80:83]
    ds_read_b128 v[56:59], v20 offset:37888
    s_add_u32 m0, s29, 70016
    v_mfma_f32_16x16x32_bf16 v[84:87], a[196:199], v[32:35], v[84:87]
    buffer_load_dwordx4 v16, s[16:19], s34 offen offset:640 lds
    v_mfma_f32_16x16x32_bf16 v[88:91], a[192:195], v[36:39], v[88:91]
    ds_read_b128 v[60:63], v20 offset:54272
    v_mfma_f32_16x16x32_bf16 v[92:95], a[196:199], v[36:39], v[92:95]
    s_waitcnt lgkmcnt(4)
    v_mfma_f32_16x16x32_bf16 v[80:83], a[200:203], v[40:43], v[80:83]
    ds_read_b128 v[32:35], v19 offset:38912
    v_mfma_f32_16x16x32_bf16 v[84:87], a[204:207], v[40:43], v[84:87]
    v_mfma_f32_16x16x32_bf16 v[88:91], a[200:203], v[44:47], v[88:91]
    ds_read_b128 v[36:39], v19 offset:55296
    v_mfma_f32_16x16x32_bf16 v[92:95], a[204:207], v[44:47], v[92:95]
    s_waitcnt lgkmcnt(4)
    v_mfma_f32_16x16x32_bf16 v[80:83], a[208:211], v[48:51], v[80:83]
    ds_read_b128 v[40:43], v20 offset:38912
    s_add_u32 m0, s29, 70912
    v_mfma_f32_16x16x32_bf16 v[84:87], a[212:215], v[48:51], v[84:87]
    buffer_load_dwordx4 v16, s[16:19], s34 offen offset:768 lds
    v_mfma_f32_16x16x32_bf16 v[88:91], a[208:211], v[52:55], v[88:91]
    ds_read_b128 v[44:47], v20 offset:55296
    v_mfma_f32_16x16x32_bf16 v[92:95], a[212:215], v[52:55], v[92:95]
    s_waitcnt lgkmcnt(4)
    v_mfma_f32_16x16x32_bf16 v[80:83], a[216:219], v[56:59], v[80:83]
    ds_read_b128 v[48:51], v19 offset:39936
    v_mfma_f32_16x16x32_bf16 v[84:87], a[220:223], v[56:59], v[84:87]
    s_cmp_lt_u32 s35, 21
    s_cselect_b64 s[44:45], -1, 0
    v_mfma_f32_16x16x32_bf16 v[88:91], a[216:219], v[60:63], v[88:91]
    ds_read_b128 v[52:55], v19 offset:56320
    v_mfma_f32_16x16x32_bf16 v[92:95], a[220:223], v[60:63], v[92:95]
    s_cselect_b32 s4, 0x10000, 0
    s_add_u32 s46, s46, s4
    s_waitcnt lgkmcnt(4)
    v_mfma_f32_16x16x32_bf16 v[80:83], a[224:227], v[32:35], v[80:83]
    ds_read_b128 v[56:59], v20 offset:39936
    s_add_u32 m0, s29, 71808
    v_mfma_f32_16x16x32_bf16 v[84:87], a[228:231], v[32:35], v[84:87]
    buffer_load_dwordx4 v16, s[16:19], s34 offen offset:896 lds
    v_mfma_f32_16x16x32_bf16 v[88:91], a[224:227], v[36:39], v[88:91]
    ds_read_b128 v[60:63], v20 offset:56320
    v_mfma_f32_16x16x32_bf16 v[92:95], a[228:231], v[36:39], v[92:95]
    s_waitcnt lgkmcnt(4)
    v_mfma_f32_16x16x32_bf16 v[80:83], a[232:235], v[40:43], v[80:83]
    s_add_u32 s34, s34, 1024
    v_mfma_f32_16x16x32_bf16 v[84:87], a[236:239], v[40:43], v[84:87]
    v_mfma_f32_16x16x32_bf16 v[88:91], a[232:235], v[44:47], v[88:91]
    v_mfma_f32_16x16x32_bf16 v[92:95], a[236:239], v[44:47], v[92:95]
    s_waitcnt lgkmcnt(0)
    s_waitcnt vmcnt(10)
    s_barrier
    ds_read_b128 v[32:35], v17 offset:0
    ds_read_b128 v[36:39], v17 offset:16384
    v_mfma_f32_16x16x32_bf16 v[80:83], a[240:243], v[48:51], v[80:83]
    ds_read_b128 v[40:43], v18 offset:0
    s_add_u32 m0, s29, 98304
    v_mfma_f32_16x16x32_bf16 v[84:87], a[244:247], v[48:51], v[84:87]
    buffer_load_dwordx4 v16, s[16:19], s34 offen offset:0 lds
    v_mfma_f32_16x16x32_bf16 v[88:91], a[240:243], v[52:55], v[88:91]
    ds_read_b128 v[44:47], v18 offset:16384
    v_mfma_f32_16x16x32_bf16 v[92:95], a[244:247], v[52:55], v[92:95]
    v_mfma_f32_16x16x32_bf16 v[80:83], a[248:251], v[56:59], v[80:83]
    ds_read_b128 v[48:51], v17 offset:1024
    v_mfma_f32_16x16x32_bf16 v[84:87], a[252:255], v[56:59], v[84:87]
    v_mfma_f32_16x16x32_bf16 v[88:91], a[248:251], v[60:63], v[88:91]
    ds_read_b128 v[52:55], v17 offset:17408
    v_mfma_f32_16x16x32_bf16 v[92:95], a[252:255], v[60:63], v[92:95]
    s_mov_b64 exec, s[36:37]
    buffer_store_dword v23, v22, s[8:11], s33 offen sc1
    s_mov_b64 exec, -1

    s_add_u32 s35, s35, 1
    s_cmp_lt_u32 s35, 32
    s_cbranch_scc1 .ql_377

    s_nop 7
    v_cvt_pk_bf16_f32 v96, v80, v81
    v_cvt_pk_bf16_f32 v97, v82, v83
    v_cvt_pk_bf16_f32 v98, v84, v85
    v_cvt_pk_bf16_f32 v99, v86, v87
    buffer_store_dwordx4 v[96:99], v21, s[8:11], s32 offen sc1
    v_cvt_pk_bf16_f32 v100, v88, v89
    v_cvt_pk_bf16_f32 v101, v90, v91
    v_cvt_pk_bf16_f32 v102, v92, v93
    v_cvt_pk_bf16_f32 v103, v94, v95
    buffer_store_dwordx4 v[100:103], v21, s[8:11], s38 offen sc1
    s_mov_b32 exec_hi, 0
    buffer_store_dwordx4 v[24:27], v21, s[8:11], s48 offen sc1
    s_mov_b32 exec_hi, -1

    v_mov_b32 v23, 64
    s_waitcnt vmcnt(0) lgkmcnt(0)
    s_barrier
    s_mov_b64 exec, s[36:37]
    buffer_store_dword v23, v22, s[8:11], s33 offen sc1
    s_mov_b64 exec, -1

    s_branch .qd_376
.qv_375:
    s_waitcnt vmcnt(16)
    s_barrier
    ds_read_b128 v[32:35], v17 offset:0
    ds_read_b128 v[36:39], v17 offset:16384
    ds_read_b128 v[40:43], v18 offset:0
    ds_read_b128 v[44:47], v18 offset:16384
    s_add_u32 m0, s29, 98304
    s_nop 0
    buffer_load_dwordx4 v16, s[16:19], s34 offen offset:0 lds
    ds_read_b128 v[48:51], v17 offset:1024
    ds_read_b128 v[52:55], v17 offset:17408
    s_branch .qe_380
.p2align 6
.ql_379:
.qe_380:
    s_waitcnt lgkmcnt(4)
    v_mfma_f32_16x16x32_bf16 v[64:67], v[32:35], a[0:3], 0
    ds_read_b128 v[56:59], v18 offset:1024
    s_add_u32 m0, s29, 99200
    v_mfma_f32_16x16x32_bf16 v[68:71], v[32:35], a[4:7], 0
    buffer_load_dwordx4 v16, s[16:19], s34 offen offset:128 lds
    v_mfma_f32_16x16x32_bf16 v[72:75], v[36:39], a[0:3], 0
    ds_read_b128 v[60:63], v18 offset:17408
    v_mfma_f32_16x16x32_bf16 v[76:79], v[36:39], a[4:7], 0
    s_waitcnt lgkmcnt(4)
    v_mfma_f32_16x16x32_bf16 v[64:67], v[40:43], a[8:11], v[64:67]
    ds_read_b128 v[32:35], v17 offset:2048
    v_mfma_f32_16x16x32_bf16 v[68:71], v[40:43], a[12:15], v[68:71]
    v_cvt_pk_bf16_f32 v96, v80, v81
    v_cvt_pk_bf16_f32 v97, v82, v83
    v_mfma_f32_16x16x32_bf16 v[72:75], v[44:47], a[8:11], v[72:75]
    ds_read_b128 v[36:39], v17 offset:18432
    v_mfma_f32_16x16x32_bf16 v[76:79], v[44:47], a[12:15], v[76:79]
    v_cvt_pk_bf16_f32 v98, v88, v89
    v_cvt_pk_bf16_f32 v99, v90, v91
    s_waitcnt lgkmcnt(4)
    v_mfma_f32_16x16x32_bf16 v[64:67], v[48:51], a[16:19], v[64:67]
    ds_read_b128 v[40:43], v18 offset:2048
    s_add_u32 m0, s29, 100096
    v_mfma_f32_16x16x32_bf16 v[68:71], v[48:51], a[20:23], v[68:71]
    buffer_load_dwordx4 v16, s[16:19], s34 offen offset:256 lds
    v_mfma_f32_16x16x32_bf16 v[72:75], v[52:55], a[16:19], v[72:75]
    ds_read_b128 v[44:47], v18 offset:18432
    v_mfma_f32_16x16x32_bf16 v[76:79], v[52:55], a[20:23], v[76:79]
    s_waitcnt lgkmcnt(4)
    v_mfma_f32_16x16x32_bf16 v[64:67], v[56:59], a[24:27], v[64:67]
    ds_read_b128 v[48:51], v17 offset:3072
    v_mfma_f32_16x16x32_bf16 v[68:71], v[56:59], a[28:31], v[68:71]
    buffer_store_dwordx4 v[96:99], v21, s[8:11], s32 offen offset:0 sc1
    v_mfma_f32_16x16x32_bf16 v[72:75], v[60:63], a[24:27], v[72:75]
    ds_read_b128 v[52:55], v17 offset:19456
    v_mfma_f32_16x16x32_bf16 v[76:79], v[60:63], a[28:31], v[76:79]
    s_waitcnt lgkmcnt(4)
    v_mfma_f32_16x16x32_bf16 v[64:67], v[32:35], a[32:35], v[64:67]
    ds_read_b128 v[56:59], v18 offset:3072
    s_add_u32 m0, s29, 100992
    v_mfma_f32_16x16x32_bf16 v[68:71], v[32:35], a[36:39], v[68:71]
    buffer_load_dwordx4 v16, s[16:19], s34 offen offset:384 lds
    v_mfma_f32_16x16x32_bf16 v[72:75], v[36:39], a[32:35], v[72:75]
    ds_read_b128 v[60:63], v18 offset:19456
    v_mfma_f32_16x16x32_bf16 v[76:79], v[36:39], a[36:39], v[76:79]
    s_waitcnt lgkmcnt(4)
    v_mfma_f32_16x16x32_bf16 v[64:67], v[40:43], a[40:43], v[64:67]
    ds_read_b128 v[32:35], v17 offset:4096
    v_mfma_f32_16x16x32_bf16 v[68:71], v[40:43], a[44:47], v[68:71]
    v_cvt_pk_bf16_f32 v100, v84, v85
    v_cvt_pk_bf16_f32 v101, v86, v87
    v_mfma_f32_16x16x32_bf16 v[72:75], v[44:47], a[40:43], v[72:75]
    ds_read_b128 v[36:39], v17 offset:20480
    v_mfma_f32_16x16x32_bf16 v[76:79], v[44:47], a[44:47], v[76:79]
    v_cvt_pk_bf16_f32 v102, v92, v93
    v_cvt_pk_bf16_f32 v103, v94, v95
    s_waitcnt lgkmcnt(4)
    v_mfma_f32_16x16x32_bf16 v[64:67], v[48:51], a[48:51], v[64:67]
    ds_read_b128 v[40:43], v18 offset:4096
    s_add_u32 m0, s29, 101888
    v_mfma_f32_16x16x32_bf16 v[68:71], v[48:51], a[52:55], v[68:71]
    buffer_load_dwordx4 v16, s[16:19], s34 offen offset:512 lds
    v_mfma_f32_16x16x32_bf16 v[72:75], v[52:55], a[48:51], v[72:75]
    ds_read_b128 v[44:47], v18 offset:20480
    v_mfma_f32_16x16x32_bf16 v[76:79], v[52:55], a[52:55], v[76:79]
    s_waitcnt lgkmcnt(4)
    v_mfma_f32_16x16x32_bf16 v[64:67], v[56:59], a[56:59], v[64:67]
    ds_read_b128 v[48:51], v17 offset:5120
    v_mfma_f32_16x16x32_bf16 v[68:71], v[56:59], a[60:63], v[68:71]
    buffer_store_dwordx4 v[100:103], v21, s[8:11], s32 offen offset:1024 sc1
    v_mfma_f32_16x16x32_bf16 v[72:75], v[60:63], a[56:59], v[72:75]
    ds_read_b128 v[52:55], v17 offset:21504
    v_mfma_f32_16x16x32_bf16 v[76:79], v[60:63], a[60:63], v[76:79]
    s_waitcnt lgkmcnt(4)
    v_mfma_f32_16x16x32_bf16 v[64:67], v[32:35], a[64:67], v[64:67]
    ds_read_b128 v[56:59], v18 offset:5120
    s_add_u32 m0, s29, 102784
    v_mfma_f32_16x16x32_bf16 v[68:71], v[32:35], a[68:71], v[68:71]
    buffer_load_dwordx4 v16, s[16:19], s34 offen offset:640 lds
    v_mfma_f32_16x16x32_bf16 v[72:75], v[36:39], a[64:67], v[72:75]
    ds_read_b128 v[60:63], v18 offset:21504
    v_mfma_f32_16x16x32_bf16 v[76:79], v[36:39], a[68:71], v[76:79]
    s_mov_b32 exec_hi, 0
    buffer_store_dwordx4 v[24:27], v21, s[8:11], s48 offen sc1
    s_mov_b32 exec_hi, -1

    s_waitcnt lgkmcnt(4)
    v_mfma_f32_16x16x32_bf16 v[64:67], v[40:43], a[72:75], v[64:67]
    ds_read_b128 v[32:35], v17 offset:6144
    v_mfma_f32_16x16x32_bf16 v[68:71], v[40:43], a[76:79], v[68:71]
    s_mov_b32 s32, s39
    s_add_u32 s38, s39, 4096
    s_add_u32 s39, s39, 262144
    s_mov_b32 s48, s49
    s_add_u32 s49, s49, 196608
    v_mfma_f32_16x16x32_bf16 v[72:75], v[44:47], a[72:75], v[72:75]
    ds_read_b128 v[36:39], v17 offset:22528
    v_mfma_f32_16x16x32_bf16 v[76:79], v[44:47], a[76:79], v[76:79]
    v_add_u32 v23, 1, v23
    s_waitcnt lgkmcnt(4)
    v_mfma_f32_16x16x32_bf16 v[64:67], v[48:51], a[80:83], v[64:67]
    ds_read_b128 v[40:43], v18 offset:6144
    s_add_u32 m0, s29, 103680
    v_mfma_f32_16x16x32_bf16 v[68:71], v[48:51], a[84:87], v[68:71]
    buffer_load_dwordx4 v16, s[16:19], s34 offen offset:768 lds
    v_mfma_f32_16x16x32_bf16 v[72:75], v[52:55], a[80:83], v[72:75]
    ds_read_b128 v[44:47], v18 offset:22528
    v_mfma_f32_16x16x32_bf16 v[76:79], v[52:55], a[84:87], v[76:79]
    s_waitcnt lgkmcnt(4)
    v_mfma_f32_16x16x32_bf16 v[64:67], v[56:59], a[88:91], v[64:67]
    ds_read_b128 v[48:51], v17 offset:7168
    v_mfma_f32_16x16x32_bf16 v[68:71], v[56:59], a[92:95], v[68:71]
    v_mfma_f32_16x16x32_bf16 v[72:75], v[60:63], a[88:91], v[72:75]
    ds_read_b128 v[52:55], v17 offset:23552
    v_mfma_f32_16x16x32_bf16 v[76:79], v[60:63], a[92:95], v[76:79]
    s_mov_b64 exec, s[44:45]
    buffer_store_dwordx4 v[24:27], v28, s[8:11], s46 offen sc1
    s_mov_b64 exec, -1
    s_waitcnt lgkmcnt(4)
    v_mfma_f32_16x16x32_bf16 v[64:67], v[32:35], a[96:99], v[64:67]
    ds_read_b128 v[56:59], v18 offset:7168
    s_add_u32 m0, s29, 104576
    v_mfma_f32_16x16x32_bf16 v[68:71], v[32:35], a[100:103], v[68:71]
    buffer_load_dwordx4 v16, s[16:19], s34 offen offset:896 lds
    v_mfma_f32_16x16x32_bf16 v[72:75], v[36:39], a[96:99], v[72:75]
    ds_read_b128 v[60:63], v18 offset:23552
    v_mfma_f32_16x16x32_bf16 v[76:79], v[36:39], a[100:103], v[76:79]
    s_waitcnt lgkmcnt(4)
    v_mfma_f32_16x16x32_bf16 v[64:67], v[40:43], a[104:107], v[64:67]
    s_add_u32 s34, s34, 64512
    s_min_u32 s34, s34, 4128768
    v_mfma_f32_16x16x32_bf16 v[68:71], v[40:43], a[108:111], v[68:71]
    v_mfma_f32_16x16x32_bf16 v[72:75], v[44:47], a[104:107], v[72:75]
    v_mfma_f32_16x16x32_bf16 v[76:79], v[44:47], a[108:111], v[76:79]
    s_waitcnt lgkmcnt(0)
    s_waitcnt vmcnt(19)
    s_barrier
    ds_read_b128 v[32:35], v17 offset:32768
    ds_read_b128 v[36:39], v17 offset:49152
    v_mfma_f32_16x16x32_bf16 v[64:67], v[48:51], a[112:115], v[64:67]
    ds_read_b128 v[40:43], v18 offset:32768
    s_add_u32 m0, s29, 0
    v_mfma_f32_16x16x32_bf16 v[68:71], v[48:51], a[116:119], v[68:71]
    buffer_load_dwordx4 v16, s[16:19], s34 offen offset:0 lds
    v_mfma_f32_16x16x32_bf16 v[72:75], v[52:55], a[112:115], v[72:75]
    ds_read_b128 v[44:47], v18 offset:49152
    v_mfma_f32_16x16x32_bf16 v[76:79], v[52:55], a[116:119], v[76:79]
    v_mfma_f32_16x16x32_bf16 v[64:67], v[56:59], a[120:123], v[64:67]
    ds_read_b128 v[48:51], v17 offset:33792
    v_mfma_f32_16x16x32_bf16 v[68:71], v[56:59], a[124:127], v[68:71]
    v_mfma_f32_16x16x32_bf16 v[72:75], v[60:63], a[120:123], v[72:75]
    ds_read_b128 v[52:55], v17 offset:50176
    v_mfma_f32_16x16x32_bf16 v[76:79], v[60:63], a[124:127], v[76:79]
    s_waitcnt lgkmcnt(4)
    v_mfma_f32_16x16x32_bf16 v[64:67], v[32:35], a[128:131], v[64:67]
    ds_read_b128 v[56:59], v18 offset:33792
    s_add_u32 m0, s29, 896
    v_mfma_f32_16x16x32_bf16 v[68:71], v[32:35], a[132:135], v[68:71]
    buffer_load_dwordx4 v16, s[16:19], s34 offen offset:128 lds
    v_mfma_f32_16x16x32_bf16 v[72:75], v[36:39], a[128:131], v[72:75]
    ds_read_b128 v[60:63], v18 offset:50176
    v_mfma_f32_16x16x32_bf16 v[76:79], v[36:39], a[132:135], v[76:79]
    s_waitcnt lgkmcnt(4)
    v_mfma_f32_16x16x32_bf16 v[64:67], v[40:43], a[136:139], v[64:67]
    ds_read_b128 v[32:35], v17 offset:34816
    v_mfma_f32_16x16x32_bf16 v[68:71], v[40:43], a[140:143], v[68:71]
    v_mfma_f32_16x16x32_bf16 v[72:75], v[44:47], a[136:139], v[72:75]
    ds_read_b128 v[36:39], v17 offset:51200
    v_mfma_f32_16x16x32_bf16 v[76:79], v[44:47], a[140:143], v[76:79]
    s_waitcnt lgkmcnt(4)
    v_mfma_f32_16x16x32_bf16 v[64:67], v[48:51], a[144:147], v[64:67]
    ds_read_b128 v[40:43], v18 offset:34816
    s_add_u32 m0, s29, 1792
    v_mfma_f32_16x16x32_bf16 v[68:71], v[48:51], a[148:151], v[68:71]
    buffer_load_dwordx4 v16, s[16:19], s34 offen offset:256 lds
    v_mfma_f32_16x16x32_bf16 v[72:75], v[52:55], a[144:147], v[72:75]
    ds_read_b128 v[44:47], v18 offset:51200
    v_mfma_f32_16x16x32_bf16 v[76:79], v[52:55], a[148:151], v[76:79]
    s_waitcnt lgkmcnt(4)
    v_mfma_f32_16x16x32_bf16 v[64:67], v[56:59], a[152:155], v[64:67]
    ds_read_b128 v[48:51], v17 offset:35840
    v_mfma_f32_16x16x32_bf16 v[68:71], v[56:59], a[156:159], v[68:71]
    v_mfma_f32_16x16x32_bf16 v[72:75], v[60:63], a[152:155], v[72:75]
    ds_read_b128 v[52:55], v17 offset:52224
    v_mfma_f32_16x16x32_bf16 v[76:79], v[60:63], a[156:159], v[76:79]
    s_waitcnt lgkmcnt(4)
    v_mfma_f32_16x16x32_bf16 v[64:67], v[32:35], a[160:163], v[64:67]
    ds_read_b128 v[56:59], v18 offset:35840
    s_add_u32 m0, s29, 2688
    v_mfma_f32_16x16x32_bf16 v[68:71], v[32:35], a[164:167], v[68:71]
    buffer_load_dwordx4 v16, s[16:19], s34 offen offset:384 lds
    v_mfma_f32_16x16x32_bf16 v[72:75], v[36:39], a[160:163], v[72:75]
    ds_read_b128 v[60:63], v18 offset:52224
    v_mfma_f32_16x16x32_bf16 v[76:79], v[36:39], a[164:167], v[76:79]
    s_waitcnt lgkmcnt(4)
    v_mfma_f32_16x16x32_bf16 v[64:67], v[40:43], a[168:171], v[64:67]
    ds_read_b128 v[32:35], v17 offset:36864
    v_mfma_f32_16x16x32_bf16 v[68:71], v[40:43], a[172:175], v[68:71]
    v_mfma_f32_16x16x32_bf16 v[72:75], v[44:47], a[168:171], v[72:75]
    ds_read_b128 v[36:39], v17 offset:53248
    v_mfma_f32_16x16x32_bf16 v[76:79], v[44:47], a[172:175], v[76:79]
    s_waitcnt lgkmcnt(4)
    v_mfma_f32_16x16x32_bf16 v[64:67], v[48:51], a[176:179], v[64:67]
    ds_read_b128 v[40:43], v18 offset:36864
    s_add_u32 m0, s29, 3584
    v_mfma_f32_16x16x32_bf16 v[68:71], v[48:51], a[180:183], v[68:71]
    buffer_load_dwordx4 v16, s[16:19], s34 offen offset:512 lds
    v_mfma_f32_16x16x32_bf16 v[72:75], v[52:55], a[176:179], v[72:75]
    ds_read_b128 v[44:47], v18 offset:53248
    v_mfma_f32_16x16x32_bf16 v[76:79], v[52:55], a[180:183], v[76:79]
    s_waitcnt lgkmcnt(4)
    v_mfma_f32_16x16x32_bf16 v[64:67], v[56:59], a[184:187], v[64:67]
    ds_read_b128 v[48:51], v17 offset:37888
    v_mfma_f32_16x16x32_bf16 v[68:71], v[56:59], a[188:191], v[68:71]
    v_mfma_f32_16x16x32_bf16 v[72:75], v[60:63], a[184:187], v[72:75]
    ds_read_b128 v[52:55], v17 offset:54272
    v_mfma_f32_16x16x32_bf16 v[76:79], v[60:63], a[188:191], v[76:79]
    s_waitcnt lgkmcnt(4)
    v_mfma_f32_16x16x32_bf16 v[64:67], v[32:35], a[192:195], v[64:67]
    ds_read_b128 v[56:59], v18 offset:37888
    s_add_u32 m0, s29, 4480
    v_mfma_f32_16x16x32_bf16 v[68:71], v[32:35], a[196:199], v[68:71]
    buffer_load_dwordx4 v16, s[16:19], s34 offen offset:640 lds
    v_mfma_f32_16x16x32_bf16 v[72:75], v[36:39], a[192:195], v[72:75]
    ds_read_b128 v[60:63], v18 offset:54272
    v_mfma_f32_16x16x32_bf16 v[76:79], v[36:39], a[196:199], v[76:79]
    s_waitcnt lgkmcnt(4)
    v_mfma_f32_16x16x32_bf16 v[64:67], v[40:43], a[200:203], v[64:67]
    ds_read_b128 v[32:35], v17 offset:38912
    v_mfma_f32_16x16x32_bf16 v[68:71], v[40:43], a[204:207], v[68:71]
    v_mfma_f32_16x16x32_bf16 v[72:75], v[44:47], a[200:203], v[72:75]
    ds_read_b128 v[36:39], v17 offset:55296
    v_mfma_f32_16x16x32_bf16 v[76:79], v[44:47], a[204:207], v[76:79]
    s_waitcnt lgkmcnt(4)
    v_mfma_f32_16x16x32_bf16 v[64:67], v[48:51], a[208:211], v[64:67]
    ds_read_b128 v[40:43], v18 offset:38912
    s_add_u32 m0, s29, 5376
    v_mfma_f32_16x16x32_bf16 v[68:71], v[48:51], a[212:215], v[68:71]
    buffer_load_dwordx4 v16, s[16:19], s34 offen offset:768 lds
    v_mfma_f32_16x16x32_bf16 v[72:75], v[52:55], a[208:211], v[72:75]
    ds_read_b128 v[44:47], v18 offset:55296
    v_mfma_f32_16x16x32_bf16 v[76:79], v[52:55], a[212:215], v[76:79]
    s_waitcnt lgkmcnt(4)
    v_mfma_f32_16x16x32_bf16 v[64:67], v[56:59], a[216:219], v[64:67]
    ds_read_b128 v[48:51], v17 offset:39936
    v_mfma_f32_16x16x32_bf16 v[68:71], v[56:59], a[220:223], v[68:71]
    v_mfma_f32_16x16x32_bf16 v[72:75], v[60:63], a[216:219], v[72:75]
    ds_read_b128 v[52:55], v17 offset:56320
    v_mfma_f32_16x16x32_bf16 v[76:79], v[60:63], a[220:223], v[76:79]
    s_mov_b64 exec, s[44:45]
    buffer_store_dwordx4 v[24:27], v29, s[8:11], s46 offen sc1
    s_mov_b64 exec, -1
    s_waitcnt lgkmcnt(4)
    v_mfma_f32_16x16x32_bf16 v[64:67], v[32:35], a[224:227], v[64:67]
    ds_read_b128 v[56:59], v18 offset:39936
    s_add_u32 m0, s29, 6272
    v_mfma_f32_16x16x32_bf16 v[68:71], v[32:35], a[228:231], v[68:71]
    buffer_load_dwordx4 v16, s[16:19], s34 offen offset:896 lds
    v_mfma_f32_16x16x32_bf16 v[72:75], v[36:39], a[224:227], v[72:75]
    ds_read_b128 v[60:63], v18 offset:56320
    v_mfma_f32_16x16x32_bf16 v[76:79], v[36:39], a[228:231], v[76:79]
    s_waitcnt lgkmcnt(4)
    v_mfma_f32_16x16x32_bf16 v[64:67], v[40:43], a[232:235], v[64:67]
    s_add_u32 s34, s34, 1024
    v_mfma_f32_16x16x32_bf16 v[68:71], v[40:43], a[236:239], v[68:71]
    v_mfma_f32_16x16x32_bf16 v[72:75], v[44:47], a[232:235], v[72:75]
    v_mfma_f32_16x16x32_bf16 v[76:79], v[44:47], a[236:239], v[76:79]
    s_waitcnt lgkmcnt(0)
    s_waitcnt vmcnt(10)
    s_barrier
    ds_read_b128 v[32:35], v19 offset:0
    ds_read_b128 v[36:39], v19 offset:16384
    v_mfma_f32_16x16x32_bf16 v[64:67], v[48:51], a[240:243], v[64:67]
    ds_read_b128 v[40:43], v20 offset:0
    s_add_u32 m0, s29, 32768
    v_mfma_f32_16x16x32_bf16 v[68:71], v[48:51], a[244:247], v[68:71]
    buffer_load_dwordx4 v16, s[16:19], s34 offen offset:0 lds
    v_mfma_f32_16x16x32_bf16 v[72:75], v[52:55], a[240:243], v[72:75]
    ds_read_b128 v[44:47], v20 offset:16384
    v_mfma_f32_16x16x32_bf16 v[76:79], v[52:55], a[244:247], v[76:79]
    v_mfma_f32_16x16x32_bf16 v[64:67], v[56:59], a[248:251], v[64:67]
    ds_read_b128 v[48:51], v19 offset:1024
    v_mfma_f32_16x16x32_bf16 v[68:71], v[56:59], a[252:255], v[68:71]
    v_mfma_f32_16x16x32_bf16 v[72:75], v[60:63], a[248:251], v[72:75]
    ds_read_b128 v[52:55], v19 offset:17408
    v_mfma_f32_16x16x32_bf16 v[76:79], v[60:63], a[252:255], v[76:79]
    s_mov_b64 exec, s[36:37]
    buffer_store_dword v23, v22, s[8:11], s33 offen sc1
    s_mov_b64 exec, -1

    s_waitcnt lgkmcnt(4)
    v_mfma_f32_16x16x32_bf16 v[80:83], v[32:35], a[0:3], 0
    ds_read_b128 v[56:59], v20 offset:1024
    s_add_u32 m0, s29, 33664
    v_mfma_f32_16x16x32_bf16 v[84:87], v[32:35], a[4:7], 0
    buffer_load_dwordx4 v16, s[16:19], s34 offen offset:128 lds
    v_mfma_f32_16x16x32_bf16 v[88:91], v[36:39], a[0:3], 0
    ds_read_b128 v[60:63], v20 offset:17408
    v_mfma_f32_16x16x32_bf16 v[92:95], v[36:39], a[4:7], 0
    s_waitcnt lgkmcnt(4)
    v_mfma_f32_16x16x32_bf16 v[80:83], v[40:43], a[8:11], v[80:83]
    ds_read_b128 v[32:35], v19 offset:2048
    v_mfma_f32_16x16x32_bf16 v[84:87], v[40:43], a[12:15], v[84:87]
    v_cvt_pk_bf16_f32 v96, v64, v65
    v_cvt_pk_bf16_f32 v97, v66, v67
    v_mfma_f32_16x16x32_bf16 v[88:91], v[44:47], a[8:11], v[88:91]
    ds_read_b128 v[36:39], v19 offset:18432
    v_mfma_f32_16x16x32_bf16 v[92:95], v[44:47], a[12:15], v[92:95]
    v_cvt_pk_bf16_f32 v98, v72, v73
    v_cvt_pk_bf16_f32 v99, v74, v75
    s_waitcnt lgkmcnt(4)
    v_mfma_f32_16x16x32_bf16 v[80:83], v[48:51], a[16:19], v[80:83]
    ds_read_b128 v[40:43], v20 offset:2048
    s_add_u32 m0, s29, 34560
    v_mfma_f32_16x16x32_bf16 v[84:87], v[48:51], a[20:23], v[84:87]
    buffer_load_dwordx4 v16, s[16:19], s34 offen offset:256 lds
    v_mfma_f32_16x16x32_bf16 v[88:91], v[52:55], a[16:19], v[88:91]
    ds_read_b128 v[44:47], v20 offset:18432
    v_mfma_f32_16x16x32_bf16 v[92:95], v[52:55], a[20:23], v[92:95]
    s_waitcnt lgkmcnt(4)
    v_mfma_f32_16x16x32_bf16 v[80:83], v[56:59], a[24:27], v[80:83]
    ds_read_b128 v[48:51], v19 offset:3072
    v_mfma_f32_16x16x32_bf16 v[84:87], v[56:59], a[28:31], v[84:87]
    buffer_store_dwordx4 v[96:99], v21, s[8:11], s32 offen offset:0 sc1
    v_mfma_f32_16x16x32_bf16 v[88:91], v[60:63], a[24:27], v[88:91]
    ds_read_b128 v[52:55], v19 offset:19456
    v_mfma_f32_16x16x32_bf16 v[92:95], v[60:63], a[28:31], v[92:95]
    s_waitcnt lgkmcnt(4)
    v_mfma_f32_16x16x32_bf16 v[80:83], v[32:35], a[32:35], v[80:83]
    ds_read_b128 v[56:59], v20 offset:3072
    s_add_u32 m0, s29, 35456
    v_mfma_f32_16x16x32_bf16 v[84:87], v[32:35], a[36:39], v[84:87]
    buffer_load_dwordx4 v16, s[16:19], s34 offen offset:384 lds
    v_mfma_f32_16x16x32_bf16 v[88:91], v[36:39], a[32:35], v[88:91]
    ds_read_b128 v[60:63], v20 offset:19456
    v_mfma_f32_16x16x32_bf16 v[92:95], v[36:39], a[36:39], v[92:95]
    s_waitcnt lgkmcnt(4)
    v_mfma_f32_16x16x32_bf16 v[80:83], v[40:43], a[40:43], v[80:83]
    ds_read_b128 v[32:35], v19 offset:4096
    v_mfma_f32_16x16x32_bf16 v[84:87], v[40:43], a[44:47], v[84:87]
    v_cvt_pk_bf16_f32 v100, v68, v69
    v_cvt_pk_bf16_f32 v101, v70, v71
    v_mfma_f32_16x16x32_bf16 v[88:91], v[44:47], a[40:43], v[88:91]
    ds_read_b128 v[36:39], v19 offset:20480
    v_mfma_f32_16x16x32_bf16 v[92:95], v[44:47], a[44:47], v[92:95]
    v_cvt_pk_bf16_f32 v102, v76, v77
    v_cvt_pk_bf16_f32 v103, v78, v79
    s_waitcnt lgkmcnt(4)
    v_mfma_f32_16x16x32_bf16 v[80:83], v[48:51], a[48:51], v[80:83]
    ds_read_b128 v[40:43], v20 offset:4096
    s_add_u32 m0, s29, 36352
    v_mfma_f32_16x16x32_bf16 v[84:87], v[48:51], a[52:55], v[84:87]
    buffer_load_dwordx4 v16, s[16:19], s34 offen offset:512 lds
    v_mfma_f32_16x16x32_bf16 v[88:91], v[52:55], a[48:51], v[88:91]
    ds_read_b128 v[44:47], v20 offset:20480
    v_mfma_f32_16x16x32_bf16 v[92:95], v[52:55], a[52:55], v[92:95]
    s_waitcnt lgkmcnt(4)
    v_mfma_f32_16x16x32_bf16 v[80:83], v[56:59], a[56:59], v[80:83]
    ds_read_b128 v[48:51], v19 offset:5120
    v_mfma_f32_16x16x32_bf16 v[84:87], v[56:59], a[60:63], v[84:87]
    buffer_store_dwordx4 v[100:103], v21, s[8:11], s32 offen offset:1024 sc1
    v_mfma_f32_16x16x32_bf16 v[88:91], v[60:63], a[56:59], v[88:91]
    ds_read_b128 v[52:55], v19 offset:21504
    v_mfma_f32_16x16x32_bf16 v[92:95], v[60:63], a[60:63], v[92:95]
    s_waitcnt lgkmcnt(4)
    v_mfma_f32_16x16x32_bf16 v[80:83], v[32:35], a[64:67], v[80:83]
    ds_read_b128 v[56:59], v20 offset:5120
    s_add_u32 m0, s29, 37248
    v_mfma_f32_16x16x32_bf16 v[84:87], v[32:35], a[68:71], v[84:87]
    buffer_load_dwordx4 v16, s[16:19], s34 offen offset:640 lds
    v_mfma_f32_16x16x32_bf16 v[88:91], v[36:39], a[64:67], v[88:91]
    ds_read_b128 v[60:63], v20 offset:21504
    v_mfma_f32_16x16x32_bf16 v[92:95], v[36:39], a[68:71], v[92:95]
    s_mov_b32 exec_hi, 0
    buffer_store_dwordx4 v[24:27], v21, s[8:11], s48 offen sc1
    s_mov_b32 exec_hi, -1

    s_waitcnt lgkmcnt(4)
    v_mfma_f32_16x16x32_bf16 v[80:83], v[40:43], a[72:75], v[80:83]
    ds_read_b128 v[32:35], v19 offset:6144
    v_mfma_f32_16x16x32_bf16 v[84:87], v[40:43], a[76:79], v[84:87]
    s_mov_b32 s32, s39
    s_add_u32 s38, s39, 4096
    s_add_u32 s39, s39, 262144
    s_mov_b32 s48, s49
    s_add_u32 s49, s49, 196608
    v_mfma_f32_16x16x32_bf16 v[88:91], v[44:47], a[72:75], v[88:91]
    ds_read_b128 v[36:39], v19 offset:22528
    v_mfma_f32_16x16x32_bf16 v[92:95], v[44:47], a[76:79], v[92:95]
    v_add_u32 v23, 1, v23
    s_waitcnt lgkmcnt(4)
    v_mfma_f32_16x16x32_bf16 v[80:83], v[48:51], a[80:83], v[80:83]
    ds_read_b128 v[40:43], v20 offset:6144
    s_add_u32 m0, s29, 38144
    v_mfma_f32_16x16x32_bf16 v[84:87], v[48:51], a[84:87], v[84:87]
    buffer_load_dwordx4 v16, s[16:19], s34 offen offset:768 lds
    v_mfma_f32_16x16x32_bf16 v[88:91], v[52:55], a[80:83], v[88:91]
    ds_read_b128 v[44:47], v20 offset:22528
    v_mfma_f32_16x16x32_bf16 v[92:95], v[52:55], a[84:87], v[92:95]
    s_waitcnt lgkmcnt(4)
    v_mfma_f32_16x16x32_bf16 v[80:83], v[56:59], a[88:91], v[80:83]
    ds_read_b128 v[48:51], v19 offset:7168
    v_mfma_f32_16x16x32_bf16 v[84:87], v[56:59], a[92:95], v[84:87]
    v_mfma_f32_16x16x32_bf16 v[88:91], v[60:63], a[88:91], v[88:91]
    ds_read_b128 v[52:55], v19 offset:23552
    v_mfma_f32_16x16x32_bf16 v[92:95], v[60:63], a[92:95], v[92:95]
    s_mov_b64 exec, s[44:45]
    buffer_store_dwordx4 v[24:27], v30, s[8:11], s46 offen sc1
    s_mov_b64 exec, -1
    s_waitcnt lgkmcnt(4)
    v_mfma_f32_16x16x32_bf16 v[80:83], v[32:35], a[96:99], v[80:83]
    ds_read_b128 v[56:59], v20 offset:7168
    s_add_u32 m0, s29, 39040
    v_mfma_f32_16x16x32_bf16 v[84:87], v[32:35], a[100:103], v[84:87]
    buffer_load_dwordx4 v16, s[16:19], s34 offen offset:896 lds
    v_mfma_f32_16x16x32_bf16 v[88:91], v[36:39], a[96:99], v[88:91]
    ds_read_b128 v[60:63], v20 offset:23552
    v_mfma_f32_16x16x32_bf16 v[92:95], v[36:39], a[100:103], v[92:95]
    s_waitcnt lgkmcnt(4)
    v_mfma_f32_16x16x32_bf16 v[80:83], v[40:43], a[104:107], v[80:83]
    s_add_u32 s34, s34, 64512
    s_min_u32 s34, s34, 4128768
    v_mfma_f32_16x16x32_bf16 v[84:87], v[40:43], a[108:111], v[84:87]
    v_mfma_f32_16x16x32_bf16 v[88:91], v[44:47], a[104:107], v[88:91]
    v_mfma_f32_16x16x32_bf16 v[92:95], v[44:47], a[108:111], v[92:95]
    s_waitcnt lgkmcnt(0)
    s_waitcnt vmcnt(19)
    s_barrier
    ds_read_b128 v[32:35], v19 offset:32768
    ds_read_b128 v[36:39], v19 offset:49152
    v_mfma_f32_16x16x32_bf16 v[80:83], v[48:51], a[112:115], v[80:83]
    ds_read_b128 v[40:43], v20 offset:32768
    s_add_u32 m0, s29, 65536
    v_mfma_f32_16x16x32_bf16 v[84:87], v[48:51], a[116:119], v[84:87]
    buffer_load_dwordx4 v16, s[16:19], s34 offen offset:0 lds
    v_mfma_f32_16x16x32_bf16 v[88:91], v[52:55], a[112:115], v[88:91]
    ds_read_b128 v[44:47], v20 offset:49152
    v_mfma_f32_16x16x32_bf16 v[92:95], v[52:55], a[116:119], v[92:95]
    v_mfma_f32_16x16x32_bf16 v[80:83], v[56:59], a[120:123], v[80:83]
    ds_read_b128 v[48:51], v19 offset:33792
    v_mfma_f32_16x16x32_bf16 v[84:87], v[56:59], a[124:127], v[84:87]
    v_mfma_f32_16x16x32_bf16 v[88:91], v[60:63], a[120:123], v[88:91]
    ds_read_b128 v[52:55], v19 offset:50176
    v_mfma_f32_16x16x32_bf16 v[92:95], v[60:63], a[124:127], v[92:95]
    s_waitcnt lgkmcnt(4)
    v_mfma_f32_16x16x32_bf16 v[80:83], v[32:35], a[128:131], v[80:83]
    ds_read_b128 v[56:59], v20 offset:33792
    s_add_u32 m0, s29, 66432
    v_mfma_f32_16x16x32_bf16 v[84:87], v[32:35], a[132:135], v[84:87]
    buffer_load_dwordx4 v16, s[16:19], s34 offen offset:128 lds
    v_mfma_f32_16x16x32_bf16 v[88:91], v[36:39], a[128:131], v[88:91]
    ds_read_b128 v[60:63], v20 offset:50176
    v_mfma_f32_16x16x32_bf16 v[92:95], v[36:39], a[132:135], v[92:95]
    s_waitcnt lgkmcnt(4)
    v_mfma_f32_16x16x32_bf16 v[80:83], v[40:43], a[136:139], v[80:83]
    ds_read_b128 v[32:35], v19 offset:34816
    v_mfma_f32_16x16x32_bf16 v[84:87], v[40:43], a[140:143], v[84:87]
    v_mfma_f32_16x16x32_bf16 v[88:91], v[44:47], a[136:139], v[88:91]
    ds_read_b128 v[36:39], v19 offset:51200
    v_mfma_f32_16x16x32_bf16 v[92:95], v[44:47], a[140:143], v[92:95]
    s_waitcnt lgkmcnt(4)
    v_mfma_f32_16x16x32_bf16 v[80:83], v[48:51], a[144:147], v[80:83]
    ds_read_b128 v[40:43], v20 offset:34816
    s_add_u32 m0, s29, 67328
    v_mfma_f32_16x16x32_bf16 v[84:87], v[48:51], a[148:151], v[84:87]
    buffer_load_dwordx4 v16, s[16:19], s34 offen offset:256 lds
    v_mfma_f32_16x16x32_bf16 v[88:91], v[52:55], a[144:147], v[88:91]
    ds_read_b128 v[44:47], v20 offset:51200
    v_mfma_f32_16x16x32_bf16 v[92:95], v[52:55], a[148:151], v[92:95]
    s_waitcnt lgkmcnt(4)
    v_mfma_f32_16x16x32_bf16 v[80:83], v[56:59], a[152:155], v[80:83]
    ds_read_b128 v[48:51], v19 offset:35840
    v_mfma_f32_16x16x32_bf16 v[84:87], v[56:59], a[156:159], v[84:87]
    v_mfma_f32_16x16x32_bf16 v[88:91], v[60:63], a[152:155], v[88:91]
    ds_read_b128 v[52:55], v19 offset:52224
    v_mfma_f32_16x16x32_bf16 v[92:95], v[60:63], a[156:159], v[92:95]
    s_waitcnt lgkmcnt(4)
    v_mfma_f32_16x16x32_bf16 v[80:83], v[32:35], a[160:163], v[80:83]
    ds_read_b128 v[56:59], v20 offset:35840
    s_add_u32 m0, s29, 68224
    v_mfma_f32_16x16x32_bf16 v[84:87], v[32:35], a[164:167], v[84:87]
    buffer_load_dwordx4 v16, s[16:19], s34 offen offset:384 lds
    v_mfma_f32_16x16x32_bf16 v[88:91], v[36:39], a[160:163], v[88:91]
    ds_read_b128 v[60:63], v20 offset:52224
    v_mfma_f32_16x16x32_bf16 v[92:95], v[36:39], a[164:167], v[92:95]
    s_waitcnt lgkmcnt(4)
    v_mfma_f32_16x16x32_bf16 v[80:83], v[40:43], a[168:171], v[80:83]
    ds_read_b128 v[32:35], v19 offset:36864
    v_mfma_f32_16x16x32_bf16 v[84:87], v[40:43], a[172:175], v[84:87]
    v_mfma_f32_16x16x32_bf16 v[88:91], v[44:47], a[168:171], v[88:91]
    ds_read_b128 v[36:39], v19 offset:53248
    v_mfma_f32_16x16x32_bf16 v[92:95], v[44:47], a[172:175], v[92:95]
    s_waitcnt lgkmcnt(4)
    v_mfma_f32_16x16x32_bf16 v[80:83], v[48:51], a[176:179], v[80:83]
    ds_read_b128 v[40:43], v20 offset:36864
    s_add_u32 m0, s29, 69120
    v_mfma_f32_16x16x32_bf16 v[84:87], v[48:51], a[180:183], v[84:87]
    buffer_load_dwordx4 v16, s[16:19], s34 offen offset:512 lds
    v_mfma_f32_16x16x32_bf16 v[88:91], v[52:55], a[176:179], v[88:91]
    ds_read_b128 v[44:47], v20 offset:53248
    v_mfma_f32_16x16x32_bf16 v[92:95], v[52:55], a[180:183], v[92:95]
    s_waitcnt lgkmcnt(4)
    v_mfma_f32_16x16x32_bf16 v[80:83], v[56:59], a[184:187], v[80:83]
    ds_read_b128 v[48:51], v19 offset:37888
    v_mfma_f32_16x16x32_bf16 v[84:87], v[56:59], a[188:191], v[84:87]
    v_mfma_f32_16x16x32_bf16 v[88:91], v[60:63], a[184:187], v[88:91]
    ds_read_b128 v[52:55], v19 offset:54272
    v_mfma_f32_16x16x32_bf16 v[92:95], v[60:63], a[188:191], v[92:95]
    s_waitcnt lgkmcnt(4)
    v_mfma_f32_16x16x32_bf16 v[80:83], v[32:35], a[192:195], v[80:83]
    ds_read_b128 v[56:59], v20 offset:37888
    s_add_u32 m0, s29, 70016
    v_mfma_f32_16x16x32_bf16 v[84:87], v[32:35], a[196:199], v[84:87]
    buffer_load_dwordx4 v16, s[16:19], s34 offen offset:640 lds
    v_mfma_f32_16x16x32_bf16 v[88:91], v[36:39], a[192:195], v[88:91]
    ds_read_b128 v[60:63], v20 offset:54272
    v_mfma_f32_16x16x32_bf16 v[92:95], v[36:39], a[196:199], v[92:95]
    s_waitcnt lgkmcnt(4)
    v_mfma_f32_16x16x32_bf16 v[80:83], v[40:43], a[200:203], v[80:83]
    ds_read_b128 v[32:35], v19 offset:38912
    v_mfma_f32_16x16x32_bf16 v[84:87], v[40:43], a[204:207], v[84:87]
    v_mfma_f32_16x16x32_bf16 v[88:91], v[44:47], a[200:203], v[88:91]
    ds_read_b128 v[36:39], v19 offset:55296
    v_mfma_f32_16x16x32_bf16 v[92:95], v[44:47], a[204:207], v[92:95]
    s_waitcnt lgkmcnt(4)
    v_mfma_f32_16x16x32_bf16 v[80:83], v[48:51], a[208:211], v[80:83]
    ds_read_b128 v[40:43], v20 offset:38912
    s_add_u32 m0, s29, 70912
    v_mfma_f32_16x16x32_bf16 v[84:87], v[48:51], a[212:215], v[84:87]
    buffer_load_dwordx4 v16, s[16:19], s34 offen offset:768 lds
    v_mfma_f32_16x16x32_bf16 v[88:91], v[52:55], a[208:211], v[88:91]
    ds_read_b128 v[44:47], v20 offset:55296
    v_mfma_f32_16x16x32_bf16 v[92:95], v[52:55], a[212:215], v[92:95]
    s_waitcnt lgkmcnt(4)
    v_mfma_f32_16x16x32_bf16 v[80:83], v[56:59], a[216:219], v[80:83]
    ds_read_b128 v[48:51], v19 offset:39936
    v_mfma_f32_16x16x32_bf16 v[84:87], v[56:59], a[220:223], v[84:87]
    s_cmp_lt_u32 s35, 21
    s_cselect_b64 s[44:45], -1, 0
    v_mfma_f32_16x16x32_bf16 v[88:91], v[60:63], a[216:219], v[88:91]
    ds_read_b128 v[52:55], v19 offset:56320
    v_mfma_f32_16x16x32_bf16 v[92:95], v[60:63], a[220:223], v[92:95]
    s_cselect_b32 s4, 0x10000, 0
    s_add_u32 s46, s46, s4
    s_waitcnt lgkmcnt(4)
    v_mfma_f32_16x16x32_bf16 v[80:83], v[32:35], a[224:227], v[80:83]
    ds_read_b128 v[56:59], v20 offset:39936
    s_add_u32 m0, s29, 71808
    v_mfma_f32_16x16x32_bf16 v[84:87], v[32:35], a[228:231], v[84:87]
    buffer_load_dwordx4 v16, s[16:19], s34 offen offset:896 lds
    v_mfma_f32_16x16x32_bf16 v[88:91], v[36:39], a[224:227], v[88:91]
    ds_read_b128 v[60:63], v20 offset:56320
    v_mfma_f32_16x16x32_bf16 v[92:95], v[36:39], a[228:231], v[92:95]
    s_waitcnt lgkmcnt(4)
    v_mfma_f32_16x16x32_bf16 v[80:83], v[40:43], a[232:235], v[80:83]
    s_add_u32 s34, s34, 1024
    v_mfma_f32_16x16x32_bf16 v[84:87], v[40:43], a[236:239], v[84:87]
    v_mfma_f32_16x16x32_bf16 v[88:91], v[44:47], a[232:235], v[88:91]
    v_mfma_f32_16x16x32_bf16 v[92:95], v[44:47], a[236:239], v[92:95]
    s_waitcnt lgkmcnt(0)
    s_waitcnt vmcnt(10)
    s_barrier
    ds_read_b128 v[32:35], v17 offset:0
    ds_read_b128 v[36:39], v17 offset:16384
    v_mfma_f32_16x16x32_bf16 v[80:83], v[48:51], a[240:243], v[80:83]
    ds_read_b128 v[40:43], v18 offset:0
    s_add_u32 m0, s29, 98304
    v_mfma_f32_16x16x32_bf16 v[84:87], v[48:51], a[244:247], v[84:87]
    buffer_load_dwordx4 v16, s[16:19], s34 offen offset:0 lds
    v_mfma_f32_16x16x32_bf16 v[88:91], v[52:55], a[240:243], v[88:91]
    ds_read_b128 v[44:47], v18 offset:16384
    v_mfma_f32_16x16x32_bf16 v[92:95], v[52:55], a[244:247], v[92:95]
    v_mfma_f32_16x16x32_bf16 v[80:83], v[56:59], a[248:251], v[80:83]
    ds_read_b128 v[48:51], v17 offset:1024
    v_mfma_f32_16x16x32_bf16 v[84:87], v[56:59], a[252:255], v[84:87]
    v_mfma_f32_16x16x32_bf16 v[88:91], v[60:63], a[248:251], v[88:91]
    ds_read_b128 v[52:55], v17 offset:17408
    v_mfma_f32_16x16x32_bf16 v[92:95], v[60:63], a[252:255], v[92:95]
    s_mov_b64 exec, s[36:37]
    buffer_store_dword v23, v22, s[8:11], s33 offen sc1
    s_mov_b64 exec, -1

    s_add_u32 s35, s35, 1
    s_cmp_lt_u32 s35, 32
    s_cbranch_scc1 .ql_379

    s_nop 7
    v_cvt_pk_bf16_f32 v96, v80, v81
    v_cvt_pk_bf16_f32 v97, v82, v83
    v_cvt_pk_bf16_f32 v98, v88, v89
    v_cvt_pk_bf16_f32 v99, v90, v91
    buffer_store_dwordx4 v[96:99], v21, s[8:11], s32 offen offset:0 sc1
    v_cvt_pk_bf16_f32 v100, v84, v85
    v_cvt_pk_bf16_f32 v101, v86, v87
    v_cvt_pk_bf16_f32 v102, v92, v93
    v_cvt_pk_bf16_f32 v103, v94, v95
    buffer_store_dwordx4 v[100:103], v21, s[8:11], s32 offen offset:1024 sc1
    s_mov_b32 exec_hi, 0
    buffer_store_dwordx4 v[24:27], v21, s[8:11], s48 offen sc1
    s_mov_b32 exec_hi, -1

    v_mov_b32 v23, 64
    s_waitcnt vmcnt(0) lgkmcnt(0)
    s_barrier
    s_mov_b64 exec, s[36:37]
    buffer_store_dword v23, v22, s[8:11], s33 offen sc1
    s_mov_b64 exec, -1

.qd_376:
    s_load_dwordx2 s[40:41], s[0:1], 88
    s_load_dwordx2 s[42:43], s[0:1], 112
    s_and_b32 s4, s33, 0xffffe7ff
    s_mov_b32 s57, s4
    s_mov_b32 s34, s47
    s_and_b32 s30, s26, 7
    s_lshr_b32 s31, s26, 3
    s_lshl_b32 s28, s91, 21
    s_lshl_b32 s4, s30, 8
    s_add_u32 s28, s28, s4
    s_waitcnt lgkmcnt(0)

    s_mov_b32 s12, s40
    s_and_b32 s13, s41, 0xffff
    s_mov_b32 s14, 0x800000
    s_mov_b32 s15, 0x00020000

    s_mov_b32 s44, s42
    s_and_b32 s45, s43, 0xffff
    s_mov_b32 s46, 0x400000
    s_mov_b32 s47, 0x00020000

    v_lshrrev_b32 v4, 1, v2
    v_xor_b32 v4, v4, v3
    v_lshlrev_b32 v4, 1, v4
    v_and_b32 v5, 1, v1
    v_or_b32 v4, v4, v5
    v_lshlrev_b32 v4, 4, v4
    v_lshlrev_b32 v5, 11, v3
    v_add_u32 v10, v4, v5
    v_xor_b32 v11, 0x80, v10
    s_lshl_b32 s4, s24, 16
    s_add_u32 s28, s28, s4
    s_lshl_b32 s29, s24, 13
    v_lshrrev_b32 v4, 2, v2
    v_and_b32 v5, 1, v3
    v_lshl_or_b32 v5, v5, 2, v4
    s_lshl_b32 s4, s24, 1
    v_xor_b32 v5, s4, v5
    v_lshlrev_b32 v5, 5, v5
    v_lshl_add_u32 v4, v3, 2, v4
    v_lshl_add_u32 v5, v4, 8, v5
    v_and_b32 v4, 3, v2
    v_lshl_add_u32 v12, v4, 3, v5
    v_xor_b32 v13, 32, v12
    v_add_u32 v14, 0x10000, v12
    v_add_u32 v15, 0x10000, v13

    s_and_b32 s4, s91, 1
    s_lshl_b32 s4, s4, 5
    v_xor_b32 v12, s4, v12
    v_xor_b32 v13, s4, v13
    v_xor_b32 v14, s4, v14
    v_xor_b32 v15, s4, v15

    s_and_b32 s4, s26, 7
    s_lshl_b32 s4, s4, 1
    s_lshr_b32 s5, s24, 1
    s_add_u32 s4, s4, s5
    s_lshl_b32 s4, s4, 6
    v_add_u32 v4, s4, v1
    v_lshlrev_b32 v4, 11, v4
    s_and_b32 s4, s24, 1
    s_lshl_b32 s4, s4, 10
    s_lshl_b32 s5, s91, 21
    s_add_u32 s4, s4, s5
    buffer_load_dword v31, v4, s[12:15], s4 offen offset:384

    s_add_u32 m0, s29, 0
    s_add_u32 s4, s28, 0
    buffer_load_dwordx4 v10, s[12:15], s4 offen lds

    s_add_u32 m0, s29, 1024
    s_add_u32 s4, s28, 8192
    buffer_load_dwordx4 v11, s[12:15], s4 offen lds

    s_add_u32 m0, s29, 2048
    s_add_u32 s4, s28, 16384
    buffer_load_dwordx4 v10, s[12:15], s4 offen lds

    s_add_u32 m0, s29, 3072
    s_add_u32 s4, s28, 24576
    buffer_load_dwordx4 v11, s[12:15], s4 offen lds

    s_add_u32 m0, s29, 4096
    s_add_u32 s4, s28, 32768
    buffer_load_dwordx4 v10, s[12:15], s4 offen lds

    s_add_u32 m0, s29, 5120
    s_add_u32 s4, s28, 40960
    buffer_load_dwordx4 v11, s[12:15], s4 offen lds

    s_add_u32 m0, s29, 6144
    s_add_u32 s4, s28, 49152
    buffer_load_dwordx4 v10, s[12:15], s4 offen lds

    s_add_u32 m0, s29, 7168
    s_add_u32 s4, s28, 57344
    buffer_load_dwordx4 v11, s[12:15], s4 offen lds

    s_add_u32 m0, s29, 32768
    s_add_u32 s4, s28, 262144
    buffer_load_dwordx4 v10, s[12:15], s4 offen lds

    s_add_u32 m0, s29, 33792
    s_add_u32 s4, s28, 270336
    buffer_load_dwordx4 v11, s[12:15], s4 offen lds

    s_add_u32 m0, s29, 34816
    s_add_u32 s4, s28, 278528
    buffer_load_dwordx4 v10, s[12:15], s4 offen lds

    s_add_u32 m0, s29, 35840
    s_add_u32 s4, s28, 286720
    buffer_load_dwordx4 v11, s[12:15], s4 offen lds

    s_add_u32 m0, s29, 36864
    s_add_u32 s4, s28, 294912
    buffer_load_dwordx4 v10, s[12:15], s4 offen lds

    s_add_u32 m0, s29, 37888
    s_add_u32 s4, s28, 303104
    buffer_load_dwordx4 v11, s[12:15], s4 offen lds

    s_add_u32 m0, s29, 38912
    s_add_u32 s4, s28, 311296
    buffer_load_dwordx4 v10, s[12:15], s4 offen lds

    s_add_u32 m0, s29, 39936
    s_add_u32 s4, s28, 319488
    buffer_load_dwordx4 v11, s[12:15], s4 offen lds

    s_add_u32 m0, s29, 65536
    s_add_u32 s4, s28, 524288
    buffer_load_dwordx4 v10, s[12:15], s4 offen lds

    s_add_u32 m0, s29, 66560
    s_add_u32 s4, s28, 532480
    buffer_load_dwordx4 v11, s[12:15], s4 offen lds

    s_add_u32 m0, s29, 67584
    s_add_u32 s4, s28, 540672
    buffer_load_dwordx4 v10, s[12:15], s4 offen lds

    s_add_u32 m0, s29, 68608
    s_add_u32 s4, s28, 548864
    buffer_load_dwordx4 v11, s[12:15], s4 offen lds

    s_add_u32 m0, s29, 69632
    s_add_u32 s4, s28, 557056
    buffer_load_dwordx4 v10, s[12:15], s4 offen lds

    s_add_u32 m0, s29, 70656
    s_add_u32 s4, s28, 565248
    buffer_load_dwordx4 v11, s[12:15], s4 offen lds

    s_add_u32 m0, s29, 71680
    s_add_u32 s4, s28, 573440
    buffer_load_dwordx4 v10, s[12:15], s4 offen lds

    s_add_u32 m0, s29, 72704
    s_add_u32 s4, s28, 581632
    buffer_load_dwordx4 v11, s[12:15], s4 offen lds

    s_add_u32 m0, s29, 98304
    s_add_u32 s4, s28, 786432
    buffer_load_dwordx4 v10, s[12:15], s4 offen lds

    s_add_u32 m0, s29, 99328
    s_add_u32 s4, s28, 794624
    buffer_load_dwordx4 v11, s[12:15], s4 offen lds

    s_add_u32 m0, s29, 100352
    s_add_u32 s4, s28, 802816
    buffer_load_dwordx4 v10, s[12:15], s4 offen lds

    s_add_u32 m0, s29, 101376
    s_add_u32 s4, s28, 811008
    buffer_load_dwordx4 v11, s[12:15], s4 offen lds

    s_add_u32 m0, s29, 102400
    s_add_u32 s4, s28, 819200
    buffer_load_dwordx4 v10, s[12:15], s4 offen lds

    s_add_u32 m0, s29, 103424
    s_add_u32 s4, s28, 827392
    buffer_load_dwordx4 v11, s[12:15], s4 offen lds

    s_add_u32 m0, s29, 104448
    s_add_u32 s4, s28, 835584
    buffer_load_dwordx4 v10, s[12:15], s4 offen lds

    s_add_u32 m0, s29, 105472
    s_add_u32 s4, s28, 843776
    buffer_load_dwordx4 v11, s[12:15], s4 offen lds

    s_waitcnt vmcnt(24)
    s_barrier
    ds_read_b64_tr_b16 a[0:1], v12 offset:0
    ds_read_b64_tr_b16 a[2:3], v12 offset:4096
    ds_read_b64_tr_b16 a[4:5], v13 offset:0
    ds_read_b64_tr_b16 a[6:7], v13 offset:4096
    ds_read_b64_tr_b16 a[8:9], v12 offset:8192
    ds_read_b64_tr_b16 a[10:11], v12 offset:12288
    ds_read_b64_tr_b16 a[12:13], v13 offset:8192
    ds_read_b64_tr_b16 a[14:15], v13 offset:12288
    ds_read_b64_tr_b16 a[16:17], v12 offset:16384
    ds_read_b64_tr_b16 a[18:19], v12 offset:20480
    ds_read_b64_tr_b16 a[20:21], v13 offset:16384
    ds_read_b64_tr_b16 a[22:23], v13 offset:20480
    ds_read_b64_tr_b16 a[24:25], v12 offset:24576
    ds_read_b64_tr_b16 a[26:27], v12 offset:28672
    ds_read_b64_tr_b16 a[28:29], v13 offset:24576
    ds_read_b64_tr_b16 a[30:31], v13 offset:28672
    s_waitcnt lgkmcnt(0)
    s_barrier
    s_add_u32 m0, s29, 0
    s_add_u32 s4, s28, 1048576
    buffer_load_dwordx4 v10, s[12:15], s4 offen lds

    s_add_u32 m0, s29, 1024
    s_add_u32 s4, s28, 1056768
    buffer_load_dwordx4 v11, s[12:15], s4 offen lds

    s_add_u32 m0, s29, 2048
    s_add_u32 s4, s28, 1064960
    buffer_load_dwordx4 v10, s[12:15], s4 offen lds

    s_add_u32 m0, s29, 3072
    s_add_u32 s4, s28, 1073152
    buffer_load_dwordx4 v11, s[12:15], s4 offen lds

    s_add_u32 m0, s29, 4096
    s_add_u32 s4, s28, 1081344
    buffer_load_dwordx4 v10, s[12:15], s4 offen lds

    s_add_u32 m0, s29, 5120
    s_add_u32 s4, s28, 1089536
    buffer_load_dwordx4 v11, s[12:15], s4 offen lds

    s_add_u32 m0, s29, 6144
    s_add_u32 s4, s28, 1097728
    buffer_load_dwordx4 v10, s[12:15], s4 offen lds

    s_add_u32 m0, s29, 7168
    s_add_u32 s4, s28, 1105920
    buffer_load_dwordx4 v11, s[12:15], s4 offen lds

    s_waitcnt vmcnt(24)
    s_barrier
    ds_read_b64_tr_b16 a[32:33], v12 offset:32768
    ds_read_b64_tr_b16 a[34:35], v12 offset:36864
    ds_read_b64_tr_b16 a[36:37], v13 offset:32768
    ds_read_b64_tr_b16 a[38:39], v13 offset:36864
    ds_read_b64_tr_b16 a[40:41], v12 offset:40960
    ds_read_b64_tr_b16 a[42:43], v12 offset:45056
    ds_read_b64_tr_b16 a[44:45], v13 offset:40960
    ds_read_b64_tr_b16 a[46:47], v13 offset:45056
    ds_read_b64_tr_b16 a[48:49], v12 offset:49152
    ds_read_b64_tr_b16 a[50:51], v12 offset:53248
    ds_read_b64_tr_b16 a[52:53], v13 offset:49152
    ds_read_b64_tr_b16 a[54:55], v13 offset:53248
    ds_read_b64_tr_b16 a[56:57], v12 offset:57344
    ds_read_b64_tr_b16 a[58:59], v12 offset:61440
    ds_read_b64_tr_b16 a[60:61], v13 offset:57344
    ds_read_b64_tr_b16 a[62:63], v13 offset:61440
    s_waitcnt lgkmcnt(0)
    s_barrier
    s_add_u32 m0, s29, 32768
    s_add_u32 s4, s28, 1310720
    buffer_load_dwordx4 v10, s[12:15], s4 offen lds

    s_add_u32 m0, s29, 33792
    s_add_u32 s4, s28, 1318912
    buffer_load_dwordx4 v11, s[12:15], s4 offen lds

    s_add_u32 m0, s29, 34816
    s_add_u32 s4, s28, 1327104
    buffer_load_dwordx4 v10, s[12:15], s4 offen lds

    s_add_u32 m0, s29, 35840
    s_add_u32 s4, s28, 1335296
    buffer_load_dwordx4 v11, s[12:15], s4 offen lds

    s_add_u32 m0, s29, 36864
    s_add_u32 s4, s28, 1343488
    buffer_load_dwordx4 v10, s[12:15], s4 offen lds

    s_add_u32 m0, s29, 37888
    s_add_u32 s4, s28, 1351680
    buffer_load_dwordx4 v11, s[12:15], s4 offen lds

    s_add_u32 m0, s29, 38912
    s_add_u32 s4, s28, 1359872
    buffer_load_dwordx4 v10, s[12:15], s4 offen lds

    s_add_u32 m0, s29, 39936
    s_add_u32 s4, s28, 1368064
    buffer_load_dwordx4 v11, s[12:15], s4 offen lds

    s_waitcnt vmcnt(24)
    s_barrier
    ds_read_b64_tr_b16 a[64:65], v14 offset:0
    ds_read_b64_tr_b16 a[66:67], v14 offset:4096
    ds_read_b64_tr_b16 a[68:69], v15 offset:0
    ds_read_b64_tr_b16 a[70:71], v15 offset:4096
    ds_read_b64_tr_b16 a[72:73], v14 offset:8192
    ds_read_b64_tr_b16 a[74:75], v14 offset:12288
    ds_read_b64_tr_b16 a[76:77], v15 offset:8192
    ds_read_b64_tr_b16 a[78:79], v15 offset:12288
    ds_read_b64_tr_b16 a[80:81], v14 offset:16384
    ds_read_b64_tr_b16 a[82:83], v14 offset:20480
    ds_read_b64_tr_b16 a[84:85], v15 offset:16384
    ds_read_b64_tr_b16 a[86:87], v15 offset:20480
    ds_read_b64_tr_b16 a[88:89], v14 offset:24576
    ds_read_b64_tr_b16 a[90:91], v14 offset:28672
    ds_read_b64_tr_b16 a[92:93], v15 offset:24576
    ds_read_b64_tr_b16 a[94:95], v15 offset:28672
    s_waitcnt lgkmcnt(0)
    s_barrier
    s_add_u32 m0, s29, 65536
    s_add_u32 s4, s28, 1572864
    buffer_load_dwordx4 v10, s[12:15], s4 offen lds

    s_add_u32 m0, s29, 66560
    s_add_u32 s4, s28, 1581056
    buffer_load_dwordx4 v11, s[12:15], s4 offen lds

    s_add_u32 m0, s29, 67584
    s_add_u32 s4, s28, 1589248
    buffer_load_dwordx4 v10, s[12:15], s4 offen lds

    s_add_u32 m0, s29, 68608
    s_add_u32 s4, s28, 1597440
    buffer_load_dwordx4 v11, s[12:15], s4 offen lds

    s_add_u32 m0, s29, 69632
    s_add_u32 s4, s28, 1605632
    buffer_load_dwordx4 v10, s[12:15], s4 offen lds

    s_add_u32 m0, s29, 70656
    s_add_u32 s4, s28, 1613824
    buffer_load_dwordx4 v11, s[12:15], s4 offen lds

    s_add_u32 m0, s29, 71680
    s_add_u32 s4, s28, 1622016
    buffer_load_dwordx4 v10, s[12:15], s4 offen lds

    s_add_u32 m0, s29, 72704
    s_add_u32 s4, s28, 1630208
    buffer_load_dwordx4 v11, s[12:15], s4 offen lds

    s_waitcnt vmcnt(24)
    s_barrier
    ds_read_b64_tr_b16 a[96:97], v14 offset:32768
    ds_read_b64_tr_b16 a[98:99], v14 offset:36864
    ds_read_b64_tr_b16 a[100:101], v15 offset:32768
    ds_read_b64_tr_b16 a[102:103], v15 offset:36864
    ds_read_b64_tr_b16 a[104:105], v14 offset:40960
    ds_read_b64_tr_b16 a[106:107], v14 offset:45056
    ds_read_b64_tr_b16 a[108:109], v15 offset:40960
    ds_read_b64_tr_b16 a[110:111], v15 offset:45056
    ds_read_b64_tr_b16 a[112:113], v14 offset:49152
    ds_read_b64_tr_b16 a[114:115], v14 offset:53248
    ds_read_b64_tr_b16 a[116:117], v15 offset:49152
    ds_read_b64_tr_b16 a[118:119], v15 offset:53248
    ds_read_b64_tr_b16 a[120:121], v14 offset:57344
    ds_read_b64_tr_b16 a[122:123], v14 offset:61440
    ds_read_b64_tr_b16 a[124:125], v15 offset:57344
    ds_read_b64_tr_b16 a[126:127], v15 offset:61440
    s_waitcnt lgkmcnt(0)
    s_barrier
    s_add_u32 m0, s29, 98304
    s_add_u32 s4, s28, 1835008
    buffer_load_dwordx4 v10, s[12:15], s4 offen lds

    s_add_u32 m0, s29, 99328
    s_add_u32 s4, s28, 1843200
    buffer_load_dwordx4 v11, s[12:15], s4 offen lds

    s_add_u32 m0, s29, 100352
    s_add_u32 s4, s28, 1851392
    buffer_load_dwordx4 v10, s[12:15], s4 offen lds

    s_add_u32 m0, s29, 101376
    s_add_u32 s4, s28, 1859584
    buffer_load_dwordx4 v11, s[12:15], s4 offen lds

    s_add_u32 m0, s29, 102400
    s_add_u32 s4, s28, 1867776
    buffer_load_dwordx4 v10, s[12:15], s4 offen lds

    s_add_u32 m0, s29, 103424
    s_add_u32 s4, s28, 1875968
    buffer_load_dwordx4 v11, s[12:15], s4 offen lds

    s_add_u32 m0, s29, 104448
    s_add_u32 s4, s28, 1884160
    buffer_load_dwordx4 v10, s[12:15], s4 offen lds

    s_add_u32 m0, s29, 105472
    s_add_u32 s4, s28, 1892352
    buffer_load_dwordx4 v11, s[12:15], s4 offen lds

    s_waitcnt vmcnt(24)
    s_barrier
    ds_read_b64_tr_b16 a[128:129], v12 offset:0
    ds_read_b64_tr_b16 a[130:131], v12 offset:4096
    ds_read_b64_tr_b16 a[132:133], v13 offset:0
    ds_read_b64_tr_b16 a[134:135], v13 offset:4096
    ds_read_b64_tr_b16 a[136:137], v12 offset:8192
    ds_read_b64_tr_b16 a[138:139], v12 offset:12288
    ds_read_b64_tr_b16 a[140:141], v13 offset:8192
    ds_read_b64_tr_b16 a[142:143], v13 offset:12288
    ds_read_b64_tr_b16 a[144:145], v12 offset:16384
    ds_read_b64_tr_b16 a[146:147], v12 offset:20480
    ds_read_b64_tr_b16 a[148:149], v13 offset:16384
    ds_read_b64_tr_b16 a[150:151], v13 offset:20480
    ds_read_b64_tr_b16 a[152:153], v12 offset:24576
    ds_read_b64_tr_b16 a[154:155], v12 offset:28672
    ds_read_b64_tr_b16 a[156:157], v13 offset:24576
    ds_read_b64_tr_b16 a[158:159], v13 offset:28672
    s_waitcnt lgkmcnt(0)
    s_barrier
    s_waitcnt vmcnt(16)
    s_barrier
    ds_read_b64_tr_b16 a[160:161], v12 offset:32768
    ds_read_b64_tr_b16 a[162:163], v12 offset:36864
    ds_read_b64_tr_b16 a[164:165], v13 offset:32768
    ds_read_b64_tr_b16 a[166:167], v13 offset:36864
    ds_read_b64_tr_b16 a[168:169], v12 offset:40960
    ds_read_b64_tr_b16 a[170:171], v12 offset:45056
    ds_read_b64_tr_b16 a[172:173], v13 offset:40960
    ds_read_b64_tr_b16 a[174:175], v13 offset:45056
    ds_read_b64_tr_b16 a[176:177], v12 offset:49152
    ds_read_b64_tr_b16 a[178:179], v12 offset:53248
    ds_read_b64_tr_b16 a[180:181], v13 offset:49152
    ds_read_b64_tr_b16 a[182:183], v13 offset:53248
    ds_read_b64_tr_b16 a[184:185], v12 offset:57344
    ds_read_b64_tr_b16 a[186:187], v12 offset:61440
    ds_read_b64_tr_b16 a[188:189], v13 offset:57344
    ds_read_b64_tr_b16 a[190:191], v13 offset:61440
    s_waitcnt lgkmcnt(0)
    s_barrier
    s_waitcnt vmcnt(8)
    s_barrier
    ds_read_b64_tr_b16 a[192:193], v14 offset:0
    ds_read_b64_tr_b16 a[194:195], v14 offset:4096
    ds_read_b64_tr_b16 a[196:197], v15 offset:0
    ds_read_b64_tr_b16 a[198:199], v15 offset:4096
    ds_read_b64_tr_b16 a[200:201], v14 offset:8192
    ds_read_b64_tr_b16 a[202:203], v14 offset:12288
    ds_read_b64_tr_b16 a[204:205], v15 offset:8192
    ds_read_b64_tr_b16 a[206:207], v15 offset:12288
    ds_read_b64_tr_b16 a[208:209], v14 offset:16384
    ds_read_b64_tr_b16 a[210:211], v14 offset:20480
    ds_read_b64_tr_b16 a[212:213], v15 offset:16384
    ds_read_b64_tr_b16 a[214:215], v15 offset:20480
    ds_read_b64_tr_b16 a[216:217], v14 offset:24576
    ds_read_b64_tr_b16 a[218:219], v14 offset:28672
    ds_read_b64_tr_b16 a[220:221], v15 offset:24576
    ds_read_b64_tr_b16 a[222:223], v15 offset:28672
    s_waitcnt lgkmcnt(0)
    s_barrier
    s_waitcnt vmcnt(0)
    s_barrier
    ds_read_b64_tr_b16 a[224:225], v14 offset:32768
    ds_read_b64_tr_b16 a[226:227], v14 offset:36864
    ds_read_b64_tr_b16 a[228:229], v15 offset:32768
    ds_read_b64_tr_b16 a[230:231], v15 offset:36864
    ds_read_b64_tr_b16 a[232:233], v14 offset:40960
    ds_read_b64_tr_b16 a[234:235], v14 offset:45056
    ds_read_b64_tr_b16 a[236:237], v15 offset:40960
    ds_read_b64_tr_b16 a[238:239], v15 offset:45056
    ds_read_b64_tr_b16 a[240:241], v14 offset:49152
    ds_read_b64_tr_b16 a[242:243], v14 offset:53248
    ds_read_b64_tr_b16 a[244:245], v15 offset:49152
    ds_read_b64_tr_b16 a[246:247], v15 offset:53248
    ds_read_b64_tr_b16 a[248:249], v14 offset:57344
    ds_read_b64_tr_b16 a[250:251], v14 offset:61440
    ds_read_b64_tr_b16 a[252:253], v15 offset:57344
    ds_read_b64_tr_b16 a[254:255], v15 offset:61440
    s_waitcnt lgkmcnt(0)
    s_barrier
    v_lshlrev_b32 v21, 4, v1
    s_lshr_b32 s4, s91, 1
    s_lshl_b32 s5, s4, 12
    v_add_u32 v17, s5, v21
    v_xor_b32 v18, 0x1000, v17
    s_lshl_b32 s4, s4, 4
    v_add_u32 v4, s4, v2
    s_lshl_b32 s5, s30, 5
    s_lshl_b32 s6, s24, 3
    s_add_u32 s5, s5, s6
    s_and_b32 s6, s91, 1
    s_lshl_b32 s6, s6, 2
    s_add_u32 s5, s5, s6
    v_add_u32 v5, s5, v3
    v_lshlrev_b32 v6, 3, v5
    v_lshl_add_u32 v22, v4, 11, v6
    v_lshlrev_b32 v6, 14, v5
    v_lshl_add_u32 v23, v4, 2, v6
    v_lshlrev_b32 v16, 2, v4
    v_bfe_u32 v4, v1, 2, 3
    v_lshlrev_b32 v19, 8, v4
    v_and_b32 v4, 3, v1
    v_lshl_add_u32 v19, v4, 2, v19
    s_lshl_b32 s33, s91, 11
    s_add_u32 s33, s33, 92299264
    s_lshl_b32 s35, s24, 14
    s_lshl_b32 s36, s91, 16
    s_add_u32 s36, s36, s35
    s_add_u32 s36, s36, 50331648
    s_mov_b32 s37, 0
    s_lshl_b32 s4, s91, 3
    s_add_u32 s4, s4, s30
    s_lshl_b32 s4, s4, 2
    s_add_u32 s4, s4, s24
    s_lshl_b32 s4, s4, 11
    s_add_u32 s4, s4, 50331648
    v_lshlrev_b32 v111, 5, v1
    v_add_u32 v111, s4, v111
    s_mov_b32 s52, 0
    s_mov_b32 s39, 0
    v_lshlrev_b32 v6, 11, v1

    s_mov_b32 s62, 0
    s_mov_b64 exec, 15
.wf_381:
    buffer_load_dword v4, v6, s[8:11], s57 offen sc1
    s_waitcnt vmcnt(0)
    v_cmp_gt_u32 vcc, 64, v4
    s_cbranch_vccz .wfd_382
    s_sleep 2
    s_add_u32 s62, s62, 1
    s_cmp_gt_u32 s62, 0x400000
    s_cbranch_scc1 .mg_end_1
    s_branch .wf_381

.wfd_382:
    s_mov_b64 exec, -1
    v_mov_b32 v5, 0
    s_mov_b32 s62, 0
    s_mov_b32 s5, 160
.wc_383:
    buffer_load_dword v4, v5, s[20:23], s5 offen sc1
    s_waitcnt vmcnt(0)
    v_readfirstlane_b32 s4, v4
    s_lshr_b32 s4, s4, 0
    s_and_b32 s4, s4, 0xffff
    s_cmp_ge_u32 s4, 32
    s_cbranch_scc1 .wcd_384
    s_sleep 6
    s_add_u32 s62, s62, 1
    s_cmp_gt_u32 s62, 0x400000
    s_cbranch_scc1 .mg_end_1
    s_branch .wc_383

.wcd_384:
.g2blk_385:
    s_mov_b32 s62, 0
    s_mov_b64 s[64:65], 0
    s_mov_b32 s38, 0
.g2bw_393:
    buffer_load_dword v20, v19, s[8:11], s33 offen sc1
    s_waitcnt vmcnt(0)
    s_lshr_b32 s6, s31, 2
    s_and_b32 s4, s31, 3
    v_cmp_ge_u32 vcc, s6, v20
    s_lshl_b32 s4, s4, 3
    s_lshr_b32 s5, vcc_lo, s4
    s_and_b32 s5, s5, 0xff
    s_cmp_eq_u32 s5, 0

    s_cbranch_scc1 .g2rd_394
    s_sleep 1
    s_add_u32 s62, s62, 1
    s_cmp_gt_u32 s62, 0x400000
    s_cbranch_scc1 .mg_end_1
    s_branch .g2bw_393

.g2rd_394:
    s_lshl_b32 s48, s31, 18
    s_add_u32 s48, s48, s36
    s_add_u32 s49, s39, s35
    s_xor_b32 s39, s39, 0x10000

    s_add_u32 m0, s49, 0
    s_add_u32 s50, s48, 0
    buffer_load_dwordx4 v21, s[8:11], s50 offen offset:0 lds
    buffer_load_dwordx4 v21, s[8:11], s50 offen offset:1024 lds
    buffer_load_dwordx4 v21, s[8:11], s50 offen offset:2048 lds
    buffer_load_dwordx4 v21, s[8:11], s50 offen offset:3072 lds
    s_add_u32 m0, s49, 4096
    s_add_u32 s50, s48, 4096
    buffer_load_dwordx4 v21, s[8:11], s50 offen offset:0 lds
    buffer_load_dwordx4 v21, s[8:11], s50 offen offset:1024 lds
    buffer_load_dwordx4 v21, s[8:11], s50 offen offset:2048 lds
    buffer_load_dwordx4 v21, s[8:11], s50 offen offset:3072 lds
    s_add_u32 m0, s49, 8192
    s_add_u32 s50, s48, 8192
    buffer_load_dwordx4 v21, s[8:11], s50 offen offset:0 lds
    buffer_load_dwordx4 v21, s[8:11], s50 offen offset:1024 lds
    buffer_load_dwordx4 v21, s[8:11], s50 offen offset:2048 lds
    buffer_load_dwordx4 v21, s[8:11], s50 offen offset:3072 lds
    s_add_u32 m0, s49, 12288
    s_add_u32 s50, s48, 12288
    buffer_load_dwordx4 v21, s[8:11], s50 offen offset:0 lds
    buffer_load_dwordx4 v21, s[8:11], s50 offen offset:1024 lds
    buffer_load_dwordx4 v21, s[8:11], s50 offen offset:2048 lds
    buffer_load_dwordx4 v21, s[8:11], s50 offen offset:3072 lds
    s_waitcnt vmcnt(0)
.g2go_386:
    s_barrier
    ds_read_b128 v[32:35], v17 offset:0
    ds_read_b128 v[36:39], v18 offset:0
    ds_read_b128 v[40:43], v17 offset:1024
    ds_read_b128 v[44:47], v18 offset:1024
    ds_read_b128 v[48:51], v17 offset:2048
    ds_read_b128 v[52:55], v18 offset:2048
    s_add_u32 s53, s31, 3
    s_sub_u32 s54, s31, 3
    s_max_i32 s54, s54, 0
    s_sub_u32 s55, s37, 0x10000
    s_add_u32 s61, s31, 6
    s_lshr_b32 s6, s53, 2
    s_and_b32 s4, s53, 3
    v_cmp_ge_u32 vcc, s6, v20
    s_lshl_b32 s4, s4, 3
    s_lshr_b32 s5, vcc_lo, s4
    s_and_b32 s5, s5, 0xff
    s_cmp_eq_u32 s5, 0

    s_cselect_b32 s56, 1, 0
    s_cmp_lt_u32 s53, 64
    s_cselect_b32 s56, s56, 0
    s_cmp_eq_u32 s56, 0
    s_cbranch_scc1 .g2nd_389
    s_lshr_b32 s6, s61, 2
    s_and_b32 s4, s61, 3
    v_cmp_ge_u32 vcc, s6, v20
    s_lshl_b32 s4, s4, 3
    s_lshr_b32 s5, vcc_lo, s4
    s_and_b32 s5, s5, 0xff
    s_cmp_eq_u32 s5, 0

    s_cbranch_scc1 .g2nf_388
    buffer_load_dword v20, v19, s[8:11], s33 offen sc1
    s_branch .g2pd_395
.g2nf_388:
    s_lshl_b32 s4, s61, 18
    buffer_load_dword v31, v111, s[8:11], s4 offen
.g2pd_395:
    s_lshl_b32 s48, s53, 18
    s_add_u32 s48, s48, s36
    s_add_u32 s49, s39, s35
    s_xor_b32 s39, s39, 0x10000

    s_waitcnt lgkmcnt(4)
    v_mfma_f32_16x16x32_bf16 v[64:67], a[0:3], v[32:35], 0
    ds_read_b128 v[56:59], v17 offset:3072
    s_add_u32 m0, s49, 0
    s_add_u32 s50, s48, 0
    v_mfma_f32_16x16x32_bf16 v[68:71], a[4:7], v[32:35], 0
    buffer_load_dwordx4 v21, s[8:11], s50 offen offset:0 lds
    v_mfma_f32_16x16x32_bf16 v[72:75], a[0:3], v[36:39], 0
    ds_read_b128 v[60:63], v18 offset:3072
    v_mfma_f32_16x16x32_bf16 v[76:79], a[4:7], v[36:39], 0
    s_waitcnt lgkmcnt(4)
    v_mfma_f32_16x16x32_bf16 v[64:67], a[8:11], v[40:43], v[64:67]
    ds_read_b128 v[32:35], v17 offset:8192
    v_mfma_f32_16x16x32_bf16 v[68:71], a[12:15], v[40:43], v[68:71]
    v_mfma_f32_16x16x32_bf16 v[72:75], a[8:11], v[44:47], v[72:75]
    ds_read_b128 v[36:39], v18 offset:8192
    v_mfma_f32_16x16x32_bf16 v[76:79], a[12:15], v[44:47], v[76:79]
    buffer_load_dwordx4 v21, s[8:11], s50 offen offset:1024 lds
    s_waitcnt lgkmcnt(4)
    v_mfma_f32_16x16x32_bf16 v[64:67], a[16:19], v[48:51], v[64:67]
    ds_read_b128 v[40:43], v17 offset:9216
    v_mfma_f32_16x16x32_bf16 v[68:71], a[20:23], v[48:51], v[68:71]
    v_mfma_f32_16x16x32_bf16 v[72:75], a[16:19], v[52:55], v[72:75]
    ds_read_b128 v[44:47], v18 offset:9216
    v_mfma_f32_16x16x32_bf16 v[76:79], a[20:23], v[52:55], v[76:79]
    s_waitcnt lgkmcnt(4)
    v_mfma_f32_16x16x32_bf16 v[64:67], a[24:27], v[56:59], v[64:67]
    ds_read_b128 v[48:51], v17 offset:10240
    v_mfma_f32_16x16x32_bf16 v[68:71], a[28:31], v[56:59], v[68:71]
    buffer_load_dwordx4 v21, s[8:11], s50 offen offset:2048 lds
    v_mfma_f32_16x16x32_bf16 v[72:75], a[24:27], v[60:63], v[72:75]
    ds_read_b128 v[52:55], v18 offset:10240
    v_mfma_f32_16x16x32_bf16 v[76:79], a[28:31], v[60:63], v[76:79]
    s_waitcnt lgkmcnt(4)
    v_mfma_f32_16x16x32_bf16 v[64:67], a[32:35], v[32:35], v[64:67]
    ds_read_b128 v[56:59], v17 offset:11264
    v_mfma_f32_16x16x32_bf16 v[68:71], a[36:39], v[32:35], v[68:71]
    v_mfma_f32_16x16x32_bf16 v[72:75], a[32:35], v[36:39], v[72:75]
    ds_read_b128 v[60:63], v18 offset:11264
    v_mfma_f32_16x16x32_bf16 v[76:79], a[36:39], v[36:39], v[76:79]
    buffer_load_dwordx4 v21, s[8:11], s50 offen offset:3072 lds
    s_waitcnt lgkmcnt(4)
    v_mfma_f32_16x16x32_bf16 v[64:67], a[40:43], v[40:43], v[64:67]
    ds_read_b128 v[32:35], v17 offset:16384
    v_mfma_f32_16x16x32_bf16 v[68:71], a[44:47], v[40:43], v[68:71]
    v_mfma_f32_16x16x32_bf16 v[72:75], a[40:43], v[44:47], v[72:75]
    ds_read_b128 v[36:39], v18 offset:16384
    v_mfma_f32_16x16x32_bf16 v[76:79], a[44:47], v[44:47], v[76:79]
    s_waitcnt lgkmcnt(4)
    v_mfma_f32_16x16x32_bf16 v[64:67], a[48:51], v[48:51], v[64:67]
    ds_read_b128 v[40:43], v17 offset:17408
    s_add_u32 m0, s49, 4096
    s_add_u32 s50, s48, 4096
    v_mfma_f32_16x16x32_bf16 v[68:71], a[52:55], v[48:51], v[68:71]
    buffer_load_dwordx4 v21, s[8:11], s50 offen offset:0 lds
    v_mfma_f32_16x16x32_bf16 v[72:75], a[48:51], v[52:55], v[72:75]
    ds_read_b128 v[44:47], v18 offset:17408
    v_mfma_f32_16x16x32_bf16 v[76:79], a[52:55], v[52:55], v[76:79]
    s_waitcnt lgkmcnt(4)
    v_mfma_f32_16x16x32_bf16 v[64:67], a[56:59], v[56:59], v[64:67]
    ds_read_b128 v[48:51], v17 offset:18432
    v_mfma_f32_16x16x32_bf16 v[68:71], a[60:63], v[56:59], v[68:71]
    v_mfma_f32_16x16x32_bf16 v[72:75], a[56:59], v[60:63], v[72:75]
    ds_read_b128 v[52:55], v18 offset:18432
    v_mfma_f32_16x16x32_bf16 v[76:79], a[60:63], v[60:63], v[76:79]
    buffer_load_dwordx4 v21, s[8:11], s50 offen offset:1024 lds
    s_waitcnt lgkmcnt(4)
    v_mfma_f32_16x16x32_bf16 v[64:67], a[64:67], v[32:35], v[64:67]
    ds_read_b128 v[56:59], v17 offset:19456
    v_mfma_f32_16x16x32_bf16 v[68:71], a[68:71], v[32:35], v[68:71]
    v_mfma_f32_16x16x32_bf16 v[72:75], a[64:67], v[36:39], v[72:75]
    ds_read_b128 v[60:63], v18 offset:19456
    v_mfma_f32_16x16x32_bf16 v[76:79], a[68:71], v[36:39], v[76:79]
    s_waitcnt lgkmcnt(4)
    v_mfma_f32_16x16x32_bf16 v[64:67], a[72:75], v[40:43], v[64:67]
    ds_read_b128 v[32:35], v17 offset:24576
    v_mfma_f32_16x16x32_bf16 v[68:71], a[76:79], v[40:43], v[68:71]
    buffer_load_dwordx4 v21, s[8:11], s50 offen offset:2048 lds
    v_mfma_f32_16x16x32_bf16 v[72:75], a[72:75], v[44:47], v[72:75]
    ds_read_b128 v[36:39], v18 offset:24576
    v_mfma_f32_16x16x32_bf16 v[76:79], a[76:79], v[44:47], v[76:79]
    s_waitcnt lgkmcnt(4)
    v_mfma_f32_16x16x32_bf16 v[64:67], a[80:83], v[48:51], v[64:67]
    ds_read_b128 v[40:43], v17 offset:25600
    v_mfma_f32_16x16x32_bf16 v[68:71], a[84:87], v[48:51], v[68:71]
    s_waitcnt vmcnt(11)
    v_mfma_f32_16x16x32_bf16 v[72:75], a[80:83], v[52:55], v[72:75]
    ds_read_b128 v[44:47], v18 offset:25600
    v_mfma_f32_16x16x32_bf16 v[76:79], a[84:87], v[52:55], v[76:79]
    buffer_load_dwordx4 v21, s[8:11], s50 offen offset:3072 lds
    s_mov_b32 s62, 0
.cc_396:
    v_max3_u32 v4, v84, v88, v92
    v_cmp_eq_u32 vcc, -1, v4
    s_and_b64 vcc, vcc, s[64:65]
    s_cbranch_vccnz .cf_397
    s_waitcnt lgkmcnt(4)
    v_mfma_f32_16x16x32_bf16 v[64:67], a[88:91], v[56:59], v[64:67]
    ds_read_b128 v[48:51], v17 offset:26624
    v_mfma_f32_16x16x32_bf16 v[68:71], a[92:95], v[56:59], v[68:71]
    v_add_f32 v84, v84, v88
    v_add_f32 v92, v112, v92
    v_mfma_f32_16x16x32_bf16 v[72:75], a[88:91], v[60:63], v[72:75]
    ds_read_b128 v[52:55], v18 offset:26624
    v_mfma_f32_16x16x32_bf16 v[76:79], a[92:95], v[60:63], v[76:79]
    v_add_f32 v85, v85, v89
    v_add_f32 v93, v113, v93
    s_waitcnt lgkmcnt(4)
    v_mfma_f32_16x16x32_bf16 v[64:67], a[96:99], v[32:35], v[64:67]
    ds_read_b128 v[56:59], v17 offset:27648
    s_add_u32 m0, s49, 8192
    s_add_u32 s50, s48, 8192
    v_mfma_f32_16x16x32_bf16 v[68:71], a[100:103], v[32:35], v[68:71]
    buffer_load_dwordx4 v21, s[8:11], s50 offen offset:0 lds
    v_add_f32 v86, v86, v90
    v_add_f32 v94, v114, v94
    v_mfma_f32_16x16x32_bf16 v[72:75], a[96:99], v[36:39], v[72:75]
    ds_read_b128 v[60:63], v18 offset:27648
    v_mfma_f32_16x16x32_bf16 v[76:79], a[100:103], v[36:39], v[76:79]
    v_add_f32 v87, v87, v91
    v_add_f32 v95, v115, v95
    s_waitcnt lgkmcnt(4)
    v_mfma_f32_16x16x32_bf16 v[64:67], a[104:107], v[40:43], v[64:67]
    ds_read_b128 v[32:35], v17 offset:32768
    v_mfma_f32_16x16x32_bf16 v[68:71], a[108:111], v[40:43], v[68:71]
    v_add_f32 v84, v92, v84
    v_add_f32 v85, v93, v85
    v_mfma_f32_16x16x32_bf16 v[72:75], a[104:107], v[44:47], v[72:75]
    ds_read_b128 v[36:39], v18 offset:32768
    v_mfma_f32_16x16x32_bf16 v[76:79], a[108:111], v[44:47], v[76:79]
    buffer_load_dwordx4 v21, s[8:11], s50 offen offset:1024 lds
    v_add_f32 v86, v94, v86
    v_add_f32 v87, v95, v87
    s_waitcnt lgkmcnt(4)
    v_mfma_f32_16x16x32_bf16 v[64:67], a[112:115], v[48:51], v[64:67]
    ds_read_b128 v[40:43], v17 offset:33792
    v_mfma_f32_16x16x32_bf16 v[68:71], a[116:119], v[48:51], v[68:71]
    v_sub_f32 v104, 1.0, v100
    v_cvt_pk_bf16_f32 v104, v104, v104
    v_mfma_f32_16x16x32_bf16 v[72:75], a[112:115], v[52:55], v[72:75]
    ds_read_b128 v[44:47], v18 offset:33792
    v_mfma_f32_16x16x32_bf16 v[76:79], a[116:119], v[52:55], v[76:79]
    v_lshlrev_b32 v104, 16, v104
    v_cvt_pk_bf16_f32 v105, v84, v85
    s_waitcnt lgkmcnt(4)
    v_mfma_f32_16x16x32_bf16 v[64:67], a[120:123], v[56:59], v[64:67]
    ds_read_b128 v[48:51], v17 offset:34816
    v_mfma_f32_16x16x32_bf16 v[68:71], a[124:127], v[56:59], v[68:71]
    buffer_load_dwordx4 v21, s[8:11], s50 offen offset:2048 lds
    v_lshlrev_b32 v107, 16, v96
    v_and_b32 v108, 0xffff0000, v96
    v_mfma_f32_16x16x32_bf16 v[72:75], a[120:123], v[60:63], v[72:75]
    ds_read_b128 v[52:55], v18 offset:34816
    v_mfma_f32_16x16x32_bf16 v[76:79], a[124:127], v[60:63], v[76:79]
    v_lshlrev_b32 v109, 16, v98
    v_and_b32 v110, 0xffff0000, v98
    s_waitcnt lgkmcnt(4)
    v_mfma_f32_16x16x32_bf16 v[64:67], a[128:131], v[32:35], v[64:67]
    ds_read_b128 v[56:59], v17 offset:35840
    v_mfma_f32_16x16x32_bf16 v[68:71], a[132:135], v[32:35], v[68:71]
    v_and_b32 v106, 0xffff0000, v105
    v_lshlrev_b32 v105, 16, v105
    v_mfma_f32_16x16x32_bf16 v[72:75], a[128:131], v[36:39], v[72:75]
    ds_read_b128 v[60:63], v18 offset:35840
    v_mfma_f32_16x16x32_bf16 v[76:79], a[132:135], v[36:39], v[76:79]
    buffer_load_dwordx4 v21, s[8:11], s50 offen offset:3072 lds
    v_mul_f32 v107, v107, v109
    v_mul_f32 v108, v108, v110
    s_waitcnt lgkmcnt(4)
    v_mfma_f32_16x16x32_bf16 v[64:67], a[136:139], v[40:43], v[64:67]
    ds_read_b128 v[32:35], v17 offset:40960
    v_mfma_f32_16x16x32_bf16 v[68:71], a[140:143], v[40:43], v[68:71]
    v_mul_f32 v105, v104, v105
    v_mul_f32 v106, v104, v106
    v_mfma_f32_16x16x32_bf16 v[72:75], a[136:139], v[44:47], v[72:75]
    ds_read_b128 v[36:39], v18 offset:40960
    v_mfma_f32_16x16x32_bf16 v[76:79], a[140:143], v[44:47], v[76:79]
    v_cvt_pk_bf16_f32 v107, v107, v108
    v_cvt_pk_bf16_f32 v105, v105, v106
    s_waitcnt lgkmcnt(4)
    v_mfma_f32_16x16x32_bf16 v[64:67], a[144:147], v[48:51], v[64:67]
    ds_read_b128 v[40:43], v17 offset:41984
    s_add_u32 m0, s49, 12288
    s_add_u32 s50, s48, 12288
    v_mfma_f32_16x16x32_bf16 v[68:71], a[148:151], v[48:51], v[68:71]
    buffer_load_dwordx4 v21, s[8:11], s50 offen offset:0 lds
    v_and_b32 v108, 0xffff0000, v107
    v_lshlrev_b32 v107, 16, v107
    v_mfma_f32_16x16x32_bf16 v[72:75], a[144:147], v[52:55], v[72:75]
    ds_read_b128 v[44:47], v18 offset:41984
    v_mfma_f32_16x16x32_bf16 v[76:79], a[148:151], v[52:55], v[76:79]
    v_and_b32 v106, 0xffff0000, v105
    v_lshlrev_b32 v105, 16, v105
    s_waitcnt lgkmcnt(4)
    v_mfma_f32_16x16x32_bf16 v[64:67], a[152:155], v[56:59], v[64:67]
    ds_read_b128 v[48:51], v17 offset:43008
    v_mfma_f32_16x16x32_bf16 v[68:71], a[156:159], v[56:59], v[68:71]
    v_mul_f32 v107, v100, v107
    v_mul_f32 v108, v100, v108
    v_mfma_f32_16x16x32_bf16 v[72:75], a[152:155], v[60:63], v[72:75]
    ds_read_b128 v[52:55], v18 offset:43008
    v_mfma_f32_16x16x32_bf16 v[76:79], a[156:159], v[60:63], v[76:79]
    buffer_load_dwordx4 v21, s[8:11], s50 offen offset:1024 lds
    v_cvt_pk_bf16_f32 v107, v107, v108
    v_and_b32 v108, 0xffff0000, v107
    s_waitcnt lgkmcnt(4)
    v_mfma_f32_16x16x32_bf16 v[64:67], a[160:163], v[32:35], v[64:67]
    ds_read_b128 v[56:59], v17 offset:44032
    v_mfma_f32_16x16x32_bf16 v[68:71], a[164:167], v[32:35], v[68:71]
    v_lshlrev_b32 v107, 16, v107
    v_add_f32 v105, v105, v107
    v_mfma_f32_16x16x32_bf16 v[72:75], a[160:163], v[36:39], v[72:75]
    ds_read_b128 v[60:63], v18 offset:44032
    v_mfma_f32_16x16x32_bf16 v[76:79], a[164:167], v[36:39], v[76:79]
    v_add_f32 v106, v106, v108
    v_cvt_pk_bf16_f32 v102, v105, v106
    s_waitcnt lgkmcnt(4)
    v_mfma_f32_16x16x32_bf16 v[64:67], a[168:171], v[40:43], v[64:67]
    ds_read_b128 v[32:35], v17 offset:49152
    v_mfma_f32_16x16x32_bf16 v[68:71], a[172:175], v[40:43], v[68:71]
    buffer_load_dwordx4 v21, s[8:11], s50 offen offset:2048 lds
    v_cvt_pk_bf16_f32 v105, v86, v87
    v_lshlrev_b32 v107, 16, v97
    v_mfma_f32_16x16x32_bf16 v[72:75], a[168:171], v[44:47], v[72:75]
    ds_read_b128 v[36:39], v18 offset:49152
    v_mfma_f32_16x16x32_bf16 v[76:79], a[172:175], v[44:47], v[76:79]
    v_and_b32 v108, 0xffff0000, v97
    v_lshlrev_b32 v109, 16, v99
    s_waitcnt lgkmcnt(4)
    v_mfma_f32_16x16x32_bf16 v[64:67], a[176:179], v[48:51], v[64:67]
    ds_read_b128 v[40:43], v17 offset:50176
    v_mfma_f32_16x16x32_bf16 v[68:71], a[180:183], v[48:51], v[68:71]
    v_and_b32 v110, 0xffff0000, v99
    v_and_b32 v106, 0xffff0000, v105
    v_mfma_f32_16x16x32_bf16 v[72:75], a[176:179], v[52:55], v[72:75]
    ds_read_b128 v[44:47], v18 offset:50176
    v_mfma_f32_16x16x32_bf16 v[76:79], a[180:183], v[52:55], v[76:79]
    buffer_load_dwordx4 v21, s[8:11], s50 offen offset:3072 lds
    v_lshlrev_b32 v105, 16, v105
    v_mul_f32 v107, v107, v109
    s_waitcnt lgkmcnt(4)
    v_mfma_f32_16x16x32_bf16 v[64:67], a[184:187], v[56:59], v[64:67]
    ds_read_b128 v[48:51], v17 offset:51200
    v_mfma_f32_16x16x32_bf16 v[68:71], a[188:191], v[56:59], v[68:71]
    v_mul_f32 v108, v108, v110
    v_mul_f32 v105, v104, v105
    v_mfma_f32_16x16x32_bf16 v[72:75], a[184:187], v[60:63], v[72:75]
    ds_read_b128 v[52:55], v18 offset:51200
    v_mfma_f32_16x16x32_bf16 v[76:79], a[188:191], v[60:63], v[76:79]
    v_mul_f32 v106, v104, v106
    v_cvt_pk_bf16_f32 v107, v107, v108
    s_waitcnt lgkmcnt(4)
    v_mfma_f32_16x16x32_bf16 v[64:67], a[192:195], v[32:35], v[64:67]
    ds_read_b128 v[56:59], v17 offset:52224
    v_mfma_f32_16x16x32_bf16 v[68:71], a[196:199], v[32:35], v[68:71]
    v_cvt_pk_bf16_f32 v105, v105, v106
    v_and_b32 v108, 0xffff0000, v107
    v_mfma_f32_16x16x32_bf16 v[72:75], a[192:195], v[36:39], v[72:75]
    ds_read_b128 v[60:63], v18 offset:52224
    v_mfma_f32_16x16x32_bf16 v[76:79], a[196:199], v[36:39], v[76:79]
    v_lshlrev_b32 v107, 16, v107
    v_and_b32 v106, 0xffff0000, v105
    s_waitcnt lgkmcnt(4)
    v_mfma_f32_16x16x32_bf16 v[64:67], a[200:203], v[40:43], v[64:67]
    ds_read_b128 v[32:35], v17 offset:57344
    v_mfma_f32_16x16x32_bf16 v[68:71], a[204:207], v[40:43], v[68:71]
    v_lshlrev_b32 v105, 16, v105
    v_mul_f32 v107, v100, v107
    v_mfma_f32_16x16x32_bf16 v[72:75], a[200:203], v[44:47], v[72:75]
    ds_read_b128 v[36:39], v18 offset:57344
    v_mfma_f32_16x16x32_bf16 v[76:79], a[204:207], v[44:47], v[76:79]
    v_mul_f32 v108, v100, v108
    v_cvt_pk_bf16_f32 v107, v107, v108
    s_waitcnt lgkmcnt(4)
    v_mfma_f32_16x16x32_bf16 v[64:67], a[208:211], v[48:51], v[64:67]
    ds_read_b128 v[40:43], v17 offset:58368
    v_mfma_f32_16x16x32_bf16 v[68:71], a[212:215], v[48:51], v[68:71]
    v_and_b32 v108, 0xffff0000, v107
    v_lshlrev_b32 v107, 16, v107
    v_mfma_f32_16x16x32_bf16 v[72:75], a[208:211], v[52:55], v[72:75]
    ds_read_b128 v[44:47], v18 offset:58368
    v_mfma_f32_16x16x32_bf16 v[76:79], a[212:215], v[52:55], v[76:79]
    v_add_f32 v105, v105, v107
    v_add_f32 v106, v106, v108
    s_waitcnt lgkmcnt(4)
    v_mfma_f32_16x16x32_bf16 v[64:67], a[216:219], v[56:59], v[64:67]
    ds_read_b128 v[48:51], v17 offset:59392
    v_mfma_f32_16x16x32_bf16 v[68:71], a[220:223], v[56:59], v[68:71]
    v_cvt_pk_bf16_f32 v103, v105, v106
    s_mov_b64 exec, s[64:65]
    buffer_store_dwordx2 v[102:103], v22, s[44:47], s52 offen
    s_mov_b64 exec, -1
    v_mfma_f32_16x16x32_bf16 v[72:75], a[216:219], v[60:63], v[72:75]
    ds_read_b128 v[52:55], v18 offset:59392
    v_mfma_f32_16x16x32_bf16 v[76:79], a[220:223], v[60:63], v[76:79]
    s_add_u32 s51, s34, s55
    s_lshl_b32 s52, s54, 16
    s_lshl_b32 s60, s54, 7
    s_add_u32 s58, s60, 117440512
    s_add_u32 s59, s60, 117448704
    s_add_u32 s60, s60, 121634816

    s_cmp_eq_u32 s38, 0
    s_waitcnt lgkmcnt(4)
    v_mfma_f32_16x16x32_bf16 v[64:67], a[224:227], v[32:35], v[64:67]
    ds_read_b128 v[56:59], v17 offset:60416
    v_mfma_f32_16x16x32_bf16 v[68:71], a[228:231], v[32:35], v[68:71]
    s_cbranch_scc1 .cs_398
    buffer_load_dwordx2 v[96:97], v22, s[16:19], s52 offen
.cs_398:
    v_mfma_f32_16x16x32_bf16 v[72:75], a[224:227], v[36:39], v[72:75]
    ds_read_b128 v[60:63], v18 offset:60416
    v_mfma_f32_16x16x32_bf16 v[76:79], a[228:231], v[36:39], v[76:79]
    s_cbranch_scc1 .cs_399
    buffer_load_dword v98, v23, s[8:11], s58 offen
.cs_399:
    s_waitcnt lgkmcnt(4)
    v_mfma_f32_16x16x32_bf16 v[64:67], a[232:235], v[40:43], v[64:67]
    v_mfma_f32_16x16x32_bf16 v[68:71], a[236:239], v[40:43], v[68:71]
    s_cbranch_scc1 .cs_400
    buffer_load_dword v99, v23, s[8:11], s59 offen
.cs_400:
    v_mfma_f32_16x16x32_bf16 v[72:75], a[232:235], v[44:47], v[72:75]
    v_mfma_f32_16x16x32_bf16 v[76:79], a[236:239], v[44:47], v[76:79]
    s_cbranch_scc1 .cs_401
    buffer_load_dword v100, v16, s[8:11], s60 offen
.cs_401:
    s_waitcnt lgkmcnt(2)
    v_mfma_f32_16x16x32_bf16 v[64:67], a[240:243], v[48:51], v[64:67]
    v_mfma_f32_16x16x32_bf16 v[68:71], a[244:247], v[48:51], v[68:71]
    s_cbranch_scc1 .cs_402
    buffer_load_dwordx4 v[84:87], v7, s[8:11], s51 offen sc1
.cs_402:
    v_mfma_f32_16x16x32_bf16 v[72:75], a[240:243], v[52:55], v[72:75]
    v_mfma_f32_16x16x32_bf16 v[76:79], a[244:247], v[52:55], v[76:79]
    s_cbranch_scc1 .cs_403
    buffer_load_dwordx4 v[88:91], v8, s[8:11], s51 offen sc1
.cs_403:
    s_waitcnt lgkmcnt(0)
    v_mfma_f32_16x16x32_bf16 v[64:67], a[248:251], v[56:59], v[64:67]
    v_mfma_f32_16x16x32_bf16 v[68:71], a[252:255], v[56:59], v[68:71]
    s_cbranch_scc1 .cs_404
    buffer_load_dwordx4 v[92:95], v9, s[8:11], s51 offen sc1
.cs_404:
    v_mfma_f32_16x16x32_bf16 v[72:75], a[248:251], v[60:63], v[72:75]
    v_mfma_f32_16x16x32_bf16 v[76:79], a[252:255], v[60:63], v[76:79]
    v_xor_b32 v17, 0x10000, v17
    v_xor_b32 v18, 0x10000, v18
    s_cselect_b64 s[64:65], 0, -1
    s_add_u32 s4, s34, s37

    v_mov_b32 v112, v80
    v_mov_b32 v113, v81
    v_mov_b32 v114, v82
    v_mov_b32 v115, v83
    s_branch .g2st_390
.g2nd_389:
    s_waitcnt lgkmcnt(4)
    v_mfma_f32_16x16x32_bf16 v[64:67], a[0:3], v[32:35], 0
    ds_read_b128 v[56:59], v17 offset:3072
    v_mfma_f32_16x16x32_bf16 v[68:71], a[4:7], v[32:35], 0
    v_mfma_f32_16x16x32_bf16 v[72:75], a[0:3], v[36:39], 0
    ds_read_b128 v[60:63], v18 offset:3072
    v_mfma_f32_16x16x32_bf16 v[76:79], a[4:7], v[36:39], 0
    s_waitcnt lgkmcnt(4)
    v_mfma_f32_16x16x32_bf16 v[64:67], a[8:11], v[40:43], v[64:67]
    ds_read_b128 v[32:35], v17 offset:8192
    v_mfma_f32_16x16x32_bf16 v[68:71], a[12:15], v[40:43], v[68:71]
    v_mfma_f32_16x16x32_bf16 v[72:75], a[8:11], v[44:47], v[72:75]
    ds_read_b128 v[36:39], v18 offset:8192
    v_mfma_f32_16x16x32_bf16 v[76:79], a[12:15], v[44:47], v[76:79]
    s_waitcnt lgkmcnt(4)
    v_mfma_f32_16x16x32_bf16 v[64:67], a[16:19], v[48:51], v[64:67]
    ds_read_b128 v[40:43], v17 offset:9216
    v_mfma_f32_16x16x32_bf16 v[68:71], a[20:23], v[48:51], v[68:71]
    v_mfma_f32_16x16x32_bf16 v[72:75], a[16:19], v[52:55], v[72:75]
    ds_read_b128 v[44:47], v18 offset:9216
    v_mfma_f32_16x16x32_bf16 v[76:79], a[20:23], v[52:55], v[76:79]
    s_waitcnt lgkmcnt(4)
    v_mfma_f32_16x16x32_bf16 v[64:67], a[24:27], v[56:59], v[64:67]
    ds_read_b128 v[48:51], v17 offset:10240
    v_mfma_f32_16x16x32_bf16 v[68:71], a[28:31], v[56:59], v[68:71]
    v_mfma_f32_16x16x32_bf16 v[72:75], a[24:27], v[60:63], v[72:75]
    ds_read_b128 v[52:55], v18 offset:10240
    v_mfma_f32_16x16x32_bf16 v[76:79], a[28:31], v[60:63], v[76:79]
    s_waitcnt lgkmcnt(4)
    v_mfma_f32_16x16x32_bf16 v[64:67], a[32:35], v[32:35], v[64:67]
    ds_read_b128 v[56:59], v17 offset:11264
    v_mfma_f32_16x16x32_bf16 v[68:71], a[36:39], v[32:35], v[68:71]
    v_mfma_f32_16x16x32_bf16 v[72:75], a[32:35], v[36:39], v[72:75]
    ds_read_b128 v[60:63], v18 offset:11264
    v_mfma_f32_16x16x32_bf16 v[76:79], a[36:39], v[36:39], v[76:79]
    s_waitcnt lgkmcnt(4)
    v_mfma_f32_16x16x32_bf16 v[64:67], a[40:43], v[40:43], v[64:67]
    ds_read_b128 v[32:35], v17 offset:16384
    v_mfma_f32_16x16x32_bf16 v[68:71], a[44:47], v[40:43], v[68:71]
    v_mfma_f32_16x16x32_bf16 v[72:75], a[40:43], v[44:47], v[72:75]
    ds_read_b128 v[36:39], v18 offset:16384
    v_mfma_f32_16x16x32_bf16 v[76:79], a[44:47], v[44:47], v[76:79]
    s_waitcnt lgkmcnt(4)
    v_mfma_f32_16x16x32_bf16 v[64:67], a[48:51], v[48:51], v[64:67]
    ds_read_b128 v[40:43], v17 offset:17408
    v_mfma_f32_16x16x32_bf16 v[68:71], a[52:55], v[48:51], v[68:71]
    v_mfma_f32_16x16x32_bf16 v[72:75], a[48:51], v[52:55], v[72:75]
    ds_read_b128 v[44:47], v18 offset:17408
    v_mfma_f32_16x16x32_bf16 v[76:79], a[52:55], v[52:55], v[76:79]
    s_waitcnt lgkmcnt(4)
    v_mfma_f32_16x16x32_bf16 v[64:67], a[56:59], v[56:59], v[64:67]
    ds_read_b128 v[48:51], v17 offset:18432
    v_mfma_f32_16x16x32_bf16 v[68:71], a[60:63], v[56:59], v[68:71]
    v_mfma_f32_16x16x32_bf16 v[72:75], a[56:59], v[60:63], v[72:75]
    ds_read_b128 v[52:55], v18 offset:18432
    v_mfma_f32_16x16x32_bf16 v[76:79], a[60:63], v[60:63], v[76:79]
    s_waitcnt lgkmcnt(4)
    v_mfma_f32_16x16x32_bf16 v[64:67], a[64:67], v[32:35], v[64:67]
    ds_read_b128 v[56:59], v17 offset:19456
    v_mfma_f32_16x16x32_bf16 v[68:71], a[68:71], v[32:35], v[68:71]
    v_mfma_f32_16x16x32_bf16 v[72:75], a[64:67], v[36:39], v[72:75]
    ds_read_b128 v[60:63], v18 offset:19456
    v_mfma_f32_16x16x32_bf16 v[76:79], a[68:71], v[36:39], v[76:79]
    s_waitcnt lgkmcnt(4)
    v_mfma_f32_16x16x32_bf16 v[64:67], a[72:75], v[40:43], v[64:67]
    ds_read_b128 v[32:35], v17 offset:24576
    v_mfma_f32_16x16x32_bf16 v[68:71], a[76:79], v[40:43], v[68:71]
    v_mfma_f32_16x16x32_bf16 v[72:75], a[72:75], v[44:47], v[72:75]
    ds_read_b128 v[36:39], v18 offset:24576
    v_mfma_f32_16x16x32_bf16 v[76:79], a[76:79], v[44:47], v[76:79]
    s_waitcnt lgkmcnt(4)
    v_mfma_f32_16x16x32_bf16 v[64:67], a[80:83], v[48:51], v[64:67]
    ds_read_b128 v[40:43], v17 offset:25600
    v_mfma_f32_16x16x32_bf16 v[68:71], a[84:87], v[48:51], v[68:71]
    s_waitcnt vmcnt(3)
    v_mfma_f32_16x16x32_bf16 v[72:75], a[80:83], v[52:55], v[72:75]
    ds_read_b128 v[44:47], v18 offset:25600
    v_mfma_f32_16x16x32_bf16 v[76:79], a[84:87], v[52:55], v[76:79]
    s_mov_b32 s62, 0
.cc_405:
    v_max3_u32 v4, v84, v88, v92
    v_cmp_eq_u32 vcc, -1, v4
    s_and_b64 vcc, vcc, s[64:65]
    s_cbranch_vccnz .cf_406
    s_waitcnt lgkmcnt(4)
    v_mfma_f32_16x16x32_bf16 v[64:67], a[88:91], v[56:59], v[64:67]
    ds_read_b128 v[48:51], v17 offset:26624
    v_mfma_f32_16x16x32_bf16 v[68:71], a[92:95], v[56:59], v[68:71]
    v_add_f32 v84, v84, v88
    v_add_f32 v92, v112, v92
    v_mfma_f32_16x16x32_bf16 v[72:75], a[88:91], v[60:63], v[72:75]
    ds_read_b128 v[52:55], v18 offset:26624
    v_mfma_f32_16x16x32_bf16 v[76:79], a[92:95], v[60:63], v[76:79]
    v_add_f32 v85, v85, v89
    v_add_f32 v93, v113, v93
    s_waitcnt lgkmcnt(4)
    v_mfma_f32_16x16x32_bf16 v[64:67], a[96:99], v[32:35], v[64:67]
    ds_read_b128 v[56:59], v17 offset:27648
    v_mfma_f32_16x16x32_bf16 v[68:71], a[100:103], v[32:35], v[68:71]
    v_add_f32 v86, v86, v90
    v_add_f32 v94, v114, v94
    v_mfma_f32_16x16x32_bf16 v[72:75], a[96:99], v[36:39], v[72:75]
    ds_read_b128 v[60:63], v18 offset:27648
    v_mfma_f32_16x16x32_bf16 v[76:79], a[100:103], v[36:39], v[76:79]
    v_add_f32 v87, v87, v91
    v_add_f32 v95, v115, v95
    s_waitcnt lgkmcnt(4)
    v_mfma_f32_16x16x32_bf16 v[64:67], a[104:107], v[40:43], v[64:67]
    ds_read_b128 v[32:35], v17 offset:32768
    v_mfma_f32_16x16x32_bf16 v[68:71], a[108:111], v[40:43], v[68:71]
    v_add_f32 v84, v92, v84
    v_add_f32 v85, v93, v85
    v_mfma_f32_16x16x32_bf16 v[72:75], a[104:107], v[44:47], v[72:75]
    ds_read_b128 v[36:39], v18 offset:32768
    v_mfma_f32_16x16x32_bf16 v[76:79], a[108:111], v[44:47], v[76:79]
    v_add_f32 v86, v94, v86
    v_add_f32 v87, v95, v87
    s_waitcnt lgkmcnt(4)
    v_mfma_f32_16x16x32_bf16 v[64:67], a[112:115], v[48:51], v[64:67]
    ds_read_b128 v[40:43], v17 offset:33792
    v_mfma_f32_16x16x32_bf16 v[68:71], a[116:119], v[48:51], v[68:71]
    v_sub_f32 v104, 1.0, v100
    v_cvt_pk_bf16_f32 v104, v104, v104
    v_mfma_f32_16x16x32_bf16 v[72:75], a[112:115], v[52:55], v[72:75]
    ds_read_b128 v[44:47], v18 offset:33792
    v_mfma_f32_16x16x32_bf16 v[76:79], a[116:119], v[52:55], v[76:79]
    v_lshlrev_b32 v104, 16, v104
    v_cvt_pk_bf16_f32 v105, v84, v85
    s_waitcnt lgkmcnt(4)
    v_mfma_f32_16x16x32_bf16 v[64:67], a[120:123], v[56:59], v[64:67]
    ds_read_b128 v[48:51], v17 offset:34816
    v_mfma_f32_16x16x32_bf16 v[68:71], a[124:127], v[56:59], v[68:71]
    v_lshlrev_b32 v107, 16, v96
    v_and_b32 v108, 0xffff0000, v96
    v_mfma_f32_16x16x32_bf16 v[72:75], a[120:123], v[60:63], v[72:75]
    ds_read_b128 v[52:55], v18 offset:34816
    v_mfma_f32_16x16x32_bf16 v[76:79], a[124:127], v[60:63], v[76:79]
    v_lshlrev_b32 v109, 16, v98
    v_and_b32 v110, 0xffff0000, v98
    s_waitcnt lgkmcnt(4)
    v_mfma_f32_16x16x32_bf16 v[64:67], a[128:131], v[32:35], v[64:67]
    ds_read_b128 v[56:59], v17 offset:35840
    v_mfma_f32_16x16x32_bf16 v[68:71], a[132:135], v[32:35], v[68:71]
    v_and_b32 v106, 0xffff0000, v105
    v_lshlrev_b32 v105, 16, v105
    v_mfma_f32_16x16x32_bf16 v[72:75], a[128:131], v[36:39], v[72:75]
    ds_read_b128 v[60:63], v18 offset:35840
    v_mfma_f32_16x16x32_bf16 v[76:79], a[132:135], v[36:39], v[76:79]
    v_mul_f32 v107, v107, v109
    v_mul_f32 v108, v108, v110
    s_waitcnt lgkmcnt(4)
    v_mfma_f32_16x16x32_bf16 v[64:67], a[136:139], v[40:43], v[64:67]
    ds_read_b128 v[32:35], v17 offset:40960
    v_mfma_f32_16x16x32_bf16 v[68:71], a[140:143], v[40:43], v[68:71]
    v_mul_f32 v105, v104, v105
    v_mul_f32 v106, v104, v106
    v_mfma_f32_16x16x32_bf16 v[72:75], a[136:139], v[44:47], v[72:75]
    ds_read_b128 v[36:39], v18 offset:40960
    v_mfma_f32_16x16x32_bf16 v[76:79], a[140:143], v[44:47], v[76:79]
    v_cvt_pk_bf16_f32 v107, v107, v108
    v_cvt_pk_bf16_f32 v105, v105, v106
    s_waitcnt lgkmcnt(4)
    v_mfma_f32_16x16x32_bf16 v[64:67], a[144:147], v[48:51], v[64:67]
    ds_read_b128 v[40:43], v17 offset:41984
    v_mfma_f32_16x16x32_bf16 v[68:71], a[148:151], v[48:51], v[68:71]
    v_and_b32 v108, 0xffff0000, v107
    v_lshlrev_b32 v107, 16, v107
    v_mfma_f32_16x16x32_bf16 v[72:75], a[144:147], v[52:55], v[72:75]
    ds_read_b128 v[44:47], v18 offset:41984
    v_mfma_f32_16x16x32_bf16 v[76:79], a[148:151], v[52:55], v[76:79]
    v_and_b32 v106, 0xffff0000, v105
    v_lshlrev_b32 v105, 16, v105
    s_waitcnt lgkmcnt(4)
    v_mfma_f32_16x16x32_bf16 v[64:67], a[152:155], v[56:59], v[64:67]
    ds_read_b128 v[48:51], v17 offset:43008
    v_mfma_f32_16x16x32_bf16 v[68:71], a[156:159], v[56:59], v[68:71]
    v_mul_f32 v107, v100, v107
    v_mul_f32 v108, v100, v108
    v_mfma_f32_16x16x32_bf16 v[72:75], a[152:155], v[60:63], v[72:75]
    ds_read_b128 v[52:55], v18 offset:43008
    v_mfma_f32_16x16x32_bf16 v[76:79], a[156:159], v[60:63], v[76:79]
    v_cvt_pk_bf16_f32 v107, v107, v108
    v_and_b32 v108, 0xffff0000, v107
    s_waitcnt lgkmcnt(4)
    v_mfma_f32_16x16x32_bf16 v[64:67], a[160:163], v[32:35], v[64:67]
    ds_read_b128 v[56:59], v17 offset:44032
    v_mfma_f32_16x16x32_bf16 v[68:71], a[164:167], v[32:35], v[68:71]
    v_lshlrev_b32 v107, 16, v107
    v_add_f32 v105, v105, v107
    v_mfma_f32_16x16x32_bf16 v[72:75], a[160:163], v[36:39], v[72:75]
    ds_read_b128 v[60:63], v18 offset:44032
    v_mfma_f32_16x16x32_bf16 v[76:79], a[164:167], v[36:39], v[76:79]
    v_add_f32 v106, v106, v108
    v_cvt_pk_bf16_f32 v102, v105, v106
    s_waitcnt lgkmcnt(4)
    v_mfma_f32_16x16x32_bf16 v[64:67], a[168:171], v[40:43], v[64:67]
    ds_read_b128 v[32:35], v17 offset:49152
    v_mfma_f32_16x16x32_bf16 v[68:71], a[172:175], v[40:43], v[68:71]
    v_cvt_pk_bf16_f32 v105, v86, v87
    v_lshlrev_b32 v107, 16, v97
    v_mfma_f32_16x16x32_bf16 v[72:75], a[168:171], v[44:47], v[72:75]
    ds_read_b128 v[36:39], v18 offset:49152
    v_mfma_f32_16x16x32_bf16 v[76:79], a[172:175], v[44:47], v[76:79]
    v_and_b32 v108, 0xffff0000, v97
    v_lshlrev_b32 v109, 16, v99
    s_waitcnt lgkmcnt(4)
    v_mfma_f32_16x16x32_bf16 v[64:67], a[176:179], v[48:51], v[64:67]
    ds_read_b128 v[40:43], v17 offset:50176
    v_mfma_f32_16x16x32_bf16 v[68:71], a[180:183], v[48:51], v[68:71]
    v_and_b32 v110, 0xffff0000, v99
    v_and_b32 v106, 0xffff0000, v105
    v_mfma_f32_16x16x32_bf16 v[72:75], a[176:179], v[52:55], v[72:75]
    ds_read_b128 v[44:47], v18 offset:50176
    v_mfma_f32_16x16x32_bf16 v[76:79], a[180:183], v[52:55], v[76:79]
    v_lshlrev_b32 v105, 16, v105
    v_mul_f32 v107, v107, v109
    s_waitcnt lgkmcnt(4)
    v_mfma_f32_16x16x32_bf16 v[64:67], a[184:187], v[56:59], v[64:67]
    ds_read_b128 v[48:51], v17 offset:51200
    v_mfma_f32_16x16x32_bf16 v[68:71], a[188:191], v[56:59], v[68:71]
    v_mul_f32 v108, v108, v110
    v_mul_f32 v105, v104, v105
    v_mfma_f32_16x16x32_bf16 v[72:75], a[184:187], v[60:63], v[72:75]
    ds_read_b128 v[52:55], v18 offset:51200
    v_mfma_f32_16x16x32_bf16 v[76:79], a[188:191], v[60:63], v[76:79]
    v_mul_f32 v106, v104, v106
    v_cvt_pk_bf16_f32 v107, v107, v108
    s_waitcnt lgkmcnt(4)
    v_mfma_f32_16x16x32_bf16 v[64:67], a[192:195], v[32:35], v[64:67]
    ds_read_b128 v[56:59], v17 offset:52224
    v_mfma_f32_16x16x32_bf16 v[68:71], a[196:199], v[32:35], v[68:71]
    v_cvt_pk_bf16_f32 v105, v105, v106
    v_and_b32 v108, 0xffff0000, v107
    v_mfma_f32_16x16x32_bf16 v[72:75], a[192:195], v[36:39], v[72:75]
    ds_read_b128 v[60:63], v18 offset:52224
    v_mfma_f32_16x16x32_bf16 v[76:79], a[196:199], v[36:39], v[76:79]
    v_lshlrev_b32 v107, 16, v107
    v_and_b32 v106, 0xffff0000, v105
    s_waitcnt lgkmcnt(4)
    v_mfma_f32_16x16x32_bf16 v[64:67], a[200:203], v[40:43], v[64:67]
    ds_read_b128 v[32:35], v17 offset:57344
    v_mfma_f32_16x16x32_bf16 v[68:71], a[204:207], v[40:43], v[68:71]
    v_lshlrev_b32 v105, 16, v105
    v_mul_f32 v107, v100, v107
    v_mfma_f32_16x16x32_bf16 v[72:75], a[200:203], v[44:47], v[72:75]
    ds_read_b128 v[36:39], v18 offset:57344
    v_mfma_f32_16x16x32_bf16 v[76:79], a[204:207], v[44:47], v[76:79]
    v_mul_f32 v108, v100, v108
    v_cvt_pk_bf16_f32 v107, v107, v108
    s_waitcnt lgkmcnt(4)
    v_mfma_f32_16x16x32_bf16 v[64:67], a[208:211], v[48:51], v[64:67]
    ds_read_b128 v[40:43], v17 offset:58368
    v_mfma_f32_16x16x32_bf16 v[68:71], a[212:215], v[48:51], v[68:71]
    v_and_b32 v108, 0xffff0000, v107
    v_lshlrev_b32 v107, 16, v107
    v_mfma_f32_16x16x32_bf16 v[72:75], a[208:211], v[52:55], v[72:75]
    ds_read_b128 v[44:47], v18 offset:58368
    v_mfma_f32_16x16x32_bf16 v[76:79], a[212:215], v[52:55], v[76:79]
    v_add_f32 v105, v105, v107
    v_add_f32 v106, v106, v108
    s_waitcnt lgkmcnt(4)
    v_mfma_f32_16x16x32_bf16 v[64:67], a[216:219], v[56:59], v[64:67]
    ds_read_b128 v[48:51], v17 offset:59392
    v_mfma_f32_16x16x32_bf16 v[68:71], a[220:223], v[56:59], v[68:71]
    v_cvt_pk_bf16_f32 v103, v105, v106
    s_mov_b64 exec, s[64:65]
    buffer_store_dwordx2 v[102:103], v22, s[44:47], s52 offen
    s_mov_b64 exec, -1
    v_mfma_f32_16x16x32_bf16 v[72:75], a[216:219], v[60:63], v[72:75]
    ds_read_b128 v[52:55], v18 offset:59392
    v_mfma_f32_16x16x32_bf16 v[76:79], a[220:223], v[60:63], v[76:79]
    s_add_u32 s51, s34, s55
    s_lshl_b32 s52, s54, 16
    s_lshl_b32 s60, s54, 7
    s_add_u32 s58, s60, 117440512
    s_add_u32 s59, s60, 117448704
    s_add_u32 s60, s60, 121634816

    s_cmp_eq_u32 s38, 0
    s_waitcnt lgkmcnt(4)
    v_mfma_f32_16x16x32_bf16 v[64:67], a[224:227], v[32:35], v[64:67]
    ds_read_b128 v[56:59], v17 offset:60416
    v_mfma_f32_16x16x32_bf16 v[68:71], a[228:231], v[32:35], v[68:71]
    s_cbranch_scc1 .cs_407
    buffer_load_dwordx2 v[96:97], v22, s[16:19], s52 offen
.cs_407:
    v_mfma_f32_16x16x32_bf16 v[72:75], a[224:227], v[36:39], v[72:75]
    ds_read_b128 v[60:63], v18 offset:60416
    v_mfma_f32_16x16x32_bf16 v[76:79], a[228:231], v[36:39], v[76:79]
    s_cbranch_scc1 .cs_408
    buffer_load_dword v98, v23, s[8:11], s58 offen
.cs_408:
    s_waitcnt lgkmcnt(4)
    v_mfma_f32_16x16x32_bf16 v[64:67], a[232:235], v[40:43], v[64:67]
    v_mfma_f32_16x16x32_bf16 v[68:71], a[236:239], v[40:43], v[68:71]
    s_cbranch_scc1 .cs_409
    buffer_load_dword v99, v23, s[8:11], s59 offen
.cs_409:
    v_mfma_f32_16x16x32_bf16 v[72:75], a[232:235], v[44:47], v[72:75]
    v_mfma_f32_16x16x32_bf16 v[76:79], a[236:239], v[44:47], v[76:79]
    s_cbranch_scc1 .cs_410
    buffer_load_dword v100, v16, s[8:11], s60 offen
.cs_410:
    s_waitcnt lgkmcnt(2)
    v_mfma_f32_16x16x32_bf16 v[64:67], a[240:243], v[48:51], v[64:67]
    v_mfma_f32_16x16x32_bf16 v[68:71], a[244:247], v[48:51], v[68:71]
    s_cbranch_scc1 .cs_411
    buffer_load_dwordx4 v[84:87], v7, s[8:11], s51 offen sc1
.cs_411:
    v_mfma_f32_16x16x32_bf16 v[72:75], a[240:243], v[52:55], v[72:75]
    v_mfma_f32_16x16x32_bf16 v[76:79], a[244:247], v[52:55], v[76:79]
    s_cbranch_scc1 .cs_412
    buffer_load_dwordx4 v[88:91], v8, s[8:11], s51 offen sc1
.cs_412:
    s_waitcnt lgkmcnt(0)
    v_mfma_f32_16x16x32_bf16 v[64:67], a[248:251], v[56:59], v[64:67]
    v_mfma_f32_16x16x32_bf16 v[68:71], a[252:255], v[56:59], v[68:71]
    s_cbranch_scc1 .cs_413
    buffer_load_dwordx4 v[92:95], v9, s[8:11], s51 offen sc1
.cs_413:
    v_mfma_f32_16x16x32_bf16 v[72:75], a[248:251], v[60:63], v[72:75]
    v_mfma_f32_16x16x32_bf16 v[76:79], a[252:255], v[60:63], v[76:79]
    v_xor_b32 v17, 0x10000, v17
    v_xor_b32 v18, 0x10000, v18
    s_cselect_b64 s[64:65], 0, -1
    s_add_u32 s4, s34, s37

    v_mov_b32 v112, v80
    v_mov_b32 v113, v81
    v_mov_b32 v114, v82
    v_mov_b32 v115, v83
.g2st_390:
    v_min_u32 v68, 0xfffffffe, v68
    buffer_store_dwordx4 v[68:71], v28, s[8:11], s4 offen sc1
    v_min_u32 v72, 0xfffffffe, v72
    buffer_store_dwordx4 v[72:75], v29, s[8:11], s4 offen sc1
    v_min_u32 v76, 0xfffffffe, v76
    buffer_store_dwordx4 v[76:79], v30, s[8:11], s4 offen sc1
    v_mov_b32 v80, v64
    v_mov_b32 v81, v65
    v_mov_b32 v82, v66
    v_mov_b32 v83, v67
    s_cmp_lg_u32 s56, 0
    s_cbranch_scc1 .g2pf_414
    s_cmp_eq_u32 s38, 0
    s_cbranch_scc1 .g2nc_391
    s_waitcnt vmcnt(0)
    s_mov_b32 s62, 0
.cc_415:
    v_max3_u32 v4, v84, v88, v92
    v_cmp_eq_u32 vcc, -1, v4
    s_cbranch_vccnz .cf_416
    v_add_f32 v84, v84, v88
    v_add_f32 v92, v112, v92
    v_add_f32 v85, v85, v89
    v_add_f32 v93, v113, v93
    v_add_f32 v86, v86, v90
    v_add_f32 v94, v114, v94
    v_add_f32 v87, v87, v91
    v_add_f32 v95, v115, v95
    v_add_f32 v84, v92, v84
    v_add_f32 v85, v93, v85
    v_add_f32 v86, v94, v86
    v_add_f32 v87, v95, v87
    v_sub_f32 v104, 1.0, v100
    v_cvt_pk_bf16_f32 v104, v104, v104
    v_lshlrev_b32 v104, 16, v104
    v_cvt_pk_bf16_f32 v105, v84, v85
    v_lshlrev_b32 v107, 16, v96
    v_and_b32 v108, 0xffff0000, v96
    v_lshlrev_b32 v109, 16, v98
    v_and_b32 v110, 0xffff0000, v98
    v_and_b32 v106, 0xffff0000, v105
    v_lshlrev_b32 v105, 16, v105
    v_mul_f32 v107, v107, v109
    v_mul_f32 v108, v108, v110
    v_mul_f32 v105, v104, v105
    v_mul_f32 v106, v104, v106
    v_cvt_pk_bf16_f32 v107, v107, v108
    v_cvt_pk_bf16_f32 v105, v105, v106
    v_and_b32 v108, 0xffff0000, v107
    v_lshlrev_b32 v107, 16, v107
    v_and_b32 v106, 0xffff0000, v105
    v_lshlrev_b32 v105, 16, v105
    v_mul_f32 v107, v100, v107
    v_mul_f32 v108, v100, v108
    v_cvt_pk_bf16_f32 v107, v107, v108
    v_and_b32 v108, 0xffff0000, v107
    v_lshlrev_b32 v107, 16, v107
    v_add_f32 v105, v105, v107
    v_add_f32 v106, v106, v108
    v_cvt_pk_bf16_f32 v102, v105, v106
    v_cvt_pk_bf16_f32 v105, v86, v87
    v_lshlrev_b32 v107, 16, v97
    v_and_b32 v108, 0xffff0000, v97
    v_lshlrev_b32 v109, 16, v99
    v_and_b32 v110, 0xffff0000, v99
    v_and_b32 v106, 0xffff0000, v105
    v_lshlrev_b32 v105, 16, v105
    v_mul_f32 v107, v107, v109
    v_mul_f32 v108, v108, v110
    v_mul_f32 v105, v104, v105
    v_mul_f32 v106, v104, v106
    v_cvt_pk_bf16_f32 v107, v107, v108
    v_cvt_pk_bf16_f32 v105, v105, v106
    v_and_b32 v108, 0xffff0000, v107
    v_lshlrev_b32 v107, 16, v107
    v_and_b32 v106, 0xffff0000, v105
    v_lshlrev_b32 v105, 16, v105
    v_mul_f32 v107, v100, v107
    v_mul_f32 v108, v100, v108
    v_cvt_pk_bf16_f32 v107, v107, v108
    v_and_b32 v108, 0xffff0000, v107
    v_lshlrev_b32 v107, 16, v107
    v_add_f32 v105, v105, v107
    v_add_f32 v106, v106, v108
    v_cvt_pk_bf16_f32 v103, v105, v106
    buffer_store_dwordx2 v[102:103], v22, s[44:47], s52 offen
.g2nc_391:
    s_add_u32 s51, s34, s37
    s_lshl_b32 s52, s31, 16
    s_lshl_b32 s60, s31, 7
    s_add_u32 s58, s60, 117440512
    s_add_u32 s59, s60, 117448704
    s_add_u32 s60, s60, 121634816

    buffer_load_dwordx2 v[96:97], v22, s[16:19], s52 offen
    buffer_load_dword v98, v23, s[8:11], s58 offen
    buffer_load_dword v99, v23, s[8:11], s59 offen
    buffer_load_dword v100, v16, s[8:11], s60 offen
    buffer_load_dwordx4 v[84:87], v7, s[8:11], s51 offen sc1
    buffer_load_dwordx4 v[88:91], v8, s[8:11], s51 offen sc1
    buffer_load_dwordx4 v[92:95], v9, s[8:11], s51 offen sc1
    s_waitcnt vmcnt(0)
    s_mov_b32 s62, 0
.cc_417:
    v_max3_u32 v4, v84, v88, v92
    v_cmp_eq_u32 vcc, -1, v4
    s_cbranch_vccnz .cf_418
    v_add_f32 v84, v84, v88
    v_add_f32 v92, v80, v92
    v_add_f32 v85, v85, v89
    v_add_f32 v93, v81, v93
    v_add_f32 v86, v86, v90
    v_add_f32 v94, v82, v94
    v_add_f32 v87, v87, v91
    v_add_f32 v95, v83, v95
    v_add_f32 v84, v92, v84
    v_add_f32 v85, v93, v85
    v_add_f32 v86, v94, v86
    v_add_f32 v87, v95, v87
    v_sub_f32 v104, 1.0, v100
    v_cvt_pk_bf16_f32 v104, v104, v104
    v_lshlrev_b32 v104, 16, v104
    v_cvt_pk_bf16_f32 v105, v84, v85
    v_lshlrev_b32 v107, 16, v96
    v_and_b32 v108, 0xffff0000, v96
    v_lshlrev_b32 v109, 16, v98
    v_and_b32 v110, 0xffff0000, v98
    v_and_b32 v106, 0xffff0000, v105
    v_lshlrev_b32 v105, 16, v105
    v_mul_f32 v107, v107, v109
    v_mul_f32 v108, v108, v110
    v_mul_f32 v105, v104, v105
    v_mul_f32 v106, v104, v106
    v_cvt_pk_bf16_f32 v107, v107, v108
    v_cvt_pk_bf16_f32 v105, v105, v106
    v_and_b32 v108, 0xffff0000, v107
    v_lshlrev_b32 v107, 16, v107
    v_and_b32 v106, 0xffff0000, v105
    v_lshlrev_b32 v105, 16, v105
    v_mul_f32 v107, v100, v107
    v_mul_f32 v108, v100, v108
    v_cvt_pk_bf16_f32 v107, v107, v108
    v_and_b32 v108, 0xffff0000, v107
    v_lshlrev_b32 v107, 16, v107
    v_add_f32 v105, v105, v107
    v_add_f32 v106, v106, v108
    v_cvt_pk_bf16_f32 v102, v105, v106
    v_cvt_pk_bf16_f32 v105, v86, v87
    v_lshlrev_b32 v107, 16, v97
    v_and_b32 v108, 0xffff0000, v97
    v_lshlrev_b32 v109, 16, v99
    v_and_b32 v110, 0xffff0000, v99
    v_and_b32 v106, 0xffff0000, v105
    v_lshlrev_b32 v105, 16, v105
    v_mul_f32 v107, v107, v109
    v_mul_f32 v108, v108, v110
    v_mul_f32 v105, v104, v105
    v_mul_f32 v106, v104, v106
    v_cvt_pk_bf16_f32 v107, v107, v108
    v_cvt_pk_bf16_f32 v105, v105, v106
    v_and_b32 v108, 0xffff0000, v107
    v_lshlrev_b32 v107, 16, v107
    v_and_b32 v106, 0xffff0000, v105
    v_lshlrev_b32 v105, 16, v105
    v_mul_f32 v107, v100, v107
    v_mul_f32 v108, v100, v108
    v_cvt_pk_bf16_f32 v107, v107, v108
    v_and_b32 v108, 0xffff0000, v107
    v_lshlrev_b32 v107, 16, v107
    v_add_f32 v105, v105, v107
    v_add_f32 v106, v106, v108
    v_cvt_pk_bf16_f32 v103, v105, v106
    buffer_store_dwordx2 v[102:103], v22, s[44:47], s52 offen
    s_mov_b32 s31, s53
    s_add_u32 s37, s37, 0x10000
    s_cmp_lt_u32 s31, 64
    s_cbranch_scc1 .g2blk_385
    s_branch .g2fin_392

.g2pf_414:
    s_mov_b32 s31, s53
    s_add_u32 s37, s37, 0x10000
    s_cmp_eq_u32 s38, 0
    s_mov_b32 s38, 1
    s_cbranch_scc1 .g2w3_387
    s_waitcnt vmcnt(10)
    s_branch .g2go_386

.g2w3_387:
    s_waitcnt vmcnt(3)
    s_branch .g2go_386
.cf_397:
    buffer_load_dwordx4 v[84:87], v7, s[8:11], s51 offen sc1
    buffer_load_dwordx4 v[88:91], v8, s[8:11], s51 offen sc1
    buffer_load_dwordx4 v[92:95], v9, s[8:11], s51 offen sc1
    s_add_u32 s62, s62, 1
    s_cmp_gt_u32 s62, 0x400000
    s_cbranch_scc1 .mg_end_1
    s_waitcnt vmcnt(0)
    s_branch .cc_396

.cf_406:
    buffer_load_dwordx4 v[84:87], v7, s[8:11], s51 offen sc1
    buffer_load_dwordx4 v[88:91], v8, s[8:11], s51 offen sc1
    buffer_load_dwordx4 v[92:95], v9, s[8:11], s51 offen sc1
    s_add_u32 s62, s62, 1
    s_cmp_gt_u32 s62, 0x400000
    s_cbranch_scc1 .mg_end_1
    s_waitcnt vmcnt(0)
    s_branch .cc_405

.cf_416:
    buffer_load_dwordx4 v[84:87], v7, s[8:11], s51 offen sc1
    buffer_load_dwordx4 v[88:91], v8, s[8:11], s51 offen sc1
    buffer_load_dwordx4 v[92:95], v9, s[8:11], s51 offen sc1
    s_add_u32 s62, s62, 1
    s_cmp_gt_u32 s62, 0x400000
    s_cbranch_scc1 .mg_end_1
    s_waitcnt vmcnt(0)
    s_branch .cc_415

.cf_418:
    buffer_load_dwordx4 v[84:87], v7, s[8:11], s51 offen sc1
    buffer_load_dwordx4 v[88:91], v8, s[8:11], s51 offen sc1
    buffer_load_dwordx4 v[92:95], v9, s[8:11], s51 offen sc1
    s_add_u32 s62, s62, 1
    s_cmp_gt_u32 s62, 0x400000
    s_cbranch_scc1 .mg_end_1
    s_waitcnt vmcnt(0)
    s_branch .cc_417

.g2fin_392:
    s_endpgm
.cvrole_368:
    s_lshl_b32 s4, s91, 3
    s_add_u32 s4, s4, s26
    s_add_u32 s4, s4, 72
    s_lshl_b32 s4, s4, 8
    s_add_u32 s92, s4, 92274688
    s_lshl_b32 s4, s24, 2
    s_add_u32 s92, s92, s4
    v_mov_b32 v4, 0
    s_mov_b64 exec, 1
    buffer_store_dword v4, v4, s[8:11], s92 offen sc1
    s_mov_b64 exec, -1

    s_waitcnt vmcnt(0)
    s_barrier
    v_mov_b32 v243, 1
    v_mov_b32 v242, 0
    s_cmp_lg_u32 s24, 1
    s_cbranch_scc1 .a1_419
    s_mov_b64 exec, 1
    s_cmp_lg_u32 s27, 0
    s_cbranch_scc1 .a1s_420
    s_lshl_b32 s4, s25, 2
    buffer_atomic_add v243, v242, s[20:23], s4 offen offset:32 sc0 sc1
    s_branch .a1_419

.a1s_420:
    buffer_atomic_add v243, v242, s[20:23], s97 offen sc1
.a1_419:
    s_mov_b64 exec, -1
    s_waitcnt vmcnt(0)
    v_readfirstlane_b32 s4, v243
    s_lshl_b32 s5, s24, 8
    s_add_u32 s4, s4, s5
    s_cmp_lg_u32 s4, 287
    s_cbranch_scc1 .a2_421
    s_mov_b64 exec, 1
    v_mov_b32 v243, 32
    buffer_atomic_add v243, v242, s[20:23], s97 offen sc1
    s_mov_b64 exec, -1

.a2_421:
    s_cmp_lg_u32 s24, 0
    s_cbranch_scc1 .pm_422
    s_lshl_b32 s93, s91, 3
    s_add_u32 s93, s93, s26
    s_sub_u32 s93, s93, 24
    s_and_b32 s94, s93, 1
    s_sub_u32 s5, 0, s100
    s_and_b32 s5, s5, 0x1fffff
    s_add_u32 s5, s5, 100663296
    s_lshl_b32 s4, s94, 21
    s_add_u32 s5, s5, s4
    s_lshl_b32 s4, s93, 8
    s_add_u32 s5, s5, s4
    s_add_u32 s6, s5, 8192
    v_and_b32 v4, 63, v0
    v_lshlrev_b32 v4, 2, v4
    v_mov_b32 v5, -1
    s_mov_b32 s82, 0x7fffffff
    s_mov_b32 s83, 0x7fffffff
    buffer_store_dword v5, v4, s[8:11], s5 offen sc1
    s_waitcnt vmcnt(0)

    s_memtime s[72:73]
    s_waitcnt lgkmcnt(0)
    buffer_store_dword v5, v4, s[8:11], s6 offen sc1
    s_waitcnt vmcnt(0)
    s_memtime s[84:85]
    s_waitcnt lgkmcnt(0)
    s_sub_u32 s84, s84, s72
    s_min_u32 s83, s83, s84

    s_memtime s[72:73]
    s_waitcnt lgkmcnt(0)
    buffer_store_dword v5, v4, s[8:11], s5 offen sc1
    s_waitcnt vmcnt(0)
    s_memtime s[84:85]
    s_waitcnt lgkmcnt(0)
    s_sub_u32 s84, s84, s72
    s_min_u32 s82, s82, s84

    s_memtime s[72:73]
    s_waitcnt lgkmcnt(0)
    buffer_store_dword v5, v4, s[8:11], s6 offen sc1
    s_waitcnt vmcnt(0)
    s_memtime s[84:85]
    s_waitcnt lgkmcnt(0)
    s_sub_u32 s84, s84, s72
    s_min_u32 s83, s83, s84

    s_memtime s[72:73]
    s_waitcnt lgkmcnt(0)
    buffer_store_dword v5, v4, s[8:11], s5 offen sc1
    s_waitcnt vmcnt(0)
    s_memtime s[84:85]
    s_waitcnt lgkmcnt(0)
    s_sub_u32 s84, s84, s72
    s_min_u32 s82, s82, s84

    s_cmp_lt_u32 s82, s83
    s_cselect_b32 s4, 1, 0
    s_mul_i32 s94, s94, 6
    s_lshl_b32 s4, s4, s94
    s_add_u32 s95, s4, 0x1000000

.pm_422:
    s_cmp_lg_u32 s24, 0
    s_cbranch_scc1 .pv_423
    s_mov_b64 exec, 1
    v_mov_b32 v4, s95
    v_mov_b32 v5, 4
    buffer_atomic_add v4, v5, s[20:23], s97 offen sc1
    s_mov_b64 exec, -1

.pv_423:
    s_barrier
    s_lshl_b32 s93, s91, 3
    s_add_u32 s93, s93, s26
    s_sub_u32 s93, s93, 24

    s_load_dwordx2 s[40:41], s[0:1], 0
    s_load_dwordx2 s[42:43], s[0:1], 104

    v_and_b32 v1, 63, v0
    v_and_b32 v2, 15, v1
    v_lshrrev_b32 v3, 4, v1

    s_waitcnt lgkmcnt(0)
    s_mov_b32 s12, s40
    s_and_b32 s13, s41, 0xffff
    s_mov_b32 s14, 0x400000
    s_mov_b32 s15, 0x00020000

    s_mov_b32 s16, s42
    s_and_b32 s17, s43, 0xffff
    s_mov_b32 s18, 0x800
    s_mov_b32 s19, 0x00020000

    s_lshl_b32 s3, s93, 6
    s_lshl_b32 s4, s24, 4
    s_add_u32 s3, s3, s4
    v_lshlrev_b32 v8, 4, v1
    buffer_load_dwordx4 v[16:19], v8, s[16:19], 0 offen
    buffer_load_dwordx4 v[20:23], v8, s[16:19], 0 offen offset:1024
    s_lshl_b32 s5, s3, 11

    buffer_load_dwordx4 v[64:67], v8, s[12:15], s5 offen
    buffer_load_dwordx4 v[68:71], v8, s[12:15], s5 offen offset:1024
    s_add_u32 s5, s5, 2048

    buffer_load_dwordx4 v[72:75], v8, s[12:15], s5 offen
    buffer_load_dwordx4 v[76:79], v8, s[12:15], s5 offen offset:1024
    s_add_u32 s5, s5, 2048

    buffer_load_dwordx4 v[80:83], v8, s[12:15], s5 offen
    buffer_load_dwordx4 v[84:87], v8, s[12:15], s5 offen offset:1024
    s_add_u32 s5, s5, 2048

    buffer_load_dwordx4 v[88:91], v8, s[12:15], s5 offen
    buffer_load_dwordx4 v[92:95], v8, s[12:15], s5 offen offset:1024
    s_add_u32 s5, s5, 2048

    buffer_load_dwordx4 v[96:99], v8, s[12:15], s5 offen
    buffer_load_dwordx4 v[100:103], v8, s[12:15], s5 offen offset:1024
    s_add_u32 s5, s5, 2048

    buffer_load_dwordx4 v[104:107], v8, s[12:15], s5 offen
    buffer_load_dwordx4 v[108:111], v8, s[12:15], s5 offen offset:1024
    s_add_u32 s5, s5, 2048

    buffer_load_dwordx4 v[112:115], v8, s[12:15], s5 offen
    buffer_load_dwordx4 v[116:119], v8, s[12:15], s5 offen offset:1024
    s_add_u32 s5, s5, 2048

    buffer_load_dwordx4 v[120:123], v8, s[12:15], s5 offen
    buffer_load_dwordx4 v[124:127], v8, s[12:15], s5 offen offset:1024
    s_add_u32 s5, s5, 2048

    buffer_load_dwordx4 v[128:131], v8, s[12:15], s5 offen
    buffer_load_dwordx4 v[132:135], v8, s[12:15], s5 offen offset:1024
    s_add_u32 s5, s5, 2048

    buffer_load_dwordx4 v[136:139], v8, s[12:15], s5 offen
    buffer_load_dwordx4 v[140:143], v8, s[12:15], s5 offen offset:1024
    s_add_u32 s5, s5, 2048

    buffer_load_dwordx4 v[144:147], v8, s[12:15], s5 offen
    buffer_load_dwordx4 v[148:151], v8, s[12:15], s5 offen offset:1024
    s_add_u32 s5, s5, 2048

    buffer_load_dwordx4 v[152:155], v8, s[12:15], s5 offen
    buffer_load_dwordx4 v[156:159], v8, s[12:15], s5 offen offset:1024
    s_add_u32 s5, s5, 2048

    buffer_load_dwordx4 v[160:163], v8, s[12:15], s5 offen
    buffer_load_dwordx4 v[164:167], v8, s[12:15], s5 offen offset:1024
    s_add_u32 s5, s5, 2048

    buffer_load_dwordx4 v[168:171], v8, s[12:15], s5 offen
    buffer_load_dwordx4 v[172:175], v8, s[12:15], s5 offen offset:1024
    s_add_u32 s5, s5, 2048

    buffer_load_dwordx4 v[176:179], v8, s[12:15], s5 offen
    buffer_load_dwordx4 v[180:183], v8, s[12:15], s5 offen offset:1024
    s_add_u32 s5, s5, 2048

    buffer_load_dwordx4 v[184:187], v8, s[12:15], s5 offen
    buffer_load_dwordx4 v[188:191], v8, s[12:15], s5 offen offset:1024
    s_add_u32 s5, s5, 2048

    v_and_b32 v241, 3, v0
    v_lshlrev_b32 v241, 2, v241
    buffer_load_dword v240, v241, s[20:23], s97 offen sc1

    s_waitcnt vmcnt(29)
    v_dot2_f32_bf16 v24, v64, v16, 0
    v_dot2_f32_bf16 v25, v72, v16, 0
    v_dot2_f32_bf16 v24, v65, v17, v24
    v_dot2_f32_bf16 v25, v73, v17, v25
    v_dot2_f32_bf16 v24, v66, v18, v24
    v_dot2_f32_bf16 v25, v74, v18, v25
    v_dot2_f32_bf16 v24, v67, v19, v24
    v_dot2_f32_bf16 v25, v75, v19, v25
    v_dot2_f32_bf16 v24, v68, v20, v24
    v_dot2_f32_bf16 v25, v76, v20, v25
    v_dot2_f32_bf16 v24, v69, v21, v24
    v_dot2_f32_bf16 v25, v77, v21, v25
    v_dot2_f32_bf16 v24, v70, v22, v24
    v_dot2_f32_bf16 v25, v78, v22, v25
    v_dot2_f32_bf16 v24, v71, v23, v24
    v_dot2_f32_bf16 v25, v79, v23, v25
    s_waitcnt vmcnt(25)
    v_dot2_f32_bf16 v26, v80, v16, 0
    v_dot2_f32_bf16 v27, v88, v16, 0
    v_dot2_f32_bf16 v26, v81, v17, v26
    v_dot2_f32_bf16 v27, v89, v17, v27
    v_dot2_f32_bf16 v26, v82, v18, v26
    v_dot2_f32_bf16 v27, v90, v18, v27
    v_dot2_f32_bf16 v26, v83, v19, v26
    v_dot2_f32_bf16 v27, v91, v19, v27
    v_dot2_f32_bf16 v26, v84, v20, v26
    v_dot2_f32_bf16 v27, v92, v20, v27
    v_dot2_f32_bf16 v26, v85, v21, v26
    v_dot2_f32_bf16 v27, v93, v21, v27
    v_dot2_f32_bf16 v26, v86, v22, v26
    v_dot2_f32_bf16 v27, v94, v22, v27
    v_dot2_f32_bf16 v26, v87, v23, v26
    v_dot2_f32_bf16 v27, v95, v23, v27
    s_waitcnt vmcnt(21)
    v_dot2_f32_bf16 v28, v96, v16, 0
    v_dot2_f32_bf16 v29, v104, v16, 0
    v_dot2_f32_bf16 v28, v97, v17, v28
    v_dot2_f32_bf16 v29, v105, v17, v29
    v_dot2_f32_bf16 v28, v98, v18, v28
    v_dot2_f32_bf16 v29, v106, v18, v29
    v_dot2_f32_bf16 v28, v99, v19, v28
    v_dot2_f32_bf16 v29, v107, v19, v29
    v_dot2_f32_bf16 v28, v100, v20, v28
    v_dot2_f32_bf16 v29, v108, v20, v29
    v_dot2_f32_bf16 v28, v101, v21, v28
    v_dot2_f32_bf16 v29, v109, v21, v29
    v_dot2_f32_bf16 v28, v102, v22, v28
    v_dot2_f32_bf16 v29, v110, v22, v29
    v_dot2_f32_bf16 v28, v103, v23, v28
    v_dot2_f32_bf16 v29, v111, v23, v29
    s_waitcnt vmcnt(17)
    v_dot2_f32_bf16 v30, v112, v16, 0
    v_dot2_f32_bf16 v31, v120, v16, 0
    v_dot2_f32_bf16 v30, v113, v17, v30
    v_dot2_f32_bf16 v31, v121, v17, v31
    v_dot2_f32_bf16 v30, v114, v18, v30
    v_dot2_f32_bf16 v31, v122, v18, v31
    v_dot2_f32_bf16 v30, v115, v19, v30
    v_dot2_f32_bf16 v31, v123, v19, v31
    v_dot2_f32_bf16 v30, v116, v20, v30
    v_dot2_f32_bf16 v31, v124, v20, v31
    v_dot2_f32_bf16 v30, v117, v21, v30
    v_dot2_f32_bf16 v31, v125, v21, v31
    v_dot2_f32_bf16 v30, v118, v22, v30
    v_dot2_f32_bf16 v31, v126, v22, v31
    v_dot2_f32_bf16 v30, v119, v23, v30
    v_dot2_f32_bf16 v31, v127, v23, v31
    s_waitcnt vmcnt(13)
    v_dot2_f32_bf16 v32, v128, v16, 0
    v_dot2_f32_bf16 v33, v136, v16, 0
    v_dot2_f32_bf16 v32, v129, v17, v32
    v_dot2_f32_bf16 v33, v137, v17, v33
    v_dot2_f32_bf16 v32, v130, v18, v32
    v_dot2_f32_bf16 v33, v138, v18, v33
    v_dot2_f32_bf16 v32, v131, v19, v32
    v_dot2_f32_bf16 v33, v139, v19, v33
    v_dot2_f32_bf16 v32, v132, v20, v32
    v_dot2_f32_bf16 v33, v140, v20, v33
    v_dot2_f32_bf16 v32, v133, v21, v32
    v_dot2_f32_bf16 v33, v141, v21, v33
    v_dot2_f32_bf16 v32, v134, v22, v32
    v_dot2_f32_bf16 v33, v142, v22, v33
    v_dot2_f32_bf16 v32, v135, v23, v32
    v_dot2_f32_bf16 v33, v143, v23, v33
    s_waitcnt vmcnt(9)
    v_dot2_f32_bf16 v34, v144, v16, 0
    v_dot2_f32_bf16 v35, v152, v16, 0
    v_dot2_f32_bf16 v34, v145, v17, v34
    v_dot2_f32_bf16 v35, v153, v17, v35
    v_dot2_f32_bf16 v34, v146, v18, v34
    v_dot2_f32_bf16 v35, v154, v18, v35
    v_dot2_f32_bf16 v34, v147, v19, v34
    v_dot2_f32_bf16 v35, v155, v19, v35
    v_dot2_f32_bf16 v34, v148, v20, v34
    v_dot2_f32_bf16 v35, v156, v20, v35
    v_dot2_f32_bf16 v34, v149, v21, v34
    v_dot2_f32_bf16 v35, v157, v21, v35
    v_dot2_f32_bf16 v34, v150, v22, v34
    v_dot2_f32_bf16 v35, v158, v22, v35
    v_dot2_f32_bf16 v34, v151, v23, v34
    v_dot2_f32_bf16 v35, v159, v23, v35
    s_waitcnt vmcnt(5)
    v_dot2_f32_bf16 v36, v160, v16, 0
    v_dot2_f32_bf16 v37, v168, v16, 0
    v_dot2_f32_bf16 v36, v161, v17, v36
    v_dot2_f32_bf16 v37, v169, v17, v37
    v_dot2_f32_bf16 v36, v162, v18, v36
    v_dot2_f32_bf16 v37, v170, v18, v37
    v_dot2_f32_bf16 v36, v163, v19, v36
    v_dot2_f32_bf16 v37, v171, v19, v37
    v_dot2_f32_bf16 v36, v164, v20, v36
    v_dot2_f32_bf16 v37, v172, v20, v37
    v_dot2_f32_bf16 v36, v165, v21, v36
    v_dot2_f32_bf16 v37, v173, v21, v37
    v_dot2_f32_bf16 v36, v166, v22, v36
    v_dot2_f32_bf16 v37, v174, v22, v37
    v_dot2_f32_bf16 v36, v167, v23, v36
    v_dot2_f32_bf16 v37, v175, v23, v37
    s_waitcnt vmcnt(1)
    v_dot2_f32_bf16 v38, v176, v16, 0
    v_dot2_f32_bf16 v39, v184, v16, 0
    v_dot2_f32_bf16 v38, v177, v17, v38
    v_dot2_f32_bf16 v39, v185, v17, v39
    v_dot2_f32_bf16 v38, v178, v18, v38
    v_dot2_f32_bf16 v39, v186, v18, v39
    v_dot2_f32_bf16 v38, v179, v19, v38
    v_dot2_f32_bf16 v39, v187, v19, v39
    v_dot2_f32_bf16 v38, v180, v20, v38
    v_dot2_f32_bf16 v39, v188, v20, v39
    v_dot2_f32_bf16 v38, v181, v21, v38
    v_dot2_f32_bf16 v39, v189, v21, v39
    v_dot2_f32_bf16 v38, v182, v22, v38
    v_dot2_f32_bf16 v39, v190, v22, v39
    v_dot2_f32_bf16 v38, v183, v23, v38
    v_dot2_f32_bf16 v39, v191, v23, v39
    s_waitcnt vmcnt(0)
    s_mov_b32 s62, 0
.vp_424:
    v_readlane_b32 s4, v240, 0
    v_readlane_b32 s7, v240, 1
    v_readlane_b32 s6, v240, 2

    s_cmp_ge_u32 s4, 256
    s_cbranch_scc1 .vd_425
    s_cmp_lg_u32 s6, 0
    s_cbranch_scc1 .vs_426
    s_add_u32 s62, s62, 1
    s_cmp_gt_u32 s62, 0x100000
    s_cbranch_scc1 .mg_end_1
    s_sleep 8
    buffer_load_dword v240, v241, s[20:23], s97 offen sc1
    s_waitcnt vmcnt(0)
    s_branch .vp_424

.vs_426:
    s_lshr_b32 s25, s2, 5
    s_and_b32 s26, s2, 31
    s_mov_b32 s27, 1
    s_mov_b32 s97, 144
    s_waitcnt vmcnt(0) lgkmcnt(0)
    s_barrier
    s_branch .mg_role_3

.vd_425:
    v_permlane32_swap_b32 v24, v26
    v_permlane32_swap_b32 v25, v27
    v_permlane32_swap_b32 v28, v30
    v_permlane32_swap_b32 v29, v31
    v_permlane32_swap_b32 v32, v34
    v_permlane32_swap_b32 v33, v35
    v_permlane32_swap_b32 v36, v38
    v_permlane32_swap_b32 v37, v39
    v_add_f32 v24, v24, v26
    v_add_f32 v25, v25, v27
    v_add_f32 v28, v28, v30
    v_add_f32 v29, v29, v31
    v_add_f32 v32, v32, v34
    v_add_f32 v33, v33, v35
    v_add_f32 v36, v36, v38
    v_add_f32 v37, v37, v39
    s_nop 0
    v_permlane16_swap_b32 v24, v25
    v_permlane16_swap_b32 v28, v29
    v_permlane16_swap_b32 v32, v33
    v_permlane16_swap_b32 v36, v37
    v_add_f32 v24, v24, v25
    v_add_f32 v28, v28, v29
    v_add_f32 v32, v32, v33
    v_add_f32 v36, v36, v37
    v_add_f32_dpp v24, v24, v24 row_ror:8 row_mask:0xf bank_mask:0xf
    v_add_f32_dpp v28, v28, v28 row_ror:8 row_mask:0xf bank_mask:0xf
    v_add_f32_dpp v32, v32, v32 row_ror:8 row_mask:0xf bank_mask:0xf
    v_add_f32_dpp v36, v36, v36 row_ror:8 row_mask:0xf bank_mask:0xf
    v_add_f32_dpp v24, v24, v24 row_ror:4 row_mask:0xf bank_mask:0xf
    v_add_f32_dpp v28, v28, v28 row_ror:4 row_mask:0xf bank_mask:0xf
    v_add_f32_dpp v32, v32, v32 row_ror:4 row_mask:0xf bank_mask:0xf
    v_add_f32_dpp v36, v36, v36 row_ror:4 row_mask:0xf bank_mask:0xf
    v_add_f32_dpp v24, v24, v24 row_ror:2 row_mask:0xf bank_mask:0xf
    v_add_f32_dpp v28, v28, v28 row_ror:2 row_mask:0xf bank_mask:0xf
    v_add_f32_dpp v32, v32, v32 row_ror:2 row_mask:0xf bank_mask:0xf
    v_add_f32_dpp v36, v36, v36 row_ror:2 row_mask:0xf bank_mask:0xf
    v_add_f32_dpp v24, v24, v24 row_ror:1 row_mask:0xf bank_mask:0xf
    v_add_f32_dpp v28, v28, v28 row_ror:1 row_mask:0xf bank_mask:0xf
    v_add_f32_dpp v32, v32, v32 row_ror:1 row_mask:0xf bank_mask:0xf
    v_add_f32_dpp v36, v36, v36 row_ror:1 row_mask:0xf bank_mask:0xf
    v_cmp_eq_u32 vcc, 1, v2
    s_nop 1
    v_cndmask_b32 v24, v24, v28, vcc
    v_cmp_eq_u32 vcc, 2, v2
    s_nop 1
    v_cndmask_b32 v24, v24, v32, vcc
    v_cmp_eq_u32 vcc, 3, v2
    s_nop 1
    v_cndmask_b32 v24, v24, v36, vcc
    v_cvt_pk_bf16_f32 v24, v24, v24
    s_mov_b32 s38, 0xbfb8aa3b
    v_lshlrev_b32 v24, 16, v24
    v_mul_f32 v24, s38, v24
    v_exp_f32 v24, v24
    v_lshlrev_b32 v8, 4, v2
    v_add_f32 v24, 1.0, v24
    v_rcp_f32 v24, v24
    v_lshl_add_u32 v8, v3, 2, v8
    v_cvt_pk_bf16_f32 v24, v24, v24
    v_cmp_gt_u32 vcc, 4, v2
    s_lshl_b32 s5, s3, 2
    s_add_u32 s5, s5, 121634816
    v_lshlrev_b32 v24, 16, v24
    s_mov_b64 exec, vcc
    buffer_store_dword v24, v8, s[8:11], s5 offen sc1
    s_mov_b64 exec, -1

    s_load_dwordx4 s[52:55], s[0:1], 8
    s_load_dwordx2 s[56:57], s[0:1], 24

    v_and_b32 v1, 63, v0
    v_and_b32 v2, 15, v1
    v_lshrrev_b32 v3, 4, v1

    v_lshrrev_b32 v4, 2, v1
    v_and_b32 v5, 3, v1
    v_lshlrev_b32 v10, 11, v4
    v_lshl_add_u32 v10, v5, 4, v10
    s_lshl_b32 s4, s93, 6
    v_add_u32 v10, s4, v10
    s_lshl_b32 s70, s24, 20
    s_mul_i32 s71, s24, 33280
    v_lshrrev_b32 v4, 2, v2
    v_lshl_add_u32 v4, v3, 5, v4
    v_lshlrev_b32 v4, 6, v4
    v_lshl_add_u32 v11, v5, 3, v4
    v_add_u32 v11, s71, v11
    s_lshl_b32 s4, s93, 17
    s_lshl_b32 s5, s24, 8
    s_add_u32 s72, s4, s5
    s_add_u32 s72, s72, 125829120
    v_lshlrev_b32 v12, 12, v2
    v_lshl_add_u32 v12, v3, 4, v12
    v_lshlrev_b32 v13, 3, v2
    s_lshl_b32 s6, s93, 8
    s_waitcnt lgkmcnt(0)

    s_mov_b32 s80, s52
    s_and_b32 s81, s53, 0xffff
    s_mov_b32 s82, 0x400000
    s_mov_b32 s83, 0x00020000

    s_mov_b32 s84, s54
    s_and_b32 s85, s55, 0xffff
    s_mov_b32 s86, 0x400000
    s_mov_b32 s87, 0x00020000

    s_mov_b32 s76, s56
    s_and_b32 s77, s57, 0xffff
    s_mov_b32 s78, 0x2000
    s_mov_b32 s79, 0x00020000

    buffer_load_dwordx2 v[196:197], v13, s[76:79], s6 offen
    buffer_load_dwordx2 v[198:199], v13, s[76:79], s6 offen offset:128

    s_add_u32 s4, s70, 0
    s_add_u32 m0, s71, 0
    s_sub_u32 s5, s4, 8192
    s_max_i32 s5, s5, 0
    s_mov_b64 exec, 0xffff
    buffer_load_dwordx4 v10, s[80:83], s5 offen lds
    s_mov_b64 exec, -1

    s_add_u32 m0, s71, 256
    s_nop 0
    buffer_load_dwordx4 v10, s[80:83], s4 offen lds
    s_add_u32 m0, s71, 8448
    s_nop 0
    buffer_load_dwordx4 v10, s[84:87], s4 offen lds
    s_add_u32 m0, s71, 1280
    s_add_u32 s4, s4, 32768
    buffer_load_dwordx4 v10, s[80:83], s4 offen lds
    s_add_u32 m0, s71, 9472
    s_nop 0
    buffer_load_dwordx4 v10, s[84:87], s4 offen lds
    s_add_u32 m0, s71, 2304
    s_add_u32 s4, s4, 32768
    buffer_load_dwordx4 v10, s[80:83], s4 offen lds
    s_add_u32 m0, s71, 10496
    s_nop 0
    buffer_load_dwordx4 v10, s[84:87], s4 offen lds
    s_add_u32 m0, s71, 3328
    s_add_u32 s4, s4, 32768
    buffer_load_dwordx4 v10, s[80:83], s4 offen lds
    s_add_u32 m0, s71, 11520
    s_nop 0
    buffer_load_dwordx4 v10, s[84:87], s4 offen lds
    s_add_u32 m0, s71, 4352
    s_add_u32 s4, s4, 32768
    buffer_load_dwordx4 v10, s[80:83], s4 offen lds
    s_add_u32 m0, s71, 12544
    s_nop 0
    buffer_load_dwordx4 v10, s[84:87], s4 offen lds
    s_add_u32 m0, s71, 5376
    s_add_u32 s4, s4, 32768
    buffer_load_dwordx4 v10, s[80:83], s4 offen lds
    s_add_u32 m0, s71, 13568
    s_nop 0
    buffer_load_dwordx4 v10, s[84:87], s4 offen lds
    s_add_u32 m0, s71, 6400
    s_add_u32 s4, s4, 32768
    buffer_load_dwordx4 v10, s[80:83], s4 offen lds
    s_add_u32 m0, s71, 14592
    s_nop 0
    buffer_load_dwordx4 v10, s[84:87], s4 offen lds
    s_add_u32 m0, s71, 7424
    s_add_u32 s4, s4, 32768
    buffer_load_dwordx4 v10, s[80:83], s4 offen lds
    s_add_u32 m0, s71, 15616
    s_nop 0
    buffer_load_dwordx4 v10, s[84:87], s4 offen lds
    s_add_u32 s4, s70, 262144
    s_add_u32 m0, s71, 16640
    s_sub_u32 s5, s4, 8192
    s_max_i32 s5, s5, 0
    s_mov_b64 exec, 0xffff
    buffer_load_dwordx4 v10, s[80:83], s5 offen lds
    s_mov_b64 exec, -1

    s_add_u32 m0, s71, 16896
    s_nop 0
    buffer_load_dwordx4 v10, s[80:83], s4 offen lds
    s_add_u32 m0, s71, 25088
    s_nop 0
    buffer_load_dwordx4 v10, s[84:87], s4 offen lds
    s_add_u32 m0, s71, 17920
    s_add_u32 s4, s4, 32768
    buffer_load_dwordx4 v10, s[80:83], s4 offen lds
    s_add_u32 m0, s71, 26112
    s_nop 0
    buffer_load_dwordx4 v10, s[84:87], s4 offen lds
    s_add_u32 m0, s71, 18944
    s_add_u32 s4, s4, 32768
    buffer_load_dwordx4 v10, s[80:83], s4 offen lds
    s_add_u32 m0, s71, 27136
    s_nop 0
    buffer_load_dwordx4 v10, s[84:87], s4 offen lds
    s_add_u32 m0, s71, 19968
    s_add_u32 s4, s4, 32768
    buffer_load_dwordx4 v10, s[80:83], s4 offen lds
    s_add_u32 m0, s71, 28160
    s_nop 0
    buffer_load_dwordx4 v10, s[84:87], s4 offen lds
    s_add_u32 m0, s71, 20992
    s_add_u32 s4, s4, 32768
    buffer_load_dwordx4 v10, s[80:83], s4 offen lds
    s_add_u32 m0, s71, 29184
    s_nop 0
    buffer_load_dwordx4 v10, s[84:87], s4 offen lds
    s_add_u32 m0, s71, 22016
    s_add_u32 s4, s4, 32768
    buffer_load_dwordx4 v10, s[80:83], s4 offen lds
    s_add_u32 m0, s71, 30208
    s_nop 0
    buffer_load_dwordx4 v10, s[84:87], s4 offen lds
    s_add_u32 m0, s71, 23040
    s_add_u32 s4, s4, 32768
    buffer_load_dwordx4 v10, s[80:83], s4 offen lds
    s_add_u32 m0, s71, 31232
    s_nop 0
    buffer_load_dwordx4 v10, s[84:87], s4 offen lds
    s_add_u32 m0, s71, 24064
    s_add_u32 s4, s4, 32768
    buffer_load_dwordx4 v10, s[80:83], s4 offen lds
    s_add_u32 m0, s71, 32256
    s_nop 0
    buffer_load_dwordx4 v10, s[84:87], s4 offen lds
    s_waitcnt vmcnt(17)
    v_alignbit_b32 v196, v196, v196, 16
    v_alignbit_b32 v197, v197, v197, 16
    v_alignbit_b32 v198, v198, v198, 16
    v_alignbit_b32 v199, v199, v199, 16
    ds_read_b64_tr_b16 v[16:17], v11 offset:0
    ds_read_b64_tr_b16 v[18:19], v11 offset:256
    ds_read_b64_tr_b16 v[20:21], v11 offset:512
    ds_read_b64_tr_b16 v[22:23], v11 offset:768
    ds_read_b64_tr_b16 v[24:25], v11 offset:1024
    ds_read_b64_tr_b16 v[26:27], v11 offset:1280
    ds_read_b64_tr_b16 v[28:29], v11 offset:1536
    ds_read_b64_tr_b16 v[30:31], v11 offset:1792
    ds_read_b64_tr_b16 v[32:33], v11 offset:2048
    ds_read_b64_tr_b16 v[34:35], v11 offset:8448
    ds_read_b64_tr_b16 v[36:37], v11 offset:8704
    ds_read_b64_tr_b16 v[38:39], v11 offset:8960
    ds_read_b64_tr_b16 v[40:41], v11 offset:9216
    ds_read_b64_tr_b16 v[42:43], v11 offset:9472
    ds_read_b64_tr_b16 v[44:45], v11 offset:9728
    ds_read_b64_tr_b16 v[46:47], v11 offset:9984
    ds_read_b64_tr_b16 v[48:49], v11 offset:10240
    ds_read_b64_tr_b16 v[50:51], v11 offset:32
    ds_read_b64_tr_b16 v[52:53], v11 offset:288
    ds_read_b64_tr_b16 v[54:55], v11 offset:544
    ds_read_b64_tr_b16 v[56:57], v11 offset:800
    ds_read_b64_tr_b16 v[58:59], v11 offset:1056
    ds_read_b64_tr_b16 v[60:61], v11 offset:1312
    ds_read_b64_tr_b16 v[62:63], v11 offset:1568
    ds_read_b64_tr_b16 v[64:65], v11 offset:1824
    ds_read_b64_tr_b16 v[66:67], v11 offset:2080
    ds_read_b64_tr_b16 v[68:69], v11 offset:8480
    ds_read_b64_tr_b16 v[70:71], v11 offset:8736
    ds_read_b64_tr_b16 v[72:73], v11 offset:8992
    ds_read_b64_tr_b16 v[74:75], v11 offset:9248
    ds_read_b64_tr_b16 v[76:77], v11 offset:9504
    ds_read_b64_tr_b16 v[78:79], v11 offset:9760
    ds_read_b64_tr_b16 v[80:81], v11 offset:10016
    ds_read_b64_tr_b16 v[82:83], v11 offset:10272
    s_waitcnt lgkmcnt(0)
    s_cmp_eq_u32 s24, 0
    s_cselect_b32 exec_lo, 0xffff, 0
    s_mov_b32 exec_hi, 0
    v_mov_b32 v16, 0
    v_mov_b32 v17, 0
    v_mov_b32 v50, 0
    v_mov_b32 v51, 0
    s_mov_b64 exec, -1
    s_add_u32 s4, s70, 524288
    s_add_u32 m0, s71, 0
    s_sub_u32 s5, s4, 8192
    s_max_i32 s5, s5, 0
    s_mov_b64 exec, 0xffff
    buffer_load_dwordx4 v10, s[80:83], s5 offen lds
    s_mov_b64 exec, -1

    s_add_u32 m0, s71, 256
    s_nop 0
    buffer_load_dwordx4 v10, s[80:83], s4 offen lds
    s_add_u32 m0, s71, 8448
    s_nop 0
    buffer_load_dwordx4 v10, s[84:87], s4 offen lds
    s_add_u32 m0, s71, 1280
    s_add_u32 s4, s4, 32768
    buffer_load_dwordx4 v10, s[80:83], s4 offen lds
    s_add_u32 m0, s71, 9472
    s_nop 0
    buffer_load_dwordx4 v10, s[84:87], s4 offen lds
    s_add_u32 m0, s71, 2304
    s_add_u32 s4, s4, 32768
    buffer_load_dwordx4 v10, s[80:83], s4 offen lds
    s_add_u32 m0, s71, 10496
    s_nop 0
    buffer_load_dwordx4 v10, s[84:87], s4 offen lds
    s_add_u32 m0, s71, 3328
    s_add_u32 s4, s4, 32768
    buffer_load_dwordx4 v10, s[80:83], s4 offen lds
    s_add_u32 m0, s71, 11520
    s_nop 0
    buffer_load_dwordx4 v10, s[84:87], s4 offen lds
    s_add_u32 m0, s71, 4352
    s_add_u32 s4, s4, 32768
    buffer_load_dwordx4 v10, s[80:83], s4 offen lds
    s_add_u32 m0, s71, 12544
    s_nop 0
    buffer_load_dwordx4 v10, s[84:87], s4 offen lds
    s_add_u32 m0, s71, 5376
    s_add_u32 s4, s4, 32768
    buffer_load_dwordx4 v10, s[80:83], s4 offen lds
    s_add_u32 m0, s71, 13568
    s_nop 0
    buffer_load_dwordx4 v10, s[84:87], s4 offen lds
    s_add_u32 m0, s71, 6400
    s_add_u32 s4, s4, 32768
    buffer_load_dwordx4 v10, s[80:83], s4 offen lds
    s_add_u32 m0, s71, 14592
    s_nop 0
    buffer_load_dwordx4 v10, s[84:87], s4 offen lds
    s_add_u32 m0, s71, 7424
    s_add_u32 s4, s4, 32768
    buffer_load_dwordx4 v10, s[80:83], s4 offen lds
    s_add_u32 m0, s71, 15616
    s_nop 0
    buffer_load_dwordx4 v10, s[84:87], s4 offen lds
    v_alignbit_b32 v84, v17, v16, 16
    v_alignbit_b32 v85, v18, v17, 16
    v_alignbit_b32 v86, v19, v18, 16
    v_alignbit_b32 v87, v20, v19, 16
    v_alignbit_b32 v88, v21, v20, 16
    v_alignbit_b32 v89, v22, v21, 16
    v_alignbit_b32 v90, v23, v22, 16
    v_alignbit_b32 v91, v24, v23, 16
    v_alignbit_b32 v92, v25, v24, 16
    v_alignbit_b32 v93, v26, v25, 16
    v_alignbit_b32 v94, v27, v26, 16
    v_alignbit_b32 v95, v28, v27, 16
    v_alignbit_b32 v96, v29, v28, 16
    v_alignbit_b32 v97, v30, v29, 16
    v_alignbit_b32 v98, v31, v30, 16
    v_alignbit_b32 v99, v32, v31, 16
    v_alignbit_b32 v100, v33, v32, 16
    v_dot2_f32_bf16 v102, v84, v197, 0
    v_dot2_f32_bf16 v103, v17, v197, 0
    v_dot2_f32_bf16 v106, v85, v197, 0
    v_dot2_f32_bf16 v107, v18, v197, 0
    v_dot2_f32_bf16 v110, v86, v197, 0
    v_dot2_f32_bf16 v111, v19, v197, 0
    v_dot2_f32_bf16 v114, v87, v197, 0
    v_dot2_f32_bf16 v115, v20, v197, 0
    v_dot2_f32_bf16 v102, v85, v196, v102
    v_dot2_f32_bf16 v103, v18, v196, v103
    v_dot2_f32_bf16 v106, v86, v196, v106
    v_dot2_f32_bf16 v107, v19, v196, v107
    v_dot2_f32_bf16 v110, v87, v196, v110
    v_dot2_f32_bf16 v111, v20, v196, v111
    v_dot2_f32_bf16 v114, v88, v196, v114
    v_dot2_f32_bf16 v115, v21, v196, v115
    v_lshlrev_b32 v104, 16, v34
    v_and_b32 v105, 0xffff0000, v34
    v_lshlrev_b32 v108, 16, v35
    v_and_b32 v109, 0xffff0000, v35
    v_lshlrev_b32 v112, 16, v36
    v_and_b32 v113, 0xffff0000, v36
    v_lshlrev_b32 v116, 16, v37
    v_and_b32 v117, 0xffff0000, v37
    v_mul_f32 v102, v102, v104
    v_mul_f32 v103, v103, v105
    v_mul_f32 v106, v106, v108
    v_mul_f32 v107, v107, v109
    v_mul_f32 v110, v110, v112
    v_mul_f32 v111, v111, v113
    v_mul_f32 v114, v114, v116
    v_mul_f32 v115, v115, v117
    v_cvt_pk_bf16_f32 v137, v103, v102
    v_cvt_pk_bf16_f32 v136, v107, v106
    v_cvt_pk_bf16_f32 v135, v111, v110
    v_cvt_pk_bf16_f32 v134, v115, v114
    s_add_u32 s4, s72, 0
    buffer_store_dwordx4 v[134:137], v12, s[8:11], s4 offen offset:0
    v_dot2_f32_bf16 v118, v88, v197, 0
    v_dot2_f32_bf16 v119, v21, v197, 0
    v_dot2_f32_bf16 v122, v89, v197, 0
    v_dot2_f32_bf16 v123, v22, v197, 0
    v_dot2_f32_bf16 v126, v90, v197, 0
    v_dot2_f32_bf16 v127, v23, v197, 0
    v_dot2_f32_bf16 v130, v91, v197, 0
    v_dot2_f32_bf16 v131, v24, v197, 0
    v_dot2_f32_bf16 v118, v89, v196, v118
    v_dot2_f32_bf16 v119, v22, v196, v119
    v_dot2_f32_bf16 v122, v90, v196, v122
    v_dot2_f32_bf16 v123, v23, v196, v123
    v_dot2_f32_bf16 v126, v91, v196, v126
    v_dot2_f32_bf16 v127, v24, v196, v127
    v_dot2_f32_bf16 v130, v92, v196, v130
    v_dot2_f32_bf16 v131, v25, v196, v131
    v_lshlrev_b32 v120, 16, v38
    v_and_b32 v121, 0xffff0000, v38
    v_lshlrev_b32 v124, 16, v39
    v_and_b32 v125, 0xffff0000, v39
    v_lshlrev_b32 v128, 16, v40
    v_and_b32 v129, 0xffff0000, v40
    v_lshlrev_b32 v132, 16, v41
    v_and_b32 v133, 0xffff0000, v41
    v_mul_f32 v118, v118, v120
    v_mul_f32 v119, v119, v121
    v_mul_f32 v122, v122, v124
    v_mul_f32 v123, v123, v125
    v_mul_f32 v126, v126, v128
    v_mul_f32 v127, v127, v129
    v_mul_f32 v130, v130, v132
    v_mul_f32 v131, v131, v133
    v_cvt_pk_bf16_f32 v141, v119, v118
    v_cvt_pk_bf16_f32 v140, v123, v122
    v_cvt_pk_bf16_f32 v139, v127, v126
    v_cvt_pk_bf16_f32 v138, v131, v130
    buffer_store_dwordx4 v[138:141], v12, s[8:11], s4 offen offset:1024
    v_dot2_f32_bf16 v102, v92, v197, 0
    v_dot2_f32_bf16 v103, v25, v197, 0
    v_dot2_f32_bf16 v106, v93, v197, 0
    v_dot2_f32_bf16 v107, v26, v197, 0
    v_dot2_f32_bf16 v110, v94, v197, 0
    v_dot2_f32_bf16 v111, v27, v197, 0
    v_dot2_f32_bf16 v114, v95, v197, 0
    v_dot2_f32_bf16 v115, v28, v197, 0
    v_dot2_f32_bf16 v102, v93, v196, v102
    v_dot2_f32_bf16 v103, v26, v196, v103
    v_dot2_f32_bf16 v106, v94, v196, v106
    v_dot2_f32_bf16 v107, v27, v196, v107
    v_dot2_f32_bf16 v110, v95, v196, v110
    v_dot2_f32_bf16 v111, v28, v196, v111
    v_dot2_f32_bf16 v114, v96, v196, v114
    v_dot2_f32_bf16 v115, v29, v196, v115
    v_lshlrev_b32 v104, 16, v42
    v_and_b32 v105, 0xffff0000, v42
    v_lshlrev_b32 v108, 16, v43
    v_and_b32 v109, 0xffff0000, v43
    v_lshlrev_b32 v112, 16, v44
    v_and_b32 v113, 0xffff0000, v44
    v_lshlrev_b32 v116, 16, v45
    v_and_b32 v117, 0xffff0000, v45
    v_mul_f32 v102, v102, v104
    v_mul_f32 v103, v103, v105
    v_mul_f32 v106, v106, v108
    v_mul_f32 v107, v107, v109
    v_mul_f32 v110, v110, v112
    v_mul_f32 v111, v111, v113
    v_mul_f32 v114, v114, v116
    v_mul_f32 v115, v115, v117
    v_cvt_pk_bf16_f32 v145, v103, v102
    v_cvt_pk_bf16_f32 v144, v107, v106
    v_cvt_pk_bf16_f32 v143, v111, v110
    v_cvt_pk_bf16_f32 v142, v115, v114
    buffer_store_dwordx4 v[142:145], v12, s[8:11], s4 offen offset:2048
    v_dot2_f32_bf16 v118, v96, v197, 0
    v_dot2_f32_bf16 v119, v29, v197, 0
    v_dot2_f32_bf16 v122, v97, v197, 0
    v_dot2_f32_bf16 v123, v30, v197, 0
    v_dot2_f32_bf16 v126, v98, v197, 0
    v_dot2_f32_bf16 v127, v31, v197, 0
    v_dot2_f32_bf16 v130, v99, v197, 0
    v_dot2_f32_bf16 v131, v32, v197, 0
    v_dot2_f32_bf16 v118, v97, v196, v118
    v_dot2_f32_bf16 v119, v30, v196, v119
    v_dot2_f32_bf16 v122, v98, v196, v122
    v_dot2_f32_bf16 v123, v31, v196, v123
    v_dot2_f32_bf16 v126, v99, v196, v126
    v_dot2_f32_bf16 v127, v32, v196, v127
    v_dot2_f32_bf16 v130, v100, v196, v130
    v_dot2_f32_bf16 v131, v33, v196, v131
    v_lshlrev_b32 v120, 16, v46
    v_and_b32 v121, 0xffff0000, v46
    v_lshlrev_b32 v124, 16, v47
    v_and_b32 v125, 0xffff0000, v47
    v_lshlrev_b32 v128, 16, v48
    v_and_b32 v129, 0xffff0000, v48
    v_lshlrev_b32 v132, 16, v49
    v_and_b32 v133, 0xffff0000, v49
    v_mul_f32 v118, v118, v120
    v_mul_f32 v119, v119, v121
    v_mul_f32 v122, v122, v124
    v_mul_f32 v123, v123, v125
    v_mul_f32 v126, v126, v128
    v_mul_f32 v127, v127, v129
    v_mul_f32 v130, v130, v132
    v_mul_f32 v131, v131, v133
    v_cvt_pk_bf16_f32 v149, v119, v118
    v_cvt_pk_bf16_f32 v148, v123, v122
    v_cvt_pk_bf16_f32 v147, v127, v126
    v_cvt_pk_bf16_f32 v146, v131, v130
    buffer_store_dwordx4 v[146:149], v12, s[8:11], s4 offen offset:3072
    v_alignbit_b32 v84, v51, v50, 16
    v_alignbit_b32 v85, v52, v51, 16
    v_alignbit_b32 v86, v53, v52, 16
    v_alignbit_b32 v87, v54, v53, 16
    v_alignbit_b32 v88, v55, v54, 16
    v_alignbit_b32 v89, v56, v55, 16
    v_alignbit_b32 v90, v57, v56, 16
    v_alignbit_b32 v91, v58, v57, 16
    v_alignbit_b32 v92, v59, v58, 16
    v_alignbit_b32 v93, v60, v59, 16
    v_alignbit_b32 v94, v61, v60, 16
    v_alignbit_b32 v95, v62, v61, 16
    v_alignbit_b32 v96, v63, v62, 16
    v_alignbit_b32 v97, v64, v63, 16
    v_alignbit_b32 v98, v65, v64, 16
    v_alignbit_b32 v99, v66, v65, 16
    v_alignbit_b32 v100, v67, v66, 16
    v_dot2_f32_bf16 v102, v84, v199, 0
    v_dot2_f32_bf16 v103, v51, v199, 0
    v_dot2_f32_bf16 v106, v85, v199, 0
    v_dot2_f32_bf16 v107, v52, v199, 0
    v_dot2_f32_bf16 v110, v86, v199, 0
    v_dot2_f32_bf16 v111, v53, v199, 0
    v_dot2_f32_bf16 v114, v87, v199, 0
    v_dot2_f32_bf16 v115, v54, v199, 0
    v_dot2_f32_bf16 v102, v85, v198, v102
    v_dot2_f32_bf16 v103, v52, v198, v103
    v_dot2_f32_bf16 v106, v86, v198, v106
    v_dot2_f32_bf16 v107, v53, v198, v107
    v_dot2_f32_bf16 v110, v87, v198, v110
    v_dot2_f32_bf16 v111, v54, v198, v111
    v_dot2_f32_bf16 v114, v88, v198, v114
    v_dot2_f32_bf16 v115, v55, v198, v115
    v_lshlrev_b32 v104, 16, v68
    v_and_b32 v105, 0xffff0000, v68
    v_lshlrev_b32 v108, 16, v69
    v_and_b32 v109, 0xffff0000, v69
    v_lshlrev_b32 v112, 16, v70
    v_and_b32 v113, 0xffff0000, v70
    v_lshlrev_b32 v116, 16, v71
    v_and_b32 v117, 0xffff0000, v71
    v_mul_f32 v102, v102, v104
    v_mul_f32 v103, v103, v105
    v_mul_f32 v106, v106, v108
    v_mul_f32 v107, v107, v109
    v_mul_f32 v110, v110, v112
    v_mul_f32 v111, v111, v113
    v_mul_f32 v114, v114, v116
    v_mul_f32 v115, v115, v117
    v_cvt_pk_bf16_f32 v153, v103, v102
    v_cvt_pk_bf16_f32 v152, v107, v106
    v_cvt_pk_bf16_f32 v151, v111, v110
    v_cvt_pk_bf16_f32 v150, v115, v114
    s_add_u32 s4, s72, 65536
    buffer_store_dwordx4 v[150:153], v12, s[8:11], s4 offen offset:0
    v_dot2_f32_bf16 v118, v88, v199, 0
    v_dot2_f32_bf16 v119, v55, v199, 0
    v_dot2_f32_bf16 v122, v89, v199, 0
    v_dot2_f32_bf16 v123, v56, v199, 0
    v_dot2_f32_bf16 v126, v90, v199, 0
    v_dot2_f32_bf16 v127, v57, v199, 0
    v_dot2_f32_bf16 v130, v91, v199, 0
    v_dot2_f32_bf16 v131, v58, v199, 0
    v_dot2_f32_bf16 v118, v89, v198, v118
    v_dot2_f32_bf16 v119, v56, v198, v119
    v_dot2_f32_bf16 v122, v90, v198, v122
    v_dot2_f32_bf16 v123, v57, v198, v123
    v_dot2_f32_bf16 v126, v91, v198, v126
    v_dot2_f32_bf16 v127, v58, v198, v127
    v_dot2_f32_bf16 v130, v92, v198, v130
    v_dot2_f32_bf16 v131, v59, v198, v131
    v_lshlrev_b32 v120, 16, v72
    v_and_b32 v121, 0xffff0000, v72
    v_lshlrev_b32 v124, 16, v73
    v_and_b32 v125, 0xffff0000, v73
    v_lshlrev_b32 v128, 16, v74
    v_and_b32 v129, 0xffff0000, v74
    v_lshlrev_b32 v132, 16, v75
    v_and_b32 v133, 0xffff0000, v75
    v_mul_f32 v118, v118, v120
    v_mul_f32 v119, v119, v121
    v_mul_f32 v122, v122, v124
    v_mul_f32 v123, v123, v125
    v_mul_f32 v126, v126, v128
    v_mul_f32 v127, v127, v129
    v_mul_f32 v130, v130, v132
    v_mul_f32 v131, v131, v133
    v_cvt_pk_bf16_f32 v157, v119, v118
    v_cvt_pk_bf16_f32 v156, v123, v122
    v_cvt_pk_bf16_f32 v155, v127, v126
    v_cvt_pk_bf16_f32 v154, v131, v130
    buffer_store_dwordx4 v[154:157], v12, s[8:11], s4 offen offset:1024
    v_dot2_f32_bf16 v102, v92, v199, 0
    v_dot2_f32_bf16 v103, v59, v199, 0
    v_dot2_f32_bf16 v106, v93, v199, 0
    v_dot2_f32_bf16 v107, v60, v199, 0
    v_dot2_f32_bf16 v110, v94, v199, 0
    v_dot2_f32_bf16 v111, v61, v199, 0
    v_dot2_f32_bf16 v114, v95, v199, 0
    v_dot2_f32_bf16 v115, v62, v199, 0
    v_dot2_f32_bf16 v102, v93, v198, v102
    v_dot2_f32_bf16 v103, v60, v198, v103
    v_dot2_f32_bf16 v106, v94, v198, v106
    v_dot2_f32_bf16 v107, v61, v198, v107
    v_dot2_f32_bf16 v110, v95, v198, v110
    v_dot2_f32_bf16 v111, v62, v198, v111
    v_dot2_f32_bf16 v114, v96, v198, v114
    v_dot2_f32_bf16 v115, v63, v198, v115
    v_lshlrev_b32 v104, 16, v76
    v_and_b32 v105, 0xffff0000, v76
    v_lshlrev_b32 v108, 16, v77
    v_and_b32 v109, 0xffff0000, v77
    v_lshlrev_b32 v112, 16, v78
    v_and_b32 v113, 0xffff0000, v78
    v_lshlrev_b32 v116, 16, v79
    v_and_b32 v117, 0xffff0000, v79
    v_mul_f32 v102, v102, v104
    v_mul_f32 v103, v103, v105
    v_mul_f32 v106, v106, v108
    v_mul_f32 v107, v107, v109
    v_mul_f32 v110, v110, v112
    v_mul_f32 v111, v111, v113
    v_mul_f32 v114, v114, v116
    v_mul_f32 v115, v115, v117
    v_cvt_pk_bf16_f32 v161, v103, v102
    v_cvt_pk_bf16_f32 v160, v107, v106
    v_cvt_pk_bf16_f32 v159, v111, v110
    v_cvt_pk_bf16_f32 v158, v115, v114
    buffer_store_dwordx4 v[158:161], v12, s[8:11], s4 offen offset:2048
    v_dot2_f32_bf16 v118, v96, v199, 0
    v_dot2_f32_bf16 v119, v63, v199, 0
    v_dot2_f32_bf16 v122, v97, v199, 0
    v_dot2_f32_bf16 v123, v64, v199, 0
    v_dot2_f32_bf16 v126, v98, v199, 0
    v_dot2_f32_bf16 v127, v65, v199, 0
    v_dot2_f32_bf16 v130, v99, v199, 0
    v_dot2_f32_bf16 v131, v66, v199, 0
    v_dot2_f32_bf16 v118, v97, v198, v118
    v_dot2_f32_bf16 v119, v64, v198, v119
    v_dot2_f32_bf16 v122, v98, v198, v122
    v_dot2_f32_bf16 v123, v65, v198, v123
    v_dot2_f32_bf16 v126, v99, v198, v126
    v_dot2_f32_bf16 v127, v66, v198, v127
    v_dot2_f32_bf16 v130, v100, v198, v130
    v_dot2_f32_bf16 v131, v67, v198, v131
    v_lshlrev_b32 v120, 16, v80
    v_and_b32 v121, 0xffff0000, v80
    v_lshlrev_b32 v124, 16, v81
    v_and_b32 v125, 0xffff0000, v81
    v_lshlrev_b32 v128, 16, v82
    v_and_b32 v129, 0xffff0000, v82
    v_lshlrev_b32 v132, 16, v83
    v_and_b32 v133, 0xffff0000, v83
    v_mul_f32 v118, v118, v120
    v_mul_f32 v119, v119, v121
    v_mul_f32 v122, v122, v124
    v_mul_f32 v123, v123, v125
    v_mul_f32 v126, v126, v128
    v_mul_f32 v127, v127, v129
    v_mul_f32 v130, v130, v132
    v_mul_f32 v131, v131, v133
    v_cvt_pk_bf16_f32 v165, v119, v118
    v_cvt_pk_bf16_f32 v164, v123, v122
    v_cvt_pk_bf16_f32 v163, v127, v126
    v_cvt_pk_bf16_f32 v162, v131, v130
    buffer_store_dwordx4 v[162:165], v12, s[8:11], s4 offen offset:3072
    s_waitcnt vmcnt(25)
    ds_read_b64_tr_b16 v[16:17], v11 offset:16640
    ds_read_b64_tr_b16 v[18:19], v11 offset:16896
    ds_read_b64_tr_b16 v[20:21], v11 offset:17152
    ds_read_b64_tr_b16 v[22:23], v11 offset:17408
    ds_read_b64_tr_b16 v[24:25], v11 offset:17664
    ds_read_b64_tr_b16 v[26:27], v11 offset:17920
    ds_read_b64_tr_b16 v[28:29], v11 offset:18176
    ds_read_b64_tr_b16 v[30:31], v11 offset:18432
    ds_read_b64_tr_b16 v[32:33], v11 offset:18688
    ds_read_b64_tr_b16 v[34:35], v11 offset:25088
    ds_read_b64_tr_b16 v[36:37], v11 offset:25344
    ds_read_b64_tr_b16 v[38:39], v11 offset:25600
    ds_read_b64_tr_b16 v[40:41], v11 offset:25856
    ds_read_b64_tr_b16 v[42:43], v11 offset:26112
    ds_read_b64_tr_b16 v[44:45], v11 offset:26368
    ds_read_b64_tr_b16 v[46:47], v11 offset:26624
    ds_read_b64_tr_b16 v[48:49], v11 offset:26880
    ds_read_b64_tr_b16 v[50:51], v11 offset:16672
    ds_read_b64_tr_b16 v[52:53], v11 offset:16928
    ds_read_b64_tr_b16 v[54:55], v11 offset:17184
    ds_read_b64_tr_b16 v[56:57], v11 offset:17440
    ds_read_b64_tr_b16 v[58:59], v11 offset:17696
    ds_read_b64_tr_b16 v[60:61], v11 offset:17952
    ds_read_b64_tr_b16 v[62:63], v11 offset:18208
    ds_read_b64_tr_b16 v[64:65], v11 offset:18464
    ds_read_b64_tr_b16 v[66:67], v11 offset:18720
    ds_read_b64_tr_b16 v[68:69], v11 offset:25120
    ds_read_b64_tr_b16 v[70:71], v11 offset:25376
    ds_read_b64_tr_b16 v[72:73], v11 offset:25632
    ds_read_b64_tr_b16 v[74:75], v11 offset:25888
    ds_read_b64_tr_b16 v[76:77], v11 offset:26144
    ds_read_b64_tr_b16 v[78:79], v11 offset:26400
    ds_read_b64_tr_b16 v[80:81], v11 offset:26656
    ds_read_b64_tr_b16 v[82:83], v11 offset:26912
    s_waitcnt lgkmcnt(0)
    s_add_u32 s4, s70, 786432
    s_add_u32 m0, s71, 16640
    s_sub_u32 s5, s4, 8192
    s_max_i32 s5, s5, 0
    s_mov_b64 exec, 0xffff
    buffer_load_dwordx4 v10, s[80:83], s5 offen lds
    s_mov_b64 exec, -1

    s_add_u32 m0, s71, 16896
    s_nop 0
    buffer_load_dwordx4 v10, s[80:83], s4 offen lds
    s_add_u32 m0, s71, 25088
    s_nop 0
    buffer_load_dwordx4 v10, s[84:87], s4 offen lds
    s_add_u32 m0, s71, 17920
    s_add_u32 s4, s4, 32768
    buffer_load_dwordx4 v10, s[80:83], s4 offen lds
    s_add_u32 m0, s71, 26112
    s_nop 0
    buffer_load_dwordx4 v10, s[84:87], s4 offen lds
    s_add_u32 m0, s71, 18944
    s_add_u32 s4, s4, 32768
    buffer_load_dwordx4 v10, s[80:83], s4 offen lds
    s_add_u32 m0, s71, 27136
    s_nop 0
    buffer_load_dwordx4 v10, s[84:87], s4 offen lds
    s_add_u32 m0, s71, 19968
    s_add_u32 s4, s4, 32768
    buffer_load_dwordx4 v10, s[80:83], s4 offen lds
    s_add_u32 m0, s71, 28160
    s_nop 0
    buffer_load_dwordx4 v10, s[84:87], s4 offen lds
    s_add_u32 m0, s71, 20992
    s_add_u32 s4, s4, 32768
    buffer_load_dwordx4 v10, s[80:83], s4 offen lds
    s_add_u32 m0, s71, 29184
    s_nop 0
    buffer_load_dwordx4 v10, s[84:87], s4 offen lds
    s_add_u32 m0, s71, 22016
    s_add_u32 s4, s4, 32768
    buffer_load_dwordx4 v10, s[80:83], s4 offen lds
    s_add_u32 m0, s71, 30208
    s_nop 0
    buffer_load_dwordx4 v10, s[84:87], s4 offen lds
    s_add_u32 m0, s71, 23040
    s_add_u32 s4, s4, 32768
    buffer_load_dwordx4 v10, s[80:83], s4 offen lds
    s_add_u32 m0, s71, 31232
    s_nop 0
    buffer_load_dwordx4 v10, s[84:87], s4 offen lds
    s_add_u32 m0, s71, 24064
    s_add_u32 s4, s4, 32768
    buffer_load_dwordx4 v10, s[80:83], s4 offen lds
    s_add_u32 m0, s71, 32256
    s_nop 0
    buffer_load_dwordx4 v10, s[84:87], s4 offen lds
    v_alignbit_b32 v84, v17, v16, 16
    v_alignbit_b32 v85, v18, v17, 16
    v_alignbit_b32 v86, v19, v18, 16
    v_alignbit_b32 v87, v20, v19, 16
    v_alignbit_b32 v88, v21, v20, 16
    v_alignbit_b32 v89, v22, v21, 16
    v_alignbit_b32 v90, v23, v22, 16
    v_alignbit_b32 v91, v24, v23, 16
    v_alignbit_b32 v92, v25, v24, 16
    v_alignbit_b32 v93, v26, v25, 16
    v_alignbit_b32 v94, v27, v26, 16
    v_alignbit_b32 v95, v28, v27, 16
    v_alignbit_b32 v96, v29, v28, 16
    v_alignbit_b32 v97, v30, v29, 16
    v_alignbit_b32 v98, v31, v30, 16
    v_alignbit_b32 v99, v32, v31, 16
    v_alignbit_b32 v100, v33, v32, 16
    v_dot2_f32_bf16 v102, v84, v197, 0
    v_dot2_f32_bf16 v103, v17, v197, 0
    v_dot2_f32_bf16 v106, v85, v197, 0
    v_dot2_f32_bf16 v107, v18, v197, 0
    v_dot2_f32_bf16 v110, v86, v197, 0
    v_dot2_f32_bf16 v111, v19, v197, 0
    v_dot2_f32_bf16 v114, v87, v197, 0
    v_dot2_f32_bf16 v115, v20, v197, 0
    v_dot2_f32_bf16 v102, v85, v196, v102
    v_dot2_f32_bf16 v103, v18, v196, v103
    v_dot2_f32_bf16 v106, v86, v196, v106
    v_dot2_f32_bf16 v107, v19, v196, v107
    v_dot2_f32_bf16 v110, v87, v196, v110
    v_dot2_f32_bf16 v111, v20, v196, v111
    v_dot2_f32_bf16 v114, v88, v196, v114
    v_dot2_f32_bf16 v115, v21, v196, v115
    v_lshlrev_b32 v104, 16, v34
    v_and_b32 v105, 0xffff0000, v34
    v_lshlrev_b32 v108, 16, v35
    v_and_b32 v109, 0xffff0000, v35
    v_lshlrev_b32 v112, 16, v36
    v_and_b32 v113, 0xffff0000, v36
    v_lshlrev_b32 v116, 16, v37
    v_and_b32 v117, 0xffff0000, v37
    v_mul_f32 v102, v102, v104
    v_mul_f32 v103, v103, v105
    v_mul_f32 v106, v106, v108
    v_mul_f32 v107, v107, v109
    v_mul_f32 v110, v110, v112
    v_mul_f32 v111, v111, v113
    v_mul_f32 v114, v114, v116
    v_mul_f32 v115, v115, v117
    v_cvt_pk_bf16_f32 v137, v103, v102
    v_cvt_pk_bf16_f32 v136, v107, v106
    v_cvt_pk_bf16_f32 v135, v111, v110
    v_cvt_pk_bf16_f32 v134, v115, v114
    s_add_u32 s4, s72, 64
    buffer_store_dwordx4 v[134:137], v12, s[8:11], s4 offen offset:0
    v_dot2_f32_bf16 v118, v88, v197, 0
    v_dot2_f32_bf16 v119, v21, v197, 0
    v_dot2_f32_bf16 v122, v89, v197, 0
    v_dot2_f32_bf16 v123, v22, v197, 0
    v_dot2_f32_bf16 v126, v90, v197, 0
    v_dot2_f32_bf16 v127, v23, v197, 0
    v_dot2_f32_bf16 v130, v91, v197, 0
    v_dot2_f32_bf16 v131, v24, v197, 0
    v_dot2_f32_bf16 v118, v89, v196, v118
    v_dot2_f32_bf16 v119, v22, v196, v119
    v_dot2_f32_bf16 v122, v90, v196, v122
    v_dot2_f32_bf16 v123, v23, v196, v123
    v_dot2_f32_bf16 v126, v91, v196, v126
    v_dot2_f32_bf16 v127, v24, v196, v127
    v_dot2_f32_bf16 v130, v92, v196, v130
    v_dot2_f32_bf16 v131, v25, v196, v131
    v_lshlrev_b32 v120, 16, v38
    v_and_b32 v121, 0xffff0000, v38
    v_lshlrev_b32 v124, 16, v39
    v_and_b32 v125, 0xffff0000, v39
    v_lshlrev_b32 v128, 16, v40
    v_and_b32 v129, 0xffff0000, v40
    v_lshlrev_b32 v132, 16, v41
    v_and_b32 v133, 0xffff0000, v41
    v_mul_f32 v118, v118, v120
    v_mul_f32 v119, v119, v121
    v_mul_f32 v122, v122, v124
    v_mul_f32 v123, v123, v125
    v_mul_f32 v126, v126, v128
    v_mul_f32 v127, v127, v129
    v_mul_f32 v130, v130, v132
    v_mul_f32 v131, v131, v133
    v_cvt_pk_bf16_f32 v141, v119, v118
    v_cvt_pk_bf16_f32 v140, v123, v122
    v_cvt_pk_bf16_f32 v139, v127, v126
    v_cvt_pk_bf16_f32 v138, v131, v130
    buffer_store_dwordx4 v[138:141], v12, s[8:11], s4 offen offset:1024
    v_dot2_f32_bf16 v102, v92, v197, 0
    v_dot2_f32_bf16 v103, v25, v197, 0
    v_dot2_f32_bf16 v106, v93, v197, 0
    v_dot2_f32_bf16 v107, v26, v197, 0
    v_dot2_f32_bf16 v110, v94, v197, 0
    v_dot2_f32_bf16 v111, v27, v197, 0
    v_dot2_f32_bf16 v114, v95, v197, 0
    v_dot2_f32_bf16 v115, v28, v197, 0
    v_dot2_f32_bf16 v102, v93, v196, v102
    v_dot2_f32_bf16 v103, v26, v196, v103
    v_dot2_f32_bf16 v106, v94, v196, v106
    v_dot2_f32_bf16 v107, v27, v196, v107
    v_dot2_f32_bf16 v110, v95, v196, v110
    v_dot2_f32_bf16 v111, v28, v196, v111
    v_dot2_f32_bf16 v114, v96, v196, v114
    v_dot2_f32_bf16 v115, v29, v196, v115
    v_lshlrev_b32 v104, 16, v42
    v_and_b32 v105, 0xffff0000, v42
    v_lshlrev_b32 v108, 16, v43
    v_and_b32 v109, 0xffff0000, v43
    v_lshlrev_b32 v112, 16, v44
    v_and_b32 v113, 0xffff0000, v44
    v_lshlrev_b32 v116, 16, v45
    v_and_b32 v117, 0xffff0000, v45
    v_mul_f32 v102, v102, v104
    v_mul_f32 v103, v103, v105
    v_mul_f32 v106, v106, v108
    v_mul_f32 v107, v107, v109
    v_mul_f32 v110, v110, v112
    v_mul_f32 v111, v111, v113
    v_mul_f32 v114, v114, v116
    v_mul_f32 v115, v115, v117
    v_cvt_pk_bf16_f32 v145, v103, v102
    v_cvt_pk_bf16_f32 v144, v107, v106
    v_cvt_pk_bf16_f32 v143, v111, v110
    v_cvt_pk_bf16_f32 v142, v115, v114
    buffer_store_dwordx4 v[142:145], v12, s[8:11], s4 offen offset:2048
    v_dot2_f32_bf16 v118, v96, v197, 0
    v_dot2_f32_bf16 v119, v29, v197, 0
    v_dot2_f32_bf16 v122, v97, v197, 0
    v_dot2_f32_bf16 v123, v30, v197, 0
    v_dot2_f32_bf16 v126, v98, v197, 0
    v_dot2_f32_bf16 v127, v31, v197, 0
    v_dot2_f32_bf16 v130, v99, v197, 0
    v_dot2_f32_bf16 v131, v32, v197, 0
    v_dot2_f32_bf16 v118, v97, v196, v118
    v_dot2_f32_bf16 v119, v30, v196, v119
    v_dot2_f32_bf16 v122, v98, v196, v122
    v_dot2_f32_bf16 v123, v31, v196, v123
    v_dot2_f32_bf16 v126, v99, v196, v126
    v_dot2_f32_bf16 v127, v32, v196, v127
    v_dot2_f32_bf16 v130, v100, v196, v130
    v_dot2_f32_bf16 v131, v33, v196, v131
    v_lshlrev_b32 v120, 16, v46
    v_and_b32 v121, 0xffff0000, v46
    v_lshlrev_b32 v124, 16, v47
    v_and_b32 v125, 0xffff0000, v47
    v_lshlrev_b32 v128, 16, v48
    v_and_b32 v129, 0xffff0000, v48
    v_lshlrev_b32 v132, 16, v49
    v_and_b32 v133, 0xffff0000, v49
    v_mul_f32 v118, v118, v120
    v_mul_f32 v119, v119, v121
    v_mul_f32 v122, v122, v124
    v_mul_f32 v123, v123, v125
    v_mul_f32 v126, v126, v128
    v_mul_f32 v127, v127, v129
    v_mul_f32 v130, v130, v132
    v_mul_f32 v131, v131, v133
    v_cvt_pk_bf16_f32 v149, v119, v118
    v_cvt_pk_bf16_f32 v148, v123, v122
    v_cvt_pk_bf16_f32 v147, v127, v126
    v_cvt_pk_bf16_f32 v146, v131, v130
    buffer_store_dwordx4 v[146:149], v12, s[8:11], s4 offen offset:3072
    v_alignbit_b32 v84, v51, v50, 16
    v_alignbit_b32 v85, v52, v51, 16
    v_alignbit_b32 v86, v53, v52, 16
    v_alignbit_b32 v87, v54, v53, 16
    v_alignbit_b32 v88, v55, v54, 16
    v_alignbit_b32 v89, v56, v55, 16
    v_alignbit_b32 v90, v57, v56, 16
    v_alignbit_b32 v91, v58, v57, 16
    v_alignbit_b32 v92, v59, v58, 16
    v_alignbit_b32 v93, v60, v59, 16
    v_alignbit_b32 v94, v61, v60, 16
    v_alignbit_b32 v95, v62, v61, 16
    v_alignbit_b32 v96, v63, v62, 16
    v_alignbit_b32 v97, v64, v63, 16
    v_alignbit_b32 v98, v65, v64, 16
    v_alignbit_b32 v99, v66, v65, 16
    v_alignbit_b32 v100, v67, v66, 16
    v_dot2_f32_bf16 v102, v84, v199, 0
    v_dot2_f32_bf16 v103, v51, v199, 0
    v_dot2_f32_bf16 v106, v85, v199, 0
    v_dot2_f32_bf16 v107, v52, v199, 0
    v_dot2_f32_bf16 v110, v86, v199, 0
    v_dot2_f32_bf16 v111, v53, v199, 0
    v_dot2_f32_bf16 v114, v87, v199, 0
    v_dot2_f32_bf16 v115, v54, v199, 0
    v_dot2_f32_bf16 v102, v85, v198, v102
    v_dot2_f32_bf16 v103, v52, v198, v103
    v_dot2_f32_bf16 v106, v86, v198, v106
    v_dot2_f32_bf16 v107, v53, v198, v107
    v_dot2_f32_bf16 v110, v87, v198, v110
    v_dot2_f32_bf16 v111, v54, v198, v111
    v_dot2_f32_bf16 v114, v88, v198, v114
    v_dot2_f32_bf16 v115, v55, v198, v115
    v_lshlrev_b32 v104, 16, v68
    v_and_b32 v105, 0xffff0000, v68
    v_lshlrev_b32 v108, 16, v69
    v_and_b32 v109, 0xffff0000, v69
    v_lshlrev_b32 v112, 16, v70
    v_and_b32 v113, 0xffff0000, v70
    v_lshlrev_b32 v116, 16, v71
    v_and_b32 v117, 0xffff0000, v71
    v_mul_f32 v102, v102, v104
    v_mul_f32 v103, v103, v105
    v_mul_f32 v106, v106, v108
    v_mul_f32 v107, v107, v109
    v_mul_f32 v110, v110, v112
    v_mul_f32 v111, v111, v113
    v_mul_f32 v114, v114, v116
    v_mul_f32 v115, v115, v117
    v_cvt_pk_bf16_f32 v153, v103, v102
    v_cvt_pk_bf16_f32 v152, v107, v106
    v_cvt_pk_bf16_f32 v151, v111, v110
    v_cvt_pk_bf16_f32 v150, v115, v114
    s_add_u32 s4, s72, 65600
    buffer_store_dwordx4 v[150:153], v12, s[8:11], s4 offen offset:0
    v_dot2_f32_bf16 v118, v88, v199, 0
    v_dot2_f32_bf16 v119, v55, v199, 0
    v_dot2_f32_bf16 v122, v89, v199, 0
    v_dot2_f32_bf16 v123, v56, v199, 0
    v_dot2_f32_bf16 v126, v90, v199, 0
    v_dot2_f32_bf16 v127, v57, v199, 0
    v_dot2_f32_bf16 v130, v91, v199, 0
    v_dot2_f32_bf16 v131, v58, v199, 0
    v_dot2_f32_bf16 v118, v89, v198, v118
    v_dot2_f32_bf16 v119, v56, v198, v119
    v_dot2_f32_bf16 v122, v90, v198, v122
    v_dot2_f32_bf16 v123, v57, v198, v123
    v_dot2_f32_bf16 v126, v91, v198, v126
    v_dot2_f32_bf16 v127, v58, v198, v127
    v_dot2_f32_bf16 v130, v92, v198, v130
    v_dot2_f32_bf16 v131, v59, v198, v131
    v_lshlrev_b32 v120, 16, v72
    v_and_b32 v121, 0xffff0000, v72
    v_lshlrev_b32 v124, 16, v73
    v_and_b32 v125, 0xffff0000, v73
    v_lshlrev_b32 v128, 16, v74
    v_and_b32 v129, 0xffff0000, v74
    v_lshlrev_b32 v132, 16, v75
    v_and_b32 v133, 0xffff0000, v75
    v_mul_f32 v118, v118, v120
    v_mul_f32 v119, v119, v121
    v_mul_f32 v122, v122, v124
    v_mul_f32 v123, v123, v125
    v_mul_f32 v126, v126, v128
    v_mul_f32 v127, v127, v129
    v_mul_f32 v130, v130, v132
    v_mul_f32 v131, v131, v133
    v_cvt_pk_bf16_f32 v157, v119, v118
    v_cvt_pk_bf16_f32 v156, v123, v122
    v_cvt_pk_bf16_f32 v155, v127, v126
    v_cvt_pk_bf16_f32 v154, v131, v130
    buffer_store_dwordx4 v[154:157], v12, s[8:11], s4 offen offset:1024
    v_dot2_f32_bf16 v102, v92, v199, 0
    v_dot2_f32_bf16 v103, v59, v199, 0
    v_dot2_f32_bf16 v106, v93, v199, 0
    v_dot2_f32_bf16 v107, v60, v199, 0
    v_dot2_f32_bf16 v110, v94, v199, 0
    v_dot2_f32_bf16 v111, v61, v199, 0
    v_dot2_f32_bf16 v114, v95, v199, 0
    v_dot2_f32_bf16 v115, v62, v199, 0
    v_dot2_f32_bf16 v102, v93, v198, v102
    v_dot2_f32_bf16 v103, v60, v198, v103
    v_dot2_f32_bf16 v106, v94, v198, v106
    v_dot2_f32_bf16 v107, v61, v198, v107
    v_dot2_f32_bf16 v110, v95, v198, v110
    v_dot2_f32_bf16 v111, v62, v198, v111
    v_dot2_f32_bf16 v114, v96, v198, v114
    v_dot2_f32_bf16 v115, v63, v198, v115
    v_lshlrev_b32 v104, 16, v76
    v_and_b32 v105, 0xffff0000, v76
    v_lshlrev_b32 v108, 16, v77
    v_and_b32 v109, 0xffff0000, v77
    v_lshlrev_b32 v112, 16, v78
    v_and_b32 v113, 0xffff0000, v78
    v_lshlrev_b32 v116, 16, v79
    v_and_b32 v117, 0xffff0000, v79
    v_mul_f32 v102, v102, v104
    v_mul_f32 v103, v103, v105
    v_mul_f32 v106, v106, v108
    v_mul_f32 v107, v107, v109
    v_mul_f32 v110, v110, v112
    v_mul_f32 v111, v111, v113
    v_mul_f32 v114, v114, v116
    v_mul_f32 v115, v115, v117
    v_cvt_pk_bf16_f32 v161, v103, v102
    v_cvt_pk_bf16_f32 v160, v107, v106
    v_cvt_pk_bf16_f32 v159, v111, v110
    v_cvt_pk_bf16_f32 v158, v115, v114
    buffer_store_dwordx4 v[158:161], v12, s[8:11], s4 offen offset:2048
    v_dot2_f32_bf16 v118, v96, v199, 0
    v_dot2_f32_bf16 v119, v63, v199, 0
    v_dot2_f32_bf16 v122, v97, v199, 0
    v_dot2_f32_bf16 v123, v64, v199, 0
    v_dot2_f32_bf16 v126, v98, v199, 0
    v_dot2_f32_bf16 v127, v65, v199, 0
    v_dot2_f32_bf16 v130, v99, v199, 0
    v_dot2_f32_bf16 v131, v66, v199, 0
    v_dot2_f32_bf16 v118, v97, v198, v118
    v_dot2_f32_bf16 v119, v64, v198, v119
    v_dot2_f32_bf16 v122, v98, v198, v122
    v_dot2_f32_bf16 v123, v65, v198, v123
    v_dot2_f32_bf16 v126, v99, v198, v126
    v_dot2_f32_bf16 v127, v66, v198, v127
    v_dot2_f32_bf16 v130, v100, v198, v130
    v_dot2_f32_bf16 v131, v67, v198, v131
    v_lshlrev_b32 v120, 16, v80
    v_and_b32 v121, 0xffff0000, v80
    v_lshlrev_b32 v124, 16, v81
    v_and_b32 v125, 0xffff0000, v81
    v_lshlrev_b32 v128, 16, v82
    v_and_b32 v129, 0xffff0000, v82
    v_lshlrev_b32 v132, 16, v83
    v_and_b32 v133, 0xffff0000, v83
    v_mul_f32 v118, v118, v120
    v_mul_f32 v119, v119, v121
    v_mul_f32 v122, v122, v124
    v_mul_f32 v123, v123, v125
    v_mul_f32 v126, v126, v128
    v_mul_f32 v127, v127, v129
    v_mul_f32 v130, v130, v132
    v_mul_f32 v131, v131, v133
    v_cvt_pk_bf16_f32 v165, v119, v118
    v_cvt_pk_bf16_f32 v164, v123, v122
    v_cvt_pk_bf16_f32 v163, v127, v126
    v_cvt_pk_bf16_f32 v162, v131, v130
    buffer_store_dwordx4 v[162:165], v12, s[8:11], s4 offen offset:3072
    s_waitcnt vmcnt(25)
    ds_read_b64_tr_b16 v[16:17], v11 offset:0
    ds_read_b64_tr_b16 v[18:19], v11 offset:256
    ds_read_b64_tr_b16 v[20:21], v11 offset:512
    ds_read_b64_tr_b16 v[22:23], v11 offset:768
    ds_read_b64_tr_b16 v[24:25], v11 offset:1024
    ds_read_b64_tr_b16 v[26:27], v11 offset:1280
    ds_read_b64_tr_b16 v[28:29], v11 offset:1536
    ds_read_b64_tr_b16 v[30:31], v11 offset:1792
    ds_read_b64_tr_b16 v[32:33], v11 offset:2048
    ds_read_b64_tr_b16 v[34:35], v11 offset:8448
    ds_read_b64_tr_b16 v[36:37], v11 offset:8704
    ds_read_b64_tr_b16 v[38:39], v11 offset:8960
    ds_read_b64_tr_b16 v[40:41], v11 offset:9216
    ds_read_b64_tr_b16 v[42:43], v11 offset:9472
    ds_read_b64_tr_b16 v[44:45], v11 offset:9728
    ds_read_b64_tr_b16 v[46:47], v11 offset:9984
    ds_read_b64_tr_b16 v[48:49], v11 offset:10240
    ds_read_b64_tr_b16 v[50:51], v11 offset:32
    ds_read_b64_tr_b16 v[52:53], v11 offset:288
    ds_read_b64_tr_b16 v[54:55], v11 offset:544
    ds_read_b64_tr_b16 v[56:57], v11 offset:800
    ds_read_b64_tr_b16 v[58:59], v11 offset:1056
    ds_read_b64_tr_b16 v[60:61], v11 offset:1312
    ds_read_b64_tr_b16 v[62:63], v11 offset:1568
    ds_read_b64_tr_b16 v[64:65], v11 offset:1824
    ds_read_b64_tr_b16 v[66:67], v11 offset:2080
    ds_read_b64_tr_b16 v[68:69], v11 offset:8480
    ds_read_b64_tr_b16 v[70:71], v11 offset:8736
    ds_read_b64_tr_b16 v[72:73], v11 offset:8992
    ds_read_b64_tr_b16 v[74:75], v11 offset:9248
    ds_read_b64_tr_b16 v[76:77], v11 offset:9504
    ds_read_b64_tr_b16 v[78:79], v11 offset:9760
    ds_read_b64_tr_b16 v[80:81], v11 offset:10016
    ds_read_b64_tr_b16 v[82:83], v11 offset:10272
    s_waitcnt lgkmcnt(0)
    v_alignbit_b32 v84, v17, v16, 16
    v_alignbit_b32 v85, v18, v17, 16
    v_alignbit_b32 v86, v19, v18, 16
    v_alignbit_b32 v87, v20, v19, 16
    v_alignbit_b32 v88, v21, v20, 16
    v_alignbit_b32 v89, v22, v21, 16
    v_alignbit_b32 v90, v23, v22, 16
    v_alignbit_b32 v91, v24, v23, 16
    v_alignbit_b32 v92, v25, v24, 16
    v_alignbit_b32 v93, v26, v25, 16
    v_alignbit_b32 v94, v27, v26, 16
    v_alignbit_b32 v95, v28, v27, 16
    v_alignbit_b32 v96, v29, v28, 16
    v_alignbit_b32 v97, v30, v29, 16
    v_alignbit_b32 v98, v31, v30, 16
    v_alignbit_b32 v99, v32, v31, 16
    v_alignbit_b32 v100, v33, v32, 16
    v_dot2_f32_bf16 v102, v84, v197, 0
    v_dot2_f32_bf16 v103, v17, v197, 0
    v_dot2_f32_bf16 v106, v85, v197, 0
    v_dot2_f32_bf16 v107, v18, v197, 0
    v_dot2_f32_bf16 v110, v86, v197, 0
    v_dot2_f32_bf16 v111, v19, v197, 0
    v_dot2_f32_bf16 v114, v87, v197, 0
    v_dot2_f32_bf16 v115, v20, v197, 0
    v_dot2_f32_bf16 v102, v85, v196, v102
    v_dot2_f32_bf16 v103, v18, v196, v103
    v_dot2_f32_bf16 v106, v86, v196, v106
    v_dot2_f32_bf16 v107, v19, v196, v107
    v_dot2_f32_bf16 v110, v87, v196, v110
    v_dot2_f32_bf16 v111, v20, v196, v111
    v_dot2_f32_bf16 v114, v88, v196, v114
    v_dot2_f32_bf16 v115, v21, v196, v115
    v_lshlrev_b32 v104, 16, v34
    v_and_b32 v105, 0xffff0000, v34
    v_lshlrev_b32 v108, 16, v35
    v_and_b32 v109, 0xffff0000, v35
    v_lshlrev_b32 v112, 16, v36
    v_and_b32 v113, 0xffff0000, v36
    v_lshlrev_b32 v116, 16, v37
    v_and_b32 v117, 0xffff0000, v37
    v_mul_f32 v102, v102, v104
    v_mul_f32 v103, v103, v105
    v_mul_f32 v106, v106, v108
    v_mul_f32 v107, v107, v109
    v_mul_f32 v110, v110, v112
    v_mul_f32 v111, v111, v113
    v_mul_f32 v114, v114, v116
    v_mul_f32 v115, v115, v117
    v_cvt_pk_bf16_f32 v137, v103, v102
    v_cvt_pk_bf16_f32 v136, v107, v106
    v_cvt_pk_bf16_f32 v135, v111, v110
    v_cvt_pk_bf16_f32 v134, v115, v114
    s_add_u32 s4, s72, 128
    buffer_store_dwordx4 v[134:137], v12, s[8:11], s4 offen offset:0
    v_dot2_f32_bf16 v118, v88, v197, 0
    v_dot2_f32_bf16 v119, v21, v197, 0
    v_dot2_f32_bf16 v122, v89, v197, 0
    v_dot2_f32_bf16 v123, v22, v197, 0
    v_dot2_f32_bf16 v126, v90, v197, 0
    v_dot2_f32_bf16 v127, v23, v197, 0
    v_dot2_f32_bf16 v130, v91, v197, 0
    v_dot2_f32_bf16 v131, v24, v197, 0
    v_dot2_f32_bf16 v118, v89, v196, v118
    v_dot2_f32_bf16 v119, v22, v196, v119
    v_dot2_f32_bf16 v122, v90, v196, v122
    v_dot2_f32_bf16 v123, v23, v196, v123
    v_dot2_f32_bf16 v126, v91, v196, v126
    v_dot2_f32_bf16 v127, v24, v196, v127
    v_dot2_f32_bf16 v130, v92, v196, v130
    v_dot2_f32_bf16 v131, v25, v196, v131
    v_lshlrev_b32 v120, 16, v38
    v_and_b32 v121, 0xffff0000, v38
    v_lshlrev_b32 v124, 16, v39
    v_and_b32 v125, 0xffff0000, v39
    v_lshlrev_b32 v128, 16, v40
    v_and_b32 v129, 0xffff0000, v40
    v_lshlrev_b32 v132, 16, v41
    v_and_b32 v133, 0xffff0000, v41
    v_mul_f32 v118, v118, v120
    v_mul_f32 v119, v119, v121
    v_mul_f32 v122, v122, v124
    v_mul_f32 v123, v123, v125
    v_mul_f32 v126, v126, v128
    v_mul_f32 v127, v127, v129
    v_mul_f32 v130, v130, v132
    v_mul_f32 v131, v131, v133
    v_cvt_pk_bf16_f32 v141, v119, v118
    v_cvt_pk_bf16_f32 v140, v123, v122
    v_cvt_pk_bf16_f32 v139, v127, v126
    v_cvt_pk_bf16_f32 v138, v131, v130
    buffer_store_dwordx4 v[138:141], v12, s[8:11], s4 offen offset:1024
    v_dot2_f32_bf16 v102, v92, v197, 0
    v_dot2_f32_bf16 v103, v25, v197, 0
    v_dot2_f32_bf16 v106, v93, v197, 0
    v_dot2_f32_bf16 v107, v26, v197, 0
    v_dot2_f32_bf16 v110, v94, v197, 0
    v_dot2_f32_bf16 v111, v27, v197, 0
    v_dot2_f32_bf16 v114, v95, v197, 0
    v_dot2_f32_bf16 v115, v28, v197, 0
    v_dot2_f32_bf16 v102, v93, v196, v102
    v_dot2_f32_bf16 v103, v26, v196, v103
    v_dot2_f32_bf16 v106, v94, v196, v106
    v_dot2_f32_bf16 v107, v27, v196, v107
    v_dot2_f32_bf16 v110, v95, v196, v110
    v_dot2_f32_bf16 v111, v28, v196, v111
    v_dot2_f32_bf16 v114, v96, v196, v114
    v_dot2_f32_bf16 v115, v29, v196, v115
    v_lshlrev_b32 v104, 16, v42
    v_and_b32 v105, 0xffff0000, v42
    v_lshlrev_b32 v108, 16, v43
    v_and_b32 v109, 0xffff0000, v43
    v_lshlrev_b32 v112, 16, v44
    v_and_b32 v113, 0xffff0000, v44
    v_lshlrev_b32 v116, 16, v45
    v_and_b32 v117, 0xffff0000, v45
    v_mul_f32 v102, v102, v104
    v_mul_f32 v103, v103, v105
    v_mul_f32 v106, v106, v108
    v_mul_f32 v107, v107, v109
    v_mul_f32 v110, v110, v112
    v_mul_f32 v111, v111, v113
    v_mul_f32 v114, v114, v116
    v_mul_f32 v115, v115, v117
    v_cvt_pk_bf16_f32 v145, v103, v102
    v_cvt_pk_bf16_f32 v144, v107, v106
    v_cvt_pk_bf16_f32 v143, v111, v110
    v_cvt_pk_bf16_f32 v142, v115, v114
    buffer_store_dwordx4 v[142:145], v12, s[8:11], s4 offen offset:2048
    v_dot2_f32_bf16 v118, v96, v197, 0
    v_dot2_f32_bf16 v119, v29, v197, 0
    v_dot2_f32_bf16 v122, v97, v197, 0
    v_dot2_f32_bf16 v123, v30, v197, 0
    v_dot2_f32_bf16 v126, v98, v197, 0
    v_dot2_f32_bf16 v127, v31, v197, 0
    v_dot2_f32_bf16 v130, v99, v197, 0
    v_dot2_f32_bf16 v131, v32, v197, 0
    v_dot2_f32_bf16 v118, v97, v196, v118
    v_dot2_f32_bf16 v119, v30, v196, v119
    v_dot2_f32_bf16 v122, v98, v196, v122
    v_dot2_f32_bf16 v123, v31, v196, v123
    v_dot2_f32_bf16 v126, v99, v196, v126
    v_dot2_f32_bf16 v127, v32, v196, v127
    v_dot2_f32_bf16 v130, v100, v196, v130
    v_dot2_f32_bf16 v131, v33, v196, v131
    v_lshlrev_b32 v120, 16, v46
    v_and_b32 v121, 0xffff0000, v46
    v_lshlrev_b32 v124, 16, v47
    v_and_b32 v125, 0xffff0000, v47
    v_lshlrev_b32 v128, 16, v48
    v_and_b32 v129, 0xffff0000, v48
    v_lshlrev_b32 v132, 16, v49
    v_and_b32 v133, 0xffff0000, v49
    v_mul_f32 v118, v118, v120
    v_mul_f32 v119, v119, v121
    v_mul_f32 v122, v122, v124
    v_mul_f32 v123, v123, v125
    v_mul_f32 v126, v126, v128
    v_mul_f32 v127, v127, v129
    v_mul_f32 v130, v130, v132
    v_mul_f32 v131, v131, v133
    v_cvt_pk_bf16_f32 v149, v119, v118
    v_cvt_pk_bf16_f32 v148, v123, v122
    v_cvt_pk_bf16_f32 v147, v127, v126
    v_cvt_pk_bf16_f32 v146, v131, v130
    buffer_store_dwordx4 v[146:149], v12, s[8:11], s4 offen offset:3072
    v_alignbit_b32 v84, v51, v50, 16
    v_alignbit_b32 v85, v52, v51, 16
    v_alignbit_b32 v86, v53, v52, 16
    v_alignbit_b32 v87, v54, v53, 16
    v_alignbit_b32 v88, v55, v54, 16
    v_alignbit_b32 v89, v56, v55, 16
    v_alignbit_b32 v90, v57, v56, 16
    v_alignbit_b32 v91, v58, v57, 16
    v_alignbit_b32 v92, v59, v58, 16
    v_alignbit_b32 v93, v60, v59, 16
    v_alignbit_b32 v94, v61, v60, 16
    v_alignbit_b32 v95, v62, v61, 16
    v_alignbit_b32 v96, v63, v62, 16
    v_alignbit_b32 v97, v64, v63, 16
    v_alignbit_b32 v98, v65, v64, 16
    v_alignbit_b32 v99, v66, v65, 16
    v_alignbit_b32 v100, v67, v66, 16
    v_dot2_f32_bf16 v102, v84, v199, 0
    v_dot2_f32_bf16 v103, v51, v199, 0
    v_dot2_f32_bf16 v106, v85, v199, 0
    v_dot2_f32_bf16 v107, v52, v199, 0
    v_dot2_f32_bf16 v110, v86, v199, 0
    v_dot2_f32_bf16 v111, v53, v199, 0
    v_dot2_f32_bf16 v114, v87, v199, 0
    v_dot2_f32_bf16 v115, v54, v199, 0
    v_dot2_f32_bf16 v102, v85, v198, v102
    v_dot2_f32_bf16 v103, v52, v198, v103
    v_dot2_f32_bf16 v106, v86, v198, v106
    v_dot2_f32_bf16 v107, v53, v198, v107
    v_dot2_f32_bf16 v110, v87, v198, v110
    v_dot2_f32_bf16 v111, v54, v198, v111
    v_dot2_f32_bf16 v114, v88, v198, v114
    v_dot2_f32_bf16 v115, v55, v198, v115
    v_lshlrev_b32 v104, 16, v68
    v_and_b32 v105, 0xffff0000, v68
    v_lshlrev_b32 v108, 16, v69
    v_and_b32 v109, 0xffff0000, v69
    v_lshlrev_b32 v112, 16, v70
    v_and_b32 v113, 0xffff0000, v70
    v_lshlrev_b32 v116, 16, v71
    v_and_b32 v117, 0xffff0000, v71
    v_mul_f32 v102, v102, v104
    v_mul_f32 v103, v103, v105
    v_mul_f32 v106, v106, v108
    v_mul_f32 v107, v107, v109
    v_mul_f32 v110, v110, v112
    v_mul_f32 v111, v111, v113
    v_mul_f32 v114, v114, v116
    v_mul_f32 v115, v115, v117
    v_cvt_pk_bf16_f32 v153, v103, v102
    v_cvt_pk_bf16_f32 v152, v107, v106
    v_cvt_pk_bf16_f32 v151, v111, v110
    v_cvt_pk_bf16_f32 v150, v115, v114
    s_add_u32 s4, s72, 65664
    buffer_store_dwordx4 v[150:153], v12, s[8:11], s4 offen offset:0
    v_dot2_f32_bf16 v118, v88, v199, 0
    v_dot2_f32_bf16 v119, v55, v199, 0
    v_dot2_f32_bf16 v122, v89, v199, 0
    v_dot2_f32_bf16 v123, v56, v199, 0
    v_dot2_f32_bf16 v126, v90, v199, 0
    v_dot2_f32_bf16 v127, v57, v199, 0
    v_dot2_f32_bf16 v130, v91, v199, 0
    v_dot2_f32_bf16 v131, v58, v199, 0
    v_dot2_f32_bf16 v118, v89, v198, v118
    v_dot2_f32_bf16 v119, v56, v198, v119
    v_dot2_f32_bf16 v122, v90, v198, v122
    v_dot2_f32_bf16 v123, v57, v198, v123
    v_dot2_f32_bf16 v126, v91, v198, v126
    v_dot2_f32_bf16 v127, v58, v198, v127
    v_dot2_f32_bf16 v130, v92, v198, v130
    v_dot2_f32_bf16 v131, v59, v198, v131
    v_lshlrev_b32 v120, 16, v72
    v_and_b32 v121, 0xffff0000, v72
    v_lshlrev_b32 v124, 16, v73
    v_and_b32 v125, 0xffff0000, v73
    v_lshlrev_b32 v128, 16, v74
    v_and_b32 v129, 0xffff0000, v74
    v_lshlrev_b32 v132, 16, v75
    v_and_b32 v133, 0xffff0000, v75
    v_mul_f32 v118, v118, v120
    v_mul_f32 v119, v119, v121
    v_mul_f32 v122, v122, v124
    v_mul_f32 v123, v123, v125
    v_mul_f32 v126, v126, v128
    v_mul_f32 v127, v127, v129
    v_mul_f32 v130, v130, v132
    v_mul_f32 v131, v131, v133
    v_cvt_pk_bf16_f32 v157, v119, v118
    v_cvt_pk_bf16_f32 v156, v123, v122
    v_cvt_pk_bf16_f32 v155, v127, v126
    v_cvt_pk_bf16_f32 v154, v131, v130
    buffer_store_dwordx4 v[154:157], v12, s[8:11], s4 offen offset:1024
    v_dot2_f32_bf16 v102, v92, v199, 0
    v_dot2_f32_bf16 v103, v59, v199, 0
    v_dot2_f32_bf16 v106, v93, v199, 0
    v_dot2_f32_bf16 v107, v60, v199, 0
    v_dot2_f32_bf16 v110, v94, v199, 0
    v_dot2_f32_bf16 v111, v61, v199, 0
    v_dot2_f32_bf16 v114, v95, v199, 0
    v_dot2_f32_bf16 v115, v62, v199, 0
    v_dot2_f32_bf16 v102, v93, v198, v102
    v_dot2_f32_bf16 v103, v60, v198, v103
    v_dot2_f32_bf16 v106, v94, v198, v106
    v_dot2_f32_bf16 v107, v61, v198, v107
    v_dot2_f32_bf16 v110, v95, v198, v110
    v_dot2_f32_bf16 v111, v62, v198, v111
    v_dot2_f32_bf16 v114, v96, v198, v114
    v_dot2_f32_bf16 v115, v63, v198, v115
    v_lshlrev_b32 v104, 16, v76
    v_and_b32 v105, 0xffff0000, v76
    v_lshlrev_b32 v108, 16, v77
    v_and_b32 v109, 0xffff0000, v77
    v_lshlrev_b32 v112, 16, v78
    v_and_b32 v113, 0xffff0000, v78
    v_lshlrev_b32 v116, 16, v79
    v_and_b32 v117, 0xffff0000, v79
    v_mul_f32 v102, v102, v104
    v_mul_f32 v103, v103, v105
    v_mul_f32 v106, v106, v108
    v_mul_f32 v107, v107, v109
    v_mul_f32 v110, v110, v112
    v_mul_f32 v111, v111, v113
    v_mul_f32 v114, v114, v116
    v_mul_f32 v115, v115, v117
    v_cvt_pk_bf16_f32 v161, v103, v102
    v_cvt_pk_bf16_f32 v160, v107, v106
    v_cvt_pk_bf16_f32 v159, v111, v110
    v_cvt_pk_bf16_f32 v158, v115, v114
    buffer_store_dwordx4 v[158:161], v12, s[8:11], s4 offen offset:2048
    v_dot2_f32_bf16 v118, v96, v199, 0
    v_dot2_f32_bf16 v119, v63, v199, 0
    v_dot2_f32_bf16 v122, v97, v199, 0
    v_dot2_f32_bf16 v123, v64, v199, 0
    v_dot2_f32_bf16 v126, v98, v199, 0
    v_dot2_f32_bf16 v127, v65, v199, 0
    v_dot2_f32_bf16 v130, v99, v199, 0
    v_dot2_f32_bf16 v131, v66, v199, 0
    v_dot2_f32_bf16 v118, v97, v198, v118
    v_dot2_f32_bf16 v119, v64, v198, v119
    v_dot2_f32_bf16 v122, v98, v198, v122
    v_dot2_f32_bf16 v123, v65, v198, v123
    v_dot2_f32_bf16 v126, v99, v198, v126
    v_dot2_f32_bf16 v127, v66, v198, v127
    v_dot2_f32_bf16 v130, v100, v198, v130
    v_dot2_f32_bf16 v131, v67, v198, v131
    v_lshlrev_b32 v120, 16, v80
    v_and_b32 v121, 0xffff0000, v80
    v_lshlrev_b32 v124, 16, v81
    v_and_b32 v125, 0xffff0000, v81
    v_lshlrev_b32 v128, 16, v82
    v_and_b32 v129, 0xffff0000, v82
    v_lshlrev_b32 v132, 16, v83
    v_and_b32 v133, 0xffff0000, v83
    v_mul_f32 v118, v118, v120
    v_mul_f32 v119, v119, v121
    v_mul_f32 v122, v122, v124
    v_mul_f32 v123, v123, v125
    v_mul_f32 v126, v126, v128
    v_mul_f32 v127, v127, v129
    v_mul_f32 v130, v130, v132
    v_mul_f32 v131, v131, v133
    v_cvt_pk_bf16_f32 v165, v119, v118
    v_cvt_pk_bf16_f32 v164, v123, v122
    v_cvt_pk_bf16_f32 v163, v127, v126
    v_cvt_pk_bf16_f32 v162, v131, v130
    buffer_store_dwordx4 v[162:165], v12, s[8:11], s4 offen offset:3072
    s_waitcnt vmcnt(8)
    ds_read_b64_tr_b16 v[16:17], v11 offset:16640
    ds_read_b64_tr_b16 v[18:19], v11 offset:16896
    ds_read_b64_tr_b16 v[20:21], v11 offset:17152
    ds_read_b64_tr_b16 v[22:23], v11 offset:17408
    ds_read_b64_tr_b16 v[24:25], v11 offset:17664
    ds_read_b64_tr_b16 v[26:27], v11 offset:17920
    ds_read_b64_tr_b16 v[28:29], v11 offset:18176
    ds_read_b64_tr_b16 v[30:31], v11 offset:18432
    ds_read_b64_tr_b16 v[32:33], v11 offset:18688
    ds_read_b64_tr_b16 v[34:35], v11 offset:25088
    ds_read_b64_tr_b16 v[36:37], v11 offset:25344
    ds_read_b64_tr_b16 v[38:39], v11 offset:25600
    ds_read_b64_tr_b16 v[40:41], v11 offset:25856
    ds_read_b64_tr_b16 v[42:43], v11 offset:26112
    ds_read_b64_tr_b16 v[44:45], v11 offset:26368
    ds_read_b64_tr_b16 v[46:47], v11 offset:26624
    ds_read_b64_tr_b16 v[48:49], v11 offset:26880
    ds_read_b64_tr_b16 v[50:51], v11 offset:16672
    ds_read_b64_tr_b16 v[52:53], v11 offset:16928
    ds_read_b64_tr_b16 v[54:55], v11 offset:17184
    ds_read_b64_tr_b16 v[56:57], v11 offset:17440
    ds_read_b64_tr_b16 v[58:59], v11 offset:17696
    ds_read_b64_tr_b16 v[60:61], v11 offset:17952
    ds_read_b64_tr_b16 v[62:63], v11 offset:18208
    ds_read_b64_tr_b16 v[64:65], v11 offset:18464
    ds_read_b64_tr_b16 v[66:67], v11 offset:18720
    ds_read_b64_tr_b16 v[68:69], v11 offset:25120
    ds_read_b64_tr_b16 v[70:71], v11 offset:25376
    ds_read_b64_tr_b16 v[72:73], v11 offset:25632
    ds_read_b64_tr_b16 v[74:75], v11 offset:25888
    ds_read_b64_tr_b16 v[76:77], v11 offset:26144
    ds_read_b64_tr_b16 v[78:79], v11 offset:26400
    ds_read_b64_tr_b16 v[80:81], v11 offset:26656
    ds_read_b64_tr_b16 v[82:83], v11 offset:26912
    s_waitcnt lgkmcnt(0)
    v_alignbit_b32 v84, v17, v16, 16
    v_alignbit_b32 v85, v18, v17, 16
    v_alignbit_b32 v86, v19, v18, 16
    v_alignbit_b32 v87, v20, v19, 16
    v_alignbit_b32 v88, v21, v20, 16
    v_alignbit_b32 v89, v22, v21, 16
    v_alignbit_b32 v90, v23, v22, 16
    v_alignbit_b32 v91, v24, v23, 16
    v_alignbit_b32 v92, v25, v24, 16
    v_alignbit_b32 v93, v26, v25, 16
    v_alignbit_b32 v94, v27, v26, 16
    v_alignbit_b32 v95, v28, v27, 16
    v_alignbit_b32 v96, v29, v28, 16
    v_alignbit_b32 v97, v30, v29, 16
    v_alignbit_b32 v98, v31, v30, 16
    v_alignbit_b32 v99, v32, v31, 16
    v_alignbit_b32 v100, v33, v32, 16
    v_dot2_f32_bf16 v102, v84, v197, 0
    v_dot2_f32_bf16 v103, v17, v197, 0
    v_dot2_f32_bf16 v106, v85, v197, 0
    v_dot2_f32_bf16 v107, v18, v197, 0
    v_dot2_f32_bf16 v110, v86, v197, 0
    v_dot2_f32_bf16 v111, v19, v197, 0
    v_dot2_f32_bf16 v114, v87, v197, 0
    v_dot2_f32_bf16 v115, v20, v197, 0
    v_dot2_f32_bf16 v102, v85, v196, v102
    v_dot2_f32_bf16 v103, v18, v196, v103
    v_dot2_f32_bf16 v106, v86, v196, v106
    v_dot2_f32_bf16 v107, v19, v196, v107
    v_dot2_f32_bf16 v110, v87, v196, v110
    v_dot2_f32_bf16 v111, v20, v196, v111
    v_dot2_f32_bf16 v114, v88, v196, v114
    v_dot2_f32_bf16 v115, v21, v196, v115
    v_lshlrev_b32 v104, 16, v34
    v_and_b32 v105, 0xffff0000, v34
    v_lshlrev_b32 v108, 16, v35
    v_and_b32 v109, 0xffff0000, v35
    v_lshlrev_b32 v112, 16, v36
    v_and_b32 v113, 0xffff0000, v36
    v_lshlrev_b32 v116, 16, v37
    v_and_b32 v117, 0xffff0000, v37
    v_mul_f32 v102, v102, v104
    v_mul_f32 v103, v103, v105
    v_mul_f32 v106, v106, v108
    v_mul_f32 v107, v107, v109
    v_mul_f32 v110, v110, v112
    v_mul_f32 v111, v111, v113
    v_mul_f32 v114, v114, v116
    v_mul_f32 v115, v115, v117
    v_cvt_pk_bf16_f32 v137, v103, v102
    v_cvt_pk_bf16_f32 v136, v107, v106
    v_cvt_pk_bf16_f32 v135, v111, v110
    v_cvt_pk_bf16_f32 v134, v115, v114
    s_add_u32 s4, s72, 192
    buffer_store_dwordx4 v[134:137], v12, s[8:11], s4 offen offset:0
    v_dot2_f32_bf16 v118, v88, v197, 0
    v_dot2_f32_bf16 v119, v21, v197, 0
    v_dot2_f32_bf16 v122, v89, v197, 0
    v_dot2_f32_bf16 v123, v22, v197, 0
    v_dot2_f32_bf16 v126, v90, v197, 0
    v_dot2_f32_bf16 v127, v23, v197, 0
    v_dot2_f32_bf16 v130, v91, v197, 0
    v_dot2_f32_bf16 v131, v24, v197, 0
    v_dot2_f32_bf16 v118, v89, v196, v118
    v_dot2_f32_bf16 v119, v22, v196, v119
    v_dot2_f32_bf16 v122, v90, v196, v122
    v_dot2_f32_bf16 v123, v23, v196, v123
    v_dot2_f32_bf16 v126, v91, v196, v126
    v_dot2_f32_bf16 v127, v24, v196, v127
    v_dot2_f32_bf16 v130, v92, v196, v130
    v_dot2_f32_bf16 v131, v25, v196, v131
    v_lshlrev_b32 v120, 16, v38
    v_and_b32 v121, 0xffff0000, v38
    v_lshlrev_b32 v124, 16, v39
    v_and_b32 v125, 0xffff0000, v39
    v_lshlrev_b32 v128, 16, v40
    v_and_b32 v129, 0xffff0000, v40
    v_lshlrev_b32 v132, 16, v41
    v_and_b32 v133, 0xffff0000, v41
    v_mul_f32 v118, v118, v120
    v_mul_f32 v119, v119, v121
    v_mul_f32 v122, v122, v124
    v_mul_f32 v123, v123, v125
    v_mul_f32 v126, v126, v128
    v_mul_f32 v127, v127, v129
    v_mul_f32 v130, v130, v132
    v_mul_f32 v131, v131, v133
    v_cvt_pk_bf16_f32 v141, v119, v118
    v_cvt_pk_bf16_f32 v140, v123, v122
    v_cvt_pk_bf16_f32 v139, v127, v126
    v_cvt_pk_bf16_f32 v138, v131, v130
    buffer_store_dwordx4 v[138:141], v12, s[8:11], s4 offen offset:1024
    v_dot2_f32_bf16 v102, v92, v197, 0
    v_dot2_f32_bf16 v103, v25, v197, 0
    v_dot2_f32_bf16 v106, v93, v197, 0
    v_dot2_f32_bf16 v107, v26, v197, 0
    v_dot2_f32_bf16 v110, v94, v197, 0
    v_dot2_f32_bf16 v111, v27, v197, 0
    v_dot2_f32_bf16 v114, v95, v197, 0
    v_dot2_f32_bf16 v115, v28, v197, 0
    v_dot2_f32_bf16 v102, v93, v196, v102
    v_dot2_f32_bf16 v103, v26, v196, v103
    v_dot2_f32_bf16 v106, v94, v196, v106
    v_dot2_f32_bf16 v107, v27, v196, v107
    v_dot2_f32_bf16 v110, v95, v196, v110
    v_dot2_f32_bf16 v111, v28, v196, v111
    v_dot2_f32_bf16 v114, v96, v196, v114
    v_dot2_f32_bf16 v115, v29, v196, v115
    v_lshlrev_b32 v104, 16, v42
    v_and_b32 v105, 0xffff0000, v42
    v_lshlrev_b32 v108, 16, v43
    v_and_b32 v109, 0xffff0000, v43
    v_lshlrev_b32 v112, 16, v44
    v_and_b32 v113, 0xffff0000, v44
    v_lshlrev_b32 v116, 16, v45
    v_and_b32 v117, 0xffff0000, v45
    v_mul_f32 v102, v102, v104
    v_mul_f32 v103, v103, v105
    v_mul_f32 v106, v106, v108
    v_mul_f32 v107, v107, v109
    v_mul_f32 v110, v110, v112
    v_mul_f32 v111, v111, v113
    v_mul_f32 v114, v114, v116
    v_mul_f32 v115, v115, v117
    v_cvt_pk_bf16_f32 v145, v103, v102
    v_cvt_pk_bf16_f32 v144, v107, v106
    v_cvt_pk_bf16_f32 v143, v111, v110
    v_cvt_pk_bf16_f32 v142, v115, v114
    buffer_store_dwordx4 v[142:145], v12, s[8:11], s4 offen offset:2048
    v_dot2_f32_bf16 v118, v96, v197, 0
    v_dot2_f32_bf16 v119, v29, v197, 0
    v_dot2_f32_bf16 v122, v97, v197, 0
    v_dot2_f32_bf16 v123, v30, v197, 0
    v_dot2_f32_bf16 v126, v98, v197, 0
    v_dot2_f32_bf16 v127, v31, v197, 0
    v_dot2_f32_bf16 v130, v99, v197, 0
    v_dot2_f32_bf16 v131, v32, v197, 0
    v_dot2_f32_bf16 v118, v97, v196, v118
    v_dot2_f32_bf16 v119, v30, v196, v119
    v_dot2_f32_bf16 v122, v98, v196, v122
    v_dot2_f32_bf16 v123, v31, v196, v123
    v_dot2_f32_bf16 v126, v99, v196, v126
    v_dot2_f32_bf16 v127, v32, v196, v127
    v_dot2_f32_bf16 v130, v100, v196, v130
    v_dot2_f32_bf16 v131, v33, v196, v131
    v_lshlrev_b32 v120, 16, v46
    v_and_b32 v121, 0xffff0000, v46
    v_lshlrev_b32 v124, 16, v47
    v_and_b32 v125, 0xffff0000, v47
    v_lshlrev_b32 v128, 16, v48
    v_and_b32 v129, 0xffff0000, v48
    v_lshlrev_b32 v132, 16, v49
    v_and_b32 v133, 0xffff0000, v49
    v_mul_f32 v118, v118, v120
    v_mul_f32 v119, v119, v121
    v_mul_f32 v122, v122, v124
    v_mul_f32 v123, v123, v125
    v_mul_f32 v126, v126, v128
    v_mul_f32 v127, v127, v129
    v_mul_f32 v130, v130, v132
    v_mul_f32 v131, v131, v133
    v_cvt_pk_bf16_f32 v149, v119, v118
    v_cvt_pk_bf16_f32 v148, v123, v122
    v_cvt_pk_bf16_f32 v147, v127, v126
    v_cvt_pk_bf16_f32 v146, v131, v130
    buffer_store_dwordx4 v[146:149], v12, s[8:11], s4 offen offset:3072
    v_alignbit_b32 v84, v51, v50, 16
    v_alignbit_b32 v85, v52, v51, 16
    v_alignbit_b32 v86, v53, v52, 16
    v_alignbit_b32 v87, v54, v53, 16
    v_alignbit_b32 v88, v55, v54, 16
    v_alignbit_b32 v89, v56, v55, 16
    v_alignbit_b32 v90, v57, v56, 16
    v_alignbit_b32 v91, v58, v57, 16
    v_alignbit_b32 v92, v59, v58, 16
    v_alignbit_b32 v93, v60, v59, 16
    v_alignbit_b32 v94, v61, v60, 16
    v_alignbit_b32 v95, v62, v61, 16
    v_alignbit_b32 v96, v63, v62, 16
    v_alignbit_b32 v97, v64, v63, 16
    v_alignbit_b32 v98, v65, v64, 16
    v_alignbit_b32 v99, v66, v65, 16
    v_alignbit_b32 v100, v67, v66, 16
    v_dot2_f32_bf16 v102, v84, v199, 0
    v_dot2_f32_bf16 v103, v51, v199, 0
    v_dot2_f32_bf16 v106, v85, v199, 0
    v_dot2_f32_bf16 v107, v52, v199, 0
    v_dot2_f32_bf16 v110, v86, v199, 0
    v_dot2_f32_bf16 v111, v53, v199, 0
    v_dot2_f32_bf16 v114, v87, v199, 0
    v_dot2_f32_bf16 v115, v54, v199, 0
    v_dot2_f32_bf16 v102, v85, v198, v102
    v_dot2_f32_bf16 v103, v52, v198, v103
    v_dot2_f32_bf16 v106, v86, v198, v106
    v_dot2_f32_bf16 v107, v53, v198, v107
    v_dot2_f32_bf16 v110, v87, v198, v110
    v_dot2_f32_bf16 v111, v54, v198, v111
    v_dot2_f32_bf16 v114, v88, v198, v114
    v_dot2_f32_bf16 v115, v55, v198, v115
    v_lshlrev_b32 v104, 16, v68
    v_and_b32 v105, 0xffff0000, v68
    v_lshlrev_b32 v108, 16, v69
    v_and_b32 v109, 0xffff0000, v69
    v_lshlrev_b32 v112, 16, v70
    v_and_b32 v113, 0xffff0000, v70
    v_lshlrev_b32 v116, 16, v71
    v_and_b32 v117, 0xffff0000, v71
    v_mul_f32 v102, v102, v104
    v_mul_f32 v103, v103, v105
    v_mul_f32 v106, v106, v108
    v_mul_f32 v107, v107, v109
    v_mul_f32 v110, v110, v112
    v_mul_f32 v111, v111, v113
    v_mul_f32 v114, v114, v116
    v_mul_f32 v115, v115, v117
    v_cvt_pk_bf16_f32 v153, v103, v102
    v_cvt_pk_bf16_f32 v152, v107, v106
    v_cvt_pk_bf16_f32 v151, v111, v110
    v_cvt_pk_bf16_f32 v150, v115, v114
    s_add_u32 s4, s72, 65728
    buffer_store_dwordx4 v[150:153], v12, s[8:11], s4 offen offset:0
    v_dot2_f32_bf16 v118, v88, v199, 0
    v_dot2_f32_bf16 v119, v55, v199, 0
    v_dot2_f32_bf16 v122, v89, v199, 0
    v_dot2_f32_bf16 v123, v56, v199, 0
    v_dot2_f32_bf16 v126, v90, v199, 0
    v_dot2_f32_bf16 v127, v57, v199, 0
    v_dot2_f32_bf16 v130, v91, v199, 0
    v_dot2_f32_bf16 v131, v58, v199, 0
    v_dot2_f32_bf16 v118, v89, v198, v118
    v_dot2_f32_bf16 v119, v56, v198, v119
    v_dot2_f32_bf16 v122, v90, v198, v122
    v_dot2_f32_bf16 v123, v57, v198, v123
    v_dot2_f32_bf16 v126, v91, v198, v126
    v_dot2_f32_bf16 v127, v58, v198, v127
    v_dot2_f32_bf16 v130, v92, v198, v130
    v_dot2_f32_bf16 v131, v59, v198, v131
    v_lshlrev_b32 v120, 16, v72
    v_and_b32 v121, 0xffff0000, v72
    v_lshlrev_b32 v124, 16, v73
    v_and_b32 v125, 0xffff0000, v73
    v_lshlrev_b32 v128, 16, v74
    v_and_b32 v129, 0xffff0000, v74
    v_lshlrev_b32 v132, 16, v75
    v_and_b32 v133, 0xffff0000, v75
    v_mul_f32 v118, v118, v120
    v_mul_f32 v119, v119, v121
    v_mul_f32 v122, v122, v124
    v_mul_f32 v123, v123, v125
    v_mul_f32 v126, v126, v128
    v_mul_f32 v127, v127, v129
    v_mul_f32 v130, v130, v132
    v_mul_f32 v131, v131, v133
    v_cvt_pk_bf16_f32 v157, v119, v118
    v_cvt_pk_bf16_f32 v156, v123, v122
    v_cvt_pk_bf16_f32 v155, v127, v126
    v_cvt_pk_bf16_f32 v154, v131, v130
    buffer_store_dwordx4 v[154:157], v12, s[8:11], s4 offen offset:1024
    v_dot2_f32_bf16 v102, v92, v199, 0
    v_dot2_f32_bf16 v103, v59, v199, 0
    v_dot2_f32_bf16 v106, v93, v199, 0
    v_dot2_f32_bf16 v107, v60, v199, 0
    v_dot2_f32_bf16 v110, v94, v199, 0
    v_dot2_f32_bf16 v111, v61, v199, 0
    v_dot2_f32_bf16 v114, v95, v199, 0
    v_dot2_f32_bf16 v115, v62, v199, 0
    v_dot2_f32_bf16 v102, v93, v198, v102
    v_dot2_f32_bf16 v103, v60, v198, v103
    v_dot2_f32_bf16 v106, v94, v198, v106
    v_dot2_f32_bf16 v107, v61, v198, v107
    v_dot2_f32_bf16 v110, v95, v198, v110
    v_dot2_f32_bf16 v111, v62, v198, v111
    v_dot2_f32_bf16 v114, v96, v198, v114
    v_dot2_f32_bf16 v115, v63, v198, v115
    v_lshlrev_b32 v104, 16, v76
    v_and_b32 v105, 0xffff0000, v76
    v_lshlrev_b32 v108, 16, v77
    v_and_b32 v109, 0xffff0000, v77
    v_lshlrev_b32 v112, 16, v78
    v_and_b32 v113, 0xffff0000, v78
    v_lshlrev_b32 v116, 16, v79
    v_and_b32 v117, 0xffff0000, v79
    v_mul_f32 v102, v102, v104
    v_mul_f32 v103, v103, v105
    v_mul_f32 v106, v106, v108
    v_mul_f32 v107, v107, v109
    v_mul_f32 v110, v110, v112
    v_mul_f32 v111, v111, v113
    v_mul_f32 v114, v114, v116
    v_mul_f32 v115, v115, v117
    v_cvt_pk_bf16_f32 v161, v103, v102
    v_cvt_pk_bf16_f32 v160, v107, v106
    v_cvt_pk_bf16_f32 v159, v111, v110
    v_cvt_pk_bf16_f32 v158, v115, v114
    buffer_store_dwordx4 v[158:161], v12, s[8:11], s4 offen offset:2048
    v_dot2_f32_bf16 v118, v96, v199, 0
    v_dot2_f32_bf16 v119, v63, v199, 0
    v_dot2_f32_bf16 v122, v97, v199, 0
    v_dot2_f32_bf16 v123, v64, v199, 0
    v_dot2_f32_bf16 v126, v98, v199, 0
    v_dot2_f32_bf16 v127, v65, v199, 0
    v_dot2_f32_bf16 v130, v99, v199, 0
    v_dot2_f32_bf16 v131, v66, v199, 0
    v_dot2_f32_bf16 v118, v97, v198, v118
    v_dot2_f32_bf16 v119, v64, v198, v119
    v_dot2_f32_bf16 v122, v98, v198, v122
    v_dot2_f32_bf16 v123, v65, v198, v123
    v_dot2_f32_bf16 v126, v99, v198, v126
    v_dot2_f32_bf16 v127, v66, v198, v127
    v_dot2_f32_bf16 v130, v100, v198, v130
    v_dot2_f32_bf16 v131, v67, v198, v131
    v_lshlrev_b32 v120, 16, v80
    v_and_b32 v121, 0xffff0000, v80
    v_lshlrev_b32 v124, 16, v81
    v_and_b32 v125, 0xffff0000, v81
    v_lshlrev_b32 v128, 16, v82
    v_and_b32 v129, 0xffff0000, v82
    v_lshlrev_b32 v132, 16, v83
    v_and_b32 v133, 0xffff0000, v83
    v_mul_f32 v118, v118, v120
    v_mul_f32 v119, v119, v121
    v_mul_f32 v122, v122, v124
    v_mul_f32 v123, v123, v125
    v_mul_f32 v126, v126, v128
    v_mul_f32 v127, v127, v129
    v_mul_f32 v130, v130, v132
    v_mul_f32 v131, v131, v133
    v_cvt_pk_bf16_f32 v165, v119, v118
    v_cvt_pk_bf16_f32 v164, v123, v122
    v_cvt_pk_bf16_f32 v163, v127, v126
    v_cvt_pk_bf16_f32 v162, v131, v130
    buffer_store_dwordx4 v[162:165], v12, s[8:11], s4 offen offset:3072
    s_waitcnt vmcnt(0)
    s_barrier
    s_load_dwordx4 s[52:55], s[0:1], 32
    s_lshl_b32 s3, s93, 5
    s_lshl_b32 s4, s24, 3
    s_add_u32 s3, s3, s4
    s_lshl_b32 s4, s3, 1
    s_waitcnt lgkmcnt(0)
    s_load_dwordx4 s[64:67], s[54:55], s4

    s_mov_b32 s28, s52
    s_and_b32 s29, s53, 0xffff
    s_mov_b32 s30, 0x400000
    s_mov_b32 s31, 0x00020000

    v_and_b32 v1, 63, v0
    v_and_b32 v2, 15, v1
    v_lshrrev_b32 v3, 4, v1

    s_lshl_b32 s32, s3, 12
    s_add_u32 s33, s32, 28672
    s_mul_i32 s34, s24, 38400
    s_add_u32 s35, s34, 33536
    s_add_u32 s38, s32, 117440512
    v_lshlrev_b32 v4, 4, v1
    v_add_u32 v5, s34, v4
    v_add_u32 v5, 64, v5
    v_sub_u32 v6, 7, v2
    v_and_b32 v6, 7, v6
    v_mul_u32_u24 v6, 4160, v6
    v_lshrrev_b32 v7, 3, v2
    v_sub_u32 v7, v7, v3
    v_add_u32 v7, 4, v7
    v_lshl_add_u32 v6, v7, 4, v6
    v_add_u32 v6, s34, v6
    v_mul_u32_u24 v7, 80, v3
    v_add_u32 v7, v7, v2
    v_lshlrev_b32 v7, 4, v7
    v_add_u32 v7, s34, v7
    v_add_u32 v7, 33296, v7
    v_lshlrev_b32 v228, 7, v2
    v_lshl_add_u32 v228, v3, 4, v228
    v_subrev_u32 v229, 16, v4
    v_max_i32 v230, 0, v229
    v_sub_u32 v232, 7, v2
    v_and_b32 v232, 7, v232
    v_and_b32 v233, 1, v232
    v_lshlrev_b32 v233, 4, v233
    v_mov_b32 v234, 0xffff
    v_lshlrev_b32 v233, v233, v234
    v_lshrrev_b32 v232, 1, v232
    v_lshrrev_b32 v234, 3, v2
    v_sub_u32 v234, v3, v234
    v_lshl_add_u32 v232, v234, 1, v232
    v_and_b32 v234, 1, v234
    v_lshl_add_u32 v232, v234, 8, v232

    v_cmp_eq_u32 vcc, 0, v232
    s_nop 1
    v_cndmask_b32 v8, 0, v233, vcc
    v_cmp_eq_u32 vcc, 1, v232
    s_nop 1
    v_cndmask_b32 v9, 0, v233, vcc
    v_cmp_eq_u32 vcc, 2, v232
    s_nop 1
    v_cndmask_b32 v10, 0, v233, vcc
    v_cmp_eq_u32 vcc, 3, v232
    s_nop 1
    v_cndmask_b32 v11, 0, v233, vcc
    v_cmp_eq_u32 vcc, 4, v232
    s_nop 1
    v_cndmask_b32 v12, 0, v233, vcc
    v_cmp_eq_u32 vcc, 5, v232
    s_nop 1
    v_cndmask_b32 v13, 0, v233, vcc
    v_cmp_eq_u32 vcc, 6, v232
    s_nop 1
    v_cndmask_b32 v14, 0, v233, vcc
    v_cmp_eq_u32 vcc, 7, v232
    s_nop 1
    v_cndmask_b32 v15, 0, v233, vcc
    v_mov_b32 v208, 0
    v_mov_b32 v209, 0
    v_mov_b32 v210, 0
    v_mov_b32 v211, 0
    v_lshrrev_b32 v232, 2, v1
    v_and_b32 v232, 7, v232
    v_mul_u32_u24 v232, 4160, v232
    v_and_b32 v233, 3, v1
    v_lshl_add_u32 v232, v233, 4, v232
    v_add_u32 v232, s34, v232
    ds_write_b128 v232, v[208:211]
    v_subrev_u32 v233, 16, v7
    ds_write_b128 v233, v[208:211]

    s_add_u32 s39, s32, 125829120
    buffer_load_dwordx4 v[176:179], v230, s[28:31], s32 offen offset:0
    buffer_load_dwordx4 v[180:183], v4, s[28:31], s32 offen offset:0
    buffer_load_dwordx4 v[184:187], v4, s[28:31], s32 offen offset:1008
    buffer_load_dwordx4 v[188:191], v4, s[28:31], s32 offen offset:1024
    buffer_load_dwordx4 v[192:195], v4, s[28:31], s32 offen offset:2032
    buffer_load_dwordx4 v[196:199], v4, s[28:31], s32 offen offset:2048
    buffer_load_dwordx4 v[200:203], v4, s[28:31], s32 offen offset:3056
    buffer_load_dwordx4 v[204:207], v4, s[28:31], s32 offen offset:3072
    s_add_u32 m0, s35, 0
    s_nop 0
    buffer_load_dwordx4 v4, s[8:11], s39 offen offset:0 lds
    s_add_u32 m0, s35, 256
    s_nop 0
    buffer_load_dwordx4 v4, s[8:11], s39 offen offset:1024 lds
    s_add_u32 m0, s35, 512
    s_nop 0
    buffer_load_dwordx4 v4, s[8:11], s39 offen offset:2048 lds
    s_add_u32 m0, s35, 768
    s_nop 0
    buffer_load_dwordx4 v4, s[8:11], s39 offen offset:3072 lds
    s_waitcnt vmcnt(0) lgkmcnt(0)
    s_pack_ll_b32_b16 s40, s64, s64
    s_add_u32 s36, s32, 4096
    s_add_u32 s37, s32, 8192
    s_add_u32 s39, s36, 125829120
    s_mov_b64 exec, 1
    v_mov_b32 v176, 0
    v_mov_b32 v177, 0
    v_mov_b32 v178, 0
    v_mov_b32 v179, 0
    s_mov_b64 exec, -1
    ds_write_b128 v5, v[180:183] offset:0
    ds_write_b128 v5, v[178:181] offset:16640
    v_mov_b32 v208, v177
    v_mov_b32 v209, v178
    v_mov_b32 v210, v179
    v_mov_b32 v211, v180
    ds_write_b128 v5, v[208:211] offset:24960
    v_mov_b32 v212, v181
    v_mov_b32 v213, v182
    ds_write_b128 v5, v[210:213] offset:8320
    v_alignbit_b32 v214, v177, v176, 16
    v_alignbit_b32 v215, v178, v177, 16
    v_alignbit_b32 v216, v179, v178, 16
    v_alignbit_b32 v217, v180, v179, 16
    ds_write_b128 v5, v[214:217] offset:29120
    v_alignbit_b32 v218, v181, v180, 16
    v_alignbit_b32 v219, v182, v181, 16
    ds_write_b128 v5, v[216:219] offset:12480
    v_alignbit_b32 v220, v178, v177, 16
    v_alignbit_b32 v221, v179, v178, 16
    v_alignbit_b32 v222, v180, v179, 16
    v_alignbit_b32 v223, v181, v180, 16
    ds_write_b128 v5, v[220:223] offset:20800
    v_alignbit_b32 v224, v182, v181, 16
    v_alignbit_b32 v225, v183, v182, 16
    ds_write_b128 v5, v[222:225] offset:4160
    buffer_load_dwordx4 v[176:179], v230, s[28:31], s36 offen offset:0
    buffer_load_dwordx4 v[180:183], v4, s[28:31], s36 offen offset:0
    ds_write_b128 v5, v[188:191] offset:1024
    ds_write_b128 v5, v[186:189] offset:17664
    v_mov_b32 v208, v185
    v_mov_b32 v209, v186
    v_mov_b32 v210, v187
    v_mov_b32 v211, v188
    ds_write_b128 v5, v[208:211] offset:25984
    v_mov_b32 v212, v189
    v_mov_b32 v213, v190
    ds_write_b128 v5, v[210:213] offset:9344
    v_alignbit_b32 v214, v185, v184, 16
    v_alignbit_b32 v215, v186, v185, 16
    v_alignbit_b32 v216, v187, v186, 16
    v_alignbit_b32 v217, v188, v187, 16
    ds_write_b128 v5, v[214:217] offset:30144
    v_alignbit_b32 v218, v189, v188, 16
    v_alignbit_b32 v219, v190, v189, 16
    ds_write_b128 v5, v[216:219] offset:13504
    v_alignbit_b32 v220, v186, v185, 16
    v_alignbit_b32 v221, v187, v186, 16
    v_alignbit_b32 v222, v188, v187, 16
    v_alignbit_b32 v223, v189, v188, 16
    ds_write_b128 v5, v[220:223] offset:21824
    v_alignbit_b32 v224, v190, v189, 16
    v_alignbit_b32 v225, v191, v190, 16
    ds_write_b128 v5, v[222:225] offset:5184
    buffer_load_dwordx4 v[184:187], v4, s[28:31], s36 offen offset:1008
    buffer_load_dwordx4 v[188:191], v4, s[28:31], s36 offen offset:1024
    v_and_b32 v236, s40, v8
    v_and_b32 v237, s40, v9
    v_and_b32 v238, s40, v10
    v_and_b32 v239, s40, v11
    v_and_b32 v240, s40, v12
    v_and_b32 v241, s40, v13
    v_and_b32 v242, s40, v14
    v_and_b32 v243, s40, v15
    ds_read_b128 a[60:63], v7 offset:240
    ds_read_b128 a[124:127], v7 offset:496
    ds_read_b128 a[188:191], v7 offset:752
    ds_read_b128 a[252:255], v7 offset:1008
    ds_read_b128 v[168:171], v6 offset:0
    ds_read_b128 v[172:175], v6 offset:32
    s_waitcnt vmcnt(0) lgkmcnt(0)
    s_mov_b32 s42, 0
.cvl_427:
    s_waitcnt lgkmcnt(5)
    v_mfma_f32_16x16x32_bf16 v[16:19], v[236:239], a[60:63], 0
    v_mfma_f32_16x16x32_bf16 v[32:35], v[240:243], a[60:63], 0
    s_waitcnt lgkmcnt(4)
    v_mfma_f32_16x16x32_bf16 v[20:23], v[236:239], a[124:127], 0
    v_mfma_f32_16x16x32_bf16 v[36:39], v[240:243], a[124:127], 0
    s_waitcnt lgkmcnt(3)
    v_mfma_f32_16x16x32_bf16 v[24:27], v[236:239], a[188:191], 0
    v_mfma_f32_16x16x32_bf16 v[40:43], v[240:243], a[188:191], 0
    ds_read_b128 a[56:59], v7 offset:224
    s_waitcnt lgkmcnt(3)
    v_mfma_f32_16x16x32_bf16 v[28:31], v[236:239], a[252:255], 0
    ds_read_b128 v[112:115], v6 offset:64
    v_mfma_f32_16x16x32_bf16 v[44:47], v[240:243], a[252:255], 0
    ds_read_b128 v[116:119], v6 offset:96
    s_waitcnt lgkmcnt(4)
    v_mfma_f32_16x16x32_bf16 v[16:19], v[168:171], a[60:63], v[16:19]
    ds_read_b128 a[120:123], v7 offset:480
    s_waitcnt lgkmcnt(4)
    v_mfma_f32_16x16x32_bf16 v[32:35], v[172:175], a[60:63], v[32:35]
    s_waitcnt vmcnt(18)
    v_mfma_f32_16x16x32_bf16 v[20:23], v[168:171], a[124:127], v[20:23]
    ds_read_b128 a[184:187], v7 offset:736
    v_mfma_f32_16x16x32_bf16 v[36:39], v[172:175], a[124:127], v[36:39]
    ds_write_b128 v5, v[196:199] offset:2048
    v_mfma_f32_16x16x32_bf16 v[24:27], v[168:171], a[188:191], v[24:27]
    ds_read_b128 a[248:251], v7 offset:992
    v_mfma_f32_16x16x32_bf16 v[40:43], v[172:175], a[188:191], v[40:43]
    ds_read_b128 a[52:55], v7 offset:208
    v_mfma_f32_16x16x32_bf16 v[28:31], v[168:171], a[252:255], v[28:31]
    ds_read_b128 v[120:123], v6 offset:128
    v_mfma_f32_16x16x32_bf16 v[44:47], v[172:175], a[252:255], v[44:47]
    ds_read_b128 v[124:127], v6 offset:160
    s_waitcnt lgkmcnt(8)
    v_mfma_f32_16x16x32_bf16 v[16:19], v[112:115], a[56:59], v[16:19]
    ds_read_b128 a[116:119], v7 offset:464
    s_waitcnt lgkmcnt(8)
    v_mfma_f32_16x16x32_bf16 v[32:35], v[116:119], a[56:59], v[32:35]
    ds_write_b128 v5, v[194:197] offset:18688
    s_waitcnt lgkmcnt(8)
    v_mfma_f32_16x16x32_bf16 v[20:23], v[112:115], a[120:123], v[20:23]
    ds_read_b128 a[180:183], v7 offset:720
    v_mfma_f32_16x16x32_bf16 v[36:39], v[116:119], a[120:123], v[36:39]
    v_mov_b32 v208, v193
    v_mov_b32 v209, v194
    s_waitcnt lgkmcnt(8)
    v_mfma_f32_16x16x32_bf16 v[24:27], v[112:115], a[184:187], v[24:27]
    ds_read_b128 a[244:247], v7 offset:976
    v_mfma_f32_16x16x32_bf16 v[40:43], v[116:119], a[184:187], v[40:43]
    ds_read_b128 a[48:51], v7 offset:192
    s_waitcnt lgkmcnt(8)
    v_mfma_f32_16x16x32_bf16 v[28:31], v[112:115], a[248:251], v[28:31]
    ds_read_b128 v[128:131], v6 offset:192
    v_mfma_f32_16x16x32_bf16 v[44:47], v[116:119], a[248:251], v[44:47]
    ds_read_b128 v[132:135], v6 offset:224
    s_waitcnt lgkmcnt(8)
    v_mfma_f32_16x16x32_bf16 v[16:19], v[120:123], a[52:55], v[16:19]
    ds_read_b128 a[112:115], v7 offset:448
    s_waitcnt lgkmcnt(8)
    v_mfma_f32_16x16x32_bf16 v[32:35], v[124:127], a[52:55], v[32:35]
    v_mov_b32 v210, v195
    v_mov_b32 v211, v196
    s_waitcnt lgkmcnt(7)
    v_mfma_f32_16x16x32_bf16 v[20:23], v[120:123], a[116:119], v[20:23]
    ds_read_b128 a[176:179], v7 offset:704
    v_mfma_f32_16x16x32_bf16 v[36:39], v[124:127], a[116:119], v[36:39]
    ds_write_b128 v5, v[208:211] offset:27008
    s_waitcnt lgkmcnt(7)
    v_mfma_f32_16x16x32_bf16 v[24:27], v[120:123], a[180:183], v[24:27]
    ds_read_b128 a[240:243], v7 offset:960
    v_mfma_f32_16x16x32_bf16 v[40:43], v[124:127], a[180:183], v[40:43]
    ds_read_b128 a[44:47], v7 offset:176
    s_waitcnt lgkmcnt(8)
    v_mfma_f32_16x16x32_bf16 v[28:31], v[120:123], a[244:247], v[28:31]
    ds_read_b128 v[136:139], v6 offset:256
    v_mfma_f32_16x16x32_bf16 v[44:47], v[124:127], a[244:247], v[44:47]
    ds_read_b128 v[140:143], v6 offset:288
    s_waitcnt lgkmcnt(8)
    v_mfma_f32_16x16x32_bf16 v[16:19], v[128:131], a[48:51], v[16:19]
    ds_read_b128 a[108:111], v7 offset:432
    s_waitcnt lgkmcnt(8)
    v_mfma_f32_16x16x32_bf16 v[32:35], v[132:135], a[48:51], v[32:35]
    v_mov_b32 v212, v197
    v_mov_b32 v213, v198
    s_waitcnt lgkmcnt(7)
    v_mfma_f32_16x16x32_bf16 v[20:23], v[128:131], a[112:115], v[20:23]
    ds_read_b128 a[172:175], v7 offset:688
    v_mfma_f32_16x16x32_bf16 v[36:39], v[132:135], a[112:115], v[36:39]
    ds_write_b128 v5, v[210:213] offset:10368
    s_waitcnt lgkmcnt(8)
    v_mfma_f32_16x16x32_bf16 v[24:27], v[128:131], a[176:179], v[24:27]
    ds_read_b128 a[236:239], v7 offset:944
    v_mfma_f32_16x16x32_bf16 v[40:43], v[132:135], a[176:179], v[40:43]
    ds_read_b128 a[40:43], v7 offset:160
    s_waitcnt lgkmcnt(8)
    v_mfma_f32_16x16x32_bf16 v[28:31], v[128:131], a[240:243], v[28:31]
    ds_read_b128 v[144:147], v6 offset:320
    v_mfma_f32_16x16x32_bf16 v[44:47], v[132:135], a[240:243], v[44:47]
    ds_read_b128 v[148:151], v6 offset:352
    s_waitcnt lgkmcnt(8)
    v_mfma_f32_16x16x32_bf16 v[16:19], v[136:139], a[44:47], v[16:19]
    ds_read_b128 a[104:107], v7 offset:416
    s_waitcnt lgkmcnt(8)
    v_mfma_f32_16x16x32_bf16 v[32:35], v[140:143], a[44:47], v[32:35]
    v_alignbit_b32 v214, v193, v192, 16
    v_alignbit_b32 v215, v194, v193, 16
    s_waitcnt lgkmcnt(7)
    v_mfma_f32_16x16x32_bf16 v[20:23], v[136:139], a[108:111], v[20:23]
    ds_read_b128 a[168:171], v7 offset:672
    v_mfma_f32_16x16x32_bf16 v[36:39], v[140:143], a[108:111], v[36:39]
    v_alignbit_b32 v216, v195, v194, 16
    v_alignbit_b32 v217, v196, v195, 16
    s_waitcnt lgkmcnt(7)
    v_mfma_f32_16x16x32_bf16 v[24:27], v[136:139], a[172:175], v[24:27]
    ds_read_b128 a[232:235], v7 offset:928
    v_mfma_f32_16x16x32_bf16 v[40:43], v[140:143], a[172:175], v[40:43]
    ds_read_b128 a[36:39], v7 offset:144
    s_waitcnt lgkmcnt(7)
    v_mfma_f32_16x16x32_bf16 v[28:31], v[136:139], a[236:239], v[28:31]
    ds_read_b128 v[152:155], v6 offset:384
    v_mfma_f32_16x16x32_bf16 v[44:47], v[140:143], a[236:239], v[44:47]
    ds_read_b128 v[156:159], v6 offset:416
    s_waitcnt lgkmcnt(7)
    v_mfma_f32_16x16x32_bf16 v[16:19], v[144:147], a[40:43], v[16:19]
    ds_read_b128 a[100:103], v7 offset:400
    s_waitcnt lgkmcnt(7)
    v_mfma_f32_16x16x32_bf16 v[32:35], v[148:151], a[40:43], v[32:35]
    ds_write_b128 v5, v[214:217] offset:31168
    s_waitcnt lgkmcnt(7)
    v_mfma_f32_16x16x32_bf16 v[20:23], v[144:147], a[104:107], v[20:23]
    ds_read_b128 a[164:167], v7 offset:656
    v_mfma_f32_16x16x32_bf16 v[36:39], v[148:151], a[104:107], v[36:39]
    v_alignbit_b32 v218, v197, v196, 16
    v_alignbit_b32 v219, v198, v197, 16
    s_waitcnt lgkmcnt(7)
    v_mfma_f32_16x16x32_bf16 v[24:27], v[144:147], a[168:171], v[24:27]
    ds_read_b128 a[228:231], v7 offset:912
    v_mfma_f32_16x16x32_bf16 v[40:43], v[148:151], a[168:171], v[40:43]
    ds_read_b128 a[32:35], v7 offset:128
    s_waitcnt lgkmcnt(8)
    v_mfma_f32_16x16x32_bf16 v[28:31], v[144:147], a[232:235], v[28:31]
    ds_read_b128 v[160:163], v6 offset:448
    v_mfma_f32_16x16x32_bf16 v[44:47], v[148:151], a[232:235], v[44:47]
    ds_read_b128 v[164:167], v6 offset:480
    s_waitcnt lgkmcnt(8)
    v_mfma_f32_16x16x32_bf16 v[16:19], v[152:155], a[36:39], v[16:19]
    ds_read_b128 a[96:99], v7 offset:384
    s_waitcnt lgkmcnt(8)
    v_mfma_f32_16x16x32_bf16 v[32:35], v[156:159], a[36:39], v[32:35]
    ds_write_b128 v5, v[216:219] offset:14528
    s_waitcnt lgkmcnt(8)
    v_mfma_f32_16x16x32_bf16 v[20:23], v[152:155], a[100:103], v[20:23]
    ds_read_b128 a[160:163], v7 offset:640
    v_mfma_f32_16x16x32_bf16 v[36:39], v[156:159], a[100:103], v[36:39]
    v_alignbit_b32 v220, v194, v193, 16
    v_alignbit_b32 v221, v195, v194, 16
    s_waitcnt lgkmcnt(7)
    v_mfma_f32_16x16x32_bf16 v[24:27], v[152:155], a[164:167], v[24:27]
    ds_read_b128 a[224:227], v7 offset:896
    v_mfma_f32_16x16x32_bf16 v[40:43], v[156:159], a[164:167], v[40:43]
    ds_read_b128 a[28:31], v7 offset:112
    s_waitcnt lgkmcnt(8)
    v_mfma_f32_16x16x32_bf16 v[28:31], v[152:155], a[228:231], v[28:31]
    ds_read_b128 v[168:171], v6 offset:512
    v_mfma_f32_16x16x32_bf16 v[44:47], v[156:159], a[228:231], v[44:47]
    ds_read_b128 v[172:175], v6 offset:544
    s_waitcnt lgkmcnt(8)
    v_mfma_f32_16x16x32_bf16 v[16:19], v[160:163], a[32:35], v[16:19]
    ds_read_b128 a[92:95], v7 offset:368
    s_waitcnt lgkmcnt(8)
    v_mfma_f32_16x16x32_bf16 v[32:35], v[164:167], a[32:35], v[32:35]
    v_alignbit_b32 v222, v196, v195, 16
    v_alignbit_b32 v223, v197, v196, 16
    s_waitcnt lgkmcnt(7)
    v_mfma_f32_16x16x32_bf16 v[20:23], v[160:163], a[96:99], v[20:23]
    ds_read_b128 a[156:159], v7 offset:624
    v_mfma_f32_16x16x32_bf16 v[36:39], v[164:167], a[96:99], v[36:39]
    ds_write_b128 v5, v[220:223] offset:22848
    s_waitcnt lgkmcnt(7)
    v_mfma_f32_16x16x32_bf16 v[24:27], v[160:163], a[160:163], v[24:27]
    ds_read_b128 a[220:223], v7 offset:880
    v_mfma_f32_16x16x32_bf16 v[40:43], v[164:167], a[160:163], v[40:43]
    ds_read_b128 a[24:27], v7 offset:96
    s_waitcnt lgkmcnt(8)
    v_mfma_f32_16x16x32_bf16 v[28:31], v[160:163], a[224:227], v[28:31]
    ds_read_b128 v[112:115], v6 offset:576
    v_mfma_f32_16x16x32_bf16 v[44:47], v[164:167], a[224:227], v[44:47]
    ds_read_b128 v[116:119], v6 offset:608
    s_waitcnt lgkmcnt(8)
    v_mfma_f32_16x16x32_bf16 v[16:19], v[168:171], a[28:31], v[16:19]
    ds_read_b128 a[88:91], v7 offset:352
    s_waitcnt lgkmcnt(8)
    v_mfma_f32_16x16x32_bf16 v[32:35], v[172:175], a[28:31], v[32:35]
    v_alignbit_b32 v224, v198, v197, 16
    v_alignbit_b32 v225, v199, v198, 16
    s_waitcnt lgkmcnt(7)
    v_mfma_f32_16x16x32_bf16 v[20:23], v[168:171], a[92:95], v[20:23]
    ds_read_b128 a[152:155], v7 offset:608
    v_mfma_f32_16x16x32_bf16 v[36:39], v[172:175], a[92:95], v[36:39]
    ds_write_b128 v5, v[222:225] offset:6208
    s_waitcnt lgkmcnt(8)
    v_mfma_f32_16x16x32_bf16 v[24:27], v[168:171], a[156:159], v[24:27]
    ds_read_b128 a[216:219], v7 offset:864
    v_mfma_f32_16x16x32_bf16 v[40:43], v[172:175], a[156:159], v[40:43]
    ds_read_b128 a[20:23], v7 offset:80
    s_waitcnt lgkmcnt(8)
    v_mfma_f32_16x16x32_bf16 v[28:31], v[168:171], a[220:223], v[28:31]
    ds_read_b128 v[120:123], v6 offset:640
    v_mfma_f32_16x16x32_bf16 v[44:47], v[172:175], a[220:223], v[44:47]
    ds_read_b128 v[124:127], v6 offset:672
    s_waitcnt lgkmcnt(8)
    v_mfma_f32_16x16x32_bf16 v[16:19], v[112:115], a[24:27], v[16:19]
    ds_read_b128 a[84:87], v7 offset:336
    s_waitcnt lgkmcnt(8)
    v_mfma_f32_16x16x32_bf16 v[32:35], v[116:119], a[24:27], v[32:35]
    buffer_load_dwordx4 v[192:195], v4, s[28:31], s36 offen offset:2032
    s_waitcnt lgkmcnt(7)
    v_mfma_f32_16x16x32_bf16 v[20:23], v[112:115], a[88:91], v[20:23]
    ds_read_b128 a[148:151], v7 offset:592
    v_mfma_f32_16x16x32_bf16 v[36:39], v[116:119], a[88:91], v[36:39]
    buffer_load_dwordx4 v[196:199], v4, s[28:31], s36 offen offset:2048
    s_waitcnt lgkmcnt(7)
    v_mfma_f32_16x16x32_bf16 v[24:27], v[112:115], a[152:155], v[24:27]
    ds_read_b128 a[212:215], v7 offset:848
    v_mfma_f32_16x16x32_bf16 v[40:43], v[116:119], a[152:155], v[40:43]
    ds_read_b128 a[16:19], v7 offset:64
    s_waitcnt lgkmcnt(7)
    v_mfma_f32_16x16x32_bf16 v[28:31], v[112:115], a[216:219], v[28:31]
    ds_read_b128 v[128:131], v6 offset:704
    v_mfma_f32_16x16x32_bf16 v[44:47], v[116:119], a[216:219], v[44:47]
    ds_read_b128 v[132:135], v6 offset:736
    s_waitcnt lgkmcnt(7)
    v_mfma_f32_16x16x32_bf16 v[16:19], v[120:123], a[20:23], v[16:19]
    ds_read_b128 a[80:83], v7 offset:320
    s_waitcnt lgkmcnt(7)
    v_mfma_f32_16x16x32_bf16 v[32:35], v[124:127], a[20:23], v[32:35]
    s_waitcnt vmcnt(18)
    s_waitcnt lgkmcnt(6)
    v_mfma_f32_16x16x32_bf16 v[20:23], v[120:123], a[84:87], v[20:23]
    ds_read_b128 a[144:147], v7 offset:576
    v_mfma_f32_16x16x32_bf16 v[36:39], v[124:127], a[84:87], v[36:39]
    ds_write_b128 v5, v[204:207] offset:3072
    s_waitcnt lgkmcnt(7)
    v_mfma_f32_16x16x32_bf16 v[24:27], v[120:123], a[148:151], v[24:27]
    ds_read_b128 a[208:211], v7 offset:832
    v_mfma_f32_16x16x32_bf16 v[40:43], v[124:127], a[148:151], v[40:43]
    ds_read_b128 a[12:15], v7 offset:48
    s_waitcnt lgkmcnt(8)
    v_mfma_f32_16x16x32_bf16 v[28:31], v[120:123], a[212:215], v[28:31]
    ds_read_b128 v[136:139], v6 offset:768
    v_mfma_f32_16x16x32_bf16 v[44:47], v[124:127], a[212:215], v[44:47]
    ds_read_b128 v[140:143], v6 offset:800
    s_waitcnt lgkmcnt(8)
    v_mfma_f32_16x16x32_bf16 v[16:19], v[128:131], a[16:19], v[16:19]
    ds_read_b128 a[76:79], v7 offset:304
    s_waitcnt lgkmcnt(8)
    v_mfma_f32_16x16x32_bf16 v[32:35], v[132:135], a[16:19], v[32:35]
    ds_write_b128 v5, v[202:205] offset:19712
    s_waitcnt lgkmcnt(8)
    v_mfma_f32_16x16x32_bf16 v[20:23], v[128:131], a[80:83], v[20:23]
    ds_read_b128 a[140:143], v7 offset:560
    v_mfma_f32_16x16x32_bf16 v[36:39], v[132:135], a[80:83], v[36:39]
    v_mov_b32 v208, v201
    v_mov_b32 v209, v202
    s_waitcnt lgkmcnt(8)
    v_mfma_f32_16x16x32_bf16 v[24:27], v[128:131], a[144:147], v[24:27]
    ds_read_b128 a[204:207], v7 offset:816
    v_mfma_f32_16x16x32_bf16 v[40:43], v[132:135], a[144:147], v[40:43]
    ds_read_b128 a[8:11], v7 offset:32
    s_waitcnt lgkmcnt(8)
    v_mfma_f32_16x16x32_bf16 v[28:31], v[128:131], a[208:211], v[28:31]
    ds_read_b128 v[144:147], v6 offset:832
    v_mfma_f32_16x16x32_bf16 v[44:47], v[132:135], a[208:211], v[44:47]
    ds_read_b128 v[148:151], v6 offset:864
    s_waitcnt lgkmcnt(8)
    v_mfma_f32_16x16x32_bf16 v[16:19], v[136:139], a[12:15], v[16:19]
    ds_read_b128 a[72:75], v7 offset:288
    s_waitcnt lgkmcnt(8)
    v_mfma_f32_16x16x32_bf16 v[32:35], v[140:143], a[12:15], v[32:35]
    v_mov_b32 v210, v203
    v_mov_b32 v211, v204
    s_waitcnt lgkmcnt(7)
    v_mfma_f32_16x16x32_bf16 v[20:23], v[136:139], a[76:79], v[20:23]
    ds_read_b128 a[136:139], v7 offset:544
    v_mfma_f32_16x16x32_bf16 v[36:39], v[140:143], a[76:79], v[36:39]
    ds_write_b128 v5, v[208:211] offset:28032
    s_waitcnt lgkmcnt(7)
    v_mfma_f32_16x16x32_bf16 v[24:27], v[136:139], a[140:143], v[24:27]
    ds_read_b128 a[200:203], v7 offset:800
    v_mfma_f32_16x16x32_bf16 v[40:43], v[140:143], a[140:143], v[40:43]
    ds_read_b128 a[4:7], v7 offset:16
    s_waitcnt lgkmcnt(8)
    v_mfma_f32_16x16x32_bf16 v[28:31], v[136:139], a[204:207], v[28:31]
    ds_read_b128 v[152:155], v6 offset:896
    v_mfma_f32_16x16x32_bf16 v[44:47], v[140:143], a[204:207], v[44:47]
    ds_read_b128 v[156:159], v6 offset:928
    s_waitcnt lgkmcnt(8)
    v_mfma_f32_16x16x32_bf16 v[16:19], v[144:147], a[8:11], v[16:19]
    ds_read_b128 a[68:71], v7 offset:272
    s_waitcnt lgkmcnt(8)
    v_mfma_f32_16x16x32_bf16 v[32:35], v[148:151], a[8:11], v[32:35]
    v_mov_b32 v212, v205
    v_mov_b32 v213, v206
    s_waitcnt lgkmcnt(7)
    v_mfma_f32_16x16x32_bf16 v[20:23], v[144:147], a[72:75], v[20:23]
    ds_read_b128 a[132:135], v7 offset:528
    v_mfma_f32_16x16x32_bf16 v[36:39], v[148:151], a[72:75], v[36:39]
    ds_write_b128 v5, v[210:213] offset:11392
    s_waitcnt lgkmcnt(8)
    v_mfma_f32_16x16x32_bf16 v[24:27], v[144:147], a[136:139], v[24:27]
    ds_read_b128 a[196:199], v7 offset:784
    v_mfma_f32_16x16x32_bf16 v[40:43], v[148:151], a[136:139], v[40:43]
    ds_read_b128 a[0:3], v7 offset:0
    s_waitcnt lgkmcnt(8)
    v_mfma_f32_16x16x32_bf16 v[28:31], v[144:147], a[200:203], v[28:31]
    ds_read_b128 v[160:163], v6 offset:960
    v_mfma_f32_16x16x32_bf16 v[44:47], v[148:151], a[200:203], v[44:47]
    ds_read_b128 v[164:167], v6 offset:992
    s_waitcnt lgkmcnt(8)
    v_mfma_f32_16x16x32_bf16 v[16:19], v[152:155], a[4:7], v[16:19]
    ds_read_b128 a[64:67], v7 offset:256
    s_waitcnt lgkmcnt(8)
    v_mfma_f32_16x16x32_bf16 v[32:35], v[156:159], a[4:7], v[32:35]
    v_alignbit_b32 v214, v201, v200, 16
    v_alignbit_b32 v215, v202, v201, 16
    s_waitcnt lgkmcnt(7)
    v_mfma_f32_16x16x32_bf16 v[20:23], v[152:155], a[68:71], v[20:23]
    ds_read_b128 a[128:131], v7 offset:512
    v_mfma_f32_16x16x32_bf16 v[36:39], v[156:159], a[68:71], v[36:39]
    v_alignbit_b32 v216, v203, v202, 16
    v_alignbit_b32 v217, v204, v203, 16
    s_waitcnt lgkmcnt(7)
    v_mfma_f32_16x16x32_bf16 v[24:27], v[152:155], a[132:135], v[24:27]
    ds_read_b128 a[192:195], v7 offset:768
    v_mfma_f32_16x16x32_bf16 v[40:43], v[156:159], a[132:135], v[40:43]
    ds_write_b128 v5, v[214:217] offset:32192
    s_waitcnt lgkmcnt(7)
    v_mfma_f32_16x16x32_bf16 v[28:31], v[152:155], a[196:199], v[28:31]
    ds_read_b128 v[168:171], v6 offset:1024
    v_mfma_f32_16x16x32_bf16 v[44:47], v[156:159], a[196:199], v[44:47]
    ds_read_b128 v[172:175], v6 offset:1056
    s_waitcnt lgkmcnt(7)
    v_mfma_f32_16x16x32_bf16 v[16:19], v[160:163], a[0:3], v[16:19]
    v_alignbit_b32 v218, v205, v204, 16
    v_alignbit_b32 v219, v206, v205, 16
    s_waitcnt lgkmcnt(6)
    v_mfma_f32_16x16x32_bf16 v[32:35], v[164:167], a[0:3], v[32:35]
    ds_write_b128 v5, v[216:219] offset:15552
    s_waitcnt lgkmcnt(6)
    v_mfma_f32_16x16x32_bf16 v[20:23], v[160:163], a[64:67], v[20:23]
    v_alignbit_b32 v220, v202, v201, 16
    v_alignbit_b32 v221, v203, v202, 16
    v_mfma_f32_16x16x32_bf16 v[36:39], v[164:167], a[64:67], v[36:39]
    v_alignbit_b32 v222, v204, v203, 16
    v_alignbit_b32 v223, v205, v204, 16
    s_waitcnt lgkmcnt(5)
    v_mfma_f32_16x16x32_bf16 v[24:27], v[160:163], a[128:131], v[24:27]
    ds_read_b128 v[112:115], v6 offset:1088
    v_mfma_f32_16x16x32_bf16 v[40:43], v[164:167], a[128:131], v[40:43]
    ds_read_b128 v[116:119], v6 offset:1120
    s_waitcnt lgkmcnt(6)
    v_mfma_f32_16x16x32_bf16 v[28:31], v[160:163], a[192:195], v[28:31]
    ds_write_b128 v5, v[220:223] offset:23872
    v_mfma_f32_16x16x32_bf16 v[44:47], v[164:167], a[192:195], v[44:47]
    v_alignbit_b32 v224, v206, v205, 16
    v_alignbit_b32 v225, v207, v206, 16
    s_waitcnt lgkmcnt(5)
    v_mfma_f32_16x16x32_bf16 v[20:23], v[168:171], a[60:63], v[20:23]
    ds_write_b128 v5, v[222:225] offset:7232
    s_waitcnt lgkmcnt(5)
    v_mfma_f32_16x16x32_bf16 v[36:39], v[172:175], a[60:63], v[36:39]
    buffer_load_dwordx4 v[200:203], v4, s[28:31], s36 offen offset:3056
    v_mfma_f32_16x16x32_bf16 v[24:27], v[168:171], a[124:127], v[24:27]
    ds_read_b128 v[120:123], v6 offset:1152
    v_mfma_f32_16x16x32_bf16 v[40:43], v[172:175], a[124:127], v[40:43]
    ds_read_b128 v[124:127], v6 offset:1184
    v_mfma_f32_16x16x32_bf16 v[28:31], v[168:171], a[188:191], v[28:31]
    buffer_load_dwordx4 v[204:207], v4, s[28:31], s36 offen offset:3072
    v_mfma_f32_16x16x32_bf16 v[44:47], v[172:175], a[188:191], v[44:47]
    s_waitcnt vmcnt(18)
    s_mov_b64 exec, 1
    v_mov_b32 v176, 0
    v_mov_b32 v177, 0
    v_mov_b32 v178, 0
    v_mov_b32 v179, 0
    s_mov_b64 exec, -1
    s_waitcnt lgkmcnt(5)
    v_mfma_f32_16x16x32_bf16 v[20:23], v[112:115], a[56:59], v[20:23]
    ds_write_b128 v5, v[180:183] offset:0
    s_waitcnt lgkmcnt(5)
    v_mfma_f32_16x16x32_bf16 v[36:39], v[116:119], a[56:59], v[36:39]
    ds_write_b128 v5, v[178:181] offset:16640
    v_mfma_f32_16x16x32_bf16 v[24:27], v[112:115], a[120:123], v[24:27]
    ds_read_b128 v[128:131], v6 offset:1216
    v_mfma_f32_16x16x32_bf16 v[40:43], v[116:119], a[120:123], v[40:43]
    ds_read_b128 v[132:135], v6 offset:1248
    v_mfma_f32_16x16x32_bf16 v[28:31], v[112:115], a[184:187], v[28:31]
    v_mov_b32 v208, v177
    v_mov_b32 v209, v178
    v_mfma_f32_16x16x32_bf16 v[44:47], v[116:119], a[184:187], v[44:47]
    v_mov_b32 v210, v179
    v_mov_b32 v211, v180
    s_waitcnt lgkmcnt(5)
    v_mfma_f32_16x16x32_bf16 v[20:23], v[120:123], a[52:55], v[20:23]
    ds_write_b128 v5, v[208:211] offset:24960
    s_waitcnt lgkmcnt(5)
    v_mfma_f32_16x16x32_bf16 v[36:39], v[124:127], a[52:55], v[36:39]
    v_mov_b32 v212, v181
    v_mov_b32 v213, v182
    v_mfma_f32_16x16x32_bf16 v[24:27], v[120:123], a[116:119], v[24:27]
    ds_read_b128 v[136:139], v6 offset:1280
    v_mfma_f32_16x16x32_bf16 v[40:43], v[124:127], a[116:119], v[40:43]
    ds_read_b128 v[140:143], v6 offset:1312
    v_mfma_f32_16x16x32_bf16 v[28:31], v[120:123], a[180:183], v[28:31]
    ds_write_b128 v5, v[210:213] offset:8320
    v_mfma_f32_16x16x32_bf16 v[44:47], v[124:127], a[180:183], v[44:47]
    v_alignbit_b32 v214, v177, v176, 16
    v_alignbit_b32 v215, v178, v177, 16
    s_waitcnt lgkmcnt(5)
    v_mfma_f32_16x16x32_bf16 v[20:23], v[128:131], a[48:51], v[20:23]
    v_alignbit_b32 v216, v179, v178, 16
    v_alignbit_b32 v217, v180, v179, 16
    s_waitcnt lgkmcnt(4)
    v_mfma_f32_16x16x32_bf16 v[36:39], v[132:135], a[48:51], v[36:39]
    ds_write_b128 v5, v[214:217] offset:29120
    v_mfma_f32_16x16x32_bf16 v[24:27], v[128:131], a[112:115], v[24:27]
    ds_read_b128 v[144:147], v6 offset:1344
    v_mfma_f32_16x16x32_bf16 v[40:43], v[132:135], a[112:115], v[40:43]
    ds_read_b128 v[148:151], v6 offset:1376
    v_mfma_f32_16x16x32_bf16 v[28:31], v[128:131], a[176:179], v[28:31]
    v_alignbit_b32 v218, v181, v180, 16
    v_alignbit_b32 v219, v182, v181, 16
    v_mfma_f32_16x16x32_bf16 v[44:47], v[132:135], a[176:179], v[44:47]
    ds_write_b128 v5, v[216:219] offset:12480
    s_waitcnt lgkmcnt(6)
    v_mfma_f32_16x16x32_bf16 v[20:23], v[136:139], a[44:47], v[20:23]
    v_alignbit_b32 v220, v178, v177, 16
    v_alignbit_b32 v221, v179, v178, 16
    s_waitcnt lgkmcnt(5)
    v_mfma_f32_16x16x32_bf16 v[36:39], v[140:143], a[44:47], v[36:39]
    v_alignbit_b32 v222, v180, v179, 16
    v_alignbit_b32 v223, v181, v180, 16
    v_mfma_f32_16x16x32_bf16 v[24:27], v[136:139], a[108:111], v[24:27]
    ds_read_b128 v[152:155], v6 offset:1408
    v_mfma_f32_16x16x32_bf16 v[40:43], v[140:143], a[108:111], v[40:43]
    ds_read_b128 v[156:159], v6 offset:1440
    v_mfma_f32_16x16x32_bf16 v[28:31], v[136:139], a[172:175], v[28:31]
    ds_write_b128 v5, v[220:223] offset:20800
    v_mfma_f32_16x16x32_bf16 v[44:47], v[140:143], a[172:175], v[44:47]
    v_alignbit_b32 v224, v182, v181, 16
    v_alignbit_b32 v225, v183, v182, 16
    s_waitcnt lgkmcnt(5)
    v_mfma_f32_16x16x32_bf16 v[20:23], v[144:147], a[40:43], v[20:23]
    ds_write_b128 v5, v[222:225] offset:4160
    s_waitcnt lgkmcnt(5)
    v_mfma_f32_16x16x32_bf16 v[36:39], v[148:151], a[40:43], v[36:39]
    buffer_load_dwordx4 v[176:179], v230, s[28:31], s37 offen offset:0
    v_mfma_f32_16x16x32_bf16 v[24:27], v[144:147], a[104:107], v[24:27]
    ds_read_b128 v[160:163], v6 offset:1472
    v_mfma_f32_16x16x32_bf16 v[40:43], v[148:151], a[104:107], v[40:43]
    ds_read_b128 v[164:167], v6 offset:1504
    v_mfma_f32_16x16x32_bf16 v[28:31], v[144:147], a[168:171], v[28:31]
    buffer_load_dwordx4 v[180:183], v4, s[28:31], s37 offen offset:0
    v_mfma_f32_16x16x32_bf16 v[44:47], v[148:151], a[168:171], v[44:47]
    s_add_u32 m0, s35, 0
    s_waitcnt lgkmcnt(5)
    v_mfma_f32_16x16x32_bf16 v[20:23], v[152:155], a[36:39], v[20:23]
    buffer_load_dwordx4 v4, s[8:11], s39 offen offset:0 lds
    s_waitcnt lgkmcnt(4)
    v_mfma_f32_16x16x32_bf16 v[36:39], v[156:159], a[36:39], v[36:39]
    s_add_u32 m0, s35, 256
    v_mfma_f32_16x16x32_bf16 v[24:27], v[152:155], a[100:103], v[24:27]
    ds_read_b128 v[168:171], v6 offset:1536
    v_mfma_f32_16x16x32_bf16 v[40:43], v[156:159], a[100:103], v[40:43]
    ds_read_b128 v[172:175], v6 offset:1568
    v_mfma_f32_16x16x32_bf16 v[28:31], v[152:155], a[164:167], v[28:31]
    buffer_load_dwordx4 v4, s[8:11], s39 offen offset:1024 lds
    v_mfma_f32_16x16x32_bf16 v[44:47], v[156:159], a[164:167], v[44:47]
    s_add_u32 m0, s35, 512
    s_waitcnt lgkmcnt(3)
    v_mfma_f32_16x16x32_bf16 v[20:23], v[160:163], a[32:35], v[20:23]
    buffer_load_dwordx4 v4, s[8:11], s39 offen offset:2048 lds
    s_waitcnt lgkmcnt(2)
    v_mfma_f32_16x16x32_bf16 v[36:39], v[164:167], a[32:35], v[36:39]
    s_add_u32 m0, s35, 768
    v_mfma_f32_16x16x32_bf16 v[24:27], v[160:163], a[96:99], v[24:27]
    ds_read_b128 v[112:115], v6 offset:1600
    v_mfma_f32_16x16x32_bf16 v[40:43], v[164:167], a[96:99], v[40:43]
    ds_read_b128 v[116:119], v6 offset:1632
    v_mfma_f32_16x16x32_bf16 v[28:31], v[160:163], a[160:163], v[28:31]
    buffer_load_dwordx4 v4, s[8:11], s39 offen offset:3072 lds
    v_mfma_f32_16x16x32_bf16 v[44:47], v[164:167], a[160:163], v[44:47]
    s_waitcnt lgkmcnt(3)
    v_mfma_f32_16x16x32_bf16 v[20:23], v[168:171], a[28:31], v[20:23]
    s_waitcnt lgkmcnt(2)
    v_mfma_f32_16x16x32_bf16 v[36:39], v[172:175], a[28:31], v[36:39]
    v_mfma_f32_16x16x32_bf16 v[24:27], v[168:171], a[92:95], v[24:27]
    ds_read_b128 v[120:123], v6 offset:1664
    v_mfma_f32_16x16x32_bf16 v[40:43], v[172:175], a[92:95], v[40:43]
    ds_read_b128 v[124:127], v6 offset:1696
    v_mfma_f32_16x16x32_bf16 v[28:31], v[168:171], a[156:159], v[28:31]
    v_mfma_f32_16x16x32_bf16 v[44:47], v[172:175], a[156:159], v[44:47]
    s_waitcnt lgkmcnt(3)
    v_mfma_f32_16x16x32_bf16 v[20:23], v[112:115], a[24:27], v[20:23]
    s_waitcnt lgkmcnt(2)
    v_mfma_f32_16x16x32_bf16 v[36:39], v[116:119], a[24:27], v[36:39]
    v_mfma_f32_16x16x32_bf16 v[24:27], v[112:115], a[88:91], v[24:27]
    ds_read_b128 v[128:131], v6 offset:1728
    v_mfma_f32_16x16x32_bf16 v[40:43], v[116:119], a[88:91], v[40:43]
    ds_read_b128 v[132:135], v6 offset:1760
    v_mfma_f32_16x16x32_bf16 v[28:31], v[112:115], a[152:155], v[28:31]
    v_mfma_f32_16x16x32_bf16 v[44:47], v[116:119], a[152:155], v[44:47]
    s_waitcnt lgkmcnt(3)
    v_mfma_f32_16x16x32_bf16 v[20:23], v[120:123], a[20:23], v[20:23]
    s_waitcnt lgkmcnt(2)
    v_mfma_f32_16x16x32_bf16 v[36:39], v[124:127], a[20:23], v[36:39]
    v_mfma_f32_16x16x32_bf16 v[24:27], v[120:123], a[84:87], v[24:27]
    ds_read_b128 v[136:139], v6 offset:1792
    v_mfma_f32_16x16x32_bf16 v[40:43], v[124:127], a[84:87], v[40:43]
    ds_read_b128 v[140:143], v6 offset:1824
    v_mfma_f32_16x16x32_bf16 v[28:31], v[120:123], a[148:151], v[28:31]
    v_mfma_f32_16x16x32_bf16 v[44:47], v[124:127], a[148:151], v[44:47]
    s_waitcnt lgkmcnt(3)
    v_mfma_f32_16x16x32_bf16 v[20:23], v[128:131], a[16:19], v[20:23]
    s_waitcnt lgkmcnt(2)
    v_mfma_f32_16x16x32_bf16 v[36:39], v[132:135], a[16:19], v[36:39]
    v_mfma_f32_16x16x32_bf16 v[24:27], v[128:131], a[80:83], v[24:27]
    ds_read_b128 v[144:147], v6 offset:1856
    v_mfma_f32_16x16x32_bf16 v[40:43], v[132:135], a[80:83], v[40:43]
    ds_read_b128 v[148:151], v6 offset:1888
    v_mfma_f32_16x16x32_bf16 v[28:31], v[128:131], a[144:147], v[28:31]
    v_mfma_f32_16x16x32_bf16 v[44:47], v[132:135], a[144:147], v[44:47]
    s_waitcnt lgkmcnt(3)
    v_mfma_f32_16x16x32_bf16 v[20:23], v[136:139], a[12:15], v[20:23]
    s_waitcnt lgkmcnt(2)
    v_mfma_f32_16x16x32_bf16 v[36:39], v[140:143], a[12:15], v[36:39]
    v_mfma_f32_16x16x32_bf16 v[24:27], v[136:139], a[76:79], v[24:27]
    ds_read_b128 v[152:155], v6 offset:1920
    v_mfma_f32_16x16x32_bf16 v[40:43], v[140:143], a[76:79], v[40:43]
    ds_read_b128 v[156:159], v6 offset:1952
    v_mfma_f32_16x16x32_bf16 v[28:31], v[136:139], a[140:143], v[28:31]
    v_mfma_f32_16x16x32_bf16 v[44:47], v[140:143], a[140:143], v[44:47]
    s_waitcnt lgkmcnt(3)
    v_mfma_f32_16x16x32_bf16 v[20:23], v[144:147], a[8:11], v[20:23]
    s_waitcnt lgkmcnt(2)
    v_mfma_f32_16x16x32_bf16 v[36:39], v[148:151], a[8:11], v[36:39]
    v_mfma_f32_16x16x32_bf16 v[24:27], v[144:147], a[72:75], v[24:27]
    ds_read_b128 v[160:163], v6 offset:1984
    v_mfma_f32_16x16x32_bf16 v[40:43], v[148:151], a[72:75], v[40:43]
    ds_read_b128 v[164:167], v6 offset:2016
    v_mfma_f32_16x16x32_bf16 v[28:31], v[144:147], a[136:139], v[28:31]
    v_mfma_f32_16x16x32_bf16 v[44:47], v[148:151], a[136:139], v[44:47]
    s_waitcnt lgkmcnt(3)
    v_mfma_f32_16x16x32_bf16 v[20:23], v[152:155], a[4:7], v[20:23]
    s_waitcnt lgkmcnt(2)
    v_mfma_f32_16x16x32_bf16 v[36:39], v[156:159], a[4:7], v[36:39]
    v_mfma_f32_16x16x32_bf16 v[24:27], v[152:155], a[68:71], v[24:27]
    ds_read_b128 v[168:171], v6 offset:2048
    v_mfma_f32_16x16x32_bf16 v[40:43], v[156:159], a[68:71], v[40:43]
    ds_read_b128 v[172:175], v6 offset:2080
    v_mfma_f32_16x16x32_bf16 v[28:31], v[152:155], a[132:135], v[28:31]
    s_waitcnt vmcnt(18)
    v_mfma_f32_16x16x32_bf16 v[44:47], v[156:159], a[132:135], v[44:47]
    ds_write_b128 v5, v[188:191] offset:1024
    s_waitcnt lgkmcnt(4)
    v_mfma_f32_16x16x32_bf16 v[20:23], v[160:163], a[0:3], v[20:23]
    ds_read_b128 v[112:115], v6 offset:2112
    s_waitcnt lgkmcnt(4)
    v_mfma_f32_16x16x32_bf16 v[36:39], v[164:167], a[0:3], v[36:39]
    ds_read_b128 v[116:119], v6 offset:2144
    v_mfma_f32_16x16x32_bf16 v[24:27], v[160:163], a[64:67], v[24:27]
    ds_write_b128 v5, v[186:189] offset:17664
    v_mfma_f32_16x16x32_bf16 v[40:43], v[164:167], a[64:67], v[40:43]
    v_mov_b32 v208, v185
    v_mov_b32 v209, v186
    v_mfma_f32_16x16x32_bf16 v[28:31], v[160:163], a[128:131], v[28:31]
    ds_read_b128 v[120:123], v6 offset:2176
    v_mfma_f32_16x16x32_bf16 v[44:47], v[164:167], a[128:131], v[44:47]
    ds_read_b128 v[124:127], v6 offset:2208
    s_waitcnt lgkmcnt(7)
    v_mfma_f32_16x16x32_bf16 v[24:27], v[168:171], a[60:63], v[24:27]
    v_mov_b32 v210, v187
    v_mov_b32 v211, v188
    s_waitcnt lgkmcnt(6)
    v_mfma_f32_16x16x32_bf16 v[40:43], v[172:175], a[60:63], v[40:43]
    ds_write_b128 v5, v[208:211] offset:25984
    v_mfma_f32_16x16x32_bf16 v[28:31], v[168:171], a[124:127], v[28:31]
    ds_read_b128 v[128:131], v6 offset:2240
    v_mfma_f32_16x16x32_bf16 v[44:47], v[172:175], a[124:127], v[44:47]
    ds_read_b128 v[132:135], v6 offset:2272
    s_waitcnt lgkmcnt(7)
    v_mfma_f32_16x16x32_bf16 v[24:27], v[112:115], a[56:59], v[24:27]
    v_mov_b32 v212, v189
    v_mov_b32 v213, v190
    s_waitcnt lgkmcnt(6)
    v_mfma_f32_16x16x32_bf16 v[40:43], v[116:119], a[56:59], v[40:43]
    ds_write_b128 v5, v[210:213] offset:9344
    v_mfma_f32_16x16x32_bf16 v[28:31], v[112:115], a[120:123], v[28:31]
    ds_read_b128 v[136:139], v6 offset:2304
    v_mfma_f32_16x16x32_bf16 v[44:47], v[116:119], a[120:123], v[44:47]
    ds_read_b128 v[140:143], v6 offset:2336
    s_waitcnt lgkmcnt(7)
    v_mfma_f32_16x16x32_bf16 v[24:27], v[120:123], a[52:55], v[24:27]
    v_alignbit_b32 v214, v185, v184, 16
    v_alignbit_b32 v215, v186, v185, 16
    s_waitcnt lgkmcnt(6)
    v_mfma_f32_16x16x32_bf16 v[40:43], v[124:127], a[52:55], v[40:43]
    v_alignbit_b32 v216, v187, v186, 16
    v_alignbit_b32 v217, v188, v187, 16
    v_mfma_f32_16x16x32_bf16 v[28:31], v[120:123], a[116:119], v[28:31]
    ds_read_b128 v[144:147], v6 offset:2368
    v_mfma_f32_16x16x32_bf16 v[44:47], v[124:127], a[116:119], v[44:47]
    ds_read_b128 v[148:151], v6 offset:2400
    s_waitcnt lgkmcnt(6)
    v_mfma_f32_16x16x32_bf16 v[24:27], v[128:131], a[48:51], v[24:27]
    ds_write_b128 v5, v[214:217] offset:30144
    s_waitcnt lgkmcnt(6)
    v_mfma_f32_16x16x32_bf16 v[40:43], v[132:135], a[48:51], v[40:43]
    v_alignbit_b32 v218, v189, v188, 16
    v_alignbit_b32 v219, v190, v189, 16
    v_mfma_f32_16x16x32_bf16 v[28:31], v[128:131], a[112:115], v[28:31]
    ds_read_b128 v[152:155], v6 offset:2432
    v_mfma_f32_16x16x32_bf16 v[44:47], v[132:135], a[112:115], v[44:47]
    ds_read_b128 v[156:159], v6 offset:2464
    s_waitcnt lgkmcnt(6)
    v_mfma_f32_16x16x32_bf16 v[24:27], v[136:139], a[44:47], v[24:27]
    ds_write_b128 v5, v[216:219] offset:13504
    s_waitcnt lgkmcnt(6)
    v_mfma_f32_16x16x32_bf16 v[40:43], v[140:143], a[44:47], v[40:43]
    v_alignbit_b32 v220, v186, v185, 16
    v_alignbit_b32 v221, v187, v186, 16
    v_mfma_f32_16x16x32_bf16 v[28:31], v[136:139], a[108:111], v[28:31]
    ds_read_b128 v[160:163], v6 offset:2496
    v_mfma_f32_16x16x32_bf16 v[44:47], v[140:143], a[108:111], v[44:47]
    ds_read_b128 v[164:167], v6 offset:2528
    s_waitcnt lgkmcnt(7)
    v_mfma_f32_16x16x32_bf16 v[24:27], v[144:147], a[40:43], v[24:27]
    v_alignbit_b32 v222, v188, v187, 16
    v_alignbit_b32 v223, v189, v188, 16
    s_waitcnt lgkmcnt(6)
    v_mfma_f32_16x16x32_bf16 v[40:43], v[148:151], a[40:43], v[40:43]
    ds_write_b128 v5, v[220:223] offset:21824
    v_mfma_f32_16x16x32_bf16 v[28:31], v[144:147], a[104:107], v[28:31]
    ds_read_b128 v[168:171], v6 offset:2560
    v_mfma_f32_16x16x32_bf16 v[44:47], v[148:151], a[104:107], v[44:47]
    ds_read_b128 v[172:175], v6 offset:2592
    s_waitcnt lgkmcnt(7)
    v_mfma_f32_16x16x32_bf16 v[24:27], v[152:155], a[36:39], v[24:27]
    v_alignbit_b32 v224, v190, v189, 16
    v_alignbit_b32 v225, v191, v190, 16
    s_waitcnt lgkmcnt(6)
    v_mfma_f32_16x16x32_bf16 v[40:43], v[156:159], a[36:39], v[40:43]
    ds_write_b128 v5, v[222:225] offset:5184
    v_mfma_f32_16x16x32_bf16 v[28:31], v[152:155], a[100:103], v[28:31]
    ds_read_b128 v[112:115], v6 offset:2624
    v_mfma_f32_16x16x32_bf16 v[44:47], v[156:159], a[100:103], v[44:47]
    ds_read_b128 v[116:119], v6 offset:2656
    s_waitcnt lgkmcnt(7)
    v_mfma_f32_16x16x32_bf16 v[24:27], v[160:163], a[32:35], v[24:27]
    buffer_load_dwordx4 v[184:187], v4, s[28:31], s37 offen offset:1008
    s_waitcnt lgkmcnt(6)
    v_mfma_f32_16x16x32_bf16 v[40:43], v[164:167], a[32:35], v[40:43]
    buffer_load_dwordx4 v[188:191], v4, s[28:31], s37 offen offset:1024
    v_mfma_f32_16x16x32_bf16 v[28:31], v[160:163], a[96:99], v[28:31]
    ds_read_b128 v[120:123], v6 offset:2688
    v_mfma_f32_16x16x32_bf16 v[44:47], v[164:167], a[96:99], v[44:47]
    ds_read_b128 v[124:127], v6 offset:2720
    s_waitcnt lgkmcnt(6)
    v_mfma_f32_16x16x32_bf16 v[24:27], v[168:171], a[28:31], v[24:27]
    s_mov_b32 s36, s37
    s_add_u32 s39, s37, 125829120
    s_add_u32 s37, s37, 4096
    s_min_u32 s37, s37, s33

    s_pack_hh_b32_b16 s40, s64, s64
    v_and_b32 v236, s40, v8
    s_waitcnt lgkmcnt(5)
    v_mfma_f32_16x16x32_bf16 v[40:43], v[172:175], a[28:31], v[40:43]
    v_and_b32 v237, s40, v9
    v_and_b32 v238, s40, v10
    v_mfma_f32_16x16x32_bf16 v[28:31], v[168:171], a[92:95], v[28:31]
    ds_read_b128 v[128:131], v6 offset:2752
    v_mfma_f32_16x16x32_bf16 v[44:47], v[172:175], a[92:95], v[44:47]
    ds_read_b128 v[132:135], v6 offset:2784
    s_waitcnt lgkmcnt(5)
    v_mfma_f32_16x16x32_bf16 v[24:27], v[112:115], a[24:27], v[24:27]
    v_and_b32 v239, s40, v11
    v_and_b32 v240, s40, v12
    s_waitcnt lgkmcnt(4)
    v_mfma_f32_16x16x32_bf16 v[40:43], v[116:119], a[24:27], v[40:43]
    v_and_b32 v241, s40, v13
    v_and_b32 v242, s40, v14
    v_mfma_f32_16x16x32_bf16 v[28:31], v[112:115], a[88:91], v[28:31]
    ds_read_b128 v[136:139], v6 offset:2816
    v_mfma_f32_16x16x32_bf16 v[44:47], v[116:119], a[88:91], v[44:47]
    ds_read_b128 v[140:143], v6 offset:2848
    s_waitcnt lgkmcnt(5)
    v_mfma_f32_16x16x32_bf16 v[24:27], v[120:123], a[20:23], v[24:27]
    v_and_b32 v243, s40, v15
    s_waitcnt lgkmcnt(4)
    v_mfma_f32_16x16x32_bf16 v[40:43], v[124:127], a[20:23], v[40:43]
    v_mfma_f32_16x16x32_bf16 v[28:31], v[120:123], a[84:87], v[28:31]
    ds_read_b128 v[144:147], v6 offset:2880
    v_mfma_f32_16x16x32_bf16 v[44:47], v[124:127], a[84:87], v[44:47]
    ds_read_b128 v[148:151], v6 offset:2912
    s_waitcnt lgkmcnt(5)
    v_mfma_f32_16x16x32_bf16 v[24:27], v[128:131], a[16:19], v[24:27]
    s_waitcnt lgkmcnt(4)
    v_mfma_f32_16x16x32_bf16 v[40:43], v[132:135], a[16:19], v[40:43]
    v_mfma_f32_16x16x32_bf16 v[28:31], v[128:131], a[80:83], v[28:31]
    ds_read_b128 v[152:155], v6 offset:2944
    v_mfma_f32_16x16x32_bf16 v[44:47], v[132:135], a[80:83], v[44:47]
    ds_read_b128 v[156:159], v6 offset:2976
    s_waitcnt lgkmcnt(5)
    v_mfma_f32_16x16x32_bf16 v[24:27], v[136:139], a[12:15], v[24:27]
    s_waitcnt lgkmcnt(4)
    v_mfma_f32_16x16x32_bf16 v[40:43], v[140:143], a[12:15], v[40:43]
    v_mfma_f32_16x16x32_bf16 v[28:31], v[136:139], a[76:79], v[28:31]
    ds_read_b128 v[160:163], v6 offset:3008
    v_mfma_f32_16x16x32_bf16 v[44:47], v[140:143], a[76:79], v[44:47]
    ds_read_b128 v[164:167], v6 offset:3040
    s_waitcnt lgkmcnt(5)
    v_mfma_f32_16x16x32_bf16 v[24:27], v[144:147], a[8:11], v[24:27]
    s_waitcnt lgkmcnt(4)
    v_mfma_f32_16x16x32_bf16 v[40:43], v[148:151], a[8:11], v[40:43]
    v_mfma_f32_16x16x32_bf16 v[28:31], v[144:147], a[72:75], v[28:31]
    ds_read_b128 v[168:171], v6 offset:3072
    v_mfma_f32_16x16x32_bf16 v[44:47], v[148:151], a[72:75], v[44:47]
    ds_read_b128 v[172:175], v6 offset:3104
    s_waitcnt lgkmcnt(5)
    v_mfma_f32_16x16x32_bf16 v[24:27], v[152:155], a[4:7], v[24:27]
    ds_read_b128 v[112:115], v6 offset:3136
    s_waitcnt lgkmcnt(5)
    v_mfma_f32_16x16x32_bf16 v[40:43], v[156:159], a[4:7], v[40:43]
    ds_read_b128 v[116:119], v6 offset:3168
    v_mfma_f32_16x16x32_bf16 v[28:31], v[152:155], a[68:71], v[28:31]
    ds_read_b128 v[120:123], v6 offset:3200
    v_mfma_f32_16x16x32_bf16 v[44:47], v[156:159], a[68:71], v[44:47]
    ds_read_b128 v[124:127], v6 offset:3232
    s_waitcnt lgkmcnt(7)
    v_mfma_f32_16x16x32_bf16 v[24:27], v[160:163], a[0:3], v[24:27]
    ds_read_b128 v[128:131], v6 offset:3264
    s_waitcnt lgkmcnt(7)
    v_mfma_f32_16x16x32_bf16 v[40:43], v[164:167], a[0:3], v[40:43]
    ds_read_b128 v[132:135], v6 offset:3296
    v_mfma_f32_16x16x32_bf16 v[28:31], v[160:163], a[64:67], v[28:31]
    ds_read_b128 v[136:139], v6 offset:3328
    v_mfma_f32_16x16x32_bf16 v[44:47], v[164:167], a[64:67], v[44:47]
    ds_read_b128 v[140:143], v6 offset:3360
    s_waitcnt lgkmcnt(9)
    v_mfma_f32_16x16x32_bf16 v[28:31], v[168:171], a[60:63], v[28:31]
    ds_read_b128 v[144:147], v6 offset:3392
    s_waitcnt lgkmcnt(9)
    v_mfma_f32_16x16x32_bf16 v[44:47], v[172:175], a[60:63], v[44:47]
    ds_read_b128 v[148:151], v6 offset:3424
    s_waitcnt lgkmcnt(9)
    v_mfma_f32_16x16x32_bf16 v[28:31], v[112:115], a[56:59], v[28:31]
    ds_read_b128 v[152:155], v6 offset:3456
    s_waitcnt lgkmcnt(9)
    v_mfma_f32_16x16x32_bf16 v[44:47], v[116:119], a[56:59], v[44:47]
    ds_read_b128 v[156:159], v6 offset:3488
    s_waitcnt lgkmcnt(9)
    v_mfma_f32_16x16x32_bf16 v[28:31], v[120:123], a[52:55], v[28:31]
    ds_read_b128 v[160:163], v6 offset:3520
    s_waitcnt lgkmcnt(9)
    v_mfma_f32_16x16x32_bf16 v[44:47], v[124:127], a[52:55], v[44:47]
    ds_read_b128 v[164:167], v6 offset:3552
    s_waitcnt lgkmcnt(9)
    v_mfma_f32_16x16x32_bf16 v[28:31], v[128:131], a[48:51], v[28:31]
    ds_read_b128 v[168:171], v6 offset:3584
    s_waitcnt lgkmcnt(9)
    v_mfma_f32_16x16x32_bf16 v[44:47], v[132:135], a[48:51], v[44:47]
    ds_read_b128 v[172:175], v6 offset:3616
    s_waitcnt lgkmcnt(9)
    v_mfma_f32_16x16x32_bf16 v[28:31], v[136:139], a[44:47], v[28:31]
    ds_read_b128 v[112:115], v6 offset:3648
    s_waitcnt lgkmcnt(9)
    v_mfma_f32_16x16x32_bf16 v[44:47], v[140:143], a[44:47], v[44:47]
    ds_read_b128 v[116:119], v6 offset:3680
    s_waitcnt lgkmcnt(9)
    v_mfma_f32_16x16x32_bf16 v[28:31], v[144:147], a[40:43], v[28:31]
    ds_read_b128 v[120:123], v6 offset:3712
    s_waitcnt lgkmcnt(9)
    v_mfma_f32_16x16x32_bf16 v[44:47], v[148:151], a[40:43], v[44:47]
    ds_read_b128 v[124:127], v6 offset:3744
    s_waitcnt lgkmcnt(9)
    v_mfma_f32_16x16x32_bf16 v[28:31], v[152:155], a[36:39], v[28:31]
    ds_read_b128 v[128:131], v6 offset:3776
    s_waitcnt lgkmcnt(9)
    v_mfma_f32_16x16x32_bf16 v[44:47], v[156:159], a[36:39], v[44:47]
    ds_read_b128 v[132:135], v6 offset:3808
    s_waitcnt lgkmcnt(9)
    v_mfma_f32_16x16x32_bf16 v[28:31], v[160:163], a[32:35], v[28:31]
    ds_read_b128 v[136:139], v6 offset:3840
    s_waitcnt lgkmcnt(9)
    v_mfma_f32_16x16x32_bf16 v[44:47], v[164:167], a[32:35], v[44:47]
    ds_read_b128 v[140:143], v6 offset:3872
    s_waitcnt lgkmcnt(9)
    v_mfma_f32_16x16x32_bf16 v[28:31], v[168:171], a[28:31], v[28:31]
    ds_read_b128 v[144:147], v6 offset:3904
    s_waitcnt lgkmcnt(9)
    v_mfma_f32_16x16x32_bf16 v[44:47], v[172:175], a[28:31], v[44:47]
    ds_read_b128 v[148:151], v6 offset:3936
    s_waitcnt lgkmcnt(9)
    v_mfma_f32_16x16x32_bf16 v[28:31], v[112:115], a[24:27], v[28:31]
    ds_read_b128 v[152:155], v6 offset:3968
    s_waitcnt lgkmcnt(9)
    v_mfma_f32_16x16x32_bf16 v[44:47], v[116:119], a[24:27], v[44:47]
    ds_read_b128 v[156:159], v6 offset:4000
    s_waitcnt lgkmcnt(9)
    v_mfma_f32_16x16x32_bf16 v[28:31], v[120:123], a[20:23], v[28:31]
    ds_read_b128 v[160:163], v6 offset:4032
    s_waitcnt lgkmcnt(9)
    v_mfma_f32_16x16x32_bf16 v[44:47], v[124:127], a[20:23], v[44:47]
    ds_read_b128 v[164:167], v6 offset:4064
    s_waitcnt lgkmcnt(9)
    v_mfma_f32_16x16x32_bf16 v[28:31], v[128:131], a[16:19], v[28:31]
    s_waitcnt vmcnt(2)
    ds_read_b128 a[60:63], v7 offset:240
    s_waitcnt lgkmcnt(9)
    v_mfma_f32_16x16x32_bf16 v[44:47], v[132:135], a[16:19], v[44:47]
    s_waitcnt lgkmcnt(8)
    v_mfma_f32_16x16x32_bf16 v[28:31], v[136:139], a[12:15], v[28:31]
    ds_read_b128 a[124:127], v7 offset:496
    s_waitcnt lgkmcnt(8)
    v_mfma_f32_16x16x32_bf16 v[44:47], v[140:143], a[12:15], v[44:47]
    s_waitcnt lgkmcnt(7)
    v_mfma_f32_16x16x32_bf16 v[28:31], v[144:147], a[8:11], v[28:31]
    ds_read_b128 a[188:191], v7 offset:752
    s_waitcnt lgkmcnt(7)
    v_mfma_f32_16x16x32_bf16 v[44:47], v[148:151], a[8:11], v[44:47]
    s_waitcnt lgkmcnt(6)
    v_mfma_f32_16x16x32_bf16 v[28:31], v[152:155], a[4:7], v[28:31]
    ds_read_b128 a[252:255], v7 offset:1008
    s_waitcnt lgkmcnt(6)
    v_mfma_f32_16x16x32_bf16 v[44:47], v[156:159], a[4:7], v[44:47]
    s_waitcnt lgkmcnt(5)
    v_mfma_f32_16x16x32_bf16 v[28:31], v[160:163], a[0:3], v[28:31]
    ds_read_b128 v[168:171], v6 offset:0
    s_waitcnt lgkmcnt(5)
    v_mfma_f32_16x16x32_bf16 v[44:47], v[164:167], a[0:3], v[44:47]
    ds_read_b128 v[172:175], v6 offset:32
    s_waitcnt lgkmcnt(5)
    v_mfma_f32_16x16x32_bf16 v[48:51], v[236:239], a[60:63], 0
    v_mfma_f32_16x16x32_bf16 v[64:67], v[240:243], a[60:63], 0
    s_waitcnt lgkmcnt(4)
    v_mfma_f32_16x16x32_bf16 v[52:55], v[236:239], a[124:127], 0
    v_mfma_f32_16x16x32_bf16 v[68:71], v[240:243], a[124:127], 0
    s_waitcnt lgkmcnt(3)
    v_mfma_f32_16x16x32_bf16 v[56:59], v[236:239], a[188:191], 0
    v_mfma_f32_16x16x32_bf16 v[72:75], v[240:243], a[188:191], 0
    ds_read_b128 a[56:59], v7 offset:224
    s_waitcnt lgkmcnt(3)
    v_mfma_f32_16x16x32_bf16 v[60:63], v[236:239], a[252:255], 0
    ds_read_b128 v[112:115], v6 offset:64
    v_mfma_f32_16x16x32_bf16 v[76:79], v[240:243], a[252:255], 0
    ds_read_b128 v[116:119], v6 offset:96
    s_waitcnt lgkmcnt(4)
    v_mfma_f32_16x16x32_bf16 v[48:51], v[168:171], a[60:63], v[48:51]
    ds_read_b128 a[120:123], v7 offset:480
    s_waitcnt lgkmcnt(4)
    v_mfma_f32_16x16x32_bf16 v[64:67], v[172:175], a[60:63], v[64:67]
    s_waitcnt vmcnt(10)
    v_mfma_f32_16x16x32_bf16 v[52:55], v[168:171], a[124:127], v[52:55]
    ds_read_b128 a[184:187], v7 offset:736
    v_mfma_f32_16x16x32_bf16 v[68:71], v[172:175], a[124:127], v[68:71]
    ds_write_b128 v5, v[196:199] offset:2048
    v_mfma_f32_16x16x32_bf16 v[56:59], v[168:171], a[188:191], v[56:59]
    ds_read_b128 a[248:251], v7 offset:992
    v_mfma_f32_16x16x32_bf16 v[72:75], v[172:175], a[188:191], v[72:75]
    ds_read_b128 a[52:55], v7 offset:208
    v_mfma_f32_16x16x32_bf16 v[60:63], v[168:171], a[252:255], v[60:63]
    ds_read_b128 v[120:123], v6 offset:128
    v_mfma_f32_16x16x32_bf16 v[76:79], v[172:175], a[252:255], v[76:79]
    ds_read_b128 v[124:127], v6 offset:160
    s_waitcnt lgkmcnt(8)
    v_mfma_f32_16x16x32_bf16 v[48:51], v[112:115], a[56:59], v[48:51]
    ds_read_b128 a[116:119], v7 offset:464
    s_waitcnt lgkmcnt(8)
    v_mfma_f32_16x16x32_bf16 v[64:67], v[116:119], a[56:59], v[64:67]
    ds_write_b128 v5, v[194:197] offset:18688
    s_waitcnt lgkmcnt(8)
    v_mfma_f32_16x16x32_bf16 v[52:55], v[112:115], a[120:123], v[52:55]
    ds_read_b128 a[180:183], v7 offset:720
    v_mfma_f32_16x16x32_bf16 v[68:71], v[116:119], a[120:123], v[68:71]
    v_mov_b32 v208, v193
    v_mov_b32 v209, v194
    s_waitcnt lgkmcnt(8)
    v_mfma_f32_16x16x32_bf16 v[56:59], v[112:115], a[184:187], v[56:59]
    ds_read_b128 a[244:247], v7 offset:976
    v_mfma_f32_16x16x32_bf16 v[72:75], v[116:119], a[184:187], v[72:75]
    ds_read_b128 a[48:51], v7 offset:192
    s_waitcnt lgkmcnt(8)
    v_mfma_f32_16x16x32_bf16 v[60:63], v[112:115], a[248:251], v[60:63]
    ds_read_b128 v[128:131], v6 offset:192
    v_mfma_f32_16x16x32_bf16 v[76:79], v[116:119], a[248:251], v[76:79]
    ds_read_b128 v[132:135], v6 offset:224
    s_waitcnt lgkmcnt(8)
    v_mfma_f32_16x16x32_bf16 v[48:51], v[120:123], a[52:55], v[48:51]
    ds_read_b128 a[112:115], v7 offset:448
    s_waitcnt lgkmcnt(8)
    v_mfma_f32_16x16x32_bf16 v[64:67], v[124:127], a[52:55], v[64:67]
    v_mov_b32 v210, v195
    v_mov_b32 v211, v196
    s_waitcnt lgkmcnt(7)
    v_mfma_f32_16x16x32_bf16 v[52:55], v[120:123], a[116:119], v[52:55]
    ds_read_b128 a[176:179], v7 offset:704
    v_mfma_f32_16x16x32_bf16 v[68:71], v[124:127], a[116:119], v[68:71]
    ds_write_b128 v5, v[208:211] offset:27008
    s_waitcnt lgkmcnt(7)
    v_mfma_f32_16x16x32_bf16 v[56:59], v[120:123], a[180:183], v[56:59]
    ds_read_b128 a[240:243], v7 offset:960
    v_mfma_f32_16x16x32_bf16 v[72:75], v[124:127], a[180:183], v[72:75]
    ds_read_b128 a[44:47], v7 offset:176
    s_waitcnt lgkmcnt(8)
    v_mfma_f32_16x16x32_bf16 v[60:63], v[120:123], a[244:247], v[60:63]
    ds_read_b128 v[136:139], v6 offset:256
    v_mfma_f32_16x16x32_bf16 v[76:79], v[124:127], a[244:247], v[76:79]
    ds_read_b128 v[140:143], v6 offset:288
    s_waitcnt lgkmcnt(8)
    v_mfma_f32_16x16x32_bf16 v[48:51], v[128:131], a[48:51], v[48:51]
    ds_read_b128 a[108:111], v7 offset:432
    s_waitcnt lgkmcnt(8)
    v_mfma_f32_16x16x32_bf16 v[64:67], v[132:135], a[48:51], v[64:67]
    v_mov_b32 v212, v197
    v_mov_b32 v213, v198
    s_waitcnt lgkmcnt(7)
    v_mfma_f32_16x16x32_bf16 v[52:55], v[128:131], a[112:115], v[52:55]
    ds_read_b128 a[172:175], v7 offset:688
    v_mfma_f32_16x16x32_bf16 v[68:71], v[132:135], a[112:115], v[68:71]
    ds_write_b128 v5, v[210:213] offset:10368
    s_waitcnt lgkmcnt(8)
    v_mfma_f32_16x16x32_bf16 v[56:59], v[128:131], a[176:179], v[56:59]
    ds_read_b128 a[236:239], v7 offset:944
    v_mfma_f32_16x16x32_bf16 v[72:75], v[132:135], a[176:179], v[72:75]
    ds_read_b128 a[40:43], v7 offset:160
    s_waitcnt lgkmcnt(8)
    v_mfma_f32_16x16x32_bf16 v[60:63], v[128:131], a[240:243], v[60:63]
    ds_read_b128 v[144:147], v6 offset:320
    v_mfma_f32_16x16x32_bf16 v[76:79], v[132:135], a[240:243], v[76:79]
    ds_read_b128 v[148:151], v6 offset:352
    s_waitcnt lgkmcnt(8)
    v_mfma_f32_16x16x32_bf16 v[48:51], v[136:139], a[44:47], v[48:51]
    ds_read_b128 a[104:107], v7 offset:416
    s_waitcnt lgkmcnt(8)
    v_mfma_f32_16x16x32_bf16 v[64:67], v[140:143], a[44:47], v[64:67]
    v_alignbit_b32 v214, v193, v192, 16
    v_alignbit_b32 v215, v194, v193, 16
    s_waitcnt lgkmcnt(7)
    v_mfma_f32_16x16x32_bf16 v[52:55], v[136:139], a[108:111], v[52:55]
    ds_read_b128 a[168:171], v7 offset:672
    v_mfma_f32_16x16x32_bf16 v[68:71], v[140:143], a[108:111], v[68:71]
    v_alignbit_b32 v216, v195, v194, 16
    v_alignbit_b32 v217, v196, v195, 16
    s_waitcnt lgkmcnt(7)
    v_mfma_f32_16x16x32_bf16 v[56:59], v[136:139], a[172:175], v[56:59]
    ds_read_b128 a[232:235], v7 offset:928
    v_mfma_f32_16x16x32_bf16 v[72:75], v[140:143], a[172:175], v[72:75]
    ds_read_b128 a[36:39], v7 offset:144
    s_waitcnt lgkmcnt(7)
    v_mfma_f32_16x16x32_bf16 v[60:63], v[136:139], a[236:239], v[60:63]
    ds_read_b128 v[152:155], v6 offset:384
    v_mfma_f32_16x16x32_bf16 v[76:79], v[140:143], a[236:239], v[76:79]
    ds_read_b128 v[156:159], v6 offset:416
    s_waitcnt lgkmcnt(7)
    v_mfma_f32_16x16x32_bf16 v[48:51], v[144:147], a[40:43], v[48:51]
    ds_read_b128 a[100:103], v7 offset:400
    s_waitcnt lgkmcnt(7)
    v_mfma_f32_16x16x32_bf16 v[64:67], v[148:151], a[40:43], v[64:67]
    ds_write_b128 v5, v[214:217] offset:31168
    s_waitcnt lgkmcnt(7)
    v_mfma_f32_16x16x32_bf16 v[52:55], v[144:147], a[104:107], v[52:55]
    ds_read_b128 a[164:167], v7 offset:656
    v_mfma_f32_16x16x32_bf16 v[68:71], v[148:151], a[104:107], v[68:71]
    v_alignbit_b32 v218, v197, v196, 16
    v_alignbit_b32 v219, v198, v197, 16
    s_waitcnt lgkmcnt(7)
    v_mfma_f32_16x16x32_bf16 v[56:59], v[144:147], a[168:171], v[56:59]
    ds_read_b128 a[228:231], v7 offset:912
    v_mfma_f32_16x16x32_bf16 v[72:75], v[148:151], a[168:171], v[72:75]
    ds_read_b128 a[32:35], v7 offset:128
    s_waitcnt lgkmcnt(8)
    v_mfma_f32_16x16x32_bf16 v[60:63], v[144:147], a[232:235], v[60:63]
    ds_read_b128 v[160:163], v6 offset:448
    v_mfma_f32_16x16x32_bf16 v[76:79], v[148:151], a[232:235], v[76:79]
    ds_read_b128 v[164:167], v6 offset:480
    s_waitcnt lgkmcnt(8)
    v_mfma_f32_16x16x32_bf16 v[48:51], v[152:155], a[36:39], v[48:51]
    ds_read_b128 a[96:99], v7 offset:384
    s_waitcnt lgkmcnt(8)
    v_mfma_f32_16x16x32_bf16 v[64:67], v[156:159], a[36:39], v[64:67]
    ds_write_b128 v5, v[216:219] offset:14528
    s_waitcnt lgkmcnt(8)
    v_mfma_f32_16x16x32_bf16 v[52:55], v[152:155], a[100:103], v[52:55]
    ds_read_b128 a[160:163], v7 offset:640
    v_mfma_f32_16x16x32_bf16 v[68:71], v[156:159], a[100:103], v[68:71]
    v_alignbit_b32 v220, v194, v193, 16
    v_alignbit_b32 v221, v195, v194, 16
    s_waitcnt lgkmcnt(7)
    v_mfma_f32_16x16x32_bf16 v[56:59], v[152:155], a[164:167], v[56:59]
    ds_read_b128 a[224:227], v7 offset:896
    v_mfma_f32_16x16x32_bf16 v[72:75], v[156:159], a[164:167], v[72:75]
    ds_read_b128 a[28:31], v7 offset:112
    s_waitcnt lgkmcnt(8)
    v_mfma_f32_16x16x32_bf16 v[60:63], v[152:155], a[228:231], v[60:63]
    ds_read_b128 v[168:171], v6 offset:512
    v_mfma_f32_16x16x32_bf16 v[76:79], v[156:159], a[228:231], v[76:79]
    ds_read_b128 v[172:175], v6 offset:544
    s_waitcnt lgkmcnt(8)
    v_mfma_f32_16x16x32_bf16 v[48:51], v[160:163], a[32:35], v[48:51]
    ds_read_b128 a[92:95], v7 offset:368
    s_waitcnt lgkmcnt(8)
    v_mfma_f32_16x16x32_bf16 v[64:67], v[164:167], a[32:35], v[64:67]
    v_alignbit_b32 v222, v196, v195, 16
    v_alignbit_b32 v223, v197, v196, 16
    s_waitcnt lgkmcnt(7)
    v_mfma_f32_16x16x32_bf16 v[52:55], v[160:163], a[96:99], v[52:55]
    ds_read_b128 a[156:159], v7 offset:624
    v_mfma_f32_16x16x32_bf16 v[68:71], v[164:167], a[96:99], v[68:71]
    ds_write_b128 v5, v[220:223] offset:22848
    s_waitcnt lgkmcnt(7)
    v_mfma_f32_16x16x32_bf16 v[56:59], v[160:163], a[160:163], v[56:59]
    ds_read_b128 a[220:223], v7 offset:880
    v_mfma_f32_16x16x32_bf16 v[72:75], v[164:167], a[160:163], v[72:75]
    ds_read_b128 a[24:27], v7 offset:96
    s_waitcnt lgkmcnt(8)
    v_mfma_f32_16x16x32_bf16 v[60:63], v[160:163], a[224:227], v[60:63]
    ds_read_b128 v[112:115], v6 offset:576
    v_mfma_f32_16x16x32_bf16 v[76:79], v[164:167], a[224:227], v[76:79]
    ds_read_b128 v[116:119], v6 offset:608
    s_waitcnt lgkmcnt(8)
    v_mfma_f32_16x16x32_bf16 v[48:51], v[168:171], a[28:31], v[48:51]
    ds_read_b128 a[88:91], v7 offset:352
    s_waitcnt lgkmcnt(8)
    v_mfma_f32_16x16x32_bf16 v[64:67], v[172:175], a[28:31], v[64:67]
    v_alignbit_b32 v224, v198, v197, 16
    v_alignbit_b32 v225, v199, v198, 16
    s_waitcnt lgkmcnt(7)
    v_mfma_f32_16x16x32_bf16 v[52:55], v[168:171], a[92:95], v[52:55]
    ds_read_b128 a[152:155], v7 offset:608
    v_mfma_f32_16x16x32_bf16 v[68:71], v[172:175], a[92:95], v[68:71]
    ds_write_b128 v5, v[222:225] offset:6208
    s_waitcnt lgkmcnt(8)
    v_mfma_f32_16x16x32_bf16 v[56:59], v[168:171], a[156:159], v[56:59]
    ds_read_b128 a[216:219], v7 offset:864
    v_mfma_f32_16x16x32_bf16 v[72:75], v[172:175], a[156:159], v[72:75]
    ds_read_b128 a[20:23], v7 offset:80
    s_waitcnt lgkmcnt(8)
    v_mfma_f32_16x16x32_bf16 v[60:63], v[168:171], a[220:223], v[60:63]
    ds_read_b128 v[120:123], v6 offset:640
    v_mfma_f32_16x16x32_bf16 v[76:79], v[172:175], a[220:223], v[76:79]
    ds_read_b128 v[124:127], v6 offset:672
    s_waitcnt lgkmcnt(8)
    v_mfma_f32_16x16x32_bf16 v[48:51], v[112:115], a[24:27], v[48:51]
    ds_read_b128 a[84:87], v7 offset:336
    s_waitcnt lgkmcnt(8)
    v_mfma_f32_16x16x32_bf16 v[64:67], v[116:119], a[24:27], v[64:67]
    buffer_load_dwordx4 v[192:195], v4, s[28:31], s36 offen offset:2032
    s_waitcnt lgkmcnt(7)
    v_mfma_f32_16x16x32_bf16 v[52:55], v[112:115], a[88:91], v[52:55]
    ds_read_b128 a[148:151], v7 offset:592
    v_mfma_f32_16x16x32_bf16 v[68:71], v[116:119], a[88:91], v[68:71]
    buffer_load_dwordx4 v[196:199], v4, s[28:31], s36 offen offset:2048
    s_waitcnt lgkmcnt(7)
    v_mfma_f32_16x16x32_bf16 v[56:59], v[112:115], a[152:155], v[56:59]
    ds_read_b128 a[212:215], v7 offset:848
    v_mfma_f32_16x16x32_bf16 v[72:75], v[116:119], a[152:155], v[72:75]
    ds_read_b128 a[16:19], v7 offset:64
    s_waitcnt lgkmcnt(7)
    v_mfma_f32_16x16x32_bf16 v[60:63], v[112:115], a[216:219], v[60:63]
    ds_read_b128 v[128:131], v6 offset:704
    v_mfma_f32_16x16x32_bf16 v[76:79], v[116:119], a[216:219], v[76:79]
    ds_read_b128 v[132:135], v6 offset:736
    s_waitcnt lgkmcnt(7)
    v_mfma_f32_16x16x32_bf16 v[48:51], v[120:123], a[20:23], v[48:51]
    ds_read_b128 a[80:83], v7 offset:320
    s_waitcnt lgkmcnt(7)
    v_mfma_f32_16x16x32_bf16 v[64:67], v[124:127], a[20:23], v[64:67]
    s_waitcnt vmcnt(10)
    s_waitcnt lgkmcnt(6)
    v_mfma_f32_16x16x32_bf16 v[52:55], v[120:123], a[84:87], v[52:55]
    ds_read_b128 a[144:147], v7 offset:576
    v_mfma_f32_16x16x32_bf16 v[68:71], v[124:127], a[84:87], v[68:71]
    ds_write_b128 v5, v[204:207] offset:3072
    s_waitcnt lgkmcnt(7)
    v_mfma_f32_16x16x32_bf16 v[56:59], v[120:123], a[148:151], v[56:59]
    ds_read_b128 a[208:211], v7 offset:832
    v_mfma_f32_16x16x32_bf16 v[72:75], v[124:127], a[148:151], v[72:75]
    ds_read_b128 a[12:15], v7 offset:48
    s_waitcnt lgkmcnt(8)
    v_mfma_f32_16x16x32_bf16 v[60:63], v[120:123], a[212:215], v[60:63]
    ds_read_b128 v[136:139], v6 offset:768
    v_mfma_f32_16x16x32_bf16 v[76:79], v[124:127], a[212:215], v[76:79]
    ds_read_b128 v[140:143], v6 offset:800
    s_waitcnt lgkmcnt(8)
    v_mfma_f32_16x16x32_bf16 v[48:51], v[128:131], a[16:19], v[48:51]
    ds_read_b128 a[76:79], v7 offset:304
    s_waitcnt lgkmcnt(8)
    v_mfma_f32_16x16x32_bf16 v[64:67], v[132:135], a[16:19], v[64:67]
    ds_write_b128 v5, v[202:205] offset:19712
    s_waitcnt lgkmcnt(8)
    v_mfma_f32_16x16x32_bf16 v[52:55], v[128:131], a[80:83], v[52:55]
    ds_read_b128 a[140:143], v7 offset:560
    v_mfma_f32_16x16x32_bf16 v[68:71], v[132:135], a[80:83], v[68:71]
    v_mov_b32 v208, v201
    v_mov_b32 v209, v202
    s_waitcnt lgkmcnt(8)
    v_mfma_f32_16x16x32_bf16 v[56:59], v[128:131], a[144:147], v[56:59]
    ds_read_b128 a[204:207], v7 offset:816
    v_mfma_f32_16x16x32_bf16 v[72:75], v[132:135], a[144:147], v[72:75]
    ds_read_b128 a[8:11], v7 offset:32
    s_waitcnt lgkmcnt(8)
    v_mfma_f32_16x16x32_bf16 v[60:63], v[128:131], a[208:211], v[60:63]
    ds_read_b128 v[144:147], v6 offset:832
    v_mfma_f32_16x16x32_bf16 v[76:79], v[132:135], a[208:211], v[76:79]
    ds_read_b128 v[148:151], v6 offset:864
    s_waitcnt lgkmcnt(8)
    v_mfma_f32_16x16x32_bf16 v[48:51], v[136:139], a[12:15], v[48:51]
    ds_read_b128 a[72:75], v7 offset:288
    s_waitcnt lgkmcnt(8)
    v_mfma_f32_16x16x32_bf16 v[64:67], v[140:143], a[12:15], v[64:67]
    v_mov_b32 v210, v203
    v_mov_b32 v211, v204
    s_waitcnt lgkmcnt(7)
    v_mfma_f32_16x16x32_bf16 v[52:55], v[136:139], a[76:79], v[52:55]
    ds_read_b128 a[136:139], v7 offset:544
    v_mfma_f32_16x16x32_bf16 v[68:71], v[140:143], a[76:79], v[68:71]
    ds_write_b128 v5, v[208:211] offset:28032
    s_waitcnt lgkmcnt(7)
    v_mfma_f32_16x16x32_bf16 v[56:59], v[136:139], a[140:143], v[56:59]
    ds_read_b128 a[200:203], v7 offset:800
    v_mfma_f32_16x16x32_bf16 v[72:75], v[140:143], a[140:143], v[72:75]
    ds_read_b128 a[4:7], v7 offset:16
    s_waitcnt lgkmcnt(8)
    v_mfma_f32_16x16x32_bf16 v[60:63], v[136:139], a[204:207], v[60:63]
    ds_read_b128 v[152:155], v6 offset:896
    v_mfma_f32_16x16x32_bf16 v[76:79], v[140:143], a[204:207], v[76:79]
    ds_read_b128 v[156:159], v6 offset:928
    s_waitcnt lgkmcnt(8)
    v_mfma_f32_16x16x32_bf16 v[48:51], v[144:147], a[8:11], v[48:51]
    ds_read_b128 a[68:71], v7 offset:272
    s_waitcnt lgkmcnt(8)
    v_mfma_f32_16x16x32_bf16 v[64:67], v[148:151], a[8:11], v[64:67]
    v_mov_b32 v212, v205
    v_mov_b32 v213, v206
    s_waitcnt lgkmcnt(7)
    v_mfma_f32_16x16x32_bf16 v[52:55], v[144:147], a[72:75], v[52:55]
    ds_read_b128 a[132:135], v7 offset:528
    v_mfma_f32_16x16x32_bf16 v[68:71], v[148:151], a[72:75], v[68:71]
    ds_write_b128 v5, v[210:213] offset:11392
    s_waitcnt lgkmcnt(8)
    v_mfma_f32_16x16x32_bf16 v[56:59], v[144:147], a[136:139], v[56:59]
    ds_read_b128 a[196:199], v7 offset:784
    v_mfma_f32_16x16x32_bf16 v[72:75], v[148:151], a[136:139], v[72:75]
    ds_read_b128 a[0:3], v7 offset:0
    s_waitcnt lgkmcnt(8)
    v_mfma_f32_16x16x32_bf16 v[60:63], v[144:147], a[200:203], v[60:63]
    ds_read_b128 v[160:163], v6 offset:960
    v_mfma_f32_16x16x32_bf16 v[76:79], v[148:151], a[200:203], v[76:79]
    ds_read_b128 v[164:167], v6 offset:992
    s_waitcnt lgkmcnt(8)
    v_mfma_f32_16x16x32_bf16 v[48:51], v[152:155], a[4:7], v[48:51]
    ds_read_b128 a[64:67], v7 offset:256
    s_waitcnt lgkmcnt(8)
    v_mfma_f32_16x16x32_bf16 v[64:67], v[156:159], a[4:7], v[64:67]
    v_alignbit_b32 v214, v201, v200, 16
    v_alignbit_b32 v215, v202, v201, 16
    s_waitcnt lgkmcnt(7)
    v_mfma_f32_16x16x32_bf16 v[52:55], v[152:155], a[68:71], v[52:55]
    ds_read_b128 a[128:131], v7 offset:512
    v_mfma_f32_16x16x32_bf16 v[68:71], v[156:159], a[68:71], v[68:71]
    v_alignbit_b32 v216, v203, v202, 16
    v_alignbit_b32 v217, v204, v203, 16
    s_waitcnt lgkmcnt(7)
    v_mfma_f32_16x16x32_bf16 v[56:59], v[152:155], a[132:135], v[56:59]
    ds_read_b128 a[192:195], v7 offset:768
    v_mfma_f32_16x16x32_bf16 v[72:75], v[156:159], a[132:135], v[72:75]
    ds_write_b128 v5, v[214:217] offset:32192
    s_waitcnt lgkmcnt(7)
    v_mfma_f32_16x16x32_bf16 v[60:63], v[152:155], a[196:199], v[60:63]
    ds_read_b128 v[168:171], v6 offset:1024
    v_mfma_f32_16x16x32_bf16 v[76:79], v[156:159], a[196:199], v[76:79]
    ds_read_b128 v[172:175], v6 offset:1056
    s_waitcnt lgkmcnt(7)
    v_mfma_f32_16x16x32_bf16 v[48:51], v[160:163], a[0:3], v[48:51]
    v_alignbit_b32 v218, v205, v204, 16
    v_alignbit_b32 v219, v206, v205, 16
    s_waitcnt lgkmcnt(6)
    v_mfma_f32_16x16x32_bf16 v[64:67], v[164:167], a[0:3], v[64:67]
    ds_write_b128 v5, v[216:219] offset:15552
    s_waitcnt lgkmcnt(6)
    v_mfma_f32_16x16x32_bf16 v[52:55], v[160:163], a[64:67], v[52:55]
    v_alignbit_b32 v220, v202, v201, 16
    v_alignbit_b32 v221, v203, v202, 16
    v_mfma_f32_16x16x32_bf16 v[68:71], v[164:167], a[64:67], v[68:71]
    v_alignbit_b32 v222, v204, v203, 16
    v_alignbit_b32 v223, v205, v204, 16
    s_waitcnt lgkmcnt(5)
    v_mfma_f32_16x16x32_bf16 v[56:59], v[160:163], a[128:131], v[56:59]
    ds_read_b128 v[112:115], v6 offset:1088
    v_mfma_f32_16x16x32_bf16 v[72:75], v[164:167], a[128:131], v[72:75]
    ds_read_b128 v[116:119], v6 offset:1120
    s_waitcnt lgkmcnt(6)
    v_mfma_f32_16x16x32_bf16 v[60:63], v[160:163], a[192:195], v[60:63]
    ds_write_b128 v5, v[220:223] offset:23872
    v_mfma_f32_16x16x32_bf16 v[76:79], v[164:167], a[192:195], v[76:79]
    v_alignbit_b32 v224, v206, v205, 16
    v_alignbit_b32 v225, v207, v206, 16
    s_waitcnt lgkmcnt(5)
    v_mfma_f32_16x16x32_bf16 v[52:55], v[168:171], a[60:63], v[52:55]
    ds_write_b128 v5, v[222:225] offset:7232
    s_waitcnt lgkmcnt(5)
    v_mfma_f32_16x16x32_bf16 v[68:71], v[172:175], a[60:63], v[68:71]
    buffer_load_dwordx4 v[200:203], v4, s[28:31], s36 offen offset:3056
    v_mfma_f32_16x16x32_bf16 v[56:59], v[168:171], a[124:127], v[56:59]
    ds_read_b128 v[120:123], v6 offset:1152
    v_mfma_f32_16x16x32_bf16 v[72:75], v[172:175], a[124:127], v[72:75]
    ds_read_b128 v[124:127], v6 offset:1184
    v_mfma_f32_16x16x32_bf16 v[60:63], v[168:171], a[188:191], v[60:63]
    buffer_load_dwordx4 v[204:207], v4, s[28:31], s36 offen offset:3072
    v_mfma_f32_16x16x32_bf16 v[76:79], v[172:175], a[188:191], v[76:79]
    s_waitcnt vmcnt(10)
    s_mov_b64 exec, 1
    v_mov_b32 v176, 0
    v_mov_b32 v177, 0
    v_mov_b32 v178, 0
    v_mov_b32 v179, 0
    s_mov_b64 exec, -1
    s_waitcnt lgkmcnt(5)
    v_mfma_f32_16x16x32_bf16 v[52:55], v[112:115], a[56:59], v[52:55]
    ds_write_b128 v5, v[180:183] offset:0
    s_waitcnt lgkmcnt(5)
    v_mfma_f32_16x16x32_bf16 v[68:71], v[116:119], a[56:59], v[68:71]
    ds_write_b128 v5, v[178:181] offset:16640
    v_mfma_f32_16x16x32_bf16 v[56:59], v[112:115], a[120:123], v[56:59]
    ds_read_b128 v[128:131], v6 offset:1216
    v_mfma_f32_16x16x32_bf16 v[72:75], v[116:119], a[120:123], v[72:75]
    ds_read_b128 v[132:135], v6 offset:1248
    v_mfma_f32_16x16x32_bf16 v[60:63], v[112:115], a[184:187], v[60:63]
    v_mov_b32 v208, v177
    v_mov_b32 v209, v178
    v_mfma_f32_16x16x32_bf16 v[76:79], v[116:119], a[184:187], v[76:79]
    v_mov_b32 v210, v179
    v_mov_b32 v211, v180
    s_waitcnt lgkmcnt(5)
    v_mfma_f32_16x16x32_bf16 v[52:55], v[120:123], a[52:55], v[52:55]
    ds_write_b128 v5, v[208:211] offset:24960
    s_waitcnt lgkmcnt(5)
    v_mfma_f32_16x16x32_bf16 v[68:71], v[124:127], a[52:55], v[68:71]
    v_mov_b32 v212, v181
    v_mov_b32 v213, v182
    v_mfma_f32_16x16x32_bf16 v[56:59], v[120:123], a[116:119], v[56:59]
    ds_read_b128 v[136:139], v6 offset:1280
    v_mfma_f32_16x16x32_bf16 v[72:75], v[124:127], a[116:119], v[72:75]
    ds_read_b128 v[140:143], v6 offset:1312
    v_mfma_f32_16x16x32_bf16 v[60:63], v[120:123], a[180:183], v[60:63]
    ds_write_b128 v5, v[210:213] offset:8320
    v_mfma_f32_16x16x32_bf16 v[76:79], v[124:127], a[180:183], v[76:79]
    v_alignbit_b32 v214, v177, v176, 16
    v_alignbit_b32 v215, v178, v177, 16
    s_waitcnt lgkmcnt(5)
    v_mfma_f32_16x16x32_bf16 v[52:55], v[128:131], a[48:51], v[52:55]
    v_alignbit_b32 v216, v179, v178, 16
    v_alignbit_b32 v217, v180, v179, 16
    s_waitcnt lgkmcnt(4)
    v_mfma_f32_16x16x32_bf16 v[68:71], v[132:135], a[48:51], v[68:71]
    ds_write_b128 v5, v[214:217] offset:29120
    v_mfma_f32_16x16x32_bf16 v[56:59], v[128:131], a[112:115], v[56:59]
    ds_read_b128 v[144:147], v6 offset:1344
    v_mfma_f32_16x16x32_bf16 v[72:75], v[132:135], a[112:115], v[72:75]
    ds_read_b128 v[148:151], v6 offset:1376
    v_mfma_f32_16x16x32_bf16 v[60:63], v[128:131], a[176:179], v[60:63]
    v_alignbit_b32 v218, v181, v180, 16
    v_alignbit_b32 v219, v182, v181, 16
    v_mfma_f32_16x16x32_bf16 v[76:79], v[132:135], a[176:179], v[76:79]
    ds_write_b128 v5, v[216:219] offset:12480
    s_waitcnt lgkmcnt(6)
    v_mfma_f32_16x16x32_bf16 v[52:55], v[136:139], a[44:47], v[52:55]
    v_alignbit_b32 v220, v178, v177, 16
    v_alignbit_b32 v221, v179, v178, 16
    s_waitcnt lgkmcnt(5)
    v_mfma_f32_16x16x32_bf16 v[68:71], v[140:143], a[44:47], v[68:71]
    v_alignbit_b32 v222, v180, v179, 16
    v_alignbit_b32 v223, v181, v180, 16
    v_mfma_f32_16x16x32_bf16 v[56:59], v[136:139], a[108:111], v[56:59]
    ds_read_b128 v[152:155], v6 offset:1408
    v_mfma_f32_16x16x32_bf16 v[72:75], v[140:143], a[108:111], v[72:75]
    ds_read_b128 v[156:159], v6 offset:1440
    v_mfma_f32_16x16x32_bf16 v[60:63], v[136:139], a[172:175], v[60:63]
    ds_write_b128 v5, v[220:223] offset:20800
    v_mfma_f32_16x16x32_bf16 v[76:79], v[140:143], a[172:175], v[76:79]
    v_alignbit_b32 v224, v182, v181, 16
    v_alignbit_b32 v225, v183, v182, 16
    s_waitcnt lgkmcnt(5)
    v_mfma_f32_16x16x32_bf16 v[52:55], v[144:147], a[40:43], v[52:55]
    ds_write_b128 v5, v[222:225] offset:4160
    s_waitcnt lgkmcnt(5)
    v_mfma_f32_16x16x32_bf16 v[68:71], v[148:151], a[40:43], v[68:71]
    buffer_load_dwordx4 v[176:179], v230, s[28:31], s37 offen offset:0
    v_mfma_f32_16x16x32_bf16 v[56:59], v[144:147], a[104:107], v[56:59]
    ds_read_b128 v[160:163], v6 offset:1472
    v_mfma_f32_16x16x32_bf16 v[72:75], v[148:151], a[104:107], v[72:75]
    ds_read_b128 v[164:167], v6 offset:1504
    v_mfma_f32_16x16x32_bf16 v[60:63], v[144:147], a[168:171], v[60:63]
    buffer_load_dwordx4 v[180:183], v4, s[28:31], s37 offen offset:0
    v_mfma_f32_16x16x32_bf16 v[76:79], v[148:151], a[168:171], v[76:79]
    s_add_u32 m0, s35, 0
    s_waitcnt lgkmcnt(5)
    v_mfma_f32_16x16x32_bf16 v[52:55], v[152:155], a[36:39], v[52:55]
    buffer_load_dwordx4 v4, s[8:11], s39 offen offset:0 lds
    s_waitcnt lgkmcnt(4)
    v_mfma_f32_16x16x32_bf16 v[68:71], v[156:159], a[36:39], v[68:71]
    s_add_u32 m0, s35, 256
    v_mfma_f32_16x16x32_bf16 v[56:59], v[152:155], a[100:103], v[56:59]
    ds_read_b128 v[168:171], v6 offset:1536
    v_mfma_f32_16x16x32_bf16 v[72:75], v[156:159], a[100:103], v[72:75]
    ds_read_b128 v[172:175], v6 offset:1568
    v_mfma_f32_16x16x32_bf16 v[60:63], v[152:155], a[164:167], v[60:63]
    buffer_load_dwordx4 v4, s[8:11], s39 offen offset:1024 lds
    v_mfma_f32_16x16x32_bf16 v[76:79], v[156:159], a[164:167], v[76:79]
    s_add_u32 m0, s35, 512
    s_waitcnt lgkmcnt(3)
    v_mfma_f32_16x16x32_bf16 v[52:55], v[160:163], a[32:35], v[52:55]
    buffer_load_dwordx4 v4, s[8:11], s39 offen offset:2048 lds
    s_waitcnt lgkmcnt(2)
    v_mfma_f32_16x16x32_bf16 v[68:71], v[164:167], a[32:35], v[68:71]
    s_add_u32 m0, s35, 768
    v_mfma_f32_16x16x32_bf16 v[56:59], v[160:163], a[96:99], v[56:59]
    ds_read_b128 v[112:115], v6 offset:1600
    v_mfma_f32_16x16x32_bf16 v[72:75], v[164:167], a[96:99], v[72:75]
    ds_read_b128 v[116:119], v6 offset:1632
    v_mfma_f32_16x16x32_bf16 v[60:63], v[160:163], a[160:163], v[60:63]
    buffer_load_dwordx4 v4, s[8:11], s39 offen offset:3072 lds
    v_mfma_f32_16x16x32_bf16 v[76:79], v[164:167], a[160:163], v[76:79]
    s_waitcnt lgkmcnt(3)
    v_mfma_f32_16x16x32_bf16 v[52:55], v[168:171], a[28:31], v[52:55]
    s_waitcnt lgkmcnt(2)
    v_mfma_f32_16x16x32_bf16 v[68:71], v[172:175], a[28:31], v[68:71]
    v_mfma_f32_16x16x32_bf16 v[56:59], v[168:171], a[92:95], v[56:59]
    ds_read_b128 v[120:123], v6 offset:1664
    v_mfma_f32_16x16x32_bf16 v[72:75], v[172:175], a[92:95], v[72:75]
    ds_read_b128 v[124:127], v6 offset:1696
    v_mfma_f32_16x16x32_bf16 v[60:63], v[168:171], a[156:159], v[60:63]
    v_mfma_f32_16x16x32_bf16 v[76:79], v[172:175], a[156:159], v[76:79]
    s_waitcnt lgkmcnt(3)
    v_mfma_f32_16x16x32_bf16 v[52:55], v[112:115], a[24:27], v[52:55]
    s_waitcnt lgkmcnt(2)
    v_mfma_f32_16x16x32_bf16 v[68:71], v[116:119], a[24:27], v[68:71]
    v_mfma_f32_16x16x32_bf16 v[56:59], v[112:115], a[88:91], v[56:59]
    ds_read_b128 v[128:131], v6 offset:1728
    v_mfma_f32_16x16x32_bf16 v[72:75], v[116:119], a[88:91], v[72:75]
    ds_read_b128 v[132:135], v6 offset:1760
    v_mfma_f32_16x16x32_bf16 v[60:63], v[112:115], a[152:155], v[60:63]
    v_mfma_f32_16x16x32_bf16 v[76:79], v[116:119], a[152:155], v[76:79]
    s_waitcnt lgkmcnt(3)
    v_mfma_f32_16x16x32_bf16 v[52:55], v[120:123], a[20:23], v[52:55]
    s_waitcnt lgkmcnt(2)
    v_mfma_f32_16x16x32_bf16 v[68:71], v[124:127], a[20:23], v[68:71]
    v_mfma_f32_16x16x32_bf16 v[56:59], v[120:123], a[84:87], v[56:59]
    ds_read_b128 v[136:139], v6 offset:1792
    v_mfma_f32_16x16x32_bf16 v[72:75], v[124:127], a[84:87], v[72:75]
    ds_read_b128 v[140:143], v6 offset:1824
    v_mfma_f32_16x16x32_bf16 v[60:63], v[120:123], a[148:151], v[60:63]
    v_mfma_f32_16x16x32_bf16 v[76:79], v[124:127], a[148:151], v[76:79]
    s_waitcnt lgkmcnt(3)
    v_mfma_f32_16x16x32_bf16 v[52:55], v[128:131], a[16:19], v[52:55]
    s_waitcnt lgkmcnt(2)
    v_mfma_f32_16x16x32_bf16 v[68:71], v[132:135], a[16:19], v[68:71]
    v_mfma_f32_16x16x32_bf16 v[56:59], v[128:131], a[80:83], v[56:59]
    ds_read_b128 v[144:147], v6 offset:1856
    v_mfma_f32_16x16x32_bf16 v[72:75], v[132:135], a[80:83], v[72:75]
    ds_read_b128 v[148:151], v6 offset:1888
    v_mfma_f32_16x16x32_bf16 v[60:63], v[128:131], a[144:147], v[60:63]
    v_mfma_f32_16x16x32_bf16 v[76:79], v[132:135], a[144:147], v[76:79]
    s_waitcnt lgkmcnt(3)
    v_mfma_f32_16x16x32_bf16 v[52:55], v[136:139], a[12:15], v[52:55]
    s_waitcnt lgkmcnt(2)
    v_mfma_f32_16x16x32_bf16 v[68:71], v[140:143], a[12:15], v[68:71]
    v_mfma_f32_16x16x32_bf16 v[56:59], v[136:139], a[76:79], v[56:59]
    ds_read_b128 v[152:155], v6 offset:1920
    v_mfma_f32_16x16x32_bf16 v[72:75], v[140:143], a[76:79], v[72:75]
    ds_read_b128 v[156:159], v6 offset:1952
    v_mfma_f32_16x16x32_bf16 v[60:63], v[136:139], a[140:143], v[60:63]
    v_mfma_f32_16x16x32_bf16 v[76:79], v[140:143], a[140:143], v[76:79]
    s_waitcnt lgkmcnt(3)
    v_mfma_f32_16x16x32_bf16 v[52:55], v[144:147], a[8:11], v[52:55]
    s_waitcnt lgkmcnt(2)
    v_mfma_f32_16x16x32_bf16 v[68:71], v[148:151], a[8:11], v[68:71]
    v_mfma_f32_16x16x32_bf16 v[56:59], v[144:147], a[72:75], v[56:59]
    ds_read_b128 v[160:163], v6 offset:1984
    v_mfma_f32_16x16x32_bf16 v[72:75], v[148:151], a[72:75], v[72:75]
    ds_read_b128 v[164:167], v6 offset:2016
    v_mfma_f32_16x16x32_bf16 v[60:63], v[144:147], a[136:139], v[60:63]
    v_mfma_f32_16x16x32_bf16 v[76:79], v[148:151], a[136:139], v[76:79]
    s_waitcnt lgkmcnt(3)
    v_mfma_f32_16x16x32_bf16 v[52:55], v[152:155], a[4:7], v[52:55]
    s_waitcnt lgkmcnt(2)
    v_mfma_f32_16x16x32_bf16 v[68:71], v[156:159], a[4:7], v[68:71]
    v_mfma_f32_16x16x32_bf16 v[56:59], v[152:155], a[68:71], v[56:59]
    ds_read_b128 v[168:171], v6 offset:2048
    v_mfma_f32_16x16x32_bf16 v[72:75], v[156:159], a[68:71], v[72:75]
    ds_read_b128 v[172:175], v6 offset:2080
    v_mfma_f32_16x16x32_bf16 v[60:63], v[152:155], a[132:135], v[60:63]
    s_waitcnt vmcnt(10)
    v_mfma_f32_16x16x32_bf16 v[76:79], v[156:159], a[132:135], v[76:79]
    ds_write_b128 v5, v[188:191] offset:1024
    s_waitcnt lgkmcnt(4)
    v_mfma_f32_16x16x32_bf16 v[52:55], v[160:163], a[0:3], v[52:55]
    ds_read_b128 v[112:115], v6 offset:2112
    s_waitcnt lgkmcnt(4)
    v_mfma_f32_16x16x32_bf16 v[68:71], v[164:167], a[0:3], v[68:71]
    ds_read_b128 v[116:119], v6 offset:2144
    v_mfma_f32_16x16x32_bf16 v[56:59], v[160:163], a[64:67], v[56:59]
    ds_write_b128 v5, v[186:189] offset:17664
    v_mfma_f32_16x16x32_bf16 v[72:75], v[164:167], a[64:67], v[72:75]
    v_mov_b32 v208, v185
    v_mov_b32 v209, v186
    v_mfma_f32_16x16x32_bf16 v[60:63], v[160:163], a[128:131], v[60:63]
    ds_read_b128 v[120:123], v6 offset:2176
    v_mfma_f32_16x16x32_bf16 v[76:79], v[164:167], a[128:131], v[76:79]
    ds_read_b128 v[124:127], v6 offset:2208
    s_waitcnt lgkmcnt(7)
    v_mfma_f32_16x16x32_bf16 v[56:59], v[168:171], a[60:63], v[56:59]
    v_mov_b32 v210, v187
    v_mov_b32 v211, v188
    s_waitcnt lgkmcnt(6)
    v_mfma_f32_16x16x32_bf16 v[72:75], v[172:175], a[60:63], v[72:75]
    ds_write_b128 v5, v[208:211] offset:25984
    v_mfma_f32_16x16x32_bf16 v[60:63], v[168:171], a[124:127], v[60:63]
    ds_read_b128 v[128:131], v6 offset:2240
    v_mfma_f32_16x16x32_bf16 v[76:79], v[172:175], a[124:127], v[76:79]
    ds_read_b128 v[132:135], v6 offset:2272
    s_waitcnt lgkmcnt(7)
    v_mfma_f32_16x16x32_bf16 v[56:59], v[112:115], a[56:59], v[56:59]
    v_mov_b32 v212, v189
    v_mov_b32 v213, v190
    s_waitcnt lgkmcnt(6)
    v_mfma_f32_16x16x32_bf16 v[72:75], v[116:119], a[56:59], v[72:75]
    ds_write_b128 v5, v[210:213] offset:9344
    v_mfma_f32_16x16x32_bf16 v[60:63], v[112:115], a[120:123], v[60:63]
    ds_read_b128 v[136:139], v6 offset:2304
    v_mfma_f32_16x16x32_bf16 v[76:79], v[116:119], a[120:123], v[76:79]
    ds_read_b128 v[140:143], v6 offset:2336
    s_waitcnt lgkmcnt(7)
    v_mfma_f32_16x16x32_bf16 v[56:59], v[120:123], a[52:55], v[56:59]
    v_alignbit_b32 v214, v185, v184, 16
    v_alignbit_b32 v215, v186, v185, 16
    s_waitcnt lgkmcnt(6)
    v_mfma_f32_16x16x32_bf16 v[72:75], v[124:127], a[52:55], v[72:75]
    v_alignbit_b32 v216, v187, v186, 16
    v_alignbit_b32 v217, v188, v187, 16
    v_mfma_f32_16x16x32_bf16 v[60:63], v[120:123], a[116:119], v[60:63]
    ds_read_b128 v[144:147], v6 offset:2368
    v_mfma_f32_16x16x32_bf16 v[76:79], v[124:127], a[116:119], v[76:79]
    ds_read_b128 v[148:151], v6 offset:2400
    s_waitcnt lgkmcnt(6)
    v_mfma_f32_16x16x32_bf16 v[56:59], v[128:131], a[48:51], v[56:59]
    ds_write_b128 v5, v[214:217] offset:30144
    s_waitcnt lgkmcnt(6)
    v_mfma_f32_16x16x32_bf16 v[72:75], v[132:135], a[48:51], v[72:75]
    v_alignbit_b32 v218, v189, v188, 16
    v_alignbit_b32 v219, v190, v189, 16
    v_mfma_f32_16x16x32_bf16 v[60:63], v[128:131], a[112:115], v[60:63]
    ds_read_b128 v[152:155], v6 offset:2432
    v_mfma_f32_16x16x32_bf16 v[76:79], v[132:135], a[112:115], v[76:79]
    ds_read_b128 v[156:159], v6 offset:2464
    s_waitcnt lgkmcnt(6)
    v_mfma_f32_16x16x32_bf16 v[56:59], v[136:139], a[44:47], v[56:59]
    ds_write_b128 v5, v[216:219] offset:13504
    s_waitcnt lgkmcnt(6)
    v_mfma_f32_16x16x32_bf16 v[72:75], v[140:143], a[44:47], v[72:75]
    v_alignbit_b32 v220, v186, v185, 16
    v_alignbit_b32 v221, v187, v186, 16
    v_mfma_f32_16x16x32_bf16 v[60:63], v[136:139], a[108:111], v[60:63]
    ds_read_b128 v[160:163], v6 offset:2496
    v_mfma_f32_16x16x32_bf16 v[76:79], v[140:143], a[108:111], v[76:79]
    ds_read_b128 v[164:167], v6 offset:2528
    s_waitcnt lgkmcnt(7)
    v_mfma_f32_16x16x32_bf16 v[56:59], v[144:147], a[40:43], v[56:59]
    v_alignbit_b32 v222, v188, v187, 16
    v_alignbit_b32 v223, v189, v188, 16
    s_waitcnt lgkmcnt(6)
    v_mfma_f32_16x16x32_bf16 v[72:75], v[148:151], a[40:43], v[72:75]
    ds_write_b128 v5, v[220:223] offset:21824
    v_mfma_f32_16x16x32_bf16 v[60:63], v[144:147], a[104:107], v[60:63]
    ds_read_b128 v[168:171], v6 offset:2560
    v_mfma_f32_16x16x32_bf16 v[76:79], v[148:151], a[104:107], v[76:79]
    ds_read_b128 v[172:175], v6 offset:2592
    s_waitcnt lgkmcnt(7)
    v_mfma_f32_16x16x32_bf16 v[56:59], v[152:155], a[36:39], v[56:59]
    v_alignbit_b32 v224, v190, v189, 16
    v_alignbit_b32 v225, v191, v190, 16
    s_waitcnt lgkmcnt(6)
    v_mfma_f32_16x16x32_bf16 v[72:75], v[156:159], a[36:39], v[72:75]
    ds_write_b128 v5, v[222:225] offset:5184
    v_mfma_f32_16x16x32_bf16 v[60:63], v[152:155], a[100:103], v[60:63]
    ds_read_b128 v[112:115], v6 offset:2624
    v_mfma_f32_16x16x32_bf16 v[76:79], v[156:159], a[100:103], v[76:79]
    ds_read_b128 v[116:119], v6 offset:2656
    s_waitcnt lgkmcnt(7)
    v_mfma_f32_16x16x32_bf16 v[56:59], v[160:163], a[32:35], v[56:59]
    buffer_load_dwordx4 v[184:187], v4, s[28:31], s37 offen offset:1008
    s_waitcnt lgkmcnt(6)
    v_mfma_f32_16x16x32_bf16 v[72:75], v[164:167], a[32:35], v[72:75]
    buffer_load_dwordx4 v[188:191], v4, s[28:31], s37 offen offset:1024
    v_mfma_f32_16x16x32_bf16 v[60:63], v[160:163], a[96:99], v[60:63]
    ds_read_b128 v[120:123], v6 offset:2688
    v_mfma_f32_16x16x32_bf16 v[76:79], v[164:167], a[96:99], v[76:79]
    ds_read_b128 v[124:127], v6 offset:2720
    s_waitcnt lgkmcnt(6)
    v_mfma_f32_16x16x32_bf16 v[56:59], v[168:171], a[28:31], v[56:59]
    s_mov_b32 s36, s37
    s_add_u32 s39, s37, 125829120
    s_add_u32 s37, s37, 4096
    s_min_u32 s37, s37, s33

    s_pack_ll_b32_b16 s40, s65, s65
    s_mov_b32 s64, s65
    s_mov_b32 s65, s66
    s_mov_b32 s66, s67
    v_and_b32 v236, s40, v8
    s_waitcnt lgkmcnt(5)
    v_mfma_f32_16x16x32_bf16 v[72:75], v[172:175], a[28:31], v[72:75]
    v_and_b32 v237, s40, v9
    v_and_b32 v238, s40, v10
    v_mfma_f32_16x16x32_bf16 v[60:63], v[168:171], a[92:95], v[60:63]
    ds_read_b128 v[128:131], v6 offset:2752
    v_mfma_f32_16x16x32_bf16 v[76:79], v[172:175], a[92:95], v[76:79]
    ds_read_b128 v[132:135], v6 offset:2784
    s_waitcnt lgkmcnt(5)
    v_mfma_f32_16x16x32_bf16 v[56:59], v[112:115], a[24:27], v[56:59]
    v_and_b32 v239, s40, v11
    v_and_b32 v240, s40, v12
    s_waitcnt lgkmcnt(4)
    v_mfma_f32_16x16x32_bf16 v[72:75], v[116:119], a[24:27], v[72:75]
    v_and_b32 v241, s40, v13
    v_and_b32 v242, s40, v14
    v_mfma_f32_16x16x32_bf16 v[60:63], v[112:115], a[88:91], v[60:63]
    ds_read_b128 v[136:139], v6 offset:2816
    v_mfma_f32_16x16x32_bf16 v[76:79], v[116:119], a[88:91], v[76:79]
    ds_read_b128 v[140:143], v6 offset:2848
    s_waitcnt lgkmcnt(5)
    v_mfma_f32_16x16x32_bf16 v[56:59], v[120:123], a[20:23], v[56:59]
    v_and_b32 v243, s40, v15
    s_waitcnt lgkmcnt(4)
    v_mfma_f32_16x16x32_bf16 v[72:75], v[124:127], a[20:23], v[72:75]
    v_mfma_f32_16x16x32_bf16 v[60:63], v[120:123], a[84:87], v[60:63]
    ds_read_b128 v[144:147], v6 offset:2880
    v_mfma_f32_16x16x32_bf16 v[76:79], v[124:127], a[84:87], v[76:79]
    ds_read_b128 v[148:151], v6 offset:2912
    s_waitcnt lgkmcnt(5)
    v_mfma_f32_16x16x32_bf16 v[56:59], v[128:131], a[16:19], v[56:59]
    s_waitcnt lgkmcnt(4)
    v_mfma_f32_16x16x32_bf16 v[72:75], v[132:135], a[16:19], v[72:75]
    v_mfma_f32_16x16x32_bf16 v[60:63], v[128:131], a[80:83], v[60:63]
    ds_read_b128 v[152:155], v6 offset:2944
    v_mfma_f32_16x16x32_bf16 v[76:79], v[132:135], a[80:83], v[76:79]
    ds_read_b128 v[156:159], v6 offset:2976
    s_waitcnt lgkmcnt(5)
    v_mfma_f32_16x16x32_bf16 v[56:59], v[136:139], a[12:15], v[56:59]
    s_waitcnt lgkmcnt(4)
    v_mfma_f32_16x16x32_bf16 v[72:75], v[140:143], a[12:15], v[72:75]
    v_mfma_f32_16x16x32_bf16 v[60:63], v[136:139], a[76:79], v[60:63]
    ds_read_b128 v[160:163], v6 offset:3008
    v_mfma_f32_16x16x32_bf16 v[76:79], v[140:143], a[76:79], v[76:79]
    ds_read_b128 v[164:167], v6 offset:3040
    s_waitcnt lgkmcnt(5)
    v_mfma_f32_16x16x32_bf16 v[56:59], v[144:147], a[8:11], v[56:59]
    s_waitcnt lgkmcnt(4)
    v_mfma_f32_16x16x32_bf16 v[72:75], v[148:151], a[8:11], v[72:75]
    v_mfma_f32_16x16x32_bf16 v[60:63], v[144:147], a[72:75], v[60:63]
    ds_read_b128 v[168:171], v6 offset:3072
    v_mfma_f32_16x16x32_bf16 v[76:79], v[148:151], a[72:75], v[76:79]
    ds_read_b128 v[172:175], v6 offset:3104
    s_waitcnt lgkmcnt(5)
    v_mfma_f32_16x16x32_bf16 v[56:59], v[152:155], a[4:7], v[56:59]
    ds_read_b128 v[112:115], v6 offset:3136
    s_waitcnt lgkmcnt(5)
    v_mfma_f32_16x16x32_bf16 v[72:75], v[156:159], a[4:7], v[72:75]
    ds_read_b128 v[116:119], v6 offset:3168
    v_mfma_f32_16x16x32_bf16 v[60:63], v[152:155], a[68:71], v[60:63]
    ds_read_b128 v[120:123], v6 offset:3200
    v_mfma_f32_16x16x32_bf16 v[76:79], v[156:159], a[68:71], v[76:79]
    ds_read_b128 v[124:127], v6 offset:3232
    s_waitcnt lgkmcnt(7)
    v_mfma_f32_16x16x32_bf16 v[56:59], v[160:163], a[0:3], v[56:59]
    ds_read_b128 v[128:131], v6 offset:3264
    s_waitcnt lgkmcnt(7)
    v_mfma_f32_16x16x32_bf16 v[72:75], v[164:167], a[0:3], v[72:75]
    ds_read_b128 v[132:135], v6 offset:3296
    v_mfma_f32_16x16x32_bf16 v[60:63], v[160:163], a[64:67], v[60:63]
    ds_read_b128 v[136:139], v6 offset:3328
    v_mfma_f32_16x16x32_bf16 v[76:79], v[164:167], a[64:67], v[76:79]
    ds_read_b128 v[140:143], v6 offset:3360
    s_waitcnt lgkmcnt(9)
    v_mfma_f32_16x16x32_bf16 v[60:63], v[168:171], a[60:63], v[60:63]
    ds_read_b128 v[144:147], v6 offset:3392
    s_waitcnt lgkmcnt(9)
    v_mfma_f32_16x16x32_bf16 v[76:79], v[172:175], a[60:63], v[76:79]
    ds_read_b128 v[148:151], v6 offset:3424
    s_waitcnt lgkmcnt(9)
    v_mfma_f32_16x16x32_bf16 v[60:63], v[112:115], a[56:59], v[60:63]
    ds_read_b128 v[152:155], v6 offset:3456
    s_waitcnt lgkmcnt(9)
    v_mfma_f32_16x16x32_bf16 v[76:79], v[116:119], a[56:59], v[76:79]
    ds_read_b128 v[156:159], v6 offset:3488
    s_waitcnt lgkmcnt(9)
    v_mfma_f32_16x16x32_bf16 v[60:63], v[120:123], a[52:55], v[60:63]
    ds_read_b128 v[160:163], v6 offset:3520
    s_waitcnt lgkmcnt(9)
    v_mfma_f32_16x16x32_bf16 v[76:79], v[124:127], a[52:55], v[76:79]
    ds_read_b128 v[164:167], v6 offset:3552
    s_waitcnt lgkmcnt(9)
    v_mfma_f32_16x16x32_bf16 v[60:63], v[128:131], a[48:51], v[60:63]
    ds_read_b128 v[168:171], v6 offset:3584
    s_waitcnt lgkmcnt(9)
    v_mfma_f32_16x16x32_bf16 v[76:79], v[132:135], a[48:51], v[76:79]
    ds_read_b128 v[172:175], v6 offset:3616
    s_waitcnt lgkmcnt(9)
    v_mfma_f32_16x16x32_bf16 v[60:63], v[136:139], a[44:47], v[60:63]
    ds_read_b128 v[112:115], v6 offset:3648
    s_waitcnt lgkmcnt(9)
    v_mfma_f32_16x16x32_bf16 v[76:79], v[140:143], a[44:47], v[76:79]
    ds_read_b128 v[116:119], v6 offset:3680
    s_waitcnt lgkmcnt(9)
    v_mfma_f32_16x16x32_bf16 v[60:63], v[144:147], a[40:43], v[60:63]
    ds_read_b128 v[120:123], v6 offset:3712
    s_waitcnt lgkmcnt(9)
    v_mfma_f32_16x16x32_bf16 v[76:79], v[148:151], a[40:43], v[76:79]
    ds_read_b128 v[124:127], v6 offset:3744
    s_waitcnt lgkmcnt(9)
    v_mfma_f32_16x16x32_bf16 v[60:63], v[152:155], a[36:39], v[60:63]
    ds_read_b128 v[128:131], v6 offset:3776
    s_waitcnt lgkmcnt(9)
    v_mfma_f32_16x16x32_bf16 v[76:79], v[156:159], a[36:39], v[76:79]
    ds_read_b128 v[132:135], v6 offset:3808
    s_waitcnt lgkmcnt(9)
    v_mfma_f32_16x16x32_bf16 v[60:63], v[160:163], a[32:35], v[60:63]
    ds_read_b128 v[136:139], v6 offset:3840
    s_waitcnt lgkmcnt(9)
    v_mfma_f32_16x16x32_bf16 v[76:79], v[164:167], a[32:35], v[76:79]
    ds_read_b128 v[140:143], v6 offset:3872
    s_waitcnt lgkmcnt(9)
    v_mfma_f32_16x16x32_bf16 v[60:63], v[168:171], a[28:31], v[60:63]
    ds_read_b128 v[144:147], v6 offset:3904
    s_waitcnt lgkmcnt(9)
    v_mfma_f32_16x16x32_bf16 v[76:79], v[172:175], a[28:31], v[76:79]
    ds_read_b128 v[148:151], v6 offset:3936
    s_waitcnt lgkmcnt(9)
    v_mfma_f32_16x16x32_bf16 v[60:63], v[112:115], a[24:27], v[60:63]
    ds_read_b128 v[152:155], v6 offset:3968
    s_waitcnt lgkmcnt(9)
    v_mfma_f32_16x16x32_bf16 v[76:79], v[116:119], a[24:27], v[76:79]
    ds_read_b128 v[156:159], v6 offset:4000
    s_waitcnt lgkmcnt(9)
    v_mfma_f32_16x16x32_bf16 v[60:63], v[120:123], a[20:23], v[60:63]
    ds_read_b128 v[160:163], v6 offset:4032
    s_waitcnt lgkmcnt(9)
    v_mfma_f32_16x16x32_bf16 v[76:79], v[124:127], a[20:23], v[76:79]
    ds_read_b128 v[164:167], v6 offset:4064
    s_waitcnt lgkmcnt(9)
    v_mfma_f32_16x16x32_bf16 v[60:63], v[128:131], a[16:19], v[60:63]
    s_waitcnt vmcnt(2)
    ds_read_b128 a[60:63], v7 offset:240
    s_waitcnt lgkmcnt(9)
    v_mfma_f32_16x16x32_bf16 v[76:79], v[132:135], a[16:19], v[76:79]
    s_waitcnt lgkmcnt(8)
    v_mfma_f32_16x16x32_bf16 v[60:63], v[136:139], a[12:15], v[60:63]
    ds_read_b128 a[124:127], v7 offset:496
    s_waitcnt lgkmcnt(8)
    v_mfma_f32_16x16x32_bf16 v[76:79], v[140:143], a[12:15], v[76:79]
    s_waitcnt lgkmcnt(7)
    v_mfma_f32_16x16x32_bf16 v[60:63], v[144:147], a[8:11], v[60:63]
    ds_read_b128 a[188:191], v7 offset:752
    s_waitcnt lgkmcnt(7)
    v_mfma_f32_16x16x32_bf16 v[76:79], v[148:151], a[8:11], v[76:79]
    s_waitcnt lgkmcnt(6)
    v_mfma_f32_16x16x32_bf16 v[60:63], v[152:155], a[4:7], v[60:63]
    ds_read_b128 a[252:255], v7 offset:1008
    s_waitcnt lgkmcnt(6)
    v_mfma_f32_16x16x32_bf16 v[76:79], v[156:159], a[4:7], v[76:79]
    s_waitcnt lgkmcnt(5)
    v_mfma_f32_16x16x32_bf16 v[60:63], v[160:163], a[0:3], v[60:63]
    ds_read_b128 v[168:171], v6 offset:0
    s_waitcnt lgkmcnt(5)
    v_mfma_f32_16x16x32_bf16 v[76:79], v[164:167], a[0:3], v[76:79]
    ds_read_b128 v[172:175], v6 offset:32
    s_add_u32 s41, s38, 4096
    v_cvt_pk_bf16_f32 v80, v16, v48
    v_cvt_pk_bf16_f32 v81, v17, v49
    v_cvt_pk_bf16_f32 v82, v18, v50
    v_cvt_pk_bf16_f32 v83, v19, v51
    buffer_store_dwordx4 v[80:83], v228, s[8:11], s38 offen offset:0 sc1
    v_cvt_pk_bf16_f32 v84, v32, v64
    v_cvt_pk_bf16_f32 v85, v33, v65
    v_cvt_pk_bf16_f32 v86, v34, v66
    v_cvt_pk_bf16_f32 v87, v35, v67
    buffer_store_dwordx4 v[84:87], v228, s[8:11], s38 offen offset:64 sc1
    v_cvt_pk_bf16_f32 v88, v20, v52
    v_cvt_pk_bf16_f32 v89, v21, v53
    v_cvt_pk_bf16_f32 v90, v22, v54
    v_cvt_pk_bf16_f32 v91, v23, v55
    buffer_store_dwordx4 v[88:91], v228, s[8:11], s38 offen offset:2048 sc1
    v_cvt_pk_bf16_f32 v92, v36, v68
    v_cvt_pk_bf16_f32 v93, v37, v69
    v_cvt_pk_bf16_f32 v94, v38, v70
    v_cvt_pk_bf16_f32 v95, v39, v71
    buffer_store_dwordx4 v[92:95], v228, s[8:11], s38 offen offset:2112 sc1
    v_cvt_pk_bf16_f32 v96, v24, v56
    v_cvt_pk_bf16_f32 v97, v25, v57
    v_cvt_pk_bf16_f32 v98, v26, v58
    v_cvt_pk_bf16_f32 v99, v27, v59
    buffer_store_dwordx4 v[96:99], v228, s[8:11], s41 offen offset:0 sc1
    v_cvt_pk_bf16_f32 v100, v40, v72
    v_cvt_pk_bf16_f32 v101, v41, v73
    v_cvt_pk_bf16_f32 v102, v42, v74
    v_cvt_pk_bf16_f32 v103, v43, v75
    buffer_store_dwordx4 v[100:103], v228, s[8:11], s41 offen offset:64 sc1
    v_cvt_pk_bf16_f32 v104, v28, v60
    v_cvt_pk_bf16_f32 v105, v29, v61
    v_cvt_pk_bf16_f32 v106, v30, v62
    v_cvt_pk_bf16_f32 v107, v31, v63
    buffer_store_dwordx4 v[104:107], v228, s[8:11], s41 offen offset:2048 sc1
    v_cvt_pk_bf16_f32 v108, v44, v76
    v_cvt_pk_bf16_f32 v109, v45, v77
    v_cvt_pk_bf16_f32 v110, v46, v78
    v_cvt_pk_bf16_f32 v111, v47, v79
    buffer_store_dwordx4 v[108:111], v228, s[8:11], s41 offen offset:2112 sc1
    s_add_u32 s38, s38, 8192
    s_add_u32 s42, s42, 1
    s_cmp_lt_u32 s42, 4
    s_cbranch_scc1 .cvl_427

    s_waitcnt vmcnt(0) lgkmcnt(0)
    s_barrier
    s_mov_b32 s5, 160
    s_cmp_lg_u32 s24, 0
    s_cbranch_scc1 .sg_428
    s_mov_b64 exec, 1
    v_mov_b32 v4, 1
    v_mov_b32 v5, 0
    buffer_atomic_add v4, v5, s[20:23], s5 offen sc1
    s_mov_b64 exec, -1

.sg_428:
    v_and_b32 v1, 63, v0
    v_and_b32 v2, 15, v1
    v_lshrrev_b32 v3, 4, v1

    s_sub_u32 s4, s26, 24
    s_lshr_b32 s25, s4, 1
    s_and_b32 s4, s4, 1
    s_lshl_b32 s4, s4, 2
    s_lshl_b32 s5, s91, 3
    s_add_u32 s4, s4, s5
    s_add_u32 s26, s4, s24
    s_lshl_b32 s35, s26, 8
    s_add_u32 s35, s35, 92274688
    s_mov_b32 s37, 0x3db504f3
    s_mov_b32 s38, 0x3fb8aa3b
    v_lshlrev_b32 v8, 4, v1
    v_min_u32 v9, 2, v1
    v_lshlrev_b32 v9, 13, v9
    v_lshlrev_b32 v6, 4, v3
    v_and_b32 v5, 7, v2
    v_add_u32 v10, v6, v5
    v_lshlrev_b32 v10, 4, v10
    v_lshlrev_b32 v11, 4, v2
    v_lshlrev_b32 v5, 3, v3
    v_add_u32 v11, v11, v5
    v_cmp_gt_u32 s[60:61], 32, v1
    v_lshlrev_b32 v5, 2, v3
    v_mov_b32 v12, 0
    v_mov_b32 v13, 0
    v_mov_b32 v14, 0xff800000
    v_lshlrev_b32 v204, 9, v1
    v_add_u32 v204, 4604, v204
    s_lshl_b32 s4, s25, 5
    s_add_u32 s4, s4, s26
    s_lshl_b32 s27, s4, 13
    s_mul_i32 s33, s4, 6144
    s_add_u32 s33, s33, 67108864
    s_add_u32 s36, s25, 1

    v_add_u32 v7, 0, v5
    v_cmp_le_u32 s[40:41], v7, v2
    v_add_u32 v7, 1, v5
    v_cmp_le_u32 s[42:43], v7, v2
    v_add_u32 v7, 2, v5
    v_cmp_le_u32 s[44:45], v7, v2
    v_add_u32 v7, 3, v5
    v_cmp_le_u32 s[46:47], v7, v2
    v_mov_b32 v112, 0
    v_mov_b32 v113, 0
    v_mov_b32 v114, 0
    v_mov_b32 v115, 0
    v_mov_b32 v116, 0
    v_mov_b32 v117, 0
    v_mov_b32 v118, 0
    v_mov_b32 v119, 0
    v_mov_b32 v120, 0
    v_mov_b32 v121, 0
    v_mov_b32 v122, 0
    v_mov_b32 v123, 0
    v_mov_b32 v124, 0
    v_mov_b32 v125, 0
    v_mov_b32 v126, 0
    v_mov_b32 v127, 0
    v_mov_b32 v128, 0
    v_mov_b32 v129, 0
    v_mov_b32 v130, 0
    v_mov_b32 v131, 0
    v_mov_b32 v132, 0
    v_mov_b32 v133, 0
    v_mov_b32 v134, 0
    v_mov_b32 v135, 0
    v_mov_b32 v136, 0
    v_mov_b32 v137, 0
    v_mov_b32 v138, 0
    v_mov_b32 v139, 0
    v_mov_b32 v140, 0
    v_mov_b32 v141, 0
    v_mov_b32 v142, 0
    v_mov_b32 v143, 0
    v_mov_b32 v15, -1
    s_mov_b32 s62, 0
    s_mov_b64 exec, 7
.wf_429:
    buffer_load_dword v15, v9, s[8:11], s35 offen sc1
    s_waitcnt vmcnt(0)
    v_cmp_gt_u32 vcc, s36, v15
    s_cbranch_vccz .wfd_430
    s_sleep 2
    s_add_u32 s62, s62, 1
    s_cmp_gt_u32 s62, 0x400000
    s_cbranch_scc1 .mg_end_1
    s_branch .wf_429

.wfd_430:
    s_mov_b64 exec, -1
    s_add_u32 s28, s27, 4096
    s_add_u32 s29, s27, 16777216
    s_add_u32 s30, s27, 16781312
    s_add_u32 s31, s27, 33554432
    s_add_u32 s32, s27, 33558528

    buffer_load_dwordx4 a[0:3], v8, s[8:11], s27 offen offset:0
    buffer_load_dwordx4 a[16:19], v8, s[8:11], s28 offen offset:0
    buffer_load_dwordx4 a[32:35], v8, s[8:11], s29 offen offset:0
    buffer_load_dwordx4 a[48:51], v8, s[8:11], s30 offen offset:0
    buffer_load_dwordx4 a[4:7], v8, s[8:11], s27 offen offset:1024
    buffer_load_dwordx4 a[20:23], v8, s[8:11], s28 offen offset:1024
    buffer_load_dwordx4 a[36:39], v8, s[8:11], s29 offen offset:1024
    buffer_load_dwordx4 a[52:55], v8, s[8:11], s30 offen offset:1024
    buffer_load_dwordx4 a[8:11], v8, s[8:11], s27 offen offset:2048
    buffer_load_dwordx4 a[24:27], v8, s[8:11], s28 offen offset:2048
    buffer_load_dwordx4 a[40:43], v8, s[8:11], s29 offen offset:2048
    buffer_load_dwordx4 a[56:59], v8, s[8:11], s30 offen offset:2048
    buffer_load_dwordx4 a[12:15], v8, s[8:11], s27 offen offset:3072
    buffer_load_dwordx4 a[28:31], v8, s[8:11], s28 offen offset:3072
    buffer_load_dwordx4 a[44:47], v8, s[8:11], s29 offen offset:3072
    buffer_load_dwordx4 a[60:63], v8, s[8:11], s30 offen offset:3072
    buffer_load_dwordx4 a[64:67], v8, s[8:11], s31 offen offset:0
    buffer_load_dwordx4 a[68:71], v8, s[8:11], s31 offen offset:1024
    buffer_load_dwordx4 a[72:75], v8, s[8:11], s31 offen offset:2048
    buffer_load_dwordx4 a[76:79], v8, s[8:11], s31 offen offset:3072
    buffer_load_dwordx4 a[80:83], v8, s[8:11], s32 offen offset:0
    buffer_load_dwordx4 a[84:87], v8, s[8:11], s32 offen offset:1024
    buffer_load_dwordx4 a[88:91], v8, s[8:11], s32 offen offset:2048
    buffer_load_dwordx4 a[92:95], v8, s[8:11], s32 offen offset:3072
    buffer_load_dwordx4 v[80:83], v10, s[8:11], s33 offen offset:2048 sc1
    buffer_load_dwordx4 v[84:87], v10, s[8:11], s33 offen offset:2176 sc1
    buffer_load_dwordx4 v[88:91], v10, s[8:11], s33 offen offset:3072 sc1
    buffer_load_dwordx4 v[92:95], v10, s[8:11], s33 offen offset:3200 sc1
    s_add_u32 s4, s33, 4096
    s_mov_b64 exec, s[60:61]
    buffer_load_dwordx2 v[128:129], v11, s[8:11], s4 offen offset:0 sc1
    buffer_load_dwordx2 v[130:131], v11, s[8:11], s4 offen offset:256 sc1
    buffer_load_dwordx2 v[132:133], v11, s[8:11], s4 offen offset:512 sc1
    buffer_load_dwordx2 v[134:135], v11, s[8:11], s4 offen offset:768 sc1
    buffer_load_dwordx2 v[136:137], v11, s[8:11], s4 offen offset:1024 sc1
    buffer_load_dwordx2 v[138:139], v11, s[8:11], s4 offen offset:1280 sc1
    buffer_load_dwordx2 v[140:141], v11, s[8:11], s4 offen offset:1536 sc1
    buffer_load_dwordx2 v[142:143], v11, s[8:11], s4 offen offset:1792 sc1
    s_mov_b64 exec, -1
    s_waitcnt vmcnt(0)
.att_431:
    s_mov_b32 s34, s33
    s_add_u32 s50, s27, 50331648
    s_add_u32 s51, s27, 50335744
    s_cmp_lt_u32 s25, 60
    s_cselect_b32 s4, 4, 0
    s_cselect_b32 s5, 1048576, 0
    s_cselect_b32 s6, 786432, 0
    s_add_u32 s36, s36, s4
    s_add_u32 s27, s27, s5
    s_add_u32 s33, s33, s6
    s_waitcnt vmcnt(8)

    v_cmp_gt_u32 vcc, s36, v15
    s_cbranch_vccnz .atw_432
.atb_433:
    s_add_u32 s28, s27, 4096
    s_add_u32 s29, s27, 16777216
    s_add_u32 s30, s27, 16781312
    s_add_u32 s31, s27, 33554432
    s_add_u32 s32, s27, 33558528

    buffer_load_dwordx4 a[96:99], v8, s[8:11], s27 offen offset:0
    buffer_load_dwordx4 a[112:115], v8, s[8:11], s28 offen offset:0
    buffer_load_dwordx4 a[128:131], v8, s[8:11], s29 offen offset:0
    buffer_load_dwordx4 a[144:147], v8, s[8:11], s30 offen offset:0
    buffer_load_dwordx4 a[100:103], v8, s[8:11], s27 offen offset:1024
    buffer_load_dwordx4 a[116:119], v8, s[8:11], s28 offen offset:1024
    buffer_load_dwordx4 a[132:135], v8, s[8:11], s29 offen offset:1024
    buffer_load_dwordx4 a[148:151], v8, s[8:11], s30 offen offset:1024
    buffer_load_dwordx4 a[104:107], v8, s[8:11], s27 offen offset:2048
    buffer_load_dwordx4 a[120:123], v8, s[8:11], s28 offen offset:2048
    buffer_load_dwordx4 a[136:139], v8, s[8:11], s29 offen offset:2048
    buffer_load_dwordx4 a[152:155], v8, s[8:11], s30 offen offset:2048
    buffer_load_dwordx4 a[108:111], v8, s[8:11], s27 offen offset:3072
    buffer_load_dwordx4 a[124:127], v8, s[8:11], s28 offen offset:3072
    buffer_load_dwordx4 a[140:143], v8, s[8:11], s29 offen offset:3072
    buffer_load_dwordx4 a[156:159], v8, s[8:11], s30 offen offset:3072
    buffer_load_dwordx4 a[160:163], v8, s[8:11], s31 offen offset:0
    buffer_load_dwordx4 a[164:167], v8, s[8:11], s31 offen offset:1024
    buffer_load_dwordx4 a[168:171], v8, s[8:11], s31 offen offset:2048
    buffer_load_dwordx4 a[172:175], v8, s[8:11], s31 offen offset:3072
    buffer_load_dwordx4 a[176:179], v8, s[8:11], s32 offen offset:0
    buffer_load_dwordx4 a[180:183], v8, s[8:11], s32 offen offset:1024
    buffer_load_dwordx4 a[184:187], v8, s[8:11], s32 offen offset:2048
    buffer_load_dwordx4 a[188:191], v8, s[8:11], s32 offen offset:3072
    buffer_load_dwordx4 v[96:99], v10, s[8:11], s33 offen offset:2048 sc1
    buffer_load_dwordx4 v[100:103], v10, s[8:11], s33 offen offset:2176 sc1
    buffer_load_dwordx4 v[104:107], v10, s[8:11], s33 offen offset:3072 sc1
    buffer_load_dwordx4 v[108:111], v10, s[8:11], s33 offen offset:3200 sc1
    s_add_u32 s4, s33, 4096
    s_mov_b64 exec, s[60:61]
    buffer_load_dwordx2 v[112:113], v11, s[8:11], s4 offen offset:0 sc1
    buffer_load_dwordx2 v[114:115], v11, s[8:11], s4 offen offset:256 sc1
    buffer_load_dwordx2 v[116:117], v11, s[8:11], s4 offen offset:512 sc1
    buffer_load_dwordx2 v[118:119], v11, s[8:11], s4 offen offset:768 sc1
    buffer_load_dwordx2 v[120:121], v11, s[8:11], s4 offen offset:1024 sc1
    buffer_load_dwordx2 v[122:123], v11, s[8:11], s4 offen offset:1280 sc1
    buffer_load_dwordx2 v[124:125], v11, s[8:11], s4 offen offset:1536 sc1
    buffer_load_dwordx2 v[126:127], v11, s[8:11], s4 offen offset:1792 sc1
    s_mov_b64 exec, -1
    v_mfma_f32_16x16x32_bf16 v[144:147], a[32:35], a[0:3], 0
    v_mfma_f32_16x16x32_bf16 v[156:159], a[32:35], a[16:19], 0
    v_mfma_f32_16x16x32_bf16 v[160:163], a[48:51], a[16:19], 0
    v_mfma_f32_16x16x32_bf16 v[144:147], a[36:39], a[4:7], v[144:147]
    v_mfma_f32_16x16x32_bf16 v[156:159], a[36:39], a[20:23], v[156:159]
    v_mfma_f32_16x16x32_bf16 v[160:163], a[52:55], a[20:23], v[160:163]
    v_mfma_f32_16x16x32_bf16 v[144:147], a[40:43], a[8:11], v[144:147]
    v_mfma_f32_16x16x32_bf16 v[156:159], a[40:43], a[24:27], v[156:159]
    v_mfma_f32_16x16x32_bf16 v[160:163], a[56:59], a[24:27], v[160:163]
    v_mfma_f32_16x16x32_bf16 v[144:147], a[44:47], a[12:15], v[144:147]
    v_mfma_f32_16x16x32_bf16 v[156:159], a[44:47], a[28:31], v[156:159]
    v_mfma_f32_16x16x32_bf16 v[160:163], a[60:63], a[28:31], v[160:163]
    s_nop 7
    v_cvt_pk_bf16_f32 v168, v144, v145
    v_cvt_pk_bf16_f32 v170, v146, v147
    v_and_b32 v169, 0xffff0000, v168
    v_lshlrev_b32 v168, 16, v168
    v_and_b32 v171, 0xffff0000, v170
    v_lshlrev_b32 v170, 16, v170
    v_mul_f32 v168, s37, v168
    v_mul_f32 v169, s37, v169
    v_mul_f32 v170, s37, v170
    v_mul_f32 v171, s37, v171
    v_cvt_pk_bf16_f32 v144, v168, v169
    v_cvt_pk_bf16_f32 v146, v170, v171
    v_and_b32 v145, 0xffff0000, v144
    v_lshlrev_b32 v144, 16, v144
    v_and_b32 v147, 0xffff0000, v146
    v_lshlrev_b32 v146, 16, v146
    v_cvt_pk_bf16_f32 v192, v156, v157
    v_cvt_pk_bf16_f32 v194, v158, v159
    v_cvt_pk_bf16_f32 v196, v160, v161
    v_cvt_pk_bf16_f32 v198, v162, v163
    v_and_b32 v193, 0xffff0000, v192
    v_lshlrev_b32 v192, 16, v192
    v_and_b32 v195, 0xffff0000, v194
    v_lshlrev_b32 v194, 16, v194
    v_and_b32 v197, 0xffff0000, v196
    v_lshlrev_b32 v196, 16, v196
    v_and_b32 v199, 0xffff0000, v198
    v_lshlrev_b32 v198, 16, v198
    v_mul_f32 v192, s37, v192
    v_mul_f32 v193, s37, v193
    v_mul_f32 v194, s37, v194
    v_mul_f32 v195, s37, v195
    v_mul_f32 v196, s37, v196
    v_mul_f32 v197, s37, v197
    v_mul_f32 v198, s37, v198
    v_mul_f32 v199, s37, v199
    v_cvt_pk_bf16_f32 v156, v192, v193
    v_cvt_pk_bf16_f32 v158, v194, v195
    v_cvt_pk_bf16_f32 v160, v196, v197
    v_cvt_pk_bf16_f32 v162, v198, v199
    v_and_b32 v157, 0xffff0000, v156
    v_lshlrev_b32 v156, 16, v156
    v_and_b32 v159, 0xffff0000, v158
    v_lshlrev_b32 v158, 16, v158
    v_and_b32 v161, 0xffff0000, v160
    v_lshlrev_b32 v160, 16, v160
    v_and_b32 v163, 0xffff0000, v162
    v_lshlrev_b32 v162, 16, v162
    v_cndmask_b32 v144, v14, v144, s[40:41]
    v_cndmask_b32 v145, v14, v145, s[42:43]
    v_cndmask_b32 v146, v14, v146, s[44:45]
    v_cndmask_b32 v147, v14, v147, s[46:47]
    v_cndmask_b32 v160, v14, v160, s[40:41]
    v_cndmask_b32 v161, v14, v161, s[42:43]
    v_cndmask_b32 v162, v14, v162, s[44:45]
    v_cndmask_b32 v163, v14, v163, s[46:47]
    s_mov_b32 s62, 0
.kmp_434:
    v_max3_u32 v4, v80, v81, v82
    v_max3_u32 v5, v83, v84, v85
    v_max3_u32 v4, v4, v86, v87
    v_max3_u32 v5, v5, v88, v89
    v_max3_u32 v4, v4, v90, v91
    v_max3_u32 v5, v5, v92, v93
    v_max3_u32 v4, v4, v94, v95
    v_max3_u32 v5, v5, v128, v129
    v_max3_u32 v4, v4, v130, v131
    v_max3_u32 v5, v5, v132, v133
    v_max3_u32 v4, v4, v134, v135
    v_max3_u32 v5, v5, v136, v137
    v_max3_u32 v4, v4, v138, v139
    v_max3_u32 v5, v5, v140, v141
    v_max3_u32 v4, v4, v142, v143
    v_max_u32 v4, v4, v5
    v_cmp_eq_u32 vcc, -1, v4
    s_cbranch_vccnz .kmf_435

    v_mfma_f32_16x16x32_bf16 v[152:155], v[80:83], a[0:3], 0
    v_mfma_f32_16x16x32_bf16 v[164:167], v[80:83], a[16:19], 0
    v_mfma_f32_16x16x32_bf16 v[152:155], v[84:87], a[4:7], v[152:155]
    v_mfma_f32_16x16x32_bf16 v[164:167], v[84:87], a[20:23], v[164:167]
    v_mfma_f32_16x16x32_bf16 v[152:155], v[88:91], a[8:11], v[152:155]
    v_mfma_f32_16x16x32_bf16 v[164:167], v[88:91], a[24:27], v[164:167]
    v_mfma_f32_16x16x32_bf16 v[152:155], v[92:95], a[12:15], v[152:155]
    v_mfma_f32_16x16x32_bf16 v[164:167], v[92:95], a[28:31], v[164:167]
    s_nop 5
    v_cvt_pk_bf16_f32 v176, v152, v153
    v_cvt_pk_bf16_f32 v178, v154, v155
    v_and_b32 v177, 0xffff0000, v176
    v_lshlrev_b32 v176, 16, v176
    v_and_b32 v179, 0xffff0000, v178
    v_lshlrev_b32 v178, 16, v178
    v_mul_f32 v176, s37, v176
    v_mul_f32 v177, s37, v177
    v_mul_f32 v178, s37, v178
    v_mul_f32 v179, s37, v179
    v_cvt_pk_bf16_f32 v152, v176, v177
    v_cvt_pk_bf16_f32 v154, v178, v179
    v_and_b32 v153, 0xffff0000, v152
    v_lshlrev_b32 v152, 16, v152
    v_and_b32 v155, 0xffff0000, v154
    v_lshlrev_b32 v154, 16, v154
    v_cndmask_b32 v152, v14, v152, s[60:61]
    v_cndmask_b32 v153, v14, v153, s[60:61]
    v_cndmask_b32 v154, v14, v154, s[60:61]
    v_cndmask_b32 v155, v14, v155, s[60:61]
    v_cvt_pk_bf16_f32 v200, v164, v165
    v_cvt_pk_bf16_f32 v202, v166, v167
    v_and_b32 v201, 0xffff0000, v200
    v_lshlrev_b32 v200, 16, v200
    v_and_b32 v203, 0xffff0000, v202
    v_lshlrev_b32 v202, 16, v202
    v_mul_f32 v200, s37, v200
    v_mul_f32 v201, s37, v201
    v_mul_f32 v202, s37, v202
    v_mul_f32 v203, s37, v203
    v_cvt_pk_bf16_f32 v164, v200, v201
    v_cvt_pk_bf16_f32 v166, v202, v203
    v_and_b32 v165, 0xffff0000, v164
    v_lshlrev_b32 v164, 16, v164
    v_and_b32 v167, 0xffff0000, v166
    v_lshlrev_b32 v166, 16, v166
    v_cndmask_b32 v164, v14, v164, s[60:61]
    v_cndmask_b32 v165, v14, v165, s[60:61]
    v_cndmask_b32 v166, v14, v166, s[60:61]
    v_cndmask_b32 v167, v14, v167, s[60:61]
    v_max3_f32 v4, v144, v145, v146
    v_max3_f32 v5, v147, v152, v153
    v_max3_f32 v4, v4, v154, v155
    v_max_f32 v4, v4, v5

    v_max3_f32 v6, v156, v157, v158
    v_max3_f32 v7, v159, v160, v161
    v_max3_f32 v6, v6, v162, v163
    v_max3_f32 v7, v7, v164, v165
    v_max3_f32 v6, v6, v166, v167
    v_max_f32 v6, v6, v7

    v_mov_b32 v5, v4
    v_mov_b32 v7, v6
    s_nop 0
    v_permlane32_swap_b32 v4, v5
    v_permlane32_swap_b32 v6, v7
    v_max_f32 v4, v4, v5
    v_max_f32 v6, v6, v7

    v_mov_b32 v5, v4
    v_mov_b32 v7, v6
    s_nop 0
    v_permlane16_swap_b32 v4, v5
    v_permlane16_swap_b32 v6, v7
    v_max_f32 v4, v4, v5
    v_max_f32 v6, v6, v7

    v_mul_f32 v4, s38, v4
    v_mul_f32 v6, s38, v6
    v_fma_f32 v168, v144, s38, -v4
    v_fma_f32 v169, v145, s38, -v4
    v_fma_f32 v170, v146, s38, -v4
    v_fma_f32 v171, v147, s38, -v4
    v_fma_f32 v176, v152, s38, -v4
    v_fma_f32 v177, v153, s38, -v4
    v_fma_f32 v178, v154, s38, -v4
    v_fma_f32 v179, v155, s38, -v4
    v_fma_f32 v192, v156, s38, -v6
    v_fma_f32 v193, v157, s38, -v6
    v_fma_f32 v194, v158, s38, -v6
    v_fma_f32 v195, v159, s38, -v6
    v_fma_f32 v196, v160, s38, -v6
    v_fma_f32 v197, v161, s38, -v6
    v_fma_f32 v198, v162, s38, -v6
    v_fma_f32 v199, v163, s38, -v6
    v_fma_f32 v200, v164, s38, -v6
    v_fma_f32 v201, v165, s38, -v6
    v_fma_f32 v202, v166, s38, -v6
    v_fma_f32 v203, v167, s38, -v6
    v_exp_f32 v168, v168
    v_exp_f32 v169, v169
    v_exp_f32 v170, v170
    v_exp_f32 v171, v171
    v_exp_f32 v176, v176
    v_exp_f32 v177, v177
    v_exp_f32 v178, v178
    v_exp_f32 v179, v179
    v_exp_f32 v192, v192
    v_exp_f32 v193, v193
    v_exp_f32 v194, v194
    v_exp_f32 v195, v195
    v_exp_f32 v196, v196
    v_exp_f32 v197, v197
    v_exp_f32 v198, v198
    v_exp_f32 v199, v199
    v_exp_f32 v200, v200
    v_exp_f32 v201, v201
    v_exp_f32 v202, v202
    v_exp_f32 v203, v203
    v_add_f32 v4, v168, v169
    v_add_f32 v5, v170, v171
    v_add_f32 v4, v4, v176
    v_add_f32 v5, v5, v177
    v_add_f32 v4, v4, v178
    v_add_f32 v5, v5, v179
    v_add_f32 v4, v4, v5
    v_add_f32 v6, v192, v193
    v_add_f32 v7, v194, v195
    v_add_f32 v6, v6, v196
    v_add_f32 v7, v7, v197
    v_add_f32 v6, v6, v198
    v_add_f32 v7, v7, v199
    v_add_f32 v6, v6, v200
    v_add_f32 v7, v7, v201
    v_add_f32 v6, v6, v202
    v_add_f32 v7, v7, v203
    v_add_f32 v6, v6, v7
    v_mov_b32 v5, v4
    v_mov_b32 v7, v6
    s_nop 0
    v_permlane32_swap_b32 v4, v5
    v_permlane32_swap_b32 v6, v7
    v_add_f32 v4, v4, v5
    v_add_f32 v6, v6, v7

    v_mov_b32 v5, v4
    v_mov_b32 v7, v6
    s_nop 0
    v_permlane16_swap_b32 v4, v5
    v_permlane16_swap_b32 v6, v7
    v_add_f32 v4, v4, v5
    v_add_f32 v6, v6, v7

    v_rcp_f32 v4, v4
    v_rcp_f32 v6, v6
    v_mov_b32 v182, 0
    v_mov_b32 v183, 0
    v_mul_f32 v168, v4, v168
    v_mul_f32 v169, v4, v169
    v_mul_f32 v170, v4, v170
    v_mul_f32 v171, v4, v171
    v_mul_f32 v176, v4, v176
    v_mul_f32 v177, v4, v177
    v_mul_f32 v178, v4, v178
    v_mul_f32 v179, v4, v179
    v_cvt_pk_bf16_f32 v180, v168, v169
    v_cvt_pk_bf16_f32 v181, v170, v171
    v_cvt_pk_bf16_f32 v184, v176, v177
    v_cvt_pk_bf16_f32 v185, v178, v179
    v_mul_f32 v192, v6, v192
    v_mul_f32 v193, v6, v193
    v_mul_f32 v194, v6, v194
    v_mul_f32 v195, v6, v195
    v_mul_f32 v196, v6, v196
    v_mul_f32 v197, v6, v197
    v_mul_f32 v198, v6, v198
    v_mul_f32 v199, v6, v199
    v_mul_f32 v200, v6, v200
    v_mul_f32 v201, v6, v201
    v_mul_f32 v202, v6, v202
    v_mul_f32 v203, v6, v203
    v_cvt_pk_bf16_f32 v186, v192, v193
    v_cvt_pk_bf16_f32 v187, v194, v195
    v_cvt_pk_bf16_f32 v188, v196, v197
    v_cvt_pk_bf16_f32 v189, v198, v199
    v_cvt_pk_bf16_f32 v190, v200, v201
    v_cvt_pk_bf16_f32 v191, v202, v203
    s_add_u32 s25, s25, 4

    v_mfma_f32_16x16x32_bf16 v[16:19], a[64:67], v[180:183], 0
    v_mfma_f32_16x16x32_bf16 v[20:23], a[68:71], v[180:183], 0
    v_mfma_f32_16x16x32_bf16 v[24:27], a[72:75], v[180:183], 0
    v_mfma_f32_16x16x32_bf16 v[28:31], a[76:79], v[180:183], 0
    v_mfma_f32_16x16x32_bf16 v[32:35], a[80:83], v[180:183], 0
    v_mfma_f32_16x16x32_bf16 v[36:39], a[84:87], v[180:183], 0
    v_mfma_f32_16x16x32_bf16 v[40:43], a[88:91], v[180:183], 0
    v_mfma_f32_16x16x32_bf16 v[44:47], a[92:95], v[180:183], 0
    v_mfma_f32_16x16x32_bf16 v[48:51], a[64:67], v[186:189], 0
    v_mfma_f32_16x16x32_bf16 v[52:55], a[68:71], v[186:189], 0
    v_mfma_f32_16x16x32_bf16 v[56:59], a[72:75], v[186:189], 0
    v_mfma_f32_16x16x32_bf16 v[60:63], a[76:79], v[186:189], 0
    v_mfma_f32_16x16x32_bf16 v[64:67], a[80:83], v[186:189], 0
    v_mfma_f32_16x16x32_bf16 v[68:71], a[84:87], v[186:189], 0
    v_mfma_f32_16x16x32_bf16 v[72:75], a[88:91], v[186:189], 0
    v_mfma_f32_16x16x32_bf16 v[76:79], a[92:95], v[186:189], 0
    s_waitcnt vmcnt(36)
    s_mov_b64 exec, 1
    buffer_store_dword v12, v13, s[8:11], s92 offen sc1
    s_mov_b64 exec, -1

    v_mfma_f32_16x16x16_bf16 v[16:19], v[128:129], v[184:185], v[16:19]
    v_mfma_f32_16x16x16_bf16 v[20:23], v[130:131], v[184:185], v[20:23]
    v_add_u32 v12, 1, v12
    v_mfma_f32_16x16x16_bf16 v[24:27], v[132:133], v[184:185], v[24:27]
    v_mfma_f32_16x16x16_bf16 v[28:31], v[134:135], v[184:185], v[28:31]
    v_mfma_f32_16x16x16_bf16 v[32:35], v[136:137], v[184:185], v[32:35]
    v_mfma_f32_16x16x16_bf16 v[36:39], v[138:139], v[184:185], v[36:39]
    v_cvt_pk_bf16_f32 v208, v16, v17
    v_cvt_pk_bf16_f32 v209, v18, v19
    v_cvt_pk_bf16_f32 v210, v20, v21
    v_cvt_pk_bf16_f32 v211, v22, v23
    buffer_store_dwordx4 v[208:211], v8, s[8:11], s50 offen offset:0 sc1
    v_mfma_f32_16x16x16_bf16 v[40:43], v[140:141], v[184:185], v[40:43]
    v_mfma_f32_16x16x16_bf16 v[44:47], v[142:143], v[184:185], v[44:47]
    v_cvt_pk_bf16_f32 v212, v24, v25
    v_cvt_pk_bf16_f32 v213, v26, v27
    v_cvt_pk_bf16_f32 v214, v28, v29
    v_cvt_pk_bf16_f32 v215, v30, v31
    buffer_store_dwordx4 v[212:215], v8, s[8:11], s50 offen offset:1024 sc1
    v_mfma_f32_16x16x16_bf16 v[48:51], v[128:129], v[190:191], v[48:51]
    v_mfma_f32_16x16x16_bf16 v[52:55], v[130:131], v[190:191], v[52:55]
    v_cvt_pk_bf16_f32 v216, v32, v33
    v_cvt_pk_bf16_f32 v217, v34, v35
    v_cvt_pk_bf16_f32 v218, v36, v37
    v_cvt_pk_bf16_f32 v219, v38, v39
    buffer_store_dwordx4 v[216:219], v8, s[8:11], s50 offen offset:2048 sc1
    v_mfma_f32_16x16x16_bf16 v[56:59], v[132:133], v[190:191], v[56:59]
    v_mfma_f32_16x16x16_bf16 v[60:63], v[134:135], v[190:191], v[60:63]
    v_cvt_pk_bf16_f32 v220, v40, v41
    v_cvt_pk_bf16_f32 v221, v42, v43
    v_cvt_pk_bf16_f32 v222, v44, v45
    v_cvt_pk_bf16_f32 v223, v46, v47
    buffer_store_dwordx4 v[220:223], v8, s[8:11], s50 offen offset:3072 sc1
    v_mfma_f32_16x16x16_bf16 v[64:67], v[136:137], v[190:191], v[64:67]
    v_mfma_f32_16x16x16_bf16 v[68:71], v[138:139], v[190:191], v[68:71]
    v_cvt_pk_bf16_f32 v224, v48, v49
    v_cvt_pk_bf16_f32 v225, v50, v51
    v_cvt_pk_bf16_f32 v226, v52, v53
    v_cvt_pk_bf16_f32 v227, v54, v55
    buffer_store_dwordx4 v[224:227], v8, s[8:11], s51 offen offset:0 sc1
    v_mfma_f32_16x16x16_bf16 v[72:75], v[140:141], v[190:191], v[72:75]
    v_mfma_f32_16x16x16_bf16 v[76:79], v[142:143], v[190:191], v[76:79]
    v_cvt_pk_bf16_f32 v228, v56, v57
    v_cvt_pk_bf16_f32 v229, v58, v59
    v_cvt_pk_bf16_f32 v230, v60, v61
    v_cvt_pk_bf16_f32 v231, v62, v63
    buffer_store_dwordx4 v[228:231], v8, s[8:11], s51 offen offset:1024 sc1
    s_nop 3
    v_cvt_pk_bf16_f32 v232, v64, v65
    v_cvt_pk_bf16_f32 v233, v66, v67
    v_cvt_pk_bf16_f32 v234, v68, v69
    v_cvt_pk_bf16_f32 v235, v70, v71
    buffer_store_dwordx4 v[232:235], v8, s[8:11], s51 offen offset:2048 sc1
    v_cvt_pk_bf16_f32 v236, v72, v73
    v_cvt_pk_bf16_f32 v237, v74, v75
    v_cvt_pk_bf16_f32 v238, v76, v77
    v_cvt_pk_bf16_f32 v239, v78, v79
    buffer_store_dwordx4 v[236:239], v8, s[8:11], s51 offen offset:3072 sc1
    s_mov_b32 s34, s33
    s_add_u32 s50, s27, 50331648
    s_add_u32 s51, s27, 50335744
    s_cmp_lt_u32 s25, 60
    s_cselect_b32 s4, 4, 0
    s_cselect_b32 s5, 1048576, 0
    s_cselect_b32 s6, 786432, 0
    s_add_u32 s36, s36, s4
    s_add_u32 s27, s27, s5
    s_add_u32 s33, s33, s6
    s_waitcnt vmcnt(8)

    v_cmp_gt_u32 vcc, s36, v15
    s_cbranch_vccnz .atw_436
.atb_437:
    s_add_u32 s28, s27, 4096
    s_add_u32 s29, s27, 16777216
    s_add_u32 s30, s27, 16781312
    s_add_u32 s31, s27, 33554432
    s_add_u32 s32, s27, 33558528

    buffer_load_dwordx4 a[0:3], v8, s[8:11], s27 offen offset:0
    buffer_load_dwordx4 a[16:19], v8, s[8:11], s28 offen offset:0
    buffer_load_dwordx4 a[32:35], v8, s[8:11], s29 offen offset:0
    buffer_load_dwordx4 a[48:51], v8, s[8:11], s30 offen offset:0
    buffer_load_dwordx4 a[4:7], v8, s[8:11], s27 offen offset:1024
    buffer_load_dwordx4 a[20:23], v8, s[8:11], s28 offen offset:1024
    buffer_load_dwordx4 a[36:39], v8, s[8:11], s29 offen offset:1024
    buffer_load_dwordx4 a[52:55], v8, s[8:11], s30 offen offset:1024
    buffer_load_dwordx4 a[8:11], v8, s[8:11], s27 offen offset:2048
    buffer_load_dwordx4 a[24:27], v8, s[8:11], s28 offen offset:2048
    buffer_load_dwordx4 a[40:43], v8, s[8:11], s29 offen offset:2048
    buffer_load_dwordx4 a[56:59], v8, s[8:11], s30 offen offset:2048
    buffer_load_dwordx4 a[12:15], v8, s[8:11], s27 offen offset:3072
    buffer_load_dwordx4 a[28:31], v8, s[8:11], s28 offen offset:3072
    buffer_load_dwordx4 a[44:47], v8, s[8:11], s29 offen offset:3072
    buffer_load_dwordx4 a[60:63], v8, s[8:11], s30 offen offset:3072
    buffer_load_dwordx4 a[64:67], v8, s[8:11], s31 offen offset:0
    buffer_load_dwordx4 a[68:71], v8, s[8:11], s31 offen offset:1024
    buffer_load_dwordx4 a[72:75], v8, s[8:11], s31 offen offset:2048
    buffer_load_dwordx4 a[76:79], v8, s[8:11], s31 offen offset:3072
    buffer_load_dwordx4 a[80:83], v8, s[8:11], s32 offen offset:0
    buffer_load_dwordx4 a[84:87], v8, s[8:11], s32 offen offset:1024
    buffer_load_dwordx4 a[88:91], v8, s[8:11], s32 offen offset:2048
    buffer_load_dwordx4 a[92:95], v8, s[8:11], s32 offen offset:3072
    buffer_load_dwordx4 v[80:83], v10, s[8:11], s33 offen offset:2048 sc1
    buffer_load_dwordx4 v[84:87], v10, s[8:11], s33 offen offset:2176 sc1
    buffer_load_dwordx4 v[88:91], v10, s[8:11], s33 offen offset:3072 sc1
    buffer_load_dwordx4 v[92:95], v10, s[8:11], s33 offen offset:3200 sc1
    s_add_u32 s4, s33, 4096
    s_mov_b64 exec, s[60:61]
    buffer_load_dwordx2 v[128:129], v11, s[8:11], s4 offen offset:0 sc1
    buffer_load_dwordx2 v[130:131], v11, s[8:11], s4 offen offset:256 sc1
    buffer_load_dwordx2 v[132:133], v11, s[8:11], s4 offen offset:512 sc1
    buffer_load_dwordx2 v[134:135], v11, s[8:11], s4 offen offset:768 sc1
    buffer_load_dwordx2 v[136:137], v11, s[8:11], s4 offen offset:1024 sc1
    buffer_load_dwordx2 v[138:139], v11, s[8:11], s4 offen offset:1280 sc1
    buffer_load_dwordx2 v[140:141], v11, s[8:11], s4 offen offset:1536 sc1
    buffer_load_dwordx2 v[142:143], v11, s[8:11], s4 offen offset:1792 sc1
    s_mov_b64 exec, -1
    v_mfma_f32_16x16x32_bf16 v[144:147], a[128:131], a[96:99], 0
    v_mfma_f32_16x16x32_bf16 v[156:159], a[128:131], a[112:115], 0
    v_mfma_f32_16x16x32_bf16 v[160:163], a[144:147], a[112:115], 0
    v_mfma_f32_16x16x32_bf16 v[144:147], a[132:135], a[100:103], v[144:147]
    v_mfma_f32_16x16x32_bf16 v[156:159], a[132:135], a[116:119], v[156:159]
    v_mfma_f32_16x16x32_bf16 v[160:163], a[148:151], a[116:119], v[160:163]
    v_mfma_f32_16x16x32_bf16 v[144:147], a[136:139], a[104:107], v[144:147]
    v_mfma_f32_16x16x32_bf16 v[156:159], a[136:139], a[120:123], v[156:159]
    v_mfma_f32_16x16x32_bf16 v[160:163], a[152:155], a[120:123], v[160:163]
    v_mfma_f32_16x16x32_bf16 v[144:147], a[140:143], a[108:111], v[144:147]
    v_mfma_f32_16x16x32_bf16 v[156:159], a[140:143], a[124:127], v[156:159]
    v_mfma_f32_16x16x32_bf16 v[160:163], a[156:159], a[124:127], v[160:163]
    s_nop 7
    v_cvt_pk_bf16_f32 v168, v144, v145
    v_cvt_pk_bf16_f32 v170, v146, v147
    v_and_b32 v169, 0xffff0000, v168
    v_lshlrev_b32 v168, 16, v168
    v_and_b32 v171, 0xffff0000, v170
    v_lshlrev_b32 v170, 16, v170
    v_mul_f32 v168, s37, v168
    v_mul_f32 v169, s37, v169
    v_mul_f32 v170, s37, v170
    v_mul_f32 v171, s37, v171
    v_cvt_pk_bf16_f32 v144, v168, v169
    v_cvt_pk_bf16_f32 v146, v170, v171
    v_and_b32 v145, 0xffff0000, v144
    v_lshlrev_b32 v144, 16, v144
    v_and_b32 v147, 0xffff0000, v146
    v_lshlrev_b32 v146, 16, v146
    v_cvt_pk_bf16_f32 v192, v156, v157
    v_cvt_pk_bf16_f32 v194, v158, v159
    v_cvt_pk_bf16_f32 v196, v160, v161
    v_cvt_pk_bf16_f32 v198, v162, v163
    v_and_b32 v193, 0xffff0000, v192
    v_lshlrev_b32 v192, 16, v192
    v_and_b32 v195, 0xffff0000, v194
    v_lshlrev_b32 v194, 16, v194
    v_and_b32 v197, 0xffff0000, v196
    v_lshlrev_b32 v196, 16, v196
    v_and_b32 v199, 0xffff0000, v198
    v_lshlrev_b32 v198, 16, v198
    v_mul_f32 v192, s37, v192
    v_mul_f32 v193, s37, v193
    v_mul_f32 v194, s37, v194
    v_mul_f32 v195, s37, v195
    v_mul_f32 v196, s37, v196
    v_mul_f32 v197, s37, v197
    v_mul_f32 v198, s37, v198
    v_mul_f32 v199, s37, v199
    v_cvt_pk_bf16_f32 v156, v192, v193
    v_cvt_pk_bf16_f32 v158, v194, v195
    v_cvt_pk_bf16_f32 v160, v196, v197
    v_cvt_pk_bf16_f32 v162, v198, v199
    v_and_b32 v157, 0xffff0000, v156
    v_lshlrev_b32 v156, 16, v156
    v_and_b32 v159, 0xffff0000, v158
    v_lshlrev_b32 v158, 16, v158
    v_and_b32 v161, 0xffff0000, v160
    v_lshlrev_b32 v160, 16, v160
    v_and_b32 v163, 0xffff0000, v162
    v_lshlrev_b32 v162, 16, v162
    v_cndmask_b32 v144, v14, v144, s[40:41]
    v_cndmask_b32 v145, v14, v145, s[42:43]
    v_cndmask_b32 v146, v14, v146, s[44:45]
    v_cndmask_b32 v147, v14, v147, s[46:47]
    v_cndmask_b32 v160, v14, v160, s[40:41]
    v_cndmask_b32 v161, v14, v161, s[42:43]
    v_cndmask_b32 v162, v14, v162, s[44:45]
    v_cndmask_b32 v163, v14, v163, s[46:47]
    s_mov_b32 s62, 0
.kmp_438:
    v_max3_u32 v4, v96, v97, v98
    v_max3_u32 v5, v99, v100, v101
    v_max3_u32 v4, v4, v102, v103
    v_max3_u32 v5, v5, v104, v105
    v_max3_u32 v4, v4, v106, v107
    v_max3_u32 v5, v5, v108, v109
    v_max3_u32 v4, v4, v110, v111
    v_max3_u32 v5, v5, v112, v113
    v_max3_u32 v4, v4, v114, v115
    v_max3_u32 v5, v5, v116, v117
    v_max3_u32 v4, v4, v118, v119
    v_max3_u32 v5, v5, v120, v121
    v_max3_u32 v4, v4, v122, v123
    v_max3_u32 v5, v5, v124, v125
    v_max3_u32 v4, v4, v126, v127
    v_max_u32 v4, v4, v5
    v_cmp_eq_u32 vcc, -1, v4
    s_cbranch_vccnz .kmf_439

    v_mfma_f32_16x16x32_bf16 v[152:155], v[96:99], a[96:99], 0
    v_mfma_f32_16x16x32_bf16 v[164:167], v[96:99], a[112:115], 0
    v_mfma_f32_16x16x32_bf16 v[152:155], v[100:103], a[100:103], v[152:155]
    v_mfma_f32_16x16x32_bf16 v[164:167], v[100:103], a[116:119], v[164:167]
    v_mfma_f32_16x16x32_bf16 v[152:155], v[104:107], a[104:107], v[152:155]
    v_mfma_f32_16x16x32_bf16 v[164:167], v[104:107], a[120:123], v[164:167]
    v_mfma_f32_16x16x32_bf16 v[152:155], v[108:111], a[108:111], v[152:155]
    v_mfma_f32_16x16x32_bf16 v[164:167], v[108:111], a[124:127], v[164:167]
    s_nop 5
    v_cvt_pk_bf16_f32 v176, v152, v153
    v_cvt_pk_bf16_f32 v178, v154, v155
    v_and_b32 v177, 0xffff0000, v176
    v_lshlrev_b32 v176, 16, v176
    v_and_b32 v179, 0xffff0000, v178
    v_lshlrev_b32 v178, 16, v178
    v_mul_f32 v176, s37, v176
    v_mul_f32 v177, s37, v177
    v_mul_f32 v178, s37, v178
    v_mul_f32 v179, s37, v179
    v_cvt_pk_bf16_f32 v152, v176, v177
    v_cvt_pk_bf16_f32 v154, v178, v179
    v_and_b32 v153, 0xffff0000, v152
    v_lshlrev_b32 v152, 16, v152
    v_and_b32 v155, 0xffff0000, v154
    v_lshlrev_b32 v154, 16, v154
    v_cndmask_b32 v152, v14, v152, s[60:61]
    v_cndmask_b32 v153, v14, v153, s[60:61]
    v_cndmask_b32 v154, v14, v154, s[60:61]
    v_cndmask_b32 v155, v14, v155, s[60:61]
    v_cvt_pk_bf16_f32 v200, v164, v165
    v_cvt_pk_bf16_f32 v202, v166, v167
    v_and_b32 v201, 0xffff0000, v200
    v_lshlrev_b32 v200, 16, v200
    v_and_b32 v203, 0xffff0000, v202
    v_lshlrev_b32 v202, 16, v202
    v_mul_f32 v200, s37, v200
    v_mul_f32 v201, s37, v201
    v_mul_f32 v202, s37, v202
    v_mul_f32 v203, s37, v203
    v_cvt_pk_bf16_f32 v164, v200, v201
    v_cvt_pk_bf16_f32 v166, v202, v203
    v_and_b32 v165, 0xffff0000, v164
    v_lshlrev_b32 v164, 16, v164
    v_and_b32 v167, 0xffff0000, v166
    v_lshlrev_b32 v166, 16, v166
    v_cndmask_b32 v164, v14, v164, s[60:61]
    v_cndmask_b32 v165, v14, v165, s[60:61]
    v_cndmask_b32 v166, v14, v166, s[60:61]
    v_cndmask_b32 v167, v14, v167, s[60:61]
    v_max3_f32 v4, v144, v145, v146
    v_max3_f32 v5, v147, v152, v153
    v_max3_f32 v4, v4, v154, v155
    v_max_f32 v4, v4, v5

    v_max3_f32 v6, v156, v157, v158
    v_max3_f32 v7, v159, v160, v161
    v_max3_f32 v6, v6, v162, v163
    v_max3_f32 v7, v7, v164, v165
    v_max3_f32 v6, v6, v166, v167
    v_max_f32 v6, v6, v7

    v_mov_b32 v5, v4
    v_mov_b32 v7, v6
    s_nop 0
    v_permlane32_swap_b32 v4, v5
    v_permlane32_swap_b32 v6, v7
    v_max_f32 v4, v4, v5
    v_max_f32 v6, v6, v7

    v_mov_b32 v5, v4
    v_mov_b32 v7, v6
    s_nop 0
    v_permlane16_swap_b32 v4, v5
    v_permlane16_swap_b32 v6, v7
    v_max_f32 v4, v4, v5
    v_max_f32 v6, v6, v7

    v_mul_f32 v4, s38, v4
    v_mul_f32 v6, s38, v6
    v_fma_f32 v168, v144, s38, -v4
    v_fma_f32 v169, v145, s38, -v4
    v_fma_f32 v170, v146, s38, -v4
    v_fma_f32 v171, v147, s38, -v4
    v_fma_f32 v176, v152, s38, -v4
    v_fma_f32 v177, v153, s38, -v4
    v_fma_f32 v178, v154, s38, -v4
    v_fma_f32 v179, v155, s38, -v4
    v_fma_f32 v192, v156, s38, -v6
    v_fma_f32 v193, v157, s38, -v6
    v_fma_f32 v194, v158, s38, -v6
    v_fma_f32 v195, v159, s38, -v6
    v_fma_f32 v196, v160, s38, -v6
    v_fma_f32 v197, v161, s38, -v6
    v_fma_f32 v198, v162, s38, -v6
    v_fma_f32 v199, v163, s38, -v6
    v_fma_f32 v200, v164, s38, -v6
    v_fma_f32 v201, v165, s38, -v6
    v_fma_f32 v202, v166, s38, -v6
    v_fma_f32 v203, v167, s38, -v6
    v_exp_f32 v168, v168
    v_exp_f32 v169, v169
    v_exp_f32 v170, v170
    v_exp_f32 v171, v171
    v_exp_f32 v176, v176
    v_exp_f32 v177, v177
    v_exp_f32 v178, v178
    v_exp_f32 v179, v179
    v_exp_f32 v192, v192
    v_exp_f32 v193, v193
    v_exp_f32 v194, v194
    v_exp_f32 v195, v195
    v_exp_f32 v196, v196
    v_exp_f32 v197, v197
    v_exp_f32 v198, v198
    v_exp_f32 v199, v199
    v_exp_f32 v200, v200
    v_exp_f32 v201, v201
    v_exp_f32 v202, v202
    v_exp_f32 v203, v203
    v_add_f32 v4, v168, v169
    v_add_f32 v5, v170, v171
    v_add_f32 v4, v4, v176
    v_add_f32 v5, v5, v177
    v_add_f32 v4, v4, v178
    v_add_f32 v5, v5, v179
    v_add_f32 v4, v4, v5
    v_add_f32 v6, v192, v193
    v_add_f32 v7, v194, v195
    v_add_f32 v6, v6, v196
    v_add_f32 v7, v7, v197
    v_add_f32 v6, v6, v198
    v_add_f32 v7, v7, v199
    v_add_f32 v6, v6, v200
    v_add_f32 v7, v7, v201
    v_add_f32 v6, v6, v202
    v_add_f32 v7, v7, v203
    v_add_f32 v6, v6, v7
    v_mov_b32 v5, v4
    v_mov_b32 v7, v6
    s_nop 0
    v_permlane32_swap_b32 v4, v5
    v_permlane32_swap_b32 v6, v7
    v_add_f32 v4, v4, v5
    v_add_f32 v6, v6, v7

    v_mov_b32 v5, v4
    v_mov_b32 v7, v6
    s_nop 0
    v_permlane16_swap_b32 v4, v5
    v_permlane16_swap_b32 v6, v7
    v_add_f32 v4, v4, v5
    v_add_f32 v6, v6, v7

    v_rcp_f32 v4, v4
    v_rcp_f32 v6, v6
    v_mov_b32 v182, 0
    v_mov_b32 v183, 0
    v_mul_f32 v168, v4, v168
    v_mul_f32 v169, v4, v169
    v_mul_f32 v170, v4, v170
    v_mul_f32 v171, v4, v171
    v_mul_f32 v176, v4, v176
    v_mul_f32 v177, v4, v177
    v_mul_f32 v178, v4, v178
    v_mul_f32 v179, v4, v179
    v_cvt_pk_bf16_f32 v180, v168, v169
    v_cvt_pk_bf16_f32 v181, v170, v171
    v_cvt_pk_bf16_f32 v184, v176, v177
    v_cvt_pk_bf16_f32 v185, v178, v179
    v_mul_f32 v192, v6, v192
    v_mul_f32 v193, v6, v193
    v_mul_f32 v194, v6, v194
    v_mul_f32 v195, v6, v195
    v_mul_f32 v196, v6, v196
    v_mul_f32 v197, v6, v197
    v_mul_f32 v198, v6, v198
    v_mul_f32 v199, v6, v199
    v_mul_f32 v200, v6, v200
    v_mul_f32 v201, v6, v201
    v_mul_f32 v202, v6, v202
    v_mul_f32 v203, v6, v203
    v_cvt_pk_bf16_f32 v186, v192, v193
    v_cvt_pk_bf16_f32 v187, v194, v195
    v_cvt_pk_bf16_f32 v188, v196, v197
    v_cvt_pk_bf16_f32 v189, v198, v199
    v_cvt_pk_bf16_f32 v190, v200, v201
    v_cvt_pk_bf16_f32 v191, v202, v203
    s_add_u32 s25, s25, 4

    v_mfma_f32_16x16x32_bf16 v[16:19], a[160:163], v[180:183], 0
    v_mfma_f32_16x16x32_bf16 v[20:23], a[164:167], v[180:183], 0
    v_mfma_f32_16x16x32_bf16 v[24:27], a[168:171], v[180:183], 0
    v_mfma_f32_16x16x32_bf16 v[28:31], a[172:175], v[180:183], 0
    v_mfma_f32_16x16x32_bf16 v[32:35], a[176:179], v[180:183], 0
    v_mfma_f32_16x16x32_bf16 v[36:39], a[180:183], v[180:183], 0
    v_mfma_f32_16x16x32_bf16 v[40:43], a[184:187], v[180:183], 0
    v_mfma_f32_16x16x32_bf16 v[44:47], a[188:191], v[180:183], 0
    v_mfma_f32_16x16x32_bf16 v[48:51], a[160:163], v[186:189], 0
    v_mfma_f32_16x16x32_bf16 v[52:55], a[164:167], v[186:189], 0
    v_mfma_f32_16x16x32_bf16 v[56:59], a[168:171], v[186:189], 0
    v_mfma_f32_16x16x32_bf16 v[60:63], a[172:175], v[186:189], 0
    v_mfma_f32_16x16x32_bf16 v[64:67], a[176:179], v[186:189], 0
    v_mfma_f32_16x16x32_bf16 v[68:71], a[180:183], v[186:189], 0
    v_mfma_f32_16x16x32_bf16 v[72:75], a[184:187], v[186:189], 0
    v_mfma_f32_16x16x32_bf16 v[76:79], a[188:191], v[186:189], 0
    s_waitcnt vmcnt(36)
    s_mov_b64 exec, 1
    buffer_store_dword v12, v13, s[8:11], s92 offen sc1
    s_mov_b64 exec, -1

    v_mfma_f32_16x16x16_bf16 v[16:19], v[112:113], v[184:185], v[16:19]
    v_mfma_f32_16x16x16_bf16 v[20:23], v[114:115], v[184:185], v[20:23]
    v_add_u32 v12, 1, v12
    v_mfma_f32_16x16x16_bf16 v[24:27], v[116:117], v[184:185], v[24:27]
    v_mfma_f32_16x16x16_bf16 v[28:31], v[118:119], v[184:185], v[28:31]
    v_mfma_f32_16x16x16_bf16 v[32:35], v[120:121], v[184:185], v[32:35]
    v_mfma_f32_16x16x16_bf16 v[36:39], v[122:123], v[184:185], v[36:39]
    v_cvt_pk_bf16_f32 v208, v16, v17
    v_cvt_pk_bf16_f32 v209, v18, v19
    v_cvt_pk_bf16_f32 v210, v20, v21
    v_cvt_pk_bf16_f32 v211, v22, v23
    buffer_store_dwordx4 v[208:211], v8, s[8:11], s50 offen offset:0 sc1
    v_mfma_f32_16x16x16_bf16 v[40:43], v[124:125], v[184:185], v[40:43]
    v_mfma_f32_16x16x16_bf16 v[44:47], v[126:127], v[184:185], v[44:47]
    v_cvt_pk_bf16_f32 v212, v24, v25
    v_cvt_pk_bf16_f32 v213, v26, v27
    v_cvt_pk_bf16_f32 v214, v28, v29
    v_cvt_pk_bf16_f32 v215, v30, v31
    buffer_store_dwordx4 v[212:215], v8, s[8:11], s50 offen offset:1024 sc1
    v_mfma_f32_16x16x16_bf16 v[48:51], v[112:113], v[190:191], v[48:51]
    v_mfma_f32_16x16x16_bf16 v[52:55], v[114:115], v[190:191], v[52:55]
    v_cvt_pk_bf16_f32 v216, v32, v33
    v_cvt_pk_bf16_f32 v217, v34, v35
    v_cvt_pk_bf16_f32 v218, v36, v37
    v_cvt_pk_bf16_f32 v219, v38, v39
    buffer_store_dwordx4 v[216:219], v8, s[8:11], s50 offen offset:2048 sc1
    v_mfma_f32_16x16x16_bf16 v[56:59], v[116:117], v[190:191], v[56:59]
    v_mfma_f32_16x16x16_bf16 v[60:63], v[118:119], v[190:191], v[60:63]
    v_cvt_pk_bf16_f32 v220, v40, v41
    v_cvt_pk_bf16_f32 v221, v42, v43
    v_cvt_pk_bf16_f32 v222, v44, v45
    v_cvt_pk_bf16_f32 v223, v46, v47
    buffer_store_dwordx4 v[220:223], v8, s[8:11], s50 offen offset:3072 sc1
    v_mfma_f32_16x16x16_bf16 v[64:67], v[120:121], v[190:191], v[64:67]
    v_mfma_f32_16x16x16_bf16 v[68:71], v[122:123], v[190:191], v[68:71]
    v_cvt_pk_bf16_f32 v224, v48, v49
    v_cvt_pk_bf16_f32 v225, v50, v51
    v_cvt_pk_bf16_f32 v226, v52, v53
    v_cvt_pk_bf16_f32 v227, v54, v55
    buffer_store_dwordx4 v[224:227], v8, s[8:11], s51 offen offset:0 sc1
    v_mfma_f32_16x16x16_bf16 v[72:75], v[124:125], v[190:191], v[72:75]
    v_mfma_f32_16x16x16_bf16 v[76:79], v[126:127], v[190:191], v[76:79]
    v_cvt_pk_bf16_f32 v228, v56, v57
    v_cvt_pk_bf16_f32 v229, v58, v59
    v_cvt_pk_bf16_f32 v230, v60, v61
    v_cvt_pk_bf16_f32 v231, v62, v63
    buffer_store_dwordx4 v[228:231], v8, s[8:11], s51 offen offset:1024 sc1
    s_nop 3
    v_cvt_pk_bf16_f32 v232, v64, v65
    v_cvt_pk_bf16_f32 v233, v66, v67
    v_cvt_pk_bf16_f32 v234, v68, v69
    v_cvt_pk_bf16_f32 v235, v70, v71
    buffer_store_dwordx4 v[232:235], v8, s[8:11], s51 offen offset:2048 sc1
    v_cvt_pk_bf16_f32 v236, v72, v73
    v_cvt_pk_bf16_f32 v237, v74, v75
    v_cvt_pk_bf16_f32 v238, v76, v77
    v_cvt_pk_bf16_f32 v239, v78, v79
    buffer_store_dwordx4 v[236:239], v8, s[8:11], s51 offen offset:3072 sc1
    s_cmp_lt_u32 s25, 64
    s_cbranch_scc1 .att_431
    s_waitcnt vmcnt(0)

    s_mov_b64 exec, 1
    buffer_store_dword v12, v13, s[8:11], s92 offen sc1
    s_mov_b64 exec, -1

    s_branch .ate_440
.atw_432:
    s_mov_b32 s62, 0
    s_mov_b64 exec, 7
.wf_441:
    buffer_load_dword v15, v9, s[8:11], s35 offen sc1
    s_waitcnt vmcnt(0)
    v_cmp_gt_u32 vcc, s36, v15
    s_cbranch_vccz .wfd_442
    s_sleep 2
    s_add_u32 s62, s62, 1
    s_cmp_gt_u32 s62, 0x400000
    s_cbranch_scc1 .mg_end_1
    s_branch .wf_441

.wfd_442:
    s_mov_b64 exec, -1
    s_branch .atb_433
.kmf_435:
    s_cmp_lg_u32 s62, 0
    s_cbranch_scc1 .kmn_443
    s_waitcnt vmcnt(36)
    s_mov_b64 exec, 1
    buffer_store_dword v12, v13, s[8:11], s92 offen sc1
    s_mov_b64 exec, -1

    s_cmp_lt_u32 s25, 60
    s_cselect_b32 s5, 0, 196608
    s_sub_u32 s5, s34, s5
    s_mov_b64 exec, 15

.kml_444:
    s_sleep 4
    buffer_load_dword v4, v204, s[8:11], s5 offen sc1
    s_add_u32 s62, s62, 1
    s_cmp_gt_u32 s62, 0x200000
    s_cbranch_scc1 .mg_end_1
    s_waitcnt vmcnt(0)
    v_cmp_eq_u32 vcc, -1, v4
    s_cbranch_vccnz .kml_444
    s_mov_b64 exec, -1

.kmn_443:
    s_sleep 1
    buffer_load_dwordx4 v[80:83], v10, s[8:11], s34 offen offset:2048 sc1
    buffer_load_dwordx4 v[84:87], v10, s[8:11], s34 offen offset:2176 sc1
    buffer_load_dwordx4 v[88:91], v10, s[8:11], s34 offen offset:3072 sc1
    buffer_load_dwordx4 v[92:95], v10, s[8:11], s34 offen offset:3200 sc1
    s_add_u32 s4, s34, 4096
    s_mov_b64 exec, s[60:61]
    buffer_load_dwordx2 v[128:129], v11, s[8:11], s4 offen offset:0 sc1
    buffer_load_dwordx2 v[130:131], v11, s[8:11], s4 offen offset:256 sc1
    buffer_load_dwordx2 v[132:133], v11, s[8:11], s4 offen offset:512 sc1
    buffer_load_dwordx2 v[134:135], v11, s[8:11], s4 offen offset:768 sc1
    buffer_load_dwordx2 v[136:137], v11, s[8:11], s4 offen offset:1024 sc1
    buffer_load_dwordx2 v[138:139], v11, s[8:11], s4 offen offset:1280 sc1
    buffer_load_dwordx2 v[140:141], v11, s[8:11], s4 offen offset:1536 sc1
    buffer_load_dwordx2 v[142:143], v11, s[8:11], s4 offen offset:1792 sc1
    s_mov_b64 exec, -1
    s_add_u32 s62, s62, 1
    s_cmp_gt_u32 s62, 0x200000
    s_cbranch_scc1 .mg_end_1
    s_waitcnt vmcnt(0)
    s_branch .kmp_434

.atw_436:
    s_mov_b32 s62, 0
    s_mov_b64 exec, 7
.wf_445:
    buffer_load_dword v15, v9, s[8:11], s35 offen sc1
    s_waitcnt vmcnt(0)
    v_cmp_gt_u32 vcc, s36, v15
    s_cbranch_vccz .wfd_446
    s_sleep 2
    s_add_u32 s62, s62, 1
    s_cmp_gt_u32 s62, 0x400000
    s_cbranch_scc1 .mg_end_1
    s_branch .wf_445

.wfd_446:
    s_mov_b64 exec, -1
    s_branch .atb_437
.kmf_439:
    s_cmp_lg_u32 s62, 0
    s_cbranch_scc1 .kmn_447
    s_waitcnt vmcnt(36)
    s_mov_b64 exec, 1
    buffer_store_dword v12, v13, s[8:11], s92 offen sc1
    s_mov_b64 exec, -1

    s_cmp_lt_u32 s25, 60
    s_cselect_b32 s5, 0, 196608
    s_sub_u32 s5, s34, s5
    s_mov_b64 exec, 15

.kml_448:
    s_sleep 4
    buffer_load_dword v4, v204, s[8:11], s5 offen sc1
    s_add_u32 s62, s62, 1
    s_cmp_gt_u32 s62, 0x200000
    s_cbranch_scc1 .mg_end_1
    s_waitcnt vmcnt(0)
    v_cmp_eq_u32 vcc, -1, v4
    s_cbranch_vccnz .kml_448
    s_mov_b64 exec, -1

.kmn_447:
    s_sleep 1
    buffer_load_dwordx4 v[96:99], v10, s[8:11], s34 offen offset:2048 sc1
    buffer_load_dwordx4 v[100:103], v10, s[8:11], s34 offen offset:2176 sc1
    buffer_load_dwordx4 v[104:107], v10, s[8:11], s34 offen offset:3072 sc1
    buffer_load_dwordx4 v[108:111], v10, s[8:11], s34 offen offset:3200 sc1
    s_add_u32 s4, s34, 4096
    s_mov_b64 exec, s[60:61]
    buffer_load_dwordx2 v[112:113], v11, s[8:11], s4 offen offset:0 sc1
    buffer_load_dwordx2 v[114:115], v11, s[8:11], s4 offen offset:256 sc1
    buffer_load_dwordx2 v[116:117], v11, s[8:11], s4 offen offset:512 sc1
    buffer_load_dwordx2 v[118:119], v11, s[8:11], s4 offen offset:768 sc1
    buffer_load_dwordx2 v[120:121], v11, s[8:11], s4 offen offset:1024 sc1
    buffer_load_dwordx2 v[122:123], v11, s[8:11], s4 offen offset:1280 sc1
    buffer_load_dwordx2 v[124:125], v11, s[8:11], s4 offen offset:1536 sc1
    buffer_load_dwordx2 v[126:127], v11, s[8:11], s4 offen offset:1792 sc1
    s_mov_b64 exec, -1
    s_add_u32 s62, s62, 1
    s_cmp_gt_u32 s62, 0x200000
    s_cbranch_scc1 .mg_end_1
    s_waitcnt vmcnt(0)
    s_branch .kmp_438

.ate_440:
.mg_end_1:
    s_endpgm
.section .rodata,"a"
.p2align 6
.amdhsa_kernel mega_kernel
  .amdhsa_next_free_vgpr 512
  .amdhsa_next_free_sgpr 102
  .amdhsa_accum_offset 256
  .amdhsa_group_segment_fixed_size 0
  .amdhsa_kernarg_size 136
  .amdhsa_user_sgpr_count 2
  .amdhsa_user_sgpr_kernarg_segment_ptr 1
  .amdhsa_system_sgpr_workgroup_id_x 1
.end_amdhsa_kernel
```

```asm
; @launch kernel=mega_kernel grid=(256,1,1) block=(256,1,1) lds=163840
.amdgcn_target "amdgcn-amd-amdhsa--gfx950"
.text
.globl mega_kernel
.p2align 8
.type mega_kernel,@function
mega_kernel:
    s_cmp_ge_u32 s2, 256
    s_cbranch_scc1 .mg_end_1
    s_load_dwordx4 s[52:55], s[0:1], 120
    s_load_dwordx2 s[40:41], s[0:1], 56
    s_getreg_b32 s3, hwreg(HW_REG_XCC_ID)
    v_and_b32 v1, 63, v0
    v_lshrrev_b32 v4, 6, v0
    s_and_b32 s3, s3, 7
    v_readfirstlane_b32 s24, v4
    s_waitcnt lgkmcnt(0)

    s_mov_b32 s8, s54
    s_and_b32 s9, s55, 0xffff
    s_mov_b32 s10, 0x10000000
    s_mov_b32 s11, 0x00020000

    s_mov_b32 s20, s52
    s_and_b32 s21, s53, 0xffff
    s_mov_b32 s22, 0x100
    s_mov_b32 s23, 0x00020000

    s_mov_b32 s100, s54
    s_cmp_lg_u32 s24, 0
    s_cbranch_scc1 .noat_4
    s_mov_b64 exec, 1
    v_mov_b32 v5, 1
    s_lshl_b32 s4, s3, 2
    v_mov_b32 v6, s4
    buffer_atomic_add v5, v6, s[20:23], 0 offen sc0 sc1
    v_mov_b32 v7, 163776
    s_waitcnt vmcnt(0)
    ds_write_b32 v7, v5
    v_cmp_lt_u32 vcc, 31, v5
    s_cbranch_vccz .nb_5
    v_mov_b32 v6, 136
    buffer_store_dword v7, v6, s[20:23], 0 offen sc1

.nb_5:
    s_waitcnt lgkmcnt(0)
    s_mov_b64 exec, -1

.noat_4:
    s_barrier
    v_mov_b32 v7, 163776
    ds_read_b32 v5, v7
    s_waitcnt lgkmcnt(0)
    v_readfirstlane_b32 s26, v5
    s_mov_b32 s25, s3
    s_mov_b32 s27, 0
    s_mov_b32 s97, 128
    s_cmp_lt_u32 s26, 32
    s_cselect_b32 s99, 1, 0
    s_and_b32 s26, s26, 31

.mg_role_3:
    s_cmp_ge_u32 s25, 4
    s_cbranch_scc1 .mg_bg_2

    s_load_dwordx8 s[44:51], s[0:1], 64
    s_load_dwordx2 s[40:41], s[0:1], 56
    v_and_b32 v1, 63, v0
    v_and_b32 v2, 15, v1
    v_lshrrev_b32 v3, 4, v1

    s_lshr_b32 s79, s26, 2
    s_and_b32 s78, s24, 1
    s_lshl_b32 s34, s25, 18
    s_add_u32 s34, s34, 83886080
    v_lshlrev_b32 v14, 4, v1
    v_lshrrev_b32 v6, 1, v3
    s_sub_u32 s101, 0, s100
    s_and_b32 s101, s101, 0x1fffff
    s_add_u32 s101, s101, 100663296

    v_mov_b32 v188, -1
    v_mov_b32 v189, -1
    v_mov_b32 v190, -1
    v_mov_b32 v191, -1
    s_lshl_b32 s5, s26, 10
    s_add_u32 s5, s5, 32768
    v_add_u32 v235, s5, v14
    s_lshl_b32 s4, s26, 9
    v_and_b32 v4, 31, v1
    v_lshlrev_b32 v236, 4, v4
    v_lshl_add_u32 v236, v6, 14, v236
    v_add_u32 v236, s4, v236
    s_and_b32 s5, s26, 7
    s_lshl_b32 s4, s5, 10
    s_lshr_b32 s5, s26, 3
    s_lshl_b32 s5, s5, 14
    s_add_u32 s4, s4, s5
    s_add_u32 s35, s4, s101
    s_lshl_b32 s5, s25, 16
    v_add_u32 v238, s5, v14
    s_lshl_b32 s4, s25, 3
    s_add_u32 s7, s4, s79
    s_mul_i32 s36, s7, 6144
    s_add_u32 s36, s36, 67108864

    s_cmp_eq_u32 s78, 0
    s_cselect_b64 vcc, -1, 0
    s_lshr_b32 s6, s24, 1
    s_lshl_b32 s4, s6, 16
    s_add_u32 s4, s4, s34
    v_cndmask_b32 v4, v235, v236, vcc
    s_mul_i32 s5, s6, 1048576
    s_lshl_b32 s6, s78, 13
    buffer_store_dwordx4 v[188:191], v4, s[8:11], s4 offen sc1
    s_add_u32 s5, s5, s6
    s_add_u32 s5, s5, s35

    buffer_store_dwordx4 v[188:191], v238, s[8:11], s5 offen sc1
    s_add_u32 s5, s5, 262144
    buffer_store_dwordx4 v[188:191], v238, s[8:11], s5 offen sc1
    s_add_u32 s5, s5, 262144
    s_lshl_b32 s4, s25, 11
    s_lshl_b32 s5, s26, 6
    s_add_u32 s4, s4, s5
    s_lshl_b32 s5, s24, 21
    s_add_u32 s4, s4, s5
    v_lshrrev_b32 v4, 2, v1
    v_and_b32 v5, 3, v1
    v_lshlrev_b32 v5, 4, v5
    v_lshlrev_b32 v6, 13, v4
    v_add_u32 v6, v6, v5
    v_add_u32 v240, s4, v6
    s_lshl_b32 s4, s25, 2
    s_and_b32 s5, s24, 1
    s_lshl_b32 s5, s5, 1
    s_add_u32 s4, s4, s5
    s_lshr_b32 s5, s24, 1
    s_add_u32 s4, s4, s5
    s_lshl_b32 s4, s4, 19
    s_lshl_b32 s5, s26, 6
    s_add_u32 s4, s4, s5
    v_lshlrev_b32 v6, 11, v4
    v_add_u32 v6, v6, v5
    v_add_u32 v241, s4, v6
    s_lshl_b32 s98, s24, 15
    s_waitcnt lgkmcnt(0)

    s_barrier
    s_cmp_eq_u32 s24, 1
    s_cselect_b64 s[42:43], s[46:47], s[44:45]
    s_cmp_eq_u32 s24, 2
    s_cselect_b64 s[42:43], s[48:49], s[42:43]
    s_cmp_eq_u32 s24, 3
    s_cselect_b64 s[42:43], s[50:51], s[42:43]
    s_cselect_b32 s6, 11, 13
    s_cselect_b32 s7, 21, 11

    s_mov_b32 s16, s42
    s_and_b32 s17, s43, 0xffff
    s_mov_b32 s18, 0x800000
    s_mov_b32 s19, 0x00020000

    s_lshl_b32 s7, s25, s7
    s_lshr_b32 s4, s26, 1
    s_lshl_b32 s4, s4, 6
    v_add_u32 v4, s4, v1
    v_lshlrev_b32 v4, s6, v4
    s_and_b32 s4, s26, 1
    s_lshl_b32 s4, s4, 10
    s_add_u32 s7, s7, s4
    buffer_load_dword v226, v4, s[16:19], s7 offen offset:384

    s_bitcmp1_b32 s26, 0
    s_cbranch_scc1 .po_7
    s_mov_b32 s16, s44
    s_and_b32 s17, s45, 0xffff
    s_mov_b32 s18, 0x800000
    s_mov_b32 s19, 0x00020000

    s_add_u32 m0, s98, 0
    s_mov_b32 s5, 0
    buffer_load_dwordx4 v240, s[16:19], s5 offen  lds

    s_add_u32 m0, s98, 1024
    s_mov_b32 s5, 131072
    buffer_load_dwordx4 v240, s[16:19], s5 offen  lds

    s_add_u32 m0, s98, 2048
    s_mov_b32 s5, 262144
    buffer_load_dwordx4 v240, s[16:19], s5 offen  lds

    s_add_u32 m0, s98, 3072
    s_mov_b32 s5, 393216
    buffer_load_dwordx4 v240, s[16:19], s5 offen  lds

    s_add_u32 m0, s98, 4096
    s_mov_b32 s5, 524288
    buffer_load_dwordx4 v240, s[16:19], s5 offen  lds

    s_add_u32 m0, s98, 5120
    s_mov_b32 s5, 655360
    buffer_load_dwordx4 v240, s[16:19], s5 offen  lds

    s_add_u32 m0, s98, 6144
    s_mov_b32 s5, 786432
    buffer_load_dwordx4 v240, s[16:19], s5 offen  lds

    s_add_u32 m0, s98, 7168
    s_mov_b32 s5, 917504
    buffer_load_dwordx4 v240, s[16:19], s5 offen  lds

    s_branch .pj_8
.po_7:
    s_mov_b32 s16, s44
    s_and_b32 s17, s45, 0xffff
    s_mov_b32 s18, 0x800000
    s_mov_b32 s19, 0x00020000

    s_add_u32 m0, s98, 8192
    s_mov_b32 s5, 1048576
    buffer_load_dwordx4 v240, s[16:19], s5 offen  lds

    s_add_u32 m0, s98, 9216
    s_mov_b32 s5, 1179648
    buffer_load_dwordx4 v240, s[16:19], s5 offen  lds

    s_add_u32 m0, s98, 10240
    s_mov_b32 s5, 1310720
    buffer_load_dwordx4 v240, s[16:19], s5 offen  lds

    s_add_u32 m0, s98, 11264
    s_mov_b32 s5, 1441792
    buffer_load_dwordx4 v240, s[16:19], s5 offen  lds

    s_add_u32 m0, s98, 12288
    s_mov_b32 s5, 1572864
    buffer_load_dwordx4 v240, s[16:19], s5 offen  lds

    s_add_u32 m0, s98, 13312
    s_mov_b32 s5, 1703936
    buffer_load_dwordx4 v240, s[16:19], s5 offen  lds

    s_add_u32 m0, s98, 14336
    s_mov_b32 s5, 1835008
    buffer_load_dwordx4 v240, s[16:19], s5 offen  lds

    s_add_u32 m0, s98, 15360
    s_mov_b32 s5, 1966080
    buffer_load_dwordx4 v240, s[16:19], s5 offen  lds

.pj_8:
    s_waitcnt vmcnt(9)
    s_barrier
    v_mov_b32 v243, s99
    v_mov_b32 v242, 0
    s_cmp_lg_u32 s24, 3
    s_cbranch_scc1 .a1_9
    s_mov_b64 exec, 1
    buffer_atomic_add v243, v242, s[20:23], s97 offen sc1
    s_mov_b64 exec, -1

.a1_9:
    s_bitcmp1_b32 s26, 0
    s_cbranch_scc1 .po_11
    s_add_u32 m0, s98, 8192
    s_mov_b32 s5, 1048576
    buffer_load_dwordx4 v240, s[16:19], s5 offen  lds

    s_add_u32 m0, s98, 9216
    s_mov_b32 s5, 1179648
    buffer_load_dwordx4 v240, s[16:19], s5 offen  lds

    s_add_u32 m0, s98, 10240
    s_mov_b32 s5, 1310720
    buffer_load_dwordx4 v240, s[16:19], s5 offen  lds

    s_add_u32 m0, s98, 11264
    s_mov_b32 s5, 1441792
    buffer_load_dwordx4 v240, s[16:19], s5 offen  lds

    s_add_u32 m0, s98, 12288
    s_mov_b32 s5, 1572864
    buffer_load_dwordx4 v240, s[16:19], s5 offen  lds

    s_add_u32 m0, s98, 13312
    s_mov_b32 s5, 1703936
    buffer_load_dwordx4 v240, s[16:19], s5 offen  lds

    s_add_u32 m0, s98, 14336
    s_mov_b32 s5, 1835008
    buffer_load_dwordx4 v240, s[16:19], s5 offen  lds

    s_add_u32 m0, s98, 15360
    s_mov_b32 s5, 1966080
    buffer_load_dwordx4 v240, s[16:19], s5 offen  lds

    s_mov_b32 s16, s46
    s_and_b32 s17, s47, 0xffff
    s_mov_b32 s18, 0x800000
    s_mov_b32 s19, 0x00020000

    s_add_u32 m0, s98, 16384
    s_mov_b32 s5, 0
    buffer_load_dwordx4 v240, s[16:19], s5 offen  lds

    s_add_u32 m0, s98, 17408
    s_mov_b32 s5, 131072
    buffer_load_dwordx4 v240, s[16:19], s5 offen  lds

    s_add_u32 m0, s98, 18432
    s_mov_b32 s5, 262144
    buffer_load_dwordx4 v240, s[16:19], s5 offen  lds

    s_add_u32 m0, s98, 19456
    s_mov_b32 s5, 393216
    buffer_load_dwordx4 v240, s[16:19], s5 offen  lds

    s_add_u32 m0, s98, 20480
    s_mov_b32 s5, 524288
    buffer_load_dwordx4 v240, s[16:19], s5 offen  lds

    s_add_u32 m0, s98, 21504
    s_mov_b32 s5, 655360
    buffer_load_dwordx4 v240, s[16:19], s5 offen  lds

    s_add_u32 m0, s98, 22528
    s_mov_b32 s5, 786432
    buffer_load_dwordx4 v240, s[16:19], s5 offen  lds

    s_add_u32 m0, s98, 23552
    s_mov_b32 s5, 917504
    buffer_load_dwordx4 v240, s[16:19], s5 offen  lds

    s_add_u32 m0, s98, 24576
    s_mov_b32 s5, 1048576
    buffer_load_dwordx4 v240, s[16:19], s5 offen  lds

    s_add_u32 m0, s98, 25600
    s_mov_b32 s5, 1179648
    buffer_load_dwordx4 v240, s[16:19], s5 offen  lds

    s_add_u32 m0, s98, 26624
    s_mov_b32 s5, 1310720
    buffer_load_dwordx4 v240, s[16:19], s5 offen  lds

    s_add_u32 m0, s98, 27648
    s_mov_b32 s5, 1441792
    buffer_load_dwordx4 v240, s[16:19], s5 offen  lds

    s_add_u32 m0, s98, 28672
    s_mov_b32 s5, 1572864
    buffer_load_dwordx4 v240, s[16:19], s5 offen  lds

    s_add_u32 m0, s98, 29696
    s_mov_b32 s5, 1703936
    buffer_load_dwordx4 v240, s[16:19], s5 offen  lds

    s_add_u32 m0, s98, 30720
    s_mov_b32 s5, 1835008
    buffer_load_dwordx4 v240, s[16:19], s5 offen  lds

    s_add_u32 m0, s98, 31744
    s_mov_b32 s5, 1966080
    buffer_load_dwordx4 v240, s[16:19], s5 offen  lds

    s_branch .pj_12
.po_11:
    s_add_u32 m0, s98, 0
    s_mov_b32 s5, 0
    buffer_load_dwordx4 v240, s[16:19], s5 offen  lds

    s_add_u32 m0, s98, 1024
    s_mov_b32 s5, 131072
    buffer_load_dwordx4 v240, s[16:19], s5 offen  lds

    s_add_u32 m0, s98, 2048
    s_mov_b32 s5, 262144
    buffer_load_dwordx4 v240, s[16:19], s5 offen  lds

    s_add_u32 m0, s98, 3072
    s_mov_b32 s5, 393216
    buffer_load_dwordx4 v240, s[16:19], s5 offen  lds

    s_add_u32 m0, s98, 4096
    s_mov_b32 s5, 524288
    buffer_load_dwordx4 v240, s[16:19], s5 offen  lds

    s_add_u32 m0, s98, 5120
    s_mov_b32 s5, 655360
    buffer_load_dwordx4 v240, s[16:19], s5 offen  lds

    s_add_u32 m0, s98, 6144
    s_mov_b32 s5, 786432
    buffer_load_dwordx4 v240, s[16:19], s5 offen  lds

    s_add_u32 m0, s98, 7168
    s_mov_b32 s5, 917504
    buffer_load_dwordx4 v240, s[16:19], s5 offen  lds

    s_mov_b32 s16, s46
    s_and_b32 s17, s47, 0xffff
    s_mov_b32 s18, 0x800000
    s_mov_b32 s19, 0x00020000

    s_add_u32 m0, s98, 24576
    s_mov_b32 s5, 1048576
    buffer_load_dwordx4 v240, s[16:19], s5 offen  lds

    s_add_u32 m0, s98, 25600
    s_mov_b32 s5, 1179648
    buffer_load_dwordx4 v240, s[16:19], s5 offen  lds

    s_add_u32 m0, s98, 26624
    s_mov_b32 s5, 1310720
    buffer_load_dwordx4 v240, s[16:19], s5 offen  lds

    s_add_u32 m0, s98, 27648
    s_mov_b32 s5, 1441792
    buffer_load_dwordx4 v240, s[16:19], s5 offen  lds

    s_add_u32 m0, s98, 28672
    s_mov_b32 s5, 1572864
    buffer_load_dwordx4 v240, s[16:19], s5 offen  lds

    s_add_u32 m0, s98, 29696
    s_mov_b32 s5, 1703936
    buffer_load_dwordx4 v240, s[16:19], s5 offen  lds

    s_add_u32 m0, s98, 30720
    s_mov_b32 s5, 1835008
    buffer_load_dwordx4 v240, s[16:19], s5 offen  lds

    s_add_u32 m0, s98, 31744
    s_mov_b32 s5, 1966080
    buffer_load_dwordx4 v240, s[16:19], s5 offen  lds

    s_add_u32 m0, s98, 16384
    s_mov_b32 s5, 0
    buffer_load_dwordx4 v240, s[16:19], s5 offen  lds

    s_add_u32 m0, s98, 17408
    s_mov_b32 s5, 131072
    buffer_load_dwordx4 v240, s[16:19], s5 offen  lds

    s_add_u32 m0, s98, 18432
    s_mov_b32 s5, 262144
    buffer_load_dwordx4 v240, s[16:19], s5 offen  lds

    s_add_u32 m0, s98, 19456
    s_mov_b32 s5, 393216
    buffer_load_dwordx4 v240, s[16:19], s5 offen  lds

    s_add_u32 m0, s98, 20480
    s_mov_b32 s5, 524288
    buffer_load_dwordx4 v240, s[16:19], s5 offen  lds

    s_add_u32 m0, s98, 21504
    s_mov_b32 s5, 655360
    buffer_load_dwordx4 v240, s[16:19], s5 offen  lds

    s_add_u32 m0, s98, 22528
    s_mov_b32 s5, 786432
    buffer_load_dwordx4 v240, s[16:19], s5 offen  lds

    s_add_u32 m0, s98, 23552
    s_mov_b32 s5, 917504
    buffer_load_dwordx4 v240, s[16:19], s5 offen  lds

.pj_12:
    s_mov_b32 s12, s40
    s_and_b32 s13, s41, 0xffff
    s_mov_b32 s14, 0x4000
    s_mov_b32 s15, 0x00020000

    v_bfe_u32 v4, v2, 2, 1
    v_lshrrev_b32 v5, 3, v2
    v_lshrrev_b32 v8, 1, v3
    v_and_b32 v9, 1, v3
    v_lshl_add_u32 v6, v5, 3, v4
    v_lshl_add_u32 v6, v8, 4, v6
    v_lshl_add_u32 v6, v9, 2, v6
    v_lshl_add_u32 v7, v5, 2, v4
    v_lshl_add_u32 v7, v8, 3, v7
    v_lshl_add_u32 v7, v9, 4, v7
    v_and_b32 v5, 3, v2
    v_lshlrev_b32 v5, 3, v5
    v_lshl_add_u32 v6, v6, 6, v5
    v_lshl_add_u32 v7, v7, 6, v5
    v_add_u32 v254, s98, v6
    v_add_u32 v255, s98, v7
    v_sub_u32 v252, v254, v5
    v_and_b32 v5, 1, v2
    v_lshl_add_u32 v252, v5, 5, v252
    v_bfe_u32 v5, v2, 1, 1
    v_lshl_add_u32 v252, v5, 3, v252

    s_and_b32 s96, s26, 3
    s_lshl_b32 s4, s25, 3
    s_add_u32 s7, s4, s79
    s_lshl_b32 s5, s24, 12
    v_add_u32 v8, s5, v14
    v_and_b32 v5, 7, v2
    v_lshrrev_b32 v6, 1, v3
    v_and_b32 v7, 1, v3
    v_lshlrev_b32 v7, 3, v7
    v_lshlrev_b32 v17, 11, v5
    v_lshl_add_u32 v17, v3, 5, v17
    v_lshrrev_b32 v4, 3, v2
    v_lshl_add_u32 v17, v4, 4, v17
    s_lshl_b32 s5, s24, 9
    v_add_u32 v17, s5, v17

    buffer_load_dwordx4 v[20:23], v17, s[12:15], 0 offen offset:0
    buffer_load_dwordx4 v[24:27], v17, s[12:15], 0 offen offset:128
    buffer_load_dwordx4 v[28:31], v17, s[12:15], 0 offen offset:256
    buffer_load_dwordx4 v[32:35], v17, s[12:15], 0 offen offset:384
    v_lshlrev_b32 v4, 7, v2
    v_lshl_add_u32 v18, s26, 10, v4
    v_add_u32 v18, 32768, v18
    v_and_b32 v4, 0x180, v4
    v_lshl_add_u32 v4, s26, 9, v4
    v_bfe_u32 v19, v2, 2, 1
    v_lshl_add_u32 v4, v19, 14, v4
    v_cmp_gt_u32 vcc, 8, v2
    s_lshl_b32 s4, s24, 16
    s_add_u32 s4, s4, s34
    v_cndmask_b32 v4, v4, v18, vcc
    s_mov_b64 exec, 0xffff
    buffer_load_dword v227, v4, s[8:11], s4 offen
    s_mov_b64 exec, -1

    s_lshl_b32 s4, s79, 12
    s_add_u32 s4, s4, 32768

    s_add_u32 s5, s96, 1
    s_and_b32 s5, s5, 3
    s_lshl_b32 s5, s5, 10
    s_add_u32 s5, s5, s4
    v_add_u32 v232, s5, v14

    s_add_u32 s5, s96, 2
    s_and_b32 s5, s5, 3
    s_lshl_b32 s5, s5, 10
    s_add_u32 s5, s5, s4
    v_add_u32 v233, s5, v14

    s_add_u32 s5, s96, 3
    s_and_b32 s5, s5, 3
    s_lshl_b32 s5, s5, 10
    s_add_u32 s5, s5, s4
    v_add_u32 v234, s5, v14

    s_lshl_b32 s5, s78, 9
    v_lshlrev_b32 v10, 8, v6
    v_lshl_add_u32 v10, v2, 4, v10
    v_add_u32 v10, v10, v7
    v_add_u32 v10, s5, v10
    v_add_u32 v18, 16384, v10
    s_lshl_b32 s5, s26, 10
    s_add_u32 s5, s5, 32768
    v_add_u32 v10, s5, v10
    v_lshlrev_b32 v11, 8, v3
    v_lshl_add_u32 v11, v5, 4, v11
    s_lshr_b32 s4, s96, 1
    s_lshl_b32 s4, s4, 10
    s_and_b32 s5, s96, 1
    s_lshl_b32 s5, s5, 7
    s_add_u32 s4, s4, s5
    s_add_u32 s4, s4, 2048
    v_add_u32 v11, s4, v11
    v_lshlrev_b32 v12, 8, v6
    v_lshl_add_u32 v12, v2, 4, v12
    s_lshl_b32 s4, s96, 9
    s_add_u32 s4, s4, 4096
    v_add_u32 v12, s4, v12
    s_lshl_b32 s4, s26, 9
    v_lshlrev_b32 v13, 7, v3
    v_lshl_add_u32 v13, v5, 4, v13
    v_add_u32 v13, s4, v13
    v_add_u32 v13, 16384, v13
    v_lshlrev_b32 v15, 7, v6
    v_lshl_add_u32 v15, v5, 4, v15
    v_add_u32 v15, v15, v7
    s_lshl_b32 s5, s78, 8
    s_add_u32 s5, s5, s4
    v_add_u32 v15, s5, v15
    v_lshlrev_b32 v16, 8, v6
    v_lshl_add_u32 v16, v2, 4, v16
    v_add_u32 v16, v16, v7
    s_lshl_b32 s5, s24, 9
    v_add_u32 v16, s5, v16
    s_lshl_b32 s5, s24, 11
    v_add_u32 v17, s5, v14
    v_cmp_gt_u32 s[58:59], 8, v2
    v_cmp_gt_u32 s[60:61], 32, v1
    v_mov_b32 v4, 0x4444
    v_mov_b32 v9, 0xeeee
    v_cndmask_b32 v9, v9, v4, s[58:59]
    s_not_b64 s[66:67], s[58:59]
    s_cmp_lt_u32 s24, 2
    s_cselect_b64 s[64:65], s[66:67], s[58:59]
    s_mov_b32 s56, 0x0000ffff
    s_mov_b32 s57, 0x0000ffff
    s_cmp_eq_u32 s24, 1
    s_cselect_b64 vcc, -1, 0
    s_cselect_b64 s[66:67], s[56:57], s[66:67]
    s_lshl_b32 s5, s78, 10
    v_add_u32 v19, s5, v14
    v_cndmask_b32 v11, v11, v12, vcc
    v_cndmask_b32 v235, v235, v236, vcc
    v_mov_b32 v4, 0xff800000
    v_cndmask_b32 v116, 0, v4, s[60:61]
    v_mov_b32 v117, v116
    v_mov_b32 v118, v116
    v_mov_b32 v119, v116
    s_lshl_b32 s5, s78, 13
    v_add_u32 v246, s5, v14
    v_lshlrev_b32 v247, 9, v6
    v_lshl_add_u32 v247, v2, 4, v247
    s_lshl_b32 s5, s78, 8
    s_add_u32 s5, s5, 12288
    v_add_u32 v247, s5, v247
    v_and_b32 v4, 31, v1
    v_lshlrev_b32 v248, 4, v4
    s_lshl_b32 s5, s78, 9
    s_add_u32 s5, s5, 12288
    v_add_u32 v248, s5, v248
    s_lshl_b32 s5, s25, 16
    v_and_b32 v7, 1, v3
    v_lshlrev_b32 v237, 18, v7
    v_lshl_add_u32 v237, v6, 8, v237
    v_lshl_add_u32 v237, v2, 4, v237
    v_add_u32 v237, s5, v237
    s_lshl_b32 s6, s78, 9
    v_add_u32 v237, s6, v237
    s_lshl_b32 s6, s78, 8
    v_lshlrev_b32 v249, 9, v7
    v_lshl_add_u32 v249, v2, 4, v249
    v_add_u32 v249, s6, v249
    v_add_u32 v4, s25, v6
    v_add_u32 v4, 1, v4
    v_and_b32 v4, 3, v4
    v_lshl_add_u32 v239, v4, 16, v249
    s_add_u32 s6, s25, 3
    s_and_b32 s6, s6, 3
    s_lshl_b32 s6, s6, 16
    v_add_u32 v249, s6, v249
    v_and_b32 v4, 1, v5
    v_lshlrev_b32 v4, 4, v4
    v_mov_b32 v6, 0x3f80
    v_lshlrev_b32 v6, v4, v6
    v_lshrrev_b32 v4, 1, v5

    v_cmp_eq_u32 vcc, 0, v4
    s_nop 1
    v_cndmask_b32 v84, 0, v6, vcc
    v_cmp_eq_u32 vcc, 1, v4
    s_nop 1
    v_cndmask_b32 v85, 0, v6, vcc
    v_cmp_eq_u32 vcc, 2, v4
    s_nop 1
    v_cndmask_b32 v86, 0, v6, vcc
    v_cmp_eq_u32 vcc, 3, v4
    s_nop 1
    v_cndmask_b32 v87, 0, v6, vcc
    v_mov_b32 v120, 0x3f803f80
    v_cndmask_b32 v112, 0, v84, s[60:61]
    v_mov_b32 v121, 0x3f803f80
    v_cndmask_b32 v113, 0, v85, s[60:61]
    v_mov_b32 v122, 0x3f803f80
    v_cndmask_b32 v114, 0, v86, s[60:61]
    v_mov_b32 v123, 0x3f803f80
    v_cndmask_b32 v115, 0, v87, s[60:61]
    v_mov_b32 v170, 0
    v_mov_b32 v171, 0
    v_mov_b32 v174, 0
    v_mov_b32 v175, 0
    v_mov_b32 v182, 0
    v_mov_b32 v183, 0
    s_add_u32 s5, s96, 0
    s_and_b32 s5, s5, 3
    s_lshl_b32 s5, s5, 10
    s_add_u32 s5, s5, 20480
    v_add_u32 v228, s5, v14

    s_add_u32 s5, s96, 1
    s_and_b32 s5, s5, 3
    s_lshl_b32 s5, s5, 10
    s_add_u32 s5, s5, 20480
    v_add_u32 v229, s5, v14

    s_add_u32 s5, s96, 2
    s_and_b32 s5, s5, 3
    s_lshl_b32 s5, s5, 10
    s_add_u32 s5, s5, 20480
    v_add_u32 v230, s5, v14

    s_add_u32 s5, s96, 3
    s_and_b32 s5, s5, 3
    s_lshl_b32 s5, s5, 10
    s_add_u32 s5, s5, 20480
    v_add_u32 v231, s5, v14

    s_lshl_b32 s89, s7, 8
    s_add_u32 s89, s89, 92282880
    v_lshlrev_b32 v253, 13, v1
    s_lshl_b32 s4, s7, 13
    s_add_u32 s38, s4, 16777216
    s_lshl_b32 s5, s96, 11
    s_add_u32 s39, s4, s5
    s_add_u32 s30, s39, 17039360
    s_add_u32 s39, s39, 33554432
    s_lshl_b32 s5, s78, 24
    s_add_u32 s30, s30, s5
    s_lshl_b32 s5, s78, 12
    s_add_u32 s38, s38, s5
    s_add_u32 s90, s5, 20480
    s_lshl_b32 s5, s78, 10
    s_add_u32 s39, s39, s5
    s_add_u32 s91, s5, 28672
    s_mov_b32 s37, 0x3e0293ee
    s_mov_b32 s28, 0

    v_and_b32 v4, 31, v1
    v_lshlrev_b32 v225, 6, v4
    v_lshrrev_b32 v4, 5, v1
    v_lshl_add_u32 v225, v4, 24, v225

    v_mov_b32 v52, 0
    v_mov_b32 v53, 0
    v_mov_b32 v54, 0
    v_mov_b32 v55, 0
    v_mov_b32 v56, 0
    v_mov_b32 v57, 0
    v_mov_b32 v58, 0
    v_mov_b32 v59, 0
    v_mov_b32 v60, 0
    v_mov_b32 v61, 0
    v_mov_b32 v62, 0
    v_mov_b32 v63, 0
    v_mov_b32 v64, 0
    v_mov_b32 v65, 0
    v_mov_b32 v66, 0
    v_mov_b32 v67, 0
    v_mov_b32 v68, 0
    v_mov_b32 v69, 0
    v_mov_b32 v70, 0
    v_mov_b32 v71, 0
    v_mov_b32 v72, 0
    v_mov_b32 v73, 0
    v_mov_b32 v74, 0
    v_mov_b32 v75, 0
    v_mov_b32 v76, 0
    v_mov_b32 v77, 0
    v_mov_b32 v78, 0
    v_mov_b32 v79, 0
    v_mov_b32 v80, 0
    v_mov_b32 v81, 0
    v_mov_b32 v82, 0
    v_mov_b32 v83, 0
    v_mov_b32 v92, -1
    v_mov_b32 v93, -1
    v_mov_b32 v94, -1
    v_mov_b32 v95, -1
    v_mov_b32 v96, -1
    v_mov_b32 v97, -1
    v_mov_b32 v98, -1
    v_mov_b32 v99, -1
    v_mov_b32 v100, -1
    v_mov_b32 v101, -1
    v_mov_b32 v102, -1
    v_mov_b32 v103, -1
    v_mov_b32 v192, -1
    v_mov_b32 v193, -1
    v_mov_b32 v194, -1
    v_mov_b32 v195, -1
    v_mov_b32 v196, -1
    v_mov_b32 v197, -1
    v_mov_b32 v198, -1
    v_mov_b32 v199, -1
    v_mov_b32 v200, -1
    v_mov_b32 v201, -1
    v_mov_b32 v202, -1
    v_mov_b32 v203, -1
    v_mov_b32 v204, -1
    v_mov_b32 v205, -1
    v_mov_b32 v206, -1
    v_mov_b32 v207, -1
    v_mov_b32 v208, -1
    v_mov_b32 v209, -1
    v_mov_b32 v210, -1
    v_mov_b32 v211, -1
    v_mov_b32 v212, -1
    v_mov_b32 v213, -1
    v_mov_b32 v214, -1
    v_mov_b32 v215, -1
    v_mov_b32 v216, -1
    v_mov_b32 v217, -1
    v_mov_b32 v218, -1
    v_mov_b32 v219, -1
    v_mov_b32 v220, -1
    v_mov_b32 v221, -1
    v_mov_b32 v222, -1
    v_mov_b32 v223, -1
    s_bitcmp1_b32 s26, 0
    s_cbranch_scc1 .po_13
    s_waitcnt vmcnt(29)
    ds_read_b64_tr_b16 a[0:1], v252 offset:0
    ds_read_b64_tr_b16 a[2:3], v252 offset:128
    ds_read_b64_tr_b16 a[4:5], v252 offset:2048
    ds_read_b64_tr_b16 a[6:7], v252 offset:2176
    ds_read_b64_tr_b16 a[8:9], v252 offset:4096
    ds_read_b64_tr_b16 a[10:11], v252 offset:4224
    ds_read_b64_tr_b16 a[12:13], v252 offset:6144
    ds_read_b64_tr_b16 a[14:15], v252 offset:6272
    ds_read_b64_tr_b16 a[32:33], v252 offset:16
    ds_read_b64_tr_b16 a[34:35], v252 offset:144
    ds_read_b64_tr_b16 a[36:37], v252 offset:2064
    ds_read_b64_tr_b16 a[38:39], v252 offset:2192
    ds_read_b64_tr_b16 a[40:41], v252 offset:4112
    ds_read_b64_tr_b16 a[42:43], v252 offset:4240
    ds_read_b64_tr_b16 a[44:45], v252 offset:6160
    ds_read_b64_tr_b16 a[46:47], v252 offset:6288
    s_waitcnt lgkmcnt(0)
    s_mov_b32 s16, s48
    s_and_b32 s17, s49, 0xffff
    s_mov_b32 s18, 0x800000
    s_mov_b32 s19, 0x00020000

    s_add_u32 m0, s98, 0
    s_mov_b32 s5, 0
    buffer_load_dwordx4 v240, s[16:19], s5 offen  lds

    s_add_u32 m0, s98, 1024
    s_mov_b32 s5, 131072
    buffer_load_dwordx4 v240, s[16:19], s5 offen  lds

    s_add_u32 m0, s98, 2048
    s_mov_b32 s5, 262144
    buffer_load_dwordx4 v240, s[16:19], s5 offen  lds

    s_add_u32 m0, s98, 3072
    s_mov_b32 s5, 393216
    buffer_load_dwordx4 v240, s[16:19], s5 offen  lds

    s_add_u32 m0, s98, 4096
    s_mov_b32 s5, 524288
    buffer_load_dwordx4 v240, s[16:19], s5 offen  lds

    s_add_u32 m0, s98, 5120
    s_mov_b32 s5, 655360
    buffer_load_dwordx4 v240, s[16:19], s5 offen  lds

    s_add_u32 m0, s98, 6144
    s_mov_b32 s5, 786432
    buffer_load_dwordx4 v240, s[16:19], s5 offen  lds

    s_add_u32 m0, s98, 7168
    s_mov_b32 s5, 917504
    buffer_load_dwordx4 v240, s[16:19], s5 offen  lds

    s_waitcnt vmcnt(29)
    ds_read_b64_tr_b16 a[16:17], v252 offset:8192
    ds_read_b64_tr_b16 a[18:19], v252 offset:8320
    ds_read_b64_tr_b16 a[20:21], v252 offset:10240
    ds_read_b64_tr_b16 a[22:23], v252 offset:10368
    ds_read_b64_tr_b16 a[24:25], v252 offset:12288
    ds_read_b64_tr_b16 a[26:27], v252 offset:12416
    ds_read_b64_tr_b16 a[28:29], v252 offset:14336
    ds_read_b64_tr_b16 a[30:31], v252 offset:14464
    ds_read_b64_tr_b16 a[48:49], v252 offset:8208
    ds_read_b64_tr_b16 a[50:51], v252 offset:8336
    ds_read_b64_tr_b16 a[52:53], v252 offset:10256
    ds_read_b64_tr_b16 a[54:55], v252 offset:10384
    ds_read_b64_tr_b16 a[56:57], v252 offset:12304
    ds_read_b64_tr_b16 a[58:59], v252 offset:12432
    ds_read_b64_tr_b16 a[60:61], v252 offset:14352
    ds_read_b64_tr_b16 a[62:63], v252 offset:14480
    s_waitcnt lgkmcnt(0)
    s_add_u32 m0, s98, 8192
    s_mov_b32 s5, 1048576
    buffer_load_dwordx4 v240, s[16:19], s5 offen  lds

    s_add_u32 m0, s98, 9216
    s_mov_b32 s5, 1179648
    buffer_load_dwordx4 v240, s[16:19], s5 offen  lds

    s_add_u32 m0, s98, 10240
    s_mov_b32 s5, 1310720
    buffer_load_dwordx4 v240, s[16:19], s5 offen  lds

    s_add_u32 m0, s98, 11264
    s_mov_b32 s5, 1441792
    buffer_load_dwordx4 v240, s[16:19], s5 offen  lds

    s_add_u32 m0, s98, 12288
    s_mov_b32 s5, 1572864
    buffer_load_dwordx4 v240, s[16:19], s5 offen  lds

    s_add_u32 m0, s98, 13312
    s_mov_b32 s5, 1703936
    buffer_load_dwordx4 v240, s[16:19], s5 offen  lds

    s_add_u32 m0, s98, 14336
    s_mov_b32 s5, 1835008
    buffer_load_dwordx4 v240, s[16:19], s5 offen  lds

    s_add_u32 m0, s98, 15360
    s_mov_b32 s5, 1966080
    buffer_load_dwordx4 v240, s[16:19], s5 offen  lds

    s_waitcnt vmcnt(29)
    ds_read_b64_tr_b16 a[64:65], v252 offset:16384
    ds_read_b64_tr_b16 a[66:67], v252 offset:16512
    ds_read_b64_tr_b16 a[68:69], v252 offset:18432
    ds_read_b64_tr_b16 a[70:71], v252 offset:18560
    ds_read_b64_tr_b16 a[72:73], v252 offset:20480
    ds_read_b64_tr_b16 a[74:75], v252 offset:20608
    ds_read_b64_tr_b16 a[76:77], v252 offset:22528
    ds_read_b64_tr_b16 a[78:79], v252 offset:22656
    ds_read_b64_tr_b16 a[96:97], v252 offset:16400
    ds_read_b64_tr_b16 a[98:99], v252 offset:16528
    ds_read_b64_tr_b16 a[100:101], v252 offset:18448
    ds_read_b64_tr_b16 a[102:103], v252 offset:18576
    ds_read_b64_tr_b16 a[104:105], v252 offset:20496
    ds_read_b64_tr_b16 a[106:107], v252 offset:20624
    ds_read_b64_tr_b16 a[108:109], v252 offset:22544
    ds_read_b64_tr_b16 a[110:111], v252 offset:22672
    s_waitcnt lgkmcnt(0)
    s_mov_b32 s16, s50
    s_and_b32 s17, s51, 0xffff
    s_mov_b32 s18, 0x800000
    s_mov_b32 s19, 0x00020000

    s_add_u32 m0, s98, 16384
    s_mov_b32 s5, 0
    buffer_load_dwordx4 v241, s[16:19], s5 offen  lds

    s_add_u32 m0, s98, 17408
    s_mov_b32 s5, 32768
    buffer_load_dwordx4 v241, s[16:19], s5 offen  lds

    s_add_u32 m0, s98, 18432
    s_mov_b32 s5, 65536
    buffer_load_dwordx4 v241, s[16:19], s5 offen  lds

    s_add_u32 m0, s98, 19456
    s_mov_b32 s5, 98304
    buffer_load_dwordx4 v241, s[16:19], s5 offen  lds

    s_add_u32 m0, s98, 20480
    s_mov_b32 s5, 131072
    buffer_load_dwordx4 v241, s[16:19], s5 offen  lds

    s_add_u32 m0, s98, 21504
    s_mov_b32 s5, 163840
    buffer_load_dwordx4 v241, s[16:19], s5 offen  lds

    s_add_u32 m0, s98, 22528
    s_mov_b32 s5, 196608
    buffer_load_dwordx4 v241, s[16:19], s5 offen  lds

    s_add_u32 m0, s98, 23552
    s_mov_b32 s5, 229376
    buffer_load_dwordx4 v241, s[16:19], s5 offen  lds

    s_waitcnt vmcnt(29)
    ds_read_b64_tr_b16 a[80:81], v252 offset:24576
    ds_read_b64_tr_b16 a[82:83], v252 offset:24704
    ds_read_b64_tr_b16 a[84:85], v252 offset:26624
    ds_read_b64_tr_b16 a[86:87], v252 offset:26752
    ds_read_b64_tr_b16 a[88:89], v252 offset:28672
    ds_read_b64_tr_b16 a[90:91], v252 offset:28800
    ds_read_b64_tr_b16 a[92:93], v252 offset:30720
    ds_read_b64_tr_b16 a[94:95], v252 offset:30848
    ds_read_b64_tr_b16 a[112:113], v252 offset:24592
    ds_read_b64_tr_b16 a[114:115], v252 offset:24720
    ds_read_b64_tr_b16 a[116:117], v252 offset:26640
    ds_read_b64_tr_b16 a[118:119], v252 offset:26768
    ds_read_b64_tr_b16 a[120:121], v252 offset:28688
    ds_read_b64_tr_b16 a[122:123], v252 offset:28816
    ds_read_b64_tr_b16 a[124:125], v252 offset:30736
    ds_read_b64_tr_b16 a[126:127], v252 offset:30864
    s_waitcnt lgkmcnt(0)
    s_add_u32 m0, s98, 24576
    s_mov_b32 s5, 262144
    buffer_load_dwordx4 v241, s[16:19], s5 offen  lds

    s_add_u32 m0, s98, 25600
    s_mov_b32 s5, 294912
    buffer_load_dwordx4 v241, s[16:19], s5 offen  lds

    s_add_u32 m0, s98, 26624
    s_mov_b32 s5, 327680
    buffer_load_dwordx4 v241, s[16:19], s5 offen  lds

    s_add_u32 m0, s98, 27648
    s_mov_b32 s5, 360448
    buffer_load_dwordx4 v241, s[16:19], s5 offen  lds

    s_add_u32 m0, s98, 28672
    s_mov_b32 s5, 393216
    buffer_load_dwordx4 v241, s[16:19], s5 offen  lds

    s_add_u32 m0, s98, 29696
    s_mov_b32 s5, 425984
    buffer_load_dwordx4 v241, s[16:19], s5 offen  lds

    s_add_u32 m0, s98, 30720
    s_mov_b32 s5, 458752
    buffer_load_dwordx4 v241, s[16:19], s5 offen  lds

    s_add_u32 m0, s98, 31744
    s_mov_b32 s5, 491520
    buffer_load_dwordx4 v241, s[16:19], s5 offen  lds

    v_and_b32 v241, 3, v0
    v_lshlrev_b32 v241, 2, v241
    buffer_load_dword v240, v241, s[20:23], s97 offen sc1

    s_waitcnt vmcnt(25)
    ds_read_b64_tr_b16 a[128:129], v254 offset:0
    ds_read_b64_tr_b16 a[130:131], v254 offset:128
    ds_read_b64_tr_b16 a[132:133], v254 offset:2048
    ds_read_b64_tr_b16 a[134:135], v254 offset:2176
    ds_read_b64_tr_b16 a[136:137], v254 offset:4096
    ds_read_b64_tr_b16 a[138:139], v254 offset:4224
    ds_read_b64_tr_b16 a[140:141], v254 offset:6144
    ds_read_b64_tr_b16 a[142:143], v254 offset:6272
    ds_read_b64_tr_b16 a[160:161], v254 offset:32
    ds_read_b64_tr_b16 a[162:163], v254 offset:160
    ds_read_b64_tr_b16 a[164:165], v254 offset:2080
    ds_read_b64_tr_b16 a[166:167], v254 offset:2208
    ds_read_b64_tr_b16 a[168:169], v254 offset:4128
    ds_read_b64_tr_b16 a[170:171], v254 offset:4256
    ds_read_b64_tr_b16 a[172:173], v254 offset:6176
    ds_read_b64_tr_b16 a[174:175], v254 offset:6304
    s_waitcnt vmcnt(17)
    ds_read_b64_tr_b16 a[144:145], v254 offset:8192
    ds_read_b64_tr_b16 a[146:147], v254 offset:8320
    ds_read_b64_tr_b16 a[148:149], v254 offset:10240
    ds_read_b64_tr_b16 a[150:151], v254 offset:10368
    ds_read_b64_tr_b16 a[152:153], v254 offset:12288
    ds_read_b64_tr_b16 a[154:155], v254 offset:12416
    ds_read_b64_tr_b16 a[156:157], v254 offset:14336
    ds_read_b64_tr_b16 a[158:159], v254 offset:14464
    ds_read_b64_tr_b16 a[176:177], v254 offset:8224
    ds_read_b64_tr_b16 a[178:179], v254 offset:8352
    ds_read_b64_tr_b16 a[180:181], v254 offset:10272
    ds_read_b64_tr_b16 a[182:183], v254 offset:10400
    ds_read_b64_tr_b16 a[184:185], v254 offset:12320
    ds_read_b64_tr_b16 a[186:187], v254 offset:12448
    ds_read_b64_tr_b16 a[188:189], v254 offset:14368
    ds_read_b64_tr_b16 a[190:191], v254 offset:14496
    s_waitcnt vmcnt(9)
    ds_read_b64_tr_b16 a[192:193], v255 offset:16384
    ds_read_b64_tr_b16 a[194:195], v255 offset:16512
    ds_read_b64_tr_b16 a[196:197], v255 offset:18432
    ds_read_b64_tr_b16 a[198:199], v255 offset:18560
    ds_read_b64_tr_b16 a[200:201], v255 offset:20480
    ds_read_b64_tr_b16 a[202:203], v255 offset:20608
    ds_read_b64_tr_b16 a[204:205], v255 offset:22528
    ds_read_b64_tr_b16 a[206:207], v255 offset:22656
    ds_read_b64_tr_b16 a[224:225], v255 offset:16416
    ds_read_b64_tr_b16 a[226:227], v255 offset:16544
    ds_read_b64_tr_b16 a[228:229], v255 offset:18464
    ds_read_b64_tr_b16 a[230:231], v255 offset:18592
    ds_read_b64_tr_b16 a[232:233], v255 offset:20512
    ds_read_b64_tr_b16 a[234:235], v255 offset:20640
    ds_read_b64_tr_b16 a[236:237], v255 offset:22560
    ds_read_b64_tr_b16 a[238:239], v255 offset:22688
    s_waitcnt vmcnt(1)
    ds_read_b64_tr_b16 a[208:209], v255 offset:24576
    ds_read_b64_tr_b16 a[210:211], v255 offset:24704
    ds_read_b64_tr_b16 a[212:213], v255 offset:26624
    ds_read_b64_tr_b16 a[214:215], v255 offset:26752
    ds_read_b64_tr_b16 a[216:217], v255 offset:28672
    ds_read_b64_tr_b16 a[218:219], v255 offset:28800
    ds_read_b64_tr_b16 a[220:221], v255 offset:30720
    ds_read_b64_tr_b16 a[222:223], v255 offset:30848
    ds_read_b64_tr_b16 a[240:241], v255 offset:24608
    ds_read_b64_tr_b16 a[242:243], v255 offset:24736
    ds_read_b64_tr_b16 a[244:245], v255 offset:26656
    ds_read_b64_tr_b16 a[246:247], v255 offset:26784
    ds_read_b64_tr_b16 a[248:249], v255 offset:28704
    ds_read_b64_tr_b16 a[250:251], v255 offset:28832
    ds_read_b64_tr_b16 a[252:253], v255 offset:30752
    ds_read_b64_tr_b16 a[254:255], v255 offset:30880
    s_branch .pj_14
.po_13:
    s_waitcnt vmcnt(29)
    ds_read_b64_tr_b16 a[16:17], v252 offset:8192
    ds_read_b64_tr_b16 a[18:19], v252 offset:8320
    ds_read_b64_tr_b16 a[20:21], v252 offset:10240
    ds_read_b64_tr_b16 a[22:23], v252 offset:10368
    ds_read_b64_tr_b16 a[24:25], v252 offset:12288
    ds_read_b64_tr_b16 a[26:27], v252 offset:12416
    ds_read_b64_tr_b16 a[28:29], v252 offset:14336
    ds_read_b64_tr_b16 a[30:31], v252 offset:14464
    ds_read_b64_tr_b16 a[48:49], v252 offset:8208
    ds_read_b64_tr_b16 a[50:51], v252 offset:8336
    ds_read_b64_tr_b16 a[52:53], v252 offset:10256
    ds_read_b64_tr_b16 a[54:55], v252 offset:10384
    ds_read_b64_tr_b16 a[56:57], v252 offset:12304
    ds_read_b64_tr_b16 a[58:59], v252 offset:12432
    ds_read_b64_tr_b16 a[60:61], v252 offset:14352
    ds_read_b64_tr_b16 a[62:63], v252 offset:14480
    s_waitcnt lgkmcnt(0)
    s_mov_b32 s16, s48
    s_and_b32 s17, s49, 0xffff
    s_mov_b32 s18, 0x800000
    s_mov_b32 s19, 0x00020000

    s_add_u32 m0, s98, 8192
    s_mov_b32 s5, 1048576
    buffer_load_dwordx4 v240, s[16:19], s5 offen  lds

    s_add_u32 m0, s98, 9216
    s_mov_b32 s5, 1179648
    buffer_load_dwordx4 v240, s[16:19], s5 offen  lds

    s_add_u32 m0, s98, 10240
    s_mov_b32 s5, 1310720
    buffer_load_dwordx4 v240, s[16:19], s5 offen  lds

    s_add_u32 m0, s98, 11264
    s_mov_b32 s5, 1441792
    buffer_load_dwordx4 v240, s[16:19], s5 offen  lds

    s_add_u32 m0, s98, 12288
    s_mov_b32 s5, 1572864
    buffer_load_dwordx4 v240, s[16:19], s5 offen  lds

    s_add_u32 m0, s98, 13312
    s_mov_b32 s5, 1703936
    buffer_load_dwordx4 v240, s[16:19], s5 offen  lds

    s_add_u32 m0, s98, 14336
    s_mov_b32 s5, 1835008
    buffer_load_dwordx4 v240, s[16:19], s5 offen  lds

    s_add_u32 m0, s98, 15360
    s_mov_b32 s5, 1966080
    buffer_load_dwordx4 v240, s[16:19], s5 offen  lds

    s_waitcnt vmcnt(29)
    ds_read_b64_tr_b16 a[0:1], v252 offset:0
    ds_read_b64_tr_b16 a[2:3], v252 offset:128
    ds_read_b64_tr_b16 a[4:5], v252 offset:2048
    ds_read_b64_tr_b16 a[6:7], v252 offset:2176
    ds_read_b64_tr_b16 a[8:9], v252 offset:4096
    ds_read_b64_tr_b16 a[10:11], v252 offset:4224
    ds_read_b64_tr_b16 a[12:13], v252 offset:6144
    ds_read_b64_tr_b16 a[14:15], v252 offset:6272
    ds_read_b64_tr_b16 a[32:33], v252 offset:16
    ds_read_b64_tr_b16 a[34:35], v252 offset:144
    ds_read_b64_tr_b16 a[36:37], v252 offset:2064
    ds_read_b64_tr_b16 a[38:39], v252 offset:2192
    ds_read_b64_tr_b16 a[40:41], v252 offset:4112
    ds_read_b64_tr_b16 a[42:43], v252 offset:4240
    ds_read_b64_tr_b16 a[44:45], v252 offset:6160
    ds_read_b64_tr_b16 a[46:47], v252 offset:6288
    s_waitcnt lgkmcnt(0)
    s_add_u32 m0, s98, 0
    s_mov_b32 s5, 0
    buffer_load_dwordx4 v240, s[16:19], s5 offen  lds

    s_add_u32 m0, s98, 1024
    s_mov_b32 s5, 131072
    buffer_load_dwordx4 v240, s[16:19], s5 offen  lds

    s_add_u32 m0, s98, 2048
    s_mov_b32 s5, 262144
    buffer_load_dwordx4 v240, s[16:19], s5 offen  lds

    s_add_u32 m0, s98, 3072
    s_mov_b32 s5, 393216
    buffer_load_dwordx4 v240, s[16:19], s5 offen  lds

    s_add_u32 m0, s98, 4096
    s_mov_b32 s5, 524288
    buffer_load_dwordx4 v240, s[16:19], s5 offen  lds

    s_add_u32 m0, s98, 5120
    s_mov_b32 s5, 655360
    buffer_load_dwordx4 v240, s[16:19], s5 offen  lds

    s_add_u32 m0, s98, 6144
    s_mov_b32 s5, 786432
    buffer_load_dwordx4 v240, s[16:19], s5 offen  lds

    s_add_u32 m0, s98, 7168
    s_mov_b32 s5, 917504
    buffer_load_dwordx4 v240, s[16:19], s5 offen  lds

    s_waitcnt vmcnt(29)
    ds_read_b64_tr_b16 a[80:81], v252 offset:24576
    ds_read_b64_tr_b16 a[82:83], v252 offset:24704
    ds_read_b64_tr_b16 a[84:85], v252 offset:26624
    ds_read_b64_tr_b16 a[86:87], v252 offset:26752
    ds_read_b64_tr_b16 a[88:89], v252 offset:28672
    ds_read_b64_tr_b16 a[90:91], v252 offset:28800
    ds_read_b64_tr_b16 a[92:93], v252 offset:30720
    ds_read_b64_tr_b16 a[94:95], v252 offset:30848
    ds_read_b64_tr_b16 a[112:113], v252 offset:24592
    ds_read_b64_tr_b16 a[114:115], v252 offset:24720
    ds_read_b64_tr_b16 a[116:117], v252 offset:26640
    ds_read_b64_tr_b16 a[118:119], v252 offset:26768
    ds_read_b64_tr_b16 a[120:121], v252 offset:28688
    ds_read_b64_tr_b16 a[122:123], v252 offset:28816
    ds_read_b64_tr_b16 a[124:125], v252 offset:30736
    ds_read_b64_tr_b16 a[126:127], v252 offset:30864
    s_waitcnt lgkmcnt(0)
    s_mov_b32 s16, s50
    s_and_b32 s17, s51, 0xffff
    s_mov_b32 s18, 0x800000
    s_mov_b32 s19, 0x00020000

    s_add_u32 m0, s98, 24576
    s_mov_b32 s5, 262144
    buffer_load_dwordx4 v241, s[16:19], s5 offen  lds

    s_add_u32 m0, s98, 25600
    s_mov_b32 s5, 294912
    buffer_load_dwordx4 v241, s[16:19], s5 offen  lds

    s_add_u32 m0, s98, 26624
    s_mov_b32 s5, 327680
    buffer_load_dwordx4 v241, s[16:19], s5 offen  lds

    s_add_u32 m0, s98, 27648
    s_mov_b32 s5, 360448
    buffer_load_dwordx4 v241, s[16:19], s5 offen  lds

    s_add_u32 m0, s98, 28672
    s_mov_b32 s5, 393216
    buffer_load_dwordx4 v241, s[16:19], s5 offen  lds

    s_add_u32 m0, s98, 29696
    s_mov_b32 s5, 425984
    buffer_load_dwordx4 v241, s[16:19], s5 offen  lds

    s_add_u32 m0, s98, 30720
    s_mov_b32 s5, 458752
    buffer_load_dwordx4 v241, s[16:19], s5 offen  lds

    s_add_u32 m0, s98, 31744
    s_mov_b32 s5, 491520
    buffer_load_dwordx4 v241, s[16:19], s5 offen  lds

    s_waitcnt vmcnt(29)
    ds_read_b64_tr_b16 a[64:65], v252 offset:16384
    ds_read_b64_tr_b16 a[66:67], v252 offset:16512
    ds_read_b64_tr_b16 a[68:69], v252 offset:18432
    ds_read_b64_tr_b16 a[70:71], v252 offset:18560
    ds_read_b64_tr_b16 a[72:73], v252 offset:20480
    ds_read_b64_tr_b16 a[74:75], v252 offset:20608
    ds_read_b64_tr_b16 a[76:77], v252 offset:22528
    ds_read_b64_tr_b16 a[78:79], v252 offset:22656
    ds_read_b64_tr_b16 a[96:97], v252 offset:16400
    ds_read_b64_tr_b16 a[98:99], v252 offset:16528
    ds_read_b64_tr_b16 a[100:101], v252 offset:18448
    ds_read_b64_tr_b16 a[102:103], v252 offset:18576
    ds_read_b64_tr_b16 a[104:105], v252 offset:20496
    ds_read_b64_tr_b16 a[106:107], v252 offset:20624
    ds_read_b64_tr_b16 a[108:109], v252 offset:22544
    ds_read_b64_tr_b16 a[110:111], v252 offset:22672
    s_waitcnt lgkmcnt(0)
    s_add_u32 m0, s98, 16384
    s_mov_b32 s5, 0
    buffer_load_dwordx4 v241, s[16:19], s5 offen  lds

    s_add_u32 m0, s98, 17408
    s_mov_b32 s5, 32768
    buffer_load_dwordx4 v241, s[16:19], s5 offen  lds

    s_add_u32 m0, s98, 18432
    s_mov_b32 s5, 65536
    buffer_load_dwordx4 v241, s[16:19], s5 offen  lds

    s_add_u32 m0, s98, 19456
    s_mov_b32 s5, 98304
    buffer_load_dwordx4 v241, s[16:19], s5 offen  lds

    s_add_u32 m0, s98, 20480
    s_mov_b32 s5, 131072
    buffer_load_dwordx4 v241, s[16:19], s5 offen  lds

    s_add_u32 m0, s98, 21504
    s_mov_b32 s5, 163840
    buffer_load_dwordx4 v241, s[16:19], s5 offen  lds

    s_add_u32 m0, s98, 22528
    s_mov_b32 s5, 196608
    buffer_load_dwordx4 v241, s[16:19], s5 offen  lds

    s_add_u32 m0, s98, 23552
    s_mov_b32 s5, 229376
    buffer_load_dwordx4 v241, s[16:19], s5 offen  lds

    v_and_b32 v241, 3, v0
    v_lshlrev_b32 v241, 2, v241
    buffer_load_dword v240, v241, s[20:23], s97 offen sc1

    s_waitcnt vmcnt(25)
    ds_read_b64_tr_b16 a[144:145], v254 offset:8192
    ds_read_b64_tr_b16 a[146:147], v254 offset:8320
    ds_read_b64_tr_b16 a[148:149], v254 offset:10240
    ds_read_b64_tr_b16 a[150:151], v254 offset:10368
    ds_read_b64_tr_b16 a[152:153], v254 offset:12288
    ds_read_b64_tr_b16 a[154:155], v254 offset:12416
    ds_read_b64_tr_b16 a[156:157], v254 offset:14336
    ds_read_b64_tr_b16 a[158:159], v254 offset:14464
    ds_read_b64_tr_b16 a[176:177], v254 offset:8224
    ds_read_b64_tr_b16 a[178:179], v254 offset:8352
    ds_read_b64_tr_b16 a[180:181], v254 offset:10272
    ds_read_b64_tr_b16 a[182:183], v254 offset:10400
    ds_read_b64_tr_b16 a[184:185], v254 offset:12320
    ds_read_b64_tr_b16 a[186:187], v254 offset:12448
    ds_read_b64_tr_b16 a[188:189], v254 offset:14368
    ds_read_b64_tr_b16 a[190:191], v254 offset:14496
    s_waitcnt vmcnt(17)
    ds_read_b64_tr_b16 a[128:129], v254 offset:0
    ds_read_b64_tr_b16 a[130:131], v254 offset:128
    ds_read_b64_tr_b16 a[132:133], v254 offset:2048
    ds_read_b64_tr_b16 a[134:135], v254 offset:2176
    ds_read_b64_tr_b16 a[136:137], v254 offset:4096
    ds_read_b64_tr_b16 a[138:139], v254 offset:4224
    ds_read_b64_tr_b16 a[140:141], v254 offset:6144
    ds_read_b64_tr_b16 a[142:143], v254 offset:6272
    ds_read_b64_tr_b16 a[160:161], v254 offset:32
    ds_read_b64_tr_b16 a[162:163], v254 offset:160
    ds_read_b64_tr_b16 a[164:165], v254 offset:2080
    ds_read_b64_tr_b16 a[166:167], v254 offset:2208
    ds_read_b64_tr_b16 a[168:169], v254 offset:4128
    ds_read_b64_tr_b16 a[170:171], v254 offset:4256
    ds_read_b64_tr_b16 a[172:173], v254 offset:6176
    ds_read_b64_tr_b16 a[174:175], v254 offset:6304
    s_waitcnt vmcnt(9)
    ds_read_b64_tr_b16 a[208:209], v255 offset:24576
    ds_read_b64_tr_b16 a[210:211], v255 offset:24704
    ds_read_b64_tr_b16 a[212:213], v255 offset:26624
    ds_read_b64_tr_b16 a[214:215], v255 offset:26752
    ds_read_b64_tr_b16 a[216:217], v255 offset:28672
    ds_read_b64_tr_b16 a[218:219], v255 offset:28800
    ds_read_b64_tr_b16 a[220:221], v255 offset:30720
    ds_read_b64_tr_b16 a[222:223], v255 offset:30848
    ds_read_b64_tr_b16 a[240:241], v255 offset:24608
    ds_read_b64_tr_b16 a[242:243], v255 offset:24736
    ds_read_b64_tr_b16 a[244:245], v255 offset:26656
    ds_read_b64_tr_b16 a[246:247], v255 offset:26784
    ds_read_b64_tr_b16 a[248:249], v255 offset:28704
    ds_read_b64_tr_b16 a[250:251], v255 offset:28832
    ds_read_b64_tr_b16 a[252:253], v255 offset:30752
    ds_read_b64_tr_b16 a[254:255], v255 offset:30880
    s_waitcnt vmcnt(1)
    ds_read_b64_tr_b16 a[192:193], v255 offset:16384
    ds_read_b64_tr_b16 a[194:195], v255 offset:16512
    ds_read_b64_tr_b16 a[196:197], v255 offset:18432
    ds_read_b64_tr_b16 a[198:199], v255 offset:18560
    ds_read_b64_tr_b16 a[200:201], v255 offset:20480
    ds_read_b64_tr_b16 a[202:203], v255 offset:20608
    ds_read_b64_tr_b16 a[204:205], v255 offset:22528
    ds_read_b64_tr_b16 a[206:207], v255 offset:22656
    ds_read_b64_tr_b16 a[224:225], v255 offset:16416
    ds_read_b64_tr_b16 a[226:227], v255 offset:16544
    ds_read_b64_tr_b16 a[228:229], v255 offset:18464
    ds_read_b64_tr_b16 a[230:231], v255 offset:18592
    ds_read_b64_tr_b16 a[232:233], v255 offset:20512
    ds_read_b64_tr_b16 a[234:235], v255 offset:20640
    ds_read_b64_tr_b16 a[236:237], v255 offset:22560
    ds_read_b64_tr_b16 a[238:239], v255 offset:22688
.pj_14:
    v_min_u32 v20, 0xfffffffe, v20
    v_min_u32 v21, 0xfffffffe, v21
    v_min_u32 v22, 0xfffffffe, v22
    v_min_u32 v23, 0xfffffffe, v23
    v_min_u32 v24, 0xfffffffe, v24
    v_min_u32 v25, 0xfffffffe, v25
    v_min_u32 v26, 0xfffffffe, v26
    v_min_u32 v27, 0xfffffffe, v27
    v_min_u32 v28, 0xfffffffe, v28
    v_min_u32 v29, 0xfffffffe, v29
    v_min_u32 v30, 0xfffffffe, v30
    v_min_u32 v31, 0xfffffffe, v31
    v_min_u32 v32, 0xfffffffe, v32
    v_min_u32 v33, 0xfffffffe, v33
    v_min_u32 v34, 0xfffffffe, v34
    v_min_u32 v35, 0xfffffffe, v35
    s_barrier
    s_cmp_ge_u32 s24, 2
    s_cbranch_scc1 .px_15
    v_xor_b32 v255, 0x10000, v255
    ds_read_b64_tr_b16 v[124:125], v255 offset:16384
    ds_read_b64_tr_b16 v[126:127], v255 offset:16512
    ds_read_b64_tr_b16 v[128:129], v255 offset:18432
    ds_read_b64_tr_b16 v[130:131], v255 offset:18560
    ds_read_b64_tr_b16 v[132:133], v255 offset:20480
    ds_read_b64_tr_b16 v[134:135], v255 offset:20608
    ds_read_b64_tr_b16 v[136:137], v255 offset:22528
    ds_read_b64_tr_b16 v[138:139], v255 offset:22656
    ds_read_b64_tr_b16 v[156:157], v255 offset:16416
    ds_read_b64_tr_b16 v[158:159], v255 offset:16544
    ds_read_b64_tr_b16 v[160:161], v255 offset:18464
    ds_read_b64_tr_b16 v[162:163], v255 offset:18592
    ds_read_b64_tr_b16 v[164:165], v255 offset:20512
    ds_read_b64_tr_b16 v[166:167], v255 offset:20640
    ds_read_b64_tr_b16 v[168:169], v255 offset:22560
    ds_read_b64_tr_b16 v[170:171], v255 offset:22688
    ds_read_b64_tr_b16 v[140:141], v255 offset:24576
    ds_read_b64_tr_b16 v[142:143], v255 offset:24704
    ds_read_b64_tr_b16 v[144:145], v255 offset:26624
    ds_read_b64_tr_b16 v[146:147], v255 offset:26752
    ds_read_b64_tr_b16 v[148:149], v255 offset:28672
    ds_read_b64_tr_b16 v[150:151], v255 offset:28800
    ds_read_b64_tr_b16 v[152:153], v255 offset:30720
    ds_read_b64_tr_b16 v[154:155], v255 offset:30848
    ds_read_b64_tr_b16 v[172:173], v255 offset:24608
    ds_read_b64_tr_b16 v[174:175], v255 offset:24736
    ds_read_b64_tr_b16 v[176:177], v255 offset:26656
    ds_read_b64_tr_b16 v[178:179], v255 offset:26784
    ds_read_b64_tr_b16 v[180:181], v255 offset:28704
    ds_read_b64_tr_b16 v[182:183], v255 offset:28832
    ds_read_b64_tr_b16 v[184:185], v255 offset:30752
    ds_read_b64_tr_b16 v[186:187], v255 offset:30880
.px_15:
    s_waitcnt vmcnt(0)
    s_mov_b32 s62, 0
.vp_18:
    v_readlane_b32 s4, v240, 0
    v_readlane_b32 s7, v240, 1
    v_readlane_b32 s6, v240, 2

    s_lshr_b32 s5, s7, 21
    s_min_u32 s4, s4, s5
    s_cmp_ge_u32 s4, 256
    s_cbranch_scc1 .vd_19
    s_cmp_lg_u32 s6, 0
    s_cbranch_scc1 .vs_20
    s_add_u32 s62, s62, 1
    s_cmp_gt_u32 s62, 0x100000
    s_cbranch_scc1 .mg_end_1
    s_sleep 8
    buffer_load_dword v240, v241, s[20:23], s97 offen sc1
    s_waitcnt vmcnt(0)
    s_branch .vp_18

.vs_20:
    s_lshr_b32 s25, s2, 5
    s_and_b32 s26, s2, 31
    s_mov_b32 s27, 1
    s_mov_b32 s99, 1
    s_mov_b32 s97, 144
    s_waitcnt vmcnt(0) lgkmcnt(0)
    s_barrier
    s_branch .mg_role_3

.vd_19:
    s_waitcnt lgkmcnt(0)
    s_barrier
    s_bfe_u32 s4, s7, 393216
    s_cmp_gt_u32 s4, 8
    s_cselect_b32 s4, 8192, 0
    s_add_u32 s4, s4, s35
    s_add_u32 s68, s4, 0

    s_bfe_u32 s4, s7, 393216
    s_cmp_gt_u32 s4, 8
    s_cselect_b32 s4, 8192, 0
    s_add_u32 s4, s4, s35
    s_add_u32 s69, s4, 1048576

    s_bfe_u32 s4, s7, 393222
    s_cmp_gt_u32 s4, 8
    s_cselect_b32 s4, 8192, 0
    s_add_u32 s4, s4, s35
    s_add_u32 s70, s4, 2097152

    s_bfe_u32 s4, s7, 393222
    s_cmp_gt_u32 s4, 8
    s_cselect_b32 s4, 8192, 0
    s_add_u32 s4, s4, s35
    s_add_u32 s71, s4, 3145728

    s_mov_b32 s62, 0x1000000
    s_cmp_ge_u32 s24, 2
    s_cbranch_scc1 .nd_21
    s_mov_b32 s62, 0
    s_mov_b64 exec, 3
.wf_22:
    buffer_load_dword v244, v253, s[8:11], s89 offen sc1
    s_waitcnt vmcnt(0)
    v_cmp_gt_u32 vcc, 1, v244
    s_cbranch_vccz .wfd_23
    s_sleep 2
    s_add_u32 s62, s62, 1
    s_cmp_gt_u32 s62, 0x400000
    s_cbranch_scc1 .mg_end_1
    s_branch .wf_22

.wfd_23:
    s_mov_b64 exec, -1
    v_readlane_b32 s4, v244, 0
    v_readlane_b32 s93, v244, 1
    s_min_u32 s93, s93, s4
    s_mov_b32 s62, 0x1000000
    s_mov_b32 m0, s90
    s_nop 0
    buffer_load_dwordx4 v14, s[8:11], s38 offen offset:0 lds
    buffer_load_dwordx4 v14, s[8:11], s38 offen offset:1024 lds
    buffer_load_dwordx4 v14, s[8:11], s38 offen offset:2048 lds
    buffer_load_dwordx4 v14, s[8:11], s38 offen offset:3072 lds
    s_mov_b32 m0, s91
    s_nop 0
    buffer_load_dwordx4 v14, s[8:11], s39 offen lds
    v_mov_b32 v4, s93
    v_mov_b32 v5, 19968
    ds_write_b32 v5, v4
    s_waitcnt vmcnt(0) lgkmcnt(0)
.nd_21:
    s_add_u32 s38, s38, 262144
    s_add_u32 s39, s39, 262144
    s_and_b32 s4, s28, 3
    s_lshl_b32 s5, s4, 16
    s_add_u32 s29, s5, s34
    s_xor_b32 s6, s5, 0x20000
    s_add_u32 s31, s6, s34
    s_add_u32 s32, s29, 16384
    s_add_u32 s33, s29, 20480
    s_mov_b64 s[14:15], 0
    s_barrier
    s_cmp_lt_u32 s24, 2
    s_cbranch_scc1 .k0_26
    ds_read_b128 v[128:131], v228 offset:0
    ds_read_b128 v[144:147], v228 offset:4096
    ds_read_b128 v[132:135], v229 offset:0
    ds_read_b128 v[148:151], v229 offset:4096
    ds_read_b128 v[136:139], v230 offset:0
    ds_read_b128 v[152:155], v230 offset:4096
    ds_read_b128 v[140:143], v231 offset:0
    ds_read_b128 v[156:159], v231 offset:4096
    ds_read_b128 v[160:163], v14 offset:28672
    ds_read_b128 v[164:167], v14 offset:29696
.k0_26:
    s_cmp_lg_u32 s27, 0
    s_cbranch_scc1 .ent1_25
    s_branch .ent0_24
.p2align 6
.top_27:
    s_barrier
    buffer_load_dwordx4 v[20:23], v8, s[8:11], s29 offen offset:0 sc1
    v_mov_b32 v52, 0
    buffer_load_dwordx4 v[24:27], v8, s[8:11], s29 offen offset:1024 sc1
    v_mov_b32 v53, 0
    buffer_load_dwordx4 v[28:31], v8, s[8:11], s29 offen offset:2048 sc1
    v_mov_b32 v54, 0
    buffer_load_dwordx4 v[32:35], v8, s[8:11], s29 offen offset:3072 sc1
.ent0_24:
    s_waitcnt vmcnt(3)
    v_max3_u32 v4, v20, v21, v22
    v_max_u32 v4, v4, v23
    v_cmp_eq_u32 vcc, -1, v4
    s_cbranch_vccnz .A_32
.W_33:
    v_smfmac_f32_16x16x64_bf16 v[52:55], v[20:23], a[0:7], v9
    v_smfmac_f32_16x16x64_bf16 v[56:59], v[20:23], a[32:39], v9
    s_waitcnt vmcnt(2)
    v_max3_u32 v4, v24, v25, v26
    v_max_u32 v4, v4, v27
    v_smfmac_f32_16x16x64_bf16 v[60:63], v[20:23], a[64:71], v9
    v_cmp_eq_u32 vcc, -1, v4
    v_smfmac_f32_16x16x64_bf16 v[64:67], v[20:23], a[96:103], v9
    s_cbranch_vccnz .A_34
.W_35:
    v_smfmac_f32_16x16x64_bf16 v[52:55], v[24:27], a[8:15], v9
    v_smfmac_f32_16x16x64_bf16 v[56:59], v[24:27], a[40:47], v9
    s_waitcnt vmcnt(1)
    v_max3_u32 v4, v28, v29, v30
    v_max_u32 v4, v4, v31
    v_smfmac_f32_16x16x64_bf16 v[60:63], v[24:27], a[72:79], v9
    v_cmp_eq_u32 vcc, -1, v4
    v_smfmac_f32_16x16x64_bf16 v[64:67], v[24:27], a[104:111], v9
    s_cbranch_vccnz .A_36
.W_37:
    v_smfmac_f32_16x16x64_bf16 v[52:55], v[28:31], a[16:23], v9
    v_smfmac_f32_16x16x64_bf16 v[56:59], v[28:31], a[48:55], v9
    s_waitcnt vmcnt(0)
    v_max3_u32 v4, v32, v33, v34
    v_max_u32 v4, v4, v35
    v_smfmac_f32_16x16x64_bf16 v[60:63], v[28:31], a[80:87], v9
    v_cmp_eq_u32 vcc, -1, v4
    v_smfmac_f32_16x16x64_bf16 v[64:67], v[28:31], a[112:119], v9
    s_cbranch_vccnz .A_38
.W_39:
    v_smfmac_f32_16x16x64_bf16 v[52:55], v[32:35], a[24:31], v9
    v_smfmac_f32_16x16x64_bf16 v[56:59], v[32:35], a[56:63], v9
    v_smfmac_f32_16x16x64_bf16 v[60:63], v[32:35], a[88:95], v9
    v_smfmac_f32_16x16x64_bf16 v[64:67], v[32:35], a[120:127], v9
.mj_31:
    v_cvt_pk_bf16_f32 v104, v52, v53
    v_cvt_pk_bf16_f32 v105, v54, v55
    v_cvt_pk_bf16_f32 v106, v56, v57
    v_cvt_pk_bf16_f32 v107, v58, v59
    ds_write_b64 v16, v[104:105] offset:4096
    v_cvt_pk_bf16_f32 v108, v60, v61
    v_cvt_pk_bf16_f32 v109, v62, v63
    ds_write_b64 v16, v[106:107] offset:6144
    ds_write_b64 v16, v[108:109] offset:0
    v_cvt_pk_bf16_f32 v110, v64, v65
    v_cvt_pk_bf16_f32 v111, v66, v67
    ds_write_b64 v16, v[110:111] offset:2048
    v_smfmac_f32_16x16x64_bf16 v[68:71], v[20:23], a[128:135], v9
    v_smfmac_f32_16x16x64_bf16 v[72:75], v[20:23], a[160:167], v9
    s_waitcnt lgkmcnt(0)
    s_barrier
    ds_read_b128 v[36:39], v17 offset:0
    ds_read_b128 v[40:43], v17 offset:1024
    v_smfmac_f32_16x16x64_bf16 v[68:71], v[24:27], a[136:143], v9
    v_smfmac_f32_16x16x64_bf16 v[72:75], v[24:27], a[168:175], v9
    s_waitcnt lgkmcnt(1)
    v_mfma_f32_16x16x32_bf16 v[44:47], v[36:39], v[84:87], 0
    s_waitcnt lgkmcnt(0)
    v_mfma_f32_16x16x32_bf16 v[44:47], v[40:43], v[84:87], v[44:47]
    v_smfmac_f32_16x16x64_bf16 v[68:71], v[28:31], a[144:151], v9
    v_smfmac_f32_16x16x64_bf16 v[72:75], v[28:31], a[176:183], v9
    s_mov_b64 exec, s[64:65]
    v_cvt_pk_bf16_f32 v48, v44, v45
    v_cvt_pk_bf16_f32 v49, v46, v47
    v_min_u32 v48, 0xfffffffe, v48
    v_min_u32 v49, 0xfffffffe, v49
    buffer_store_dwordx2 v[48:49], v10, s[8:11], s29 offen

    ds_write_b64 v18, v[48:49]
    s_mov_b64 exec, -1

    v_smfmac_f32_16x16x64_bf16 v[68:71], v[32:35], a[152:159], v9
    v_smfmac_f32_16x16x64_bf16 v[72:75], v[32:35], a[184:191], v9
    s_nop 3
    v_cvt_pk_bf16_f32 v104, v68, v69
    v_cvt_pk_bf16_f32 v105, v70, v71
    ds_write_b64 v16, v[104:105] offset:8192
    s_nop 0
    v_cvt_pk_bf16_f32 v106, v72, v73
    v_cvt_pk_bf16_f32 v107, v74, v75
    ds_write_b64 v16, v[106:107] offset:10240
    s_cmp_lg_u32 s24, 2
    s_waitcnt lgkmcnt(0)
    s_barrier
    s_cbranch_scc1 .oth_28
    buffer_load_dwordx4 v[92:95], v232, s[8:11], s29 offen sc1
    buffer_load_dwordx4 v[96:99], v233, s[8:11], s29 offen sc1
    buffer_load_dwordx4 v[100:103], v234, s[8:11], s29 offen sc1
    ds_read_b128 v[88:91], v14 offset:16384
    s_cmp_eq_u32 s28, 63
    s_cbranch_scc1 .rec_fin_6
    s_waitcnt lgkmcnt(0)
    v_mfma_f32_16x16x32_bf16 v[208:211], v[128:131], v[88:91], 0
    v_mfma_f32_16x16x32_bf16 v[212:215], v[144:147], v[88:91], 0
    v_mfma_f32_16x16x32_bf16 v[216:219], v[88:91], v[88:91], v[116:119]
    s_waitcnt vmcnt(2)
    v_max3_u32 v4, v92, v93, v94
    v_max_u32 v4, v4, v95
    v_cmp_eq_u32 vcc, -1, v4
    s_cbranch_vccnz .A_41
.W_42:
    v_mfma_f32_16x16x32_bf16 v[208:211], v[132:135], v[92:95], v[208:211]
    s_waitcnt vmcnt(1)
    v_max3_u32 v4, v96, v97, v98
    v_max_u32 v4, v4, v99
    v_mfma_f32_16x16x32_bf16 v[212:215], v[148:151], v[92:95], v[212:215]
    v_cmp_eq_u32 vcc, -1, v4
    v_mfma_f32_16x16x32_bf16 v[216:219], v[92:95], v[92:95], v[216:219]
    s_cbranch_vccnz .A_43
.W_44:
    v_mfma_f32_16x16x32_bf16 v[208:211], v[136:139], v[96:99], v[208:211]
    s_waitcnt vmcnt(0)
    v_max3_u32 v4, v100, v101, v102
    v_max_u32 v4, v4, v103
    v_mfma_f32_16x16x32_bf16 v[212:215], v[152:155], v[96:99], v[212:215]
    v_cmp_eq_u32 vcc, -1, v4
    v_mfma_f32_16x16x32_bf16 v[216:219], v[96:99], v[96:99], v[216:219]
    s_cbranch_vccnz .A_45
.W_46:
    v_mfma_f32_16x16x32_bf16 v[208:211], v[140:143], v[100:103], v[208:211]
    v_mfma_f32_16x16x32_bf16 v[212:215], v[156:159], v[100:103], v[212:215]
    v_mfma_f32_16x16x32_bf16 v[216:219], v[100:103], v[100:103], v[216:219]
.mj_40:
    s_barrier
    ds_read_b64 v[168:169], v14 offset:18432
    ds_read_b64 v[172:173], v14 offset:18440
    s_nop 0

    v_mov_b32_dpp v208, v212 row_ror:8 row_mask:0xf bank_mask:0xc
    v_mov_b32_dpp v209, v213 row_ror:8 row_mask:0xf bank_mask:0xc
    v_mov_b32_dpp v210, v214 row_ror:8 row_mask:0xf bank_mask:0xc
    v_mov_b32_dpp v211, v215 row_ror:8 row_mask:0xf bank_mask:0xc
    v_mov_b32_dpp v216, v218 row_ror:8 row_mask:0xf bank_mask:0xc
    v_mov_b32_dpp v217, v219 row_ror:8 row_mask:0xf bank_mask:0xc
    v_max3_f32 v4, v208, v209, v210
    v_max3_f32 v5, v211, v216, v217
    v_max_f32 v6, v4, v5
    v_max_f32 v4, v4, v5
    s_nop 1
    v_permlane32_swap_b32 v4, v6
    v_max_f32 v5, v4, v6
    v_max_f32 v4, v4, v6
    s_nop 1
    v_permlane16_swap_b32 v4, v5
    v_max_f32 v4, v4, v5
    s_nop 1
    v_max_f32_dpp v4, v4, v4 row_ror:8 row_mask:0xf bank_mask:0xf
    v_mul_f32 v4, s37, v4

    v_fma_f32 v104, v208, s37, -v4
    v_fma_f32 v105, v209, s37, -v4
    v_fma_f32 v106, v210, s37, -v4
    v_fma_f32 v107, v211, s37, -v4
    v_fma_f32 v108, v216, s37, -v4
    v_fma_f32 v109, v217, s37, -v4
    v_exp_f32 v104, v104
    v_exp_f32 v105, v105
    v_exp_f32 v106, v106
    v_exp_f32 v107, v107
    v_exp_f32 v108, v108
    v_exp_f32 v109, v109
    v_cvt_pk_bf16_f32 v176, v104, v105
    v_cvt_pk_bf16_f32 v177, v106, v107
    v_cvt_pk_bf16_f32 v180, v108, v109
    v_mov_b32_dpp v178, v176 row_ror:8 row_mask:0xf bank_mask:0xf
    v_mov_b32_dpp v179, v177 row_ror:8 row_mask:0xf bank_mask:0xf
    v_mov_b32_dpp v181, v180 row_ror:8 row_mask:0xf bank_mask:0xf
    s_waitcnt lgkmcnt(0)

    v_mfma_f32_16x16x32_bf16 v[208:211], v[120:123], v[176:179], 0
    v_mfma_f32_16x16x32_bf16 v[208:211], v[120:123], v[180:183], v[208:211]
    v_mfma_f32_16x16x32_bf16 v[212:215], v[160:163], v[176:179], 0
    v_mfma_f32_16x16x32_bf16 v[216:219], v[164:167], v[176:179], 0
    v_mfma_f32_16x16x32_bf16 v[212:215], v[168:171], v[180:183], v[212:215]
    v_rcp_f32 v4, v208
    v_mfma_f32_16x16x32_bf16 v[216:219], v[172:175], v[180:183], v[216:219]
    s_mov_b64 exec, s[58:59]
    s_nop 2
    v_mul_f32 v212, v4, v212
    v_mul_f32 v213, v4, v213
    v_mul_f32 v214, v4, v214
    v_mul_f32 v215, v4, v215
    v_cvt_pk_bf16_f32 v184, v212, v213
    v_cvt_pk_bf16_f32 v185, v214, v215
    v_mul_f32 v216, v4, v216
    v_mul_f32 v217, v4, v217
    v_min_u32 v184, 0xfffffffe, v184
    v_min_u32 v185, 0xfffffffe, v185
    v_mul_f32 v218, v4, v218
    v_mul_f32 v219, v4, v219
    v_cvt_pk_bf16_f32 v186, v216, v217
    v_cvt_pk_bf16_f32 v187, v218, v219
    v_min_u32 v186, 0xfffffffe, v186
    v_min_u32 v187, 0xfffffffe, v187
    buffer_store_dwordx4 v[184:187], v13, s[8:11], s29 offen
    s_mov_b64 exec, -1

.gp_30:
    s_barrier
    v_mov_b32 v5, 19968
    ds_read_b32 v4, v5
    s_mov_b32 s99, s68
    s_waitcnt vmcnt(0)
    s_cmp_eq_u32 s24, 3
    s_cbranch_scc1 .u3_47
    s_add_u32 s6, s28, 3
    s_add_u32 s7, s30, 262144
    s_waitcnt lgkmcnt(0)
    v_readfirstlane_b32 s5, v4
    s_cmp_lt_u32 s5, s6
    s_barrier
    s_cbranch_scc1 .np_49
    buffer_load_dword v226, v225, s[8:11], s7 offen

.np_49:
    s_add_u32 s4, s70, 0
    buffer_store_dwordx4 v[188:191], v238, s[8:11], s4 offen sc1
    s_add_u32 s4, s70, 262144
    buffer_store_dwordx4 v[188:191], v238, s[8:11], s4 offen sc1
    s_branch .u4_48
.u3_47:
    s_sub_u32 s4, s36, 0
    s_barrier
    s_mov_b64 exec, s[66:67]
    buffer_store_dwordx4 v[88:91], v11, s[8:11], s4 offen sc1
    s_mov_b64 exec, s[56:57]
    buffer_store_dwordx4 v[172:175], v12, s[8:11], s4 offen sc1
    s_mov_b64 exec, -1

.u4_48:
    s_barrier
    s_add_u32 s28, s28, 1
    s_add_u32 s36, s36, 196608
    s_cmp_lt_u32 s28, 63
    s_cselect_b32 s4, 262144, 0
    s_add_u32 s38, s38, s4
    s_add_u32 s39, s39, s4
    s_add_u32 s30, s30, s4
    s_mov_b32 s4, s68
    s_mov_b32 s68, s69
    s_mov_b32 s69, s70
    s_mov_b32 s70, s71
    s_mov_b32 s71, s4
    s_and_b32 s4, s28, 3
    s_lshl_b32 s5, s4, 16
    s_add_u32 s29, s5, s34
    s_xor_b32 s6, s5, 0x20000
    s_add_u32 s31, s6, s34
    s_add_u32 s32, s29, 16384
    s_add_u32 s33, s29, 20480
    v_mov_b32 v55, 0
    v_mov_b32 v56, 0
    v_mov_b32 v57, 0
    v_mov_b32 v58, 0
    v_mov_b32 v59, 0
    v_mov_b32 v60, 0
    v_mov_b32 v61, 0
    v_mov_b32 v62, 0
    v_mov_b32 v63, 0
    v_mov_b32 v64, 0
    v_mov_b32 v65, 0
    v_mov_b32 v66, 0
    v_mov_b32 v67, 0
    v_mov_b32 v68, 0
    v_mov_b32 v69, 0
    v_mov_b32 v70, 0
    v_mov_b32 v71, 0
    v_mov_b32 v72, 0
    v_mov_b32 v73, 0
    v_mov_b32 v74, 0
    v_mov_b32 v75, 0
    v_mov_b32 v20, -1
    v_mov_b32 v21, -1
    v_mov_b32 v22, -1
    v_mov_b32 v23, -1
    v_mov_b32 v24, -1
    v_mov_b32 v25, -1
    v_mov_b32 v26, -1
    v_mov_b32 v27, -1
    v_mov_b32 v28, -1
    v_mov_b32 v29, -1
    v_mov_b32 v30, -1
    v_mov_b32 v31, -1
    v_mov_b32 v32, -1
    v_mov_b32 v33, -1
    v_mov_b32 v34, -1
    v_mov_b32 v35, -1
    v_mov_b32 v92, -1
    v_mov_b32 v93, -1
    v_mov_b32 v94, -1
    v_mov_b32 v95, -1
    v_mov_b32 v96, -1
    v_mov_b32 v97, -1
    v_mov_b32 v98, -1
    v_mov_b32 v99, -1
    v_mov_b32 v100, -1
    v_mov_b32 v101, -1
    v_mov_b32 v102, -1
    v_mov_b32 v103, -1
    s_add_u32 s4, s99, 0
    buffer_load_dwordx4 v[192:195], v239, s[8:11], s4 offen sc1
    buffer_load_dwordx4 v[196:199], v249, s[8:11], s4 offen sc1

    ds_read_b128 v[128:131], v228 offset:0
    ds_read_b128 v[144:147], v228 offset:4096
    ds_read_b128 v[132:135], v229 offset:0
    ds_read_b128 v[148:151], v229 offset:4096
    ds_read_b128 v[136:139], v230 offset:0
    ds_read_b128 v[152:155], v230 offset:4096
    ds_read_b128 v[140:143], v231 offset:0
    ds_read_b128 v[156:159], v231 offset:4096
    ds_read_b128 v[160:163], v14 offset:28672
    ds_read_b128 v[164:167], v14 offset:29696
    ds_read_b128 v[108:111], v248
    s_waitcnt lgkmcnt(0)
    v_mfma_f32_16x16x32_bf16 v[76:79], v[108:111], v[112:115], 0
    s_add_u32 s4, s99, 262144
    buffer_load_dwordx4 v[200:203], v239, s[8:11], s4 offen sc1
    buffer_load_dwordx4 v[204:207], v249, s[8:11], s4 offen sc1

.gc_50:
    s_waitcnt vmcnt(2)

    v_max_u32 v4, v192, v196
    v_cmp_eq_u32 vcc, -1, v4
    s_cbranch_vccnz .gf_51
    v_mfma_f32_16x16x32_bf16 v[76:79], v[192:195], v[84:87], v[76:79]
    v_mfma_f32_16x16x32_bf16 v[76:79], v[196:199], v[112:115], v[76:79]
    s_mov_b64 exec, s[58:59]
    s_nop 6
    v_cvt_pk_bf16_f32 v104, v76, v77
    v_cvt_pk_bf16_f32 v105, v78, v79
    v_min_u32 v104, 0xfffffffe, v104
    v_min_u32 v105, 0xfffffffe, v105
    buffer_store_dwordx2 v[104:105], v15, s[8:11], s29 offen
    s_mov_b64 exec, -1

    s_branch .top_27
.gf_51:
    s_add_u32 s4, s99, 0
    buffer_load_dwordx4 v[192:195], v239, s[8:11], s4 offen sc1
    buffer_load_dwordx4 v[196:199], v249, s[8:11], s4 offen sc1

    s_waitcnt vmcnt(2)

    v_max_u32 v4, v200, v204
    v_cmp_eq_u32 vcc, -1, v4
    s_cbranch_vccnz .gf_52
    v_mfma_f32_16x16x32_bf16 v[76:79], v[200:203], v[84:87], v[76:79]
    v_mfma_f32_16x16x32_bf16 v[76:79], v[204:207], v[112:115], v[76:79]
    s_mov_b64 exec, s[58:59]
    s_nop 6
    v_cvt_pk_bf16_f32 v104, v76, v77
    v_cvt_pk_bf16_f32 v105, v78, v79
    v_min_u32 v104, 0xfffffffe, v104
    v_min_u32 v105, 0xfffffffe, v105
    buffer_store_dwordx2 v[104:105], v15, s[8:11], s29 offen
    s_mov_b64 exec, -1

    s_branch .top_27
.gf_52:
    s_add_u32 s4, s99, 262144
    buffer_load_dwordx4 v[200:203], v239, s[8:11], s4 offen sc1
    buffer_load_dwordx4 v[204:207], v249, s[8:11], s4 offen sc1

    s_sub_u32 s62, s62, 1
    s_cbranch_scc1 .mg_end_1
    s_branch .gc_50
.oth_28:
    s_cmp_eq_u32 s24, 3
    s_cbranch_scc1 .w3_29
    s_cmp_eq_u32 s28, 63
    s_cbranch_scc1 .rec_fin_6
    s_add_u32 s6, s28, 4
    s_cmp_ge_u32 s93, s6
    s_cbranch_scc1 .nl_53
    s_buffer_load_dword s14, s[8:11], s89 glc
    s_buffer_load_dword s15, s[8:11], s89 offset:8192 glc

.nl_53:
    s_waitcnt vmcnt(0)
    v_mov_b32 v20, -1
    v_mov_b32 v21, -1
    v_mov_b32 v22, -1
    v_mov_b32 v23, -1
    v_mov_b32 v24, -1
    v_mov_b32 v25, -1
    v_mov_b32 v26, -1
    v_mov_b32 v27, -1
    v_mov_b32 v28, -1
    v_mov_b32 v29, -1
    v_mov_b32 v30, -1
    v_mov_b32 v31, -1
    v_mov_b32 v32, -1
    v_mov_b32 v33, -1
    v_mov_b32 v34, -1
    v_mov_b32 v35, -1
    v_mov_b32 v55, 0
    v_mov_b32 v56, 0
    v_mov_b32 v57, 0
    v_mov_b32 v58, 0
    v_mov_b32 v59, 0
    v_mov_b32 v60, 0
    v_mov_b32 v61, 0
    v_mov_b32 v62, 0
    v_mov_b32 v63, 0
    v_mov_b32 v64, 0
    v_mov_b32 v65, 0
    v_mov_b32 v66, 0
    v_mov_b32 v67, 0
    v_mov_b32 v68, 0
    v_mov_b32 v69, 0
    v_mov_b32 v70, 0
    v_mov_b32 v71, 0
    v_mov_b32 v72, 0
    v_mov_b32 v73, 0
    v_mov_b32 v74, 0
    v_mov_b32 v75, 0
    s_barrier
    s_add_u32 s6, s28, 2
    s_min_u32 s6, s6, 64
    s_cmp_lt_u32 s93, s6
    s_cbranch_scc1 .kf_54
.kb_55:
    s_mov_b32 m0, s90
    s_nop 0
    buffer_load_dwordx4 v14, s[8:11], s38 offen offset:0 lds
    buffer_load_dwordx4 v14, s[8:11], s38 offen offset:1024 lds
    buffer_load_dwordx4 v14, s[8:11], s38 offen offset:2048 lds
    buffer_load_dwordx4 v14, s[8:11], s38 offen offset:3072 lds
    s_mov_b32 m0, s91
    s_nop 0
    buffer_load_dwordx4 v14, s[8:11], s39 offen lds
    s_barrier
    buffer_load_dwordx4 v[192:195], v246, s[8:11], s32 offen offset:0 sc1
    buffer_load_dwordx4 v[196:199], v246, s[8:11], s32 offen offset:1024 sc1
    v_mov_b32 v76, 0
    buffer_load_dwordx4 v[200:203], v246, s[8:11], s32 offen offset:2048 sc1
    buffer_load_dwordx4 v[204:207], v246, s[8:11], s32 offen offset:3072 sc1
    v_mov_b32 v77, 0
    buffer_load_dwordx4 v[208:211], v246, s[8:11], s33 offen offset:0 sc1
    buffer_load_dwordx4 v[212:215], v246, s[8:11], s33 offen offset:1024 sc1
    v_mov_b32 v78, 0
    buffer_load_dwordx4 v[216:219], v246, s[8:11], s33 offen offset:2048 sc1
    buffer_load_dwordx4 v[220:223], v246, s[8:11], s33 offen offset:3072 sc1
    s_waitcnt vmcnt(6)
    v_max3_u32 v4, v192, v193, v194
    v_max3_u32 v5, v195, v196, v197
    v_max3_u32 v4, v4, v198, v199
    v_max_u32 v4, v4, v5
    v_cmp_eq_u32 vcc, -1, v4
    s_cbranch_vccnz .A_57
.W_58:
    v_smfmac_f32_16x16x64_bf16 v[76:79], v[192:195], a[192:199], v9
    v_smfmac_f32_16x16x64_bf16 v[80:83], v[192:195], a[224:231], v9
    s_waitcnt vmcnt(4)
    v_max3_u32 v4, v200, v201, v202
    v_max3_u32 v5, v203, v204, v205
    v_max3_u32 v4, v4, v206, v207
    v_smfmac_f32_16x16x64_bf16 v[76:79], v[196:199], a[200:207], v9
    v_max_u32 v4, v4, v5
    v_cmp_eq_u32 vcc, -1, v4
    v_smfmac_f32_16x16x64_bf16 v[80:83], v[196:199], a[232:239], v9
    s_cbranch_vccnz .A_59
.W_60:
    v_smfmac_f32_16x16x64_bf16 v[76:79], v[200:203], a[208:215], v9
    v_smfmac_f32_16x16x64_bf16 v[80:83], v[200:203], a[240:247], v9
    s_waitcnt vmcnt(2)
    v_max3_u32 v4, v208, v209, v210
    v_max3_u32 v5, v211, v212, v213
    v_max3_u32 v4, v4, v214, v215
    v_smfmac_f32_16x16x64_bf16 v[76:79], v[204:207], a[216:223], v9
    v_max_u32 v4, v4, v5
    v_cmp_eq_u32 vcc, -1, v4
    v_smfmac_f32_16x16x64_bf16 v[80:83], v[204:207], a[248:255], v9
    s_cbranch_vccnz .A_61
.W_62:
    v_smfmac_f32_16x16x64_bf16 v[76:79], v[208:211], v[124:131], v9
    v_smfmac_f32_16x16x64_bf16 v[80:83], v[208:211], v[156:163], v9
    s_waitcnt vmcnt(0)
    v_max3_u32 v4, v216, v217, v218
    v_max3_u32 v5, v219, v220, v221
    v_max3_u32 v4, v4, v222, v223
    v_smfmac_f32_16x16x64_bf16 v[76:79], v[212:215], v[132:139], v9
    v_max_u32 v4, v4, v5
    v_cmp_eq_u32 vcc, -1, v4
    v_smfmac_f32_16x16x64_bf16 v[80:83], v[212:215], v[164:171], v9
    s_cbranch_vccnz .A_63
.W_64:
    v_smfmac_f32_16x16x64_bf16 v[76:79], v[216:219], v[140:147], v9
    v_smfmac_f32_16x16x64_bf16 v[80:83], v[216:219], v[172:179], v9
    v_smfmac_f32_16x16x64_bf16 v[76:79], v[220:223], v[148:155], v9
    v_smfmac_f32_16x16x64_bf16 v[80:83], v[220:223], v[180:187], v9
.mj_56:
    s_barrier
    s_nop 7
    v_permlane32_swap_b32 v76, v80
    v_permlane32_swap_b32 v77, v81
    v_permlane32_swap_b32 v78, v82
    v_permlane32_swap_b32 v79, v83
    v_add_f32 v76, v76, v80
    v_add_f32 v77, v77, v81
    v_add_f32 v78, v78, v82
    v_add_f32 v79, v79, v83
    v_cvt_pk_bf16_f32 v104, v76, v77
    v_cvt_pk_bf16_f32 v106, v76, v77
    v_cvt_pk_bf16_f32 v105, v78, v79
    v_cvt_pk_bf16_f32 v107, v78, v79
    v_permlane16_swap_b32 v104, v106
    s_nop 0
    v_permlane16_swap_b32 v105, v107
    v_min_u32 v104, 0xfffffffe, v104
    buffer_store_dwordx4 v[104:107], v237, s[8:11], s68 offen sc1

    ds_write_b128 v247, v[104:107]
    s_waitcnt lgkmcnt(0)
    s_barrier
    s_min_u32 s4, s14, s15
    s_max_u32 s93, s93, s4
    v_mov_b32 v4, s93
    v_mov_b32 v5, 19968
    ds_write_b32 v5, v4
    v_mov_b32 v79, 0
    v_mov_b32 v80, 0
    v_mov_b32 v81, 0
    v_mov_b32 v82, 0
    v_mov_b32 v83, 0
    s_waitcnt vmcnt(1)
    v_mov_b32 v192, -1
    v_mov_b32 v193, -1
    v_mov_b32 v194, -1
    v_mov_b32 v195, -1
    v_mov_b32 v196, -1
    v_mov_b32 v197, -1
    v_mov_b32 v198, -1
    v_mov_b32 v199, -1
    v_mov_b32 v200, -1
    v_mov_b32 v201, -1
    v_mov_b32 v202, -1
    v_mov_b32 v203, -1
    v_mov_b32 v204, -1
    v_mov_b32 v205, -1
    v_mov_b32 v206, -1
    v_mov_b32 v207, -1
    v_mov_b32 v208, -1
    v_mov_b32 v209, -1
    v_mov_b32 v210, -1
    v_mov_b32 v211, -1
    v_mov_b32 v212, -1
    v_mov_b32 v213, -1
    v_mov_b32 v214, -1
    v_mov_b32 v215, -1
    v_mov_b32 v216, -1
    v_mov_b32 v217, -1
    v_mov_b32 v218, -1
    v_mov_b32 v219, -1
    v_mov_b32 v220, -1
    v_mov_b32 v221, -1
    v_mov_b32 v222, -1
    v_mov_b32 v223, -1
    s_add_u32 s28, s28, 1
    s_add_u32 s36, s36, 196608
    s_cmp_lt_u32 s28, 63
    s_cselect_b32 s4, 262144, 0
    s_add_u32 s38, s38, s4
    s_add_u32 s39, s39, s4
    s_add_u32 s30, s30, s4
    s_mov_b32 s4, s68
    s_mov_b32 s68, s69
    s_mov_b32 s69, s70
    s_mov_b32 s70, s71
    s_mov_b32 s71, s4
    s_and_b32 s4, s28, 3
    s_lshl_b32 s5, s4, 16
    s_add_u32 s29, s5, s34
    s_xor_b32 s6, s5, 0x20000
    s_add_u32 s31, s6, s34
    s_add_u32 s32, s29, 16384
    s_add_u32 s33, s29, 20480
    s_branch .top_27
.w3_29:
    ds_read_b128 v[36:39], v14 offset:8192
    ds_read_b128 v[40:43], v14 offset:9216
    ds_read_b128 v[44:47], v14 offset:10240
    ds_read_b128 v[48:51], v14 offset:11264
    ds_read_b128 v[88:91], v14 offset:16384
    s_waitcnt lgkmcnt(0)
    v_mfma_f32_16x16x32_bf16 v[104:107], v[84:87], v[36:39], 0
    v_mfma_f32_16x16x32_bf16 v[108:111], v[84:87], v[44:47], 0
    v_mfma_f32_16x16x32_bf16 v[104:107], v[84:87], v[40:43], v[104:107]
    v_mfma_f32_16x16x32_bf16 v[108:111], v[84:87], v[48:51], v[108:111]
    s_nop 7
    v_cvt_pk_bf16_f32 v168, v104, v105
    v_cvt_pk_bf16_f32 v169, v106, v107
    v_cvt_pk_bf16_f32 v170, v108, v109
    v_cvt_pk_bf16_f32 v171, v110, v111
    ds_write_b128 v14, v[168:171] offset:18432
    v_cndmask_b32 v172, v170, v168, s[60:61]
    v_cndmask_b32 v173, v171, v169, s[60:61]
    v_min_u32 v172, 0xfffffffe, v172
    v_min_u32 v173, 0xfffffffe, v173
    v_mov_b32 v174, v172
    v_mov_b32 v175, v173
    s_cmp_eq_u32 s28, 63
    s_nop 0
    v_permlane16_swap_b32 v172, v174
    v_permlane16_swap_b32 v173, v175
    ds_write_b128 v14, v[172:175] offset:17408

    s_cbranch_scc1 .sk_65
    s_waitcnt lgkmcnt(0)
    s_barrier
    buffer_store_dwordx4 v[188:191], v235, s[8:11], s31 offen
    buffer_store_dwordx4 v[188:191], v236, s[8:11], s31 offen

    s_branch .gp_30
.A_66:
    buffer_load_dwordx4 v[32:35], v8, s[8:11], s29 offen offset:3072 sc1
    s_sub_u32 s62, s62, 1
    s_cbranch_scc1 .mg_end_1
    s_waitcnt vmcnt(3)
    v_max3_u32 v4, v20, v21, v22
    v_max_u32 v4, v4, v23
    v_cmp_eq_u32 vcc, -1, v4
    s_cbranch_vccz .W_33
.A_32:
    buffer_load_dwordx4 v[20:23], v8, s[8:11], s29 offen offset:0 sc1
    s_waitcnt vmcnt(3)
    v_max3_u32 v4, v24, v25, v26
    v_max_u32 v4, v4, v27
    v_cmp_eq_u32 vcc, -1, v4
    s_cbranch_vccz .W_67
.A_68:
    buffer_load_dwordx4 v[24:27], v8, s[8:11], s29 offen offset:1024 sc1
    s_waitcnt vmcnt(3)
    v_max3_u32 v4, v28, v29, v30
    v_max_u32 v4, v4, v31
    v_cmp_eq_u32 vcc, -1, v4
    s_cbranch_vccz .W_69
.A_70:
    buffer_load_dwordx4 v[28:31], v8, s[8:11], s29 offen offset:2048 sc1
    s_waitcnt vmcnt(3)
    v_max3_u32 v4, v32, v33, v34
    v_max_u32 v4, v4, v35
    v_cmp_eq_u32 vcc, -1, v4
    s_cbranch_vccnz .A_66
.W_71:
    v_smfmac_f32_16x16x64_bf16 v[52:55], v[32:35], a[24:31], v9
    v_smfmac_f32_16x16x64_bf16 v[56:59], v[32:35], a[56:63], v9
    s_waitcnt vmcnt(2)
    v_max3_u32 v4, v20, v21, v22
    v_max_u32 v4, v4, v23
    v_smfmac_f32_16x16x64_bf16 v[60:63], v[32:35], a[88:95], v9
    v_cmp_eq_u32 vcc, -1, v4
    v_smfmac_f32_16x16x64_bf16 v[64:67], v[32:35], a[120:127], v9
    s_cbranch_vccnz .A_72
.W_73:
    v_smfmac_f32_16x16x64_bf16 v[52:55], v[20:23], a[0:7], v9
    v_smfmac_f32_16x16x64_bf16 v[56:59], v[20:23], a[32:39], v9
    s_waitcnt vmcnt(1)
    v_max3_u32 v4, v24, v25, v26
    v_max_u32 v4, v4, v27
    v_smfmac_f32_16x16x64_bf16 v[60:63], v[20:23], a[64:71], v9
    v_cmp_eq_u32 vcc, -1, v4
    v_smfmac_f32_16x16x64_bf16 v[64:67], v[20:23], a[96:103], v9
    s_cbranch_vccnz .A_74
.W_75:
    v_smfmac_f32_16x16x64_bf16 v[52:55], v[24:27], a[8:15], v9
    v_smfmac_f32_16x16x64_bf16 v[56:59], v[24:27], a[40:47], v9
    s_waitcnt vmcnt(0)
    v_max3_u32 v4, v28, v29, v30
    v_max_u32 v4, v4, v31
    v_smfmac_f32_16x16x64_bf16 v[60:63], v[24:27], a[72:79], v9
    v_cmp_eq_u32 vcc, -1, v4
    v_smfmac_f32_16x16x64_bf16 v[64:67], v[24:27], a[104:111], v9
    s_cbranch_vccnz .A_76
.W_77:
    v_smfmac_f32_16x16x64_bf16 v[52:55], v[28:31], a[16:23], v9
    v_smfmac_f32_16x16x64_bf16 v[56:59], v[28:31], a[48:55], v9
    v_smfmac_f32_16x16x64_bf16 v[60:63], v[28:31], a[80:87], v9
    v_smfmac_f32_16x16x64_bf16 v[64:67], v[28:31], a[112:119], v9
    s_branch .mj_31
.W_67:
    v_smfmac_f32_16x16x64_bf16 v[52:55], v[24:27], a[8:15], v9
    v_smfmac_f32_16x16x64_bf16 v[56:59], v[24:27], a[40:47], v9
    s_waitcnt vmcnt(2)
    v_max3_u32 v4, v28, v29, v30
    v_max_u32 v4, v4, v31
    v_smfmac_f32_16x16x64_bf16 v[60:63], v[24:27], a[72:79], v9
    v_cmp_eq_u32 vcc, -1, v4
    v_smfmac_f32_16x16x64_bf16 v[64:67], v[24:27], a[104:111], v9
    s_cbranch_vccnz .A_78
.W_79:
    v_smfmac_f32_16x16x64_bf16 v[52:55], v[28:31], a[16:23], v9
    v_smfmac_f32_16x16x64_bf16 v[56:59], v[28:31], a[48:55], v9
    s_waitcnt vmcnt(1)
    v_max3_u32 v4, v32, v33, v34
    v_max_u32 v4, v4, v35
    v_smfmac_f32_16x16x64_bf16 v[60:63], v[28:31], a[80:87], v9
    v_cmp_eq_u32 vcc, -1, v4
    v_smfmac_f32_16x16x64_bf16 v[64:67], v[28:31], a[112:119], v9
    s_cbranch_vccnz .A_80
.W_81:
    v_smfmac_f32_16x16x64_bf16 v[52:55], v[32:35], a[24:31], v9
    v_smfmac_f32_16x16x64_bf16 v[56:59], v[32:35], a[56:63], v9
    s_waitcnt vmcnt(0)
    v_max3_u32 v4, v20, v21, v22
    v_max_u32 v4, v4, v23
    v_smfmac_f32_16x16x64_bf16 v[60:63], v[32:35], a[88:95], v9
    v_cmp_eq_u32 vcc, -1, v4
    v_smfmac_f32_16x16x64_bf16 v[64:67], v[32:35], a[120:127], v9
    s_cbranch_vccnz .A_82
.W_83:
    v_smfmac_f32_16x16x64_bf16 v[52:55], v[20:23], a[0:7], v9
    v_smfmac_f32_16x16x64_bf16 v[56:59], v[20:23], a[32:39], v9
    v_smfmac_f32_16x16x64_bf16 v[60:63], v[20:23], a[64:71], v9
    v_smfmac_f32_16x16x64_bf16 v[64:67], v[20:23], a[96:103], v9
    s_branch .mj_31
.W_69:
    v_smfmac_f32_16x16x64_bf16 v[52:55], v[28:31], a[16:23], v9
    v_smfmac_f32_16x16x64_bf16 v[56:59], v[28:31], a[48:55], v9
    s_waitcnt vmcnt(2)
    v_max3_u32 v4, v32, v33, v34
    v_max_u32 v4, v4, v35
    v_smfmac_f32_16x16x64_bf16 v[60:63], v[28:31], a[80:87], v9
    v_cmp_eq_u32 vcc, -1, v4
    v_smfmac_f32_16x16x64_bf16 v[64:67], v[28:31], a[112:119], v9
    s_cbranch_vccnz .A_84
.W_85:
    v_smfmac_f32_16x16x64_bf16 v[52:55], v[32:35], a[24:31], v9
    v_smfmac_f32_16x16x64_bf16 v[56:59], v[32:35], a[56:63], v9
    s_waitcnt vmcnt(1)
    v_max3_u32 v4, v20, v21, v22
    v_max_u32 v4, v4, v23
    v_smfmac_f32_16x16x64_bf16 v[60:63], v[32:35], a[88:95], v9
    v_cmp_eq_u32 vcc, -1, v4
    v_smfmac_f32_16x16x64_bf16 v[64:67], v[32:35], a[120:127], v9
    s_cbranch_vccnz .A_86
.W_87:
    v_smfmac_f32_16x16x64_bf16 v[52:55], v[20:23], a[0:7], v9
    v_smfmac_f32_16x16x64_bf16 v[56:59], v[20:23], a[32:39], v9
    s_waitcnt vmcnt(0)
    v_max3_u32 v4, v24, v25, v26
    v_max_u32 v4, v4, v27
    v_smfmac_f32_16x16x64_bf16 v[60:63], v[20:23], a[64:71], v9
    v_cmp_eq_u32 vcc, -1, v4
    v_smfmac_f32_16x16x64_bf16 v[64:67], v[20:23], a[96:103], v9
    s_cbranch_vccnz .A_88
.W_89:
    v_smfmac_f32_16x16x64_bf16 v[52:55], v[24:27], a[8:15], v9
    v_smfmac_f32_16x16x64_bf16 v[56:59], v[24:27], a[40:47], v9
    v_smfmac_f32_16x16x64_bf16 v[60:63], v[24:27], a[72:79], v9
    v_smfmac_f32_16x16x64_bf16 v[64:67], v[24:27], a[104:111], v9
    s_branch .mj_31
.A_90:
    buffer_load_dwordx4 v[28:31], v8, s[8:11], s29 offen offset:2048 sc1
    s_sub_u32 s62, s62, 1
    s_cbranch_scc1 .mg_end_1
    s_waitcnt vmcnt(2)
    v_max3_u32 v4, v20, v21, v22
    v_max_u32 v4, v4, v23
    v_cmp_eq_u32 vcc, -1, v4
    s_cbranch_vccz .W_73
.A_72:
    buffer_load_dwordx4 v[20:23], v8, s[8:11], s29 offen offset:0 sc1
    s_waitcnt vmcnt(2)
    v_max3_u32 v4, v24, v25, v26
    v_max_u32 v4, v4, v27
    v_cmp_eq_u32 vcc, -1, v4
    s_cbranch_vccz .W_91
.A_92:
    buffer_load_dwordx4 v[24:27], v8, s[8:11], s29 offen offset:1024 sc1
    s_waitcnt vmcnt(2)
    v_max3_u32 v4, v28, v29, v30
    v_max_u32 v4, v4, v31
    v_cmp_eq_u32 vcc, -1, v4
    s_cbranch_vccnz .A_90
.W_93:
    v_smfmac_f32_16x16x64_bf16 v[52:55], v[28:31], a[16:23], v9
    v_smfmac_f32_16x16x64_bf16 v[56:59], v[28:31], a[48:55], v9
    s_waitcnt vmcnt(1)
    v_max3_u32 v4, v20, v21, v22
    v_max_u32 v4, v4, v23
    v_smfmac_f32_16x16x64_bf16 v[60:63], v[28:31], a[80:87], v9
    v_cmp_eq_u32 vcc, -1, v4
    v_smfmac_f32_16x16x64_bf16 v[64:67], v[28:31], a[112:119], v9
    s_cbranch_vccz .W_87
    s_branch .A_86
.W_91:
    v_smfmac_f32_16x16x64_bf16 v[52:55], v[24:27], a[8:15], v9
    v_smfmac_f32_16x16x64_bf16 v[56:59], v[24:27], a[40:47], v9
    s_waitcnt vmcnt(1)
    v_max3_u32 v4, v28, v29, v30
    v_max_u32 v4, v4, v31
    v_smfmac_f32_16x16x64_bf16 v[60:63], v[24:27], a[72:79], v9
    v_cmp_eq_u32 vcc, -1, v4
    v_smfmac_f32_16x16x64_bf16 v[64:67], v[24:27], a[104:111], v9
    s_cbranch_vccnz .A_94
.W_95:
    v_smfmac_f32_16x16x64_bf16 v[52:55], v[28:31], a[16:23], v9
    v_smfmac_f32_16x16x64_bf16 v[56:59], v[28:31], a[48:55], v9
    s_waitcnt vmcnt(0)
    v_max3_u32 v4, v20, v21, v22
    v_max_u32 v4, v4, v23
    v_smfmac_f32_16x16x64_bf16 v[60:63], v[28:31], a[80:87], v9
    v_cmp_eq_u32 vcc, -1, v4
    v_smfmac_f32_16x16x64_bf16 v[64:67], v[28:31], a[112:119], v9
    s_cbranch_vccz .W_83
    s_branch .A_82
.A_96:
    buffer_load_dwordx4 v[24:27], v8, s[8:11], s29 offen offset:1024 sc1
    s_sub_u32 s62, s62, 1
    s_cbranch_scc1 .mg_end_1
    s_waitcnt vmcnt(2)
    v_max3_u32 v4, v32, v33, v34
    v_max_u32 v4, v4, v35
    v_cmp_eq_u32 vcc, -1, v4
    s_cbranch_vccz .W_85
.A_84:
    buffer_load_dwordx4 v[32:35], v8, s[8:11], s29 offen offset:3072 sc1
    s_waitcnt vmcnt(2)
    v_max3_u32 v4, v20, v21, v22
    v_max_u32 v4, v4, v23
    v_cmp_eq_u32 vcc, -1, v4
    s_cbranch_vccz .W_97
.A_98:
    buffer_load_dwordx4 v[20:23], v8, s[8:11], s29 offen offset:0 sc1
    s_waitcnt vmcnt(2)
    v_max3_u32 v4, v24, v25, v26
    v_max_u32 v4, v4, v27
    v_cmp_eq_u32 vcc, -1, v4
    s_cbranch_vccnz .A_96
.W_99:
    v_smfmac_f32_16x16x64_bf16 v[52:55], v[24:27], a[8:15], v9
    v_smfmac_f32_16x16x64_bf16 v[56:59], v[24:27], a[40:47], v9
    s_waitcnt vmcnt(1)
    v_max3_u32 v4, v32, v33, v34
    v_max_u32 v4, v4, v35
    v_smfmac_f32_16x16x64_bf16 v[60:63], v[24:27], a[72:79], v9
    v_cmp_eq_u32 vcc, -1, v4
    v_smfmac_f32_16x16x64_bf16 v[64:67], v[24:27], a[104:111], v9
    s_cbranch_vccz .W_81
    s_branch .A_80
.W_97:
    v_smfmac_f32_16x16x64_bf16 v[52:55], v[20:23], a[0:7], v9
    v_smfmac_f32_16x16x64_bf16 v[56:59], v[20:23], a[32:39], v9
    s_waitcnt vmcnt(1)
    v_max3_u32 v4, v24, v25, v26
    v_max_u32 v4, v4, v27
    v_smfmac_f32_16x16x64_bf16 v[60:63], v[20:23], a[64:71], v9
    v_cmp_eq_u32 vcc, -1, v4
    v_smfmac_f32_16x16x64_bf16 v[64:67], v[20:23], a[96:103], v9
    s_cbranch_vccnz .A_100
.W_101:
    v_smfmac_f32_16x16x64_bf16 v[52:55], v[24:27], a[8:15], v9
    v_smfmac_f32_16x16x64_bf16 v[56:59], v[24:27], a[40:47], v9
    s_waitcnt vmcnt(0)
    v_max3_u32 v4, v32, v33, v34
    v_max_u32 v4, v4, v35
    v_smfmac_f32_16x16x64_bf16 v[60:63], v[24:27], a[72:79], v9
    v_cmp_eq_u32 vcc, -1, v4
    v_smfmac_f32_16x16x64_bf16 v[64:67], v[24:27], a[104:111], v9
    s_cbranch_vccz .W_39
    s_branch .A_38
.A_102:
    buffer_load_dwordx4 v[32:35], v8, s[8:11], s29 offen offset:3072 sc1
    s_sub_u32 s62, s62, 1
    s_cbranch_scc1 .mg_end_1
    s_waitcnt vmcnt(2)
    v_max3_u32 v4, v20, v21, v22
    v_max_u32 v4, v4, v23
    v_cmp_eq_u32 vcc, -1, v4
    s_cbranch_vccz .W_103
.A_104:
    buffer_load_dwordx4 v[20:23], v8, s[8:11], s29 offen offset:0 sc1
    s_waitcnt vmcnt(2)
    v_max3_u32 v4, v28, v29, v30
    v_max_u32 v4, v4, v31
    v_cmp_eq_u32 vcc, -1, v4
    s_cbranch_vccz .W_79
.A_78:
    buffer_load_dwordx4 v[28:31], v8, s[8:11], s29 offen offset:2048 sc1
    s_waitcnt vmcnt(2)
    v_max3_u32 v4, v32, v33, v34
    v_max_u32 v4, v4, v35
    v_cmp_eq_u32 vcc, -1, v4
    s_cbranch_vccnz .A_102
.W_105:
    v_smfmac_f32_16x16x64_bf16 v[52:55], v[32:35], a[24:31], v9
    v_smfmac_f32_16x16x64_bf16 v[56:59], v[32:35], a[56:63], v9
    s_waitcnt vmcnt(1)
    v_max3_u32 v4, v20, v21, v22
    v_max_u32 v4, v4, v23
    v_smfmac_f32_16x16x64_bf16 v[60:63], v[32:35], a[88:95], v9
    v_cmp_eq_u32 vcc, -1, v4
    v_smfmac_f32_16x16x64_bf16 v[64:67], v[32:35], a[120:127], v9
    s_cbranch_vccnz .A_106
.W_107:
    v_smfmac_f32_16x16x64_bf16 v[52:55], v[20:23], a[0:7], v9
    v_smfmac_f32_16x16x64_bf16 v[56:59], v[20:23], a[32:39], v9
    s_waitcnt vmcnt(0)
    v_max3_u32 v4, v28, v29, v30
    v_max_u32 v4, v4, v31
    v_smfmac_f32_16x16x64_bf16 v[60:63], v[20:23], a[64:71], v9
    v_cmp_eq_u32 vcc, -1, v4
    v_smfmac_f32_16x16x64_bf16 v[64:67], v[20:23], a[96:103], v9
    s_cbranch_vccz .W_77
    s_branch .A_76
.W_103:
    v_smfmac_f32_16x16x64_bf16 v[52:55], v[20:23], a[0:7], v9
    v_smfmac_f32_16x16x64_bf16 v[56:59], v[20:23], a[32:39], v9
    s_waitcnt vmcnt(1)
    v_max3_u32 v4, v28, v29, v30
    v_max_u32 v4, v4, v31
    v_smfmac_f32_16x16x64_bf16 v[60:63], v[20:23], a[64:71], v9
    v_cmp_eq_u32 vcc, -1, v4
    v_smfmac_f32_16x16x64_bf16 v[64:67], v[20:23], a[96:103], v9
    s_cbranch_vccz .W_37
    s_branch .A_36
.A_108:
    buffer_load_dwordx4 v[32:35], v8, s[8:11], s29 offen offset:3072 sc1
    s_sub_u32 s62, s62, 1
    s_cbranch_scc1 .mg_end_1
    s_waitcnt vmcnt(2)
    v_max3_u32 v4, v24, v25, v26
    v_max_u32 v4, v4, v27
    v_cmp_eq_u32 vcc, -1, v4
    s_cbranch_vccz .W_35
.A_34:
    buffer_load_dwordx4 v[24:27], v8, s[8:11], s29 offen offset:1024 sc1
    s_waitcnt vmcnt(2)
    v_max3_u32 v4, v28, v29, v30
    v_max_u32 v4, v4, v31
    v_cmp_eq_u32 vcc, -1, v4
    s_cbranch_vccz .W_109
.A_110:
    buffer_load_dwordx4 v[28:31], v8, s[8:11], s29 offen offset:2048 sc1
    s_waitcnt vmcnt(2)
    v_max3_u32 v4, v32, v33, v34
    v_max_u32 v4, v4, v35
    v_cmp_eq_u32 vcc, -1, v4
    s_cbranch_vccnz .A_108
.W_111:
    v_smfmac_f32_16x16x64_bf16 v[52:55], v[32:35], a[24:31], v9
    v_smfmac_f32_16x16x64_bf16 v[56:59], v[32:35], a[56:63], v9
    s_waitcnt vmcnt(1)
    v_max3_u32 v4, v24, v25, v26
    v_max_u32 v4, v4, v27
    v_smfmac_f32_16x16x64_bf16 v[60:63], v[32:35], a[88:95], v9
    v_cmp_eq_u32 vcc, -1, v4
    v_smfmac_f32_16x16x64_bf16 v[64:67], v[32:35], a[120:127], v9
    s_cbranch_vccz .W_75
    s_branch .A_74
.W_109:
    v_smfmac_f32_16x16x64_bf16 v[52:55], v[28:31], a[16:23], v9
    v_smfmac_f32_16x16x64_bf16 v[56:59], v[28:31], a[48:55], v9
    s_waitcnt vmcnt(1)
    v_max3_u32 v4, v32, v33, v34
    v_max_u32 v4, v4, v35
    v_smfmac_f32_16x16x64_bf16 v[60:63], v[28:31], a[80:87], v9
    v_cmp_eq_u32 vcc, -1, v4
    v_smfmac_f32_16x16x64_bf16 v[64:67], v[28:31], a[112:119], v9
    s_cbranch_vccnz .A_112
.W_113:
    v_smfmac_f32_16x16x64_bf16 v[52:55], v[32:35], a[24:31], v9
    v_smfmac_f32_16x16x64_bf16 v[56:59], v[32:35], a[56:63], v9
    s_waitcnt vmcnt(0)
    v_max3_u32 v4, v24, v25, v26
    v_max_u32 v4, v4, v27
    v_smfmac_f32_16x16x64_bf16 v[60:63], v[32:35], a[88:95], v9
    v_cmp_eq_u32 vcc, -1, v4
    v_smfmac_f32_16x16x64_bf16 v[64:67], v[32:35], a[120:127], v9
    s_cbranch_vccz .W_89
    s_branch .A_88
.A_114:
    buffer_load_dwordx4 v[24:27], v8, s[8:11], s29 offen offset:1024 sc1
    s_sub_u32 s62, s62, 1
    s_cbranch_scc1 .mg_end_1
    s_waitcnt vmcnt(1)
    v_max3_u32 v4, v20, v21, v22
    v_max_u32 v4, v4, v23
    v_cmp_eq_u32 vcc, -1, v4
    s_cbranch_vccz .W_87
.A_86:
    buffer_load_dwordx4 v[20:23], v8, s[8:11], s29 offen offset:0 sc1
    s_waitcnt vmcnt(1)
    v_max3_u32 v4, v24, v25, v26
    v_max_u32 v4, v4, v27
    v_cmp_eq_u32 vcc, -1, v4
    s_cbranch_vccnz .A_114
.W_115:
    v_smfmac_f32_16x16x64_bf16 v[52:55], v[24:27], a[8:15], v9
    v_smfmac_f32_16x16x64_bf16 v[56:59], v[24:27], a[40:47], v9
    s_waitcnt vmcnt(0)
    v_max3_u32 v4, v20, v21, v22
    v_max_u32 v4, v4, v23
    v_smfmac_f32_16x16x64_bf16 v[60:63], v[24:27], a[72:79], v9
    v_cmp_eq_u32 vcc, -1, v4
    v_smfmac_f32_16x16x64_bf16 v[64:67], v[24:27], a[104:111], v9
    s_cbranch_vccz .W_83
    s_branch .A_82
.A_94:
    buffer_load_dwordx4 v[28:31], v8, s[8:11], s29 offen offset:2048 sc1
    s_sub_u32 s62, s62, 1
    s_cbranch_scc1 .mg_end_1
    s_waitcnt vmcnt(1)
    v_max3_u32 v4, v20, v21, v22
    v_max_u32 v4, v4, v23
    v_cmp_eq_u32 vcc, -1, v4
    s_cbranch_vccz .W_107
.A_106:
    buffer_load_dwordx4 v[20:23], v8, s[8:11], s29 offen offset:0 sc1
    s_waitcnt vmcnt(1)
    v_max3_u32 v4, v28, v29, v30
    v_max_u32 v4, v4, v31
    v_cmp_eq_u32 vcc, -1, v4
    s_cbranch_vccnz .A_94
    s_branch .W_95
.A_116:
    buffer_load_dwordx4 v[20:23], v8, s[8:11], s29 offen offset:0 sc1
    s_sub_u32 s62, s62, 1
    s_cbranch_scc1 .mg_end_1
    s_waitcnt vmcnt(1)
    v_max3_u32 v4, v32, v33, v34
    v_max_u32 v4, v4, v35
    v_cmp_eq_u32 vcc, -1, v4
    s_cbranch_vccz .W_81
.A_80:
    buffer_load_dwordx4 v[32:35], v8, s[8:11], s29 offen offset:3072 sc1
    s_waitcnt vmcnt(1)
    v_max3_u32 v4, v20, v21, v22
    v_max_u32 v4, v4, v23
    v_cmp_eq_u32 vcc, -1, v4
    s_cbranch_vccnz .A_116
.W_117:
    v_smfmac_f32_16x16x64_bf16 v[52:55], v[20:23], a[0:7], v9
    v_smfmac_f32_16x16x64_bf16 v[56:59], v[20:23], a[32:39], v9
    s_waitcnt vmcnt(0)
    v_max3_u32 v4, v32, v33, v34
    v_max_u32 v4, v4, v35
    v_smfmac_f32_16x16x64_bf16 v[60:63], v[20:23], a[64:71], v9
    v_cmp_eq_u32 vcc, -1, v4
    v_smfmac_f32_16x16x64_bf16 v[64:67], v[20:23], a[96:103], v9
    s_cbranch_vccz .W_39
    s_branch .A_38
.A_118:
    buffer_load_dwordx4 v[28:31], v8, s[8:11], s29 offen offset:2048 sc1
    s_sub_u32 s62, s62, 1
    s_cbranch_scc1 .mg_end_1
    s_waitcnt vmcnt(1)
    v_max3_u32 v4, v24, v25, v26
    v_max_u32 v4, v4, v27
    v_cmp_eq_u32 vcc, -1, v4
    s_cbranch_vccz .W_75
.A_74:
    buffer_load_dwordx4 v[24:27], v8, s[8:11], s29 offen offset:1024 sc1
    s_waitcnt vmcnt(1)
    v_max3_u32 v4, v28, v29, v30
    v_max_u32 v4, v4, v31
    v_cmp_eq_u32 vcc, -1, v4
    s_cbranch_vccnz .A_118
.W_119:
    v_smfmac_f32_16x16x64_bf16 v[52:55], v[28:31], a[16:23], v9
    v_smfmac_f32_16x16x64_bf16 v[56:59], v[28:31], a[48:55], v9
    s_waitcnt vmcnt(0)
    v_max3_u32 v4, v24, v25, v26
    v_max_u32 v4, v4, v27
    v_smfmac_f32_16x16x64_bf16 v[60:63], v[28:31], a[80:87], v9
    v_cmp_eq_u32 vcc, -1, v4
    v_smfmac_f32_16x16x64_bf16 v[64:67], v[28:31], a[112:119], v9
    s_cbranch_vccz .W_89
    s_branch .A_88
.A_112:
    buffer_load_dwordx4 v[32:35], v8, s[8:11], s29 offen offset:3072 sc1
    s_sub_u32 s62, s62, 1
    s_cbranch_scc1 .mg_end_1
    s_waitcnt vmcnt(1)
    v_max3_u32 v4, v24, v25, v26
    v_max_u32 v4, v4, v27
    v_cmp_eq_u32 vcc, -1, v4
    s_cbranch_vccz .W_101
.A_100:
    buffer_load_dwordx4 v[24:27], v8, s[8:11], s29 offen offset:1024 sc1
    s_waitcnt vmcnt(1)
    v_max3_u32 v4, v32, v33, v34
    v_max_u32 v4, v4, v35
    v_cmp_eq_u32 vcc, -1, v4
    s_cbranch_vccnz .A_112
    s_branch .W_113
.A_120:
    buffer_load_dwordx4 v[32:35], v8, s[8:11], s29 offen offset:3072 sc1
    s_sub_u32 s62, s62, 1
    s_cbranch_scc1 .mg_end_1
    s_waitcnt vmcnt(1)
    v_max3_u32 v4, v28, v29, v30
    v_max_u32 v4, v4, v31
    v_cmp_eq_u32 vcc, -1, v4
    s_cbranch_vccz .W_37
.A_36:
    buffer_load_dwordx4 v[28:31], v8, s[8:11], s29 offen offset:2048 sc1
    s_waitcnt vmcnt(1)
    v_max3_u32 v4, v32, v33, v34
    v_max_u32 v4, v4, v35
    v_cmp_eq_u32 vcc, -1, v4
    s_cbranch_vccnz .A_120
.W_121:
    v_smfmac_f32_16x16x64_bf16 v[52:55], v[32:35], a[24:31], v9
    v_smfmac_f32_16x16x64_bf16 v[56:59], v[32:35], a[56:63], v9
    s_waitcnt vmcnt(0)
    v_max3_u32 v4, v28, v29, v30
    v_max_u32 v4, v4, v31
    v_smfmac_f32_16x16x64_bf16 v[60:63], v[32:35], a[88:95], v9
    v_cmp_eq_u32 vcc, -1, v4
    v_smfmac_f32_16x16x64_bf16 v[64:67], v[32:35], a[120:127], v9
    s_cbranch_vccz .W_77
    s_branch .A_76
.A_82:
    buffer_load_dwordx4 v[20:23], v8, s[8:11], s29 offen offset:0 sc1
    s_sub_u32 s62, s62, 1
    s_cbranch_scc1 .mg_end_1
    s_waitcnt vmcnt(1)
    v_max3_u32 v4, v20, v21, v22
    v_max_u32 v4, v4, v23
    v_cmp_eq_u32 vcc, -1, v4
    s_cbranch_vccnz .A_82
    v_smfmac_f32_16x16x64_bf16 v[52:55], v[20:23], a[0:7], v9
    v_smfmac_f32_16x16x64_bf16 v[56:59], v[20:23], a[32:39], v9
    v_smfmac_f32_16x16x64_bf16 v[60:63], v[20:23], a[64:71], v9
    v_smfmac_f32_16x16x64_bf16 v[64:67], v[20:23], a[96:103], v9
    s_branch .mj_31
.A_88:
    buffer_load_dwordx4 v[24:27], v8, s[8:11], s29 offen offset:1024 sc1
    s_sub_u32 s62, s62, 1
    s_cbranch_scc1 .mg_end_1
    s_waitcnt vmcnt(1)
    v_max3_u32 v4, v24, v25, v26
    v_max_u32 v4, v4, v27
    v_cmp_eq_u32 vcc, -1, v4
    s_cbranch_vccnz .A_88
    v_smfmac_f32_16x16x64_bf16 v[52:55], v[24:27], a[8:15], v9
    v_smfmac_f32_16x16x64_bf16 v[56:59], v[24:27], a[40:47], v9
    v_smfmac_f32_16x16x64_bf16 v[60:63], v[24:27], a[72:79], v9
    v_smfmac_f32_16x16x64_bf16 v[64:67], v[24:27], a[104:111], v9
    s_branch .mj_31
.A_76:
    buffer_load_dwordx4 v[28:31], v8, s[8:11], s29 offen offset:2048 sc1
    s_sub_u32 s62, s62, 1
    s_cbranch_scc1 .mg_end_1
    s_waitcnt vmcnt(1)
    v_max3_u32 v4, v28, v29, v30
    v_max_u32 v4, v4, v31
    v_cmp_eq_u32 vcc, -1, v4
    s_cbranch_vccnz .A_76
    v_smfmac_f32_16x16x64_bf16 v[52:55], v[28:31], a[16:23], v9
    v_smfmac_f32_16x16x64_bf16 v[56:59], v[28:31], a[48:55], v9
    v_smfmac_f32_16x16x64_bf16 v[60:63], v[28:31], a[80:87], v9
    v_smfmac_f32_16x16x64_bf16 v[64:67], v[28:31], a[112:119], v9
    s_branch .mj_31
.A_38:
    buffer_load_dwordx4 v[32:35], v8, s[8:11], s29 offen offset:3072 sc1
    s_sub_u32 s62, s62, 1
    s_cbranch_scc1 .mg_end_1
    s_waitcnt vmcnt(1)
    v_max3_u32 v4, v32, v33, v34
    v_max_u32 v4, v4, v35
    v_cmp_eq_u32 vcc, -1, v4
    s_cbranch_vccnz .A_38
    v_smfmac_f32_16x16x64_bf16 v[52:55], v[32:35], a[24:31], v9
    v_smfmac_f32_16x16x64_bf16 v[56:59], v[32:35], a[56:63], v9
    v_smfmac_f32_16x16x64_bf16 v[60:63], v[32:35], a[88:95], v9
    v_smfmac_f32_16x16x64_bf16 v[64:67], v[32:35], a[120:127], v9
    s_branch .mj_31
.A_122:
    buffer_load_dwordx4 v[100:103], v234, s[8:11], s29 offen sc1
    s_sub_u32 s62, s62, 1
    s_cbranch_scc1 .mg_end_1
    s_waitcnt vmcnt(2)
    v_max3_u32 v4, v92, v93, v94
    v_max_u32 v4, v4, v95
    v_cmp_eq_u32 vcc, -1, v4
    s_cbranch_vccz .W_42
.A_41:
    buffer_load_dwordx4 v[92:95], v232, s[8:11], s29 offen sc1
    s_waitcnt vmcnt(2)
    v_max3_u32 v4, v96, v97, v98
    v_max_u32 v4, v4, v99
    v_cmp_eq_u32 vcc, -1, v4
    s_cbranch_vccz .W_123
.A_124:
    buffer_load_dwordx4 v[96:99], v233, s[8:11], s29 offen sc1
    s_waitcnt vmcnt(2)
    v_max3_u32 v4, v100, v101, v102
    v_max_u32 v4, v4, v103
    v_cmp_eq_u32 vcc, -1, v4
    s_cbranch_vccnz .A_122
.W_125:
    v_mfma_f32_16x16x32_bf16 v[208:211], v[140:143], v[100:103], v[208:211]
    s_waitcnt vmcnt(1)
    v_max3_u32 v4, v92, v93, v94
    v_max_u32 v4, v4, v95
    v_mfma_f32_16x16x32_bf16 v[212:215], v[156:159], v[100:103], v[212:215]
    v_cmp_eq_u32 vcc, -1, v4
    v_mfma_f32_16x16x32_bf16 v[216:219], v[100:103], v[100:103], v[216:219]
    s_cbranch_vccnz .A_126
.W_127:
    v_mfma_f32_16x16x32_bf16 v[208:211], v[132:135], v[92:95], v[208:211]
    s_waitcnt vmcnt(0)
    v_max3_u32 v4, v96, v97, v98
    v_max_u32 v4, v4, v99
    v_mfma_f32_16x16x32_bf16 v[212:215], v[148:151], v[92:95], v[212:215]
    v_cmp_eq_u32 vcc, -1, v4
    v_mfma_f32_16x16x32_bf16 v[216:219], v[92:95], v[92:95], v[216:219]
    s_cbranch_vccnz .A_128
.W_129:
    v_mfma_f32_16x16x32_bf16 v[208:211], v[136:139], v[96:99], v[208:211]
    v_mfma_f32_16x16x32_bf16 v[212:215], v[152:155], v[96:99], v[212:215]
    v_mfma_f32_16x16x32_bf16 v[216:219], v[96:99], v[96:99], v[216:219]
    s_branch .mj_40
.W_123:
    v_mfma_f32_16x16x32_bf16 v[208:211], v[136:139], v[96:99], v[208:211]
    s_waitcnt vmcnt(1)
    v_max3_u32 v4, v100, v101, v102
    v_max_u32 v4, v4, v103
    v_mfma_f32_16x16x32_bf16 v[212:215], v[152:155], v[96:99], v[212:215]
    v_cmp_eq_u32 vcc, -1, v4
    v_mfma_f32_16x16x32_bf16 v[216:219], v[96:99], v[96:99], v[216:219]
    s_cbranch_vccnz .A_130
.W_131:
    v_mfma_f32_16x16x32_bf16 v[208:211], v[140:143], v[100:103], v[208:211]
    s_waitcnt vmcnt(0)
    v_max3_u32 v4, v92, v93, v94
    v_max_u32 v4, v4, v95
    v_mfma_f32_16x16x32_bf16 v[212:215], v[156:159], v[100:103], v[212:215]
    v_cmp_eq_u32 vcc, -1, v4
    v_mfma_f32_16x16x32_bf16 v[216:219], v[100:103], v[100:103], v[216:219]
    s_cbranch_vccnz .A_132
.W_133:
    v_mfma_f32_16x16x32_bf16 v[208:211], v[132:135], v[92:95], v[208:211]
    v_mfma_f32_16x16x32_bf16 v[212:215], v[148:151], v[92:95], v[212:215]
    v_mfma_f32_16x16x32_bf16 v[216:219], v[92:95], v[92:95], v[216:219]
    s_branch .mj_40
.A_134:
    buffer_load_dwordx4 v[96:99], v233, s[8:11], s29 offen sc1
    s_sub_u32 s62, s62, 1
    s_cbranch_scc1 .mg_end_1
    s_waitcnt vmcnt(1)
    v_max3_u32 v4, v92, v93, v94
    v_max_u32 v4, v4, v95
    v_cmp_eq_u32 vcc, -1, v4
    s_cbranch_vccz .W_127
.A_126:
    buffer_load_dwordx4 v[92:95], v232, s[8:11], s29 offen sc1
    s_waitcnt vmcnt(1)
    v_max3_u32 v4, v96, v97, v98
    v_max_u32 v4, v4, v99
    v_cmp_eq_u32 vcc, -1, v4
    s_cbranch_vccnz .A_134
.W_135:
    v_mfma_f32_16x16x32_bf16 v[208:211], v[136:139], v[96:99], v[208:211]
    s_waitcnt vmcnt(0)
    v_max3_u32 v4, v92, v93, v94
    v_max_u32 v4, v4, v95
    v_mfma_f32_16x16x32_bf16 v[212:215], v[152:155], v[96:99], v[212:215]
    v_cmp_eq_u32 vcc, -1, v4
    v_mfma_f32_16x16x32_bf16 v[216:219], v[96:99], v[96:99], v[216:219]
    s_cbranch_vccz .W_133
    s_branch .A_132
.A_136:
    buffer_load_dwordx4 v[92:95], v232, s[8:11], s29 offen sc1
    s_sub_u32 s62, s62, 1
    s_cbranch_scc1 .mg_end_1
    s_waitcnt vmcnt(1)
    v_max3_u32 v4, v100, v101, v102
    v_max_u32 v4, v4, v103
    v_cmp_eq_u32 vcc, -1, v4
    s_cbranch_vccz .W_131
.A_130:
    buffer_load_dwordx4 v[100:103], v234, s[8:11], s29 offen sc1
    s_waitcnt vmcnt(1)
    v_max3_u32 v4, v92, v93, v94
    v_max_u32 v4, v4, v95
    v_cmp_eq_u32 vcc, -1, v4
    s_cbranch_vccnz .A_136
.W_137:
    v_mfma_f32_16x16x32_bf16 v[208:211], v[132:135], v[92:95], v[208:211]
    s_waitcnt vmcnt(0)
    v_max3_u32 v4, v100, v101, v102
    v_max_u32 v4, v4, v103
    v_mfma_f32_16x16x32_bf16 v[212:215], v[148:151], v[92:95], v[212:215]
    v_cmp_eq_u32 vcc, -1, v4
    v_mfma_f32_16x16x32_bf16 v[216:219], v[92:95], v[92:95], v[216:219]
    s_cbranch_vccz .W_46
    s_branch .A_45
.A_138:
    buffer_load_dwordx4 v[100:103], v234, s[8:11], s29 offen sc1
    s_sub_u32 s62, s62, 1
    s_cbranch_scc1 .mg_end_1
    s_waitcnt vmcnt(1)
    v_max3_u32 v4, v96, v97, v98
    v_max_u32 v4, v4, v99
    v_cmp_eq_u32 vcc, -1, v4
    s_cbranch_vccz .W_44
.A_43:
    buffer_load_dwordx4 v[96:99], v233, s[8:11], s29 offen sc1
    s_waitcnt vmcnt(1)
    v_max3_u32 v4, v100, v101, v102
    v_max_u32 v4, v4, v103
    v_cmp_eq_u32 vcc, -1, v4
    s_cbranch_vccnz .A_138
.W_139:
    v_mfma_f32_16x16x32_bf16 v[208:211], v[140:143], v[100:103], v[208:211]
    s_waitcnt vmcnt(0)
    v_max3_u32 v4, v96, v97, v98
    v_max_u32 v4, v4, v99
    v_mfma_f32_16x16x32_bf16 v[212:215], v[156:159], v[100:103], v[212:215]
    v_cmp_eq_u32 vcc, -1, v4
    v_mfma_f32_16x16x32_bf16 v[216:219], v[100:103], v[100:103], v[216:219]
    s_cbranch_vccz .W_129
    s_branch .A_128
.A_132:
    buffer_load_dwordx4 v[92:95], v232, s[8:11], s29 offen sc1
    s_sub_u32 s62, s62, 1
    s_cbranch_scc1 .mg_end_1
    s_waitcnt vmcnt(1)
    v_max3_u32 v4, v92, v93, v94
    v_max_u32 v4, v4, v95
    v_cmp_eq_u32 vcc, -1, v4
    s_cbranch_vccnz .A_132
    v_mfma_f32_16x16x32_bf16 v[208:211], v[132:135], v[92:95], v[208:211]
    v_mfma_f32_16x16x32_bf16 v[212:215], v[148:151], v[92:95], v[212:215]
    v_mfma_f32_16x16x32_bf16 v[216:219], v[92:95], v[92:95], v[216:219]
    s_branch .mj_40
.A_128:
    buffer_load_dwordx4 v[96:99], v233, s[8:11], s29 offen sc1
    s_sub_u32 s62, s62, 1
    s_cbranch_scc1 .mg_end_1
    s_waitcnt vmcnt(1)
    v_max3_u32 v4, v96, v97, v98
    v_max_u32 v4, v4, v99
    v_cmp_eq_u32 vcc, -1, v4
    s_cbranch_vccnz .A_128
    v_mfma_f32_16x16x32_bf16 v[208:211], v[136:139], v[96:99], v[208:211]
    v_mfma_f32_16x16x32_bf16 v[212:215], v[152:155], v[96:99], v[212:215]
    v_mfma_f32_16x16x32_bf16 v[216:219], v[96:99], v[96:99], v[216:219]
    s_branch .mj_40
.A_45:
    buffer_load_dwordx4 v[100:103], v234, s[8:11], s29 offen sc1
    s_sub_u32 s62, s62, 1
    s_cbranch_scc1 .mg_end_1
    s_waitcnt vmcnt(1)
    v_max3_u32 v4, v100, v101, v102
    v_max_u32 v4, v4, v103
    v_cmp_eq_u32 vcc, -1, v4
    s_cbranch_vccnz .A_45
    v_mfma_f32_16x16x32_bf16 v[208:211], v[140:143], v[100:103], v[208:211]
    v_mfma_f32_16x16x32_bf16 v[212:215], v[156:159], v[100:103], v[212:215]
    v_mfma_f32_16x16x32_bf16 v[216:219], v[100:103], v[100:103], v[216:219]
    s_branch .mj_40
.kf_54:
    s_mov_b32 s62, 0
    s_mov_b64 exec, 3
.wf_140:
    buffer_load_dword v244, v253, s[8:11], s89 offen sc1
    s_waitcnt vmcnt(0)
    v_cmp_gt_u32 vcc, s6, v244
    s_cbranch_vccz .wfd_141
    s_sleep 2
    s_add_u32 s62, s62, 1
    s_cmp_gt_u32 s62, 0x400000
    s_cbranch_scc1 .mg_end_1
    s_branch .wf_140

.wfd_141:
    s_mov_b64 exec, -1
    v_readlane_b32 s4, v244, 0
    v_readlane_b32 s93, v244, 1
    s_min_u32 s93, s93, s4
    s_mov_b32 s62, 0x1000000
    s_branch .kb_55
.A_142:
    buffer_load_dwordx4 v[216:219], v246, s[8:11], s33 offen offset:2048 sc1
    buffer_load_dwordx4 v[220:223], v246, s[8:11], s33 offen offset:3072 sc1
    s_sub_u32 s62, s62, 1
    s_cbranch_scc1 .mg_end_1
    s_waitcnt vmcnt(6)
    v_max3_u32 v4, v192, v193, v194
    v_max3_u32 v5, v195, v196, v197
    v_max3_u32 v4, v4, v198, v199
    v_max_u32 v4, v4, v5
    v_cmp_eq_u32 vcc, -1, v4
    s_cbranch_vccz .W_58
.A_57:
    buffer_load_dwordx4 v[192:195], v246, s[8:11], s32 offen offset:0 sc1
    buffer_load_dwordx4 v[196:199], v246, s[8:11], s32 offen offset:1024 sc1
    s_waitcnt vmcnt(6)
    v_max3_u32 v4, v200, v201, v202
    v_max3_u32 v5, v203, v204, v205
    v_max3_u32 v4, v4, v206, v207
    v_max_u32 v4, v4, v5
    v_cmp_eq_u32 vcc, -1, v4
    s_cbranch_vccz .W_143
.A_144:
    buffer_load_dwordx4 v[200:203], v246, s[8:11], s32 offen offset:2048 sc1
    buffer_load_dwordx4 v[204:207], v246, s[8:11], s32 offen offset:3072 sc1
    s_waitcnt vmcnt(6)
    v_max3_u32 v4, v208, v209, v210
    v_max3_u32 v5, v211, v212, v213
    v_max3_u32 v4, v4, v214, v215
    v_max_u32 v4, v4, v5
    v_cmp_eq_u32 vcc, -1, v4
    s_cbranch_vccz .W_145
.A_146:
    buffer_load_dwordx4 v[208:211], v246, s[8:11], s33 offen offset:0 sc1
    buffer_load_dwordx4 v[212:215], v246, s[8:11], s33 offen offset:1024 sc1
    s_waitcnt vmcnt(6)
    v_max3_u32 v4, v216, v217, v218
    v_max3_u32 v5, v219, v220, v221
    v_max3_u32 v4, v4, v222, v223
    v_max_u32 v4, v4, v5
    v_cmp_eq_u32 vcc, -1, v4
    s_cbranch_vccnz .A_142
.W_147:
    v_smfmac_f32_16x16x64_bf16 v[76:79], v[216:219], v[140:147], v9
    v_smfmac_f32_16x16x64_bf16 v[80:83], v[216:219], v[172:179], v9
    s_waitcnt vmcnt(4)
    v_max3_u32 v4, v192, v193, v194
    v_max3_u32 v5, v195, v196, v197
    v_max3_u32 v4, v4, v198, v199
    v_smfmac_f32_16x16x64_bf16 v[76:79], v[220:223], v[148:155], v9
    v_max_u32 v4, v4, v5
    v_cmp_eq_u32 vcc, -1, v4
    v_smfmac_f32_16x16x64_bf16 v[80:83], v[220:223], v[180:187], v9
    s_cbranch_vccnz .A_148
.W_149:
    v_smfmac_f32_16x16x64_bf16 v[76:79], v[192:195], a[192:199], v9
    v_smfmac_f32_16x16x64_bf16 v[80:83], v[192:195], a[224:231], v9
    s_waitcnt vmcnt(2)
    v_max3_u32 v4, v200, v201, v202
    v_max3_u32 v5, v203, v204, v205
    v_max3_u32 v4, v4, v206, v207
    v_smfmac_f32_16x16x64_bf16 v[76:79], v[196:199], a[200:207], v9
    v_max_u32 v4, v4, v5
    v_cmp_eq_u32 vcc, -1, v4
    v_smfmac_f32_16x16x64_bf16 v[80:83], v[196:199], a[232:239], v9
    s_cbranch_vccnz .A_150
.W_151:
    v_smfmac_f32_16x16x64_bf16 v[76:79], v[200:203], a[208:215], v9
    v_smfmac_f32_16x16x64_bf16 v[80:83], v[200:203], a[240:247], v9
    s_waitcnt vmcnt(0)
    v_max3_u32 v4, v208, v209, v210
    v_max3_u32 v5, v211, v212, v213
    v_max3_u32 v4, v4, v214, v215
    v_smfmac_f32_16x16x64_bf16 v[76:79], v[204:207], a[216:223], v9
    v_max_u32 v4, v4, v5
    v_cmp_eq_u32 vcc, -1, v4
    v_smfmac_f32_16x16x64_bf16 v[80:83], v[204:207], a[248:255], v9
    s_cbranch_vccnz .A_152
.W_153:
    v_smfmac_f32_16x16x64_bf16 v[76:79], v[208:211], v[124:131], v9
    v_smfmac_f32_16x16x64_bf16 v[80:83], v[208:211], v[156:163], v9
    v_smfmac_f32_16x16x64_bf16 v[76:79], v[212:215], v[132:139], v9
    v_smfmac_f32_16x16x64_bf16 v[80:83], v[212:215], v[164:171], v9
    s_branch .mj_56
.W_143:
    v_smfmac_f32_16x16x64_bf16 v[76:79], v[200:203], a[208:215], v9
    v_smfmac_f32_16x16x64_bf16 v[80:83], v[200:203], a[240:247], v9
    s_waitcnt vmcnt(4)
    v_max3_u32 v4, v208, v209, v210
    v_max3_u32 v5, v211, v212, v213
    v_max3_u32 v4, v4, v214, v215
    v_smfmac_f32_16x16x64_bf16 v[76:79], v[204:207], a[216:223], v9
    v_max_u32 v4, v4, v5
    v_cmp_eq_u32 vcc, -1, v4
    v_smfmac_f32_16x16x64_bf16 v[80:83], v[204:207], a[248:255], v9
    s_cbranch_vccnz .A_154
.W_155:
    v_smfmac_f32_16x16x64_bf16 v[76:79], v[208:211], v[124:131], v9
    v_smfmac_f32_16x16x64_bf16 v[80:83], v[208:211], v[156:163], v9
    s_waitcnt vmcnt(2)
    v_max3_u32 v4, v216, v217, v218
    v_max3_u32 v5, v219, v220, v221
    v_max3_u32 v4, v4, v222, v223
    v_smfmac_f32_16x16x64_bf16 v[76:79], v[212:215], v[132:139], v9
    v_max_u32 v4, v4, v5
    v_cmp_eq_u32 vcc, -1, v4
    v_smfmac_f32_16x16x64_bf16 v[80:83], v[212:215], v[164:171], v9
    s_cbranch_vccnz .A_156
.W_157:
    v_smfmac_f32_16x16x64_bf16 v[76:79], v[216:219], v[140:147], v9
    v_smfmac_f32_16x16x64_bf16 v[80:83], v[216:219], v[172:179], v9
    s_waitcnt vmcnt(0)
    v_max3_u32 v4, v192, v193, v194
    v_max3_u32 v5, v195, v196, v197
    v_max3_u32 v4, v4, v198, v199
    v_smfmac_f32_16x16x64_bf16 v[76:79], v[220:223], v[148:155], v9
    v_max_u32 v4, v4, v5
    v_cmp_eq_u32 vcc, -1, v4
    v_smfmac_f32_16x16x64_bf16 v[80:83], v[220:223], v[180:187], v9
    s_cbranch_vccnz .A_158
.W_159:
    v_smfmac_f32_16x16x64_bf16 v[76:79], v[192:195], a[192:199], v9
    v_smfmac_f32_16x16x64_bf16 v[80:83], v[192:195], a[224:231], v9
    v_smfmac_f32_16x16x64_bf16 v[76:79], v[196:199], a[200:207], v9
    v_smfmac_f32_16x16x64_bf16 v[80:83], v[196:199], a[232:239], v9
    s_branch .mj_56
.W_145:
    v_smfmac_f32_16x16x64_bf16 v[76:79], v[208:211], v[124:131], v9
    v_smfmac_f32_16x16x64_bf16 v[80:83], v[208:211], v[156:163], v9
    s_waitcnt vmcnt(4)
    v_max3_u32 v4, v216, v217, v218
    v_max3_u32 v5, v219, v220, v221
    v_max3_u32 v4, v4, v222, v223
    v_smfmac_f32_16x16x64_bf16 v[76:79], v[212:215], v[132:139], v9
    v_max_u32 v4, v4, v5
    v_cmp_eq_u32 vcc, -1, v4
    v_smfmac_f32_16x16x64_bf16 v[80:83], v[212:215], v[164:171], v9
    s_cbranch_vccnz .A_160
.W_161:
    v_smfmac_f32_16x16x64_bf16 v[76:79], v[216:219], v[140:147], v9
    v_smfmac_f32_16x16x64_bf16 v[80:83], v[216:219], v[172:179], v9
    s_waitcnt vmcnt(2)
    v_max3_u32 v4, v192, v193, v194
    v_max3_u32 v5, v195, v196, v197
    v_max3_u32 v4, v4, v198, v199
    v_smfmac_f32_16x16x64_bf16 v[76:79], v[220:223], v[148:155], v9
    v_max_u32 v4, v4, v5
    v_cmp_eq_u32 vcc, -1, v4
    v_smfmac_f32_16x16x64_bf16 v[80:83], v[220:223], v[180:187], v9
    s_cbranch_vccnz .A_162
.W_163:
    v_smfmac_f32_16x16x64_bf16 v[76:79], v[192:195], a[192:199], v9
    v_smfmac_f32_16x16x64_bf16 v[80:83], v[192:195], a[224:231], v9
    s_waitcnt vmcnt(0)
    v_max3_u32 v4, v200, v201, v202
    v_max3_u32 v5, v203, v204, v205
    v_max3_u32 v4, v4, v206, v207
    v_smfmac_f32_16x16x64_bf16 v[76:79], v[196:199], a[200:207], v9
    v_max_u32 v4, v4, v5
    v_cmp_eq_u32 vcc, -1, v4
    v_smfmac_f32_16x16x64_bf16 v[80:83], v[196:199], a[232:239], v9
    s_cbranch_vccnz .A_164
.W_165:
    v_smfmac_f32_16x16x64_bf16 v[76:79], v[200:203], a[208:215], v9
    v_smfmac_f32_16x16x64_bf16 v[80:83], v[200:203], a[240:247], v9
    v_smfmac_f32_16x16x64_bf16 v[76:79], v[204:207], a[216:223], v9
    v_smfmac_f32_16x16x64_bf16 v[80:83], v[204:207], a[248:255], v9
    s_branch .mj_56
.A_166:
    buffer_load_dwordx4 v[208:211], v246, s[8:11], s33 offen offset:0 sc1
    buffer_load_dwordx4 v[212:215], v246, s[8:11], s33 offen offset:1024 sc1
    s_sub_u32 s62, s62, 1
    s_cbranch_scc1 .mg_end_1
    s_waitcnt vmcnt(4)
    v_max3_u32 v4, v192, v193, v194
    v_max3_u32 v5, v195, v196, v197
    v_max3_u32 v4, v4, v198, v199
    v_max_u32 v4, v4, v5
    v_cmp_eq_u32 vcc, -1, v4
    s_cbranch_vccz .W_149
.A_148:
    buffer_load_dwordx4 v[192:195], v246, s[8:11], s32 offen offset:0 sc1
    buffer_load_dwordx4 v[196:199], v246, s[8:11], s32 offen offset:1024 sc1
    s_waitcnt vmcnt(4)
    v_max3_u32 v4, v200, v201, v202
    v_max3_u32 v5, v203, v204, v205
    v_max3_u32 v4, v4, v206, v207
    v_max_u32 v4, v4, v5
    v_cmp_eq_u32 vcc, -1, v4
    s_cbranch_vccz .W_167
.A_168:
    buffer_load_dwordx4 v[200:203], v246, s[8:11], s32 offen offset:2048 sc1
    buffer_load_dwordx4 v[204:207], v246, s[8:11], s32 offen offset:3072 sc1
    s_waitcnt vmcnt(4)
    v_max3_u32 v4, v208, v209, v210
    v_max3_u32 v5, v211, v212, v213
    v_max3_u32 v4, v4, v214, v215
    v_max_u32 v4, v4, v5
    v_cmp_eq_u32 vcc, -1, v4
    s_cbranch_vccnz .A_166
.W_169:
    v_smfmac_f32_16x16x64_bf16 v[76:79], v[208:211], v[124:131], v9
    v_smfmac_f32_16x16x64_bf16 v[80:83], v[208:211], v[156:163], v9
    s_waitcnt vmcnt(2)
    v_max3_u32 v4, v192, v193, v194
    v_max3_u32 v5, v195, v196, v197
    v_max3_u32 v4, v4, v198, v199
    v_smfmac_f32_16x16x64_bf16 v[76:79], v[212:215], v[132:139], v9
    v_max_u32 v4, v4, v5
    v_cmp_eq_u32 vcc, -1, v4
    v_smfmac_f32_16x16x64_bf16 v[80:83], v[212:215], v[164:171], v9
    s_cbranch_vccz .W_163
    s_branch .A_162
.W_167:
    v_smfmac_f32_16x16x64_bf16 v[76:79], v[200:203], a[208:215], v9
    v_smfmac_f32_16x16x64_bf16 v[80:83], v[200:203], a[240:247], v9
    s_waitcnt vmcnt(2)
    v_max3_u32 v4, v208, v209, v210
    v_max3_u32 v5, v211, v212, v213
    v_max3_u32 v4, v4, v214, v215
    v_smfmac_f32_16x16x64_bf16 v[76:79], v[204:207], a[216:223], v9
    v_max_u32 v4, v4, v5
    v_cmp_eq_u32 vcc, -1, v4
    v_smfmac_f32_16x16x64_bf16 v[80:83], v[204:207], a[248:255], v9
    s_cbranch_vccnz .A_170
.W_171:
    v_smfmac_f32_16x16x64_bf16 v[76:79], v[208:211], v[124:131], v9
    v_smfmac_f32_16x16x64_bf16 v[80:83], v[208:211], v[156:163], v9
    s_waitcnt vmcnt(0)
    v_max3_u32 v4, v192, v193, v194
    v_max3_u32 v5, v195, v196, v197
    v_max3_u32 v4, v4, v198, v199
    v_smfmac_f32_16x16x64_bf16 v[76:79], v[212:215], v[132:139], v9
    v_max_u32 v4, v4, v5
    v_cmp_eq_u32 vcc, -1, v4
    v_smfmac_f32_16x16x64_bf16 v[80:83], v[212:215], v[164:171], v9
    s_cbranch_vccz .W_159
    s_branch .A_158
.A_172:
    buffer_load_dwordx4 v[200:203], v246, s[8:11], s32 offen offset:2048 sc1
    buffer_load_dwordx4 v[204:207], v246, s[8:11], s32 offen offset:3072 sc1
    s_sub_u32 s62, s62, 1
    s_cbranch_scc1 .mg_end_1
    s_waitcnt vmcnt(4)
    v_max3_u32 v4, v216, v217, v218
    v_max3_u32 v5, v219, v220, v221
    v_max3_u32 v4, v4, v222, v223
    v_max_u32 v4, v4, v5
    v_cmp_eq_u32 vcc, -1, v4
    s_cbranch_vccz .W_161
.A_160:
    buffer_load_dwordx4 v[216:219], v246, s[8:11], s33 offen offset:2048 sc1
    buffer_load_dwordx4 v[220:223], v246, s[8:11], s33 offen offset:3072 sc1
    s_waitcnt vmcnt(4)
    v_max3_u32 v4, v192, v193, v194
    v_max3_u32 v5, v195, v196, v197
    v_max3_u32 v4, v4, v198, v199
    v_max_u32 v4, v4, v5
    v_cmp_eq_u32 vcc, -1, v4
    s_cbranch_vccz .W_173
.A_174:
    buffer_load_dwordx4 v[192:195], v246, s[8:11], s32 offen offset:0 sc1
    buffer_load_dwordx4 v[196:199], v246, s[8:11], s32 offen offset:1024 sc1
    s_waitcnt vmcnt(4)
    v_max3_u32 v4, v200, v201, v202
    v_max3_u32 v5, v203, v204, v205
    v_max3_u32 v4, v4, v206, v207
    v_max_u32 v4, v4, v5
    v_cmp_eq_u32 vcc, -1, v4
    s_cbranch_vccnz .A_172
.W_175:
    v_smfmac_f32_16x16x64_bf16 v[76:79], v[200:203], a[208:215], v9
    v_smfmac_f32_16x16x64_bf16 v[80:83], v[200:203], a[240:247], v9
    s_waitcnt vmcnt(2)
    v_max3_u32 v4, v216, v217, v218
    v_max3_u32 v5, v219, v220, v221
    v_max3_u32 v4, v4, v222, v223
    v_smfmac_f32_16x16x64_bf16 v[76:79], v[204:207], a[216:223], v9
    v_max_u32 v4, v4, v5
    v_cmp_eq_u32 vcc, -1, v4
    v_smfmac_f32_16x16x64_bf16 v[80:83], v[204:207], a[248:255], v9
    s_cbranch_vccz .W_157
    s_branch .A_156
.W_173:
    v_smfmac_f32_16x16x64_bf16 v[76:79], v[192:195], a[192:199], v9
    v_smfmac_f32_16x16x64_bf16 v[80:83], v[192:195], a[224:231], v9
    s_waitcnt vmcnt(2)
    v_max3_u32 v4, v200, v201, v202
    v_max3_u32 v5, v203, v204, v205
    v_max3_u32 v4, v4, v206, v207
    v_smfmac_f32_16x16x64_bf16 v[76:79], v[196:199], a[200:207], v9
    v_max_u32 v4, v4, v5
    v_cmp_eq_u32 vcc, -1, v4
    v_smfmac_f32_16x16x64_bf16 v[80:83], v[196:199], a[232:239], v9
    s_cbranch_vccnz .A_176
.W_177:
    v_smfmac_f32_16x16x64_bf16 v[76:79], v[200:203], a[208:215], v9
    v_smfmac_f32_16x16x64_bf16 v[80:83], v[200:203], a[240:247], v9
    s_waitcnt vmcnt(0)
    v_max3_u32 v4, v216, v217, v218
    v_max3_u32 v5, v219, v220, v221
    v_max3_u32 v4, v4, v222, v223
    v_smfmac_f32_16x16x64_bf16 v[76:79], v[204:207], a[216:223], v9
    v_max_u32 v4, v4, v5
    v_cmp_eq_u32 vcc, -1, v4
    v_smfmac_f32_16x16x64_bf16 v[80:83], v[204:207], a[248:255], v9
    s_cbranch_vccz .W_64
    s_branch .A_63
.A_178:
    buffer_load_dwordx4 v[216:219], v246, s[8:11], s33 offen offset:2048 sc1
    buffer_load_dwordx4 v[220:223], v246, s[8:11], s33 offen offset:3072 sc1
    s_sub_u32 s62, s62, 1
    s_cbranch_scc1 .mg_end_1
    s_waitcnt vmcnt(4)
    v_max3_u32 v4, v192, v193, v194
    v_max3_u32 v5, v195, v196, v197
    v_max3_u32 v4, v4, v198, v199
    v_max_u32 v4, v4, v5
    v_cmp_eq_u32 vcc, -1, v4
    s_cbranch_vccz .W_179
.A_180:
    buffer_load_dwordx4 v[192:195], v246, s[8:11], s32 offen offset:0 sc1
    buffer_load_dwordx4 v[196:199], v246, s[8:11], s32 offen offset:1024 sc1
    s_waitcnt vmcnt(4)
    v_max3_u32 v4, v208, v209, v210
    v_max3_u32 v5, v211, v212, v213
    v_max3_u32 v4, v4, v214, v215
    v_max_u32 v4, v4, v5
    v_cmp_eq_u32 vcc, -1, v4
    s_cbranch_vccz .W_155
.A_154:
    buffer_load_dwordx4 v[208:211], v246, s[8:11], s33 offen offset:0 sc1
    buffer_load_dwordx4 v[212:215], v246, s[8:11], s33 offen offset:1024 sc1
    s_waitcnt vmcnt(4)
    v_max3_u32 v4, v216, v217, v218
    v_max3_u32 v5, v219, v220, v221
    v_max3_u32 v4, v4, v222, v223
    v_max_u32 v4, v4, v5
    v_cmp_eq_u32 vcc, -1, v4
    s_cbranch_vccnz .A_178
.W_181:
    v_smfmac_f32_16x16x64_bf16 v[76:79], v[216:219], v[140:147], v9
    v_smfmac_f32_16x16x64_bf16 v[80:83], v[216:219], v[172:179], v9
    s_waitcnt vmcnt(2)
    v_max3_u32 v4, v192, v193, v194
    v_max3_u32 v5, v195, v196, v197
    v_max3_u32 v4, v4, v198, v199
    v_smfmac_f32_16x16x64_bf16 v[76:79], v[220:223], v[148:155], v9
    v_max_u32 v4, v4, v5
    v_cmp_eq_u32 vcc, -1, v4
    v_smfmac_f32_16x16x64_bf16 v[80:83], v[220:223], v[180:187], v9
    s_cbranch_vccnz .A_182
.W_183:
    v_smfmac_f32_16x16x64_bf16 v[76:79], v[192:195], a[192:199], v9
    v_smfmac_f32_16x16x64_bf16 v[80:83], v[192:195], a[224:231], v9
    s_waitcnt vmcnt(0)
    v_max3_u32 v4, v208, v209, v210
    v_max3_u32 v5, v211, v212, v213
    v_max3_u32 v4, v4, v214, v215
    v_smfmac_f32_16x16x64_bf16 v[76:79], v[196:199], a[200:207], v9
    v_max_u32 v4, v4, v5
    v_cmp_eq_u32 vcc, -1, v4
    v_smfmac_f32_16x16x64_bf16 v[80:83], v[196:199], a[232:239], v9
    s_cbranch_vccz .W_153
    s_branch .A_152
.W_179:
    v_smfmac_f32_16x16x64_bf16 v[76:79], v[192:195], a[192:199], v9
    v_smfmac_f32_16x16x64_bf16 v[80:83], v[192:195], a[224:231], v9
    s_waitcnt vmcnt(2)
    v_max3_u32 v4, v208, v209, v210
    v_max3_u32 v5, v211, v212, v213
    v_max3_u32 v4, v4, v214, v215
    v_smfmac_f32_16x16x64_bf16 v[76:79], v[196:199], a[200:207], v9
    v_max_u32 v4, v4, v5
    v_cmp_eq_u32 vcc, -1, v4
    v_smfmac_f32_16x16x64_bf16 v[80:83], v[196:199], a[232:239], v9
    s_cbranch_vccz .W_62
    s_branch .A_61
.A_184:
    buffer_load_dwordx4 v[216:219], v246, s[8:11], s33 offen offset:2048 sc1
    buffer_load_dwordx4 v[220:223], v246, s[8:11], s33 offen offset:3072 sc1
    s_sub_u32 s62, s62, 1
    s_cbranch_scc1 .mg_end_1
    s_waitcnt vmcnt(4)
    v_max3_u32 v4, v200, v201, v202
    v_max3_u32 v5, v203, v204, v205
    v_max3_u32 v4, v4, v206, v207
    v_max_u32 v4, v4, v5
    v_cmp_eq_u32 vcc, -1, v4
    s_cbranch_vccz .W_60
.A_59:
    buffer_load_dwordx4 v[200:203], v246, s[8:11], s32 offen offset:2048 sc1
    buffer_load_dwordx4 v[204:207], v246, s[8:11], s32 offen offset:3072 sc1
    s_waitcnt vmcnt(4)
    v_max3_u32 v4, v208, v209, v210
    v_max3_u32 v5, v211, v212, v213
    v_max3_u32 v4, v4, v214, v215
    v_max_u32 v4, v4, v5
    v_cmp_eq_u32 vcc, -1, v4
    s_cbranch_vccz .W_185
.A_186:
    buffer_load_dwordx4 v[208:211], v246, s[8:11], s33 offen offset:0 sc1
    buffer_load_dwordx4 v[212:215], v246, s[8:11], s33 offen offset:1024 sc1
    s_waitcnt vmcnt(4)
    v_max3_u32 v4, v216, v217, v218
    v_max3_u32 v5, v219, v220, v221
    v_max3_u32 v4, v4, v222, v223
    v_max_u32 v4, v4, v5
    v_cmp_eq_u32 vcc, -1, v4
    s_cbranch_vccnz .A_184
.W_187:
    v_smfmac_f32_16x16x64_bf16 v[76:79], v[216:219], v[140:147], v9
    v_smfmac_f32_16x16x64_bf16 v[80:83], v[216:219], v[172:179], v9
    s_waitcnt vmcnt(2)
    v_max3_u32 v4, v200, v201, v202
    v_max3_u32 v5, v203, v204, v205
    v_max3_u32 v4, v4, v206, v207
    v_smfmac_f32_16x16x64_bf16 v[76:79], v[220:223], v[148:155], v9
    v_max_u32 v4, v4, v5
    v_cmp_eq_u32 vcc, -1, v4
    v_smfmac_f32_16x16x64_bf16 v[80:83], v[220:223], v[180:187], v9
    s_cbranch_vccz .W_151
    s_branch .A_150
.W_185:
    v_smfmac_f32_16x16x64_bf16 v[76:79], v[208:211], v[124:131], v9
    v_smfmac_f32_16x16x64_bf16 v[80:83], v[208:211], v[156:163], v9
    s_waitcnt vmcnt(2)
    v_max3_u32 v4, v216, v217, v218
    v_max3_u32 v5, v219, v220, v221
    v_max3_u32 v4, v4, v222, v223
    v_smfmac_f32_16x16x64_bf16 v[76:79], v[212:215], v[132:139], v9
    v_max_u32 v4, v4, v5
    v_cmp_eq_u32 vcc, -1, v4
    v_smfmac_f32_16x16x64_bf16 v[80:83], v[212:215], v[164:171], v9
    s_cbranch_vccnz .A_188
.W_189:
    v_smfmac_f32_16x16x64_bf16 v[76:79], v[216:219], v[140:147], v9
    v_smfmac_f32_16x16x64_bf16 v[80:83], v[216:219], v[172:179], v9
    s_waitcnt vmcnt(0)
    v_max3_u32 v4, v200, v201, v202
    v_max3_u32 v5, v203, v204, v205
    v_max3_u32 v4, v4, v206, v207
    v_smfmac_f32_16x16x64_bf16 v[76:79], v[220:223], v[148:155], v9
    v_max_u32 v4, v4, v5
    v_cmp_eq_u32 vcc, -1, v4
    v_smfmac_f32_16x16x64_bf16 v[80:83], v[220:223], v[180:187], v9
    s_cbranch_vccz .W_165
    s_branch .A_164
.A_190:
    buffer_load_dwordx4 v[200:203], v246, s[8:11], s32 offen offset:2048 sc1
    buffer_load_dwordx4 v[204:207], v246, s[8:11], s32 offen offset:3072 sc1
    s_sub_u32 s62, s62, 1
    s_cbranch_scc1 .mg_end_1
    s_waitcnt vmcnt(2)
    v_max3_u32 v4, v192, v193, v194
    v_max3_u32 v5, v195, v196, v197
    v_max3_u32 v4, v4, v198, v199
    v_max_u32 v4, v4, v5
    v_cmp_eq_u32 vcc, -1, v4
    s_cbranch_vccz .W_163
.A_162:
    buffer_load_dwordx4 v[192:195], v246, s[8:11], s32 offen offset:0 sc1
    buffer_load_dwordx4 v[196:199], v246, s[8:11], s32 offen offset:1024 sc1
    s_waitcnt vmcnt(2)
    v_max3_u32 v4, v200, v201, v202
    v_max3_u32 v5, v203, v204, v205
    v_max3_u32 v4, v4, v206, v207
    v_max_u32 v4, v4, v5
    v_cmp_eq_u32 vcc, -1, v4
    s_cbranch_vccnz .A_190
.W_191:
    v_smfmac_f32_16x16x64_bf16 v[76:79], v[200:203], a[208:215], v9
    v_smfmac_f32_16x16x64_bf16 v[80:83], v[200:203], a[240:247], v9
    s_waitcnt vmcnt(0)
    v_max3_u32 v4, v192, v193, v194
    v_max3_u32 v5, v195, v196, v197
    v_max3_u32 v4, v4, v198, v199
    v_smfmac_f32_16x16x64_bf16 v[76:79], v[204:207], a[216:223], v9
    v_max_u32 v4, v4, v5
    v_cmp_eq_u32 vcc, -1, v4
    v_smfmac_f32_16x16x64_bf16 v[80:83], v[204:207], a[248:255], v9
    s_cbranch_vccz .W_159
    s_branch .A_158
.A_170:
    buffer_load_dwordx4 v[208:211], v246, s[8:11], s33 offen offset:0 sc1
    buffer_load_dwordx4 v[212:215], v246, s[8:11], s33 offen offset:1024 sc1
    s_sub_u32 s62, s62, 1
    s_cbranch_scc1 .mg_end_1
    s_waitcnt vmcnt(2)
    v_max3_u32 v4, v192, v193, v194
    v_max3_u32 v5, v195, v196, v197
    v_max3_u32 v4, v4, v198, v199
    v_max_u32 v4, v4, v5
    v_cmp_eq_u32 vcc, -1, v4
    s_cbranch_vccz .W_183
.A_182:
    buffer_load_dwordx4 v[192:195], v246, s[8:11], s32 offen offset:0 sc1
    buffer_load_dwordx4 v[196:199], v246, s[8:11], s32 offen offset:1024 sc1
    s_waitcnt vmcnt(2)
    v_max3_u32 v4, v208, v209, v210
    v_max3_u32 v5, v211, v212, v213
    v_max3_u32 v4, v4, v214, v215
    v_max_u32 v4, v4, v5
    v_cmp_eq_u32 vcc, -1, v4
    s_cbranch_vccnz .A_170
    s_branch .W_171
.A_192:
    buffer_load_dwordx4 v[192:195], v246, s[8:11], s32 offen offset:0 sc1
    buffer_load_dwordx4 v[196:199], v246, s[8:11], s32 offen offset:1024 sc1
    s_sub_u32 s62, s62, 1
    s_cbranch_scc1 .mg_end_1
    s_waitcnt vmcnt(2)
    v_max3_u32 v4, v216, v217, v218
    v_max3_u32 v5, v219, v220, v221
    v_max3_u32 v4, v4, v222, v223
    v_max_u32 v4, v4, v5
    v_cmp_eq_u32 vcc, -1, v4
    s_cbranch_vccz .W_157
.A_156:
    buffer_load_dwordx4 v[216:219], v246, s[8:11], s33 offen offset:2048 sc1
    buffer_load_dwordx4 v[220:223], v246, s[8:11], s33 offen offset:3072 sc1
    s_waitcnt vmcnt(2)
    v_max3_u32 v4, v192, v193, v194
    v_max3_u32 v5, v195, v196, v197
    v_max3_u32 v4, v4, v198, v199
    v_max_u32 v4, v4, v5
    v_cmp_eq_u32 vcc, -1, v4
    s_cbranch_vccnz .A_192
.W_193:
    v_smfmac_f32_16x16x64_bf16 v[76:79], v[192:195], a[192:199], v9
    v_smfmac_f32_16x16x64_bf16 v[80:83], v[192:195], a[224:231], v9
    s_waitcnt vmcnt(0)
    v_max3_u32 v4, v216, v217, v218
    v_max3_u32 v5, v219, v220, v221
    v_max3_u32 v4, v4, v222, v223
    v_smfmac_f32_16x16x64_bf16 v[76:79], v[196:199], a[200:207], v9
    v_max_u32 v4, v4, v5
    v_cmp_eq_u32 vcc, -1, v4
    v_smfmac_f32_16x16x64_bf16 v[80:83], v[196:199], a[232:239], v9
    s_cbranch_vccz .W_64
    s_branch .A_63
.A_194:
    buffer_load_dwordx4 v[208:211], v246, s[8:11], s33 offen offset:0 sc1
    buffer_load_dwordx4 v[212:215], v246, s[8:11], s33 offen offset:1024 sc1
    s_sub_u32 s62, s62, 1
    s_cbranch_scc1 .mg_end_1
    s_waitcnt vmcnt(2)
    v_max3_u32 v4, v200, v201, v202
    v_max3_u32 v5, v203, v204, v205
    v_max3_u32 v4, v4, v206, v207
    v_max_u32 v4, v4, v5
    v_cmp_eq_u32 vcc, -1, v4
    s_cbranch_vccz .W_151
.A_150:
    buffer_load_dwordx4 v[200:203], v246, s[8:11], s32 offen offset:2048 sc1
    buffer_load_dwordx4 v[204:207], v246, s[8:11], s32 offen offset:3072 sc1
    s_waitcnt vmcnt(2)
    v_max3_u32 v4, v208, v209, v210
    v_max3_u32 v5, v211, v212, v213
    v_max3_u32 v4, v4, v214, v215
    v_max_u32 v4, v4, v5
    v_cmp_eq_u32 vcc, -1, v4
    s_cbranch_vccnz .A_194
.W_195:
    v_smfmac_f32_16x16x64_bf16 v[76:79], v[208:211], v[124:131], v9
    v_smfmac_f32_16x16x64_bf16 v[80:83], v[208:211], v[156:163], v9
    s_waitcnt vmcnt(0)
    v_max3_u32 v4, v200, v201, v202
    v_max3_u32 v5, v203, v204, v205
    v_max3_u32 v4, v4, v206, v207
    v_smfmac_f32_16x16x64_bf16 v[76:79], v[212:215], v[132:139], v9
    v_max_u32 v4, v4, v5
    v_cmp_eq_u32 vcc, -1, v4
    v_smfmac_f32_16x16x64_bf16 v[80:83], v[212:215], v[164:171], v9
    s_cbranch_vccz .W_165
    s_branch .A_164
.A_188:
    buffer_load_dwordx4 v[216:219], v246, s[8:11], s33 offen offset:2048 sc1
    buffer_load_dwordx4 v[220:223], v246, s[8:11], s33 offen offset:3072 sc1
    s_sub_u32 s62, s62, 1
    s_cbranch_scc1 .mg_end_1
    s_waitcnt vmcnt(2)
    v_max3_u32 v4, v200, v201, v202
    v_max3_u32 v5, v203, v204, v205
    v_max3_u32 v4, v4, v206, v207
    v_max_u32 v4, v4, v5
    v_cmp_eq_u32 vcc, -1, v4
    s_cbranch_vccz .W_177
.A_176:
    buffer_load_dwordx4 v[200:203], v246, s[8:11], s32 offen offset:2048 sc1
    buffer_load_dwordx4 v[204:207], v246, s[8:11], s32 offen offset:3072 sc1
    s_waitcnt vmcnt(2)
    v_max3_u32 v4, v216, v217, v218
    v_max3_u32 v5, v219, v220, v221
    v_max3_u32 v4, v4, v222, v223
    v_max_u32 v4, v4, v5
    v_cmp_eq_u32 vcc, -1, v4
    s_cbranch_vccnz .A_188
    s_branch .W_189
.A_196:
    buffer_load_dwordx4 v[216:219], v246, s[8:11], s33 offen offset:2048 sc1
    buffer_load_dwordx4 v[220:223], v246, s[8:11], s33 offen offset:3072 sc1
    s_sub_u32 s62, s62, 1
    s_cbranch_scc1 .mg_end_1
    s_waitcnt vmcnt(2)
    v_max3_u32 v4, v208, v209, v210
    v_max3_u32 v5, v211, v212, v213
    v_max3_u32 v4, v4, v214, v215
    v_max_u32 v4, v4, v5
    v_cmp_eq_u32 vcc, -1, v4
    s_cbranch_vccz .W_62
.A_61:
    buffer_load_dwordx4 v[208:211], v246, s[8:11], s33 offen offset:0 sc1
    buffer_load_dwordx4 v[212:215], v246, s[8:11], s33 offen offset:1024 sc1
    s_waitcnt vmcnt(2)
    v_max3_u32 v4, v216, v217, v218
    v_max3_u32 v5, v219, v220, v221
    v_max3_u32 v4, v4, v222, v223
    v_max_u32 v4, v4, v5
    v_cmp_eq_u32 vcc, -1, v4
    s_cbranch_vccnz .A_196
.W_197:
    v_smfmac_f32_16x16x64_bf16 v[76:79], v[216:219], v[140:147], v9
    v_smfmac_f32_16x16x64_bf16 v[80:83], v[216:219], v[172:179], v9
    s_waitcnt vmcnt(0)
    v_max3_u32 v4, v208, v209, v210
    v_max3_u32 v5, v211, v212, v213
    v_max3_u32 v4, v4, v214, v215
    v_smfmac_f32_16x16x64_bf16 v[76:79], v[220:223], v[148:155], v9
    v_max_u32 v4, v4, v5
    v_cmp_eq_u32 vcc, -1, v4
    v_smfmac_f32_16x16x64_bf16 v[80:83], v[220:223], v[180:187], v9
    s_cbranch_vccz .W_153
    s_branch .A_152
.A_158:
    buffer_load_dwordx4 v[192:195], v246, s[8:11], s32 offen offset:0 sc1
    buffer_load_dwordx4 v[196:199], v246, s[8:11], s32 offen offset:1024 sc1
    s_sub_u32 s62, s62, 1
    s_cbranch_scc1 .mg_end_1
    s_waitcnt vmcnt(2)
    v_max3_u32 v4, v192, v193, v194
    v_max3_u32 v5, v195, v196, v197
    v_max3_u32 v4, v4, v198, v199
    v_max_u32 v4, v4, v5
    v_cmp_eq_u32 vcc, -1, v4
    s_cbranch_vccnz .A_158
    v_smfmac_f32_16x16x64_bf16 v[76:79], v[192:195], a[192:199], v9
    v_smfmac_f32_16x16x64_bf16 v[80:83], v[192:195], a[224:231], v9
    v_smfmac_f32_16x16x64_bf16 v[76:79], v[196:199], a[200:207], v9
    v_smfmac_f32_16x16x64_bf16 v[80:83], v[196:199], a[232:239], v9
    s_branch .mj_56
.A_164:
    buffer_load_dwordx4 v[200:203], v246, s[8:11], s32 offen offset:2048 sc1
    buffer_load_dwordx4 v[204:207], v246, s[8:11], s32 offen offset:3072 sc1
    s_sub_u32 s62, s62, 1
    s_cbranch_scc1 .mg_end_1
    s_waitcnt vmcnt(2)
    v_max3_u32 v4, v200, v201, v202
    v_max3_u32 v5, v203, v204, v205
    v_max3_u32 v4, v4, v206, v207
    v_max_u32 v4, v4, v5
    v_cmp_eq_u32 vcc, -1, v4
    s_cbranch_vccnz .A_164
    v_smfmac_f32_16x16x64_bf16 v[76:79], v[200:203], a[208:215], v9
    v_smfmac_f32_16x16x64_bf16 v[80:83], v[200:203], a[240:247], v9
    v_smfmac_f32_16x16x64_bf16 v[76:79], v[204:207], a[216:223], v9
    v_smfmac_f32_16x16x64_bf16 v[80:83], v[204:207], a[248:255], v9
    s_branch .mj_56
.A_152:
    buffer_load_dwordx4 v[208:211], v246, s[8:11], s33 offen offset:0 sc1
    buffer_load_dwordx4 v[212:215], v246, s[8:11], s33 offen offset:1024 sc1
    s_sub_u32 s62, s62, 1
    s_cbranch_scc1 .mg_end_1
    s_waitcnt vmcnt(2)
    v_max3_u32 v4, v208, v209, v210
    v_max3_u32 v5, v211, v212, v213
    v_max3_u32 v4, v4, v214, v215
    v_max_u32 v4, v4, v5
    v_cmp_eq_u32 vcc, -1, v4
    s_cbranch_vccnz .A_152
    v_smfmac_f32_16x16x64_bf16 v[76:79], v[208:211], v[124:131], v9
    v_smfmac_f32_16x16x64_bf16 v[80:83], v[208:211], v[156:163], v9
    v_smfmac_f32_16x16x64_bf16 v[76:79], v[212:215], v[132:139], v9
    v_smfmac_f32_16x16x64_bf16 v[80:83], v[212:215], v[164:171], v9
    s_branch .mj_56
.A_63:
    buffer_load_dwordx4 v[216:219], v246, s[8:11], s33 offen offset:2048 sc1
    buffer_load_dwordx4 v[220:223], v246, s[8:11], s33 offen offset:3072 sc1
    s_sub_u32 s62, s62, 1
    s_cbranch_scc1 .mg_end_1
    s_waitcnt vmcnt(2)
    v_max3_u32 v4, v216, v217, v218
    v_max3_u32 v5, v219, v220, v221
    v_max3_u32 v4, v4, v222, v223
    v_max_u32 v4, v4, v5
    v_cmp_eq_u32 vcc, -1, v4
    s_cbranch_vccnz .A_63
    v_smfmac_f32_16x16x64_bf16 v[76:79], v[216:219], v[140:147], v9
    v_smfmac_f32_16x16x64_bf16 v[80:83], v[216:219], v[172:179], v9
    v_smfmac_f32_16x16x64_bf16 v[76:79], v[220:223], v[148:155], v9
    v_smfmac_f32_16x16x64_bf16 v[80:83], v[220:223], v[180:187], v9
    s_branch .mj_56
.sk_65:
    s_mov_b64 exec, s[66:67]
    buffer_store_dwordx4 v[88:91], v11, s[8:11], s36 offen sc1
    s_mov_b64 exec, s[56:57]
    buffer_store_dwordx4 v[172:175], v12, s[8:11], s36 offen sc1
    s_mov_b64 exec, -1

    s_branch .rec_fin_6
.p2align 6
.top_198:
    s_barrier
    buffer_load_dwordx4 v[20:23], v8, s[8:11], s29 offen offset:0 sc1
    v_mov_b32 v52, 0
    buffer_load_dwordx4 v[24:27], v8, s[8:11], s29 offen offset:1024 sc1
    v_mov_b32 v53, 0
    buffer_load_dwordx4 v[28:31], v8, s[8:11], s29 offen offset:2048 sc1
    v_mov_b32 v54, 0
    buffer_load_dwordx4 v[32:35], v8, s[8:11], s29 offen offset:3072 sc1
.ent1_25:
    s_waitcnt vmcnt(3)
    v_max3_u32 v4, v20, v21, v22
    v_max_u32 v4, v4, v23
    v_cmp_eq_u32 vcc, -1, v4
    s_cbranch_vccnz .A_203
.W_204:
    v_smfmac_f32_16x16x64_bf16 v[52:55], v[20:23], a[0:7], v9
    v_smfmac_f32_16x16x64_bf16 v[56:59], v[20:23], a[32:39], v9
    s_waitcnt vmcnt(2)
    v_max3_u32 v4, v24, v25, v26
    v_max_u32 v4, v4, v27
    v_smfmac_f32_16x16x64_bf16 v[60:63], v[20:23], a[64:71], v9
    v_cmp_eq_u32 vcc, -1, v4
    v_smfmac_f32_16x16x64_bf16 v[64:67], v[20:23], a[96:103], v9
    s_cbranch_vccnz .A_205
.W_206:
    v_smfmac_f32_16x16x64_bf16 v[52:55], v[24:27], a[8:15], v9
    v_smfmac_f32_16x16x64_bf16 v[56:59], v[24:27], a[40:47], v9
    s_waitcnt vmcnt(1)
    v_max3_u32 v4, v28, v29, v30
    v_max_u32 v4, v4, v31
    v_smfmac_f32_16x16x64_bf16 v[60:63], v[24:27], a[72:79], v9
    v_cmp_eq_u32 vcc, -1, v4
    v_smfmac_f32_16x16x64_bf16 v[64:67], v[24:27], a[104:111], v9
    s_cbranch_vccnz .A_207
.W_208:
    v_smfmac_f32_16x16x64_bf16 v[52:55], v[28:31], a[16:23], v9
    v_smfmac_f32_16x16x64_bf16 v[56:59], v[28:31], a[48:55], v9
    s_waitcnt vmcnt(0)
    v_max3_u32 v4, v32, v33, v34
    v_max_u32 v4, v4, v35
    v_smfmac_f32_16x16x64_bf16 v[60:63], v[28:31], a[80:87], v9
    v_cmp_eq_u32 vcc, -1, v4
    v_smfmac_f32_16x16x64_bf16 v[64:67], v[28:31], a[112:119], v9
    s_cbranch_vccnz .A_209
.W_210:
    v_smfmac_f32_16x16x64_bf16 v[52:55], v[32:35], a[24:31], v9
    v_smfmac_f32_16x16x64_bf16 v[56:59], v[32:35], a[56:63], v9
    v_smfmac_f32_16x16x64_bf16 v[60:63], v[32:35], a[88:95], v9
    v_smfmac_f32_16x16x64_bf16 v[64:67], v[32:35], a[120:127], v9
.mj_202:
    v_cvt_pk_bf16_f32 v104, v52, v53
    v_cvt_pk_bf16_f32 v105, v54, v55
    v_cvt_pk_bf16_f32 v106, v56, v57
    v_cvt_pk_bf16_f32 v107, v58, v59
    ds_write_b64 v16, v[104:105] offset:4096
    v_cvt_pk_bf16_f32 v108, v60, v61
    v_cvt_pk_bf16_f32 v109, v62, v63
    ds_write_b64 v16, v[106:107] offset:6144
    ds_write_b64 v16, v[108:109] offset:0
    v_cvt_pk_bf16_f32 v110, v64, v65
    v_cvt_pk_bf16_f32 v111, v66, v67
    ds_write_b64 v16, v[110:111] offset:2048
    v_smfmac_f32_16x16x64_bf16 v[68:71], v[20:23], a[128:135], v9
    v_smfmac_f32_16x16x64_bf16 v[72:75], v[20:23], a[160:167], v9
    s_waitcnt lgkmcnt(0)
    s_barrier
    ds_read_b128 v[36:39], v17 offset:0
    ds_read_b128 v[40:43], v17 offset:1024
    v_smfmac_f32_16x16x64_bf16 v[68:71], v[24:27], a[136:143], v9
    v_smfmac_f32_16x16x64_bf16 v[72:75], v[24:27], a[168:175], v9
    s_waitcnt lgkmcnt(1)
    v_mfma_f32_16x16x32_bf16 v[44:47], v[36:39], v[84:87], 0
    s_waitcnt lgkmcnt(0)
    v_mfma_f32_16x16x32_bf16 v[44:47], v[40:43], v[84:87], v[44:47]
    v_smfmac_f32_16x16x64_bf16 v[68:71], v[28:31], a[144:151], v9
    v_smfmac_f32_16x16x64_bf16 v[72:75], v[28:31], a[176:183], v9
    s_mov_b64 exec, s[64:65]
    v_cvt_pk_bf16_f32 v48, v44, v45
    v_cvt_pk_bf16_f32 v49, v46, v47
    v_min_u32 v48, 0xfffffffe, v48
    v_min_u32 v49, 0xfffffffe, v49
    buffer_store_dwordx2 v[48:49], v10, s[8:11], s29 offen sc1

    ds_write_b64 v18, v[48:49]
    s_mov_b64 exec, -1

    v_smfmac_f32_16x16x64_bf16 v[68:71], v[32:35], a[152:159], v9
    v_smfmac_f32_16x16x64_bf16 v[72:75], v[32:35], a[184:191], v9
    s_nop 3
    v_cvt_pk_bf16_f32 v104, v68, v69
    v_cvt_pk_bf16_f32 v105, v70, v71
    ds_write_b64 v16, v[104:105] offset:8192
    s_nop 0
    v_cvt_pk_bf16_f32 v106, v72, v73
    v_cvt_pk_bf16_f32 v107, v74, v75
    ds_write_b64 v16, v[106:107] offset:10240
    s_cmp_lg_u32 s24, 2
    s_waitcnt lgkmcnt(0)
    s_barrier
    s_cbranch_scc1 .oth_199
    buffer_load_dwordx4 v[92:95], v232, s[8:11], s29 offen sc1
    buffer_load_dwordx4 v[96:99], v233, s[8:11], s29 offen sc1
    buffer_load_dwordx4 v[100:103], v234, s[8:11], s29 offen sc1
    ds_read_b128 v[88:91], v14 offset:16384
    s_cmp_eq_u32 s28, 63
    s_cbranch_scc1 .rec_fin_6
    s_waitcnt lgkmcnt(0)
    v_mfma_f32_16x16x32_bf16 v[208:211], v[128:131], v[88:91], 0
    v_mfma_f32_16x16x32_bf16 v[212:215], v[144:147], v[88:91], 0
    v_mfma_f32_16x16x32_bf16 v[216:219], v[88:91], v[88:91], v[116:119]
    s_waitcnt vmcnt(2)
    v_max3_u32 v4, v92, v93, v94
    v_max_u32 v4, v4, v95
    v_cmp_eq_u32 vcc, -1, v4
    s_cbranch_vccnz .A_212
.W_213:
    v_mfma_f32_16x16x32_bf16 v[208:211], v[132:135], v[92:95], v[208:211]
    s_waitcnt vmcnt(1)
    v_max3_u32 v4, v96, v97, v98
    v_max_u32 v4, v4, v99
    v_mfma_f32_16x16x32_bf16 v[212:215], v[148:151], v[92:95], v[212:215]
    v_cmp_eq_u32 vcc, -1, v4
    v_mfma_f32_16x16x32_bf16 v[216:219], v[92:95], v[92:95], v[216:219]
    s_cbranch_vccnz .A_214
.W_215:
    v_mfma_f32_16x16x32_bf16 v[208:211], v[136:139], v[96:99], v[208:211]
    s_waitcnt vmcnt(0)
    v_max3_u32 v4, v100, v101, v102
    v_max_u32 v4, v4, v103
    v_mfma_f32_16x16x32_bf16 v[212:215], v[152:155], v[96:99], v[212:215]
    v_cmp_eq_u32 vcc, -1, v4
    v_mfma_f32_16x16x32_bf16 v[216:219], v[96:99], v[96:99], v[216:219]
    s_cbranch_vccnz .A_216
.W_217:
    v_mfma_f32_16x16x32_bf16 v[208:211], v[140:143], v[100:103], v[208:211]
    v_mfma_f32_16x16x32_bf16 v[212:215], v[156:159], v[100:103], v[212:215]
    v_mfma_f32_16x16x32_bf16 v[216:219], v[100:103], v[100:103], v[216:219]
.mj_211:
    s_barrier
    ds_read_b64 v[168:169], v14 offset:18432
    ds_read_b64 v[172:173], v14 offset:18440
    s_nop 0

    v_mov_b32_dpp v208, v212 row_ror:8 row_mask:0xf bank_mask:0xc
    v_mov_b32_dpp v209, v213 row_ror:8 row_mask:0xf bank_mask:0xc
    v_mov_b32_dpp v210, v214 row_ror:8 row_mask:0xf bank_mask:0xc
    v_mov_b32_dpp v211, v215 row_ror:8 row_mask:0xf bank_mask:0xc
    v_mov_b32_dpp v216, v218 row_ror:8 row_mask:0xf bank_mask:0xc
    v_mov_b32_dpp v217, v219 row_ror:8 row_mask:0xf bank_mask:0xc
    v_max3_f32 v4, v208, v209, v210
    v_max3_f32 v5, v211, v216, v217
    v_max_f32 v6, v4, v5
    v_max_f32 v4, v4, v5
    s_nop 1
    v_permlane32_swap_b32 v4, v6
    v_max_f32 v5, v4, v6
    v_max_f32 v4, v4, v6
    s_nop 1
    v_permlane16_swap_b32 v4, v5
    v_max_f32 v4, v4, v5
    s_nop 1
    v_max_f32_dpp v4, v4, v4 row_ror:8 row_mask:0xf bank_mask:0xf
    v_mul_f32 v4, s37, v4

    v_fma_f32 v104, v208, s37, -v4
    v_fma_f32 v105, v209, s37, -v4
    v_fma_f32 v106, v210, s37, -v4
    v_fma_f32 v107, v211, s37, -v4
    v_fma_f32 v108, v216, s37, -v4
    v_fma_f32 v109, v217, s37, -v4
    v_exp_f32 v104, v104
    v_exp_f32 v105, v105
    v_exp_f32 v106, v106
    v_exp_f32 v107, v107
    v_exp_f32 v108, v108
    v_exp_f32 v109, v109
    v_cvt_pk_bf16_f32 v176, v104, v105
    v_cvt_pk_bf16_f32 v177, v106, v107
    v_cvt_pk_bf16_f32 v180, v108, v109
    v_mov_b32_dpp v178, v176 row_ror:8 row_mask:0xf bank_mask:0xf
    v_mov_b32_dpp v179, v177 row_ror:8 row_mask:0xf bank_mask:0xf
    v_mov_b32_dpp v181, v180 row_ror:8 row_mask:0xf bank_mask:0xf
    s_waitcnt lgkmcnt(0)

    v_mfma_f32_16x16x32_bf16 v[208:211], v[120:123], v[176:179], 0
    v_mfma_f32_16x16x32_bf16 v[208:211], v[120:123], v[180:183], v[208:211]
    v_mfma_f32_16x16x32_bf16 v[212:215], v[160:163], v[176:179], 0
    v_mfma_f32_16x16x32_bf16 v[216:219], v[164:167], v[176:179], 0
    v_mfma_f32_16x16x32_bf16 v[212:215], v[168:171], v[180:183], v[212:215]
    v_rcp_f32 v4, v208
    v_mfma_f32_16x16x32_bf16 v[216:219], v[172:175], v[180:183], v[216:219]
    s_mov_b64 exec, s[58:59]
    s_nop 2
    v_mul_f32 v212, v4, v212
    v_mul_f32 v213, v4, v213
    v_mul_f32 v214, v4, v214
    v_mul_f32 v215, v4, v215
    v_cvt_pk_bf16_f32 v184, v212, v213
    v_cvt_pk_bf16_f32 v185, v214, v215
    v_mul_f32 v216, v4, v216
    v_mul_f32 v217, v4, v217
    v_min_u32 v184, 0xfffffffe, v184
    v_min_u32 v185, 0xfffffffe, v185
    v_mul_f32 v218, v4, v218
    v_mul_f32 v219, v4, v219
    v_cvt_pk_bf16_f32 v186, v216, v217
    v_cvt_pk_bf16_f32 v187, v218, v219
    v_min_u32 v186, 0xfffffffe, v186
    v_min_u32 v187, 0xfffffffe, v187
    buffer_store_dwordx4 v[184:187], v13, s[8:11], s29 offen sc1
    s_mov_b64 exec, -1

.gp_201:
    s_barrier
    v_mov_b32 v5, 19968
    ds_read_b32 v4, v5
    s_mov_b32 s99, s68
    s_waitcnt vmcnt(0)
    s_cmp_eq_u32 s24, 3
    s_cbranch_scc1 .u3_218
    s_add_u32 s6, s28, 3
    s_add_u32 s7, s30, 262144
    s_waitcnt lgkmcnt(0)
    v_readfirstlane_b32 s5, v4
    s_cmp_lt_u32 s5, s6
    s_barrier
    s_cbranch_scc1 .np_220
    buffer_load_dword v226, v225, s[8:11], s7 offen

.np_220:
    s_add_u32 s4, s70, 0
    buffer_store_dwordx4 v[188:191], v238, s[8:11], s4 offen sc1
    s_add_u32 s4, s70, 262144
    buffer_store_dwordx4 v[188:191], v238, s[8:11], s4 offen sc1
    s_branch .u4_219
.u3_218:
    s_sub_u32 s4, s36, 0
    s_barrier
    s_mov_b64 exec, s[66:67]
    buffer_store_dwordx4 v[88:91], v11, s[8:11], s4 offen sc1
    s_mov_b64 exec, s[56:57]
    buffer_store_dwordx4 v[172:175], v12, s[8:11], s4 offen sc1
    s_mov_b64 exec, -1

.u4_219:
    s_barrier
    s_add_u32 s28, s28, 1
    s_add_u32 s36, s36, 196608
    s_cmp_lt_u32 s28, 63
    s_cselect_b32 s4, 262144, 0
    s_add_u32 s38, s38, s4
    s_add_u32 s39, s39, s4
    s_add_u32 s30, s30, s4
    s_mov_b32 s4, s68
    s_mov_b32 s68, s69
    s_mov_b32 s69, s70
    s_mov_b32 s70, s71
    s_mov_b32 s71, s4
    s_and_b32 s4, s28, 3
    s_lshl_b32 s5, s4, 16
    s_add_u32 s29, s5, s34
    s_xor_b32 s6, s5, 0x20000
    s_add_u32 s31, s6, s34
    s_add_u32 s32, s29, 16384
    s_add_u32 s33, s29, 20480
    v_mov_b32 v55, 0
    v_mov_b32 v56, 0
    v_mov_b32 v57, 0
    v_mov_b32 v58, 0
    v_mov_b32 v59, 0
    v_mov_b32 v60, 0
    v_mov_b32 v61, 0
    v_mov_b32 v62, 0
    v_mov_b32 v63, 0
    v_mov_b32 v64, 0
    v_mov_b32 v65, 0
    v_mov_b32 v66, 0
    v_mov_b32 v67, 0
    v_mov_b32 v68, 0
    v_mov_b32 v69, 0
    v_mov_b32 v70, 0
    v_mov_b32 v71, 0
    v_mov_b32 v72, 0
    v_mov_b32 v73, 0
    v_mov_b32 v74, 0
    v_mov_b32 v75, 0
    v_mov_b32 v20, -1
    v_mov_b32 v21, -1
    v_mov_b32 v22, -1
    v_mov_b32 v23, -1
    v_mov_b32 v24, -1
    v_mov_b32 v25, -1
    v_mov_b32 v26, -1
    v_mov_b32 v27, -1
    v_mov_b32 v28, -1
    v_mov_b32 v29, -1
    v_mov_b32 v30, -1
    v_mov_b32 v31, -1
    v_mov_b32 v32, -1
    v_mov_b32 v33, -1
    v_mov_b32 v34, -1
    v_mov_b32 v35, -1
    v_mov_b32 v92, -1
    v_mov_b32 v93, -1
    v_mov_b32 v94, -1
    v_mov_b32 v95, -1
    v_mov_b32 v96, -1
    v_mov_b32 v97, -1
    v_mov_b32 v98, -1
    v_mov_b32 v99, -1
    v_mov_b32 v100, -1
    v_mov_b32 v101, -1
    v_mov_b32 v102, -1
    v_mov_b32 v103, -1
    s_add_u32 s4, s99, 0
    buffer_load_dwordx4 v[192:195], v239, s[8:11], s4 offen sc1
    buffer_load_dwordx4 v[196:199], v249, s[8:11], s4 offen sc1

    ds_read_b128 v[128:131], v228 offset:0
    ds_read_b128 v[144:147], v228 offset:4096
    ds_read_b128 v[132:135], v229 offset:0
    ds_read_b128 v[148:151], v229 offset:4096
    ds_read_b128 v[136:139], v230 offset:0
    ds_read_b128 v[152:155], v230 offset:4096
    ds_read_b128 v[140:143], v231 offset:0
    ds_read_b128 v[156:159], v231 offset:4096
    ds_read_b128 v[160:163], v14 offset:28672
    ds_read_b128 v[164:167], v14 offset:29696
    ds_read_b128 v[108:111], v248
    s_waitcnt lgkmcnt(0)
    v_mfma_f32_16x16x32_bf16 v[76:79], v[108:111], v[112:115], 0
    s_add_u32 s4, s99, 262144
    buffer_load_dwordx4 v[200:203], v239, s[8:11], s4 offen sc1
    buffer_load_dwordx4 v[204:207], v249, s[8:11], s4 offen sc1

.gc_221:
    s_waitcnt vmcnt(2)

    v_max_u32 v4, v192, v196
    v_cmp_eq_u32 vcc, -1, v4
    s_cbranch_vccnz .gf_222
    v_mfma_f32_16x16x32_bf16 v[76:79], v[192:195], v[84:87], v[76:79]
    v_mfma_f32_16x16x32_bf16 v[76:79], v[196:199], v[112:115], v[76:79]
    s_mov_b64 exec, s[58:59]
    s_nop 6
    v_cvt_pk_bf16_f32 v104, v76, v77
    v_cvt_pk_bf16_f32 v105, v78, v79
    v_min_u32 v104, 0xfffffffe, v104
    v_min_u32 v105, 0xfffffffe, v105
    buffer_store_dwordx2 v[104:105], v15, s[8:11], s29 offen sc1
    s_mov_b64 exec, -1

    s_branch .top_198
.gf_222:
    s_add_u32 s4, s99, 0
    buffer_load_dwordx4 v[192:195], v239, s[8:11], s4 offen sc1
    buffer_load_dwordx4 v[196:199], v249, s[8:11], s4 offen sc1

    s_waitcnt vmcnt(2)

    v_max_u32 v4, v200, v204
    v_cmp_eq_u32 vcc, -1, v4
    s_cbranch_vccnz .gf_223
    v_mfma_f32_16x16x32_bf16 v[76:79], v[200:203], v[84:87], v[76:79]
    v_mfma_f32_16x16x32_bf16 v[76:79], v[204:207], v[112:115], v[76:79]
    s_mov_b64 exec, s[58:59]
    s_nop 6
    v_cvt_pk_bf16_f32 v104, v76, v77
    v_cvt_pk_bf16_f32 v105, v78, v79
    v_min_u32 v104, 0xfffffffe, v104
    v_min_u32 v105, 0xfffffffe, v105
    buffer_store_dwordx2 v[104:105], v15, s[8:11], s29 offen sc1
    s_mov_b64 exec, -1

    s_branch .top_198
.gf_223:
    s_add_u32 s4, s99, 262144
    buffer_load_dwordx4 v[200:203], v239, s[8:11], s4 offen sc1
    buffer_load_dwordx4 v[204:207], v249, s[8:11], s4 offen sc1

    s_sub_u32 s62, s62, 1
    s_cbranch_scc1 .mg_end_1
    s_branch .gc_221
.oth_199:
    s_cmp_eq_u32 s24, 3
    s_cbranch_scc1 .w3_200
    s_cmp_eq_u32 s28, 63
    s_cbranch_scc1 .rec_fin_6
    s_add_u32 s6, s28, 4
    s_cmp_ge_u32 s93, s6
    s_cbranch_scc1 .nl_224
    s_buffer_load_dword s14, s[8:11], s89 glc
    s_buffer_load_dword s15, s[8:11], s89 offset:8192 glc

.nl_224:
    s_waitcnt vmcnt(0)
    v_mov_b32 v20, -1
    v_mov_b32 v21, -1
    v_mov_b32 v22, -1
    v_mov_b32 v23, -1
    v_mov_b32 v24, -1
    v_mov_b32 v25, -1
    v_mov_b32 v26, -1
    v_mov_b32 v27, -1
    v_mov_b32 v28, -1
    v_mov_b32 v29, -1
    v_mov_b32 v30, -1
    v_mov_b32 v31, -1
    v_mov_b32 v32, -1
    v_mov_b32 v33, -1
    v_mov_b32 v34, -1
    v_mov_b32 v35, -1
    v_mov_b32 v55, 0
    v_mov_b32 v56, 0
    v_mov_b32 v57, 0
    v_mov_b32 v58, 0
    v_mov_b32 v59, 0
    v_mov_b32 v60, 0
    v_mov_b32 v61, 0
    v_mov_b32 v62, 0
    v_mov_b32 v63, 0
    v_mov_b32 v64, 0
    v_mov_b32 v65, 0
    v_mov_b32 v66, 0
    v_mov_b32 v67, 0
    v_mov_b32 v68, 0
    v_mov_b32 v69, 0
    v_mov_b32 v70, 0
    v_mov_b32 v71, 0
    v_mov_b32 v72, 0
    v_mov_b32 v73, 0
    v_mov_b32 v74, 0
    v_mov_b32 v75, 0
    s_barrier
    s_add_u32 s6, s28, 2
    s_min_u32 s6, s6, 64
    s_cmp_lt_u32 s93, s6
    s_cbranch_scc1 .kf_225
.kb_226:
    s_mov_b32 m0, s90
    s_nop 0
    buffer_load_dwordx4 v14, s[8:11], s38 offen offset:0 lds
    buffer_load_dwordx4 v14, s[8:11], s38 offen offset:1024 lds
    buffer_load_dwordx4 v14, s[8:11], s38 offen offset:2048 lds
    buffer_load_dwordx4 v14, s[8:11], s38 offen offset:3072 lds
    s_mov_b32 m0, s91
    s_nop 0
    buffer_load_dwordx4 v14, s[8:11], s39 offen lds
    s_barrier
    buffer_load_dwordx4 v[192:195], v246, s[8:11], s32 offen offset:0 sc1
    buffer_load_dwordx4 v[196:199], v246, s[8:11], s32 offen offset:1024 sc1
    v_mov_b32 v76, 0
    buffer_load_dwordx4 v[200:203], v246, s[8:11], s32 offen offset:2048 sc1
    buffer_load_dwordx4 v[204:207], v246, s[8:11], s32 offen offset:3072 sc1
    v_mov_b32 v77, 0
    buffer_load_dwordx4 v[208:211], v246, s[8:11], s33 offen offset:0 sc1
    buffer_load_dwordx4 v[212:215], v246, s[8:11], s33 offen offset:1024 sc1
    v_mov_b32 v78, 0
    buffer_load_dwordx4 v[216:219], v246, s[8:11], s33 offen offset:2048 sc1
    buffer_load_dwordx4 v[220:223], v246, s[8:11], s33 offen offset:3072 sc1
    s_waitcnt vmcnt(6)
    v_max3_u32 v4, v192, v193, v194
    v_max3_u32 v5, v195, v196, v197
    v_max3_u32 v4, v4, v198, v199
    v_max_u32 v4, v4, v5
    v_cmp_eq_u32 vcc, -1, v4
    s_cbranch_vccnz .A_228
.W_229:
    v_smfmac_f32_16x16x64_bf16 v[76:79], v[192:195], a[192:199], v9
    v_smfmac_f32_16x16x64_bf16 v[80:83], v[192:195], a[224:231], v9
    s_waitcnt vmcnt(4)
    v_max3_u32 v4, v200, v201, v202
    v_max3_u32 v5, v203, v204, v205
    v_max3_u32 v4, v4, v206, v207
    v_smfmac_f32_16x16x64_bf16 v[76:79], v[196:199], a[200:207], v9
    v_max_u32 v4, v4, v5
    v_cmp_eq_u32 vcc, -1, v4
    v_smfmac_f32_16x16x64_bf16 v[80:83], v[196:199], a[232:239], v9
    s_cbranch_vccnz .A_230
.W_231:
    v_smfmac_f32_16x16x64_bf16 v[76:79], v[200:203], a[208:215], v9
    v_smfmac_f32_16x16x64_bf16 v[80:83], v[200:203], a[240:247], v9
    s_waitcnt vmcnt(2)
    v_max3_u32 v4, v208, v209, v210
    v_max3_u32 v5, v211, v212, v213
    v_max3_u32 v4, v4, v214, v215
    v_smfmac_f32_16x16x64_bf16 v[76:79], v[204:207], a[216:223], v9
    v_max_u32 v4, v4, v5
    v_cmp_eq_u32 vcc, -1, v4
    v_smfmac_f32_16x16x64_bf16 v[80:83], v[204:207], a[248:255], v9
    s_cbranch_vccnz .A_232
.W_233:
    v_smfmac_f32_16x16x64_bf16 v[76:79], v[208:211], v[124:131], v9
    v_smfmac_f32_16x16x64_bf16 v[80:83], v[208:211], v[156:163], v9
    s_waitcnt vmcnt(0)
    v_max3_u32 v4, v216, v217, v218
    v_max3_u32 v5, v219, v220, v221
    v_max3_u32 v4, v4, v222, v223
    v_smfmac_f32_16x16x64_bf16 v[76:79], v[212:215], v[132:139], v9
    v_max_u32 v4, v4, v5
    v_cmp_eq_u32 vcc, -1, v4
    v_smfmac_f32_16x16x64_bf16 v[80:83], v[212:215], v[164:171], v9
    s_cbranch_vccnz .A_234
.W_235:
    v_smfmac_f32_16x16x64_bf16 v[76:79], v[216:219], v[140:147], v9
    v_smfmac_f32_16x16x64_bf16 v[80:83], v[216:219], v[172:179], v9
    v_smfmac_f32_16x16x64_bf16 v[76:79], v[220:223], v[148:155], v9
    v_smfmac_f32_16x16x64_bf16 v[80:83], v[220:223], v[180:187], v9
.mj_227:
    s_barrier
    s_nop 7
    v_permlane32_swap_b32 v76, v80
    v_permlane32_swap_b32 v77, v81
    v_permlane32_swap_b32 v78, v82
    v_permlane32_swap_b32 v79, v83
    v_add_f32 v76, v76, v80
    v_add_f32 v77, v77, v81
    v_add_f32 v78, v78, v82
    v_add_f32 v79, v79, v83
    v_cvt_pk_bf16_f32 v104, v76, v77
    v_cvt_pk_bf16_f32 v106, v76, v77
    v_cvt_pk_bf16_f32 v105, v78, v79
    v_cvt_pk_bf16_f32 v107, v78, v79
    v_permlane16_swap_b32 v104, v106
    s_nop 0
    v_permlane16_swap_b32 v105, v107
    v_min_u32 v104, 0xfffffffe, v104
    buffer_store_dwordx4 v[104:107], v237, s[8:11], s68 offen sc1

    ds_write_b128 v247, v[104:107]
    s_waitcnt lgkmcnt(0)
    s_barrier
    s_min_u32 s4, s14, s15
    s_max_u32 s93, s93, s4
    v_mov_b32 v4, s93
    v_mov_b32 v5, 19968
    ds_write_b32 v5, v4
    v_mov_b32 v79, 0
    v_mov_b32 v80, 0
    v_mov_b32 v81, 0
    v_mov_b32 v82, 0
    v_mov_b32 v83, 0
    s_waitcnt vmcnt(1)
    v_mov_b32 v192, -1
    v_mov_b32 v193, -1
    v_mov_b32 v194, -1
    v_mov_b32 v195, -1
    v_mov_b32 v196, -1
    v_mov_b32 v197, -1
    v_mov_b32 v198, -1
    v_mov_b32 v199, -1
    v_mov_b32 v200, -1
    v_mov_b32 v201, -1
    v_mov_b32 v202, -1
    v_mov_b32 v203, -1
    v_mov_b32 v204, -1
    v_mov_b32 v205, -1
    v_mov_b32 v206, -1
    v_mov_b32 v207, -1
    v_mov_b32 v208, -1
    v_mov_b32 v209, -1
    v_mov_b32 v210, -1
    v_mov_b32 v211, -1
    v_mov_b32 v212, -1
    v_mov_b32 v213, -1
    v_mov_b32 v214, -1
    v_mov_b32 v215, -1
    v_mov_b32 v216, -1
    v_mov_b32 v217, -1
    v_mov_b32 v218, -1
    v_mov_b32 v219, -1
    v_mov_b32 v220, -1
    v_mov_b32 v221, -1
    v_mov_b32 v222, -1
    v_mov_b32 v223, -1
    s_add_u32 s28, s28, 1
    s_add_u32 s36, s36, 196608
    s_cmp_lt_u32 s28, 63
    s_cselect_b32 s4, 262144, 0
    s_add_u32 s38, s38, s4
    s_add_u32 s39, s39, s4
    s_add_u32 s30, s30, s4
    s_mov_b32 s4, s68
    s_mov_b32 s68, s69
    s_mov_b32 s69, s70
    s_mov_b32 s70, s71
    s_mov_b32 s71, s4
    s_and_b32 s4, s28, 3
    s_lshl_b32 s5, s4, 16
    s_add_u32 s29, s5, s34
    s_xor_b32 s6, s5, 0x20000
    s_add_u32 s31, s6, s34
    s_add_u32 s32, s29, 16384
    s_add_u32 s33, s29, 20480
    s_branch .top_198
.w3_200:
    ds_read_b128 v[36:39], v14 offset:8192
    ds_read_b128 v[40:43], v14 offset:9216
    ds_read_b128 v[44:47], v14 offset:10240
    ds_read_b128 v[48:51], v14 offset:11264
    ds_read_b128 v[88:91], v14 offset:16384
    s_waitcnt lgkmcnt(0)
    v_mfma_f32_16x16x32_bf16 v[104:107], v[84:87], v[36:39], 0
    v_mfma_f32_16x16x32_bf16 v[108:111], v[84:87], v[44:47], 0
    v_mfma_f32_16x16x32_bf16 v[104:107], v[84:87], v[40:43], v[104:107]
    v_mfma_f32_16x16x32_bf16 v[108:111], v[84:87], v[48:51], v[108:111]
    s_nop 7
    v_cvt_pk_bf16_f32 v168, v104, v105
    v_cvt_pk_bf16_f32 v169, v106, v107
    v_cvt_pk_bf16_f32 v170, v108, v109
    v_cvt_pk_bf16_f32 v171, v110, v111
    ds_write_b128 v14, v[168:171] offset:18432
    v_cndmask_b32 v172, v170, v168, s[60:61]
    v_cndmask_b32 v173, v171, v169, s[60:61]
    v_min_u32 v172, 0xfffffffe, v172
    v_min_u32 v173, 0xfffffffe, v173
    v_mov_b32 v174, v172
    v_mov_b32 v175, v173
    s_cmp_eq_u32 s28, 63
    s_nop 0
    v_permlane16_swap_b32 v172, v174
    v_permlane16_swap_b32 v173, v175
    ds_write_b128 v14, v[172:175] offset:17408

    s_cbranch_scc1 .sk_236
    s_waitcnt lgkmcnt(0)
    s_barrier
    buffer_store_dwordx4 v[188:191], v235, s[8:11], s31 offen sc1
    buffer_store_dwordx4 v[188:191], v236, s[8:11], s31 offen sc1

    s_branch .gp_201
.A_237:
    buffer_load_dwordx4 v[32:35], v8, s[8:11], s29 offen offset:3072 sc1
    s_sub_u32 s62, s62, 1
    s_cbranch_scc1 .mg_end_1
    s_waitcnt vmcnt(3)
    v_max3_u32 v4, v20, v21, v22
    v_max_u32 v4, v4, v23
    v_cmp_eq_u32 vcc, -1, v4
    s_cbranch_vccz .W_204
.A_203:
    buffer_load_dwordx4 v[20:23], v8, s[8:11], s29 offen offset:0 sc1
    s_waitcnt vmcnt(3)
    v_max3_u32 v4, v24, v25, v26
    v_max_u32 v4, v4, v27
    v_cmp_eq_u32 vcc, -1, v4
    s_cbranch_vccz .W_238
.A_239:
    buffer_load_dwordx4 v[24:27], v8, s[8:11], s29 offen offset:1024 sc1
    s_waitcnt vmcnt(3)
    v_max3_u32 v4, v28, v29, v30
    v_max_u32 v4, v4, v31
    v_cmp_eq_u32 vcc, -1, v4
    s_cbranch_vccz .W_240
.A_241:
    buffer_load_dwordx4 v[28:31], v8, s[8:11], s29 offen offset:2048 sc1
    s_waitcnt vmcnt(3)
    v_max3_u32 v4, v32, v33, v34
    v_max_u32 v4, v4, v35
    v_cmp_eq_u32 vcc, -1, v4
    s_cbranch_vccnz .A_237
.W_242:
    v_smfmac_f32_16x16x64_bf16 v[52:55], v[32:35], a[24:31], v9
    v_smfmac_f32_16x16x64_bf16 v[56:59], v[32:35], a[56:63], v9
    s_waitcnt vmcnt(2)
    v_max3_u32 v4, v20, v21, v22
    v_max_u32 v4, v4, v23
    v_smfmac_f32_16x16x64_bf16 v[60:63], v[32:35], a[88:95], v9
    v_cmp_eq_u32 vcc, -1, v4
    v_smfmac_f32_16x16x64_bf16 v[64:67], v[32:35], a[120:127], v9
    s_cbranch_vccnz .A_243
.W_244:
    v_smfmac_f32_16x16x64_bf16 v[52:55], v[20:23], a[0:7], v9
    v_smfmac_f32_16x16x64_bf16 v[56:59], v[20:23], a[32:39], v9
    s_waitcnt vmcnt(1)
    v_max3_u32 v4, v24, v25, v26
    v_max_u32 v4, v4, v27
    v_smfmac_f32_16x16x64_bf16 v[60:63], v[20:23], a[64:71], v9
    v_cmp_eq_u32 vcc, -1, v4
    v_smfmac_f32_16x16x64_bf16 v[64:67], v[20:23], a[96:103], v9
    s_cbranch_vccnz .A_245
.W_246:
    v_smfmac_f32_16x16x64_bf16 v[52:55], v[24:27], a[8:15], v9
    v_smfmac_f32_16x16x64_bf16 v[56:59], v[24:27], a[40:47], v9
    s_waitcnt vmcnt(0)
    v_max3_u32 v4, v28, v29, v30
    v_max_u32 v4, v4, v31
    v_smfmac_f32_16x16x64_bf16 v[60:63], v[24:27], a[72:79], v9
    v_cmp_eq_u32 vcc, -1, v4
    v_smfmac_f32_16x16x64_bf16 v[64:67], v[24:27], a[104:111], v9
    s_cbranch_vccnz .A_247
.W_248:
    v_smfmac_f32_16x16x64_bf16 v[52:55], v[28:31], a[16:23], v9
    v_smfmac_f32_16x16x64_bf16 v[56:59], v[28:31], a[48:55], v9
    v_smfmac_f32_16x16x64_bf16 v[60:63], v[28:31], a[80:87], v9
    v_smfmac_f32_16x16x64_bf16 v[64:67], v[28:31], a[112:119], v9
    s_branch .mj_202
.W_238:
    v_smfmac_f32_16x16x64_bf16 v[52:55], v[24:27], a[8:15], v9
    v_smfmac_f32_16x16x64_bf16 v[56:59], v[24:27], a[40:47], v9
    s_waitcnt vmcnt(2)
    v_max3_u32 v4, v28, v29, v30
    v_max_u32 v4, v4, v31
    v_smfmac_f32_16x16x64_bf16 v[60:63], v[24:27], a[72:79], v9
    v_cmp_eq_u32 vcc, -1, v4
    v_smfmac_f32_16x16x64_bf16 v[64:67], v[24:27], a[104:111], v9
    s_cbranch_vccnz .A_249
.W_250:
    v_smfmac_f32_16x16x64_bf16 v[52:55], v[28:31], a[16:23], v9
    v_smfmac_f32_16x16x64_bf16 v[56:59], v[28:31], a[48:55], v9
    s_waitcnt vmcnt(1)
    v_max3_u32 v4, v32, v33, v34
    v_max_u32 v4, v4, v35
    v_smfmac_f32_16x16x64_bf16 v[60:63], v[28:31], a[80:87], v9
    v_cmp_eq_u32 vcc, -1, v4
    v_smfmac_f32_16x16x64_bf16 v[64:67], v[28:31], a[112:119], v9
    s_cbranch_vccnz .A_251
.W_252:
    v_smfmac_f32_16x16x64_bf16 v[52:55], v[32:35], a[24:31], v9
    v_smfmac_f32_16x16x64_bf16 v[56:59], v[32:35], a[56:63], v9
    s_waitcnt vmcnt(0)
    v_max3_u32 v4, v20, v21, v22
    v_max_u32 v4, v4, v23
    v_smfmac_f32_16x16x64_bf16 v[60:63], v[32:35], a[88:95], v9
    v_cmp_eq_u32 vcc, -1, v4
    v_smfmac_f32_16x16x64_bf16 v[64:67], v[32:35], a[120:127], v9
    s_cbranch_vccnz .A_253
.W_254:
    v_smfmac_f32_16x16x64_bf16 v[52:55], v[20:23], a[0:7], v9
    v_smfmac_f32_16x16x64_bf16 v[56:59], v[20:23], a[32:39], v9
    v_smfmac_f32_16x16x64_bf16 v[60:63], v[20:23], a[64:71], v9
    v_smfmac_f32_16x16x64_bf16 v[64:67], v[20:23], a[96:103], v9
    s_branch .mj_202
.W_240:
    v_smfmac_f32_16x16x64_bf16 v[52:55], v[28:31], a[16:23], v9
    v_smfmac_f32_16x16x64_bf16 v[56:59], v[28:31], a[48:55], v9
    s_waitcnt vmcnt(2)
    v_max3_u32 v4, v32, v33, v34
    v_max_u32 v4, v4, v35
    v_smfmac_f32_16x16x64_bf16 v[60:63], v[28:31], a[80:87], v9
    v_cmp_eq_u32 vcc, -1, v4
    v_smfmac_f32_16x16x64_bf16 v[64:67], v[28:31], a[112:119], v9
    s_cbranch_vccnz .A_255
.W_256:
    v_smfmac_f32_16x16x64_bf16 v[52:55], v[32:35], a[24:31], v9
    v_smfmac_f32_16x16x64_bf16 v[56:59], v[32:35], a[56:63], v9
    s_waitcnt vmcnt(1)
    v_max3_u32 v4, v20, v21, v22
    v_max_u32 v4, v4, v23
    v_smfmac_f32_16x16x64_bf16 v[60:63], v[32:35], a[88:95], v9
    v_cmp_eq_u32 vcc, -1, v4
    v_smfmac_f32_16x16x64_bf16 v[64:67], v[32:35], a[120:127], v9
    s_cbranch_vccnz .A_257
.W_258:
    v_smfmac_f32_16x16x64_bf16 v[52:55], v[20:23], a[0:7], v9
    v_smfmac_f32_16x16x64_bf16 v[56:59], v[20:23], a[32:39], v9
    s_waitcnt vmcnt(0)
    v_max3_u32 v4, v24, v25, v26
    v_max_u32 v4, v4, v27
    v_smfmac_f32_16x16x64_bf16 v[60:63], v[20:23], a[64:71], v9
    v_cmp_eq_u32 vcc, -1, v4
    v_smfmac_f32_16x16x64_bf16 v[64:67], v[20:23], a[96:103], v9
    s_cbranch_vccnz .A_259
.W_260:
    v_smfmac_f32_16x16x64_bf16 v[52:55], v[24:27], a[8:15], v9
    v_smfmac_f32_16x16x64_bf16 v[56:59], v[24:27], a[40:47], v9
    v_smfmac_f32_16x16x64_bf16 v[60:63], v[24:27], a[72:79], v9
    v_smfmac_f32_16x16x64_bf16 v[64:67], v[24:27], a[104:111], v9
    s_branch .mj_202
.A_261:
    buffer_load_dwordx4 v[28:31], v8, s[8:11], s29 offen offset:2048 sc1
    s_sub_u32 s62, s62, 1
    s_cbranch_scc1 .mg_end_1
    s_waitcnt vmcnt(2)
    v_max3_u32 v4, v20, v21, v22
    v_max_u32 v4, v4, v23
    v_cmp_eq_u32 vcc, -1, v4
    s_cbranch_vccz .W_244
.A_243:
    buffer_load_dwordx4 v[20:23], v8, s[8:11], s29 offen offset:0 sc1
    s_waitcnt vmcnt(2)
    v_max3_u32 v4, v24, v25, v26
    v_max_u32 v4, v4, v27
    v_cmp_eq_u32 vcc, -1, v4
    s_cbranch_vccz .W_262
.A_263:
    buffer_load_dwordx4 v[24:27], v8, s[8:11], s29 offen offset:1024 sc1
    s_waitcnt vmcnt(2)
    v_max3_u32 v4, v28, v29, v30
    v_max_u32 v4, v4, v31
    v_cmp_eq_u32 vcc, -1, v4
    s_cbranch_vccnz .A_261
.W_264:
    v_smfmac_f32_16x16x64_bf16 v[52:55], v[28:31], a[16:23], v9
    v_smfmac_f32_16x16x64_bf16 v[56:59], v[28:31], a[48:55], v9
    s_waitcnt vmcnt(1)
    v_max3_u32 v4, v20, v21, v22
    v_max_u32 v4, v4, v23
    v_smfmac_f32_16x16x64_bf16 v[60:63], v[28:31], a[80:87], v9
    v_cmp_eq_u32 vcc, -1, v4
    v_smfmac_f32_16x16x64_bf16 v[64:67], v[28:31], a[112:119], v9
    s_cbranch_vccz .W_258
    s_branch .A_257
.W_262:
    v_smfmac_f32_16x16x64_bf16 v[52:55], v[24:27], a[8:15], v9
    v_smfmac_f32_16x16x64_bf16 v[56:59], v[24:27], a[40:47], v9
    s_waitcnt vmcnt(1)
    v_max3_u32 v4, v28, v29, v30
    v_max_u32 v4, v4, v31
    v_smfmac_f32_16x16x64_bf16 v[60:63], v[24:27], a[72:79], v9
    v_cmp_eq_u32 vcc, -1, v4
    v_smfmac_f32_16x16x64_bf16 v[64:67], v[24:27], a[104:111], v9
    s_cbranch_vccnz .A_265
.W_266:
    v_smfmac_f32_16x16x64_bf16 v[52:55], v[28:31], a[16:23], v9
    v_smfmac_f32_16x16x64_bf16 v[56:59], v[28:31], a[48:55], v9
    s_waitcnt vmcnt(0)
    v_max3_u32 v4, v20, v21, v22
    v_max_u32 v4, v4, v23
    v_smfmac_f32_16x16x64_bf16 v[60:63], v[28:31], a[80:87], v9
    v_cmp_eq_u32 vcc, -1, v4
    v_smfmac_f32_16x16x64_bf16 v[64:67], v[28:31], a[112:119], v9
    s_cbranch_vccz .W_254
    s_branch .A_253
.A_267:
    buffer_load_dwordx4 v[24:27], v8, s[8:11], s29 offen offset:1024 sc1
    s_sub_u32 s62, s62, 1
    s_cbranch_scc1 .mg_end_1
    s_waitcnt vmcnt(2)
    v_max3_u32 v4, v32, v33, v34
    v_max_u32 v4, v4, v35
    v_cmp_eq_u32 vcc, -1, v4
    s_cbranch_vccz .W_256
.A_255:
    buffer_load_dwordx4 v[32:35], v8, s[8:11], s29 offen offset:3072 sc1
    s_waitcnt vmcnt(2)
    v_max3_u32 v4, v20, v21, v22
    v_max_u32 v4, v4, v23
    v_cmp_eq_u32 vcc, -1, v4
    s_cbranch_vccz .W_268
.A_269:
    buffer_load_dwordx4 v[20:23], v8, s[8:11], s29 offen offset:0 sc1
    s_waitcnt vmcnt(2)
    v_max3_u32 v4, v24, v25, v26
    v_max_u32 v4, v4, v27
    v_cmp_eq_u32 vcc, -1, v4
    s_cbranch_vccnz .A_267
.W_270:
    v_smfmac_f32_16x16x64_bf16 v[52:55], v[24:27], a[8:15], v9
    v_smfmac_f32_16x16x64_bf16 v[56:59], v[24:27], a[40:47], v9
    s_waitcnt vmcnt(1)
    v_max3_u32 v4, v32, v33, v34
    v_max_u32 v4, v4, v35
    v_smfmac_f32_16x16x64_bf16 v[60:63], v[24:27], a[72:79], v9
    v_cmp_eq_u32 vcc, -1, v4
    v_smfmac_f32_16x16x64_bf16 v[64:67], v[24:27], a[104:111], v9
    s_cbranch_vccz .W_252
    s_branch .A_251
.W_268:
    v_smfmac_f32_16x16x64_bf16 v[52:55], v[20:23], a[0:7], v9
    v_smfmac_f32_16x16x64_bf16 v[56:59], v[20:23], a[32:39], v9
    s_waitcnt vmcnt(1)
    v_max3_u32 v4, v24, v25, v26
    v_max_u32 v4, v4, v27
    v_smfmac_f32_16x16x64_bf16 v[60:63], v[20:23], a[64:71], v9
    v_cmp_eq_u32 vcc, -1, v4
    v_smfmac_f32_16x16x64_bf16 v[64:67], v[20:23], a[96:103], v9
    s_cbranch_vccnz .A_271
.W_272:
    v_smfmac_f32_16x16x64_bf16 v[52:55], v[24:27], a[8:15], v9
    v_smfmac_f32_16x16x64_bf16 v[56:59], v[24:27], a[40:47], v9
    s_waitcnt vmcnt(0)
    v_max3_u32 v4, v32, v33, v34
    v_max_u32 v4, v4, v35
    v_smfmac_f32_16x16x64_bf16 v[60:63], v[24:27], a[72:79], v9
    v_cmp_eq_u32 vcc, -1, v4
    v_smfmac_f32_16x16x64_bf16 v[64:67], v[24:27], a[104:111], v9
    s_cbranch_vccz .W_210
    s_branch .A_209
.A_273:
    buffer_load_dwordx4 v[32:35], v8, s[8:11], s29 offen offset:3072 sc1
    s_sub_u32 s62, s62, 1
    s_cbranch_scc1 .mg_end_1
    s_waitcnt vmcnt(2)
    v_max3_u32 v4, v20, v21, v22
    v_max_u32 v4, v4, v23
    v_cmp_eq_u32 vcc, -1, v4
    s_cbranch_vccz .W_274
.A_275:
    buffer_load_dwordx4 v[20:23], v8, s[8:11], s29 offen offset:0 sc1
    s_waitcnt vmcnt(2)
    v_max3_u32 v4, v28, v29, v30
    v_max_u32 v4, v4, v31
    v_cmp_eq_u32 vcc, -1, v4
    s_cbranch_vccz .W_250
.A_249:
    buffer_load_dwordx4 v[28:31], v8, s[8:11], s29 offen offset:2048 sc1
    s_waitcnt vmcnt(2)
    v_max3_u32 v4, v32, v33, v34
    v_max_u32 v4, v4, v35
    v_cmp_eq_u32 vcc, -1, v4
    s_cbranch_vccnz .A_273
.W_276:
    v_smfmac_f32_16x16x64_bf16 v[52:55], v[32:35], a[24:31], v9
    v_smfmac_f32_16x16x64_bf16 v[56:59], v[32:35], a[56:63], v9
    s_waitcnt vmcnt(1)
    v_max3_u32 v4, v20, v21, v22
    v_max_u32 v4, v4, v23
    v_smfmac_f32_16x16x64_bf16 v[60:63], v[32:35], a[88:95], v9
    v_cmp_eq_u32 vcc, -1, v4
    v_smfmac_f32_16x16x64_bf16 v[64:67], v[32:35], a[120:127], v9
    s_cbranch_vccnz .A_277
.W_278:
    v_smfmac_f32_16x16x64_bf16 v[52:55], v[20:23], a[0:7], v9
    v_smfmac_f32_16x16x64_bf16 v[56:59], v[20:23], a[32:39], v9
    s_waitcnt vmcnt(0)
    v_max3_u32 v4, v28, v29, v30
    v_max_u32 v4, v4, v31
    v_smfmac_f32_16x16x64_bf16 v[60:63], v[20:23], a[64:71], v9
    v_cmp_eq_u32 vcc, -1, v4
    v_smfmac_f32_16x16x64_bf16 v[64:67], v[20:23], a[96:103], v9
    s_cbranch_vccz .W_248
    s_branch .A_247
.W_274:
    v_smfmac_f32_16x16x64_bf16 v[52:55], v[20:23], a[0:7], v9
    v_smfmac_f32_16x16x64_bf16 v[56:59], v[20:23], a[32:39], v9
    s_waitcnt vmcnt(1)
    v_max3_u32 v4, v28, v29, v30
    v_max_u32 v4, v4, v31
    v_smfmac_f32_16x16x64_bf16 v[60:63], v[20:23], a[64:71], v9
    v_cmp_eq_u32 vcc, -1, v4
    v_smfmac_f32_16x16x64_bf16 v[64:67], v[20:23], a[96:103], v9
    s_cbranch_vccz .W_208
    s_branch .A_207
.A_279:
    buffer_load_dwordx4 v[32:35], v8, s[8:11], s29 offen offset:3072 sc1
    s_sub_u32 s62, s62, 1
    s_cbranch_scc1 .mg_end_1
    s_waitcnt vmcnt(2)
    v_max3_u32 v4, v24, v25, v26
    v_max_u32 v4, v4, v27
    v_cmp_eq_u32 vcc, -1, v4
    s_cbranch_vccz .W_206
.A_205:
    buffer_load_dwordx4 v[24:27], v8, s[8:11], s29 offen offset:1024 sc1
    s_waitcnt vmcnt(2)
    v_max3_u32 v4, v28, v29, v30
    v_max_u32 v4, v4, v31
    v_cmp_eq_u32 vcc, -1, v4
    s_cbranch_vccz .W_280
.A_281:
    buffer_load_dwordx4 v[28:31], v8, s[8:11], s29 offen offset:2048 sc1
    s_waitcnt vmcnt(2)
    v_max3_u32 v4, v32, v33, v34
    v_max_u32 v4, v4, v35
    v_cmp_eq_u32 vcc, -1, v4
    s_cbranch_vccnz .A_279
.W_282:
    v_smfmac_f32_16x16x64_bf16 v[52:55], v[32:35], a[24:31], v9
    v_smfmac_f32_16x16x64_bf16 v[56:59], v[32:35], a[56:63], v9
    s_waitcnt vmcnt(1)
    v_max3_u32 v4, v24, v25, v26
    v_max_u32 v4, v4, v27
    v_smfmac_f32_16x16x64_bf16 v[60:63], v[32:35], a[88:95], v9
    v_cmp_eq_u32 vcc, -1, v4
    v_smfmac_f32_16x16x64_bf16 v[64:67], v[32:35], a[120:127], v9
    s_cbranch_vccz .W_246
    s_branch .A_245
.W_280:
    v_smfmac_f32_16x16x64_bf16 v[52:55], v[28:31], a[16:23], v9
    v_smfmac_f32_16x16x64_bf16 v[56:59], v[28:31], a[48:55], v9
    s_waitcnt vmcnt(1)
    v_max3_u32 v4, v32, v33, v34
    v_max_u32 v4, v4, v35
    v_smfmac_f32_16x16x64_bf16 v[60:63], v[28:31], a[80:87], v9
    v_cmp_eq_u32 vcc, -1, v4
    v_smfmac_f32_16x16x64_bf16 v[64:67], v[28:31], a[112:119], v9
    s_cbranch_vccnz .A_283
.W_284:
    v_smfmac_f32_16x16x64_bf16 v[52:55], v[32:35], a[24:31], v9
    v_smfmac_f32_16x16x64_bf16 v[56:59], v[32:35], a[56:63], v9
    s_waitcnt vmcnt(0)
    v_max3_u32 v4, v24, v25, v26
    v_max_u32 v4, v4, v27
    v_smfmac_f32_16x16x64_bf16 v[60:63], v[32:35], a[88:95], v9
    v_cmp_eq_u32 vcc, -1, v4
    v_smfmac_f32_16x16x64_bf16 v[64:67], v[32:35], a[120:127], v9
    s_cbranch_vccz .W_260
    s_branch .A_259
.A_285:
    buffer_load_dwordx4 v[24:27], v8, s[8:11], s29 offen offset:1024 sc1
    s_sub_u32 s62, s62, 1
    s_cbranch_scc1 .mg_end_1
    s_waitcnt vmcnt(1)
    v_max3_u32 v4, v20, v21, v22
    v_max_u32 v4, v4, v23
    v_cmp_eq_u32 vcc, -1, v4
    s_cbranch_vccz .W_258
.A_257:
    buffer_load_dwordx4 v[20:23], v8, s[8:11], s29 offen offset:0 sc1
    s_waitcnt vmcnt(1)
    v_max3_u32 v4, v24, v25, v26
    v_max_u32 v4, v4, v27
    v_cmp_eq_u32 vcc, -1, v4
    s_cbranch_vccnz .A_285
.W_286:
    v_smfmac_f32_16x16x64_bf16 v[52:55], v[24:27], a[8:15], v9
    v_smfmac_f32_16x16x64_bf16 v[56:59], v[24:27], a[40:47], v9
    s_waitcnt vmcnt(0)
    v_max3_u32 v4, v20, v21, v22
    v_max_u32 v4, v4, v23
    v_smfmac_f32_16x16x64_bf16 v[60:63], v[24:27], a[72:79], v9
    v_cmp_eq_u32 vcc, -1, v4
    v_smfmac_f32_16x16x64_bf16 v[64:67], v[24:27], a[104:111], v9
    s_cbranch_vccz .W_254
    s_branch .A_253
.A_265:
    buffer_load_dwordx4 v[28:31], v8, s[8:11], s29 offen offset:2048 sc1
    s_sub_u32 s62, s62, 1
    s_cbranch_scc1 .mg_end_1
    s_waitcnt vmcnt(1)
    v_max3_u32 v4, v20, v21, v22
    v_max_u32 v4, v4, v23
    v_cmp_eq_u32 vcc, -1, v4
    s_cbranch_vccz .W_278
.A_277:
    buffer_load_dwordx4 v[20:23], v8, s[8:11], s29 offen offset:0 sc1
    s_waitcnt vmcnt(1)
    v_max3_u32 v4, v28, v29, v30
    v_max_u32 v4, v4, v31
    v_cmp_eq_u32 vcc, -1, v4
    s_cbranch_vccnz .A_265
    s_branch .W_266
.A_287:
    buffer_load_dwordx4 v[20:23], v8, s[8:11], s29 offen offset:0 sc1
    s_sub_u32 s62, s62, 1
    s_cbranch_scc1 .mg_end_1
    s_waitcnt vmcnt(1)
    v_max3_u32 v4, v32, v33, v34
    v_max_u32 v4, v4, v35
    v_cmp_eq_u32 vcc, -1, v4
    s_cbranch_vccz .W_252
.A_251:
    buffer_load_dwordx4 v[32:35], v8, s[8:11], s29 offen offset:3072 sc1
    s_waitcnt vmcnt(1)
    v_max3_u32 v4, v20, v21, v22
    v_max_u32 v4, v4, v23
    v_cmp_eq_u32 vcc, -1, v4
    s_cbranch_vccnz .A_287
.W_288:
    v_smfmac_f32_16x16x64_bf16 v[52:55], v[20:23], a[0:7], v9
    v_smfmac_f32_16x16x64_bf16 v[56:59], v[20:23], a[32:39], v9
    s_waitcnt vmcnt(0)
    v_max3_u32 v4, v32, v33, v34
    v_max_u32 v4, v4, v35
    v_smfmac_f32_16x16x64_bf16 v[60:63], v[20:23], a[64:71], v9
    v_cmp_eq_u32 vcc, -1, v4
    v_smfmac_f32_16x16x64_bf16 v[64:67], v[20:23], a[96:103], v9
    s_cbranch_vccz .W_210
    s_branch .A_209
.A_289:
    buffer_load_dwordx4 v[28:31], v8, s[8:11], s29 offen offset:2048 sc1
    s_sub_u32 s62, s62, 1
    s_cbranch_scc1 .mg_end_1
    s_waitcnt vmcnt(1)
    v_max3_u32 v4, v24, v25, v26
    v_max_u32 v4, v4, v27
    v_cmp_eq_u32 vcc, -1, v4
    s_cbranch_vccz .W_246
.A_245:
    buffer_load_dwordx4 v[24:27], v8, s[8:11], s29 offen offset:1024 sc1
    s_waitcnt vmcnt(1)
    v_max3_u32 v4, v28, v29, v30
    v_max_u32 v4, v4, v31
    v_cmp_eq_u32 vcc, -1, v4
    s_cbranch_vccnz .A_289
.W_290:
    v_smfmac_f32_16x16x64_bf16 v[52:55], v[28:31], a[16:23], v9
    v_smfmac_f32_16x16x64_bf16 v[56:59], v[28:31], a[48:55], v9
    s_waitcnt vmcnt(0)
    v_max3_u32 v4, v24, v25, v26
    v_max_u32 v4, v4, v27
    v_smfmac_f32_16x16x64_bf16 v[60:63], v[28:31], a[80:87], v9
    v_cmp_eq_u32 vcc, -1, v4
    v_smfmac_f32_16x16x64_bf16 v[64:67], v[28:31], a[112:119], v9
    s_cbranch_vccz .W_260
    s_branch .A_259
.A_283:
    buffer_load_dwordx4 v[32:35], v8, s[8:11], s29 offen offset:3072 sc1
    s_sub_u32 s62, s62, 1
    s_cbranch_scc1 .mg_end_1
    s_waitcnt vmcnt(1)
    v_max3_u32 v4, v24, v25, v26
    v_max_u32 v4, v4, v27
    v_cmp_eq_u32 vcc, -1, v4
    s_cbranch_vccz .W_272
.A_271:
    buffer_load_dwordx4 v[24:27], v8, s[8:11], s29 offen offset:1024 sc1
    s_waitcnt vmcnt(1)
    v_max3_u32 v4, v32, v33, v34
    v_max_u32 v4, v4, v35
    v_cmp_eq_u32 vcc, -1, v4
    s_cbranch_vccnz .A_283
    s_branch .W_284
.A_291:
    buffer_load_dwordx4 v[32:35], v8, s[8:11], s29 offen offset:3072 sc1
    s_sub_u32 s62, s62, 1
    s_cbranch_scc1 .mg_end_1
    s_waitcnt vmcnt(1)
    v_max3_u32 v4, v28, v29, v30
    v_max_u32 v4, v4, v31
    v_cmp_eq_u32 vcc, -1, v4
    s_cbranch_vccz .W_208
.A_207:
    buffer_load_dwordx4 v[28:31], v8, s[8:11], s29 offen offset:2048 sc1
    s_waitcnt vmcnt(1)
    v_max3_u32 v4, v32, v33, v34
    v_max_u32 v4, v4, v35
    v_cmp_eq_u32 vcc, -1, v4
    s_cbranch_vccnz .A_291
.W_292:
    v_smfmac_f32_16x16x64_bf16 v[52:55], v[32:35], a[24:31], v9
    v_smfmac_f32_16x16x64_bf16 v[56:59], v[32:35], a[56:63], v9
    s_waitcnt vmcnt(0)
    v_max3_u32 v4, v28, v29, v30
    v_max_u32 v4, v4, v31
    v_smfmac_f32_16x16x64_bf16 v[60:63], v[32:35], a[88:95], v9
    v_cmp_eq_u32 vcc, -1, v4
    v_smfmac_f32_16x16x64_bf16 v[64:67], v[32:35], a[120:127], v9
    s_cbranch_vccz .W_248
    s_branch .A_247
.A_253:
    buffer_load_dwordx4 v[20:23], v8, s[8:11], s29 offen offset:0 sc1
    s_sub_u32 s62, s62, 1
    s_cbranch_scc1 .mg_end_1
    s_waitcnt vmcnt(1)
    v_max3_u32 v4, v20, v21, v22
    v_max_u32 v4, v4, v23
    v_cmp_eq_u32 vcc, -1, v4
    s_cbranch_vccnz .A_253
    v_smfmac_f32_16x16x64_bf16 v[52:55], v[20:23], a[0:7], v9
    v_smfmac_f32_16x16x64_bf16 v[56:59], v[20:23], a[32:39], v9
    v_smfmac_f32_16x16x64_bf16 v[60:63], v[20:23], a[64:71], v9
    v_smfmac_f32_16x16x64_bf16 v[64:67], v[20:23], a[96:103], v9
    s_branch .mj_202
.A_259:
    buffer_load_dwordx4 v[24:27], v8, s[8:11], s29 offen offset:1024 sc1
    s_sub_u32 s62, s62, 1
    s_cbranch_scc1 .mg_end_1
    s_waitcnt vmcnt(1)
    v_max3_u32 v4, v24, v25, v26
    v_max_u32 v4, v4, v27
    v_cmp_eq_u32 vcc, -1, v4
    s_cbranch_vccnz .A_259
    v_smfmac_f32_16x16x64_bf16 v[52:55], v[24:27], a[8:15], v9
    v_smfmac_f32_16x16x64_bf16 v[56:59], v[24:27], a[40:47], v9
    v_smfmac_f32_16x16x64_bf16 v[60:63], v[24:27], a[72:79], v9
    v_smfmac_f32_16x16x64_bf16 v[64:67], v[24:27], a[104:111], v9
    s_branch .mj_202
.A_247:
    buffer_load_dwordx4 v[28:31], v8, s[8:11], s29 offen offset:2048 sc1
    s_sub_u32 s62, s62, 1
    s_cbranch_scc1 .mg_end_1
    s_waitcnt vmcnt(1)
    v_max3_u32 v4, v28, v29, v30
    v_max_u32 v4, v4, v31
    v_cmp_eq_u32 vcc, -1, v4
    s_cbranch_vccnz .A_247
    v_smfmac_f32_16x16x64_bf16 v[52:55], v[28:31], a[16:23], v9
    v_smfmac_f32_16x16x64_bf16 v[56:59], v[28:31], a[48:55], v9
    v_smfmac_f32_16x16x64_bf16 v[60:63], v[28:31], a[80:87], v9
    v_smfmac_f32_16x16x64_bf16 v[64:67], v[28:31], a[112:119], v9
    s_branch .mj_202
.A_209:
    buffer_load_dwordx4 v[32:35], v8, s[8:11], s29 offen offset:3072 sc1
    s_sub_u32 s62, s62, 1
    s_cbranch_scc1 .mg_end_1
    s_waitcnt vmcnt(1)
    v_max3_u32 v4, v32, v33, v34
    v_max_u32 v4, v4, v35
    v_cmp_eq_u32 vcc, -1, v4
    s_cbranch_vccnz .A_209
    v_smfmac_f32_16x16x64_bf16 v[52:55], v[32:35], a[24:31], v9
    v_smfmac_f32_16x16x64_bf16 v[56:59], v[32:35], a[56:63], v9
    v_smfmac_f32_16x16x64_bf16 v[60:63], v[32:35], a[88:95], v9
    v_smfmac_f32_16x16x64_bf16 v[64:67], v[32:35], a[120:127], v9
    s_branch .mj_202
.A_293:
    buffer_load_dwordx4 v[100:103], v234, s[8:11], s29 offen sc1
    s_sub_u32 s62, s62, 1
    s_cbranch_scc1 .mg_end_1
    s_waitcnt vmcnt(2)
    v_max3_u32 v4, v92, v93, v94
    v_max_u32 v4, v4, v95
    v_cmp_eq_u32 vcc, -1, v4
    s_cbranch_vccz .W_213
.A_212:
    buffer_load_dwordx4 v[92:95], v232, s[8:11], s29 offen sc1
    s_waitcnt vmcnt(2)
    v_max3_u32 v4, v96, v97, v98
    v_max_u32 v4, v4, v99
    v_cmp_eq_u32 vcc, -1, v4
    s_cbranch_vccz .W_294
.A_295:
    buffer_load_dwordx4 v[96:99], v233, s[8:11], s29 offen sc1
    s_waitcnt vmcnt(2)
    v_max3_u32 v4, v100, v101, v102
    v_max_u32 v4, v4, v103
    v_cmp_eq_u32 vcc, -1, v4
    s_cbranch_vccnz .A_293
.W_296:
    v_mfma_f32_16x16x32_bf16 v[208:211], v[140:143], v[100:103], v[208:211]
    s_waitcnt vmcnt(1)
    v_max3_u32 v4, v92, v93, v94
    v_max_u32 v4, v4, v95
    v_mfma_f32_16x16x32_bf16 v[212:215], v[156:159], v[100:103], v[212:215]
    v_cmp_eq_u32 vcc, -1, v4
    v_mfma_f32_16x16x32_bf16 v[216:219], v[100:103], v[100:103], v[216:219]
    s_cbranch_vccnz .A_297
.W_298:
    v_mfma_f32_16x16x32_bf16 v[208:211], v[132:135], v[92:95], v[208:211]
    s_waitcnt vmcnt(0)
    v_max3_u32 v4, v96, v97, v98
    v_max_u32 v4, v4, v99
    v_mfma_f32_16x16x32_bf16 v[212:215], v[148:151], v[92:95], v[212:215]
    v_cmp_eq_u32 vcc, -1, v4
    v_mfma_f32_16x16x32_bf16 v[216:219], v[92:95], v[92:95], v[216:219]
    s_cbranch_vccnz .A_299
.W_300:
    v_mfma_f32_16x16x32_bf16 v[208:211], v[136:139], v[96:99], v[208:211]
    v_mfma_f32_16x16x32_bf16 v[212:215], v[152:155], v[96:99], v[212:215]
    v_mfma_f32_16x16x32_bf16 v[216:219], v[96:99], v[96:99], v[216:219]
    s_branch .mj_211
.W_294:
    v_mfma_f32_16x16x32_bf16 v[208:211], v[136:139], v[96:99], v[208:211]
    s_waitcnt vmcnt(1)
    v_max3_u32 v4, v100, v101, v102
    v_max_u32 v4, v4, v103
    v_mfma_f32_16x16x32_bf16 v[212:215], v[152:155], v[96:99], v[212:215]
    v_cmp_eq_u32 vcc, -1, v4
    v_mfma_f32_16x16x32_bf16 v[216:219], v[96:99], v[96:99], v[216:219]
    s_cbranch_vccnz .A_301
.W_302:
    v_mfma_f32_16x16x32_bf16 v[208:211], v[140:143], v[100:103], v[208:211]
    s_waitcnt vmcnt(0)
    v_max3_u32 v4, v92, v93, v94
    v_max_u32 v4, v4, v95
    v_mfma_f32_16x16x32_bf16 v[212:215], v[156:159], v[100:103], v[212:215]
    v_cmp_eq_u32 vcc, -1, v4
    v_mfma_f32_16x16x32_bf16 v[216:219], v[100:103], v[100:103], v[216:219]
    s_cbranch_vccnz .A_303
.W_304:
    v_mfma_f32_16x16x32_bf16 v[208:211], v[132:135], v[92:95], v[208:211]
    v_mfma_f32_16x16x32_bf16 v[212:215], v[148:151], v[92:95], v[212:215]
    v_mfma_f32_16x16x32_bf16 v[216:219], v[92:95], v[92:95], v[216:219]
    s_branch .mj_211
.A_305:
    buffer_load_dwordx4 v[96:99], v233, s[8:11], s29 offen sc1
    s_sub_u32 s62, s62, 1
    s_cbranch_scc1 .mg_end_1
    s_waitcnt vmcnt(1)
    v_max3_u32 v4, v92, v93, v94
    v_max_u32 v4, v4, v95
    v_cmp_eq_u32 vcc, -1, v4
    s_cbranch_vccz .W_298
.A_297:
    buffer_load_dwordx4 v[92:95], v232, s[8:11], s29 offen sc1
    s_waitcnt vmcnt(1)
    v_max3_u32 v4, v96, v97, v98
    v_max_u32 v4, v4, v99
    v_cmp_eq_u32 vcc, -1, v4
    s_cbranch_vccnz .A_305
.W_306:
    v_mfma_f32_16x16x32_bf16 v[208:211], v[136:139], v[96:99], v[208:211]
    s_waitcnt vmcnt(0)
    v_max3_u32 v4, v92, v93, v94
    v_max_u32 v4, v4, v95
    v_mfma_f32_16x16x32_bf16 v[212:215], v[152:155], v[96:99], v[212:215]
    v_cmp_eq_u32 vcc, -1, v4
    v_mfma_f32_16x16x32_bf16 v[216:219], v[96:99], v[96:99], v[216:219]
    s_cbranch_vccz .W_304
    s_branch .A_303
.A_307:
    buffer_load_dwordx4 v[92:95], v232, s[8:11], s29 offen sc1
    s_sub_u32 s62, s62, 1
    s_cbranch_scc1 .mg_end_1
    s_waitcnt vmcnt(1)
    v_max3_u32 v4, v100, v101, v102
    v_max_u32 v4, v4, v103
    v_cmp_eq_u32 vcc, -1, v4
    s_cbranch_vccz .W_302
.A_301:
    buffer_load_dwordx4 v[100:103], v234, s[8:11], s29 offen sc1
    s_waitcnt vmcnt(1)
    v_max3_u32 v4, v92, v93, v94
    v_max_u32 v4, v4, v95
    v_cmp_eq_u32 vcc, -1, v4
    s_cbranch_vccnz .A_307
.W_308:
    v_mfma_f32_16x16x32_bf16 v[208:211], v[132:135], v[92:95], v[208:211]
    s_waitcnt vmcnt(0)
    v_max3_u32 v4, v100, v101, v102
    v_max_u32 v4, v4, v103
    v_mfma_f32_16x16x32_bf16 v[212:215], v[148:151], v[92:95], v[212:215]
    v_cmp_eq_u32 vcc, -1, v4
    v_mfma_f32_16x16x32_bf16 v[216:219], v[92:95], v[92:95], v[216:219]
    s_cbranch_vccz .W_217
    s_branch .A_216
.A_309:
    buffer_load_dwordx4 v[100:103], v234, s[8:11], s29 offen sc1
    s_sub_u32 s62, s62, 1
    s_cbranch_scc1 .mg_end_1
    s_waitcnt vmcnt(1)
    v_max3_u32 v4, v96, v97, v98
    v_max_u32 v4, v4, v99
    v_cmp_eq_u32 vcc, -1, v4
    s_cbranch_vccz .W_215
.A_214:
    buffer_load_dwordx4 v[96:99], v233, s[8:11], s29 offen sc1
    s_waitcnt vmcnt(1)
    v_max3_u32 v4, v100, v101, v102
    v_max_u32 v4, v4, v103
    v_cmp_eq_u32 vcc, -1, v4
    s_cbranch_vccnz .A_309
.W_310:
    v_mfma_f32_16x16x32_bf16 v[208:211], v[140:143], v[100:103], v[208:211]
    s_waitcnt vmcnt(0)
    v_max3_u32 v4, v96, v97, v98
    v_max_u32 v4, v4, v99
    v_mfma_f32_16x16x32_bf16 v[212:215], v[156:159], v[100:103], v[212:215]
    v_cmp_eq_u32 vcc, -1, v4
    v_mfma_f32_16x16x32_bf16 v[216:219], v[100:103], v[100:103], v[216:219]
    s_cbranch_vccz .W_300
    s_branch .A_299
.A_303:
    buffer_load_dwordx4 v[92:95], v232, s[8:11], s29 offen sc1
    s_sub_u32 s62, s62, 1
    s_cbranch_scc1 .mg_end_1
    s_waitcnt vmcnt(1)
    v_max3_u32 v4, v92, v93, v94
    v_max_u32 v4, v4, v95
    v_cmp_eq_u32 vcc, -1, v4
    s_cbranch_vccnz .A_303
    v_mfma_f32_16x16x32_bf16 v[208:211], v[132:135], v[92:95], v[208:211]
    v_mfma_f32_16x16x32_bf16 v[212:215], v[148:151], v[92:95], v[212:215]
    v_mfma_f32_16x16x32_bf16 v[216:219], v[92:95], v[92:95], v[216:219]
    s_branch .mj_211
.A_299:
    buffer_load_dwordx4 v[96:99], v233, s[8:11], s29 offen sc1
    s_sub_u32 s62, s62, 1
    s_cbranch_scc1 .mg_end_1
    s_waitcnt vmcnt(1)
    v_max3_u32 v4, v96, v97, v98
    v_max_u32 v4, v4, v99
    v_cmp_eq_u32 vcc, -1, v4
    s_cbranch_vccnz .A_299
    v_mfma_f32_16x16x32_bf16 v[208:211], v[136:139], v[96:99], v[208:211]
    v_mfma_f32_16x16x32_bf16 v[212:215], v[152:155], v[96:99], v[212:215]
    v_mfma_f32_16x16x32_bf16 v[216:219], v[96:99], v[96:99], v[216:219]
    s_branch .mj_211
.A_216:
    buffer_load_dwordx4 v[100:103], v234, s[8:11], s29 offen sc1
    s_sub_u32 s62, s62, 1
    s_cbranch_scc1 .mg_end_1
    s_waitcnt vmcnt(1)
    v_max3_u32 v4, v100, v101, v102
    v_max_u32 v4, v4, v103
    v_cmp_eq_u32 vcc, -1, v4
    s_cbranch_vccnz .A_216
    v_mfma_f32_16x16x32_bf16 v[208:211], v[140:143], v[100:103], v[208:211]
    v_mfma_f32_16x16x32_bf16 v[212:215], v[156:159], v[100:103], v[212:215]
    v_mfma_f32_16x16x32_bf16 v[216:219], v[100:103], v[100:103], v[216:219]
    s_branch .mj_211
.kf_225:
    s_mov_b32 s62, 0
    s_mov_b64 exec, 3
.wf_311:
    buffer_load_dword v244, v253, s[8:11], s89 offen sc1
    s_waitcnt vmcnt(0)
    v_cmp_gt_u32 vcc, s6, v244
    s_cbranch_vccz .wfd_312
    s_sleep 2
    s_add_u32 s62, s62, 1
    s_cmp_gt_u32 s62, 0x400000
    s_cbranch_scc1 .mg_end_1
    s_branch .wf_311

.wfd_312:
    s_mov_b64 exec, -1
    v_readlane_b32 s4, v244, 0
    v_readlane_b32 s93, v244, 1
    s_min_u32 s93, s93, s4
    s_mov_b32 s62, 0x1000000
    s_branch .kb_226
.A_313:
    buffer_load_dwordx4 v[216:219], v246, s[8:11], s33 offen offset:2048 sc1
    buffer_load_dwordx4 v[220:223], v246, s[8:11], s33 offen offset:3072 sc1
    s_sub_u32 s62, s62, 1
    s_cbranch_scc1 .mg_end_1
    s_waitcnt vmcnt(6)
    v_max3_u32 v4, v192, v193, v194
    v_max3_u32 v5, v195, v196, v197
    v_max3_u32 v4, v4, v198, v199
    v_max_u32 v4, v4, v5
    v_cmp_eq_u32 vcc, -1, v4
    s_cbranch_vccz .W_229
.A_228:
    buffer_load_dwordx4 v[192:195], v246, s[8:11], s32 offen offset:0 sc1
    buffer_load_dwordx4 v[196:199], v246, s[8:11], s32 offen offset:1024 sc1
    s_waitcnt vmcnt(6)
    v_max3_u32 v4, v200, v201, v202
    v_max3_u32 v5, v203, v204, v205
    v_max3_u32 v4, v4, v206, v207
    v_max_u32 v4, v4, v5
    v_cmp_eq_u32 vcc, -1, v4
    s_cbranch_vccz .W_314
.A_315:
    buffer_load_dwordx4 v[200:203], v246, s[8:11], s32 offen offset:2048 sc1
    buffer_load_dwordx4 v[204:207], v246, s[8:11], s32 offen offset:3072 sc1
    s_waitcnt vmcnt(6)
    v_max3_u32 v4, v208, v209, v210
    v_max3_u32 v5, v211, v212, v213
    v_max3_u32 v4, v4, v214, v215
    v_max_u32 v4, v4, v5
    v_cmp_eq_u32 vcc, -1, v4
    s_cbranch_vccz .W_316
.A_317:
    buffer_load_dwordx4 v[208:211], v246, s[8:11], s33 offen offset:0 sc1
    buffer_load_dwordx4 v[212:215], v246, s[8:11], s33 offen offset:1024 sc1
    s_waitcnt vmcnt(6)
    v_max3_u32 v4, v216, v217, v218
    v_max3_u32 v5, v219, v220, v221
    v_max3_u32 v4, v4, v222, v223
    v_max_u32 v4, v4, v5
    v_cmp_eq_u32 vcc, -1, v4
    s_cbranch_vccnz .A_313
.W_318:
    v_smfmac_f32_16x16x64_bf16 v[76:79], v[216:219], v[140:147], v9
    v_smfmac_f32_16x16x64_bf16 v[80:83], v[216:219], v[172:179], v9
    s_waitcnt vmcnt(4)
    v_max3_u32 v4, v192, v193, v194
    v_max3_u32 v5, v195, v196, v197
    v_max3_u32 v4, v4, v198, v199
    v_smfmac_f32_16x16x64_bf16 v[76:79], v[220:223], v[148:155], v9
    v_max_u32 v4, v4, v5
    v_cmp_eq_u32 vcc, -1, v4
    v_smfmac_f32_16x16x64_bf16 v[80:83], v[220:223], v[180:187], v9
    s_cbranch_vccnz .A_319
.W_320:
    v_smfmac_f32_16x16x64_bf16 v[76:79], v[192:195], a[192:199], v9
    v_smfmac_f32_16x16x64_bf16 v[80:83], v[192:195], a[224:231], v9
    s_waitcnt vmcnt(2)
    v_max3_u32 v4, v200, v201, v202
    v_max3_u32 v5, v203, v204, v205
    v_max3_u32 v4, v4, v206, v207
    v_smfmac_f32_16x16x64_bf16 v[76:79], v[196:199], a[200:207], v9
    v_max_u32 v4, v4, v5
    v_cmp_eq_u32 vcc, -1, v4
    v_smfmac_f32_16x16x64_bf16 v[80:83], v[196:199], a[232:239], v9
    s_cbranch_vccnz .A_321
.W_322:
    v_smfmac_f32_16x16x64_bf16 v[76:79], v[200:203], a[208:215], v9
    v_smfmac_f32_16x16x64_bf16 v[80:83], v[200:203], a[240:247], v9
    s_waitcnt vmcnt(0)
    v_max3_u32 v4, v208, v209, v210
    v_max3_u32 v5, v211, v212, v213
    v_max3_u32 v4, v4, v214, v215
    v_smfmac_f32_16x16x64_bf16 v[76:79], v[204:207], a[216:223], v9
    v_max_u32 v4, v4, v5
    v_cmp_eq_u32 vcc, -1, v4
    v_smfmac_f32_16x16x64_bf16 v[80:83], v[204:207], a[248:255], v9
    s_cbranch_vccnz .A_323
.W_324:
    v_smfmac_f32_16x16x64_bf16 v[76:79], v[208:211], v[124:131], v9
    v_smfmac_f32_16x16x64_bf16 v[80:83], v[208:211], v[156:163], v9
    v_smfmac_f32_16x16x64_bf16 v[76:79], v[212:215], v[132:139], v9
    v_smfmac_f32_16x16x64_bf16 v[80:83], v[212:215], v[164:171], v9
    s_branch .mj_227
.W_314:
    v_smfmac_f32_16x16x64_bf16 v[76:79], v[200:203], a[208:215], v9
    v_smfmac_f32_16x16x64_bf16 v[80:83], v[200:203], a[240:247], v9
    s_waitcnt vmcnt(4)
    v_max3_u32 v4, v208, v209, v210
    v_max3_u32 v5, v211, v212, v213
    v_max3_u32 v4, v4, v214, v215
    v_smfmac_f32_16x16x64_bf16 v[76:79], v[204:207], a[216:223], v9
    v_max_u32 v4, v4, v5
    v_cmp_eq_u32 vcc, -1, v4
    v_smfmac_f32_16x16x64_bf16 v[80:83], v[204:207], a[248:255], v9
    s_cbranch_vccnz .A_325
.W_326:
    v_smfmac_f32_16x16x64_bf16 v[76:79], v[208:211], v[124:131], v9
    v_smfmac_f32_16x16x64_bf16 v[80:83], v[208:211], v[156:163], v9
    s_waitcnt vmcnt(2)
    v_max3_u32 v4, v216, v217, v218
    v_max3_u32 v5, v219, v220, v221
    v_max3_u32 v4, v4, v222, v223
    v_smfmac_f32_16x16x64_bf16 v[76:79], v[212:215], v[132:139], v9
    v_max_u32 v4, v4, v5
    v_cmp_eq_u32 vcc, -1, v4
    v_smfmac_f32_16x16x64_bf16 v[80:83], v[212:215], v[164:171], v9
    s_cbranch_vccnz .A_327
.W_328:
    v_smfmac_f32_16x16x64_bf16 v[76:79], v[216:219], v[140:147], v9
    v_smfmac_f32_16x16x64_bf16 v[80:83], v[216:219], v[172:179], v9
    s_waitcnt vmcnt(0)
    v_max3_u32 v4, v192, v193, v194
    v_max3_u32 v5, v195, v196, v197
    v_max3_u32 v4, v4, v198, v199
    v_smfmac_f32_16x16x64_bf16 v[76:79], v[220:223], v[148:155], v9
    v_max_u32 v4, v4, v5
    v_cmp_eq_u32 vcc, -1, v4
    v_smfmac_f32_16x16x64_bf16 v[80:83], v[220:223], v[180:187], v9
    s_cbranch_vccnz .A_329
.W_330:
    v_smfmac_f32_16x16x64_bf16 v[76:79], v[192:195], a[192:199], v9
    v_smfmac_f32_16x16x64_bf16 v[80:83], v[192:195], a[224:231], v9
    v_smfmac_f32_16x16x64_bf16 v[76:79], v[196:199], a[200:207], v9
    v_smfmac_f32_16x16x64_bf16 v[80:83], v[196:199], a[232:239], v9
    s_branch .mj_227
.W_316:
    v_smfmac_f32_16x16x64_bf16 v[76:79], v[208:211], v[124:131], v9
    v_smfmac_f32_16x16x64_bf16 v[80:83], v[208:211], v[156:163], v9
    s_waitcnt vmcnt(4)
    v_max3_u32 v4, v216, v217, v218
    v_max3_u32 v5, v219, v220, v221
    v_max3_u32 v4, v4, v222, v223
    v_smfmac_f32_16x16x64_bf16 v[76:79], v[212:215], v[132:139], v9
    v_max_u32 v4, v4, v5
    v_cmp_eq_u32 vcc, -1, v4
    v_smfmac_f32_16x16x64_bf16 v[80:83], v[212:215], v[164:171], v9
    s_cbranch_vccnz .A_331
.W_332:
    v_smfmac_f32_16x16x64_bf16 v[76:79], v[216:219], v[140:147], v9
    v_smfmac_f32_16x16x64_bf16 v[80:83], v[216:219], v[172:179], v9
    s_waitcnt vmcnt(2)
    v_max3_u32 v4, v192, v193, v194
    v_max3_u32 v5, v195, v196, v197
    v_max3_u32 v4, v4, v198, v199
    v_smfmac_f32_16x16x64_bf16 v[76:79], v[220:223], v[148:155], v9
    v_max_u32 v4, v4, v5
    v_cmp_eq_u32 vcc, -1, v4
    v_smfmac_f32_16x16x64_bf16 v[80:83], v[220:223], v[180:187], v9
    s_cbranch_vccnz .A_333
.W_334:
    v_smfmac_f32_16x16x64_bf16 v[76:79], v[192:195], a[192:199], v9
    v_smfmac_f32_16x16x64_bf16 v[80:83], v[192:195], a[224:231], v9
    s_waitcnt vmcnt(0)
    v_max3_u32 v4, v200, v201, v202
    v_max3_u32 v5, v203, v204, v205
    v_max3_u32 v4, v4, v206, v207
    v_smfmac_f32_16x16x64_bf16 v[76:79], v[196:199], a[200:207], v9
    v_max_u32 v4, v4, v5
    v_cmp_eq_u32 vcc, -1, v4
    v_smfmac_f32_16x16x64_bf16 v[80:83], v[196:199], a[232:239], v9
    s_cbranch_vccnz .A_335
.W_336:
    v_smfmac_f32_16x16x64_bf16 v[76:79], v[200:203], a[208:215], v9
    v_smfmac_f32_16x16x64_bf16 v[80:83], v[200:203], a[240:247], v9
    v_smfmac_f32_16x16x64_bf16 v[76:79], v[204:207], a[216:223], v9
    v_smfmac_f32_16x16x64_bf16 v[80:83], v[204:207], a[248:255], v9
    s_branch .mj_227
.A_337:
    buffer_load_dwordx4 v[208:211], v246, s[8:11], s33 offen offset:0 sc1
    buffer_load_dwordx4 v[212:215], v246, s[8:11], s33 offen offset:1024 sc1
    s_sub_u32 s62, s62, 1
    s_cbranch_scc1 .mg_end_1
    s_waitcnt vmcnt(4)
    v_max3_u32 v4, v192, v193, v194
    v_max3_u32 v5, v195, v196, v197
    v_max3_u32 v4, v4, v198, v199
    v_max_u32 v4, v4, v5
    v_cmp_eq_u32 vcc, -1, v4
    s_cbranch_vccz .W_320
.A_319:
    buffer_load_dwordx4 v[192:195], v246, s[8:11], s32 offen offset:0 sc1
    buffer_load_dwordx4 v[196:199], v246, s[8:11], s32 offen offset:1024 sc1
    s_waitcnt vmcnt(4)
    v_max3_u32 v4, v200, v201, v202
    v_max3_u32 v5, v203, v204, v205
    v_max3_u32 v4, v4, v206, v207
    v_max_u32 v4, v4, v5
    v_cmp_eq_u32 vcc, -1, v4
    s_cbranch_vccz .W_338
.A_339:
    buffer_load_dwordx4 v[200:203], v246, s[8:11], s32 offen offset:2048 sc1
    buffer_load_dwordx4 v[204:207], v246, s[8:11], s32 offen offset:3072 sc1
    s_waitcnt vmcnt(4)
    v_max3_u32 v4, v208, v209, v210
    v_max3_u32 v5, v211, v212, v213
    v_max3_u32 v4, v4, v214, v215
    v_max_u32 v4, v4, v5
    v_cmp_eq_u32 vcc, -1, v4
    s_cbranch_vccnz .A_337
.W_340:
    v_smfmac_f32_16x16x64_bf16 v[76:79], v[208:211], v[124:131], v9
    v_smfmac_f32_16x16x64_bf16 v[80:83], v[208:211], v[156:163], v9
    s_waitcnt vmcnt(2)
    v_max3_u32 v4, v192, v193, v194
    v_max3_u32 v5, v195, v196, v197
    v_max3_u32 v4, v4, v198, v199
    v_smfmac_f32_16x16x64_bf16 v[76:79], v[212:215], v[132:139], v9
    v_max_u32 v4, v4, v5
    v_cmp_eq_u32 vcc, -1, v4
    v_smfmac_f32_16x16x64_bf16 v[80:83], v[212:215], v[164:171], v9
    s_cbranch_vccz .W_334
    s_branch .A_333
.W_338:
    v_smfmac_f32_16x16x64_bf16 v[76:79], v[200:203], a[208:215], v9
    v_smfmac_f32_16x16x64_bf16 v[80:83], v[200:203], a[240:247], v9
    s_waitcnt vmcnt(2)
    v_max3_u32 v4, v208, v209, v210
    v_max3_u32 v5, v211, v212, v213
    v_max3_u32 v4, v4, v214, v215
    v_smfmac_f32_16x16x64_bf16 v[76:79], v[204:207], a[216:223], v9
    v_max_u32 v4, v4, v5
    v_cmp_eq_u32 vcc, -1, v4
    v_smfmac_f32_16x16x64_bf16 v[80:83], v[204:207], a[248:255], v9
    s_cbranch_vccnz .A_341
.W_342:
    v_smfmac_f32_16x16x64_bf16 v[76:79], v[208:211], v[124:131], v9
    v_smfmac_f32_16x16x64_bf16 v[80:83], v[208:211], v[156:163], v9
    s_waitcnt vmcnt(0)
    v_max3_u32 v4, v192, v193, v194
    v_max3_u32 v5, v195, v196, v197
    v_max3_u32 v4, v4, v198, v199
    v_smfmac_f32_16x16x64_bf16 v[76:79], v[212:215], v[132:139], v9
    v_max_u32 v4, v4, v5
    v_cmp_eq_u32 vcc, -1, v4
    v_smfmac_f32_16x16x64_bf16 v[80:83], v[212:215], v[164:171], v9
    s_cbranch_vccz .W_330
    s_branch .A_329
.A_343:
    buffer_load_dwordx4 v[200:203], v246, s[8:11], s32 offen offset:2048 sc1
    buffer_load_dwordx4 v[204:207], v246, s[8:11], s32 offen offset:3072 sc1
    s_sub_u32 s62, s62, 1
    s_cbranch_scc1 .mg_end_1
    s_waitcnt vmcnt(4)
    v_max3_u32 v4, v216, v217, v218
    v_max3_u32 v5, v219, v220, v221
    v_max3_u32 v4, v4, v222, v223
    v_max_u32 v4, v4, v5
    v_cmp_eq_u32 vcc, -1, v4
    s_cbranch_vccz .W_332
.A_331:
    buffer_load_dwordx4 v[216:219], v246, s[8:11], s33 offen offset:2048 sc1
    buffer_load_dwordx4 v[220:223], v246, s[8:11], s33 offen offset:3072 sc1
    s_waitcnt vmcnt(4)
    v_max3_u32 v4, v192, v193, v194
    v_max3_u32 v5, v195, v196, v197
    v_max3_u32 v4, v4, v198, v199
    v_max_u32 v4, v4, v5
    v_cmp_eq_u32 vcc, -1, v4
    s_cbranch_vccz .W_344
.A_345:
    buffer_load_dwordx4 v[192:195], v246, s[8:11], s32 offen offset:0 sc1
    buffer_load_dwordx4 v[196:199], v246, s[8:11], s32 offen offset:1024 sc1
    s_waitcnt vmcnt(4)
    v_max3_u32 v4, v200, v201, v202
    v_max3_u32 v5, v203, v204, v205
    v_max3_u32 v4, v4, v206, v207
    v_max_u32 v4, v4, v5
    v_cmp_eq_u32 vcc, -1, v4
    s_cbranch_vccnz .A_343
.W_346:
    v_smfmac_f32_16x16x64_bf16 v[76:79], v[200:203], a[208:215], v9
    v_smfmac_f32_16x16x64_bf16 v[80:83], v[200:203], a[240:247], v9
    s_waitcnt vmcnt(2)
    v_max3_u32 v4, v216, v217, v218
    v_max3_u32 v5, v219, v220, v221
    v_max3_u32 v4, v4, v222, v223
    v_smfmac_f32_16x16x64_bf16 v[76:79], v[204:207], a[216:223], v9
    v_max_u32 v4, v4, v5
    v_cmp_eq_u32 vcc, -1, v4
    v_smfmac_f32_16x16x64_bf16 v[80:83], v[204:207], a[248:255], v9
    s_cbranch_vccz .W_328
    s_branch .A_327
.W_344:
    v_smfmac_f32_16x16x64_bf16 v[76:79], v[192:195], a[192:199], v9
    v_smfmac_f32_16x16x64_bf16 v[80:83], v[192:195], a[224:231], v9
    s_waitcnt vmcnt(2)
    v_max3_u32 v4, v200, v201, v202
    v_max3_u32 v5, v203, v204, v205
    v_max3_u32 v4, v4, v206, v207
    v_smfmac_f32_16x16x64_bf16 v[76:79], v[196:199], a[200:207], v9
    v_max_u32 v4, v4, v5
    v_cmp_eq_u32 vcc, -1, v4
    v_smfmac_f32_16x16x64_bf16 v[80:83], v[196:199], a[232:239], v9
    s_cbranch_vccnz .A_347
.W_348:
    v_smfmac_f32_16x16x64_bf16 v[76:79], v[200:203], a[208:215], v9
    v_smfmac_f32_16x16x64_bf16 v[80:83], v[200:203], a[240:247], v9
    s_waitcnt vmcnt(0)
    v_max3_u32 v4, v216, v217, v218
    v_max3_u32 v5, v219, v220, v221
    v_max3_u32 v4, v4, v222, v223
    v_smfmac_f32_16x16x64_bf16 v[76:79], v[204:207], a[216:223], v9
    v_max_u32 v4, v4, v5
    v_cmp_eq_u32 vcc, -1, v4
    v_smfmac_f32_16x16x64_bf16 v[80:83], v[204:207], a[248:255], v9
    s_cbranch_vccz .W_235
    s_branch .A_234
.A_349:
    buffer_load_dwordx4 v[216:219], v246, s[8:11], s33 offen offset:2048 sc1
    buffer_load_dwordx4 v[220:223], v246, s[8:11], s33 offen offset:3072 sc1
    s_sub_u32 s62, s62, 1
    s_cbranch_scc1 .mg_end_1
    s_waitcnt vmcnt(4)
    v_max3_u32 v4, v192, v193, v194
    v_max3_u32 v5, v195, v196, v197
    v_max3_u32 v4, v4, v198, v199
    v_max_u32 v4, v4, v5
    v_cmp_eq_u32 vcc, -1, v4
    s_cbranch_vccz .W_350
.A_351:
    buffer_load_dwordx4 v[192:195], v246, s[8:11], s32 offen offset:0 sc1
    buffer_load_dwordx4 v[196:199], v246, s[8:11], s32 offen offset:1024 sc1
    s_waitcnt vmcnt(4)
    v_max3_u32 v4, v208, v209, v210
    v_max3_u32 v5, v211, v212, v213
    v_max3_u32 v4, v4, v214, v215
    v_max_u32 v4, v4, v5
    v_cmp_eq_u32 vcc, -1, v4
    s_cbranch_vccz .W_326
.A_325:
    buffer_load_dwordx4 v[208:211], v246, s[8:11], s33 offen offset:0 sc1
    buffer_load_dwordx4 v[212:215], v246, s[8:11], s33 offen offset:1024 sc1
    s_waitcnt vmcnt(4)
    v_max3_u32 v4, v216, v217, v218
    v_max3_u32 v5, v219, v220, v221
    v_max3_u32 v4, v4, v222, v223
    v_max_u32 v4, v4, v5
    v_cmp_eq_u32 vcc, -1, v4
    s_cbranch_vccnz .A_349
.W_352:
    v_smfmac_f32_16x16x64_bf16 v[76:79], v[216:219], v[140:147], v9
    v_smfmac_f32_16x16x64_bf16 v[80:83], v[216:219], v[172:179], v9
    s_waitcnt vmcnt(2)
    v_max3_u32 v4, v192, v193, v194
    v_max3_u32 v5, v195, v196, v197
    v_max3_u32 v4, v4, v198, v199
    v_smfmac_f32_16x16x64_bf16 v[76:79], v[220:223], v[148:155], v9
    v_max_u32 v4, v4, v5
    v_cmp_eq_u32 vcc, -1, v4
    v_smfmac_f32_16x16x64_bf16 v[80:83], v[220:223], v[180:187], v9
    s_cbranch_vccnz .A_353
.W_354:
    v_smfmac_f32_16x16x64_bf16 v[76:79], v[192:195], a[192:199], v9
    v_smfmac_f32_16x16x64_bf16 v[80:83], v[192:195], a[224:231], v9
    s_waitcnt vmcnt(0)
    v_max3_u32 v4, v208, v209, v210
    v_max3_u32 v5, v211, v212, v213
    v_max3_u32 v4, v4, v214, v215
    v_smfmac_f32_16x16x64_bf16 v[76:79], v[196:199], a[200:207], v9
    v_max_u32 v4, v4, v5
    v_cmp_eq_u32 vcc, -1, v4
    v_smfmac_f32_16x16x64_bf16 v[80:83], v[196:199], a[232:239], v9
    s_cbranch_vccz .W_324
    s_branch .A_323
.W_350:
    v_smfmac_f32_16x16x64_bf16 v[76:79], v[192:195], a[192:199], v9
    v_smfmac_f32_16x16x64_bf16 v[80:83], v[192:195], a[224:231], v9
    s_waitcnt vmcnt(2)
    v_max3_u32 v4, v208, v209, v210
    v_max3_u32 v5, v211, v212, v213
    v_max3_u32 v4, v4, v214, v215
    v_smfmac_f32_16x16x64_bf16 v[76:79], v[196:199], a[200:207], v9
    v_max_u32 v4, v4, v5
    v_cmp_eq_u32 vcc, -1, v4
    v_smfmac_f32_16x16x64_bf16 v[80:83], v[196:199], a[232:239], v9
    s_cbranch_vccz .W_233
    s_branch .A_232
.A_355:
    buffer_load_dwordx4 v[216:219], v246, s[8:11], s33 offen offset:2048 sc1
    buffer_load_dwordx4 v[220:223], v246, s[8:11], s33 offen offset:3072 sc1
    s_sub_u32 s62, s62, 1
    s_cbranch_scc1 .mg_end_1
    s_waitcnt vmcnt(4)
    v_max3_u32 v4, v200, v201, v202
    v_max3_u32 v5, v203, v204, v205
    v_max3_u32 v4, v4, v206, v207
    v_max_u32 v4, v4, v5
    v_cmp_eq_u32 vcc, -1, v4
    s_cbranch_vccz .W_231
.A_230:
    buffer_load_dwordx4 v[200:203], v246, s[8:11], s32 offen offset:2048 sc1
    buffer_load_dwordx4 v[204:207], v246, s[8:11], s32 offen offset:3072 sc1
    s_waitcnt vmcnt(4)
    v_max3_u32 v4, v208, v209, v210
    v_max3_u32 v5, v211, v212, v213
    v_max3_u32 v4, v4, v214, v215
    v_max_u32 v4, v4, v5
    v_cmp_eq_u32 vcc, -1, v4
    s_cbranch_vccz .W_356
.A_357:
    buffer_load_dwordx4 v[208:211], v246, s[8:11], s33 offen offset:0 sc1
    buffer_load_dwordx4 v[212:215], v246, s[8:11], s33 offen offset:1024 sc1
    s_waitcnt vmcnt(4)
    v_max3_u32 v4, v216, v217, v218
    v_max3_u32 v5, v219, v220, v221
    v_max3_u32 v4, v4, v222, v223
    v_max_u32 v4, v4, v5
    v_cmp_eq_u32 vcc, -1, v4
    s_cbranch_vccnz .A_355
.W_358:
    v_smfmac_f32_16x16x64_bf16 v[76:79], v[216:219], v[140:147], v9
    v_smfmac_f32_16x16x64_bf16 v[80:83], v[216:219], v[172:179], v9
    s_waitcnt vmcnt(2)
    v_max3_u32 v4, v200, v201, v202
    v_max3_u32 v5, v203, v204, v205
    v_max3_u32 v4, v4, v206, v207
    v_smfmac_f32_16x16x64_bf16 v[76:79], v[220:223], v[148:155], v9
    v_max_u32 v4, v4, v5
    v_cmp_eq_u32 vcc, -1, v4
    v_smfmac_f32_16x16x64_bf16 v[80:83], v[220:223], v[180:187], v9
    s_cbranch_vccz .W_322
    s_branch .A_321
.W_356:
    v_smfmac_f32_16x16x64_bf16 v[76:79], v[208:211], v[124:131], v9
    v_smfmac_f32_16x16x64_bf16 v[80:83], v[208:211], v[156:163], v9
    s_waitcnt vmcnt(2)
    v_max3_u32 v4, v216, v217, v218
    v_max3_u32 v5, v219, v220, v221
    v_max3_u32 v4, v4, v222, v223
    v_smfmac_f32_16x16x64_bf16 v[76:79], v[212:215], v[132:139], v9
    v_max_u32 v4, v4, v5
    v_cmp_eq_u32 vcc, -1, v4
    v_smfmac_f32_16x16x64_bf16 v[80:83], v[212:215], v[164:171], v9
    s_cbranch_vccnz .A_359
.W_360:
    v_smfmac_f32_16x16x64_bf16 v[76:79], v[216:219], v[140:147], v9
    v_smfmac_f32_16x16x64_bf16 v[80:83], v[216:219], v[172:179], v9
    s_waitcnt vmcnt(0)
    v_max3_u32 v4, v200, v201, v202
    v_max3_u32 v5, v203, v204, v205
    v_max3_u32 v4, v4, v206, v207
    v_smfmac_f32_16x16x64_bf16 v[76:79], v[220:223], v[148:155], v9
    v_max_u32 v4, v4, v5
    v_cmp_eq_u32 vcc, -1, v4
    v_smfmac_f32_16x16x64_bf16 v[80:83], v[220:223], v[180:187], v9
    s_cbranch_vccz .W_336
    s_branch .A_335
.A_361:
    buffer_load_dwordx4 v[200:203], v246, s[8:11], s32 offen offset:2048 sc1
    buffer_load_dwordx4 v[204:207], v246, s[8:11], s32 offen offset:3072 sc1
    s_sub_u32 s62, s62, 1
    s_cbranch_scc1 .mg_end_1
    s_waitcnt vmcnt(2)
    v_max3_u32 v4, v192, v193, v194
    v_max3_u32 v5, v195, v196, v197
    v_max3_u32 v4, v4, v198, v199
    v_max_u32 v4, v4, v5
    v_cmp_eq_u32 vcc, -1, v4
    s_cbranch_vccz .W_334
.A_333:
    buffer_load_dwordx4 v[192:195], v246, s[8:11], s32 offen offset:0 sc1
    buffer_load_dwordx4 v[196:199], v246, s[8:11], s32 offen offset:1024 sc1
    s_waitcnt vmcnt(2)
    v_max3_u32 v4, v200, v201, v202
    v_max3_u32 v5, v203, v204, v205
    v_max3_u32 v4, v4, v206, v207
    v_max_u32 v4, v4, v5
    v_cmp_eq_u32 vcc, -1, v4
    s_cbranch_vccnz .A_361
.W_362:
    v_smfmac_f32_16x16x64_bf16 v[76:79], v[200:203], a[208:215], v9
    v_smfmac_f32_16x16x64_bf16 v[80:83], v[200:203], a[240:247], v9
    s_waitcnt vmcnt(0)
    v_max3_u32 v4, v192, v193, v194
    v_max3_u32 v5, v195, v196, v197
    v_max3_u32 v4, v4, v198, v199
    v_smfmac_f32_16x16x64_bf16 v[76:79], v[204:207], a[216:223], v9
    v_max_u32 v4, v4, v5
    v_cmp_eq_u32 vcc, -1, v4
    v_smfmac_f32_16x16x64_bf16 v[80:83], v[204:207], a[248:255], v9
    s_cbranch_vccz .W_330
    s_branch .A_329
.A_341:
    buffer_load_dwordx4 v[208:211], v246, s[8:11], s33 offen offset:0 sc1
    buffer_load_dwordx4 v[212:215], v246, s[8:11], s33 offen offset:1024 sc1
    s_sub_u32 s62, s62, 1
    s_cbranch_scc1 .mg_end_1
    s_waitcnt vmcnt(2)
    v_max3_u32 v4, v192, v193, v194
    v_max3_u32 v5, v195, v196, v197
    v_max3_u32 v4, v4, v198, v199
    v_max_u32 v4, v4, v5
    v_cmp_eq_u32 vcc, -1, v4
    s_cbranch_vccz .W_354
.A_353:
    buffer_load_dwordx4 v[192:195], v246, s[8:11], s32 offen offset:0 sc1
    buffer_load_dwordx4 v[196:199], v246, s[8:11], s32 offen offset:1024 sc1
    s_waitcnt vmcnt(2)
    v_max3_u32 v4, v208, v209, v210
    v_max3_u32 v5, v211, v212, v213
    v_max3_u32 v4, v4, v214, v215
    v_max_u32 v4, v4, v5
    v_cmp_eq_u32 vcc, -1, v4
    s_cbranch_vccnz .A_341
    s_branch .W_342
.A_363:
    buffer_load_dwordx4 v[192:195], v246, s[8:11], s32 offen offset:0 sc1
    buffer_load_dwordx4 v[196:199], v246, s[8:11], s32 offen offset:1024 sc1
    s_sub_u32 s62, s62, 1
    s_cbranch_scc1 .mg_end_1
    s_waitcnt vmcnt(2)
    v_max3_u32 v4, v216, v217, v218
    v_max3_u32 v5, v219, v220, v221
    v_max3_u32 v4, v4, v222, v223
    v_max_u32 v4, v4, v5
    v_cmp_eq_u32 vcc, -1, v4
    s_cbranch_vccz .W_328
.A_327:
    buffer_load_dwordx4 v[216:219], v246, s[8:11], s33 offen offset:2048 sc1
    buffer_load_dwordx4 v[220:223], v246, s[8:11], s33 offen offset:3072 sc1
    s_waitcnt vmcnt(2)
    v_max3_u32 v4, v192, v193, v194
    v_max3_u32 v5, v195, v196, v197
    v_max3_u32 v4, v4, v198, v199
    v_max_u32 v4, v4, v5
    v_cmp_eq_u32 vcc, -1, v4
    s_cbranch_vccnz .A_363
.W_364:
    v_smfmac_f32_16x16x64_bf16 v[76:79], v[192:195], a[192:199], v9
    v_smfmac_f32_16x16x64_bf16 v[80:83], v[192:195], a[224:231], v9
    s_waitcnt vmcnt(0)
    v_max3_u32 v4, v216, v217, v218
    v_max3_u32 v5, v219, v220, v221
    v_max3_u32 v4, v4, v222, v223
    v_smfmac_f32_16x16x64_bf16 v[76:79], v[196:199], a[200:207], v9
    v_max_u32 v4, v4, v5
    v_cmp_eq_u32 vcc, -1, v4
    v_smfmac_f32_16x16x64_bf16 v[80:83], v[196:199], a[232:239], v9
    s_cbranch_vccz .W_235
    s_branch .A_234
.A_365:
    buffer_load_dwordx4 v[208:211], v246, s[8:11], s33 offen offset:0 sc1
    buffer_load_dwordx4 v[212:215], v246, s[8:11], s33 offen offset:1024 sc1
    s_sub_u32 s62, s62, 1
    s_cbranch_scc1 .mg_end_1
    s_waitcnt vmcnt(2)
    v_max3_u32 v4, v200, v201, v202
    v_max3_u32 v5, v203, v204, v205
    v_max3_u32 v4, v4, v206, v207
    v_max_u32 v4, v4, v5
    v_cmp_eq_u32 vcc, -1, v4
    s_cbranch_vccz .W_322
.A_321:
    buffer_load_dwordx4 v[200:203], v246, s[8:11], s32 offen offset:2048 sc1
    buffer_load_dwordx4 v[204:207], v246, s[8:11], s32 offen offset:3072 sc1
    s_waitcnt vmcnt(2)
    v_max3_u32 v4, v208, v209, v210
    v_max3_u32 v5, v211, v212, v213
    v_max3_u32 v4, v4, v214, v215
    v_max_u32 v4, v4, v5
    v_cmp_eq_u32 vcc, -1, v4
    s_cbranch_vccnz .A_365
.W_366:
    v_smfmac_f32_16x16x64_bf16 v[76:79], v[208:211], v[124:131], v9
    v_smfmac_f32_16x16x64_bf16 v[80:83], v[208:211], v[156:163], v9
    s_waitcnt vmcnt(0)
    v_max3_u32 v4, v200, v201, v202
    v_max3_u32 v5, v203, v204, v205
    v_max3_u32 v4, v4, v206, v207
    v_smfmac_f32_16x16x64_bf16 v[76:79], v[212:215], v[132:139], v9
    v_max_u32 v4, v4, v5
    v_cmp_eq_u32 vcc, -1, v4
    v_smfmac_f32_16x16x64_bf16 v[80:83], v[212:215], v[164:171], v9
    s_cbranch_vccz .W_336
    s_branch .A_335
.A_359:
    buffer_load_dwordx4 v[216:219], v246, s[8:11], s33 offen offset:2048 sc1
    buffer_load_dwordx4 v[220:223], v246, s[8:11], s33 offen offset:3072 sc1
    s_sub_u32 s62, s62, 1
    s_cbranch_scc1 .mg_end_1
    s_waitcnt vmcnt(2)
    v_max3_u32 v4, v200, v201, v202
    v_max3_u32 v5, v203, v204, v205
    v_max3_u32 v4, v4, v206, v207
    v_max_u32 v4, v4, v5
    v_cmp_eq_u32 vcc, -1, v4
    s_cbranch_vccz .W_348
.A_347:
    buffer_load_dwordx4 v[200:203], v246, s[8:11], s32 offen offset:2048 sc1
    buffer_load_dwordx4 v[204:207], v246, s[8:11], s32 offen offset:3072 sc1
    s_waitcnt vmcnt(2)
    v_max3_u32 v4, v216, v217, v218
    v_max3_u32 v5, v219, v220, v221
    v_max3_u32 v4, v4, v222, v223
    v_max_u32 v4, v4, v5
    v_cmp_eq_u32 vcc, -1, v4
    s_cbranch_vccnz .A_359
    s_branch .W_360
.A_367:
    buffer_load_dwordx4 v[216:219], v246, s[8:11], s33 offen offset:2048 sc1
    buffer_load_dwordx4 v[220:223], v246, s[8:11], s33 offen offset:3072 sc1
    s_sub_u32 s62, s62, 1
    s_cbranch_scc1 .mg_end_1
    s_waitcnt vmcnt(2)
    v_max3_u32 v4, v208, v209, v210
    v_max3_u32 v5, v211, v212, v213
    v_max3_u32 v4, v4, v214, v215
    v_max_u32 v4, v4, v5
    v_cmp_eq_u32 vcc, -1, v4
    s_cbranch_vccz .W_233
.A_232:
    buffer_load_dwordx4 v[208:211], v246, s[8:11], s33 offen offset:0 sc1
    buffer_load_dwordx4 v[212:215], v246, s[8:11], s33 offen offset:1024 sc1
    s_waitcnt vmcnt(2)
    v_max3_u32 v4, v216, v217, v218
    v_max3_u32 v5, v219, v220, v221
    v_max3_u32 v4, v4, v222, v223
    v_max_u32 v4, v4, v5
    v_cmp_eq_u32 vcc, -1, v4
    s_cbranch_vccnz .A_367
.W_368:
    v_smfmac_f32_16x16x64_bf16 v[76:79], v[216:219], v[140:147], v9
    v_smfmac_f32_16x16x64_bf16 v[80:83], v[216:219], v[172:179], v9
    s_waitcnt vmcnt(0)
    v_max3_u32 v4, v208, v209, v210
    v_max3_u32 v5, v211, v212, v213
    v_max3_u32 v4, v4, v214, v215
    v_smfmac_f32_16x16x64_bf16 v[76:79], v[220:223], v[148:155], v9
    v_max_u32 v4, v4, v5
    v_cmp_eq_u32 vcc, -1, v4
    v_smfmac_f32_16x16x64_bf16 v[80:83], v[220:223], v[180:187], v9
    s_cbranch_vccz .W_324
    s_branch .A_323
.A_329:
    buffer_load_dwordx4 v[192:195], v246, s[8:11], s32 offen offset:0 sc1
    buffer_load_dwordx4 v[196:199], v246, s[8:11], s32 offen offset:1024 sc1
    s_sub_u32 s62, s62, 1
    s_cbranch_scc1 .mg_end_1
    s_waitcnt vmcnt(2)
    v_max3_u32 v4, v192, v193, v194
    v_max3_u32 v5, v195, v196, v197
    v_max3_u32 v4, v4, v198, v199
    v_max_u32 v4, v4, v5
    v_cmp_eq_u32 vcc, -1, v4
    s_cbranch_vccnz .A_329
    v_smfmac_f32_16x16x64_bf16 v[76:79], v[192:195], a[192:199], v9
    v_smfmac_f32_16x16x64_bf16 v[80:83], v[192:195], a[224:231], v9
    v_smfmac_f32_16x16x64_bf16 v[76:79], v[196:199], a[200:207], v9
    v_smfmac_f32_16x16x64_bf16 v[80:83], v[196:199], a[232:239], v9
    s_branch .mj_227
.A_335:
    buffer_load_dwordx4 v[200:203], v246, s[8:11], s32 offen offset:2048 sc1
    buffer_load_dwordx4 v[204:207], v246, s[8:11], s32 offen offset:3072 sc1
    s_sub_u32 s62, s62, 1
    s_cbranch_scc1 .mg_end_1
    s_waitcnt vmcnt(2)
    v_max3_u32 v4, v200, v201, v202
    v_max3_u32 v5, v203, v204, v205
    v_max3_u32 v4, v4, v206, v207
    v_max_u32 v4, v4, v5
    v_cmp_eq_u32 vcc, -1, v4
    s_cbranch_vccnz .A_335
    v_smfmac_f32_16x16x64_bf16 v[76:79], v[200:203], a[208:215], v9
    v_smfmac_f32_16x16x64_bf16 v[80:83], v[200:203], a[240:247], v9
    v_smfmac_f32_16x16x64_bf16 v[76:79], v[204:207], a[216:223], v9
    v_smfmac_f32_16x16x64_bf16 v[80:83], v[204:207], a[248:255], v9
    s_branch .mj_227
.A_323:
    buffer_load_dwordx4 v[208:211], v246, s[8:11], s33 offen offset:0 sc1
    buffer_load_dwordx4 v[212:215], v246, s[8:11], s33 offen offset:1024 sc1
    s_sub_u32 s62, s62, 1
    s_cbranch_scc1 .mg_end_1
    s_waitcnt vmcnt(2)
    v_max3_u32 v4, v208, v209, v210
    v_max3_u32 v5, v211, v212, v213
    v_max3_u32 v4, v4, v214, v215
    v_max_u32 v4, v4, v5
    v_cmp_eq_u32 vcc, -1, v4
    s_cbranch_vccnz .A_323
    v_smfmac_f32_16x16x64_bf16 v[76:79], v[208:211], v[124:131], v9
    v_smfmac_f32_16x16x64_bf16 v[80:83], v[208:211], v[156:163], v9
    v_smfmac_f32_16x16x64_bf16 v[76:79], v[212:215], v[132:139], v9
    v_smfmac_f32_16x16x64_bf16 v[80:83], v[212:215], v[164:171], v9
    s_branch .mj_227
.A_234:
    buffer_load_dwordx4 v[216:219], v246, s[8:11], s33 offen offset:2048 sc1
    buffer_load_dwordx4 v[220:223], v246, s[8:11], s33 offen offset:3072 sc1
    s_sub_u32 s62, s62, 1
    s_cbranch_scc1 .mg_end_1
    s_waitcnt vmcnt(2)
    v_max3_u32 v4, v216, v217, v218
    v_max3_u32 v5, v219, v220, v221
    v_max3_u32 v4, v4, v222, v223
    v_max_u32 v4, v4, v5
    v_cmp_eq_u32 vcc, -1, v4
    s_cbranch_vccnz .A_234
    v_smfmac_f32_16x16x64_bf16 v[76:79], v[216:219], v[140:147], v9
    v_smfmac_f32_16x16x64_bf16 v[80:83], v[216:219], v[172:179], v9
    v_smfmac_f32_16x16x64_bf16 v[76:79], v[220:223], v[148:155], v9
    v_smfmac_f32_16x16x64_bf16 v[80:83], v[220:223], v[180:187], v9
    s_branch .mj_227
.sk_236:
    s_mov_b64 exec, s[66:67]
    buffer_store_dwordx4 v[88:91], v11, s[8:11], s36 offen sc1
    s_mov_b64 exec, s[56:57]
    buffer_store_dwordx4 v[172:175], v12, s[8:11], s36 offen sc1
    s_mov_b64 exec, -1

    s_branch .rec_fin_6
.rec_fin_6:
    s_mov_b64 exec, -1
    s_endpgm
.mg_bg_2:
    s_sub_u32 s91, s25, 4
    s_lshl_b32 s90, s91, 5
    s_add_u32 s90, s90, s26
    s_cmp_ge_u32 s26, 24
    s_cbranch_scc1 .cvrole_369
    s_lshr_b32 s30, s26, 3
    s_sub_u32 s30, 2, s30
    s_and_b32 s31, s26, 7
    s_lshl_b32 s4, s91, 3
    s_add_u32 s31, s31, s4

    s_lshl_b32 s4, s30, 5
    s_add_u32 s4, s4, s31
    s_lshl_b32 s4, s4, 8
    s_add_u32 s4, s4, 92274688
    v_mov_b32 v4, 0
    s_mov_b64 exec, 1
    buffer_store_dword v4, v4, s[8:11], s4 offen sc1
    s_mov_b64 exec, -1

    s_load_dwordx2 s[40:41], s[0:1], 0
    s_load_dwordx4 s[44:47], s[0:1], 64
    s_load_dwordx2 s[42:43], s[0:1], 80

    v_and_b32 v1, 63, v0
    v_and_b32 v2, 15, v1
    v_lshrrev_b32 v3, 4, v1

    s_lshl_b32 s28, s31, 8
    s_waitcnt lgkmcnt(0)
    s_mov_b64 s[48:49], s[42:43]
    s_cmp_eq_u32 s30, 0
    s_cselect_b64 s[42:43], s[44:45], s[42:43]
    s_cmp_eq_u32 s30, 1
    s_cselect_b64 s[42:43], s[46:47], s[42:43]

    s_mov_b32 s16, s40
    s_and_b32 s17, s41, 0xffff
    s_mov_b32 s18, 0x400000
    s_mov_b32 s19, 0x00020000

    s_mov_b32 s12, s42
    s_and_b32 s13, s43, 0xffff
    s_mov_b32 s14, 0x800000
    s_mov_b32 s15, 0x00020000

    v_lshrrev_b32 v4, 1, v2
    v_xor_b32 v4, v4, v3
    v_lshlrev_b32 v4, 1, v4
    v_and_b32 v5, 1, v1
    v_or_b32 v4, v4, v5
    v_lshlrev_b32 v4, 4, v4
    v_lshlrev_b32 v5, 13, v3
    v_add_u32 v10, v4, v5
    v_xor_b32 v11, 0x80, v10
    s_lshl_b32 s4, s24, 18
    s_add_u32 s28, s28, s4
    s_lshl_b32 s29, s24, 13
    v_lshrrev_b32 v4, 2, v2
    v_and_b32 v5, 1, v3
    v_lshl_or_b32 v5, v5, 2, v4
    s_lshl_b32 s4, s24, 1
    v_xor_b32 v5, s4, v5
    v_lshlrev_b32 v5, 5, v5
    v_lshl_add_u32 v4, v3, 3, v4
    v_lshl_add_u32 v5, v4, 8, v5
    v_and_b32 v4, 3, v2
    v_lshl_add_u32 v12, v4, 3, v5
    v_xor_b32 v13, 32, v12
    v_add_u32 v14, 0x10000, v12
    v_add_u32 v15, 0x10000, v13

    s_mov_b32 s63, 0
    s_cmp_lg_u32 s30, 0
    s_cbranch_scc1 .qh_370
    s_cmp_lt_u32 s24, 2
    s_cselect_b64 s[48:49], s[46:47], s[48:49]

    s_mov_b32 s64, s48
    s_and_b32 s65, s49, 0xffff
    s_mov_b32 s66, 0x800000
    s_mov_b32 s67, 0x00020000

    v_lshlrev_b32 v4, 13, v1
    s_and_b32 s4, s24, 1
    s_lshl_b32 s4, s4, 7
    s_lshl_b32 s5, s31, 8
    s_add_u32 s4, s4, s5
    s_add_u32 s4, s4, 4194304
    s_waitcnt vmcnt(0)

    v_mov_b32 v243, s99
    v_mov_b32 v242, 0
    s_cmp_lg_u32 s24, 0
    s_cbranch_scc1 .a1_371
    s_mov_b64 exec, 1
    buffer_atomic_add v243, v242, s[20:23], s97 offen sc1
    s_mov_b64 exec, -1

.a1_371:
    buffer_load_dword v31, v4, s[64:67], s4 offen
    s_add_u32 s4, s4, 524288
    buffer_load_dword v31, v4, s[64:67], s4 offen
    s_add_u32 s4, s4, 524288
    buffer_load_dword v31, v4, s[64:67], s4 offen
    s_add_u32 s4, s4, 524288
    buffer_load_dword v31, v4, s[64:67], s4 offen
    s_add_u32 s4, s4, 524288
    buffer_load_dword v31, v4, s[64:67], s4 offen
    s_add_u32 s4, s4, 524288
    buffer_load_dword v31, v4, s[64:67], s4 offen
    s_add_u32 s4, s4, 524288
    buffer_load_dword v31, v4, s[64:67], s4 offen
    s_add_u32 s4, s4, 524288
    buffer_load_dword v31, v4, s[64:67], s4 offen
    s_add_u32 s4, s4, 524288
    s_waitcnt vmcnt(0)
    s_mov_b32 s63, 99
.qh_370:
    s_and_b32 s4, s26, 7
    s_lshl_b32 s4, s4, 1
    s_lshr_b32 s5, s24, 1
    s_add_u32 s4, s4, s5
    s_lshl_b32 s4, s4, 6
    v_add_u32 v4, s4, v1
    v_lshlrev_b32 v4, 13, v4
    s_and_b32 s4, s24, 1
    s_lshl_b32 s4, s4, 10
    s_lshl_b32 s5, s91, 11
    s_add_u32 s4, s4, s5
    buffer_load_dword v31, v4, s[12:15], s4 offen offset:384

    s_add_u32 m0, s29, 0
    s_add_u32 s4, s28, 0
    buffer_load_dwordx4 v10, s[12:15], s4 offen lds

    s_add_u32 m0, s29, 1024
    s_add_u32 s4, s28, 32768
    buffer_load_dwordx4 v10, s[12:15], s4 offen lds

    s_add_u32 m0, s29, 2048
    s_add_u32 s4, s28, 65536
    buffer_load_dwordx4 v11, s[12:15], s4 offen lds

    s_add_u32 m0, s29, 3072
    s_add_u32 s4, s28, 98304
    buffer_load_dwordx4 v11, s[12:15], s4 offen lds

    s_add_u32 m0, s29, 4096
    s_add_u32 s4, s28, 131072
    buffer_load_dwordx4 v10, s[12:15], s4 offen lds

    s_add_u32 m0, s29, 5120
    s_add_u32 s4, s28, 163840
    buffer_load_dwordx4 v10, s[12:15], s4 offen lds

    s_add_u32 m0, s29, 6144
    s_add_u32 s4, s28, 196608
    buffer_load_dwordx4 v11, s[12:15], s4 offen lds

    s_add_u32 m0, s29, 7168
    s_add_u32 s4, s28, 229376
    buffer_load_dwordx4 v11, s[12:15], s4 offen lds

    s_waitcnt vmcnt(9)
    v_mov_b32 v243, s99
    v_mov_b32 v242, 0
    s_cmp_lg_u32 s24, s63
    s_cbranch_scc1 .a1_373
    s_mov_b64 exec, 1
    buffer_atomic_add v243, v242, s[20:23], s97 offen sc1
    s_mov_b64 exec, -1

.a1_373:
    s_add_u32 m0, s29, 32768
    s_add_u32 s4, s28, 1048576
    buffer_load_dwordx4 v10, s[12:15], s4 offen lds

    s_add_u32 m0, s29, 33792
    s_add_u32 s4, s28, 1081344
    buffer_load_dwordx4 v10, s[12:15], s4 offen lds

    s_add_u32 m0, s29, 34816
    s_add_u32 s4, s28, 1114112
    buffer_load_dwordx4 v11, s[12:15], s4 offen lds

    s_add_u32 m0, s29, 35840
    s_add_u32 s4, s28, 1146880
    buffer_load_dwordx4 v11, s[12:15], s4 offen lds

    s_add_u32 m0, s29, 36864
    s_add_u32 s4, s28, 1179648
    buffer_load_dwordx4 v10, s[12:15], s4 offen lds

    s_add_u32 m0, s29, 37888
    s_add_u32 s4, s28, 1212416
    buffer_load_dwordx4 v10, s[12:15], s4 offen lds

    s_add_u32 m0, s29, 38912
    s_add_u32 s4, s28, 1245184
    buffer_load_dwordx4 v11, s[12:15], s4 offen lds

    s_add_u32 m0, s29, 39936
    s_add_u32 s4, s28, 1277952
    buffer_load_dwordx4 v11, s[12:15], s4 offen lds

    s_add_u32 m0, s29, 65536
    s_add_u32 s4, s28, 2097152
    buffer_load_dwordx4 v10, s[12:15], s4 offen lds

    s_add_u32 m0, s29, 66560
    s_add_u32 s4, s28, 2129920
    buffer_load_dwordx4 v10, s[12:15], s4 offen lds

    s_add_u32 m0, s29, 67584
    s_add_u32 s4, s28, 2162688
    buffer_load_dwordx4 v11, s[12:15], s4 offen lds

    s_add_u32 m0, s29, 68608
    s_add_u32 s4, s28, 2195456
    buffer_load_dwordx4 v11, s[12:15], s4 offen lds

    s_add_u32 m0, s29, 69632
    s_add_u32 s4, s28, 2228224
    buffer_load_dwordx4 v10, s[12:15], s4 offen lds

    s_add_u32 m0, s29, 70656
    s_add_u32 s4, s28, 2260992
    buffer_load_dwordx4 v10, s[12:15], s4 offen lds

    s_add_u32 m0, s29, 71680
    s_add_u32 s4, s28, 2293760
    buffer_load_dwordx4 v11, s[12:15], s4 offen lds

    s_add_u32 m0, s29, 72704
    s_add_u32 s4, s28, 2326528
    buffer_load_dwordx4 v11, s[12:15], s4 offen lds

    s_add_u32 m0, s29, 98304
    s_add_u32 s4, s28, 3145728
    buffer_load_dwordx4 v10, s[12:15], s4 offen lds

    s_add_u32 m0, s29, 99328
    s_add_u32 s4, s28, 3178496
    buffer_load_dwordx4 v10, s[12:15], s4 offen lds

    s_add_u32 m0, s29, 100352
    s_add_u32 s4, s28, 3211264
    buffer_load_dwordx4 v11, s[12:15], s4 offen lds

    s_add_u32 m0, s29, 101376
    s_add_u32 s4, s28, 3244032
    buffer_load_dwordx4 v11, s[12:15], s4 offen lds

    s_add_u32 m0, s29, 102400
    s_add_u32 s4, s28, 3276800
    buffer_load_dwordx4 v10, s[12:15], s4 offen lds

    s_add_u32 m0, s29, 103424
    s_add_u32 s4, s28, 3309568
    buffer_load_dwordx4 v10, s[12:15], s4 offen lds

    s_add_u32 m0, s29, 104448
    s_add_u32 s4, s28, 3342336
    buffer_load_dwordx4 v11, s[12:15], s4 offen lds

    s_add_u32 m0, s29, 105472
    s_add_u32 s4, s28, 3375104
    buffer_load_dwordx4 v11, s[12:15], s4 offen lds

    v_lshrrev_b32 v4, 3, v1
    v_and_b32 v5, 7, v1
    v_xor_b32 v5, v5, v4
    v_lshlrev_b32 v5, 4, v5
    v_lshl_add_u32 v16, v4, 11, v5
    s_lshl_b32 s4, s24, 14
    v_add_u32 v16, s4, v16
    v_and_b32 v4, 7, v2
    v_xor_b32 v5, v4, v3
    v_lshlrev_b32 v5, 4, v5
    v_lshl_add_u32 v5, v4, 7, v5
    v_lshrrev_b32 v4, 3, v2
    v_lshl_add_u32 v17, v4, 13, v5
    v_xor_b32 v18, 64, v17
    v_add_u32 v19, 0x10000, v17
    v_add_u32 v20, 0x10000, v18
    v_lshlrev_b32 v21, 4, v1
    s_lshl_b32 s32, s30, 24
    s_lshl_b32 s4, s31, 13
    s_add_u32 s32, s32, s4
    s_lshr_b32 s5, s30, 1
    s_add_u32 s5, s5, 10
    s_lshl_b32 s4, s24, s5
    s_add_u32 s39, s32, s4
    s_mov_b32 s32, s39
    s_add_u32 s38, s39, 4096
    s_mul_i32 s49, s31, 6144
    s_lshl_b32 s4, s30, 11
    s_add_u32 s49, s49, s4
    s_lshl_b32 s4, s24, 9
    s_add_u32 s49, s49, s4
    s_add_u32 s49, s49, 67108864
    s_mov_b32 s48, s49
    v_mov_b32 v23, -1
    s_lshl_b32 s4, s30, 5
    s_add_u32 s4, s4, s31
    s_lshl_b32 s4, s4, 8
    s_add_u32 s33, s4, 92274688
    s_cmp_eq_u32 s24, 0
    s_cselect_b32 s36, 1, 0
    s_mov_b32 s37, 0
    v_mov_b32 v22, 0
    s_mov_b32 s34, 0
    s_mov_b32 s35, 0
    s_and_b32 s4, s26, 7
    s_lshl_b32 s4, s4, 2
    s_add_u32 s4, s4, s24
    s_lshl_b32 s4, s4, 11
    v_lshlrev_b32 v111, 5, v1
    v_add_u32 v111, s4, v111

    s_mul_i32 s47, s26, 1441792
    s_lshl_b32 s4, s24, 10
    s_add_u32 s47, s47, s4
    s_add_u32 s47, s47, 184549376
    v_mov_b32 v24, -1
    v_mov_b32 v25, -1
    v_mov_b32 v26, -1
    v_mov_b32 v27, -1

    s_xor_b32 s4, s91, 1
    s_lshl_b32 s5, s4, 14
    s_lshl_b32 s6, s91, 12
    s_add_u32 s5, s5, s6
    v_add_u32 v28, s5, v21
    s_lshl_b32 s5, s91, 14
    s_lshl_b32 s6, s4, 12
    s_add_u32 s5, s5, s6
    v_add_u32 v7, s5, v21

    s_xor_b32 s4, s91, 2
    s_lshl_b32 s5, s4, 14
    s_lshl_b32 s6, s91, 12
    s_add_u32 s5, s5, s6
    v_add_u32 v29, s5, v21
    s_lshl_b32 s5, s91, 14
    s_lshl_b32 s6, s4, 12
    s_add_u32 s5, s5, s6
    v_add_u32 v8, s5, v21

    s_xor_b32 s4, s91, 3
    s_lshl_b32 s5, s4, 14
    s_lshl_b32 s6, s91, 12
    s_add_u32 s5, s5, s6
    v_add_u32 v30, s5, v21
    s_lshl_b32 s5, s91, 14
    s_lshl_b32 s6, s4, 12
    s_add_u32 s5, s5, s6
    v_add_u32 v9, s5, v21

    s_mov_b64 s[44:45], -1
    s_mov_b32 s46, s47
    s_waitcnt vmcnt(24)
    s_barrier
    ds_read_b64_tr_b16 a[0:1], v12 offset:0
    ds_read_b64_tr_b16 a[2:3], v12 offset:1024
    ds_read_b64_tr_b16 a[4:5], v13 offset:0
    ds_read_b64_tr_b16 a[6:7], v13 offset:1024
    ds_read_b64_tr_b16 a[8:9], v12 offset:8192
    ds_read_b64_tr_b16 a[10:11], v12 offset:9216
    ds_read_b64_tr_b16 a[12:13], v13 offset:8192
    ds_read_b64_tr_b16 a[14:15], v13 offset:9216
    ds_read_b64_tr_b16 a[16:17], v12 offset:16384
    ds_read_b64_tr_b16 a[18:19], v12 offset:17408
    ds_read_b64_tr_b16 a[20:21], v13 offset:16384
    ds_read_b64_tr_b16 a[22:23], v13 offset:17408
    ds_read_b64_tr_b16 a[24:25], v12 offset:24576
    ds_read_b64_tr_b16 a[26:27], v12 offset:25600
    ds_read_b64_tr_b16 a[28:29], v13 offset:24576
    ds_read_b64_tr_b16 a[30:31], v13 offset:25600
    s_waitcnt lgkmcnt(0)
    s_barrier
    s_add_u32 m0, s29, 0
    s_add_u32 s4, s28, 4194304
    buffer_load_dwordx4 v10, s[12:15], s4 offen lds

    s_add_u32 m0, s29, 1024
    s_add_u32 s4, s28, 4227072
    buffer_load_dwordx4 v10, s[12:15], s4 offen lds

    s_add_u32 m0, s29, 2048
    s_add_u32 s4, s28, 4259840
    buffer_load_dwordx4 v11, s[12:15], s4 offen lds

    s_add_u32 m0, s29, 3072
    s_add_u32 s4, s28, 4292608
    buffer_load_dwordx4 v11, s[12:15], s4 offen lds

    s_add_u32 m0, s29, 4096
    s_add_u32 s4, s28, 4325376
    buffer_load_dwordx4 v10, s[12:15], s4 offen lds

    s_add_u32 m0, s29, 5120
    s_add_u32 s4, s28, 4358144
    buffer_load_dwordx4 v10, s[12:15], s4 offen lds

    s_add_u32 m0, s29, 6144
    s_add_u32 s4, s28, 4390912
    buffer_load_dwordx4 v11, s[12:15], s4 offen lds

    s_add_u32 m0, s29, 7168
    s_add_u32 s4, s28, 4423680
    buffer_load_dwordx4 v11, s[12:15], s4 offen lds

    s_waitcnt vmcnt(24)
    s_barrier
    ds_read_b64_tr_b16 a[32:33], v12 offset:32768
    ds_read_b64_tr_b16 a[34:35], v12 offset:33792
    ds_read_b64_tr_b16 a[36:37], v13 offset:32768
    ds_read_b64_tr_b16 a[38:39], v13 offset:33792
    ds_read_b64_tr_b16 a[40:41], v12 offset:40960
    ds_read_b64_tr_b16 a[42:43], v12 offset:41984
    ds_read_b64_tr_b16 a[44:45], v13 offset:40960
    ds_read_b64_tr_b16 a[46:47], v13 offset:41984
    ds_read_b64_tr_b16 a[48:49], v12 offset:49152
    ds_read_b64_tr_b16 a[50:51], v12 offset:50176
    ds_read_b64_tr_b16 a[52:53], v13 offset:49152
    ds_read_b64_tr_b16 a[54:55], v13 offset:50176
    ds_read_b64_tr_b16 a[56:57], v12 offset:57344
    ds_read_b64_tr_b16 a[58:59], v12 offset:58368
    ds_read_b64_tr_b16 a[60:61], v13 offset:57344
    ds_read_b64_tr_b16 a[62:63], v13 offset:58368
    s_waitcnt lgkmcnt(0)
    s_barrier
    s_add_u32 m0, s29, 32768
    s_add_u32 s4, s28, 5242880
    buffer_load_dwordx4 v10, s[12:15], s4 offen lds

    s_add_u32 m0, s29, 33792
    s_add_u32 s4, s28, 5275648
    buffer_load_dwordx4 v10, s[12:15], s4 offen lds

    s_add_u32 m0, s29, 34816
    s_add_u32 s4, s28, 5308416
    buffer_load_dwordx4 v11, s[12:15], s4 offen lds

    s_add_u32 m0, s29, 35840
    s_add_u32 s4, s28, 5341184
    buffer_load_dwordx4 v11, s[12:15], s4 offen lds

    s_add_u32 m0, s29, 36864
    s_add_u32 s4, s28, 5373952
    buffer_load_dwordx4 v10, s[12:15], s4 offen lds

    s_add_u32 m0, s29, 37888
    s_add_u32 s4, s28, 5406720
    buffer_load_dwordx4 v10, s[12:15], s4 offen lds

    s_add_u32 m0, s29, 38912
    s_add_u32 s4, s28, 5439488
    buffer_load_dwordx4 v11, s[12:15], s4 offen lds

    s_add_u32 m0, s29, 39936
    s_add_u32 s4, s28, 5472256
    buffer_load_dwordx4 v11, s[12:15], s4 offen lds

    s_waitcnt vmcnt(24)
    s_barrier
    ds_read_b64_tr_b16 a[64:65], v14 offset:0
    ds_read_b64_tr_b16 a[66:67], v14 offset:1024
    ds_read_b64_tr_b16 a[68:69], v15 offset:0
    ds_read_b64_tr_b16 a[70:71], v15 offset:1024
    ds_read_b64_tr_b16 a[72:73], v14 offset:8192
    ds_read_b64_tr_b16 a[74:75], v14 offset:9216
    ds_read_b64_tr_b16 a[76:77], v15 offset:8192
    ds_read_b64_tr_b16 a[78:79], v15 offset:9216
    ds_read_b64_tr_b16 a[80:81], v14 offset:16384
    ds_read_b64_tr_b16 a[82:83], v14 offset:17408
    ds_read_b64_tr_b16 a[84:85], v15 offset:16384
    ds_read_b64_tr_b16 a[86:87], v15 offset:17408
    ds_read_b64_tr_b16 a[88:89], v14 offset:24576
    ds_read_b64_tr_b16 a[90:91], v14 offset:25600
    ds_read_b64_tr_b16 a[92:93], v15 offset:24576
    ds_read_b64_tr_b16 a[94:95], v15 offset:25600
    s_waitcnt lgkmcnt(0)
    s_barrier
    s_add_u32 m0, s29, 65536
    s_add_u32 s4, s28, 6291456
    buffer_load_dwordx4 v10, s[12:15], s4 offen lds

    s_add_u32 m0, s29, 66560
    s_add_u32 s4, s28, 6324224
    buffer_load_dwordx4 v10, s[12:15], s4 offen lds

    s_add_u32 m0, s29, 67584
    s_add_u32 s4, s28, 6356992
    buffer_load_dwordx4 v11, s[12:15], s4 offen lds

    s_add_u32 m0, s29, 68608
    s_add_u32 s4, s28, 6389760
    buffer_load_dwordx4 v11, s[12:15], s4 offen lds

    s_add_u32 m0, s29, 69632
    s_add_u32 s4, s28, 6422528
    buffer_load_dwordx4 v10, s[12:15], s4 offen lds

    s_add_u32 m0, s29, 70656
    s_add_u32 s4, s28, 6455296
    buffer_load_dwordx4 v10, s[12:15], s4 offen lds

    s_add_u32 m0, s29, 71680
    s_add_u32 s4, s28, 6488064
    buffer_load_dwordx4 v11, s[12:15], s4 offen lds

    s_add_u32 m0, s29, 72704
    s_add_u32 s4, s28, 6520832
    buffer_load_dwordx4 v11, s[12:15], s4 offen lds

    s_waitcnt vmcnt(24)
    s_barrier
    ds_read_b64_tr_b16 a[96:97], v14 offset:32768
    ds_read_b64_tr_b16 a[98:99], v14 offset:33792
    ds_read_b64_tr_b16 a[100:101], v15 offset:32768
    ds_read_b64_tr_b16 a[102:103], v15 offset:33792
    ds_read_b64_tr_b16 a[104:105], v14 offset:40960
    ds_read_b64_tr_b16 a[106:107], v14 offset:41984
    ds_read_b64_tr_b16 a[108:109], v15 offset:40960
    ds_read_b64_tr_b16 a[110:111], v15 offset:41984
    ds_read_b64_tr_b16 a[112:113], v14 offset:49152
    ds_read_b64_tr_b16 a[114:115], v14 offset:50176
    ds_read_b64_tr_b16 a[116:117], v15 offset:49152
    ds_read_b64_tr_b16 a[118:119], v15 offset:50176
    ds_read_b64_tr_b16 a[120:121], v14 offset:57344
    ds_read_b64_tr_b16 a[122:123], v14 offset:58368
    ds_read_b64_tr_b16 a[124:125], v15 offset:57344
    ds_read_b64_tr_b16 a[126:127], v15 offset:58368
    s_waitcnt lgkmcnt(0)
    s_barrier
    s_add_u32 m0, s29, 98304
    s_add_u32 s4, s28, 7340032
    buffer_load_dwordx4 v10, s[12:15], s4 offen lds

    s_add_u32 m0, s29, 99328
    s_add_u32 s4, s28, 7372800
    buffer_load_dwordx4 v10, s[12:15], s4 offen lds

    s_add_u32 m0, s29, 100352
    s_add_u32 s4, s28, 7405568
    buffer_load_dwordx4 v11, s[12:15], s4 offen lds

    s_add_u32 m0, s29, 101376
    s_add_u32 s4, s28, 7438336
    buffer_load_dwordx4 v11, s[12:15], s4 offen lds

    s_add_u32 m0, s29, 102400
    s_add_u32 s4, s28, 7471104
    buffer_load_dwordx4 v10, s[12:15], s4 offen lds

    s_add_u32 m0, s29, 103424
    s_add_u32 s4, s28, 7503872
    buffer_load_dwordx4 v10, s[12:15], s4 offen lds

    s_add_u32 m0, s29, 104448
    s_add_u32 s4, s28, 7536640
    buffer_load_dwordx4 v11, s[12:15], s4 offen lds

    s_add_u32 m0, s29, 105472
    s_add_u32 s4, s28, 7569408
    buffer_load_dwordx4 v11, s[12:15], s4 offen lds

    v_and_b32 v241, 3, v0
    v_lshlrev_b32 v241, 2, v241
    buffer_load_dword v240, v241, s[20:23], s97 offen sc1

    s_waitcnt vmcnt(25)
    s_barrier
    ds_read_b64_tr_b16 a[128:129], v12 offset:0
    ds_read_b64_tr_b16 a[130:131], v12 offset:1024
    ds_read_b64_tr_b16 a[132:133], v13 offset:0
    ds_read_b64_tr_b16 a[134:135], v13 offset:1024
    ds_read_b64_tr_b16 a[136:137], v12 offset:8192
    ds_read_b64_tr_b16 a[138:139], v12 offset:9216
    ds_read_b64_tr_b16 a[140:141], v13 offset:8192
    ds_read_b64_tr_b16 a[142:143], v13 offset:9216
    ds_read_b64_tr_b16 a[144:145], v12 offset:16384
    ds_read_b64_tr_b16 a[146:147], v12 offset:17408
    ds_read_b64_tr_b16 a[148:149], v13 offset:16384
    ds_read_b64_tr_b16 a[150:151], v13 offset:17408
    ds_read_b64_tr_b16 a[152:153], v12 offset:24576
    ds_read_b64_tr_b16 a[154:155], v12 offset:25600
    ds_read_b64_tr_b16 a[156:157], v13 offset:24576
    ds_read_b64_tr_b16 a[158:159], v13 offset:25600
    s_waitcnt lgkmcnt(0)
    s_barrier
    s_add_u32 m0, s29, 0
    s_nop 0
    buffer_load_dwordx4 v16, s[16:19], s34 offen offset:0 lds
    s_add_u32 m0, s29, 896
    s_nop 0
    buffer_load_dwordx4 v16, s[16:19], s34 offen offset:128 lds
    s_add_u32 m0, s29, 1792
    s_nop 0
    buffer_load_dwordx4 v16, s[16:19], s34 offen offset:256 lds
    s_add_u32 m0, s29, 2688
    s_nop 0
    buffer_load_dwordx4 v16, s[16:19], s34 offen offset:384 lds
    s_add_u32 m0, s29, 3584
    s_nop 0
    buffer_load_dwordx4 v16, s[16:19], s34 offen offset:512 lds
    s_add_u32 m0, s29, 4480
    s_nop 0
    buffer_load_dwordx4 v16, s[16:19], s34 offen offset:640 lds
    s_add_u32 m0, s29, 5376
    s_nop 0
    buffer_load_dwordx4 v16, s[16:19], s34 offen offset:768 lds
    s_add_u32 m0, s29, 6272
    s_nop 0
    buffer_load_dwordx4 v16, s[16:19], s34 offen offset:896 lds
    s_add_u32 s34, s34, 1024
    s_waitcnt vmcnt(25)
    s_barrier
    ds_read_b64_tr_b16 a[160:161], v12 offset:32768
    ds_read_b64_tr_b16 a[162:163], v12 offset:33792
    ds_read_b64_tr_b16 a[164:165], v13 offset:32768
    ds_read_b64_tr_b16 a[166:167], v13 offset:33792
    ds_read_b64_tr_b16 a[168:169], v12 offset:40960
    ds_read_b64_tr_b16 a[170:171], v12 offset:41984
    ds_read_b64_tr_b16 a[172:173], v13 offset:40960
    ds_read_b64_tr_b16 a[174:175], v13 offset:41984
    ds_read_b64_tr_b16 a[176:177], v12 offset:49152
    ds_read_b64_tr_b16 a[178:179], v12 offset:50176
    ds_read_b64_tr_b16 a[180:181], v13 offset:49152
    ds_read_b64_tr_b16 a[182:183], v13 offset:50176
    ds_read_b64_tr_b16 a[184:185], v12 offset:57344
    ds_read_b64_tr_b16 a[186:187], v12 offset:58368
    ds_read_b64_tr_b16 a[188:189], v13 offset:57344
    ds_read_b64_tr_b16 a[190:191], v13 offset:58368
    s_waitcnt lgkmcnt(0)
    s_barrier
    s_add_u32 m0, s29, 32768
    s_nop 0
    buffer_load_dwordx4 v16, s[16:19], s34 offen offset:0 lds
    s_add_u32 m0, s29, 33664
    s_nop 0
    buffer_load_dwordx4 v16, s[16:19], s34 offen offset:128 lds
    s_add_u32 m0, s29, 34560
    s_nop 0
    buffer_load_dwordx4 v16, s[16:19], s34 offen offset:256 lds
    s_add_u32 m0, s29, 35456
    s_nop 0
    buffer_load_dwordx4 v16, s[16:19], s34 offen offset:384 lds
    s_add_u32 m0, s29, 36352
    s_nop 0
    buffer_load_dwordx4 v16, s[16:19], s34 offen offset:512 lds
    s_add_u32 m0, s29, 37248
    s_nop 0
    buffer_load_dwordx4 v16, s[16:19], s34 offen offset:640 lds
    s_add_u32 m0, s29, 38144
    s_nop 0
    buffer_load_dwordx4 v16, s[16:19], s34 offen offset:768 lds
    s_add_u32 m0, s29, 39040
    s_nop 0
    buffer_load_dwordx4 v16, s[16:19], s34 offen offset:896 lds
    s_add_u32 s34, s34, 64512
    s_min_u32 s34, s34, 4128768
    s_waitcnt vmcnt(25)
    s_barrier
    ds_read_b64_tr_b16 a[192:193], v14 offset:0
    ds_read_b64_tr_b16 a[194:195], v14 offset:1024
    ds_read_b64_tr_b16 a[196:197], v15 offset:0
    ds_read_b64_tr_b16 a[198:199], v15 offset:1024
    ds_read_b64_tr_b16 a[200:201], v14 offset:8192
    ds_read_b64_tr_b16 a[202:203], v14 offset:9216
    ds_read_b64_tr_b16 a[204:205], v15 offset:8192
    ds_read_b64_tr_b16 a[206:207], v15 offset:9216
    ds_read_b64_tr_b16 a[208:209], v14 offset:16384
    ds_read_b64_tr_b16 a[210:211], v14 offset:17408
    ds_read_b64_tr_b16 a[212:213], v15 offset:16384
    ds_read_b64_tr_b16 a[214:215], v15 offset:17408
    ds_read_b64_tr_b16 a[216:217], v14 offset:24576
    ds_read_b64_tr_b16 a[218:219], v14 offset:25600
    ds_read_b64_tr_b16 a[220:221], v15 offset:24576
    ds_read_b64_tr_b16 a[222:223], v15 offset:25600
    s_waitcnt lgkmcnt(0)
    s_barrier
    s_add_u32 m0, s29, 65536
    s_nop 0
    buffer_load_dwordx4 v16, s[16:19], s34 offen offset:0 lds
    s_add_u32 m0, s29, 66432
    s_nop 0
    buffer_load_dwordx4 v16, s[16:19], s34 offen offset:128 lds
    s_add_u32 m0, s29, 67328
    s_nop 0
    buffer_load_dwordx4 v16, s[16:19], s34 offen offset:256 lds
    s_add_u32 m0, s29, 68224
    s_nop 0
    buffer_load_dwordx4 v16, s[16:19], s34 offen offset:384 lds
    s_add_u32 m0, s29, 69120
    s_nop 0
    buffer_load_dwordx4 v16, s[16:19], s34 offen offset:512 lds
    s_add_u32 m0, s29, 70016
    s_nop 0
    buffer_load_dwordx4 v16, s[16:19], s34 offen offset:640 lds
    s_add_u32 m0, s29, 70912
    s_nop 0
    buffer_load_dwordx4 v16, s[16:19], s34 offen offset:768 lds
    s_add_u32 m0, s29, 71808
    s_nop 0
    buffer_load_dwordx4 v16, s[16:19], s34 offen offset:896 lds
    s_add_u32 s34, s34, 1024
    s_waitcnt vmcnt(24)
    s_barrier
    ds_read_b64_tr_b16 a[224:225], v14 offset:32768
    ds_read_b64_tr_b16 a[226:227], v14 offset:33792
    ds_read_b64_tr_b16 a[228:229], v15 offset:32768
    ds_read_b64_tr_b16 a[230:231], v15 offset:33792
    ds_read_b64_tr_b16 a[232:233], v14 offset:40960
    ds_read_b64_tr_b16 a[234:235], v14 offset:41984
    ds_read_b64_tr_b16 a[236:237], v15 offset:40960
    ds_read_b64_tr_b16 a[238:239], v15 offset:41984
    ds_read_b64_tr_b16 a[240:241], v14 offset:49152
    ds_read_b64_tr_b16 a[242:243], v14 offset:50176
    ds_read_b64_tr_b16 a[244:245], v15 offset:49152
    ds_read_b64_tr_b16 a[246:247], v15 offset:50176
    ds_read_b64_tr_b16 a[248:249], v14 offset:57344
    ds_read_b64_tr_b16 a[250:251], v14 offset:58368
    ds_read_b64_tr_b16 a[252:253], v15 offset:57344
    ds_read_b64_tr_b16 a[254:255], v15 offset:58368
    s_mov_b32 s62, 0
.vp_375:
    v_readlane_b32 s4, v240, 0
    v_readlane_b32 s7, v240, 1
    v_readlane_b32 s6, v240, 2

    s_cmp_ge_u32 s4, 256
    s_cbranch_scc1 .vd_376
    s_cmp_lg_u32 s6, 0
    s_cbranch_scc1 .vs_377
    s_add_u32 s62, s62, 1
    s_cmp_gt_u32 s62, 0x100000
    s_cbranch_scc1 .mg_end_1
    s_sleep 8
    buffer_load_dword v240, v241, s[20:23], s97 offen sc1
    s_waitcnt vmcnt(0)
    s_branch .vp_375

.vs_377:
    s_lshr_b32 s25, s2, 5
    s_and_b32 s26, s2, 31
    s_mov_b32 s27, 1
    s_mov_b32 s99, 1
    s_mov_b32 s97, 144
    s_waitcnt vmcnt(0) lgkmcnt(0)
    s_barrier
    s_branch .mg_role_3

.vd_376:
    s_waitcnt lgkmcnt(0)
    s_barrier
    s_cmp_eq_u32 s30, 2
    s_cbranch_scc1 .qv_378
    s_waitcnt vmcnt(16)
    s_barrier
    ds_read_b128 v[32:35], v17 offset:0
    ds_read_b128 v[36:39], v17 offset:16384
    ds_read_b128 v[40:43], v18 offset:0
    ds_read_b128 v[44:47], v18 offset:16384
    s_add_u32 m0, s29, 98304
    s_nop 0
    buffer_load_dwordx4 v16, s[16:19], s34 offen offset:0 lds
    ds_read_b128 v[48:51], v17 offset:1024
    ds_read_b128 v[52:55], v17 offset:17408
    s_branch .qe_381
.p2align 6
.ql_380:
.qe_381:
    s_waitcnt lgkmcnt(4)
    v_mfma_f32_16x16x32_bf16 v[64:67], a[0:3], v[32:35], 0
    ds_read_b128 v[56:59], v18 offset:1024
    s_add_u32 m0, s29, 99200
    v_mfma_f32_16x16x32_bf16 v[68:71], a[4:7], v[32:35], 0
    buffer_load_dwordx4 v16, s[16:19], s34 offen offset:128 lds
    v_mfma_f32_16x16x32_bf16 v[72:75], a[0:3], v[36:39], 0
    ds_read_b128 v[60:63], v18 offset:17408
    v_mfma_f32_16x16x32_bf16 v[76:79], a[4:7], v[36:39], 0
    s_waitcnt lgkmcnt(4)
    v_mfma_f32_16x16x32_bf16 v[64:67], a[8:11], v[40:43], v[64:67]
    ds_read_b128 v[32:35], v17 offset:2048
    v_mfma_f32_16x16x32_bf16 v[68:71], a[12:15], v[40:43], v[68:71]
    v_cvt_pk_bf16_f32 v96, v80, v81
    v_cvt_pk_bf16_f32 v97, v82, v83
    v_mfma_f32_16x16x32_bf16 v[72:75], a[8:11], v[44:47], v[72:75]
    ds_read_b128 v[36:39], v17 offset:18432
    v_mfma_f32_16x16x32_bf16 v[76:79], a[12:15], v[44:47], v[76:79]
    v_cvt_pk_bf16_f32 v98, v84, v85
    v_cvt_pk_bf16_f32 v99, v86, v87
    s_waitcnt lgkmcnt(4)
    v_mfma_f32_16x16x32_bf16 v[64:67], a[16:19], v[48:51], v[64:67]
    ds_read_b128 v[40:43], v18 offset:2048
    s_add_u32 m0, s29, 100096
    v_mfma_f32_16x16x32_bf16 v[68:71], a[20:23], v[48:51], v[68:71]
    buffer_load_dwordx4 v16, s[16:19], s34 offen offset:256 lds
    v_mfma_f32_16x16x32_bf16 v[72:75], a[16:19], v[52:55], v[72:75]
    ds_read_b128 v[44:47], v18 offset:18432
    v_mfma_f32_16x16x32_bf16 v[76:79], a[20:23], v[52:55], v[76:79]
    s_waitcnt lgkmcnt(4)
    v_mfma_f32_16x16x32_bf16 v[64:67], a[24:27], v[56:59], v[64:67]
    ds_read_b128 v[48:51], v17 offset:3072
    v_mfma_f32_16x16x32_bf16 v[68:71], a[28:31], v[56:59], v[68:71]
    buffer_store_dwordx4 v[96:99], v21, s[8:11], s32 offen sc1
    v_mfma_f32_16x16x32_bf16 v[72:75], a[24:27], v[60:63], v[72:75]
    ds_read_b128 v[52:55], v17 offset:19456
    v_mfma_f32_16x16x32_bf16 v[76:79], a[28:31], v[60:63], v[76:79]
    s_waitcnt lgkmcnt(4)
    v_mfma_f32_16x16x32_bf16 v[64:67], a[32:35], v[32:35], v[64:67]
    ds_read_b128 v[56:59], v18 offset:3072
    s_add_u32 m0, s29, 100992
    v_mfma_f32_16x16x32_bf16 v[68:71], a[36:39], v[32:35], v[68:71]
    buffer_load_dwordx4 v16, s[16:19], s34 offen offset:384 lds
    v_mfma_f32_16x16x32_bf16 v[72:75], a[32:35], v[36:39], v[72:75]
    ds_read_b128 v[60:63], v18 offset:19456
    v_mfma_f32_16x16x32_bf16 v[76:79], a[36:39], v[36:39], v[76:79]
    s_waitcnt lgkmcnt(4)
    v_mfma_f32_16x16x32_bf16 v[64:67], a[40:43], v[40:43], v[64:67]
    ds_read_b128 v[32:35], v17 offset:4096
    v_mfma_f32_16x16x32_bf16 v[68:71], a[44:47], v[40:43], v[68:71]
    v_cvt_pk_bf16_f32 v100, v88, v89
    v_cvt_pk_bf16_f32 v101, v90, v91
    v_mfma_f32_16x16x32_bf16 v[72:75], a[40:43], v[44:47], v[72:75]
    ds_read_b128 v[36:39], v17 offset:20480
    v_mfma_f32_16x16x32_bf16 v[76:79], a[44:47], v[44:47], v[76:79]
    v_cvt_pk_bf16_f32 v102, v92, v93
    v_cvt_pk_bf16_f32 v103, v94, v95
    s_waitcnt lgkmcnt(4)
    v_mfma_f32_16x16x32_bf16 v[64:67], a[48:51], v[48:51], v[64:67]
    ds_read_b128 v[40:43], v18 offset:4096
    s_add_u32 m0, s29, 101888
    v_mfma_f32_16x16x32_bf16 v[68:71], a[52:55], v[48:51], v[68:71]
    buffer_load_dwordx4 v16, s[16:19], s34 offen offset:512 lds
    v_mfma_f32_16x16x32_bf16 v[72:75], a[48:51], v[52:55], v[72:75]
    ds_read_b128 v[44:47], v18 offset:20480
    v_mfma_f32_16x16x32_bf16 v[76:79], a[52:55], v[52:55], v[76:79]
    s_waitcnt lgkmcnt(4)
    v_mfma_f32_16x16x32_bf16 v[64:67], a[56:59], v[56:59], v[64:67]
    ds_read_b128 v[48:51], v17 offset:5120
    v_mfma_f32_16x16x32_bf16 v[68:71], a[60:63], v[56:59], v[68:71]
    buffer_store_dwordx4 v[100:103], v21, s[8:11], s38 offen sc1
    v_mfma_f32_16x16x32_bf16 v[72:75], a[56:59], v[60:63], v[72:75]
    ds_read_b128 v[52:55], v17 offset:21504
    v_mfma_f32_16x16x32_bf16 v[76:79], a[60:63], v[60:63], v[76:79]
    s_waitcnt lgkmcnt(4)
    v_mfma_f32_16x16x32_bf16 v[64:67], a[64:67], v[32:35], v[64:67]
    ds_read_b128 v[56:59], v18 offset:5120
    s_add_u32 m0, s29, 102784
    v_mfma_f32_16x16x32_bf16 v[68:71], a[68:71], v[32:35], v[68:71]
    buffer_load_dwordx4 v16, s[16:19], s34 offen offset:640 lds
    v_mfma_f32_16x16x32_bf16 v[72:75], a[64:67], v[36:39], v[72:75]
    ds_read_b128 v[60:63], v18 offset:21504
    v_mfma_f32_16x16x32_bf16 v[76:79], a[68:71], v[36:39], v[76:79]
    s_mov_b32 exec_hi, 0
    buffer_store_dwordx4 v[24:27], v21, s[8:11], s48 offen sc1
    s_mov_b32 exec_hi, -1

    s_waitcnt lgkmcnt(4)
    v_mfma_f32_16x16x32_bf16 v[64:67], a[72:75], v[40:43], v[64:67]
    ds_read_b128 v[32:35], v17 offset:6144
    v_mfma_f32_16x16x32_bf16 v[68:71], a[76:79], v[40:43], v[68:71]
    s_mov_b32 s32, s39
    s_add_u32 s38, s39, 4096
    s_add_u32 s39, s39, 262144
    s_mov_b32 s48, s49
    s_add_u32 s49, s49, 196608
    v_mfma_f32_16x16x32_bf16 v[72:75], a[72:75], v[44:47], v[72:75]
    ds_read_b128 v[36:39], v17 offset:22528
    v_mfma_f32_16x16x32_bf16 v[76:79], a[76:79], v[44:47], v[76:79]
    v_add_u32 v23, 1, v23
    s_waitcnt lgkmcnt(4)
    v_mfma_f32_16x16x32_bf16 v[64:67], a[80:83], v[48:51], v[64:67]
    ds_read_b128 v[40:43], v18 offset:6144
    s_add_u32 m0, s29, 103680
    v_mfma_f32_16x16x32_bf16 v[68:71], a[84:87], v[48:51], v[68:71]
    buffer_load_dwordx4 v16, s[16:19], s34 offen offset:768 lds
    v_mfma_f32_16x16x32_bf16 v[72:75], a[80:83], v[52:55], v[72:75]
    ds_read_b128 v[44:47], v18 offset:22528
    v_mfma_f32_16x16x32_bf16 v[76:79], a[84:87], v[52:55], v[76:79]
    s_waitcnt lgkmcnt(4)
    v_mfma_f32_16x16x32_bf16 v[64:67], a[88:91], v[56:59], v[64:67]
    ds_read_b128 v[48:51], v17 offset:7168
    v_mfma_f32_16x16x32_bf16 v[68:71], a[92:95], v[56:59], v[68:71]
    v_mfma_f32_16x16x32_bf16 v[72:75], a[88:91], v[60:63], v[72:75]
    ds_read_b128 v[52:55], v17 offset:23552
    v_mfma_f32_16x16x32_bf16 v[76:79], a[92:95], v[60:63], v[76:79]
    s_mov_b64 exec, s[44:45]
    buffer_store_dwordx4 v[24:27], v28, s[8:11], s46 offen sc1
    s_mov_b64 exec, -1
    s_waitcnt lgkmcnt(4)
    v_mfma_f32_16x16x32_bf16 v[64:67], a[96:99], v[32:35], v[64:67]
    ds_read_b128 v[56:59], v18 offset:7168
    s_add_u32 m0, s29, 104576
    v_mfma_f32_16x16x32_bf16 v[68:71], a[100:103], v[32:35], v[68:71]
    buffer_load_dwordx4 v16, s[16:19], s34 offen offset:896 lds
    v_mfma_f32_16x16x32_bf16 v[72:75], a[96:99], v[36:39], v[72:75]
    ds_read_b128 v[60:63], v18 offset:23552
    v_mfma_f32_16x16x32_bf16 v[76:79], a[100:103], v[36:39], v[76:79]
    s_waitcnt lgkmcnt(4)
    v_mfma_f32_16x16x32_bf16 v[64:67], a[104:107], v[40:43], v[64:67]
    s_add_u32 s34, s34, 64512
    s_min_u32 s34, s34, 4128768
    v_mfma_f32_16x16x32_bf16 v[68:71], a[108:111], v[40:43], v[68:71]
    v_mfma_f32_16x16x32_bf16 v[72:75], a[104:107], v[44:47], v[72:75]
    v_mfma_f32_16x16x32_bf16 v[76:79], a[108:111], v[44:47], v[76:79]
    s_waitcnt lgkmcnt(0)
    s_waitcnt vmcnt(19)
    s_barrier
    ds_read_b128 v[32:35], v17 offset:32768
    ds_read_b128 v[36:39], v17 offset:49152
    v_mfma_f32_16x16x32_bf16 v[64:67], a[112:115], v[48:51], v[64:67]
    ds_read_b128 v[40:43], v18 offset:32768
    s_add_u32 m0, s29, 0
    v_mfma_f32_16x16x32_bf16 v[68:71], a[116:119], v[48:51], v[68:71]
    buffer_load_dwordx4 v16, s[16:19], s34 offen offset:0 lds
    v_mfma_f32_16x16x32_bf16 v[72:75], a[112:115], v[52:55], v[72:75]
    ds_read_b128 v[44:47], v18 offset:49152
    v_mfma_f32_16x16x32_bf16 v[76:79], a[116:119], v[52:55], v[76:79]
    v_mfma_f32_16x16x32_bf16 v[64:67], a[120:123], v[56:59], v[64:67]
    ds_read_b128 v[48:51], v17 offset:33792
    v_mfma_f32_16x16x32_bf16 v[68:71], a[124:127], v[56:59], v[68:71]
    v_mfma_f32_16x16x32_bf16 v[72:75], a[120:123], v[60:63], v[72:75]
    ds_read_b128 v[52:55], v17 offset:50176
    v_mfma_f32_16x16x32_bf16 v[76:79], a[124:127], v[60:63], v[76:79]
    s_waitcnt lgkmcnt(4)
    v_mfma_f32_16x16x32_bf16 v[64:67], a[128:131], v[32:35], v[64:67]
    ds_read_b128 v[56:59], v18 offset:33792
    s_add_u32 m0, s29, 896
    v_mfma_f32_16x16x32_bf16 v[68:71], a[132:135], v[32:35], v[68:71]
    buffer_load_dwordx4 v16, s[16:19], s34 offen offset:128 lds
    v_mfma_f32_16x16x32_bf16 v[72:75], a[128:131], v[36:39], v[72:75]
    ds_read_b128 v[60:63], v18 offset:50176
    v_mfma_f32_16x16x32_bf16 v[76:79], a[132:135], v[36:39], v[76:79]
    s_waitcnt lgkmcnt(4)
    v_mfma_f32_16x16x32_bf16 v[64:67], a[136:139], v[40:43], v[64:67]
    ds_read_b128 v[32:35], v17 offset:34816
    v_mfma_f32_16x16x32_bf16 v[68:71], a[140:143], v[40:43], v[68:71]
    v_mfma_f32_16x16x32_bf16 v[72:75], a[136:139], v[44:47], v[72:75]
    ds_read_b128 v[36:39], v17 offset:51200
    v_mfma_f32_16x16x32_bf16 v[76:79], a[140:143], v[44:47], v[76:79]
    s_waitcnt lgkmcnt(4)
    v_mfma_f32_16x16x32_bf16 v[64:67], a[144:147], v[48:51], v[64:67]
    ds_read_b128 v[40:43], v18 offset:34816
    s_add_u32 m0, s29, 1792
    v_mfma_f32_16x16x32_bf16 v[68:71], a[148:151], v[48:51], v[68:71]
    buffer_load_dwordx4 v16, s[16:19], s34 offen offset:256 lds
    v_mfma_f32_16x16x32_bf16 v[72:75], a[144:147], v[52:55], v[72:75]
    ds_read_b128 v[44:47], v18 offset:51200
    v_mfma_f32_16x16x32_bf16 v[76:79], a[148:151], v[52:55], v[76:79]
    s_waitcnt lgkmcnt(4)
    v_mfma_f32_16x16x32_bf16 v[64:67], a[152:155], v[56:59], v[64:67]
    ds_read_b128 v[48:51], v17 offset:35840
    v_mfma_f32_16x16x32_bf16 v[68:71], a[156:159], v[56:59], v[68:71]
    v_mfma_f32_16x16x32_bf16 v[72:75], a[152:155], v[60:63], v[72:75]
    ds_read_b128 v[52:55], v17 offset:52224
    v_mfma_f32_16x16x32_bf16 v[76:79], a[156:159], v[60:63], v[76:79]
    s_waitcnt lgkmcnt(4)
    v_mfma_f32_16x16x32_bf16 v[64:67], a[160:163], v[32:35], v[64:67]
    ds_read_b128 v[56:59], v18 offset:35840
    s_add_u32 m0, s29, 2688
    v_mfma_f32_16x16x32_bf16 v[68:71], a[164:167], v[32:35], v[68:71]
    buffer_load_dwordx4 v16, s[16:19], s34 offen offset:384 lds
    v_mfma_f32_16x16x32_bf16 v[72:75], a[160:163], v[36:39], v[72:75]
    ds_read_b128 v[60:63], v18 offset:52224
    v_mfma_f32_16x16x32_bf16 v[76:79], a[164:167], v[36:39], v[76:79]
    s_waitcnt lgkmcnt(4)
    v_mfma_f32_16x16x32_bf16 v[64:67], a[168:171], v[40:43], v[64:67]
    ds_read_b128 v[32:35], v17 offset:36864
    v_mfma_f32_16x16x32_bf16 v[68:71], a[172:175], v[40:43], v[68:71]
    v_mfma_f32_16x16x32_bf16 v[72:75], a[168:171], v[44:47], v[72:75]
    ds_read_b128 v[36:39], v17 offset:53248
    v_mfma_f32_16x16x32_bf16 v[76:79], a[172:175], v[44:47], v[76:79]
    s_waitcnt lgkmcnt(4)
    v_mfma_f32_16x16x32_bf16 v[64:67], a[176:179], v[48:51], v[64:67]
    ds_read_b128 v[40:43], v18 offset:36864
    s_add_u32 m0, s29, 3584
    v_mfma_f32_16x16x32_bf16 v[68:71], a[180:183], v[48:51], v[68:71]
    buffer_load_dwordx4 v16, s[16:19], s34 offen offset:512 lds
    v_mfma_f32_16x16x32_bf16 v[72:75], a[176:179], v[52:55], v[72:75]
    ds_read_b128 v[44:47], v18 offset:53248
    v_mfma_f32_16x16x32_bf16 v[76:79], a[180:183], v[52:55], v[76:79]
    s_waitcnt lgkmcnt(4)
    v_mfma_f32_16x16x32_bf16 v[64:67], a[184:187], v[56:59], v[64:67]
    ds_read_b128 v[48:51], v17 offset:37888
    v_mfma_f32_16x16x32_bf16 v[68:71], a[188:191], v[56:59], v[68:71]
    v_mfma_f32_16x16x32_bf16 v[72:75], a[184:187], v[60:63], v[72:75]
    ds_read_b128 v[52:55], v17 offset:54272
    v_mfma_f32_16x16x32_bf16 v[76:79], a[188:191], v[60:63], v[76:79]
    s_waitcnt lgkmcnt(4)
    v_mfma_f32_16x16x32_bf16 v[64:67], a[192:195], v[32:35], v[64:67]
    ds_read_b128 v[56:59], v18 offset:37888
    s_add_u32 m0, s29, 4480
    v_mfma_f32_16x16x32_bf16 v[68:71], a[196:199], v[32:35], v[68:71]
    buffer_load_dwordx4 v16, s[16:19], s34 offen offset:640 lds
    v_mfma_f32_16x16x32_bf16 v[72:75], a[192:195], v[36:39], v[72:75]
    ds_read_b128 v[60:63], v18 offset:54272
    v_mfma_f32_16x16x32_bf16 v[76:79], a[196:199], v[36:39], v[76:79]
    s_waitcnt lgkmcnt(4)
    v_mfma_f32_16x16x32_bf16 v[64:67], a[200:203], v[40:43], v[64:67]
    ds_read_b128 v[32:35], v17 offset:38912
    v_mfma_f32_16x16x32_bf16 v[68:71], a[204:207], v[40:43], v[68:71]
    v_mfma_f32_16x16x32_bf16 v[72:75], a[200:203], v[44:47], v[72:75]
    ds_read_b128 v[36:39], v17 offset:55296
    v_mfma_f32_16x16x32_bf16 v[76:79], a[204:207], v[44:47], v[76:79]
    s_waitcnt lgkmcnt(4)
    v_mfma_f32_16x16x32_bf16 v[64:67], a[208:211], v[48:51], v[64:67]
    ds_read_b128 v[40:43], v18 offset:38912
    s_add_u32 m0, s29, 5376
    v_mfma_f32_16x16x32_bf16 v[68:71], a[212:215], v[48:51], v[68:71]
    buffer_load_dwordx4 v16, s[16:19], s34 offen offset:768 lds
    v_mfma_f32_16x16x32_bf16 v[72:75], a[208:211], v[52:55], v[72:75]
    ds_read_b128 v[44:47], v18 offset:55296
    v_mfma_f32_16x16x32_bf16 v[76:79], a[212:215], v[52:55], v[76:79]
    s_waitcnt lgkmcnt(4)
    v_mfma_f32_16x16x32_bf16 v[64:67], a[216:219], v[56:59], v[64:67]
    ds_read_b128 v[48:51], v17 offset:39936
    v_mfma_f32_16x16x32_bf16 v[68:71], a[220:223], v[56:59], v[68:71]
    v_mfma_f32_16x16x32_bf16 v[72:75], a[216:219], v[60:63], v[72:75]
    ds_read_b128 v[52:55], v17 offset:56320
    v_mfma_f32_16x16x32_bf16 v[76:79], a[220:223], v[60:63], v[76:79]
    s_mov_b64 exec, s[44:45]
    buffer_store_dwordx4 v[24:27], v29, s[8:11], s46 offen sc1
    s_mov_b64 exec, -1
    s_waitcnt lgkmcnt(4)
    v_mfma_f32_16x16x32_bf16 v[64:67], a[224:227], v[32:35], v[64:67]
    ds_read_b128 v[56:59], v18 offset:39936
    s_add_u32 m0, s29, 6272
    v_mfma_f32_16x16x32_bf16 v[68:71], a[228:231], v[32:35], v[68:71]
    buffer_load_dwordx4 v16, s[16:19], s34 offen offset:896 lds
    v_mfma_f32_16x16x32_bf16 v[72:75], a[224:227], v[36:39], v[72:75]
    ds_read_b128 v[60:63], v18 offset:56320
    v_mfma_f32_16x16x32_bf16 v[76:79], a[228:231], v[36:39], v[76:79]
    s_waitcnt lgkmcnt(4)
    v_mfma_f32_16x16x32_bf16 v[64:67], a[232:235], v[40:43], v[64:67]
    s_add_u32 s34, s34, 1024
    v_mfma_f32_16x16x32_bf16 v[68:71], a[236:239], v[40:43], v[68:71]
    v_mfma_f32_16x16x32_bf16 v[72:75], a[232:235], v[44:47], v[72:75]
    v_mfma_f32_16x16x32_bf16 v[76:79], a[236:239], v[44:47], v[76:79]
    s_waitcnt lgkmcnt(0)
    s_waitcnt vmcnt(10)
    s_barrier
    ds_read_b128 v[32:35], v19 offset:0
    ds_read_b128 v[36:39], v19 offset:16384
    v_mfma_f32_16x16x32_bf16 v[64:67], a[240:243], v[48:51], v[64:67]
    ds_read_b128 v[40:43], v20 offset:0
    s_add_u32 m0, s29, 32768
    v_mfma_f32_16x16x32_bf16 v[68:71], a[244:247], v[48:51], v[68:71]
    buffer_load_dwordx4 v16, s[16:19], s34 offen offset:0 lds
    v_mfma_f32_16x16x32_bf16 v[72:75], a[240:243], v[52:55], v[72:75]
    ds_read_b128 v[44:47], v20 offset:16384
    v_mfma_f32_16x16x32_bf16 v[76:79], a[244:247], v[52:55], v[76:79]
    v_mfma_f32_16x16x32_bf16 v[64:67], a[248:251], v[56:59], v[64:67]
    ds_read_b128 v[48:51], v19 offset:1024
    v_mfma_f32_16x16x32_bf16 v[68:71], a[252:255], v[56:59], v[68:71]
    v_mfma_f32_16x16x32_bf16 v[72:75], a[248:251], v[60:63], v[72:75]
    ds_read_b128 v[52:55], v19 offset:17408
    v_mfma_f32_16x16x32_bf16 v[76:79], a[252:255], v[60:63], v[76:79]
    s_mov_b64 exec, s[36:37]
    buffer_store_dword v23, v22, s[8:11], s33 offen sc1
    s_mov_b64 exec, -1

    s_waitcnt lgkmcnt(4)
    v_mfma_f32_16x16x32_bf16 v[80:83], a[0:3], v[32:35], 0
    ds_read_b128 v[56:59], v20 offset:1024
    s_add_u32 m0, s29, 33664
    v_mfma_f32_16x16x32_bf16 v[84:87], a[4:7], v[32:35], 0
    buffer_load_dwordx4 v16, s[16:19], s34 offen offset:128 lds
    v_mfma_f32_16x16x32_bf16 v[88:91], a[0:3], v[36:39], 0
    ds_read_b128 v[60:63], v20 offset:17408
    v_mfma_f32_16x16x32_bf16 v[92:95], a[4:7], v[36:39], 0
    s_waitcnt lgkmcnt(4)
    v_mfma_f32_16x16x32_bf16 v[80:83], a[8:11], v[40:43], v[80:83]
    ds_read_b128 v[32:35], v19 offset:2048
    v_mfma_f32_16x16x32_bf16 v[84:87], a[12:15], v[40:43], v[84:87]
    v_cvt_pk_bf16_f32 v96, v64, v65
    v_cvt_pk_bf16_f32 v97, v66, v67
    v_mfma_f32_16x16x32_bf16 v[88:91], a[8:11], v[44:47], v[88:91]
    ds_read_b128 v[36:39], v19 offset:18432
    v_mfma_f32_16x16x32_bf16 v[92:95], a[12:15], v[44:47], v[92:95]
    v_cvt_pk_bf16_f32 v98, v68, v69
    v_cvt_pk_bf16_f32 v99, v70, v71
    s_waitcnt lgkmcnt(4)
    v_mfma_f32_16x16x32_bf16 v[80:83], a[16:19], v[48:51], v[80:83]
    ds_read_b128 v[40:43], v20 offset:2048
    s_add_u32 m0, s29, 34560
    v_mfma_f32_16x16x32_bf16 v[84:87], a[20:23], v[48:51], v[84:87]
    buffer_load_dwordx4 v16, s[16:19], s34 offen offset:256 lds
    v_mfma_f32_16x16x32_bf16 v[88:91], a[16:19], v[52:55], v[88:91]
    ds_read_b128 v[44:47], v20 offset:18432
    v_mfma_f32_16x16x32_bf16 v[92:95], a[20:23], v[52:55], v[92:95]
    s_waitcnt lgkmcnt(4)
    v_mfma_f32_16x16x32_bf16 v[80:83], a[24:27], v[56:59], v[80:83]
    ds_read_b128 v[48:51], v19 offset:3072
    v_mfma_f32_16x16x32_bf16 v[84:87], a[28:31], v[56:59], v[84:87]
    buffer_store_dwordx4 v[96:99], v21, s[8:11], s32 offen sc1
    v_mfma_f32_16x16x32_bf16 v[88:91], a[24:27], v[60:63], v[88:91]
    ds_read_b128 v[52:55], v19 offset:19456
    v_mfma_f32_16x16x32_bf16 v[92:95], a[28:31], v[60:63], v[92:95]
    s_waitcnt lgkmcnt(4)
    v_mfma_f32_16x16x32_bf16 v[80:83], a[32:35], v[32:35], v[80:83]
    ds_read_b128 v[56:59], v20 offset:3072
    s_add_u32 m0, s29, 35456
    v_mfma_f32_16x16x32_bf16 v[84:87], a[36:39], v[32:35], v[84:87]
    buffer_load_dwordx4 v16, s[16:19], s34 offen offset:384 lds
    v_mfma_f32_16x16x32_bf16 v[88:91], a[32:35], v[36:39], v[88:91]
    ds_read_b128 v[60:63], v20 offset:19456
    v_mfma_f32_16x16x32_bf16 v[92:95], a[36:39], v[36:39], v[92:95]
    s_waitcnt lgkmcnt(4)
    v_mfma_f32_16x16x32_bf16 v[80:83], a[40:43], v[40:43], v[80:83]
    ds_read_b128 v[32:35], v19 offset:4096
    v_mfma_f32_16x16x32_bf16 v[84:87], a[44:47], v[40:43], v[84:87]
    v_cvt_pk_bf16_f32 v100, v72, v73
    v_cvt_pk_bf16_f32 v101, v74, v75
    v_mfma_f32_16x16x32_bf16 v[88:91], a[40:43], v[44:47], v[88:91]
    ds_read_b128 v[36:39], v19 offset:20480
    v_mfma_f32_16x16x32_bf16 v[92:95], a[44:47], v[44:47], v[92:95]
    v_cvt_pk_bf16_f32 v102, v76, v77
    v_cvt_pk_bf16_f32 v103, v78, v79
    s_waitcnt lgkmcnt(4)
    v_mfma_f32_16x16x32_bf16 v[80:83], a[48:51], v[48:51], v[80:83]
    ds_read_b128 v[40:43], v20 offset:4096
    s_add_u32 m0, s29, 36352
    v_mfma_f32_16x16x32_bf16 v[84:87], a[52:55], v[48:51], v[84:87]
    buffer_load_dwordx4 v16, s[16:19], s34 offen offset:512 lds
    v_mfma_f32_16x16x32_bf16 v[88:91], a[48:51], v[52:55], v[88:91]
    ds_read_b128 v[44:47], v20 offset:20480
    v_mfma_f32_16x16x32_bf16 v[92:95], a[52:55], v[52:55], v[92:95]
    s_waitcnt lgkmcnt(4)
    v_mfma_f32_16x16x32_bf16 v[80:83], a[56:59], v[56:59], v[80:83]
    ds_read_b128 v[48:51], v19 offset:5120
    v_mfma_f32_16x16x32_bf16 v[84:87], a[60:63], v[56:59], v[84:87]
    buffer_store_dwordx4 v[100:103], v21, s[8:11], s38 offen sc1
    v_mfma_f32_16x16x32_bf16 v[88:91], a[56:59], v[60:63], v[88:91]
    ds_read_b128 v[52:55], v19 offset:21504
    v_mfma_f32_16x16x32_bf16 v[92:95], a[60:63], v[60:63], v[92:95]
    s_waitcnt lgkmcnt(4)
    v_mfma_f32_16x16x32_bf16 v[80:83], a[64:67], v[32:35], v[80:83]
    ds_read_b128 v[56:59], v20 offset:5120
    s_add_u32 m0, s29, 37248
    v_mfma_f32_16x16x32_bf16 v[84:87], a[68:71], v[32:35], v[84:87]
    buffer_load_dwordx4 v16, s[16:19], s34 offen offset:640 lds
    v_mfma_f32_16x16x32_bf16 v[88:91], a[64:67], v[36:39], v[88:91]
    ds_read_b128 v[60:63], v20 offset:21504
    v_mfma_f32_16x16x32_bf16 v[92:95], a[68:71], v[36:39], v[92:95]
    s_mov_b32 exec_hi, 0
    buffer_store_dwordx4 v[24:27], v21, s[8:11], s48 offen sc1
    s_mov_b32 exec_hi, -1

    s_waitcnt lgkmcnt(4)
    v_mfma_f32_16x16x32_bf16 v[80:83], a[72:75], v[40:43], v[80:83]
    ds_read_b128 v[32:35], v19 offset:6144
    v_mfma_f32_16x16x32_bf16 v[84:87], a[76:79], v[40:43], v[84:87]
    s_mov_b32 s32, s39
    s_add_u32 s38, s39, 4096
    s_add_u32 s39, s39, 262144
    s_mov_b32 s48, s49
    s_add_u32 s49, s49, 196608
    v_mfma_f32_16x16x32_bf16 v[88:91], a[72:75], v[44:47], v[88:91]
    ds_read_b128 v[36:39], v19 offset:22528
    v_mfma_f32_16x16x32_bf16 v[92:95], a[76:79], v[44:47], v[92:95]
    v_add_u32 v23, 1, v23
    s_waitcnt lgkmcnt(4)
    v_mfma_f32_16x16x32_bf16 v[80:83], a[80:83], v[48:51], v[80:83]
    ds_read_b128 v[40:43], v20 offset:6144
    s_add_u32 m0, s29, 38144
    v_mfma_f32_16x16x32_bf16 v[84:87], a[84:87], v[48:51], v[84:87]
    buffer_load_dwordx4 v16, s[16:19], s34 offen offset:768 lds
    v_mfma_f32_16x16x32_bf16 v[88:91], a[80:83], v[52:55], v[88:91]
    ds_read_b128 v[44:47], v20 offset:22528
    v_mfma_f32_16x16x32_bf16 v[92:95], a[84:87], v[52:55], v[92:95]
    s_waitcnt lgkmcnt(4)
    v_mfma_f32_16x16x32_bf16 v[80:83], a[88:91], v[56:59], v[80:83]
    ds_read_b128 v[48:51], v19 offset:7168
    v_mfma_f32_16x16x32_bf16 v[84:87], a[92:95], v[56:59], v[84:87]
    v_mfma_f32_16x16x32_bf16 v[88:91], a[88:91], v[60:63], v[88:91]
    ds_read_b128 v[52:55], v19 offset:23552
    v_mfma_f32_16x16x32_bf16 v[92:95], a[92:95], v[60:63], v[92:95]
    s_mov_b64 exec, s[44:45]
    buffer_store_dwordx4 v[24:27], v30, s[8:11], s46 offen sc1
    s_mov_b64 exec, -1
    s_waitcnt lgkmcnt(4)
    v_mfma_f32_16x16x32_bf16 v[80:83], a[96:99], v[32:35], v[80:83]
    ds_read_b128 v[56:59], v20 offset:7168
    s_add_u32 m0, s29, 39040
    v_mfma_f32_16x16x32_bf16 v[84:87], a[100:103], v[32:35], v[84:87]
    buffer_load_dwordx4 v16, s[16:19], s34 offen offset:896 lds
    v_mfma_f32_16x16x32_bf16 v[88:91], a[96:99], v[36:39], v[88:91]
    ds_read_b128 v[60:63], v20 offset:23552
    v_mfma_f32_16x16x32_bf16 v[92:95], a[100:103], v[36:39], v[92:95]
    s_waitcnt lgkmcnt(4)
    v_mfma_f32_16x16x32_bf16 v[80:83], a[104:107], v[40:43], v[80:83]
    s_add_u32 s34, s34, 64512
    s_min_u32 s34, s34, 4128768
    v_mfma_f32_16x16x32_bf16 v[84:87], a[108:111], v[40:43], v[84:87]
    v_mfma_f32_16x16x32_bf16 v[88:91], a[104:107], v[44:47], v[88:91]
    v_mfma_f32_16x16x32_bf16 v[92:95], a[108:111], v[44:47], v[92:95]
    s_waitcnt lgkmcnt(0)
    s_waitcnt vmcnt(19)
    s_barrier
    ds_read_b128 v[32:35], v19 offset:32768
    ds_read_b128 v[36:39], v19 offset:49152
    v_mfma_f32_16x16x32_bf16 v[80:83], a[112:115], v[48:51], v[80:83]
    ds_read_b128 v[40:43], v20 offset:32768
    s_add_u32 m0, s29, 65536
    v_mfma_f32_16x16x32_bf16 v[84:87], a[116:119], v[48:51], v[84:87]
    buffer_load_dwordx4 v16, s[16:19], s34 offen offset:0 lds
    v_mfma_f32_16x16x32_bf16 v[88:91], a[112:115], v[52:55], v[88:91]
    ds_read_b128 v[44:47], v20 offset:49152
    v_mfma_f32_16x16x32_bf16 v[92:95], a[116:119], v[52:55], v[92:95]
    v_mfma_f32_16x16x32_bf16 v[80:83], a[120:123], v[56:59], v[80:83]
    ds_read_b128 v[48:51], v19 offset:33792
    v_mfma_f32_16x16x32_bf16 v[84:87], a[124:127], v[56:59], v[84:87]
    v_mfma_f32_16x16x32_bf16 v[88:91], a[120:123], v[60:63], v[88:91]
    ds_read_b128 v[52:55], v19 offset:50176
    v_mfma_f32_16x16x32_bf16 v[92:95], a[124:127], v[60:63], v[92:95]
    s_waitcnt lgkmcnt(4)
    v_mfma_f32_16x16x32_bf16 v[80:83], a[128:131], v[32:35], v[80:83]
    ds_read_b128 v[56:59], v20 offset:33792
    s_add_u32 m0, s29, 66432
    v_mfma_f32_16x16x32_bf16 v[84:87], a[132:135], v[32:35], v[84:87]
    buffer_load_dwordx4 v16, s[16:19], s34 offen offset:128 lds
    v_mfma_f32_16x16x32_bf16 v[88:91], a[128:131], v[36:39], v[88:91]
    ds_read_b128 v[60:63], v20 offset:50176
    v_mfma_f32_16x16x32_bf16 v[92:95], a[132:135], v[36:39], v[92:95]
    s_waitcnt lgkmcnt(4)
    v_mfma_f32_16x16x32_bf16 v[80:83], a[136:139], v[40:43], v[80:83]
    ds_read_b128 v[32:35], v19 offset:34816
    v_mfma_f32_16x16x32_bf16 v[84:87], a[140:143], v[40:43], v[84:87]
    v_mfma_f32_16x16x32_bf16 v[88:91], a[136:139], v[44:47], v[88:91]
    ds_read_b128 v[36:39], v19 offset:51200
    v_mfma_f32_16x16x32_bf16 v[92:95], a[140:143], v[44:47], v[92:95]
    s_waitcnt lgkmcnt(4)
    v_mfma_f32_16x16x32_bf16 v[80:83], a[144:147], v[48:51], v[80:83]
    ds_read_b128 v[40:43], v20 offset:34816
    s_add_u32 m0, s29, 67328
    v_mfma_f32_16x16x32_bf16 v[84:87], a[148:151], v[48:51], v[84:87]
    buffer_load_dwordx4 v16, s[16:19], s34 offen offset:256 lds
    v_mfma_f32_16x16x32_bf16 v[88:91], a[144:147], v[52:55], v[88:91]
    ds_read_b128 v[44:47], v20 offset:51200
    v_mfma_f32_16x16x32_bf16 v[92:95], a[148:151], v[52:55], v[92:95]
    s_waitcnt lgkmcnt(4)
    v_mfma_f32_16x16x32_bf16 v[80:83], a[152:155], v[56:59], v[80:83]
    ds_read_b128 v[48:51], v19 offset:35840
    v_mfma_f32_16x16x32_bf16 v[84:87], a[156:159], v[56:59], v[84:87]
    v_mfma_f32_16x16x32_bf16 v[88:91], a[152:155], v[60:63], v[88:91]
    ds_read_b128 v[52:55], v19 offset:52224
    v_mfma_f32_16x16x32_bf16 v[92:95], a[156:159], v[60:63], v[92:95]
    s_waitcnt lgkmcnt(4)
    v_mfma_f32_16x16x32_bf16 v[80:83], a[160:163], v[32:35], v[80:83]
    ds_read_b128 v[56:59], v20 offset:35840
    s_add_u32 m0, s29, 68224
    v_mfma_f32_16x16x32_bf16 v[84:87], a[164:167], v[32:35], v[84:87]
    buffer_load_dwordx4 v16, s[16:19], s34 offen offset:384 lds
    v_mfma_f32_16x16x32_bf16 v[88:91], a[160:163], v[36:39], v[88:91]
    ds_read_b128 v[60:63], v20 offset:52224
    v_mfma_f32_16x16x32_bf16 v[92:95], a[164:167], v[36:39], v[92:95]
    s_waitcnt lgkmcnt(4)
    v_mfma_f32_16x16x32_bf16 v[80:83], a[168:171], v[40:43], v[80:83]
    ds_read_b128 v[32:35], v19 offset:36864
    v_mfma_f32_16x16x32_bf16 v[84:87], a[172:175], v[40:43], v[84:87]
    v_mfma_f32_16x16x32_bf16 v[88:91], a[168:171], v[44:47], v[88:91]
    ds_read_b128 v[36:39], v19 offset:53248
    v_mfma_f32_16x16x32_bf16 v[92:95], a[172:175], v[44:47], v[92:95]
    s_waitcnt lgkmcnt(4)
    v_mfma_f32_16x16x32_bf16 v[80:83], a[176:179], v[48:51], v[80:83]
    ds_read_b128 v[40:43], v20 offset:36864
    s_add_u32 m0, s29, 69120
    v_mfma_f32_16x16x32_bf16 v[84:87], a[180:183], v[48:51], v[84:87]
    buffer_load_dwordx4 v16, s[16:19], s34 offen offset:512 lds
    v_mfma_f32_16x16x32_bf16 v[88:91], a[176:179], v[52:55], v[88:91]
    ds_read_b128 v[44:47], v20 offset:53248
    v_mfma_f32_16x16x32_bf16 v[92:95], a[180:183], v[52:55], v[92:95]
    s_waitcnt lgkmcnt(4)
    v_mfma_f32_16x16x32_bf16 v[80:83], a[184:187], v[56:59], v[80:83]
    ds_read_b128 v[48:51], v19 offset:37888
    v_mfma_f32_16x16x32_bf16 v[84:87], a[188:191], v[56:59], v[84:87]
    v_mfma_f32_16x16x32_bf16 v[88:91], a[184:187], v[60:63], v[88:91]
    ds_read_b128 v[52:55], v19 offset:54272
    v_mfma_f32_16x16x32_bf16 v[92:95], a[188:191], v[60:63], v[92:95]
    s_waitcnt lgkmcnt(4)
    v_mfma_f32_16x16x32_bf16 v[80:83], a[192:195], v[32:35], v[80:83]
    ds_read_b128 v[56:59], v20 offset:37888
    s_add_u32 m0, s29, 70016
    v_mfma_f32_16x16x32_bf16 v[84:87], a[196:199], v[32:35], v[84:87]
    buffer_load_dwordx4 v16, s[16:19], s34 offen offset:640 lds
    v_mfma_f32_16x16x32_bf16 v[88:91], a[192:195], v[36:39], v[88:91]
    ds_read_b128 v[60:63], v20 offset:54272
    v_mfma_f32_16x16x32_bf16 v[92:95], a[196:199], v[36:39], v[92:95]
    s_waitcnt lgkmcnt(4)
    v_mfma_f32_16x16x32_bf16 v[80:83], a[200:203], v[40:43], v[80:83]
    ds_read_b128 v[32:35], v19 offset:38912
    v_mfma_f32_16x16x32_bf16 v[84:87], a[204:207], v[40:43], v[84:87]
    v_mfma_f32_16x16x32_bf16 v[88:91], a[200:203], v[44:47], v[88:91]
    ds_read_b128 v[36:39], v19 offset:55296
    v_mfma_f32_16x16x32_bf16 v[92:95], a[204:207], v[44:47], v[92:95]
    s_waitcnt lgkmcnt(4)
    v_mfma_f32_16x16x32_bf16 v[80:83], a[208:211], v[48:51], v[80:83]
    ds_read_b128 v[40:43], v20 offset:38912
    s_add_u32 m0, s29, 70912
    v_mfma_f32_16x16x32_bf16 v[84:87], a[212:215], v[48:51], v[84:87]
    buffer_load_dwordx4 v16, s[16:19], s34 offen offset:768 lds
    v_mfma_f32_16x16x32_bf16 v[88:91], a[208:211], v[52:55], v[88:91]
    ds_read_b128 v[44:47], v20 offset:55296
    v_mfma_f32_16x16x32_bf16 v[92:95], a[212:215], v[52:55], v[92:95]
    s_waitcnt lgkmcnt(4)
    v_mfma_f32_16x16x32_bf16 v[80:83], a[216:219], v[56:59], v[80:83]
    ds_read_b128 v[48:51], v19 offset:39936
    v_mfma_f32_16x16x32_bf16 v[84:87], a[220:223], v[56:59], v[84:87]
    s_cmp_lt_u32 s35, 21
    s_cselect_b64 s[44:45], -1, 0
    v_mfma_f32_16x16x32_bf16 v[88:91], a[216:219], v[60:63], v[88:91]
    ds_read_b128 v[52:55], v19 offset:56320
    v_mfma_f32_16x16x32_bf16 v[92:95], a[220:223], v[60:63], v[92:95]
    s_cselect_b32 s4, 0x10000, 0
    s_add_u32 s46, s46, s4
    s_waitcnt lgkmcnt(4)
    v_mfma_f32_16x16x32_bf16 v[80:83], a[224:227], v[32:35], v[80:83]
    ds_read_b128 v[56:59], v20 offset:39936
    s_add_u32 m0, s29, 71808
    v_mfma_f32_16x16x32_bf16 v[84:87], a[228:231], v[32:35], v[84:87]
    buffer_load_dwordx4 v16, s[16:19], s34 offen offset:896 lds
    v_mfma_f32_16x16x32_bf16 v[88:91], a[224:227], v[36:39], v[88:91]
    ds_read_b128 v[60:63], v20 offset:56320
    v_mfma_f32_16x16x32_bf16 v[92:95], a[228:231], v[36:39], v[92:95]
    s_waitcnt lgkmcnt(4)
    v_mfma_f32_16x16x32_bf16 v[80:83], a[232:235], v[40:43], v[80:83]
    s_add_u32 s34, s34, 1024
    v_mfma_f32_16x16x32_bf16 v[84:87], a[236:239], v[40:43], v[84:87]
    v_mfma_f32_16x16x32_bf16 v[88:91], a[232:235], v[44:47], v[88:91]
    v_mfma_f32_16x16x32_bf16 v[92:95], a[236:239], v[44:47], v[92:95]
    s_waitcnt lgkmcnt(0)
    s_waitcnt vmcnt(10)
    s_barrier
    ds_read_b128 v[32:35], v17 offset:0
    ds_read_b128 v[36:39], v17 offset:16384
    v_mfma_f32_16x16x32_bf16 v[80:83], a[240:243], v[48:51], v[80:83]
    ds_read_b128 v[40:43], v18 offset:0
    s_add_u32 m0, s29, 98304
    v_mfma_f32_16x16x32_bf16 v[84:87], a[244:247], v[48:51], v[84:87]
    buffer_load_dwordx4 v16, s[16:19], s34 offen offset:0 lds
    v_mfma_f32_16x16x32_bf16 v[88:91], a[240:243], v[52:55], v[88:91]
    ds_read_b128 v[44:47], v18 offset:16384
    v_mfma_f32_16x16x32_bf16 v[92:95], a[244:247], v[52:55], v[92:95]
    v_mfma_f32_16x16x32_bf16 v[80:83], a[248:251], v[56:59], v[80:83]
    ds_read_b128 v[48:51], v17 offset:1024
    v_mfma_f32_16x16x32_bf16 v[84:87], a[252:255], v[56:59], v[84:87]
    v_mfma_f32_16x16x32_bf16 v[88:91], a[248:251], v[60:63], v[88:91]
    ds_read_b128 v[52:55], v17 offset:17408
    v_mfma_f32_16x16x32_bf16 v[92:95], a[252:255], v[60:63], v[92:95]
    s_mov_b64 exec, s[36:37]
    buffer_store_dword v23, v22, s[8:11], s33 offen sc1
    s_mov_b64 exec, -1

    s_add_u32 s35, s35, 1
    s_cmp_lt_u32 s35, 32
    s_cbranch_scc1 .ql_380

    s_nop 7
    v_cvt_pk_bf16_f32 v96, v80, v81
    v_cvt_pk_bf16_f32 v97, v82, v83
    v_cvt_pk_bf16_f32 v98, v84, v85
    v_cvt_pk_bf16_f32 v99, v86, v87
    buffer_store_dwordx4 v[96:99], v21, s[8:11], s32 offen sc1
    v_cvt_pk_bf16_f32 v100, v88, v89
    v_cvt_pk_bf16_f32 v101, v90, v91
    v_cvt_pk_bf16_f32 v102, v92, v93
    v_cvt_pk_bf16_f32 v103, v94, v95
    buffer_store_dwordx4 v[100:103], v21, s[8:11], s38 offen sc1
    s_mov_b32 exec_hi, 0
    buffer_store_dwordx4 v[24:27], v21, s[8:11], s48 offen sc1
    s_mov_b32 exec_hi, -1

    v_mov_b32 v23, 64
    s_waitcnt vmcnt(0) lgkmcnt(0)
    s_barrier
    s_mov_b64 exec, s[36:37]
    buffer_store_dword v23, v22, s[8:11], s33 offen sc1
    s_mov_b64 exec, -1

    s_branch .qd_379
.qv_378:
    s_waitcnt vmcnt(16)
    s_barrier
    ds_read_b128 v[32:35], v17 offset:0
    ds_read_b128 v[36:39], v17 offset:16384
    ds_read_b128 v[40:43], v18 offset:0
    ds_read_b128 v[44:47], v18 offset:16384
    s_add_u32 m0, s29, 98304
    s_nop 0
    buffer_load_dwordx4 v16, s[16:19], s34 offen offset:0 lds
    ds_read_b128 v[48:51], v17 offset:1024
    ds_read_b128 v[52:55], v17 offset:17408
    s_branch .qe_383
.p2align 6
.ql_382:
.qe_383:
    s_waitcnt lgkmcnt(4)
    v_mfma_f32_16x16x32_bf16 v[64:67], v[32:35], a[0:3], 0
    ds_read_b128 v[56:59], v18 offset:1024
    s_add_u32 m0, s29, 99200
    v_mfma_f32_16x16x32_bf16 v[68:71], v[32:35], a[4:7], 0
    buffer_load_dwordx4 v16, s[16:19], s34 offen offset:128 lds
    v_mfma_f32_16x16x32_bf16 v[72:75], v[36:39], a[0:3], 0
    ds_read_b128 v[60:63], v18 offset:17408
    v_mfma_f32_16x16x32_bf16 v[76:79], v[36:39], a[4:7], 0
    s_waitcnt lgkmcnt(4)
    v_mfma_f32_16x16x32_bf16 v[64:67], v[40:43], a[8:11], v[64:67]
    ds_read_b128 v[32:35], v17 offset:2048
    v_mfma_f32_16x16x32_bf16 v[68:71], v[40:43], a[12:15], v[68:71]
    v_cvt_pk_bf16_f32 v96, v80, v81
    v_cvt_pk_bf16_f32 v97, v82, v83
    v_mfma_f32_16x16x32_bf16 v[72:75], v[44:47], a[8:11], v[72:75]
    ds_read_b128 v[36:39], v17 offset:18432
    v_mfma_f32_16x16x32_bf16 v[76:79], v[44:47], a[12:15], v[76:79]
    v_cvt_pk_bf16_f32 v98, v88, v89
    v_cvt_pk_bf16_f32 v99, v90, v91
    s_waitcnt lgkmcnt(4)
    v_mfma_f32_16x16x32_bf16 v[64:67], v[48:51], a[16:19], v[64:67]
    ds_read_b128 v[40:43], v18 offset:2048
    s_add_u32 m0, s29, 100096
    v_mfma_f32_16x16x32_bf16 v[68:71], v[48:51], a[20:23], v[68:71]
    buffer_load_dwordx4 v16, s[16:19], s34 offen offset:256 lds
    v_mfma_f32_16x16x32_bf16 v[72:75], v[52:55], a[16:19], v[72:75]
    ds_read_b128 v[44:47], v18 offset:18432
    v_mfma_f32_16x16x32_bf16 v[76:79], v[52:55], a[20:23], v[76:79]
    s_waitcnt lgkmcnt(4)
    v_mfma_f32_16x16x32_bf16 v[64:67], v[56:59], a[24:27], v[64:67]
    ds_read_b128 v[48:51], v17 offset:3072
    v_mfma_f32_16x16x32_bf16 v[68:71], v[56:59], a[28:31], v[68:71]
    buffer_store_dwordx4 v[96:99], v21, s[8:11], s32 offen offset:0 sc1
    v_mfma_f32_16x16x32_bf16 v[72:75], v[60:63], a[24:27], v[72:75]
    ds_read_b128 v[52:55], v17 offset:19456
    v_mfma_f32_16x16x32_bf16 v[76:79], v[60:63], a[28:31], v[76:79]
    s_waitcnt lgkmcnt(4)
    v_mfma_f32_16x16x32_bf16 v[64:67], v[32:35], a[32:35], v[64:67]
    ds_read_b128 v[56:59], v18 offset:3072
    s_add_u32 m0, s29, 100992
    v_mfma_f32_16x16x32_bf16 v[68:71], v[32:35], a[36:39], v[68:71]
    buffer_load_dwordx4 v16, s[16:19], s34 offen offset:384 lds
    v_mfma_f32_16x16x32_bf16 v[72:75], v[36:39], a[32:35], v[72:75]
    ds_read_b128 v[60:63], v18 offset:19456
    v_mfma_f32_16x16x32_bf16 v[76:79], v[36:39], a[36:39], v[76:79]
    s_waitcnt lgkmcnt(4)
    v_mfma_f32_16x16x32_bf16 v[64:67], v[40:43], a[40:43], v[64:67]
    ds_read_b128 v[32:35], v17 offset:4096
    v_mfma_f32_16x16x32_bf16 v[68:71], v[40:43], a[44:47], v[68:71]
    v_cvt_pk_bf16_f32 v100, v84, v85
    v_cvt_pk_bf16_f32 v101, v86, v87
    v_mfma_f32_16x16x32_bf16 v[72:75], v[44:47], a[40:43], v[72:75]
    ds_read_b128 v[36:39], v17 offset:20480
    v_mfma_f32_16x16x32_bf16 v[76:79], v[44:47], a[44:47], v[76:79]
    v_cvt_pk_bf16_f32 v102, v92, v93
    v_cvt_pk_bf16_f32 v103, v94, v95
    s_waitcnt lgkmcnt(4)
    v_mfma_f32_16x16x32_bf16 v[64:67], v[48:51], a[48:51], v[64:67]
    ds_read_b128 v[40:43], v18 offset:4096
    s_add_u32 m0, s29, 101888
    v_mfma_f32_16x16x32_bf16 v[68:71], v[48:51], a[52:55], v[68:71]
    buffer_load_dwordx4 v16, s[16:19], s34 offen offset:512 lds
    v_mfma_f32_16x16x32_bf16 v[72:75], v[52:55], a[48:51], v[72:75]
    ds_read_b128 v[44:47], v18 offset:20480
    v_mfma_f32_16x16x32_bf16 v[76:79], v[52:55], a[52:55], v[76:79]
    s_waitcnt lgkmcnt(4)
    v_mfma_f32_16x16x32_bf16 v[64:67], v[56:59], a[56:59], v[64:67]
    ds_read_b128 v[48:51], v17 offset:5120
    v_mfma_f32_16x16x32_bf16 v[68:71], v[56:59], a[60:63], v[68:71]
    buffer_store_dwordx4 v[100:103], v21, s[8:11], s32 offen offset:1024 sc1
    v_mfma_f32_16x16x32_bf16 v[72:75], v[60:63], a[56:59], v[72:75]
    ds_read_b128 v[52:55], v17 offset:21504
    v_mfma_f32_16x16x32_bf16 v[76:79], v[60:63], a[60:63], v[76:79]
    s_waitcnt lgkmcnt(4)
    v_mfma_f32_16x16x32_bf16 v[64:67], v[32:35], a[64:67], v[64:67]
    ds_read_b128 v[56:59], v18 offset:5120
    s_add_u32 m0, s29, 102784
    v_mfma_f32_16x16x32_bf16 v[68:71], v[32:35], a[68:71], v[68:71]
    buffer_load_dwordx4 v16, s[16:19], s34 offen offset:640 lds
    v_mfma_f32_16x16x32_bf16 v[72:75], v[36:39], a[64:67], v[72:75]
    ds_read_b128 v[60:63], v18 offset:21504
    v_mfma_f32_16x16x32_bf16 v[76:79], v[36:39], a[68:71], v[76:79]
    s_mov_b32 exec_hi, 0
    buffer_store_dwordx4 v[24:27], v21, s[8:11], s48 offen sc1
    s_mov_b32 exec_hi, -1

    s_waitcnt lgkmcnt(4)
    v_mfma_f32_16x16x32_bf16 v[64:67], v[40:43], a[72:75], v[64:67]
    ds_read_b128 v[32:35], v17 offset:6144
    v_mfma_f32_16x16x32_bf16 v[68:71], v[40:43], a[76:79], v[68:71]
    s_mov_b32 s32, s39
    s_add_u32 s38, s39, 4096
    s_add_u32 s39, s39, 262144
    s_mov_b32 s48, s49
    s_add_u32 s49, s49, 196608
    v_mfma_f32_16x16x32_bf16 v[72:75], v[44:47], a[72:75], v[72:75]
    ds_read_b128 v[36:39], v17 offset:22528
    v_mfma_f32_16x16x32_bf16 v[76:79], v[44:47], a[76:79], v[76:79]
    v_add_u32 v23, 1, v23
    s_waitcnt lgkmcnt(4)
    v_mfma_f32_16x16x32_bf16 v[64:67], v[48:51], a[80:83], v[64:67]
    ds_read_b128 v[40:43], v18 offset:6144
    s_add_u32 m0, s29, 103680
    v_mfma_f32_16x16x32_bf16 v[68:71], v[48:51], a[84:87], v[68:71]
    buffer_load_dwordx4 v16, s[16:19], s34 offen offset:768 lds
    v_mfma_f32_16x16x32_bf16 v[72:75], v[52:55], a[80:83], v[72:75]
    ds_read_b128 v[44:47], v18 offset:22528
    v_mfma_f32_16x16x32_bf16 v[76:79], v[52:55], a[84:87], v[76:79]
    s_waitcnt lgkmcnt(4)
    v_mfma_f32_16x16x32_bf16 v[64:67], v[56:59], a[88:91], v[64:67]
    ds_read_b128 v[48:51], v17 offset:7168
    v_mfma_f32_16x16x32_bf16 v[68:71], v[56:59], a[92:95], v[68:71]
    v_mfma_f32_16x16x32_bf16 v[72:75], v[60:63], a[88:91], v[72:75]
    ds_read_b128 v[52:55], v17 offset:23552
    v_mfma_f32_16x16x32_bf16 v[76:79], v[60:63], a[92:95], v[76:79]
    s_mov_b64 exec, s[44:45]
    buffer_store_dwordx4 v[24:27], v28, s[8:11], s46 offen sc1
    s_mov_b64 exec, -1
    s_waitcnt lgkmcnt(4)
    v_mfma_f32_16x16x32_bf16 v[64:67], v[32:35], a[96:99], v[64:67]
    ds_read_b128 v[56:59], v18 offset:7168
    s_add_u32 m0, s29, 104576
    v_mfma_f32_16x16x32_bf16 v[68:71], v[32:35], a[100:103], v[68:71]
    buffer_load_dwordx4 v16, s[16:19], s34 offen offset:896 lds
    v_mfma_f32_16x16x32_bf16 v[72:75], v[36:39], a[96:99], v[72:75]
    ds_read_b128 v[60:63], v18 offset:23552
    v_mfma_f32_16x16x32_bf16 v[76:79], v[36:39], a[100:103], v[76:79]
    s_waitcnt lgkmcnt(4)
    v_mfma_f32_16x16x32_bf16 v[64:67], v[40:43], a[104:107], v[64:67]
    s_add_u32 s34, s34, 64512
    s_min_u32 s34, s34, 4128768
    v_mfma_f32_16x16x32_bf16 v[68:71], v[40:43], a[108:111], v[68:71]
    v_mfma_f32_16x16x32_bf16 v[72:75], v[44:47], a[104:107], v[72:75]
    v_mfma_f32_16x16x32_bf16 v[76:79], v[44:47], a[108:111], v[76:79]
    s_waitcnt lgkmcnt(0)
    s_waitcnt vmcnt(19)
    s_barrier
    ds_read_b128 v[32:35], v17 offset:32768
    ds_read_b128 v[36:39], v17 offset:49152
    v_mfma_f32_16x16x32_bf16 v[64:67], v[48:51], a[112:115], v[64:67]
    ds_read_b128 v[40:43], v18 offset:32768
    s_add_u32 m0, s29, 0
    v_mfma_f32_16x16x32_bf16 v[68:71], v[48:51], a[116:119], v[68:71]
    buffer_load_dwordx4 v16, s[16:19], s34 offen offset:0 lds
    v_mfma_f32_16x16x32_bf16 v[72:75], v[52:55], a[112:115], v[72:75]
    ds_read_b128 v[44:47], v18 offset:49152
    v_mfma_f32_16x16x32_bf16 v[76:79], v[52:55], a[116:119], v[76:79]
    v_mfma_f32_16x16x32_bf16 v[64:67], v[56:59], a[120:123], v[64:67]
    ds_read_b128 v[48:51], v17 offset:33792
    v_mfma_f32_16x16x32_bf16 v[68:71], v[56:59], a[124:127], v[68:71]
    v_mfma_f32_16x16x32_bf16 v[72:75], v[60:63], a[120:123], v[72:75]
    ds_read_b128 v[52:55], v17 offset:50176
    v_mfma_f32_16x16x32_bf16 v[76:79], v[60:63], a[124:127], v[76:79]
    s_waitcnt lgkmcnt(4)
    v_mfma_f32_16x16x32_bf16 v[64:67], v[32:35], a[128:131], v[64:67]
    ds_read_b128 v[56:59], v18 offset:33792
    s_add_u32 m0, s29, 896
    v_mfma_f32_16x16x32_bf16 v[68:71], v[32:35], a[132:135], v[68:71]
    buffer_load_dwordx4 v16, s[16:19], s34 offen offset:128 lds
    v_mfma_f32_16x16x32_bf16 v[72:75], v[36:39], a[128:131], v[72:75]
    ds_read_b128 v[60:63], v18 offset:50176
    v_mfma_f32_16x16x32_bf16 v[76:79], v[36:39], a[132:135], v[76:79]
    s_waitcnt lgkmcnt(4)
    v_mfma_f32_16x16x32_bf16 v[64:67], v[40:43], a[136:139], v[64:67]
    ds_read_b128 v[32:35], v17 offset:34816
    v_mfma_f32_16x16x32_bf16 v[68:71], v[40:43], a[140:143], v[68:71]
    v_mfma_f32_16x16x32_bf16 v[72:75], v[44:47], a[136:139], v[72:75]
    ds_read_b128 v[36:39], v17 offset:51200
    v_mfma_f32_16x16x32_bf16 v[76:79], v[44:47], a[140:143], v[76:79]
    s_waitcnt lgkmcnt(4)
    v_mfma_f32_16x16x32_bf16 v[64:67], v[48:51], a[144:147], v[64:67]
    ds_read_b128 v[40:43], v18 offset:34816
    s_add_u32 m0, s29, 1792
    v_mfma_f32_16x16x32_bf16 v[68:71], v[48:51], a[148:151], v[68:71]
    buffer_load_dwordx4 v16, s[16:19], s34 offen offset:256 lds
    v_mfma_f32_16x16x32_bf16 v[72:75], v[52:55], a[144:147], v[72:75]
    ds_read_b128 v[44:47], v18 offset:51200
    v_mfma_f32_16x16x32_bf16 v[76:79], v[52:55], a[148:151], v[76:79]
    s_waitcnt lgkmcnt(4)
    v_mfma_f32_16x16x32_bf16 v[64:67], v[56:59], a[152:155], v[64:67]
    ds_read_b128 v[48:51], v17 offset:35840
    v_mfma_f32_16x16x32_bf16 v[68:71], v[56:59], a[156:159], v[68:71]
    v_mfma_f32_16x16x32_bf16 v[72:75], v[60:63], a[152:155], v[72:75]
    ds_read_b128 v[52:55], v17 offset:52224
    v_mfma_f32_16x16x32_bf16 v[76:79], v[60:63], a[156:159], v[76:79]
    s_waitcnt lgkmcnt(4)
    v_mfma_f32_16x16x32_bf16 v[64:67], v[32:35], a[160:163], v[64:67]
    ds_read_b128 v[56:59], v18 offset:35840
    s_add_u32 m0, s29, 2688
    v_mfma_f32_16x16x32_bf16 v[68:71], v[32:35], a[164:167], v[68:71]
    buffer_load_dwordx4 v16, s[16:19], s34 offen offset:384 lds
    v_mfma_f32_16x16x32_bf16 v[72:75], v[36:39], a[160:163], v[72:75]
    ds_read_b128 v[60:63], v18 offset:52224
    v_mfma_f32_16x16x32_bf16 v[76:79], v[36:39], a[164:167], v[76:79]
    s_waitcnt lgkmcnt(4)
    v_mfma_f32_16x16x32_bf16 v[64:67], v[40:43], a[168:171], v[64:67]
    ds_read_b128 v[32:35], v17 offset:36864
    v_mfma_f32_16x16x32_bf16 v[68:71], v[40:43], a[172:175], v[68:71]
    v_mfma_f32_16x16x32_bf16 v[72:75], v[44:47], a[168:171], v[72:75]
    ds_read_b128 v[36:39], v17 offset:53248
    v_mfma_f32_16x16x32_bf16 v[76:79], v[44:47], a[172:175], v[76:79]
    s_waitcnt lgkmcnt(4)
    v_mfma_f32_16x16x32_bf16 v[64:67], v[48:51], a[176:179], v[64:67]
    ds_read_b128 v[40:43], v18 offset:36864
    s_add_u32 m0, s29, 3584
    v_mfma_f32_16x16x32_bf16 v[68:71], v[48:51], a[180:183], v[68:71]
    buffer_load_dwordx4 v16, s[16:19], s34 offen offset:512 lds
    v_mfma_f32_16x16x32_bf16 v[72:75], v[52:55], a[176:179], v[72:75]
    ds_read_b128 v[44:47], v18 offset:53248
    v_mfma_f32_16x16x32_bf16 v[76:79], v[52:55], a[180:183], v[76:79]
    s_waitcnt lgkmcnt(4)
    v_mfma_f32_16x16x32_bf16 v[64:67], v[56:59], a[184:187], v[64:67]
    ds_read_b128 v[48:51], v17 offset:37888
    v_mfma_f32_16x16x32_bf16 v[68:71], v[56:59], a[188:191], v[68:71]
    v_mfma_f32_16x16x32_bf16 v[72:75], v[60:63], a[184:187], v[72:75]
    ds_read_b128 v[52:55], v17 offset:54272
    v_mfma_f32_16x16x32_bf16 v[76:79], v[60:63], a[188:191], v[76:79]
    s_waitcnt lgkmcnt(4)
    v_mfma_f32_16x16x32_bf16 v[64:67], v[32:35], a[192:195], v[64:67]
    ds_read_b128 v[56:59], v18 offset:37888
    s_add_u32 m0, s29, 4480
    v_mfma_f32_16x16x32_bf16 v[68:71], v[32:35], a[196:199], v[68:71]
    buffer_load_dwordx4 v16, s[16:19], s34 offen offset:640 lds
    v_mfma_f32_16x16x32_bf16 v[72:75], v[36:39], a[192:195], v[72:75]
    ds_read_b128 v[60:63], v18 offset:54272
    v_mfma_f32_16x16x32_bf16 v[76:79], v[36:39], a[196:199], v[76:79]
    s_waitcnt lgkmcnt(4)
    v_mfma_f32_16x16x32_bf16 v[64:67], v[40:43], a[200:203], v[64:67]
    ds_read_b128 v[32:35], v17 offset:38912
    v_mfma_f32_16x16x32_bf16 v[68:71], v[40:43], a[204:207], v[68:71]
    v_mfma_f32_16x16x32_bf16 v[72:75], v[44:47], a[200:203], v[72:75]
    ds_read_b128 v[36:39], v17 offset:55296
    v_mfma_f32_16x16x32_bf16 v[76:79], v[44:47], a[204:207], v[76:79]
    s_waitcnt lgkmcnt(4)
    v_mfma_f32_16x16x32_bf16 v[64:67], v[48:51], a[208:211], v[64:67]
    ds_read_b128 v[40:43], v18 offset:38912
    s_add_u32 m0, s29, 5376
    v_mfma_f32_16x16x32_bf16 v[68:71], v[48:51], a[212:215], v[68:71]
    buffer_load_dwordx4 v16, s[16:19], s34 offen offset:768 lds
    v_mfma_f32_16x16x32_bf16 v[72:75], v[52:55], a[208:211], v[72:75]
    ds_read_b128 v[44:47], v18 offset:55296
    v_mfma_f32_16x16x32_bf16 v[76:79], v[52:55], a[212:215], v[76:79]
    s_waitcnt lgkmcnt(4)
    v_mfma_f32_16x16x32_bf16 v[64:67], v[56:59], a[216:219], v[64:67]
    ds_read_b128 v[48:51], v17 offset:39936
    v_mfma_f32_16x16x32_bf16 v[68:71], v[56:59], a[220:223], v[68:71]
    v_mfma_f32_16x16x32_bf16 v[72:75], v[60:63], a[216:219], v[72:75]
    ds_read_b128 v[52:55], v17 offset:56320
    v_mfma_f32_16x16x32_bf16 v[76:79], v[60:63], a[220:223], v[76:79]
    s_mov_b64 exec, s[44:45]
    buffer_store_dwordx4 v[24:27], v29, s[8:11], s46 offen sc1
    s_mov_b64 exec, -1
    s_waitcnt lgkmcnt(4)
    v_mfma_f32_16x16x32_bf16 v[64:67], v[32:35], a[224:227], v[64:67]
    ds_read_b128 v[56:59], v18 offset:39936
    s_add_u32 m0, s29, 6272
    v_mfma_f32_16x16x32_bf16 v[68:71], v[32:35], a[228:231], v[68:71]
    buffer_load_dwordx4 v16, s[16:19], s34 offen offset:896 lds
    v_mfma_f32_16x16x32_bf16 v[72:75], v[36:39], a[224:227], v[72:75]
    ds_read_b128 v[60:63], v18 offset:56320
    v_mfma_f32_16x16x32_bf16 v[76:79], v[36:39], a[228:231], v[76:79]
    s_waitcnt lgkmcnt(4)
    v_mfma_f32_16x16x32_bf16 v[64:67], v[40:43], a[232:235], v[64:67]
    s_add_u32 s34, s34, 1024
    v_mfma_f32_16x16x32_bf16 v[68:71], v[40:43], a[236:239], v[68:71]
    v_mfma_f32_16x16x32_bf16 v[72:75], v[44:47], a[232:235], v[72:75]
    v_mfma_f32_16x16x32_bf16 v[76:79], v[44:47], a[236:239], v[76:79]
    s_waitcnt lgkmcnt(0)
    s_waitcnt vmcnt(10)
    s_barrier
    ds_read_b128 v[32:35], v19 offset:0
    ds_read_b128 v[36:39], v19 offset:16384
    v_mfma_f32_16x16x32_bf16 v[64:67], v[48:51], a[240:243], v[64:67]
    ds_read_b128 v[40:43], v20 offset:0
    s_add_u32 m0, s29, 32768
    v_mfma_f32_16x16x32_bf16 v[68:71], v[48:51], a[244:247], v[68:71]
    buffer_load_dwordx4 v16, s[16:19], s34 offen offset:0 lds
    v_mfma_f32_16x16x32_bf16 v[72:75], v[52:55], a[240:243], v[72:75]
    ds_read_b128 v[44:47], v20 offset:16384
    v_mfma_f32_16x16x32_bf16 v[76:79], v[52:55], a[244:247], v[76:79]
    v_mfma_f32_16x16x32_bf16 v[64:67], v[56:59], a[248:251], v[64:67]
    ds_read_b128 v[48:51], v19 offset:1024
    v_mfma_f32_16x16x32_bf16 v[68:71], v[56:59], a[252:255], v[68:71]
    v_mfma_f32_16x16x32_bf16 v[72:75], v[60:63], a[248:251], v[72:75]
    ds_read_b128 v[52:55], v19 offset:17408
    v_mfma_f32_16x16x32_bf16 v[76:79], v[60:63], a[252:255], v[76:79]
    s_mov_b64 exec, s[36:37]
    buffer_store_dword v23, v22, s[8:11], s33 offen sc1
    s_mov_b64 exec, -1

    s_waitcnt lgkmcnt(4)
    v_mfma_f32_16x16x32_bf16 v[80:83], v[32:35], a[0:3], 0
    ds_read_b128 v[56:59], v20 offset:1024
    s_add_u32 m0, s29, 33664
    v_mfma_f32_16x16x32_bf16 v[84:87], v[32:35], a[4:7], 0
    buffer_load_dwordx4 v16, s[16:19], s34 offen offset:128 lds
    v_mfma_f32_16x16x32_bf16 v[88:91], v[36:39], a[0:3], 0
    ds_read_b128 v[60:63], v20 offset:17408
    v_mfma_f32_16x16x32_bf16 v[92:95], v[36:39], a[4:7], 0
    s_waitcnt lgkmcnt(4)
    v_mfma_f32_16x16x32_bf16 v[80:83], v[40:43], a[8:11], v[80:83]
    ds_read_b128 v[32:35], v19 offset:2048
    v_mfma_f32_16x16x32_bf16 v[84:87], v[40:43], a[12:15], v[84:87]
    v_cvt_pk_bf16_f32 v96, v64, v65
    v_cvt_pk_bf16_f32 v97, v66, v67
    v_mfma_f32_16x16x32_bf16 v[88:91], v[44:47], a[8:11], v[88:91]
    ds_read_b128 v[36:39], v19 offset:18432
    v_mfma_f32_16x16x32_bf16 v[92:95], v[44:47], a[12:15], v[92:95]
    v_cvt_pk_bf16_f32 v98, v72, v73
    v_cvt_pk_bf16_f32 v99, v74, v75
    s_waitcnt lgkmcnt(4)
    v_mfma_f32_16x16x32_bf16 v[80:83], v[48:51], a[16:19], v[80:83]
    ds_read_b128 v[40:43], v20 offset:2048
    s_add_u32 m0, s29, 34560
    v_mfma_f32_16x16x32_bf16 v[84:87], v[48:51], a[20:23], v[84:87]
    buffer_load_dwordx4 v16, s[16:19], s34 offen offset:256 lds
    v_mfma_f32_16x16x32_bf16 v[88:91], v[52:55], a[16:19], v[88:91]
    ds_read_b128 v[44:47], v20 offset:18432
    v_mfma_f32_16x16x32_bf16 v[92:95], v[52:55], a[20:23], v[92:95]
    s_waitcnt lgkmcnt(4)
    v_mfma_f32_16x16x32_bf16 v[80:83], v[56:59], a[24:27], v[80:83]
    ds_read_b128 v[48:51], v19 offset:3072
    v_mfma_f32_16x16x32_bf16 v[84:87], v[56:59], a[28:31], v[84:87]
    buffer_store_dwordx4 v[96:99], v21, s[8:11], s32 offen offset:0 sc1
    v_mfma_f32_16x16x32_bf16 v[88:91], v[60:63], a[24:27], v[88:91]
    ds_read_b128 v[52:55], v19 offset:19456
    v_mfma_f32_16x16x32_bf16 v[92:95], v[60:63], a[28:31], v[92:95]
    s_waitcnt lgkmcnt(4)
    v_mfma_f32_16x16x32_bf16 v[80:83], v[32:35], a[32:35], v[80:83]
    ds_read_b128 v[56:59], v20 offset:3072
    s_add_u32 m0, s29, 35456
    v_mfma_f32_16x16x32_bf16 v[84:87], v[32:35], a[36:39], v[84:87]
    buffer_load_dwordx4 v16, s[16:19], s34 offen offset:384 lds
    v_mfma_f32_16x16x32_bf16 v[88:91], v[36:39], a[32:35], v[88:91]
    ds_read_b128 v[60:63], v20 offset:19456
    v_mfma_f32_16x16x32_bf16 v[92:95], v[36:39], a[36:39], v[92:95]
    s_waitcnt lgkmcnt(4)
    v_mfma_f32_16x16x32_bf16 v[80:83], v[40:43], a[40:43], v[80:83]
    ds_read_b128 v[32:35], v19 offset:4096
    v_mfma_f32_16x16x32_bf16 v[84:87], v[40:43], a[44:47], v[84:87]
    v_cvt_pk_bf16_f32 v100, v68, v69
    v_cvt_pk_bf16_f32 v101, v70, v71
    v_mfma_f32_16x16x32_bf16 v[88:91], v[44:47], a[40:43], v[88:91]
    ds_read_b128 v[36:39], v19 offset:20480
    v_mfma_f32_16x16x32_bf16 v[92:95], v[44:47], a[44:47], v[92:95]
    v_cvt_pk_bf16_f32 v102, v76, v77
    v_cvt_pk_bf16_f32 v103, v78, v79
    s_waitcnt lgkmcnt(4)
    v_mfma_f32_16x16x32_bf16 v[80:83], v[48:51], a[48:51], v[80:83]
    ds_read_b128 v[40:43], v20 offset:4096
    s_add_u32 m0, s29, 36352
    v_mfma_f32_16x16x32_bf16 v[84:87], v[48:51], a[52:55], v[84:87]
    buffer_load_dwordx4 v16, s[16:19], s34 offen offset:512 lds
    v_mfma_f32_16x16x32_bf16 v[88:91], v[52:55], a[48:51], v[88:91]
    ds_read_b128 v[44:47], v20 offset:20480
    v_mfma_f32_16x16x32_bf16 v[92:95], v[52:55], a[52:55], v[92:95]
    s_waitcnt lgkmcnt(4)
    v_mfma_f32_16x16x32_bf16 v[80:83], v[56:59], a[56:59], v[80:83]
    ds_read_b128 v[48:51], v19 offset:5120
    v_mfma_f32_16x16x32_bf16 v[84:87], v[56:59], a[60:63], v[84:87]
    buffer_store_dwordx4 v[100:103], v21, s[8:11], s32 offen offset:1024 sc1
    v_mfma_f32_16x16x32_bf16 v[88:91], v[60:63], a[56:59], v[88:91]
    ds_read_b128 v[52:55], v19 offset:21504
    v_mfma_f32_16x16x32_bf16 v[92:95], v[60:63], a[60:63], v[92:95]
    s_waitcnt lgkmcnt(4)
    v_mfma_f32_16x16x32_bf16 v[80:83], v[32:35], a[64:67], v[80:83]
    ds_read_b128 v[56:59], v20 offset:5120
    s_add_u32 m0, s29, 37248
    v_mfma_f32_16x16x32_bf16 v[84:87], v[32:35], a[68:71], v[84:87]
    buffer_load_dwordx4 v16, s[16:19], s34 offen offset:640 lds
    v_mfma_f32_16x16x32_bf16 v[88:91], v[36:39], a[64:67], v[88:91]
    ds_read_b128 v[60:63], v20 offset:21504
    v_mfma_f32_16x16x32_bf16 v[92:95], v[36:39], a[68:71], v[92:95]
    s_mov_b32 exec_hi, 0
    buffer_store_dwordx4 v[24:27], v21, s[8:11], s48 offen sc1
    s_mov_b32 exec_hi, -1

    s_waitcnt lgkmcnt(4)
    v_mfma_f32_16x16x32_bf16 v[80:83], v[40:43], a[72:75], v[80:83]
    ds_read_b128 v[32:35], v19 offset:6144
    v_mfma_f32_16x16x32_bf16 v[84:87], v[40:43], a[76:79], v[84:87]
    s_mov_b32 s32, s39
    s_add_u32 s38, s39, 4096
    s_add_u32 s39, s39, 262144
    s_mov_b32 s48, s49
    s_add_u32 s49, s49, 196608
    v_mfma_f32_16x16x32_bf16 v[88:91], v[44:47], a[72:75], v[88:91]
    ds_read_b128 v[36:39], v19 offset:22528
    v_mfma_f32_16x16x32_bf16 v[92:95], v[44:47], a[76:79], v[92:95]
    v_add_u32 v23, 1, v23
    s_waitcnt lgkmcnt(4)
    v_mfma_f32_16x16x32_bf16 v[80:83], v[48:51], a[80:83], v[80:83]
    ds_read_b128 v[40:43], v20 offset:6144
    s_add_u32 m0, s29, 38144
    v_mfma_f32_16x16x32_bf16 v[84:87], v[48:51], a[84:87], v[84:87]
    buffer_load_dwordx4 v16, s[16:19], s34 offen offset:768 lds
    v_mfma_f32_16x16x32_bf16 v[88:91], v[52:55], a[80:83], v[88:91]
    ds_read_b128 v[44:47], v20 offset:22528
    v_mfma_f32_16x16x32_bf16 v[92:95], v[52:55], a[84:87], v[92:95]
    s_waitcnt lgkmcnt(4)
    v_mfma_f32_16x16x32_bf16 v[80:83], v[56:59], a[88:91], v[80:83]
    ds_read_b128 v[48:51], v19 offset:7168
    v_mfma_f32_16x16x32_bf16 v[84:87], v[56:59], a[92:95], v[84:87]
    v_mfma_f32_16x16x32_bf16 v[88:91], v[60:63], a[88:91], v[88:91]
    ds_read_b128 v[52:55], v19 offset:23552
    v_mfma_f32_16x16x32_bf16 v[92:95], v[60:63], a[92:95], v[92:95]
    s_mov_b64 exec, s[44:45]
    buffer_store_dwordx4 v[24:27], v30, s[8:11], s46 offen sc1
    s_mov_b64 exec, -1
    s_waitcnt lgkmcnt(4)
    v_mfma_f32_16x16x32_bf16 v[80:83], v[32:35], a[96:99], v[80:83]
    ds_read_b128 v[56:59], v20 offset:7168
    s_add_u32 m0, s29, 39040
    v_mfma_f32_16x16x32_bf16 v[84:87], v[32:35], a[100:103], v[84:87]
    buffer_load_dwordx4 v16, s[16:19], s34 offen offset:896 lds
    v_mfma_f32_16x16x32_bf16 v[88:91], v[36:39], a[96:99], v[88:91]
    ds_read_b128 v[60:63], v20 offset:23552
    v_mfma_f32_16x16x32_bf16 v[92:95], v[36:39], a[100:103], v[92:95]
    s_waitcnt lgkmcnt(4)
    v_mfma_f32_16x16x32_bf16 v[80:83], v[40:43], a[104:107], v[80:83]
    s_add_u32 s34, s34, 64512
    s_min_u32 s34, s34, 4128768
    v_mfma_f32_16x16x32_bf16 v[84:87], v[40:43], a[108:111], v[84:87]
    v_mfma_f32_16x16x32_bf16 v[88:91], v[44:47], a[104:107], v[88:91]
    v_mfma_f32_16x16x32_bf16 v[92:95], v[44:47], a[108:111], v[92:95]
    s_waitcnt lgkmcnt(0)
    s_waitcnt vmcnt(19)
    s_barrier
    ds_read_b128 v[32:35], v19 offset:32768
    ds_read_b128 v[36:39], v19 offset:49152
    v_mfma_f32_16x16x32_bf16 v[80:83], v[48:51], a[112:115], v[80:83]
    ds_read_b128 v[40:43], v20 offset:32768
    s_add_u32 m0, s29, 65536
    v_mfma_f32_16x16x32_bf16 v[84:87], v[48:51], a[116:119], v[84:87]
    buffer_load_dwordx4 v16, s[16:19], s34 offen offset:0 lds
    v_mfma_f32_16x16x32_bf16 v[88:91], v[52:55], a[112:115], v[88:91]
    ds_read_b128 v[44:47], v20 offset:49152
    v_mfma_f32_16x16x32_bf16 v[92:95], v[52:55], a[116:119], v[92:95]
    v_mfma_f32_16x16x32_bf16 v[80:83], v[56:59], a[120:123], v[80:83]
    ds_read_b128 v[48:51], v19 offset:33792
    v_mfma_f32_16x16x32_bf16 v[84:87], v[56:59], a[124:127], v[84:87]
    v_mfma_f32_16x16x32_bf16 v[88:91], v[60:63], a[120:123], v[88:91]
    ds_read_b128 v[52:55], v19 offset:50176
    v_mfma_f32_16x16x32_bf16 v[92:95], v[60:63], a[124:127], v[92:95]
    s_waitcnt lgkmcnt(4)
    v_mfma_f32_16x16x32_bf16 v[80:83], v[32:35], a[128:131], v[80:83]
    ds_read_b128 v[56:59], v20 offset:33792
    s_add_u32 m0, s29, 66432
    v_mfma_f32_16x16x32_bf16 v[84:87], v[32:35], a[132:135], v[84:87]
    buffer_load_dwordx4 v16, s[16:19], s34 offen offset:128 lds
    v_mfma_f32_16x16x32_bf16 v[88:91], v[36:39], a[128:131], v[88:91]
    ds_read_b128 v[60:63], v20 offset:50176
    v_mfma_f32_16x16x32_bf16 v[92:95], v[36:39], a[132:135], v[92:95]
    s_waitcnt lgkmcnt(4)
    v_mfma_f32_16x16x32_bf16 v[80:83], v[40:43], a[136:139], v[80:83]
    ds_read_b128 v[32:35], v19 offset:34816
    v_mfma_f32_16x16x32_bf16 v[84:87], v[40:43], a[140:143], v[84:87]
    v_mfma_f32_16x16x32_bf16 v[88:91], v[44:47], a[136:139], v[88:91]
    ds_read_b128 v[36:39], v19 offset:51200
    v_mfma_f32_16x16x32_bf16 v[92:95], v[44:47], a[140:143], v[92:95]
    s_waitcnt lgkmcnt(4)
    v_mfma_f32_16x16x32_bf16 v[80:83], v[48:51], a[144:147], v[80:83]
    ds_read_b128 v[40:43], v20 offset:34816
    s_add_u32 m0, s29, 67328
    v_mfma_f32_16x16x32_bf16 v[84:87], v[48:51], a[148:151], v[84:87]
    buffer_load_dwordx4 v16, s[16:19], s34 offen offset:256 lds
    v_mfma_f32_16x16x32_bf16 v[88:91], v[52:55], a[144:147], v[88:91]
    ds_read_b128 v[44:47], v20 offset:51200
    v_mfma_f32_16x16x32_bf16 v[92:95], v[52:55], a[148:151], v[92:95]
    s_waitcnt lgkmcnt(4)
    v_mfma_f32_16x16x32_bf16 v[80:83], v[56:59], a[152:155], v[80:83]
    ds_read_b128 v[48:51], v19 offset:35840
    v_mfma_f32_16x16x32_bf16 v[84:87], v[56:59], a[156:159], v[84:87]
    v_mfma_f32_16x16x32_bf16 v[88:91], v[60:63], a[152:155], v[88:91]
    ds_read_b128 v[52:55], v19 offset:52224
    v_mfma_f32_16x16x32_bf16 v[92:95], v[60:63], a[156:159], v[92:95]
    s_waitcnt lgkmcnt(4)
    v_mfma_f32_16x16x32_bf16 v[80:83], v[32:35], a[160:163], v[80:83]
    ds_read_b128 v[56:59], v20 offset:35840
    s_add_u32 m0, s29, 68224
    v_mfma_f32_16x16x32_bf16 v[84:87], v[32:35], a[164:167], v[84:87]
    buffer_load_dwordx4 v16, s[16:19], s34 offen offset:384 lds
    v_mfma_f32_16x16x32_bf16 v[88:91], v[36:39], a[160:163], v[88:91]
    ds_read_b128 v[60:63], v20 offset:52224
    v_mfma_f32_16x16x32_bf16 v[92:95], v[36:39], a[164:167], v[92:95]
    s_waitcnt lgkmcnt(4)
    v_mfma_f32_16x16x32_bf16 v[80:83], v[40:43], a[168:171], v[80:83]
    ds_read_b128 v[32:35], v19 offset:36864
    v_mfma_f32_16x16x32_bf16 v[84:87], v[40:43], a[172:175], v[84:87]
    v_mfma_f32_16x16x32_bf16 v[88:91], v[44:47], a[168:171], v[88:91]
    ds_read_b128 v[36:39], v19 offset:53248
    v_mfma_f32_16x16x32_bf16 v[92:95], v[44:47], a[172:175], v[92:95]
    s_waitcnt lgkmcnt(4)
    v_mfma_f32_16x16x32_bf16 v[80:83], v[48:51], a[176:179], v[80:83]
    ds_read_b128 v[40:43], v20 offset:36864
    s_add_u32 m0, s29, 69120
    v_mfma_f32_16x16x32_bf16 v[84:87], v[48:51], a[180:183], v[84:87]
    buffer_load_dwordx4 v16, s[16:19], s34 offen offset:512 lds
    v_mfma_f32_16x16x32_bf16 v[88:91], v[52:55], a[176:179], v[88:91]
    ds_read_b128 v[44:47], v20 offset:53248
    v_mfma_f32_16x16x32_bf16 v[92:95], v[52:55], a[180:183], v[92:95]
    s_waitcnt lgkmcnt(4)
    v_mfma_f32_16x16x32_bf16 v[80:83], v[56:59], a[184:187], v[80:83]
    ds_read_b128 v[48:51], v19 offset:37888
    v_mfma_f32_16x16x32_bf16 v[84:87], v[56:59], a[188:191], v[84:87]
    v_mfma_f32_16x16x32_bf16 v[88:91], v[60:63], a[184:187], v[88:91]
    ds_read_b128 v[52:55], v19 offset:54272
    v_mfma_f32_16x16x32_bf16 v[92:95], v[60:63], a[188:191], v[92:95]
    s_waitcnt lgkmcnt(4)
    v_mfma_f32_16x16x32_bf16 v[80:83], v[32:35], a[192:195], v[80:83]
    ds_read_b128 v[56:59], v20 offset:37888
    s_add_u32 m0, s29, 70016
    v_mfma_f32_16x16x32_bf16 v[84:87], v[32:35], a[196:199], v[84:87]
    buffer_load_dwordx4 v16, s[16:19], s34 offen offset:640 lds
    v_mfma_f32_16x16x32_bf16 v[88:91], v[36:39], a[192:195], v[88:91]
    ds_read_b128 v[60:63], v20 offset:54272
    v_mfma_f32_16x16x32_bf16 v[92:95], v[36:39], a[196:199], v[92:95]
    s_waitcnt lgkmcnt(4)
    v_mfma_f32_16x16x32_bf16 v[80:83], v[40:43], a[200:203], v[80:83]
    ds_read_b128 v[32:35], v19 offset:38912
    v_mfma_f32_16x16x32_bf16 v[84:87], v[40:43], a[204:207], v[84:87]
    v_mfma_f32_16x16x32_bf16 v[88:91], v[44:47], a[200:203], v[88:91]
    ds_read_b128 v[36:39], v19 offset:55296
    v_mfma_f32_16x16x32_bf16 v[92:95], v[44:47], a[204:207], v[92:95]
    s_waitcnt lgkmcnt(4)
    v_mfma_f32_16x16x32_bf16 v[80:83], v[48:51], a[208:211], v[80:83]
    ds_read_b128 v[40:43], v20 offset:38912
    s_add_u32 m0, s29, 70912
    v_mfma_f32_16x16x32_bf16 v[84:87], v[48:51], a[212:215], v[84:87]
    buffer_load_dwordx4 v16, s[16:19], s34 offen offset:768 lds
    v_mfma_f32_16x16x32_bf16 v[88:91], v[52:55], a[208:211], v[88:91]
    ds_read_b128 v[44:47], v20 offset:55296
    v_mfma_f32_16x16x32_bf16 v[92:95], v[52:55], a[212:215], v[92:95]
    s_waitcnt lgkmcnt(4)
    v_mfma_f32_16x16x32_bf16 v[80:83], v[56:59], a[216:219], v[80:83]
    ds_read_b128 v[48:51], v19 offset:39936
    v_mfma_f32_16x16x32_bf16 v[84:87], v[56:59], a[220:223], v[84:87]
    s_cmp_lt_u32 s35, 21
    s_cselect_b64 s[44:45], -1, 0
    v_mfma_f32_16x16x32_bf16 v[88:91], v[60:63], a[216:219], v[88:91]
    ds_read_b128 v[52:55], v19 offset:56320
    v_mfma_f32_16x16x32_bf16 v[92:95], v[60:63], a[220:223], v[92:95]
    s_cselect_b32 s4, 0x10000, 0
    s_add_u32 s46, s46, s4
    s_waitcnt lgkmcnt(4)
    v_mfma_f32_16x16x32_bf16 v[80:83], v[32:35], a[224:227], v[80:83]
    ds_read_b128 v[56:59], v20 offset:39936
    s_add_u32 m0, s29, 71808
    v_mfma_f32_16x16x32_bf16 v[84:87], v[32:35], a[228:231], v[84:87]
    buffer_load_dwordx4 v16, s[16:19], s34 offen offset:896 lds
    v_mfma_f32_16x16x32_bf16 v[88:91], v[36:39], a[224:227], v[88:91]
    ds_read_b128 v[60:63], v20 offset:56320
    v_mfma_f32_16x16x32_bf16 v[92:95], v[36:39], a[228:231], v[92:95]
    s_waitcnt lgkmcnt(4)
    v_mfma_f32_16x16x32_bf16 v[80:83], v[40:43], a[232:235], v[80:83]
    s_add_u32 s34, s34, 1024
    v_mfma_f32_16x16x32_bf16 v[84:87], v[40:43], a[236:239], v[84:87]
    v_mfma_f32_16x16x32_bf16 v[88:91], v[44:47], a[232:235], v[88:91]
    v_mfma_f32_16x16x32_bf16 v[92:95], v[44:47], a[236:239], v[92:95]
    s_waitcnt lgkmcnt(0)
    s_waitcnt vmcnt(10)
    s_barrier
    ds_read_b128 v[32:35], v17 offset:0
    ds_read_b128 v[36:39], v17 offset:16384
    v_mfma_f32_16x16x32_bf16 v[80:83], v[48:51], a[240:243], v[80:83]
    ds_read_b128 v[40:43], v18 offset:0
    s_add_u32 m0, s29, 98304
    v_mfma_f32_16x16x32_bf16 v[84:87], v[48:51], a[244:247], v[84:87]
    buffer_load_dwordx4 v16, s[16:19], s34 offen offset:0 lds
    v_mfma_f32_16x16x32_bf16 v[88:91], v[52:55], a[240:243], v[88:91]
    ds_read_b128 v[44:47], v18 offset:16384
    v_mfma_f32_16x16x32_bf16 v[92:95], v[52:55], a[244:247], v[92:95]
    v_mfma_f32_16x16x32_bf16 v[80:83], v[56:59], a[248:251], v[80:83]
    ds_read_b128 v[48:51], v17 offset:1024
    v_mfma_f32_16x16x32_bf16 v[84:87], v[56:59], a[252:255], v[84:87]
    v_mfma_f32_16x16x32_bf16 v[88:91], v[60:63], a[248:251], v[88:91]
    ds_read_b128 v[52:55], v17 offset:17408
    v_mfma_f32_16x16x32_bf16 v[92:95], v[60:63], a[252:255], v[92:95]
    s_mov_b64 exec, s[36:37]
    buffer_store_dword v23, v22, s[8:11], s33 offen sc1
    s_mov_b64 exec, -1

    s_add_u32 s35, s35, 1
    s_cmp_lt_u32 s35, 32
    s_cbranch_scc1 .ql_382

    s_nop 7
    v_cvt_pk_bf16_f32 v96, v80, v81
    v_cvt_pk_bf16_f32 v97, v82, v83
    v_cvt_pk_bf16_f32 v98, v88, v89
    v_cvt_pk_bf16_f32 v99, v90, v91
    buffer_store_dwordx4 v[96:99], v21, s[8:11], s32 offen offset:0 sc1
    v_cvt_pk_bf16_f32 v100, v84, v85
    v_cvt_pk_bf16_f32 v101, v86, v87
    v_cvt_pk_bf16_f32 v102, v92, v93
    v_cvt_pk_bf16_f32 v103, v94, v95
    buffer_store_dwordx4 v[100:103], v21, s[8:11], s32 offen offset:1024 sc1
    s_mov_b32 exec_hi, 0
    buffer_store_dwordx4 v[24:27], v21, s[8:11], s48 offen sc1
    s_mov_b32 exec_hi, -1

    v_mov_b32 v23, 64
    s_waitcnt vmcnt(0) lgkmcnt(0)
    s_barrier
    s_mov_b64 exec, s[36:37]
    buffer_store_dword v23, v22, s[8:11], s33 offen sc1
    s_mov_b64 exec, -1

.qd_379:
    s_load_dwordx2 s[40:41], s[0:1], 88
    s_load_dwordx2 s[42:43], s[0:1], 112
    s_and_b32 s4, s33, 0xffffe7ff
    s_mov_b32 s57, s4
    s_mov_b32 s34, s47
    s_and_b32 s30, s26, 7
    s_lshr_b32 s31, s26, 3
    s_lshl_b32 s28, s91, 21
    s_lshl_b32 s4, s30, 8
    s_add_u32 s28, s28, s4
    s_waitcnt lgkmcnt(0)

    s_mov_b32 s12, s40
    s_and_b32 s13, s41, 0xffff
    s_mov_b32 s14, 0x800000
    s_mov_b32 s15, 0x00020000

    s_mov_b32 s44, s42
    s_and_b32 s45, s43, 0xffff
    s_mov_b32 s46, 0x400000
    s_mov_b32 s47, 0x00020000

    v_lshrrev_b32 v4, 1, v2
    v_xor_b32 v4, v4, v3
    v_lshlrev_b32 v4, 1, v4
    v_and_b32 v5, 1, v1
    v_or_b32 v4, v4, v5
    v_lshlrev_b32 v4, 4, v4
    v_lshlrev_b32 v5, 11, v3
    v_add_u32 v10, v4, v5
    v_xor_b32 v11, 0x80, v10
    s_lshl_b32 s4, s24, 16
    s_add_u32 s28, s28, s4
    s_lshl_b32 s29, s24, 13
    v_lshrrev_b32 v4, 2, v2
    v_and_b32 v5, 1, v3
    v_lshl_or_b32 v5, v5, 2, v4
    s_lshl_b32 s4, s24, 1
    v_xor_b32 v5, s4, v5
    v_lshlrev_b32 v5, 5, v5
    v_lshl_add_u32 v4, v3, 2, v4
    v_lshl_add_u32 v5, v4, 8, v5
    v_and_b32 v4, 3, v2
    v_lshl_add_u32 v12, v4, 3, v5
    v_xor_b32 v13, 32, v12
    v_add_u32 v14, 0x10000, v12
    v_add_u32 v15, 0x10000, v13

    s_and_b32 s4, s91, 1
    s_lshl_b32 s4, s4, 5
    v_xor_b32 v12, s4, v12
    v_xor_b32 v13, s4, v13
    v_xor_b32 v14, s4, v14
    v_xor_b32 v15, s4, v15

    s_and_b32 s4, s26, 7
    s_lshl_b32 s4, s4, 1
    s_lshr_b32 s5, s24, 1
    s_add_u32 s4, s4, s5
    s_lshl_b32 s4, s4, 6
    v_add_u32 v4, s4, v1
    v_lshlrev_b32 v4, 11, v4
    s_and_b32 s4, s24, 1
    s_lshl_b32 s4, s4, 10
    s_lshl_b32 s5, s91, 21
    s_add_u32 s4, s4, s5
    buffer_load_dword v31, v4, s[12:15], s4 offen offset:384

    s_add_u32 m0, s29, 0
    s_add_u32 s4, s28, 0
    buffer_load_dwordx4 v10, s[12:15], s4 offen lds

    s_add_u32 m0, s29, 1024
    s_add_u32 s4, s28, 8192
    buffer_load_dwordx4 v11, s[12:15], s4 offen lds

    s_add_u32 m0, s29, 2048
    s_add_u32 s4, s28, 16384
    buffer_load_dwordx4 v10, s[12:15], s4 offen lds

    s_add_u32 m0, s29, 3072
    s_add_u32 s4, s28, 24576
    buffer_load_dwordx4 v11, s[12:15], s4 offen lds

    s_add_u32 m0, s29, 4096
    s_add_u32 s4, s28, 32768
    buffer_load_dwordx4 v10, s[12:15], s4 offen lds

    s_add_u32 m0, s29, 5120
    s_add_u32 s4, s28, 40960
    buffer_load_dwordx4 v11, s[12:15], s4 offen lds

    s_add_u32 m0, s29, 6144
    s_add_u32 s4, s28, 49152
    buffer_load_dwordx4 v10, s[12:15], s4 offen lds

    s_add_u32 m0, s29, 7168
    s_add_u32 s4, s28, 57344
    buffer_load_dwordx4 v11, s[12:15], s4 offen lds

    s_add_u32 m0, s29, 32768
    s_add_u32 s4, s28, 262144
    buffer_load_dwordx4 v10, s[12:15], s4 offen lds

    s_add_u32 m0, s29, 33792
    s_add_u32 s4, s28, 270336
    buffer_load_dwordx4 v11, s[12:15], s4 offen lds

    s_add_u32 m0, s29, 34816
    s_add_u32 s4, s28, 278528
    buffer_load_dwordx4 v10, s[12:15], s4 offen lds

    s_add_u32 m0, s29, 35840
    s_add_u32 s4, s28, 286720
    buffer_load_dwordx4 v11, s[12:15], s4 offen lds

    s_add_u32 m0, s29, 36864
    s_add_u32 s4, s28, 294912
    buffer_load_dwordx4 v10, s[12:15], s4 offen lds

    s_add_u32 m0, s29, 37888
    s_add_u32 s4, s28, 303104
    buffer_load_dwordx4 v11, s[12:15], s4 offen lds

    s_add_u32 m0, s29, 38912
    s_add_u32 s4, s28, 311296
    buffer_load_dwordx4 v10, s[12:15], s4 offen lds

    s_add_u32 m0, s29, 39936
    s_add_u32 s4, s28, 319488
    buffer_load_dwordx4 v11, s[12:15], s4 offen lds

    s_add_u32 m0, s29, 65536
    s_add_u32 s4, s28, 524288
    buffer_load_dwordx4 v10, s[12:15], s4 offen lds

    s_add_u32 m0, s29, 66560
    s_add_u32 s4, s28, 532480
    buffer_load_dwordx4 v11, s[12:15], s4 offen lds

    s_add_u32 m0, s29, 67584
    s_add_u32 s4, s28, 540672
    buffer_load_dwordx4 v10, s[12:15], s4 offen lds

    s_add_u32 m0, s29, 68608
    s_add_u32 s4, s28, 548864
    buffer_load_dwordx4 v11, s[12:15], s4 offen lds

    s_add_u32 m0, s29, 69632
    s_add_u32 s4, s28, 557056
    buffer_load_dwordx4 v10, s[12:15], s4 offen lds

    s_add_u32 m0, s29, 70656
    s_add_u32 s4, s28, 565248
    buffer_load_dwordx4 v11, s[12:15], s4 offen lds

    s_add_u32 m0, s29, 71680
    s_add_u32 s4, s28, 573440
    buffer_load_dwordx4 v10, s[12:15], s4 offen lds

    s_add_u32 m0, s29, 72704
    s_add_u32 s4, s28, 581632
    buffer_load_dwordx4 v11, s[12:15], s4 offen lds

    s_add_u32 m0, s29, 98304
    s_add_u32 s4, s28, 786432
    buffer_load_dwordx4 v10, s[12:15], s4 offen lds

    s_add_u32 m0, s29, 99328
    s_add_u32 s4, s28, 794624
    buffer_load_dwordx4 v11, s[12:15], s4 offen lds

    s_add_u32 m0, s29, 100352
    s_add_u32 s4, s28, 802816
    buffer_load_dwordx4 v10, s[12:15], s4 offen lds

    s_add_u32 m0, s29, 101376
    s_add_u32 s4, s28, 811008
    buffer_load_dwordx4 v11, s[12:15], s4 offen lds

    s_add_u32 m0, s29, 102400
    s_add_u32 s4, s28, 819200
    buffer_load_dwordx4 v10, s[12:15], s4 offen lds

    s_add_u32 m0, s29, 103424
    s_add_u32 s4, s28, 827392
    buffer_load_dwordx4 v11, s[12:15], s4 offen lds

    s_add_u32 m0, s29, 104448
    s_add_u32 s4, s28, 835584
    buffer_load_dwordx4 v10, s[12:15], s4 offen lds

    s_add_u32 m0, s29, 105472
    s_add_u32 s4, s28, 843776
    buffer_load_dwordx4 v11, s[12:15], s4 offen lds

    s_waitcnt vmcnt(24)
    s_barrier
    ds_read_b64_tr_b16 a[0:1], v12 offset:0
    ds_read_b64_tr_b16 a[2:3], v12 offset:4096
    ds_read_b64_tr_b16 a[4:5], v13 offset:0
    ds_read_b64_tr_b16 a[6:7], v13 offset:4096
    ds_read_b64_tr_b16 a[8:9], v12 offset:8192
    ds_read_b64_tr_b16 a[10:11], v12 offset:12288
    ds_read_b64_tr_b16 a[12:13], v13 offset:8192
    ds_read_b64_tr_b16 a[14:15], v13 offset:12288
    ds_read_b64_tr_b16 a[16:17], v12 offset:16384
    ds_read_b64_tr_b16 a[18:19], v12 offset:20480
    ds_read_b64_tr_b16 a[20:21], v13 offset:16384
    ds_read_b64_tr_b16 a[22:23], v13 offset:20480
    ds_read_b64_tr_b16 a[24:25], v12 offset:24576
    ds_read_b64_tr_b16 a[26:27], v12 offset:28672
    ds_read_b64_tr_b16 a[28:29], v13 offset:24576
    ds_read_b64_tr_b16 a[30:31], v13 offset:28672
    s_waitcnt lgkmcnt(0)
    s_barrier
    s_add_u32 m0, s29, 0
    s_add_u32 s4, s28, 1048576
    buffer_load_dwordx4 v10, s[12:15], s4 offen lds

    s_add_u32 m0, s29, 1024
    s_add_u32 s4, s28, 1056768
    buffer_load_dwordx4 v11, s[12:15], s4 offen lds

    s_add_u32 m0, s29, 2048
    s_add_u32 s4, s28, 1064960
    buffer_load_dwordx4 v10, s[12:15], s4 offen lds

    s_add_u32 m0, s29, 3072
    s_add_u32 s4, s28, 1073152
    buffer_load_dwordx4 v11, s[12:15], s4 offen lds

    s_add_u32 m0, s29, 4096
    s_add_u32 s4, s28, 1081344
    buffer_load_dwordx4 v10, s[12:15], s4 offen lds

    s_add_u32 m0, s29, 5120
    s_add_u32 s4, s28, 1089536
    buffer_load_dwordx4 v11, s[12:15], s4 offen lds

    s_add_u32 m0, s29, 6144
    s_add_u32 s4, s28, 1097728
    buffer_load_dwordx4 v10, s[12:15], s4 offen lds

    s_add_u32 m0, s29, 7168
    s_add_u32 s4, s28, 1105920
    buffer_load_dwordx4 v11, s[12:15], s4 offen lds

    s_waitcnt vmcnt(24)
    s_barrier
    ds_read_b64_tr_b16 a[32:33], v12 offset:32768
    ds_read_b64_tr_b16 a[34:35], v12 offset:36864
    ds_read_b64_tr_b16 a[36:37], v13 offset:32768
    ds_read_b64_tr_b16 a[38:39], v13 offset:36864
    ds_read_b64_tr_b16 a[40:41], v12 offset:40960
    ds_read_b64_tr_b16 a[42:43], v12 offset:45056
    ds_read_b64_tr_b16 a[44:45], v13 offset:40960
    ds_read_b64_tr_b16 a[46:47], v13 offset:45056
    ds_read_b64_tr_b16 a[48:49], v12 offset:49152
    ds_read_b64_tr_b16 a[50:51], v12 offset:53248
    ds_read_b64_tr_b16 a[52:53], v13 offset:49152
    ds_read_b64_tr_b16 a[54:55], v13 offset:53248
    ds_read_b64_tr_b16 a[56:57], v12 offset:57344
    ds_read_b64_tr_b16 a[58:59], v12 offset:61440
    ds_read_b64_tr_b16 a[60:61], v13 offset:57344
    ds_read_b64_tr_b16 a[62:63], v13 offset:61440
    s_waitcnt lgkmcnt(0)
    s_barrier
    s_add_u32 m0, s29, 32768
    s_add_u32 s4, s28, 1310720
    buffer_load_dwordx4 v10, s[12:15], s4 offen lds

    s_add_u32 m0, s29, 33792
    s_add_u32 s4, s28, 1318912
    buffer_load_dwordx4 v11, s[12:15], s4 offen lds

    s_add_u32 m0, s29, 34816
    s_add_u32 s4, s28, 1327104
    buffer_load_dwordx4 v10, s[12:15], s4 offen lds

    s_add_u32 m0, s29, 35840
    s_add_u32 s4, s28, 1335296
    buffer_load_dwordx4 v11, s[12:15], s4 offen lds

    s_add_u32 m0, s29, 36864
    s_add_u32 s4, s28, 1343488
    buffer_load_dwordx4 v10, s[12:15], s4 offen lds

    s_add_u32 m0, s29, 37888
    s_add_u32 s4, s28, 1351680
    buffer_load_dwordx4 v11, s[12:15], s4 offen lds

    s_add_u32 m0, s29, 38912
    s_add_u32 s4, s28, 1359872
    buffer_load_dwordx4 v10, s[12:15], s4 offen lds

    s_add_u32 m0, s29, 39936
    s_add_u32 s4, s28, 1368064
    buffer_load_dwordx4 v11, s[12:15], s4 offen lds

    s_waitcnt vmcnt(24)
    s_barrier
    ds_read_b64_tr_b16 a[64:65], v14 offset:0
    ds_read_b64_tr_b16 a[66:67], v14 offset:4096
    ds_read_b64_tr_b16 a[68:69], v15 offset:0
    ds_read_b64_tr_b16 a[70:71], v15 offset:4096
    ds_read_b64_tr_b16 a[72:73], v14 offset:8192
    ds_read_b64_tr_b16 a[74:75], v14 offset:12288
    ds_read_b64_tr_b16 a[76:77], v15 offset:8192
    ds_read_b64_tr_b16 a[78:79], v15 offset:12288
    ds_read_b64_tr_b16 a[80:81], v14 offset:16384
    ds_read_b64_tr_b16 a[82:83], v14 offset:20480
    ds_read_b64_tr_b16 a[84:85], v15 offset:16384
    ds_read_b64_tr_b16 a[86:87], v15 offset:20480
    ds_read_b64_tr_b16 a[88:89], v14 offset:24576
    ds_read_b64_tr_b16 a[90:91], v14 offset:28672
    ds_read_b64_tr_b16 a[92:93], v15 offset:24576
    ds_read_b64_tr_b16 a[94:95], v15 offset:28672
    s_waitcnt lgkmcnt(0)
    s_barrier
    s_add_u32 m0, s29, 65536
    s_add_u32 s4, s28, 1572864
    buffer_load_dwordx4 v10, s[12:15], s4 offen lds

    s_add_u32 m0, s29, 66560
    s_add_u32 s4, s28, 1581056
    buffer_load_dwordx4 v11, s[12:15], s4 offen lds

    s_add_u32 m0, s29, 67584
    s_add_u32 s4, s28, 1589248
    buffer_load_dwordx4 v10, s[12:15], s4 offen lds

    s_add_u32 m0, s29, 68608
    s_add_u32 s4, s28, 1597440
    buffer_load_dwordx4 v11, s[12:15], s4 offen lds

    s_add_u32 m0, s29, 69632
    s_add_u32 s4, s28, 1605632
    buffer_load_dwordx4 v10, s[12:15], s4 offen lds

    s_add_u32 m0, s29, 70656
    s_add_u32 s4, s28, 1613824
    buffer_load_dwordx4 v11, s[12:15], s4 offen lds

    s_add_u32 m0, s29, 71680
    s_add_u32 s4, s28, 1622016
    buffer_load_dwordx4 v10, s[12:15], s4 offen lds

    s_add_u32 m0, s29, 72704
    s_add_u32 s4, s28, 1630208
    buffer_load_dwordx4 v11, s[12:15], s4 offen lds

    s_waitcnt vmcnt(24)
    s_barrier
    ds_read_b64_tr_b16 a[96:97], v14 offset:32768
    ds_read_b64_tr_b16 a[98:99], v14 offset:36864
    ds_read_b64_tr_b16 a[100:101], v15 offset:32768
    ds_read_b64_tr_b16 a[102:103], v15 offset:36864
    ds_read_b64_tr_b16 a[104:105], v14 offset:40960
    ds_read_b64_tr_b16 a[106:107], v14 offset:45056
    ds_read_b64_tr_b16 a[108:109], v15 offset:40960
    ds_read_b64_tr_b16 a[110:111], v15 offset:45056
    ds_read_b64_tr_b16 a[112:113], v14 offset:49152
    ds_read_b64_tr_b16 a[114:115], v14 offset:53248
    ds_read_b64_tr_b16 a[116:117], v15 offset:49152
    ds_read_b64_tr_b16 a[118:119], v15 offset:53248
    ds_read_b64_tr_b16 a[120:121], v14 offset:57344
    ds_read_b64_tr_b16 a[122:123], v14 offset:61440
    ds_read_b64_tr_b16 a[124:125], v15 offset:57344
    ds_read_b64_tr_b16 a[126:127], v15 offset:61440
    s_waitcnt lgkmcnt(0)
    s_barrier
    s_add_u32 m0, s29, 98304
    s_add_u32 s4, s28, 1835008
    buffer_load_dwordx4 v10, s[12:15], s4 offen lds

    s_add_u32 m0, s29, 99328
    s_add_u32 s4, s28, 1843200
    buffer_load_dwordx4 v11, s[12:15], s4 offen lds

    s_add_u32 m0, s29, 100352
    s_add_u32 s4, s28, 1851392
    buffer_load_dwordx4 v10, s[12:15], s4 offen lds

    s_add_u32 m0, s29, 101376
    s_add_u32 s4, s28, 1859584
    buffer_load_dwordx4 v11, s[12:15], s4 offen lds

    s_add_u32 m0, s29, 102400
    s_add_u32 s4, s28, 1867776
    buffer_load_dwordx4 v10, s[12:15], s4 offen lds

    s_add_u32 m0, s29, 103424
    s_add_u32 s4, s28, 1875968
    buffer_load_dwordx4 v11, s[12:15], s4 offen lds

    s_add_u32 m0, s29, 104448
    s_add_u32 s4, s28, 1884160
    buffer_load_dwordx4 v10, s[12:15], s4 offen lds

    s_add_u32 m0, s29, 105472
    s_add_u32 s4, s28, 1892352
    buffer_load_dwordx4 v11, s[12:15], s4 offen lds

    s_waitcnt vmcnt(24)
    s_barrier
    ds_read_b64_tr_b16 a[128:129], v12 offset:0
    ds_read_b64_tr_b16 a[130:131], v12 offset:4096
    ds_read_b64_tr_b16 a[132:133], v13 offset:0
    ds_read_b64_tr_b16 a[134:135], v13 offset:4096
    ds_read_b64_tr_b16 a[136:137], v12 offset:8192
    ds_read_b64_tr_b16 a[138:139], v12 offset:12288
    ds_read_b64_tr_b16 a[140:141], v13 offset:8192
    ds_read_b64_tr_b16 a[142:143], v13 offset:12288
    ds_read_b64_tr_b16 a[144:145], v12 offset:16384
    ds_read_b64_tr_b16 a[146:147], v12 offset:20480
    ds_read_b64_tr_b16 a[148:149], v13 offset:16384
    ds_read_b64_tr_b16 a[150:151], v13 offset:20480
    ds_read_b64_tr_b16 a[152:153], v12 offset:24576
    ds_read_b64_tr_b16 a[154:155], v12 offset:28672
    ds_read_b64_tr_b16 a[156:157], v13 offset:24576
    ds_read_b64_tr_b16 a[158:159], v13 offset:28672
    s_waitcnt lgkmcnt(0)
    s_barrier
    s_waitcnt vmcnt(16)
    s_barrier
    ds_read_b64_tr_b16 a[160:161], v12 offset:32768
    ds_read_b64_tr_b16 a[162:163], v12 offset:36864
    ds_read_b64_tr_b16 a[164:165], v13 offset:32768
    ds_read_b64_tr_b16 a[166:167], v13 offset:36864
    ds_read_b64_tr_b16 a[168:169], v12 offset:40960
    ds_read_b64_tr_b16 a[170:171], v12 offset:45056
    ds_read_b64_tr_b16 a[172:173], v13 offset:40960
    ds_read_b64_tr_b16 a[174:175], v13 offset:45056
    ds_read_b64_tr_b16 a[176:177], v12 offset:49152
    ds_read_b64_tr_b16 a[178:179], v12 offset:53248
    ds_read_b64_tr_b16 a[180:181], v13 offset:49152
    ds_read_b64_tr_b16 a[182:183], v13 offset:53248
    ds_read_b64_tr_b16 a[184:185], v12 offset:57344
    ds_read_b64_tr_b16 a[186:187], v12 offset:61440
    ds_read_b64_tr_b16 a[188:189], v13 offset:57344
    ds_read_b64_tr_b16 a[190:191], v13 offset:61440
    s_waitcnt lgkmcnt(0)
    s_barrier
    s_waitcnt vmcnt(8)
    s_barrier
    ds_read_b64_tr_b16 a[192:193], v14 offset:0
    ds_read_b64_tr_b16 a[194:195], v14 offset:4096
    ds_read_b64_tr_b16 a[196:197], v15 offset:0
    ds_read_b64_tr_b16 a[198:199], v15 offset:4096
    ds_read_b64_tr_b16 a[200:201], v14 offset:8192
    ds_read_b64_tr_b16 a[202:203], v14 offset:12288
    ds_read_b64_tr_b16 a[204:205], v15 offset:8192
    ds_read_b64_tr_b16 a[206:207], v15 offset:12288
    ds_read_b64_tr_b16 a[208:209], v14 offset:16384
    ds_read_b64_tr_b16 a[210:211], v14 offset:20480
    ds_read_b64_tr_b16 a[212:213], v15 offset:16384
    ds_read_b64_tr_b16 a[214:215], v15 offset:20480
    ds_read_b64_tr_b16 a[216:217], v14 offset:24576
    ds_read_b64_tr_b16 a[218:219], v14 offset:28672
    ds_read_b64_tr_b16 a[220:221], v15 offset:24576
    ds_read_b64_tr_b16 a[222:223], v15 offset:28672
    s_waitcnt lgkmcnt(0)
    s_barrier
    s_waitcnt vmcnt(0)
    s_barrier
    ds_read_b64_tr_b16 a[224:225], v14 offset:32768
    ds_read_b64_tr_b16 a[226:227], v14 offset:36864
    ds_read_b64_tr_b16 a[228:229], v15 offset:32768
    ds_read_b64_tr_b16 a[230:231], v15 offset:36864
    ds_read_b64_tr_b16 a[232:233], v14 offset:40960
    ds_read_b64_tr_b16 a[234:235], v14 offset:45056
    ds_read_b64_tr_b16 a[236:237], v15 offset:40960
    ds_read_b64_tr_b16 a[238:239], v15 offset:45056
    ds_read_b64_tr_b16 a[240:241], v14 offset:49152
    ds_read_b64_tr_b16 a[242:243], v14 offset:53248
    ds_read_b64_tr_b16 a[244:245], v15 offset:49152
    ds_read_b64_tr_b16 a[246:247], v15 offset:53248
    ds_read_b64_tr_b16 a[248:249], v14 offset:57344
    ds_read_b64_tr_b16 a[250:251], v14 offset:61440
    ds_read_b64_tr_b16 a[252:253], v15 offset:57344
    ds_read_b64_tr_b16 a[254:255], v15 offset:61440
    s_waitcnt lgkmcnt(0)
    s_barrier
    v_lshlrev_b32 v21, 4, v1
    s_lshr_b32 s4, s91, 1
    s_lshl_b32 s5, s4, 12
    v_add_u32 v17, s5, v21
    v_xor_b32 v18, 0x1000, v17
    s_lshl_b32 s4, s4, 4
    v_add_u32 v4, s4, v2
    s_lshl_b32 s5, s30, 5
    s_lshl_b32 s6, s24, 3
    s_add_u32 s5, s5, s6
    s_and_b32 s6, s91, 1
    s_lshl_b32 s6, s6, 2
    s_add_u32 s5, s5, s6
    v_add_u32 v5, s5, v3
    v_lshlrev_b32 v6, 3, v5
    v_lshl_add_u32 v22, v4, 11, v6
    v_lshlrev_b32 v6, 14, v5
    v_lshl_add_u32 v23, v4, 2, v6
    v_lshlrev_b32 v16, 2, v4
    v_bfe_u32 v4, v1, 2, 3
    v_lshlrev_b32 v19, 8, v4
    v_and_b32 v4, 3, v1
    v_lshl_add_u32 v19, v4, 2, v19
    s_lshl_b32 s33, s91, 11
    s_add_u32 s33, s33, 92299264
    s_lshl_b32 s35, s24, 14
    s_lshl_b32 s36, s91, 16
    s_add_u32 s36, s36, s35
    s_add_u32 s36, s36, 50331648
    s_mov_b32 s37, 0
    s_lshl_b32 s4, s91, 3
    s_add_u32 s4, s4, s30
    s_lshl_b32 s4, s4, 2
    s_add_u32 s4, s4, s24
    s_lshl_b32 s4, s4, 11
    s_add_u32 s4, s4, 50331648
    v_lshlrev_b32 v111, 5, v1
    v_add_u32 v111, s4, v111
    s_mov_b32 s52, 0
    s_mov_b32 s39, 0
    v_lshlrev_b32 v6, 11, v1

    s_mov_b32 s62, 0
    s_mov_b64 exec, 15
.wf_384:
    buffer_load_dword v4, v6, s[8:11], s57 offen sc1
    s_waitcnt vmcnt(0)
    v_cmp_gt_u32 vcc, 64, v4
    s_cbranch_vccz .wfd_385
    s_sleep 2
    s_add_u32 s62, s62, 1
    s_cmp_gt_u32 s62, 0x400000
    s_cbranch_scc1 .mg_end_1
    s_branch .wf_384

.wfd_385:
    s_mov_b64 exec, -1
    v_mov_b32 v5, 0
    s_mov_b32 s62, 0
    s_mov_b32 s5, 160
.wc_386:
    buffer_load_dword v4, v5, s[20:23], s5 offen sc1
    s_waitcnt vmcnt(0)
    v_readfirstlane_b32 s4, v4
    s_lshr_b32 s4, s4, 0
    s_and_b32 s4, s4, 0xffff
    s_cmp_ge_u32 s4, 32
    s_cbranch_scc1 .wcd_387
    s_sleep 6
    s_add_u32 s62, s62, 1
    s_cmp_gt_u32 s62, 0x400000
    s_cbranch_scc1 .mg_end_1
    s_branch .wc_386

.wcd_387:
.g2blk_388:
    s_mov_b32 s62, 0
    s_mov_b64 s[64:65], 0
    s_mov_b32 s38, 0
.g2bw_396:
    buffer_load_dword v20, v19, s[8:11], s33 offen sc1
    s_waitcnt vmcnt(0)
    s_lshr_b32 s6, s31, 2
    s_and_b32 s4, s31, 3
    v_cmp_ge_u32 vcc, s6, v20
    s_lshl_b32 s4, s4, 3
    s_lshr_b32 s5, vcc_lo, s4
    s_and_b32 s5, s5, 0xff
    s_cmp_eq_u32 s5, 0

    s_cbranch_scc1 .g2rd_397
    s_sleep 1
    s_add_u32 s62, s62, 1
    s_cmp_gt_u32 s62, 0x400000
    s_cbranch_scc1 .mg_end_1
    s_branch .g2bw_396

.g2rd_397:
    s_lshl_b32 s48, s31, 18
    s_add_u32 s48, s48, s36
    s_add_u32 s49, s39, s35
    s_xor_b32 s39, s39, 0x10000

    s_add_u32 m0, s49, 0
    s_add_u32 s50, s48, 0
    buffer_load_dwordx4 v21, s[8:11], s50 offen offset:0 lds
    buffer_load_dwordx4 v21, s[8:11], s50 offen offset:1024 lds
    buffer_load_dwordx4 v21, s[8:11], s50 offen offset:2048 lds
    buffer_load_dwordx4 v21, s[8:11], s50 offen offset:3072 lds
    s_add_u32 m0, s49, 4096
    s_add_u32 s50, s48, 4096
    buffer_load_dwordx4 v21, s[8:11], s50 offen offset:0 lds
    buffer_load_dwordx4 v21, s[8:11], s50 offen offset:1024 lds
    buffer_load_dwordx4 v21, s[8:11], s50 offen offset:2048 lds
    buffer_load_dwordx4 v21, s[8:11], s50 offen offset:3072 lds
    s_add_u32 m0, s49, 8192
    s_add_u32 s50, s48, 8192
    buffer_load_dwordx4 v21, s[8:11], s50 offen offset:0 lds
    buffer_load_dwordx4 v21, s[8:11], s50 offen offset:1024 lds
    buffer_load_dwordx4 v21, s[8:11], s50 offen offset:2048 lds
    buffer_load_dwordx4 v21, s[8:11], s50 offen offset:3072 lds
    s_add_u32 m0, s49, 12288
    s_add_u32 s50, s48, 12288
    buffer_load_dwordx4 v21, s[8:11], s50 offen offset:0 lds
    buffer_load_dwordx4 v21, s[8:11], s50 offen offset:1024 lds
    buffer_load_dwordx4 v21, s[8:11], s50 offen offset:2048 lds
    buffer_load_dwordx4 v21, s[8:11], s50 offen offset:3072 lds
    s_waitcnt vmcnt(0)
.g2go_389:
    s_barrier
    ds_read_b128 v[32:35], v17 offset:0
    ds_read_b128 v[36:39], v18 offset:0
    ds_read_b128 v[40:43], v17 offset:1024
    ds_read_b128 v[44:47], v18 offset:1024
    ds_read_b128 v[48:51], v17 offset:2048
    ds_read_b128 v[52:55], v18 offset:2048
    s_add_u32 s53, s31, 3
    s_sub_u32 s54, s31, 3
    s_max_i32 s54, s54, 0
    s_sub_u32 s55, s37, 0x10000
    s_add_u32 s61, s31, 6
    s_lshr_b32 s6, s53, 2
    s_and_b32 s4, s53, 3
    v_cmp_ge_u32 vcc, s6, v20
    s_lshl_b32 s4, s4, 3
    s_lshr_b32 s5, vcc_lo, s4
    s_and_b32 s5, s5, 0xff
    s_cmp_eq_u32 s5, 0

    s_cselect_b32 s56, 1, 0
    s_cmp_lt_u32 s53, 64
    s_cselect_b32 s56, s56, 0
    s_cmp_eq_u32 s56, 0
    s_cbranch_scc1 .g2nd_392
    s_lshr_b32 s6, s61, 2
    s_and_b32 s4, s61, 3
    v_cmp_ge_u32 vcc, s6, v20
    s_lshl_b32 s4, s4, 3
    s_lshr_b32 s5, vcc_lo, s4
    s_and_b32 s5, s5, 0xff
    s_cmp_eq_u32 s5, 0

    s_cbranch_scc1 .g2nf_391
    buffer_load_dword v20, v19, s[8:11], s33 offen sc1
    s_branch .g2pd_398
.g2nf_391:
    s_lshl_b32 s4, s61, 18
    buffer_load_dword v31, v111, s[8:11], s4 offen
.g2pd_398:
    s_lshl_b32 s48, s53, 18
    s_add_u32 s48, s48, s36
    s_add_u32 s49, s39, s35
    s_xor_b32 s39, s39, 0x10000

    s_waitcnt lgkmcnt(4)
    v_mfma_f32_16x16x32_bf16 v[64:67], a[0:3], v[32:35], 0
    ds_read_b128 v[56:59], v17 offset:3072
    s_add_u32 m0, s49, 0
    s_add_u32 s50, s48, 0
    v_mfma_f32_16x16x32_bf16 v[68:71], a[4:7], v[32:35], 0
    buffer_load_dwordx4 v21, s[8:11], s50 offen offset:0 lds
    v_mfma_f32_16x16x32_bf16 v[72:75], a[0:3], v[36:39], 0
    ds_read_b128 v[60:63], v18 offset:3072
    v_mfma_f32_16x16x32_bf16 v[76:79], a[4:7], v[36:39], 0
    s_waitcnt lgkmcnt(4)
    v_mfma_f32_16x16x32_bf16 v[64:67], a[8:11], v[40:43], v[64:67]
    ds_read_b128 v[32:35], v17 offset:8192
    v_mfma_f32_16x16x32_bf16 v[68:71], a[12:15], v[40:43], v[68:71]
    v_mfma_f32_16x16x32_bf16 v[72:75], a[8:11], v[44:47], v[72:75]
    ds_read_b128 v[36:39], v18 offset:8192
    v_mfma_f32_16x16x32_bf16 v[76:79], a[12:15], v[44:47], v[76:79]
    buffer_load_dwordx4 v21, s[8:11], s50 offen offset:1024 lds
    s_waitcnt lgkmcnt(4)
    v_mfma_f32_16x16x32_bf16 v[64:67], a[16:19], v[48:51], v[64:67]
    ds_read_b128 v[40:43], v17 offset:9216
    v_mfma_f32_16x16x32_bf16 v[68:71], a[20:23], v[48:51], v[68:71]
    v_mfma_f32_16x16x32_bf16 v[72:75], a[16:19], v[52:55], v[72:75]
    ds_read_b128 v[44:47], v18 offset:9216
    v_mfma_f32_16x16x32_bf16 v[76:79], a[20:23], v[52:55], v[76:79]
    s_waitcnt lgkmcnt(4)
    v_mfma_f32_16x16x32_bf16 v[64:67], a[24:27], v[56:59], v[64:67]
    ds_read_b128 v[48:51], v17 offset:10240
    v_mfma_f32_16x16x32_bf16 v[68:71], a[28:31], v[56:59], v[68:71]
    buffer_load_dwordx4 v21, s[8:11], s50 offen offset:2048 lds
    v_mfma_f32_16x16x32_bf16 v[72:75], a[24:27], v[60:63], v[72:75]
    ds_read_b128 v[52:55], v18 offset:10240
    v_mfma_f32_16x16x32_bf16 v[76:79], a[28:31], v[60:63], v[76:79]
    s_waitcnt lgkmcnt(4)
    v_mfma_f32_16x16x32_bf16 v[64:67], a[32:35], v[32:35], v[64:67]
    ds_read_b128 v[56:59], v17 offset:11264
    v_mfma_f32_16x16x32_bf16 v[68:71], a[36:39], v[32:35], v[68:71]
    v_mfma_f32_16x16x32_bf16 v[72:75], a[32:35], v[36:39], v[72:75]
    ds_read_b128 v[60:63], v18 offset:11264
    v_mfma_f32_16x16x32_bf16 v[76:79], a[36:39], v[36:39], v[76:79]
    buffer_load_dwordx4 v21, s[8:11], s50 offen offset:3072 lds
    s_waitcnt lgkmcnt(4)
    v_mfma_f32_16x16x32_bf16 v[64:67], a[40:43], v[40:43], v[64:67]
    ds_read_b128 v[32:35], v17 offset:16384
    v_mfma_f32_16x16x32_bf16 v[68:71], a[44:47], v[40:43], v[68:71]
    v_mfma_f32_16x16x32_bf16 v[72:75], a[40:43], v[44:47], v[72:75]
    ds_read_b128 v[36:39], v18 offset:16384
    v_mfma_f32_16x16x32_bf16 v[76:79], a[44:47], v[44:47], v[76:79]
    s_waitcnt lgkmcnt(4)
    v_mfma_f32_16x16x32_bf16 v[64:67], a[48:51], v[48:51], v[64:67]
    ds_read_b128 v[40:43], v17 offset:17408
    s_add_u32 m0, s49, 4096
    s_add_u32 s50, s48, 4096
    v_mfma_f32_16x16x32_bf16 v[68:71], a[52:55], v[48:51], v[68:71]
    buffer_load_dwordx4 v21, s[8:11], s50 offen offset:0 lds
    v_mfma_f32_16x16x32_bf16 v[72:75], a[48:51], v[52:55], v[72:75]
    ds_read_b128 v[44:47], v18 offset:17408
    v_mfma_f32_16x16x32_bf16 v[76:79], a[52:55], v[52:55], v[76:79]
    s_waitcnt lgkmcnt(4)
    v_mfma_f32_16x16x32_bf16 v[64:67], a[56:59], v[56:59], v[64:67]
    ds_read_b128 v[48:51], v17 offset:18432
    v_mfma_f32_16x16x32_bf16 v[68:71], a[60:63], v[56:59], v[68:71]
    v_mfma_f32_16x16x32_bf16 v[72:75], a[56:59], v[60:63], v[72:75]
    ds_read_b128 v[52:55], v18 offset:18432
    v_mfma_f32_16x16x32_bf16 v[76:79], a[60:63], v[60:63], v[76:79]
    buffer_load_dwordx4 v21, s[8:11], s50 offen offset:1024 lds
    s_waitcnt lgkmcnt(4)
    v_mfma_f32_16x16x32_bf16 v[64:67], a[64:67], v[32:35], v[64:67]
    ds_read_b128 v[56:59], v17 offset:19456
    v_mfma_f32_16x16x32_bf16 v[68:71], a[68:71], v[32:35], v[68:71]
    v_mfma_f32_16x16x32_bf16 v[72:75], a[64:67], v[36:39], v[72:75]
    ds_read_b128 v[60:63], v18 offset:19456
    v_mfma_f32_16x16x32_bf16 v[76:79], a[68:71], v[36:39], v[76:79]
    s_waitcnt lgkmcnt(4)
    v_mfma_f32_16x16x32_bf16 v[64:67], a[72:75], v[40:43], v[64:67]
    ds_read_b128 v[32:35], v17 offset:24576
    v_mfma_f32_16x16x32_bf16 v[68:71], a[76:79], v[40:43], v[68:71]
    buffer_load_dwordx4 v21, s[8:11], s50 offen offset:2048 lds
    v_mfma_f32_16x16x32_bf16 v[72:75], a[72:75], v[44:47], v[72:75]
    ds_read_b128 v[36:39], v18 offset:24576
    v_mfma_f32_16x16x32_bf16 v[76:79], a[76:79], v[44:47], v[76:79]
    s_waitcnt lgkmcnt(4)
    v_mfma_f32_16x16x32_bf16 v[64:67], a[80:83], v[48:51], v[64:67]
    ds_read_b128 v[40:43], v17 offset:25600
    v_mfma_f32_16x16x32_bf16 v[68:71], a[84:87], v[48:51], v[68:71]
    s_waitcnt vmcnt(11)
    v_mfma_f32_16x16x32_bf16 v[72:75], a[80:83], v[52:55], v[72:75]
    ds_read_b128 v[44:47], v18 offset:25600
    v_mfma_f32_16x16x32_bf16 v[76:79], a[84:87], v[52:55], v[76:79]
    buffer_load_dwordx4 v21, s[8:11], s50 offen offset:3072 lds
    s_mov_b32 s62, 0
.cc_399:
    v_max3_u32 v4, v84, v88, v92
    v_cmp_eq_u32 vcc, -1, v4
    s_and_b64 vcc, vcc, s[64:65]
    s_cbranch_vccnz .cf_400
    s_waitcnt lgkmcnt(4)
    v_mfma_f32_16x16x32_bf16 v[64:67], a[88:91], v[56:59], v[64:67]
    ds_read_b128 v[48:51], v17 offset:26624
    v_mfma_f32_16x16x32_bf16 v[68:71], a[92:95], v[56:59], v[68:71]
    v_add_f32 v84, v84, v88
    v_add_f32 v92, v112, v92
    v_mfma_f32_16x16x32_bf16 v[72:75], a[88:91], v[60:63], v[72:75]
    ds_read_b128 v[52:55], v18 offset:26624
    v_mfma_f32_16x16x32_bf16 v[76:79], a[92:95], v[60:63], v[76:79]
    v_add_f32 v85, v85, v89
    v_add_f32 v93, v113, v93
    s_waitcnt lgkmcnt(4)
    v_mfma_f32_16x16x32_bf16 v[64:67], a[96:99], v[32:35], v[64:67]
    ds_read_b128 v[56:59], v17 offset:27648
    s_add_u32 m0, s49, 8192
    s_add_u32 s50, s48, 8192
    v_mfma_f32_16x16x32_bf16 v[68:71], a[100:103], v[32:35], v[68:71]
    buffer_load_dwordx4 v21, s[8:11], s50 offen offset:0 lds
    v_add_f32 v86, v86, v90
    v_add_f32 v94, v114, v94
    v_mfma_f32_16x16x32_bf16 v[72:75], a[96:99], v[36:39], v[72:75]
    ds_read_b128 v[60:63], v18 offset:27648
    v_mfma_f32_16x16x32_bf16 v[76:79], a[100:103], v[36:39], v[76:79]
    v_add_f32 v87, v87, v91
    v_add_f32 v95, v115, v95
    s_waitcnt lgkmcnt(4)
    v_mfma_f32_16x16x32_bf16 v[64:67], a[104:107], v[40:43], v[64:67]
    ds_read_b128 v[32:35], v17 offset:32768
    v_mfma_f32_16x16x32_bf16 v[68:71], a[108:111], v[40:43], v[68:71]
    v_add_f32 v84, v92, v84
    v_add_f32 v85, v93, v85
    v_mfma_f32_16x16x32_bf16 v[72:75], a[104:107], v[44:47], v[72:75]
    ds_read_b128 v[36:39], v18 offset:32768
    v_mfma_f32_16x16x32_bf16 v[76:79], a[108:111], v[44:47], v[76:79]
    buffer_load_dwordx4 v21, s[8:11], s50 offen offset:1024 lds
    v_add_f32 v86, v94, v86
    v_add_f32 v87, v95, v87
    s_waitcnt lgkmcnt(4)
    v_mfma_f32_16x16x32_bf16 v[64:67], a[112:115], v[48:51], v[64:67]
    ds_read_b128 v[40:43], v17 offset:33792
    v_mfma_f32_16x16x32_bf16 v[68:71], a[116:119], v[48:51], v[68:71]
    v_sub_f32 v104, 1.0, v100
    v_cvt_pk_bf16_f32 v104, v104, v104
    v_mfma_f32_16x16x32_bf16 v[72:75], a[112:115], v[52:55], v[72:75]
    ds_read_b128 v[44:47], v18 offset:33792
    v_mfma_f32_16x16x32_bf16 v[76:79], a[116:119], v[52:55], v[76:79]
    v_lshlrev_b32 v104, 16, v104
    v_cvt_pk_bf16_f32 v105, v84, v85
    s_waitcnt lgkmcnt(4)
    v_mfma_f32_16x16x32_bf16 v[64:67], a[120:123], v[56:59], v[64:67]
    ds_read_b128 v[48:51], v17 offset:34816
    v_mfma_f32_16x16x32_bf16 v[68:71], a[124:127], v[56:59], v[68:71]
    buffer_load_dwordx4 v21, s[8:11], s50 offen offset:2048 lds
    v_lshlrev_b32 v107, 16, v96
    v_and_b32 v108, 0xffff0000, v96
    v_mfma_f32_16x16x32_bf16 v[72:75], a[120:123], v[60:63], v[72:75]
    ds_read_b128 v[52:55], v18 offset:34816
    v_mfma_f32_16x16x32_bf16 v[76:79], a[124:127], v[60:63], v[76:79]
    v_lshlrev_b32 v109, 16, v98
    v_and_b32 v110, 0xffff0000, v98
    s_waitcnt lgkmcnt(4)
    v_mfma_f32_16x16x32_bf16 v[64:67], a[128:131], v[32:35], v[64:67]
    ds_read_b128 v[56:59], v17 offset:35840
    v_mfma_f32_16x16x32_bf16 v[68:71], a[132:135], v[32:35], v[68:71]
    v_and_b32 v106, 0xffff0000, v105
    v_lshlrev_b32 v105, 16, v105
    v_mfma_f32_16x16x32_bf16 v[72:75], a[128:131], v[36:39], v[72:75]
    ds_read_b128 v[60:63], v18 offset:35840
    v_mfma_f32_16x16x32_bf16 v[76:79], a[132:135], v[36:39], v[76:79]
    buffer_load_dwordx4 v21, s[8:11], s50 offen offset:3072 lds
    v_mul_f32 v107, v107, v109
    v_mul_f32 v108, v108, v110
    s_waitcnt lgkmcnt(4)
    v_mfma_f32_16x16x32_bf16 v[64:67], a[136:139], v[40:43], v[64:67]
    ds_read_b128 v[32:35], v17 offset:40960
    v_mfma_f32_16x16x32_bf16 v[68:71], a[140:143], v[40:43], v[68:71]
    v_mul_f32 v105, v104, v105
    v_mul_f32 v106, v104, v106
    v_mfma_f32_16x16x32_bf16 v[72:75], a[136:139], v[44:47], v[72:75]
    ds_read_b128 v[36:39], v18 offset:40960
    v_mfma_f32_16x16x32_bf16 v[76:79], a[140:143], v[44:47], v[76:79]
    v_cvt_pk_bf16_f32 v107, v107, v108
    v_cvt_pk_bf16_f32 v105, v105, v106
    s_waitcnt lgkmcnt(4)
    v_mfma_f32_16x16x32_bf16 v[64:67], a[144:147], v[48:51], v[64:67]
    ds_read_b128 v[40:43], v17 offset:41984
    s_add_u32 m0, s49, 12288
    s_add_u32 s50, s48, 12288
    v_mfma_f32_16x16x32_bf16 v[68:71], a[148:151], v[48:51], v[68:71]
    buffer_load_dwordx4 v21, s[8:11], s50 offen offset:0 lds
    v_and_b32 v108, 0xffff0000, v107
    v_lshlrev_b32 v107, 16, v107
    v_mfma_f32_16x16x32_bf16 v[72:75], a[144:147], v[52:55], v[72:75]
    ds_read_b128 v[44:47], v18 offset:41984
    v_mfma_f32_16x16x32_bf16 v[76:79], a[148:151], v[52:55], v[76:79]
    v_and_b32 v106, 0xffff0000, v105
    v_lshlrev_b32 v105, 16, v105
    s_waitcnt lgkmcnt(4)
    v_mfma_f32_16x16x32_bf16 v[64:67], a[152:155], v[56:59], v[64:67]
    ds_read_b128 v[48:51], v17 offset:43008
    v_mfma_f32_16x16x32_bf16 v[68:71], a[156:159], v[56:59], v[68:71]
    v_mul_f32 v107, v100, v107
    v_mul_f32 v108, v100, v108
    v_mfma_f32_16x16x32_bf16 v[72:75], a[152:155], v[60:63], v[72:75]
    ds_read_b128 v[52:55], v18 offset:43008
    v_mfma_f32_16x16x32_bf16 v[76:79], a[156:159], v[60:63], v[76:79]
    buffer_load_dwordx4 v21, s[8:11], s50 offen offset:1024 lds
    v_cvt_pk_bf16_f32 v107, v107, v108
    v_and_b32 v108, 0xffff0000, v107
    s_waitcnt lgkmcnt(4)
    v_mfma_f32_16x16x32_bf16 v[64:67], a[160:163], v[32:35], v[64:67]
    ds_read_b128 v[56:59], v17 offset:44032
    v_mfma_f32_16x16x32_bf16 v[68:71], a[164:167], v[32:35], v[68:71]
    v_lshlrev_b32 v107, 16, v107
    v_add_f32 v105, v105, v107
    v_mfma_f32_16x16x32_bf16 v[72:75], a[160:163], v[36:39], v[72:75]
    ds_read_b128 v[60:63], v18 offset:44032
    v_mfma_f32_16x16x32_bf16 v[76:79], a[164:167], v[36:39], v[76:79]
    v_add_f32 v106, v106, v108
    v_cvt_pk_bf16_f32 v102, v105, v106
    s_waitcnt lgkmcnt(4)
    v_mfma_f32_16x16x32_bf16 v[64:67], a[168:171], v[40:43], v[64:67]
    ds_read_b128 v[32:35], v17 offset:49152
    v_mfma_f32_16x16x32_bf16 v[68:71], a[172:175], v[40:43], v[68:71]
    buffer_load_dwordx4 v21, s[8:11], s50 offen offset:2048 lds
    v_cvt_pk_bf16_f32 v105, v86, v87
    v_lshlrev_b32 v107, 16, v97
    v_mfma_f32_16x16x32_bf16 v[72:75], a[168:171], v[44:47], v[72:75]
    ds_read_b128 v[36:39], v18 offset:49152
    v_mfma_f32_16x16x32_bf16 v[76:79], a[172:175], v[44:47], v[76:79]
    v_and_b32 v108, 0xffff0000, v97
    v_lshlrev_b32 v109, 16, v99
    s_waitcnt lgkmcnt(4)
    v_mfma_f32_16x16x32_bf16 v[64:67], a[176:179], v[48:51], v[64:67]
    ds_read_b128 v[40:43], v17 offset:50176
    v_mfma_f32_16x16x32_bf16 v[68:71], a[180:183], v[48:51], v[68:71]
    v_and_b32 v110, 0xffff0000, v99
    v_and_b32 v106, 0xffff0000, v105
    v_mfma_f32_16x16x32_bf16 v[72:75], a[176:179], v[52:55], v[72:75]
    ds_read_b128 v[44:47], v18 offset:50176
    v_mfma_f32_16x16x32_bf16 v[76:79], a[180:183], v[52:55], v[76:79]
    buffer_load_dwordx4 v21, s[8:11], s50 offen offset:3072 lds
    v_lshlrev_b32 v105, 16, v105
    v_mul_f32 v107, v107, v109
    s_waitcnt lgkmcnt(4)
    v_mfma_f32_16x16x32_bf16 v[64:67], a[184:187], v[56:59], v[64:67]
    ds_read_b128 v[48:51], v17 offset:51200
    v_mfma_f32_16x16x32_bf16 v[68:71], a[188:191], v[56:59], v[68:71]
    v_mul_f32 v108, v108, v110
    v_mul_f32 v105, v104, v105
    v_mfma_f32_16x16x32_bf16 v[72:75], a[184:187], v[60:63], v[72:75]
    ds_read_b128 v[52:55], v18 offset:51200
    v_mfma_f32_16x16x32_bf16 v[76:79], a[188:191], v[60:63], v[76:79]
    v_mul_f32 v106, v104, v106
    v_cvt_pk_bf16_f32 v107, v107, v108
    s_waitcnt lgkmcnt(4)
    v_mfma_f32_16x16x32_bf16 v[64:67], a[192:195], v[32:35], v[64:67]
    ds_read_b128 v[56:59], v17 offset:52224
    v_mfma_f32_16x16x32_bf16 v[68:71], a[196:199], v[32:35], v[68:71]
    v_cvt_pk_bf16_f32 v105, v105, v106
    v_and_b32 v108, 0xffff0000, v107
    v_mfma_f32_16x16x32_bf16 v[72:75], a[192:195], v[36:39], v[72:75]
    ds_read_b128 v[60:63], v18 offset:52224
    v_mfma_f32_16x16x32_bf16 v[76:79], a[196:199], v[36:39], v[76:79]
    v_lshlrev_b32 v107, 16, v107
    v_and_b32 v106, 0xffff0000, v105
    s_waitcnt lgkmcnt(4)
    v_mfma_f32_16x16x32_bf16 v[64:67], a[200:203], v[40:43], v[64:67]
    ds_read_b128 v[32:35], v17 offset:57344
    v_mfma_f32_16x16x32_bf16 v[68:71], a[204:207], v[40:43], v[68:71]
    v_lshlrev_b32 v105, 16, v105
    v_mul_f32 v107, v100, v107
    v_mfma_f32_16x16x32_bf16 v[72:75], a[200:203], v[44:47], v[72:75]
    ds_read_b128 v[36:39], v18 offset:57344
    v_mfma_f32_16x16x32_bf16 v[76:79], a[204:207], v[44:47], v[76:79]
    v_mul_f32 v108, v100, v108
    v_cvt_pk_bf16_f32 v107, v107, v108
    s_waitcnt lgkmcnt(4)
    v_mfma_f32_16x16x32_bf16 v[64:67], a[208:211], v[48:51], v[64:67]
    ds_read_b128 v[40:43], v17 offset:58368
    v_mfma_f32_16x16x32_bf16 v[68:71], a[212:215], v[48:51], v[68:71]
    v_and_b32 v108, 0xffff0000, v107
    v_lshlrev_b32 v107, 16, v107
    v_mfma_f32_16x16x32_bf16 v[72:75], a[208:211], v[52:55], v[72:75]
    ds_read_b128 v[44:47], v18 offset:58368
    v_mfma_f32_16x16x32_bf16 v[76:79], a[212:215], v[52:55], v[76:79]
    v_add_f32 v105, v105, v107
    v_add_f32 v106, v106, v108
    s_waitcnt lgkmcnt(4)
    v_mfma_f32_16x16x32_bf16 v[64:67], a[216:219], v[56:59], v[64:67]
    ds_read_b128 v[48:51], v17 offset:59392
    v_mfma_f32_16x16x32_bf16 v[68:71], a[220:223], v[56:59], v[68:71]
    v_cvt_pk_bf16_f32 v103, v105, v106
    s_mov_b64 exec, s[64:65]
    buffer_store_dwordx2 v[102:103], v22, s[44:47], s52 offen
    s_mov_b64 exec, -1
    v_mfma_f32_16x16x32_bf16 v[72:75], a[216:219], v[60:63], v[72:75]
    ds_read_b128 v[52:55], v18 offset:59392
    v_mfma_f32_16x16x32_bf16 v[76:79], a[220:223], v[60:63], v[76:79]
    s_add_u32 s51, s34, s55
    s_lshl_b32 s52, s54, 16
    s_lshl_b32 s60, s54, 7
    s_add_u32 s58, s60, 117440512
    s_add_u32 s59, s60, 117448704
    s_add_u32 s60, s60, 121634816

    s_cmp_eq_u32 s38, 0
    s_waitcnt lgkmcnt(4)
    v_mfma_f32_16x16x32_bf16 v[64:67], a[224:227], v[32:35], v[64:67]
    ds_read_b128 v[56:59], v17 offset:60416
    v_mfma_f32_16x16x32_bf16 v[68:71], a[228:231], v[32:35], v[68:71]
    s_cbranch_scc1 .cs_401
    buffer_load_dwordx2 v[96:97], v22, s[16:19], s52 offen
.cs_401:
    v_mfma_f32_16x16x32_bf16 v[72:75], a[224:227], v[36:39], v[72:75]
    ds_read_b128 v[60:63], v18 offset:60416
    v_mfma_f32_16x16x32_bf16 v[76:79], a[228:231], v[36:39], v[76:79]
    s_cbranch_scc1 .cs_402
    buffer_load_dword v98, v23, s[8:11], s58 offen
.cs_402:
    s_waitcnt lgkmcnt(4)
    v_mfma_f32_16x16x32_bf16 v[64:67], a[232:235], v[40:43], v[64:67]
    v_mfma_f32_16x16x32_bf16 v[68:71], a[236:239], v[40:43], v[68:71]
    s_cbranch_scc1 .cs_403
    buffer_load_dword v99, v23, s[8:11], s59 offen
.cs_403:
    v_mfma_f32_16x16x32_bf16 v[72:75], a[232:235], v[44:47], v[72:75]
    v_mfma_f32_16x16x32_bf16 v[76:79], a[236:239], v[44:47], v[76:79]
    s_cbranch_scc1 .cs_404
    buffer_load_dword v100, v16, s[8:11], s60 offen
.cs_404:
    s_waitcnt lgkmcnt(2)
    v_mfma_f32_16x16x32_bf16 v[64:67], a[240:243], v[48:51], v[64:67]
    v_mfma_f32_16x16x32_bf16 v[68:71], a[244:247], v[48:51], v[68:71]
    s_cbranch_scc1 .cs_405
    buffer_load_dwordx4 v[84:87], v7, s[8:11], s51 offen sc1
.cs_405:
    v_mfma_f32_16x16x32_bf16 v[72:75], a[240:243], v[52:55], v[72:75]
    v_mfma_f32_16x16x32_bf16 v[76:79], a[244:247], v[52:55], v[76:79]
    s_cbranch_scc1 .cs_406
    buffer_load_dwordx4 v[88:91], v8, s[8:11], s51 offen sc1
.cs_406:
    s_waitcnt lgkmcnt(0)
    v_mfma_f32_16x16x32_bf16 v[64:67], a[248:251], v[56:59], v[64:67]
    v_mfma_f32_16x16x32_bf16 v[68:71], a[252:255], v[56:59], v[68:71]
    s_cbranch_scc1 .cs_407
    buffer_load_dwordx4 v[92:95], v9, s[8:11], s51 offen sc1
.cs_407:
    v_mfma_f32_16x16x32_bf16 v[72:75], a[248:251], v[60:63], v[72:75]
    v_mfma_f32_16x16x32_bf16 v[76:79], a[252:255], v[60:63], v[76:79]
    v_xor_b32 v17, 0x10000, v17
    v_xor_b32 v18, 0x10000, v18
    s_cselect_b64 s[64:65], 0, -1
    s_add_u32 s4, s34, s37

    v_mov_b32 v112, v80
    v_mov_b32 v113, v81
    v_mov_b32 v114, v82
    v_mov_b32 v115, v83
    s_branch .g2st_393
.g2nd_392:
    s_waitcnt lgkmcnt(4)
    v_mfma_f32_16x16x32_bf16 v[64:67], a[0:3], v[32:35], 0
    ds_read_b128 v[56:59], v17 offset:3072
    v_mfma_f32_16x16x32_bf16 v[68:71], a[4:7], v[32:35], 0
    v_mfma_f32_16x16x32_bf16 v[72:75], a[0:3], v[36:39], 0
    ds_read_b128 v[60:63], v18 offset:3072
    v_mfma_f32_16x16x32_bf16 v[76:79], a[4:7], v[36:39], 0
    s_waitcnt lgkmcnt(4)
    v_mfma_f32_16x16x32_bf16 v[64:67], a[8:11], v[40:43], v[64:67]
    ds_read_b128 v[32:35], v17 offset:8192
    v_mfma_f32_16x16x32_bf16 v[68:71], a[12:15], v[40:43], v[68:71]
    v_mfma_f32_16x16x32_bf16 v[72:75], a[8:11], v[44:47], v[72:75]
    ds_read_b128 v[36:39], v18 offset:8192
    v_mfma_f32_16x16x32_bf16 v[76:79], a[12:15], v[44:47], v[76:79]
    s_waitcnt lgkmcnt(4)
    v_mfma_f32_16x16x32_bf16 v[64:67], a[16:19], v[48:51], v[64:67]
    ds_read_b128 v[40:43], v17 offset:9216
    v_mfma_f32_16x16x32_bf16 v[68:71], a[20:23], v[48:51], v[68:71]
    v_mfma_f32_16x16x32_bf16 v[72:75], a[16:19], v[52:55], v[72:75]
    ds_read_b128 v[44:47], v18 offset:9216
    v_mfma_f32_16x16x32_bf16 v[76:79], a[20:23], v[52:55], v[76:79]
    s_waitcnt lgkmcnt(4)
    v_mfma_f32_16x16x32_bf16 v[64:67], a[24:27], v[56:59], v[64:67]
    ds_read_b128 v[48:51], v17 offset:10240
    v_mfma_f32_16x16x32_bf16 v[68:71], a[28:31], v[56:59], v[68:71]
    v_mfma_f32_16x16x32_bf16 v[72:75], a[24:27], v[60:63], v[72:75]
    ds_read_b128 v[52:55], v18 offset:10240
    v_mfma_f32_16x16x32_bf16 v[76:79], a[28:31], v[60:63], v[76:79]
    s_waitcnt lgkmcnt(4)
    v_mfma_f32_16x16x32_bf16 v[64:67], a[32:35], v[32:35], v[64:67]
    ds_read_b128 v[56:59], v17 offset:11264
    v_mfma_f32_16x16x32_bf16 v[68:71], a[36:39], v[32:35], v[68:71]
    v_mfma_f32_16x16x32_bf16 v[72:75], a[32:35], v[36:39], v[72:75]
    ds_read_b128 v[60:63], v18 offset:11264
    v_mfma_f32_16x16x32_bf16 v[76:79], a[36:39], v[36:39], v[76:79]
    s_waitcnt lgkmcnt(4)
    v_mfma_f32_16x16x32_bf16 v[64:67], a[40:43], v[40:43], v[64:67]
    ds_read_b128 v[32:35], v17 offset:16384
    v_mfma_f32_16x16x32_bf16 v[68:71], a[44:47], v[40:43], v[68:71]
    v_mfma_f32_16x16x32_bf16 v[72:75], a[40:43], v[44:47], v[72:75]
    ds_read_b128 v[36:39], v18 offset:16384
    v_mfma_f32_16x16x32_bf16 v[76:79], a[44:47], v[44:47], v[76:79]
    s_waitcnt lgkmcnt(4)
    v_mfma_f32_16x16x32_bf16 v[64:67], a[48:51], v[48:51], v[64:67]
    ds_read_b128 v[40:43], v17 offset:17408
    v_mfma_f32_16x16x32_bf16 v[68:71], a[52:55], v[48:51], v[68:71]
    v_mfma_f32_16x16x32_bf16 v[72:75], a[48:51], v[52:55], v[72:75]
    ds_read_b128 v[44:47], v18 offset:17408
    v_mfma_f32_16x16x32_bf16 v[76:79], a[52:55], v[52:55], v[76:79]
    s_waitcnt lgkmcnt(4)
    v_mfma_f32_16x16x32_bf16 v[64:67], a[56:59], v[56:59], v[64:67]
    ds_read_b128 v[48:51], v17 offset:18432
    v_mfma_f32_16x16x32_bf16 v[68:71], a[60:63], v[56:59], v[68:71]
    v_mfma_f32_16x16x32_bf16 v[72:75], a[56:59], v[60:63], v[72:75]
    ds_read_b128 v[52:55], v18 offset:18432
    v_mfma_f32_16x16x32_bf16 v[76:79], a[60:63], v[60:63], v[76:79]
    s_waitcnt lgkmcnt(4)
    v_mfma_f32_16x16x32_bf16 v[64:67], a[64:67], v[32:35], v[64:67]
    ds_read_b128 v[56:59], v17 offset:19456
    v_mfma_f32_16x16x32_bf16 v[68:71], a[68:71], v[32:35], v[68:71]
    v_mfma_f32_16x16x32_bf16 v[72:75], a[64:67], v[36:39], v[72:75]
    ds_read_b128 v[60:63], v18 offset:19456
    v_mfma_f32_16x16x32_bf16 v[76:79], a[68:71], v[36:39], v[76:79]
    s_waitcnt lgkmcnt(4)
    v_mfma_f32_16x16x32_bf16 v[64:67], a[72:75], v[40:43], v[64:67]
    ds_read_b128 v[32:35], v17 offset:24576
    v_mfma_f32_16x16x32_bf16 v[68:71], a[76:79], v[40:43], v[68:71]
    v_mfma_f32_16x16x32_bf16 v[72:75], a[72:75], v[44:47], v[72:75]
    ds_read_b128 v[36:39], v18 offset:24576
    v_mfma_f32_16x16x32_bf16 v[76:79], a[76:79], v[44:47], v[76:79]
    s_waitcnt lgkmcnt(4)
    v_mfma_f32_16x16x32_bf16 v[64:67], a[80:83], v[48:51], v[64:67]
    ds_read_b128 v[40:43], v17 offset:25600
    v_mfma_f32_16x16x32_bf16 v[68:71], a[84:87], v[48:51], v[68:71]
    s_waitcnt vmcnt(3)
    v_mfma_f32_16x16x32_bf16 v[72:75], a[80:83], v[52:55], v[72:75]
    ds_read_b128 v[44:47], v18 offset:25600
    v_mfma_f32_16x16x32_bf16 v[76:79], a[84:87], v[52:55], v[76:79]
    s_mov_b32 s62, 0
.cc_408:
    v_max3_u32 v4, v84, v88, v92
    v_cmp_eq_u32 vcc, -1, v4
    s_and_b64 vcc, vcc, s[64:65]
    s_cbranch_vccnz .cf_409
    s_waitcnt lgkmcnt(4)
    v_mfma_f32_16x16x32_bf16 v[64:67], a[88:91], v[56:59], v[64:67]
    ds_read_b128 v[48:51], v17 offset:26624
    v_mfma_f32_16x16x32_bf16 v[68:71], a[92:95], v[56:59], v[68:71]
    v_add_f32 v84, v84, v88
    v_add_f32 v92, v112, v92
    v_mfma_f32_16x16x32_bf16 v[72:75], a[88:91], v[60:63], v[72:75]
    ds_read_b128 v[52:55], v18 offset:26624
    v_mfma_f32_16x16x32_bf16 v[76:79], a[92:95], v[60:63], v[76:79]
    v_add_f32 v85, v85, v89
    v_add_f32 v93, v113, v93
    s_waitcnt lgkmcnt(4)
    v_mfma_f32_16x16x32_bf16 v[64:67], a[96:99], v[32:35], v[64:67]
    ds_read_b128 v[56:59], v17 offset:27648
    v_mfma_f32_16x16x32_bf16 v[68:71], a[100:103], v[32:35], v[68:71]
    v_add_f32 v86, v86, v90
    v_add_f32 v94, v114, v94
    v_mfma_f32_16x16x32_bf16 v[72:75], a[96:99], v[36:39], v[72:75]
    ds_read_b128 v[60:63], v18 offset:27648
    v_mfma_f32_16x16x32_bf16 v[76:79], a[100:103], v[36:39], v[76:79]
    v_add_f32 v87, v87, v91
    v_add_f32 v95, v115, v95
    s_waitcnt lgkmcnt(4)
    v_mfma_f32_16x16x32_bf16 v[64:67], a[104:107], v[40:43], v[64:67]
    ds_read_b128 v[32:35], v17 offset:32768
    v_mfma_f32_16x16x32_bf16 v[68:71], a[108:111], v[40:43], v[68:71]
    v_add_f32 v84, v92, v84
    v_add_f32 v85, v93, v85
    v_mfma_f32_16x16x32_bf16 v[72:75], a[104:107], v[44:47], v[72:75]
    ds_read_b128 v[36:39], v18 offset:32768
    v_mfma_f32_16x16x32_bf16 v[76:79], a[108:111], v[44:47], v[76:79]
    v_add_f32 v86, v94, v86
    v_add_f32 v87, v95, v87
    s_waitcnt lgkmcnt(4)
    v_mfma_f32_16x16x32_bf16 v[64:67], a[112:115], v[48:51], v[64:67]
    ds_read_b128 v[40:43], v17 offset:33792
    v_mfma_f32_16x16x32_bf16 v[68:71], a[116:119], v[48:51], v[68:71]
    v_sub_f32 v104, 1.0, v100
    v_cvt_pk_bf16_f32 v104, v104, v104
    v_mfma_f32_16x16x32_bf16 v[72:75], a[112:115], v[52:55], v[72:75]
    ds_read_b128 v[44:47], v18 offset:33792
    v_mfma_f32_16x16x32_bf16 v[76:79], a[116:119], v[52:55], v[76:79]
    v_lshlrev_b32 v104, 16, v104
    v_cvt_pk_bf16_f32 v105, v84, v85
    s_waitcnt lgkmcnt(4)
    v_mfma_f32_16x16x32_bf16 v[64:67], a[120:123], v[56:59], v[64:67]
    ds_read_b128 v[48:51], v17 offset:34816
    v_mfma_f32_16x16x32_bf16 v[68:71], a[124:127], v[56:59], v[68:71]
    v_lshlrev_b32 v107, 16, v96
    v_and_b32 v108, 0xffff0000, v96
    v_mfma_f32_16x16x32_bf16 v[72:75], a[120:123], v[60:63], v[72:75]
    ds_read_b128 v[52:55], v18 offset:34816
    v_mfma_f32_16x16x32_bf16 v[76:79], a[124:127], v[60:63], v[76:79]
    v_lshlrev_b32 v109, 16, v98
    v_and_b32 v110, 0xffff0000, v98
    s_waitcnt lgkmcnt(4)
    v_mfma_f32_16x16x32_bf16 v[64:67], a[128:131], v[32:35], v[64:67]
    ds_read_b128 v[56:59], v17 offset:35840
    v_mfma_f32_16x16x32_bf16 v[68:71], a[132:135], v[32:35], v[68:71]
    v_and_b32 v106, 0xffff0000, v105
    v_lshlrev_b32 v105, 16, v105
    v_mfma_f32_16x16x32_bf16 v[72:75], a[128:131], v[36:39], v[72:75]
    ds_read_b128 v[60:63], v18 offset:35840
    v_mfma_f32_16x16x32_bf16 v[76:79], a[132:135], v[36:39], v[76:79]
    v_mul_f32 v107, v107, v109
    v_mul_f32 v108, v108, v110
    s_waitcnt lgkmcnt(4)
    v_mfma_f32_16x16x32_bf16 v[64:67], a[136:139], v[40:43], v[64:67]
    ds_read_b128 v[32:35], v17 offset:40960
    v_mfma_f32_16x16x32_bf16 v[68:71], a[140:143], v[40:43], v[68:71]
    v_mul_f32 v105, v104, v105
    v_mul_f32 v106, v104, v106
    v_mfma_f32_16x16x32_bf16 v[72:75], a[136:139], v[44:47], v[72:75]
    ds_read_b128 v[36:39], v18 offset:40960
    v_mfma_f32_16x16x32_bf16 v[76:79], a[140:143], v[44:47], v[76:79]
    v_cvt_pk_bf16_f32 v107, v107, v108
    v_cvt_pk_bf16_f32 v105, v105, v106
    s_waitcnt lgkmcnt(4)
    v_mfma_f32_16x16x32_bf16 v[64:67], a[144:147], v[48:51], v[64:67]
    ds_read_b128 v[40:43], v17 offset:41984
    v_mfma_f32_16x16x32_bf16 v[68:71], a[148:151], v[48:51], v[68:71]
    v_and_b32 v108, 0xffff0000, v107
    v_lshlrev_b32 v107, 16, v107
    v_mfma_f32_16x16x32_bf16 v[72:75], a[144:147], v[52:55], v[72:75]
    ds_read_b128 v[44:47], v18 offset:41984
    v_mfma_f32_16x16x32_bf16 v[76:79], a[148:151], v[52:55], v[76:79]
    v_and_b32 v106, 0xffff0000, v105
    v_lshlrev_b32 v105, 16, v105
    s_waitcnt lgkmcnt(4)
    v_mfma_f32_16x16x32_bf16 v[64:67], a[152:155], v[56:59], v[64:67]
    ds_read_b128 v[48:51], v17 offset:43008
    v_mfma_f32_16x16x32_bf16 v[68:71], a[156:159], v[56:59], v[68:71]
    v_mul_f32 v107, v100, v107
    v_mul_f32 v108, v100, v108
    v_mfma_f32_16x16x32_bf16 v[72:75], a[152:155], v[60:63], v[72:75]
    ds_read_b128 v[52:55], v18 offset:43008
    v_mfma_f32_16x16x32_bf16 v[76:79], a[156:159], v[60:63], v[76:79]
    v_cvt_pk_bf16_f32 v107, v107, v108
    v_and_b32 v108, 0xffff0000, v107
    s_waitcnt lgkmcnt(4)
    v_mfma_f32_16x16x32_bf16 v[64:67], a[160:163], v[32:35], v[64:67]
    ds_read_b128 v[56:59], v17 offset:44032
    v_mfma_f32_16x16x32_bf16 v[68:71], a[164:167], v[32:35], v[68:71]
    v_lshlrev_b32 v107, 16, v107
    v_add_f32 v105, v105, v107
    v_mfma_f32_16x16x32_bf16 v[72:75], a[160:163], v[36:39], v[72:75]
    ds_read_b128 v[60:63], v18 offset:44032
    v_mfma_f32_16x16x32_bf16 v[76:79], a[164:167], v[36:39], v[76:79]
    v_add_f32 v106, v106, v108
    v_cvt_pk_bf16_f32 v102, v105, v106
    s_waitcnt lgkmcnt(4)
    v_mfma_f32_16x16x32_bf16 v[64:67], a[168:171], v[40:43], v[64:67]
    ds_read_b128 v[32:35], v17 offset:49152
    v_mfma_f32_16x16x32_bf16 v[68:71], a[172:175], v[40:43], v[68:71]
    v_cvt_pk_bf16_f32 v105, v86, v87
    v_lshlrev_b32 v107, 16, v97
    v_mfma_f32_16x16x32_bf16 v[72:75], a[168:171], v[44:47], v[72:75]
    ds_read_b128 v[36:39], v18 offset:49152
    v_mfma_f32_16x16x32_bf16 v[76:79], a[172:175], v[44:47], v[76:79]
    v_and_b32 v108, 0xffff0000, v97
    v_lshlrev_b32 v109, 16, v99
    s_waitcnt lgkmcnt(4)
    v_mfma_f32_16x16x32_bf16 v[64:67], a[176:179], v[48:51], v[64:67]
    ds_read_b128 v[40:43], v17 offset:50176
    v_mfma_f32_16x16x32_bf16 v[68:71], a[180:183], v[48:51], v[68:71]
    v_and_b32 v110, 0xffff0000, v99
    v_and_b32 v106, 0xffff0000, v105
    v_mfma_f32_16x16x32_bf16 v[72:75], a[176:179], v[52:55], v[72:75]
    ds_read_b128 v[44:47], v18 offset:50176
    v_mfma_f32_16x16x32_bf16 v[76:79], a[180:183], v[52:55], v[76:79]
    v_lshlrev_b32 v105, 16, v105
    v_mul_f32 v107, v107, v109
    s_waitcnt lgkmcnt(4)
    v_mfma_f32_16x16x32_bf16 v[64:67], a[184:187], v[56:59], v[64:67]
    ds_read_b128 v[48:51], v17 offset:51200
    v_mfma_f32_16x16x32_bf16 v[68:71], a[188:191], v[56:59], v[68:71]
    v_mul_f32 v108, v108, v110
    v_mul_f32 v105, v104, v105
    v_mfma_f32_16x16x32_bf16 v[72:75], a[184:187], v[60:63], v[72:75]
    ds_read_b128 v[52:55], v18 offset:51200
    v_mfma_f32_16x16x32_bf16 v[76:79], a[188:191], v[60:63], v[76:79]
    v_mul_f32 v106, v104, v106
    v_cvt_pk_bf16_f32 v107, v107, v108
    s_waitcnt lgkmcnt(4)
    v_mfma_f32_16x16x32_bf16 v[64:67], a[192:195], v[32:35], v[64:67]
    ds_read_b128 v[56:59], v17 offset:52224
    v_mfma_f32_16x16x32_bf16 v[68:71], a[196:199], v[32:35], v[68:71]
    v_cvt_pk_bf16_f32 v105, v105, v106
    v_and_b32 v108, 0xffff0000, v107
    v_mfma_f32_16x16x32_bf16 v[72:75], a[192:195], v[36:39], v[72:75]
    ds_read_b128 v[60:63], v18 offset:52224
    v_mfma_f32_16x16x32_bf16 v[76:79], a[196:199], v[36:39], v[76:79]
    v_lshlrev_b32 v107, 16, v107
    v_and_b32 v106, 0xffff0000, v105
    s_waitcnt lgkmcnt(4)
    v_mfma_f32_16x16x32_bf16 v[64:67], a[200:203], v[40:43], v[64:67]
    ds_read_b128 v[32:35], v17 offset:57344
    v_mfma_f32_16x16x32_bf16 v[68:71], a[204:207], v[40:43], v[68:71]
    v_lshlrev_b32 v105, 16, v105
    v_mul_f32 v107, v100, v107
    v_mfma_f32_16x16x32_bf16 v[72:75], a[200:203], v[44:47], v[72:75]
    ds_read_b128 v[36:39], v18 offset:57344
    v_mfma_f32_16x16x32_bf16 v[76:79], a[204:207], v[44:47], v[76:79]
    v_mul_f32 v108, v100, v108
    v_cvt_pk_bf16_f32 v107, v107, v108
    s_waitcnt lgkmcnt(4)
    v_mfma_f32_16x16x32_bf16 v[64:67], a[208:211], v[48:51], v[64:67]
    ds_read_b128 v[40:43], v17 offset:58368
    v_mfma_f32_16x16x32_bf16 v[68:71], a[212:215], v[48:51], v[68:71]
    v_and_b32 v108, 0xffff0000, v107
    v_lshlrev_b32 v107, 16, v107
    v_mfma_f32_16x16x32_bf16 v[72:75], a[208:211], v[52:55], v[72:75]
    ds_read_b128 v[44:47], v18 offset:58368
    v_mfma_f32_16x16x32_bf16 v[76:79], a[212:215], v[52:55], v[76:79]
    v_add_f32 v105, v105, v107
    v_add_f32 v106, v106, v108
    s_waitcnt lgkmcnt(4)
    v_mfma_f32_16x16x32_bf16 v[64:67], a[216:219], v[56:59], v[64:67]
    ds_read_b128 v[48:51], v17 offset:59392
    v_mfma_f32_16x16x32_bf16 v[68:71], a[220:223], v[56:59], v[68:71]
    v_cvt_pk_bf16_f32 v103, v105, v106
    s_mov_b64 exec, s[64:65]
    buffer_store_dwordx2 v[102:103], v22, s[44:47], s52 offen
    s_mov_b64 exec, -1
    v_mfma_f32_16x16x32_bf16 v[72:75], a[216:219], v[60:63], v[72:75]
    ds_read_b128 v[52:55], v18 offset:59392
    v_mfma_f32_16x16x32_bf16 v[76:79], a[220:223], v[60:63], v[76:79]
    s_add_u32 s51, s34, s55
    s_lshl_b32 s52, s54, 16
    s_lshl_b32 s60, s54, 7
    s_add_u32 s58, s60, 117440512
    s_add_u32 s59, s60, 117448704
    s_add_u32 s60, s60, 121634816

    s_cmp_eq_u32 s38, 0
    s_waitcnt lgkmcnt(4)
    v_mfma_f32_16x16x32_bf16 v[64:67], a[224:227], v[32:35], v[64:67]
    ds_read_b128 v[56:59], v17 offset:60416
    v_mfma_f32_16x16x32_bf16 v[68:71], a[228:231], v[32:35], v[68:71]
    s_cbranch_scc1 .cs_410
    buffer_load_dwordx2 v[96:97], v22, s[16:19], s52 offen
.cs_410:
    v_mfma_f32_16x16x32_bf16 v[72:75], a[224:227], v[36:39], v[72:75]
    ds_read_b128 v[60:63], v18 offset:60416
    v_mfma_f32_16x16x32_bf16 v[76:79], a[228:231], v[36:39], v[76:79]
    s_cbranch_scc1 .cs_411
    buffer_load_dword v98, v23, s[8:11], s58 offen
.cs_411:
    s_waitcnt lgkmcnt(4)
    v_mfma_f32_16x16x32_bf16 v[64:67], a[232:235], v[40:43], v[64:67]
    v_mfma_f32_16x16x32_bf16 v[68:71], a[236:239], v[40:43], v[68:71]
    s_cbranch_scc1 .cs_412
    buffer_load_dword v99, v23, s[8:11], s59 offen
.cs_412:
    v_mfma_f32_16x16x32_bf16 v[72:75], a[232:235], v[44:47], v[72:75]
    v_mfma_f32_16x16x32_bf16 v[76:79], a[236:239], v[44:47], v[76:79]
    s_cbranch_scc1 .cs_413
    buffer_load_dword v100, v16, s[8:11], s60 offen
.cs_413:
    s_waitcnt lgkmcnt(2)
    v_mfma_f32_16x16x32_bf16 v[64:67], a[240:243], v[48:51], v[64:67]
    v_mfma_f32_16x16x32_bf16 v[68:71], a[244:247], v[48:51], v[68:71]
    s_cbranch_scc1 .cs_414
    buffer_load_dwordx4 v[84:87], v7, s[8:11], s51 offen sc1
.cs_414:
    v_mfma_f32_16x16x32_bf16 v[72:75], a[240:243], v[52:55], v[72:75]
    v_mfma_f32_16x16x32_bf16 v[76:79], a[244:247], v[52:55], v[76:79]
    s_cbranch_scc1 .cs_415
    buffer_load_dwordx4 v[88:91], v8, s[8:11], s51 offen sc1
.cs_415:
    s_waitcnt lgkmcnt(0)
    v_mfma_f32_16x16x32_bf16 v[64:67], a[248:251], v[56:59], v[64:67]
    v_mfma_f32_16x16x32_bf16 v[68:71], a[252:255], v[56:59], v[68:71]
    s_cbranch_scc1 .cs_416
    buffer_load_dwordx4 v[92:95], v9, s[8:11], s51 offen sc1
.cs_416:
    v_mfma_f32_16x16x32_bf16 v[72:75], a[248:251], v[60:63], v[72:75]
    v_mfma_f32_16x16x32_bf16 v[76:79], a[252:255], v[60:63], v[76:79]
    v_xor_b32 v17, 0x10000, v17
    v_xor_b32 v18, 0x10000, v18
    s_cselect_b64 s[64:65], 0, -1
    s_add_u32 s4, s34, s37

    v_mov_b32 v112, v80
    v_mov_b32 v113, v81
    v_mov_b32 v114, v82
    v_mov_b32 v115, v83
.g2st_393:
    v_min_u32 v68, 0xfffffffe, v68
    buffer_store_dwordx4 v[68:71], v28, s[8:11], s4 offen sc1
    v_min_u32 v72, 0xfffffffe, v72
    buffer_store_dwordx4 v[72:75], v29, s[8:11], s4 offen sc1
    v_min_u32 v76, 0xfffffffe, v76
    buffer_store_dwordx4 v[76:79], v30, s[8:11], s4 offen sc1
    v_mov_b32 v80, v64
    v_mov_b32 v81, v65
    v_mov_b32 v82, v66
    v_mov_b32 v83, v67
    s_cmp_lg_u32 s56, 0
    s_cbranch_scc1 .g2pf_417
    s_cmp_eq_u32 s38, 0
    s_cbranch_scc1 .g2nc_394
    s_waitcnt vmcnt(0)
    s_mov_b32 s62, 0
.cc_418:
    v_max3_u32 v4, v84, v88, v92
    v_cmp_eq_u32 vcc, -1, v4
    s_cbranch_vccnz .cf_419
    v_add_f32 v84, v84, v88
    v_add_f32 v92, v112, v92
    v_add_f32 v85, v85, v89
    v_add_f32 v93, v113, v93
    v_add_f32 v86, v86, v90
    v_add_f32 v94, v114, v94
    v_add_f32 v87, v87, v91
    v_add_f32 v95, v115, v95
    v_add_f32 v84, v92, v84
    v_add_f32 v85, v93, v85
    v_add_f32 v86, v94, v86
    v_add_f32 v87, v95, v87
    v_sub_f32 v104, 1.0, v100
    v_cvt_pk_bf16_f32 v104, v104, v104
    v_lshlrev_b32 v104, 16, v104
    v_cvt_pk_bf16_f32 v105, v84, v85
    v_lshlrev_b32 v107, 16, v96
    v_and_b32 v108, 0xffff0000, v96
    v_lshlrev_b32 v109, 16, v98
    v_and_b32 v110, 0xffff0000, v98
    v_and_b32 v106, 0xffff0000, v105
    v_lshlrev_b32 v105, 16, v105
    v_mul_f32 v107, v107, v109
    v_mul_f32 v108, v108, v110
    v_mul_f32 v105, v104, v105
    v_mul_f32 v106, v104, v106
    v_cvt_pk_bf16_f32 v107, v107, v108
    v_cvt_pk_bf16_f32 v105, v105, v106
    v_and_b32 v108, 0xffff0000, v107
    v_lshlrev_b32 v107, 16, v107
    v_and_b32 v106, 0xffff0000, v105
    v_lshlrev_b32 v105, 16, v105
    v_mul_f32 v107, v100, v107
    v_mul_f32 v108, v100, v108
    v_cvt_pk_bf16_f32 v107, v107, v108
    v_and_b32 v108, 0xffff0000, v107
    v_lshlrev_b32 v107, 16, v107
    v_add_f32 v105, v105, v107
    v_add_f32 v106, v106, v108
    v_cvt_pk_bf16_f32 v102, v105, v106
    v_cvt_pk_bf16_f32 v105, v86, v87
    v_lshlrev_b32 v107, 16, v97
    v_and_b32 v108, 0xffff0000, v97
    v_lshlrev_b32 v109, 16, v99
    v_and_b32 v110, 0xffff0000, v99
    v_and_b32 v106, 0xffff0000, v105
    v_lshlrev_b32 v105, 16, v105
    v_mul_f32 v107, v107, v109
    v_mul_f32 v108, v108, v110
    v_mul_f32 v105, v104, v105
    v_mul_f32 v106, v104, v106
    v_cvt_pk_bf16_f32 v107, v107, v108
    v_cvt_pk_bf16_f32 v105, v105, v106
    v_and_b32 v108, 0xffff0000, v107
    v_lshlrev_b32 v107, 16, v107
    v_and_b32 v106, 0xffff0000, v105
    v_lshlrev_b32 v105, 16, v105
    v_mul_f32 v107, v100, v107
    v_mul_f32 v108, v100, v108
    v_cvt_pk_bf16_f32 v107, v107, v108
    v_and_b32 v108, 0xffff0000, v107
    v_lshlrev_b32 v107, 16, v107
    v_add_f32 v105, v105, v107
    v_add_f32 v106, v106, v108
    v_cvt_pk_bf16_f32 v103, v105, v106
    buffer_store_dwordx2 v[102:103], v22, s[44:47], s52 offen
.g2nc_394:
    s_add_u32 s51, s34, s37
    s_lshl_b32 s52, s31, 16
    s_lshl_b32 s60, s31, 7
    s_add_u32 s58, s60, 117440512
    s_add_u32 s59, s60, 117448704
    s_add_u32 s60, s60, 121634816

    buffer_load_dwordx2 v[96:97], v22, s[16:19], s52 offen
    buffer_load_dword v98, v23, s[8:11], s58 offen
    buffer_load_dword v99, v23, s[8:11], s59 offen
    buffer_load_dword v100, v16, s[8:11], s60 offen
    buffer_load_dwordx4 v[84:87], v7, s[8:11], s51 offen sc1
    buffer_load_dwordx4 v[88:91], v8, s[8:11], s51 offen sc1
    buffer_load_dwordx4 v[92:95], v9, s[8:11], s51 offen sc1
    s_waitcnt vmcnt(0)
    s_mov_b32 s62, 0
.cc_420:
    v_max3_u32 v4, v84, v88, v92
    v_cmp_eq_u32 vcc, -1, v4
    s_cbranch_vccnz .cf_421
    v_add_f32 v84, v84, v88
    v_add_f32 v92, v80, v92
    v_add_f32 v85, v85, v89
    v_add_f32 v93, v81, v93
    v_add_f32 v86, v86, v90
    v_add_f32 v94, v82, v94
    v_add_f32 v87, v87, v91
    v_add_f32 v95, v83, v95
    v_add_f32 v84, v92, v84
    v_add_f32 v85, v93, v85
    v_add_f32 v86, v94, v86
    v_add_f32 v87, v95, v87
    v_sub_f32 v104, 1.0, v100
    v_cvt_pk_bf16_f32 v104, v104, v104
    v_lshlrev_b32 v104, 16, v104
    v_cvt_pk_bf16_f32 v105, v84, v85
    v_lshlrev_b32 v107, 16, v96
    v_and_b32 v108, 0xffff0000, v96
    v_lshlrev_b32 v109, 16, v98
    v_and_b32 v110, 0xffff0000, v98
    v_and_b32 v106, 0xffff0000, v105
    v_lshlrev_b32 v105, 16, v105
    v_mul_f32 v107, v107, v109
    v_mul_f32 v108, v108, v110
    v_mul_f32 v105, v104, v105
    v_mul_f32 v106, v104, v106
    v_cvt_pk_bf16_f32 v107, v107, v108
    v_cvt_pk_bf16_f32 v105, v105, v106
    v_and_b32 v108, 0xffff0000, v107
    v_lshlrev_b32 v107, 16, v107
    v_and_b32 v106, 0xffff0000, v105
    v_lshlrev_b32 v105, 16, v105
    v_mul_f32 v107, v100, v107
    v_mul_f32 v108, v100, v108
    v_cvt_pk_bf16_f32 v107, v107, v108
    v_and_b32 v108, 0xffff0000, v107
    v_lshlrev_b32 v107, 16, v107
    v_add_f32 v105, v105, v107
    v_add_f32 v106, v106, v108
    v_cvt_pk_bf16_f32 v102, v105, v106
    v_cvt_pk_bf16_f32 v105, v86, v87
    v_lshlrev_b32 v107, 16, v97
    v_and_b32 v108, 0xffff0000, v97
    v_lshlrev_b32 v109, 16, v99
    v_and_b32 v110, 0xffff0000, v99
    v_and_b32 v106, 0xffff0000, v105
    v_lshlrev_b32 v105, 16, v105
    v_mul_f32 v107, v107, v109
    v_mul_f32 v108, v108, v110
    v_mul_f32 v105, v104, v105
    v_mul_f32 v106, v104, v106
    v_cvt_pk_bf16_f32 v107, v107, v108
    v_cvt_pk_bf16_f32 v105, v105, v106
    v_and_b32 v108, 0xffff0000, v107
    v_lshlrev_b32 v107, 16, v107
    v_and_b32 v106, 0xffff0000, v105
    v_lshlrev_b32 v105, 16, v105
    v_mul_f32 v107, v100, v107
    v_mul_f32 v108, v100, v108
    v_cvt_pk_bf16_f32 v107, v107, v108
    v_and_b32 v108, 0xffff0000, v107
    v_lshlrev_b32 v107, 16, v107
    v_add_f32 v105, v105, v107
    v_add_f32 v106, v106, v108
    v_cvt_pk_bf16_f32 v103, v105, v106
    buffer_store_dwordx2 v[102:103], v22, s[44:47], s52 offen
    s_mov_b32 s31, s53
    s_add_u32 s37, s37, 0x10000
    s_cmp_lt_u32 s31, 64
    s_cbranch_scc1 .g2blk_388
    s_branch .g2fin_395

.g2pf_417:
    s_mov_b32 s31, s53
    s_add_u32 s37, s37, 0x10000
    s_cmp_eq_u32 s38, 0
    s_mov_b32 s38, 1
    s_cbranch_scc1 .g2w3_390
    s_waitcnt vmcnt(10)
    s_branch .g2go_389

.g2w3_390:
    s_waitcnt vmcnt(3)
    s_branch .g2go_389
.cf_400:
    buffer_load_dwordx4 v[84:87], v7, s[8:11], s51 offen sc1
    buffer_load_dwordx4 v[88:91], v8, s[8:11], s51 offen sc1
    buffer_load_dwordx4 v[92:95], v9, s[8:11], s51 offen sc1
    s_add_u32 s62, s62, 1
    s_cmp_gt_u32 s62, 0x400000
    s_cbranch_scc1 .mg_end_1
    s_waitcnt vmcnt(0)
    s_branch .cc_399

.cf_409:
    buffer_load_dwordx4 v[84:87], v7, s[8:11], s51 offen sc1
    buffer_load_dwordx4 v[88:91], v8, s[8:11], s51 offen sc1
    buffer_load_dwordx4 v[92:95], v9, s[8:11], s51 offen sc1
    s_add_u32 s62, s62, 1
    s_cmp_gt_u32 s62, 0x400000
    s_cbranch_scc1 .mg_end_1
    s_waitcnt vmcnt(0)
    s_branch .cc_408

.cf_419:
    buffer_load_dwordx4 v[84:87], v7, s[8:11], s51 offen sc1
    buffer_load_dwordx4 v[88:91], v8, s[8:11], s51 offen sc1
    buffer_load_dwordx4 v[92:95], v9, s[8:11], s51 offen sc1
    s_add_u32 s62, s62, 1
    s_cmp_gt_u32 s62, 0x400000
    s_cbranch_scc1 .mg_end_1
    s_waitcnt vmcnt(0)
    s_branch .cc_418

.cf_421:
    buffer_load_dwordx4 v[84:87], v7, s[8:11], s51 offen sc1
    buffer_load_dwordx4 v[88:91], v8, s[8:11], s51 offen sc1
    buffer_load_dwordx4 v[92:95], v9, s[8:11], s51 offen sc1
    s_add_u32 s62, s62, 1
    s_cmp_gt_u32 s62, 0x400000
    s_cbranch_scc1 .mg_end_1
    s_waitcnt vmcnt(0)
    s_branch .cc_420

.g2fin_395:
    s_endpgm
.cvrole_369:
    s_lshl_b32 s4, s91, 3
    s_add_u32 s4, s4, s26
    s_add_u32 s4, s4, 72
    s_lshl_b32 s4, s4, 8
    s_add_u32 s92, s4, 92274688
    s_lshl_b32 s4, s24, 2
    s_add_u32 s92, s92, s4
    v_mov_b32 v4, 0
    s_mov_b64 exec, 1
    buffer_store_dword v4, v4, s[8:11], s92 offen sc1
    s_mov_b64 exec, -1

    s_waitcnt vmcnt(0)
    s_barrier
    v_mov_b32 v243, s99
    v_mov_b32 v242, 0
    s_cmp_lg_u32 s24, 0
    s_cbranch_scc1 .a1_422
    s_mov_b64 exec, 1
    buffer_atomic_add v243, v242, s[20:23], s97 offen sc1
    s_mov_b64 exec, -1

.a1_422:
    s_waitcnt vmcnt(0)
    s_cmp_lg_u32 s24, 0
    s_cbranch_scc1 .pm_424
    s_lshl_b32 s93, s91, 3
    s_add_u32 s93, s93, s26
    s_sub_u32 s93, s93, 24
    s_and_b32 s94, s93, 1
    s_sub_u32 s5, 0, s100
    s_and_b32 s5, s5, 0x1fffff
    s_add_u32 s5, s5, 100663296
    s_lshl_b32 s4, s94, 21
    s_add_u32 s5, s5, s4
    s_lshl_b32 s4, s93, 8
    s_add_u32 s5, s5, s4
    s_add_u32 s6, s5, 8192
    v_and_b32 v4, 63, v0
    v_lshlrev_b32 v4, 2, v4
    v_mov_b32 v5, -1
    s_mov_b32 s82, 0x7fffffff
    s_mov_b32 s83, 0x7fffffff
    buffer_store_dword v5, v4, s[8:11], s5 offen sc1
    s_waitcnt vmcnt(0)

    s_memtime s[72:73]
    s_waitcnt lgkmcnt(0)
    buffer_store_dword v5, v4, s[8:11], s6 offen sc1
    s_waitcnt vmcnt(0)
    s_memtime s[84:85]
    s_waitcnt lgkmcnt(0)
    s_sub_u32 s84, s84, s72
    s_min_u32 s83, s83, s84

    s_memtime s[72:73]
    s_waitcnt lgkmcnt(0)
    buffer_store_dword v5, v4, s[8:11], s5 offen sc1
    s_waitcnt vmcnt(0)
    s_memtime s[84:85]
    s_waitcnt lgkmcnt(0)
    s_sub_u32 s84, s84, s72
    s_min_u32 s82, s82, s84

    s_memtime s[72:73]
    s_waitcnt lgkmcnt(0)
    buffer_store_dword v5, v4, s[8:11], s6 offen sc1
    s_waitcnt vmcnt(0)
    s_memtime s[84:85]
    s_waitcnt lgkmcnt(0)
    s_sub_u32 s84, s84, s72
    s_min_u32 s83, s83, s84

    s_memtime s[72:73]
    s_waitcnt lgkmcnt(0)
    buffer_store_dword v5, v4, s[8:11], s5 offen sc1
    s_waitcnt vmcnt(0)
    s_memtime s[84:85]
    s_waitcnt lgkmcnt(0)
    s_sub_u32 s84, s84, s72
    s_min_u32 s82, s82, s84

    s_memtime s[72:73]
    s_waitcnt lgkmcnt(0)
    buffer_store_dword v5, v4, s[8:11], s6 offen sc1
    s_waitcnt vmcnt(0)
    s_memtime s[84:85]
    s_waitcnt lgkmcnt(0)
    s_sub_u32 s84, s84, s72
    s_min_u32 s83, s83, s84

    s_memtime s[72:73]
    s_waitcnt lgkmcnt(0)
    buffer_store_dword v5, v4, s[8:11], s5 offen sc1
    s_waitcnt vmcnt(0)
    s_memtime s[84:85]
    s_waitcnt lgkmcnt(0)
    s_sub_u32 s84, s84, s72
    s_min_u32 s82, s82, s84

    s_memtime s[72:73]
    s_waitcnt lgkmcnt(0)
    buffer_store_dword v5, v4, s[8:11], s6 offen sc1
    s_waitcnt vmcnt(0)
    s_memtime s[84:85]
    s_waitcnt lgkmcnt(0)
    s_sub_u32 s84, s84, s72
    s_min_u32 s83, s83, s84

    s_memtime s[72:73]
    s_waitcnt lgkmcnt(0)
    buffer_store_dword v5, v4, s[8:11], s5 offen sc1
    s_waitcnt vmcnt(0)
    s_memtime s[84:85]
    s_waitcnt lgkmcnt(0)
    s_sub_u32 s84, s84, s72
    s_min_u32 s82, s82, s84

    s_cmp_lt_u32 s82, s83
    s_cselect_b32 s4, 1, 0
    s_mul_i32 s94, s94, 6
    s_lshl_b32 s4, s4, s94
    s_add_u32 s95, s4, 0x1000000

.pm_424:
    s_cmp_lg_u32 s24, 0
    s_cbranch_scc1 .pv_425
    s_mov_b64 exec, 1
    v_mov_b32 v4, s95
    v_mov_b32 v5, 4
    buffer_atomic_add v4, v5, s[20:23], s97 offen sc1
    s_mov_b64 exec, -1

.pv_425:
    s_barrier
    s_lshl_b32 s93, s91, 3
    s_add_u32 s93, s93, s26
    s_sub_u32 s93, s93, 24

    s_load_dwordx2 s[40:41], s[0:1], 0
    s_load_dwordx2 s[42:43], s[0:1], 104

    v_and_b32 v1, 63, v0
    v_and_b32 v2, 15, v1
    v_lshrrev_b32 v3, 4, v1

    s_waitcnt lgkmcnt(0)
    s_mov_b32 s12, s40
    s_and_b32 s13, s41, 0xffff
    s_mov_b32 s14, 0x400000
    s_mov_b32 s15, 0x00020000

    s_mov_b32 s16, s42
    s_and_b32 s17, s43, 0xffff
    s_mov_b32 s18, 0x800
    s_mov_b32 s19, 0x00020000

    s_lshl_b32 s3, s93, 6
    s_lshl_b32 s4, s24, 4
    s_add_u32 s3, s3, s4
    v_lshlrev_b32 v8, 4, v1
    buffer_load_dwordx4 v[16:19], v8, s[16:19], 0 offen
    buffer_load_dwordx4 v[20:23], v8, s[16:19], 0 offen offset:1024
    s_lshl_b32 s5, s3, 11

    buffer_load_dwordx4 v[64:67], v8, s[12:15], s5 offen
    buffer_load_dwordx4 v[68:71], v8, s[12:15], s5 offen offset:1024
    s_add_u32 s5, s5, 2048

    buffer_load_dwordx4 v[72:75], v8, s[12:15], s5 offen
    buffer_load_dwordx4 v[76:79], v8, s[12:15], s5 offen offset:1024
    s_add_u32 s5, s5, 2048

    buffer_load_dwordx4 v[80:83], v8, s[12:15], s5 offen
    buffer_load_dwordx4 v[84:87], v8, s[12:15], s5 offen offset:1024
    s_add_u32 s5, s5, 2048

    buffer_load_dwordx4 v[88:91], v8, s[12:15], s5 offen
    buffer_load_dwordx4 v[92:95], v8, s[12:15], s5 offen offset:1024
    s_add_u32 s5, s5, 2048

    buffer_load_dwordx4 v[96:99], v8, s[12:15], s5 offen
    buffer_load_dwordx4 v[100:103], v8, s[12:15], s5 offen offset:1024
    s_add_u32 s5, s5, 2048

    buffer_load_dwordx4 v[104:107], v8, s[12:15], s5 offen
    buffer_load_dwordx4 v[108:111], v8, s[12:15], s5 offen offset:1024
    s_add_u32 s5, s5, 2048

    buffer_load_dwordx4 v[112:115], v8, s[12:15], s5 offen
    buffer_load_dwordx4 v[116:119], v8, s[12:15], s5 offen offset:1024
    s_add_u32 s5, s5, 2048

    buffer_load_dwordx4 v[120:123], v8, s[12:15], s5 offen
    buffer_load_dwordx4 v[124:127], v8, s[12:15], s5 offen offset:1024
    s_add_u32 s5, s5, 2048

    buffer_load_dwordx4 v[128:131], v8, s[12:15], s5 offen
    buffer_load_dwordx4 v[132:135], v8, s[12:15], s5 offen offset:1024
    s_add_u32 s5, s5, 2048

    buffer_load_dwordx4 v[136:139], v8, s[12:15], s5 offen
    buffer_load_dwordx4 v[140:143], v8, s[12:15], s5 offen offset:1024
    s_add_u32 s5, s5, 2048

    buffer_load_dwordx4 v[144:147], v8, s[12:15], s5 offen
    buffer_load_dwordx4 v[148:151], v8, s[12:15], s5 offen offset:1024
    s_add_u32 s5, s5, 2048

    buffer_load_dwordx4 v[152:155], v8, s[12:15], s5 offen
    buffer_load_dwordx4 v[156:159], v8, s[12:15], s5 offen offset:1024
    s_add_u32 s5, s5, 2048

    buffer_load_dwordx4 v[160:163], v8, s[12:15], s5 offen
    buffer_load_dwordx4 v[164:167], v8, s[12:15], s5 offen offset:1024
    s_add_u32 s5, s5, 2048

    buffer_load_dwordx4 v[168:171], v8, s[12:15], s5 offen
    buffer_load_dwordx4 v[172:175], v8, s[12:15], s5 offen offset:1024
    s_add_u32 s5, s5, 2048

    buffer_load_dwordx4 v[176:179], v8, s[12:15], s5 offen
    buffer_load_dwordx4 v[180:183], v8, s[12:15], s5 offen offset:1024
    s_add_u32 s5, s5, 2048

    buffer_load_dwordx4 v[184:187], v8, s[12:15], s5 offen
    buffer_load_dwordx4 v[188:191], v8, s[12:15], s5 offen offset:1024
    s_add_u32 s5, s5, 2048

    v_and_b32 v241, 3, v0
    v_lshlrev_b32 v241, 2, v241
    buffer_load_dword v240, v241, s[20:23], s97 offen sc1

    s_waitcnt vmcnt(29)
    v_dot2_f32_bf16 v24, v64, v16, 0
    v_dot2_f32_bf16 v25, v72, v16, 0
    v_dot2_f32_bf16 v24, v65, v17, v24
    v_dot2_f32_bf16 v25, v73, v17, v25
    v_dot2_f32_bf16 v24, v66, v18, v24
    v_dot2_f32_bf16 v25, v74, v18, v25
    v_dot2_f32_bf16 v24, v67, v19, v24
    v_dot2_f32_bf16 v25, v75, v19, v25
    v_dot2_f32_bf16 v24, v68, v20, v24
    v_dot2_f32_bf16 v25, v76, v20, v25
    v_dot2_f32_bf16 v24, v69, v21, v24
    v_dot2_f32_bf16 v25, v77, v21, v25
    v_dot2_f32_bf16 v24, v70, v22, v24
    v_dot2_f32_bf16 v25, v78, v22, v25
    v_dot2_f32_bf16 v24, v71, v23, v24
    v_dot2_f32_bf16 v25, v79, v23, v25
    s_waitcnt vmcnt(25)
    v_dot2_f32_bf16 v26, v80, v16, 0
    v_dot2_f32_bf16 v27, v88, v16, 0
    v_dot2_f32_bf16 v26, v81, v17, v26
    v_dot2_f32_bf16 v27, v89, v17, v27
    v_dot2_f32_bf16 v26, v82, v18, v26
    v_dot2_f32_bf16 v27, v90, v18, v27
    v_dot2_f32_bf16 v26, v83, v19, v26
    v_dot2_f32_bf16 v27, v91, v19, v27
    v_dot2_f32_bf16 v26, v84, v20, v26
    v_dot2_f32_bf16 v27, v92, v20, v27
    v_dot2_f32_bf16 v26, v85, v21, v26
    v_dot2_f32_bf16 v27, v93, v21, v27
    v_dot2_f32_bf16 v26, v86, v22, v26
    v_dot2_f32_bf16 v27, v94, v22, v27
    v_dot2_f32_bf16 v26, v87, v23, v26
    v_dot2_f32_bf16 v27, v95, v23, v27
    s_waitcnt vmcnt(21)
    v_dot2_f32_bf16 v28, v96, v16, 0
    v_dot2_f32_bf16 v29, v104, v16, 0
    v_dot2_f32_bf16 v28, v97, v17, v28
    v_dot2_f32_bf16 v29, v105, v17, v29
    v_dot2_f32_bf16 v28, v98, v18, v28
    v_dot2_f32_bf16 v29, v106, v18, v29
    v_dot2_f32_bf16 v28, v99, v19, v28
    v_dot2_f32_bf16 v29, v107, v19, v29
    v_dot2_f32_bf16 v28, v100, v20, v28
    v_dot2_f32_bf16 v29, v108, v20, v29
    v_dot2_f32_bf16 v28, v101, v21, v28
    v_dot2_f32_bf16 v29, v109, v21, v29
    v_dot2_f32_bf16 v28, v102, v22, v28
    v_dot2_f32_bf16 v29, v110, v22, v29
    v_dot2_f32_bf16 v28, v103, v23, v28
    v_dot2_f32_bf16 v29, v111, v23, v29
    s_waitcnt vmcnt(17)
    v_dot2_f32_bf16 v30, v112, v16, 0
    v_dot2_f32_bf16 v31, v120, v16, 0
    v_dot2_f32_bf16 v30, v113, v17, v30
    v_dot2_f32_bf16 v31, v121, v17, v31
    v_dot2_f32_bf16 v30, v114, v18, v30
    v_dot2_f32_bf16 v31, v122, v18, v31
    v_dot2_f32_bf16 v30, v115, v19, v30
    v_dot2_f32_bf16 v31, v123, v19, v31
    v_dot2_f32_bf16 v30, v116, v20, v30
    v_dot2_f32_bf16 v31, v124, v20, v31
    v_dot2_f32_bf16 v30, v117, v21, v30
    v_dot2_f32_bf16 v31, v125, v21, v31
    v_dot2_f32_bf16 v30, v118, v22, v30
    v_dot2_f32_bf16 v31, v126, v22, v31
    v_dot2_f32_bf16 v30, v119, v23, v30
    v_dot2_f32_bf16 v31, v127, v23, v31
    s_waitcnt vmcnt(13)
    v_dot2_f32_bf16 v32, v128, v16, 0
    v_dot2_f32_bf16 v33, v136, v16, 0
    v_dot2_f32_bf16 v32, v129, v17, v32
    v_dot2_f32_bf16 v33, v137, v17, v33
    v_dot2_f32_bf16 v32, v130, v18, v32
    v_dot2_f32_bf16 v33, v138, v18, v33
    v_dot2_f32_bf16 v32, v131, v19, v32
    v_dot2_f32_bf16 v33, v139, v19, v33
    v_dot2_f32_bf16 v32, v132, v20, v32
    v_dot2_f32_bf16 v33, v140, v20, v33
    v_dot2_f32_bf16 v32, v133, v21, v32
    v_dot2_f32_bf16 v33, v141, v21, v33
    v_dot2_f32_bf16 v32, v134, v22, v32
    v_dot2_f32_bf16 v33, v142, v22, v33
    v_dot2_f32_bf16 v32, v135, v23, v32
    v_dot2_f32_bf16 v33, v143, v23, v33
    s_waitcnt vmcnt(9)
    v_dot2_f32_bf16 v34, v144, v16, 0
    v_dot2_f32_bf16 v35, v152, v16, 0
    v_dot2_f32_bf16 v34, v145, v17, v34
    v_dot2_f32_bf16 v35, v153, v17, v35
    v_dot2_f32_bf16 v34, v146, v18, v34
    v_dot2_f32_bf16 v35, v154, v18, v35
    v_dot2_f32_bf16 v34, v147, v19, v34
    v_dot2_f32_bf16 v35, v155, v19, v35
    v_dot2_f32_bf16 v34, v148, v20, v34
    v_dot2_f32_bf16 v35, v156, v20, v35
    v_dot2_f32_bf16 v34, v149, v21, v34
    v_dot2_f32_bf16 v35, v157, v21, v35
    v_dot2_f32_bf16 v34, v150, v22, v34
    v_dot2_f32_bf16 v35, v158, v22, v35
    v_dot2_f32_bf16 v34, v151, v23, v34
    v_dot2_f32_bf16 v35, v159, v23, v35
    s_waitcnt vmcnt(5)
    v_dot2_f32_bf16 v36, v160, v16, 0
    v_dot2_f32_bf16 v37, v168, v16, 0
    v_dot2_f32_bf16 v36, v161, v17, v36
    v_dot2_f32_bf16 v37, v169, v17, v37
    v_dot2_f32_bf16 v36, v162, v18, v36
    v_dot2_f32_bf16 v37, v170, v18, v37
    v_dot2_f32_bf16 v36, v163, v19, v36
    v_dot2_f32_bf16 v37, v171, v19, v37
    v_dot2_f32_bf16 v36, v164, v20, v36
    v_dot2_f32_bf16 v37, v172, v20, v37
    v_dot2_f32_bf16 v36, v165, v21, v36
    v_dot2_f32_bf16 v37, v173, v21, v37
    v_dot2_f32_bf16 v36, v166, v22, v36
    v_dot2_f32_bf16 v37, v174, v22, v37
    v_dot2_f32_bf16 v36, v167, v23, v36
    v_dot2_f32_bf16 v37, v175, v23, v37
    s_waitcnt vmcnt(1)
    v_dot2_f32_bf16 v38, v176, v16, 0
    v_dot2_f32_bf16 v39, v184, v16, 0
    v_dot2_f32_bf16 v38, v177, v17, v38
    v_dot2_f32_bf16 v39, v185, v17, v39
    v_dot2_f32_bf16 v38, v178, v18, v38
    v_dot2_f32_bf16 v39, v186, v18, v39
    v_dot2_f32_bf16 v38, v179, v19, v38
    v_dot2_f32_bf16 v39, v187, v19, v39
    v_dot2_f32_bf16 v38, v180, v20, v38
    v_dot2_f32_bf16 v39, v188, v20, v39
    v_dot2_f32_bf16 v38, v181, v21, v38
    v_dot2_f32_bf16 v39, v189, v21, v39
    v_dot2_f32_bf16 v38, v182, v22, v38
    v_dot2_f32_bf16 v39, v190, v22, v39
    v_dot2_f32_bf16 v38, v183, v23, v38
    v_dot2_f32_bf16 v39, v191, v23, v39
    s_waitcnt vmcnt(0)
    s_mov_b32 s62, 0
.vp_426:
    v_readlane_b32 s4, v240, 0
    v_readlane_b32 s7, v240, 1
    v_readlane_b32 s6, v240, 2

    s_cmp_ge_u32 s4, 256
    s_cbranch_scc1 .vd_427
    s_cmp_lg_u32 s6, 0
    s_cbranch_scc1 .vs_428
    s_add_u32 s62, s62, 1
    s_cmp_gt_u32 s62, 0x100000
    s_cbranch_scc1 .mg_end_1
    s_sleep 8
    buffer_load_dword v240, v241, s[20:23], s97 offen sc1
    s_waitcnt vmcnt(0)
    s_branch .vp_426

.vs_428:
    s_lshr_b32 s25, s2, 5
    s_and_b32 s26, s2, 31
    s_mov_b32 s27, 1
    s_mov_b32 s99, 1
    s_mov_b32 s97, 144
    s_waitcnt vmcnt(0) lgkmcnt(0)
    s_barrier
    s_branch .mg_role_3

.vd_427:
    v_permlane32_swap_b32 v24, v26
    v_permlane32_swap_b32 v25, v27
    v_permlane32_swap_b32 v28, v30
    v_permlane32_swap_b32 v29, v31
    v_permlane32_swap_b32 v32, v34
    v_permlane32_swap_b32 v33, v35
    v_permlane32_swap_b32 v36, v38
    v_permlane32_swap_b32 v37, v39
    v_add_f32 v24, v24, v26
    v_add_f32 v25, v25, v27
    v_add_f32 v28, v28, v30
    v_add_f32 v29, v29, v31
    v_add_f32 v32, v32, v34
    v_add_f32 v33, v33, v35
    v_add_f32 v36, v36, v38
    v_add_f32 v37, v37, v39
    s_nop 0
    v_permlane16_swap_b32 v24, v25
    v_permlane16_swap_b32 v28, v29
    v_permlane16_swap_b32 v32, v33
    v_permlane16_swap_b32 v36, v37
    v_add_f32 v24, v24, v25
    v_add_f32 v28, v28, v29
    v_add_f32 v32, v32, v33
    v_add_f32 v36, v36, v37
    v_add_f32_dpp v24, v24, v24 row_ror:8 row_mask:0xf bank_mask:0xf
    v_add_f32_dpp v28, v28, v28 row_ror:8 row_mask:0xf bank_mask:0xf
    v_add_f32_dpp v32, v32, v32 row_ror:8 row_mask:0xf bank_mask:0xf
    v_add_f32_dpp v36, v36, v36 row_ror:8 row_mask:0xf bank_mask:0xf
    v_add_f32_dpp v24, v24, v24 row_ror:4 row_mask:0xf bank_mask:0xf
    v_add_f32_dpp v28, v28, v28 row_ror:4 row_mask:0xf bank_mask:0xf
    v_add_f32_dpp v32, v32, v32 row_ror:4 row_mask:0xf bank_mask:0xf
    v_add_f32_dpp v36, v36, v36 row_ror:4 row_mask:0xf bank_mask:0xf
    v_add_f32_dpp v24, v24, v24 row_ror:2 row_mask:0xf bank_mask:0xf
    v_add_f32_dpp v28, v28, v28 row_ror:2 row_mask:0xf bank_mask:0xf
    v_add_f32_dpp v32, v32, v32 row_ror:2 row_mask:0xf bank_mask:0xf
    v_add_f32_dpp v36, v36, v36 row_ror:2 row_mask:0xf bank_mask:0xf
    v_add_f32_dpp v24, v24, v24 row_ror:1 row_mask:0xf bank_mask:0xf
    v_add_f32_dpp v28, v28, v28 row_ror:1 row_mask:0xf bank_mask:0xf
    v_add_f32_dpp v32, v32, v32 row_ror:1 row_mask:0xf bank_mask:0xf
    v_add_f32_dpp v36, v36, v36 row_ror:1 row_mask:0xf bank_mask:0xf
    v_cmp_eq_u32 vcc, 1, v2
    s_nop 1
    v_cndmask_b32 v24, v24, v28, vcc
    v_cmp_eq_u32 vcc, 2, v2
    s_nop 1
    v_cndmask_b32 v24, v24, v32, vcc
    v_cmp_eq_u32 vcc, 3, v2
    s_nop 1
    v_cndmask_b32 v24, v24, v36, vcc
    v_cvt_pk_bf16_f32 v24, v24, v24
    s_mov_b32 s38, 0xbfb8aa3b
    v_lshlrev_b32 v24, 16, v24
    v_mul_f32 v24, s38, v24
    v_exp_f32 v24, v24
    v_lshlrev_b32 v8, 4, v2
    v_add_f32 v24, 1.0, v24
    v_rcp_f32 v24, v24
    v_lshl_add_u32 v8, v3, 2, v8
    v_cvt_pk_bf16_f32 v24, v24, v24
    v_cmp_gt_u32 vcc, 4, v2
    s_lshl_b32 s5, s3, 2
    s_add_u32 s5, s5, 121634816
    v_lshlrev_b32 v24, 16, v24
    s_mov_b64 exec, vcc
    buffer_store_dword v24, v8, s[8:11], s5 offen sc1
    s_mov_b64 exec, -1

    s_load_dwordx4 s[52:55], s[0:1], 8
    s_load_dwordx2 s[56:57], s[0:1], 24

    v_and_b32 v1, 63, v0
    v_and_b32 v2, 15, v1
    v_lshrrev_b32 v3, 4, v1

    v_lshrrev_b32 v4, 2, v1
    v_and_b32 v5, 3, v1
    v_lshlrev_b32 v10, 11, v4
    v_lshl_add_u32 v10, v5, 4, v10
    s_lshl_b32 s4, s93, 6
    v_add_u32 v10, s4, v10
    s_lshl_b32 s70, s24, 20
    s_mul_i32 s71, s24, 33280
    v_lshrrev_b32 v4, 2, v2
    v_lshl_add_u32 v4, v3, 5, v4
    v_lshlrev_b32 v4, 6, v4
    v_lshl_add_u32 v11, v5, 3, v4
    v_add_u32 v11, s71, v11
    s_lshl_b32 s4, s93, 17
    s_lshl_b32 s5, s24, 8
    s_add_u32 s72, s4, s5
    s_add_u32 s72, s72, 125829120
    v_lshlrev_b32 v12, 12, v2
    v_lshl_add_u32 v12, v3, 4, v12
    v_lshlrev_b32 v13, 3, v2
    s_lshl_b32 s6, s93, 8
    s_waitcnt lgkmcnt(0)

    s_mov_b32 s80, s52
    s_and_b32 s81, s53, 0xffff
    s_mov_b32 s82, 0x400000
    s_mov_b32 s83, 0x00020000

    s_mov_b32 s84, s54
    s_and_b32 s85, s55, 0xffff
    s_mov_b32 s86, 0x400000
    s_mov_b32 s87, 0x00020000

    s_mov_b32 s76, s56
    s_and_b32 s77, s57, 0xffff
    s_mov_b32 s78, 0x2000
    s_mov_b32 s79, 0x00020000

    buffer_load_dwordx2 v[196:197], v13, s[76:79], s6 offen
    buffer_load_dwordx2 v[198:199], v13, s[76:79], s6 offen offset:128

    s_add_u32 s4, s70, 0
    s_add_u32 m0, s71, 0
    s_sub_u32 s5, s4, 8192
    s_max_i32 s5, s5, 0
    s_mov_b64 exec, 0xffff
    buffer_load_dwordx4 v10, s[80:83], s5 offen lds
    s_mov_b64 exec, -1

    s_add_u32 m0, s71, 256
    s_nop 0
    buffer_load_dwordx4 v10, s[80:83], s4 offen lds
    s_add_u32 m0, s71, 8448
    s_nop 0
    buffer_load_dwordx4 v10, s[84:87], s4 offen lds
    s_add_u32 m0, s71, 1280
    s_add_u32 s4, s4, 32768
    buffer_load_dwordx4 v10, s[80:83], s4 offen lds
    s_add_u32 m0, s71, 9472
    s_nop 0
    buffer_load_dwordx4 v10, s[84:87], s4 offen lds
    s_add_u32 m0, s71, 2304
    s_add_u32 s4, s4, 32768
    buffer_load_dwordx4 v10, s[80:83], s4 offen lds
    s_add_u32 m0, s71, 10496
    s_nop 0
    buffer_load_dwordx4 v10, s[84:87], s4 offen lds
    s_add_u32 m0, s71, 3328
    s_add_u32 s4, s4, 32768
    buffer_load_dwordx4 v10, s[80:83], s4 offen lds
    s_add_u32 m0, s71, 11520
    s_nop 0
    buffer_load_dwordx4 v10, s[84:87], s4 offen lds
    s_add_u32 m0, s71, 4352
    s_add_u32 s4, s4, 32768
    buffer_load_dwordx4 v10, s[80:83], s4 offen lds
    s_add_u32 m0, s71, 12544
    s_nop 0
    buffer_load_dwordx4 v10, s[84:87], s4 offen lds
    s_add_u32 m0, s71, 5376
    s_add_u32 s4, s4, 32768
    buffer_load_dwordx4 v10, s[80:83], s4 offen lds
    s_add_u32 m0, s71, 13568
    s_nop 0
    buffer_load_dwordx4 v10, s[84:87], s4 offen lds
    s_add_u32 m0, s71, 6400
    s_add_u32 s4, s4, 32768
    buffer_load_dwordx4 v10, s[80:83], s4 offen lds
    s_add_u32 m0, s71, 14592
    s_nop 0
    buffer_load_dwordx4 v10, s[84:87], s4 offen lds
    s_add_u32 m0, s71, 7424
    s_add_u32 s4, s4, 32768
    buffer_load_dwordx4 v10, s[80:83], s4 offen lds
    s_add_u32 m0, s71, 15616
    s_nop 0
    buffer_load_dwordx4 v10, s[84:87], s4 offen lds
    s_add_u32 s4, s70, 262144
    s_add_u32 m0, s71, 16640
    s_sub_u32 s5, s4, 8192
    s_max_i32 s5, s5, 0
    s_mov_b64 exec, 0xffff
    buffer_load_dwordx4 v10, s[80:83], s5 offen lds
    s_mov_b64 exec, -1

    s_add_u32 m0, s71, 16896
    s_nop 0
    buffer_load_dwordx4 v10, s[80:83], s4 offen lds
    s_add_u32 m0, s71, 25088
    s_nop 0
    buffer_load_dwordx4 v10, s[84:87], s4 offen lds
    s_add_u32 m0, s71, 17920
    s_add_u32 s4, s4, 32768
    buffer_load_dwordx4 v10, s[80:83], s4 offen lds
    s_add_u32 m0, s71, 26112
    s_nop 0
    buffer_load_dwordx4 v10, s[84:87], s4 offen lds
    s_add_u32 m0, s71, 18944
    s_add_u32 s4, s4, 32768
    buffer_load_dwordx4 v10, s[80:83], s4 offen lds
    s_add_u32 m0, s71, 27136
    s_nop 0
    buffer_load_dwordx4 v10, s[84:87], s4 offen lds
    s_add_u32 m0, s71, 19968
    s_add_u32 s4, s4, 32768
    buffer_load_dwordx4 v10, s[80:83], s4 offen lds
    s_add_u32 m0, s71, 28160
    s_nop 0
    buffer_load_dwordx4 v10, s[84:87], s4 offen lds
    s_add_u32 m0, s71, 20992
    s_add_u32 s4, s4, 32768
    buffer_load_dwordx4 v10, s[80:83], s4 offen lds
    s_add_u32 m0, s71, 29184
    s_nop 0
    buffer_load_dwordx4 v10, s[84:87], s4 offen lds
    s_add_u32 m0, s71, 22016
    s_add_u32 s4, s4, 32768
    buffer_load_dwordx4 v10, s[80:83], s4 offen lds
    s_add_u32 m0, s71, 30208
    s_nop 0
    buffer_load_dwordx4 v10, s[84:87], s4 offen lds
    s_add_u32 m0, s71, 23040
    s_add_u32 s4, s4, 32768
    buffer_load_dwordx4 v10, s[80:83], s4 offen lds
    s_add_u32 m0, s71, 31232
    s_nop 0
    buffer_load_dwordx4 v10, s[84:87], s4 offen lds
    s_add_u32 m0, s71, 24064
    s_add_u32 s4, s4, 32768
    buffer_load_dwordx4 v10, s[80:83], s4 offen lds
    s_add_u32 m0, s71, 32256
    s_nop 0
    buffer_load_dwordx4 v10, s[84:87], s4 offen lds
    s_waitcnt vmcnt(17)
    v_alignbit_b32 v196, v196, v196, 16
    v_alignbit_b32 v197, v197, v197, 16
    v_alignbit_b32 v198, v198, v198, 16
    v_alignbit_b32 v199, v199, v199, 16
    ds_read_b64_tr_b16 v[16:17], v11 offset:0
    ds_read_b64_tr_b16 v[18:19], v11 offset:256
    ds_read_b64_tr_b16 v[20:21], v11 offset:512
    ds_read_b64_tr_b16 v[22:23], v11 offset:768
    ds_read_b64_tr_b16 v[24:25], v11 offset:1024
    ds_read_b64_tr_b16 v[26:27], v11 offset:1280
    ds_read_b64_tr_b16 v[28:29], v11 offset:1536
    ds_read_b64_tr_b16 v[30:31], v11 offset:1792
    ds_read_b64_tr_b16 v[32:33], v11 offset:2048
    ds_read_b64_tr_b16 v[34:35], v11 offset:8448
    ds_read_b64_tr_b16 v[36:37], v11 offset:8704
    ds_read_b64_tr_b16 v[38:39], v11 offset:8960
    ds_read_b64_tr_b16 v[40:41], v11 offset:9216
    ds_read_b64_tr_b16 v[42:43], v11 offset:9472
    ds_read_b64_tr_b16 v[44:45], v11 offset:9728
    ds_read_b64_tr_b16 v[46:47], v11 offset:9984
    ds_read_b64_tr_b16 v[48:49], v11 offset:10240
    ds_read_b64_tr_b16 v[50:51], v11 offset:32
    ds_read_b64_tr_b16 v[52:53], v11 offset:288
    ds_read_b64_tr_b16 v[54:55], v11 offset:544
    ds_read_b64_tr_b16 v[56:57], v11 offset:800
    ds_read_b64_tr_b16 v[58:59], v11 offset:1056
    ds_read_b64_tr_b16 v[60:61], v11 offset:1312
    ds_read_b64_tr_b16 v[62:63], v11 offset:1568
    ds_read_b64_tr_b16 v[64:65], v11 offset:1824
    ds_read_b64_tr_b16 v[66:67], v11 offset:2080
    ds_read_b64_tr_b16 v[68:69], v11 offset:8480
    ds_read_b64_tr_b16 v[70:71], v11 offset:8736
    ds_read_b64_tr_b16 v[72:73], v11 offset:8992
    ds_read_b64_tr_b16 v[74:75], v11 offset:9248
    ds_read_b64_tr_b16 v[76:77], v11 offset:9504
    ds_read_b64_tr_b16 v[78:79], v11 offset:9760
    ds_read_b64_tr_b16 v[80:81], v11 offset:10016
    ds_read_b64_tr_b16 v[82:83], v11 offset:10272
    s_waitcnt lgkmcnt(0)
    s_cmp_eq_u32 s24, 0
    s_cselect_b32 exec_lo, 0xffff, 0
    s_mov_b32 exec_hi, 0
    v_mov_b32 v16, 0
    v_mov_b32 v17, 0
    v_mov_b32 v50, 0
    v_mov_b32 v51, 0
    s_mov_b64 exec, -1
    s_add_u32 s4, s70, 524288
    s_add_u32 m0, s71, 0
    s_sub_u32 s5, s4, 8192
    s_max_i32 s5, s5, 0
    s_mov_b64 exec, 0xffff
    buffer_load_dwordx4 v10, s[80:83], s5 offen lds
    s_mov_b64 exec, -1

    s_add_u32 m0, s71, 256
    s_nop 0
    buffer_load_dwordx4 v10, s[80:83], s4 offen lds
    s_add_u32 m0, s71, 8448
    s_nop 0
    buffer_load_dwordx4 v10, s[84:87], s4 offen lds
    s_add_u32 m0, s71, 1280
    s_add_u32 s4, s4, 32768
    buffer_load_dwordx4 v10, s[80:83], s4 offen lds
    s_add_u32 m0, s71, 9472
    s_nop 0
    buffer_load_dwordx4 v10, s[84:87], s4 offen lds
    s_add_u32 m0, s71, 2304
    s_add_u32 s4, s4, 32768
    buffer_load_dwordx4 v10, s[80:83], s4 offen lds
    s_add_u32 m0, s71, 10496
    s_nop 0
    buffer_load_dwordx4 v10, s[84:87], s4 offen lds
    s_add_u32 m0, s71, 3328
    s_add_u32 s4, s4, 32768
    buffer_load_dwordx4 v10, s[80:83], s4 offen lds
    s_add_u32 m0, s71, 11520
    s_nop 0
    buffer_load_dwordx4 v10, s[84:87], s4 offen lds
    s_add_u32 m0, s71, 4352
    s_add_u32 s4, s4, 32768
    buffer_load_dwordx4 v10, s[80:83], s4 offen lds
    s_add_u32 m0, s71, 12544
    s_nop 0
    buffer_load_dwordx4 v10, s[84:87], s4 offen lds
    s_add_u32 m0, s71, 5376
    s_add_u32 s4, s4, 32768
    buffer_load_dwordx4 v10, s[80:83], s4 offen lds
    s_add_u32 m0, s71, 13568
    s_nop 0
    buffer_load_dwordx4 v10, s[84:87], s4 offen lds
    s_add_u32 m0, s71, 6400
    s_add_u32 s4, s4, 32768
    buffer_load_dwordx4 v10, s[80:83], s4 offen lds
    s_add_u32 m0, s71, 14592
    s_nop 0
    buffer_load_dwordx4 v10, s[84:87], s4 offen lds
    s_add_u32 m0, s71, 7424
    s_add_u32 s4, s4, 32768
    buffer_load_dwordx4 v10, s[80:83], s4 offen lds
    s_add_u32 m0, s71, 15616
    s_nop 0
    buffer_load_dwordx4 v10, s[84:87], s4 offen lds
    v_alignbit_b32 v84, v17, v16, 16
    v_alignbit_b32 v85, v18, v17, 16
    v_alignbit_b32 v86, v19, v18, 16
    v_alignbit_b32 v87, v20, v19, 16
    v_alignbit_b32 v88, v21, v20, 16
    v_alignbit_b32 v89, v22, v21, 16
    v_alignbit_b32 v90, v23, v22, 16
    v_alignbit_b32 v91, v24, v23, 16
    v_alignbit_b32 v92, v25, v24, 16
    v_alignbit_b32 v93, v26, v25, 16
    v_alignbit_b32 v94, v27, v26, 16
    v_alignbit_b32 v95, v28, v27, 16
    v_alignbit_b32 v96, v29, v28, 16
    v_alignbit_b32 v97, v30, v29, 16
    v_alignbit_b32 v98, v31, v30, 16
    v_alignbit_b32 v99, v32, v31, 16
    v_alignbit_b32 v100, v33, v32, 16
    v_dot2_f32_bf16 v102, v84, v197, 0
    v_dot2_f32_bf16 v103, v17, v197, 0
    v_dot2_f32_bf16 v106, v85, v197, 0
    v_dot2_f32_bf16 v107, v18, v197, 0
    v_dot2_f32_bf16 v110, v86, v197, 0
    v_dot2_f32_bf16 v111, v19, v197, 0
    v_dot2_f32_bf16 v114, v87, v197, 0
    v_dot2_f32_bf16 v115, v20, v197, 0
    v_dot2_f32_bf16 v102, v85, v196, v102
    v_dot2_f32_bf16 v103, v18, v196, v103
    v_dot2_f32_bf16 v106, v86, v196, v106
    v_dot2_f32_bf16 v107, v19, v196, v107
    v_dot2_f32_bf16 v110, v87, v196, v110
    v_dot2_f32_bf16 v111, v20, v196, v111
    v_dot2_f32_bf16 v114, v88, v196, v114
    v_dot2_f32_bf16 v115, v21, v196, v115
    v_lshlrev_b32 v104, 16, v34
    v_and_b32 v105, 0xffff0000, v34
    v_lshlrev_b32 v108, 16, v35
    v_and_b32 v109, 0xffff0000, v35
    v_lshlrev_b32 v112, 16, v36
    v_and_b32 v113, 0xffff0000, v36
    v_lshlrev_b32 v116, 16, v37
    v_and_b32 v117, 0xffff0000, v37
    v_mul_f32 v102, v102, v104
    v_mul_f32 v103, v103, v105
    v_mul_f32 v106, v106, v108
    v_mul_f32 v107, v107, v109
    v_mul_f32 v110, v110, v112
    v_mul_f32 v111, v111, v113
    v_mul_f32 v114, v114, v116
    v_mul_f32 v115, v115, v117
    v_cvt_pk_bf16_f32 v137, v103, v102
    v_cvt_pk_bf16_f32 v136, v107, v106
    v_cvt_pk_bf16_f32 v135, v111, v110
    v_cvt_pk_bf16_f32 v134, v115, v114
    s_add_u32 s4, s72, 0
    buffer_store_dwordx4 v[134:137], v12, s[8:11], s4 offen offset:0
    v_dot2_f32_bf16 v118, v88, v197, 0
    v_dot2_f32_bf16 v119, v21, v197, 0
    v_dot2_f32_bf16 v122, v89, v197, 0
    v_dot2_f32_bf16 v123, v22, v197, 0
    v_dot2_f32_bf16 v126, v90, v197, 0
    v_dot2_f32_bf16 v127, v23, v197, 0
    v_dot2_f32_bf16 v130, v91, v197, 0
    v_dot2_f32_bf16 v131, v24, v197, 0
    v_dot2_f32_bf16 v118, v89, v196, v118
    v_dot2_f32_bf16 v119, v22, v196, v119
    v_dot2_f32_bf16 v122, v90, v196, v122
    v_dot2_f32_bf16 v123, v23, v196, v123
    v_dot2_f32_bf16 v126, v91, v196, v126
    v_dot2_f32_bf16 v127, v24, v196, v127
    v_dot2_f32_bf16 v130, v92, v196, v130
    v_dot2_f32_bf16 v131, v25, v196, v131
    v_lshlrev_b32 v120, 16, v38
    v_and_b32 v121, 0xffff0000, v38
    v_lshlrev_b32 v124, 16, v39
    v_and_b32 v125, 0xffff0000, v39
    v_lshlrev_b32 v128, 16, v40
    v_and_b32 v129, 0xffff0000, v40
    v_lshlrev_b32 v132, 16, v41
    v_and_b32 v133, 0xffff0000, v41
    v_mul_f32 v118, v118, v120
    v_mul_f32 v119, v119, v121
    v_mul_f32 v122, v122, v124
    v_mul_f32 v123, v123, v125
    v_mul_f32 v126, v126, v128
    v_mul_f32 v127, v127, v129
    v_mul_f32 v130, v130, v132
    v_mul_f32 v131, v131, v133
    v_cvt_pk_bf16_f32 v141, v119, v118
    v_cvt_pk_bf16_f32 v140, v123, v122
    v_cvt_pk_bf16_f32 v139, v127, v126
    v_cvt_pk_bf16_f32 v138, v131, v130
    buffer_store_dwordx4 v[138:141], v12, s[8:11], s4 offen offset:1024
    v_dot2_f32_bf16 v102, v92, v197, 0
    v_dot2_f32_bf16 v103, v25, v197, 0
    v_dot2_f32_bf16 v106, v93, v197, 0
    v_dot2_f32_bf16 v107, v26, v197, 0
    v_dot2_f32_bf16 v110, v94, v197, 0
    v_dot2_f32_bf16 v111, v27, v197, 0
    v_dot2_f32_bf16 v114, v95, v197, 0
    v_dot2_f32_bf16 v115, v28, v197, 0
    v_dot2_f32_bf16 v102, v93, v196, v102
    v_dot2_f32_bf16 v103, v26, v196, v103
    v_dot2_f32_bf16 v106, v94, v196, v106
    v_dot2_f32_bf16 v107, v27, v196, v107
    v_dot2_f32_bf16 v110, v95, v196, v110
    v_dot2_f32_bf16 v111, v28, v196, v111
    v_dot2_f32_bf16 v114, v96, v196, v114
    v_dot2_f32_bf16 v115, v29, v196, v115
    v_lshlrev_b32 v104, 16, v42
    v_and_b32 v105, 0xffff0000, v42
    v_lshlrev_b32 v108, 16, v43
    v_and_b32 v109, 0xffff0000, v43
    v_lshlrev_b32 v112, 16, v44
    v_and_b32 v113, 0xffff0000, v44
    v_lshlrev_b32 v116, 16, v45
    v_and_b32 v117, 0xffff0000, v45
    v_mul_f32 v102, v102, v104
    v_mul_f32 v103, v103, v105
    v_mul_f32 v106, v106, v108
    v_mul_f32 v107, v107, v109
    v_mul_f32 v110, v110, v112
    v_mul_f32 v111, v111, v113
    v_mul_f32 v114, v114, v116
    v_mul_f32 v115, v115, v117
    v_cvt_pk_bf16_f32 v145, v103, v102
    v_cvt_pk_bf16_f32 v144, v107, v106
    v_cvt_pk_bf16_f32 v143, v111, v110
    v_cvt_pk_bf16_f32 v142, v115, v114
    buffer_store_dwordx4 v[142:145], v12, s[8:11], s4 offen offset:2048
    v_dot2_f32_bf16 v118, v96, v197, 0
    v_dot2_f32_bf16 v119, v29, v197, 0
    v_dot2_f32_bf16 v122, v97, v197, 0
    v_dot2_f32_bf16 v123, v30, v197, 0
    v_dot2_f32_bf16 v126, v98, v197, 0
    v_dot2_f32_bf16 v127, v31, v197, 0
    v_dot2_f32_bf16 v130, v99, v197, 0
    v_dot2_f32_bf16 v131, v32, v197, 0
    v_dot2_f32_bf16 v118, v97, v196, v118
    v_dot2_f32_bf16 v119, v30, v196, v119
    v_dot2_f32_bf16 v122, v98, v196, v122
    v_dot2_f32_bf16 v123, v31, v196, v123
    v_dot2_f32_bf16 v126, v99, v196, v126
    v_dot2_f32_bf16 v127, v32, v196, v127
    v_dot2_f32_bf16 v130, v100, v196, v130
    v_dot2_f32_bf16 v131, v33, v196, v131
    v_lshlrev_b32 v120, 16, v46
    v_and_b32 v121, 0xffff0000, v46
    v_lshlrev_b32 v124, 16, v47
    v_and_b32 v125, 0xffff0000, v47
    v_lshlrev_b32 v128, 16, v48
    v_and_b32 v129, 0xffff0000, v48
    v_lshlrev_b32 v132, 16, v49
    v_and_b32 v133, 0xffff0000, v49
    v_mul_f32 v118, v118, v120
    v_mul_f32 v119, v119, v121
    v_mul_f32 v122, v122, v124
    v_mul_f32 v123, v123, v125
    v_mul_f32 v126, v126, v128
    v_mul_f32 v127, v127, v129
    v_mul_f32 v130, v130, v132
    v_mul_f32 v131, v131, v133
    v_cvt_pk_bf16_f32 v149, v119, v118
    v_cvt_pk_bf16_f32 v148, v123, v122
    v_cvt_pk_bf16_f32 v147, v127, v126
    v_cvt_pk_bf16_f32 v146, v131, v130
    buffer_store_dwordx4 v[146:149], v12, s[8:11], s4 offen offset:3072
    v_alignbit_b32 v84, v51, v50, 16
    v_alignbit_b32 v85, v52, v51, 16
    v_alignbit_b32 v86, v53, v52, 16
    v_alignbit_b32 v87, v54, v53, 16
    v_alignbit_b32 v88, v55, v54, 16
    v_alignbit_b32 v89, v56, v55, 16
    v_alignbit_b32 v90, v57, v56, 16
    v_alignbit_b32 v91, v58, v57, 16
    v_alignbit_b32 v92, v59, v58, 16
    v_alignbit_b32 v93, v60, v59, 16
    v_alignbit_b32 v94, v61, v60, 16
    v_alignbit_b32 v95, v62, v61, 16
    v_alignbit_b32 v96, v63, v62, 16
    v_alignbit_b32 v97, v64, v63, 16
    v_alignbit_b32 v98, v65, v64, 16
    v_alignbit_b32 v99, v66, v65, 16
    v_alignbit_b32 v100, v67, v66, 16
    v_dot2_f32_bf16 v102, v84, v199, 0
    v_dot2_f32_bf16 v103, v51, v199, 0
    v_dot2_f32_bf16 v106, v85, v199, 0
    v_dot2_f32_bf16 v107, v52, v199, 0
    v_dot2_f32_bf16 v110, v86, v199, 0
    v_dot2_f32_bf16 v111, v53, v199, 0
    v_dot2_f32_bf16 v114, v87, v199, 0
    v_dot2_f32_bf16 v115, v54, v199, 0
    v_dot2_f32_bf16 v102, v85, v198, v102
    v_dot2_f32_bf16 v103, v52, v198, v103
    v_dot2_f32_bf16 v106, v86, v198, v106
    v_dot2_f32_bf16 v107, v53, v198, v107
    v_dot2_f32_bf16 v110, v87, v198, v110
    v_dot2_f32_bf16 v111, v54, v198, v111
    v_dot2_f32_bf16 v114, v88, v198, v114
    v_dot2_f32_bf16 v115, v55, v198, v115
    v_lshlrev_b32 v104, 16, v68
    v_and_b32 v105, 0xffff0000, v68
    v_lshlrev_b32 v108, 16, v69
    v_and_b32 v109, 0xffff0000, v69
    v_lshlrev_b32 v112, 16, v70
    v_and_b32 v113, 0xffff0000, v70
    v_lshlrev_b32 v116, 16, v71
    v_and_b32 v117, 0xffff0000, v71
    v_mul_f32 v102, v102, v104
    v_mul_f32 v103, v103, v105
    v_mul_f32 v106, v106, v108
    v_mul_f32 v107, v107, v109
    v_mul_f32 v110, v110, v112
    v_mul_f32 v111, v111, v113
    v_mul_f32 v114, v114, v116
    v_mul_f32 v115, v115, v117
    v_cvt_pk_bf16_f32 v153, v103, v102
    v_cvt_pk_bf16_f32 v152, v107, v106
    v_cvt_pk_bf16_f32 v151, v111, v110
    v_cvt_pk_bf16_f32 v150, v115, v114
    s_add_u32 s4, s72, 65536
    buffer_store_dwordx4 v[150:153], v12, s[8:11], s4 offen offset:0
    v_dot2_f32_bf16 v118, v88, v199, 0
    v_dot2_f32_bf16 v119, v55, v199, 0
    v_dot2_f32_bf16 v122, v89, v199, 0
    v_dot2_f32_bf16 v123, v56, v199, 0
    v_dot2_f32_bf16 v126, v90, v199, 0
    v_dot2_f32_bf16 v127, v57, v199, 0
    v_dot2_f32_bf16 v130, v91, v199, 0
    v_dot2_f32_bf16 v131, v58, v199, 0
    v_dot2_f32_bf16 v118, v89, v198, v118
    v_dot2_f32_bf16 v119, v56, v198, v119
    v_dot2_f32_bf16 v122, v90, v198, v122
    v_dot2_f32_bf16 v123, v57, v198, v123
    v_dot2_f32_bf16 v126, v91, v198, v126
    v_dot2_f32_bf16 v127, v58, v198, v127
    v_dot2_f32_bf16 v130, v92, v198, v130
    v_dot2_f32_bf16 v131, v59, v198, v131
    v_lshlrev_b32 v120, 16, v72
    v_and_b32 v121, 0xffff0000, v72
    v_lshlrev_b32 v124, 16, v73
    v_and_b32 v125, 0xffff0000, v73
    v_lshlrev_b32 v128, 16, v74
    v_and_b32 v129, 0xffff0000, v74
    v_lshlrev_b32 v132, 16, v75
    v_and_b32 v133, 0xffff0000, v75
    v_mul_f32 v118, v118, v120
    v_mul_f32 v119, v119, v121
    v_mul_f32 v122, v122, v124
    v_mul_f32 v123, v123, v125
    v_mul_f32 v126, v126, v128
    v_mul_f32 v127, v127, v129
    v_mul_f32 v130, v130, v132
    v_mul_f32 v131, v131, v133
    v_cvt_pk_bf16_f32 v157, v119, v118
    v_cvt_pk_bf16_f32 v156, v123, v122
    v_cvt_pk_bf16_f32 v155, v127, v126
    v_cvt_pk_bf16_f32 v154, v131, v130
    buffer_store_dwordx4 v[154:157], v12, s[8:11], s4 offen offset:1024
    v_dot2_f32_bf16 v102, v92, v199, 0
    v_dot2_f32_bf16 v103, v59, v199, 0
    v_dot2_f32_bf16 v106, v93, v199, 0
    v_dot2_f32_bf16 v107, v60, v199, 0
    v_dot2_f32_bf16 v110, v94, v199, 0
    v_dot2_f32_bf16 v111, v61, v199, 0
    v_dot2_f32_bf16 v114, v95, v199, 0
    v_dot2_f32_bf16 v115, v62, v199, 0
    v_dot2_f32_bf16 v102, v93, v198, v102
    v_dot2_f32_bf16 v103, v60, v198, v103
    v_dot2_f32_bf16 v106, v94, v198, v106
    v_dot2_f32_bf16 v107, v61, v198, v107
    v_dot2_f32_bf16 v110, v95, v198, v110
    v_dot2_f32_bf16 v111, v62, v198, v111
    v_dot2_f32_bf16 v114, v96, v198, v114
    v_dot2_f32_bf16 v115, v63, v198, v115
    v_lshlrev_b32 v104, 16, v76
    v_and_b32 v105, 0xffff0000, v76
    v_lshlrev_b32 v108, 16, v77
    v_and_b32 v109, 0xffff0000, v77
    v_lshlrev_b32 v112, 16, v78
    v_and_b32 v113, 0xffff0000, v78
    v_lshlrev_b32 v116, 16, v79
    v_and_b32 v117, 0xffff0000, v79
    v_mul_f32 v102, v102, v104
    v_mul_f32 v103, v103, v105
    v_mul_f32 v106, v106, v108
    v_mul_f32 v107, v107, v109
    v_mul_f32 v110, v110, v112
    v_mul_f32 v111, v111, v113
    v_mul_f32 v114, v114, v116
    v_mul_f32 v115, v115, v117
    v_cvt_pk_bf16_f32 v161, v103, v102
    v_cvt_pk_bf16_f32 v160, v107, v106
    v_cvt_pk_bf16_f32 v159, v111, v110
    v_cvt_pk_bf16_f32 v158, v115, v114
    buffer_store_dwordx4 v[158:161], v12, s[8:11], s4 offen offset:2048
    v_dot2_f32_bf16 v118, v96, v199, 0
    v_dot2_f32_bf16 v119, v63, v199, 0
    v_dot2_f32_bf16 v122, v97, v199, 0
    v_dot2_f32_bf16 v123, v64, v199, 0
    v_dot2_f32_bf16 v126, v98, v199, 0
    v_dot2_f32_bf16 v127, v65, v199, 0
    v_dot2_f32_bf16 v130, v99, v199, 0
    v_dot2_f32_bf16 v131, v66, v199, 0
    v_dot2_f32_bf16 v118, v97, v198, v118
    v_dot2_f32_bf16 v119, v64, v198, v119
    v_dot2_f32_bf16 v122, v98, v198, v122
    v_dot2_f32_bf16 v123, v65, v198, v123
    v_dot2_f32_bf16 v126, v99, v198, v126
    v_dot2_f32_bf16 v127, v66, v198, v127
    v_dot2_f32_bf16 v130, v100, v198, v130
    v_dot2_f32_bf16 v131, v67, v198, v131
    v_lshlrev_b32 v120, 16, v80
    v_and_b32 v121, 0xffff0000, v80
    v_lshlrev_b32 v124, 16, v81
    v_and_b32 v125, 0xffff0000, v81
    v_lshlrev_b32 v128, 16, v82
    v_and_b32 v129, 0xffff0000, v82
    v_lshlrev_b32 v132, 16, v83
    v_and_b32 v133, 0xffff0000, v83
    v_mul_f32 v118, v118, v120
    v_mul_f32 v119, v119, v121
    v_mul_f32 v122, v122, v124
    v_mul_f32 v123, v123, v125
    v_mul_f32 v126, v126, v128
    v_mul_f32 v127, v127, v129
    v_mul_f32 v130, v130, v132
    v_mul_f32 v131, v131, v133
    v_cvt_pk_bf16_f32 v165, v119, v118
    v_cvt_pk_bf16_f32 v164, v123, v122
    v_cvt_pk_bf16_f32 v163, v127, v126
    v_cvt_pk_bf16_f32 v162, v131, v130
    buffer_store_dwordx4 v[162:165], v12, s[8:11], s4 offen offset:3072
    s_waitcnt vmcnt(25)
    ds_read_b64_tr_b16 v[16:17], v11 offset:16640
    ds_read_b64_tr_b16 v[18:19], v11 offset:16896
    ds_read_b64_tr_b16 v[20:21], v11 offset:17152
    ds_read_b64_tr_b16 v[22:23], v11 offset:17408
    ds_read_b64_tr_b16 v[24:25], v11 offset:17664
    ds_read_b64_tr_b16 v[26:27], v11 offset:17920
    ds_read_b64_tr_b16 v[28:29], v11 offset:18176
    ds_read_b64_tr_b16 v[30:31], v11 offset:18432
    ds_read_b64_tr_b16 v[32:33], v11 offset:18688
    ds_read_b64_tr_b16 v[34:35], v11 offset:25088
    ds_read_b64_tr_b16 v[36:37], v11 offset:25344
    ds_read_b64_tr_b16 v[38:39], v11 offset:25600
    ds_read_b64_tr_b16 v[40:41], v11 offset:25856
    ds_read_b64_tr_b16 v[42:43], v11 offset:26112
    ds_read_b64_tr_b16 v[44:45], v11 offset:26368
    ds_read_b64_tr_b16 v[46:47], v11 offset:26624
    ds_read_b64_tr_b16 v[48:49], v11 offset:26880
    ds_read_b64_tr_b16 v[50:51], v11 offset:16672
    ds_read_b64_tr_b16 v[52:53], v11 offset:16928
    ds_read_b64_tr_b16 v[54:55], v11 offset:17184
    ds_read_b64_tr_b16 v[56:57], v11 offset:17440
    ds_read_b64_tr_b16 v[58:59], v11 offset:17696
    ds_read_b64_tr_b16 v[60:61], v11 offset:17952
    ds_read_b64_tr_b16 v[62:63], v11 offset:18208
    ds_read_b64_tr_b16 v[64:65], v11 offset:18464
    ds_read_b64_tr_b16 v[66:67], v11 offset:18720
    ds_read_b64_tr_b16 v[68:69], v11 offset:25120
    ds_read_b64_tr_b16 v[70:71], v11 offset:25376
    ds_read_b64_tr_b16 v[72:73], v11 offset:25632
    ds_read_b64_tr_b16 v[74:75], v11 offset:25888
    ds_read_b64_tr_b16 v[76:77], v11 offset:26144
    ds_read_b64_tr_b16 v[78:79], v11 offset:26400
    ds_read_b64_tr_b16 v[80:81], v11 offset:26656
    ds_read_b64_tr_b16 v[82:83], v11 offset:26912
    s_waitcnt lgkmcnt(0)
    s_add_u32 s4, s70, 786432
    s_add_u32 m0, s71, 16640
    s_sub_u32 s5, s4, 8192
    s_max_i32 s5, s5, 0
    s_mov_b64 exec, 0xffff
    buffer_load_dwordx4 v10, s[80:83], s5 offen lds
    s_mov_b64 exec, -1

    s_add_u32 m0, s71, 16896
    s_nop 0
    buffer_load_dwordx4 v10, s[80:83], s4 offen lds
    s_add_u32 m0, s71, 25088
    s_nop 0
    buffer_load_dwordx4 v10, s[84:87], s4 offen lds
    s_add_u32 m0, s71, 17920
    s_add_u32 s4, s4, 32768
    buffer_load_dwordx4 v10, s[80:83], s4 offen lds
    s_add_u32 m0, s71, 26112
    s_nop 0
    buffer_load_dwordx4 v10, s[84:87], s4 offen lds
    s_add_u32 m0, s71, 18944
    s_add_u32 s4, s4, 32768
    buffer_load_dwordx4 v10, s[80:83], s4 offen lds
    s_add_u32 m0, s71, 27136
    s_nop 0
    buffer_load_dwordx4 v10, s[84:87], s4 offen lds
    s_add_u32 m0, s71, 19968
    s_add_u32 s4, s4, 32768
    buffer_load_dwordx4 v10, s[80:83], s4 offen lds
    s_add_u32 m0, s71, 28160
    s_nop 0
    buffer_load_dwordx4 v10, s[84:87], s4 offen lds
    s_add_u32 m0, s71, 20992
    s_add_u32 s4, s4, 32768
    buffer_load_dwordx4 v10, s[80:83], s4 offen lds
    s_add_u32 m0, s71, 29184
    s_nop 0
    buffer_load_dwordx4 v10, s[84:87], s4 offen lds
    s_add_u32 m0, s71, 22016
    s_add_u32 s4, s4, 32768
    buffer_load_dwordx4 v10, s[80:83], s4 offen lds
    s_add_u32 m0, s71, 30208
    s_nop 0
    buffer_load_dwordx4 v10, s[84:87], s4 offen lds
    s_add_u32 m0, s71, 23040
    s_add_u32 s4, s4, 32768
    buffer_load_dwordx4 v10, s[80:83], s4 offen lds
    s_add_u32 m0, s71, 31232
    s_nop 0
    buffer_load_dwordx4 v10, s[84:87], s4 offen lds
    s_add_u32 m0, s71, 24064
    s_add_u32 s4, s4, 32768
    buffer_load_dwordx4 v10, s[80:83], s4 offen lds
    s_add_u32 m0, s71, 32256
    s_nop 0
    buffer_load_dwordx4 v10, s[84:87], s4 offen lds
    v_alignbit_b32 v84, v17, v16, 16
    v_alignbit_b32 v85, v18, v17, 16
    v_alignbit_b32 v86, v19, v18, 16
    v_alignbit_b32 v87, v20, v19, 16
    v_alignbit_b32 v88, v21, v20, 16
    v_alignbit_b32 v89, v22, v21, 16
    v_alignbit_b32 v90, v23, v22, 16
    v_alignbit_b32 v91, v24, v23, 16
    v_alignbit_b32 v92, v25, v24, 16
    v_alignbit_b32 v93, v26, v25, 16
    v_alignbit_b32 v94, v27, v26, 16
    v_alignbit_b32 v95, v28, v27, 16
    v_alignbit_b32 v96, v29, v28, 16
    v_alignbit_b32 v97, v30, v29, 16
    v_alignbit_b32 v98, v31, v30, 16
    v_alignbit_b32 v99, v32, v31, 16
    v_alignbit_b32 v100, v33, v32, 16
    v_dot2_f32_bf16 v102, v84, v197, 0
    v_dot2_f32_bf16 v103, v17, v197, 0
    v_dot2_f32_bf16 v106, v85, v197, 0
    v_dot2_f32_bf16 v107, v18, v197, 0
    v_dot2_f32_bf16 v110, v86, v197, 0
    v_dot2_f32_bf16 v111, v19, v197, 0
    v_dot2_f32_bf16 v114, v87, v197, 0
    v_dot2_f32_bf16 v115, v20, v197, 0
    v_dot2_f32_bf16 v102, v85, v196, v102
    v_dot2_f32_bf16 v103, v18, v196, v103
    v_dot2_f32_bf16 v106, v86, v196, v106
    v_dot2_f32_bf16 v107, v19, v196, v107
    v_dot2_f32_bf16 v110, v87, v196, v110
    v_dot2_f32_bf16 v111, v20, v196, v111
    v_dot2_f32_bf16 v114, v88, v196, v114
    v_dot2_f32_bf16 v115, v21, v196, v115
    v_lshlrev_b32 v104, 16, v34
    v_and_b32 v105, 0xffff0000, v34
    v_lshlrev_b32 v108, 16, v35
    v_and_b32 v109, 0xffff0000, v35
    v_lshlrev_b32 v112, 16, v36
    v_and_b32 v113, 0xffff0000, v36
    v_lshlrev_b32 v116, 16, v37
    v_and_b32 v117, 0xffff0000, v37
    v_mul_f32 v102, v102, v104
    v_mul_f32 v103, v103, v105
    v_mul_f32 v106, v106, v108
    v_mul_f32 v107, v107, v109
    v_mul_f32 v110, v110, v112
    v_mul_f32 v111, v111, v113
    v_mul_f32 v114, v114, v116
    v_mul_f32 v115, v115, v117
    v_cvt_pk_bf16_f32 v137, v103, v102
    v_cvt_pk_bf16_f32 v136, v107, v106
    v_cvt_pk_bf16_f32 v135, v111, v110
    v_cvt_pk_bf16_f32 v134, v115, v114
    s_add_u32 s4, s72, 64
    buffer_store_dwordx4 v[134:137], v12, s[8:11], s4 offen offset:0
    v_dot2_f32_bf16 v118, v88, v197, 0
    v_dot2_f32_bf16 v119, v21, v197, 0
    v_dot2_f32_bf16 v122, v89, v197, 0
    v_dot2_f32_bf16 v123, v22, v197, 0
    v_dot2_f32_bf16 v126, v90, v197, 0
    v_dot2_f32_bf16 v127, v23, v197, 0
    v_dot2_f32_bf16 v130, v91, v197, 0
    v_dot2_f32_bf16 v131, v24, v197, 0
    v_dot2_f32_bf16 v118, v89, v196, v118
    v_dot2_f32_bf16 v119, v22, v196, v119
    v_dot2_f32_bf16 v122, v90, v196, v122
    v_dot2_f32_bf16 v123, v23, v196, v123
    v_dot2_f32_bf16 v126, v91, v196, v126
    v_dot2_f32_bf16 v127, v24, v196, v127
    v_dot2_f32_bf16 v130, v92, v196, v130
    v_dot2_f32_bf16 v131, v25, v196, v131
    v_lshlrev_b32 v120, 16, v38
    v_and_b32 v121, 0xffff0000, v38
    v_lshlrev_b32 v124, 16, v39
    v_and_b32 v125, 0xffff0000, v39
    v_lshlrev_b32 v128, 16, v40
    v_and_b32 v129, 0xffff0000, v40
    v_lshlrev_b32 v132, 16, v41
    v_and_b32 v133, 0xffff0000, v41
    v_mul_f32 v118, v118, v120
    v_mul_f32 v119, v119, v121
    v_mul_f32 v122, v122, v124
    v_mul_f32 v123, v123, v125
    v_mul_f32 v126, v126, v128
    v_mul_f32 v127, v127, v129
    v_mul_f32 v130, v130, v132
    v_mul_f32 v131, v131, v133
    v_cvt_pk_bf16_f32 v141, v119, v118
    v_cvt_pk_bf16_f32 v140, v123, v122
    v_cvt_pk_bf16_f32 v139, v127, v126
    v_cvt_pk_bf16_f32 v138, v131, v130
    buffer_store_dwordx4 v[138:141], v12, s[8:11], s4 offen offset:1024
    v_dot2_f32_bf16 v102, v92, v197, 0
    v_dot2_f32_bf16 v103, v25, v197, 0
    v_dot2_f32_bf16 v106, v93, v197, 0
    v_dot2_f32_bf16 v107, v26, v197, 0
    v_dot2_f32_bf16 v110, v94, v197, 0
    v_dot2_f32_bf16 v111, v27, v197, 0
    v_dot2_f32_bf16 v114, v95, v197, 0
    v_dot2_f32_bf16 v115, v28, v197, 0
    v_dot2_f32_bf16 v102, v93, v196, v102
    v_dot2_f32_bf16 v103, v26, v196, v103
    v_dot2_f32_bf16 v106, v94, v196, v106
    v_dot2_f32_bf16 v107, v27, v196, v107
    v_dot2_f32_bf16 v110, v95, v196, v110
    v_dot2_f32_bf16 v111, v28, v196, v111
    v_dot2_f32_bf16 v114, v96, v196, v114
    v_dot2_f32_bf16 v115, v29, v196, v115
    v_lshlrev_b32 v104, 16, v42
    v_and_b32 v105, 0xffff0000, v42
    v_lshlrev_b32 v108, 16, v43
    v_and_b32 v109, 0xffff0000, v43
    v_lshlrev_b32 v112, 16, v44
    v_and_b32 v113, 0xffff0000, v44
    v_lshlrev_b32 v116, 16, v45
    v_and_b32 v117, 0xffff0000, v45
    v_mul_f32 v102, v102, v104
    v_mul_f32 v103, v103, v105
    v_mul_f32 v106, v106, v108
    v_mul_f32 v107, v107, v109
    v_mul_f32 v110, v110, v112
    v_mul_f32 v111, v111, v113
    v_mul_f32 v114, v114, v116
    v_mul_f32 v115, v115, v117
    v_cvt_pk_bf16_f32 v145, v103, v102
    v_cvt_pk_bf16_f32 v144, v107, v106
    v_cvt_pk_bf16_f32 v143, v111, v110
    v_cvt_pk_bf16_f32 v142, v115, v114
    buffer_store_dwordx4 v[142:145], v12, s[8:11], s4 offen offset:2048
    v_dot2_f32_bf16 v118, v96, v197, 0
    v_dot2_f32_bf16 v119, v29, v197, 0
    v_dot2_f32_bf16 v122, v97, v197, 0
    v_dot2_f32_bf16 v123, v30, v197, 0
    v_dot2_f32_bf16 v126, v98, v197, 0
    v_dot2_f32_bf16 v127, v31, v197, 0
    v_dot2_f32_bf16 v130, v99, v197, 0
    v_dot2_f32_bf16 v131, v32, v197, 0
    v_dot2_f32_bf16 v118, v97, v196, v118
    v_dot2_f32_bf16 v119, v30, v196, v119
    v_dot2_f32_bf16 v122, v98, v196, v122
    v_dot2_f32_bf16 v123, v31, v196, v123
    v_dot2_f32_bf16 v126, v99, v196, v126
    v_dot2_f32_bf16 v127, v32, v196, v127
    v_dot2_f32_bf16 v130, v100, v196, v130
    v_dot2_f32_bf16 v131, v33, v196, v131
    v_lshlrev_b32 v120, 16, v46
    v_and_b32 v121, 0xffff0000, v46
    v_lshlrev_b32 v124, 16, v47
    v_and_b32 v125, 0xffff0000, v47
    v_lshlrev_b32 v128, 16, v48
    v_and_b32 v129, 0xffff0000, v48
    v_lshlrev_b32 v132, 16, v49
    v_and_b32 v133, 0xffff0000, v49
    v_mul_f32 v118, v118, v120
    v_mul_f32 v119, v119, v121
    v_mul_f32 v122, v122, v124
    v_mul_f32 v123, v123, v125
    v_mul_f32 v126, v126, v128
    v_mul_f32 v127, v127, v129
    v_mul_f32 v130, v130, v132
    v_mul_f32 v131, v131, v133
    v_cvt_pk_bf16_f32 v149, v119, v118
    v_cvt_pk_bf16_f32 v148, v123, v122
    v_cvt_pk_bf16_f32 v147, v127, v126
    v_cvt_pk_bf16_f32 v146, v131, v130
    buffer_store_dwordx4 v[146:149], v12, s[8:11], s4 offen offset:3072
    v_alignbit_b32 v84, v51, v50, 16
    v_alignbit_b32 v85, v52, v51, 16
    v_alignbit_b32 v86, v53, v52, 16
    v_alignbit_b32 v87, v54, v53, 16
    v_alignbit_b32 v88, v55, v54, 16
    v_alignbit_b32 v89, v56, v55, 16
    v_alignbit_b32 v90, v57, v56, 16
    v_alignbit_b32 v91, v58, v57, 16
    v_alignbit_b32 v92, v59, v58, 16
    v_alignbit_b32 v93, v60, v59, 16
    v_alignbit_b32 v94, v61, v60, 16
    v_alignbit_b32 v95, v62, v61, 16
    v_alignbit_b32 v96, v63, v62, 16
    v_alignbit_b32 v97, v64, v63, 16
    v_alignbit_b32 v98, v65, v64, 16
    v_alignbit_b32 v99, v66, v65, 16
    v_alignbit_b32 v100, v67, v66, 16
    v_dot2_f32_bf16 v102, v84, v199, 0
    v_dot2_f32_bf16 v103, v51, v199, 0
    v_dot2_f32_bf16 v106, v85, v199, 0
    v_dot2_f32_bf16 v107, v52, v199, 0
    v_dot2_f32_bf16 v110, v86, v199, 0
    v_dot2_f32_bf16 v111, v53, v199, 0
    v_dot2_f32_bf16 v114, v87, v199, 0
    v_dot2_f32_bf16 v115, v54, v199, 0
    v_dot2_f32_bf16 v102, v85, v198, v102
    v_dot2_f32_bf16 v103, v52, v198, v103
    v_dot2_f32_bf16 v106, v86, v198, v106
    v_dot2_f32_bf16 v107, v53, v198, v107
    v_dot2_f32_bf16 v110, v87, v198, v110
    v_dot2_f32_bf16 v111, v54, v198, v111
    v_dot2_f32_bf16 v114, v88, v198, v114
    v_dot2_f32_bf16 v115, v55, v198, v115
    v_lshlrev_b32 v104, 16, v68
    v_and_b32 v105, 0xffff0000, v68
    v_lshlrev_b32 v108, 16, v69
    v_and_b32 v109, 0xffff0000, v69
    v_lshlrev_b32 v112, 16, v70
    v_and_b32 v113, 0xffff0000, v70
    v_lshlrev_b32 v116, 16, v71
    v_and_b32 v117, 0xffff0000, v71
    v_mul_f32 v102, v102, v104
    v_mul_f32 v103, v103, v105
    v_mul_f32 v106, v106, v108
    v_mul_f32 v107, v107, v109
    v_mul_f32 v110, v110, v112
    v_mul_f32 v111, v111, v113
    v_mul_f32 v114, v114, v116
    v_mul_f32 v115, v115, v117
    v_cvt_pk_bf16_f32 v153, v103, v102
    v_cvt_pk_bf16_f32 v152, v107, v106
    v_cvt_pk_bf16_f32 v151, v111, v110
    v_cvt_pk_bf16_f32 v150, v115, v114
    s_add_u32 s4, s72, 65600
    buffer_store_dwordx4 v[150:153], v12, s[8:11], s4 offen offset:0
    v_dot2_f32_bf16 v118, v88, v199, 0
    v_dot2_f32_bf16 v119, v55, v199, 0
    v_dot2_f32_bf16 v122, v89, v199, 0
    v_dot2_f32_bf16 v123, v56, v199, 0
    v_dot2_f32_bf16 v126, v90, v199, 0
    v_dot2_f32_bf16 v127, v57, v199, 0
    v_dot2_f32_bf16 v130, v91, v199, 0
    v_dot2_f32_bf16 v131, v58, v199, 0
    v_dot2_f32_bf16 v118, v89, v198, v118
    v_dot2_f32_bf16 v119, v56, v198, v119
    v_dot2_f32_bf16 v122, v90, v198, v122
    v_dot2_f32_bf16 v123, v57, v198, v123
    v_dot2_f32_bf16 v126, v91, v198, v126
    v_dot2_f32_bf16 v127, v58, v198, v127
    v_dot2_f32_bf16 v130, v92, v198, v130
    v_dot2_f32_bf16 v131, v59, v198, v131
    v_lshlrev_b32 v120, 16, v72
    v_and_b32 v121, 0xffff0000, v72
    v_lshlrev_b32 v124, 16, v73
    v_and_b32 v125, 0xffff0000, v73
    v_lshlrev_b32 v128, 16, v74
    v_and_b32 v129, 0xffff0000, v74
    v_lshlrev_b32 v132, 16, v75
    v_and_b32 v133, 0xffff0000, v75
    v_mul_f32 v118, v118, v120
    v_mul_f32 v119, v119, v121
    v_mul_f32 v122, v122, v124
    v_mul_f32 v123, v123, v125
    v_mul_f32 v126, v126, v128
    v_mul_f32 v127, v127, v129
    v_mul_f32 v130, v130, v132
    v_mul_f32 v131, v131, v133
    v_cvt_pk_bf16_f32 v157, v119, v118
    v_cvt_pk_bf16_f32 v156, v123, v122
    v_cvt_pk_bf16_f32 v155, v127, v126
    v_cvt_pk_bf16_f32 v154, v131, v130
    buffer_store_dwordx4 v[154:157], v12, s[8:11], s4 offen offset:1024
    v_dot2_f32_bf16 v102, v92, v199, 0
    v_dot2_f32_bf16 v103, v59, v199, 0
    v_dot2_f32_bf16 v106, v93, v199, 0
    v_dot2_f32_bf16 v107, v60, v199, 0
    v_dot2_f32_bf16 v110, v94, v199, 0
    v_dot2_f32_bf16 v111, v61, v199, 0
    v_dot2_f32_bf16 v114, v95, v199, 0
    v_dot2_f32_bf16 v115, v62, v199, 0
    v_dot2_f32_bf16 v102, v93, v198, v102
    v_dot2_f32_bf16 v103, v60, v198, v103
    v_dot2_f32_bf16 v106, v94, v198, v106
    v_dot2_f32_bf16 v107, v61, v198, v107
    v_dot2_f32_bf16 v110, v95, v198, v110
    v_dot2_f32_bf16 v111, v62, v198, v111
    v_dot2_f32_bf16 v114, v96, v198, v114
    v_dot2_f32_bf16 v115, v63, v198, v115
    v_lshlrev_b32 v104, 16, v76
    v_and_b32 v105, 0xffff0000, v76
    v_lshlrev_b32 v108, 16, v77
    v_and_b32 v109, 0xffff0000, v77
    v_lshlrev_b32 v112, 16, v78
    v_and_b32 v113, 0xffff0000, v78
    v_lshlrev_b32 v116, 16, v79
    v_and_b32 v117, 0xffff0000, v79
    v_mul_f32 v102, v102, v104
    v_mul_f32 v103, v103, v105
    v_mul_f32 v106, v106, v108
    v_mul_f32 v107, v107, v109
    v_mul_f32 v110, v110, v112
    v_mul_f32 v111, v111, v113
    v_mul_f32 v114, v114, v116
    v_mul_f32 v115, v115, v117
    v_cvt_pk_bf16_f32 v161, v103, v102
    v_cvt_pk_bf16_f32 v160, v107, v106
    v_cvt_pk_bf16_f32 v159, v111, v110
    v_cvt_pk_bf16_f32 v158, v115, v114
    buffer_store_dwordx4 v[158:161], v12, s[8:11], s4 offen offset:2048
    v_dot2_f32_bf16 v118, v96, v199, 0
    v_dot2_f32_bf16 v119, v63, v199, 0
    v_dot2_f32_bf16 v122, v97, v199, 0
    v_dot2_f32_bf16 v123, v64, v199, 0
    v_dot2_f32_bf16 v126, v98, v199, 0
    v_dot2_f32_bf16 v127, v65, v199, 0
    v_dot2_f32_bf16 v130, v99, v199, 0
    v_dot2_f32_bf16 v131, v66, v199, 0
    v_dot2_f32_bf16 v118, v97, v198, v118
    v_dot2_f32_bf16 v119, v64, v198, v119
    v_dot2_f32_bf16 v122, v98, v198, v122
    v_dot2_f32_bf16 v123, v65, v198, v123
    v_dot2_f32_bf16 v126, v99, v198, v126
    v_dot2_f32_bf16 v127, v66, v198, v127
    v_dot2_f32_bf16 v130, v100, v198, v130
    v_dot2_f32_bf16 v131, v67, v198, v131
    v_lshlrev_b32 v120, 16, v80
    v_and_b32 v121, 0xffff0000, v80
    v_lshlrev_b32 v124, 16, v81
    v_and_b32 v125, 0xffff0000, v81
    v_lshlrev_b32 v128, 16, v82
    v_and_b32 v129, 0xffff0000, v82
    v_lshlrev_b32 v132, 16, v83
    v_and_b32 v133, 0xffff0000, v83
    v_mul_f32 v118, v118, v120
    v_mul_f32 v119, v119, v121
    v_mul_f32 v122, v122, v124
    v_mul_f32 v123, v123, v125
    v_mul_f32 v126, v126, v128
    v_mul_f32 v127, v127, v129
    v_mul_f32 v130, v130, v132
    v_mul_f32 v131, v131, v133
    v_cvt_pk_bf16_f32 v165, v119, v118
    v_cvt_pk_bf16_f32 v164, v123, v122
    v_cvt_pk_bf16_f32 v163, v127, v126
    v_cvt_pk_bf16_f32 v162, v131, v130
    buffer_store_dwordx4 v[162:165], v12, s[8:11], s4 offen offset:3072
    s_waitcnt vmcnt(25)
    ds_read_b64_tr_b16 v[16:17], v11 offset:0
    ds_read_b64_tr_b16 v[18:19], v11 offset:256
    ds_read_b64_tr_b16 v[20:21], v11 offset:512
    ds_read_b64_tr_b16 v[22:23], v11 offset:768
    ds_read_b64_tr_b16 v[24:25], v11 offset:1024
    ds_read_b64_tr_b16 v[26:27], v11 offset:1280
    ds_read_b64_tr_b16 v[28:29], v11 offset:1536
    ds_read_b64_tr_b16 v[30:31], v11 offset:1792
    ds_read_b64_tr_b16 v[32:33], v11 offset:2048
    ds_read_b64_tr_b16 v[34:35], v11 offset:8448
    ds_read_b64_tr_b16 v[36:37], v11 offset:8704
    ds_read_b64_tr_b16 v[38:39], v11 offset:8960
    ds_read_b64_tr_b16 v[40:41], v11 offset:9216
    ds_read_b64_tr_b16 v[42:43], v11 offset:9472
    ds_read_b64_tr_b16 v[44:45], v11 offset:9728
    ds_read_b64_tr_b16 v[46:47], v11 offset:9984
    ds_read_b64_tr_b16 v[48:49], v11 offset:10240
    ds_read_b64_tr_b16 v[50:51], v11 offset:32
    ds_read_b64_tr_b16 v[52:53], v11 offset:288
    ds_read_b64_tr_b16 v[54:55], v11 offset:544
    ds_read_b64_tr_b16 v[56:57], v11 offset:800
    ds_read_b64_tr_b16 v[58:59], v11 offset:1056
    ds_read_b64_tr_b16 v[60:61], v11 offset:1312
    ds_read_b64_tr_b16 v[62:63], v11 offset:1568
    ds_read_b64_tr_b16 v[64:65], v11 offset:1824
    ds_read_b64_tr_b16 v[66:67], v11 offset:2080
    ds_read_b64_tr_b16 v[68:69], v11 offset:8480
    ds_read_b64_tr_b16 v[70:71], v11 offset:8736
    ds_read_b64_tr_b16 v[72:73], v11 offset:8992
    ds_read_b64_tr_b16 v[74:75], v11 offset:9248
    ds_read_b64_tr_b16 v[76:77], v11 offset:9504
    ds_read_b64_tr_b16 v[78:79], v11 offset:9760
    ds_read_b64_tr_b16 v[80:81], v11 offset:10016
    ds_read_b64_tr_b16 v[82:83], v11 offset:10272
    s_waitcnt lgkmcnt(0)
    v_alignbit_b32 v84, v17, v16, 16
    v_alignbit_b32 v85, v18, v17, 16
    v_alignbit_b32 v86, v19, v18, 16
    v_alignbit_b32 v87, v20, v19, 16
    v_alignbit_b32 v88, v21, v20, 16
    v_alignbit_b32 v89, v22, v21, 16
    v_alignbit_b32 v90, v23, v22, 16
    v_alignbit_b32 v91, v24, v23, 16
    v_alignbit_b32 v92, v25, v24, 16
    v_alignbit_b32 v93, v26, v25, 16
    v_alignbit_b32 v94, v27, v26, 16
    v_alignbit_b32 v95, v28, v27, 16
    v_alignbit_b32 v96, v29, v28, 16
    v_alignbit_b32 v97, v30, v29, 16
    v_alignbit_b32 v98, v31, v30, 16
    v_alignbit_b32 v99, v32, v31, 16
    v_alignbit_b32 v100, v33, v32, 16
    v_dot2_f32_bf16 v102, v84, v197, 0
    v_dot2_f32_bf16 v103, v17, v197, 0
    v_dot2_f32_bf16 v106, v85, v197, 0
    v_dot2_f32_bf16 v107, v18, v197, 0
    v_dot2_f32_bf16 v110, v86, v197, 0
    v_dot2_f32_bf16 v111, v19, v197, 0
    v_dot2_f32_bf16 v114, v87, v197, 0
    v_dot2_f32_bf16 v115, v20, v197, 0
    v_dot2_f32_bf16 v102, v85, v196, v102
    v_dot2_f32_bf16 v103, v18, v196, v103
    v_dot2_f32_bf16 v106, v86, v196, v106
    v_dot2_f32_bf16 v107, v19, v196, v107
    v_dot2_f32_bf16 v110, v87, v196, v110
    v_dot2_f32_bf16 v111, v20, v196, v111
    v_dot2_f32_bf16 v114, v88, v196, v114
    v_dot2_f32_bf16 v115, v21, v196, v115
    v_lshlrev_b32 v104, 16, v34
    v_and_b32 v105, 0xffff0000, v34
    v_lshlrev_b32 v108, 16, v35
    v_and_b32 v109, 0xffff0000, v35
    v_lshlrev_b32 v112, 16, v36
    v_and_b32 v113, 0xffff0000, v36
    v_lshlrev_b32 v116, 16, v37
    v_and_b32 v117, 0xffff0000, v37
    v_mul_f32 v102, v102, v104
    v_mul_f32 v103, v103, v105
    v_mul_f32 v106, v106, v108
    v_mul_f32 v107, v107, v109
    v_mul_f32 v110, v110, v112
    v_mul_f32 v111, v111, v113
    v_mul_f32 v114, v114, v116
    v_mul_f32 v115, v115, v117
    v_cvt_pk_bf16_f32 v137, v103, v102
    v_cvt_pk_bf16_f32 v136, v107, v106
    v_cvt_pk_bf16_f32 v135, v111, v110
    v_cvt_pk_bf16_f32 v134, v115, v114
    s_add_u32 s4, s72, 128
    buffer_store_dwordx4 v[134:137], v12, s[8:11], s4 offen offset:0
    v_dot2_f32_bf16 v118, v88, v197, 0
    v_dot2_f32_bf16 v119, v21, v197, 0
    v_dot2_f32_bf16 v122, v89, v197, 0
    v_dot2_f32_bf16 v123, v22, v197, 0
    v_dot2_f32_bf16 v126, v90, v197, 0
    v_dot2_f32_bf16 v127, v23, v197, 0
    v_dot2_f32_bf16 v130, v91, v197, 0
    v_dot2_f32_bf16 v131, v24, v197, 0
    v_dot2_f32_bf16 v118, v89, v196, v118
    v_dot2_f32_bf16 v119, v22, v196, v119
    v_dot2_f32_bf16 v122, v90, v196, v122
    v_dot2_f32_bf16 v123, v23, v196, v123
    v_dot2_f32_bf16 v126, v91, v196, v126
    v_dot2_f32_bf16 v127, v24, v196, v127
    v_dot2_f32_bf16 v130, v92, v196, v130
    v_dot2_f32_bf16 v131, v25, v196, v131
    v_lshlrev_b32 v120, 16, v38
    v_and_b32 v121, 0xffff0000, v38
    v_lshlrev_b32 v124, 16, v39
    v_and_b32 v125, 0xffff0000, v39
    v_lshlrev_b32 v128, 16, v40
    v_and_b32 v129, 0xffff0000, v40
    v_lshlrev_b32 v132, 16, v41
    v_and_b32 v133, 0xffff0000, v41
    v_mul_f32 v118, v118, v120
    v_mul_f32 v119, v119, v121
    v_mul_f32 v122, v122, v124
    v_mul_f32 v123, v123, v125
    v_mul_f32 v126, v126, v128
    v_mul_f32 v127, v127, v129
    v_mul_f32 v130, v130, v132
    v_mul_f32 v131, v131, v133
    v_cvt_pk_bf16_f32 v141, v119, v118
    v_cvt_pk_bf16_f32 v140, v123, v122
    v_cvt_pk_bf16_f32 v139, v127, v126
    v_cvt_pk_bf16_f32 v138, v131, v130
    buffer_store_dwordx4 v[138:141], v12, s[8:11], s4 offen offset:1024
    v_dot2_f32_bf16 v102, v92, v197, 0
    v_dot2_f32_bf16 v103, v25, v197, 0
    v_dot2_f32_bf16 v106, v93, v197, 0
    v_dot2_f32_bf16 v107, v26, v197, 0
    v_dot2_f32_bf16 v110, v94, v197, 0
    v_dot2_f32_bf16 v111, v27, v197, 0
    v_dot2_f32_bf16 v114, v95, v197, 0
    v_dot2_f32_bf16 v115, v28, v197, 0
    v_dot2_f32_bf16 v102, v93, v196, v102
    v_dot2_f32_bf16 v103, v26, v196, v103
    v_dot2_f32_bf16 v106, v94, v196, v106
    v_dot2_f32_bf16 v107, v27, v196, v107
    v_dot2_f32_bf16 v110, v95, v196, v110
    v_dot2_f32_bf16 v111, v28, v196, v111
    v_dot2_f32_bf16 v114, v96, v196, v114
    v_dot2_f32_bf16 v115, v29, v196, v115
    v_lshlrev_b32 v104, 16, v42
    v_and_b32 v105, 0xffff0000, v42
    v_lshlrev_b32 v108, 16, v43
    v_and_b32 v109, 0xffff0000, v43
    v_lshlrev_b32 v112, 16, v44
    v_and_b32 v113, 0xffff0000, v44
    v_lshlrev_b32 v116, 16, v45
    v_and_b32 v117, 0xffff0000, v45
    v_mul_f32 v102, v102, v104
    v_mul_f32 v103, v103, v105
    v_mul_f32 v106, v106, v108
    v_mul_f32 v107, v107, v109
    v_mul_f32 v110, v110, v112
    v_mul_f32 v111, v111, v113
    v_mul_f32 v114, v114, v116
    v_mul_f32 v115, v115, v117
    v_cvt_pk_bf16_f32 v145, v103, v102
    v_cvt_pk_bf16_f32 v144, v107, v106
    v_cvt_pk_bf16_f32 v143, v111, v110
    v_cvt_pk_bf16_f32 v142, v115, v114
    buffer_store_dwordx4 v[142:145], v12, s[8:11], s4 offen offset:2048
    v_dot2_f32_bf16 v118, v96, v197, 0
    v_dot2_f32_bf16 v119, v29, v197, 0
    v_dot2_f32_bf16 v122, v97, v197, 0
    v_dot2_f32_bf16 v123, v30, v197, 0
    v_dot2_f32_bf16 v126, v98, v197, 0
    v_dot2_f32_bf16 v127, v31, v197, 0
    v_dot2_f32_bf16 v130, v99, v197, 0
    v_dot2_f32_bf16 v131, v32, v197, 0
    v_dot2_f32_bf16 v118, v97, v196, v118
    v_dot2_f32_bf16 v119, v30, v196, v119
    v_dot2_f32_bf16 v122, v98, v196, v122
    v_dot2_f32_bf16 v123, v31, v196, v123
    v_dot2_f32_bf16 v126, v99, v196, v126
    v_dot2_f32_bf16 v127, v32, v196, v127
    v_dot2_f32_bf16 v130, v100, v196, v130
    v_dot2_f32_bf16 v131, v33, v196, v131
    v_lshlrev_b32 v120, 16, v46
    v_and_b32 v121, 0xffff0000, v46
    v_lshlrev_b32 v124, 16, v47
    v_and_b32 v125, 0xffff0000, v47
    v_lshlrev_b32 v128, 16, v48
    v_and_b32 v129, 0xffff0000, v48
    v_lshlrev_b32 v132, 16, v49
    v_and_b32 v133, 0xffff0000, v49
    v_mul_f32 v118, v118, v120
    v_mul_f32 v119, v119, v121
    v_mul_f32 v122, v122, v124
    v_mul_f32 v123, v123, v125
    v_mul_f32 v126, v126, v128
    v_mul_f32 v127, v127, v129
    v_mul_f32 v130, v130, v132
    v_mul_f32 v131, v131, v133
    v_cvt_pk_bf16_f32 v149, v119, v118
    v_cvt_pk_bf16_f32 v148, v123, v122
    v_cvt_pk_bf16_f32 v147, v127, v126
    v_cvt_pk_bf16_f32 v146, v131, v130
    buffer_store_dwordx4 v[146:149], v12, s[8:11], s4 offen offset:3072
    v_alignbit_b32 v84, v51, v50, 16
    v_alignbit_b32 v85, v52, v51, 16
    v_alignbit_b32 v86, v53, v52, 16
    v_alignbit_b32 v87, v54, v53, 16
    v_alignbit_b32 v88, v55, v54, 16
    v_alignbit_b32 v89, v56, v55, 16
    v_alignbit_b32 v90, v57, v56, 16
    v_alignbit_b32 v91, v58, v57, 16
    v_alignbit_b32 v92, v59, v58, 16
    v_alignbit_b32 v93, v60, v59, 16
    v_alignbit_b32 v94, v61, v60, 16
    v_alignbit_b32 v95, v62, v61, 16
    v_alignbit_b32 v96, v63, v62, 16
    v_alignbit_b32 v97, v64, v63, 16
    v_alignbit_b32 v98, v65, v64, 16
    v_alignbit_b32 v99, v66, v65, 16
    v_alignbit_b32 v100, v67, v66, 16
    v_dot2_f32_bf16 v102, v84, v199, 0
    v_dot2_f32_bf16 v103, v51, v199, 0
    v_dot2_f32_bf16 v106, v85, v199, 0
    v_dot2_f32_bf16 v107, v52, v199, 0
    v_dot2_f32_bf16 v110, v86, v199, 0
    v_dot2_f32_bf16 v111, v53, v199, 0
    v_dot2_f32_bf16 v114, v87, v199, 0
    v_dot2_f32_bf16 v115, v54, v199, 0
    v_dot2_f32_bf16 v102, v85, v198, v102
    v_dot2_f32_bf16 v103, v52, v198, v103
    v_dot2_f32_bf16 v106, v86, v198, v106
    v_dot2_f32_bf16 v107, v53, v198, v107
    v_dot2_f32_bf16 v110, v87, v198, v110
    v_dot2_f32_bf16 v111, v54, v198, v111
    v_dot2_f32_bf16 v114, v88, v198, v114
    v_dot2_f32_bf16 v115, v55, v198, v115
    v_lshlrev_b32 v104, 16, v68
    v_and_b32 v105, 0xffff0000, v68
    v_lshlrev_b32 v108, 16, v69
    v_and_b32 v109, 0xffff0000, v69
    v_lshlrev_b32 v112, 16, v70
    v_and_b32 v113, 0xffff0000, v70
    v_lshlrev_b32 v116, 16, v71
    v_and_b32 v117, 0xffff0000, v71
    v_mul_f32 v102, v102, v104
    v_mul_f32 v103, v103, v105
    v_mul_f32 v106, v106, v108
    v_mul_f32 v107, v107, v109
    v_mul_f32 v110, v110, v112
    v_mul_f32 v111, v111, v113
    v_mul_f32 v114, v114, v116
    v_mul_f32 v115, v115, v117
    v_cvt_pk_bf16_f32 v153, v103, v102
    v_cvt_pk_bf16_f32 v152, v107, v106
    v_cvt_pk_bf16_f32 v151, v111, v110
    v_cvt_pk_bf16_f32 v150, v115, v114
    s_add_u32 s4, s72, 65664
    buffer_store_dwordx4 v[150:153], v12, s[8:11], s4 offen offset:0
    v_dot2_f32_bf16 v118, v88, v199, 0
    v_dot2_f32_bf16 v119, v55, v199, 0
    v_dot2_f32_bf16 v122, v89, v199, 0
    v_dot2_f32_bf16 v123, v56, v199, 0
    v_dot2_f32_bf16 v126, v90, v199, 0
    v_dot2_f32_bf16 v127, v57, v199, 0
    v_dot2_f32_bf16 v130, v91, v199, 0
    v_dot2_f32_bf16 v131, v58, v199, 0
    v_dot2_f32_bf16 v118, v89, v198, v118
    v_dot2_f32_bf16 v119, v56, v198, v119
    v_dot2_f32_bf16 v122, v90, v198, v122
    v_dot2_f32_bf16 v123, v57, v198, v123
    v_dot2_f32_bf16 v126, v91, v198, v126
    v_dot2_f32_bf16 v127, v58, v198, v127
    v_dot2_f32_bf16 v130, v92, v198, v130
    v_dot2_f32_bf16 v131, v59, v198, v131
    v_lshlrev_b32 v120, 16, v72
    v_and_b32 v121, 0xffff0000, v72
    v_lshlrev_b32 v124, 16, v73
    v_and_b32 v125, 0xffff0000, v73
    v_lshlrev_b32 v128, 16, v74
    v_and_b32 v129, 0xffff0000, v74
    v_lshlrev_b32 v132, 16, v75
    v_and_b32 v133, 0xffff0000, v75
    v_mul_f32 v118, v118, v120
    v_mul_f32 v119, v119, v121
    v_mul_f32 v122, v122, v124
    v_mul_f32 v123, v123, v125
    v_mul_f32 v126, v126, v128
    v_mul_f32 v127, v127, v129
    v_mul_f32 v130, v130, v132
    v_mul_f32 v131, v131, v133
    v_cvt_pk_bf16_f32 v157, v119, v118
    v_cvt_pk_bf16_f32 v156, v123, v122
    v_cvt_pk_bf16_f32 v155, v127, v126
    v_cvt_pk_bf16_f32 v154, v131, v130
    buffer_store_dwordx4 v[154:157], v12, s[8:11], s4 offen offset:1024
    v_dot2_f32_bf16 v102, v92, v199, 0
    v_dot2_f32_bf16 v103, v59, v199, 0
    v_dot2_f32_bf16 v106, v93, v199, 0
    v_dot2_f32_bf16 v107, v60, v199, 0
    v_dot2_f32_bf16 v110, v94, v199, 0
    v_dot2_f32_bf16 v111, v61, v199, 0
    v_dot2_f32_bf16 v114, v95, v199, 0
    v_dot2_f32_bf16 v115, v62, v199, 0
    v_dot2_f32_bf16 v102, v93, v198, v102
    v_dot2_f32_bf16 v103, v60, v198, v103
    v_dot2_f32_bf16 v106, v94, v198, v106
    v_dot2_f32_bf16 v107, v61, v198, v107
    v_dot2_f32_bf16 v110, v95, v198, v110
    v_dot2_f32_bf16 v111, v62, v198, v111
    v_dot2_f32_bf16 v114, v96, v198, v114
    v_dot2_f32_bf16 v115, v63, v198, v115
    v_lshlrev_b32 v104, 16, v76
    v_and_b32 v105, 0xffff0000, v76
    v_lshlrev_b32 v108, 16, v77
    v_and_b32 v109, 0xffff0000, v77
    v_lshlrev_b32 v112, 16, v78
    v_and_b32 v113, 0xffff0000, v78
    v_lshlrev_b32 v116, 16, v79
    v_and_b32 v117, 0xffff0000, v79
    v_mul_f32 v102, v102, v104
    v_mul_f32 v103, v103, v105
    v_mul_f32 v106, v106, v108
    v_mul_f32 v107, v107, v109
    v_mul_f32 v110, v110, v112
    v_mul_f32 v111, v111, v113
    v_mul_f32 v114, v114, v116
    v_mul_f32 v115, v115, v117
    v_cvt_pk_bf16_f32 v161, v103, v102
    v_cvt_pk_bf16_f32 v160, v107, v106
    v_cvt_pk_bf16_f32 v159, v111, v110
    v_cvt_pk_bf16_f32 v158, v115, v114
    buffer_store_dwordx4 v[158:161], v12, s[8:11], s4 offen offset:2048
    v_dot2_f32_bf16 v118, v96, v199, 0
    v_dot2_f32_bf16 v119, v63, v199, 0
    v_dot2_f32_bf16 v122, v97, v199, 0
    v_dot2_f32_bf16 v123, v64, v199, 0
    v_dot2_f32_bf16 v126, v98, v199, 0
    v_dot2_f32_bf16 v127, v65, v199, 0
    v_dot2_f32_bf16 v130, v99, v199, 0
    v_dot2_f32_bf16 v131, v66, v199, 0
    v_dot2_f32_bf16 v118, v97, v198, v118
    v_dot2_f32_bf16 v119, v64, v198, v119
    v_dot2_f32_bf16 v122, v98, v198, v122
    v_dot2_f32_bf16 v123, v65, v198, v123
    v_dot2_f32_bf16 v126, v99, v198, v126
    v_dot2_f32_bf16 v127, v66, v198, v127
    v_dot2_f32_bf16 v130, v100, v198, v130
    v_dot2_f32_bf16 v131, v67, v198, v131
    v_lshlrev_b32 v120, 16, v80
    v_and_b32 v121, 0xffff0000, v80
    v_lshlrev_b32 v124, 16, v81
    v_and_b32 v125, 0xffff0000, v81
    v_lshlrev_b32 v128, 16, v82
    v_and_b32 v129, 0xffff0000, v82
    v_lshlrev_b32 v132, 16, v83
    v_and_b32 v133, 0xffff0000, v83
    v_mul_f32 v118, v118, v120
    v_mul_f32 v119, v119, v121
    v_mul_f32 v122, v122, v124
    v_mul_f32 v123, v123, v125
    v_mul_f32 v126, v126, v128
    v_mul_f32 v127, v127, v129
    v_mul_f32 v130, v130, v132
    v_mul_f32 v131, v131, v133
    v_cvt_pk_bf16_f32 v165, v119, v118
    v_cvt_pk_bf16_f32 v164, v123, v122
    v_cvt_pk_bf16_f32 v163, v127, v126
    v_cvt_pk_bf16_f32 v162, v131, v130
    buffer_store_dwordx4 v[162:165], v12, s[8:11], s4 offen offset:3072
    s_waitcnt vmcnt(8)
    ds_read_b64_tr_b16 v[16:17], v11 offset:16640
    ds_read_b64_tr_b16 v[18:19], v11 offset:16896
    ds_read_b64_tr_b16 v[20:21], v11 offset:17152
    ds_read_b64_tr_b16 v[22:23], v11 offset:17408
    ds_read_b64_tr_b16 v[24:25], v11 offset:17664
    ds_read_b64_tr_b16 v[26:27], v11 offset:17920
    ds_read_b64_tr_b16 v[28:29], v11 offset:18176
    ds_read_b64_tr_b16 v[30:31], v11 offset:18432
    ds_read_b64_tr_b16 v[32:33], v11 offset:18688
    ds_read_b64_tr_b16 v[34:35], v11 offset:25088
    ds_read_b64_tr_b16 v[36:37], v11 offset:25344
    ds_read_b64_tr_b16 v[38:39], v11 offset:25600
    ds_read_b64_tr_b16 v[40:41], v11 offset:25856
    ds_read_b64_tr_b16 v[42:43], v11 offset:26112
    ds_read_b64_tr_b16 v[44:45], v11 offset:26368
    ds_read_b64_tr_b16 v[46:47], v11 offset:26624
    ds_read_b64_tr_b16 v[48:49], v11 offset:26880
    ds_read_b64_tr_b16 v[50:51], v11 offset:16672
    ds_read_b64_tr_b16 v[52:53], v11 offset:16928
    ds_read_b64_tr_b16 v[54:55], v11 offset:17184
    ds_read_b64_tr_b16 v[56:57], v11 offset:17440
    ds_read_b64_tr_b16 v[58:59], v11 offset:17696
    ds_read_b64_tr_b16 v[60:61], v11 offset:17952
    ds_read_b64_tr_b16 v[62:63], v11 offset:18208
    ds_read_b64_tr_b16 v[64:65], v11 offset:18464
    ds_read_b64_tr_b16 v[66:67], v11 offset:18720
    ds_read_b64_tr_b16 v[68:69], v11 offset:25120
    ds_read_b64_tr_b16 v[70:71], v11 offset:25376
    ds_read_b64_tr_b16 v[72:73], v11 offset:25632
    ds_read_b64_tr_b16 v[74:75], v11 offset:25888
    ds_read_b64_tr_b16 v[76:77], v11 offset:26144
    ds_read_b64_tr_b16 v[78:79], v11 offset:26400
    ds_read_b64_tr_b16 v[80:81], v11 offset:26656
    ds_read_b64_tr_b16 v[82:83], v11 offset:26912
    s_waitcnt lgkmcnt(0)
    v_alignbit_b32 v84, v17, v16, 16
    v_alignbit_b32 v85, v18, v17, 16
    v_alignbit_b32 v86, v19, v18, 16
    v_alignbit_b32 v87, v20, v19, 16
    v_alignbit_b32 v88, v21, v20, 16
    v_alignbit_b32 v89, v22, v21, 16
    v_alignbit_b32 v90, v23, v22, 16
    v_alignbit_b32 v91, v24, v23, 16
    v_alignbit_b32 v92, v25, v24, 16
    v_alignbit_b32 v93, v26, v25, 16
    v_alignbit_b32 v94, v27, v26, 16
    v_alignbit_b32 v95, v28, v27, 16
    v_alignbit_b32 v96, v29, v28, 16
    v_alignbit_b32 v97, v30, v29, 16
    v_alignbit_b32 v98, v31, v30, 16
    v_alignbit_b32 v99, v32, v31, 16
    v_alignbit_b32 v100, v33, v32, 16
    v_dot2_f32_bf16 v102, v84, v197, 0
    v_dot2_f32_bf16 v103, v17, v197, 0
    v_dot2_f32_bf16 v106, v85, v197, 0
    v_dot2_f32_bf16 v107, v18, v197, 0
    v_dot2_f32_bf16 v110, v86, v197, 0
    v_dot2_f32_bf16 v111, v19, v197, 0
    v_dot2_f32_bf16 v114, v87, v197, 0
    v_dot2_f32_bf16 v115, v20, v197, 0
    v_dot2_f32_bf16 v102, v85, v196, v102
    v_dot2_f32_bf16 v103, v18, v196, v103
    v_dot2_f32_bf16 v106, v86, v196, v106
    v_dot2_f32_bf16 v107, v19, v196, v107
    v_dot2_f32_bf16 v110, v87, v196, v110
    v_dot2_f32_bf16 v111, v20, v196, v111
    v_dot2_f32_bf16 v114, v88, v196, v114
    v_dot2_f32_bf16 v115, v21, v196, v115
    v_lshlrev_b32 v104, 16, v34
    v_and_b32 v105, 0xffff0000, v34
    v_lshlrev_b32 v108, 16, v35
    v_and_b32 v109, 0xffff0000, v35
    v_lshlrev_b32 v112, 16, v36
    v_and_b32 v113, 0xffff0000, v36
    v_lshlrev_b32 v116, 16, v37
    v_and_b32 v117, 0xffff0000, v37
    v_mul_f32 v102, v102, v104
    v_mul_f32 v103, v103, v105
    v_mul_f32 v106, v106, v108
    v_mul_f32 v107, v107, v109
    v_mul_f32 v110, v110, v112
    v_mul_f32 v111, v111, v113
    v_mul_f32 v114, v114, v116
    v_mul_f32 v115, v115, v117
    v_cvt_pk_bf16_f32 v137, v103, v102
    v_cvt_pk_bf16_f32 v136, v107, v106
    v_cvt_pk_bf16_f32 v135, v111, v110
    v_cvt_pk_bf16_f32 v134, v115, v114
    s_add_u32 s4, s72, 192
    buffer_store_dwordx4 v[134:137], v12, s[8:11], s4 offen offset:0
    v_dot2_f32_bf16 v118, v88, v197, 0
    v_dot2_f32_bf16 v119, v21, v197, 0
    v_dot2_f32_bf16 v122, v89, v197, 0
    v_dot2_f32_bf16 v123, v22, v197, 0
    v_dot2_f32_bf16 v126, v90, v197, 0
    v_dot2_f32_bf16 v127, v23, v197, 0
    v_dot2_f32_bf16 v130, v91, v197, 0
    v_dot2_f32_bf16 v131, v24, v197, 0
    v_dot2_f32_bf16 v118, v89, v196, v118
    v_dot2_f32_bf16 v119, v22, v196, v119
    v_dot2_f32_bf16 v122, v90, v196, v122
    v_dot2_f32_bf16 v123, v23, v196, v123
    v_dot2_f32_bf16 v126, v91, v196, v126
    v_dot2_f32_bf16 v127, v24, v196, v127
    v_dot2_f32_bf16 v130, v92, v196, v130
    v_dot2_f32_bf16 v131, v25, v196, v131
    v_lshlrev_b32 v120, 16, v38
    v_and_b32 v121, 0xffff0000, v38
    v_lshlrev_b32 v124, 16, v39
    v_and_b32 v125, 0xffff0000, v39
    v_lshlrev_b32 v128, 16, v40
    v_and_b32 v129, 0xffff0000, v40
    v_lshlrev_b32 v132, 16, v41
    v_and_b32 v133, 0xffff0000, v41
    v_mul_f32 v118, v118, v120
    v_mul_f32 v119, v119, v121
    v_mul_f32 v122, v122, v124
    v_mul_f32 v123, v123, v125
    v_mul_f32 v126, v126, v128
    v_mul_f32 v127, v127, v129
    v_mul_f32 v130, v130, v132
    v_mul_f32 v131, v131, v133
    v_cvt_pk_bf16_f32 v141, v119, v118
    v_cvt_pk_bf16_f32 v140, v123, v122
    v_cvt_pk_bf16_f32 v139, v127, v126
    v_cvt_pk_bf16_f32 v138, v131, v130
    buffer_store_dwordx4 v[138:141], v12, s[8:11], s4 offen offset:1024
    v_dot2_f32_bf16 v102, v92, v197, 0
    v_dot2_f32_bf16 v103, v25, v197, 0
    v_dot2_f32_bf16 v106, v93, v197, 0
    v_dot2_f32_bf16 v107, v26, v197, 0
    v_dot2_f32_bf16 v110, v94, v197, 0
    v_dot2_f32_bf16 v111, v27, v197, 0
    v_dot2_f32_bf16 v114, v95, v197, 0
    v_dot2_f32_bf16 v115, v28, v197, 0
    v_dot2_f32_bf16 v102, v93, v196, v102
    v_dot2_f32_bf16 v103, v26, v196, v103
    v_dot2_f32_bf16 v106, v94, v196, v106
    v_dot2_f32_bf16 v107, v27, v196, v107
    v_dot2_f32_bf16 v110, v95, v196, v110
    v_dot2_f32_bf16 v111, v28, v196, v111
    v_dot2_f32_bf16 v114, v96, v196, v114
    v_dot2_f32_bf16 v115, v29, v196, v115
    v_lshlrev_b32 v104, 16, v42
    v_and_b32 v105, 0xffff0000, v42
    v_lshlrev_b32 v108, 16, v43
    v_and_b32 v109, 0xffff0000, v43
    v_lshlrev_b32 v112, 16, v44
    v_and_b32 v113, 0xffff0000, v44
    v_lshlrev_b32 v116, 16, v45
    v_and_b32 v117, 0xffff0000, v45
    v_mul_f32 v102, v102, v104
    v_mul_f32 v103, v103, v105
    v_mul_f32 v106, v106, v108
    v_mul_f32 v107, v107, v109
    v_mul_f32 v110, v110, v112
    v_mul_f32 v111, v111, v113
    v_mul_f32 v114, v114, v116
    v_mul_f32 v115, v115, v117
    v_cvt_pk_bf16_f32 v145, v103, v102
    v_cvt_pk_bf16_f32 v144, v107, v106
    v_cvt_pk_bf16_f32 v143, v111, v110
    v_cvt_pk_bf16_f32 v142, v115, v114
    buffer_store_dwordx4 v[142:145], v12, s[8:11], s4 offen offset:2048
    v_dot2_f32_bf16 v118, v96, v197, 0
    v_dot2_f32_bf16 v119, v29, v197, 0
    v_dot2_f32_bf16 v122, v97, v197, 0
    v_dot2_f32_bf16 v123, v30, v197, 0
    v_dot2_f32_bf16 v126, v98, v197, 0
    v_dot2_f32_bf16 v127, v31, v197, 0
    v_dot2_f32_bf16 v130, v99, v197, 0
    v_dot2_f32_bf16 v131, v32, v197, 0
    v_dot2_f32_bf16 v118, v97, v196, v118
    v_dot2_f32_bf16 v119, v30, v196, v119
    v_dot2_f32_bf16 v122, v98, v196, v122
    v_dot2_f32_bf16 v123, v31, v196, v123
    v_dot2_f32_bf16 v126, v99, v196, v126
    v_dot2_f32_bf16 v127, v32, v196, v127
    v_dot2_f32_bf16 v130, v100, v196, v130
    v_dot2_f32_bf16 v131, v33, v196, v131
    v_lshlrev_b32 v120, 16, v46
    v_and_b32 v121, 0xffff0000, v46
    v_lshlrev_b32 v124, 16, v47
    v_and_b32 v125, 0xffff0000, v47
    v_lshlrev_b32 v128, 16, v48
    v_and_b32 v129, 0xffff0000, v48
    v_lshlrev_b32 v132, 16, v49
    v_and_b32 v133, 0xffff0000, v49
    v_mul_f32 v118, v118, v120
    v_mul_f32 v119, v119, v121
    v_mul_f32 v122, v122, v124
    v_mul_f32 v123, v123, v125
    v_mul_f32 v126, v126, v128
    v_mul_f32 v127, v127, v129
    v_mul_f32 v130, v130, v132
    v_mul_f32 v131, v131, v133
    v_cvt_pk_bf16_f32 v149, v119, v118
    v_cvt_pk_bf16_f32 v148, v123, v122
    v_cvt_pk_bf16_f32 v147, v127, v126
    v_cvt_pk_bf16_f32 v146, v131, v130
    buffer_store_dwordx4 v[146:149], v12, s[8:11], s4 offen offset:3072
    v_alignbit_b32 v84, v51, v50, 16
    v_alignbit_b32 v85, v52, v51, 16
    v_alignbit_b32 v86, v53, v52, 16
    v_alignbit_b32 v87, v54, v53, 16
    v_alignbit_b32 v88, v55, v54, 16
    v_alignbit_b32 v89, v56, v55, 16
    v_alignbit_b32 v90, v57, v56, 16
    v_alignbit_b32 v91, v58, v57, 16
    v_alignbit_b32 v92, v59, v58, 16
    v_alignbit_b32 v93, v60, v59, 16
    v_alignbit_b32 v94, v61, v60, 16
    v_alignbit_b32 v95, v62, v61, 16
    v_alignbit_b32 v96, v63, v62, 16
    v_alignbit_b32 v97, v64, v63, 16
    v_alignbit_b32 v98, v65, v64, 16
    v_alignbit_b32 v99, v66, v65, 16
    v_alignbit_b32 v100, v67, v66, 16
    v_dot2_f32_bf16 v102, v84, v199, 0
    v_dot2_f32_bf16 v103, v51, v199, 0
    v_dot2_f32_bf16 v106, v85, v199, 0
    v_dot2_f32_bf16 v107, v52, v199, 0
    v_dot2_f32_bf16 v110, v86, v199, 0
    v_dot2_f32_bf16 v111, v53, v199, 0
    v_dot2_f32_bf16 v114, v87, v199, 0
    v_dot2_f32_bf16 v115, v54, v199, 0
    v_dot2_f32_bf16 v102, v85, v198, v102
    v_dot2_f32_bf16 v103, v52, v198, v103
    v_dot2_f32_bf16 v106, v86, v198, v106
    v_dot2_f32_bf16 v107, v53, v198, v107
    v_dot2_f32_bf16 v110, v87, v198, v110
    v_dot2_f32_bf16 v111, v54, v198, v111
    v_dot2_f32_bf16 v114, v88, v198, v114
    v_dot2_f32_bf16 v115, v55, v198, v115
    v_lshlrev_b32 v104, 16, v68
    v_and_b32 v105, 0xffff0000, v68
    v_lshlrev_b32 v108, 16, v69
    v_and_b32 v109, 0xffff0000, v69
    v_lshlrev_b32 v112, 16, v70
    v_and_b32 v113, 0xffff0000, v70
    v_lshlrev_b32 v116, 16, v71
    v_and_b32 v117, 0xffff0000, v71
    v_mul_f32 v102, v102, v104
    v_mul_f32 v103, v103, v105
    v_mul_f32 v106, v106, v108
    v_mul_f32 v107, v107, v109
    v_mul_f32 v110, v110, v112
    v_mul_f32 v111, v111, v113
    v_mul_f32 v114, v114, v116
    v_mul_f32 v115, v115, v117
    v_cvt_pk_bf16_f32 v153, v103, v102
    v_cvt_pk_bf16_f32 v152, v107, v106
    v_cvt_pk_bf16_f32 v151, v111, v110
    v_cvt_pk_bf16_f32 v150, v115, v114
    s_add_u32 s4, s72, 65728
    buffer_store_dwordx4 v[150:153], v12, s[8:11], s4 offen offset:0
    v_dot2_f32_bf16 v118, v88, v199, 0
    v_dot2_f32_bf16 v119, v55, v199, 0
    v_dot2_f32_bf16 v122, v89, v199, 0
    v_dot2_f32_bf16 v123, v56, v199, 0
    v_dot2_f32_bf16 v126, v90, v199, 0
    v_dot2_f32_bf16 v127, v57, v199, 0
    v_dot2_f32_bf16 v130, v91, v199, 0
    v_dot2_f32_bf16 v131, v58, v199, 0
    v_dot2_f32_bf16 v118, v89, v198, v118
    v_dot2_f32_bf16 v119, v56, v198, v119
    v_dot2_f32_bf16 v122, v90, v198, v122
    v_dot2_f32_bf16 v123, v57, v198, v123
    v_dot2_f32_bf16 v126, v91, v198, v126
    v_dot2_f32_bf16 v127, v58, v198, v127
    v_dot2_f32_bf16 v130, v92, v198, v130
    v_dot2_f32_bf16 v131, v59, v198, v131
    v_lshlrev_b32 v120, 16, v72
    v_and_b32 v121, 0xffff0000, v72
    v_lshlrev_b32 v124, 16, v73
    v_and_b32 v125, 0xffff0000, v73
    v_lshlrev_b32 v128, 16, v74
    v_and_b32 v129, 0xffff0000, v74
    v_lshlrev_b32 v132, 16, v75
    v_and_b32 v133, 0xffff0000, v75
    v_mul_f32 v118, v118, v120
    v_mul_f32 v119, v119, v121
    v_mul_f32 v122, v122, v124
    v_mul_f32 v123, v123, v125
    v_mul_f32 v126, v126, v128
    v_mul_f32 v127, v127, v129
    v_mul_f32 v130, v130, v132
    v_mul_f32 v131, v131, v133
    v_cvt_pk_bf16_f32 v157, v119, v118
    v_cvt_pk_bf16_f32 v156, v123, v122
    v_cvt_pk_bf16_f32 v155, v127, v126
    v_cvt_pk_bf16_f32 v154, v131, v130
    buffer_store_dwordx4 v[154:157], v12, s[8:11], s4 offen offset:1024
    v_dot2_f32_bf16 v102, v92, v199, 0
    v_dot2_f32_bf16 v103, v59, v199, 0
    v_dot2_f32_bf16 v106, v93, v199, 0
    v_dot2_f32_bf16 v107, v60, v199, 0
    v_dot2_f32_bf16 v110, v94, v199, 0
    v_dot2_f32_bf16 v111, v61, v199, 0
    v_dot2_f32_bf16 v114, v95, v199, 0
    v_dot2_f32_bf16 v115, v62, v199, 0
    v_dot2_f32_bf16 v102, v93, v198, v102
    v_dot2_f32_bf16 v103, v60, v198, v103
    v_dot2_f32_bf16 v106, v94, v198, v106
    v_dot2_f32_bf16 v107, v61, v198, v107
    v_dot2_f32_bf16 v110, v95, v198, v110
    v_dot2_f32_bf16 v111, v62, v198, v111
    v_dot2_f32_bf16 v114, v96, v198, v114
    v_dot2_f32_bf16 v115, v63, v198, v115
    v_lshlrev_b32 v104, 16, v76
    v_and_b32 v105, 0xffff0000, v76
    v_lshlrev_b32 v108, 16, v77
    v_and_b32 v109, 0xffff0000, v77
    v_lshlrev_b32 v112, 16, v78
    v_and_b32 v113, 0xffff0000, v78
    v_lshlrev_b32 v116, 16, v79
    v_and_b32 v117, 0xffff0000, v79
    v_mul_f32 v102, v102, v104
    v_mul_f32 v103, v103, v105
    v_mul_f32 v106, v106, v108
    v_mul_f32 v107, v107, v109
    v_mul_f32 v110, v110, v112
    v_mul_f32 v111, v111, v113
    v_mul_f32 v114, v114, v116
    v_mul_f32 v115, v115, v117
    v_cvt_pk_bf16_f32 v161, v103, v102
    v_cvt_pk_bf16_f32 v160, v107, v106
    v_cvt_pk_bf16_f32 v159, v111, v110
    v_cvt_pk_bf16_f32 v158, v115, v114
    buffer_store_dwordx4 v[158:161], v12, s[8:11], s4 offen offset:2048
    v_dot2_f32_bf16 v118, v96, v199, 0
    v_dot2_f32_bf16 v119, v63, v199, 0
    v_dot2_f32_bf16 v122, v97, v199, 0
    v_dot2_f32_bf16 v123, v64, v199, 0
    v_dot2_f32_bf16 v126, v98, v199, 0
    v_dot2_f32_bf16 v127, v65, v199, 0
    v_dot2_f32_bf16 v130, v99, v199, 0
    v_dot2_f32_bf16 v131, v66, v199, 0
    v_dot2_f32_bf16 v118, v97, v198, v118
    v_dot2_f32_bf16 v119, v64, v198, v119
    v_dot2_f32_bf16 v122, v98, v198, v122
    v_dot2_f32_bf16 v123, v65, v198, v123
    v_dot2_f32_bf16 v126, v99, v198, v126
    v_dot2_f32_bf16 v127, v66, v198, v127
    v_dot2_f32_bf16 v130, v100, v198, v130
    v_dot2_f32_bf16 v131, v67, v198, v131
    v_lshlrev_b32 v120, 16, v80
    v_and_b32 v121, 0xffff0000, v80
    v_lshlrev_b32 v124, 16, v81
    v_and_b32 v125, 0xffff0000, v81
    v_lshlrev_b32 v128, 16, v82
    v_and_b32 v129, 0xffff0000, v82
    v_lshlrev_b32 v132, 16, v83
    v_and_b32 v133, 0xffff0000, v83
    v_mul_f32 v118, v118, v120
    v_mul_f32 v119, v119, v121
    v_mul_f32 v122, v122, v124
    v_mul_f32 v123, v123, v125
    v_mul_f32 v126, v126, v128
    v_mul_f32 v127, v127, v129
    v_mul_f32 v130, v130, v132
    v_mul_f32 v131, v131, v133
    v_cvt_pk_bf16_f32 v165, v119, v118
    v_cvt_pk_bf16_f32 v164, v123, v122
    v_cvt_pk_bf16_f32 v163, v127, v126
    v_cvt_pk_bf16_f32 v162, v131, v130
    buffer_store_dwordx4 v[162:165], v12, s[8:11], s4 offen offset:3072
    s_waitcnt vmcnt(0)
    s_barrier
    s_load_dwordx4 s[52:55], s[0:1], 32
    s_lshl_b32 s3, s93, 5
    s_lshl_b32 s4, s24, 3
    s_add_u32 s3, s3, s4
    s_lshl_b32 s4, s3, 1
    s_waitcnt lgkmcnt(0)
    s_load_dwordx4 s[64:67], s[54:55], s4

    s_mov_b32 s28, s52
    s_and_b32 s29, s53, 0xffff
    s_mov_b32 s30, 0x400000
    s_mov_b32 s31, 0x00020000

    v_and_b32 v1, 63, v0
    v_and_b32 v2, 15, v1
    v_lshrrev_b32 v3, 4, v1

    s_lshl_b32 s32, s3, 12
    s_add_u32 s33, s32, 28672
    s_mul_i32 s34, s24, 38400
    s_add_u32 s35, s34, 33536
    s_add_u32 s38, s32, 117440512
    v_lshlrev_b32 v4, 4, v1
    v_add_u32 v5, s34, v4
    v_add_u32 v5, 64, v5
    v_sub_u32 v6, 7, v2
    v_and_b32 v6, 7, v6
    v_mul_u32_u24 v6, 4160, v6
    v_lshrrev_b32 v7, 3, v2
    v_sub_u32 v7, v7, v3
    v_add_u32 v7, 4, v7
    v_lshl_add_u32 v6, v7, 4, v6
    v_add_u32 v6, s34, v6
    v_mul_u32_u24 v7, 80, v3
    v_add_u32 v7, v7, v2
    v_lshlrev_b32 v7, 4, v7
    v_add_u32 v7, s34, v7
    v_add_u32 v7, 33296, v7
    v_lshlrev_b32 v228, 7, v2
    v_lshl_add_u32 v228, v3, 4, v228
    v_subrev_u32 v229, 16, v4
    v_max_i32 v230, 0, v229
    v_sub_u32 v232, 7, v2
    v_and_b32 v232, 7, v232
    v_and_b32 v233, 1, v232
    v_lshlrev_b32 v233, 4, v233
    v_mov_b32 v234, 0xffff
    v_lshlrev_b32 v233, v233, v234
    v_lshrrev_b32 v232, 1, v232
    v_lshrrev_b32 v234, 3, v2
    v_sub_u32 v234, v3, v234
    v_lshl_add_u32 v232, v234, 1, v232
    v_and_b32 v234, 1, v234
    v_lshl_add_u32 v232, v234, 8, v232

    v_cmp_eq_u32 vcc, 0, v232
    s_nop 1
    v_cndmask_b32 v8, 0, v233, vcc
    v_cmp_eq_u32 vcc, 1, v232
    s_nop 1
    v_cndmask_b32 v9, 0, v233, vcc
    v_cmp_eq_u32 vcc, 2, v232
    s_nop 1
    v_cndmask_b32 v10, 0, v233, vcc
    v_cmp_eq_u32 vcc, 3, v232
    s_nop 1
    v_cndmask_b32 v11, 0, v233, vcc
    v_cmp_eq_u32 vcc, 4, v232
    s_nop 1
    v_cndmask_b32 v12, 0, v233, vcc
    v_cmp_eq_u32 vcc, 5, v232
    s_nop 1
    v_cndmask_b32 v13, 0, v233, vcc
    v_cmp_eq_u32 vcc, 6, v232
    s_nop 1
    v_cndmask_b32 v14, 0, v233, vcc
    v_cmp_eq_u32 vcc, 7, v232
    s_nop 1
    v_cndmask_b32 v15, 0, v233, vcc
    v_mov_b32 v208, 0
    v_mov_b32 v209, 0
    v_mov_b32 v210, 0
    v_mov_b32 v211, 0
    v_lshrrev_b32 v232, 2, v1
    v_and_b32 v232, 7, v232
    v_mul_u32_u24 v232, 4160, v232
    v_and_b32 v233, 3, v1
    v_lshl_add_u32 v232, v233, 4, v232
    v_add_u32 v232, s34, v232
    ds_write_b128 v232, v[208:211]
    v_subrev_u32 v233, 16, v7
    ds_write_b128 v233, v[208:211]

    s_add_u32 s39, s32, 125829120
    buffer_load_dwordx4 v[176:179], v230, s[28:31], s32 offen offset:0
    buffer_load_dwordx4 v[180:183], v4, s[28:31], s32 offen offset:0
    buffer_load_dwordx4 v[184:187], v4, s[28:31], s32 offen offset:1008
    buffer_load_dwordx4 v[188:191], v4, s[28:31], s32 offen offset:1024
    buffer_load_dwordx4 v[192:195], v4, s[28:31], s32 offen offset:2032
    buffer_load_dwordx4 v[196:199], v4, s[28:31], s32 offen offset:2048
    buffer_load_dwordx4 v[200:203], v4, s[28:31], s32 offen offset:3056
    buffer_load_dwordx4 v[204:207], v4, s[28:31], s32 offen offset:3072
    s_add_u32 m0, s35, 0
    s_nop 0
    buffer_load_dwordx4 v4, s[8:11], s39 offen offset:0 lds
    s_add_u32 m0, s35, 256
    s_nop 0
    buffer_load_dwordx4 v4, s[8:11], s39 offen offset:1024 lds
    s_add_u32 m0, s35, 512
    s_nop 0
    buffer_load_dwordx4 v4, s[8:11], s39 offen offset:2048 lds
    s_add_u32 m0, s35, 768
    s_nop 0
    buffer_load_dwordx4 v4, s[8:11], s39 offen offset:3072 lds
    s_waitcnt vmcnt(0) lgkmcnt(0)
    s_pack_ll_b32_b16 s40, s64, s64
    s_add_u32 s36, s32, 4096
    s_add_u32 s37, s32, 8192
    s_add_u32 s39, s36, 125829120
    s_mov_b64 exec, 1
    v_mov_b32 v176, 0
    v_mov_b32 v177, 0
    v_mov_b32 v178, 0
    v_mov_b32 v179, 0
    s_mov_b64 exec, -1
    ds_write_b128 v5, v[180:183] offset:0
    ds_write_b128 v5, v[178:181] offset:16640
    v_mov_b32 v208, v177
    v_mov_b32 v209, v178
    v_mov_b32 v210, v179
    v_mov_b32 v211, v180
    ds_write_b128 v5, v[208:211] offset:24960
    v_mov_b32 v212, v181
    v_mov_b32 v213, v182
    ds_write_b128 v5, v[210:213] offset:8320
    v_alignbit_b32 v214, v177, v176, 16
    v_alignbit_b32 v215, v178, v177, 16
    v_alignbit_b32 v216, v179, v178, 16
    v_alignbit_b32 v217, v180, v179, 16
    ds_write_b128 v5, v[214:217] offset:29120
    v_alignbit_b32 v218, v181, v180, 16
    v_alignbit_b32 v219, v182, v181, 16
    ds_write_b128 v5, v[216:219] offset:12480
    v_alignbit_b32 v220, v178, v177, 16
    v_alignbit_b32 v221, v179, v178, 16
    v_alignbit_b32 v222, v180, v179, 16
    v_alignbit_b32 v223, v181, v180, 16
    ds_write_b128 v5, v[220:223] offset:20800
    v_alignbit_b32 v224, v182, v181, 16
    v_alignbit_b32 v225, v183, v182, 16
    ds_write_b128 v5, v[222:225] offset:4160
    buffer_load_dwordx4 v[176:179], v230, s[28:31], s36 offen offset:0
    buffer_load_dwordx4 v[180:183], v4, s[28:31], s36 offen offset:0
    ds_write_b128 v5, v[188:191] offset:1024
    ds_write_b128 v5, v[186:189] offset:17664
    v_mov_b32 v208, v185
    v_mov_b32 v209, v186
    v_mov_b32 v210, v187
    v_mov_b32 v211, v188
    ds_write_b128 v5, v[208:211] offset:25984
    v_mov_b32 v212, v189
    v_mov_b32 v213, v190
    ds_write_b128 v5, v[210:213] offset:9344
    v_alignbit_b32 v214, v185, v184, 16
    v_alignbit_b32 v215, v186, v185, 16
    v_alignbit_b32 v216, v187, v186, 16
    v_alignbit_b32 v217, v188, v187, 16
    ds_write_b128 v5, v[214:217] offset:30144
    v_alignbit_b32 v218, v189, v188, 16
    v_alignbit_b32 v219, v190, v189, 16
    ds_write_b128 v5, v[216:219] offset:13504
    v_alignbit_b32 v220, v186, v185, 16
    v_alignbit_b32 v221, v187, v186, 16
    v_alignbit_b32 v222, v188, v187, 16
    v_alignbit_b32 v223, v189, v188, 16
    ds_write_b128 v5, v[220:223] offset:21824
    v_alignbit_b32 v224, v190, v189, 16
    v_alignbit_b32 v225, v191, v190, 16
    ds_write_b128 v5, v[222:225] offset:5184
    buffer_load_dwordx4 v[184:187], v4, s[28:31], s36 offen offset:1008
    buffer_load_dwordx4 v[188:191], v4, s[28:31], s36 offen offset:1024
    v_and_b32 v236, s40, v8
    v_and_b32 v237, s40, v9
    v_and_b32 v238, s40, v10
    v_and_b32 v239, s40, v11
    v_and_b32 v240, s40, v12
    v_and_b32 v241, s40, v13
    v_and_b32 v242, s40, v14
    v_and_b32 v243, s40, v15
    ds_read_b128 a[60:63], v7 offset:240
    ds_read_b128 a[124:127], v7 offset:496
    ds_read_b128 a[188:191], v7 offset:752
    ds_read_b128 a[252:255], v7 offset:1008
    ds_read_b128 v[168:171], v6 offset:0
    ds_read_b128 v[172:175], v6 offset:32
    s_waitcnt vmcnt(0) lgkmcnt(0)
    s_mov_b32 s42, 0
.cvl_429:
    s_waitcnt lgkmcnt(5)
    v_mfma_f32_16x16x32_bf16 v[16:19], v[236:239], a[60:63], 0
    v_mfma_f32_16x16x32_bf16 v[32:35], v[240:243], a[60:63], 0
    s_waitcnt lgkmcnt(4)
    v_mfma_f32_16x16x32_bf16 v[20:23], v[236:239], a[124:127], 0
    v_mfma_f32_16x16x32_bf16 v[36:39], v[240:243], a[124:127], 0
    s_waitcnt lgkmcnt(3)
    v_mfma_f32_16x16x32_bf16 v[24:27], v[236:239], a[188:191], 0
    v_mfma_f32_16x16x32_bf16 v[40:43], v[240:243], a[188:191], 0
    ds_read_b128 a[56:59], v7 offset:224
    s_waitcnt lgkmcnt(3)
    v_mfma_f32_16x16x32_bf16 v[28:31], v[236:239], a[252:255], 0
    ds_read_b128 v[112:115], v6 offset:64
    v_mfma_f32_16x16x32_bf16 v[44:47], v[240:243], a[252:255], 0
    ds_read_b128 v[116:119], v6 offset:96
    s_waitcnt lgkmcnt(4)
    v_mfma_f32_16x16x32_bf16 v[16:19], v[168:171], a[60:63], v[16:19]
    ds_read_b128 a[120:123], v7 offset:480
    s_waitcnt lgkmcnt(4)
    v_mfma_f32_16x16x32_bf16 v[32:35], v[172:175], a[60:63], v[32:35]
    s_waitcnt vmcnt(18)
    v_mfma_f32_16x16x32_bf16 v[20:23], v[168:171], a[124:127], v[20:23]
    ds_read_b128 a[184:187], v7 offset:736
    v_mfma_f32_16x16x32_bf16 v[36:39], v[172:175], a[124:127], v[36:39]
    ds_write_b128 v5, v[196:199] offset:2048
    v_mfma_f32_16x16x32_bf16 v[24:27], v[168:171], a[188:191], v[24:27]
    ds_read_b128 a[248:251], v7 offset:992
    v_mfma_f32_16x16x32_bf16 v[40:43], v[172:175], a[188:191], v[40:43]
    ds_read_b128 a[52:55], v7 offset:208
    v_mfma_f32_16x16x32_bf16 v[28:31], v[168:171], a[252:255], v[28:31]
    ds_read_b128 v[120:123], v6 offset:128
    v_mfma_f32_16x16x32_bf16 v[44:47], v[172:175], a[252:255], v[44:47]
    ds_read_b128 v[124:127], v6 offset:160
    s_waitcnt lgkmcnt(8)
    v_mfma_f32_16x16x32_bf16 v[16:19], v[112:115], a[56:59], v[16:19]
    ds_read_b128 a[116:119], v7 offset:464
    s_waitcnt lgkmcnt(8)
    v_mfma_f32_16x16x32_bf16 v[32:35], v[116:119], a[56:59], v[32:35]
    ds_write_b128 v5, v[194:197] offset:18688
    s_waitcnt lgkmcnt(8)
    v_mfma_f32_16x16x32_bf16 v[20:23], v[112:115], a[120:123], v[20:23]
    ds_read_b128 a[180:183], v7 offset:720
    v_mfma_f32_16x16x32_bf16 v[36:39], v[116:119], a[120:123], v[36:39]
    v_mov_b32 v208, v193
    v_mov_b32 v209, v194
    s_waitcnt lgkmcnt(8)
    v_mfma_f32_16x16x32_bf16 v[24:27], v[112:115], a[184:187], v[24:27]
    ds_read_b128 a[244:247], v7 offset:976
    v_mfma_f32_16x16x32_bf16 v[40:43], v[116:119], a[184:187], v[40:43]
    ds_read_b128 a[48:51], v7 offset:192
    s_waitcnt lgkmcnt(8)
    v_mfma_f32_16x16x32_bf16 v[28:31], v[112:115], a[248:251], v[28:31]
    ds_read_b128 v[128:131], v6 offset:192
    v_mfma_f32_16x16x32_bf16 v[44:47], v[116:119], a[248:251], v[44:47]
    ds_read_b128 v[132:135], v6 offset:224
    s_waitcnt lgkmcnt(8)
    v_mfma_f32_16x16x32_bf16 v[16:19], v[120:123], a[52:55], v[16:19]
    ds_read_b128 a[112:115], v7 offset:448
    s_waitcnt lgkmcnt(8)
    v_mfma_f32_16x16x32_bf16 v[32:35], v[124:127], a[52:55], v[32:35]
    v_mov_b32 v210, v195
    v_mov_b32 v211, v196
    s_waitcnt lgkmcnt(7)
    v_mfma_f32_16x16x32_bf16 v[20:23], v[120:123], a[116:119], v[20:23]
    ds_read_b128 a[176:179], v7 offset:704
    v_mfma_f32_16x16x32_bf16 v[36:39], v[124:127], a[116:119], v[36:39]
    ds_write_b128 v5, v[208:211] offset:27008
    s_waitcnt lgkmcnt(7)
    v_mfma_f32_16x16x32_bf16 v[24:27], v[120:123], a[180:183], v[24:27]
    ds_read_b128 a[240:243], v7 offset:960
    v_mfma_f32_16x16x32_bf16 v[40:43], v[124:127], a[180:183], v[40:43]
    ds_read_b128 a[44:47], v7 offset:176
    s_waitcnt lgkmcnt(8)
    v_mfma_f32_16x16x32_bf16 v[28:31], v[120:123], a[244:247], v[28:31]
    ds_read_b128 v[136:139], v6 offset:256
    v_mfma_f32_16x16x32_bf16 v[44:47], v[124:127], a[244:247], v[44:47]
    ds_read_b128 v[140:143], v6 offset:288
    s_waitcnt lgkmcnt(8)
    v_mfma_f32_16x16x32_bf16 v[16:19], v[128:131], a[48:51], v[16:19]
    ds_read_b128 a[108:111], v7 offset:432
    s_waitcnt lgkmcnt(8)
    v_mfma_f32_16x16x32_bf16 v[32:35], v[132:135], a[48:51], v[32:35]
    v_mov_b32 v212, v197
    v_mov_b32 v213, v198
    s_waitcnt lgkmcnt(7)
    v_mfma_f32_16x16x32_bf16 v[20:23], v[128:131], a[112:115], v[20:23]
    ds_read_b128 a[172:175], v7 offset:688
    v_mfma_f32_16x16x32_bf16 v[36:39], v[132:135], a[112:115], v[36:39]
    ds_write_b128 v5, v[210:213] offset:10368
    s_waitcnt lgkmcnt(8)
    v_mfma_f32_16x16x32_bf16 v[24:27], v[128:131], a[176:179], v[24:27]
    ds_read_b128 a[236:239], v7 offset:944
    v_mfma_f32_16x16x32_bf16 v[40:43], v[132:135], a[176:179], v[40:43]
    ds_read_b128 a[40:43], v7 offset:160
    s_waitcnt lgkmcnt(8)
    v_mfma_f32_16x16x32_bf16 v[28:31], v[128:131], a[240:243], v[28:31]
    ds_read_b128 v[144:147], v6 offset:320
    v_mfma_f32_16x16x32_bf16 v[44:47], v[132:135], a[240:243], v[44:47]
    ds_read_b128 v[148:151], v6 offset:352
    s_waitcnt lgkmcnt(8)
    v_mfma_f32_16x16x32_bf16 v[16:19], v[136:139], a[44:47], v[16:19]
    ds_read_b128 a[104:107], v7 offset:416
    s_waitcnt lgkmcnt(8)
    v_mfma_f32_16x16x32_bf16 v[32:35], v[140:143], a[44:47], v[32:35]
    v_alignbit_b32 v214, v193, v192, 16
    v_alignbit_b32 v215, v194, v193, 16
    s_waitcnt lgkmcnt(7)
    v_mfma_f32_16x16x32_bf16 v[20:23], v[136:139], a[108:111], v[20:23]
    ds_read_b128 a[168:171], v7 offset:672
    v_mfma_f32_16x16x32_bf16 v[36:39], v[140:143], a[108:111], v[36:39]
    v_alignbit_b32 v216, v195, v194, 16
    v_alignbit_b32 v217, v196, v195, 16
    s_waitcnt lgkmcnt(7)
    v_mfma_f32_16x16x32_bf16 v[24:27], v[136:139], a[172:175], v[24:27]
    ds_read_b128 a[232:235], v7 offset:928
    v_mfma_f32_16x16x32_bf16 v[40:43], v[140:143], a[172:175], v[40:43]
    ds_read_b128 a[36:39], v7 offset:144
    s_waitcnt lgkmcnt(7)
    v_mfma_f32_16x16x32_bf16 v[28:31], v[136:139], a[236:239], v[28:31]
    ds_read_b128 v[152:155], v6 offset:384
    v_mfma_f32_16x16x32_bf16 v[44:47], v[140:143], a[236:239], v[44:47]
    ds_read_b128 v[156:159], v6 offset:416
    s_waitcnt lgkmcnt(7)
    v_mfma_f32_16x16x32_bf16 v[16:19], v[144:147], a[40:43], v[16:19]
    ds_read_b128 a[100:103], v7 offset:400
    s_waitcnt lgkmcnt(7)
    v_mfma_f32_16x16x32_bf16 v[32:35], v[148:151], a[40:43], v[32:35]
    ds_write_b128 v5, v[214:217] offset:31168
    s_waitcnt lgkmcnt(7)
    v_mfma_f32_16x16x32_bf16 v[20:23], v[144:147], a[104:107], v[20:23]
    ds_read_b128 a[164:167], v7 offset:656
    v_mfma_f32_16x16x32_bf16 v[36:39], v[148:151], a[104:107], v[36:39]
    v_alignbit_b32 v218, v197, v196, 16
    v_alignbit_b32 v219, v198, v197, 16
    s_waitcnt lgkmcnt(7)
    v_mfma_f32_16x16x32_bf16 v[24:27], v[144:147], a[168:171], v[24:27]
    ds_read_b128 a[228:231], v7 offset:912
    v_mfma_f32_16x16x32_bf16 v[40:43], v[148:151], a[168:171], v[40:43]
    ds_read_b128 a[32:35], v7 offset:128
    s_waitcnt lgkmcnt(8)
    v_mfma_f32_16x16x32_bf16 v[28:31], v[144:147], a[232:235], v[28:31]
    ds_read_b128 v[160:163], v6 offset:448
    v_mfma_f32_16x16x32_bf16 v[44:47], v[148:151], a[232:235], v[44:47]
    ds_read_b128 v[164:167], v6 offset:480
    s_waitcnt lgkmcnt(8)
    v_mfma_f32_16x16x32_bf16 v[16:19], v[152:155], a[36:39], v[16:19]
    ds_read_b128 a[96:99], v7 offset:384
    s_waitcnt lgkmcnt(8)
    v_mfma_f32_16x16x32_bf16 v[32:35], v[156:159], a[36:39], v[32:35]
    ds_write_b128 v5, v[216:219] offset:14528
    s_waitcnt lgkmcnt(8)
    v_mfma_f32_16x16x32_bf16 v[20:23], v[152:155], a[100:103], v[20:23]
    ds_read_b128 a[160:163], v7 offset:640
    v_mfma_f32_16x16x32_bf16 v[36:39], v[156:159], a[100:103], v[36:39]
    v_alignbit_b32 v220, v194, v193, 16
    v_alignbit_b32 v221, v195, v194, 16
    s_waitcnt lgkmcnt(7)
    v_mfma_f32_16x16x32_bf16 v[24:27], v[152:155], a[164:167], v[24:27]
    ds_read_b128 a[224:227], v7 offset:896
    v_mfma_f32_16x16x32_bf16 v[40:43], v[156:159], a[164:167], v[40:43]
    ds_read_b128 a[28:31], v7 offset:112
    s_waitcnt lgkmcnt(8)
    v_mfma_f32_16x16x32_bf16 v[28:31], v[152:155], a[228:231], v[28:31]
    ds_read_b128 v[168:171], v6 offset:512
    v_mfma_f32_16x16x32_bf16 v[44:47], v[156:159], a[228:231], v[44:47]
    ds_read_b128 v[172:175], v6 offset:544
    s_waitcnt lgkmcnt(8)
    v_mfma_f32_16x16x32_bf16 v[16:19], v[160:163], a[32:35], v[16:19]
    ds_read_b128 a[92:95], v7 offset:368
    s_waitcnt lgkmcnt(8)
    v_mfma_f32_16x16x32_bf16 v[32:35], v[164:167], a[32:35], v[32:35]
    v_alignbit_b32 v222, v196, v195, 16
    v_alignbit_b32 v223, v197, v196, 16
    s_waitcnt lgkmcnt(7)
    v_mfma_f32_16x16x32_bf16 v[20:23], v[160:163], a[96:99], v[20:23]
    ds_read_b128 a[156:159], v7 offset:624
    v_mfma_f32_16x16x32_bf16 v[36:39], v[164:167], a[96:99], v[36:39]
    ds_write_b128 v5, v[220:223] offset:22848
    s_waitcnt lgkmcnt(7)
    v_mfma_f32_16x16x32_bf16 v[24:27], v[160:163], a[160:163], v[24:27]
    ds_read_b128 a[220:223], v7 offset:880
    v_mfma_f32_16x16x32_bf16 v[40:43], v[164:167], a[160:163], v[40:43]
    ds_read_b128 a[24:27], v7 offset:96
    s_waitcnt lgkmcnt(8)
    v_mfma_f32_16x16x32_bf16 v[28:31], v[160:163], a[224:227], v[28:31]
    ds_read_b128 v[112:115], v6 offset:576
    v_mfma_f32_16x16x32_bf16 v[44:47], v[164:167], a[224:227], v[44:47]
    ds_read_b128 v[116:119], v6 offset:608
    s_waitcnt lgkmcnt(8)
    v_mfma_f32_16x16x32_bf16 v[16:19], v[168:171], a[28:31], v[16:19]
    ds_read_b128 a[88:91], v7 offset:352
    s_waitcnt lgkmcnt(8)
    v_mfma_f32_16x16x32_bf16 v[32:35], v[172:175], a[28:31], v[32:35]
    v_alignbit_b32 v224, v198, v197, 16
    v_alignbit_b32 v225, v199, v198, 16
    s_waitcnt lgkmcnt(7)
    v_mfma_f32_16x16x32_bf16 v[20:23], v[168:171], a[92:95], v[20:23]
    ds_read_b128 a[152:155], v7 offset:608
    v_mfma_f32_16x16x32_bf16 v[36:39], v[172:175], a[92:95], v[36:39]
    ds_write_b128 v5, v[222:225] offset:6208
    s_waitcnt lgkmcnt(8)
    v_mfma_f32_16x16x32_bf16 v[24:27], v[168:171], a[156:159], v[24:27]
    ds_read_b128 a[216:219], v7 offset:864
    v_mfma_f32_16x16x32_bf16 v[40:43], v[172:175], a[156:159], v[40:43]
    ds_read_b128 a[20:23], v7 offset:80
    s_waitcnt lgkmcnt(8)
    v_mfma_f32_16x16x32_bf16 v[28:31], v[168:171], a[220:223], v[28:31]
    ds_read_b128 v[120:123], v6 offset:640
    v_mfma_f32_16x16x32_bf16 v[44:47], v[172:175], a[220:223], v[44:47]
    ds_read_b128 v[124:127], v6 offset:672
    s_waitcnt lgkmcnt(8)
    v_mfma_f32_16x16x32_bf16 v[16:19], v[112:115], a[24:27], v[16:19]
    ds_read_b128 a[84:87], v7 offset:336
    s_waitcnt lgkmcnt(8)
    v_mfma_f32_16x16x32_bf16 v[32:35], v[116:119], a[24:27], v[32:35]
    buffer_load_dwordx4 v[192:195], v4, s[28:31], s36 offen offset:2032
    s_waitcnt lgkmcnt(7)
    v_mfma_f32_16x16x32_bf16 v[20:23], v[112:115], a[88:91], v[20:23]
    ds_read_b128 a[148:151], v7 offset:592
    v_mfma_f32_16x16x32_bf16 v[36:39], v[116:119], a[88:91], v[36:39]
    buffer_load_dwordx4 v[196:199], v4, s[28:31], s36 offen offset:2048
    s_waitcnt lgkmcnt(7)
    v_mfma_f32_16x16x32_bf16 v[24:27], v[112:115], a[152:155], v[24:27]
    ds_read_b128 a[212:215], v7 offset:848
    v_mfma_f32_16x16x32_bf16 v[40:43], v[116:119], a[152:155], v[40:43]
    ds_read_b128 a[16:19], v7 offset:64
    s_waitcnt lgkmcnt(7)
    v_mfma_f32_16x16x32_bf16 v[28:31], v[112:115], a[216:219], v[28:31]
    ds_read_b128 v[128:131], v6 offset:704
    v_mfma_f32_16x16x32_bf16 v[44:47], v[116:119], a[216:219], v[44:47]
    ds_read_b128 v[132:135], v6 offset:736
    s_waitcnt lgkmcnt(7)
    v_mfma_f32_16x16x32_bf16 v[16:19], v[120:123], a[20:23], v[16:19]
    ds_read_b128 a[80:83], v7 offset:320
    s_waitcnt lgkmcnt(7)
    v_mfma_f32_16x16x32_bf16 v[32:35], v[124:127], a[20:23], v[32:35]
    s_waitcnt vmcnt(18)
    s_waitcnt lgkmcnt(6)
    v_mfma_f32_16x16x32_bf16 v[20:23], v[120:123], a[84:87], v[20:23]
    ds_read_b128 a[144:147], v7 offset:576
    v_mfma_f32_16x16x32_bf16 v[36:39], v[124:127], a[84:87], v[36:39]
    ds_write_b128 v5, v[204:207] offset:3072
    s_waitcnt lgkmcnt(7)
    v_mfma_f32_16x16x32_bf16 v[24:27], v[120:123], a[148:151], v[24:27]
    ds_read_b128 a[208:211], v7 offset:832
    v_mfma_f32_16x16x32_bf16 v[40:43], v[124:127], a[148:151], v[40:43]
    ds_read_b128 a[12:15], v7 offset:48
    s_waitcnt lgkmcnt(8)
    v_mfma_f32_16x16x32_bf16 v[28:31], v[120:123], a[212:215], v[28:31]
    ds_read_b128 v[136:139], v6 offset:768
    v_mfma_f32_16x16x32_bf16 v[44:47], v[124:127], a[212:215], v[44:47]
    ds_read_b128 v[140:143], v6 offset:800
    s_waitcnt lgkmcnt(8)
    v_mfma_f32_16x16x32_bf16 v[16:19], v[128:131], a[16:19], v[16:19]
    ds_read_b128 a[76:79], v7 offset:304
    s_waitcnt lgkmcnt(8)
    v_mfma_f32_16x16x32_bf16 v[32:35], v[132:135], a[16:19], v[32:35]
    ds_write_b128 v5, v[202:205] offset:19712
    s_waitcnt lgkmcnt(8)
    v_mfma_f32_16x16x32_bf16 v[20:23], v[128:131], a[80:83], v[20:23]
    ds_read_b128 a[140:143], v7 offset:560
    v_mfma_f32_16x16x32_bf16 v[36:39], v[132:135], a[80:83], v[36:39]
    v_mov_b32 v208, v201
    v_mov_b32 v209, v202
    s_waitcnt lgkmcnt(8)
    v_mfma_f32_16x16x32_bf16 v[24:27], v[128:131], a[144:147], v[24:27]
    ds_read_b128 a[204:207], v7 offset:816
    v_mfma_f32_16x16x32_bf16 v[40:43], v[132:135], a[144:147], v[40:43]
    ds_read_b128 a[8:11], v7 offset:32
    s_waitcnt lgkmcnt(8)
    v_mfma_f32_16x16x32_bf16 v[28:31], v[128:131], a[208:211], v[28:31]
    ds_read_b128 v[144:147], v6 offset:832
    v_mfma_f32_16x16x32_bf16 v[44:47], v[132:135], a[208:211], v[44:47]
    ds_read_b128 v[148:151], v6 offset:864
    s_waitcnt lgkmcnt(8)
    v_mfma_f32_16x16x32_bf16 v[16:19], v[136:139], a[12:15], v[16:19]
    ds_read_b128 a[72:75], v7 offset:288
    s_waitcnt lgkmcnt(8)
    v_mfma_f32_16x16x32_bf16 v[32:35], v[140:143], a[12:15], v[32:35]
    v_mov_b32 v210, v203
    v_mov_b32 v211, v204
    s_waitcnt lgkmcnt(7)
    v_mfma_f32_16x16x32_bf16 v[20:23], v[136:139], a[76:79], v[20:23]
    ds_read_b128 a[136:139], v7 offset:544
    v_mfma_f32_16x16x32_bf16 v[36:39], v[140:143], a[76:79], v[36:39]
    ds_write_b128 v5, v[208:211] offset:28032
    s_waitcnt lgkmcnt(7)
    v_mfma_f32_16x16x32_bf16 v[24:27], v[136:139], a[140:143], v[24:27]
    ds_read_b128 a[200:203], v7 offset:800
    v_mfma_f32_16x16x32_bf16 v[40:43], v[140:143], a[140:143], v[40:43]
    ds_read_b128 a[4:7], v7 offset:16
    s_waitcnt lgkmcnt(8)
    v_mfma_f32_16x16x32_bf16 v[28:31], v[136:139], a[204:207], v[28:31]
    ds_read_b128 v[152:155], v6 offset:896
    v_mfma_f32_16x16x32_bf16 v[44:47], v[140:143], a[204:207], v[44:47]
    ds_read_b128 v[156:159], v6 offset:928
    s_waitcnt lgkmcnt(8)
    v_mfma_f32_16x16x32_bf16 v[16:19], v[144:147], a[8:11], v[16:19]
    ds_read_b128 a[68:71], v7 offset:272
    s_waitcnt lgkmcnt(8)
    v_mfma_f32_16x16x32_bf16 v[32:35], v[148:151], a[8:11], v[32:35]
    v_mov_b32 v212, v205
    v_mov_b32 v213, v206
    s_waitcnt lgkmcnt(7)
    v_mfma_f32_16x16x32_bf16 v[20:23], v[144:147], a[72:75], v[20:23]
    ds_read_b128 a[132:135], v7 offset:528
    v_mfma_f32_16x16x32_bf16 v[36:39], v[148:151], a[72:75], v[36:39]
    ds_write_b128 v5, v[210:213] offset:11392
    s_waitcnt lgkmcnt(8)
    v_mfma_f32_16x16x32_bf16 v[24:27], v[144:147], a[136:139], v[24:27]
    ds_read_b128 a[196:199], v7 offset:784
    v_mfma_f32_16x16x32_bf16 v[40:43], v[148:151], a[136:139], v[40:43]
    ds_read_b128 a[0:3], v7 offset:0
    s_waitcnt lgkmcnt(8)
    v_mfma_f32_16x16x32_bf16 v[28:31], v[144:147], a[200:203], v[28:31]
    ds_read_b128 v[160:163], v6 offset:960
    v_mfma_f32_16x16x32_bf16 v[44:47], v[148:151], a[200:203], v[44:47]
    ds_read_b128 v[164:167], v6 offset:992
    s_waitcnt lgkmcnt(8)
    v_mfma_f32_16x16x32_bf16 v[16:19], v[152:155], a[4:7], v[16:19]
    ds_read_b128 a[64:67], v7 offset:256
    s_waitcnt lgkmcnt(8)
    v_mfma_f32_16x16x32_bf16 v[32:35], v[156:159], a[4:7], v[32:35]
    v_alignbit_b32 v214, v201, v200, 16
    v_alignbit_b32 v215, v202, v201, 16
    s_waitcnt lgkmcnt(7)
    v_mfma_f32_16x16x32_bf16 v[20:23], v[152:155], a[68:71], v[20:23]
    ds_read_b128 a[128:131], v7 offset:512
    v_mfma_f32_16x16x32_bf16 v[36:39], v[156:159], a[68:71], v[36:39]
    v_alignbit_b32 v216, v203, v202, 16
    v_alignbit_b32 v217, v204, v203, 16
    s_waitcnt lgkmcnt(7)
    v_mfma_f32_16x16x32_bf16 v[24:27], v[152:155], a[132:135], v[24:27]
    ds_read_b128 a[192:195], v7 offset:768
    v_mfma_f32_16x16x32_bf16 v[40:43], v[156:159], a[132:135], v[40:43]
    ds_write_b128 v5, v[214:217] offset:32192
    s_waitcnt lgkmcnt(7)
    v_mfma_f32_16x16x32_bf16 v[28:31], v[152:155], a[196:199], v[28:31]
    ds_read_b128 v[168:171], v6 offset:1024
    v_mfma_f32_16x16x32_bf16 v[44:47], v[156:159], a[196:199], v[44:47]
    ds_read_b128 v[172:175], v6 offset:1056
    s_waitcnt lgkmcnt(7)
    v_mfma_f32_16x16x32_bf16 v[16:19], v[160:163], a[0:3], v[16:19]
    v_alignbit_b32 v218, v205, v204, 16
    v_alignbit_b32 v219, v206, v205, 16
    s_waitcnt lgkmcnt(6)
    v_mfma_f32_16x16x32_bf16 v[32:35], v[164:167], a[0:3], v[32:35]
    ds_write_b128 v5, v[216:219] offset:15552
    s_waitcnt lgkmcnt(6)
    v_mfma_f32_16x16x32_bf16 v[20:23], v[160:163], a[64:67], v[20:23]
    v_alignbit_b32 v220, v202, v201, 16
    v_alignbit_b32 v221, v203, v202, 16
    v_mfma_f32_16x16x32_bf16 v[36:39], v[164:167], a[64:67], v[36:39]
    v_alignbit_b32 v222, v204, v203, 16
    v_alignbit_b32 v223, v205, v204, 16
    s_waitcnt lgkmcnt(5)
    v_mfma_f32_16x16x32_bf16 v[24:27], v[160:163], a[128:131], v[24:27]
    ds_read_b128 v[112:115], v6 offset:1088
    v_mfma_f32_16x16x32_bf16 v[40:43], v[164:167], a[128:131], v[40:43]
    ds_read_b128 v[116:119], v6 offset:1120
    s_waitcnt lgkmcnt(6)
    v_mfma_f32_16x16x32_bf16 v[28:31], v[160:163], a[192:195], v[28:31]
    ds_write_b128 v5, v[220:223] offset:23872
    v_mfma_f32_16x16x32_bf16 v[44:47], v[164:167], a[192:195], v[44:47]
    v_alignbit_b32 v224, v206, v205, 16
    v_alignbit_b32 v225, v207, v206, 16
    s_waitcnt lgkmcnt(5)
    v_mfma_f32_16x16x32_bf16 v[20:23], v[168:171], a[60:63], v[20:23]
    ds_write_b128 v5, v[222:225] offset:7232
    s_waitcnt lgkmcnt(5)
    v_mfma_f32_16x16x32_bf16 v[36:39], v[172:175], a[60:63], v[36:39]
    buffer_load_dwordx4 v[200:203], v4, s[28:31], s36 offen offset:3056
    v_mfma_f32_16x16x32_bf16 v[24:27], v[168:171], a[124:127], v[24:27]
    ds_read_b128 v[120:123], v6 offset:1152
    v_mfma_f32_16x16x32_bf16 v[40:43], v[172:175], a[124:127], v[40:43]
    ds_read_b128 v[124:127], v6 offset:1184
    v_mfma_f32_16x16x32_bf16 v[28:31], v[168:171], a[188:191], v[28:31]
    buffer_load_dwordx4 v[204:207], v4, s[28:31], s36 offen offset:3072
    v_mfma_f32_16x16x32_bf16 v[44:47], v[172:175], a[188:191], v[44:47]
    s_waitcnt vmcnt(18)
    s_mov_b64 exec, 1
    v_mov_b32 v176, 0
    v_mov_b32 v177, 0
    v_mov_b32 v178, 0
    v_mov_b32 v179, 0
    s_mov_b64 exec, -1
    s_waitcnt lgkmcnt(5)
    v_mfma_f32_16x16x32_bf16 v[20:23], v[112:115], a[56:59], v[20:23]
    ds_write_b128 v5, v[180:183] offset:0
    s_waitcnt lgkmcnt(5)
    v_mfma_f32_16x16x32_bf16 v[36:39], v[116:119], a[56:59], v[36:39]
    ds_write_b128 v5, v[178:181] offset:16640
    v_mfma_f32_16x16x32_bf16 v[24:27], v[112:115], a[120:123], v[24:27]
    ds_read_b128 v[128:131], v6 offset:1216
    v_mfma_f32_16x16x32_bf16 v[40:43], v[116:119], a[120:123], v[40:43]
    ds_read_b128 v[132:135], v6 offset:1248
    v_mfma_f32_16x16x32_bf16 v[28:31], v[112:115], a[184:187], v[28:31]
    v_mov_b32 v208, v177
    v_mov_b32 v209, v178
    v_mfma_f32_16x16x32_bf16 v[44:47], v[116:119], a[184:187], v[44:47]
    v_mov_b32 v210, v179
    v_mov_b32 v211, v180
    s_waitcnt lgkmcnt(5)
    v_mfma_f32_16x16x32_bf16 v[20:23], v[120:123], a[52:55], v[20:23]
    ds_write_b128 v5, v[208:211] offset:24960
    s_waitcnt lgkmcnt(5)
    v_mfma_f32_16x16x32_bf16 v[36:39], v[124:127], a[52:55], v[36:39]
    v_mov_b32 v212, v181
    v_mov_b32 v213, v182
    v_mfma_f32_16x16x32_bf16 v[24:27], v[120:123], a[116:119], v[24:27]
    ds_read_b128 v[136:139], v6 offset:1280
    v_mfma_f32_16x16x32_bf16 v[40:43], v[124:127], a[116:119], v[40:43]
    ds_read_b128 v[140:143], v6 offset:1312
    v_mfma_f32_16x16x32_bf16 v[28:31], v[120:123], a[180:183], v[28:31]
    ds_write_b128 v5, v[210:213] offset:8320
    v_mfma_f32_16x16x32_bf16 v[44:47], v[124:127], a[180:183], v[44:47]
    v_alignbit_b32 v214, v177, v176, 16
    v_alignbit_b32 v215, v178, v177, 16
    s_waitcnt lgkmcnt(5)
    v_mfma_f32_16x16x32_bf16 v[20:23], v[128:131], a[48:51], v[20:23]
    v_alignbit_b32 v216, v179, v178, 16
    v_alignbit_b32 v217, v180, v179, 16
    s_waitcnt lgkmcnt(4)
    v_mfma_f32_16x16x32_bf16 v[36:39], v[132:135], a[48:51], v[36:39]
    ds_write_b128 v5, v[214:217] offset:29120
    v_mfma_f32_16x16x32_bf16 v[24:27], v[128:131], a[112:115], v[24:27]
    ds_read_b128 v[144:147], v6 offset:1344
    v_mfma_f32_16x16x32_bf16 v[40:43], v[132:135], a[112:115], v[40:43]
    ds_read_b128 v[148:151], v6 offset:1376
    v_mfma_f32_16x16x32_bf16 v[28:31], v[128:131], a[176:179], v[28:31]
    v_alignbit_b32 v218, v181, v180, 16
    v_alignbit_b32 v219, v182, v181, 16
    v_mfma_f32_16x16x32_bf16 v[44:47], v[132:135], a[176:179], v[44:47]
    ds_write_b128 v5, v[216:219] offset:12480
    s_waitcnt lgkmcnt(6)
    v_mfma_f32_16x16x32_bf16 v[20:23], v[136:139], a[44:47], v[20:23]
    v_alignbit_b32 v220, v178, v177, 16
    v_alignbit_b32 v221, v179, v178, 16
    s_waitcnt lgkmcnt(5)
    v_mfma_f32_16x16x32_bf16 v[36:39], v[140:143], a[44:47], v[36:39]
    v_alignbit_b32 v222, v180, v179, 16
    v_alignbit_b32 v223, v181, v180, 16
    v_mfma_f32_16x16x32_bf16 v[24:27], v[136:139], a[108:111], v[24:27]
    ds_read_b128 v[152:155], v6 offset:1408
    v_mfma_f32_16x16x32_bf16 v[40:43], v[140:143], a[108:111], v[40:43]
    ds_read_b128 v[156:159], v6 offset:1440
    v_mfma_f32_16x16x32_bf16 v[28:31], v[136:139], a[172:175], v[28:31]
    ds_write_b128 v5, v[220:223] offset:20800
    v_mfma_f32_16x16x32_bf16 v[44:47], v[140:143], a[172:175], v[44:47]
    v_alignbit_b32 v224, v182, v181, 16
    v_alignbit_b32 v225, v183, v182, 16
    s_waitcnt lgkmcnt(5)
    v_mfma_f32_16x16x32_bf16 v[20:23], v[144:147], a[40:43], v[20:23]
    ds_write_b128 v5, v[222:225] offset:4160
    s_waitcnt lgkmcnt(5)
    v_mfma_f32_16x16x32_bf16 v[36:39], v[148:151], a[40:43], v[36:39]
    buffer_load_dwordx4 v[176:179], v230, s[28:31], s37 offen offset:0
    v_mfma_f32_16x16x32_bf16 v[24:27], v[144:147], a[104:107], v[24:27]
    ds_read_b128 v[160:163], v6 offset:1472
    v_mfma_f32_16x16x32_bf16 v[40:43], v[148:151], a[104:107], v[40:43]
    ds_read_b128 v[164:167], v6 offset:1504
    v_mfma_f32_16x16x32_bf16 v[28:31], v[144:147], a[168:171], v[28:31]
    buffer_load_dwordx4 v[180:183], v4, s[28:31], s37 offen offset:0
    v_mfma_f32_16x16x32_bf16 v[44:47], v[148:151], a[168:171], v[44:47]
    s_add_u32 m0, s35, 0
    s_waitcnt lgkmcnt(5)
    v_mfma_f32_16x16x32_bf16 v[20:23], v[152:155], a[36:39], v[20:23]
    buffer_load_dwordx4 v4, s[8:11], s39 offen offset:0 lds
    s_waitcnt lgkmcnt(4)
    v_mfma_f32_16x16x32_bf16 v[36:39], v[156:159], a[36:39], v[36:39]
    s_add_u32 m0, s35, 256
    v_mfma_f32_16x16x32_bf16 v[24:27], v[152:155], a[100:103], v[24:27]
    ds_read_b128 v[168:171], v6 offset:1536
    v_mfma_f32_16x16x32_bf16 v[40:43], v[156:159], a[100:103], v[40:43]
    ds_read_b128 v[172:175], v6 offset:1568
    v_mfma_f32_16x16x32_bf16 v[28:31], v[152:155], a[164:167], v[28:31]
    buffer_load_dwordx4 v4, s[8:11], s39 offen offset:1024 lds
    v_mfma_f32_16x16x32_bf16 v[44:47], v[156:159], a[164:167], v[44:47]
    s_add_u32 m0, s35, 512
    s_waitcnt lgkmcnt(3)
    v_mfma_f32_16x16x32_bf16 v[20:23], v[160:163], a[32:35], v[20:23]
    buffer_load_dwordx4 v4, s[8:11], s39 offen offset:2048 lds
    s_waitcnt lgkmcnt(2)
    v_mfma_f32_16x16x32_bf16 v[36:39], v[164:167], a[32:35], v[36:39]
    s_add_u32 m0, s35, 768
    v_mfma_f32_16x16x32_bf16 v[24:27], v[160:163], a[96:99], v[24:27]
    ds_read_b128 v[112:115], v6 offset:1600
    v_mfma_f32_16x16x32_bf16 v[40:43], v[164:167], a[96:99], v[40:43]
    ds_read_b128 v[116:119], v6 offset:1632
    v_mfma_f32_16x16x32_bf16 v[28:31], v[160:163], a[160:163], v[28:31]
    buffer_load_dwordx4 v4, s[8:11], s39 offen offset:3072 lds
    v_mfma_f32_16x16x32_bf16 v[44:47], v[164:167], a[160:163], v[44:47]
    s_waitcnt lgkmcnt(3)
    v_mfma_f32_16x16x32_bf16 v[20:23], v[168:171], a[28:31], v[20:23]
    s_waitcnt lgkmcnt(2)
    v_mfma_f32_16x16x32_bf16 v[36:39], v[172:175], a[28:31], v[36:39]
    v_mfma_f32_16x16x32_bf16 v[24:27], v[168:171], a[92:95], v[24:27]
    ds_read_b128 v[120:123], v6 offset:1664
    v_mfma_f32_16x16x32_bf16 v[40:43], v[172:175], a[92:95], v[40:43]
    ds_read_b128 v[124:127], v6 offset:1696
    v_mfma_f32_16x16x32_bf16 v[28:31], v[168:171], a[156:159], v[28:31]
    v_mfma_f32_16x16x32_bf16 v[44:47], v[172:175], a[156:159], v[44:47]
    s_waitcnt lgkmcnt(3)
    v_mfma_f32_16x16x32_bf16 v[20:23], v[112:115], a[24:27], v[20:23]
    s_waitcnt lgkmcnt(2)
    v_mfma_f32_16x16x32_bf16 v[36:39], v[116:119], a[24:27], v[36:39]
    v_mfma_f32_16x16x32_bf16 v[24:27], v[112:115], a[88:91], v[24:27]
    ds_read_b128 v[128:131], v6 offset:1728
    v_mfma_f32_16x16x32_bf16 v[40:43], v[116:119], a[88:91], v[40:43]
    ds_read_b128 v[132:135], v6 offset:1760
    v_mfma_f32_16x16x32_bf16 v[28:31], v[112:115], a[152:155], v[28:31]
    v_mfma_f32_16x16x32_bf16 v[44:47], v[116:119], a[152:155], v[44:47]
    s_waitcnt lgkmcnt(3)
    v_mfma_f32_16x16x32_bf16 v[20:23], v[120:123], a[20:23], v[20:23]
    s_waitcnt lgkmcnt(2)
    v_mfma_f32_16x16x32_bf16 v[36:39], v[124:127], a[20:23], v[36:39]
    v_mfma_f32_16x16x32_bf16 v[24:27], v[120:123], a[84:87], v[24:27]
    ds_read_b128 v[136:139], v6 offset:1792
    v_mfma_f32_16x16x32_bf16 v[40:43], v[124:127], a[84:87], v[40:43]
    ds_read_b128 v[140:143], v6 offset:1824
    v_mfma_f32_16x16x32_bf16 v[28:31], v[120:123], a[148:151], v[28:31]
    v_mfma_f32_16x16x32_bf16 v[44:47], v[124:127], a[148:151], v[44:47]
    s_waitcnt lgkmcnt(3)
    v_mfma_f32_16x16x32_bf16 v[20:23], v[128:131], a[16:19], v[20:23]
    s_waitcnt lgkmcnt(2)
    v_mfma_f32_16x16x32_bf16 v[36:39], v[132:135], a[16:19], v[36:39]
    v_mfma_f32_16x16x32_bf16 v[24:27], v[128:131], a[80:83], v[24:27]
    ds_read_b128 v[144:147], v6 offset:1856
    v_mfma_f32_16x16x32_bf16 v[40:43], v[132:135], a[80:83], v[40:43]
    ds_read_b128 v[148:151], v6 offset:1888
    v_mfma_f32_16x16x32_bf16 v[28:31], v[128:131], a[144:147], v[28:31]
    v_mfma_f32_16x16x32_bf16 v[44:47], v[132:135], a[144:147], v[44:47]
    s_waitcnt lgkmcnt(3)
    v_mfma_f32_16x16x32_bf16 v[20:23], v[136:139], a[12:15], v[20:23]
    s_waitcnt lgkmcnt(2)
    v_mfma_f32_16x16x32_bf16 v[36:39], v[140:143], a[12:15], v[36:39]
    v_mfma_f32_16x16x32_bf16 v[24:27], v[136:139], a[76:79], v[24:27]
    ds_read_b128 v[152:155], v6 offset:1920
    v_mfma_f32_16x16x32_bf16 v[40:43], v[140:143], a[76:79], v[40:43]
    ds_read_b128 v[156:159], v6 offset:1952
    v_mfma_f32_16x16x32_bf16 v[28:31], v[136:139], a[140:143], v[28:31]
    v_mfma_f32_16x16x32_bf16 v[44:47], v[140:143], a[140:143], v[44:47]
    s_waitcnt lgkmcnt(3)
    v_mfma_f32_16x16x32_bf16 v[20:23], v[144:147], a[8:11], v[20:23]
    s_waitcnt lgkmcnt(2)
    v_mfma_f32_16x16x32_bf16 v[36:39], v[148:151], a[8:11], v[36:39]
    v_mfma_f32_16x16x32_bf16 v[24:27], v[144:147], a[72:75], v[24:27]
    ds_read_b128 v[160:163], v6 offset:1984
    v_mfma_f32_16x16x32_bf16 v[40:43], v[148:151], a[72:75], v[40:43]
    ds_read_b128 v[164:167], v6 offset:2016
    v_mfma_f32_16x16x32_bf16 v[28:31], v[144:147], a[136:139], v[28:31]
    v_mfma_f32_16x16x32_bf16 v[44:47], v[148:151], a[136:139], v[44:47]
    s_waitcnt lgkmcnt(3)
    v_mfma_f32_16x16x32_bf16 v[20:23], v[152:155], a[4:7], v[20:23]
    s_waitcnt lgkmcnt(2)
    v_mfma_f32_16x16x32_bf16 v[36:39], v[156:159], a[4:7], v[36:39]
    v_mfma_f32_16x16x32_bf16 v[24:27], v[152:155], a[68:71], v[24:27]
    ds_read_b128 v[168:171], v6 offset:2048
    v_mfma_f32_16x16x32_bf16 v[40:43], v[156:159], a[68:71], v[40:43]
    ds_read_b128 v[172:175], v6 offset:2080
    v_mfma_f32_16x16x32_bf16 v[28:31], v[152:155], a[132:135], v[28:31]
    s_waitcnt vmcnt(18)
    v_mfma_f32_16x16x32_bf16 v[44:47], v[156:159], a[132:135], v[44:47]
    ds_write_b128 v5, v[188:191] offset:1024
    s_waitcnt lgkmcnt(4)
    v_mfma_f32_16x16x32_bf16 v[20:23], v[160:163], a[0:3], v[20:23]
    ds_read_b128 v[112:115], v6 offset:2112
    s_waitcnt lgkmcnt(4)
    v_mfma_f32_16x16x32_bf16 v[36:39], v[164:167], a[0:3], v[36:39]
    ds_read_b128 v[116:119], v6 offset:2144
    v_mfma_f32_16x16x32_bf16 v[24:27], v[160:163], a[64:67], v[24:27]
    ds_write_b128 v5, v[186:189] offset:17664
    v_mfma_f32_16x16x32_bf16 v[40:43], v[164:167], a[64:67], v[40:43]
    v_mov_b32 v208, v185
    v_mov_b32 v209, v186
    v_mfma_f32_16x16x32_bf16 v[28:31], v[160:163], a[128:131], v[28:31]
    ds_read_b128 v[120:123], v6 offset:2176
    v_mfma_f32_16x16x32_bf16 v[44:47], v[164:167], a[128:131], v[44:47]
    ds_read_b128 v[124:127], v6 offset:2208
    s_waitcnt lgkmcnt(7)
    v_mfma_f32_16x16x32_bf16 v[24:27], v[168:171], a[60:63], v[24:27]
    v_mov_b32 v210, v187
    v_mov_b32 v211, v188
    s_waitcnt lgkmcnt(6)
    v_mfma_f32_16x16x32_bf16 v[40:43], v[172:175], a[60:63], v[40:43]
    ds_write_b128 v5, v[208:211] offset:25984
    v_mfma_f32_16x16x32_bf16 v[28:31], v[168:171], a[124:127], v[28:31]
    ds_read_b128 v[128:131], v6 offset:2240
    v_mfma_f32_16x16x32_bf16 v[44:47], v[172:175], a[124:127], v[44:47]
    ds_read_b128 v[132:135], v6 offset:2272
    s_waitcnt lgkmcnt(7)
    v_mfma_f32_16x16x32_bf16 v[24:27], v[112:115], a[56:59], v[24:27]
    v_mov_b32 v212, v189
    v_mov_b32 v213, v190
    s_waitcnt lgkmcnt(6)
    v_mfma_f32_16x16x32_bf16 v[40:43], v[116:119], a[56:59], v[40:43]
    ds_write_b128 v5, v[210:213] offset:9344
    v_mfma_f32_16x16x32_bf16 v[28:31], v[112:115], a[120:123], v[28:31]
    ds_read_b128 v[136:139], v6 offset:2304
    v_mfma_f32_16x16x32_bf16 v[44:47], v[116:119], a[120:123], v[44:47]
    ds_read_b128 v[140:143], v6 offset:2336
    s_waitcnt lgkmcnt(7)
    v_mfma_f32_16x16x32_bf16 v[24:27], v[120:123], a[52:55], v[24:27]
    v_alignbit_b32 v214, v185, v184, 16
    v_alignbit_b32 v215, v186, v185, 16
    s_waitcnt lgkmcnt(6)
    v_mfma_f32_16x16x32_bf16 v[40:43], v[124:127], a[52:55], v[40:43]
    v_alignbit_b32 v216, v187, v186, 16
    v_alignbit_b32 v217, v188, v187, 16
    v_mfma_f32_16x16x32_bf16 v[28:31], v[120:123], a[116:119], v[28:31]
    ds_read_b128 v[144:147], v6 offset:2368
    v_mfma_f32_16x16x32_bf16 v[44:47], v[124:127], a[116:119], v[44:47]
    ds_read_b128 v[148:151], v6 offset:2400
    s_waitcnt lgkmcnt(6)
    v_mfma_f32_16x16x32_bf16 v[24:27], v[128:131], a[48:51], v[24:27]
    ds_write_b128 v5, v[214:217] offset:30144
    s_waitcnt lgkmcnt(6)
    v_mfma_f32_16x16x32_bf16 v[40:43], v[132:135], a[48:51], v[40:43]
    v_alignbit_b32 v218, v189, v188, 16
    v_alignbit_b32 v219, v190, v189, 16
    v_mfma_f32_16x16x32_bf16 v[28:31], v[128:131], a[112:115], v[28:31]
    ds_read_b128 v[152:155], v6 offset:2432
    v_mfma_f32_16x16x32_bf16 v[44:47], v[132:135], a[112:115], v[44:47]
    ds_read_b128 v[156:159], v6 offset:2464
    s_waitcnt lgkmcnt(6)
    v_mfma_f32_16x16x32_bf16 v[24:27], v[136:139], a[44:47], v[24:27]
    ds_write_b128 v5, v[216:219] offset:13504
    s_waitcnt lgkmcnt(6)
    v_mfma_f32_16x16x32_bf16 v[40:43], v[140:143], a[44:47], v[40:43]
    v_alignbit_b32 v220, v186, v185, 16
    v_alignbit_b32 v221, v187, v186, 16
    v_mfma_f32_16x16x32_bf16 v[28:31], v[136:139], a[108:111], v[28:31]
    ds_read_b128 v[160:163], v6 offset:2496
    v_mfma_f32_16x16x32_bf16 v[44:47], v[140:143], a[108:111], v[44:47]
    ds_read_b128 v[164:167], v6 offset:2528
    s_waitcnt lgkmcnt(7)
    v_mfma_f32_16x16x32_bf16 v[24:27], v[144:147], a[40:43], v[24:27]
    v_alignbit_b32 v222, v188, v187, 16
    v_alignbit_b32 v223, v189, v188, 16
    s_waitcnt lgkmcnt(6)
    v_mfma_f32_16x16x32_bf16 v[40:43], v[148:151], a[40:43], v[40:43]
    ds_write_b128 v5, v[220:223] offset:21824
    v_mfma_f32_16x16x32_bf16 v[28:31], v[144:147], a[104:107], v[28:31]
    ds_read_b128 v[168:171], v6 offset:2560
    v_mfma_f32_16x16x32_bf16 v[44:47], v[148:151], a[104:107], v[44:47]
    ds_read_b128 v[172:175], v6 offset:2592
    s_waitcnt lgkmcnt(7)
    v_mfma_f32_16x16x32_bf16 v[24:27], v[152:155], a[36:39], v[24:27]
    v_alignbit_b32 v224, v190, v189, 16
    v_alignbit_b32 v225, v191, v190, 16
    s_waitcnt lgkmcnt(6)
    v_mfma_f32_16x16x32_bf16 v[40:43], v[156:159], a[36:39], v[40:43]
    ds_write_b128 v5, v[222:225] offset:5184
    v_mfma_f32_16x16x32_bf16 v[28:31], v[152:155], a[100:103], v[28:31]
    ds_read_b128 v[112:115], v6 offset:2624
    v_mfma_f32_16x16x32_bf16 v[44:47], v[156:159], a[100:103], v[44:47]
    ds_read_b128 v[116:119], v6 offset:2656
    s_waitcnt lgkmcnt(7)
    v_mfma_f32_16x16x32_bf16 v[24:27], v[160:163], a[32:35], v[24:27]
    buffer_load_dwordx4 v[184:187], v4, s[28:31], s37 offen offset:1008
    s_waitcnt lgkmcnt(6)
    v_mfma_f32_16x16x32_bf16 v[40:43], v[164:167], a[32:35], v[40:43]
    buffer_load_dwordx4 v[188:191], v4, s[28:31], s37 offen offset:1024
    v_mfma_f32_16x16x32_bf16 v[28:31], v[160:163], a[96:99], v[28:31]
    ds_read_b128 v[120:123], v6 offset:2688
    v_mfma_f32_16x16x32_bf16 v[44:47], v[164:167], a[96:99], v[44:47]
    ds_read_b128 v[124:127], v6 offset:2720
    s_waitcnt lgkmcnt(6)
    v_mfma_f32_16x16x32_bf16 v[24:27], v[168:171], a[28:31], v[24:27]
    s_mov_b32 s36, s37
    s_add_u32 s39, s37, 125829120
    s_add_u32 s37, s37, 4096
    s_min_u32 s37, s37, s33

    s_pack_hh_b32_b16 s40, s64, s64
    v_and_b32 v236, s40, v8
    s_waitcnt lgkmcnt(5)
    v_mfma_f32_16x16x32_bf16 v[40:43], v[172:175], a[28:31], v[40:43]
    v_and_b32 v237, s40, v9
    v_and_b32 v238, s40, v10
    v_mfma_f32_16x16x32_bf16 v[28:31], v[168:171], a[92:95], v[28:31]
    ds_read_b128 v[128:131], v6 offset:2752
    v_mfma_f32_16x16x32_bf16 v[44:47], v[172:175], a[92:95], v[44:47]
    ds_read_b128 v[132:135], v6 offset:2784
    s_waitcnt lgkmcnt(5)
    v_mfma_f32_16x16x32_bf16 v[24:27], v[112:115], a[24:27], v[24:27]
    v_and_b32 v239, s40, v11
    v_and_b32 v240, s40, v12
    s_waitcnt lgkmcnt(4)
    v_mfma_f32_16x16x32_bf16 v[40:43], v[116:119], a[24:27], v[40:43]
    v_and_b32 v241, s40, v13
    v_and_b32 v242, s40, v14
    v_mfma_f32_16x16x32_bf16 v[28:31], v[112:115], a[88:91], v[28:31]
    ds_read_b128 v[136:139], v6 offset:2816
    v_mfma_f32_16x16x32_bf16 v[44:47], v[116:119], a[88:91], v[44:47]
    ds_read_b128 v[140:143], v6 offset:2848
    s_waitcnt lgkmcnt(5)
    v_mfma_f32_16x16x32_bf16 v[24:27], v[120:123], a[20:23], v[24:27]
    v_and_b32 v243, s40, v15
    s_waitcnt lgkmcnt(4)
    v_mfma_f32_16x16x32_bf16 v[40:43], v[124:127], a[20:23], v[40:43]
    v_mfma_f32_16x16x32_bf16 v[28:31], v[120:123], a[84:87], v[28:31]
    ds_read_b128 v[144:147], v6 offset:2880
    v_mfma_f32_16x16x32_bf16 v[44:47], v[124:127], a[84:87], v[44:47]
    ds_read_b128 v[148:151], v6 offset:2912
    s_waitcnt lgkmcnt(5)
    v_mfma_f32_16x16x32_bf16 v[24:27], v[128:131], a[16:19], v[24:27]
    s_waitcnt lgkmcnt(4)
    v_mfma_f32_16x16x32_bf16 v[40:43], v[132:135], a[16:19], v[40:43]
    v_mfma_f32_16x16x32_bf16 v[28:31], v[128:131], a[80:83], v[28:31]
    ds_read_b128 v[152:155], v6 offset:2944
    v_mfma_f32_16x16x32_bf16 v[44:47], v[132:135], a[80:83], v[44:47]
    ds_read_b128 v[156:159], v6 offset:2976
    s_waitcnt lgkmcnt(5)
    v_mfma_f32_16x16x32_bf16 v[24:27], v[136:139], a[12:15], v[24:27]
    s_waitcnt lgkmcnt(4)
    v_mfma_f32_16x16x32_bf16 v[40:43], v[140:143], a[12:15], v[40:43]
    v_mfma_f32_16x16x32_bf16 v[28:31], v[136:139], a[76:79], v[28:31]
    ds_read_b128 v[160:163], v6 offset:3008
    v_mfma_f32_16x16x32_bf16 v[44:47], v[140:143], a[76:79], v[44:47]
    ds_read_b128 v[164:167], v6 offset:3040
    s_waitcnt lgkmcnt(5)
    v_mfma_f32_16x16x32_bf16 v[24:27], v[144:147], a[8:11], v[24:27]
    s_waitcnt lgkmcnt(4)
    v_mfma_f32_16x16x32_bf16 v[40:43], v[148:151], a[8:11], v[40:43]
    v_mfma_f32_16x16x32_bf16 v[28:31], v[144:147], a[72:75], v[28:31]
    ds_read_b128 v[168:171], v6 offset:3072
    v_mfma_f32_16x16x32_bf16 v[44:47], v[148:151], a[72:75], v[44:47]
    ds_read_b128 v[172:175], v6 offset:3104
    s_waitcnt lgkmcnt(5)
    v_mfma_f32_16x16x32_bf16 v[24:27], v[152:155], a[4:7], v[24:27]
    ds_read_b128 v[112:115], v6 offset:3136
    s_waitcnt lgkmcnt(5)
    v_mfma_f32_16x16x32_bf16 v[40:43], v[156:159], a[4:7], v[40:43]
    ds_read_b128 v[116:119], v6 offset:3168
    v_mfma_f32_16x16x32_bf16 v[28:31], v[152:155], a[68:71], v[28:31]
    ds_read_b128 v[120:123], v6 offset:3200
    v_mfma_f32_16x16x32_bf16 v[44:47], v[156:159], a[68:71], v[44:47]
    ds_read_b128 v[124:127], v6 offset:3232
    s_waitcnt lgkmcnt(7)
    v_mfma_f32_16x16x32_bf16 v[24:27], v[160:163], a[0:3], v[24:27]
    ds_read_b128 v[128:131], v6 offset:3264
    s_waitcnt lgkmcnt(7)
    v_mfma_f32_16x16x32_bf16 v[40:43], v[164:167], a[0:3], v[40:43]
    ds_read_b128 v[132:135], v6 offset:3296
    v_mfma_f32_16x16x32_bf16 v[28:31], v[160:163], a[64:67], v[28:31]
    ds_read_b128 v[136:139], v6 offset:3328
    v_mfma_f32_16x16x32_bf16 v[44:47], v[164:167], a[64:67], v[44:47]
    ds_read_b128 v[140:143], v6 offset:3360
    s_waitcnt lgkmcnt(9)
    v_mfma_f32_16x16x32_bf16 v[28:31], v[168:171], a[60:63], v[28:31]
    ds_read_b128 v[144:147], v6 offset:3392
    s_waitcnt lgkmcnt(9)
    v_mfma_f32_16x16x32_bf16 v[44:47], v[172:175], a[60:63], v[44:47]
    ds_read_b128 v[148:151], v6 offset:3424
    s_waitcnt lgkmcnt(9)
    v_mfma_f32_16x16x32_bf16 v[28:31], v[112:115], a[56:59], v[28:31]
    ds_read_b128 v[152:155], v6 offset:3456
    s_waitcnt lgkmcnt(9)
    v_mfma_f32_16x16x32_bf16 v[44:47], v[116:119], a[56:59], v[44:47]
    ds_read_b128 v[156:159], v6 offset:3488
    s_waitcnt lgkmcnt(9)
    v_mfma_f32_16x16x32_bf16 v[28:31], v[120:123], a[52:55], v[28:31]
    ds_read_b128 v[160:163], v6 offset:3520
    s_waitcnt lgkmcnt(9)
    v_mfma_f32_16x16x32_bf16 v[44:47], v[124:127], a[52:55], v[44:47]
    ds_read_b128 v[164:167], v6 offset:3552
    s_waitcnt lgkmcnt(9)
    v_mfma_f32_16x16x32_bf16 v[28:31], v[128:131], a[48:51], v[28:31]
    ds_read_b128 v[168:171], v6 offset:3584
    s_waitcnt lgkmcnt(9)
    v_mfma_f32_16x16x32_bf16 v[44:47], v[132:135], a[48:51], v[44:47]
    ds_read_b128 v[172:175], v6 offset:3616
    s_waitcnt lgkmcnt(9)
    v_mfma_f32_16x16x32_bf16 v[28:31], v[136:139], a[44:47], v[28:31]
    ds_read_b128 v[112:115], v6 offset:3648
    s_waitcnt lgkmcnt(9)
    v_mfma_f32_16x16x32_bf16 v[44:47], v[140:143], a[44:47], v[44:47]
    ds_read_b128 v[116:119], v6 offset:3680
    s_waitcnt lgkmcnt(9)
    v_mfma_f32_16x16x32_bf16 v[28:31], v[144:147], a[40:43], v[28:31]
    ds_read_b128 v[120:123], v6 offset:3712
    s_waitcnt lgkmcnt(9)
    v_mfma_f32_16x16x32_bf16 v[44:47], v[148:151], a[40:43], v[44:47]
    ds_read_b128 v[124:127], v6 offset:3744
    s_waitcnt lgkmcnt(9)
    v_mfma_f32_16x16x32_bf16 v[28:31], v[152:155], a[36:39], v[28:31]
    ds_read_b128 v[128:131], v6 offset:3776
    s_waitcnt lgkmcnt(9)
    v_mfma_f32_16x16x32_bf16 v[44:47], v[156:159], a[36:39], v[44:47]
    ds_read_b128 v[132:135], v6 offset:3808
    s_waitcnt lgkmcnt(9)
    v_mfma_f32_16x16x32_bf16 v[28:31], v[160:163], a[32:35], v[28:31]
    ds_read_b128 v[136:139], v6 offset:3840
    s_waitcnt lgkmcnt(9)
    v_mfma_f32_16x16x32_bf16 v[44:47], v[164:167], a[32:35], v[44:47]
    ds_read_b128 v[140:143], v6 offset:3872
    s_waitcnt lgkmcnt(9)
    v_mfma_f32_16x16x32_bf16 v[28:31], v[168:171], a[28:31], v[28:31]
    ds_read_b128 v[144:147], v6 offset:3904
    s_waitcnt lgkmcnt(9)
    v_mfma_f32_16x16x32_bf16 v[44:47], v[172:175], a[28:31], v[44:47]
    ds_read_b128 v[148:151], v6 offset:3936
    s_waitcnt lgkmcnt(9)
    v_mfma_f32_16x16x32_bf16 v[28:31], v[112:115], a[24:27], v[28:31]
    ds_read_b128 v[152:155], v6 offset:3968
    s_waitcnt lgkmcnt(9)
    v_mfma_f32_16x16x32_bf16 v[44:47], v[116:119], a[24:27], v[44:47]
    ds_read_b128 v[156:159], v6 offset:4000
    s_waitcnt lgkmcnt(9)
    v_mfma_f32_16x16x32_bf16 v[28:31], v[120:123], a[20:23], v[28:31]
    ds_read_b128 v[160:163], v6 offset:4032
    s_waitcnt lgkmcnt(9)
    v_mfma_f32_16x16x32_bf16 v[44:47], v[124:127], a[20:23], v[44:47]
    ds_read_b128 v[164:167], v6 offset:4064
    s_waitcnt lgkmcnt(9)
    v_mfma_f32_16x16x32_bf16 v[28:31], v[128:131], a[16:19], v[28:31]
    s_waitcnt vmcnt(2)
    ds_read_b128 a[60:63], v7 offset:240
    s_waitcnt lgkmcnt(9)
    v_mfma_f32_16x16x32_bf16 v[44:47], v[132:135], a[16:19], v[44:47]
    s_waitcnt lgkmcnt(8)
    v_mfma_f32_16x16x32_bf16 v[28:31], v[136:139], a[12:15], v[28:31]
    ds_read_b128 a[124:127], v7 offset:496
    s_waitcnt lgkmcnt(8)
    v_mfma_f32_16x16x32_bf16 v[44:47], v[140:143], a[12:15], v[44:47]
    s_waitcnt lgkmcnt(7)
    v_mfma_f32_16x16x32_bf16 v[28:31], v[144:147], a[8:11], v[28:31]
    ds_read_b128 a[188:191], v7 offset:752
    s_waitcnt lgkmcnt(7)
    v_mfma_f32_16x16x32_bf16 v[44:47], v[148:151], a[8:11], v[44:47]
    s_waitcnt lgkmcnt(6)
    v_mfma_f32_16x16x32_bf16 v[28:31], v[152:155], a[4:7], v[28:31]
    ds_read_b128 a[252:255], v7 offset:1008
    s_waitcnt lgkmcnt(6)
    v_mfma_f32_16x16x32_bf16 v[44:47], v[156:159], a[4:7], v[44:47]
    s_waitcnt lgkmcnt(5)
    v_mfma_f32_16x16x32_bf16 v[28:31], v[160:163], a[0:3], v[28:31]
    ds_read_b128 v[168:171], v6 offset:0
    s_waitcnt lgkmcnt(5)
    v_mfma_f32_16x16x32_bf16 v[44:47], v[164:167], a[0:3], v[44:47]
    ds_read_b128 v[172:175], v6 offset:32
    s_waitcnt lgkmcnt(5)
    v_mfma_f32_16x16x32_bf16 v[48:51], v[236:239], a[60:63], 0
    v_mfma_f32_16x16x32_bf16 v[64:67], v[240:243], a[60:63], 0
    s_waitcnt lgkmcnt(4)
    v_mfma_f32_16x16x32_bf16 v[52:55], v[236:239], a[124:127], 0
    v_mfma_f32_16x16x32_bf16 v[68:71], v[240:243], a[124:127], 0
    s_waitcnt lgkmcnt(3)
    v_mfma_f32_16x16x32_bf16 v[56:59], v[236:239], a[188:191], 0
    v_mfma_f32_16x16x32_bf16 v[72:75], v[240:243], a[188:191], 0
    ds_read_b128 a[56:59], v7 offset:224
    s_waitcnt lgkmcnt(3)
    v_mfma_f32_16x16x32_bf16 v[60:63], v[236:239], a[252:255], 0
    ds_read_b128 v[112:115], v6 offset:64
    v_mfma_f32_16x16x32_bf16 v[76:79], v[240:243], a[252:255], 0
    ds_read_b128 v[116:119], v6 offset:96
    s_waitcnt lgkmcnt(4)
    v_mfma_f32_16x16x32_bf16 v[48:51], v[168:171], a[60:63], v[48:51]
    ds_read_b128 a[120:123], v7 offset:480
    s_waitcnt lgkmcnt(4)
    v_mfma_f32_16x16x32_bf16 v[64:67], v[172:175], a[60:63], v[64:67]
    s_waitcnt vmcnt(10)
    v_mfma_f32_16x16x32_bf16 v[52:55], v[168:171], a[124:127], v[52:55]
    ds_read_b128 a[184:187], v7 offset:736
    v_mfma_f32_16x16x32_bf16 v[68:71], v[172:175], a[124:127], v[68:71]
    ds_write_b128 v5, v[196:199] offset:2048
    v_mfma_f32_16x16x32_bf16 v[56:59], v[168:171], a[188:191], v[56:59]
    ds_read_b128 a[248:251], v7 offset:992
    v_mfma_f32_16x16x32_bf16 v[72:75], v[172:175], a[188:191], v[72:75]
    ds_read_b128 a[52:55], v7 offset:208
    v_mfma_f32_16x16x32_bf16 v[60:63], v[168:171], a[252:255], v[60:63]
    ds_read_b128 v[120:123], v6 offset:128
    v_mfma_f32_16x16x32_bf16 v[76:79], v[172:175], a[252:255], v[76:79]
    ds_read_b128 v[124:127], v6 offset:160
    s_waitcnt lgkmcnt(8)
    v_mfma_f32_16x16x32_bf16 v[48:51], v[112:115], a[56:59], v[48:51]
    ds_read_b128 a[116:119], v7 offset:464
    s_waitcnt lgkmcnt(8)
    v_mfma_f32_16x16x32_bf16 v[64:67], v[116:119], a[56:59], v[64:67]
    ds_write_b128 v5, v[194:197] offset:18688
    s_waitcnt lgkmcnt(8)
    v_mfma_f32_16x16x32_bf16 v[52:55], v[112:115], a[120:123], v[52:55]
    ds_read_b128 a[180:183], v7 offset:720
    v_mfma_f32_16x16x32_bf16 v[68:71], v[116:119], a[120:123], v[68:71]
    v_mov_b32 v208, v193
    v_mov_b32 v209, v194
    s_waitcnt lgkmcnt(8)
    v_mfma_f32_16x16x32_bf16 v[56:59], v[112:115], a[184:187], v[56:59]
    ds_read_b128 a[244:247], v7 offset:976
    v_mfma_f32_16x16x32_bf16 v[72:75], v[116:119], a[184:187], v[72:75]
    ds_read_b128 a[48:51], v7 offset:192
    s_waitcnt lgkmcnt(8)
    v_mfma_f32_16x16x32_bf16 v[60:63], v[112:115], a[248:251], v[60:63]
    ds_read_b128 v[128:131], v6 offset:192
    v_mfma_f32_16x16x32_bf16 v[76:79], v[116:119], a[248:251], v[76:79]
    ds_read_b128 v[132:135], v6 offset:224
    s_waitcnt lgkmcnt(8)
    v_mfma_f32_16x16x32_bf16 v[48:51], v[120:123], a[52:55], v[48:51]
    ds_read_b128 a[112:115], v7 offset:448
    s_waitcnt lgkmcnt(8)
    v_mfma_f32_16x16x32_bf16 v[64:67], v[124:127], a[52:55], v[64:67]
    v_mov_b32 v210, v195
    v_mov_b32 v211, v196
    s_waitcnt lgkmcnt(7)
    v_mfma_f32_16x16x32_bf16 v[52:55], v[120:123], a[116:119], v[52:55]
    ds_read_b128 a[176:179], v7 offset:704
    v_mfma_f32_16x16x32_bf16 v[68:71], v[124:127], a[116:119], v[68:71]
    ds_write_b128 v5, v[208:211] offset:27008
    s_waitcnt lgkmcnt(7)
    v_mfma_f32_16x16x32_bf16 v[56:59], v[120:123], a[180:183], v[56:59]
    ds_read_b128 a[240:243], v7 offset:960
    v_mfma_f32_16x16x32_bf16 v[72:75], v[124:127], a[180:183], v[72:75]
    ds_read_b128 a[44:47], v7 offset:176
    s_waitcnt lgkmcnt(8)
    v_mfma_f32_16x16x32_bf16 v[60:63], v[120:123], a[244:247], v[60:63]
    ds_read_b128 v[136:139], v6 offset:256
    v_mfma_f32_16x16x32_bf16 v[76:79], v[124:127], a[244:247], v[76:79]
    ds_read_b128 v[140:143], v6 offset:288
    s_waitcnt lgkmcnt(8)
    v_mfma_f32_16x16x32_bf16 v[48:51], v[128:131], a[48:51], v[48:51]
    ds_read_b128 a[108:111], v7 offset:432
    s_waitcnt lgkmcnt(8)
    v_mfma_f32_16x16x32_bf16 v[64:67], v[132:135], a[48:51], v[64:67]
    v_mov_b32 v212, v197
    v_mov_b32 v213, v198
    s_waitcnt lgkmcnt(7)
    v_mfma_f32_16x16x32_bf16 v[52:55], v[128:131], a[112:115], v[52:55]
    ds_read_b128 a[172:175], v7 offset:688
    v_mfma_f32_16x16x32_bf16 v[68:71], v[132:135], a[112:115], v[68:71]
    ds_write_b128 v5, v[210:213] offset:10368
    s_waitcnt lgkmcnt(8)
    v_mfma_f32_16x16x32_bf16 v[56:59], v[128:131], a[176:179], v[56:59]
    ds_read_b128 a[236:239], v7 offset:944
    v_mfma_f32_16x16x32_bf16 v[72:75], v[132:135], a[176:179], v[72:75]
    ds_read_b128 a[40:43], v7 offset:160
    s_waitcnt lgkmcnt(8)
    v_mfma_f32_16x16x32_bf16 v[60:63], v[128:131], a[240:243], v[60:63]
    ds_read_b128 v[144:147], v6 offset:320
    v_mfma_f32_16x16x32_bf16 v[76:79], v[132:135], a[240:243], v[76:79]
    ds_read_b128 v[148:151], v6 offset:352
    s_waitcnt lgkmcnt(8)
    v_mfma_f32_16x16x32_bf16 v[48:51], v[136:139], a[44:47], v[48:51]
    ds_read_b128 a[104:107], v7 offset:416
    s_waitcnt lgkmcnt(8)
    v_mfma_f32_16x16x32_bf16 v[64:67], v[140:143], a[44:47], v[64:67]
    v_alignbit_b32 v214, v193, v192, 16
    v_alignbit_b32 v215, v194, v193, 16
    s_waitcnt lgkmcnt(7)
    v_mfma_f32_16x16x32_bf16 v[52:55], v[136:139], a[108:111], v[52:55]
    ds_read_b128 a[168:171], v7 offset:672
    v_mfma_f32_16x16x32_bf16 v[68:71], v[140:143], a[108:111], v[68:71]
    v_alignbit_b32 v216, v195, v194, 16
    v_alignbit_b32 v217, v196, v195, 16
    s_waitcnt lgkmcnt(7)
    v_mfma_f32_16x16x32_bf16 v[56:59], v[136:139], a[172:175], v[56:59]
    ds_read_b128 a[232:235], v7 offset:928
    v_mfma_f32_16x16x32_bf16 v[72:75], v[140:143], a[172:175], v[72:75]
    ds_read_b128 a[36:39], v7 offset:144
    s_waitcnt lgkmcnt(7)
    v_mfma_f32_16x16x32_bf16 v[60:63], v[136:139], a[236:239], v[60:63]
    ds_read_b128 v[152:155], v6 offset:384
    v_mfma_f32_16x16x32_bf16 v[76:79], v[140:143], a[236:239], v[76:79]
    ds_read_b128 v[156:159], v6 offset:416
    s_waitcnt lgkmcnt(7)
    v_mfma_f32_16x16x32_bf16 v[48:51], v[144:147], a[40:43], v[48:51]
    ds_read_b128 a[100:103], v7 offset:400
    s_waitcnt lgkmcnt(7)
    v_mfma_f32_16x16x32_bf16 v[64:67], v[148:151], a[40:43], v[64:67]
    ds_write_b128 v5, v[214:217] offset:31168
    s_waitcnt lgkmcnt(7)
    v_mfma_f32_16x16x32_bf16 v[52:55], v[144:147], a[104:107], v[52:55]
    ds_read_b128 a[164:167], v7 offset:656
    v_mfma_f32_16x16x32_bf16 v[68:71], v[148:151], a[104:107], v[68:71]
    v_alignbit_b32 v218, v197, v196, 16
    v_alignbit_b32 v219, v198, v197, 16
    s_waitcnt lgkmcnt(7)
    v_mfma_f32_16x16x32_bf16 v[56:59], v[144:147], a[168:171], v[56:59]
    ds_read_b128 a[228:231], v7 offset:912
    v_mfma_f32_16x16x32_bf16 v[72:75], v[148:151], a[168:171], v[72:75]
    ds_read_b128 a[32:35], v7 offset:128
    s_waitcnt lgkmcnt(8)
    v_mfma_f32_16x16x32_bf16 v[60:63], v[144:147], a[232:235], v[60:63]
    ds_read_b128 v[160:163], v6 offset:448
    v_mfma_f32_16x16x32_bf16 v[76:79], v[148:151], a[232:235], v[76:79]
    ds_read_b128 v[164:167], v6 offset:480
    s_waitcnt lgkmcnt(8)
    v_mfma_f32_16x16x32_bf16 v[48:51], v[152:155], a[36:39], v[48:51]
    ds_read_b128 a[96:99], v7 offset:384
    s_waitcnt lgkmcnt(8)
    v_mfma_f32_16x16x32_bf16 v[64:67], v[156:159], a[36:39], v[64:67]
    ds_write_b128 v5, v[216:219] offset:14528
    s_waitcnt lgkmcnt(8)
    v_mfma_f32_16x16x32_bf16 v[52:55], v[152:155], a[100:103], v[52:55]
    ds_read_b128 a[160:163], v7 offset:640
    v_mfma_f32_16x16x32_bf16 v[68:71], v[156:159], a[100:103], v[68:71]
    v_alignbit_b32 v220, v194, v193, 16
    v_alignbit_b32 v221, v195, v194, 16
    s_waitcnt lgkmcnt(7)
    v_mfma_f32_16x16x32_bf16 v[56:59], v[152:155], a[164:167], v[56:59]
    ds_read_b128 a[224:227], v7 offset:896
    v_mfma_f32_16x16x32_bf16 v[72:75], v[156:159], a[164:167], v[72:75]
    ds_read_b128 a[28:31], v7 offset:112
    s_waitcnt lgkmcnt(8)
    v_mfma_f32_16x16x32_bf16 v[60:63], v[152:155], a[228:231], v[60:63]
    ds_read_b128 v[168:171], v6 offset:512
    v_mfma_f32_16x16x32_bf16 v[76:79], v[156:159], a[228:231], v[76:79]
    ds_read_b128 v[172:175], v6 offset:544
    s_waitcnt lgkmcnt(8)
    v_mfma_f32_16x16x32_bf16 v[48:51], v[160:163], a[32:35], v[48:51]
    ds_read_b128 a[92:95], v7 offset:368
    s_waitcnt lgkmcnt(8)
    v_mfma_f32_16x16x32_bf16 v[64:67], v[164:167], a[32:35], v[64:67]
    v_alignbit_b32 v222, v196, v195, 16
    v_alignbit_b32 v223, v197, v196, 16
    s_waitcnt lgkmcnt(7)
    v_mfma_f32_16x16x32_bf16 v[52:55], v[160:163], a[96:99], v[52:55]
    ds_read_b128 a[156:159], v7 offset:624
    v_mfma_f32_16x16x32_bf16 v[68:71], v[164:167], a[96:99], v[68:71]
    ds_write_b128 v5, v[220:223] offset:22848
    s_waitcnt lgkmcnt(7)
    v_mfma_f32_16x16x32_bf16 v[56:59], v[160:163], a[160:163], v[56:59]
    ds_read_b128 a[220:223], v7 offset:880
    v_mfma_f32_16x16x32_bf16 v[72:75], v[164:167], a[160:163], v[72:75]
    ds_read_b128 a[24:27], v7 offset:96
    s_waitcnt lgkmcnt(8)
    v_mfma_f32_16x16x32_bf16 v[60:63], v[160:163], a[224:227], v[60:63]
    ds_read_b128 v[112:115], v6 offset:576
    v_mfma_f32_16x16x32_bf16 v[76:79], v[164:167], a[224:227], v[76:79]
    ds_read_b128 v[116:119], v6 offset:608
    s_waitcnt lgkmcnt(8)
    v_mfma_f32_16x16x32_bf16 v[48:51], v[168:171], a[28:31], v[48:51]
    ds_read_b128 a[88:91], v7 offset:352
    s_waitcnt lgkmcnt(8)
    v_mfma_f32_16x16x32_bf16 v[64:67], v[172:175], a[28:31], v[64:67]
    v_alignbit_b32 v224, v198, v197, 16
    v_alignbit_b32 v225, v199, v198, 16
    s_waitcnt lgkmcnt(7)
    v_mfma_f32_16x16x32_bf16 v[52:55], v[168:171], a[92:95], v[52:55]
    ds_read_b128 a[152:155], v7 offset:608
    v_mfma_f32_16x16x32_bf16 v[68:71], v[172:175], a[92:95], v[68:71]
    ds_write_b128 v5, v[222:225] offset:6208
    s_waitcnt lgkmcnt(8)
    v_mfma_f32_16x16x32_bf16 v[56:59], v[168:171], a[156:159], v[56:59]
    ds_read_b128 a[216:219], v7 offset:864
    v_mfma_f32_16x16x32_bf16 v[72:75], v[172:175], a[156:159], v[72:75]
    ds_read_b128 a[20:23], v7 offset:80
    s_waitcnt lgkmcnt(8)
    v_mfma_f32_16x16x32_bf16 v[60:63], v[168:171], a[220:223], v[60:63]
    ds_read_b128 v[120:123], v6 offset:640
    v_mfma_f32_16x16x32_bf16 v[76:79], v[172:175], a[220:223], v[76:79]
    ds_read_b128 v[124:127], v6 offset:672
    s_waitcnt lgkmcnt(8)
    v_mfma_f32_16x16x32_bf16 v[48:51], v[112:115], a[24:27], v[48:51]
    ds_read_b128 a[84:87], v7 offset:336
    s_waitcnt lgkmcnt(8)
    v_mfma_f32_16x16x32_bf16 v[64:67], v[116:119], a[24:27], v[64:67]
    buffer_load_dwordx4 v[192:195], v4, s[28:31], s36 offen offset:2032
    s_waitcnt lgkmcnt(7)
    v_mfma_f32_16x16x32_bf16 v[52:55], v[112:115], a[88:91], v[52:55]
    ds_read_b128 a[148:151], v7 offset:592
    v_mfma_f32_16x16x32_bf16 v[68:71], v[116:119], a[88:91], v[68:71]
    buffer_load_dwordx4 v[196:199], v4, s[28:31], s36 offen offset:2048
    s_waitcnt lgkmcnt(7)
    v_mfma_f32_16x16x32_bf16 v[56:59], v[112:115], a[152:155], v[56:59]
    ds_read_b128 a[212:215], v7 offset:848
    v_mfma_f32_16x16x32_bf16 v[72:75], v[116:119], a[152:155], v[72:75]
    ds_read_b128 a[16:19], v7 offset:64
    s_waitcnt lgkmcnt(7)
    v_mfma_f32_16x16x32_bf16 v[60:63], v[112:115], a[216:219], v[60:63]
    ds_read_b128 v[128:131], v6 offset:704
    v_mfma_f32_16x16x32_bf16 v[76:79], v[116:119], a[216:219], v[76:79]
    ds_read_b128 v[132:135], v6 offset:736
    s_waitcnt lgkmcnt(7)
    v_mfma_f32_16x16x32_bf16 v[48:51], v[120:123], a[20:23], v[48:51]
    ds_read_b128 a[80:83], v7 offset:320
    s_waitcnt lgkmcnt(7)
    v_mfma_f32_16x16x32_bf16 v[64:67], v[124:127], a[20:23], v[64:67]
    s_waitcnt vmcnt(10)
    s_waitcnt lgkmcnt(6)
    v_mfma_f32_16x16x32_bf16 v[52:55], v[120:123], a[84:87], v[52:55]
    ds_read_b128 a[144:147], v7 offset:576
    v_mfma_f32_16x16x32_bf16 v[68:71], v[124:127], a[84:87], v[68:71]
    ds_write_b128 v5, v[204:207] offset:3072
    s_waitcnt lgkmcnt(7)
    v_mfma_f32_16x16x32_bf16 v[56:59], v[120:123], a[148:151], v[56:59]
    ds_read_b128 a[208:211], v7 offset:832
    v_mfma_f32_16x16x32_bf16 v[72:75], v[124:127], a[148:151], v[72:75]
    ds_read_b128 a[12:15], v7 offset:48
    s_waitcnt lgkmcnt(8)
    v_mfma_f32_16x16x32_bf16 v[60:63], v[120:123], a[212:215], v[60:63]
    ds_read_b128 v[136:139], v6 offset:768
    v_mfma_f32_16x16x32_bf16 v[76:79], v[124:127], a[212:215], v[76:79]
    ds_read_b128 v[140:143], v6 offset:800
    s_waitcnt lgkmcnt(8)
    v_mfma_f32_16x16x32_bf16 v[48:51], v[128:131], a[16:19], v[48:51]
    ds_read_b128 a[76:79], v7 offset:304
    s_waitcnt lgkmcnt(8)
    v_mfma_f32_16x16x32_bf16 v[64:67], v[132:135], a[16:19], v[64:67]
    ds_write_b128 v5, v[202:205] offset:19712
    s_waitcnt lgkmcnt(8)
    v_mfma_f32_16x16x32_bf16 v[52:55], v[128:131], a[80:83], v[52:55]
    ds_read_b128 a[140:143], v7 offset:560
    v_mfma_f32_16x16x32_bf16 v[68:71], v[132:135], a[80:83], v[68:71]
    v_mov_b32 v208, v201
    v_mov_b32 v209, v202
    s_waitcnt lgkmcnt(8)
    v_mfma_f32_16x16x32_bf16 v[56:59], v[128:131], a[144:147], v[56:59]
    ds_read_b128 a[204:207], v7 offset:816
    v_mfma_f32_16x16x32_bf16 v[72:75], v[132:135], a[144:147], v[72:75]
    ds_read_b128 a[8:11], v7 offset:32
    s_waitcnt lgkmcnt(8)
    v_mfma_f32_16x16x32_bf16 v[60:63], v[128:131], a[208:211], v[60:63]
    ds_read_b128 v[144:147], v6 offset:832
    v_mfma_f32_16x16x32_bf16 v[76:79], v[132:135], a[208:211], v[76:79]
    ds_read_b128 v[148:151], v6 offset:864
    s_waitcnt lgkmcnt(8)
    v_mfma_f32_16x16x32_bf16 v[48:51], v[136:139], a[12:15], v[48:51]
    ds_read_b128 a[72:75], v7 offset:288
    s_waitcnt lgkmcnt(8)
    v_mfma_f32_16x16x32_bf16 v[64:67], v[140:143], a[12:15], v[64:67]
    v_mov_b32 v210, v203
    v_mov_b32 v211, v204
    s_waitcnt lgkmcnt(7)
    v_mfma_f32_16x16x32_bf16 v[52:55], v[136:139], a[76:79], v[52:55]
    ds_read_b128 a[136:139], v7 offset:544
    v_mfma_f32_16x16x32_bf16 v[68:71], v[140:143], a[76:79], v[68:71]
    ds_write_b128 v5, v[208:211] offset:28032
    s_waitcnt lgkmcnt(7)
    v_mfma_f32_16x16x32_bf16 v[56:59], v[136:139], a[140:143], v[56:59]
    ds_read_b128 a[200:203], v7 offset:800
    v_mfma_f32_16x16x32_bf16 v[72:75], v[140:143], a[140:143], v[72:75]
    ds_read_b128 a[4:7], v7 offset:16
    s_waitcnt lgkmcnt(8)
    v_mfma_f32_16x16x32_bf16 v[60:63], v[136:139], a[204:207], v[60:63]
    ds_read_b128 v[152:155], v6 offset:896
    v_mfma_f32_16x16x32_bf16 v[76:79], v[140:143], a[204:207], v[76:79]
    ds_read_b128 v[156:159], v6 offset:928
    s_waitcnt lgkmcnt(8)
    v_mfma_f32_16x16x32_bf16 v[48:51], v[144:147], a[8:11], v[48:51]
    ds_read_b128 a[68:71], v7 offset:272
    s_waitcnt lgkmcnt(8)
    v_mfma_f32_16x16x32_bf16 v[64:67], v[148:151], a[8:11], v[64:67]
    v_mov_b32 v212, v205
    v_mov_b32 v213, v206
    s_waitcnt lgkmcnt(7)
    v_mfma_f32_16x16x32_bf16 v[52:55], v[144:147], a[72:75], v[52:55]
    ds_read_b128 a[132:135], v7 offset:528
    v_mfma_f32_16x16x32_bf16 v[68:71], v[148:151], a[72:75], v[68:71]
    ds_write_b128 v5, v[210:213] offset:11392
    s_waitcnt lgkmcnt(8)
    v_mfma_f32_16x16x32_bf16 v[56:59], v[144:147], a[136:139], v[56:59]
    ds_read_b128 a[196:199], v7 offset:784
    v_mfma_f32_16x16x32_bf16 v[72:75], v[148:151], a[136:139], v[72:75]
    ds_read_b128 a[0:3], v7 offset:0
    s_waitcnt lgkmcnt(8)
    v_mfma_f32_16x16x32_bf16 v[60:63], v[144:147], a[200:203], v[60:63]
    ds_read_b128 v[160:163], v6 offset:960
    v_mfma_f32_16x16x32_bf16 v[76:79], v[148:151], a[200:203], v[76:79]
    ds_read_b128 v[164:167], v6 offset:992
    s_waitcnt lgkmcnt(8)
    v_mfma_f32_16x16x32_bf16 v[48:51], v[152:155], a[4:7], v[48:51]
    ds_read_b128 a[64:67], v7 offset:256
    s_waitcnt lgkmcnt(8)
    v_mfma_f32_16x16x32_bf16 v[64:67], v[156:159], a[4:7], v[64:67]
    v_alignbit_b32 v214, v201, v200, 16
    v_alignbit_b32 v215, v202, v201, 16
    s_waitcnt lgkmcnt(7)
    v_mfma_f32_16x16x32_bf16 v[52:55], v[152:155], a[68:71], v[52:55]
    ds_read_b128 a[128:131], v7 offset:512
    v_mfma_f32_16x16x32_bf16 v[68:71], v[156:159], a[68:71], v[68:71]
    v_alignbit_b32 v216, v203, v202, 16
    v_alignbit_b32 v217, v204, v203, 16
    s_waitcnt lgkmcnt(7)
    v_mfma_f32_16x16x32_bf16 v[56:59], v[152:155], a[132:135], v[56:59]
    ds_read_b128 a[192:195], v7 offset:768
    v_mfma_f32_16x16x32_bf16 v[72:75], v[156:159], a[132:135], v[72:75]
    ds_write_b128 v5, v[214:217] offset:32192
    s_waitcnt lgkmcnt(7)
    v_mfma_f32_16x16x32_bf16 v[60:63], v[152:155], a[196:199], v[60:63]
    ds_read_b128 v[168:171], v6 offset:1024
    v_mfma_f32_16x16x32_bf16 v[76:79], v[156:159], a[196:199], v[76:79]
    ds_read_b128 v[172:175], v6 offset:1056
    s_waitcnt lgkmcnt(7)
    v_mfma_f32_16x16x32_bf16 v[48:51], v[160:163], a[0:3], v[48:51]
    v_alignbit_b32 v218, v205, v204, 16
    v_alignbit_b32 v219, v206, v205, 16
    s_waitcnt lgkmcnt(6)
    v_mfma_f32_16x16x32_bf16 v[64:67], v[164:167], a[0:3], v[64:67]
    ds_write_b128 v5, v[216:219] offset:15552
    s_waitcnt lgkmcnt(6)
    v_mfma_f32_16x16x32_bf16 v[52:55], v[160:163], a[64:67], v[52:55]
    v_alignbit_b32 v220, v202, v201, 16
    v_alignbit_b32 v221, v203, v202, 16
    v_mfma_f32_16x16x32_bf16 v[68:71], v[164:167], a[64:67], v[68:71]
    v_alignbit_b32 v222, v204, v203, 16
    v_alignbit_b32 v223, v205, v204, 16
    s_waitcnt lgkmcnt(5)
    v_mfma_f32_16x16x32_bf16 v[56:59], v[160:163], a[128:131], v[56:59]
    ds_read_b128 v[112:115], v6 offset:1088
    v_mfma_f32_16x16x32_bf16 v[72:75], v[164:167], a[128:131], v[72:75]
    ds_read_b128 v[116:119], v6 offset:1120
    s_waitcnt lgkmcnt(6)
    v_mfma_f32_16x16x32_bf16 v[60:63], v[160:163], a[192:195], v[60:63]
    ds_write_b128 v5, v[220:223] offset:23872
    v_mfma_f32_16x16x32_bf16 v[76:79], v[164:167], a[192:195], v[76:79]
    v_alignbit_b32 v224, v206, v205, 16
    v_alignbit_b32 v225, v207, v206, 16
    s_waitcnt lgkmcnt(5)
    v_mfma_f32_16x16x32_bf16 v[52:55], v[168:171], a[60:63], v[52:55]
    ds_write_b128 v5, v[222:225] offset:7232
    s_waitcnt lgkmcnt(5)
    v_mfma_f32_16x16x32_bf16 v[68:71], v[172:175], a[60:63], v[68:71]
    buffer_load_dwordx4 v[200:203], v4, s[28:31], s36 offen offset:3056
    v_mfma_f32_16x16x32_bf16 v[56:59], v[168:171], a[124:127], v[56:59]
    ds_read_b128 v[120:123], v6 offset:1152
    v_mfma_f32_16x16x32_bf16 v[72:75], v[172:175], a[124:127], v[72:75]
    ds_read_b128 v[124:127], v6 offset:1184
    v_mfma_f32_16x16x32_bf16 v[60:63], v[168:171], a[188:191], v[60:63]
    buffer_load_dwordx4 v[204:207], v4, s[28:31], s36 offen offset:3072
    v_mfma_f32_16x16x32_bf16 v[76:79], v[172:175], a[188:191], v[76:79]
    s_waitcnt vmcnt(10)
    s_mov_b64 exec, 1
    v_mov_b32 v176, 0
    v_mov_b32 v177, 0
    v_mov_b32 v178, 0
    v_mov_b32 v179, 0
    s_mov_b64 exec, -1
    s_waitcnt lgkmcnt(5)
    v_mfma_f32_16x16x32_bf16 v[52:55], v[112:115], a[56:59], v[52:55]
    ds_write_b128 v5, v[180:183] offset:0
    s_waitcnt lgkmcnt(5)
    v_mfma_f32_16x16x32_bf16 v[68:71], v[116:119], a[56:59], v[68:71]
    ds_write_b128 v5, v[178:181] offset:16640
    v_mfma_f32_16x16x32_bf16 v[56:59], v[112:115], a[120:123], v[56:59]
    ds_read_b128 v[128:131], v6 offset:1216
    v_mfma_f32_16x16x32_bf16 v[72:75], v[116:119], a[120:123], v[72:75]
    ds_read_b128 v[132:135], v6 offset:1248
    v_mfma_f32_16x16x32_bf16 v[60:63], v[112:115], a[184:187], v[60:63]
    v_mov_b32 v208, v177
    v_mov_b32 v209, v178
    v_mfma_f32_16x16x32_bf16 v[76:79], v[116:119], a[184:187], v[76:79]
    v_mov_b32 v210, v179
    v_mov_b32 v211, v180
    s_waitcnt lgkmcnt(5)
    v_mfma_f32_16x16x32_bf16 v[52:55], v[120:123], a[52:55], v[52:55]
    ds_write_b128 v5, v[208:211] offset:24960
    s_waitcnt lgkmcnt(5)
    v_mfma_f32_16x16x32_bf16 v[68:71], v[124:127], a[52:55], v[68:71]
    v_mov_b32 v212, v181
    v_mov_b32 v213, v182
    v_mfma_f32_16x16x32_bf16 v[56:59], v[120:123], a[116:119], v[56:59]
    ds_read_b128 v[136:139], v6 offset:1280
    v_mfma_f32_16x16x32_bf16 v[72:75], v[124:127], a[116:119], v[72:75]
    ds_read_b128 v[140:143], v6 offset:1312
    v_mfma_f32_16x16x32_bf16 v[60:63], v[120:123], a[180:183], v[60:63]
    ds_write_b128 v5, v[210:213] offset:8320
    v_mfma_f32_16x16x32_bf16 v[76:79], v[124:127], a[180:183], v[76:79]
    v_alignbit_b32 v214, v177, v176, 16
    v_alignbit_b32 v215, v178, v177, 16
    s_waitcnt lgkmcnt(5)
    v_mfma_f32_16x16x32_bf16 v[52:55], v[128:131], a[48:51], v[52:55]
    v_alignbit_b32 v216, v179, v178, 16
    v_alignbit_b32 v217, v180, v179, 16
    s_waitcnt lgkmcnt(4)
    v_mfma_f32_16x16x32_bf16 v[68:71], v[132:135], a[48:51], v[68:71]
    ds_write_b128 v5, v[214:217] offset:29120
    v_mfma_f32_16x16x32_bf16 v[56:59], v[128:131], a[112:115], v[56:59]
    ds_read_b128 v[144:147], v6 offset:1344
    v_mfma_f32_16x16x32_bf16 v[72:75], v[132:135], a[112:115], v[72:75]
    ds_read_b128 v[148:151], v6 offset:1376
    v_mfma_f32_16x16x32_bf16 v[60:63], v[128:131], a[176:179], v[60:63]
    v_alignbit_b32 v218, v181, v180, 16
    v_alignbit_b32 v219, v182, v181, 16
    v_mfma_f32_16x16x32_bf16 v[76:79], v[132:135], a[176:179], v[76:79]
    ds_write_b128 v5, v[216:219] offset:12480
    s_waitcnt lgkmcnt(6)
    v_mfma_f32_16x16x32_bf16 v[52:55], v[136:139], a[44:47], v[52:55]
    v_alignbit_b32 v220, v178, v177, 16
    v_alignbit_b32 v221, v179, v178, 16
    s_waitcnt lgkmcnt(5)
    v_mfma_f32_16x16x32_bf16 v[68:71], v[140:143], a[44:47], v[68:71]
    v_alignbit_b32 v222, v180, v179, 16
    v_alignbit_b32 v223, v181, v180, 16
    v_mfma_f32_16x16x32_bf16 v[56:59], v[136:139], a[108:111], v[56:59]
    ds_read_b128 v[152:155], v6 offset:1408
    v_mfma_f32_16x16x32_bf16 v[72:75], v[140:143], a[108:111], v[72:75]
    ds_read_b128 v[156:159], v6 offset:1440
    v_mfma_f32_16x16x32_bf16 v[60:63], v[136:139], a[172:175], v[60:63]
    ds_write_b128 v5, v[220:223] offset:20800
    v_mfma_f32_16x16x32_bf16 v[76:79], v[140:143], a[172:175], v[76:79]
    v_alignbit_b32 v224, v182, v181, 16
    v_alignbit_b32 v225, v183, v182, 16
    s_waitcnt lgkmcnt(5)
    v_mfma_f32_16x16x32_bf16 v[52:55], v[144:147], a[40:43], v[52:55]
    ds_write_b128 v5, v[222:225] offset:4160
    s_waitcnt lgkmcnt(5)
    v_mfma_f32_16x16x32_bf16 v[68:71], v[148:151], a[40:43], v[68:71]
    buffer_load_dwordx4 v[176:179], v230, s[28:31], s37 offen offset:0
    v_mfma_f32_16x16x32_bf16 v[56:59], v[144:147], a[104:107], v[56:59]
    ds_read_b128 v[160:163], v6 offset:1472
    v_mfma_f32_16x16x32_bf16 v[72:75], v[148:151], a[104:107], v[72:75]
    ds_read_b128 v[164:167], v6 offset:1504
    v_mfma_f32_16x16x32_bf16 v[60:63], v[144:147], a[168:171], v[60:63]
    buffer_load_dwordx4 v[180:183], v4, s[28:31], s37 offen offset:0
    v_mfma_f32_16x16x32_bf16 v[76:79], v[148:151], a[168:171], v[76:79]
    s_add_u32 m0, s35, 0
    s_waitcnt lgkmcnt(5)
    v_mfma_f32_16x16x32_bf16 v[52:55], v[152:155], a[36:39], v[52:55]
    buffer_load_dwordx4 v4, s[8:11], s39 offen offset:0 lds
    s_waitcnt lgkmcnt(4)
    v_mfma_f32_16x16x32_bf16 v[68:71], v[156:159], a[36:39], v[68:71]
    s_add_u32 m0, s35, 256
    v_mfma_f32_16x16x32_bf16 v[56:59], v[152:155], a[100:103], v[56:59]
    ds_read_b128 v[168:171], v6 offset:1536
    v_mfma_f32_16x16x32_bf16 v[72:75], v[156:159], a[100:103], v[72:75]
    ds_read_b128 v[172:175], v6 offset:1568
    v_mfma_f32_16x16x32_bf16 v[60:63], v[152:155], a[164:167], v[60:63]
    buffer_load_dwordx4 v4, s[8:11], s39 offen offset:1024 lds
    v_mfma_f32_16x16x32_bf16 v[76:79], v[156:159], a[164:167], v[76:79]
    s_add_u32 m0, s35, 512
    s_waitcnt lgkmcnt(3)
    v_mfma_f32_16x16x32_bf16 v[52:55], v[160:163], a[32:35], v[52:55]
    buffer_load_dwordx4 v4, s[8:11], s39 offen offset:2048 lds
    s_waitcnt lgkmcnt(2)
    v_mfma_f32_16x16x32_bf16 v[68:71], v[164:167], a[32:35], v[68:71]
    s_add_u32 m0, s35, 768
    v_mfma_f32_16x16x32_bf16 v[56:59], v[160:163], a[96:99], v[56:59]
    ds_read_b128 v[112:115], v6 offset:1600
    v_mfma_f32_16x16x32_bf16 v[72:75], v[164:167], a[96:99], v[72:75]
    ds_read_b128 v[116:119], v6 offset:1632
    v_mfma_f32_16x16x32_bf16 v[60:63], v[160:163], a[160:163], v[60:63]
    buffer_load_dwordx4 v4, s[8:11], s39 offen offset:3072 lds
    v_mfma_f32_16x16x32_bf16 v[76:79], v[164:167], a[160:163], v[76:79]
    s_waitcnt lgkmcnt(3)
    v_mfma_f32_16x16x32_bf16 v[52:55], v[168:171], a[28:31], v[52:55]
    s_waitcnt lgkmcnt(2)
    v_mfma_f32_16x16x32_bf16 v[68:71], v[172:175], a[28:31], v[68:71]
    v_mfma_f32_16x16x32_bf16 v[56:59], v[168:171], a[92:95], v[56:59]
    ds_read_b128 v[120:123], v6 offset:1664
    v_mfma_f32_16x16x32_bf16 v[72:75], v[172:175], a[92:95], v[72:75]
    ds_read_b128 v[124:127], v6 offset:1696
    v_mfma_f32_16x16x32_bf16 v[60:63], v[168:171], a[156:159], v[60:63]
    v_mfma_f32_16x16x32_bf16 v[76:79], v[172:175], a[156:159], v[76:79]
    s_waitcnt lgkmcnt(3)
    v_mfma_f32_16x16x32_bf16 v[52:55], v[112:115], a[24:27], v[52:55]
    s_waitcnt lgkmcnt(2)
    v_mfma_f32_16x16x32_bf16 v[68:71], v[116:119], a[24:27], v[68:71]
    v_mfma_f32_16x16x32_bf16 v[56:59], v[112:115], a[88:91], v[56:59]
    ds_read_b128 v[128:131], v6 offset:1728
    v_mfma_f32_16x16x32_bf16 v[72:75], v[116:119], a[88:91], v[72:75]
    ds_read_b128 v[132:135], v6 offset:1760
    v_mfma_f32_16x16x32_bf16 v[60:63], v[112:115], a[152:155], v[60:63]
    v_mfma_f32_16x16x32_bf16 v[76:79], v[116:119], a[152:155], v[76:79]
    s_waitcnt lgkmcnt(3)
    v_mfma_f32_16x16x32_bf16 v[52:55], v[120:123], a[20:23], v[52:55]
    s_waitcnt lgkmcnt(2)
    v_mfma_f32_16x16x32_bf16 v[68:71], v[124:127], a[20:23], v[68:71]
    v_mfma_f32_16x16x32_bf16 v[56:59], v[120:123], a[84:87], v[56:59]
    ds_read_b128 v[136:139], v6 offset:1792
    v_mfma_f32_16x16x32_bf16 v[72:75], v[124:127], a[84:87], v[72:75]
    ds_read_b128 v[140:143], v6 offset:1824
    v_mfma_f32_16x16x32_bf16 v[60:63], v[120:123], a[148:151], v[60:63]
    v_mfma_f32_16x16x32_bf16 v[76:79], v[124:127], a[148:151], v[76:79]
    s_waitcnt lgkmcnt(3)
    v_mfma_f32_16x16x32_bf16 v[52:55], v[128:131], a[16:19], v[52:55]
    s_waitcnt lgkmcnt(2)
    v_mfma_f32_16x16x32_bf16 v[68:71], v[132:135], a[16:19], v[68:71]
    v_mfma_f32_16x16x32_bf16 v[56:59], v[128:131], a[80:83], v[56:59]
    ds_read_b128 v[144:147], v6 offset:1856
    v_mfma_f32_16x16x32_bf16 v[72:75], v[132:135], a[80:83], v[72:75]
    ds_read_b128 v[148:151], v6 offset:1888
    v_mfma_f32_16x16x32_bf16 v[60:63], v[128:131], a[144:147], v[60:63]
    v_mfma_f32_16x16x32_bf16 v[76:79], v[132:135], a[144:147], v[76:79]
    s_waitcnt lgkmcnt(3)
    v_mfma_f32_16x16x32_bf16 v[52:55], v[136:139], a[12:15], v[52:55]
    s_waitcnt lgkmcnt(2)
    v_mfma_f32_16x16x32_bf16 v[68:71], v[140:143], a[12:15], v[68:71]
    v_mfma_f32_16x16x32_bf16 v[56:59], v[136:139], a[76:79], v[56:59]
    ds_read_b128 v[152:155], v6 offset:1920
    v_mfma_f32_16x16x32_bf16 v[72:75], v[140:143], a[76:79], v[72:75]
    ds_read_b128 v[156:159], v6 offset:1952
    v_mfma_f32_16x16x32_bf16 v[60:63], v[136:139], a[140:143], v[60:63]
    v_mfma_f32_16x16x32_bf16 v[76:79], v[140:143], a[140:143], v[76:79]
    s_waitcnt lgkmcnt(3)
    v_mfma_f32_16x16x32_bf16 v[52:55], v[144:147], a[8:11], v[52:55]
    s_waitcnt lgkmcnt(2)
    v_mfma_f32_16x16x32_bf16 v[68:71], v[148:151], a[8:11], v[68:71]
    v_mfma_f32_16x16x32_bf16 v[56:59], v[144:147], a[72:75], v[56:59]
    ds_read_b128 v[160:163], v6 offset:1984
    v_mfma_f32_16x16x32_bf16 v[72:75], v[148:151], a[72:75], v[72:75]
    ds_read_b128 v[164:167], v6 offset:2016
    v_mfma_f32_16x16x32_bf16 v[60:63], v[144:147], a[136:139], v[60:63]
    v_mfma_f32_16x16x32_bf16 v[76:79], v[148:151], a[136:139], v[76:79]
    s_waitcnt lgkmcnt(3)
    v_mfma_f32_16x16x32_bf16 v[52:55], v[152:155], a[4:7], v[52:55]
    s_waitcnt lgkmcnt(2)
    v_mfma_f32_16x16x32_bf16 v[68:71], v[156:159], a[4:7], v[68:71]
    v_mfma_f32_16x16x32_bf16 v[56:59], v[152:155], a[68:71], v[56:59]
    ds_read_b128 v[168:171], v6 offset:2048
    v_mfma_f32_16x16x32_bf16 v[72:75], v[156:159], a[68:71], v[72:75]
    ds_read_b128 v[172:175], v6 offset:2080
    v_mfma_f32_16x16x32_bf16 v[60:63], v[152:155], a[132:135], v[60:63]
    s_waitcnt vmcnt(10)
    v_mfma_f32_16x16x32_bf16 v[76:79], v[156:159], a[132:135], v[76:79]
    ds_write_b128 v5, v[188:191] offset:1024
    s_waitcnt lgkmcnt(4)
    v_mfma_f32_16x16x32_bf16 v[52:55], v[160:163], a[0:3], v[52:55]
    ds_read_b128 v[112:115], v6 offset:2112
    s_waitcnt lgkmcnt(4)
    v_mfma_f32_16x16x32_bf16 v[68:71], v[164:167], a[0:3], v[68:71]
    ds_read_b128 v[116:119], v6 offset:2144
    v_mfma_f32_16x16x32_bf16 v[56:59], v[160:163], a[64:67], v[56:59]
    ds_write_b128 v5, v[186:189] offset:17664
    v_mfma_f32_16x16x32_bf16 v[72:75], v[164:167], a[64:67], v[72:75]
    v_mov_b32 v208, v185
    v_mov_b32 v209, v186
    v_mfma_f32_16x16x32_bf16 v[60:63], v[160:163], a[128:131], v[60:63]
    ds_read_b128 v[120:123], v6 offset:2176
    v_mfma_f32_16x16x32_bf16 v[76:79], v[164:167], a[128:131], v[76:79]
    ds_read_b128 v[124:127], v6 offset:2208
    s_waitcnt lgkmcnt(7)
    v_mfma_f32_16x16x32_bf16 v[56:59], v[168:171], a[60:63], v[56:59]
    v_mov_b32 v210, v187
    v_mov_b32 v211, v188
    s_waitcnt lgkmcnt(6)
    v_mfma_f32_16x16x32_bf16 v[72:75], v[172:175], a[60:63], v[72:75]
    ds_write_b128 v5, v[208:211] offset:25984
    v_mfma_f32_16x16x32_bf16 v[60:63], v[168:171], a[124:127], v[60:63]
    ds_read_b128 v[128:131], v6 offset:2240
    v_mfma_f32_16x16x32_bf16 v[76:79], v[172:175], a[124:127], v[76:79]
    ds_read_b128 v[132:135], v6 offset:2272
    s_waitcnt lgkmcnt(7)
    v_mfma_f32_16x16x32_bf16 v[56:59], v[112:115], a[56:59], v[56:59]
    v_mov_b32 v212, v189
    v_mov_b32 v213, v190
    s_waitcnt lgkmcnt(6)
    v_mfma_f32_16x16x32_bf16 v[72:75], v[116:119], a[56:59], v[72:75]
    ds_write_b128 v5, v[210:213] offset:9344
    v_mfma_f32_16x16x32_bf16 v[60:63], v[112:115], a[120:123], v[60:63]
    ds_read_b128 v[136:139], v6 offset:2304
    v_mfma_f32_16x16x32_bf16 v[76:79], v[116:119], a[120:123], v[76:79]
    ds_read_b128 v[140:143], v6 offset:2336
    s_waitcnt lgkmcnt(7)
    v_mfma_f32_16x16x32_bf16 v[56:59], v[120:123], a[52:55], v[56:59]
    v_alignbit_b32 v214, v185, v184, 16
    v_alignbit_b32 v215, v186, v185, 16
    s_waitcnt lgkmcnt(6)
    v_mfma_f32_16x16x32_bf16 v[72:75], v[124:127], a[52:55], v[72:75]
    v_alignbit_b32 v216, v187, v186, 16
    v_alignbit_b32 v217, v188, v187, 16
    v_mfma_f32_16x16x32_bf16 v[60:63], v[120:123], a[116:119], v[60:63]
    ds_read_b128 v[144:147], v6 offset:2368
    v_mfma_f32_16x16x32_bf16 v[76:79], v[124:127], a[116:119], v[76:79]
    ds_read_b128 v[148:151], v6 offset:2400
    s_waitcnt lgkmcnt(6)
    v_mfma_f32_16x16x32_bf16 v[56:59], v[128:131], a[48:51], v[56:59]
    ds_write_b128 v5, v[214:217] offset:30144
    s_waitcnt lgkmcnt(6)
    v_mfma_f32_16x16x32_bf16 v[72:75], v[132:135], a[48:51], v[72:75]
    v_alignbit_b32 v218, v189, v188, 16
    v_alignbit_b32 v219, v190, v189, 16
    v_mfma_f32_16x16x32_bf16 v[60:63], v[128:131], a[112:115], v[60:63]
    ds_read_b128 v[152:155], v6 offset:2432
    v_mfma_f32_16x16x32_bf16 v[76:79], v[132:135], a[112:115], v[76:79]
    ds_read_b128 v[156:159], v6 offset:2464
    s_waitcnt lgkmcnt(6)
    v_mfma_f32_16x16x32_bf16 v[56:59], v[136:139], a[44:47], v[56:59]
    ds_write_b128 v5, v[216:219] offset:13504
    s_waitcnt lgkmcnt(6)
    v_mfma_f32_16x16x32_bf16 v[72:75], v[140:143], a[44:47], v[72:75]
    v_alignbit_b32 v220, v186, v185, 16
    v_alignbit_b32 v221, v187, v186, 16
    v_mfma_f32_16x16x32_bf16 v[60:63], v[136:139], a[108:111], v[60:63]
    ds_read_b128 v[160:163], v6 offset:2496
    v_mfma_f32_16x16x32_bf16 v[76:79], v[140:143], a[108:111], v[76:79]
    ds_read_b128 v[164:167], v6 offset:2528
    s_waitcnt lgkmcnt(7)
    v_mfma_f32_16x16x32_bf16 v[56:59], v[144:147], a[40:43], v[56:59]
    v_alignbit_b32 v222, v188, v187, 16
    v_alignbit_b32 v223, v189, v188, 16
    s_waitcnt lgkmcnt(6)
    v_mfma_f32_16x16x32_bf16 v[72:75], v[148:151], a[40:43], v[72:75]
    ds_write_b128 v5, v[220:223] offset:21824
    v_mfma_f32_16x16x32_bf16 v[60:63], v[144:147], a[104:107], v[60:63]
    ds_read_b128 v[168:171], v6 offset:2560
    v_mfma_f32_16x16x32_bf16 v[76:79], v[148:151], a[104:107], v[76:79]
    ds_read_b128 v[172:175], v6 offset:2592
    s_waitcnt lgkmcnt(7)
    v_mfma_f32_16x16x32_bf16 v[56:59], v[152:155], a[36:39], v[56:59]
    v_alignbit_b32 v224, v190, v189, 16
    v_alignbit_b32 v225, v191, v190, 16
    s_waitcnt lgkmcnt(6)
    v_mfma_f32_16x16x32_bf16 v[72:75], v[156:159], a[36:39], v[72:75]
    ds_write_b128 v5, v[222:225] offset:5184
    v_mfma_f32_16x16x32_bf16 v[60:63], v[152:155], a[100:103], v[60:63]
    ds_read_b128 v[112:115], v6 offset:2624
    v_mfma_f32_16x16x32_bf16 v[76:79], v[156:159], a[100:103], v[76:79]
    ds_read_b128 v[116:119], v6 offset:2656
    s_waitcnt lgkmcnt(7)
    v_mfma_f32_16x16x32_bf16 v[56:59], v[160:163], a[32:35], v[56:59]
    buffer_load_dwordx4 v[184:187], v4, s[28:31], s37 offen offset:1008
    s_waitcnt lgkmcnt(6)
    v_mfma_f32_16x16x32_bf16 v[72:75], v[164:167], a[32:35], v[72:75]
    buffer_load_dwordx4 v[188:191], v4, s[28:31], s37 offen offset:1024
    v_mfma_f32_16x16x32_bf16 v[60:63], v[160:163], a[96:99], v[60:63]
    ds_read_b128 v[120:123], v6 offset:2688
    v_mfma_f32_16x16x32_bf16 v[76:79], v[164:167], a[96:99], v[76:79]
    ds_read_b128 v[124:127], v6 offset:2720
    s_waitcnt lgkmcnt(6)
    v_mfma_f32_16x16x32_bf16 v[56:59], v[168:171], a[28:31], v[56:59]
    s_mov_b32 s36, s37
    s_add_u32 s39, s37, 125829120
    s_add_u32 s37, s37, 4096
    s_min_u32 s37, s37, s33

    s_pack_ll_b32_b16 s40, s65, s65
    s_mov_b32 s64, s65
    s_mov_b32 s65, s66
    s_mov_b32 s66, s67
    v_and_b32 v236, s40, v8
    s_waitcnt lgkmcnt(5)
    v_mfma_f32_16x16x32_bf16 v[72:75], v[172:175], a[28:31], v[72:75]
    v_and_b32 v237, s40, v9
    v_and_b32 v238, s40, v10
    v_mfma_f32_16x16x32_bf16 v[60:63], v[168:171], a[92:95], v[60:63]
    ds_read_b128 v[128:131], v6 offset:2752
    v_mfma_f32_16x16x32_bf16 v[76:79], v[172:175], a[92:95], v[76:79]
    ds_read_b128 v[132:135], v6 offset:2784
    s_waitcnt lgkmcnt(5)
    v_mfma_f32_16x16x32_bf16 v[56:59], v[112:115], a[24:27], v[56:59]
    v_and_b32 v239, s40, v11
    v_and_b32 v240, s40, v12
    s_waitcnt lgkmcnt(4)
    v_mfma_f32_16x16x32_bf16 v[72:75], v[116:119], a[24:27], v[72:75]
    v_and_b32 v241, s40, v13
    v_and_b32 v242, s40, v14
    v_mfma_f32_16x16x32_bf16 v[60:63], v[112:115], a[88:91], v[60:63]
    ds_read_b128 v[136:139], v6 offset:2816
    v_mfma_f32_16x16x32_bf16 v[76:79], v[116:119], a[88:91], v[76:79]
    ds_read_b128 v[140:143], v6 offset:2848
    s_waitcnt lgkmcnt(5)
    v_mfma_f32_16x16x32_bf16 v[56:59], v[120:123], a[20:23], v[56:59]
    v_and_b32 v243, s40, v15
    s_waitcnt lgkmcnt(4)
    v_mfma_f32_16x16x32_bf16 v[72:75], v[124:127], a[20:23], v[72:75]
    v_mfma_f32_16x16x32_bf16 v[60:63], v[120:123], a[84:87], v[60:63]
    ds_read_b128 v[144:147], v6 offset:2880
    v_mfma_f32_16x16x32_bf16 v[76:79], v[124:127], a[84:87], v[76:79]
    ds_read_b128 v[148:151], v6 offset:2912
    s_waitcnt lgkmcnt(5)
    v_mfma_f32_16x16x32_bf16 v[56:59], v[128:131], a[16:19], v[56:59]
    s_waitcnt lgkmcnt(4)
    v_mfma_f32_16x16x32_bf16 v[72:75], v[132:135], a[16:19], v[72:75]
    v_mfma_f32_16x16x32_bf16 v[60:63], v[128:131], a[80:83], v[60:63]
    ds_read_b128 v[152:155], v6 offset:2944
    v_mfma_f32_16x16x32_bf16 v[76:79], v[132:135], a[80:83], v[76:79]
    ds_read_b128 v[156:159], v6 offset:2976
    s_waitcnt lgkmcnt(5)
    v_mfma_f32_16x16x32_bf16 v[56:59], v[136:139], a[12:15], v[56:59]
    s_waitcnt lgkmcnt(4)
    v_mfma_f32_16x16x32_bf16 v[72:75], v[140:143], a[12:15], v[72:75]
    v_mfma_f32_16x16x32_bf16 v[60:63], v[136:139], a[76:79], v[60:63]
    ds_read_b128 v[160:163], v6 offset:3008
    v_mfma_f32_16x16x32_bf16 v[76:79], v[140:143], a[76:79], v[76:79]
    ds_read_b128 v[164:167], v6 offset:3040
    s_waitcnt lgkmcnt(5)
    v_mfma_f32_16x16x32_bf16 v[56:59], v[144:147], a[8:11], v[56:59]
    s_waitcnt lgkmcnt(4)
    v_mfma_f32_16x16x32_bf16 v[72:75], v[148:151], a[8:11], v[72:75]
    v_mfma_f32_16x16x32_bf16 v[60:63], v[144:147], a[72:75], v[60:63]
    ds_read_b128 v[168:171], v6 offset:3072
    v_mfma_f32_16x16x32_bf16 v[76:79], v[148:151], a[72:75], v[76:79]
    ds_read_b128 v[172:175], v6 offset:3104
    s_waitcnt lgkmcnt(5)
    v_mfma_f32_16x16x32_bf16 v[56:59], v[152:155], a[4:7], v[56:59]
    ds_read_b128 v[112:115], v6 offset:3136
    s_waitcnt lgkmcnt(5)
    v_mfma_f32_16x16x32_bf16 v[72:75], v[156:159], a[4:7], v[72:75]
    ds_read_b128 v[116:119], v6 offset:3168
    v_mfma_f32_16x16x32_bf16 v[60:63], v[152:155], a[68:71], v[60:63]
    ds_read_b128 v[120:123], v6 offset:3200
    v_mfma_f32_16x16x32_bf16 v[76:79], v[156:159], a[68:71], v[76:79]
    ds_read_b128 v[124:127], v6 offset:3232
    s_waitcnt lgkmcnt(7)
    v_mfma_f32_16x16x32_bf16 v[56:59], v[160:163], a[0:3], v[56:59]
    ds_read_b128 v[128:131], v6 offset:3264
    s_waitcnt lgkmcnt(7)
    v_mfma_f32_16x16x32_bf16 v[72:75], v[164:167], a[0:3], v[72:75]
    ds_read_b128 v[132:135], v6 offset:3296
    v_mfma_f32_16x16x32_bf16 v[60:63], v[160:163], a[64:67], v[60:63]
    ds_read_b128 v[136:139], v6 offset:3328
    v_mfma_f32_16x16x32_bf16 v[76:79], v[164:167], a[64:67], v[76:79]
    ds_read_b128 v[140:143], v6 offset:3360
    s_waitcnt lgkmcnt(9)
    v_mfma_f32_16x16x32_bf16 v[60:63], v[168:171], a[60:63], v[60:63]
    ds_read_b128 v[144:147], v6 offset:3392
    s_waitcnt lgkmcnt(9)
    v_mfma_f32_16x16x32_bf16 v[76:79], v[172:175], a[60:63], v[76:79]
    ds_read_b128 v[148:151], v6 offset:3424
    s_waitcnt lgkmcnt(9)
    v_mfma_f32_16x16x32_bf16 v[60:63], v[112:115], a[56:59], v[60:63]
    ds_read_b128 v[152:155], v6 offset:3456
    s_waitcnt lgkmcnt(9)
    v_mfma_f32_16x16x32_bf16 v[76:79], v[116:119], a[56:59], v[76:79]
    ds_read_b128 v[156:159], v6 offset:3488
    s_waitcnt lgkmcnt(9)
    v_mfma_f32_16x16x32_bf16 v[60:63], v[120:123], a[52:55], v[60:63]
    ds_read_b128 v[160:163], v6 offset:3520
    s_waitcnt lgkmcnt(9)
    v_mfma_f32_16x16x32_bf16 v[76:79], v[124:127], a[52:55], v[76:79]
    ds_read_b128 v[164:167], v6 offset:3552
    s_waitcnt lgkmcnt(9)
    v_mfma_f32_16x16x32_bf16 v[60:63], v[128:131], a[48:51], v[60:63]
    ds_read_b128 v[168:171], v6 offset:3584
    s_waitcnt lgkmcnt(9)
    v_mfma_f32_16x16x32_bf16 v[76:79], v[132:135], a[48:51], v[76:79]
    ds_read_b128 v[172:175], v6 offset:3616
    s_waitcnt lgkmcnt(9)
    v_mfma_f32_16x16x32_bf16 v[60:63], v[136:139], a[44:47], v[60:63]
    ds_read_b128 v[112:115], v6 offset:3648
    s_waitcnt lgkmcnt(9)
    v_mfma_f32_16x16x32_bf16 v[76:79], v[140:143], a[44:47], v[76:79]
    ds_read_b128 v[116:119], v6 offset:3680
    s_waitcnt lgkmcnt(9)
    v_mfma_f32_16x16x32_bf16 v[60:63], v[144:147], a[40:43], v[60:63]
    ds_read_b128 v[120:123], v6 offset:3712
    s_waitcnt lgkmcnt(9)
    v_mfma_f32_16x16x32_bf16 v[76:79], v[148:151], a[40:43], v[76:79]
    ds_read_b128 v[124:127], v6 offset:3744
    s_waitcnt lgkmcnt(9)
    v_mfma_f32_16x16x32_bf16 v[60:63], v[152:155], a[36:39], v[60:63]
    ds_read_b128 v[128:131], v6 offset:3776
    s_waitcnt lgkmcnt(9)
    v_mfma_f32_16x16x32_bf16 v[76:79], v[156:159], a[36:39], v[76:79]
    ds_read_b128 v[132:135], v6 offset:3808
    s_waitcnt lgkmcnt(9)
    v_mfma_f32_16x16x32_bf16 v[60:63], v[160:163], a[32:35], v[60:63]
    ds_read_b128 v[136:139], v6 offset:3840
    s_waitcnt lgkmcnt(9)
    v_mfma_f32_16x16x32_bf16 v[76:79], v[164:167], a[32:35], v[76:79]
    ds_read_b128 v[140:143], v6 offset:3872
    s_waitcnt lgkmcnt(9)
    v_mfma_f32_16x16x32_bf16 v[60:63], v[168:171], a[28:31], v[60:63]
    ds_read_b128 v[144:147], v6 offset:3904
    s_waitcnt lgkmcnt(9)
    v_mfma_f32_16x16x32_bf16 v[76:79], v[172:175], a[28:31], v[76:79]
    ds_read_b128 v[148:151], v6 offset:3936
    s_waitcnt lgkmcnt(9)
    v_mfma_f32_16x16x32_bf16 v[60:63], v[112:115], a[24:27], v[60:63]
    ds_read_b128 v[152:155], v6 offset:3968
    s_waitcnt lgkmcnt(9)
    v_mfma_f32_16x16x32_bf16 v[76:79], v[116:119], a[24:27], v[76:79]
    ds_read_b128 v[156:159], v6 offset:4000
    s_waitcnt lgkmcnt(9)
    v_mfma_f32_16x16x32_bf16 v[60:63], v[120:123], a[20:23], v[60:63]
    ds_read_b128 v[160:163], v6 offset:4032
    s_waitcnt lgkmcnt(9)
    v_mfma_f32_16x16x32_bf16 v[76:79], v[124:127], a[20:23], v[76:79]
    ds_read_b128 v[164:167], v6 offset:4064
    s_waitcnt lgkmcnt(9)
    v_mfma_f32_16x16x32_bf16 v[60:63], v[128:131], a[16:19], v[60:63]
    s_waitcnt vmcnt(2)
    ds_read_b128 a[60:63], v7 offset:240
    s_waitcnt lgkmcnt(9)
    v_mfma_f32_16x16x32_bf16 v[76:79], v[132:135], a[16:19], v[76:79]
    s_waitcnt lgkmcnt(8)
    v_mfma_f32_16x16x32_bf16 v[60:63], v[136:139], a[12:15], v[60:63]
    ds_read_b128 a[124:127], v7 offset:496
    s_waitcnt lgkmcnt(8)
    v_mfma_f32_16x16x32_bf16 v[76:79], v[140:143], a[12:15], v[76:79]
    s_waitcnt lgkmcnt(7)
    v_mfma_f32_16x16x32_bf16 v[60:63], v[144:147], a[8:11], v[60:63]
    ds_read_b128 a[188:191], v7 offset:752
    s_waitcnt lgkmcnt(7)
    v_mfma_f32_16x16x32_bf16 v[76:79], v[148:151], a[8:11], v[76:79]
    s_waitcnt lgkmcnt(6)
    v_mfma_f32_16x16x32_bf16 v[60:63], v[152:155], a[4:7], v[60:63]
    ds_read_b128 a[252:255], v7 offset:1008
    s_waitcnt lgkmcnt(6)
    v_mfma_f32_16x16x32_bf16 v[76:79], v[156:159], a[4:7], v[76:79]
    s_waitcnt lgkmcnt(5)
    v_mfma_f32_16x16x32_bf16 v[60:63], v[160:163], a[0:3], v[60:63]
    ds_read_b128 v[168:171], v6 offset:0
    s_waitcnt lgkmcnt(5)
    v_mfma_f32_16x16x32_bf16 v[76:79], v[164:167], a[0:3], v[76:79]
    ds_read_b128 v[172:175], v6 offset:32
    s_add_u32 s41, s38, 4096
    v_cvt_pk_bf16_f32 v80, v16, v48
    v_cvt_pk_bf16_f32 v81, v17, v49
    v_cvt_pk_bf16_f32 v82, v18, v50
    v_cvt_pk_bf16_f32 v83, v19, v51
    buffer_store_dwordx4 v[80:83], v228, s[8:11], s38 offen offset:0 sc1
    v_cvt_pk_bf16_f32 v84, v32, v64
    v_cvt_pk_bf16_f32 v85, v33, v65
    v_cvt_pk_bf16_f32 v86, v34, v66
    v_cvt_pk_bf16_f32 v87, v35, v67
    buffer_store_dwordx4 v[84:87], v228, s[8:11], s38 offen offset:64 sc1
    v_cvt_pk_bf16_f32 v88, v20, v52
    v_cvt_pk_bf16_f32 v89, v21, v53
    v_cvt_pk_bf16_f32 v90, v22, v54
    v_cvt_pk_bf16_f32 v91, v23, v55
    buffer_store_dwordx4 v[88:91], v228, s[8:11], s38 offen offset:2048 sc1
    v_cvt_pk_bf16_f32 v92, v36, v68
    v_cvt_pk_bf16_f32 v93, v37, v69
    v_cvt_pk_bf16_f32 v94, v38, v70
    v_cvt_pk_bf16_f32 v95, v39, v71
    buffer_store_dwordx4 v[92:95], v228, s[8:11], s38 offen offset:2112 sc1
    v_cvt_pk_bf16_f32 v96, v24, v56
    v_cvt_pk_bf16_f32 v97, v25, v57
    v_cvt_pk_bf16_f32 v98, v26, v58
    v_cvt_pk_bf16_f32 v99, v27, v59
    buffer_store_dwordx4 v[96:99], v228, s[8:11], s41 offen offset:0 sc1
    v_cvt_pk_bf16_f32 v100, v40, v72
    v_cvt_pk_bf16_f32 v101, v41, v73
    v_cvt_pk_bf16_f32 v102, v42, v74
    v_cvt_pk_bf16_f32 v103, v43, v75
    buffer_store_dwordx4 v[100:103], v228, s[8:11], s41 offen offset:64 sc1
    v_cvt_pk_bf16_f32 v104, v28, v60
    v_cvt_pk_bf16_f32 v105, v29, v61
    v_cvt_pk_bf16_f32 v106, v30, v62
    v_cvt_pk_bf16_f32 v107, v31, v63
    buffer_store_dwordx4 v[104:107], v228, s[8:11], s41 offen offset:2048 sc1
    v_cvt_pk_bf16_f32 v108, v44, v76
    v_cvt_pk_bf16_f32 v109, v45, v77
    v_cvt_pk_bf16_f32 v110, v46, v78
    v_cvt_pk_bf16_f32 v111, v47, v79
    buffer_store_dwordx4 v[108:111], v228, s[8:11], s41 offen offset:2112 sc1
    s_add_u32 s38, s38, 8192
    s_add_u32 s42, s42, 1
    s_cmp_lt_u32 s42, 4
    s_cbranch_scc1 .cvl_429

    s_waitcnt vmcnt(0) lgkmcnt(0)
    s_barrier
    s_mov_b32 s5, 160
    s_cmp_lg_u32 s24, 0
    s_cbranch_scc1 .sg_430
    s_mov_b64 exec, 1
    v_mov_b32 v4, 1
    v_mov_b32 v5, 0
    buffer_atomic_add v4, v5, s[20:23], s5 offen sc1
    s_mov_b64 exec, -1

.sg_430:
    v_and_b32 v1, 63, v0
    v_and_b32 v2, 15, v1
    v_lshrrev_b32 v3, 4, v1

    s_sub_u32 s4, s26, 24
    s_lshr_b32 s25, s4, 1
    s_and_b32 s4, s4, 1
    s_lshl_b32 s4, s4, 2
    s_lshl_b32 s5, s91, 3
    s_add_u32 s4, s4, s5
    s_add_u32 s26, s4, s24
    s_lshl_b32 s35, s26, 8
    s_add_u32 s35, s35, 92274688
    s_mov_b32 s37, 0x3db504f3
    s_mov_b32 s38, 0x3fb8aa3b
    v_lshlrev_b32 v8, 4, v1
    v_min_u32 v9, 2, v1
    v_lshlrev_b32 v9, 13, v9
    v_lshlrev_b32 v6, 4, v3
    v_and_b32 v5, 7, v2
    v_add_u32 v10, v6, v5
    v_lshlrev_b32 v10, 4, v10
    v_lshlrev_b32 v11, 4, v2
    v_lshlrev_b32 v5, 3, v3
    v_add_u32 v11, v11, v5
    v_cmp_gt_u32 s[60:61], 32, v1
    v_lshlrev_b32 v5, 2, v3
    v_mov_b32 v12, 0
    v_mov_b32 v13, 0
    v_mov_b32 v14, 0xff800000
    v_lshlrev_b32 v204, 9, v1
    v_add_u32 v204, 4604, v204
    s_lshl_b32 s4, s25, 5
    s_add_u32 s4, s4, s26
    s_lshl_b32 s27, s4, 13
    s_mul_i32 s33, s4, 6144
    s_add_u32 s33, s33, 67108864
    s_add_u32 s36, s25, 1

    v_add_u32 v7, 0, v5
    v_cmp_le_u32 s[40:41], v7, v2
    v_add_u32 v7, 1, v5
    v_cmp_le_u32 s[42:43], v7, v2
    v_add_u32 v7, 2, v5
    v_cmp_le_u32 s[44:45], v7, v2
    v_add_u32 v7, 3, v5
    v_cmp_le_u32 s[46:47], v7, v2
    v_mov_b32 v112, 0
    v_mov_b32 v113, 0
    v_mov_b32 v114, 0
    v_mov_b32 v115, 0
    v_mov_b32 v116, 0
    v_mov_b32 v117, 0
    v_mov_b32 v118, 0
    v_mov_b32 v119, 0
    v_mov_b32 v120, 0
    v_mov_b32 v121, 0
    v_mov_b32 v122, 0
    v_mov_b32 v123, 0
    v_mov_b32 v124, 0
    v_mov_b32 v125, 0
    v_mov_b32 v126, 0
    v_mov_b32 v127, 0
    v_mov_b32 v128, 0
    v_mov_b32 v129, 0
    v_mov_b32 v130, 0
    v_mov_b32 v131, 0
    v_mov_b32 v132, 0
    v_mov_b32 v133, 0
    v_mov_b32 v134, 0
    v_mov_b32 v135, 0
    v_mov_b32 v136, 0
    v_mov_b32 v137, 0
    v_mov_b32 v138, 0
    v_mov_b32 v139, 0
    v_mov_b32 v140, 0
    v_mov_b32 v141, 0
    v_mov_b32 v142, 0
    v_mov_b32 v143, 0
    v_mov_b32 v15, -1
    s_mov_b32 s62, 0
    s_mov_b64 exec, 7
.wf_431:
    buffer_load_dword v15, v9, s[8:11], s35 offen sc1
    s_waitcnt vmcnt(0)
    v_cmp_gt_u32 vcc, s36, v15
    s_cbranch_vccz .wfd_432
    s_sleep 2
    s_add_u32 s62, s62, 1
    s_cmp_gt_u32 s62, 0x400000
    s_cbranch_scc1 .mg_end_1
    s_branch .wf_431

.wfd_432:
    s_mov_b64 exec, -1
    s_add_u32 s28, s27, 4096
    s_add_u32 s29, s27, 16777216
    s_add_u32 s30, s27, 16781312
    s_add_u32 s31, s27, 33554432
    s_add_u32 s32, s27, 33558528

    buffer_load_dwordx4 a[0:3], v8, s[8:11], s27 offen offset:0
    buffer_load_dwordx4 a[16:19], v8, s[8:11], s28 offen offset:0
    buffer_load_dwordx4 a[32:35], v8, s[8:11], s29 offen offset:0
    buffer_load_dwordx4 a[48:51], v8, s[8:11], s30 offen offset:0
    buffer_load_dwordx4 a[4:7], v8, s[8:11], s27 offen offset:1024
    buffer_load_dwordx4 a[20:23], v8, s[8:11], s28 offen offset:1024
    buffer_load_dwordx4 a[36:39], v8, s[8:11], s29 offen offset:1024
    buffer_load_dwordx4 a[52:55], v8, s[8:11], s30 offen offset:1024
    buffer_load_dwordx4 a[8:11], v8, s[8:11], s27 offen offset:2048
    buffer_load_dwordx4 a[24:27], v8, s[8:11], s28 offen offset:2048
    buffer_load_dwordx4 a[40:43], v8, s[8:11], s29 offen offset:2048
    buffer_load_dwordx4 a[56:59], v8, s[8:11], s30 offen offset:2048
    buffer_load_dwordx4 a[12:15], v8, s[8:11], s27 offen offset:3072
    buffer_load_dwordx4 a[28:31], v8, s[8:11], s28 offen offset:3072
    buffer_load_dwordx4 a[44:47], v8, s[8:11], s29 offen offset:3072
    buffer_load_dwordx4 a[60:63], v8, s[8:11], s30 offen offset:3072
    buffer_load_dwordx4 a[64:67], v8, s[8:11], s31 offen offset:0
    buffer_load_dwordx4 a[68:71], v8, s[8:11], s31 offen offset:1024
    buffer_load_dwordx4 a[72:75], v8, s[8:11], s31 offen offset:2048
    buffer_load_dwordx4 a[76:79], v8, s[8:11], s31 offen offset:3072
    buffer_load_dwordx4 a[80:83], v8, s[8:11], s32 offen offset:0
    buffer_load_dwordx4 a[84:87], v8, s[8:11], s32 offen offset:1024
    buffer_load_dwordx4 a[88:91], v8, s[8:11], s32 offen offset:2048
    buffer_load_dwordx4 a[92:95], v8, s[8:11], s32 offen offset:3072
    buffer_load_dwordx4 v[80:83], v10, s[8:11], s33 offen offset:2048 sc1
    buffer_load_dwordx4 v[84:87], v10, s[8:11], s33 offen offset:2176 sc1
    buffer_load_dwordx4 v[88:91], v10, s[8:11], s33 offen offset:3072 sc1
    buffer_load_dwordx4 v[92:95], v10, s[8:11], s33 offen offset:3200 sc1
    s_add_u32 s4, s33, 4096
    s_mov_b64 exec, s[60:61]
    buffer_load_dwordx2 v[128:129], v11, s[8:11], s4 offen offset:0 sc1
    buffer_load_dwordx2 v[130:131], v11, s[8:11], s4 offen offset:256 sc1
    buffer_load_dwordx2 v[132:133], v11, s[8:11], s4 offen offset:512 sc1
    buffer_load_dwordx2 v[134:135], v11, s[8:11], s4 offen offset:768 sc1
    buffer_load_dwordx2 v[136:137], v11, s[8:11], s4 offen offset:1024 sc1
    buffer_load_dwordx2 v[138:139], v11, s[8:11], s4 offen offset:1280 sc1
    buffer_load_dwordx2 v[140:141], v11, s[8:11], s4 offen offset:1536 sc1
    buffer_load_dwordx2 v[142:143], v11, s[8:11], s4 offen offset:1792 sc1
    s_mov_b64 exec, -1
    s_waitcnt vmcnt(0)
.att_433:
    s_mov_b32 s34, s33
    s_add_u32 s50, s27, 50331648
    s_add_u32 s51, s27, 50335744
    s_cmp_lt_u32 s25, 60
    s_cselect_b32 s4, 4, 0
    s_cselect_b32 s5, 1048576, 0
    s_cselect_b32 s6, 786432, 0
    s_add_u32 s36, s36, s4
    s_add_u32 s27, s27, s5
    s_add_u32 s33, s33, s6
    s_waitcnt vmcnt(8)

    v_cmp_gt_u32 vcc, s36, v15
    s_cbranch_vccnz .atw_434
.atb_435:
    s_add_u32 s28, s27, 4096
    s_add_u32 s29, s27, 16777216
    s_add_u32 s30, s27, 16781312
    s_add_u32 s31, s27, 33554432
    s_add_u32 s32, s27, 33558528

    buffer_load_dwordx4 a[96:99], v8, s[8:11], s27 offen offset:0
    buffer_load_dwordx4 a[112:115], v8, s[8:11], s28 offen offset:0
    buffer_load_dwordx4 a[128:131], v8, s[8:11], s29 offen offset:0
    buffer_load_dwordx4 a[144:147], v8, s[8:11], s30 offen offset:0
    buffer_load_dwordx4 a[100:103], v8, s[8:11], s27 offen offset:1024
    buffer_load_dwordx4 a[116:119], v8, s[8:11], s28 offen offset:1024
    buffer_load_dwordx4 a[132:135], v8, s[8:11], s29 offen offset:1024
    buffer_load_dwordx4 a[148:151], v8, s[8:11], s30 offen offset:1024
    buffer_load_dwordx4 a[104:107], v8, s[8:11], s27 offen offset:2048
    buffer_load_dwordx4 a[120:123], v8, s[8:11], s28 offen offset:2048
    buffer_load_dwordx4 a[136:139], v8, s[8:11], s29 offen offset:2048
    buffer_load_dwordx4 a[152:155], v8, s[8:11], s30 offen offset:2048
    buffer_load_dwordx4 a[108:111], v8, s[8:11], s27 offen offset:3072
    buffer_load_dwordx4 a[124:127], v8, s[8:11], s28 offen offset:3072
    buffer_load_dwordx4 a[140:143], v8, s[8:11], s29 offen offset:3072
    buffer_load_dwordx4 a[156:159], v8, s[8:11], s30 offen offset:3072
    buffer_load_dwordx4 a[160:163], v8, s[8:11], s31 offen offset:0
    buffer_load_dwordx4 a[164:167], v8, s[8:11], s31 offen offset:1024
    buffer_load_dwordx4 a[168:171], v8, s[8:11], s31 offen offset:2048
    buffer_load_dwordx4 a[172:175], v8, s[8:11], s31 offen offset:3072
    buffer_load_dwordx4 a[176:179], v8, s[8:11], s32 offen offset:0
    buffer_load_dwordx4 a[180:183], v8, s[8:11], s32 offen offset:1024
    buffer_load_dwordx4 a[184:187], v8, s[8:11], s32 offen offset:2048
    buffer_load_dwordx4 a[188:191], v8, s[8:11], s32 offen offset:3072
    buffer_load_dwordx4 v[96:99], v10, s[8:11], s33 offen offset:2048 sc1
    buffer_load_dwordx4 v[100:103], v10, s[8:11], s33 offen offset:2176 sc1
    buffer_load_dwordx4 v[104:107], v10, s[8:11], s33 offen offset:3072 sc1
    buffer_load_dwordx4 v[108:111], v10, s[8:11], s33 offen offset:3200 sc1
    s_add_u32 s4, s33, 4096
    s_mov_b64 exec, s[60:61]
    buffer_load_dwordx2 v[112:113], v11, s[8:11], s4 offen offset:0 sc1
    buffer_load_dwordx2 v[114:115], v11, s[8:11], s4 offen offset:256 sc1
    buffer_load_dwordx2 v[116:117], v11, s[8:11], s4 offen offset:512 sc1
    buffer_load_dwordx2 v[118:119], v11, s[8:11], s4 offen offset:768 sc1
    buffer_load_dwordx2 v[120:121], v11, s[8:11], s4 offen offset:1024 sc1
    buffer_load_dwordx2 v[122:123], v11, s[8:11], s4 offen offset:1280 sc1
    buffer_load_dwordx2 v[124:125], v11, s[8:11], s4 offen offset:1536 sc1
    buffer_load_dwordx2 v[126:127], v11, s[8:11], s4 offen offset:1792 sc1
    s_mov_b64 exec, -1
    v_mfma_f32_16x16x32_bf16 v[144:147], a[32:35], a[0:3], 0
    v_mfma_f32_16x16x32_bf16 v[156:159], a[32:35], a[16:19], 0
    v_mfma_f32_16x16x32_bf16 v[160:163], a[48:51], a[16:19], 0
    v_mfma_f32_16x16x32_bf16 v[144:147], a[36:39], a[4:7], v[144:147]
    v_mfma_f32_16x16x32_bf16 v[156:159], a[36:39], a[20:23], v[156:159]
    v_mfma_f32_16x16x32_bf16 v[160:163], a[52:55], a[20:23], v[160:163]
    v_mfma_f32_16x16x32_bf16 v[144:147], a[40:43], a[8:11], v[144:147]
    v_mfma_f32_16x16x32_bf16 v[156:159], a[40:43], a[24:27], v[156:159]
    v_mfma_f32_16x16x32_bf16 v[160:163], a[56:59], a[24:27], v[160:163]
    v_mfma_f32_16x16x32_bf16 v[144:147], a[44:47], a[12:15], v[144:147]
    v_mfma_f32_16x16x32_bf16 v[156:159], a[44:47], a[28:31], v[156:159]
    v_mfma_f32_16x16x32_bf16 v[160:163], a[60:63], a[28:31], v[160:163]
    s_nop 7
    v_cvt_pk_bf16_f32 v168, v144, v145
    v_cvt_pk_bf16_f32 v170, v146, v147
    v_and_b32 v169, 0xffff0000, v168
    v_lshlrev_b32 v168, 16, v168
    v_and_b32 v171, 0xffff0000, v170
    v_lshlrev_b32 v170, 16, v170
    v_mul_f32 v168, s37, v168
    v_mul_f32 v169, s37, v169
    v_mul_f32 v170, s37, v170
    v_mul_f32 v171, s37, v171
    v_cvt_pk_bf16_f32 v144, v168, v169
    v_cvt_pk_bf16_f32 v146, v170, v171
    v_and_b32 v145, 0xffff0000, v144
    v_lshlrev_b32 v144, 16, v144
    v_and_b32 v147, 0xffff0000, v146
    v_lshlrev_b32 v146, 16, v146
    v_cvt_pk_bf16_f32 v192, v156, v157
    v_cvt_pk_bf16_f32 v194, v158, v159
    v_cvt_pk_bf16_f32 v196, v160, v161
    v_cvt_pk_bf16_f32 v198, v162, v163
    v_and_b32 v193, 0xffff0000, v192
    v_lshlrev_b32 v192, 16, v192
    v_and_b32 v195, 0xffff0000, v194
    v_lshlrev_b32 v194, 16, v194
    v_and_b32 v197, 0xffff0000, v196
    v_lshlrev_b32 v196, 16, v196
    v_and_b32 v199, 0xffff0000, v198
    v_lshlrev_b32 v198, 16, v198
    v_mul_f32 v192, s37, v192
    v_mul_f32 v193, s37, v193
    v_mul_f32 v194, s37, v194
    v_mul_f32 v195, s37, v195
    v_mul_f32 v196, s37, v196
    v_mul_f32 v197, s37, v197
    v_mul_f32 v198, s37, v198
    v_mul_f32 v199, s37, v199
    v_cvt_pk_bf16_f32 v156, v192, v193
    v_cvt_pk_bf16_f32 v158, v194, v195
    v_cvt_pk_bf16_f32 v160, v196, v197
    v_cvt_pk_bf16_f32 v162, v198, v199
    v_and_b32 v157, 0xffff0000, v156
    v_lshlrev_b32 v156, 16, v156
    v_and_b32 v159, 0xffff0000, v158
    v_lshlrev_b32 v158, 16, v158
    v_and_b32 v161, 0xffff0000, v160
    v_lshlrev_b32 v160, 16, v160
    v_and_b32 v163, 0xffff0000, v162
    v_lshlrev_b32 v162, 16, v162
    v_cndmask_b32 v144, v14, v144, s[40:41]
    v_cndmask_b32 v145, v14, v145, s[42:43]
    v_cndmask_b32 v146, v14, v146, s[44:45]
    v_cndmask_b32 v147, v14, v147, s[46:47]
    v_cndmask_b32 v160, v14, v160, s[40:41]
    v_cndmask_b32 v161, v14, v161, s[42:43]
    v_cndmask_b32 v162, v14, v162, s[44:45]
    v_cndmask_b32 v163, v14, v163, s[46:47]
    s_mov_b32 s62, 0
.kmp_436:
    v_max3_u32 v4, v80, v81, v82
    v_max3_u32 v5, v83, v84, v85
    v_max3_u32 v4, v4, v86, v87
    v_max3_u32 v5, v5, v88, v89
    v_max3_u32 v4, v4, v90, v91
    v_max3_u32 v5, v5, v92, v93
    v_max3_u32 v4, v4, v94, v95
    v_max3_u32 v5, v5, v128, v129
    v_max3_u32 v4, v4, v130, v131
    v_max3_u32 v5, v5, v132, v133
    v_max3_u32 v4, v4, v134, v135
    v_max3_u32 v5, v5, v136, v137
    v_max3_u32 v4, v4, v138, v139
    v_max3_u32 v5, v5, v140, v141
    v_max3_u32 v4, v4, v142, v143
    v_max_u32 v4, v4, v5
    v_cmp_eq_u32 vcc, -1, v4
    s_cbranch_vccnz .kmf_437

    v_mfma_f32_16x16x32_bf16 v[152:155], v[80:83], a[0:3], 0
    v_mfma_f32_16x16x32_bf16 v[164:167], v[80:83], a[16:19], 0
    v_mfma_f32_16x16x32_bf16 v[152:155], v[84:87], a[4:7], v[152:155]
    v_mfma_f32_16x16x32_bf16 v[164:167], v[84:87], a[20:23], v[164:167]
    v_mfma_f32_16x16x32_bf16 v[152:155], v[88:91], a[8:11], v[152:155]
    v_mfma_f32_16x16x32_bf16 v[164:167], v[88:91], a[24:27], v[164:167]
    v_mfma_f32_16x16x32_bf16 v[152:155], v[92:95], a[12:15], v[152:155]
    v_mfma_f32_16x16x32_bf16 v[164:167], v[92:95], a[28:31], v[164:167]
    s_nop 5
    v_cvt_pk_bf16_f32 v176, v152, v153
    v_cvt_pk_bf16_f32 v178, v154, v155
    v_and_b32 v177, 0xffff0000, v176
    v_lshlrev_b32 v176, 16, v176
    v_and_b32 v179, 0xffff0000, v178
    v_lshlrev_b32 v178, 16, v178
    v_mul_f32 v176, s37, v176
    v_mul_f32 v177, s37, v177
    v_mul_f32 v178, s37, v178
    v_mul_f32 v179, s37, v179
    v_cvt_pk_bf16_f32 v152, v176, v177
    v_cvt_pk_bf16_f32 v154, v178, v179
    v_and_b32 v153, 0xffff0000, v152
    v_lshlrev_b32 v152, 16, v152
    v_and_b32 v155, 0xffff0000, v154
    v_lshlrev_b32 v154, 16, v154
    v_cndmask_b32 v152, v14, v152, s[60:61]
    v_cndmask_b32 v153, v14, v153, s[60:61]
    v_cndmask_b32 v154, v14, v154, s[60:61]
    v_cndmask_b32 v155, v14, v155, s[60:61]
    v_cvt_pk_bf16_f32 v200, v164, v165
    v_cvt_pk_bf16_f32 v202, v166, v167
    v_and_b32 v201, 0xffff0000, v200
    v_lshlrev_b32 v200, 16, v200
    v_and_b32 v203, 0xffff0000, v202
    v_lshlrev_b32 v202, 16, v202
    v_mul_f32 v200, s37, v200
    v_mul_f32 v201, s37, v201
    v_mul_f32 v202, s37, v202
    v_mul_f32 v203, s37, v203
    v_cvt_pk_bf16_f32 v164, v200, v201
    v_cvt_pk_bf16_f32 v166, v202, v203
    v_and_b32 v165, 0xffff0000, v164
    v_lshlrev_b32 v164, 16, v164
    v_and_b32 v167, 0xffff0000, v166
    v_lshlrev_b32 v166, 16, v166
    v_cndmask_b32 v164, v14, v164, s[60:61]
    v_cndmask_b32 v165, v14, v165, s[60:61]
    v_cndmask_b32 v166, v14, v166, s[60:61]
    v_cndmask_b32 v167, v14, v167, s[60:61]
    v_max3_f32 v4, v144, v145, v146
    v_max3_f32 v5, v147, v152, v153
    v_max3_f32 v4, v4, v154, v155
    v_max_f32 v4, v4, v5

    v_max3_f32 v6, v156, v157, v158
    v_max3_f32 v7, v159, v160, v161
    v_max3_f32 v6, v6, v162, v163
    v_max3_f32 v7, v7, v164, v165
    v_max3_f32 v6, v6, v166, v167
    v_max_f32 v6, v6, v7

    v_mov_b32 v5, v4
    v_mov_b32 v7, v6
    s_nop 0
    v_permlane32_swap_b32 v4, v5
    v_permlane32_swap_b32 v6, v7
    v_max_f32 v4, v4, v5
    v_max_f32 v6, v6, v7

    v_mov_b32 v5, v4
    v_mov_b32 v7, v6
    s_nop 0
    v_permlane16_swap_b32 v4, v5
    v_permlane16_swap_b32 v6, v7
    v_max_f32 v4, v4, v5
    v_max_f32 v6, v6, v7

    v_mul_f32 v4, s38, v4
    v_mul_f32 v6, s38, v6
    v_fma_f32 v168, v144, s38, -v4
    v_fma_f32 v169, v145, s38, -v4
    v_fma_f32 v170, v146, s38, -v4
    v_fma_f32 v171, v147, s38, -v4
    v_fma_f32 v176, v152, s38, -v4
    v_fma_f32 v177, v153, s38, -v4
    v_fma_f32 v178, v154, s38, -v4
    v_fma_f32 v179, v155, s38, -v4
    v_fma_f32 v192, v156, s38, -v6
    v_fma_f32 v193, v157, s38, -v6
    v_fma_f32 v194, v158, s38, -v6
    v_fma_f32 v195, v159, s38, -v6
    v_fma_f32 v196, v160, s38, -v6
    v_fma_f32 v197, v161, s38, -v6
    v_fma_f32 v198, v162, s38, -v6
    v_fma_f32 v199, v163, s38, -v6
    v_fma_f32 v200, v164, s38, -v6
    v_fma_f32 v201, v165, s38, -v6
    v_fma_f32 v202, v166, s38, -v6
    v_fma_f32 v203, v167, s38, -v6
    v_exp_f32 v168, v168
    v_exp_f32 v169, v169
    v_exp_f32 v170, v170
    v_exp_f32 v171, v171
    v_exp_f32 v176, v176
    v_exp_f32 v177, v177
    v_exp_f32 v178, v178
    v_exp_f32 v179, v179
    v_exp_f32 v192, v192
    v_exp_f32 v193, v193
    v_exp_f32 v194, v194
    v_exp_f32 v195, v195
    v_exp_f32 v196, v196
    v_exp_f32 v197, v197
    v_exp_f32 v198, v198
    v_exp_f32 v199, v199
    v_exp_f32 v200, v200
    v_exp_f32 v201, v201
    v_exp_f32 v202, v202
    v_exp_f32 v203, v203
    v_add_f32 v4, v168, v169
    v_add_f32 v5, v170, v171
    v_add_f32 v4, v4, v176
    v_add_f32 v5, v5, v177
    v_add_f32 v4, v4, v178
    v_add_f32 v5, v5, v179
    v_add_f32 v4, v4, v5
    v_add_f32 v6, v192, v193
    v_add_f32 v7, v194, v195
    v_add_f32 v6, v6, v196
    v_add_f32 v7, v7, v197
    v_add_f32 v6, v6, v198
    v_add_f32 v7, v7, v199
    v_add_f32 v6, v6, v200
    v_add_f32 v7, v7, v201
    v_add_f32 v6, v6, v202
    v_add_f32 v7, v7, v203
    v_add_f32 v6, v6, v7
    v_mov_b32 v5, v4
    v_mov_b32 v7, v6
    s_nop 0
    v_permlane32_swap_b32 v4, v5
    v_permlane32_swap_b32 v6, v7
    v_add_f32 v4, v4, v5
    v_add_f32 v6, v6, v7

    v_mov_b32 v5, v4
    v_mov_b32 v7, v6
    s_nop 0
    v_permlane16_swap_b32 v4, v5
    v_permlane16_swap_b32 v6, v7
    v_add_f32 v4, v4, v5
    v_add_f32 v6, v6, v7

    v_rcp_f32 v4, v4
    v_rcp_f32 v6, v6
    v_mov_b32 v182, 0
    v_mov_b32 v183, 0
    v_mul_f32 v168, v4, v168
    v_mul_f32 v169, v4, v169
    v_mul_f32 v170, v4, v170
    v_mul_f32 v171, v4, v171
    v_mul_f32 v176, v4, v176
    v_mul_f32 v177, v4, v177
    v_mul_f32 v178, v4, v178
    v_mul_f32 v179, v4, v179
    v_cvt_pk_bf16_f32 v180, v168, v169
    v_cvt_pk_bf16_f32 v181, v170, v171
    v_cvt_pk_bf16_f32 v184, v176, v177
    v_cvt_pk_bf16_f32 v185, v178, v179
    v_mul_f32 v192, v6, v192
    v_mul_f32 v193, v6, v193
    v_mul_f32 v194, v6, v194
    v_mul_f32 v195, v6, v195
    v_mul_f32 v196, v6, v196
    v_mul_f32 v197, v6, v197
    v_mul_f32 v198, v6, v198
    v_mul_f32 v199, v6, v199
    v_mul_f32 v200, v6, v200
    v_mul_f32 v201, v6, v201
    v_mul_f32 v202, v6, v202
    v_mul_f32 v203, v6, v203
    v_cvt_pk_bf16_f32 v186, v192, v193
    v_cvt_pk_bf16_f32 v187, v194, v195
    v_cvt_pk_bf16_f32 v188, v196, v197
    v_cvt_pk_bf16_f32 v189, v198, v199
    v_cvt_pk_bf16_f32 v190, v200, v201
    v_cvt_pk_bf16_f32 v191, v202, v203
    s_add_u32 s25, s25, 4

    v_mfma_f32_16x16x32_bf16 v[16:19], a[64:67], v[180:183], 0
    v_mfma_f32_16x16x32_bf16 v[20:23], a[68:71], v[180:183], 0
    v_mfma_f32_16x16x32_bf16 v[24:27], a[72:75], v[180:183], 0
    v_mfma_f32_16x16x32_bf16 v[28:31], a[76:79], v[180:183], 0
    v_mfma_f32_16x16x32_bf16 v[32:35], a[80:83], v[180:183], 0
    v_mfma_f32_16x16x32_bf16 v[36:39], a[84:87], v[180:183], 0
    v_mfma_f32_16x16x32_bf16 v[40:43], a[88:91], v[180:183], 0
    v_mfma_f32_16x16x32_bf16 v[44:47], a[92:95], v[180:183], 0
    v_mfma_f32_16x16x32_bf16 v[48:51], a[64:67], v[186:189], 0
    v_mfma_f32_16x16x32_bf16 v[52:55], a[68:71], v[186:189], 0
    v_mfma_f32_16x16x32_bf16 v[56:59], a[72:75], v[186:189], 0
    v_mfma_f32_16x16x32_bf16 v[60:63], a[76:79], v[186:189], 0
    v_mfma_f32_16x16x32_bf16 v[64:67], a[80:83], v[186:189], 0
    v_mfma_f32_16x16x32_bf16 v[68:71], a[84:87], v[186:189], 0
    v_mfma_f32_16x16x32_bf16 v[72:75], a[88:91], v[186:189], 0
    v_mfma_f32_16x16x32_bf16 v[76:79], a[92:95], v[186:189], 0
    s_waitcnt vmcnt(36)
    s_mov_b64 exec, 1
    buffer_store_dword v12, v13, s[8:11], s92 offen sc1
    s_mov_b64 exec, -1

    v_mfma_f32_16x16x16_bf16 v[16:19], v[128:129], v[184:185], v[16:19]
    v_mfma_f32_16x16x16_bf16 v[20:23], v[130:131], v[184:185], v[20:23]
    v_add_u32 v12, 1, v12
    v_mfma_f32_16x16x16_bf16 v[24:27], v[132:133], v[184:185], v[24:27]
    v_mfma_f32_16x16x16_bf16 v[28:31], v[134:135], v[184:185], v[28:31]
    v_mfma_f32_16x16x16_bf16 v[32:35], v[136:137], v[184:185], v[32:35]
    v_mfma_f32_16x16x16_bf16 v[36:39], v[138:139], v[184:185], v[36:39]
    v_cvt_pk_bf16_f32 v208, v16, v17
    v_cvt_pk_bf16_f32 v209, v18, v19
    v_cvt_pk_bf16_f32 v210, v20, v21
    v_cvt_pk_bf16_f32 v211, v22, v23
    buffer_store_dwordx4 v[208:211], v8, s[8:11], s50 offen offset:0 sc1
    v_mfma_f32_16x16x16_bf16 v[40:43], v[140:141], v[184:185], v[40:43]
    v_mfma_f32_16x16x16_bf16 v[44:47], v[142:143], v[184:185], v[44:47]
    v_cvt_pk_bf16_f32 v212, v24, v25
    v_cvt_pk_bf16_f32 v213, v26, v27
    v_cvt_pk_bf16_f32 v214, v28, v29
    v_cvt_pk_bf16_f32 v215, v30, v31
    buffer_store_dwordx4 v[212:215], v8, s[8:11], s50 offen offset:1024 sc1
    v_mfma_f32_16x16x16_bf16 v[48:51], v[128:129], v[190:191], v[48:51]
    v_mfma_f32_16x16x16_bf16 v[52:55], v[130:131], v[190:191], v[52:55]
    v_cvt_pk_bf16_f32 v216, v32, v33
    v_cvt_pk_bf16_f32 v217, v34, v35
    v_cvt_pk_bf16_f32 v218, v36, v37
    v_cvt_pk_bf16_f32 v219, v38, v39
    buffer_store_dwordx4 v[216:219], v8, s[8:11], s50 offen offset:2048 sc1
    v_mfma_f32_16x16x16_bf16 v[56:59], v[132:133], v[190:191], v[56:59]
    v_mfma_f32_16x16x16_bf16 v[60:63], v[134:135], v[190:191], v[60:63]
    v_cvt_pk_bf16_f32 v220, v40, v41
    v_cvt_pk_bf16_f32 v221, v42, v43
    v_cvt_pk_bf16_f32 v222, v44, v45
    v_cvt_pk_bf16_f32 v223, v46, v47
    buffer_store_dwordx4 v[220:223], v8, s[8:11], s50 offen offset:3072 sc1
    v_mfma_f32_16x16x16_bf16 v[64:67], v[136:137], v[190:191], v[64:67]
    v_mfma_f32_16x16x16_bf16 v[68:71], v[138:139], v[190:191], v[68:71]
    v_cvt_pk_bf16_f32 v224, v48, v49
    v_cvt_pk_bf16_f32 v225, v50, v51
    v_cvt_pk_bf16_f32 v226, v52, v53
    v_cvt_pk_bf16_f32 v227, v54, v55
    buffer_store_dwordx4 v[224:227], v8, s[8:11], s51 offen offset:0 sc1
    v_mfma_f32_16x16x16_bf16 v[72:75], v[140:141], v[190:191], v[72:75]
    v_mfma_f32_16x16x16_bf16 v[76:79], v[142:143], v[190:191], v[76:79]
    v_cvt_pk_bf16_f32 v228, v56, v57
    v_cvt_pk_bf16_f32 v229, v58, v59
    v_cvt_pk_bf16_f32 v230, v60, v61
    v_cvt_pk_bf16_f32 v231, v62, v63
    buffer_store_dwordx4 v[228:231], v8, s[8:11], s51 offen offset:1024 sc1
    s_nop 3
    v_cvt_pk_bf16_f32 v232, v64, v65
    v_cvt_pk_bf16_f32 v233, v66, v67
    v_cvt_pk_bf16_f32 v234, v68, v69
    v_cvt_pk_bf16_f32 v235, v70, v71
    buffer_store_dwordx4 v[232:235], v8, s[8:11], s51 offen offset:2048 sc1
    v_cvt_pk_bf16_f32 v236, v72, v73
    v_cvt_pk_bf16_f32 v237, v74, v75
    v_cvt_pk_bf16_f32 v238, v76, v77
    v_cvt_pk_bf16_f32 v239, v78, v79
    buffer_store_dwordx4 v[236:239], v8, s[8:11], s51 offen offset:3072 sc1
    s_mov_b32 s34, s33
    s_add_u32 s50, s27, 50331648
    s_add_u32 s51, s27, 50335744
    s_cmp_lt_u32 s25, 60
    s_cselect_b32 s4, 4, 0
    s_cselect_b32 s5, 1048576, 0
    s_cselect_b32 s6, 786432, 0
    s_add_u32 s36, s36, s4
    s_add_u32 s27, s27, s5
    s_add_u32 s33, s33, s6
    s_waitcnt vmcnt(8)

    v_cmp_gt_u32 vcc, s36, v15
    s_cbranch_vccnz .atw_438
.atb_439:
    s_add_u32 s28, s27, 4096
    s_add_u32 s29, s27, 16777216
    s_add_u32 s30, s27, 16781312
    s_add_u32 s31, s27, 33554432
    s_add_u32 s32, s27, 33558528

    buffer_load_dwordx4 a[0:3], v8, s[8:11], s27 offen offset:0
    buffer_load_dwordx4 a[16:19], v8, s[8:11], s28 offen offset:0
    buffer_load_dwordx4 a[32:35], v8, s[8:11], s29 offen offset:0
    buffer_load_dwordx4 a[48:51], v8, s[8:11], s30 offen offset:0
    buffer_load_dwordx4 a[4:7], v8, s[8:11], s27 offen offset:1024
    buffer_load_dwordx4 a[20:23], v8, s[8:11], s28 offen offset:1024
    buffer_load_dwordx4 a[36:39], v8, s[8:11], s29 offen offset:1024
    buffer_load_dwordx4 a[52:55], v8, s[8:11], s30 offen offset:1024
    buffer_load_dwordx4 a[8:11], v8, s[8:11], s27 offen offset:2048
    buffer_load_dwordx4 a[24:27], v8, s[8:11], s28 offen offset:2048
    buffer_load_dwordx4 a[40:43], v8, s[8:11], s29 offen offset:2048
    buffer_load_dwordx4 a[56:59], v8, s[8:11], s30 offen offset:2048
    buffer_load_dwordx4 a[12:15], v8, s[8:11], s27 offen offset:3072
    buffer_load_dwordx4 a[28:31], v8, s[8:11], s28 offen offset:3072
    buffer_load_dwordx4 a[44:47], v8, s[8:11], s29 offen offset:3072
    buffer_load_dwordx4 a[60:63], v8, s[8:11], s30 offen offset:3072
    buffer_load_dwordx4 a[64:67], v8, s[8:11], s31 offen offset:0
    buffer_load_dwordx4 a[68:71], v8, s[8:11], s31 offen offset:1024
    buffer_load_dwordx4 a[72:75], v8, s[8:11], s31 offen offset:2048
    buffer_load_dwordx4 a[76:79], v8, s[8:11], s31 offen offset:3072
    buffer_load_dwordx4 a[80:83], v8, s[8:11], s32 offen offset:0
    buffer_load_dwordx4 a[84:87], v8, s[8:11], s32 offen offset:1024
    buffer_load_dwordx4 a[88:91], v8, s[8:11], s32 offen offset:2048
    buffer_load_dwordx4 a[92:95], v8, s[8:11], s32 offen offset:3072
    buffer_load_dwordx4 v[80:83], v10, s[8:11], s33 offen offset:2048 sc1
    buffer_load_dwordx4 v[84:87], v10, s[8:11], s33 offen offset:2176 sc1
    buffer_load_dwordx4 v[88:91], v10, s[8:11], s33 offen offset:3072 sc1
    buffer_load_dwordx4 v[92:95], v10, s[8:11], s33 offen offset:3200 sc1
    s_add_u32 s4, s33, 4096
    s_mov_b64 exec, s[60:61]
    buffer_load_dwordx2 v[128:129], v11, s[8:11], s4 offen offset:0 sc1
    buffer_load_dwordx2 v[130:131], v11, s[8:11], s4 offen offset:256 sc1
    buffer_load_dwordx2 v[132:133], v11, s[8:11], s4 offen offset:512 sc1
    buffer_load_dwordx2 v[134:135], v11, s[8:11], s4 offen offset:768 sc1
    buffer_load_dwordx2 v[136:137], v11, s[8:11], s4 offen offset:1024 sc1
    buffer_load_dwordx2 v[138:139], v11, s[8:11], s4 offen offset:1280 sc1
    buffer_load_dwordx2 v[140:141], v11, s[8:11], s4 offen offset:1536 sc1
    buffer_load_dwordx2 v[142:143], v11, s[8:11], s4 offen offset:1792 sc1
    s_mov_b64 exec, -1
    v_mfma_f32_16x16x32_bf16 v[144:147], a[128:131], a[96:99], 0
    v_mfma_f32_16x16x32_bf16 v[156:159], a[128:131], a[112:115], 0
    v_mfma_f32_16x16x32_bf16 v[160:163], a[144:147], a[112:115], 0
    v_mfma_f32_16x16x32_bf16 v[144:147], a[132:135], a[100:103], v[144:147]
    v_mfma_f32_16x16x32_bf16 v[156:159], a[132:135], a[116:119], v[156:159]
    v_mfma_f32_16x16x32_bf16 v[160:163], a[148:151], a[116:119], v[160:163]
    v_mfma_f32_16x16x32_bf16 v[144:147], a[136:139], a[104:107], v[144:147]
    v_mfma_f32_16x16x32_bf16 v[156:159], a[136:139], a[120:123], v[156:159]
    v_mfma_f32_16x16x32_bf16 v[160:163], a[152:155], a[120:123], v[160:163]
    v_mfma_f32_16x16x32_bf16 v[144:147], a[140:143], a[108:111], v[144:147]
    v_mfma_f32_16x16x32_bf16 v[156:159], a[140:143], a[124:127], v[156:159]
    v_mfma_f32_16x16x32_bf16 v[160:163], a[156:159], a[124:127], v[160:163]
    s_nop 7
    v_cvt_pk_bf16_f32 v168, v144, v145
    v_cvt_pk_bf16_f32 v170, v146, v147
    v_and_b32 v169, 0xffff0000, v168
    v_lshlrev_b32 v168, 16, v168
    v_and_b32 v171, 0xffff0000, v170
    v_lshlrev_b32 v170, 16, v170
    v_mul_f32 v168, s37, v168
    v_mul_f32 v169, s37, v169
    v_mul_f32 v170, s37, v170
    v_mul_f32 v171, s37, v171
    v_cvt_pk_bf16_f32 v144, v168, v169
    v_cvt_pk_bf16_f32 v146, v170, v171
    v_and_b32 v145, 0xffff0000, v144
    v_lshlrev_b32 v144, 16, v144
    v_and_b32 v147, 0xffff0000, v146
    v_lshlrev_b32 v146, 16, v146
    v_cvt_pk_bf16_f32 v192, v156, v157
    v_cvt_pk_bf16_f32 v194, v158, v159
    v_cvt_pk_bf16_f32 v196, v160, v161
    v_cvt_pk_bf16_f32 v198, v162, v163
    v_and_b32 v193, 0xffff0000, v192
    v_lshlrev_b32 v192, 16, v192
    v_and_b32 v195, 0xffff0000, v194
    v_lshlrev_b32 v194, 16, v194
    v_and_b32 v197, 0xffff0000, v196
    v_lshlrev_b32 v196, 16, v196
    v_and_b32 v199, 0xffff0000, v198
    v_lshlrev_b32 v198, 16, v198
    v_mul_f32 v192, s37, v192
    v_mul_f32 v193, s37, v193
    v_mul_f32 v194, s37, v194
    v_mul_f32 v195, s37, v195
    v_mul_f32 v196, s37, v196
    v_mul_f32 v197, s37, v197
    v_mul_f32 v198, s37, v198
    v_mul_f32 v199, s37, v199
    v_cvt_pk_bf16_f32 v156, v192, v193
    v_cvt_pk_bf16_f32 v158, v194, v195
    v_cvt_pk_bf16_f32 v160, v196, v197
    v_cvt_pk_bf16_f32 v162, v198, v199
    v_and_b32 v157, 0xffff0000, v156
    v_lshlrev_b32 v156, 16, v156
    v_and_b32 v159, 0xffff0000, v158
    v_lshlrev_b32 v158, 16, v158
    v_and_b32 v161, 0xffff0000, v160
    v_lshlrev_b32 v160, 16, v160
    v_and_b32 v163, 0xffff0000, v162
    v_lshlrev_b32 v162, 16, v162
    v_cndmask_b32 v144, v14, v144, s[40:41]
    v_cndmask_b32 v145, v14, v145, s[42:43]
    v_cndmask_b32 v146, v14, v146, s[44:45]
    v_cndmask_b32 v147, v14, v147, s[46:47]
    v_cndmask_b32 v160, v14, v160, s[40:41]
    v_cndmask_b32 v161, v14, v161, s[42:43]
    v_cndmask_b32 v162, v14, v162, s[44:45]
    v_cndmask_b32 v163, v14, v163, s[46:47]
    s_mov_b32 s62, 0
.kmp_440:
    v_max3_u32 v4, v96, v97, v98
    v_max3_u32 v5, v99, v100, v101
    v_max3_u32 v4, v4, v102, v103
    v_max3_u32 v5, v5, v104, v105
    v_max3_u32 v4, v4, v106, v107
    v_max3_u32 v5, v5, v108, v109
    v_max3_u32 v4, v4, v110, v111
    v_max3_u32 v5, v5, v112, v113
    v_max3_u32 v4, v4, v114, v115
    v_max3_u32 v5, v5, v116, v117
    v_max3_u32 v4, v4, v118, v119
    v_max3_u32 v5, v5, v120, v121
    v_max3_u32 v4, v4, v122, v123
    v_max3_u32 v5, v5, v124, v125
    v_max3_u32 v4, v4, v126, v127
    v_max_u32 v4, v4, v5
    v_cmp_eq_u32 vcc, -1, v4
    s_cbranch_vccnz .kmf_441

    v_mfma_f32_16x16x32_bf16 v[152:155], v[96:99], a[96:99], 0
    v_mfma_f32_16x16x32_bf16 v[164:167], v[96:99], a[112:115], 0
    v_mfma_f32_16x16x32_bf16 v[152:155], v[100:103], a[100:103], v[152:155]
    v_mfma_f32_16x16x32_bf16 v[164:167], v[100:103], a[116:119], v[164:167]
    v_mfma_f32_16x16x32_bf16 v[152:155], v[104:107], a[104:107], v[152:155]
    v_mfma_f32_16x16x32_bf16 v[164:167], v[104:107], a[120:123], v[164:167]
    v_mfma_f32_16x16x32_bf16 v[152:155], v[108:111], a[108:111], v[152:155]
    v_mfma_f32_16x16x32_bf16 v[164:167], v[108:111], a[124:127], v[164:167]
    s_nop 5
    v_cvt_pk_bf16_f32 v176, v152, v153
    v_cvt_pk_bf16_f32 v178, v154, v155
    v_and_b32 v177, 0xffff0000, v176
    v_lshlrev_b32 v176, 16, v176
    v_and_b32 v179, 0xffff0000, v178
    v_lshlrev_b32 v178, 16, v178
    v_mul_f32 v176, s37, v176
    v_mul_f32 v177, s37, v177
    v_mul_f32 v178, s37, v178
    v_mul_f32 v179, s37, v179
    v_cvt_pk_bf16_f32 v152, v176, v177
    v_cvt_pk_bf16_f32 v154, v178, v179
    v_and_b32 v153, 0xffff0000, v152
    v_lshlrev_b32 v152, 16, v152
    v_and_b32 v155, 0xffff0000, v154
    v_lshlrev_b32 v154, 16, v154
    v_cndmask_b32 v152, v14, v152, s[60:61]
    v_cndmask_b32 v153, v14, v153, s[60:61]
    v_cndmask_b32 v154, v14, v154, s[60:61]
    v_cndmask_b32 v155, v14, v155, s[60:61]
    v_cvt_pk_bf16_f32 v200, v164, v165
    v_cvt_pk_bf16_f32 v202, v166, v167
    v_and_b32 v201, 0xffff0000, v200
    v_lshlrev_b32 v200, 16, v200
    v_and_b32 v203, 0xffff0000, v202
    v_lshlrev_b32 v202, 16, v202
    v_mul_f32 v200, s37, v200
    v_mul_f32 v201, s37, v201
    v_mul_f32 v202, s37, v202
    v_mul_f32 v203, s37, v203
    v_cvt_pk_bf16_f32 v164, v200, v201
    v_cvt_pk_bf16_f32 v166, v202, v203
    v_and_b32 v165, 0xffff0000, v164
    v_lshlrev_b32 v164, 16, v164
    v_and_b32 v167, 0xffff0000, v166
    v_lshlrev_b32 v166, 16, v166
    v_cndmask_b32 v164, v14, v164, s[60:61]
    v_cndmask_b32 v165, v14, v165, s[60:61]
    v_cndmask_b32 v166, v14, v166, s[60:61]
    v_cndmask_b32 v167, v14, v167, s[60:61]
    v_max3_f32 v4, v144, v145, v146
    v_max3_f32 v5, v147, v152, v153
    v_max3_f32 v4, v4, v154, v155
    v_max_f32 v4, v4, v5

    v_max3_f32 v6, v156, v157, v158
    v_max3_f32 v7, v159, v160, v161
    v_max3_f32 v6, v6, v162, v163
    v_max3_f32 v7, v7, v164, v165
    v_max3_f32 v6, v6, v166, v167
    v_max_f32 v6, v6, v7

    v_mov_b32 v5, v4
    v_mov_b32 v7, v6
    s_nop 0
    v_permlane32_swap_b32 v4, v5
    v_permlane32_swap_b32 v6, v7
    v_max_f32 v4, v4, v5
    v_max_f32 v6, v6, v7

    v_mov_b32 v5, v4
    v_mov_b32 v7, v6
    s_nop 0
    v_permlane16_swap_b32 v4, v5
    v_permlane16_swap_b32 v6, v7
    v_max_f32 v4, v4, v5
    v_max_f32 v6, v6, v7

    v_mul_f32 v4, s38, v4
    v_mul_f32 v6, s38, v6
    v_fma_f32 v168, v144, s38, -v4
    v_fma_f32 v169, v145, s38, -v4
    v_fma_f32 v170, v146, s38, -v4
    v_fma_f32 v171, v147, s38, -v4
    v_fma_f32 v176, v152, s38, -v4
    v_fma_f32 v177, v153, s38, -v4
    v_fma_f32 v178, v154, s38, -v4
    v_fma_f32 v179, v155, s38, -v4
    v_fma_f32 v192, v156, s38, -v6
    v_fma_f32 v193, v157, s38, -v6
    v_fma_f32 v194, v158, s38, -v6
    v_fma_f32 v195, v159, s38, -v6
    v_fma_f32 v196, v160, s38, -v6
    v_fma_f32 v197, v161, s38, -v6
    v_fma_f32 v198, v162, s38, -v6
    v_fma_f32 v199, v163, s38, -v6
    v_fma_f32 v200, v164, s38, -v6
    v_fma_f32 v201, v165, s38, -v6
    v_fma_f32 v202, v166, s38, -v6
    v_fma_f32 v203, v167, s38, -v6
    v_exp_f32 v168, v168
    v_exp_f32 v169, v169
    v_exp_f32 v170, v170
    v_exp_f32 v171, v171
    v_exp_f32 v176, v176
    v_exp_f32 v177, v177
    v_exp_f32 v178, v178
    v_exp_f32 v179, v179
    v_exp_f32 v192, v192
    v_exp_f32 v193, v193
    v_exp_f32 v194, v194
    v_exp_f32 v195, v195
    v_exp_f32 v196, v196
    v_exp_f32 v197, v197
    v_exp_f32 v198, v198
    v_exp_f32 v199, v199
    v_exp_f32 v200, v200
    v_exp_f32 v201, v201
    v_exp_f32 v202, v202
    v_exp_f32 v203, v203
    v_add_f32 v4, v168, v169
    v_add_f32 v5, v170, v171
    v_add_f32 v4, v4, v176
    v_add_f32 v5, v5, v177
    v_add_f32 v4, v4, v178
    v_add_f32 v5, v5, v179
    v_add_f32 v4, v4, v5
    v_add_f32 v6, v192, v193
    v_add_f32 v7, v194, v195
    v_add_f32 v6, v6, v196
    v_add_f32 v7, v7, v197
    v_add_f32 v6, v6, v198
    v_add_f32 v7, v7, v199
    v_add_f32 v6, v6, v200
    v_add_f32 v7, v7, v201
    v_add_f32 v6, v6, v202
    v_add_f32 v7, v7, v203
    v_add_f32 v6, v6, v7
    v_mov_b32 v5, v4
    v_mov_b32 v7, v6
    s_nop 0
    v_permlane32_swap_b32 v4, v5
    v_permlane32_swap_b32 v6, v7
    v_add_f32 v4, v4, v5
    v_add_f32 v6, v6, v7

    v_mov_b32 v5, v4
    v_mov_b32 v7, v6
    s_nop 0
    v_permlane16_swap_b32 v4, v5
    v_permlane16_swap_b32 v6, v7
    v_add_f32 v4, v4, v5
    v_add_f32 v6, v6, v7

    v_rcp_f32 v4, v4
    v_rcp_f32 v6, v6
    v_mov_b32 v182, 0
    v_mov_b32 v183, 0
    v_mul_f32 v168, v4, v168
    v_mul_f32 v169, v4, v169
    v_mul_f32 v170, v4, v170
    v_mul_f32 v171, v4, v171
    v_mul_f32 v176, v4, v176
    v_mul_f32 v177, v4, v177
    v_mul_f32 v178, v4, v178
    v_mul_f32 v179, v4, v179
    v_cvt_pk_bf16_f32 v180, v168, v169
    v_cvt_pk_bf16_f32 v181, v170, v171
    v_cvt_pk_bf16_f32 v184, v176, v177
    v_cvt_pk_bf16_f32 v185, v178, v179
    v_mul_f32 v192, v6, v192
    v_mul_f32 v193, v6, v193
    v_mul_f32 v194, v6, v194
    v_mul_f32 v195, v6, v195
    v_mul_f32 v196, v6, v196
    v_mul_f32 v197, v6, v197
    v_mul_f32 v198, v6, v198
    v_mul_f32 v199, v6, v199
    v_mul_f32 v200, v6, v200
    v_mul_f32 v201, v6, v201
    v_mul_f32 v202, v6, v202
    v_mul_f32 v203, v6, v203
    v_cvt_pk_bf16_f32 v186, v192, v193
    v_cvt_pk_bf16_f32 v187, v194, v195
    v_cvt_pk_bf16_f32 v188, v196, v197
    v_cvt_pk_bf16_f32 v189, v198, v199
    v_cvt_pk_bf16_f32 v190, v200, v201
    v_cvt_pk_bf16_f32 v191, v202, v203
    s_add_u32 s25, s25, 4

    v_mfma_f32_16x16x32_bf16 v[16:19], a[160:163], v[180:183], 0
    v_mfma_f32_16x16x32_bf16 v[20:23], a[164:167], v[180:183], 0
    v_mfma_f32_16x16x32_bf16 v[24:27], a[168:171], v[180:183], 0
    v_mfma_f32_16x16x32_bf16 v[28:31], a[172:175], v[180:183], 0
    v_mfma_f32_16x16x32_bf16 v[32:35], a[176:179], v[180:183], 0
    v_mfma_f32_16x16x32_bf16 v[36:39], a[180:183], v[180:183], 0
    v_mfma_f32_16x16x32_bf16 v[40:43], a[184:187], v[180:183], 0
    v_mfma_f32_16x16x32_bf16 v[44:47], a[188:191], v[180:183], 0
    v_mfma_f32_16x16x32_bf16 v[48:51], a[160:163], v[186:189], 0
    v_mfma_f32_16x16x32_bf16 v[52:55], a[164:167], v[186:189], 0
    v_mfma_f32_16x16x32_bf16 v[56:59], a[168:171], v[186:189], 0
    v_mfma_f32_16x16x32_bf16 v[60:63], a[172:175], v[186:189], 0
    v_mfma_f32_16x16x32_bf16 v[64:67], a[176:179], v[186:189], 0
    v_mfma_f32_16x16x32_bf16 v[68:71], a[180:183], v[186:189], 0
    v_mfma_f32_16x16x32_bf16 v[72:75], a[184:187], v[186:189], 0
    v_mfma_f32_16x16x32_bf16 v[76:79], a[188:191], v[186:189], 0
    s_waitcnt vmcnt(36)
    s_mov_b64 exec, 1
    buffer_store_dword v12, v13, s[8:11], s92 offen sc1
    s_mov_b64 exec, -1

    v_mfma_f32_16x16x16_bf16 v[16:19], v[112:113], v[184:185], v[16:19]
    v_mfma_f32_16x16x16_bf16 v[20:23], v[114:115], v[184:185], v[20:23]
    v_add_u32 v12, 1, v12
    v_mfma_f32_16x16x16_bf16 v[24:27], v[116:117], v[184:185], v[24:27]
    v_mfma_f32_16x16x16_bf16 v[28:31], v[118:119], v[184:185], v[28:31]
    v_mfma_f32_16x16x16_bf16 v[32:35], v[120:121], v[184:185], v[32:35]
    v_mfma_f32_16x16x16_bf16 v[36:39], v[122:123], v[184:185], v[36:39]
    v_cvt_pk_bf16_f32 v208, v16, v17
    v_cvt_pk_bf16_f32 v209, v18, v19
    v_cvt_pk_bf16_f32 v210, v20, v21
    v_cvt_pk_bf16_f32 v211, v22, v23
    buffer_store_dwordx4 v[208:211], v8, s[8:11], s50 offen offset:0 sc1
    v_mfma_f32_16x16x16_bf16 v[40:43], v[124:125], v[184:185], v[40:43]
    v_mfma_f32_16x16x16_bf16 v[44:47], v[126:127], v[184:185], v[44:47]
    v_cvt_pk_bf16_f32 v212, v24, v25
    v_cvt_pk_bf16_f32 v213, v26, v27
    v_cvt_pk_bf16_f32 v214, v28, v29
    v_cvt_pk_bf16_f32 v215, v30, v31
    buffer_store_dwordx4 v[212:215], v8, s[8:11], s50 offen offset:1024 sc1
    v_mfma_f32_16x16x16_bf16 v[48:51], v[112:113], v[190:191], v[48:51]
    v_mfma_f32_16x16x16_bf16 v[52:55], v[114:115], v[190:191], v[52:55]
    v_cvt_pk_bf16_f32 v216, v32, v33
    v_cvt_pk_bf16_f32 v217, v34, v35
    v_cvt_pk_bf16_f32 v218, v36, v37
    v_cvt_pk_bf16_f32 v219, v38, v39
    buffer_store_dwordx4 v[216:219], v8, s[8:11], s50 offen offset:2048 sc1
    v_mfma_f32_16x16x16_bf16 v[56:59], v[116:117], v[190:191], v[56:59]
    v_mfma_f32_16x16x16_bf16 v[60:63], v[118:119], v[190:191], v[60:63]
    v_cvt_pk_bf16_f32 v220, v40, v41
    v_cvt_pk_bf16_f32 v221, v42, v43
    v_cvt_pk_bf16_f32 v222, v44, v45
    v_cvt_pk_bf16_f32 v223, v46, v47
    buffer_store_dwordx4 v[220:223], v8, s[8:11], s50 offen offset:3072 sc1
    v_mfma_f32_16x16x16_bf16 v[64:67], v[120:121], v[190:191], v[64:67]
    v_mfma_f32_16x16x16_bf16 v[68:71], v[122:123], v[190:191], v[68:71]
    v_cvt_pk_bf16_f32 v224, v48, v49
    v_cvt_pk_bf16_f32 v225, v50, v51
    v_cvt_pk_bf16_f32 v226, v52, v53
    v_cvt_pk_bf16_f32 v227, v54, v55
    buffer_store_dwordx4 v[224:227], v8, s[8:11], s51 offen offset:0 sc1
    v_mfma_f32_16x16x16_bf16 v[72:75], v[124:125], v[190:191], v[72:75]
    v_mfma_f32_16x16x16_bf16 v[76:79], v[126:127], v[190:191], v[76:79]
    v_cvt_pk_bf16_f32 v228, v56, v57
    v_cvt_pk_bf16_f32 v229, v58, v59
    v_cvt_pk_bf16_f32 v230, v60, v61
    v_cvt_pk_bf16_f32 v231, v62, v63
    buffer_store_dwordx4 v[228:231], v8, s[8:11], s51 offen offset:1024 sc1
    s_nop 3
    v_cvt_pk_bf16_f32 v232, v64, v65
    v_cvt_pk_bf16_f32 v233, v66, v67
    v_cvt_pk_bf16_f32 v234, v68, v69
    v_cvt_pk_bf16_f32 v235, v70, v71
    buffer_store_dwordx4 v[232:235], v8, s[8:11], s51 offen offset:2048 sc1
    v_cvt_pk_bf16_f32 v236, v72, v73
    v_cvt_pk_bf16_f32 v237, v74, v75
    v_cvt_pk_bf16_f32 v238, v76, v77
    v_cvt_pk_bf16_f32 v239, v78, v79
    buffer_store_dwordx4 v[236:239], v8, s[8:11], s51 offen offset:3072 sc1
    s_cmp_lt_u32 s25, 64
    s_cbranch_scc1 .att_433
    s_waitcnt vmcnt(0)

    s_mov_b64 exec, 1
    buffer_store_dword v12, v13, s[8:11], s92 offen sc1
    s_mov_b64 exec, -1

    s_branch .ate_442
.atw_434:
    s_mov_b32 s62, 0
    s_mov_b64 exec, 7
.wf_443:
    buffer_load_dword v15, v9, s[8:11], s35 offen sc1
    s_waitcnt vmcnt(0)
    v_cmp_gt_u32 vcc, s36, v15
    s_cbranch_vccz .wfd_444
    s_sleep 2
    s_add_u32 s62, s62, 1
    s_cmp_gt_u32 s62, 0x400000
    s_cbranch_scc1 .mg_end_1
    s_branch .wf_443

.wfd_444:
    s_mov_b64 exec, -1
    s_branch .atb_435
.kmf_437:
    s_cmp_lg_u32 s62, 0
    s_cbranch_scc1 .kmn_445
    s_waitcnt vmcnt(36)
    s_mov_b64 exec, 1
    buffer_store_dword v12, v13, s[8:11], s92 offen sc1
    s_mov_b64 exec, -1

    s_cmp_lt_u32 s25, 60
    s_cselect_b32 s5, 0, 196608
    s_sub_u32 s5, s34, s5
    s_mov_b64 exec, 15

.kml_446:
    s_sleep 4
    buffer_load_dword v4, v204, s[8:11], s5 offen sc1
    s_add_u32 s62, s62, 1
    s_cmp_gt_u32 s62, 0x200000
    s_cbranch_scc1 .mg_end_1
    s_waitcnt vmcnt(0)
    v_cmp_eq_u32 vcc, -1, v4
    s_cbranch_vccnz .kml_446
    s_mov_b64 exec, -1

.kmn_445:
    s_sleep 1
    buffer_load_dwordx4 v[80:83], v10, s[8:11], s34 offen offset:2048 sc1
    buffer_load_dwordx4 v[84:87], v10, s[8:11], s34 offen offset:2176 sc1
    buffer_load_dwordx4 v[88:91], v10, s[8:11], s34 offen offset:3072 sc1
    buffer_load_dwordx4 v[92:95], v10, s[8:11], s34 offen offset:3200 sc1
    s_add_u32 s4, s34, 4096
    s_mov_b64 exec, s[60:61]
    buffer_load_dwordx2 v[128:129], v11, s[8:11], s4 offen offset:0 sc1
    buffer_load_dwordx2 v[130:131], v11, s[8:11], s4 offen offset:256 sc1
    buffer_load_dwordx2 v[132:133], v11, s[8:11], s4 offen offset:512 sc1
    buffer_load_dwordx2 v[134:135], v11, s[8:11], s4 offen offset:768 sc1
    buffer_load_dwordx2 v[136:137], v11, s[8:11], s4 offen offset:1024 sc1
    buffer_load_dwordx2 v[138:139], v11, s[8:11], s4 offen offset:1280 sc1
    buffer_load_dwordx2 v[140:141], v11, s[8:11], s4 offen offset:1536 sc1
    buffer_load_dwordx2 v[142:143], v11, s[8:11], s4 offen offset:1792 sc1
    s_mov_b64 exec, -1
    s_add_u32 s62, s62, 1
    s_cmp_gt_u32 s62, 0x200000
    s_cbranch_scc1 .mg_end_1
    s_waitcnt vmcnt(0)
    s_branch .kmp_436

.atw_438:
    s_mov_b32 s62, 0
    s_mov_b64 exec, 7
.wf_447:
    buffer_load_dword v15, v9, s[8:11], s35 offen sc1
    s_waitcnt vmcnt(0)
    v_cmp_gt_u32 vcc, s36, v15
    s_cbranch_vccz .wfd_448
    s_sleep 2
    s_add_u32 s62, s62, 1
    s_cmp_gt_u32 s62, 0x400000
    s_cbranch_scc1 .mg_end_1
    s_branch .wf_447

.wfd_448:
    s_mov_b64 exec, -1
    s_branch .atb_439
.kmf_441:
    s_cmp_lg_u32 s62, 0
    s_cbranch_scc1 .kmn_449
    s_waitcnt vmcnt(36)
    s_mov_b64 exec, 1
    buffer_store_dword v12, v13, s[8:11], s92 offen sc1
    s_mov_b64 exec, -1

    s_cmp_lt_u32 s25, 60
    s_cselect_b32 s5, 0, 196608
    s_sub_u32 s5, s34, s5
    s_mov_b64 exec, 15

.kml_450:
    s_sleep 4
    buffer_load_dword v4, v204, s[8:11], s5 offen sc1
    s_add_u32 s62, s62, 1
    s_cmp_gt_u32 s62, 0x200000
    s_cbranch_scc1 .mg_end_1
    s_waitcnt vmcnt(0)
    v_cmp_eq_u32 vcc, -1, v4
    s_cbranch_vccnz .kml_450
    s_mov_b64 exec, -1

.kmn_449:
    s_sleep 1
    buffer_load_dwordx4 v[96:99], v10, s[8:11], s34 offen offset:2048 sc1
    buffer_load_dwordx4 v[100:103], v10, s[8:11], s34 offen offset:2176 sc1
    buffer_load_dwordx4 v[104:107], v10, s[8:11], s34 offen offset:3072 sc1
    buffer_load_dwordx4 v[108:111], v10, s[8:11], s34 offen offset:3200 sc1
    s_add_u32 s4, s34, 4096
    s_mov_b64 exec, s[60:61]
    buffer_load_dwordx2 v[112:113], v11, s[8:11], s4 offen offset:0 sc1
    buffer_load_dwordx2 v[114:115], v11, s[8:11], s4 offen offset:256 sc1
    buffer_load_dwordx2 v[116:117], v11, s[8:11], s4 offen offset:512 sc1
    buffer_load_dwordx2 v[118:119], v11, s[8:11], s4 offen offset:768 sc1
    buffer_load_dwordx2 v[120:121], v11, s[8:11], s4 offen offset:1024 sc1
    buffer_load_dwordx2 v[122:123], v11, s[8:11], s4 offen offset:1280 sc1
    buffer_load_dwordx2 v[124:125], v11, s[8:11], s4 offen offset:1536 sc1
    buffer_load_dwordx2 v[126:127], v11, s[8:11], s4 offen offset:1792 sc1
    s_mov_b64 exec, -1
    s_add_u32 s62, s62, 1
    s_cmp_gt_u32 s62, 0x200000
    s_cbranch_scc1 .mg_end_1
    s_waitcnt vmcnt(0)
    s_branch .kmp_440

.ate_442:
.mg_end_1:
    s_endpgm
.section .rodata,"a"
.p2align 6
.amdhsa_kernel mega_kernel
  .amdhsa_next_free_vgpr 512
  .amdhsa_next_free_sgpr 102
  .amdhsa_accum_offset 256
  .amdhsa_group_segment_fixed_size 0
  .amdhsa_kernarg_size 136
  .amdhsa_user_sgpr_count 2
  .amdhsa_user_sgpr_kernarg_segment_ptr 1
  .amdhsa_system_sgpr_workgroup_id_x 1
.end_amdhsa_kernel
```

```asm
; @launch kernel=mega_kernel grid=(256,1,1) block=(256,1,1) lds=163840
.amdgcn_target "amdgcn-amd-amdhsa--gfx950"
.text
.globl mega_kernel
.p2align 8
.type mega_kernel,@function
mega_kernel:
    s_cmp_ge_u32 s2, 256
    s_cbranch_scc1 .mg_end_1

    s_load_dwordx4 s[52:55], s[0:1], 120
    s_load_dwordx2 s[40:41], s[0:1], 56
    s_getreg_b32 s3, hwreg(HW_REG_XCC_ID)
    v_and_b32 v1, 63, v0
    v_lshrrev_b32 v4, 6, v0
    s_and_b32 s3, s3, 7
    v_readfirstlane_b32 s24, v4
    s_waitcnt lgkmcnt(0)

    s_mov_b32 s8, s54
    s_and_b32 s9, s55, 0xffff
    s_mov_b32 s10, 0x10000000
    s_mov_b32 s11, 0x00020000

    s_mov_b32 s20, s52
    s_and_b32 s21, s53, 0xffff
    s_mov_b32 s22, 0x100
    s_mov_b32 s23, 0x00020000

    s_mov_b32 s100, s54
    s_cmp_lg_u32 s24, 0
    s_cbranch_scc1 .noat_4
    s_mov_b64 exec, 1
    v_mov_b32 v5, 1
    s_lshl_b32 s4, s3, 2
    v_mov_b32 v6, s4
    buffer_atomic_add v5, v6, s[20:23], 0 offen sc0 sc1
    v_mov_b32 v7, 163776
    s_waitcnt vmcnt(0)
    ds_write_b32 v7, v5
    v_cmp_lt_u32 vcc, 31, v5
    s_cbranch_vccz .nb_5
    v_mov_b32 v6, 136
    buffer_store_dword v7, v6, s[20:23], 0 offen sc1

.nb_5:
    s_waitcnt lgkmcnt(0)
    s_mov_b64 exec, -1

.noat_4:
    s_barrier
    v_mov_b32 v7, 163776
    ds_read_b32 v5, v7
    s_waitcnt lgkmcnt(0)
    v_readfirstlane_b32 s26, v5
    s_mov_b32 s25, s3
    s_mov_b32 s27, 0
    s_mov_b32 s97, 128
    s_cmp_lt_u32 s26, 32
    s_cselect_b32 s99, 1, 0
    s_and_b32 s26, s26, 31

.mg_role_3:
    s_cmp_ge_u32 s25, 4
    s_cbranch_scc1 .mg_bg_2

    s_load_dwordx8 s[44:51], s[0:1], 64
    s_load_dwordx2 s[40:41], s[0:1], 56
    v_and_b32 v1, 63, v0
    v_and_b32 v2, 15, v1
    v_lshrrev_b32 v3, 4, v1

    s_lshr_b32 s79, s26, 2
    s_and_b32 s78, s24, 1
    s_lshl_b32 s34, s25, 19
    s_add_u32 s34, s34, 83886080
    v_lshlrev_b32 v14, 4, v1
    v_lshrrev_b32 v6, 1, v3
    s_sub_u32 s101, 0, s100
    s_and_b32 s101, s101, 0x1fffff
    s_add_u32 s101, s101, 100663296

    v_mov_b32 v188, -1
    v_mov_b32 v189, -1
    v_mov_b32 v190, -1
    v_mov_b32 v191, -1
    s_lshl_b32 s5, s26, 10
    s_add_u32 s5, s5, 40960
    v_add_u32 v235, s5, v14
    s_lshr_b32 s4, s26, 3
    s_mul_i32 s4, s4, 1024
    s_lshl_b32 s5, s26, 9
    s_add_u32 s76, s4, s5
    s_lshr_b32 s4, s26, 4
    s_mul_i32 s4, s4, 0
    s_add_u32 s77, s4, s5
    s_add_u32 s77, s77, 20480
    s_sub_u32 s4, s77, s76
    v_and_b32 v4, 31, v1
    v_lshlrev_b32 v236, 4, v4
    v_mad_u32_u24 v236, v6, s4, v236
    v_add_u32 v236, s76, v236
    s_and_b32 s5, s26, 7
    s_lshl_b32 s4, s5, 10
    s_lshr_b32 s5, s26, 3
    s_lshl_b32 s5, s5, 14
    s_add_u32 s4, s4, s5
    s_add_u32 s35, s4, s101
    s_lshl_b32 s5, s25, 16
    v_add_u32 v238, s5, v14
    s_lshl_b32 s4, s25, 3
    s_add_u32 s7, s4, s79
    s_mul_i32 s36, s7, 6144
    s_add_u32 s36, s36, 67108864

    s_cmp_eq_u32 s78, 0
    s_cselect_b64 vcc, -1, 0
    s_lshr_b32 s6, s24, 1
    s_lshl_b32 s4, s6, 17
    s_add_u32 s4, s4, s34
    v_cndmask_b32 v4, v235, v236, vcc
    s_mul_i32 s5, s6, 1048576
    s_lshl_b32 s6, s78, 13
    buffer_store_dwordx4 v[188:191], v4, s[8:11], s4 offen sc1
    s_add_u32 s5, s5, s6
    s_add_u32 s5, s5, s35

    buffer_store_dwordx4 v[188:191], v238, s[8:11], s5 offen sc1
    s_add_u32 s5, s5, 262144
    buffer_store_dwordx4 v[188:191], v238, s[8:11], s5 offen sc1
    s_add_u32 s5, s5, 262144
    s_lshl_b32 s4, s25, 11
    s_lshl_b32 s5, s26, 6
    s_add_u32 s4, s4, s5
    s_lshl_b32 s5, s24, 21
    s_add_u32 s4, s4, s5
    v_lshrrev_b32 v4, 2, v1
    v_and_b32 v5, 3, v1
    v_lshlrev_b32 v5, 4, v5
    v_lshlrev_b32 v6, 13, v4
    v_add_u32 v6, v6, v5
    v_add_u32 v240, s4, v6
    s_lshl_b32 s4, s25, 2
    s_and_b32 s5, s24, 1
    s_lshl_b32 s5, s5, 1
    s_add_u32 s4, s4, s5
    s_lshr_b32 s5, s24, 1
    s_lshl_b32 s80, s5, 1
    s_lshl_b32 s4, s4, 19
    s_lshl_b32 s5, s26, 6
    s_add_u32 s4, s4, s5
    v_lshlrev_b32 v6, 11, v4
    v_add_u32 v6, v6, v5
    v_add_u32 v241, s4, v6
    s_lshl_b32 s98, s24, 15
    s_waitcnt lgkmcnt(0)

    s_add_u32 s80, s80, s79
    s_add_u32 s81, s80, 2
    s_add_u32 s80, s80, 1
    s_and_b32 s80, s80, 3
    s_and_b32 s81, s81, 3
    s_lshl_b32 s80, s80, 18
    s_lshl_b32 s81, s81, 18

    s_barrier
    s_cmp_eq_u32 s24, 1
    s_cselect_b64 s[42:43], s[46:47], s[44:45]
    s_cmp_eq_u32 s24, 2
    s_cselect_b64 s[42:43], s[48:49], s[42:43]
    s_cmp_eq_u32 s24, 3
    s_cselect_b64 s[42:43], s[50:51], s[42:43]
    s_cselect_b32 s6, 11, 13
    s_cselect_b32 s7, 21, 11

    s_mov_b32 s16, s42
    s_and_b32 s17, s43, 0xffff
    s_mov_b32 s18, 0x800000
    s_mov_b32 s19, 0x00020000

    s_lshl_b32 s7, s25, s7
    s_lshr_b32 s4, s26, 1
    s_lshl_b32 s4, s4, 6
    v_add_u32 v4, s4, v1
    v_lshlrev_b32 v4, s6, v4
    s_and_b32 s4, s26, 1
    s_lshl_b32 s4, s4, 10
    s_add_u32 s7, s7, s4
    buffer_load_dword v226, v4, s[16:19], s7 offen offset:384

    s_bitcmp1_b32 s26, 0
    s_cbranch_scc1 .po_7
    s_mov_b32 s16, s44
    s_and_b32 s17, s45, 0xffff
    s_mov_b32 s18, 0x800000
    s_mov_b32 s19, 0x00020000

    s_add_u32 m0, s98, 0
    s_mov_b32 s5, 0
    buffer_load_dwordx4 v240, s[16:19], s5 offen  lds

    s_add_u32 m0, s98, 1024
    s_mov_b32 s5, 131072
    buffer_load_dwordx4 v240, s[16:19], s5 offen  lds

    s_add_u32 m0, s98, 2048
    s_mov_b32 s5, 262144
    buffer_load_dwordx4 v240, s[16:19], s5 offen  lds

    s_add_u32 m0, s98, 3072
    s_mov_b32 s5, 393216
    buffer_load_dwordx4 v240, s[16:19], s5 offen  lds

    s_add_u32 m0, s98, 4096
    s_mov_b32 s5, 524288
    buffer_load_dwordx4 v240, s[16:19], s5 offen  lds

    s_add_u32 m0, s98, 5120
    s_mov_b32 s5, 655360
    buffer_load_dwordx4 v240, s[16:19], s5 offen  lds

    s_add_u32 m0, s98, 6144
    s_mov_b32 s5, 786432
    buffer_load_dwordx4 v240, s[16:19], s5 offen  lds

    s_add_u32 m0, s98, 7168
    s_mov_b32 s5, 917504
    buffer_load_dwordx4 v240, s[16:19], s5 offen  lds

    s_branch .pj_8
.po_7:
    s_mov_b32 s16, s44
    s_and_b32 s17, s45, 0xffff
    s_mov_b32 s18, 0x800000
    s_mov_b32 s19, 0x00020000

    s_add_u32 m0, s98, 8192
    s_mov_b32 s5, 1048576
    buffer_load_dwordx4 v240, s[16:19], s5 offen  lds

    s_add_u32 m0, s98, 9216
    s_mov_b32 s5, 1179648
    buffer_load_dwordx4 v240, s[16:19], s5 offen  lds

    s_add_u32 m0, s98, 10240
    s_mov_b32 s5, 1310720
    buffer_load_dwordx4 v240, s[16:19], s5 offen  lds

    s_add_u32 m0, s98, 11264
    s_mov_b32 s5, 1441792
    buffer_load_dwordx4 v240, s[16:19], s5 offen  lds

    s_add_u32 m0, s98, 12288
    s_mov_b32 s5, 1572864
    buffer_load_dwordx4 v240, s[16:19], s5 offen  lds

    s_add_u32 m0, s98, 13312
    s_mov_b32 s5, 1703936
    buffer_load_dwordx4 v240, s[16:19], s5 offen  lds

    s_add_u32 m0, s98, 14336
    s_mov_b32 s5, 1835008
    buffer_load_dwordx4 v240, s[16:19], s5 offen  lds

    s_add_u32 m0, s98, 15360
    s_mov_b32 s5, 1966080
    buffer_load_dwordx4 v240, s[16:19], s5 offen  lds

.pj_8:
    s_waitcnt vmcnt(9)
    s_barrier
    v_mov_b32 v243, s99
    v_mov_b32 v242, 0
    s_cmp_lg_u32 s24, 3
    s_cbranch_scc1 .a1_9
    s_mov_b64 exec, 1
    buffer_atomic_add v243, v242, s[20:23], s97 offen sc1
    s_mov_b64 exec, -1

.a1_9:
    s_bitcmp1_b32 s26, 0
    s_cbranch_scc1 .po_11
    s_add_u32 m0, s98, 8192
    s_mov_b32 s5, 1048576
    buffer_load_dwordx4 v240, s[16:19], s5 offen  lds

    s_add_u32 m0, s98, 9216
    s_mov_b32 s5, 1179648
    buffer_load_dwordx4 v240, s[16:19], s5 offen  lds

    s_add_u32 m0, s98, 10240
    s_mov_b32 s5, 1310720
    buffer_load_dwordx4 v240, s[16:19], s5 offen  lds

    s_add_u32 m0, s98, 11264
    s_mov_b32 s5, 1441792
    buffer_load_dwordx4 v240, s[16:19], s5 offen  lds

    s_add_u32 m0, s98, 12288
    s_mov_b32 s5, 1572864
    buffer_load_dwordx4 v240, s[16:19], s5 offen  lds

    s_add_u32 m0, s98, 13312
    s_mov_b32 s5, 1703936
    buffer_load_dwordx4 v240, s[16:19], s5 offen  lds

    s_add_u32 m0, s98, 14336
    s_mov_b32 s5, 1835008
    buffer_load_dwordx4 v240, s[16:19], s5 offen  lds

    s_add_u32 m0, s98, 15360
    s_mov_b32 s5, 1966080
    buffer_load_dwordx4 v240, s[16:19], s5 offen  lds

    s_mov_b32 s16, s46
    s_and_b32 s17, s47, 0xffff
    s_mov_b32 s18, 0x800000
    s_mov_b32 s19, 0x00020000

    s_add_u32 m0, s98, 16384
    s_mov_b32 s5, 0
    buffer_load_dwordx4 v240, s[16:19], s5 offen  lds

    s_add_u32 m0, s98, 17408
    s_mov_b32 s5, 131072
    buffer_load_dwordx4 v240, s[16:19], s5 offen  lds

    s_add_u32 m0, s98, 18432
    s_mov_b32 s5, 262144
    buffer_load_dwordx4 v240, s[16:19], s5 offen  lds

    s_add_u32 m0, s98, 19456
    s_mov_b32 s5, 393216
    buffer_load_dwordx4 v240, s[16:19], s5 offen  lds

    s_add_u32 m0, s98, 20480
    s_mov_b32 s5, 524288
    buffer_load_dwordx4 v240, s[16:19], s5 offen  lds

    s_add_u32 m0, s98, 21504
    s_mov_b32 s5, 655360
    buffer_load_dwordx4 v240, s[16:19], s5 offen  lds

    s_add_u32 m0, s98, 22528
    s_mov_b32 s5, 786432
    buffer_load_dwordx4 v240, s[16:19], s5 offen  lds

    s_add_u32 m0, s98, 23552
    s_mov_b32 s5, 917504
    buffer_load_dwordx4 v240, s[16:19], s5 offen  lds

    s_add_u32 m0, s98, 24576
    s_mov_b32 s5, 1048576
    buffer_load_dwordx4 v240, s[16:19], s5 offen  lds

    s_add_u32 m0, s98, 25600
    s_mov_b32 s5, 1179648
    buffer_load_dwordx4 v240, s[16:19], s5 offen  lds

    s_add_u32 m0, s98, 26624
    s_mov_b32 s5, 1310720
    buffer_load_dwordx4 v240, s[16:19], s5 offen  lds

    s_add_u32 m0, s98, 27648
    s_mov_b32 s5, 1441792
    buffer_load_dwordx4 v240, s[16:19], s5 offen  lds

    s_add_u32 m0, s98, 28672
    s_mov_b32 s5, 1572864
    buffer_load_dwordx4 v240, s[16:19], s5 offen  lds

    s_add_u32 m0, s98, 29696
    s_mov_b32 s5, 1703936
    buffer_load_dwordx4 v240, s[16:19], s5 offen  lds

    s_add_u32 m0, s98, 30720
    s_mov_b32 s5, 1835008
    buffer_load_dwordx4 v240, s[16:19], s5 offen  lds

    s_add_u32 m0, s98, 31744
    s_mov_b32 s5, 1966080
    buffer_load_dwordx4 v240, s[16:19], s5 offen  lds

    s_branch .pj_12
.po_11:
    s_add_u32 m0, s98, 0
    s_mov_b32 s5, 0
    buffer_load_dwordx4 v240, s[16:19], s5 offen  lds

    s_add_u32 m0, s98, 1024
    s_mov_b32 s5, 131072
    buffer_load_dwordx4 v240, s[16:19], s5 offen  lds

    s_add_u32 m0, s98, 2048
    s_mov_b32 s5, 262144
    buffer_load_dwordx4 v240, s[16:19], s5 offen  lds

    s_add_u32 m0, s98, 3072
    s_mov_b32 s5, 393216
    buffer_load_dwordx4 v240, s[16:19], s5 offen  lds

    s_add_u32 m0, s98, 4096
    s_mov_b32 s5, 524288
    buffer_load_dwordx4 v240, s[16:19], s5 offen  lds

    s_add_u32 m0, s98, 5120
    s_mov_b32 s5, 655360
    buffer_load_dwordx4 v240, s[16:19], s5 offen  lds

    s_add_u32 m0, s98, 6144
    s_mov_b32 s5, 786432
    buffer_load_dwordx4 v240, s[16:19], s5 offen  lds

    s_add_u32 m0, s98, 7168
    s_mov_b32 s5, 917504
    buffer_load_dwordx4 v240, s[16:19], s5 offen  lds

    s_mov_b32 s16, s46
    s_and_b32 s17, s47, 0xffff
    s_mov_b32 s18, 0x800000
    s_mov_b32 s19, 0x00020000

    s_add_u32 m0, s98, 24576
    s_mov_b32 s5, 1048576
    buffer_load_dwordx4 v240, s[16:19], s5 offen  lds

    s_add_u32 m0, s98, 25600
    s_mov_b32 s5, 1179648
    buffer_load_dwordx4 v240, s[16:19], s5 offen  lds

    s_add_u32 m0, s98, 26624
    s_mov_b32 s5, 1310720
    buffer_load_dwordx4 v240, s[16:19], s5 offen  lds

    s_add_u32 m0, s98, 27648
    s_mov_b32 s5, 1441792
    buffer_load_dwordx4 v240, s[16:19], s5 offen  lds

    s_add_u32 m0, s98, 28672
    s_mov_b32 s5, 1572864
    buffer_load_dwordx4 v240, s[16:19], s5 offen  lds

    s_add_u32 m0, s98, 29696
    s_mov_b32 s5, 1703936
    buffer_load_dwordx4 v240, s[16:19], s5 offen  lds

    s_add_u32 m0, s98, 30720
    s_mov_b32 s5, 1835008
    buffer_load_dwordx4 v240, s[16:19], s5 offen  lds

    s_add_u32 m0, s98, 31744
    s_mov_b32 s5, 1966080
    buffer_load_dwordx4 v240, s[16:19], s5 offen  lds

    s_add_u32 m0, s98, 16384
    s_mov_b32 s5, 0
    buffer_load_dwordx4 v240, s[16:19], s5 offen  lds

    s_add_u32 m0, s98, 17408
    s_mov_b32 s5, 131072
    buffer_load_dwordx4 v240, s[16:19], s5 offen  lds

    s_add_u32 m0, s98, 18432
    s_mov_b32 s5, 262144
    buffer_load_dwordx4 v240, s[16:19], s5 offen  lds

    s_add_u32 m0, s98, 19456
    s_mov_b32 s5, 393216
    buffer_load_dwordx4 v240, s[16:19], s5 offen  lds

    s_add_u32 m0, s98, 20480
    s_mov_b32 s5, 524288
    buffer_load_dwordx4 v240, s[16:19], s5 offen  lds

    s_add_u32 m0, s98, 21504
    s_mov_b32 s5, 655360
    buffer_load_dwordx4 v240, s[16:19], s5 offen  lds

    s_add_u32 m0, s98, 22528
    s_mov_b32 s5, 786432
    buffer_load_dwordx4 v240, s[16:19], s5 offen  lds

    s_add_u32 m0, s98, 23552
    s_mov_b32 s5, 917504
    buffer_load_dwordx4 v240, s[16:19], s5 offen  lds

.pj_12:
    s_mov_b32 s12, s40
    s_and_b32 s13, s41, 0xffff
    s_mov_b32 s14, 0x4000
    s_mov_b32 s15, 0x00020000

    v_bfe_u32 v4, v2, 2, 1
    v_lshrrev_b32 v5, 3, v2
    v_lshrrev_b32 v8, 1, v3
    v_and_b32 v9, 1, v3
    v_lshl_add_u32 v6, v5, 3, v4
    v_lshl_add_u32 v6, v8, 4, v6
    v_lshl_add_u32 v6, v9, 2, v6
    v_lshl_add_u32 v7, v5, 2, v4
    v_lshl_add_u32 v7, v8, 3, v7
    v_lshl_add_u32 v7, v9, 4, v7
    v_and_b32 v5, 3, v2
    v_lshlrev_b32 v5, 3, v5
    v_lshl_add_u32 v6, v6, 6, v5
    v_lshl_add_u32 v7, v7, 6, v5
    v_add_u32 v254, s98, v6
    v_add_u32 v255, s98, v7
    v_sub_u32 v252, v254, v5
    v_and_b32 v5, 1, v2
    v_lshl_add_u32 v252, v5, 5, v252
    v_bfe_u32 v5, v2, 1, 1
    v_lshl_add_u32 v252, v5, 3, v252

    s_and_b32 s96, s26, 3
    s_lshl_b32 s4, s25, 3
    s_add_u32 s7, s4, s79
    s_mul_i32 s5, s24, 5120
    v_add_u32 v8, s5, v14
    v_and_b32 v5, 7, v2
    v_lshrrev_b32 v6, 1, v3
    v_and_b32 v7, 1, v3
    v_lshlrev_b32 v7, 3, v7
    v_lshlrev_b32 v17, 11, v5
    v_lshl_add_u32 v17, v3, 5, v17
    v_lshrrev_b32 v4, 3, v2
    v_lshl_add_u32 v17, v4, 4, v17
    s_lshl_b32 s5, s24, 9
    v_add_u32 v17, s5, v17

    buffer_load_dwordx4 v[20:23], v17, s[12:15], 0 offen offset:0
    buffer_load_dwordx4 v[24:27], v17, s[12:15], 0 offen offset:128
    buffer_load_dwordx4 v[28:31], v17, s[12:15], 0 offen offset:256
    buffer_load_dwordx4 v[32:35], v17, s[12:15], 0 offen offset:384
    v_lshlrev_b32 v4, 7, v2
    v_lshl_add_u32 v18, s26, 10, v4
    v_add_u32 v18, 40960, v18
    v_and_b32 v4, 0x180, v4
    v_add_u32 v4, s76, v4
    v_bfe_u32 v19, v2, 2, 1
    s_sub_u32 s4, s77, s76
    v_mad_u32_u24 v4, v19, s4, v4
    v_cmp_gt_u32 vcc, 8, v2
    s_lshl_b32 s4, s24, 17
    s_add_u32 s4, s4, s34
    v_cndmask_b32 v4, v4, v18, vcc
    s_mov_b64 exec, 0xffff
    buffer_load_dword v227, v4, s[8:11], s4 offen
    s_mov_b64 exec, -1

    s_lshl_b32 s4, s79, 12
    s_add_u32 s4, s4, 40960

    s_add_u32 s5, s96, 1
    s_and_b32 s5, s5, 3
    s_lshl_b32 s5, s5, 10
    s_add_u32 s5, s5, s4
    v_add_u32 v232, s5, v14

    s_add_u32 s5, s96, 2
    s_and_b32 s5, s5, 3
    s_lshl_b32 s5, s5, 10
    s_add_u32 s5, s5, s4
    v_add_u32 v233, s5, v14

    s_add_u32 s5, s96, 3
    s_and_b32 s5, s5, 3
    s_lshl_b32 s5, s5, 10
    s_add_u32 s5, s5, s4
    v_add_u32 v234, s5, v14

    s_lshl_b32 s5, s78, 9
    v_lshlrev_b32 v10, 8, v6
    v_lshl_add_u32 v10, v2, 4, v10
    v_add_u32 v10, v10, v7
    v_add_u32 v10, s5, v10
    v_add_u32 v18, 16384, v10
    s_lshl_b32 s5, s26, 10
    s_add_u32 s5, s5, 40960
    v_add_u32 v10, s5, v10
    v_lshlrev_b32 v11, 8, v3
    v_lshl_add_u32 v11, v5, 4, v11
    s_lshr_b32 s4, s96, 1
    s_lshl_b32 s4, s4, 10
    s_and_b32 s5, s96, 1
    s_lshl_b32 s5, s5, 7
    s_add_u32 s4, s4, s5
    s_add_u32 s4, s4, 2048
    v_add_u32 v11, s4, v11
    v_lshlrev_b32 v12, 8, v6
    v_lshl_add_u32 v12, v2, 4, v12
    s_lshl_b32 s4, s96, 9
    s_add_u32 s4, s4, 4096
    v_add_u32 v12, s4, v12
    v_lshlrev_b32 v13, 7, v3
    v_lshl_add_u32 v13, v5, 4, v13
    v_add_u32 v13, s77, v13
    v_lshlrev_b32 v15, 7, v6
    v_lshl_add_u32 v15, v5, 4, v15
    v_add_u32 v15, v15, v7
    s_lshl_b32 s5, s78, 8
    s_add_u32 s5, s5, s76
    v_add_u32 v15, s5, v15
    v_lshlrev_b32 v16, 8, v6
    v_lshl_add_u32 v16, v2, 4, v16
    v_add_u32 v16, v16, v7
    s_lshl_b32 s5, s24, 9
    v_add_u32 v16, s5, v16
    s_lshl_b32 s5, s24, 11
    v_add_u32 v17, s5, v14
    v_cmp_gt_u32 s[58:59], 8, v2
    v_cmp_gt_u32 s[60:61], 32, v1
    v_mov_b32 v4, 0x4444
    v_mov_b32 v9, 0xeeee
    v_cndmask_b32 v9, v9, v4, s[58:59]
    s_not_b64 s[66:67], s[58:59]
    s_cmp_lt_u32 s24, 2
    s_cselect_b64 s[64:65], s[66:67], s[58:59]
    s_mov_b32 s56, 0x0000ffff
    s_mov_b32 s57, 0x0000ffff
    s_cmp_eq_u32 s24, 1
    s_cselect_b64 vcc, -1, 0
    s_cselect_b64 s[66:67], s[56:57], s[66:67]
    s_lshl_b32 s5, s78, 10
    v_add_u32 v19, s5, v14
    v_cndmask_b32 v11, v11, v12, vcc
    v_cndmask_b32 v235, v235, v236, vcc
    v_mov_b32 v4, 0xff800000
    v_cndmask_b32 v116, 0, v4, s[60:61]
    v_mov_b32 v117, v116
    v_mov_b32 v118, v116
    v_mov_b32 v119, v116
    s_mul_i32 s5, s78, 8192
    v_add_u32 v246, s5, v14
    v_lshlrev_b32 v247, 9, v6
    v_lshl_add_u32 v247, v2, 4, v247
    s_lshl_b32 s5, s78, 8
    s_add_u32 s5, s5, 12288
    v_add_u32 v247, s5, v247
    v_and_b32 v4, 31, v1
    v_lshlrev_b32 v248, 4, v4
    s_lshl_b32 s5, s78, 9
    s_add_u32 s5, s5, 12288
    v_add_u32 v248, s5, v248
    s_lshl_b32 s5, s25, 16
    v_and_b32 v7, 1, v3
    v_lshlrev_b32 v237, 18, v7
    v_lshl_add_u32 v237, v6, 8, v237
    v_lshl_add_u32 v237, v2, 4, v237
    v_add_u32 v237, s5, v237
    s_lshl_b32 s6, s78, 9
    v_add_u32 v237, s6, v237
    s_lshl_b32 s6, s78, 8
    v_lshlrev_b32 v249, 9, v7
    v_lshl_add_u32 v249, v2, 4, v249
    v_add_u32 v249, s6, v249
    v_add_u32 v4, s25, v6
    v_add_u32 v4, 1, v4
    v_and_b32 v4, 3, v4
    v_lshl_add_u32 v239, v4, 16, v249
    s_add_u32 s6, s25, 3
    s_and_b32 s6, s6, 3
    s_lshl_b32 s6, s6, 16
    v_add_u32 v249, s6, v249
    v_and_b32 v4, 1, v5
    v_lshlrev_b32 v4, 4, v4
    v_mov_b32 v6, 0x3f80
    v_lshlrev_b32 v6, v4, v6
    v_lshrrev_b32 v4, 1, v5

    v_cmp_eq_u32 vcc, 0, v4
    s_nop 1
    v_cndmask_b32 v84, 0, v6, vcc
    v_cmp_eq_u32 vcc, 1, v4
    s_nop 1
    v_cndmask_b32 v85, 0, v6, vcc
    v_cmp_eq_u32 vcc, 2, v4
    s_nop 1
    v_cndmask_b32 v86, 0, v6, vcc
    v_cmp_eq_u32 vcc, 3, v4
    s_nop 1
    v_cndmask_b32 v87, 0, v6, vcc
    v_mov_b32 v120, 0x3f803f80
    v_cndmask_b32 v112, 0, v84, s[60:61]
    v_mov_b32 v121, 0x3f803f80
    v_cndmask_b32 v113, 0, v85, s[60:61]
    v_mov_b32 v122, 0x3f803f80
    v_cndmask_b32 v114, 0, v86, s[60:61]
    v_mov_b32 v123, 0x3f803f80
    v_cndmask_b32 v115, 0, v87, s[60:61]
    v_mov_b32 v170, 0
    v_mov_b32 v171, 0
    v_mov_b32 v174, 0
    v_mov_b32 v175, 0
    v_mov_b32 v182, 0
    v_mov_b32 v183, 0
    s_add_u32 s5, s96, 0
    s_and_b32 s5, s5, 3
    s_lshl_b32 s5, s5, 10
    s_add_u32 s5, s5, 20480
    v_add_u32 v228, s5, v14

    s_add_u32 s5, s96, 1
    s_and_b32 s5, s5, 3
    s_lshl_b32 s5, s5, 10
    s_add_u32 s5, s5, 20480
    v_add_u32 v229, s5, v14

    s_add_u32 s5, s96, 2
    s_and_b32 s5, s5, 3
    s_lshl_b32 s5, s5, 10
    s_add_u32 s5, s5, 20480
    v_add_u32 v230, s5, v14

    s_add_u32 s5, s96, 3
    s_and_b32 s5, s5, 3
    s_lshl_b32 s5, s5, 10
    s_add_u32 s5, s5, 20480
    v_add_u32 v231, s5, v14

    s_lshl_b32 s89, s7, 8
    s_add_u32 s89, s89, 92282880
    v_lshlrev_b32 v253, 13, v1
    s_lshl_b32 s4, s7, 13
    s_add_u32 s38, s4, 16777216
    s_lshl_b32 s5, s96, 11
    s_add_u32 s39, s4, s5
    s_add_u32 s30, s39, 17039360
    s_add_u32 s39, s39, 33554432
    s_lshl_b32 s5, s78, 24
    s_add_u32 s30, s30, s5
    s_lshl_b32 s5, s78, 12
    s_add_u32 s38, s38, s5
    s_add_u32 s90, s5, 20480
    s_lshl_b32 s5, s78, 10
    s_add_u32 s39, s39, s5
    s_add_u32 s91, s5, 28672
    s_mov_b32 s37, 0x3e0293ee
    s_mov_b32 s28, 0

    v_and_b32 v4, 31, v1
    v_lshlrev_b32 v225, 6, v4
    v_lshrrev_b32 v4, 5, v1
    v_lshl_add_u32 v225, v4, 24, v225

    v_mov_b32 v52, 0
    v_mov_b32 v53, 0
    v_mov_b32 v54, 0
    v_mov_b32 v55, 0
    v_mov_b32 v56, 0
    v_mov_b32 v57, 0
    v_mov_b32 v58, 0
    v_mov_b32 v59, 0
    v_mov_b32 v60, 0
    v_mov_b32 v61, 0
    v_mov_b32 v62, 0
    v_mov_b32 v63, 0
    v_mov_b32 v64, 0
    v_mov_b32 v65, 0
    v_mov_b32 v66, 0
    v_mov_b32 v67, 0
    v_mov_b32 v68, 0
    v_mov_b32 v69, 0
    v_mov_b32 v70, 0
    v_mov_b32 v71, 0
    v_mov_b32 v72, 0
    v_mov_b32 v73, 0
    v_mov_b32 v74, 0
    v_mov_b32 v75, 0
    v_mov_b32 v76, 0
    v_mov_b32 v77, 0
    v_mov_b32 v78, 0
    v_mov_b32 v79, 0
    v_mov_b32 v80, 0
    v_mov_b32 v81, 0
    v_mov_b32 v82, 0
    v_mov_b32 v83, 0
    v_mov_b32 v92, -1
    v_mov_b32 v93, -1
    v_mov_b32 v94, -1
    v_mov_b32 v95, -1
    v_mov_b32 v96, -1
    v_mov_b32 v97, -1
    v_mov_b32 v98, -1
    v_mov_b32 v99, -1
    v_mov_b32 v100, -1
    v_mov_b32 v101, -1
    v_mov_b32 v102, -1
    v_mov_b32 v103, -1
    v_mov_b32 v192, -1
    v_mov_b32 v193, -1
    v_mov_b32 v194, -1
    v_mov_b32 v195, -1
    v_mov_b32 v196, -1
    v_mov_b32 v197, -1
    v_mov_b32 v198, -1
    v_mov_b32 v199, -1
    v_mov_b32 v200, -1
    v_mov_b32 v201, -1
    v_mov_b32 v202, -1
    v_mov_b32 v203, -1
    v_mov_b32 v204, -1
    v_mov_b32 v205, -1
    v_mov_b32 v206, -1
    v_mov_b32 v207, -1
    v_mov_b32 v208, -1
    v_mov_b32 v209, -1
    v_mov_b32 v210, -1
    v_mov_b32 v211, -1
    v_mov_b32 v212, -1
    v_mov_b32 v213, -1
    v_mov_b32 v214, -1
    v_mov_b32 v215, -1
    v_mov_b32 v216, -1
    v_mov_b32 v217, -1
    v_mov_b32 v218, -1
    v_mov_b32 v219, -1
    v_mov_b32 v220, -1
    v_mov_b32 v221, -1
    v_mov_b32 v222, -1
    v_mov_b32 v223, -1
    s_bitcmp1_b32 s26, 0
    s_cbranch_scc1 .po_13
    s_waitcnt vmcnt(29)
    ds_read_b64_tr_b16 a[0:1], v252 offset:0
    ds_read_b64_tr_b16 a[2:3], v252 offset:128
    ds_read_b64_tr_b16 a[4:5], v252 offset:2048
    ds_read_b64_tr_b16 a[6:7], v252 offset:2176
    ds_read_b64_tr_b16 a[8:9], v252 offset:4096
    ds_read_b64_tr_b16 a[10:11], v252 offset:4224
    ds_read_b64_tr_b16 a[12:13], v252 offset:6144
    ds_read_b64_tr_b16 a[14:15], v252 offset:6272
    ds_read_b64_tr_b16 a[32:33], v252 offset:16
    ds_read_b64_tr_b16 a[34:35], v252 offset:144
    ds_read_b64_tr_b16 a[36:37], v252 offset:2064
    ds_read_b64_tr_b16 a[38:39], v252 offset:2192
    ds_read_b64_tr_b16 a[40:41], v252 offset:4112
    ds_read_b64_tr_b16 a[42:43], v252 offset:4240
    ds_read_b64_tr_b16 a[44:45], v252 offset:6160
    ds_read_b64_tr_b16 a[46:47], v252 offset:6288
    s_waitcnt lgkmcnt(0)
    s_mov_b32 s16, s48
    s_and_b32 s17, s49, 0xffff
    s_mov_b32 s18, 0x800000
    s_mov_b32 s19, 0x00020000

    s_add_u32 m0, s98, 0
    s_mov_b32 s5, 0
    buffer_load_dwordx4 v240, s[16:19], s5 offen  lds

    s_add_u32 m0, s98, 1024
    s_mov_b32 s5, 131072
    buffer_load_dwordx4 v240, s[16:19], s5 offen  lds

    s_add_u32 m0, s98, 2048
    s_mov_b32 s5, 262144
    buffer_load_dwordx4 v240, s[16:19], s5 offen  lds

    s_add_u32 m0, s98, 3072
    s_mov_b32 s5, 393216
    buffer_load_dwordx4 v240, s[16:19], s5 offen  lds

    s_add_u32 m0, s98, 4096
    s_mov_b32 s5, 524288
    buffer_load_dwordx4 v240, s[16:19], s5 offen  lds

    s_add_u32 m0, s98, 5120
    s_mov_b32 s5, 655360
    buffer_load_dwordx4 v240, s[16:19], s5 offen  lds

    s_add_u32 m0, s98, 6144
    s_mov_b32 s5, 786432
    buffer_load_dwordx4 v240, s[16:19], s5 offen  lds

    s_add_u32 m0, s98, 7168
    s_mov_b32 s5, 917504
    buffer_load_dwordx4 v240, s[16:19], s5 offen  lds

    s_waitcnt vmcnt(29)
    ds_read_b64_tr_b16 a[16:17], v252 offset:8192
    ds_read_b64_tr_b16 a[18:19], v252 offset:8320
    ds_read_b64_tr_b16 a[20:21], v252 offset:10240
    ds_read_b64_tr_b16 a[22:23], v252 offset:10368
    ds_read_b64_tr_b16 a[24:25], v252 offset:12288
    ds_read_b64_tr_b16 a[26:27], v252 offset:12416
    ds_read_b64_tr_b16 a[28:29], v252 offset:14336
    ds_read_b64_tr_b16 a[30:31], v252 offset:14464
    ds_read_b64_tr_b16 a[48:49], v252 offset:8208
    ds_read_b64_tr_b16 a[50:51], v252 offset:8336
    ds_read_b64_tr_b16 a[52:53], v252 offset:10256
    ds_read_b64_tr_b16 a[54:55], v252 offset:10384
    ds_read_b64_tr_b16 a[56:57], v252 offset:12304
    ds_read_b64_tr_b16 a[58:59], v252 offset:12432
    ds_read_b64_tr_b16 a[60:61], v252 offset:14352
    ds_read_b64_tr_b16 a[62:63], v252 offset:14480
    s_waitcnt lgkmcnt(0)
    s_add_u32 m0, s98, 8192
    s_mov_b32 s5, 1048576
    buffer_load_dwordx4 v240, s[16:19], s5 offen  lds

    s_add_u32 m0, s98, 9216
    s_mov_b32 s5, 1179648
    buffer_load_dwordx4 v240, s[16:19], s5 offen  lds

    s_add_u32 m0, s98, 10240
    s_mov_b32 s5, 1310720
    buffer_load_dwordx4 v240, s[16:19], s5 offen  lds

    s_add_u32 m0, s98, 11264
    s_mov_b32 s5, 1441792
    buffer_load_dwordx4 v240, s[16:19], s5 offen  lds

    s_add_u32 m0, s98, 12288
    s_mov_b32 s5, 1572864
    buffer_load_dwordx4 v240, s[16:19], s5 offen  lds

    s_add_u32 m0, s98, 13312
    s_mov_b32 s5, 1703936
    buffer_load_dwordx4 v240, s[16:19], s5 offen  lds

    s_add_u32 m0, s98, 14336
    s_mov_b32 s5, 1835008
    buffer_load_dwordx4 v240, s[16:19], s5 offen  lds

    s_add_u32 m0, s98, 15360
    s_mov_b32 s5, 1966080
    buffer_load_dwordx4 v240, s[16:19], s5 offen  lds

    s_waitcnt vmcnt(29)
    ds_read_b64_tr_b16 a[64:65], v252 offset:16384
    ds_read_b64_tr_b16 a[66:67], v252 offset:16512
    ds_read_b64_tr_b16 a[68:69], v252 offset:18432
    ds_read_b64_tr_b16 a[70:71], v252 offset:18560
    ds_read_b64_tr_b16 a[72:73], v252 offset:20480
    ds_read_b64_tr_b16 a[74:75], v252 offset:20608
    ds_read_b64_tr_b16 a[76:77], v252 offset:22528
    ds_read_b64_tr_b16 a[78:79], v252 offset:22656
    ds_read_b64_tr_b16 a[96:97], v252 offset:16400
    ds_read_b64_tr_b16 a[98:99], v252 offset:16528
    ds_read_b64_tr_b16 a[100:101], v252 offset:18448
    ds_read_b64_tr_b16 a[102:103], v252 offset:18576
    ds_read_b64_tr_b16 a[104:105], v252 offset:20496
    ds_read_b64_tr_b16 a[106:107], v252 offset:20624
    ds_read_b64_tr_b16 a[108:109], v252 offset:22544
    ds_read_b64_tr_b16 a[110:111], v252 offset:22672
    s_waitcnt lgkmcnt(0)
    s_mov_b32 s16, s50
    s_and_b32 s17, s51, 0xffff
    s_mov_b32 s18, 0x800000
    s_mov_b32 s19, 0x00020000

    s_add_u32 m0, s98, 16384
    s_add_u32 s5, s80, 0
    buffer_load_dwordx4 v241, s[16:19], s5 offen  lds

    s_add_u32 m0, s98, 17408
    s_add_u32 s5, s80, 32768
    buffer_load_dwordx4 v241, s[16:19], s5 offen  lds

    s_add_u32 m0, s98, 18432
    s_add_u32 s5, s80, 65536
    buffer_load_dwordx4 v241, s[16:19], s5 offen  lds

    s_add_u32 m0, s98, 19456
    s_add_u32 s5, s80, 98304
    buffer_load_dwordx4 v241, s[16:19], s5 offen  lds

    s_add_u32 m0, s98, 20480
    s_add_u32 s5, s80, 131072
    buffer_load_dwordx4 v241, s[16:19], s5 offen  lds

    s_add_u32 m0, s98, 21504
    s_add_u32 s5, s80, 163840
    buffer_load_dwordx4 v241, s[16:19], s5 offen  lds

    s_add_u32 m0, s98, 22528
    s_add_u32 s5, s80, 196608
    buffer_load_dwordx4 v241, s[16:19], s5 offen  lds

    s_add_u32 m0, s98, 23552
    s_add_u32 s5, s80, 229376
    buffer_load_dwordx4 v241, s[16:19], s5 offen  lds

    s_waitcnt vmcnt(29)
    ds_read_b64_tr_b16 a[80:81], v252 offset:24576
    ds_read_b64_tr_b16 a[82:83], v252 offset:24704
    ds_read_b64_tr_b16 a[84:85], v252 offset:26624
    ds_read_b64_tr_b16 a[86:87], v252 offset:26752
    ds_read_b64_tr_b16 a[88:89], v252 offset:28672
    ds_read_b64_tr_b16 a[90:91], v252 offset:28800
    ds_read_b64_tr_b16 a[92:93], v252 offset:30720
    ds_read_b64_tr_b16 a[94:95], v252 offset:30848
    ds_read_b64_tr_b16 a[112:113], v252 offset:24592
    ds_read_b64_tr_b16 a[114:115], v252 offset:24720
    ds_read_b64_tr_b16 a[116:117], v252 offset:26640
    ds_read_b64_tr_b16 a[118:119], v252 offset:26768
    ds_read_b64_tr_b16 a[120:121], v252 offset:28688
    ds_read_b64_tr_b16 a[122:123], v252 offset:28816
    ds_read_b64_tr_b16 a[124:125], v252 offset:30736
    ds_read_b64_tr_b16 a[126:127], v252 offset:30864
    s_waitcnt lgkmcnt(0)
    s_add_u32 m0, s98, 24576
    s_add_u32 s5, s81, 0
    buffer_load_dwordx4 v241, s[16:19], s5 offen  lds

    s_add_u32 m0, s98, 25600
    s_add_u32 s5, s81, 32768
    buffer_load_dwordx4 v241, s[16:19], s5 offen  lds

    s_add_u32 m0, s98, 26624
    s_add_u32 s5, s81, 65536
    buffer_load_dwordx4 v241, s[16:19], s5 offen  lds

    s_add_u32 m0, s98, 27648
    s_add_u32 s5, s81, 98304
    buffer_load_dwordx4 v241, s[16:19], s5 offen  lds

    s_add_u32 m0, s98, 28672
    s_add_u32 s5, s81, 131072
    buffer_load_dwordx4 v241, s[16:19], s5 offen  lds

    s_add_u32 m0, s98, 29696
    s_add_u32 s5, s81, 163840
    buffer_load_dwordx4 v241, s[16:19], s5 offen  lds

    s_add_u32 m0, s98, 30720
    s_add_u32 s5, s81, 196608
    buffer_load_dwordx4 v241, s[16:19], s5 offen  lds

    s_add_u32 m0, s98, 31744
    s_add_u32 s5, s81, 229376
    buffer_load_dwordx4 v241, s[16:19], s5 offen  lds

    v_and_b32 v241, 3, v0
    v_lshlrev_b32 v241, 2, v241
    buffer_load_dword v240, v241, s[20:23], s97 offen sc1

    s_waitcnt vmcnt(25)
    ds_read_b64_tr_b16 a[128:129], v254 offset:0
    ds_read_b64_tr_b16 a[130:131], v254 offset:128
    ds_read_b64_tr_b16 a[132:133], v254 offset:2048
    ds_read_b64_tr_b16 a[134:135], v254 offset:2176
    ds_read_b64_tr_b16 a[136:137], v254 offset:4096
    ds_read_b64_tr_b16 a[138:139], v254 offset:4224
    ds_read_b64_tr_b16 a[140:141], v254 offset:6144
    ds_read_b64_tr_b16 a[142:143], v254 offset:6272
    ds_read_b64_tr_b16 a[160:161], v254 offset:32
    ds_read_b64_tr_b16 a[162:163], v254 offset:160
    ds_read_b64_tr_b16 a[164:165], v254 offset:2080
    ds_read_b64_tr_b16 a[166:167], v254 offset:2208
    ds_read_b64_tr_b16 a[168:169], v254 offset:4128
    ds_read_b64_tr_b16 a[170:171], v254 offset:4256
    ds_read_b64_tr_b16 a[172:173], v254 offset:6176
    ds_read_b64_tr_b16 a[174:175], v254 offset:6304
    s_waitcnt vmcnt(17)
    ds_read_b64_tr_b16 a[144:145], v254 offset:8192
    ds_read_b64_tr_b16 a[146:147], v254 offset:8320
    ds_read_b64_tr_b16 a[148:149], v254 offset:10240
    ds_read_b64_tr_b16 a[150:151], v254 offset:10368
    ds_read_b64_tr_b16 a[152:153], v254 offset:12288
    ds_read_b64_tr_b16 a[154:155], v254 offset:12416
    ds_read_b64_tr_b16 a[156:157], v254 offset:14336
    ds_read_b64_tr_b16 a[158:159], v254 offset:14464
    ds_read_b64_tr_b16 a[176:177], v254 offset:8224
    ds_read_b64_tr_b16 a[178:179], v254 offset:8352
    ds_read_b64_tr_b16 a[180:181], v254 offset:10272
    ds_read_b64_tr_b16 a[182:183], v254 offset:10400
    ds_read_b64_tr_b16 a[184:185], v254 offset:12320
    ds_read_b64_tr_b16 a[186:187], v254 offset:12448
    ds_read_b64_tr_b16 a[188:189], v254 offset:14368
    ds_read_b64_tr_b16 a[190:191], v254 offset:14496
    s_waitcnt vmcnt(9)
    ds_read_b64_tr_b16 a[192:193], v255 offset:16384
    ds_read_b64_tr_b16 a[194:195], v255 offset:16512
    ds_read_b64_tr_b16 a[196:197], v255 offset:18432
    ds_read_b64_tr_b16 a[198:199], v255 offset:18560
    ds_read_b64_tr_b16 a[200:201], v255 offset:20480
    ds_read_b64_tr_b16 a[202:203], v255 offset:20608
    ds_read_b64_tr_b16 a[204:205], v255 offset:22528
    ds_read_b64_tr_b16 a[206:207], v255 offset:22656
    ds_read_b64_tr_b16 a[224:225], v255 offset:16416
    ds_read_b64_tr_b16 a[226:227], v255 offset:16544
    ds_read_b64_tr_b16 a[228:229], v255 offset:18464
    ds_read_b64_tr_b16 a[230:231], v255 offset:18592
    ds_read_b64_tr_b16 a[232:233], v255 offset:20512
    ds_read_b64_tr_b16 a[234:235], v255 offset:20640
    ds_read_b64_tr_b16 a[236:237], v255 offset:22560
    ds_read_b64_tr_b16 a[238:239], v255 offset:22688
    s_waitcnt vmcnt(1)
    ds_read_b64_tr_b16 a[208:209], v255 offset:24576
    ds_read_b64_tr_b16 a[210:211], v255 offset:24704
    ds_read_b64_tr_b16 a[212:213], v255 offset:26624
    ds_read_b64_tr_b16 a[214:215], v255 offset:26752
    ds_read_b64_tr_b16 a[216:217], v255 offset:28672
    ds_read_b64_tr_b16 a[218:219], v255 offset:28800
    ds_read_b64_tr_b16 a[220:221], v255 offset:30720
    ds_read_b64_tr_b16 a[222:223], v255 offset:30848
    ds_read_b64_tr_b16 a[240:241], v255 offset:24608
    ds_read_b64_tr_b16 a[242:243], v255 offset:24736
    ds_read_b64_tr_b16 a[244:245], v255 offset:26656
    ds_read_b64_tr_b16 a[246:247], v255 offset:26784
    ds_read_b64_tr_b16 a[248:249], v255 offset:28704
    ds_read_b64_tr_b16 a[250:251], v255 offset:28832
    ds_read_b64_tr_b16 a[252:253], v255 offset:30752
    ds_read_b64_tr_b16 a[254:255], v255 offset:30880
    s_branch .pj_14
.po_13:
    s_waitcnt vmcnt(29)
    ds_read_b64_tr_b16 a[16:17], v252 offset:8192
    ds_read_b64_tr_b16 a[18:19], v252 offset:8320
    ds_read_b64_tr_b16 a[20:21], v252 offset:10240
    ds_read_b64_tr_b16 a[22:23], v252 offset:10368
    ds_read_b64_tr_b16 a[24:25], v252 offset:12288
    ds_read_b64_tr_b16 a[26:27], v252 offset:12416
    ds_read_b64_tr_b16 a[28:29], v252 offset:14336
    ds_read_b64_tr_b16 a[30:31], v252 offset:14464
    ds_read_b64_tr_b16 a[48:49], v252 offset:8208
    ds_read_b64_tr_b16 a[50:51], v252 offset:8336
    ds_read_b64_tr_b16 a[52:53], v252 offset:10256
    ds_read_b64_tr_b16 a[54:55], v252 offset:10384
    ds_read_b64_tr_b16 a[56:57], v252 offset:12304
    ds_read_b64_tr_b16 a[58:59], v252 offset:12432
    ds_read_b64_tr_b16 a[60:61], v252 offset:14352
    ds_read_b64_tr_b16 a[62:63], v252 offset:14480
    s_waitcnt lgkmcnt(0)
    s_mov_b32 s16, s48
    s_and_b32 s17, s49, 0xffff
    s_mov_b32 s18, 0x800000
    s_mov_b32 s19, 0x00020000

    s_add_u32 m0, s98, 8192
    s_mov_b32 s5, 1048576
    buffer_load_dwordx4 v240, s[16:19], s5 offen  lds

    s_add_u32 m0, s98, 9216
    s_mov_b32 s5, 1179648
    buffer_load_dwordx4 v240, s[16:19], s5 offen  lds

    s_add_u32 m0, s98, 10240
    s_mov_b32 s5, 1310720
    buffer_load_dwordx4 v240, s[16:19], s5 offen  lds

    s_add_u32 m0, s98, 11264
    s_mov_b32 s5, 1441792
    buffer_load_dwordx4 v240, s[16:19], s5 offen  lds

    s_add_u32 m0, s98, 12288
    s_mov_b32 s5, 1572864
    buffer_load_dwordx4 v240, s[16:19], s5 offen  lds

    s_add_u32 m0, s98, 13312
    s_mov_b32 s5, 1703936
    buffer_load_dwordx4 v240, s[16:19], s5 offen  lds

    s_add_u32 m0, s98, 14336
    s_mov_b32 s5, 1835008
    buffer_load_dwordx4 v240, s[16:19], s5 offen  lds

    s_add_u32 m0, s98, 15360
    s_mov_b32 s5, 1966080
    buffer_load_dwordx4 v240, s[16:19], s5 offen  lds

    s_waitcnt vmcnt(29)
    ds_read_b64_tr_b16 a[0:1], v252 offset:0
    ds_read_b64_tr_b16 a[2:3], v252 offset:128
    ds_read_b64_tr_b16 a[4:5], v252 offset:2048
    ds_read_b64_tr_b16 a[6:7], v252 offset:2176
    ds_read_b64_tr_b16 a[8:9], v252 offset:4096
    ds_read_b64_tr_b16 a[10:11], v252 offset:4224
    ds_read_b64_tr_b16 a[12:13], v252 offset:6144
    ds_read_b64_tr_b16 a[14:15], v252 offset:6272
    ds_read_b64_tr_b16 a[32:33], v252 offset:16
    ds_read_b64_tr_b16 a[34:35], v252 offset:144
    ds_read_b64_tr_b16 a[36:37], v252 offset:2064
    ds_read_b64_tr_b16 a[38:39], v252 offset:2192
    ds_read_b64_tr_b16 a[40:41], v252 offset:4112
    ds_read_b64_tr_b16 a[42:43], v252 offset:4240
    ds_read_b64_tr_b16 a[44:45], v252 offset:6160
    ds_read_b64_tr_b16 a[46:47], v252 offset:6288
    s_waitcnt lgkmcnt(0)
    s_add_u32 m0, s98, 0
    s_mov_b32 s5, 0
    buffer_load_dwordx4 v240, s[16:19], s5 offen  lds

    s_add_u32 m0, s98, 1024
    s_mov_b32 s5, 131072
    buffer_load_dwordx4 v240, s[16:19], s5 offen  lds

    s_add_u32 m0, s98, 2048
    s_mov_b32 s5, 262144
    buffer_load_dwordx4 v240, s[16:19], s5 offen  lds

    s_add_u32 m0, s98, 3072
    s_mov_b32 s5, 393216
    buffer_load_dwordx4 v240, s[16:19], s5 offen  lds

    s_add_u32 m0, s98, 4096
    s_mov_b32 s5, 524288
    buffer_load_dwordx4 v240, s[16:19], s5 offen  lds

    s_add_u32 m0, s98, 5120
    s_mov_b32 s5, 655360
    buffer_load_dwordx4 v240, s[16:19], s5 offen  lds

    s_add_u32 m0, s98, 6144
    s_mov_b32 s5, 786432
    buffer_load_dwordx4 v240, s[16:19], s5 offen  lds

    s_add_u32 m0, s98, 7168
    s_mov_b32 s5, 917504
    buffer_load_dwordx4 v240, s[16:19], s5 offen  lds

    s_waitcnt vmcnt(29)
    ds_read_b64_tr_b16 a[80:81], v252 offset:24576
    ds_read_b64_tr_b16 a[82:83], v252 offset:24704
    ds_read_b64_tr_b16 a[84:85], v252 offset:26624
    ds_read_b64_tr_b16 a[86:87], v252 offset:26752
    ds_read_b64_tr_b16 a[88:89], v252 offset:28672
    ds_read_b64_tr_b16 a[90:91], v252 offset:28800
    ds_read_b64_tr_b16 a[92:93], v252 offset:30720
    ds_read_b64_tr_b16 a[94:95], v252 offset:30848
    ds_read_b64_tr_b16 a[112:113], v252 offset:24592
    ds_read_b64_tr_b16 a[114:115], v252 offset:24720
    ds_read_b64_tr_b16 a[116:117], v252 offset:26640
    ds_read_b64_tr_b16 a[118:119], v252 offset:26768
    ds_read_b64_tr_b16 a[120:121], v252 offset:28688
    ds_read_b64_tr_b16 a[122:123], v252 offset:28816
    ds_read_b64_tr_b16 a[124:125], v252 offset:30736
    ds_read_b64_tr_b16 a[126:127], v252 offset:30864
    s_waitcnt lgkmcnt(0)
    s_mov_b32 s16, s50
    s_and_b32 s17, s51, 0xffff
    s_mov_b32 s18, 0x800000
    s_mov_b32 s19, 0x00020000

    s_add_u32 m0, s98, 24576
    s_add_u32 s5, s81, 0
    buffer_load_dwordx4 v241, s[16:19], s5 offen  lds

    s_add_u32 m0, s98, 25600
    s_add_u32 s5, s81, 32768
    buffer_load_dwordx4 v241, s[16:19], s5 offen  lds

    s_add_u32 m0, s98, 26624
    s_add_u32 s5, s81, 65536
    buffer_load_dwordx4 v241, s[16:19], s5 offen  lds

    s_add_u32 m0, s98, 27648
    s_add_u32 s5, s81, 98304
    buffer_load_dwordx4 v241, s[16:19], s5 offen  lds

    s_add_u32 m0, s98, 28672
    s_add_u32 s5, s81, 131072
    buffer_load_dwordx4 v241, s[16:19], s5 offen  lds

    s_add_u32 m0, s98, 29696
    s_add_u32 s5, s81, 163840
    buffer_load_dwordx4 v241, s[16:19], s5 offen  lds

    s_add_u32 m0, s98, 30720
    s_add_u32 s5, s81, 196608
    buffer_load_dwordx4 v241, s[16:19], s5 offen  lds

    s_add_u32 m0, s98, 31744
    s_add_u32 s5, s81, 229376
    buffer_load_dwordx4 v241, s[16:19], s5 offen  lds

    s_waitcnt vmcnt(29)
    ds_read_b64_tr_b16 a[64:65], v252 offset:16384
    ds_read_b64_tr_b16 a[66:67], v252 offset:16512
    ds_read_b64_tr_b16 a[68:69], v252 offset:18432
    ds_read_b64_tr_b16 a[70:71], v252 offset:18560
    ds_read_b64_tr_b16 a[72:73], v252 offset:20480
    ds_read_b64_tr_b16 a[74:75], v252 offset:20608
    ds_read_b64_tr_b16 a[76:77], v252 offset:22528
    ds_read_b64_tr_b16 a[78:79], v252 offset:22656
    ds_read_b64_tr_b16 a[96:97], v252 offset:16400
    ds_read_b64_tr_b16 a[98:99], v252 offset:16528
    ds_read_b64_tr_b16 a[100:101], v252 offset:18448
    ds_read_b64_tr_b16 a[102:103], v252 offset:18576
    ds_read_b64_tr_b16 a[104:105], v252 offset:20496
    ds_read_b64_tr_b16 a[106:107], v252 offset:20624
    ds_read_b64_tr_b16 a[108:109], v252 offset:22544
    ds_read_b64_tr_b16 a[110:111], v252 offset:22672
    s_waitcnt lgkmcnt(0)
    s_add_u32 m0, s98, 16384
    s_add_u32 s5, s80, 0
    buffer_load_dwordx4 v241, s[16:19], s5 offen  lds

    s_add_u32 m0, s98, 17408
    s_add_u32 s5, s80, 32768
    buffer_load_dwordx4 v241, s[16:19], s5 offen  lds

    s_add_u32 m0, s98, 18432
    s_add_u32 s5, s80, 65536
    buffer_load_dwordx4 v241, s[16:19], s5 offen  lds

    s_add_u32 m0, s98, 19456
    s_add_u32 s5, s80, 98304
    buffer_load_dwordx4 v241, s[16:19], s5 offen  lds

    s_add_u32 m0, s98, 20480
    s_add_u32 s5, s80, 131072
    buffer_load_dwordx4 v241, s[16:19], s5 offen  lds

    s_add_u32 m0, s98, 21504
    s_add_u32 s5, s80, 163840
    buffer_load_dwordx4 v241, s[16:19], s5 offen  lds

    s_add_u32 m0, s98, 22528
    s_add_u32 s5, s80, 196608
    buffer_load_dwordx4 v241, s[16:19], s5 offen  lds

    s_add_u32 m0, s98, 23552
    s_add_u32 s5, s80, 229376
    buffer_load_dwordx4 v241, s[16:19], s5 offen  lds

    v_and_b32 v241, 3, v0
    v_lshlrev_b32 v241, 2, v241
    buffer_load_dword v240, v241, s[20:23], s97 offen sc1

    s_waitcnt vmcnt(25)
    ds_read_b64_tr_b16 a[144:145], v254 offset:8192
    ds_read_b64_tr_b16 a[146:147], v254 offset:8320
    ds_read_b64_tr_b16 a[148:149], v254 offset:10240
    ds_read_b64_tr_b16 a[150:151], v254 offset:10368
    ds_read_b64_tr_b16 a[152:153], v254 offset:12288
    ds_read_b64_tr_b16 a[154:155], v254 offset:12416
    ds_read_b64_tr_b16 a[156:157], v254 offset:14336
    ds_read_b64_tr_b16 a[158:159], v254 offset:14464
    ds_read_b64_tr_b16 a[176:177], v254 offset:8224
    ds_read_b64_tr_b16 a[178:179], v254 offset:8352
    ds_read_b64_tr_b16 a[180:181], v254 offset:10272
    ds_read_b64_tr_b16 a[182:183], v254 offset:10400
    ds_read_b64_tr_b16 a[184:185], v254 offset:12320
    ds_read_b64_tr_b16 a[186:187], v254 offset:12448
    ds_read_b64_tr_b16 a[188:189], v254 offset:14368
    ds_read_b64_tr_b16 a[190:191], v254 offset:14496
    s_waitcnt vmcnt(17)
    ds_read_b64_tr_b16 a[128:129], v254 offset:0
    ds_read_b64_tr_b16 a[130:131], v254 offset:128
    ds_read_b64_tr_b16 a[132:133], v254 offset:2048
    ds_read_b64_tr_b16 a[134:135], v254 offset:2176
    ds_read_b64_tr_b16 a[136:137], v254 offset:4096
    ds_read_b64_tr_b16 a[138:139], v254 offset:4224
    ds_read_b64_tr_b16 a[140:141], v254 offset:6144
    ds_read_b64_tr_b16 a[142:143], v254 offset:6272
    ds_read_b64_tr_b16 a[160:161], v254 offset:32
    ds_read_b64_tr_b16 a[162:163], v254 offset:160
    ds_read_b64_tr_b16 a[164:165], v254 offset:2080
    ds_read_b64_tr_b16 a[166:167], v254 offset:2208
    ds_read_b64_tr_b16 a[168:169], v254 offset:4128
    ds_read_b64_tr_b16 a[170:171], v254 offset:4256
    ds_read_b64_tr_b16 a[172:173], v254 offset:6176
    ds_read_b64_tr_b16 a[174:175], v254 offset:6304
    s_waitcnt vmcnt(9)
    ds_read_b64_tr_b16 a[208:209], v255 offset:24576
    ds_read_b64_tr_b16 a[210:211], v255 offset:24704
    ds_read_b64_tr_b16 a[212:213], v255 offset:26624
    ds_read_b64_tr_b16 a[214:215], v255 offset:26752
    ds_read_b64_tr_b16 a[216:217], v255 offset:28672
    ds_read_b64_tr_b16 a[218:219], v255 offset:28800
    ds_read_b64_tr_b16 a[220:221], v255 offset:30720
    ds_read_b64_tr_b16 a[222:223], v255 offset:30848
    ds_read_b64_tr_b16 a[240:241], v255 offset:24608
    ds_read_b64_tr_b16 a[242:243], v255 offset:24736
    ds_read_b64_tr_b16 a[244:245], v255 offset:26656
    ds_read_b64_tr_b16 a[246:247], v255 offset:26784
    ds_read_b64_tr_b16 a[248:249], v255 offset:28704
    ds_read_b64_tr_b16 a[250:251], v255 offset:28832
    ds_read_b64_tr_b16 a[252:253], v255 offset:30752
    ds_read_b64_tr_b16 a[254:255], v255 offset:30880
    s_waitcnt vmcnt(1)
    ds_read_b64_tr_b16 a[192:193], v255 offset:16384
    ds_read_b64_tr_b16 a[194:195], v255 offset:16512
    ds_read_b64_tr_b16 a[196:197], v255 offset:18432
    ds_read_b64_tr_b16 a[198:199], v255 offset:18560
    ds_read_b64_tr_b16 a[200:201], v255 offset:20480
    ds_read_b64_tr_b16 a[202:203], v255 offset:20608
    ds_read_b64_tr_b16 a[204:205], v255 offset:22528
    ds_read_b64_tr_b16 a[206:207], v255 offset:22656
    ds_read_b64_tr_b16 a[224:225], v255 offset:16416
    ds_read_b64_tr_b16 a[226:227], v255 offset:16544
    ds_read_b64_tr_b16 a[228:229], v255 offset:18464
    ds_read_b64_tr_b16 a[230:231], v255 offset:18592
    ds_read_b64_tr_b16 a[232:233], v255 offset:20512
    ds_read_b64_tr_b16 a[234:235], v255 offset:20640
    ds_read_b64_tr_b16 a[236:237], v255 offset:22560
    ds_read_b64_tr_b16 a[238:239], v255 offset:22688
.pj_14:
    v_min_u32 v20, 0xfffffffe, v20
    v_min_u32 v21, 0xfffffffe, v21
    v_min_u32 v22, 0xfffffffe, v22
    v_min_u32 v23, 0xfffffffe, v23
    v_min_u32 v24, 0xfffffffe, v24
    v_min_u32 v25, 0xfffffffe, v25
    v_min_u32 v26, 0xfffffffe, v26
    v_min_u32 v27, 0xfffffffe, v27
    v_min_u32 v28, 0xfffffffe, v28
    v_min_u32 v29, 0xfffffffe, v29
    v_min_u32 v30, 0xfffffffe, v30
    v_min_u32 v31, 0xfffffffe, v31
    v_min_u32 v32, 0xfffffffe, v32
    v_min_u32 v33, 0xfffffffe, v33
    v_min_u32 v34, 0xfffffffe, v34
    v_min_u32 v35, 0xfffffffe, v35
    s_barrier
    s_cmp_ge_u32 s24, 2
    s_cbranch_scc1 .px_15
    v_xor_b32 v255, 0x10000, v255
    ds_read_b64_tr_b16 v[124:125], v255 offset:16384
    ds_read_b64_tr_b16 v[126:127], v255 offset:16512
    ds_read_b64_tr_b16 v[128:129], v255 offset:18432
    ds_read_b64_tr_b16 v[130:131], v255 offset:18560
    ds_read_b64_tr_b16 v[132:133], v255 offset:20480
    ds_read_b64_tr_b16 v[134:135], v255 offset:20608
    ds_read_b64_tr_b16 v[136:137], v255 offset:22528
    ds_read_b64_tr_b16 v[138:139], v255 offset:22656
    ds_read_b64_tr_b16 v[156:157], v255 offset:16416
    ds_read_b64_tr_b16 v[158:159], v255 offset:16544
    ds_read_b64_tr_b16 v[160:161], v255 offset:18464
    ds_read_b64_tr_b16 v[162:163], v255 offset:18592
    ds_read_b64_tr_b16 v[164:165], v255 offset:20512
    ds_read_b64_tr_b16 v[166:167], v255 offset:20640
    ds_read_b64_tr_b16 v[168:169], v255 offset:22560
    ds_read_b64_tr_b16 v[170:171], v255 offset:22688
    ds_read_b64_tr_b16 v[140:141], v255 offset:24576
    ds_read_b64_tr_b16 v[142:143], v255 offset:24704
    ds_read_b64_tr_b16 v[144:145], v255 offset:26624
    ds_read_b64_tr_b16 v[146:147], v255 offset:26752
    ds_read_b64_tr_b16 v[148:149], v255 offset:28672
    ds_read_b64_tr_b16 v[150:151], v255 offset:28800
    ds_read_b64_tr_b16 v[152:153], v255 offset:30720
    ds_read_b64_tr_b16 v[154:155], v255 offset:30848
    ds_read_b64_tr_b16 v[172:173], v255 offset:24608
    ds_read_b64_tr_b16 v[174:175], v255 offset:24736
    ds_read_b64_tr_b16 v[176:177], v255 offset:26656
    ds_read_b64_tr_b16 v[178:179], v255 offset:26784
    ds_read_b64_tr_b16 v[180:181], v255 offset:28704
    ds_read_b64_tr_b16 v[182:183], v255 offset:28832
    ds_read_b64_tr_b16 v[184:185], v255 offset:30752
    ds_read_b64_tr_b16 v[186:187], v255 offset:30880
.px_15:
    s_waitcnt vmcnt(0)
    s_mov_b32 s62, 0
.vp_18:
    v_readlane_b32 s4, v240, 0
    v_readlane_b32 s7, v240, 1
    v_readlane_b32 s6, v240, 2

    s_lshr_b32 s5, s7, 21
    s_min_u32 s4, s4, s5
    s_cmp_ge_u32 s4, 256
    s_cbranch_scc1 .vd_19
    s_cmp_lg_u32 s6, 0
    s_cbranch_scc1 .vs_20
    s_add_u32 s62, s62, 1
    s_cmp_gt_u32 s62, 0x100000
    s_cbranch_scc1 .mg_end_1
    s_sleep 8
    buffer_load_dword v240, v241, s[20:23], s97 offen sc1
    s_waitcnt vmcnt(0)
    s_branch .vp_18

.vs_20:
    s_lshr_b32 s25, s2, 5
    s_and_b32 s26, s2, 31
    s_mov_b32 s27, 1
    s_mov_b32 s99, 1
    s_mov_b32 s97, 144
    s_waitcnt vmcnt(0) lgkmcnt(0)
    s_barrier
    s_branch .mg_role_3

.vd_19:
    s_waitcnt lgkmcnt(0)
    s_barrier
    s_add_u32 s4, s79, 1
    s_and_b32 s4, s4, 3
    s_lshl_b32 s4, s4, 11
    v_add_u32 v243, s4, v246
    s_add_u32 s4, s79, 2
    s_and_b32 s4, s4, 3
    s_lshl_b32 s4, s4, 11
    v_add_u32 v252, s4, v246
    s_add_u32 s4, s79, 3
    s_and_b32 s4, s4, 3
    s_lshl_b32 s4, s4, 11
    v_add_u32 v254, s4, v246
    s_add_u32 s4, s79, 4
    s_and_b32 s4, s4, 3
    s_lshl_b32 s4, s4, 11
    v_add_u32 v246, s4, v246
    s_bfe_u32 s4, s7, 393216
    s_cmp_gt_u32 s4, 8
    s_cselect_b32 s4, 8192, 0
    s_add_u32 s4, s4, s35
    s_add_u32 s68, s4, 0

    s_bfe_u32 s4, s7, 393216
    s_cmp_gt_u32 s4, 8
    s_cselect_b32 s4, 8192, 0
    s_add_u32 s4, s4, s35
    s_add_u32 s69, s4, 1048576

    s_bfe_u32 s4, s7, 393222
    s_cmp_gt_u32 s4, 8
    s_cselect_b32 s4, 8192, 0
    s_add_u32 s4, s4, s35
    s_add_u32 s70, s4, 2097152

    s_bfe_u32 s4, s7, 393222
    s_cmp_gt_u32 s4, 8
    s_cselect_b32 s4, 8192, 0
    s_add_u32 s4, s4, s35
    s_add_u32 s71, s4, 3145728

    s_mov_b32 s62, 0x1000000
    s_cmp_ge_u32 s24, 2
    s_cbranch_scc1 .nd_21
    s_mov_b32 s62, 0
    s_mov_b64 exec, 3
.wf_22:
    buffer_load_dword v244, v253, s[8:11], s89 offen sc1
    s_waitcnt vmcnt(0)
    v_cmp_gt_u32 vcc, 1, v244
    s_cbranch_vccz .wfd_23
    s_sleep 2
    s_add_u32 s62, s62, 1
    s_cmp_gt_u32 s62, 0x400000
    s_cbranch_scc1 .mg_end_1
    s_branch .wf_22

.wfd_23:
    s_mov_b64 exec, -1
    v_readlane_b32 s4, v244, 0
    v_readlane_b32 s93, v244, 1
    s_min_u32 s93, s93, s4
    s_mov_b32 s62, 0x1000000
    s_mov_b32 m0, s90
    s_nop 0
    buffer_load_dwordx4 v14, s[8:11], s38 offen offset:0 lds
    buffer_load_dwordx4 v14, s[8:11], s38 offen offset:1024 lds
    buffer_load_dwordx4 v14, s[8:11], s38 offen offset:2048 lds
    buffer_load_dwordx4 v14, s[8:11], s38 offen offset:3072 lds
    s_mov_b32 m0, s91
    s_nop 0
    buffer_load_dwordx4 v14, s[8:11], s39 offen lds
    v_mov_b32 v4, s93
    v_mov_b32 v5, 19968
    ds_write_b32 v5, v4
    s_waitcnt vmcnt(0) lgkmcnt(0)
.nd_21:
    s_add_u32 s38, s38, 262144
    s_add_u32 s39, s39, 262144
    s_and_b32 s4, s28, 3
    s_lshl_b32 s5, s4, 17
    s_add_u32 s29, s5, s34
    s_xor_b32 s6, s5, 262144
    s_add_u32 s31, s6, s34
    s_add_u32 s32, s29, 20480
    s_add_u32 s33, s29, 24576
    s_mov_b64 s[14:15], 0
    s_barrier
    s_cmp_lt_u32 s24, 2
    s_cbranch_scc1 .k0_26
    ds_read_b128 v[128:131], v228 offset:0
    ds_read_b128 v[144:147], v228 offset:4096
    ds_read_b128 v[132:135], v229 offset:0
    ds_read_b128 v[148:151], v229 offset:4096
    ds_read_b128 v[136:139], v230 offset:0
    ds_read_b128 v[152:155], v230 offset:4096
    ds_read_b128 v[140:143], v231 offset:0
    ds_read_b128 v[156:159], v231 offset:4096
    ds_read_b128 v[160:163], v14 offset:28672
    ds_read_b128 v[164:167], v14 offset:29696
.k0_26:
    s_cmp_lg_u32 s27, 0
    s_cbranch_scc1 .ent1_25
    s_branch .ent0_24
.p2align 6
.top_27:
    s_barrier
    buffer_load_dwordx4 v[20:23], v8, s[8:11], s29 offen offset:0 sc1
    v_mov_b32 v52, 0
    buffer_load_dwordx4 v[24:27], v8, s[8:11], s29 offen offset:1024 sc1
    v_mov_b32 v53, 0
    buffer_load_dwordx4 v[28:31], v8, s[8:11], s29 offen offset:2048 sc1
    v_mov_b32 v54, 0
    buffer_load_dwordx4 v[32:35], v8, s[8:11], s29 offen offset:3072 sc1
.ent0_24:
    s_waitcnt vmcnt(3)
    v_max3_u32 v4, v20, v21, v22
    v_max_u32 v4, v4, v23
    v_cmp_eq_u32 vcc, -1, v4
    s_cbranch_vccnz .A_32
.W_33:
    v_smfmac_f32_16x16x64_bf16 v[52:55], v[20:23], a[0:7], v9
    v_smfmac_f32_16x16x64_bf16 v[56:59], v[20:23], a[32:39], v9
    s_waitcnt vmcnt(2)
    v_max3_u32 v4, v24, v25, v26
    v_max_u32 v4, v4, v27
    v_smfmac_f32_16x16x64_bf16 v[60:63], v[20:23], a[64:71], v9
    v_cmp_eq_u32 vcc, -1, v4
    v_smfmac_f32_16x16x64_bf16 v[64:67], v[20:23], a[96:103], v9
    s_cbranch_vccnz .A_34
.W_35:
    v_smfmac_f32_16x16x64_bf16 v[52:55], v[24:27], a[8:15], v9
    v_smfmac_f32_16x16x64_bf16 v[56:59], v[24:27], a[40:47], v9
    s_waitcnt vmcnt(1)
    v_max3_u32 v4, v28, v29, v30
    v_max_u32 v4, v4, v31
    v_smfmac_f32_16x16x64_bf16 v[60:63], v[24:27], a[72:79], v9
    v_cmp_eq_u32 vcc, -1, v4
    v_smfmac_f32_16x16x64_bf16 v[64:67], v[24:27], a[104:111], v9
    s_cbranch_vccnz .A_36
.W_37:
    v_smfmac_f32_16x16x64_bf16 v[52:55], v[28:31], a[16:23], v9
    v_smfmac_f32_16x16x64_bf16 v[56:59], v[28:31], a[48:55], v9
    s_waitcnt vmcnt(0)
    v_max3_u32 v4, v32, v33, v34
    v_max_u32 v4, v4, v35
    v_smfmac_f32_16x16x64_bf16 v[60:63], v[28:31], a[80:87], v9
    v_cmp_eq_u32 vcc, -1, v4
    v_smfmac_f32_16x16x64_bf16 v[64:67], v[28:31], a[112:119], v9
    s_cbranch_vccnz .A_38
.W_39:
    v_smfmac_f32_16x16x64_bf16 v[52:55], v[32:35], a[24:31], v9
    v_smfmac_f32_16x16x64_bf16 v[56:59], v[32:35], a[56:63], v9
    v_smfmac_f32_16x16x64_bf16 v[60:63], v[32:35], a[88:95], v9
    v_smfmac_f32_16x16x64_bf16 v[64:67], v[32:35], a[120:127], v9
.mj_31:
    v_cvt_pk_bf16_f32 v104, v52, v53
    v_cvt_pk_bf16_f32 v105, v54, v55
    v_cvt_pk_bf16_f32 v106, v56, v57
    v_cvt_pk_bf16_f32 v107, v58, v59
    ds_write_b64 v16, v[104:105] offset:4096
    v_cvt_pk_bf16_f32 v108, v60, v61
    v_cvt_pk_bf16_f32 v109, v62, v63
    ds_write_b64 v16, v[106:107] offset:6144
    ds_write_b64 v16, v[108:109] offset:0
    v_cvt_pk_bf16_f32 v110, v64, v65
    v_cvt_pk_bf16_f32 v111, v66, v67
    ds_write_b64 v16, v[110:111] offset:2048
    v_smfmac_f32_16x16x64_bf16 v[68:71], v[20:23], a[128:135], v9
    v_smfmac_f32_16x16x64_bf16 v[72:75], v[20:23], a[160:167], v9
    s_waitcnt lgkmcnt(0)
    s_barrier
    ds_read_b128 v[36:39], v17 offset:0
    ds_read_b128 v[40:43], v17 offset:1024
    v_smfmac_f32_16x16x64_bf16 v[68:71], v[24:27], a[136:143], v9
    v_smfmac_f32_16x16x64_bf16 v[72:75], v[24:27], a[168:175], v9
    s_waitcnt lgkmcnt(1)
    v_mfma_f32_16x16x32_bf16 v[44:47], v[36:39], v[84:87], 0
    s_waitcnt lgkmcnt(0)
    v_mfma_f32_16x16x32_bf16 v[44:47], v[40:43], v[84:87], v[44:47]
    v_smfmac_f32_16x16x64_bf16 v[68:71], v[28:31], a[144:151], v9
    v_smfmac_f32_16x16x64_bf16 v[72:75], v[28:31], a[176:183], v9
    s_mov_b64 exec, s[64:65]
    v_cvt_pk_bf16_f32 v48, v44, v45
    v_cvt_pk_bf16_f32 v49, v46, v47
    v_min_u32 v48, 0xfffffffe, v48
    v_min_u32 v49, 0xfffffffe, v49
    buffer_store_dwordx2 v[48:49], v10, s[8:11], s29 offen

    ds_write_b64 v18, v[48:49]
    s_mov_b64 exec, -1

    v_smfmac_f32_16x16x64_bf16 v[68:71], v[32:35], a[152:159], v9
    v_smfmac_f32_16x16x64_bf16 v[72:75], v[32:35], a[184:191], v9
    s_nop 3
    v_cvt_pk_bf16_f32 v104, v68, v69
    v_cvt_pk_bf16_f32 v105, v70, v71
    ds_write_b64 v16, v[104:105] offset:8192
    s_nop 0
    v_cvt_pk_bf16_f32 v106, v72, v73
    v_cvt_pk_bf16_f32 v107, v74, v75
    ds_write_b64 v16, v[106:107] offset:10240
    s_cmp_lg_u32 s24, 2
    s_waitcnt lgkmcnt(0)
    s_barrier
    s_cbranch_scc1 .oth_28
    buffer_load_dwordx4 v[92:95], v232, s[8:11], s29 offen sc1
    buffer_load_dwordx4 v[96:99], v233, s[8:11], s29 offen sc1
    buffer_load_dwordx4 v[100:103], v234, s[8:11], s29 offen sc1
    ds_read_b128 v[88:91], v14 offset:16384
    s_cmp_eq_u32 s28, 63
    s_cbranch_scc1 .rec_fin_6
    s_waitcnt lgkmcnt(0)
    v_mfma_f32_16x16x32_bf16 v[208:211], v[128:131], v[88:91], 0
    v_mfma_f32_16x16x32_bf16 v[212:215], v[144:147], v[88:91], 0
    v_mfma_f32_16x16x32_bf16 v[216:219], v[88:91], v[88:91], v[116:119]
    s_waitcnt vmcnt(2)
    v_max3_u32 v4, v92, v93, v94
    v_max_u32 v4, v4, v95
    v_cmp_eq_u32 vcc, -1, v4
    s_cbranch_vccnz .A_41
.W_42:
    v_mfma_f32_16x16x32_bf16 v[208:211], v[132:135], v[92:95], v[208:211]
    s_waitcnt vmcnt(1)
    v_max3_u32 v4, v96, v97, v98
    v_max_u32 v4, v4, v99
    v_mfma_f32_16x16x32_bf16 v[212:215], v[148:151], v[92:95], v[212:215]
    v_cmp_eq_u32 vcc, -1, v4
    v_mfma_f32_16x16x32_bf16 v[216:219], v[92:95], v[92:95], v[216:219]
    s_cbranch_vccnz .A_43
.W_44:
    v_mfma_f32_16x16x32_bf16 v[208:211], v[136:139], v[96:99], v[208:211]
    s_waitcnt vmcnt(0)
    v_max3_u32 v4, v100, v101, v102
    v_max_u32 v4, v4, v103
    v_mfma_f32_16x16x32_bf16 v[212:215], v[152:155], v[96:99], v[212:215]
    v_cmp_eq_u32 vcc, -1, v4
    v_mfma_f32_16x16x32_bf16 v[216:219], v[96:99], v[96:99], v[216:219]
    s_cbranch_vccnz .A_45
.W_46:
    v_mfma_f32_16x16x32_bf16 v[208:211], v[140:143], v[100:103], v[208:211]
    v_mfma_f32_16x16x32_bf16 v[212:215], v[156:159], v[100:103], v[212:215]
    v_mfma_f32_16x16x32_bf16 v[216:219], v[100:103], v[100:103], v[216:219]
.mj_40:
    s_barrier
    ds_read_b64 v[168:169], v14 offset:18432
    ds_read_b64 v[172:173], v14 offset:18440
    s_nop 0

    v_mov_b32_dpp v208, v212 row_ror:8 row_mask:0xf bank_mask:0xc
    v_mov_b32_dpp v209, v213 row_ror:8 row_mask:0xf bank_mask:0xc
    v_mov_b32_dpp v210, v214 row_ror:8 row_mask:0xf bank_mask:0xc
    v_mov_b32_dpp v211, v215 row_ror:8 row_mask:0xf bank_mask:0xc
    v_mov_b32_dpp v216, v218 row_ror:8 row_mask:0xf bank_mask:0xc
    v_mov_b32_dpp v217, v219 row_ror:8 row_mask:0xf bank_mask:0xc
    v_max3_f32 v4, v208, v209, v210
    v_max3_f32 v5, v211, v216, v217
    v_max_f32 v6, v4, v5
    v_max_f32 v4, v4, v5
    s_nop 1
    v_permlane32_swap_b32 v4, v6
    v_max_f32 v5, v4, v6
    v_max_f32 v4, v4, v6
    s_nop 1
    v_permlane16_swap_b32 v4, v5
    v_max_f32 v4, v4, v5
    s_nop 1
    v_max_f32_dpp v4, v4, v4 row_ror:8 row_mask:0xf bank_mask:0xf
    v_mul_f32 v4, s37, v4

    v_fma_f32 v104, v208, s37, -v4
    v_fma_f32 v105, v209, s37, -v4
    v_fma_f32 v106, v210, s37, -v4
    v_fma_f32 v107, v211, s37, -v4
    v_fma_f32 v108, v216, s37, -v4
    v_fma_f32 v109, v217, s37, -v4
    v_exp_f32 v104, v104
    v_exp_f32 v105, v105
    v_exp_f32 v106, v106
    v_exp_f32 v107, v107
    v_exp_f32 v108, v108
    v_exp_f32 v109, v109
    v_cvt_pk_bf16_f32 v176, v104, v105
    v_cvt_pk_bf16_f32 v177, v106, v107
    v_cvt_pk_bf16_f32 v180, v108, v109
    v_mov_b32_dpp v178, v176 row_ror:8 row_mask:0xf bank_mask:0xf
    v_mov_b32_dpp v179, v177 row_ror:8 row_mask:0xf bank_mask:0xf
    v_mov_b32_dpp v181, v180 row_ror:8 row_mask:0xf bank_mask:0xf
    s_waitcnt lgkmcnt(0)

    v_mfma_f32_16x16x32_bf16 v[208:211], v[120:123], v[176:179], 0
    v_mfma_f32_16x16x32_bf16 v[208:211], v[120:123], v[180:183], v[208:211]
    v_mfma_f32_16x16x32_bf16 v[212:215], v[160:163], v[176:179], 0
    v_mfma_f32_16x16x32_bf16 v[216:219], v[164:167], v[176:179], 0
    v_mfma_f32_16x16x32_bf16 v[212:215], v[168:171], v[180:183], v[212:215]
    v_rcp_f32 v4, v208
    v_mfma_f32_16x16x32_bf16 v[216:219], v[172:175], v[180:183], v[216:219]
    s_mov_b64 exec, s[58:59]
    s_nop 2
    v_mul_f32 v212, v4, v212
    v_mul_f32 v213, v4, v213
    v_mul_f32 v214, v4, v214
    v_mul_f32 v215, v4, v215
    v_cvt_pk_bf16_f32 v184, v212, v213
    v_cvt_pk_bf16_f32 v185, v214, v215
    v_mul_f32 v216, v4, v216
    v_mul_f32 v217, v4, v217
    v_min_u32 v184, 0xfffffffe, v184
    v_min_u32 v185, 0xfffffffe, v185
    v_mul_f32 v218, v4, v218
    v_mul_f32 v219, v4, v219
    v_cvt_pk_bf16_f32 v186, v216, v217
    v_cvt_pk_bf16_f32 v187, v218, v219
    v_min_u32 v186, 0xfffffffe, v186
    v_min_u32 v187, 0xfffffffe, v187
    buffer_store_dwordx4 v[184:187], v13, s[8:11], s29 offen
    s_mov_b64 exec, -1

.gp_30:
    s_barrier
    v_mov_b32 v5, 19968
    ds_read_b32 v4, v5
    s_mov_b32 s99, s68
    s_waitcnt vmcnt(0)
    s_cmp_eq_u32 s24, 3
    s_cbranch_scc1 .u3_47
    s_add_u32 s6, s28, 3
    s_add_u32 s7, s30, 262144
    s_waitcnt lgkmcnt(0)
    v_readfirstlane_b32 s5, v4
    s_cmp_lt_u32 s5, s6
    s_barrier
    s_cbranch_scc1 .np_49
    buffer_load_dword v226, v225, s[8:11], s7 offen

.np_49:
    s_add_u32 s4, s70, 0
    buffer_store_dwordx4 v[188:191], v238, s[8:11], s4 offen sc1
    s_add_u32 s4, s70, 262144
    buffer_store_dwordx4 v[188:191], v238, s[8:11], s4 offen sc1
    s_branch .u4_48
.u3_47:
    s_sub_u32 s4, s36, 0
    s_barrier
    s_mov_b64 exec, s[66:67]
    buffer_store_dwordx4 v[88:91], v11, s[8:11], s4 offen sc1
    s_mov_b64 exec, s[56:57]
    buffer_store_dwordx4 v[172:175], v12, s[8:11], s4 offen sc1
    s_mov_b64 exec, -1

.u4_48:
    s_barrier
    s_add_u32 s28, s28, 1
    s_add_u32 s36, s36, 196608
    s_cmp_lt_u32 s28, 63
    s_cselect_b32 s4, 262144, 0
    s_add_u32 s38, s38, s4
    s_add_u32 s39, s39, s4
    s_add_u32 s30, s30, s4
    s_mov_b32 s4, s68
    s_mov_b32 s68, s69
    s_mov_b32 s69, s70
    s_mov_b32 s70, s71
    s_mov_b32 s71, s4
    s_and_b32 s4, s28, 3
    s_lshl_b32 s5, s4, 17
    s_add_u32 s29, s5, s34
    s_xor_b32 s6, s5, 262144
    s_add_u32 s31, s6, s34
    s_add_u32 s32, s29, 20480
    s_add_u32 s33, s29, 24576
    v_mov_b32 v55, 0
    v_mov_b32 v56, 0
    v_mov_b32 v57, 0
    v_mov_b32 v58, 0
    v_mov_b32 v59, 0
    v_mov_b32 v60, 0
    v_mov_b32 v61, 0
    v_mov_b32 v62, 0
    v_mov_b32 v63, 0
    v_mov_b32 v64, 0
    v_mov_b32 v65, 0
    v_mov_b32 v66, 0
    v_mov_b32 v67, 0
    v_mov_b32 v68, 0
    v_mov_b32 v69, 0
    v_mov_b32 v70, 0
    v_mov_b32 v71, 0
    v_mov_b32 v72, 0
    v_mov_b32 v73, 0
    v_mov_b32 v74, 0
    v_mov_b32 v75, 0
    v_mov_b32 v20, -1
    v_mov_b32 v21, -1
    v_mov_b32 v22, -1
    v_mov_b32 v23, -1
    v_mov_b32 v24, -1
    v_mov_b32 v25, -1
    v_mov_b32 v26, -1
    v_mov_b32 v27, -1
    v_mov_b32 v28, -1
    v_mov_b32 v29, -1
    v_mov_b32 v30, -1
    v_mov_b32 v31, -1
    v_mov_b32 v32, -1
    v_mov_b32 v33, -1
    v_mov_b32 v34, -1
    v_mov_b32 v35, -1
    v_mov_b32 v92, -1
    v_mov_b32 v93, -1
    v_mov_b32 v94, -1
    v_mov_b32 v95, -1
    v_mov_b32 v96, -1
    v_mov_b32 v97, -1
    v_mov_b32 v98, -1
    v_mov_b32 v99, -1
    v_mov_b32 v100, -1
    v_mov_b32 v101, -1
    v_mov_b32 v102, -1
    v_mov_b32 v103, -1
    s_add_u32 s4, s99, 0
    buffer_load_dwordx4 v[192:195], v239, s[8:11], s4 offen sc1
    buffer_load_dwordx4 v[196:199], v249, s[8:11], s4 offen sc1

    ds_read_b128 v[128:131], v228 offset:0
    ds_read_b128 v[144:147], v228 offset:4096
    ds_read_b128 v[132:135], v229 offset:0
    ds_read_b128 v[148:151], v229 offset:4096
    ds_read_b128 v[136:139], v230 offset:0
    ds_read_b128 v[152:155], v230 offset:4096
    ds_read_b128 v[140:143], v231 offset:0
    ds_read_b128 v[156:159], v231 offset:4096
    ds_read_b128 v[160:163], v14 offset:28672
    ds_read_b128 v[164:167], v14 offset:29696
    ds_read_b128 v[108:111], v248
    s_waitcnt lgkmcnt(0)
    v_mfma_f32_16x16x32_bf16 v[76:79], v[108:111], v[112:115], 0
    s_add_u32 s4, s99, 262144
    buffer_load_dwordx4 v[200:203], v239, s[8:11], s4 offen sc1
    buffer_load_dwordx4 v[204:207], v249, s[8:11], s4 offen sc1

.gc_50:
    s_waitcnt vmcnt(2)

    v_max_u32 v4, v192, v196
    v_cmp_eq_u32 vcc, -1, v4
    s_cbranch_vccnz .gf_51
    v_mfma_f32_16x16x32_bf16 v[76:79], v[192:195], v[84:87], v[76:79]
    v_mfma_f32_16x16x32_bf16 v[76:79], v[196:199], v[112:115], v[76:79]
    s_mov_b64 exec, s[58:59]
    s_nop 6
    v_cvt_pk_bf16_f32 v104, v76, v77
    v_cvt_pk_bf16_f32 v105, v78, v79
    v_min_u32 v104, 0xfffffffe, v104
    v_min_u32 v105, 0xfffffffe, v105
    buffer_store_dwordx2 v[104:105], v15, s[8:11], s29 offen
    s_mov_b64 exec, -1

    s_branch .top_27
.gf_51:
    s_add_u32 s4, s99, 0
    buffer_load_dwordx4 v[192:195], v239, s[8:11], s4 offen sc1
    buffer_load_dwordx4 v[196:199], v249, s[8:11], s4 offen sc1

    s_waitcnt vmcnt(2)

    v_max_u32 v4, v200, v204
    v_cmp_eq_u32 vcc, -1, v4
    s_cbranch_vccnz .gf_52
    v_mfma_f32_16x16x32_bf16 v[76:79], v[200:203], v[84:87], v[76:79]
    v_mfma_f32_16x16x32_bf16 v[76:79], v[204:207], v[112:115], v[76:79]
    s_mov_b64 exec, s[58:59]
    s_nop 6
    v_cvt_pk_bf16_f32 v104, v76, v77
    v_cvt_pk_bf16_f32 v105, v78, v79
    v_min_u32 v104, 0xfffffffe, v104
    v_min_u32 v105, 0xfffffffe, v105
    buffer_store_dwordx2 v[104:105], v15, s[8:11], s29 offen
    s_mov_b64 exec, -1

    s_branch .top_27
.gf_52:
    s_add_u32 s4, s99, 262144
    buffer_load_dwordx4 v[200:203], v239, s[8:11], s4 offen sc1
    buffer_load_dwordx4 v[204:207], v249, s[8:11], s4 offen sc1

    s_sub_u32 s62, s62, 1
    s_cbranch_scc1 .mg_end_1
    s_branch .gc_50
.oth_28:
    s_cmp_eq_u32 s24, 3
    s_cbranch_scc1 .w3_29
    s_cmp_eq_u32 s28, 63
    s_cbranch_scc1 .rec_fin_6
    s_add_u32 s6, s28, 4
    s_cmp_ge_u32 s93, s6
    s_cbranch_scc1 .nl_53
    s_buffer_load_dword s14, s[8:11], s89 glc
    s_buffer_load_dword s15, s[8:11], s89 offset:8192 glc

.nl_53:
    s_waitcnt vmcnt(0)
    v_mov_b32 v71, 0
    v_mov_b32 v72, 0
    v_mov_b32 v73, 0
    v_mov_b32 v74, 0
    v_mov_b32 v75, 0
    s_barrier
    s_add_u32 s6, s28, 2
    s_min_u32 s6, s6, 64
    s_cmp_lt_u32 s93, s6
    s_cbranch_scc1 .kf_54
.kb_55:
    s_mov_b32 m0, s90
    s_nop 0
    buffer_load_dwordx4 v14, s[8:11], s38 offen offset:0 lds
    buffer_load_dwordx4 v14, s[8:11], s38 offen offset:1024 lds
    buffer_load_dwordx4 v14, s[8:11], s38 offen offset:2048 lds
    buffer_load_dwordx4 v14, s[8:11], s38 offen offset:3072 lds
    s_mov_b32 m0, s91
    s_nop 0
    buffer_load_dwordx4 v14, s[8:11], s39 offen lds
    s_barrier
    v_mov_b32 v20, -1
    v_mov_b32 v21, -1
    v_mov_b32 v22, -1
    v_mov_b32 v23, -1
    v_mov_b32 v24, -1
    v_mov_b32 v25, -1
    v_mov_b32 v26, -1
    v_mov_b32 v27, -1
    v_mov_b32 v28, -1
    v_mov_b32 v29, -1
    v_mov_b32 v30, -1
    v_mov_b32 v31, -1
    v_mov_b32 v32, -1
    v_mov_b32 v33, -1
    v_mov_b32 v34, -1
    v_mov_b32 v35, -1
    v_mov_b32 v55, 0
    v_mov_b32 v56, 0
    v_mov_b32 v57, 0
    v_mov_b32 v58, 0
    v_mov_b32 v59, 0
    v_mov_b32 v60, 0
    v_mov_b32 v61, 0
    v_mov_b32 v62, 0
    v_mov_b32 v63, 0
    v_mov_b32 v64, 0
    v_mov_b32 v65, 0
    v_mov_b32 v66, 0
    v_mov_b32 v67, 0
    v_mov_b32 v68, 0
    v_mov_b32 v69, 0
    v_mov_b32 v70, 0
    buffer_load_dwordx4 v[192:195], v243, s[8:11], s32 offen offset:0 sc1
    buffer_load_dwordx4 v[196:199], v243, s[8:11], s32 offen offset:1024 sc1
    v_mov_b32 v76, 0
    buffer_load_dwordx4 v[200:203], v252, s[8:11], s32 offen offset:0 sc1
    buffer_load_dwordx4 v[204:207], v252, s[8:11], s32 offen offset:1024 sc1
    v_mov_b32 v77, 0
    buffer_load_dwordx4 v[208:211], v254, s[8:11], s32 offen offset:0 sc1
    buffer_load_dwordx4 v[212:215], v254, s[8:11], s32 offen offset:1024 sc1
    v_mov_b32 v78, 0
    buffer_load_dwordx4 v[216:219], v246, s[8:11], s32 offen offset:0 sc1
    buffer_load_dwordx4 v[220:223], v246, s[8:11], s32 offen offset:1024 sc1
    s_waitcnt vmcnt(6)
    v_max3_u32 v4, v192, v193, v194
    v_max3_u32 v5, v195, v196, v197
    v_max3_u32 v4, v4, v198, v199
    v_max_u32 v4, v4, v5
    v_cmp_eq_u32 vcc, -1, v4
    s_cbranch_vccnz .A_57
.W_58:
    v_smfmac_f32_16x16x64_bf16 v[76:79], v[192:195], a[192:199], v9
    v_smfmac_f32_16x16x64_bf16 v[80:83], v[192:195], a[224:231], v9
    s_waitcnt vmcnt(4)
    v_max3_u32 v4, v200, v201, v202
    v_max3_u32 v5, v203, v204, v205
    v_max3_u32 v4, v4, v206, v207
    v_smfmac_f32_16x16x64_bf16 v[76:79], v[196:199], a[200:207], v9
    v_max_u32 v4, v4, v5
    v_cmp_eq_u32 vcc, -1, v4
    v_smfmac_f32_16x16x64_bf16 v[80:83], v[196:199], a[232:239], v9
    s_cbranch_vccnz .A_59
.W_60:
    v_smfmac_f32_16x16x64_bf16 v[76:79], v[200:203], a[208:215], v9
    v_smfmac_f32_16x16x64_bf16 v[80:83], v[200:203], a[240:247], v9
    s_waitcnt vmcnt(2)
    v_max3_u32 v4, v208, v209, v210
    v_max3_u32 v5, v211, v212, v213
    v_max3_u32 v4, v4, v214, v215
    v_smfmac_f32_16x16x64_bf16 v[76:79], v[204:207], a[216:223], v9
    v_max_u32 v4, v4, v5
    v_cmp_eq_u32 vcc, -1, v4
    v_smfmac_f32_16x16x64_bf16 v[80:83], v[204:207], a[248:255], v9
    s_cbranch_vccnz .A_61
.W_62:
    v_smfmac_f32_16x16x64_bf16 v[76:79], v[208:211], v[124:131], v9
    v_smfmac_f32_16x16x64_bf16 v[80:83], v[208:211], v[156:163], v9
    s_waitcnt vmcnt(0)
    v_max3_u32 v4, v216, v217, v218
    v_max3_u32 v5, v219, v220, v221
    v_max3_u32 v4, v4, v222, v223
    v_smfmac_f32_16x16x64_bf16 v[76:79], v[212:215], v[132:139], v9
    v_max_u32 v4, v4, v5
    v_cmp_eq_u32 vcc, -1, v4
    v_smfmac_f32_16x16x64_bf16 v[80:83], v[212:215], v[164:171], v9
    s_cbranch_vccnz .A_63
.W_64:
    v_smfmac_f32_16x16x64_bf16 v[76:79], v[216:219], v[140:147], v9
    v_smfmac_f32_16x16x64_bf16 v[80:83], v[216:219], v[172:179], v9
    v_smfmac_f32_16x16x64_bf16 v[76:79], v[220:223], v[148:155], v9
    v_smfmac_f32_16x16x64_bf16 v[80:83], v[220:223], v[180:187], v9
.mj_56:
    s_barrier
    s_nop 7
    v_permlane32_swap_b32 v76, v80
    v_permlane32_swap_b32 v77, v81
    v_permlane32_swap_b32 v78, v82
    v_permlane32_swap_b32 v79, v83
    v_add_f32 v76, v76, v80
    v_add_f32 v77, v77, v81
    v_add_f32 v78, v78, v82
    v_add_f32 v79, v79, v83
    v_cvt_pk_bf16_f32 v104, v76, v77
    v_cvt_pk_bf16_f32 v106, v76, v77
    v_cvt_pk_bf16_f32 v105, v78, v79
    v_cvt_pk_bf16_f32 v107, v78, v79
    v_permlane16_swap_b32 v104, v106
    s_nop 0
    v_permlane16_swap_b32 v105, v107
    v_min_u32 v104, 0xfffffffe, v104
    buffer_store_dwordx4 v[104:107], v237, s[8:11], s68 offen sc1

    ds_write_b128 v247, v[104:107]
    s_waitcnt lgkmcnt(0)
    s_barrier
    s_min_u32 s4, s14, s15
    s_max_u32 s93, s93, s4
    v_mov_b32 v4, s93
    v_mov_b32 v5, 19968
    ds_write_b32 v5, v4
    v_mov_b32 v79, 0
    v_mov_b32 v80, 0
    v_mov_b32 v81, 0
    v_mov_b32 v82, 0
    v_mov_b32 v83, 0
    s_waitcnt vmcnt(1)
    v_mov_b32 v192, -1
    v_mov_b32 v193, -1
    v_mov_b32 v194, -1
    v_mov_b32 v195, -1
    v_mov_b32 v196, -1
    v_mov_b32 v197, -1
    v_mov_b32 v198, -1
    v_mov_b32 v199, -1
    v_mov_b32 v200, -1
    v_mov_b32 v201, -1
    v_mov_b32 v202, -1
    v_mov_b32 v203, -1
    v_mov_b32 v204, -1
    v_mov_b32 v205, -1
    v_mov_b32 v206, -1
    v_mov_b32 v207, -1
    v_mov_b32 v208, -1
    v_mov_b32 v209, -1
    v_mov_b32 v210, -1
    v_mov_b32 v211, -1
    v_mov_b32 v212, -1
    v_mov_b32 v213, -1
    v_mov_b32 v214, -1
    v_mov_b32 v215, -1
    v_mov_b32 v216, -1
    v_mov_b32 v217, -1
    v_mov_b32 v218, -1
    v_mov_b32 v219, -1
    v_mov_b32 v220, -1
    v_mov_b32 v221, -1
    v_mov_b32 v222, -1
    v_mov_b32 v223, -1
    s_add_u32 s28, s28, 1
    s_add_u32 s36, s36, 196608
    s_cmp_lt_u32 s28, 63
    s_cselect_b32 s4, 262144, 0
    s_add_u32 s38, s38, s4
    s_add_u32 s39, s39, s4
    s_add_u32 s30, s30, s4
    s_mov_b32 s4, s68
    s_mov_b32 s68, s69
    s_mov_b32 s69, s70
    s_mov_b32 s70, s71
    s_mov_b32 s71, s4
    s_and_b32 s4, s28, 3
    s_lshl_b32 s5, s4, 17
    s_add_u32 s29, s5, s34
    s_xor_b32 s6, s5, 262144
    s_add_u32 s31, s6, s34
    s_add_u32 s32, s29, 20480
    s_add_u32 s33, s29, 24576
    s_branch .top_27
.w3_29:
    ds_read_b128 v[36:39], v14 offset:8192
    ds_read_b128 v[40:43], v14 offset:9216
    ds_read_b128 v[44:47], v14 offset:10240
    ds_read_b128 v[48:51], v14 offset:11264
    ds_read_b128 v[88:91], v14 offset:16384
    s_waitcnt lgkmcnt(0)
    v_mfma_f32_16x16x32_bf16 v[104:107], v[84:87], v[36:39], 0
    v_mfma_f32_16x16x32_bf16 v[108:111], v[84:87], v[44:47], 0
    v_mfma_f32_16x16x32_bf16 v[104:107], v[84:87], v[40:43], v[104:107]
    v_mfma_f32_16x16x32_bf16 v[108:111], v[84:87], v[48:51], v[108:111]
    s_nop 7
    v_cvt_pk_bf16_f32 v168, v104, v105
    v_cvt_pk_bf16_f32 v169, v106, v107
    v_cvt_pk_bf16_f32 v170, v108, v109
    v_cvt_pk_bf16_f32 v171, v110, v111
    ds_write_b128 v14, v[168:171] offset:18432
    v_cndmask_b32 v172, v170, v168, s[60:61]
    v_cndmask_b32 v173, v171, v169, s[60:61]
    v_min_u32 v172, 0xfffffffe, v172
    v_min_u32 v173, 0xfffffffe, v173
    v_mov_b32 v174, v172
    v_mov_b32 v175, v173
    s_cmp_eq_u32 s28, 63
    s_nop 0
    v_permlane16_swap_b32 v172, v174
    v_permlane16_swap_b32 v173, v175
    ds_write_b128 v14, v[172:175] offset:17408

    s_cbranch_scc1 .sk_65
    s_waitcnt lgkmcnt(0)
    s_barrier
    buffer_store_dwordx4 v[188:191], v235, s[8:11], s31 offen
    buffer_store_dwordx4 v[188:191], v236, s[8:11], s31 offen

    s_branch .gp_30
.A_66:
    s_mov_b64 exec, vcc
    buffer_load_dwordx4 v[32:35], v8, s[8:11], s29 offen offset:3072 sc1
    s_mov_b64 exec, -1
    s_sub_u32 s62, s62, 1
    s_cbranch_scc1 .mg_end_1
    s_waitcnt vmcnt(3)
    v_max3_u32 v4, v20, v21, v22
    v_max_u32 v4, v4, v23
    v_cmp_eq_u32 vcc, -1, v4
    s_cbranch_vccz .W_33
.A_32:
    s_mov_b64 exec, vcc
    buffer_load_dwordx4 v[20:23], v8, s[8:11], s29 offen offset:0 sc1
    s_mov_b64 exec, -1
    s_waitcnt vmcnt(3)
    v_max3_u32 v4, v24, v25, v26
    v_max_u32 v4, v4, v27
    v_cmp_eq_u32 vcc, -1, v4
    s_cbranch_vccz .W_67
.A_68:
    s_mov_b64 exec, vcc
    buffer_load_dwordx4 v[24:27], v8, s[8:11], s29 offen offset:1024 sc1
    s_mov_b64 exec, -1
    s_waitcnt vmcnt(3)
    v_max3_u32 v4, v28, v29, v30
    v_max_u32 v4, v4, v31
    v_cmp_eq_u32 vcc, -1, v4
    s_cbranch_vccz .W_69
.A_70:
    s_mov_b64 exec, vcc
    buffer_load_dwordx4 v[28:31], v8, s[8:11], s29 offen offset:2048 sc1
    s_mov_b64 exec, -1
    s_waitcnt vmcnt(3)
    v_max3_u32 v4, v32, v33, v34
    v_max_u32 v4, v4, v35
    v_cmp_eq_u32 vcc, -1, v4
    s_cbranch_vccnz .A_66
.W_71:
    v_smfmac_f32_16x16x64_bf16 v[52:55], v[32:35], a[24:31], v9
    v_smfmac_f32_16x16x64_bf16 v[56:59], v[32:35], a[56:63], v9
    s_waitcnt vmcnt(2)
    v_max3_u32 v4, v20, v21, v22
    v_max_u32 v4, v4, v23
    v_smfmac_f32_16x16x64_bf16 v[60:63], v[32:35], a[88:95], v9
    v_cmp_eq_u32 vcc, -1, v4
    v_smfmac_f32_16x16x64_bf16 v[64:67], v[32:35], a[120:127], v9
    s_cbranch_vccnz .A_72
.W_73:
    v_smfmac_f32_16x16x64_bf16 v[52:55], v[20:23], a[0:7], v9
    v_smfmac_f32_16x16x64_bf16 v[56:59], v[20:23], a[32:39], v9
    s_waitcnt vmcnt(1)
    v_max3_u32 v4, v24, v25, v26
    v_max_u32 v4, v4, v27
    v_smfmac_f32_16x16x64_bf16 v[60:63], v[20:23], a[64:71], v9
    v_cmp_eq_u32 vcc, -1, v4
    v_smfmac_f32_16x16x64_bf16 v[64:67], v[20:23], a[96:103], v9
    s_cbranch_vccnz .A_74
.W_75:
    v_smfmac_f32_16x16x64_bf16 v[52:55], v[24:27], a[8:15], v9
    v_smfmac_f32_16x16x64_bf16 v[56:59], v[24:27], a[40:47], v9
    s_waitcnt vmcnt(0)
    v_max3_u32 v4, v28, v29, v30
    v_max_u32 v4, v4, v31
    v_smfmac_f32_16x16x64_bf16 v[60:63], v[24:27], a[72:79], v9
    v_cmp_eq_u32 vcc, -1, v4
    v_smfmac_f32_16x16x64_bf16 v[64:67], v[24:27], a[104:111], v9
    s_cbranch_vccnz .A_76
.W_77:
    v_smfmac_f32_16x16x64_bf16 v[52:55], v[28:31], a[16:23], v9
    v_smfmac_f32_16x16x64_bf16 v[56:59], v[28:31], a[48:55], v9
    v_smfmac_f32_16x16x64_bf16 v[60:63], v[28:31], a[80:87], v9
    v_smfmac_f32_16x16x64_bf16 v[64:67], v[28:31], a[112:119], v9
    s_branch .mj_31
.W_67:
    v_smfmac_f32_16x16x64_bf16 v[52:55], v[24:27], a[8:15], v9
    v_smfmac_f32_16x16x64_bf16 v[56:59], v[24:27], a[40:47], v9
    s_waitcnt vmcnt(2)
    v_max3_u32 v4, v28, v29, v30
    v_max_u32 v4, v4, v31
    v_smfmac_f32_16x16x64_bf16 v[60:63], v[24:27], a[72:79], v9
    v_cmp_eq_u32 vcc, -1, v4
    v_smfmac_f32_16x16x64_bf16 v[64:67], v[24:27], a[104:111], v9
    s_cbranch_vccnz .A_78
.W_79:
    v_smfmac_f32_16x16x64_bf16 v[52:55], v[28:31], a[16:23], v9
    v_smfmac_f32_16x16x64_bf16 v[56:59], v[28:31], a[48:55], v9
    s_waitcnt vmcnt(1)
    v_max3_u32 v4, v32, v33, v34
    v_max_u32 v4, v4, v35
    v_smfmac_f32_16x16x64_bf16 v[60:63], v[28:31], a[80:87], v9
    v_cmp_eq_u32 vcc, -1, v4
    v_smfmac_f32_16x16x64_bf16 v[64:67], v[28:31], a[112:119], v9
    s_cbranch_vccnz .A_80
.W_81:
    v_smfmac_f32_16x16x64_bf16 v[52:55], v[32:35], a[24:31], v9
    v_smfmac_f32_16x16x64_bf16 v[56:59], v[32:35], a[56:63], v9
    s_waitcnt vmcnt(0)
    v_max3_u32 v4, v20, v21, v22
    v_max_u32 v4, v4, v23
    v_smfmac_f32_16x16x64_bf16 v[60:63], v[32:35], a[88:95], v9
    v_cmp_eq_u32 vcc, -1, v4
    v_smfmac_f32_16x16x64_bf16 v[64:67], v[32:35], a[120:127], v9
    s_cbranch_vccnz .A_82
.W_83:
    v_smfmac_f32_16x16x64_bf16 v[52:55], v[20:23], a[0:7], v9
    v_smfmac_f32_16x16x64_bf16 v[56:59], v[20:23], a[32:39], v9
    v_smfmac_f32_16x16x64_bf16 v[60:63], v[20:23], a[64:71], v9
    v_smfmac_f32_16x16x64_bf16 v[64:67], v[20:23], a[96:103], v9
    s_branch .mj_31
.W_69:
    v_smfmac_f32_16x16x64_bf16 v[52:55], v[28:31], a[16:23], v9
    v_smfmac_f32_16x16x64_bf16 v[56:59], v[28:31], a[48:55], v9
    s_waitcnt vmcnt(2)
    v_max3_u32 v4, v32, v33, v34
    v_max_u32 v4, v4, v35
    v_smfmac_f32_16x16x64_bf16 v[60:63], v[28:31], a[80:87], v9
    v_cmp_eq_u32 vcc, -1, v4
    v_smfmac_f32_16x16x64_bf16 v[64:67], v[28:31], a[112:119], v9
    s_cbranch_vccnz .A_84
.W_85:
    v_smfmac_f32_16x16x64_bf16 v[52:55], v[32:35], a[24:31], v9
    v_smfmac_f32_16x16x64_bf16 v[56:59], v[32:35], a[56:63], v9
    s_waitcnt vmcnt(1)
    v_max3_u32 v4, v20, v21, v22
    v_max_u32 v4, v4, v23
    v_smfmac_f32_16x16x64_bf16 v[60:63], v[32:35], a[88:95], v9
    v_cmp_eq_u32 vcc, -1, v4
    v_smfmac_f32_16x16x64_bf16 v[64:67], v[32:35], a[120:127], v9
    s_cbranch_vccnz .A_86
.W_87:
    v_smfmac_f32_16x16x64_bf16 v[52:55], v[20:23], a[0:7], v9
    v_smfmac_f32_16x16x64_bf16 v[56:59], v[20:23], a[32:39], v9
    s_waitcnt vmcnt(0)
    v_max3_u32 v4, v24, v25, v26
    v_max_u32 v4, v4, v27
    v_smfmac_f32_16x16x64_bf16 v[60:63], v[20:23], a[64:71], v9
    v_cmp_eq_u32 vcc, -1, v4
    v_smfmac_f32_16x16x64_bf16 v[64:67], v[20:23], a[96:103], v9
    s_cbranch_vccnz .A_88
.W_89:
    v_smfmac_f32_16x16x64_bf16 v[52:55], v[24:27], a[8:15], v9
    v_smfmac_f32_16x16x64_bf16 v[56:59], v[24:27], a[40:47], v9
    v_smfmac_f32_16x16x64_bf16 v[60:63], v[24:27], a[72:79], v9
    v_smfmac_f32_16x16x64_bf16 v[64:67], v[24:27], a[104:111], v9
    s_branch .mj_31
.A_90:
    s_mov_b64 exec, vcc
    buffer_load_dwordx4 v[28:31], v8, s[8:11], s29 offen offset:2048 sc1
    s_mov_b64 exec, -1
    s_sub_u32 s62, s62, 1
    s_cbranch_scc1 .mg_end_1
    s_waitcnt vmcnt(2)
    v_max3_u32 v4, v20, v21, v22
    v_max_u32 v4, v4, v23
    v_cmp_eq_u32 vcc, -1, v4
    s_cbranch_vccz .W_73
.A_72:
    s_mov_b64 exec, vcc
    buffer_load_dwordx4 v[20:23], v8, s[8:11], s29 offen offset:0 sc1
    s_mov_b64 exec, -1
    s_waitcnt vmcnt(2)
    v_max3_u32 v4, v24, v25, v26
    v_max_u32 v4, v4, v27
    v_cmp_eq_u32 vcc, -1, v4
    s_cbranch_vccz .W_91
.A_92:
    s_mov_b64 exec, vcc
    buffer_load_dwordx4 v[24:27], v8, s[8:11], s29 offen offset:1024 sc1
    s_mov_b64 exec, -1
    s_waitcnt vmcnt(2)
    v_max3_u32 v4, v28, v29, v30
    v_max_u32 v4, v4, v31
    v_cmp_eq_u32 vcc, -1, v4
    s_cbranch_vccnz .A_90
.W_93:
    v_smfmac_f32_16x16x64_bf16 v[52:55], v[28:31], a[16:23], v9
    v_smfmac_f32_16x16x64_bf16 v[56:59], v[28:31], a[48:55], v9
    s_waitcnt vmcnt(1)
    v_max3_u32 v4, v20, v21, v22
    v_max_u32 v4, v4, v23
    v_smfmac_f32_16x16x64_bf16 v[60:63], v[28:31], a[80:87], v9
    v_cmp_eq_u32 vcc, -1, v4
    v_smfmac_f32_16x16x64_bf16 v[64:67], v[28:31], a[112:119], v9
    s_cbranch_vccz .W_87
    s_branch .A_86
.W_91:
    v_smfmac_f32_16x16x64_bf16 v[52:55], v[24:27], a[8:15], v9
    v_smfmac_f32_16x16x64_bf16 v[56:59], v[24:27], a[40:47], v9
    s_waitcnt vmcnt(1)
    v_max3_u32 v4, v28, v29, v30
    v_max_u32 v4, v4, v31
    v_smfmac_f32_16x16x64_bf16 v[60:63], v[24:27], a[72:79], v9
    v_cmp_eq_u32 vcc, -1, v4
    v_smfmac_f32_16x16x64_bf16 v[64:67], v[24:27], a[104:111], v9
    s_cbranch_vccnz .A_94
.W_95:
    v_smfmac_f32_16x16x64_bf16 v[52:55], v[28:31], a[16:23], v9
    v_smfmac_f32_16x16x64_bf16 v[56:59], v[28:31], a[48:55], v9
    s_waitcnt vmcnt(0)
    v_max3_u32 v4, v20, v21, v22
    v_max_u32 v4, v4, v23
    v_smfmac_f32_16x16x64_bf16 v[60:63], v[28:31], a[80:87], v9
    v_cmp_eq_u32 vcc, -1, v4
    v_smfmac_f32_16x16x64_bf16 v[64:67], v[28:31], a[112:119], v9
    s_cbranch_vccz .W_83
    s_branch .A_82
.A_96:
    s_mov_b64 exec, vcc
    buffer_load_dwordx4 v[24:27], v8, s[8:11], s29 offen offset:1024 sc1
    s_mov_b64 exec, -1
    s_sub_u32 s62, s62, 1
    s_cbranch_scc1 .mg_end_1
    s_waitcnt vmcnt(2)
    v_max3_u32 v4, v32, v33, v34
    v_max_u32 v4, v4, v35
    v_cmp_eq_u32 vcc, -1, v4
    s_cbranch_vccz .W_85
.A_84:
    s_mov_b64 exec, vcc
    buffer_load_dwordx4 v[32:35], v8, s[8:11], s29 offen offset:3072 sc1
    s_mov_b64 exec, -1
    s_waitcnt vmcnt(2)
    v_max3_u32 v4, v20, v21, v22
    v_max_u32 v4, v4, v23
    v_cmp_eq_u32 vcc, -1, v4
    s_cbranch_vccz .W_97
.A_98:
    s_mov_b64 exec, vcc
    buffer_load_dwordx4 v[20:23], v8, s[8:11], s29 offen offset:0 sc1
    s_mov_b64 exec, -1
    s_waitcnt vmcnt(2)
    v_max3_u32 v4, v24, v25, v26
    v_max_u32 v4, v4, v27
    v_cmp_eq_u32 vcc, -1, v4
    s_cbranch_vccnz .A_96
.W_99:
    v_smfmac_f32_16x16x64_bf16 v[52:55], v[24:27], a[8:15], v9
    v_smfmac_f32_16x16x64_bf16 v[56:59], v[24:27], a[40:47], v9
    s_waitcnt vmcnt(1)
    v_max3_u32 v4, v32, v33, v34
    v_max_u32 v4, v4, v35
    v_smfmac_f32_16x16x64_bf16 v[60:63], v[24:27], a[72:79], v9
    v_cmp_eq_u32 vcc, -1, v4
    v_smfmac_f32_16x16x64_bf16 v[64:67], v[24:27], a[104:111], v9
    s_cbranch_vccz .W_81
    s_branch .A_80
.W_97:
    v_smfmac_f32_16x16x64_bf16 v[52:55], v[20:23], a[0:7], v9
    v_smfmac_f32_16x16x64_bf16 v[56:59], v[20:23], a[32:39], v9
    s_waitcnt vmcnt(1)
    v_max3_u32 v4, v24, v25, v26
    v_max_u32 v4, v4, v27
    v_smfmac_f32_16x16x64_bf16 v[60:63], v[20:23], a[64:71], v9
    v_cmp_eq_u32 vcc, -1, v4
    v_smfmac_f32_16x16x64_bf16 v[64:67], v[20:23], a[96:103], v9
    s_cbranch_vccnz .A_100
.W_101:
    v_smfmac_f32_16x16x64_bf16 v[52:55], v[24:27], a[8:15], v9
    v_smfmac_f32_16x16x64_bf16 v[56:59], v[24:27], a[40:47], v9
    s_waitcnt vmcnt(0)
    v_max3_u32 v4, v32, v33, v34
    v_max_u32 v4, v4, v35
    v_smfmac_f32_16x16x64_bf16 v[60:63], v[24:27], a[72:79], v9
    v_cmp_eq_u32 vcc, -1, v4
    v_smfmac_f32_16x16x64_bf16 v[64:67], v[24:27], a[104:111], v9
    s_cbranch_vccz .W_39
    s_branch .A_38
.A_102:
    s_mov_b64 exec, vcc
    buffer_load_dwordx4 v[32:35], v8, s[8:11], s29 offen offset:3072 sc1
    s_mov_b64 exec, -1
    s_sub_u32 s62, s62, 1
    s_cbranch_scc1 .mg_end_1
    s_waitcnt vmcnt(2)
    v_max3_u32 v4, v20, v21, v22
    v_max_u32 v4, v4, v23
    v_cmp_eq_u32 vcc, -1, v4
    s_cbranch_vccz .W_103
.A_104:
    s_mov_b64 exec, vcc
    buffer_load_dwordx4 v[20:23], v8, s[8:11], s29 offen offset:0 sc1
    s_mov_b64 exec, -1
    s_waitcnt vmcnt(2)
    v_max3_u32 v4, v28, v29, v30
    v_max_u32 v4, v4, v31
    v_cmp_eq_u32 vcc, -1, v4
    s_cbranch_vccz .W_79
.A_78:
    s_mov_b64 exec, vcc
    buffer_load_dwordx4 v[28:31], v8, s[8:11], s29 offen offset:2048 sc1
    s_mov_b64 exec, -1
    s_waitcnt vmcnt(2)
    v_max3_u32 v4, v32, v33, v34
    v_max_u32 v4, v4, v35
    v_cmp_eq_u32 vcc, -1, v4
    s_cbranch_vccnz .A_102
.W_105:
    v_smfmac_f32_16x16x64_bf16 v[52:55], v[32:35], a[24:31], v9
    v_smfmac_f32_16x16x64_bf16 v[56:59], v[32:35], a[56:63], v9
    s_waitcnt vmcnt(1)
    v_max3_u32 v4, v20, v21, v22
    v_max_u32 v4, v4, v23
    v_smfmac_f32_16x16x64_bf16 v[60:63], v[32:35], a[88:95], v9
    v_cmp_eq_u32 vcc, -1, v4
    v_smfmac_f32_16x16x64_bf16 v[64:67], v[32:35], a[120:127], v9
    s_cbranch_vccnz .A_106
.W_107:
    v_smfmac_f32_16x16x64_bf16 v[52:55], v[20:23], a[0:7], v9
    v_smfmac_f32_16x16x64_bf16 v[56:59], v[20:23], a[32:39], v9
    s_waitcnt vmcnt(0)
    v_max3_u32 v4, v28, v29, v30
    v_max_u32 v4, v4, v31
    v_smfmac_f32_16x16x64_bf16 v[60:63], v[20:23], a[64:71], v9
    v_cmp_eq_u32 vcc, -1, v4
    v_smfmac_f32_16x16x64_bf16 v[64:67], v[20:23], a[96:103], v9
    s_cbranch_vccz .W_77
    s_branch .A_76
.W_103:
    v_smfmac_f32_16x16x64_bf16 v[52:55], v[20:23], a[0:7], v9
    v_smfmac_f32_16x16x64_bf16 v[56:59], v[20:23], a[32:39], v9
    s_waitcnt vmcnt(1)
    v_max3_u32 v4, v28, v29, v30
    v_max_u32 v4, v4, v31
    v_smfmac_f32_16x16x64_bf16 v[60:63], v[20:23], a[64:71], v9
    v_cmp_eq_u32 vcc, -1, v4
    v_smfmac_f32_16x16x64_bf16 v[64:67], v[20:23], a[96:103], v9
    s_cbranch_vccz .W_37
    s_branch .A_36
.A_108:
    s_mov_b64 exec, vcc
    buffer_load_dwordx4 v[32:35], v8, s[8:11], s29 offen offset:3072 sc1
    s_mov_b64 exec, -1
    s_sub_u32 s62, s62, 1
    s_cbranch_scc1 .mg_end_1
    s_waitcnt vmcnt(2)
    v_max3_u32 v4, v24, v25, v26
    v_max_u32 v4, v4, v27
    v_cmp_eq_u32 vcc, -1, v4
    s_cbranch_vccz .W_35
.A_34:
    s_mov_b64 exec, vcc
    buffer_load_dwordx4 v[24:27], v8, s[8:11], s29 offen offset:1024 sc1
    s_mov_b64 exec, -1
    s_waitcnt vmcnt(2)
    v_max3_u32 v4, v28, v29, v30
    v_max_u32 v4, v4, v31
    v_cmp_eq_u32 vcc, -1, v4
    s_cbranch_vccz .W_109
.A_110:
    s_mov_b64 exec, vcc
    buffer_load_dwordx4 v[28:31], v8, s[8:11], s29 offen offset:2048 sc1
    s_mov_b64 exec, -1
    s_waitcnt vmcnt(2)
    v_max3_u32 v4, v32, v33, v34
    v_max_u32 v4, v4, v35
    v_cmp_eq_u32 vcc, -1, v4
    s_cbranch_vccnz .A_108
.W_111:
    v_smfmac_f32_16x16x64_bf16 v[52:55], v[32:35], a[24:31], v9
    v_smfmac_f32_16x16x64_bf16 v[56:59], v[32:35], a[56:63], v9
    s_waitcnt vmcnt(1)
    v_max3_u32 v4, v24, v25, v26
    v_max_u32 v4, v4, v27
    v_smfmac_f32_16x16x64_bf16 v[60:63], v[32:35], a[88:95], v9
    v_cmp_eq_u32 vcc, -1, v4
    v_smfmac_f32_16x16x64_bf16 v[64:67], v[32:35], a[120:127], v9
    s_cbranch_vccz .W_75
    s_branch .A_74
.W_109:
    v_smfmac_f32_16x16x64_bf16 v[52:55], v[28:31], a[16:23], v9
    v_smfmac_f32_16x16x64_bf16 v[56:59], v[28:31], a[48:55], v9
    s_waitcnt vmcnt(1)
    v_max3_u32 v4, v32, v33, v34
    v_max_u32 v4, v4, v35
    v_smfmac_f32_16x16x64_bf16 v[60:63], v[28:31], a[80:87], v9
    v_cmp_eq_u32 vcc, -1, v4
    v_smfmac_f32_16x16x64_bf16 v[64:67], v[28:31], a[112:119], v9
    s_cbranch_vccnz .A_112
.W_113:
    v_smfmac_f32_16x16x64_bf16 v[52:55], v[32:35], a[24:31], v9
    v_smfmac_f32_16x16x64_bf16 v[56:59], v[32:35], a[56:63], v9
    s_waitcnt vmcnt(0)
    v_max3_u32 v4, v24, v25, v26
    v_max_u32 v4, v4, v27
    v_smfmac_f32_16x16x64_bf16 v[60:63], v[32:35], a[88:95], v9
    v_cmp_eq_u32 vcc, -1, v4
    v_smfmac_f32_16x16x64_bf16 v[64:67], v[32:35], a[120:127], v9
    s_cbranch_vccz .W_89
    s_branch .A_88
.A_114:
    s_mov_b64 exec, vcc
    buffer_load_dwordx4 v[24:27], v8, s[8:11], s29 offen offset:1024 sc1
    s_mov_b64 exec, -1
    s_sub_u32 s62, s62, 1
    s_cbranch_scc1 .mg_end_1
    s_waitcnt vmcnt(1)
    v_max3_u32 v4, v20, v21, v22
    v_max_u32 v4, v4, v23
    v_cmp_eq_u32 vcc, -1, v4
    s_cbranch_vccz .W_87
.A_86:
    s_mov_b64 exec, vcc
    buffer_load_dwordx4 v[20:23], v8, s[8:11], s29 offen offset:0 sc1
    s_mov_b64 exec, -1
    s_waitcnt vmcnt(1)
    v_max3_u32 v4, v24, v25, v26
    v_max_u32 v4, v4, v27
    v_cmp_eq_u32 vcc, -1, v4
    s_cbranch_vccnz .A_114
.W_115:
    v_smfmac_f32_16x16x64_bf16 v[52:55], v[24:27], a[8:15], v9
    v_smfmac_f32_16x16x64_bf16 v[56:59], v[24:27], a[40:47], v9
    s_waitcnt vmcnt(0)
    v_max3_u32 v4, v20, v21, v22
    v_max_u32 v4, v4, v23
    v_smfmac_f32_16x16x64_bf16 v[60:63], v[24:27], a[72:79], v9
    v_cmp_eq_u32 vcc, -1, v4
    v_smfmac_f32_16x16x64_bf16 v[64:67], v[24:27], a[104:111], v9
    s_cbranch_vccz .W_83
    s_branch .A_82
.A_94:
    s_mov_b64 exec, vcc
    buffer_load_dwordx4 v[28:31], v8, s[8:11], s29 offen offset:2048 sc1
    s_mov_b64 exec, -1
    s_sub_u32 s62, s62, 1
    s_cbranch_scc1 .mg_end_1
    s_waitcnt vmcnt(1)
    v_max3_u32 v4, v20, v21, v22
    v_max_u32 v4, v4, v23
    v_cmp_eq_u32 vcc, -1, v4
    s_cbranch_vccz .W_107
.A_106:
    s_mov_b64 exec, vcc
    buffer_load_dwordx4 v[20:23], v8, s[8:11], s29 offen offset:0 sc1
    s_mov_b64 exec, -1
    s_waitcnt vmcnt(1)
    v_max3_u32 v4, v28, v29, v30
    v_max_u32 v4, v4, v31
    v_cmp_eq_u32 vcc, -1, v4
    s_cbranch_vccnz .A_94
    s_branch .W_95
.A_116:
    s_mov_b64 exec, vcc
    buffer_load_dwordx4 v[20:23], v8, s[8:11], s29 offen offset:0 sc1
    s_mov_b64 exec, -1
    s_sub_u32 s62, s62, 1
    s_cbranch_scc1 .mg_end_1
    s_waitcnt vmcnt(1)
    v_max3_u32 v4, v32, v33, v34
    v_max_u32 v4, v4, v35
    v_cmp_eq_u32 vcc, -1, v4
    s_cbranch_vccz .W_81
.A_80:
    s_mov_b64 exec, vcc
    buffer_load_dwordx4 v[32:35], v8, s[8:11], s29 offen offset:3072 sc1
    s_mov_b64 exec, -1
    s_waitcnt vmcnt(1)
    v_max3_u32 v4, v20, v21, v22
    v_max_u32 v4, v4, v23
    v_cmp_eq_u32 vcc, -1, v4
    s_cbranch_vccnz .A_116
.W_117:
    v_smfmac_f32_16x16x64_bf16 v[52:55], v[20:23], a[0:7], v9
    v_smfmac_f32_16x16x64_bf16 v[56:59], v[20:23], a[32:39], v9
    s_waitcnt vmcnt(0)
    v_max3_u32 v4, v32, v33, v34
    v_max_u32 v4, v4, v35
    v_smfmac_f32_16x16x64_bf16 v[60:63], v[20:23], a[64:71], v9
    v_cmp_eq_u32 vcc, -1, v4
    v_smfmac_f32_16x16x64_bf16 v[64:67], v[20:23], a[96:103], v9
    s_cbranch_vccz .W_39
    s_branch .A_38
.A_118:
    s_mov_b64 exec, vcc
    buffer_load_dwordx4 v[28:31], v8, s[8:11], s29 offen offset:2048 sc1
    s_mov_b64 exec, -1
    s_sub_u32 s62, s62, 1
    s_cbranch_scc1 .mg_end_1
    s_waitcnt vmcnt(1)
    v_max3_u32 v4, v24, v25, v26
    v_max_u32 v4, v4, v27
    v_cmp_eq_u32 vcc, -1, v4
    s_cbranch_vccz .W_75
.A_74:
    s_mov_b64 exec, vcc
    buffer_load_dwordx4 v[24:27], v8, s[8:11], s29 offen offset:1024 sc1
    s_mov_b64 exec, -1
    s_waitcnt vmcnt(1)
    v_max3_u32 v4, v28, v29, v30
    v_max_u32 v4, v4, v31
    v_cmp_eq_u32 vcc, -1, v4
    s_cbranch_vccnz .A_118
.W_119:
    v_smfmac_f32_16x16x64_bf16 v[52:55], v[28:31], a[16:23], v9
    v_smfmac_f32_16x16x64_bf16 v[56:59], v[28:31], a[48:55], v9
    s_waitcnt vmcnt(0)
    v_max3_u32 v4, v24, v25, v26
    v_max_u32 v4, v4, v27
    v_smfmac_f32_16x16x64_bf16 v[60:63], v[28:31], a[80:87], v9
    v_cmp_eq_u32 vcc, -1, v4
    v_smfmac_f32_16x16x64_bf16 v[64:67], v[28:31], a[112:119], v9
    s_cbranch_vccz .W_89
    s_branch .A_88
.A_112:
    s_mov_b64 exec, vcc
    buffer_load_dwordx4 v[32:35], v8, s[8:11], s29 offen offset:3072 sc1
    s_mov_b64 exec, -1
    s_sub_u32 s62, s62, 1
    s_cbranch_scc1 .mg_end_1
    s_waitcnt vmcnt(1)
    v_max3_u32 v4, v24, v25, v26
    v_max_u32 v4, v4, v27
    v_cmp_eq_u32 vcc, -1, v4
    s_cbranch_vccz .W_101
.A_100:
    s_mov_b64 exec, vcc
    buffer_load_dwordx4 v[24:27], v8, s[8:11], s29 offen offset:1024 sc1
    s_mov_b64 exec, -1
    s_waitcnt vmcnt(1)
    v_max3_u32 v4, v32, v33, v34
    v_max_u32 v4, v4, v35
    v_cmp_eq_u32 vcc, -1, v4
    s_cbranch_vccnz .A_112
    s_branch .W_113
.A_120:
    s_mov_b64 exec, vcc
    buffer_load_dwordx4 v[32:35], v8, s[8:11], s29 offen offset:3072 sc1
    s_mov_b64 exec, -1
    s_sub_u32 s62, s62, 1
    s_cbranch_scc1 .mg_end_1
    s_waitcnt vmcnt(1)
    v_max3_u32 v4, v28, v29, v30
    v_max_u32 v4, v4, v31
    v_cmp_eq_u32 vcc, -1, v4
    s_cbranch_vccz .W_37
.A_36:
    s_mov_b64 exec, vcc
    buffer_load_dwordx4 v[28:31], v8, s[8:11], s29 offen offset:2048 sc1
    s_mov_b64 exec, -1
    s_waitcnt vmcnt(1)
    v_max3_u32 v4, v32, v33, v34
    v_max_u32 v4, v4, v35
    v_cmp_eq_u32 vcc, -1, v4
    s_cbranch_vccnz .A_120
.W_121:
    v_smfmac_f32_16x16x64_bf16 v[52:55], v[32:35], a[24:31], v9
    v_smfmac_f32_16x16x64_bf16 v[56:59], v[32:35], a[56:63], v9
    s_waitcnt vmcnt(0)
    v_max3_u32 v4, v28, v29, v30
    v_max_u32 v4, v4, v31
    v_smfmac_f32_16x16x64_bf16 v[60:63], v[32:35], a[88:95], v9
    v_cmp_eq_u32 vcc, -1, v4
    v_smfmac_f32_16x16x64_bf16 v[64:67], v[32:35], a[120:127], v9
    s_cbranch_vccz .W_77
    s_branch .A_76
.A_82:
    s_mov_b64 exec, vcc
    buffer_load_dwordx4 v[20:23], v8, s[8:11], s29 offen offset:0 sc1
    s_mov_b64 exec, -1
    s_sub_u32 s62, s62, 1
    s_cbranch_scc1 .mg_end_1
    s_waitcnt vmcnt(1)
    v_max3_u32 v4, v20, v21, v22
    v_max_u32 v4, v4, v23
    v_cmp_eq_u32 vcc, -1, v4
    s_cbranch_vccnz .A_82
    v_smfmac_f32_16x16x64_bf16 v[52:55], v[20:23], a[0:7], v9
    v_smfmac_f32_16x16x64_bf16 v[56:59], v[20:23], a[32:39], v9
    v_smfmac_f32_16x16x64_bf16 v[60:63], v[20:23], a[64:71], v9
    v_smfmac_f32_16x16x64_bf16 v[64:67], v[20:23], a[96:103], v9
    s_branch .mj_31
.A_88:
    s_mov_b64 exec, vcc
    buffer_load_dwordx4 v[24:27], v8, s[8:11], s29 offen offset:1024 sc1
    s_mov_b64 exec, -1
    s_sub_u32 s62, s62, 1
    s_cbranch_scc1 .mg_end_1
    s_waitcnt vmcnt(1)
    v_max3_u32 v4, v24, v25, v26
    v_max_u32 v4, v4, v27
    v_cmp_eq_u32 vcc, -1, v4
    s_cbranch_vccnz .A_88
    v_smfmac_f32_16x16x64_bf16 v[52:55], v[24:27], a[8:15], v9
    v_smfmac_f32_16x16x64_bf16 v[56:59], v[24:27], a[40:47], v9
    v_smfmac_f32_16x16x64_bf16 v[60:63], v[24:27], a[72:79], v9
    v_smfmac_f32_16x16x64_bf16 v[64:67], v[24:27], a[104:111], v9
    s_branch .mj_31
.A_76:
    s_mov_b64 exec, vcc
    buffer_load_dwordx4 v[28:31], v8, s[8:11], s29 offen offset:2048 sc1
    s_mov_b64 exec, -1
    s_sub_u32 s62, s62, 1
    s_cbranch_scc1 .mg_end_1
    s_waitcnt vmcnt(1)
    v_max3_u32 v4, v28, v29, v30
    v_max_u32 v4, v4, v31
    v_cmp_eq_u32 vcc, -1, v4
    s_cbranch_vccnz .A_76
    v_smfmac_f32_16x16x64_bf16 v[52:55], v[28:31], a[16:23], v9
    v_smfmac_f32_16x16x64_bf16 v[56:59], v[28:31], a[48:55], v9
    v_smfmac_f32_16x16x64_bf16 v[60:63], v[28:31], a[80:87], v9
    v_smfmac_f32_16x16x64_bf16 v[64:67], v[28:31], a[112:119], v9
    s_branch .mj_31
.A_38:
    s_mov_b64 exec, vcc
    buffer_load_dwordx4 v[32:35], v8, s[8:11], s29 offen offset:3072 sc1
    s_mov_b64 exec, -1
    s_sub_u32 s62, s62, 1
    s_cbranch_scc1 .mg_end_1
    s_waitcnt vmcnt(1)
    v_max3_u32 v4, v32, v33, v34
    v_max_u32 v4, v4, v35
    v_cmp_eq_u32 vcc, -1, v4
    s_cbranch_vccnz .A_38
    v_smfmac_f32_16x16x64_bf16 v[52:55], v[32:35], a[24:31], v9
    v_smfmac_f32_16x16x64_bf16 v[56:59], v[32:35], a[56:63], v9
    v_smfmac_f32_16x16x64_bf16 v[60:63], v[32:35], a[88:95], v9
    v_smfmac_f32_16x16x64_bf16 v[64:67], v[32:35], a[120:127], v9
    s_branch .mj_31
.A_122:
    buffer_load_dwordx4 v[100:103], v234, s[8:11], s29 offen sc1
    s_sub_u32 s62, s62, 1
    s_cbranch_scc1 .mg_end_1
    s_waitcnt vmcnt(2)
    v_max3_u32 v4, v92, v93, v94
    v_max_u32 v4, v4, v95
    v_cmp_eq_u32 vcc, -1, v4
    s_cbranch_vccz .W_42
.A_41:
    buffer_load_dwordx4 v[92:95], v232, s[8:11], s29 offen sc1
    s_waitcnt vmcnt(2)
    v_max3_u32 v4, v96, v97, v98
    v_max_u32 v4, v4, v99
    v_cmp_eq_u32 vcc, -1, v4
    s_cbranch_vccz .W_123
.A_124:
    buffer_load_dwordx4 v[96:99], v233, s[8:11], s29 offen sc1
    s_waitcnt vmcnt(2)
    v_max3_u32 v4, v100, v101, v102
    v_max_u32 v4, v4, v103
    v_cmp_eq_u32 vcc, -1, v4
    s_cbranch_vccnz .A_122
.W_125:
    v_mfma_f32_16x16x32_bf16 v[208:211], v[140:143], v[100:103], v[208:211]
    s_waitcnt vmcnt(1)
    v_max3_u32 v4, v92, v93, v94
    v_max_u32 v4, v4, v95
    v_mfma_f32_16x16x32_bf16 v[212:215], v[156:159], v[100:103], v[212:215]
    v_cmp_eq_u32 vcc, -1, v4
    v_mfma_f32_16x16x32_bf16 v[216:219], v[100:103], v[100:103], v[216:219]
    s_cbranch_vccnz .A_126
.W_127:
    v_mfma_f32_16x16x32_bf16 v[208:211], v[132:135], v[92:95], v[208:211]
    s_waitcnt vmcnt(0)
    v_max3_u32 v4, v96, v97, v98
    v_max_u32 v4, v4, v99
    v_mfma_f32_16x16x32_bf16 v[212:215], v[148:151], v[92:95], v[212:215]
    v_cmp_eq_u32 vcc, -1, v4
    v_mfma_f32_16x16x32_bf16 v[216:219], v[92:95], v[92:95], v[216:219]
    s_cbranch_vccnz .A_128
.W_129:
    v_mfma_f32_16x16x32_bf16 v[208:211], v[136:139], v[96:99], v[208:211]
    v_mfma_f32_16x16x32_bf16 v[212:215], v[152:155], v[96:99], v[212:215]
    v_mfma_f32_16x16x32_bf16 v[216:219], v[96:99], v[96:99], v[216:219]
    s_branch .mj_40
.W_123:
    v_mfma_f32_16x16x32_bf16 v[208:211], v[136:139], v[96:99], v[208:211]
    s_waitcnt vmcnt(1)
    v_max3_u32 v4, v100, v101, v102
    v_max_u32 v4, v4, v103
    v_mfma_f32_16x16x32_bf16 v[212:215], v[152:155], v[96:99], v[212:215]
    v_cmp_eq_u32 vcc, -1, v4
    v_mfma_f32_16x16x32_bf16 v[216:219], v[96:99], v[96:99], v[216:219]
    s_cbranch_vccnz .A_130
.W_131:
    v_mfma_f32_16x16x32_bf16 v[208:211], v[140:143], v[100:103], v[208:211]
    s_waitcnt vmcnt(0)
    v_max3_u32 v4, v92, v93, v94
    v_max_u32 v4, v4, v95
    v_mfma_f32_16x16x32_bf16 v[212:215], v[156:159], v[100:103], v[212:215]
    v_cmp_eq_u32 vcc, -1, v4
    v_mfma_f32_16x16x32_bf16 v[216:219], v[100:103], v[100:103], v[216:219]
    s_cbranch_vccnz .A_132
.W_133:
    v_mfma_f32_16x16x32_bf16 v[208:211], v[132:135], v[92:95], v[208:211]
    v_mfma_f32_16x16x32_bf16 v[212:215], v[148:151], v[92:95], v[212:215]
    v_mfma_f32_16x16x32_bf16 v[216:219], v[92:95], v[92:95], v[216:219]
    s_branch .mj_40
.A_134:
    buffer_load_dwordx4 v[96:99], v233, s[8:11], s29 offen sc1
    s_sub_u32 s62, s62, 1
    s_cbranch_scc1 .mg_end_1
    s_waitcnt vmcnt(1)
    v_max3_u32 v4, v92, v93, v94
    v_max_u32 v4, v4, v95
    v_cmp_eq_u32 vcc, -1, v4
    s_cbranch_vccz .W_127
.A_126:
    buffer_load_dwordx4 v[92:95], v232, s[8:11], s29 offen sc1
    s_waitcnt vmcnt(1)
    v_max3_u32 v4, v96, v97, v98
    v_max_u32 v4, v4, v99
    v_cmp_eq_u32 vcc, -1, v4
    s_cbranch_vccnz .A_134
.W_135:
    v_mfma_f32_16x16x32_bf16 v[208:211], v[136:139], v[96:99], v[208:211]
    s_waitcnt vmcnt(0)
    v_max3_u32 v4, v92, v93, v94
    v_max_u32 v4, v4, v95
    v_mfma_f32_16x16x32_bf16 v[212:215], v[152:155], v[96:99], v[212:215]
    v_cmp_eq_u32 vcc, -1, v4
    v_mfma_f32_16x16x32_bf16 v[216:219], v[96:99], v[96:99], v[216:219]
    s_cbranch_vccz .W_133
    s_branch .A_132
.A_136:
    buffer_load_dwordx4 v[92:95], v232, s[8:11], s29 offen sc1
    s_sub_u32 s62, s62, 1
    s_cbranch_scc1 .mg_end_1
    s_waitcnt vmcnt(1)
    v_max3_u32 v4, v100, v101, v102
    v_max_u32 v4, v4, v103
    v_cmp_eq_u32 vcc, -1, v4
    s_cbranch_vccz .W_131
.A_130:
    buffer_load_dwordx4 v[100:103], v234, s[8:11], s29 offen sc1
    s_waitcnt vmcnt(1)
    v_max3_u32 v4, v92, v93, v94
    v_max_u32 v4, v4, v95
    v_cmp_eq_u32 vcc, -1, v4
    s_cbranch_vccnz .A_136
.W_137:
    v_mfma_f32_16x16x32_bf16 v[208:211], v[132:135], v[92:95], v[208:211]
    s_waitcnt vmcnt(0)
    v_max3_u32 v4, v100, v101, v102
    v_max_u32 v4, v4, v103
    v_mfma_f32_16x16x32_bf16 v[212:215], v[148:151], v[92:95], v[212:215]
    v_cmp_eq_u32 vcc, -1, v4
    v_mfma_f32_16x16x32_bf16 v[216:219], v[92:95], v[92:95], v[216:219]
    s_cbranch_vccz .W_46
    s_branch .A_45
.A_138:
    buffer_load_dwordx4 v[100:103], v234, s[8:11], s29 offen sc1
    s_sub_u32 s62, s62, 1
    s_cbranch_scc1 .mg_end_1
    s_waitcnt vmcnt(1)
    v_max3_u32 v4, v96, v97, v98
    v_max_u32 v4, v4, v99
    v_cmp_eq_u32 vcc, -1, v4
    s_cbranch_vccz .W_44
.A_43:
    buffer_load_dwordx4 v[96:99], v233, s[8:11], s29 offen sc1
    s_waitcnt vmcnt(1)
    v_max3_u32 v4, v100, v101, v102
    v_max_u32 v4, v4, v103
    v_cmp_eq_u32 vcc, -1, v4
    s_cbranch_vccnz .A_138
.W_139:
    v_mfma_f32_16x16x32_bf16 v[208:211], v[140:143], v[100:103], v[208:211]
    s_waitcnt vmcnt(0)
    v_max3_u32 v4, v96, v97, v98
    v_max_u32 v4, v4, v99
    v_mfma_f32_16x16x32_bf16 v[212:215], v[156:159], v[100:103], v[212:215]
    v_cmp_eq_u32 vcc, -1, v4
    v_mfma_f32_16x16x32_bf16 v[216:219], v[100:103], v[100:103], v[216:219]
    s_cbranch_vccz .W_129
    s_branch .A_128
.A_132:
    buffer_load_dwordx4 v[92:95], v232, s[8:11], s29 offen sc1
    s_sub_u32 s62, s62, 1
    s_cbranch_scc1 .mg_end_1
    s_waitcnt vmcnt(1)
    v_max3_u32 v4, v92, v93, v94
    v_max_u32 v4, v4, v95
    v_cmp_eq_u32 vcc, -1, v4
    s_cbranch_vccnz .A_132
    v_mfma_f32_16x16x32_bf16 v[208:211], v[132:135], v[92:95], v[208:211]
    v_mfma_f32_16x16x32_bf16 v[212:215], v[148:151], v[92:95], v[212:215]
    v_mfma_f32_16x16x32_bf16 v[216:219], v[92:95], v[92:95], v[216:219]
    s_branch .mj_40
.A_128:
    buffer_load_dwordx4 v[96:99], v233, s[8:11], s29 offen sc1
    s_sub_u32 s62, s62, 1
    s_cbranch_scc1 .mg_end_1
    s_waitcnt vmcnt(1)
    v_max3_u32 v4, v96, v97, v98
    v_max_u32 v4, v4, v99
    v_cmp_eq_u32 vcc, -1, v4
    s_cbranch_vccnz .A_128
    v_mfma_f32_16x16x32_bf16 v[208:211], v[136:139], v[96:99], v[208:211]
    v_mfma_f32_16x16x32_bf16 v[212:215], v[152:155], v[96:99], v[212:215]
    v_mfma_f32_16x16x32_bf16 v[216:219], v[96:99], v[96:99], v[216:219]
    s_branch .mj_40
.A_45:
    buffer_load_dwordx4 v[100:103], v234, s[8:11], s29 offen sc1
    s_sub_u32 s62, s62, 1
    s_cbranch_scc1 .mg_end_1
    s_waitcnt vmcnt(1)
    v_max3_u32 v4, v100, v101, v102
    v_max_u32 v4, v4, v103
    v_cmp_eq_u32 vcc, -1, v4
    s_cbranch_vccnz .A_45
    v_mfma_f32_16x16x32_bf16 v[208:211], v[140:143], v[100:103], v[208:211]
    v_mfma_f32_16x16x32_bf16 v[212:215], v[156:159], v[100:103], v[212:215]
    v_mfma_f32_16x16x32_bf16 v[216:219], v[100:103], v[100:103], v[216:219]
    s_branch .mj_40
.kf_54:
    s_mov_b32 s62, 0
    s_mov_b64 exec, 3
.wf_140:
    buffer_load_dword v244, v253, s[8:11], s89 offen sc1
    s_waitcnt vmcnt(0)
    v_cmp_gt_u32 vcc, s6, v244
    s_cbranch_vccz .wfd_141
    s_sleep 2
    s_add_u32 s62, s62, 1
    s_cmp_gt_u32 s62, 0x400000
    s_cbranch_scc1 .mg_end_1
    s_branch .wf_140

.wfd_141:
    s_mov_b64 exec, -1
    v_readlane_b32 s4, v244, 0
    v_readlane_b32 s93, v244, 1
    s_min_u32 s93, s93, s4
    s_mov_b32 s62, 0x1000000
    s_branch .kb_55
.A_142:
    buffer_load_dwordx4 v[216:219], v246, s[8:11], s32 offen offset:0 sc1
    buffer_load_dwordx4 v[220:223], v246, s[8:11], s32 offen offset:1024 sc1
    s_sub_u32 s62, s62, 1
    s_cbranch_scc1 .mg_end_1
    s_waitcnt vmcnt(6)
    v_max3_u32 v4, v192, v193, v194
    v_max3_u32 v5, v195, v196, v197
    v_max3_u32 v4, v4, v198, v199
    v_max_u32 v4, v4, v5
    v_cmp_eq_u32 vcc, -1, v4
    s_cbranch_vccz .W_58
.A_57:
    buffer_load_dwordx4 v[192:195], v243, s[8:11], s32 offen offset:0 sc1
    buffer_load_dwordx4 v[196:199], v243, s[8:11], s32 offen offset:1024 sc1
    s_waitcnt vmcnt(6)
    v_max3_u32 v4, v200, v201, v202
    v_max3_u32 v5, v203, v204, v205
    v_max3_u32 v4, v4, v206, v207
    v_max_u32 v4, v4, v5
    v_cmp_eq_u32 vcc, -1, v4
    s_cbranch_vccz .W_143
.A_144:
    buffer_load_dwordx4 v[200:203], v252, s[8:11], s32 offen offset:0 sc1
    buffer_load_dwordx4 v[204:207], v252, s[8:11], s32 offen offset:1024 sc1
    s_waitcnt vmcnt(6)
    v_max3_u32 v4, v208, v209, v210
    v_max3_u32 v5, v211, v212, v213
    v_max3_u32 v4, v4, v214, v215
    v_max_u32 v4, v4, v5
    v_cmp_eq_u32 vcc, -1, v4
    s_cbranch_vccz .W_145
.A_146:
    buffer_load_dwordx4 v[208:211], v254, s[8:11], s32 offen offset:0 sc1
    buffer_load_dwordx4 v[212:215], v254, s[8:11], s32 offen offset:1024 sc1
    s_waitcnt vmcnt(6)
    v_max3_u32 v4, v216, v217, v218
    v_max3_u32 v5, v219, v220, v221
    v_max3_u32 v4, v4, v222, v223
    v_max_u32 v4, v4, v5
    v_cmp_eq_u32 vcc, -1, v4
    s_cbranch_vccnz .A_142
.W_147:
    v_smfmac_f32_16x16x64_bf16 v[76:79], v[216:219], v[140:147], v9
    v_smfmac_f32_16x16x64_bf16 v[80:83], v[216:219], v[172:179], v9
    s_waitcnt vmcnt(4)
    v_max3_u32 v4, v192, v193, v194
    v_max3_u32 v5, v195, v196, v197
    v_max3_u32 v4, v4, v198, v199
    v_smfmac_f32_16x16x64_bf16 v[76:79], v[220:223], v[148:155], v9
    v_max_u32 v4, v4, v5
    v_cmp_eq_u32 vcc, -1, v4
    v_smfmac_f32_16x16x64_bf16 v[80:83], v[220:223], v[180:187], v9
    s_cbranch_vccnz .A_148
.W_149:
    v_smfmac_f32_16x16x64_bf16 v[76:79], v[192:195], a[192:199], v9
    v_smfmac_f32_16x16x64_bf16 v[80:83], v[192:195], a[224:231], v9
    s_waitcnt vmcnt(2)
    v_max3_u32 v4, v200, v201, v202
    v_max3_u32 v5, v203, v204, v205
    v_max3_u32 v4, v4, v206, v207
    v_smfmac_f32_16x16x64_bf16 v[76:79], v[196:199], a[200:207], v9
    v_max_u32 v4, v4, v5
    v_cmp_eq_u32 vcc, -1, v4
    v_smfmac_f32_16x16x64_bf16 v[80:83], v[196:199], a[232:239], v9
    s_cbranch_vccnz .A_150
.W_151:
    v_smfmac_f32_16x16x64_bf16 v[76:79], v[200:203], a[208:215], v9
    v_smfmac_f32_16x16x64_bf16 v[80:83], v[200:203], a[240:247], v9
    s_waitcnt vmcnt(0)
    v_max3_u32 v4, v208, v209, v210
    v_max3_u32 v5, v211, v212, v213
    v_max3_u32 v4, v4, v214, v215
    v_smfmac_f32_16x16x64_bf16 v[76:79], v[204:207], a[216:223], v9
    v_max_u32 v4, v4, v5
    v_cmp_eq_u32 vcc, -1, v4
    v_smfmac_f32_16x16x64_bf16 v[80:83], v[204:207], a[248:255], v9
    s_cbranch_vccnz .A_152
.W_153:
    v_smfmac_f32_16x16x64_bf16 v[76:79], v[208:211], v[124:131], v9
    v_smfmac_f32_16x16x64_bf16 v[80:83], v[208:211], v[156:163], v9
    v_smfmac_f32_16x16x64_bf16 v[76:79], v[212:215], v[132:139], v9
    v_smfmac_f32_16x16x64_bf16 v[80:83], v[212:215], v[164:171], v9
    s_branch .mj_56
.W_143:
    v_smfmac_f32_16x16x64_bf16 v[76:79], v[200:203], a[208:215], v9
    v_smfmac_f32_16x16x64_bf16 v[80:83], v[200:203], a[240:247], v9
    s_waitcnt vmcnt(4)
    v_max3_u32 v4, v208, v209, v210
    v_max3_u32 v5, v211, v212, v213
    v_max3_u32 v4, v4, v214, v215
    v_smfmac_f32_16x16x64_bf16 v[76:79], v[204:207], a[216:223], v9
    v_max_u32 v4, v4, v5
    v_cmp_eq_u32 vcc, -1, v4
    v_smfmac_f32_16x16x64_bf16 v[80:83], v[204:207], a[248:255], v9
    s_cbranch_vccnz .A_154
.W_155:
    v_smfmac_f32_16x16x64_bf16 v[76:79], v[208:211], v[124:131], v9
    v_smfmac_f32_16x16x64_bf16 v[80:83], v[208:211], v[156:163], v9
    s_waitcnt vmcnt(2)
    v_max3_u32 v4, v216, v217, v218
    v_max3_u32 v5, v219, v220, v221
    v_max3_u32 v4, v4, v222, v223
    v_smfmac_f32_16x16x64_bf16 v[76:79], v[212:215], v[132:139], v9
    v_max_u32 v4, v4, v5
    v_cmp_eq_u32 vcc, -1, v4
    v_smfmac_f32_16x16x64_bf16 v[80:83], v[212:215], v[164:171], v9
    s_cbranch_vccnz .A_156
.W_157:
    v_smfmac_f32_16x16x64_bf16 v[76:79], v[216:219], v[140:147], v9
    v_smfmac_f32_16x16x64_bf16 v[80:83], v[216:219], v[172:179], v9
    s_waitcnt vmcnt(0)
    v_max3_u32 v4, v192, v193, v194
    v_max3_u32 v5, v195, v196, v197
    v_max3_u32 v4, v4, v198, v199
    v_smfmac_f32_16x16x64_bf16 v[76:79], v[220:223], v[148:155], v9
    v_max_u32 v4, v4, v5
    v_cmp_eq_u32 vcc, -1, v4
    v_smfmac_f32_16x16x64_bf16 v[80:83], v[220:223], v[180:187], v9
    s_cbranch_vccnz .A_158
.W_159:
    v_smfmac_f32_16x16x64_bf16 v[76:79], v[192:195], a[192:199], v9
    v_smfmac_f32_16x16x64_bf16 v[80:83], v[192:195], a[224:231], v9
    v_smfmac_f32_16x16x64_bf16 v[76:79], v[196:199], a[200:207], v9
    v_smfmac_f32_16x16x64_bf16 v[80:83], v[196:199], a[232:239], v9
    s_branch .mj_56
.W_145:
    v_smfmac_f32_16x16x64_bf16 v[76:79], v[208:211], v[124:131], v9
    v_smfmac_f32_16x16x64_bf16 v[80:83], v[208:211], v[156:163], v9
    s_waitcnt vmcnt(4)
    v_max3_u32 v4, v216, v217, v218
    v_max3_u32 v5, v219, v220, v221
    v_max3_u32 v4, v4, v222, v223
    v_smfmac_f32_16x16x64_bf16 v[76:79], v[212:215], v[132:139], v9
    v_max_u32 v4, v4, v5
    v_cmp_eq_u32 vcc, -1, v4
    v_smfmac_f32_16x16x64_bf16 v[80:83], v[212:215], v[164:171], v9
    s_cbranch_vccnz .A_160
.W_161:
    v_smfmac_f32_16x16x64_bf16 v[76:79], v[216:219], v[140:147], v9
    v_smfmac_f32_16x16x64_bf16 v[80:83], v[216:219], v[172:179], v9
    s_waitcnt vmcnt(2)
    v_max3_u32 v4, v192, v193, v194
    v_max3_u32 v5, v195, v196, v197
    v_max3_u32 v4, v4, v198, v199
    v_smfmac_f32_16x16x64_bf16 v[76:79], v[220:223], v[148:155], v9
    v_max_u32 v4, v4, v5
    v_cmp_eq_u32 vcc, -1, v4
    v_smfmac_f32_16x16x64_bf16 v[80:83], v[220:223], v[180:187], v9
    s_cbranch_vccnz .A_162
.W_163:
    v_smfmac_f32_16x16x64_bf16 v[76:79], v[192:195], a[192:199], v9
    v_smfmac_f32_16x16x64_bf16 v[80:83], v[192:195], a[224:231], v9
    s_waitcnt vmcnt(0)
    v_max3_u32 v4, v200, v201, v202
    v_max3_u32 v5, v203, v204, v205
    v_max3_u32 v4, v4, v206, v207
    v_smfmac_f32_16x16x64_bf16 v[76:79], v[196:199], a[200:207], v9
    v_max_u32 v4, v4, v5
    v_cmp_eq_u32 vcc, -1, v4
    v_smfmac_f32_16x16x64_bf16 v[80:83], v[196:199], a[232:239], v9
    s_cbranch_vccnz .A_164
.W_165:
    v_smfmac_f32_16x16x64_bf16 v[76:79], v[200:203], a[208:215], v9
    v_smfmac_f32_16x16x64_bf16 v[80:83], v[200:203], a[240:247], v9
    v_smfmac_f32_16x16x64_bf16 v[76:79], v[204:207], a[216:223], v9
    v_smfmac_f32_16x16x64_bf16 v[80:83], v[204:207], a[248:255], v9
    s_branch .mj_56
.A_166:
    buffer_load_dwordx4 v[208:211], v254, s[8:11], s32 offen offset:0 sc1
    buffer_load_dwordx4 v[212:215], v254, s[8:11], s32 offen offset:1024 sc1
    s_sub_u32 s62, s62, 1
    s_cbranch_scc1 .mg_end_1
    s_waitcnt vmcnt(4)
    v_max3_u32 v4, v192, v193, v194
    v_max3_u32 v5, v195, v196, v197
    v_max3_u32 v4, v4, v198, v199
    v_max_u32 v4, v4, v5
    v_cmp_eq_u32 vcc, -1, v4
    s_cbranch_vccz .W_149
.A_148:
    buffer_load_dwordx4 v[192:195], v243, s[8:11], s32 offen offset:0 sc1
    buffer_load_dwordx4 v[196:199], v243, s[8:11], s32 offen offset:1024 sc1
    s_waitcnt vmcnt(4)
    v_max3_u32 v4, v200, v201, v202
    v_max3_u32 v5, v203, v204, v205
    v_max3_u32 v4, v4, v206, v207
    v_max_u32 v4, v4, v5
    v_cmp_eq_u32 vcc, -1, v4
    s_cbranch_vccz .W_167
.A_168:
    buffer_load_dwordx4 v[200:203], v252, s[8:11], s32 offen offset:0 sc1
    buffer_load_dwordx4 v[204:207], v252, s[8:11], s32 offen offset:1024 sc1
    s_waitcnt vmcnt(4)
    v_max3_u32 v4, v208, v209, v210
    v_max3_u32 v5, v211, v212, v213
    v_max3_u32 v4, v4, v214, v215
    v_max_u32 v4, v4, v5
    v_cmp_eq_u32 vcc, -1, v4
    s_cbranch_vccnz .A_166
.W_169:
    v_smfmac_f32_16x16x64_bf16 v[76:79], v[208:211], v[124:131], v9
    v_smfmac_f32_16x16x64_bf16 v[80:83], v[208:211], v[156:163], v9
    s_waitcnt vmcnt(2)
    v_max3_u32 v4, v192, v193, v194
    v_max3_u32 v5, v195, v196, v197
    v_max3_u32 v4, v4, v198, v199
    v_smfmac_f32_16x16x64_bf16 v[76:79], v[212:215], v[132:139], v9
    v_max_u32 v4, v4, v5
    v_cmp_eq_u32 vcc, -1, v4
    v_smfmac_f32_16x16x64_bf16 v[80:83], v[212:215], v[164:171], v9
    s_cbranch_vccz .W_163
    s_branch .A_162
.W_167:
    v_smfmac_f32_16x16x64_bf16 v[76:79], v[200:203], a[208:215], v9
    v_smfmac_f32_16x16x64_bf16 v[80:83], v[200:203], a[240:247], v9
    s_waitcnt vmcnt(2)
    v_max3_u32 v4, v208, v209, v210
    v_max3_u32 v5, v211, v212, v213
    v_max3_u32 v4, v4, v214, v215
    v_smfmac_f32_16x16x64_bf16 v[76:79], v[204:207], a[216:223], v9
    v_max_u32 v4, v4, v5
    v_cmp_eq_u32 vcc, -1, v4
    v_smfmac_f32_16x16x64_bf16 v[80:83], v[204:207], a[248:255], v9
    s_cbranch_vccnz .A_170
.W_171:
    v_smfmac_f32_16x16x64_bf16 v[76:79], v[208:211], v[124:131], v9
    v_smfmac_f32_16x16x64_bf16 v[80:83], v[208:211], v[156:163], v9
    s_waitcnt vmcnt(0)
    v_max3_u32 v4, v192, v193, v194
    v_max3_u32 v5, v195, v196, v197
    v_max3_u32 v4, v4, v198, v199
    v_smfmac_f32_16x16x64_bf16 v[76:79], v[212:215], v[132:139], v9
    v_max_u32 v4, v4, v5
    v_cmp_eq_u32 vcc, -1, v4
    v_smfmac_f32_16x16x64_bf16 v[80:83], v[212:215], v[164:171], v9
    s_cbranch_vccz .W_159
    s_branch .A_158
.A_172:
    buffer_load_dwordx4 v[200:203], v252, s[8:11], s32 offen offset:0 sc1
    buffer_load_dwordx4 v[204:207], v252, s[8:11], s32 offen offset:1024 sc1
    s_sub_u32 s62, s62, 1
    s_cbranch_scc1 .mg_end_1
    s_waitcnt vmcnt(4)
    v_max3_u32 v4, v216, v217, v218
    v_max3_u32 v5, v219, v220, v221
    v_max3_u32 v4, v4, v222, v223
    v_max_u32 v4, v4, v5
    v_cmp_eq_u32 vcc, -1, v4
    s_cbranch_vccz .W_161
.A_160:
    buffer_load_dwordx4 v[216:219], v246, s[8:11], s32 offen offset:0 sc1
    buffer_load_dwordx4 v[220:223], v246, s[8:11], s32 offen offset:1024 sc1
    s_waitcnt vmcnt(4)
    v_max3_u32 v4, v192, v193, v194
    v_max3_u32 v5, v195, v196, v197
    v_max3_u32 v4, v4, v198, v199
    v_max_u32 v4, v4, v5
    v_cmp_eq_u32 vcc, -1, v4
    s_cbranch_vccz .W_173
.A_174:
    buffer_load_dwordx4 v[192:195], v243, s[8:11], s32 offen offset:0 sc1
    buffer_load_dwordx4 v[196:199], v243, s[8:11], s32 offen offset:1024 sc1
    s_waitcnt vmcnt(4)
    v_max3_u32 v4, v200, v201, v202
    v_max3_u32 v5, v203, v204, v205
    v_max3_u32 v4, v4, v206, v207
    v_max_u32 v4, v4, v5
    v_cmp_eq_u32 vcc, -1, v4
    s_cbranch_vccnz .A_172
.W_175:
    v_smfmac_f32_16x16x64_bf16 v[76:79], v[200:203], a[208:215], v9
    v_smfmac_f32_16x16x64_bf16 v[80:83], v[200:203], a[240:247], v9
    s_waitcnt vmcnt(2)
    v_max3_u32 v4, v216, v217, v218
    v_max3_u32 v5, v219, v220, v221
    v_max3_u32 v4, v4, v222, v223
    v_smfmac_f32_16x16x64_bf16 v[76:79], v[204:207], a[216:223], v9
    v_max_u32 v4, v4, v5
    v_cmp_eq_u32 vcc, -1, v4
    v_smfmac_f32_16x16x64_bf16 v[80:83], v[204:207], a[248:255], v9
    s_cbranch_vccz .W_157
    s_branch .A_156
.W_173:
    v_smfmac_f32_16x16x64_bf16 v[76:79], v[192:195], a[192:199], v9
    v_smfmac_f32_16x16x64_bf16 v[80:83], v[192:195], a[224:231], v9
    s_waitcnt vmcnt(2)
    v_max3_u32 v4, v200, v201, v202
    v_max3_u32 v5, v203, v204, v205
    v_max3_u32 v4, v4, v206, v207
    v_smfmac_f32_16x16x64_bf16 v[76:79], v[196:199], a[200:207], v9
    v_max_u32 v4, v4, v5
    v_cmp_eq_u32 vcc, -1, v4
    v_smfmac_f32_16x16x64_bf16 v[80:83], v[196:199], a[232:239], v9
    s_cbranch_vccnz .A_176
.W_177:
    v_smfmac_f32_16x16x64_bf16 v[76:79], v[200:203], a[208:215], v9
    v_smfmac_f32_16x16x64_bf16 v[80:83], v[200:203], a[240:247], v9
    s_waitcnt vmcnt(0)
    v_max3_u32 v4, v216, v217, v218
    v_max3_u32 v5, v219, v220, v221
    v_max3_u32 v4, v4, v222, v223
    v_smfmac_f32_16x16x64_bf16 v[76:79], v[204:207], a[216:223], v9
    v_max_u32 v4, v4, v5
    v_cmp_eq_u32 vcc, -1, v4
    v_smfmac_f32_16x16x64_bf16 v[80:83], v[204:207], a[248:255], v9
    s_cbranch_vccz .W_64
    s_branch .A_63
.A_178:
    buffer_load_dwordx4 v[216:219], v246, s[8:11], s32 offen offset:0 sc1
    buffer_load_dwordx4 v[220:223], v246, s[8:11], s32 offen offset:1024 sc1
    s_sub_u32 s62, s62, 1
    s_cbranch_scc1 .mg_end_1
    s_waitcnt vmcnt(4)
    v_max3_u32 v4, v192, v193, v194
    v_max3_u32 v5, v195, v196, v197
    v_max3_u32 v4, v4, v198, v199
    v_max_u32 v4, v4, v5
    v_cmp_eq_u32 vcc, -1, v4
    s_cbranch_vccz .W_179
.A_180:
    buffer_load_dwordx4 v[192:195], v243, s[8:11], s32 offen offset:0 sc1
    buffer_load_dwordx4 v[196:199], v243, s[8:11], s32 offen offset:1024 sc1
    s_waitcnt vmcnt(4)
    v_max3_u32 v4, v208, v209, v210
    v_max3_u32 v5, v211, v212, v213
    v_max3_u32 v4, v4, v214, v215
    v_max_u32 v4, v4, v5
    v_cmp_eq_u32 vcc, -1, v4
    s_cbranch_vccz .W_155
.A_154:
    buffer_load_dwordx4 v[208:211], v254, s[8:11], s32 offen offset:0 sc1
    buffer_load_dwordx4 v[212:215], v254, s[8:11], s32 offen offset:1024 sc1
    s_waitcnt vmcnt(4)
    v_max3_u32 v4, v216, v217, v218
    v_max3_u32 v5, v219, v220, v221
    v_max3_u32 v4, v4, v222, v223
    v_max_u32 v4, v4, v5
    v_cmp_eq_u32 vcc, -1, v4
    s_cbranch_vccnz .A_178
.W_181:
    v_smfmac_f32_16x16x64_bf16 v[76:79], v[216:219], v[140:147], v9
    v_smfmac_f32_16x16x64_bf16 v[80:83], v[216:219], v[172:179], v9
    s_waitcnt vmcnt(2)
    v_max3_u32 v4, v192, v193, v194
    v_max3_u32 v5, v195, v196, v197
    v_max3_u32 v4, v4, v198, v199
    v_smfmac_f32_16x16x64_bf16 v[76:79], v[220:223], v[148:155], v9
    v_max_u32 v4, v4, v5
    v_cmp_eq_u32 vcc, -1, v4
    v_smfmac_f32_16x16x64_bf16 v[80:83], v[220:223], v[180:187], v9
    s_cbranch_vccnz .A_182
.W_183:
    v_smfmac_f32_16x16x64_bf16 v[76:79], v[192:195], a[192:199], v9
    v_smfmac_f32_16x16x64_bf16 v[80:83], v[192:195], a[224:231], v9
    s_waitcnt vmcnt(0)
    v_max3_u32 v4, v208, v209, v210
    v_max3_u32 v5, v211, v212, v213
    v_max3_u32 v4, v4, v214, v215
    v_smfmac_f32_16x16x64_bf16 v[76:79], v[196:199], a[200:207], v9
    v_max_u32 v4, v4, v5
    v_cmp_eq_u32 vcc, -1, v4
    v_smfmac_f32_16x16x64_bf16 v[80:83], v[196:199], a[232:239], v9
    s_cbranch_vccz .W_153
    s_branch .A_152
.W_179:
    v_smfmac_f32_16x16x64_bf16 v[76:79], v[192:195], a[192:199], v9
    v_smfmac_f32_16x16x64_bf16 v[80:83], v[192:195], a[224:231], v9
    s_waitcnt vmcnt(2)
    v_max3_u32 v4, v208, v209, v210
    v_max3_u32 v5, v211, v212, v213
    v_max3_u32 v4, v4, v214, v215
    v_smfmac_f32_16x16x64_bf16 v[76:79], v[196:199], a[200:207], v9
    v_max_u32 v4, v4, v5
    v_cmp_eq_u32 vcc, -1, v4
    v_smfmac_f32_16x16x64_bf16 v[80:83], v[196:199], a[232:239], v9
    s_cbranch_vccz .W_62
    s_branch .A_61
.A_184:
    buffer_load_dwordx4 v[216:219], v246, s[8:11], s32 offen offset:0 sc1
    buffer_load_dwordx4 v[220:223], v246, s[8:11], s32 offen offset:1024 sc1
    s_sub_u32 s62, s62, 1
    s_cbranch_scc1 .mg_end_1
    s_waitcnt vmcnt(4)
    v_max3_u32 v4, v200, v201, v202
    v_max3_u32 v5, v203, v204, v205
    v_max3_u32 v4, v4, v206, v207
    v_max_u32 v4, v4, v5
    v_cmp_eq_u32 vcc, -1, v4
    s_cbranch_vccz .W_60
.A_59:
    buffer_load_dwordx4 v[200:203], v252, s[8:11], s32 offen offset:0 sc1
    buffer_load_dwordx4 v[204:207], v252, s[8:11], s32 offen offset:1024 sc1
    s_waitcnt vmcnt(4)
    v_max3_u32 v4, v208, v209, v210
    v_max3_u32 v5, v211, v212, v213
    v_max3_u32 v4, v4, v214, v215
    v_max_u32 v4, v4, v5
    v_cmp_eq_u32 vcc, -1, v4
    s_cbranch_vccz .W_185
.A_186:
    buffer_load_dwordx4 v[208:211], v254, s[8:11], s32 offen offset:0 sc1
    buffer_load_dwordx4 v[212:215], v254, s[8:11], s32 offen offset:1024 sc1
    s_waitcnt vmcnt(4)
    v_max3_u32 v4, v216, v217, v218
    v_max3_u32 v5, v219, v220, v221
    v_max3_u32 v4, v4, v222, v223
    v_max_u32 v4, v4, v5
    v_cmp_eq_u32 vcc, -1, v4
    s_cbranch_vccnz .A_184
.W_187:
    v_smfmac_f32_16x16x64_bf16 v[76:79], v[216:219], v[140:147], v9
    v_smfmac_f32_16x16x64_bf16 v[80:83], v[216:219], v[172:179], v9
    s_waitcnt vmcnt(2)
    v_max3_u32 v4, v200, v201, v202
    v_max3_u32 v5, v203, v204, v205
    v_max3_u32 v4, v4, v206, v207
    v_smfmac_f32_16x16x64_bf16 v[76:79], v[220:223], v[148:155], v9
    v_max_u32 v4, v4, v5
    v_cmp_eq_u32 vcc, -1, v4
    v_smfmac_f32_16x16x64_bf16 v[80:83], v[220:223], v[180:187], v9
    s_cbranch_vccz .W_151
    s_branch .A_150
.W_185:
    v_smfmac_f32_16x16x64_bf16 v[76:79], v[208:211], v[124:131], v9
    v_smfmac_f32_16x16x64_bf16 v[80:83], v[208:211], v[156:163], v9
    s_waitcnt vmcnt(2)
    v_max3_u32 v4, v216, v217, v218
    v_max3_u32 v5, v219, v220, v221
    v_max3_u32 v4, v4, v222, v223
    v_smfmac_f32_16x16x64_bf16 v[76:79], v[212:215], v[132:139], v9
    v_max_u32 v4, v4, v5
    v_cmp_eq_u32 vcc, -1, v4
    v_smfmac_f32_16x16x64_bf16 v[80:83], v[212:215], v[164:171], v9
    s_cbranch_vccnz .A_188
.W_189:
    v_smfmac_f32_16x16x64_bf16 v[76:79], v[216:219], v[140:147], v9
    v_smfmac_f32_16x16x64_bf16 v[80:83], v[216:219], v[172:179], v9
    s_waitcnt vmcnt(0)
    v_max3_u32 v4, v200, v201, v202
    v_max3_u32 v5, v203, v204, v205
    v_max3_u32 v4, v4, v206, v207
    v_smfmac_f32_16x16x64_bf16 v[76:79], v[220:223], v[148:155], v9
    v_max_u32 v4, v4, v5
    v_cmp_eq_u32 vcc, -1, v4
    v_smfmac_f32_16x16x64_bf16 v[80:83], v[220:223], v[180:187], v9
    s_cbranch_vccz .W_165
    s_branch .A_164
.A_190:
    buffer_load_dwordx4 v[200:203], v252, s[8:11], s32 offen offset:0 sc1
    buffer_load_dwordx4 v[204:207], v252, s[8:11], s32 offen offset:1024 sc1
    s_sub_u32 s62, s62, 1
    s_cbranch_scc1 .mg_end_1
    s_waitcnt vmcnt(2)
    v_max3_u32 v4, v192, v193, v194
    v_max3_u32 v5, v195, v196, v197
    v_max3_u32 v4, v4, v198, v199
    v_max_u32 v4, v4, v5
    v_cmp_eq_u32 vcc, -1, v4
    s_cbranch_vccz .W_163
.A_162:
    buffer_load_dwordx4 v[192:195], v243, s[8:11], s32 offen offset:0 sc1
    buffer_load_dwordx4 v[196:199], v243, s[8:11], s32 offen offset:1024 sc1
    s_waitcnt vmcnt(2)
    v_max3_u32 v4, v200, v201, v202
    v_max3_u32 v5, v203, v204, v205
    v_max3_u32 v4, v4, v206, v207
    v_max_u32 v4, v4, v5
    v_cmp_eq_u32 vcc, -1, v4
    s_cbranch_vccnz .A_190
.W_191:
    v_smfmac_f32_16x16x64_bf16 v[76:79], v[200:203], a[208:215], v9
    v_smfmac_f32_16x16x64_bf16 v[80:83], v[200:203], a[240:247], v9
    s_waitcnt vmcnt(0)
    v_max3_u32 v4, v192, v193, v194
    v_max3_u32 v5, v195, v196, v197
    v_max3_u32 v4, v4, v198, v199
    v_smfmac_f32_16x16x64_bf16 v[76:79], v[204:207], a[216:223], v9
    v_max_u32 v4, v4, v5
    v_cmp_eq_u32 vcc, -1, v4
    v_smfmac_f32_16x16x64_bf16 v[80:83], v[204:207], a[248:255], v9
    s_cbranch_vccz .W_159
    s_branch .A_158
.A_170:
    buffer_load_dwordx4 v[208:211], v254, s[8:11], s32 offen offset:0 sc1
    buffer_load_dwordx4 v[212:215], v254, s[8:11], s32 offen offset:1024 sc1
    s_sub_u32 s62, s62, 1
    s_cbranch_scc1 .mg_end_1
    s_waitcnt vmcnt(2)
    v_max3_u32 v4, v192, v193, v194
    v_max3_u32 v5, v195, v196, v197
    v_max3_u32 v4, v4, v198, v199
    v_max_u32 v4, v4, v5
    v_cmp_eq_u32 vcc, -1, v4
    s_cbranch_vccz .W_183
.A_182:
    buffer_load_dwordx4 v[192:195], v243, s[8:11], s32 offen offset:0 sc1
    buffer_load_dwordx4 v[196:199], v243, s[8:11], s32 offen offset:1024 sc1
    s_waitcnt vmcnt(2)
    v_max3_u32 v4, v208, v209, v210
    v_max3_u32 v5, v211, v212, v213
    v_max3_u32 v4, v4, v214, v215
    v_max_u32 v4, v4, v5
    v_cmp_eq_u32 vcc, -1, v4
    s_cbranch_vccnz .A_170
    s_branch .W_171
.A_192:
    buffer_load_dwordx4 v[192:195], v243, s[8:11], s32 offen offset:0 sc1
    buffer_load_dwordx4 v[196:199], v243, s[8:11], s32 offen offset:1024 sc1
    s_sub_u32 s62, s62, 1
    s_cbranch_scc1 .mg_end_1
    s_waitcnt vmcnt(2)
    v_max3_u32 v4, v216, v217, v218
    v_max3_u32 v5, v219, v220, v221
    v_max3_u32 v4, v4, v222, v223
    v_max_u32 v4, v4, v5
    v_cmp_eq_u32 vcc, -1, v4
    s_cbranch_vccz .W_157
.A_156:
    buffer_load_dwordx4 v[216:219], v246, s[8:11], s32 offen offset:0 sc1
    buffer_load_dwordx4 v[220:223], v246, s[8:11], s32 offen offset:1024 sc1
    s_waitcnt vmcnt(2)
    v_max3_u32 v4, v192, v193, v194
    v_max3_u32 v5, v195, v196, v197
    v_max3_u32 v4, v4, v198, v199
    v_max_u32 v4, v4, v5
    v_cmp_eq_u32 vcc, -1, v4
    s_cbranch_vccnz .A_192
.W_193:
    v_smfmac_f32_16x16x64_bf16 v[76:79], v[192:195], a[192:199], v9
    v_smfmac_f32_16x16x64_bf16 v[80:83], v[192:195], a[224:231], v9
    s_waitcnt vmcnt(0)
    v_max3_u32 v4, v216, v217, v218
    v_max3_u32 v5, v219, v220, v221
    v_max3_u32 v4, v4, v222, v223
    v_smfmac_f32_16x16x64_bf16 v[76:79], v[196:199], a[200:207], v9
    v_max_u32 v4, v4, v5
    v_cmp_eq_u32 vcc, -1, v4
    v_smfmac_f32_16x16x64_bf16 v[80:83], v[196:199], a[232:239], v9
    s_cbranch_vccz .W_64
    s_branch .A_63
.A_194:
    buffer_load_dwordx4 v[208:211], v254, s[8:11], s32 offen offset:0 sc1
    buffer_load_dwordx4 v[212:215], v254, s[8:11], s32 offen offset:1024 sc1
    s_sub_u32 s62, s62, 1
    s_cbranch_scc1 .mg_end_1
    s_waitcnt vmcnt(2)
    v_max3_u32 v4, v200, v201, v202
    v_max3_u32 v5, v203, v204, v205
    v_max3_u32 v4, v4, v206, v207
    v_max_u32 v4, v4, v5
    v_cmp_eq_u32 vcc, -1, v4
    s_cbranch_vccz .W_151
.A_150:
    buffer_load_dwordx4 v[200:203], v252, s[8:11], s32 offen offset:0 sc1
    buffer_load_dwordx4 v[204:207], v252, s[8:11], s32 offen offset:1024 sc1
    s_waitcnt vmcnt(2)
    v_max3_u32 v4, v208, v209, v210
    v_max3_u32 v5, v211, v212, v213
    v_max3_u32 v4, v4, v214, v215
    v_max_u32 v4, v4, v5
    v_cmp_eq_u32 vcc, -1, v4
    s_cbranch_vccnz .A_194
.W_195:
    v_smfmac_f32_16x16x64_bf16 v[76:79], v[208:211], v[124:131], v9
    v_smfmac_f32_16x16x64_bf16 v[80:83], v[208:211], v[156:163], v9
    s_waitcnt vmcnt(0)
    v_max3_u32 v4, v200, v201, v202
    v_max3_u32 v5, v203, v204, v205
    v_max3_u32 v4, v4, v206, v207
    v_smfmac_f32_16x16x64_bf16 v[76:79], v[212:215], v[132:139], v9
    v_max_u32 v4, v4, v5
    v_cmp_eq_u32 vcc, -1, v4
    v_smfmac_f32_16x16x64_bf16 v[80:83], v[212:215], v[164:171], v9
    s_cbranch_vccz .W_165
    s_branch .A_164
.A_188:
    buffer_load_dwordx4 v[216:219], v246, s[8:11], s32 offen offset:0 sc1
    buffer_load_dwordx4 v[220:223], v246, s[8:11], s32 offen offset:1024 sc1
    s_sub_u32 s62, s62, 1
    s_cbranch_scc1 .mg_end_1
    s_waitcnt vmcnt(2)
    v_max3_u32 v4, v200, v201, v202
    v_max3_u32 v5, v203, v204, v205
    v_max3_u32 v4, v4, v206, v207
    v_max_u32 v4, v4, v5
    v_cmp_eq_u32 vcc, -1, v4
    s_cbranch_vccz .W_177
.A_176:
    buffer_load_dwordx4 v[200:203], v252, s[8:11], s32 offen offset:0 sc1
    buffer_load_dwordx4 v[204:207], v252, s[8:11], s32 offen offset:1024 sc1
    s_waitcnt vmcnt(2)
    v_max3_u32 v4, v216, v217, v218
    v_max3_u32 v5, v219, v220, v221
    v_max3_u32 v4, v4, v222, v223
    v_max_u32 v4, v4, v5
    v_cmp_eq_u32 vcc, -1, v4
    s_cbranch_vccnz .A_188
    s_branch .W_189
.A_196:
    buffer_load_dwordx4 v[216:219], v246, s[8:11], s32 offen offset:0 sc1
    buffer_load_dwordx4 v[220:223], v246, s[8:11], s32 offen offset:1024 sc1
    s_sub_u32 s62, s62, 1
    s_cbranch_scc1 .mg_end_1
    s_waitcnt vmcnt(2)
    v_max3_u32 v4, v208, v209, v210
    v_max3_u32 v5, v211, v212, v213
    v_max3_u32 v4, v4, v214, v215
    v_max_u32 v4, v4, v5
    v_cmp_eq_u32 vcc, -1, v4
    s_cbranch_vccz .W_62
.A_61:
    buffer_load_dwordx4 v[208:211], v254, s[8:11], s32 offen offset:0 sc1
    buffer_load_dwordx4 v[212:215], v254, s[8:11], s32 offen offset:1024 sc1
    s_waitcnt vmcnt(2)
    v_max3_u32 v4, v216, v217, v218
    v_max3_u32 v5, v219, v220, v221
    v_max3_u32 v4, v4, v222, v223
    v_max_u32 v4, v4, v5
    v_cmp_eq_u32 vcc, -1, v4
    s_cbranch_vccnz .A_196
.W_197:
    v_smfmac_f32_16x16x64_bf16 v[76:79], v[216:219], v[140:147], v9
    v_smfmac_f32_16x16x64_bf16 v[80:83], v[216:219], v[172:179], v9
    s_waitcnt vmcnt(0)
    v_max3_u32 v4, v208, v209, v210
    v_max3_u32 v5, v211, v212, v213
    v_max3_u32 v4, v4, v214, v215
    v_smfmac_f32_16x16x64_bf16 v[76:79], v[220:223], v[148:155], v9
    v_max_u32 v4, v4, v5
    v_cmp_eq_u32 vcc, -1, v4
    v_smfmac_f32_16x16x64_bf16 v[80:83], v[220:223], v[180:187], v9
    s_cbranch_vccz .W_153
    s_branch .A_152
.A_158:
    buffer_load_dwordx4 v[192:195], v243, s[8:11], s32 offen offset:0 sc1
    buffer_load_dwordx4 v[196:199], v243, s[8:11], s32 offen offset:1024 sc1
    s_sub_u32 s62, s62, 1
    s_cbranch_scc1 .mg_end_1
    s_waitcnt vmcnt(2)
    v_max3_u32 v4, v192, v193, v194
    v_max3_u32 v5, v195, v196, v197
    v_max3_u32 v4, v4, v198, v199
    v_max_u32 v4, v4, v5
    v_cmp_eq_u32 vcc, -1, v4
    s_cbranch_vccnz .A_158
    v_smfmac_f32_16x16x64_bf16 v[76:79], v[192:195], a[192:199], v9
    v_smfmac_f32_16x16x64_bf16 v[80:83], v[192:195], a[224:231], v9
    v_smfmac_f32_16x16x64_bf16 v[76:79], v[196:199], a[200:207], v9
    v_smfmac_f32_16x16x64_bf16 v[80:83], v[196:199], a[232:239], v9
    s_branch .mj_56
.A_164:
    buffer_load_dwordx4 v[200:203], v252, s[8:11], s32 offen offset:0 sc1
    buffer_load_dwordx4 v[204:207], v252, s[8:11], s32 offen offset:1024 sc1
    s_sub_u32 s62, s62, 1
    s_cbranch_scc1 .mg_end_1
    s_waitcnt vmcnt(2)
    v_max3_u32 v4, v200, v201, v202
    v_max3_u32 v5, v203, v204, v205
    v_max3_u32 v4, v4, v206, v207
    v_max_u32 v4, v4, v5
    v_cmp_eq_u32 vcc, -1, v4
    s_cbranch_vccnz .A_164
    v_smfmac_f32_16x16x64_bf16 v[76:79], v[200:203], a[208:215], v9
    v_smfmac_f32_16x16x64_bf16 v[80:83], v[200:203], a[240:247], v9
    v_smfmac_f32_16x16x64_bf16 v[76:79], v[204:207], a[216:223], v9
    v_smfmac_f32_16x16x64_bf16 v[80:83], v[204:207], a[248:255], v9
    s_branch .mj_56
.A_152:
    buffer_load_dwordx4 v[208:211], v254, s[8:11], s32 offen offset:0 sc1
    buffer_load_dwordx4 v[212:215], v254, s[8:11], s32 offen offset:1024 sc1
    s_sub_u32 s62, s62, 1
    s_cbranch_scc1 .mg_end_1
    s_waitcnt vmcnt(2)
    v_max3_u32 v4, v208, v209, v210
    v_max3_u32 v5, v211, v212, v213
    v_max3_u32 v4, v4, v214, v215
    v_max_u32 v4, v4, v5
    v_cmp_eq_u32 vcc, -1, v4
    s_cbranch_vccnz .A_152
    v_smfmac_f32_16x16x64_bf16 v[76:79], v[208:211], v[124:131], v9
    v_smfmac_f32_16x16x64_bf16 v[80:83], v[208:211], v[156:163], v9
    v_smfmac_f32_16x16x64_bf16 v[76:79], v[212:215], v[132:139], v9
    v_smfmac_f32_16x16x64_bf16 v[80:83], v[212:215], v[164:171], v9
    s_branch .mj_56
.A_63:
    buffer_load_dwordx4 v[216:219], v246, s[8:11], s32 offen offset:0 sc1
    buffer_load_dwordx4 v[220:223], v246, s[8:11], s32 offen offset:1024 sc1
    s_sub_u32 s62, s62, 1
    s_cbranch_scc1 .mg_end_1
    s_waitcnt vmcnt(2)
    v_max3_u32 v4, v216, v217, v218
    v_max3_u32 v5, v219, v220, v221
    v_max3_u32 v4, v4, v222, v223
    v_max_u32 v4, v4, v5
    v_cmp_eq_u32 vcc, -1, v4
    s_cbranch_vccnz .A_63
    v_smfmac_f32_16x16x64_bf16 v[76:79], v[216:219], v[140:147], v9
    v_smfmac_f32_16x16x64_bf16 v[80:83], v[216:219], v[172:179], v9
    v_smfmac_f32_16x16x64_bf16 v[76:79], v[220:223], v[148:155], v9
    v_smfmac_f32_16x16x64_bf16 v[80:83], v[220:223], v[180:187], v9
    s_branch .mj_56
.sk_65:
    s_mov_b64 exec, s[66:67]
    buffer_store_dwordx4 v[88:91], v11, s[8:11], s36 offen sc1
    s_mov_b64 exec, s[56:57]
    buffer_store_dwordx4 v[172:175], v12, s[8:11], s36 offen sc1
    s_mov_b64 exec, -1

    s_branch .rec_fin_6
.p2align 6
.top_198:
    s_barrier
    buffer_load_dwordx4 v[20:23], v8, s[8:11], s29 offen offset:0 sc1
    v_mov_b32 v52, 0
    buffer_load_dwordx4 v[24:27], v8, s[8:11], s29 offen offset:1024 sc1
    v_mov_b32 v53, 0
    buffer_load_dwordx4 v[28:31], v8, s[8:11], s29 offen offset:2048 sc1
    v_mov_b32 v54, 0
    buffer_load_dwordx4 v[32:35], v8, s[8:11], s29 offen offset:3072 sc1
.ent1_25:
    s_waitcnt vmcnt(3)
    v_max3_u32 v4, v20, v21, v22
    v_max_u32 v4, v4, v23
    v_cmp_eq_u32 vcc, -1, v4
    s_cbranch_vccnz .A_203
.W_204:
    v_smfmac_f32_16x16x64_bf16 v[52:55], v[20:23], a[0:7], v9
    v_smfmac_f32_16x16x64_bf16 v[56:59], v[20:23], a[32:39], v9
    s_waitcnt vmcnt(2)
    v_max3_u32 v4, v24, v25, v26
    v_max_u32 v4, v4, v27
    v_smfmac_f32_16x16x64_bf16 v[60:63], v[20:23], a[64:71], v9
    v_cmp_eq_u32 vcc, -1, v4
    v_smfmac_f32_16x16x64_bf16 v[64:67], v[20:23], a[96:103], v9
    s_cbranch_vccnz .A_205
.W_206:
    v_smfmac_f32_16x16x64_bf16 v[52:55], v[24:27], a[8:15], v9
    v_smfmac_f32_16x16x64_bf16 v[56:59], v[24:27], a[40:47], v9
    s_waitcnt vmcnt(1)
    v_max3_u32 v4, v28, v29, v30
    v_max_u32 v4, v4, v31
    v_smfmac_f32_16x16x64_bf16 v[60:63], v[24:27], a[72:79], v9
    v_cmp_eq_u32 vcc, -1, v4
    v_smfmac_f32_16x16x64_bf16 v[64:67], v[24:27], a[104:111], v9
    s_cbranch_vccnz .A_207
.W_208:
    v_smfmac_f32_16x16x64_bf16 v[52:55], v[28:31], a[16:23], v9
    v_smfmac_f32_16x16x64_bf16 v[56:59], v[28:31], a[48:55], v9
    s_waitcnt vmcnt(0)
    v_max3_u32 v4, v32, v33, v34
    v_max_u32 v4, v4, v35
    v_smfmac_f32_16x16x64_bf16 v[60:63], v[28:31], a[80:87], v9
    v_cmp_eq_u32 vcc, -1, v4
    v_smfmac_f32_16x16x64_bf16 v[64:67], v[28:31], a[112:119], v9
    s_cbranch_vccnz .A_209
.W_210:
    v_smfmac_f32_16x16x64_bf16 v[52:55], v[32:35], a[24:31], v9
    v_smfmac_f32_16x16x64_bf16 v[56:59], v[32:35], a[56:63], v9
    v_smfmac_f32_16x16x64_bf16 v[60:63], v[32:35], a[88:95], v9
    v_smfmac_f32_16x16x64_bf16 v[64:67], v[32:35], a[120:127], v9
.mj_202:
    v_cvt_pk_bf16_f32 v104, v52, v53
    v_cvt_pk_bf16_f32 v105, v54, v55
    v_cvt_pk_bf16_f32 v106, v56, v57
    v_cvt_pk_bf16_f32 v107, v58, v59
    ds_write_b64 v16, v[104:105] offset:4096
    v_cvt_pk_bf16_f32 v108, v60, v61
    v_cvt_pk_bf16_f32 v109, v62, v63
    ds_write_b64 v16, v[106:107] offset:6144
    ds_write_b64 v16, v[108:109] offset:0
    v_cvt_pk_bf16_f32 v110, v64, v65
    v_cvt_pk_bf16_f32 v111, v66, v67
    ds_write_b64 v16, v[110:111] offset:2048
    v_smfmac_f32_16x16x64_bf16 v[68:71], v[20:23], a[128:135], v9
    v_smfmac_f32_16x16x64_bf16 v[72:75], v[20:23], a[160:167], v9
    s_waitcnt lgkmcnt(0)
    s_barrier
    ds_read_b128 v[36:39], v17 offset:0
    ds_read_b128 v[40:43], v17 offset:1024
    v_smfmac_f32_16x16x64_bf16 v[68:71], v[24:27], a[136:143], v9
    v_smfmac_f32_16x16x64_bf16 v[72:75], v[24:27], a[168:175], v9
    s_waitcnt lgkmcnt(1)
    v_mfma_f32_16x16x32_bf16 v[44:47], v[36:39], v[84:87], 0
    s_waitcnt lgkmcnt(0)
    v_mfma_f32_16x16x32_bf16 v[44:47], v[40:43], v[84:87], v[44:47]
    v_smfmac_f32_16x16x64_bf16 v[68:71], v[28:31], a[144:151], v9
    v_smfmac_f32_16x16x64_bf16 v[72:75], v[28:31], a[176:183], v9
    s_mov_b64 exec, s[64:65]
    v_cvt_pk_bf16_f32 v48, v44, v45
    v_cvt_pk_bf16_f32 v49, v46, v47
    v_min_u32 v48, 0xfffffffe, v48
    v_min_u32 v49, 0xfffffffe, v49
    buffer_store_dwordx2 v[48:49], v10, s[8:11], s29 offen sc1

    ds_write_b64 v18, v[48:49]
    s_mov_b64 exec, -1

    v_smfmac_f32_16x16x64_bf16 v[68:71], v[32:35], a[152:159], v9
    v_smfmac_f32_16x16x64_bf16 v[72:75], v[32:35], a[184:191], v9
    s_nop 3
    v_cvt_pk_bf16_f32 v104, v68, v69
    v_cvt_pk_bf16_f32 v105, v70, v71
    ds_write_b64 v16, v[104:105] offset:8192
    s_nop 0
    v_cvt_pk_bf16_f32 v106, v72, v73
    v_cvt_pk_bf16_f32 v107, v74, v75
    ds_write_b64 v16, v[106:107] offset:10240
    s_cmp_lg_u32 s24, 2
    s_waitcnt lgkmcnt(0)
    s_barrier
    s_cbranch_scc1 .oth_199
    buffer_load_dwordx4 v[92:95], v232, s[8:11], s29 offen sc1
    buffer_load_dwordx4 v[96:99], v233, s[8:11], s29 offen sc1
    buffer_load_dwordx4 v[100:103], v234, s[8:11], s29 offen sc1
    ds_read_b128 v[88:91], v14 offset:16384
    s_cmp_eq_u32 s28, 63
    s_cbranch_scc1 .rec_fin_6
    s_waitcnt lgkmcnt(0)
    v_mfma_f32_16x16x32_bf16 v[208:211], v[128:131], v[88:91], 0
    v_mfma_f32_16x16x32_bf16 v[212:215], v[144:147], v[88:91], 0
    v_mfma_f32_16x16x32_bf16 v[216:219], v[88:91], v[88:91], v[116:119]
    s_waitcnt vmcnt(2)
    v_max3_u32 v4, v92, v93, v94
    v_max_u32 v4, v4, v95
    v_cmp_eq_u32 vcc, -1, v4
    s_cbranch_vccnz .A_212
.W_213:
    v_mfma_f32_16x16x32_bf16 v[208:211], v[132:135], v[92:95], v[208:211]
    s_waitcnt vmcnt(1)
    v_max3_u32 v4, v96, v97, v98
    v_max_u32 v4, v4, v99
    v_mfma_f32_16x16x32_bf16 v[212:215], v[148:151], v[92:95], v[212:215]
    v_cmp_eq_u32 vcc, -1, v4
    v_mfma_f32_16x16x32_bf16 v[216:219], v[92:95], v[92:95], v[216:219]
    s_cbranch_vccnz .A_214
.W_215:
    v_mfma_f32_16x16x32_bf16 v[208:211], v[136:139], v[96:99], v[208:211]
    s_waitcnt vmcnt(0)
    v_max3_u32 v4, v100, v101, v102
    v_max_u32 v4, v4, v103
    v_mfma_f32_16x16x32_bf16 v[212:215], v[152:155], v[96:99], v[212:215]
    v_cmp_eq_u32 vcc, -1, v4
    v_mfma_f32_16x16x32_bf16 v[216:219], v[96:99], v[96:99], v[216:219]
    s_cbranch_vccnz .A_216
.W_217:
    v_mfma_f32_16x16x32_bf16 v[208:211], v[140:143], v[100:103], v[208:211]
    v_mfma_f32_16x16x32_bf16 v[212:215], v[156:159], v[100:103], v[212:215]
    v_mfma_f32_16x16x32_bf16 v[216:219], v[100:103], v[100:103], v[216:219]
.mj_211:
    s_barrier
    ds_read_b64 v[168:169], v14 offset:18432
    ds_read_b64 v[172:173], v14 offset:18440
    s_nop 0

    v_mov_b32_dpp v208, v212 row_ror:8 row_mask:0xf bank_mask:0xc
    v_mov_b32_dpp v209, v213 row_ror:8 row_mask:0xf bank_mask:0xc
    v_mov_b32_dpp v210, v214 row_ror:8 row_mask:0xf bank_mask:0xc
    v_mov_b32_dpp v211, v215 row_ror:8 row_mask:0xf bank_mask:0xc
    v_mov_b32_dpp v216, v218 row_ror:8 row_mask:0xf bank_mask:0xc
    v_mov_b32_dpp v217, v219 row_ror:8 row_mask:0xf bank_mask:0xc
    v_max3_f32 v4, v208, v209, v210
    v_max3_f32 v5, v211, v216, v217
    v_max_f32 v6, v4, v5
    v_max_f32 v4, v4, v5
    s_nop 1
    v_permlane32_swap_b32 v4, v6
    v_max_f32 v5, v4, v6
    v_max_f32 v4, v4, v6
    s_nop 1
    v_permlane16_swap_b32 v4, v5
    v_max_f32 v4, v4, v5
    s_nop 1
    v_max_f32_dpp v4, v4, v4 row_ror:8 row_mask:0xf bank_mask:0xf
    v_mul_f32 v4, s37, v4

    v_fma_f32 v104, v208, s37, -v4
    v_fma_f32 v105, v209, s37, -v4
    v_fma_f32 v106, v210, s37, -v4
    v_fma_f32 v107, v211, s37, -v4
    v_fma_f32 v108, v216, s37, -v4
    v_fma_f32 v109, v217, s37, -v4
    v_exp_f32 v104, v104
    v_exp_f32 v105, v105
    v_exp_f32 v106, v106
    v_exp_f32 v107, v107
    v_exp_f32 v108, v108
    v_exp_f32 v109, v109
    v_cvt_pk_bf16_f32 v176, v104, v105
    v_cvt_pk_bf16_f32 v177, v106, v107
    v_cvt_pk_bf16_f32 v180, v108, v109
    v_mov_b32_dpp v178, v176 row_ror:8 row_mask:0xf bank_mask:0xf
    v_mov_b32_dpp v179, v177 row_ror:8 row_mask:0xf bank_mask:0xf
    v_mov_b32_dpp v181, v180 row_ror:8 row_mask:0xf bank_mask:0xf
    s_waitcnt lgkmcnt(0)

    v_mfma_f32_16x16x32_bf16 v[208:211], v[120:123], v[176:179], 0
    v_mfma_f32_16x16x32_bf16 v[208:211], v[120:123], v[180:183], v[208:211]
    v_mfma_f32_16x16x32_bf16 v[212:215], v[160:163], v[176:179], 0
    v_mfma_f32_16x16x32_bf16 v[216:219], v[164:167], v[176:179], 0
    v_mfma_f32_16x16x32_bf16 v[212:215], v[168:171], v[180:183], v[212:215]
    v_rcp_f32 v4, v208
    v_mfma_f32_16x16x32_bf16 v[216:219], v[172:175], v[180:183], v[216:219]
    s_mov_b64 exec, s[58:59]
    s_nop 2
    v_mul_f32 v212, v4, v212
    v_mul_f32 v213, v4, v213
    v_mul_f32 v214, v4, v214
    v_mul_f32 v215, v4, v215
    v_cvt_pk_bf16_f32 v184, v212, v213
    v_cvt_pk_bf16_f32 v185, v214, v215
    v_mul_f32 v216, v4, v216
    v_mul_f32 v217, v4, v217
    v_min_u32 v184, 0xfffffffe, v184
    v_min_u32 v185, 0xfffffffe, v185
    v_mul_f32 v218, v4, v218
    v_mul_f32 v219, v4, v219
    v_cvt_pk_bf16_f32 v186, v216, v217
    v_cvt_pk_bf16_f32 v187, v218, v219
    v_min_u32 v186, 0xfffffffe, v186
    v_min_u32 v187, 0xfffffffe, v187
    buffer_store_dwordx4 v[184:187], v13, s[8:11], s29 offen sc1
    s_mov_b64 exec, -1

.gp_201:
    s_barrier
    v_mov_b32 v5, 19968
    ds_read_b32 v4, v5
    s_mov_b32 s99, s68
    s_waitcnt vmcnt(0)
    s_cmp_eq_u32 s24, 3
    s_cbranch_scc1 .u3_218
    s_add_u32 s6, s28, 3
    s_add_u32 s7, s30, 262144
    s_waitcnt lgkmcnt(0)
    v_readfirstlane_b32 s5, v4
    s_cmp_lt_u32 s5, s6
    s_barrier
    s_cbranch_scc1 .np_220
    buffer_load_dword v226, v225, s[8:11], s7 offen

.np_220:
    s_add_u32 s4, s70, 0
    buffer_store_dwordx4 v[188:191], v238, s[8:11], s4 offen sc1
    s_add_u32 s4, s70, 262144
    buffer_store_dwordx4 v[188:191], v238, s[8:11], s4 offen sc1
    s_branch .u4_219
.u3_218:
    s_sub_u32 s4, s36, 0
    s_barrier
    s_mov_b64 exec, s[66:67]
    buffer_store_dwordx4 v[88:91], v11, s[8:11], s4 offen sc1
    s_mov_b64 exec, s[56:57]
    buffer_store_dwordx4 v[172:175], v12, s[8:11], s4 offen sc1
    s_mov_b64 exec, -1

.u4_219:
    s_barrier
    s_add_u32 s28, s28, 1
    s_add_u32 s36, s36, 196608
    s_cmp_lt_u32 s28, 63
    s_cselect_b32 s4, 262144, 0
    s_add_u32 s38, s38, s4
    s_add_u32 s39, s39, s4
    s_add_u32 s30, s30, s4
    s_mov_b32 s4, s68
    s_mov_b32 s68, s69
    s_mov_b32 s69, s70
    s_mov_b32 s70, s71
    s_mov_b32 s71, s4
    s_and_b32 s4, s28, 3
    s_lshl_b32 s5, s4, 17
    s_add_u32 s29, s5, s34
    s_xor_b32 s6, s5, 262144
    s_add_u32 s31, s6, s34
    s_add_u32 s32, s29, 20480
    s_add_u32 s33, s29, 24576
    v_mov_b32 v55, 0
    v_mov_b32 v56, 0
    v_mov_b32 v57, 0
    v_mov_b32 v58, 0
    v_mov_b32 v59, 0
    v_mov_b32 v60, 0
    v_mov_b32 v61, 0
    v_mov_b32 v62, 0
    v_mov_b32 v63, 0
    v_mov_b32 v64, 0
    v_mov_b32 v65, 0
    v_mov_b32 v66, 0
    v_mov_b32 v67, 0
    v_mov_b32 v68, 0
    v_mov_b32 v69, 0
    v_mov_b32 v70, 0
    v_mov_b32 v71, 0
    v_mov_b32 v72, 0
    v_mov_b32 v73, 0
    v_mov_b32 v74, 0
    v_mov_b32 v75, 0
    v_mov_b32 v20, -1
    v_mov_b32 v21, -1
    v_mov_b32 v22, -1
    v_mov_b32 v23, -1
    v_mov_b32 v24, -1
    v_mov_b32 v25, -1
    v_mov_b32 v26, -1
    v_mov_b32 v27, -1
    v_mov_b32 v28, -1
    v_mov_b32 v29, -1
    v_mov_b32 v30, -1
    v_mov_b32 v31, -1
    v_mov_b32 v32, -1
    v_mov_b32 v33, -1
    v_mov_b32 v34, -1
    v_mov_b32 v35, -1
    v_mov_b32 v92, -1
    v_mov_b32 v93, -1
    v_mov_b32 v94, -1
    v_mov_b32 v95, -1
    v_mov_b32 v96, -1
    v_mov_b32 v97, -1
    v_mov_b32 v98, -1
    v_mov_b32 v99, -1
    v_mov_b32 v100, -1
    v_mov_b32 v101, -1
    v_mov_b32 v102, -1
    v_mov_b32 v103, -1
    s_add_u32 s4, s99, 0
    buffer_load_dwordx4 v[192:195], v239, s[8:11], s4 offen sc1
    buffer_load_dwordx4 v[196:199], v249, s[8:11], s4 offen sc1

    ds_read_b128 v[128:131], v228 offset:0
    ds_read_b128 v[144:147], v228 offset:4096
    ds_read_b128 v[132:135], v229 offset:0
    ds_read_b128 v[148:151], v229 offset:4096
    ds_read_b128 v[136:139], v230 offset:0
    ds_read_b128 v[152:155], v230 offset:4096
    ds_read_b128 v[140:143], v231 offset:0
    ds_read_b128 v[156:159], v231 offset:4096
    ds_read_b128 v[160:163], v14 offset:28672
    ds_read_b128 v[164:167], v14 offset:29696
    ds_read_b128 v[108:111], v248
    s_waitcnt lgkmcnt(0)
    v_mfma_f32_16x16x32_bf16 v[76:79], v[108:111], v[112:115], 0
    s_add_u32 s4, s99, 262144
    buffer_load_dwordx4 v[200:203], v239, s[8:11], s4 offen sc1
    buffer_load_dwordx4 v[204:207], v249, s[8:11], s4 offen sc1

.gc_221:
    s_waitcnt vmcnt(2)

    v_max_u32 v4, v192, v196
    v_cmp_eq_u32 vcc, -1, v4
    s_cbranch_vccnz .gf_222
    v_mfma_f32_16x16x32_bf16 v[76:79], v[192:195], v[84:87], v[76:79]
    v_mfma_f32_16x16x32_bf16 v[76:79], v[196:199], v[112:115], v[76:79]
    s_mov_b64 exec, s[58:59]
    s_nop 6
    v_cvt_pk_bf16_f32 v104, v76, v77
    v_cvt_pk_bf16_f32 v105, v78, v79
    v_min_u32 v104, 0xfffffffe, v104
    v_min_u32 v105, 0xfffffffe, v105
    buffer_store_dwordx2 v[104:105], v15, s[8:11], s29 offen sc1
    s_mov_b64 exec, -1

    s_branch .top_198
.gf_222:
    s_add_u32 s4, s99, 0
    buffer_load_dwordx4 v[192:195], v239, s[8:11], s4 offen sc1
    buffer_load_dwordx4 v[196:199], v249, s[8:11], s4 offen sc1

    s_waitcnt vmcnt(2)

    v_max_u32 v4, v200, v204
    v_cmp_eq_u32 vcc, -1, v4
    s_cbranch_vccnz .gf_223
    v_mfma_f32_16x16x32_bf16 v[76:79], v[200:203], v[84:87], v[76:79]
    v_mfma_f32_16x16x32_bf16 v[76:79], v[204:207], v[112:115], v[76:79]
    s_mov_b64 exec, s[58:59]
    s_nop 6
    v_cvt_pk_bf16_f32 v104, v76, v77
    v_cvt_pk_bf16_f32 v105, v78, v79
    v_min_u32 v104, 0xfffffffe, v104
    v_min_u32 v105, 0xfffffffe, v105
    buffer_store_dwordx2 v[104:105], v15, s[8:11], s29 offen sc1
    s_mov_b64 exec, -1

    s_branch .top_198
.gf_223:
    s_add_u32 s4, s99, 262144
    buffer_load_dwordx4 v[200:203], v239, s[8:11], s4 offen sc1
    buffer_load_dwordx4 v[204:207], v249, s[8:11], s4 offen sc1

    s_sub_u32 s62, s62, 1
    s_cbranch_scc1 .mg_end_1
    s_branch .gc_221
.oth_199:
    s_cmp_eq_u32 s24, 3
    s_cbranch_scc1 .w3_200
    s_cmp_eq_u32 s28, 63
    s_cbranch_scc1 .rec_fin_6
    s_add_u32 s6, s28, 4
    s_cmp_ge_u32 s93, s6
    s_cbranch_scc1 .nl_224
    s_buffer_load_dword s14, s[8:11], s89 glc
    s_buffer_load_dword s15, s[8:11], s89 offset:8192 glc

.nl_224:
    s_waitcnt vmcnt(0)
    v_mov_b32 v71, 0
    v_mov_b32 v72, 0
    v_mov_b32 v73, 0
    v_mov_b32 v74, 0
    v_mov_b32 v75, 0
    s_barrier
    s_add_u32 s6, s28, 2
    s_min_u32 s6, s6, 64
    s_cmp_lt_u32 s93, s6
    s_cbranch_scc1 .kf_225
.kb_226:
    s_mov_b32 m0, s90
    s_nop 0
    buffer_load_dwordx4 v14, s[8:11], s38 offen offset:0 lds
    buffer_load_dwordx4 v14, s[8:11], s38 offen offset:1024 lds
    buffer_load_dwordx4 v14, s[8:11], s38 offen offset:2048 lds
    buffer_load_dwordx4 v14, s[8:11], s38 offen offset:3072 lds
    s_mov_b32 m0, s91
    s_nop 0
    buffer_load_dwordx4 v14, s[8:11], s39 offen lds
    s_barrier
    v_mov_b32 v20, -1
    v_mov_b32 v21, -1
    v_mov_b32 v22, -1
    v_mov_b32 v23, -1
    v_mov_b32 v24, -1
    v_mov_b32 v25, -1
    v_mov_b32 v26, -1
    v_mov_b32 v27, -1
    v_mov_b32 v28, -1
    v_mov_b32 v29, -1
    v_mov_b32 v30, -1
    v_mov_b32 v31, -1
    v_mov_b32 v32, -1
    v_mov_b32 v33, -1
    v_mov_b32 v34, -1
    v_mov_b32 v35, -1
    v_mov_b32 v55, 0
    v_mov_b32 v56, 0
    v_mov_b32 v57, 0
    v_mov_b32 v58, 0
    v_mov_b32 v59, 0
    v_mov_b32 v60, 0
    v_mov_b32 v61, 0
    v_mov_b32 v62, 0
    v_mov_b32 v63, 0
    v_mov_b32 v64, 0
    v_mov_b32 v65, 0
    v_mov_b32 v66, 0
    v_mov_b32 v67, 0
    v_mov_b32 v68, 0
    v_mov_b32 v69, 0
    v_mov_b32 v70, 0
    buffer_load_dwordx4 v[192:195], v243, s[8:11], s32 offen offset:0 sc1
    buffer_load_dwordx4 v[196:199], v243, s[8:11], s32 offen offset:1024 sc1
    v_mov_b32 v76, 0
    buffer_load_dwordx4 v[200:203], v252, s[8:11], s32 offen offset:0 sc1
    buffer_load_dwordx4 v[204:207], v252, s[8:11], s32 offen offset:1024 sc1
    v_mov_b32 v77, 0
    buffer_load_dwordx4 v[208:211], v254, s[8:11], s32 offen offset:0 sc1
    buffer_load_dwordx4 v[212:215], v254, s[8:11], s32 offen offset:1024 sc1
    v_mov_b32 v78, 0
    buffer_load_dwordx4 v[216:219], v246, s[8:11], s32 offen offset:0 sc1
    buffer_load_dwordx4 v[220:223], v246, s[8:11], s32 offen offset:1024 sc1
    s_waitcnt vmcnt(6)
    v_max3_u32 v4, v192, v193, v194
    v_max3_u32 v5, v195, v196, v197
    v_max3_u32 v4, v4, v198, v199
    v_max_u32 v4, v4, v5
    v_cmp_eq_u32 vcc, -1, v4
    s_cbranch_vccnz .A_228
.W_229:
    v_smfmac_f32_16x16x64_bf16 v[76:79], v[192:195], a[192:199], v9
    v_smfmac_f32_16x16x64_bf16 v[80:83], v[192:195], a[224:231], v9
    s_waitcnt vmcnt(4)
    v_max3_u32 v4, v200, v201, v202
    v_max3_u32 v5, v203, v204, v205
    v_max3_u32 v4, v4, v206, v207
    v_smfmac_f32_16x16x64_bf16 v[76:79], v[196:199], a[200:207], v9
    v_max_u32 v4, v4, v5
    v_cmp_eq_u32 vcc, -1, v4
    v_smfmac_f32_16x16x64_bf16 v[80:83], v[196:199], a[232:239], v9
    s_cbranch_vccnz .A_230
.W_231:
    v_smfmac_f32_16x16x64_bf16 v[76:79], v[200:203], a[208:215], v9
    v_smfmac_f32_16x16x64_bf16 v[80:83], v[200:203], a[240:247], v9
    s_waitcnt vmcnt(2)
    v_max3_u32 v4, v208, v209, v210
    v_max3_u32 v5, v211, v212, v213
    v_max3_u32 v4, v4, v214, v215
    v_smfmac_f32_16x16x64_bf16 v[76:79], v[204:207], a[216:223], v9
    v_max_u32 v4, v4, v5
    v_cmp_eq_u32 vcc, -1, v4
    v_smfmac_f32_16x16x64_bf16 v[80:83], v[204:207], a[248:255], v9
    s_cbranch_vccnz .A_232
.W_233:
    v_smfmac_f32_16x16x64_bf16 v[76:79], v[208:211], v[124:131], v9
    v_smfmac_f32_16x16x64_bf16 v[80:83], v[208:211], v[156:163], v9
    s_waitcnt vmcnt(0)
    v_max3_u32 v4, v216, v217, v218
    v_max3_u32 v5, v219, v220, v221
    v_max3_u32 v4, v4, v222, v223
    v_smfmac_f32_16x16x64_bf16 v[76:79], v[212:215], v[132:139], v9
    v_max_u32 v4, v4, v5
    v_cmp_eq_u32 vcc, -1, v4
    v_smfmac_f32_16x16x64_bf16 v[80:83], v[212:215], v[164:171], v9
    s_cbranch_vccnz .A_234
.W_235:
    v_smfmac_f32_16x16x64_bf16 v[76:79], v[216:219], v[140:147], v9
    v_smfmac_f32_16x16x64_bf16 v[80:83], v[216:219], v[172:179], v9
    v_smfmac_f32_16x16x64_bf16 v[76:79], v[220:223], v[148:155], v9
    v_smfmac_f32_16x16x64_bf16 v[80:83], v[220:223], v[180:187], v9
.mj_227:
    s_barrier
    s_nop 7
    v_permlane32_swap_b32 v76, v80
    v_permlane32_swap_b32 v77, v81
    v_permlane32_swap_b32 v78, v82
    v_permlane32_swap_b32 v79, v83
    v_add_f32 v76, v76, v80
    v_add_f32 v77, v77, v81
    v_add_f32 v78, v78, v82
    v_add_f32 v79, v79, v83
    v_cvt_pk_bf16_f32 v104, v76, v77
    v_cvt_pk_bf16_f32 v106, v76, v77
    v_cvt_pk_bf16_f32 v105, v78, v79
    v_cvt_pk_bf16_f32 v107, v78, v79
    v_permlane16_swap_b32 v104, v106
    s_nop 0
    v_permlane16_swap_b32 v105, v107
    v_min_u32 v104, 0xfffffffe, v104
    buffer_store_dwordx4 v[104:107], v237, s[8:11], s68 offen sc1

    ds_write_b128 v247, v[104:107]
    s_waitcnt lgkmcnt(0)
    s_barrier
    s_min_u32 s4, s14, s15
    s_max_u32 s93, s93, s4
    v_mov_b32 v4, s93
    v_mov_b32 v5, 19968
    ds_write_b32 v5, v4
    v_mov_b32 v79, 0
    v_mov_b32 v80, 0
    v_mov_b32 v81, 0
    v_mov_b32 v82, 0
    v_mov_b32 v83, 0
    s_waitcnt vmcnt(1)
    v_mov_b32 v192, -1
    v_mov_b32 v193, -1
    v_mov_b32 v194, -1
    v_mov_b32 v195, -1
    v_mov_b32 v196, -1
    v_mov_b32 v197, -1
    v_mov_b32 v198, -1
    v_mov_b32 v199, -1
    v_mov_b32 v200, -1
    v_mov_b32 v201, -1
    v_mov_b32 v202, -1
    v_mov_b32 v203, -1
    v_mov_b32 v204, -1
    v_mov_b32 v205, -1
    v_mov_b32 v206, -1
    v_mov_b32 v207, -1
    v_mov_b32 v208, -1
    v_mov_b32 v209, -1
    v_mov_b32 v210, -1
    v_mov_b32 v211, -1
    v_mov_b32 v212, -1
    v_mov_b32 v213, -1
    v_mov_b32 v214, -1
    v_mov_b32 v215, -1
    v_mov_b32 v216, -1
    v_mov_b32 v217, -1
    v_mov_b32 v218, -1
    v_mov_b32 v219, -1
    v_mov_b32 v220, -1
    v_mov_b32 v221, -1
    v_mov_b32 v222, -1
    v_mov_b32 v223, -1
    s_add_u32 s28, s28, 1
    s_add_u32 s36, s36, 196608
    s_cmp_lt_u32 s28, 63
    s_cselect_b32 s4, 262144, 0
    s_add_u32 s38, s38, s4
    s_add_u32 s39, s39, s4
    s_add_u32 s30, s30, s4
    s_mov_b32 s4, s68
    s_mov_b32 s68, s69
    s_mov_b32 s69, s70
    s_mov_b32 s70, s71
    s_mov_b32 s71, s4
    s_and_b32 s4, s28, 3
    s_lshl_b32 s5, s4, 17
    s_add_u32 s29, s5, s34
    s_xor_b32 s6, s5, 262144
    s_add_u32 s31, s6, s34
    s_add_u32 s32, s29, 20480
    s_add_u32 s33, s29, 24576
    s_branch .top_198
.w3_200:
    ds_read_b128 v[36:39], v14 offset:8192
    ds_read_b128 v[40:43], v14 offset:9216
    ds_read_b128 v[44:47], v14 offset:10240
    ds_read_b128 v[48:51], v14 offset:11264
    ds_read_b128 v[88:91], v14 offset:16384
    s_waitcnt lgkmcnt(0)
    v_mfma_f32_16x16x32_bf16 v[104:107], v[84:87], v[36:39], 0
    v_mfma_f32_16x16x32_bf16 v[108:111], v[84:87], v[44:47], 0
    v_mfma_f32_16x16x32_bf16 v[104:107], v[84:87], v[40:43], v[104:107]
    v_mfma_f32_16x16x32_bf16 v[108:111], v[84:87], v[48:51], v[108:111]
    s_nop 7
    v_cvt_pk_bf16_f32 v168, v104, v105
    v_cvt_pk_bf16_f32 v169, v106, v107
    v_cvt_pk_bf16_f32 v170, v108, v109
    v_cvt_pk_bf16_f32 v171, v110, v111
    ds_write_b128 v14, v[168:171] offset:18432
    v_cndmask_b32 v172, v170, v168, s[60:61]
    v_cndmask_b32 v173, v171, v169, s[60:61]
    v_min_u32 v172, 0xfffffffe, v172
    v_min_u32 v173, 0xfffffffe, v173
    v_mov_b32 v174, v172
    v_mov_b32 v175, v173
    s_cmp_eq_u32 s28, 63
    s_nop 0
    v_permlane16_swap_b32 v172, v174
    v_permlane16_swap_b32 v173, v175
    ds_write_b128 v14, v[172:175] offset:17408

    s_cbranch_scc1 .sk_236
    s_waitcnt lgkmcnt(0)
    s_barrier
    buffer_store_dwordx4 v[188:191], v235, s[8:11], s31 offen sc1
    buffer_store_dwordx4 v[188:191], v236, s[8:11], s31 offen sc1

    s_branch .gp_201
.A_237:
    s_mov_b64 exec, vcc
    buffer_load_dwordx4 v[32:35], v8, s[8:11], s29 offen offset:3072 sc1
    s_mov_b64 exec, -1
    s_sub_u32 s62, s62, 1
    s_cbranch_scc1 .mg_end_1
    s_waitcnt vmcnt(3)
    v_max3_u32 v4, v20, v21, v22
    v_max_u32 v4, v4, v23
    v_cmp_eq_u32 vcc, -1, v4
    s_cbranch_vccz .W_204
.A_203:
    s_mov_b64 exec, vcc
    buffer_load_dwordx4 v[20:23], v8, s[8:11], s29 offen offset:0 sc1
    s_mov_b64 exec, -1
    s_waitcnt vmcnt(3)
    v_max3_u32 v4, v24, v25, v26
    v_max_u32 v4, v4, v27
    v_cmp_eq_u32 vcc, -1, v4
    s_cbranch_vccz .W_238
.A_239:
    s_mov_b64 exec, vcc
    buffer_load_dwordx4 v[24:27], v8, s[8:11], s29 offen offset:1024 sc1
    s_mov_b64 exec, -1
    s_waitcnt vmcnt(3)
    v_max3_u32 v4, v28, v29, v30
    v_max_u32 v4, v4, v31
    v_cmp_eq_u32 vcc, -1, v4
    s_cbranch_vccz .W_240
.A_241:
    s_mov_b64 exec, vcc
    buffer_load_dwordx4 v[28:31], v8, s[8:11], s29 offen offset:2048 sc1
    s_mov_b64 exec, -1
    s_waitcnt vmcnt(3)
    v_max3_u32 v4, v32, v33, v34
    v_max_u32 v4, v4, v35
    v_cmp_eq_u32 vcc, -1, v4
    s_cbranch_vccnz .A_237
.W_242:
    v_smfmac_f32_16x16x64_bf16 v[52:55], v[32:35], a[24:31], v9
    v_smfmac_f32_16x16x64_bf16 v[56:59], v[32:35], a[56:63], v9
    s_waitcnt vmcnt(2)
    v_max3_u32 v4, v20, v21, v22
    v_max_u32 v4, v4, v23
    v_smfmac_f32_16x16x64_bf16 v[60:63], v[32:35], a[88:95], v9
    v_cmp_eq_u32 vcc, -1, v4
    v_smfmac_f32_16x16x64_bf16 v[64:67], v[32:35], a[120:127], v9
    s_cbranch_vccnz .A_243
.W_244:
    v_smfmac_f32_16x16x64_bf16 v[52:55], v[20:23], a[0:7], v9
    v_smfmac_f32_16x16x64_bf16 v[56:59], v[20:23], a[32:39], v9
    s_waitcnt vmcnt(1)
    v_max3_u32 v4, v24, v25, v26
    v_max_u32 v4, v4, v27
    v_smfmac_f32_16x16x64_bf16 v[60:63], v[20:23], a[64:71], v9
    v_cmp_eq_u32 vcc, -1, v4
    v_smfmac_f32_16x16x64_bf16 v[64:67], v[20:23], a[96:103], v9
    s_cbranch_vccnz .A_245
.W_246:
    v_smfmac_f32_16x16x64_bf16 v[52:55], v[24:27], a[8:15], v9
    v_smfmac_f32_16x16x64_bf16 v[56:59], v[24:27], a[40:47], v9
    s_waitcnt vmcnt(0)
    v_max3_u32 v4, v28, v29, v30
    v_max_u32 v4, v4, v31
    v_smfmac_f32_16x16x64_bf16 v[60:63], v[24:27], a[72:79], v9
    v_cmp_eq_u32 vcc, -1, v4
    v_smfmac_f32_16x16x64_bf16 v[64:67], v[24:27], a[104:111], v9
    s_cbranch_vccnz .A_247
.W_248:
    v_smfmac_f32_16x16x64_bf16 v[52:55], v[28:31], a[16:23], v9
    v_smfmac_f32_16x16x64_bf16 v[56:59], v[28:31], a[48:55], v9
    v_smfmac_f32_16x16x64_bf16 v[60:63], v[28:31], a[80:87], v9
    v_smfmac_f32_16x16x64_bf16 v[64:67], v[28:31], a[112:119], v9
    s_branch .mj_202
.W_238:
    v_smfmac_f32_16x16x64_bf16 v[52:55], v[24:27], a[8:15], v9
    v_smfmac_f32_16x16x64_bf16 v[56:59], v[24:27], a[40:47], v9
    s_waitcnt vmcnt(2)
    v_max3_u32 v4, v28, v29, v30
    v_max_u32 v4, v4, v31
    v_smfmac_f32_16x16x64_bf16 v[60:63], v[24:27], a[72:79], v9
    v_cmp_eq_u32 vcc, -1, v4
    v_smfmac_f32_16x16x64_bf16 v[64:67], v[24:27], a[104:111], v9
    s_cbranch_vccnz .A_249
.W_250:
    v_smfmac_f32_16x16x64_bf16 v[52:55], v[28:31], a[16:23], v9
    v_smfmac_f32_16x16x64_bf16 v[56:59], v[28:31], a[48:55], v9
    s_waitcnt vmcnt(1)
    v_max3_u32 v4, v32, v33, v34
    v_max_u32 v4, v4, v35
    v_smfmac_f32_16x16x64_bf16 v[60:63], v[28:31], a[80:87], v9
    v_cmp_eq_u32 vcc, -1, v4
    v_smfmac_f32_16x16x64_bf16 v[64:67], v[28:31], a[112:119], v9
    s_cbranch_vccnz .A_251
.W_252:
    v_smfmac_f32_16x16x64_bf16 v[52:55], v[32:35], a[24:31], v9
    v_smfmac_f32_16x16x64_bf16 v[56:59], v[32:35], a[56:63], v9
    s_waitcnt vmcnt(0)
    v_max3_u32 v4, v20, v21, v22
    v_max_u32 v4, v4, v23
    v_smfmac_f32_16x16x64_bf16 v[60:63], v[32:35], a[88:95], v9
    v_cmp_eq_u32 vcc, -1, v4
    v_smfmac_f32_16x16x64_bf16 v[64:67], v[32:35], a[120:127], v9
    s_cbranch_vccnz .A_253
.W_254:
    v_smfmac_f32_16x16x64_bf16 v[52:55], v[20:23], a[0:7], v9
    v_smfmac_f32_16x16x64_bf16 v[56:59], v[20:23], a[32:39], v9
    v_smfmac_f32_16x16x64_bf16 v[60:63], v[20:23], a[64:71], v9
    v_smfmac_f32_16x16x64_bf16 v[64:67], v[20:23], a[96:103], v9
    s_branch .mj_202
.W_240:
    v_smfmac_f32_16x16x64_bf16 v[52:55], v[28:31], a[16:23], v9
    v_smfmac_f32_16x16x64_bf16 v[56:59], v[28:31], a[48:55], v9
    s_waitcnt vmcnt(2)
    v_max3_u32 v4, v32, v33, v34
    v_max_u32 v4, v4, v35
    v_smfmac_f32_16x16x64_bf16 v[60:63], v[28:31], a[80:87], v9
    v_cmp_eq_u32 vcc, -1, v4
    v_smfmac_f32_16x16x64_bf16 v[64:67], v[28:31], a[112:119], v9
    s_cbranch_vccnz .A_255
.W_256:
    v_smfmac_f32_16x16x64_bf16 v[52:55], v[32:35], a[24:31], v9
    v_smfmac_f32_16x16x64_bf16 v[56:59], v[32:35], a[56:63], v9
    s_waitcnt vmcnt(1)
    v_max3_u32 v4, v20, v21, v22
    v_max_u32 v4, v4, v23
    v_smfmac_f32_16x16x64_bf16 v[60:63], v[32:35], a[88:95], v9
    v_cmp_eq_u32 vcc, -1, v4
    v_smfmac_f32_16x16x64_bf16 v[64:67], v[32:35], a[120:127], v9
    s_cbranch_vccnz .A_257
.W_258:
    v_smfmac_f32_16x16x64_bf16 v[52:55], v[20:23], a[0:7], v9
    v_smfmac_f32_16x16x64_bf16 v[56:59], v[20:23], a[32:39], v9
    s_waitcnt vmcnt(0)
    v_max3_u32 v4, v24, v25, v26
    v_max_u32 v4, v4, v27
    v_smfmac_f32_16x16x64_bf16 v[60:63], v[20:23], a[64:71], v9
    v_cmp_eq_u32 vcc, -1, v4
    v_smfmac_f32_16x16x64_bf16 v[64:67], v[20:23], a[96:103], v9
    s_cbranch_vccnz .A_259
.W_260:
    v_smfmac_f32_16x16x64_bf16 v[52:55], v[24:27], a[8:15], v9
    v_smfmac_f32_16x16x64_bf16 v[56:59], v[24:27], a[40:47], v9
    v_smfmac_f32_16x16x64_bf16 v[60:63], v[24:27], a[72:79], v9
    v_smfmac_f32_16x16x64_bf16 v[64:67], v[24:27], a[104:111], v9
    s_branch .mj_202
.A_261:
    s_mov_b64 exec, vcc
    buffer_load_dwordx4 v[28:31], v8, s[8:11], s29 offen offset:2048 sc1
    s_mov_b64 exec, -1
    s_sub_u32 s62, s62, 1
    s_cbranch_scc1 .mg_end_1
    s_waitcnt vmcnt(2)
    v_max3_u32 v4, v20, v21, v22
    v_max_u32 v4, v4, v23
    v_cmp_eq_u32 vcc, -1, v4
    s_cbranch_vccz .W_244
.A_243:
    s_mov_b64 exec, vcc
    buffer_load_dwordx4 v[20:23], v8, s[8:11], s29 offen offset:0 sc1
    s_mov_b64 exec, -1
    s_waitcnt vmcnt(2)
    v_max3_u32 v4, v24, v25, v26
    v_max_u32 v4, v4, v27
    v_cmp_eq_u32 vcc, -1, v4
    s_cbranch_vccz .W_262
.A_263:
    s_mov_b64 exec, vcc
    buffer_load_dwordx4 v[24:27], v8, s[8:11], s29 offen offset:1024 sc1
    s_mov_b64 exec, -1
    s_waitcnt vmcnt(2)
    v_max3_u32 v4, v28, v29, v30
    v_max_u32 v4, v4, v31
    v_cmp_eq_u32 vcc, -1, v4
    s_cbranch_vccnz .A_261
.W_264:
    v_smfmac_f32_16x16x64_bf16 v[52:55], v[28:31], a[16:23], v9
    v_smfmac_f32_16x16x64_bf16 v[56:59], v[28:31], a[48:55], v9
    s_waitcnt vmcnt(1)
    v_max3_u32 v4, v20, v21, v22
    v_max_u32 v4, v4, v23
    v_smfmac_f32_16x16x64_bf16 v[60:63], v[28:31], a[80:87], v9
    v_cmp_eq_u32 vcc, -1, v4
    v_smfmac_f32_16x16x64_bf16 v[64:67], v[28:31], a[112:119], v9
    s_cbranch_vccz .W_258
    s_branch .A_257
.W_262:
    v_smfmac_f32_16x16x64_bf16 v[52:55], v[24:27], a[8:15], v9
    v_smfmac_f32_16x16x64_bf16 v[56:59], v[24:27], a[40:47], v9
    s_waitcnt vmcnt(1)
    v_max3_u32 v4, v28, v29, v30
    v_max_u32 v4, v4, v31
    v_smfmac_f32_16x16x64_bf16 v[60:63], v[24:27], a[72:79], v9
    v_cmp_eq_u32 vcc, -1, v4
    v_smfmac_f32_16x16x64_bf16 v[64:67], v[24:27], a[104:111], v9
    s_cbranch_vccnz .A_265
.W_266:
    v_smfmac_f32_16x16x64_bf16 v[52:55], v[28:31], a[16:23], v9
    v_smfmac_f32_16x16x64_bf16 v[56:59], v[28:31], a[48:55], v9
    s_waitcnt vmcnt(0)
    v_max3_u32 v4, v20, v21, v22
    v_max_u32 v4, v4, v23
    v_smfmac_f32_16x16x64_bf16 v[60:63], v[28:31], a[80:87], v9
    v_cmp_eq_u32 vcc, -1, v4
    v_smfmac_f32_16x16x64_bf16 v[64:67], v[28:31], a[112:119], v9
    s_cbranch_vccz .W_254
    s_branch .A_253
.A_267:
    s_mov_b64 exec, vcc
    buffer_load_dwordx4 v[24:27], v8, s[8:11], s29 offen offset:1024 sc1
    s_mov_b64 exec, -1
    s_sub_u32 s62, s62, 1
    s_cbranch_scc1 .mg_end_1
    s_waitcnt vmcnt(2)
    v_max3_u32 v4, v32, v33, v34
    v_max_u32 v4, v4, v35
    v_cmp_eq_u32 vcc, -1, v4
    s_cbranch_vccz .W_256
.A_255:
    s_mov_b64 exec, vcc
    buffer_load_dwordx4 v[32:35], v8, s[8:11], s29 offen offset:3072 sc1
    s_mov_b64 exec, -1
    s_waitcnt vmcnt(2)
    v_max3_u32 v4, v20, v21, v22
    v_max_u32 v4, v4, v23
    v_cmp_eq_u32 vcc, -1, v4
    s_cbranch_vccz .W_268
.A_269:
    s_mov_b64 exec, vcc
    buffer_load_dwordx4 v[20:23], v8, s[8:11], s29 offen offset:0 sc1
    s_mov_b64 exec, -1
    s_waitcnt vmcnt(2)
    v_max3_u32 v4, v24, v25, v26
    v_max_u32 v4, v4, v27
    v_cmp_eq_u32 vcc, -1, v4
    s_cbranch_vccnz .A_267
.W_270:
    v_smfmac_f32_16x16x64_bf16 v[52:55], v[24:27], a[8:15], v9
    v_smfmac_f32_16x16x64_bf16 v[56:59], v[24:27], a[40:47], v9
    s_waitcnt vmcnt(1)
    v_max3_u32 v4, v32, v33, v34
    v_max_u32 v4, v4, v35
    v_smfmac_f32_16x16x64_bf16 v[60:63], v[24:27], a[72:79], v9
    v_cmp_eq_u32 vcc, -1, v4
    v_smfmac_f32_16x16x64_bf16 v[64:67], v[24:27], a[104:111], v9
    s_cbranch_vccz .W_252
    s_branch .A_251
.W_268:
    v_smfmac_f32_16x16x64_bf16 v[52:55], v[20:23], a[0:7], v9
    v_smfmac_f32_16x16x64_bf16 v[56:59], v[20:23], a[32:39], v9
    s_waitcnt vmcnt(1)
    v_max3_u32 v4, v24, v25, v26
    v_max_u32 v4, v4, v27
    v_smfmac_f32_16x16x64_bf16 v[60:63], v[20:23], a[64:71], v9
    v_cmp_eq_u32 vcc, -1, v4
    v_smfmac_f32_16x16x64_bf16 v[64:67], v[20:23], a[96:103], v9
    s_cbranch_vccnz .A_271
.W_272:
    v_smfmac_f32_16x16x64_bf16 v[52:55], v[24:27], a[8:15], v9
    v_smfmac_f32_16x16x64_bf16 v[56:59], v[24:27], a[40:47], v9
    s_waitcnt vmcnt(0)
    v_max3_u32 v4, v32, v33, v34
    v_max_u32 v4, v4, v35
    v_smfmac_f32_16x16x64_bf16 v[60:63], v[24:27], a[72:79], v9
    v_cmp_eq_u32 vcc, -1, v4
    v_smfmac_f32_16x16x64_bf16 v[64:67], v[24:27], a[104:111], v9
    s_cbranch_vccz .W_210
    s_branch .A_209
.A_273:
    s_mov_b64 exec, vcc
    buffer_load_dwordx4 v[32:35], v8, s[8:11], s29 offen offset:3072 sc1
    s_mov_b64 exec, -1
    s_sub_u32 s62, s62, 1
    s_cbranch_scc1 .mg_end_1
    s_waitcnt vmcnt(2)
    v_max3_u32 v4, v20, v21, v22
    v_max_u32 v4, v4, v23
    v_cmp_eq_u32 vcc, -1, v4
    s_cbranch_vccz .W_274
.A_275:
    s_mov_b64 exec, vcc
    buffer_load_dwordx4 v[20:23], v8, s[8:11], s29 offen offset:0 sc1
    s_mov_b64 exec, -1
    s_waitcnt vmcnt(2)
    v_max3_u32 v4, v28, v29, v30
    v_max_u32 v4, v4, v31
    v_cmp_eq_u32 vcc, -1, v4
    s_cbranch_vccz .W_250
.A_249:
    s_mov_b64 exec, vcc
    buffer_load_dwordx4 v[28:31], v8, s[8:11], s29 offen offset:2048 sc1
    s_mov_b64 exec, -1
    s_waitcnt vmcnt(2)
    v_max3_u32 v4, v32, v33, v34
    v_max_u32 v4, v4, v35
    v_cmp_eq_u32 vcc, -1, v4
    s_cbranch_vccnz .A_273
.W_276:
    v_smfmac_f32_16x16x64_bf16 v[52:55], v[32:35], a[24:31], v9
    v_smfmac_f32_16x16x64_bf16 v[56:59], v[32:35], a[56:63], v9
    s_waitcnt vmcnt(1)
    v_max3_u32 v4, v20, v21, v22
    v_max_u32 v4, v4, v23
    v_smfmac_f32_16x16x64_bf16 v[60:63], v[32:35], a[88:95], v9
    v_cmp_eq_u32 vcc, -1, v4
    v_smfmac_f32_16x16x64_bf16 v[64:67], v[32:35], a[120:127], v9
    s_cbranch_vccnz .A_277
.W_278:
    v_smfmac_f32_16x16x64_bf16 v[52:55], v[20:23], a[0:7], v9
    v_smfmac_f32_16x16x64_bf16 v[56:59], v[20:23], a[32:39], v9
    s_waitcnt vmcnt(0)
    v_max3_u32 v4, v28, v29, v30
    v_max_u32 v4, v4, v31
    v_smfmac_f32_16x16x64_bf16 v[60:63], v[20:23], a[64:71], v9
    v_cmp_eq_u32 vcc, -1, v4
    v_smfmac_f32_16x16x64_bf16 v[64:67], v[20:23], a[96:103], v9
    s_cbranch_vccz .W_248
    s_branch .A_247
.W_274:
    v_smfmac_f32_16x16x64_bf16 v[52:55], v[20:23], a[0:7], v9
    v_smfmac_f32_16x16x64_bf16 v[56:59], v[20:23], a[32:39], v9
    s_waitcnt vmcnt(1)
    v_max3_u32 v4, v28, v29, v30
    v_max_u32 v4, v4, v31
    v_smfmac_f32_16x16x64_bf16 v[60:63], v[20:23], a[64:71], v9
    v_cmp_eq_u32 vcc, -1, v4
    v_smfmac_f32_16x16x64_bf16 v[64:67], v[20:23], a[96:103], v9
    s_cbranch_vccz .W_208
    s_branch .A_207
.A_279:
    s_mov_b64 exec, vcc
    buffer_load_dwordx4 v[32:35], v8, s[8:11], s29 offen offset:3072 sc1
    s_mov_b64 exec, -1
    s_sub_u32 s62, s62, 1
    s_cbranch_scc1 .mg_end_1
    s_waitcnt vmcnt(2)
    v_max3_u32 v4, v24, v25, v26
    v_max_u32 v4, v4, v27
    v_cmp_eq_u32 vcc, -1, v4
    s_cbranch_vccz .W_206
.A_205:
    s_mov_b64 exec, vcc
    buffer_load_dwordx4 v[24:27], v8, s[8:11], s29 offen offset:1024 sc1
    s_mov_b64 exec, -1
    s_waitcnt vmcnt(2)
    v_max3_u32 v4, v28, v29, v30
    v_max_u32 v4, v4, v31
    v_cmp_eq_u32 vcc, -1, v4
    s_cbranch_vccz .W_280
.A_281:
    s_mov_b64 exec, vcc
    buffer_load_dwordx4 v[28:31], v8, s[8:11], s29 offen offset:2048 sc1
    s_mov_b64 exec, -1
    s_waitcnt vmcnt(2)
    v_max3_u32 v4, v32, v33, v34
    v_max_u32 v4, v4, v35
    v_cmp_eq_u32 vcc, -1, v4
    s_cbranch_vccnz .A_279
.W_282:
    v_smfmac_f32_16x16x64_bf16 v[52:55], v[32:35], a[24:31], v9
    v_smfmac_f32_16x16x64_bf16 v[56:59], v[32:35], a[56:63], v9
    s_waitcnt vmcnt(1)
    v_max3_u32 v4, v24, v25, v26
    v_max_u32 v4, v4, v27
    v_smfmac_f32_16x16x64_bf16 v[60:63], v[32:35], a[88:95], v9
    v_cmp_eq_u32 vcc, -1, v4
    v_smfmac_f32_16x16x64_bf16 v[64:67], v[32:35], a[120:127], v9
    s_cbranch_vccz .W_246
    s_branch .A_245
.W_280:
    v_smfmac_f32_16x16x64_bf16 v[52:55], v[28:31], a[16:23], v9
    v_smfmac_f32_16x16x64_bf16 v[56:59], v[28:31], a[48:55], v9
    s_waitcnt vmcnt(1)
    v_max3_u32 v4, v32, v33, v34
    v_max_u32 v4, v4, v35
    v_smfmac_f32_16x16x64_bf16 v[60:63], v[28:31], a[80:87], v9
    v_cmp_eq_u32 vcc, -1, v4
    v_smfmac_f32_16x16x64_bf16 v[64:67], v[28:31], a[112:119], v9
    s_cbranch_vccnz .A_283
.W_284:
    v_smfmac_f32_16x16x64_bf16 v[52:55], v[32:35], a[24:31], v9
    v_smfmac_f32_16x16x64_bf16 v[56:59], v[32:35], a[56:63], v9
    s_waitcnt vmcnt(0)
    v_max3_u32 v4, v24, v25, v26
    v_max_u32 v4, v4, v27
    v_smfmac_f32_16x16x64_bf16 v[60:63], v[32:35], a[88:95], v9
    v_cmp_eq_u32 vcc, -1, v4
    v_smfmac_f32_16x16x64_bf16 v[64:67], v[32:35], a[120:127], v9
    s_cbranch_vccz .W_260
    s_branch .A_259
.A_285:
    s_mov_b64 exec, vcc
    buffer_load_dwordx4 v[24:27], v8, s[8:11], s29 offen offset:1024 sc1
    s_mov_b64 exec, -1
    s_sub_u32 s62, s62, 1
    s_cbranch_scc1 .mg_end_1
    s_waitcnt vmcnt(1)
    v_max3_u32 v4, v20, v21, v22
    v_max_u32 v4, v4, v23
    v_cmp_eq_u32 vcc, -1, v4
    s_cbranch_vccz .W_258
.A_257:
    s_mov_b64 exec, vcc
    buffer_load_dwordx4 v[20:23], v8, s[8:11], s29 offen offset:0 sc1
    s_mov_b64 exec, -1
    s_waitcnt vmcnt(1)
    v_max3_u32 v4, v24, v25, v26
    v_max_u32 v4, v4, v27
    v_cmp_eq_u32 vcc, -1, v4
    s_cbranch_vccnz .A_285
.W_286:
    v_smfmac_f32_16x16x64_bf16 v[52:55], v[24:27], a[8:15], v9
    v_smfmac_f32_16x16x64_bf16 v[56:59], v[24:27], a[40:47], v9
    s_waitcnt vmcnt(0)
    v_max3_u32 v4, v20, v21, v22
    v_max_u32 v4, v4, v23
    v_smfmac_f32_16x16x64_bf16 v[60:63], v[24:27], a[72:79], v9
    v_cmp_eq_u32 vcc, -1, v4
    v_smfmac_f32_16x16x64_bf16 v[64:67], v[24:27], a[104:111], v9
    s_cbranch_vccz .W_254
    s_branch .A_253
.A_265:
    s_mov_b64 exec, vcc
    buffer_load_dwordx4 v[28:31], v8, s[8:11], s29 offen offset:2048 sc1
    s_mov_b64 exec, -1
    s_sub_u32 s62, s62, 1
    s_cbranch_scc1 .mg_end_1
    s_waitcnt vmcnt(1)
    v_max3_u32 v4, v20, v21, v22
    v_max_u32 v4, v4, v23
    v_cmp_eq_u32 vcc, -1, v4
    s_cbranch_vccz .W_278
.A_277:
    s_mov_b64 exec, vcc
    buffer_load_dwordx4 v[20:23], v8, s[8:11], s29 offen offset:0 sc1
    s_mov_b64 exec, -1
    s_waitcnt vmcnt(1)
    v_max3_u32 v4, v28, v29, v30
    v_max_u32 v4, v4, v31
    v_cmp_eq_u32 vcc, -1, v4
    s_cbranch_vccnz .A_265
    s_branch .W_266
.A_287:
    s_mov_b64 exec, vcc
    buffer_load_dwordx4 v[20:23], v8, s[8:11], s29 offen offset:0 sc1
    s_mov_b64 exec, -1
    s_sub_u32 s62, s62, 1
    s_cbranch_scc1 .mg_end_1
    s_waitcnt vmcnt(1)
    v_max3_u32 v4, v32, v33, v34
    v_max_u32 v4, v4, v35
    v_cmp_eq_u32 vcc, -1, v4
    s_cbranch_vccz .W_252
.A_251:
    s_mov_b64 exec, vcc
    buffer_load_dwordx4 v[32:35], v8, s[8:11], s29 offen offset:3072 sc1
    s_mov_b64 exec, -1
    s_waitcnt vmcnt(1)
    v_max3_u32 v4, v20, v21, v22
    v_max_u32 v4, v4, v23
    v_cmp_eq_u32 vcc, -1, v4
    s_cbranch_vccnz .A_287
.W_288:
    v_smfmac_f32_16x16x64_bf16 v[52:55], v[20:23], a[0:7], v9
    v_smfmac_f32_16x16x64_bf16 v[56:59], v[20:23], a[32:39], v9
    s_waitcnt vmcnt(0)
    v_max3_u32 v4, v32, v33, v34
    v_max_u32 v4, v4, v35
    v_smfmac_f32_16x16x64_bf16 v[60:63], v[20:23], a[64:71], v9
    v_cmp_eq_u32 vcc, -1, v4
    v_smfmac_f32_16x16x64_bf16 v[64:67], v[20:23], a[96:103], v9
    s_cbranch_vccz .W_210
    s_branch .A_209
.A_289:
    s_mov_b64 exec, vcc
    buffer_load_dwordx4 v[28:31], v8, s[8:11], s29 offen offset:2048 sc1
    s_mov_b64 exec, -1
    s_sub_u32 s62, s62, 1
    s_cbranch_scc1 .mg_end_1
    s_waitcnt vmcnt(1)
    v_max3_u32 v4, v24, v25, v26
    v_max_u32 v4, v4, v27
    v_cmp_eq_u32 vcc, -1, v4
    s_cbranch_vccz .W_246
.A_245:
    s_mov_b64 exec, vcc
    buffer_load_dwordx4 v[24:27], v8, s[8:11], s29 offen offset:1024 sc1
    s_mov_b64 exec, -1
    s_waitcnt vmcnt(1)
    v_max3_u32 v4, v28, v29, v30
    v_max_u32 v4, v4, v31
    v_cmp_eq_u32 vcc, -1, v4
    s_cbranch_vccnz .A_289
.W_290:
    v_smfmac_f32_16x16x64_bf16 v[52:55], v[28:31], a[16:23], v9
    v_smfmac_f32_16x16x64_bf16 v[56:59], v[28:31], a[48:55], v9
    s_waitcnt vmcnt(0)
    v_max3_u32 v4, v24, v25, v26
    v_max_u32 v4, v4, v27
    v_smfmac_f32_16x16x64_bf16 v[60:63], v[28:31], a[80:87], v9
    v_cmp_eq_u32 vcc, -1, v4
    v_smfmac_f32_16x16x64_bf16 v[64:67], v[28:31], a[112:119], v9
    s_cbranch_vccz .W_260
    s_branch .A_259
.A_283:
    s_mov_b64 exec, vcc
    buffer_load_dwordx4 v[32:35], v8, s[8:11], s29 offen offset:3072 sc1
    s_mov_b64 exec, -1
    s_sub_u32 s62, s62, 1
    s_cbranch_scc1 .mg_end_1
    s_waitcnt vmcnt(1)
    v_max3_u32 v4, v24, v25, v26
    v_max_u32 v4, v4, v27
    v_cmp_eq_u32 vcc, -1, v4
    s_cbranch_vccz .W_272
.A_271:
    s_mov_b64 exec, vcc
    buffer_load_dwordx4 v[24:27], v8, s[8:11], s29 offen offset:1024 sc1
    s_mov_b64 exec, -1
    s_waitcnt vmcnt(1)
    v_max3_u32 v4, v32, v33, v34
    v_max_u32 v4, v4, v35
    v_cmp_eq_u32 vcc, -1, v4
    s_cbranch_vccnz .A_283
    s_branch .W_284
.A_291:
    s_mov_b64 exec, vcc
    buffer_load_dwordx4 v[32:35], v8, s[8:11], s29 offen offset:3072 sc1
    s_mov_b64 exec, -1
    s_sub_u32 s62, s62, 1
    s_cbranch_scc1 .mg_end_1
    s_waitcnt vmcnt(1)
    v_max3_u32 v4, v28, v29, v30
    v_max_u32 v4, v4, v31
    v_cmp_eq_u32 vcc, -1, v4
    s_cbranch_vccz .W_208
.A_207:
    s_mov_b64 exec, vcc
    buffer_load_dwordx4 v[28:31], v8, s[8:11], s29 offen offset:2048 sc1
    s_mov_b64 exec, -1
    s_waitcnt vmcnt(1)
    v_max3_u32 v4, v32, v33, v34
    v_max_u32 v4, v4, v35
    v_cmp_eq_u32 vcc, -1, v4
    s_cbranch_vccnz .A_291
.W_292:
    v_smfmac_f32_16x16x64_bf16 v[52:55], v[32:35], a[24:31], v9
    v_smfmac_f32_16x16x64_bf16 v[56:59], v[32:35], a[56:63], v9
    s_waitcnt vmcnt(0)
    v_max3_u32 v4, v28, v29, v30
    v_max_u32 v4, v4, v31
    v_smfmac_f32_16x16x64_bf16 v[60:63], v[32:35], a[88:95], v9
    v_cmp_eq_u32 vcc, -1, v4
    v_smfmac_f32_16x16x64_bf16 v[64:67], v[32:35], a[120:127], v9
    s_cbranch_vccz .W_248
    s_branch .A_247
.A_253:
    s_mov_b64 exec, vcc
    buffer_load_dwordx4 v[20:23], v8, s[8:11], s29 offen offset:0 sc1
    s_mov_b64 exec, -1
    s_sub_u32 s62, s62, 1
    s_cbranch_scc1 .mg_end_1
    s_waitcnt vmcnt(1)
    v_max3_u32 v4, v20, v21, v22
    v_max_u32 v4, v4, v23
    v_cmp_eq_u32 vcc, -1, v4
    s_cbranch_vccnz .A_253
    v_smfmac_f32_16x16x64_bf16 v[52:55], v[20:23], a[0:7], v9
    v_smfmac_f32_16x16x64_bf16 v[56:59], v[20:23], a[32:39], v9
    v_smfmac_f32_16x16x64_bf16 v[60:63], v[20:23], a[64:71], v9
    v_smfmac_f32_16x16x64_bf16 v[64:67], v[20:23], a[96:103], v9
    s_branch .mj_202
.A_259:
    s_mov_b64 exec, vcc
    buffer_load_dwordx4 v[24:27], v8, s[8:11], s29 offen offset:1024 sc1
    s_mov_b64 exec, -1
    s_sub_u32 s62, s62, 1
    s_cbranch_scc1 .mg_end_1
    s_waitcnt vmcnt(1)
    v_max3_u32 v4, v24, v25, v26
    v_max_u32 v4, v4, v27
    v_cmp_eq_u32 vcc, -1, v4
    s_cbranch_vccnz .A_259
    v_smfmac_f32_16x16x64_bf16 v[52:55], v[24:27], a[8:15], v9
    v_smfmac_f32_16x16x64_bf16 v[56:59], v[24:27], a[40:47], v9
    v_smfmac_f32_16x16x64_bf16 v[60:63], v[24:27], a[72:79], v9
    v_smfmac_f32_16x16x64_bf16 v[64:67], v[24:27], a[104:111], v9
    s_branch .mj_202
.A_247:
    s_mov_b64 exec, vcc
    buffer_load_dwordx4 v[28:31], v8, s[8:11], s29 offen offset:2048 sc1
    s_mov_b64 exec, -1
    s_sub_u32 s62, s62, 1
    s_cbranch_scc1 .mg_end_1
    s_waitcnt vmcnt(1)
    v_max3_u32 v4, v28, v29, v30
    v_max_u32 v4, v4, v31
    v_cmp_eq_u32 vcc, -1, v4
    s_cbranch_vccnz .A_247
    v_smfmac_f32_16x16x64_bf16 v[52:55], v[28:31], a[16:23], v9
    v_smfmac_f32_16x16x64_bf16 v[56:59], v[28:31], a[48:55], v9
    v_smfmac_f32_16x16x64_bf16 v[60:63], v[28:31], a[80:87], v9
    v_smfmac_f32_16x16x64_bf16 v[64:67], v[28:31], a[112:119], v9
    s_branch .mj_202
.A_209:
    s_mov_b64 exec, vcc
    buffer_load_dwordx4 v[32:35], v8, s[8:11], s29 offen offset:3072 sc1
    s_mov_b64 exec, -1
    s_sub_u32 s62, s62, 1
    s_cbranch_scc1 .mg_end_1
    s_waitcnt vmcnt(1)
    v_max3_u32 v4, v32, v33, v34
    v_max_u32 v4, v4, v35
    v_cmp_eq_u32 vcc, -1, v4
    s_cbranch_vccnz .A_209
    v_smfmac_f32_16x16x64_bf16 v[52:55], v[32:35], a[24:31], v9
    v_smfmac_f32_16x16x64_bf16 v[56:59], v[32:35], a[56:63], v9
    v_smfmac_f32_16x16x64_bf16 v[60:63], v[32:35], a[88:95], v9
    v_smfmac_f32_16x16x64_bf16 v[64:67], v[32:35], a[120:127], v9
    s_branch .mj_202
.A_293:
    buffer_load_dwordx4 v[100:103], v234, s[8:11], s29 offen sc1
    s_sub_u32 s62, s62, 1
    s_cbranch_scc1 .mg_end_1
    s_waitcnt vmcnt(2)
    v_max3_u32 v4, v92, v93, v94
    v_max_u32 v4, v4, v95
    v_cmp_eq_u32 vcc, -1, v4
    s_cbranch_vccz .W_213
.A_212:
    buffer_load_dwordx4 v[92:95], v232, s[8:11], s29 offen sc1
    s_waitcnt vmcnt(2)
    v_max3_u32 v4, v96, v97, v98
    v_max_u32 v4, v4, v99
    v_cmp_eq_u32 vcc, -1, v4
    s_cbranch_vccz .W_294
.A_295:
    buffer_load_dwordx4 v[96:99], v233, s[8:11], s29 offen sc1
    s_waitcnt vmcnt(2)
    v_max3_u32 v4, v100, v101, v102
    v_max_u32 v4, v4, v103
    v_cmp_eq_u32 vcc, -1, v4
    s_cbranch_vccnz .A_293
.W_296:
    v_mfma_f32_16x16x32_bf16 v[208:211], v[140:143], v[100:103], v[208:211]
    s_waitcnt vmcnt(1)
    v_max3_u32 v4, v92, v93, v94
    v_max_u32 v4, v4, v95
    v_mfma_f32_16x16x32_bf16 v[212:215], v[156:159], v[100:103], v[212:215]
    v_cmp_eq_u32 vcc, -1, v4
    v_mfma_f32_16x16x32_bf16 v[216:219], v[100:103], v[100:103], v[216:219]
    s_cbranch_vccnz .A_297
.W_298:
    v_mfma_f32_16x16x32_bf16 v[208:211], v[132:135], v[92:95], v[208:211]
    s_waitcnt vmcnt(0)
    v_max3_u32 v4, v96, v97, v98
    v_max_u32 v4, v4, v99
    v_mfma_f32_16x16x32_bf16 v[212:215], v[148:151], v[92:95], v[212:215]
    v_cmp_eq_u32 vcc, -1, v4
    v_mfma_f32_16x16x32_bf16 v[216:219], v[92:95], v[92:95], v[216:219]
    s_cbranch_vccnz .A_299
.W_300:
    v_mfma_f32_16x16x32_bf16 v[208:211], v[136:139], v[96:99], v[208:211]
    v_mfma_f32_16x16x32_bf16 v[212:215], v[152:155], v[96:99], v[212:215]
    v_mfma_f32_16x16x32_bf16 v[216:219], v[96:99], v[96:99], v[216:219]
    s_branch .mj_211
.W_294:
    v_mfma_f32_16x16x32_bf16 v[208:211], v[136:139], v[96:99], v[208:211]
    s_waitcnt vmcnt(1)
    v_max3_u32 v4, v100, v101, v102
    v_max_u32 v4, v4, v103
    v_mfma_f32_16x16x32_bf16 v[212:215], v[152:155], v[96:99], v[212:215]
    v_cmp_eq_u32 vcc, -1, v4
    v_mfma_f32_16x16x32_bf16 v[216:219], v[96:99], v[96:99], v[216:219]
    s_cbranch_vccnz .A_301
.W_302:
    v_mfma_f32_16x16x32_bf16 v[208:211], v[140:143], v[100:103], v[208:211]
    s_waitcnt vmcnt(0)
    v_max3_u32 v4, v92, v93, v94
    v_max_u32 v4, v4, v95
    v_mfma_f32_16x16x32_bf16 v[212:215], v[156:159], v[100:103], v[212:215]
    v_cmp_eq_u32 vcc, -1, v4
    v_mfma_f32_16x16x32_bf16 v[216:219], v[100:103], v[100:103], v[216:219]
    s_cbranch_vccnz .A_303
.W_304:
    v_mfma_f32_16x16x32_bf16 v[208:211], v[132:135], v[92:95], v[208:211]
    v_mfma_f32_16x16x32_bf16 v[212:215], v[148:151], v[92:95], v[212:215]
    v_mfma_f32_16x16x32_bf16 v[216:219], v[92:95], v[92:95], v[216:219]
    s_branch .mj_211
.A_305:
    buffer_load_dwordx4 v[96:99], v233, s[8:11], s29 offen sc1
    s_sub_u32 s62, s62, 1
    s_cbranch_scc1 .mg_end_1
    s_waitcnt vmcnt(1)
    v_max3_u32 v4, v92, v93, v94
    v_max_u32 v4, v4, v95
    v_cmp_eq_u32 vcc, -1, v4
    s_cbranch_vccz .W_298
.A_297:
    buffer_load_dwordx4 v[92:95], v232, s[8:11], s29 offen sc1
    s_waitcnt vmcnt(1)
    v_max3_u32 v4, v96, v97, v98
    v_max_u32 v4, v4, v99
    v_cmp_eq_u32 vcc, -1, v4
    s_cbranch_vccnz .A_305
.W_306:
    v_mfma_f32_16x16x32_bf16 v[208:211], v[136:139], v[96:99], v[208:211]
    s_waitcnt vmcnt(0)
    v_max3_u32 v4, v92, v93, v94
    v_max_u32 v4, v4, v95
    v_mfma_f32_16x16x32_bf16 v[212:215], v[152:155], v[96:99], v[212:215]
    v_cmp_eq_u32 vcc, -1, v4
    v_mfma_f32_16x16x32_bf16 v[216:219], v[96:99], v[96:99], v[216:219]
    s_cbranch_vccz .W_304
    s_branch .A_303
.A_307:
    buffer_load_dwordx4 v[92:95], v232, s[8:11], s29 offen sc1
    s_sub_u32 s62, s62, 1
    s_cbranch_scc1 .mg_end_1
    s_waitcnt vmcnt(1)
    v_max3_u32 v4, v100, v101, v102
    v_max_u32 v4, v4, v103
    v_cmp_eq_u32 vcc, -1, v4
    s_cbranch_vccz .W_302
.A_301:
    buffer_load_dwordx4 v[100:103], v234, s[8:11], s29 offen sc1
    s_waitcnt vmcnt(1)
    v_max3_u32 v4, v92, v93, v94
    v_max_u32 v4, v4, v95
    v_cmp_eq_u32 vcc, -1, v4
    s_cbranch_vccnz .A_307
.W_308:
    v_mfma_f32_16x16x32_bf16 v[208:211], v[132:135], v[92:95], v[208:211]
    s_waitcnt vmcnt(0)
    v_max3_u32 v4, v100, v101, v102
    v_max_u32 v4, v4, v103
    v_mfma_f32_16x16x32_bf16 v[212:215], v[148:151], v[92:95], v[212:215]
    v_cmp_eq_u32 vcc, -1, v4
    v_mfma_f32_16x16x32_bf16 v[216:219], v[92:95], v[92:95], v[216:219]
    s_cbranch_vccz .W_217
    s_branch .A_216
.A_309:
    buffer_load_dwordx4 v[100:103], v234, s[8:11], s29 offen sc1
    s_sub_u32 s62, s62, 1
    s_cbranch_scc1 .mg_end_1
    s_waitcnt vmcnt(1)
    v_max3_u32 v4, v96, v97, v98
    v_max_u32 v4, v4, v99
    v_cmp_eq_u32 vcc, -1, v4
    s_cbranch_vccz .W_215
.A_214:
    buffer_load_dwordx4 v[96:99], v233, s[8:11], s29 offen sc1
    s_waitcnt vmcnt(1)
    v_max3_u32 v4, v100, v101, v102
    v_max_u32 v4, v4, v103
    v_cmp_eq_u32 vcc, -1, v4
    s_cbranch_vccnz .A_309
.W_310:
    v_mfma_f32_16x16x32_bf16 v[208:211], v[140:143], v[100:103], v[208:211]
    s_waitcnt vmcnt(0)
    v_max3_u32 v4, v96, v97, v98
    v_max_u32 v4, v4, v99
    v_mfma_f32_16x16x32_bf16 v[212:215], v[156:159], v[100:103], v[212:215]
    v_cmp_eq_u32 vcc, -1, v4
    v_mfma_f32_16x16x32_bf16 v[216:219], v[100:103], v[100:103], v[216:219]
    s_cbranch_vccz .W_300
    s_branch .A_299
.A_303:
    buffer_load_dwordx4 v[92:95], v232, s[8:11], s29 offen sc1
    s_sub_u32 s62, s62, 1
    s_cbranch_scc1 .mg_end_1
    s_waitcnt vmcnt(1)
    v_max3_u32 v4, v92, v93, v94
    v_max_u32 v4, v4, v95
    v_cmp_eq_u32 vcc, -1, v4
    s_cbranch_vccnz .A_303
    v_mfma_f32_16x16x32_bf16 v[208:211], v[132:135], v[92:95], v[208:211]
    v_mfma_f32_16x16x32_bf16 v[212:215], v[148:151], v[92:95], v[212:215]
    v_mfma_f32_16x16x32_bf16 v[216:219], v[92:95], v[92:95], v[216:219]
    s_branch .mj_211
.A_299:
    buffer_load_dwordx4 v[96:99], v233, s[8:11], s29 offen sc1
    s_sub_u32 s62, s62, 1
    s_cbranch_scc1 .mg_end_1
    s_waitcnt vmcnt(1)
    v_max3_u32 v4, v96, v97, v98
    v_max_u32 v4, v4, v99
    v_cmp_eq_u32 vcc, -1, v4
    s_cbranch_vccnz .A_299
    v_mfma_f32_16x16x32_bf16 v[208:211], v[136:139], v[96:99], v[208:211]
    v_mfma_f32_16x16x32_bf16 v[212:215], v[152:155], v[96:99], v[212:215]
    v_mfma_f32_16x16x32_bf16 v[216:219], v[96:99], v[96:99], v[216:219]
    s_branch .mj_211
.A_216:
    buffer_load_dwordx4 v[100:103], v234, s[8:11], s29 offen sc1
    s_sub_u32 s62, s62, 1
    s_cbranch_scc1 .mg_end_1
    s_waitcnt vmcnt(1)
    v_max3_u32 v4, v100, v101, v102
    v_max_u32 v4, v4, v103
    v_cmp_eq_u32 vcc, -1, v4
    s_cbranch_vccnz .A_216
    v_mfma_f32_16x16x32_bf16 v[208:211], v[140:143], v[100:103], v[208:211]
    v_mfma_f32_16x16x32_bf16 v[212:215], v[156:159], v[100:103], v[212:215]
    v_mfma_f32_16x16x32_bf16 v[216:219], v[100:103], v[100:103], v[216:219]
    s_branch .mj_211
.kf_225:
    s_mov_b32 s62, 0
    s_mov_b64 exec, 3
.wf_311:
    buffer_load_dword v244, v253, s[8:11], s89 offen sc1
    s_waitcnt vmcnt(0)
    v_cmp_gt_u32 vcc, s6, v244
    s_cbranch_vccz .wfd_312
    s_sleep 2
    s_add_u32 s62, s62, 1
    s_cmp_gt_u32 s62, 0x400000
    s_cbranch_scc1 .mg_end_1
    s_branch .wf_311

.wfd_312:
    s_mov_b64 exec, -1
    v_readlane_b32 s4, v244, 0
    v_readlane_b32 s93, v244, 1
    s_min_u32 s93, s93, s4
    s_mov_b32 s62, 0x1000000
    s_branch .kb_226
.A_313:
    buffer_load_dwordx4 v[216:219], v246, s[8:11], s32 offen offset:0 sc1
    buffer_load_dwordx4 v[220:223], v246, s[8:11], s32 offen offset:1024 sc1
    s_sub_u32 s62, s62, 1
    s_cbranch_scc1 .mg_end_1
    s_waitcnt vmcnt(6)
    v_max3_u32 v4, v192, v193, v194
    v_max3_u32 v5, v195, v196, v197
    v_max3_u32 v4, v4, v198, v199
    v_max_u32 v4, v4, v5
    v_cmp_eq_u32 vcc, -1, v4
    s_cbranch_vccz .W_229
.A_228:
    buffer_load_dwordx4 v[192:195], v243, s[8:11], s32 offen offset:0 sc1
    buffer_load_dwordx4 v[196:199], v243, s[8:11], s32 offen offset:1024 sc1
    s_waitcnt vmcnt(6)
    v_max3_u32 v4, v200, v201, v202
    v_max3_u32 v5, v203, v204, v205
    v_max3_u32 v4, v4, v206, v207
    v_max_u32 v4, v4, v5
    v_cmp_eq_u32 vcc, -1, v4
    s_cbranch_vccz .W_314
.A_315:
    buffer_load_dwordx4 v[200:203], v252, s[8:11], s32 offen offset:0 sc1
    buffer_load_dwordx4 v[204:207], v252, s[8:11], s32 offen offset:1024 sc1
    s_waitcnt vmcnt(6)
    v_max3_u32 v4, v208, v209, v210
    v_max3_u32 v5, v211, v212, v213
    v_max3_u32 v4, v4, v214, v215
    v_max_u32 v4, v4, v5
    v_cmp_eq_u32 vcc, -1, v4
    s_cbranch_vccz .W_316
.A_317:
    buffer_load_dwordx4 v[208:211], v254, s[8:11], s32 offen offset:0 sc1
    buffer_load_dwordx4 v[212:215], v254, s[8:11], s32 offen offset:1024 sc1
    s_waitcnt vmcnt(6)
    v_max3_u32 v4, v216, v217, v218
    v_max3_u32 v5, v219, v220, v221
    v_max3_u32 v4, v4, v222, v223
    v_max_u32 v4, v4, v5
    v_cmp_eq_u32 vcc, -1, v4
    s_cbranch_vccnz .A_313
.W_318:
    v_smfmac_f32_16x16x64_bf16 v[76:79], v[216:219], v[140:147], v9
    v_smfmac_f32_16x16x64_bf16 v[80:83], v[216:219], v[172:179], v9
    s_waitcnt vmcnt(4)
    v_max3_u32 v4, v192, v193, v194
    v_max3_u32 v5, v195, v196, v197
    v_max3_u32 v4, v4, v198, v199
    v_smfmac_f32_16x16x64_bf16 v[76:79], v[220:223], v[148:155], v9
    v_max_u32 v4, v4, v5
    v_cmp_eq_u32 vcc, -1, v4
    v_smfmac_f32_16x16x64_bf16 v[80:83], v[220:223], v[180:187], v9
    s_cbranch_vccnz .A_319
.W_320:
    v_smfmac_f32_16x16x64_bf16 v[76:79], v[192:195], a[192:199], v9
    v_smfmac_f32_16x16x64_bf16 v[80:83], v[192:195], a[224:231], v9
    s_waitcnt vmcnt(2)
    v_max3_u32 v4, v200, v201, v202
    v_max3_u32 v5, v203, v204, v205
    v_max3_u32 v4, v4, v206, v207
    v_smfmac_f32_16x16x64_bf16 v[76:79], v[196:199], a[200:207], v9
    v_max_u32 v4, v4, v5
    v_cmp_eq_u32 vcc, -1, v4
    v_smfmac_f32_16x16x64_bf16 v[80:83], v[196:199], a[232:239], v9
    s_cbranch_vccnz .A_321
.W_322:
    v_smfmac_f32_16x16x64_bf16 v[76:79], v[200:203], a[208:215], v9
    v_smfmac_f32_16x16x64_bf16 v[80:83], v[200:203], a[240:247], v9
    s_waitcnt vmcnt(0)
    v_max3_u32 v4, v208, v209, v210
    v_max3_u32 v5, v211, v212, v213
    v_max3_u32 v4, v4, v214, v215
    v_smfmac_f32_16x16x64_bf16 v[76:79], v[204:207], a[216:223], v9
    v_max_u32 v4, v4, v5
    v_cmp_eq_u32 vcc, -1, v4
    v_smfmac_f32_16x16x64_bf16 v[80:83], v[204:207], a[248:255], v9
    s_cbranch_vccnz .A_323
.W_324:
    v_smfmac_f32_16x16x64_bf16 v[76:79], v[208:211], v[124:131], v9
    v_smfmac_f32_16x16x64_bf16 v[80:83], v[208:211], v[156:163], v9
    v_smfmac_f32_16x16x64_bf16 v[76:79], v[212:215], v[132:139], v9
    v_smfmac_f32_16x16x64_bf16 v[80:83], v[212:215], v[164:171], v9
    s_branch .mj_227
.W_314:
    v_smfmac_f32_16x16x64_bf16 v[76:79], v[200:203], a[208:215], v9
    v_smfmac_f32_16x16x64_bf16 v[80:83], v[200:203], a[240:247], v9
    s_waitcnt vmcnt(4)
    v_max3_u32 v4, v208, v209, v210
    v_max3_u32 v5, v211, v212, v213
    v_max3_u32 v4, v4, v214, v215
    v_smfmac_f32_16x16x64_bf16 v[76:79], v[204:207], a[216:223], v9
    v_max_u32 v4, v4, v5
    v_cmp_eq_u32 vcc, -1, v4
    v_smfmac_f32_16x16x64_bf16 v[80:83], v[204:207], a[248:255], v9
    s_cbranch_vccnz .A_325
.W_326:
    v_smfmac_f32_16x16x64_bf16 v[76:79], v[208:211], v[124:131], v9
    v_smfmac_f32_16x16x64_bf16 v[80:83], v[208:211], v[156:163], v9
    s_waitcnt vmcnt(2)
    v_max3_u32 v4, v216, v217, v218
    v_max3_u32 v5, v219, v220, v221
    v_max3_u32 v4, v4, v222, v223
    v_smfmac_f32_16x16x64_bf16 v[76:79], v[212:215], v[132:139], v9
    v_max_u32 v4, v4, v5
    v_cmp_eq_u32 vcc, -1, v4
    v_smfmac_f32_16x16x64_bf16 v[80:83], v[212:215], v[164:171], v9
    s_cbranch_vccnz .A_327
.W_328:
    v_smfmac_f32_16x16x64_bf16 v[76:79], v[216:219], v[140:147], v9
    v_smfmac_f32_16x16x64_bf16 v[80:83], v[216:219], v[172:179], v9
    s_waitcnt vmcnt(0)
    v_max3_u32 v4, v192, v193, v194
    v_max3_u32 v5, v195, v196, v197
    v_max3_u32 v4, v4, v198, v199
    v_smfmac_f32_16x16x64_bf16 v[76:79], v[220:223], v[148:155], v9
    v_max_u32 v4, v4, v5
    v_cmp_eq_u32 vcc, -1, v4
    v_smfmac_f32_16x16x64_bf16 v[80:83], v[220:223], v[180:187], v9
    s_cbranch_vccnz .A_329
.W_330:
    v_smfmac_f32_16x16x64_bf16 v[76:79], v[192:195], a[192:199], v9
    v_smfmac_f32_16x16x64_bf16 v[80:83], v[192:195], a[224:231], v9
    v_smfmac_f32_16x16x64_bf16 v[76:79], v[196:199], a[200:207], v9
    v_smfmac_f32_16x16x64_bf16 v[80:83], v[196:199], a[232:239], v9
    s_branch .mj_227
.W_316:
    v_smfmac_f32_16x16x64_bf16 v[76:79], v[208:211], v[124:131], v9
    v_smfmac_f32_16x16x64_bf16 v[80:83], v[208:211], v[156:163], v9
    s_waitcnt vmcnt(4)
    v_max3_u32 v4, v216, v217, v218
    v_max3_u32 v5, v219, v220, v221
    v_max3_u32 v4, v4, v222, v223
    v_smfmac_f32_16x16x64_bf16 v[76:79], v[212:215], v[132:139], v9
    v_max_u32 v4, v4, v5
    v_cmp_eq_u32 vcc, -1, v4
    v_smfmac_f32_16x16x64_bf16 v[80:83], v[212:215], v[164:171], v9
    s_cbranch_vccnz .A_331
.W_332:
    v_smfmac_f32_16x16x64_bf16 v[76:79], v[216:219], v[140:147], v9
    v_smfmac_f32_16x16x64_bf16 v[80:83], v[216:219], v[172:179], v9
    s_waitcnt vmcnt(2)
    v_max3_u32 v4, v192, v193, v194
    v_max3_u32 v5, v195, v196, v197
    v_max3_u32 v4, v4, v198, v199
    v_smfmac_f32_16x16x64_bf16 v[76:79], v[220:223], v[148:155], v9
    v_max_u32 v4, v4, v5
    v_cmp_eq_u32 vcc, -1, v4
    v_smfmac_f32_16x16x64_bf16 v[80:83], v[220:223], v[180:187], v9
    s_cbranch_vccnz .A_333
.W_334:
    v_smfmac_f32_16x16x64_bf16 v[76:79], v[192:195], a[192:199], v9
    v_smfmac_f32_16x16x64_bf16 v[80:83], v[192:195], a[224:231], v9
    s_waitcnt vmcnt(0)
    v_max3_u32 v4, v200, v201, v202
    v_max3_u32 v5, v203, v204, v205
    v_max3_u32 v4, v4, v206, v207
    v_smfmac_f32_16x16x64_bf16 v[76:79], v[196:199], a[200:207], v9
    v_max_u32 v4, v4, v5
    v_cmp_eq_u32 vcc, -1, v4
    v_smfmac_f32_16x16x64_bf16 v[80:83], v[196:199], a[232:239], v9
    s_cbranch_vccnz .A_335
.W_336:
    v_smfmac_f32_16x16x64_bf16 v[76:79], v[200:203], a[208:215], v9
    v_smfmac_f32_16x16x64_bf16 v[80:83], v[200:203], a[240:247], v9
    v_smfmac_f32_16x16x64_bf16 v[76:79], v[204:207], a[216:223], v9
    v_smfmac_f32_16x16x64_bf16 v[80:83], v[204:207], a[248:255], v9
    s_branch .mj_227
.A_337:
    buffer_load_dwordx4 v[208:211], v254, s[8:11], s32 offen offset:0 sc1
    buffer_load_dwordx4 v[212:215], v254, s[8:11], s32 offen offset:1024 sc1
    s_sub_u32 s62, s62, 1
    s_cbranch_scc1 .mg_end_1
    s_waitcnt vmcnt(4)
    v_max3_u32 v4, v192, v193, v194
    v_max3_u32 v5, v195, v196, v197
    v_max3_u32 v4, v4, v198, v199
    v_max_u32 v4, v4, v5
    v_cmp_eq_u32 vcc, -1, v4
    s_cbranch_vccz .W_320
.A_319:
    buffer_load_dwordx4 v[192:195], v243, s[8:11], s32 offen offset:0 sc1
    buffer_load_dwordx4 v[196:199], v243, s[8:11], s32 offen offset:1024 sc1
    s_waitcnt vmcnt(4)
    v_max3_u32 v4, v200, v201, v202
    v_max3_u32 v5, v203, v204, v205
    v_max3_u32 v4, v4, v206, v207
    v_max_u32 v4, v4, v5
    v_cmp_eq_u32 vcc, -1, v4
    s_cbranch_vccz .W_338
.A_339:
    buffer_load_dwordx4 v[200:203], v252, s[8:11], s32 offen offset:0 sc1
    buffer_load_dwordx4 v[204:207], v252, s[8:11], s32 offen offset:1024 sc1
    s_waitcnt vmcnt(4)
    v_max3_u32 v4, v208, v209, v210
    v_max3_u32 v5, v211, v212, v213
    v_max3_u32 v4, v4, v214, v215
    v_max_u32 v4, v4, v5
    v_cmp_eq_u32 vcc, -1, v4
    s_cbranch_vccnz .A_337
.W_340:
    v_smfmac_f32_16x16x64_bf16 v[76:79], v[208:211], v[124:131], v9
    v_smfmac_f32_16x16x64_bf16 v[80:83], v[208:211], v[156:163], v9
    s_waitcnt vmcnt(2)
    v_max3_u32 v4, v192, v193, v194
    v_max3_u32 v5, v195, v196, v197
    v_max3_u32 v4, v4, v198, v199
    v_smfmac_f32_16x16x64_bf16 v[76:79], v[212:215], v[132:139], v9
    v_max_u32 v4, v4, v5
    v_cmp_eq_u32 vcc, -1, v4
    v_smfmac_f32_16x16x64_bf16 v[80:83], v[212:215], v[164:171], v9
    s_cbranch_vccz .W_334
    s_branch .A_333
.W_338:
    v_smfmac_f32_16x16x64_bf16 v[76:79], v[200:203], a[208:215], v9
    v_smfmac_f32_16x16x64_bf16 v[80:83], v[200:203], a[240:247], v9
    s_waitcnt vmcnt(2)
    v_max3_u32 v4, v208, v209, v210
    v_max3_u32 v5, v211, v212, v213
    v_max3_u32 v4, v4, v214, v215
    v_smfmac_f32_16x16x64_bf16 v[76:79], v[204:207], a[216:223], v9
    v_max_u32 v4, v4, v5
    v_cmp_eq_u32 vcc, -1, v4
    v_smfmac_f32_16x16x64_bf16 v[80:83], v[204:207], a[248:255], v9
    s_cbranch_vccnz .A_341
.W_342:
    v_smfmac_f32_16x16x64_bf16 v[76:79], v[208:211], v[124:131], v9
    v_smfmac_f32_16x16x64_bf16 v[80:83], v[208:211], v[156:163], v9
    s_waitcnt vmcnt(0)
    v_max3_u32 v4, v192, v193, v194
    v_max3_u32 v5, v195, v196, v197
    v_max3_u32 v4, v4, v198, v199
    v_smfmac_f32_16x16x64_bf16 v[76:79], v[212:215], v[132:139], v9
    v_max_u32 v4, v4, v5
    v_cmp_eq_u32 vcc, -1, v4
    v_smfmac_f32_16x16x64_bf16 v[80:83], v[212:215], v[164:171], v9
    s_cbranch_vccz .W_330
    s_branch .A_329
.A_343:
    buffer_load_dwordx4 v[200:203], v252, s[8:11], s32 offen offset:0 sc1
    buffer_load_dwordx4 v[204:207], v252, s[8:11], s32 offen offset:1024 sc1
    s_sub_u32 s62, s62, 1
    s_cbranch_scc1 .mg_end_1
    s_waitcnt vmcnt(4)
    v_max3_u32 v4, v216, v217, v218
    v_max3_u32 v5, v219, v220, v221
    v_max3_u32 v4, v4, v222, v223
    v_max_u32 v4, v4, v5
    v_cmp_eq_u32 vcc, -1, v4
    s_cbranch_vccz .W_332
.A_331:
    buffer_load_dwordx4 v[216:219], v246, s[8:11], s32 offen offset:0 sc1
    buffer_load_dwordx4 v[220:223], v246, s[8:11], s32 offen offset:1024 sc1
    s_waitcnt vmcnt(4)
    v_max3_u32 v4, v192, v193, v194
    v_max3_u32 v5, v195, v196, v197
    v_max3_u32 v4, v4, v198, v199
    v_max_u32 v4, v4, v5
    v_cmp_eq_u32 vcc, -1, v4
    s_cbranch_vccz .W_344
.A_345:
    buffer_load_dwordx4 v[192:195], v243, s[8:11], s32 offen offset:0 sc1
    buffer_load_dwordx4 v[196:199], v243, s[8:11], s32 offen offset:1024 sc1
    s_waitcnt vmcnt(4)
    v_max3_u32 v4, v200, v201, v202
    v_max3_u32 v5, v203, v204, v205
    v_max3_u32 v4, v4, v206, v207
    v_max_u32 v4, v4, v5
    v_cmp_eq_u32 vcc, -1, v4
    s_cbranch_vccnz .A_343
.W_346:
    v_smfmac_f32_16x16x64_bf16 v[76:79], v[200:203], a[208:215], v9
    v_smfmac_f32_16x16x64_bf16 v[80:83], v[200:203], a[240:247], v9
    s_waitcnt vmcnt(2)
    v_max3_u32 v4, v216, v217, v218
    v_max3_u32 v5, v219, v220, v221
    v_max3_u32 v4, v4, v222, v223
    v_smfmac_f32_16x16x64_bf16 v[76:79], v[204:207], a[216:223], v9
    v_max_u32 v4, v4, v5
    v_cmp_eq_u32 vcc, -1, v4
    v_smfmac_f32_16x16x64_bf16 v[80:83], v[204:207], a[248:255], v9
    s_cbranch_vccz .W_328
    s_branch .A_327
.W_344:
    v_smfmac_f32_16x16x64_bf16 v[76:79], v[192:195], a[192:199], v9
    v_smfmac_f32_16x16x64_bf16 v[80:83], v[192:195], a[224:231], v9
    s_waitcnt vmcnt(2)
    v_max3_u32 v4, v200, v201, v202
    v_max3_u32 v5, v203, v204, v205
    v_max3_u32 v4, v4, v206, v207
    v_smfmac_f32_16x16x64_bf16 v[76:79], v[196:199], a[200:207], v9
    v_max_u32 v4, v4, v5
    v_cmp_eq_u32 vcc, -1, v4
    v_smfmac_f32_16x16x64_bf16 v[80:83], v[196:199], a[232:239], v9
    s_cbranch_vccnz .A_347
.W_348:
    v_smfmac_f32_16x16x64_bf16 v[76:79], v[200:203], a[208:215], v9
    v_smfmac_f32_16x16x64_bf16 v[80:83], v[200:203], a[240:247], v9
    s_waitcnt vmcnt(0)
    v_max3_u32 v4, v216, v217, v218
    v_max3_u32 v5, v219, v220, v221
    v_max3_u32 v4, v4, v222, v223
    v_smfmac_f32_16x16x64_bf16 v[76:79], v[204:207], a[216:223], v9
    v_max_u32 v4, v4, v5
    v_cmp_eq_u32 vcc, -1, v4
    v_smfmac_f32_16x16x64_bf16 v[80:83], v[204:207], a[248:255], v9
    s_cbranch_vccz .W_235
    s_branch .A_234
.A_349:
    buffer_load_dwordx4 v[216:219], v246, s[8:11], s32 offen offset:0 sc1
    buffer_load_dwordx4 v[220:223], v246, s[8:11], s32 offen offset:1024 sc1
    s_sub_u32 s62, s62, 1
    s_cbranch_scc1 .mg_end_1
    s_waitcnt vmcnt(4)
    v_max3_u32 v4, v192, v193, v194
    v_max3_u32 v5, v195, v196, v197
    v_max3_u32 v4, v4, v198, v199
    v_max_u32 v4, v4, v5
    v_cmp_eq_u32 vcc, -1, v4
    s_cbranch_vccz .W_350
.A_351:
    buffer_load_dwordx4 v[192:195], v243, s[8:11], s32 offen offset:0 sc1
    buffer_load_dwordx4 v[196:199], v243, s[8:11], s32 offen offset:1024 sc1
    s_waitcnt vmcnt(4)
    v_max3_u32 v4, v208, v209, v210
    v_max3_u32 v5, v211, v212, v213
    v_max3_u32 v4, v4, v214, v215
    v_max_u32 v4, v4, v5
    v_cmp_eq_u32 vcc, -1, v4
    s_cbranch_vccz .W_326
.A_325:
    buffer_load_dwordx4 v[208:211], v254, s[8:11], s32 offen offset:0 sc1
    buffer_load_dwordx4 v[212:215], v254, s[8:11], s32 offen offset:1024 sc1
    s_waitcnt vmcnt(4)
    v_max3_u32 v4, v216, v217, v218
    v_max3_u32 v5, v219, v220, v221
    v_max3_u32 v4, v4, v222, v223
    v_max_u32 v4, v4, v5
    v_cmp_eq_u32 vcc, -1, v4
    s_cbranch_vccnz .A_349
.W_352:
    v_smfmac_f32_16x16x64_bf16 v[76:79], v[216:219], v[140:147], v9
    v_smfmac_f32_16x16x64_bf16 v[80:83], v[216:219], v[172:179], v9
    s_waitcnt vmcnt(2)
    v_max3_u32 v4, v192, v193, v194
    v_max3_u32 v5, v195, v196, v197
    v_max3_u32 v4, v4, v198, v199
    v_smfmac_f32_16x16x64_bf16 v[76:79], v[220:223], v[148:155], v9
    v_max_u32 v4, v4, v5
    v_cmp_eq_u32 vcc, -1, v4
    v_smfmac_f32_16x16x64_bf16 v[80:83], v[220:223], v[180:187], v9
    s_cbranch_vccnz .A_353
.W_354:
    v_smfmac_f32_16x16x64_bf16 v[76:79], v[192:195], a[192:199], v9
    v_smfmac_f32_16x16x64_bf16 v[80:83], v[192:195], a[224:231], v9
    s_waitcnt vmcnt(0)
    v_max3_u32 v4, v208, v209, v210
    v_max3_u32 v5, v211, v212, v213
    v_max3_u32 v4, v4, v214, v215
    v_smfmac_f32_16x16x64_bf16 v[76:79], v[196:199], a[200:207], v9
    v_max_u32 v4, v4, v5
    v_cmp_eq_u32 vcc, -1, v4
    v_smfmac_f32_16x16x64_bf16 v[80:83], v[196:199], a[232:239], v9
    s_cbranch_vccz .W_324
    s_branch .A_323
.W_350:
    v_smfmac_f32_16x16x64_bf16 v[76:79], v[192:195], a[192:199], v9
    v_smfmac_f32_16x16x64_bf16 v[80:83], v[192:195], a[224:231], v9
    s_waitcnt vmcnt(2)
    v_max3_u32 v4, v208, v209, v210
    v_max3_u32 v5, v211, v212, v213
    v_max3_u32 v4, v4, v214, v215
    v_smfmac_f32_16x16x64_bf16 v[76:79], v[196:199], a[200:207], v9
    v_max_u32 v4, v4, v5
    v_cmp_eq_u32 vcc, -1, v4
    v_smfmac_f32_16x16x64_bf16 v[80:83], v[196:199], a[232:239], v9
    s_cbranch_vccz .W_233
    s_branch .A_232
.A_355:
    buffer_load_dwordx4 v[216:219], v246, s[8:11], s32 offen offset:0 sc1
    buffer_load_dwordx4 v[220:223], v246, s[8:11], s32 offen offset:1024 sc1
    s_sub_u32 s62, s62, 1
    s_cbranch_scc1 .mg_end_1
    s_waitcnt vmcnt(4)
    v_max3_u32 v4, v200, v201, v202
    v_max3_u32 v5, v203, v204, v205
    v_max3_u32 v4, v4, v206, v207
    v_max_u32 v4, v4, v5
    v_cmp_eq_u32 vcc, -1, v4
    s_cbranch_vccz .W_231
.A_230:
    buffer_load_dwordx4 v[200:203], v252, s[8:11], s32 offen offset:0 sc1
    buffer_load_dwordx4 v[204:207], v252, s[8:11], s32 offen offset:1024 sc1
    s_waitcnt vmcnt(4)
    v_max3_u32 v4, v208, v209, v210
    v_max3_u32 v5, v211, v212, v213
    v_max3_u32 v4, v4, v214, v215
    v_max_u32 v4, v4, v5
    v_cmp_eq_u32 vcc, -1, v4
    s_cbranch_vccz .W_356
.A_357:
    buffer_load_dwordx4 v[208:211], v254, s[8:11], s32 offen offset:0 sc1
    buffer_load_dwordx4 v[212:215], v254, s[8:11], s32 offen offset:1024 sc1
    s_waitcnt vmcnt(4)
    v_max3_u32 v4, v216, v217, v218
    v_max3_u32 v5, v219, v220, v221
    v_max3_u32 v4, v4, v222, v223
    v_max_u32 v4, v4, v5
    v_cmp_eq_u32 vcc, -1, v4
    s_cbranch_vccnz .A_355
.W_358:
    v_smfmac_f32_16x16x64_bf16 v[76:79], v[216:219], v[140:147], v9
    v_smfmac_f32_16x16x64_bf16 v[80:83], v[216:219], v[172:179], v9
    s_waitcnt vmcnt(2)
    v_max3_u32 v4, v200, v201, v202
    v_max3_u32 v5, v203, v204, v205
    v_max3_u32 v4, v4, v206, v207
    v_smfmac_f32_16x16x64_bf16 v[76:79], v[220:223], v[148:155], v9
    v_max_u32 v4, v4, v5
    v_cmp_eq_u32 vcc, -1, v4
    v_smfmac_f32_16x16x64_bf16 v[80:83], v[220:223], v[180:187], v9
    s_cbranch_vccz .W_322
    s_branch .A_321
.W_356:
    v_smfmac_f32_16x16x64_bf16 v[76:79], v[208:211], v[124:131], v9
    v_smfmac_f32_16x16x64_bf16 v[80:83], v[208:211], v[156:163], v9
    s_waitcnt vmcnt(2)
    v_max3_u32 v4, v216, v217, v218
    v_max3_u32 v5, v219, v220, v221
    v_max3_u32 v4, v4, v222, v223
    v_smfmac_f32_16x16x64_bf16 v[76:79], v[212:215], v[132:139], v9
    v_max_u32 v4, v4, v5
    v_cmp_eq_u32 vcc, -1, v4
    v_smfmac_f32_16x16x64_bf16 v[80:83], v[212:215], v[164:171], v9
    s_cbranch_vccnz .A_359
.W_360:
    v_smfmac_f32_16x16x64_bf16 v[76:79], v[216:219], v[140:147], v9
    v_smfmac_f32_16x16x64_bf16 v[80:83], v[216:219], v[172:179], v9
    s_waitcnt vmcnt(0)
    v_max3_u32 v4, v200, v201, v202
    v_max3_u32 v5, v203, v204, v205
    v_max3_u32 v4, v4, v206, v207
    v_smfmac_f32_16x16x64_bf16 v[76:79], v[220:223], v[148:155], v9
    v_max_u32 v4, v4, v5
    v_cmp_eq_u32 vcc, -1, v4
    v_smfmac_f32_16x16x64_bf16 v[80:83], v[220:223], v[180:187], v9
    s_cbranch_vccz .W_336
    s_branch .A_335
.A_361:
    buffer_load_dwordx4 v[200:203], v252, s[8:11], s32 offen offset:0 sc1
    buffer_load_dwordx4 v[204:207], v252, s[8:11], s32 offen offset:1024 sc1
    s_sub_u32 s62, s62, 1
    s_cbranch_scc1 .mg_end_1
    s_waitcnt vmcnt(2)
    v_max3_u32 v4, v192, v193, v194
    v_max3_u32 v5, v195, v196, v197
    v_max3_u32 v4, v4, v198, v199
    v_max_u32 v4, v4, v5
    v_cmp_eq_u32 vcc, -1, v4
    s_cbranch_vccz .W_334
.A_333:
    buffer_load_dwordx4 v[192:195], v243, s[8:11], s32 offen offset:0 sc1
    buffer_load_dwordx4 v[196:199], v243, s[8:11], s32 offen offset:1024 sc1
    s_waitcnt vmcnt(2)
    v_max3_u32 v4, v200, v201, v202
    v_max3_u32 v5, v203, v204, v205
    v_max3_u32 v4, v4, v206, v207
    v_max_u32 v4, v4, v5
    v_cmp_eq_u32 vcc, -1, v4
    s_cbranch_vccnz .A_361
.W_362:
    v_smfmac_f32_16x16x64_bf16 v[76:79], v[200:203], a[208:215], v9
    v_smfmac_f32_16x16x64_bf16 v[80:83], v[200:203], a[240:247], v9
    s_waitcnt vmcnt(0)
    v_max3_u32 v4, v192, v193, v194
    v_max3_u32 v5, v195, v196, v197
    v_max3_u32 v4, v4, v198, v199
    v_smfmac_f32_16x16x64_bf16 v[76:79], v[204:207], a[216:223], v9
    v_max_u32 v4, v4, v5
    v_cmp_eq_u32 vcc, -1, v4
    v_smfmac_f32_16x16x64_bf16 v[80:83], v[204:207], a[248:255], v9
    s_cbranch_vccz .W_330
    s_branch .A_329
.A_341:
    buffer_load_dwordx4 v[208:211], v254, s[8:11], s32 offen offset:0 sc1
    buffer_load_dwordx4 v[212:215], v254, s[8:11], s32 offen offset:1024 sc1
    s_sub_u32 s62, s62, 1
    s_cbranch_scc1 .mg_end_1
    s_waitcnt vmcnt(2)
    v_max3_u32 v4, v192, v193, v194
    v_max3_u32 v5, v195, v196, v197
    v_max3_u32 v4, v4, v198, v199
    v_max_u32 v4, v4, v5
    v_cmp_eq_u32 vcc, -1, v4
    s_cbranch_vccz .W_354
.A_353:
    buffer_load_dwordx4 v[192:195], v243, s[8:11], s32 offen offset:0 sc1
    buffer_load_dwordx4 v[196:199], v243, s[8:11], s32 offen offset:1024 sc1
    s_waitcnt vmcnt(2)
    v_max3_u32 v4, v208, v209, v210
    v_max3_u32 v5, v211, v212, v213
    v_max3_u32 v4, v4, v214, v215
    v_max_u32 v4, v4, v5
    v_cmp_eq_u32 vcc, -1, v4
    s_cbranch_vccnz .A_341
    s_branch .W_342
.A_363:
    buffer_load_dwordx4 v[192:195], v243, s[8:11], s32 offen offset:0 sc1
    buffer_load_dwordx4 v[196:199], v243, s[8:11], s32 offen offset:1024 sc1
    s_sub_u32 s62, s62, 1
    s_cbranch_scc1 .mg_end_1
    s_waitcnt vmcnt(2)
    v_max3_u32 v4, v216, v217, v218
    v_max3_u32 v5, v219, v220, v221
    v_max3_u32 v4, v4, v222, v223
    v_max_u32 v4, v4, v5
    v_cmp_eq_u32 vcc, -1, v4
    s_cbranch_vccz .W_328
.A_327:
    buffer_load_dwordx4 v[216:219], v246, s[8:11], s32 offen offset:0 sc1
    buffer_load_dwordx4 v[220:223], v246, s[8:11], s32 offen offset:1024 sc1
    s_waitcnt vmcnt(2)
    v_max3_u32 v4, v192, v193, v194
    v_max3_u32 v5, v195, v196, v197
    v_max3_u32 v4, v4, v198, v199
    v_max_u32 v4, v4, v5
    v_cmp_eq_u32 vcc, -1, v4
    s_cbranch_vccnz .A_363
.W_364:
    v_smfmac_f32_16x16x64_bf16 v[76:79], v[192:195], a[192:199], v9
    v_smfmac_f32_16x16x64_bf16 v[80:83], v[192:195], a[224:231], v9
    s_waitcnt vmcnt(0)
    v_max3_u32 v4, v216, v217, v218
    v_max3_u32 v5, v219, v220, v221
    v_max3_u32 v4, v4, v222, v223
    v_smfmac_f32_16x16x64_bf16 v[76:79], v[196:199], a[200:207], v9
    v_max_u32 v4, v4, v5
    v_cmp_eq_u32 vcc, -1, v4
    v_smfmac_f32_16x16x64_bf16 v[80:83], v[196:199], a[232:239], v9
    s_cbranch_vccz .W_235
    s_branch .A_234
.A_365:
    buffer_load_dwordx4 v[208:211], v254, s[8:11], s32 offen offset:0 sc1
    buffer_load_dwordx4 v[212:215], v254, s[8:11], s32 offen offset:1024 sc1
    s_sub_u32 s62, s62, 1
    s_cbranch_scc1 .mg_end_1
    s_waitcnt vmcnt(2)
    v_max3_u32 v4, v200, v201, v202
    v_max3_u32 v5, v203, v204, v205
    v_max3_u32 v4, v4, v206, v207
    v_max_u32 v4, v4, v5
    v_cmp_eq_u32 vcc, -1, v4
    s_cbranch_vccz .W_322
.A_321:
    buffer_load_dwordx4 v[200:203], v252, s[8:11], s32 offen offset:0 sc1
    buffer_load_dwordx4 v[204:207], v252, s[8:11], s32 offen offset:1024 sc1
    s_waitcnt vmcnt(2)
    v_max3_u32 v4, v208, v209, v210
    v_max3_u32 v5, v211, v212, v213
    v_max3_u32 v4, v4, v214, v215
    v_max_u32 v4, v4, v5
    v_cmp_eq_u32 vcc, -1, v4
    s_cbranch_vccnz .A_365
.W_366:
    v_smfmac_f32_16x16x64_bf16 v[76:79], v[208:211], v[124:131], v9
    v_smfmac_f32_16x16x64_bf16 v[80:83], v[208:211], v[156:163], v9
    s_waitcnt vmcnt(0)
    v_max3_u32 v4, v200, v201, v202
    v_max3_u32 v5, v203, v204, v205
    v_max3_u32 v4, v4, v206, v207
    v_smfmac_f32_16x16x64_bf16 v[76:79], v[212:215], v[132:139], v9
    v_max_u32 v4, v4, v5
    v_cmp_eq_u32 vcc, -1, v4
    v_smfmac_f32_16x16x64_bf16 v[80:83], v[212:215], v[164:171], v9
    s_cbranch_vccz .W_336
    s_branch .A_335
.A_359:
    buffer_load_dwordx4 v[216:219], v246, s[8:11], s32 offen offset:0 sc1
    buffer_load_dwordx4 v[220:223], v246, s[8:11], s32 offen offset:1024 sc1
    s_sub_u32 s62, s62, 1
    s_cbranch_scc1 .mg_end_1
    s_waitcnt vmcnt(2)
    v_max3_u32 v4, v200, v201, v202
    v_max3_u32 v5, v203, v204, v205
    v_max3_u32 v4, v4, v206, v207
    v_max_u32 v4, v4, v5
    v_cmp_eq_u32 vcc, -1, v4
    s_cbranch_vccz .W_348
.A_347:
    buffer_load_dwordx4 v[200:203], v252, s[8:11], s32 offen offset:0 sc1
    buffer_load_dwordx4 v[204:207], v252, s[8:11], s32 offen offset:1024 sc1
    s_waitcnt vmcnt(2)
    v_max3_u32 v4, v216, v217, v218
    v_max3_u32 v5, v219, v220, v221
    v_max3_u32 v4, v4, v222, v223
    v_max_u32 v4, v4, v5
    v_cmp_eq_u32 vcc, -1, v4
    s_cbranch_vccnz .A_359
    s_branch .W_360
.A_367:
    buffer_load_dwordx4 v[216:219], v246, s[8:11], s32 offen offset:0 sc1
    buffer_load_dwordx4 v[220:223], v246, s[8:11], s32 offen offset:1024 sc1
    s_sub_u32 s62, s62, 1
    s_cbranch_scc1 .mg_end_1
    s_waitcnt vmcnt(2)
    v_max3_u32 v4, v208, v209, v210
    v_max3_u32 v5, v211, v212, v213
    v_max3_u32 v4, v4, v214, v215
    v_max_u32 v4, v4, v5
    v_cmp_eq_u32 vcc, -1, v4
    s_cbranch_vccz .W_233
.A_232:
    buffer_load_dwordx4 v[208:211], v254, s[8:11], s32 offen offset:0 sc1
    buffer_load_dwordx4 v[212:215], v254, s[8:11], s32 offen offset:1024 sc1
    s_waitcnt vmcnt(2)
    v_max3_u32 v4, v216, v217, v218
    v_max3_u32 v5, v219, v220, v221
    v_max3_u32 v4, v4, v222, v223
    v_max_u32 v4, v4, v5
    v_cmp_eq_u32 vcc, -1, v4
    s_cbranch_vccnz .A_367
.W_368:
    v_smfmac_f32_16x16x64_bf16 v[76:79], v[216:219], v[140:147], v9
    v_smfmac_f32_16x16x64_bf16 v[80:83], v[216:219], v[172:179], v9
    s_waitcnt vmcnt(0)
    v_max3_u32 v4, v208, v209, v210
    v_max3_u32 v5, v211, v212, v213
    v_max3_u32 v4, v4, v214, v215
    v_smfmac_f32_16x16x64_bf16 v[76:79], v[220:223], v[148:155], v9
    v_max_u32 v4, v4, v5
    v_cmp_eq_u32 vcc, -1, v4
    v_smfmac_f32_16x16x64_bf16 v[80:83], v[220:223], v[180:187], v9
    s_cbranch_vccz .W_324
    s_branch .A_323
.A_329:
    buffer_load_dwordx4 v[192:195], v243, s[8:11], s32 offen offset:0 sc1
    buffer_load_dwordx4 v[196:199], v243, s[8:11], s32 offen offset:1024 sc1
    s_sub_u32 s62, s62, 1
    s_cbranch_scc1 .mg_end_1
    s_waitcnt vmcnt(2)
    v_max3_u32 v4, v192, v193, v194
    v_max3_u32 v5, v195, v196, v197
    v_max3_u32 v4, v4, v198, v199
    v_max_u32 v4, v4, v5
    v_cmp_eq_u32 vcc, -1, v4
    s_cbranch_vccnz .A_329
    v_smfmac_f32_16x16x64_bf16 v[76:79], v[192:195], a[192:199], v9
    v_smfmac_f32_16x16x64_bf16 v[80:83], v[192:195], a[224:231], v9
    v_smfmac_f32_16x16x64_bf16 v[76:79], v[196:199], a[200:207], v9
    v_smfmac_f32_16x16x64_bf16 v[80:83], v[196:199], a[232:239], v9
    s_branch .mj_227
.A_335:
    buffer_load_dwordx4 v[200:203], v252, s[8:11], s32 offen offset:0 sc1
    buffer_load_dwordx4 v[204:207], v252, s[8:11], s32 offen offset:1024 sc1
    s_sub_u32 s62, s62, 1
    s_cbranch_scc1 .mg_end_1
    s_waitcnt vmcnt(2)
    v_max3_u32 v4, v200, v201, v202
    v_max3_u32 v5, v203, v204, v205
    v_max3_u32 v4, v4, v206, v207
    v_max_u32 v4, v4, v5
    v_cmp_eq_u32 vcc, -1, v4
    s_cbranch_vccnz .A_335
    v_smfmac_f32_16x16x64_bf16 v[76:79], v[200:203], a[208:215], v9
    v_smfmac_f32_16x16x64_bf16 v[80:83], v[200:203], a[240:247], v9
    v_smfmac_f32_16x16x64_bf16 v[76:79], v[204:207], a[216:223], v9
    v_smfmac_f32_16x16x64_bf16 v[80:83], v[204:207], a[248:255], v9
    s_branch .mj_227
.A_323:
    buffer_load_dwordx4 v[208:211], v254, s[8:11], s32 offen offset:0 sc1
    buffer_load_dwordx4 v[212:215], v254, s[8:11], s32 offen offset:1024 sc1
    s_sub_u32 s62, s62, 1
    s_cbranch_scc1 .mg_end_1
    s_waitcnt vmcnt(2)
    v_max3_u32 v4, v208, v209, v210
    v_max3_u32 v5, v211, v212, v213
    v_max3_u32 v4, v4, v214, v215
    v_max_u32 v4, v4, v5
    v_cmp_eq_u32 vcc, -1, v4
    s_cbranch_vccnz .A_323
    v_smfmac_f32_16x16x64_bf16 v[76:79], v[208:211], v[124:131], v9
    v_smfmac_f32_16x16x64_bf16 v[80:83], v[208:211], v[156:163], v9
    v_smfmac_f32_16x16x64_bf16 v[76:79], v[212:215], v[132:139], v9
    v_smfmac_f32_16x16x64_bf16 v[80:83], v[212:215], v[164:171], v9
    s_branch .mj_227
.A_234:
    buffer_load_dwordx4 v[216:219], v246, s[8:11], s32 offen offset:0 sc1
    buffer_load_dwordx4 v[220:223], v246, s[8:11], s32 offen offset:1024 sc1
    s_sub_u32 s62, s62, 1
    s_cbranch_scc1 .mg_end_1
    s_waitcnt vmcnt(2)
    v_max3_u32 v4, v216, v217, v218
    v_max3_u32 v5, v219, v220, v221
    v_max3_u32 v4, v4, v222, v223
    v_max_u32 v4, v4, v5
    v_cmp_eq_u32 vcc, -1, v4
    s_cbranch_vccnz .A_234
    v_smfmac_f32_16x16x64_bf16 v[76:79], v[216:219], v[140:147], v9
    v_smfmac_f32_16x16x64_bf16 v[80:83], v[216:219], v[172:179], v9
    v_smfmac_f32_16x16x64_bf16 v[76:79], v[220:223], v[148:155], v9
    v_smfmac_f32_16x16x64_bf16 v[80:83], v[220:223], v[180:187], v9
    s_branch .mj_227
.sk_236:
    s_mov_b64 exec, s[66:67]
    buffer_store_dwordx4 v[88:91], v11, s[8:11], s36 offen sc1
    s_mov_b64 exec, s[56:57]
    buffer_store_dwordx4 v[172:175], v12, s[8:11], s36 offen sc1
    s_mov_b64 exec, -1

    s_branch .rec_fin_6
.rec_fin_6:
    s_mov_b64 exec, -1
    s_endpgm
.mg_bg_2:
    s_sub_u32 s91, s25, 4
    s_lshl_b32 s90, s91, 5
    s_add_u32 s90, s90, s26
    s_cmp_ge_u32 s26, 24
    s_cbranch_scc1 .cvrole_369
    s_lshr_b32 s30, s26, 3
    s_sub_u32 s30, 2, s30
    s_and_b32 s31, s26, 7
    s_lshl_b32 s4, s91, 3
    s_add_u32 s31, s31, s4

    s_lshl_b32 s4, s30, 5
    s_add_u32 s4, s4, s31
    s_lshl_b32 s4, s4, 8
    s_add_u32 s4, s4, 92274688
    v_mov_b32 v4, 0
    s_mov_b64 exec, 1
    buffer_store_dword v4, v4, s[8:11], s4 offen sc1
    s_mov_b64 exec, -1

    s_load_dwordx2 s[40:41], s[0:1], 0
    s_load_dwordx4 s[44:47], s[0:1], 64
    s_load_dwordx2 s[42:43], s[0:1], 80

    v_and_b32 v1, 63, v0
    v_and_b32 v2, 15, v1
    v_lshrrev_b32 v3, 4, v1

    s_lshl_b32 s28, s31, 8
    s_waitcnt lgkmcnt(0)
    s_mov_b64 s[48:49], s[42:43]
    s_cmp_eq_u32 s30, 0
    s_cselect_b64 s[42:43], s[44:45], s[42:43]
    s_cmp_eq_u32 s30, 1
    s_cselect_b64 s[42:43], s[46:47], s[42:43]

    s_mov_b32 s16, s40
    s_and_b32 s17, s41, 0xffff
    s_mov_b32 s18, 0x400000
    s_mov_b32 s19, 0x00020000

    s_mov_b32 s12, s42
    s_and_b32 s13, s43, 0xffff
    s_mov_b32 s14, 0x800000
    s_mov_b32 s15, 0x00020000

    v_lshrrev_b32 v4, 1, v2
    v_xor_b32 v4, v4, v3
    v_lshlrev_b32 v4, 1, v4
    v_and_b32 v5, 1, v1
    v_or_b32 v4, v4, v5
    v_lshlrev_b32 v4, 4, v4
    v_lshlrev_b32 v5, 13, v3
    v_add_u32 v10, v4, v5
    v_xor_b32 v11, 0x80, v10
    s_lshl_b32 s4, s24, 18
    s_add_u32 s28, s28, s4
    s_lshl_b32 s29, s24, 13
    v_lshrrev_b32 v4, 2, v2
    v_and_b32 v5, 1, v3
    v_lshl_or_b32 v5, v5, 2, v4
    s_lshl_b32 s4, s24, 1
    v_xor_b32 v5, s4, v5
    v_lshlrev_b32 v5, 5, v5
    v_lshl_add_u32 v4, v3, 3, v4
    v_lshl_add_u32 v5, v4, 8, v5
    v_and_b32 v4, 3, v2
    v_lshl_add_u32 v12, v4, 3, v5
    v_xor_b32 v13, 32, v12
    v_add_u32 v14, 0x10000, v12
    v_add_u32 v15, 0x10000, v13

    s_mov_b32 s63, 0
    s_cmp_lg_u32 s30, 0
    s_cbranch_scc1 .qh_370
    s_cmp_lt_u32 s24, 2
    s_cselect_b64 s[48:49], s[46:47], s[48:49]

    s_mov_b32 s64, s48
    s_and_b32 s65, s49, 0xffff
    s_mov_b32 s66, 0x800000
    s_mov_b32 s67, 0x00020000

    v_lshlrev_b32 v4, 13, v1
    s_and_b32 s4, s24, 1
    s_lshl_b32 s4, s4, 7
    s_lshl_b32 s5, s31, 8
    s_add_u32 s4, s4, s5
    s_add_u32 s4, s4, 4194304
    s_waitcnt vmcnt(0)

    v_mov_b32 v243, s99
    v_mov_b32 v242, 0
    s_cmp_lg_u32 s24, 0
    s_cbranch_scc1 .a1_371
    s_mov_b64 exec, 1
    buffer_atomic_add v243, v242, s[20:23], s97 offen sc1
    s_mov_b64 exec, -1

.a1_371:
    buffer_load_dword v31, v4, s[64:67], s4 offen
    s_add_u32 s4, s4, 524288
    buffer_load_dword v31, v4, s[64:67], s4 offen
    s_add_u32 s4, s4, 524288
    buffer_load_dword v31, v4, s[64:67], s4 offen
    s_add_u32 s4, s4, 524288
    buffer_load_dword v31, v4, s[64:67], s4 offen
    s_add_u32 s4, s4, 524288
    buffer_load_dword v31, v4, s[64:67], s4 offen
    s_add_u32 s4, s4, 524288
    buffer_load_dword v31, v4, s[64:67], s4 offen
    s_add_u32 s4, s4, 524288
    buffer_load_dword v31, v4, s[64:67], s4 offen
    s_add_u32 s4, s4, 524288
    buffer_load_dword v31, v4, s[64:67], s4 offen
    s_add_u32 s4, s4, 524288
    s_waitcnt vmcnt(0)
    s_mov_b32 s63, 99
.qh_370:
    s_and_b32 s4, s26, 7
    s_lshl_b32 s4, s4, 1
    s_lshr_b32 s5, s24, 1
    s_add_u32 s4, s4, s5
    s_lshl_b32 s4, s4, 6
    v_add_u32 v4, s4, v1
    v_lshlrev_b32 v4, 13, v4
    s_and_b32 s4, s24, 1
    s_lshl_b32 s4, s4, 10
    s_lshl_b32 s5, s91, 11
    s_add_u32 s4, s4, s5
    buffer_load_dword v31, v4, s[12:15], s4 offen offset:384

    s_add_u32 m0, s29, 0
    s_add_u32 s4, s28, 0
    buffer_load_dwordx4 v10, s[12:15], s4 offen lds

    s_add_u32 m0, s29, 1024
    s_add_u32 s4, s28, 32768
    buffer_load_dwordx4 v10, s[12:15], s4 offen lds

    s_add_u32 m0, s29, 2048
    s_add_u32 s4, s28, 65536
    buffer_load_dwordx4 v11, s[12:15], s4 offen lds

    s_add_u32 m0, s29, 3072
    s_add_u32 s4, s28, 98304
    buffer_load_dwordx4 v11, s[12:15], s4 offen lds

    s_add_u32 m0, s29, 4096
    s_add_u32 s4, s28, 131072
    buffer_load_dwordx4 v10, s[12:15], s4 offen lds

    s_add_u32 m0, s29, 5120
    s_add_u32 s4, s28, 163840
    buffer_load_dwordx4 v10, s[12:15], s4 offen lds

    s_add_u32 m0, s29, 6144
    s_add_u32 s4, s28, 196608
    buffer_load_dwordx4 v11, s[12:15], s4 offen lds

    s_add_u32 m0, s29, 7168
    s_add_u32 s4, s28, 229376
    buffer_load_dwordx4 v11, s[12:15], s4 offen lds

    s_waitcnt vmcnt(9)
    v_mov_b32 v243, s99
    v_mov_b32 v242, 0
    s_cmp_lg_u32 s24, s63
    s_cbranch_scc1 .a1_373
    s_mov_b64 exec, 1
    buffer_atomic_add v243, v242, s[20:23], s97 offen sc1
    s_mov_b64 exec, -1

.a1_373:
    s_add_u32 m0, s29, 32768
    s_add_u32 s4, s28, 1048576
    buffer_load_dwordx4 v10, s[12:15], s4 offen lds

    s_add_u32 m0, s29, 33792
    s_add_u32 s4, s28, 1081344
    buffer_load_dwordx4 v10, s[12:15], s4 offen lds

    s_add_u32 m0, s29, 34816
    s_add_u32 s4, s28, 1114112
    buffer_load_dwordx4 v11, s[12:15], s4 offen lds

    s_add_u32 m0, s29, 35840
    s_add_u32 s4, s28, 1146880
    buffer_load_dwordx4 v11, s[12:15], s4 offen lds

    s_add_u32 m0, s29, 36864
    s_add_u32 s4, s28, 1179648
    buffer_load_dwordx4 v10, s[12:15], s4 offen lds

    s_add_u32 m0, s29, 37888
    s_add_u32 s4, s28, 1212416
    buffer_load_dwordx4 v10, s[12:15], s4 offen lds

    s_add_u32 m0, s29, 38912
    s_add_u32 s4, s28, 1245184
    buffer_load_dwordx4 v11, s[12:15], s4 offen lds

    s_add_u32 m0, s29, 39936
    s_add_u32 s4, s28, 1277952
    buffer_load_dwordx4 v11, s[12:15], s4 offen lds

    s_add_u32 m0, s29, 65536
    s_add_u32 s4, s28, 2097152
    buffer_load_dwordx4 v10, s[12:15], s4 offen lds

    s_add_u32 m0, s29, 66560
    s_add_u32 s4, s28, 2129920
    buffer_load_dwordx4 v10, s[12:15], s4 offen lds

    s_add_u32 m0, s29, 67584
    s_add_u32 s4, s28, 2162688
    buffer_load_dwordx4 v11, s[12:15], s4 offen lds

    s_add_u32 m0, s29, 68608
    s_add_u32 s4, s28, 2195456
    buffer_load_dwordx4 v11, s[12:15], s4 offen lds

    s_add_u32 m0, s29, 69632
    s_add_u32 s4, s28, 2228224
    buffer_load_dwordx4 v10, s[12:15], s4 offen lds

    s_add_u32 m0, s29, 70656
    s_add_u32 s4, s28, 2260992
    buffer_load_dwordx4 v10, s[12:15], s4 offen lds

    s_add_u32 m0, s29, 71680
    s_add_u32 s4, s28, 2293760
    buffer_load_dwordx4 v11, s[12:15], s4 offen lds

    s_add_u32 m0, s29, 72704
    s_add_u32 s4, s28, 2326528
    buffer_load_dwordx4 v11, s[12:15], s4 offen lds

    s_add_u32 m0, s29, 98304
    s_add_u32 s4, s28, 3145728
    buffer_load_dwordx4 v10, s[12:15], s4 offen lds

    s_add_u32 m0, s29, 99328
    s_add_u32 s4, s28, 3178496
    buffer_load_dwordx4 v10, s[12:15], s4 offen lds

    s_add_u32 m0, s29, 100352
    s_add_u32 s4, s28, 3211264
    buffer_load_dwordx4 v11, s[12:15], s4 offen lds

    s_add_u32 m0, s29, 101376
    s_add_u32 s4, s28, 3244032
    buffer_load_dwordx4 v11, s[12:15], s4 offen lds

    s_add_u32 m0, s29, 102400
    s_add_u32 s4, s28, 3276800
    buffer_load_dwordx4 v10, s[12:15], s4 offen lds

    s_add_u32 m0, s29, 103424
    s_add_u32 s4, s28, 3309568
    buffer_load_dwordx4 v10, s[12:15], s4 offen lds

    s_add_u32 m0, s29, 104448
    s_add_u32 s4, s28, 3342336
    buffer_load_dwordx4 v11, s[12:15], s4 offen lds

    s_add_u32 m0, s29, 105472
    s_add_u32 s4, s28, 3375104
    buffer_load_dwordx4 v11, s[12:15], s4 offen lds

    v_lshrrev_b32 v4, 3, v1
    v_and_b32 v5, 7, v1
    v_xor_b32 v5, v5, v4
    v_lshlrev_b32 v5, 4, v5
    v_lshl_add_u32 v16, v4, 11, v5
    s_lshl_b32 s4, s24, 14
    v_add_u32 v16, s4, v16
    v_and_b32 v4, 7, v2
    v_xor_b32 v5, v4, v3
    v_lshlrev_b32 v5, 4, v5
    v_lshl_add_u32 v5, v4, 7, v5
    v_lshrrev_b32 v4, 3, v2
    v_lshl_add_u32 v17, v4, 13, v5
    v_xor_b32 v18, 64, v17
    v_add_u32 v19, 0x10000, v17
    v_add_u32 v20, 0x10000, v18
    v_lshlrev_b32 v21, 4, v1
    s_lshl_b32 s32, s30, 24
    s_lshl_b32 s4, s31, 13
    s_add_u32 s32, s32, s4
    s_lshr_b32 s5, s30, 1
    s_add_u32 s5, s5, 10
    s_lshl_b32 s4, s24, s5
    s_add_u32 s39, s32, s4
    s_mov_b32 s32, s39
    s_add_u32 s38, s39, 4096
    s_mul_i32 s49, s31, 6144
    s_lshl_b32 s4, s30, 11
    s_add_u32 s49, s49, s4
    s_lshl_b32 s4, s24, 9
    s_add_u32 s49, s49, s4
    s_add_u32 s49, s49, 67108864
    s_mov_b32 s48, s49
    v_mov_b32 v23, -1
    s_lshl_b32 s4, s30, 5
    s_add_u32 s4, s4, s31
    s_lshl_b32 s4, s4, 8
    s_add_u32 s33, s4, 92274688
    s_cmp_eq_u32 s24, 0
    s_cselect_b32 s36, 1, 0
    s_mov_b32 s37, 0
    v_mov_b32 v22, 0
    s_mov_b32 s34, 0
    s_mov_b32 s35, 0
    s_and_b32 s4, s26, 7
    s_lshl_b32 s4, s4, 2
    s_add_u32 s4, s4, s24
    s_lshl_b32 s4, s4, 11
    v_lshlrev_b32 v111, 5, v1
    v_add_u32 v111, s4, v111

    s_mul_i32 s47, s26, 1441792
    s_lshl_b32 s4, s24, 10
    s_add_u32 s47, s47, s4
    s_add_u32 s47, s47, 184549376
    v_mov_b32 v24, -1
    v_mov_b32 v25, -1
    v_mov_b32 v26, -1
    v_mov_b32 v27, -1

    s_xor_b32 s4, s91, 1
    s_lshl_b32 s5, s4, 14
    s_lshl_b32 s6, s91, 12
    s_add_u32 s5, s5, s6
    v_add_u32 v28, s5, v21
    s_lshl_b32 s5, s91, 14
    s_lshl_b32 s6, s4, 12
    s_add_u32 s5, s5, s6
    v_add_u32 v7, s5, v21

    s_xor_b32 s4, s91, 2
    s_lshl_b32 s5, s4, 14
    s_lshl_b32 s6, s91, 12
    s_add_u32 s5, s5, s6
    v_add_u32 v29, s5, v21
    s_lshl_b32 s5, s91, 14
    s_lshl_b32 s6, s4, 12
    s_add_u32 s5, s5, s6
    v_add_u32 v8, s5, v21

    s_xor_b32 s4, s91, 3
    s_lshl_b32 s5, s4, 14
    s_lshl_b32 s6, s91, 12
    s_add_u32 s5, s5, s6
    v_add_u32 v30, s5, v21
    s_lshl_b32 s5, s91, 14
    s_lshl_b32 s6, s4, 12
    s_add_u32 s5, s5, s6
    v_add_u32 v9, s5, v21

    s_mov_b64 s[44:45], -1
    s_mov_b32 s46, s47
    s_waitcnt vmcnt(24)
    s_barrier
    ds_read_b64_tr_b16 a[0:1], v12 offset:0
    ds_read_b64_tr_b16 a[2:3], v12 offset:1024
    ds_read_b64_tr_b16 a[4:5], v13 offset:0
    ds_read_b64_tr_b16 a[6:7], v13 offset:1024
    ds_read_b64_tr_b16 a[8:9], v12 offset:8192
    ds_read_b64_tr_b16 a[10:11], v12 offset:9216
    ds_read_b64_tr_b16 a[12:13], v13 offset:8192
    ds_read_b64_tr_b16 a[14:15], v13 offset:9216
    ds_read_b64_tr_b16 a[16:17], v12 offset:16384
    ds_read_b64_tr_b16 a[18:19], v12 offset:17408
    ds_read_b64_tr_b16 a[20:21], v13 offset:16384
    ds_read_b64_tr_b16 a[22:23], v13 offset:17408
    ds_read_b64_tr_b16 a[24:25], v12 offset:24576
    ds_read_b64_tr_b16 a[26:27], v12 offset:25600
    ds_read_b64_tr_b16 a[28:29], v13 offset:24576
    ds_read_b64_tr_b16 a[30:31], v13 offset:25600
    s_waitcnt lgkmcnt(0)
    s_barrier
    s_add_u32 m0, s29, 0
    s_add_u32 s4, s28, 4194304
    buffer_load_dwordx4 v10, s[12:15], s4 offen lds

    s_add_u32 m0, s29, 1024
    s_add_u32 s4, s28, 4227072
    buffer_load_dwordx4 v10, s[12:15], s4 offen lds

    s_add_u32 m0, s29, 2048
    s_add_u32 s4, s28, 4259840
    buffer_load_dwordx4 v11, s[12:15], s4 offen lds

    s_add_u32 m0, s29, 3072
    s_add_u32 s4, s28, 4292608
    buffer_load_dwordx4 v11, s[12:15], s4 offen lds

    s_add_u32 m0, s29, 4096
    s_add_u32 s4, s28, 4325376
    buffer_load_dwordx4 v10, s[12:15], s4 offen lds

    s_add_u32 m0, s29, 5120
    s_add_u32 s4, s28, 4358144
    buffer_load_dwordx4 v10, s[12:15], s4 offen lds

    s_add_u32 m0, s29, 6144
    s_add_u32 s4, s28, 4390912
    buffer_load_dwordx4 v11, s[12:15], s4 offen lds

    s_add_u32 m0, s29, 7168
    s_add_u32 s4, s28, 4423680
    buffer_load_dwordx4 v11, s[12:15], s4 offen lds

    s_waitcnt vmcnt(24)
    s_barrier
    ds_read_b64_tr_b16 a[32:33], v12 offset:32768
    ds_read_b64_tr_b16 a[34:35], v12 offset:33792
    ds_read_b64_tr_b16 a[36:37], v13 offset:32768
    ds_read_b64_tr_b16 a[38:39], v13 offset:33792
    ds_read_b64_tr_b16 a[40:41], v12 offset:40960
    ds_read_b64_tr_b16 a[42:43], v12 offset:41984
    ds_read_b64_tr_b16 a[44:45], v13 offset:40960
    ds_read_b64_tr_b16 a[46:47], v13 offset:41984
    ds_read_b64_tr_b16 a[48:49], v12 offset:49152
    ds_read_b64_tr_b16 a[50:51], v12 offset:50176
    ds_read_b64_tr_b16 a[52:53], v13 offset:49152
    ds_read_b64_tr_b16 a[54:55], v13 offset:50176
    ds_read_b64_tr_b16 a[56:57], v12 offset:57344
    ds_read_b64_tr_b16 a[58:59], v12 offset:58368
    ds_read_b64_tr_b16 a[60:61], v13 offset:57344
    ds_read_b64_tr_b16 a[62:63], v13 offset:58368
    s_waitcnt lgkmcnt(0)
    s_barrier
    s_add_u32 m0, s29, 32768
    s_add_u32 s4, s28, 5242880
    buffer_load_dwordx4 v10, s[12:15], s4 offen lds

    s_add_u32 m0, s29, 33792
    s_add_u32 s4, s28, 5275648
    buffer_load_dwordx4 v10, s[12:15], s4 offen lds

    s_add_u32 m0, s29, 34816
    s_add_u32 s4, s28, 5308416
    buffer_load_dwordx4 v11, s[12:15], s4 offen lds

    s_add_u32 m0, s29, 35840
    s_add_u32 s4, s28, 5341184
    buffer_load_dwordx4 v11, s[12:15], s4 offen lds

    s_add_u32 m0, s29, 36864
    s_add_u32 s4, s28, 5373952
    buffer_load_dwordx4 v10, s[12:15], s4 offen lds

    s_add_u32 m0, s29, 37888
    s_add_u32 s4, s28, 5406720
    buffer_load_dwordx4 v10, s[12:15], s4 offen lds

    s_add_u32 m0, s29, 38912
    s_add_u32 s4, s28, 5439488
    buffer_load_dwordx4 v11, s[12:15], s4 offen lds

    s_add_u32 m0, s29, 39936
    s_add_u32 s4, s28, 5472256
    buffer_load_dwordx4 v11, s[12:15], s4 offen lds

    s_waitcnt vmcnt(24)
    s_barrier
    ds_read_b64_tr_b16 a[64:65], v14 offset:0
    ds_read_b64_tr_b16 a[66:67], v14 offset:1024
    ds_read_b64_tr_b16 a[68:69], v15 offset:0
    ds_read_b64_tr_b16 a[70:71], v15 offset:1024
    ds_read_b64_tr_b16 a[72:73], v14 offset:8192
    ds_read_b64_tr_b16 a[74:75], v14 offset:9216
    ds_read_b64_tr_b16 a[76:77], v15 offset:8192
    ds_read_b64_tr_b16 a[78:79], v15 offset:9216
    ds_read_b64_tr_b16 a[80:81], v14 offset:16384
    ds_read_b64_tr_b16 a[82:83], v14 offset:17408
    ds_read_b64_tr_b16 a[84:85], v15 offset:16384
    ds_read_b64_tr_b16 a[86:87], v15 offset:17408
    ds_read_b64_tr_b16 a[88:89], v14 offset:24576
    ds_read_b64_tr_b16 a[90:91], v14 offset:25600
    ds_read_b64_tr_b16 a[92:93], v15 offset:24576
    ds_read_b64_tr_b16 a[94:95], v15 offset:25600
    s_waitcnt lgkmcnt(0)
    s_barrier
    s_add_u32 m0, s29, 65536
    s_add_u32 s4, s28, 6291456
    buffer_load_dwordx4 v10, s[12:15], s4 offen lds

    s_add_u32 m0, s29, 66560
    s_add_u32 s4, s28, 6324224
    buffer_load_dwordx4 v10, s[12:15], s4 offen lds

    s_add_u32 m0, s29, 67584
    s_add_u32 s4, s28, 6356992
    buffer_load_dwordx4 v11, s[12:15], s4 offen lds

    s_add_u32 m0, s29, 68608
    s_add_u32 s4, s28, 6389760
    buffer_load_dwordx4 v11, s[12:15], s4 offen lds

    s_add_u32 m0, s29, 69632
    s_add_u32 s4, s28, 6422528
    buffer_load_dwordx4 v10, s[12:15], s4 offen lds

    s_add_u32 m0, s29, 70656
    s_add_u32 s4, s28, 6455296
    buffer_load_dwordx4 v10, s[12:15], s4 offen lds

    s_add_u32 m0, s29, 71680
    s_add_u32 s4, s28, 6488064
    buffer_load_dwordx4 v11, s[12:15], s4 offen lds

    s_add_u32 m0, s29, 72704
    s_add_u32 s4, s28, 6520832
    buffer_load_dwordx4 v11, s[12:15], s4 offen lds

    s_waitcnt vmcnt(24)
    s_barrier
    ds_read_b64_tr_b16 a[96:97], v14 offset:32768
    ds_read_b64_tr_b16 a[98:99], v14 offset:33792
    ds_read_b64_tr_b16 a[100:101], v15 offset:32768
    ds_read_b64_tr_b16 a[102:103], v15 offset:33792
    ds_read_b64_tr_b16 a[104:105], v14 offset:40960
    ds_read_b64_tr_b16 a[106:107], v14 offset:41984
    ds_read_b64_tr_b16 a[108:109], v15 offset:40960
    ds_read_b64_tr_b16 a[110:111], v15 offset:41984
    ds_read_b64_tr_b16 a[112:113], v14 offset:49152
    ds_read_b64_tr_b16 a[114:115], v14 offset:50176
    ds_read_b64_tr_b16 a[116:117], v15 offset:49152
    ds_read_b64_tr_b16 a[118:119], v15 offset:50176
    ds_read_b64_tr_b16 a[120:121], v14 offset:57344
    ds_read_b64_tr_b16 a[122:123], v14 offset:58368
    ds_read_b64_tr_b16 a[124:125], v15 offset:57344
    ds_read_b64_tr_b16 a[126:127], v15 offset:58368
    s_waitcnt lgkmcnt(0)
    s_barrier
    s_add_u32 m0, s29, 98304
    s_add_u32 s4, s28, 7340032
    buffer_load_dwordx4 v10, s[12:15], s4 offen lds

    s_add_u32 m0, s29, 99328
    s_add_u32 s4, s28, 7372800
    buffer_load_dwordx4 v10, s[12:15], s4 offen lds

    s_add_u32 m0, s29, 100352
    s_add_u32 s4, s28, 7405568
    buffer_load_dwordx4 v11, s[12:15], s4 offen lds

    s_add_u32 m0, s29, 101376
    s_add_u32 s4, s28, 7438336
    buffer_load_dwordx4 v11, s[12:15], s4 offen lds

    s_add_u32 m0, s29, 102400
    s_add_u32 s4, s28, 7471104
    buffer_load_dwordx4 v10, s[12:15], s4 offen lds

    s_add_u32 m0, s29, 103424
    s_add_u32 s4, s28, 7503872
    buffer_load_dwordx4 v10, s[12:15], s4 offen lds

    s_add_u32 m0, s29, 104448
    s_add_u32 s4, s28, 7536640
    buffer_load_dwordx4 v11, s[12:15], s4 offen lds

    s_add_u32 m0, s29, 105472
    s_add_u32 s4, s28, 7569408
    buffer_load_dwordx4 v11, s[12:15], s4 offen lds

    v_and_b32 v241, 3, v0
    v_lshlrev_b32 v241, 2, v241
    buffer_load_dword v240, v241, s[20:23], s97 offen sc1

    s_waitcnt vmcnt(25)
    s_barrier
    ds_read_b64_tr_b16 a[128:129], v12 offset:0
    ds_read_b64_tr_b16 a[130:131], v12 offset:1024
    ds_read_b64_tr_b16 a[132:133], v13 offset:0
    ds_read_b64_tr_b16 a[134:135], v13 offset:1024
    ds_read_b64_tr_b16 a[136:137], v12 offset:8192
    ds_read_b64_tr_b16 a[138:139], v12 offset:9216
    ds_read_b64_tr_b16 a[140:141], v13 offset:8192
    ds_read_b64_tr_b16 a[142:143], v13 offset:9216
    ds_read_b64_tr_b16 a[144:145], v12 offset:16384
    ds_read_b64_tr_b16 a[146:147], v12 offset:17408
    ds_read_b64_tr_b16 a[148:149], v13 offset:16384
    ds_read_b64_tr_b16 a[150:151], v13 offset:17408
    ds_read_b64_tr_b16 a[152:153], v12 offset:24576
    ds_read_b64_tr_b16 a[154:155], v12 offset:25600
    ds_read_b64_tr_b16 a[156:157], v13 offset:24576
    ds_read_b64_tr_b16 a[158:159], v13 offset:25600
    s_waitcnt lgkmcnt(0)
    s_barrier
    s_add_u32 m0, s29, 0
    s_nop 0
    buffer_load_dwordx4 v16, s[16:19], s34 offen offset:0 lds
    s_add_u32 m0, s29, 896
    s_nop 0
    buffer_load_dwordx4 v16, s[16:19], s34 offen offset:128 lds
    s_add_u32 m0, s29, 1792
    s_nop 0
    buffer_load_dwordx4 v16, s[16:19], s34 offen offset:256 lds
    s_add_u32 m0, s29, 2688
    s_nop 0
    buffer_load_dwordx4 v16, s[16:19], s34 offen offset:384 lds
    s_add_u32 m0, s29, 3584
    s_nop 0
    buffer_load_dwordx4 v16, s[16:19], s34 offen offset:512 lds
    s_add_u32 m0, s29, 4480
    s_nop 0
    buffer_load_dwordx4 v16, s[16:19], s34 offen offset:640 lds
    s_add_u32 m0, s29, 5376
    s_nop 0
    buffer_load_dwordx4 v16, s[16:19], s34 offen offset:768 lds
    s_add_u32 m0, s29, 6272
    s_nop 0
    buffer_load_dwordx4 v16, s[16:19], s34 offen offset:896 lds
    s_add_u32 s34, s34, 1024
    s_waitcnt vmcnt(25)
    s_barrier
    ds_read_b64_tr_b16 a[160:161], v12 offset:32768
    ds_read_b64_tr_b16 a[162:163], v12 offset:33792
    ds_read_b64_tr_b16 a[164:165], v13 offset:32768
    ds_read_b64_tr_b16 a[166:167], v13 offset:33792
    ds_read_b64_tr_b16 a[168:169], v12 offset:40960
    ds_read_b64_tr_b16 a[170:171], v12 offset:41984
    ds_read_b64_tr_b16 a[172:173], v13 offset:40960
    ds_read_b64_tr_b16 a[174:175], v13 offset:41984
    ds_read_b64_tr_b16 a[176:177], v12 offset:49152
    ds_read_b64_tr_b16 a[178:179], v12 offset:50176
    ds_read_b64_tr_b16 a[180:181], v13 offset:49152
    ds_read_b64_tr_b16 a[182:183], v13 offset:50176
    ds_read_b64_tr_b16 a[184:185], v12 offset:57344
    ds_read_b64_tr_b16 a[186:187], v12 offset:58368
    ds_read_b64_tr_b16 a[188:189], v13 offset:57344
    ds_read_b64_tr_b16 a[190:191], v13 offset:58368
    s_waitcnt lgkmcnt(0)
    s_barrier
    s_add_u32 m0, s29, 32768
    s_nop 0
    buffer_load_dwordx4 v16, s[16:19], s34 offen offset:0 lds
    s_add_u32 m0, s29, 33664
    s_nop 0
    buffer_load_dwordx4 v16, s[16:19], s34 offen offset:128 lds
    s_add_u32 m0, s29, 34560
    s_nop 0
    buffer_load_dwordx4 v16, s[16:19], s34 offen offset:256 lds
    s_add_u32 m0, s29, 35456
    s_nop 0
    buffer_load_dwordx4 v16, s[16:19], s34 offen offset:384 lds
    s_add_u32 m0, s29, 36352
    s_nop 0
    buffer_load_dwordx4 v16, s[16:19], s34 offen offset:512 lds
    s_add_u32 m0, s29, 37248
    s_nop 0
    buffer_load_dwordx4 v16, s[16:19], s34 offen offset:640 lds
    s_add_u32 m0, s29, 38144
    s_nop 0
    buffer_load_dwordx4 v16, s[16:19], s34 offen offset:768 lds
    s_add_u32 m0, s29, 39040
    s_nop 0
    buffer_load_dwordx4 v16, s[16:19], s34 offen offset:896 lds
    s_add_u32 s34, s34, 64512
    s_min_u32 s34, s34, 4128768
    s_waitcnt vmcnt(25)
    s_barrier
    ds_read_b64_tr_b16 a[192:193], v14 offset:0
    ds_read_b64_tr_b16 a[194:195], v14 offset:1024
    ds_read_b64_tr_b16 a[196:197], v15 offset:0
    ds_read_b64_tr_b16 a[198:199], v15 offset:1024
    ds_read_b64_tr_b16 a[200:201], v14 offset:8192
    ds_read_b64_tr_b16 a[202:203], v14 offset:9216
    ds_read_b64_tr_b16 a[204:205], v15 offset:8192
    ds_read_b64_tr_b16 a[206:207], v15 offset:9216
    ds_read_b64_tr_b16 a[208:209], v14 offset:16384
    ds_read_b64_tr_b16 a[210:211], v14 offset:17408
    ds_read_b64_tr_b16 a[212:213], v15 offset:16384
    ds_read_b64_tr_b16 a[214:215], v15 offset:17408
    ds_read_b64_tr_b16 a[216:217], v14 offset:24576
    ds_read_b64_tr_b16 a[218:219], v14 offset:25600
    ds_read_b64_tr_b16 a[220:221], v15 offset:24576
    ds_read_b64_tr_b16 a[222:223], v15 offset:25600
    s_waitcnt lgkmcnt(0)
    s_barrier
    s_add_u32 m0, s29, 65536
    s_nop 0
    buffer_load_dwordx4 v16, s[16:19], s34 offen offset:0 lds
    s_add_u32 m0, s29, 66432
    s_nop 0
    buffer_load_dwordx4 v16, s[16:19], s34 offen offset:128 lds
    s_add_u32 m0, s29, 67328
    s_nop 0
    buffer_load_dwordx4 v16, s[16:19], s34 offen offset:256 lds
    s_add_u32 m0, s29, 68224
    s_nop 0
    buffer_load_dwordx4 v16, s[16:19], s34 offen offset:384 lds
    s_add_u32 m0, s29, 69120
    s_nop 0
    buffer_load_dwordx4 v16, s[16:19], s34 offen offset:512 lds
    s_add_u32 m0, s29, 70016
    s_nop 0
    buffer_load_dwordx4 v16, s[16:19], s34 offen offset:640 lds
    s_add_u32 m0, s29, 70912
    s_nop 0
    buffer_load_dwordx4 v16, s[16:19], s34 offen offset:768 lds
    s_add_u32 m0, s29, 71808
    s_nop 0
    buffer_load_dwordx4 v16, s[16:19], s34 offen offset:896 lds
    s_add_u32 s34, s34, 1024
    s_waitcnt vmcnt(24)
    s_barrier
    ds_read_b64_tr_b16 a[224:225], v14 offset:32768
    ds_read_b64_tr_b16 a[226:227], v14 offset:33792
    ds_read_b64_tr_b16 a[228:229], v15 offset:32768
    ds_read_b64_tr_b16 a[230:231], v15 offset:33792
    ds_read_b64_tr_b16 a[232:233], v14 offset:40960
    ds_read_b64_tr_b16 a[234:235], v14 offset:41984
    ds_read_b64_tr_b16 a[236:237], v15 offset:40960
    ds_read_b64_tr_b16 a[238:239], v15 offset:41984
    ds_read_b64_tr_b16 a[240:241], v14 offset:49152
    ds_read_b64_tr_b16 a[242:243], v14 offset:50176
    ds_read_b64_tr_b16 a[244:245], v15 offset:49152
    ds_read_b64_tr_b16 a[246:247], v15 offset:50176
    ds_read_b64_tr_b16 a[248:249], v14 offset:57344
    ds_read_b64_tr_b16 a[250:251], v14 offset:58368
    ds_read_b64_tr_b16 a[252:253], v15 offset:57344
    ds_read_b64_tr_b16 a[254:255], v15 offset:58368
    s_mov_b32 s62, 0
.vp_375:
    v_readlane_b32 s4, v240, 0
    v_readlane_b32 s7, v240, 1
    v_readlane_b32 s6, v240, 2

    s_cmp_ge_u32 s4, 256
    s_cbranch_scc1 .vd_376
    s_cmp_lg_u32 s6, 0
    s_cbranch_scc1 .vs_377
    s_add_u32 s62, s62, 1
    s_cmp_gt_u32 s62, 0x100000
    s_cbranch_scc1 .mg_end_1
    s_sleep 8
    buffer_load_dword v240, v241, s[20:23], s97 offen sc1
    s_waitcnt vmcnt(0)
    s_branch .vp_375

.vs_377:
    s_lshr_b32 s25, s2, 5
    s_and_b32 s26, s2, 31
    s_mov_b32 s27, 1
    s_mov_b32 s99, 1
    s_mov_b32 s97, 144
    s_waitcnt vmcnt(0) lgkmcnt(0)
    s_barrier
    s_branch .mg_role_3

.vd_376:
    s_waitcnt lgkmcnt(0)
    s_barrier
    s_cmp_eq_u32 s30, 2
    s_cbranch_scc1 .qv_378
    s_waitcnt vmcnt(16)
    s_barrier
    ds_read_b128 v[32:35], v17 offset:0
    ds_read_b128 v[36:39], v17 offset:16384
    ds_read_b128 v[40:43], v18 offset:0
    ds_read_b128 v[44:47], v18 offset:16384
    s_add_u32 m0, s29, 98304
    s_nop 0
    buffer_load_dwordx4 v16, s[16:19], s34 offen offset:0 lds
    ds_read_b128 v[48:51], v17 offset:1024
    ds_read_b128 v[52:55], v17 offset:17408
    s_branch .qe_381
.p2align 6
.ql_380:
.qe_381:
    s_waitcnt lgkmcnt(4)
    v_mfma_f32_16x16x32_bf16 v[64:67], a[0:3], v[32:35], 0
    ds_read_b128 v[56:59], v18 offset:1024
    s_add_u32 m0, s29, 99200
    v_mfma_f32_16x16x32_bf16 v[68:71], a[4:7], v[32:35], 0
    buffer_load_dwordx4 v16, s[16:19], s34 offen offset:128 lds
    v_mfma_f32_16x16x32_bf16 v[72:75], a[0:3], v[36:39], 0
    ds_read_b128 v[60:63], v18 offset:17408
    v_mfma_f32_16x16x32_bf16 v[76:79], a[4:7], v[36:39], 0
    s_waitcnt lgkmcnt(4)
    v_mfma_f32_16x16x32_bf16 v[64:67], a[8:11], v[40:43], v[64:67]
    ds_read_b128 v[32:35], v17 offset:2048
    v_mfma_f32_16x16x32_bf16 v[68:71], a[12:15], v[40:43], v[68:71]
    v_cvt_pk_bf16_f32 v96, v80, v81
    v_cvt_pk_bf16_f32 v97, v82, v83
    v_mfma_f32_16x16x32_bf16 v[72:75], a[8:11], v[44:47], v[72:75]
    ds_read_b128 v[36:39], v17 offset:18432
    v_mfma_f32_16x16x32_bf16 v[76:79], a[12:15], v[44:47], v[76:79]
    v_cvt_pk_bf16_f32 v98, v84, v85
    v_cvt_pk_bf16_f32 v99, v86, v87
    s_waitcnt lgkmcnt(4)
    v_mfma_f32_16x16x32_bf16 v[64:67], a[16:19], v[48:51], v[64:67]
    ds_read_b128 v[40:43], v18 offset:2048
    s_add_u32 m0, s29, 100096
    v_mfma_f32_16x16x32_bf16 v[68:71], a[20:23], v[48:51], v[68:71]
    buffer_load_dwordx4 v16, s[16:19], s34 offen offset:256 lds
    v_mfma_f32_16x16x32_bf16 v[72:75], a[16:19], v[52:55], v[72:75]
    ds_read_b128 v[44:47], v18 offset:18432
    v_mfma_f32_16x16x32_bf16 v[76:79], a[20:23], v[52:55], v[76:79]
    s_waitcnt lgkmcnt(4)
    v_mfma_f32_16x16x32_bf16 v[64:67], a[24:27], v[56:59], v[64:67]
    ds_read_b128 v[48:51], v17 offset:3072
    v_mfma_f32_16x16x32_bf16 v[68:71], a[28:31], v[56:59], v[68:71]
    buffer_store_dwordx4 v[96:99], v21, s[8:11], s32 offen sc1
    v_mfma_f32_16x16x32_bf16 v[72:75], a[24:27], v[60:63], v[72:75]
    ds_read_b128 v[52:55], v17 offset:19456
    v_mfma_f32_16x16x32_bf16 v[76:79], a[28:31], v[60:63], v[76:79]
    s_waitcnt lgkmcnt(4)
    v_mfma_f32_16x16x32_bf16 v[64:67], a[32:35], v[32:35], v[64:67]
    ds_read_b128 v[56:59], v18 offset:3072
    s_add_u32 m0, s29, 100992
    v_mfma_f32_16x16x32_bf16 v[68:71], a[36:39], v[32:35], v[68:71]
    buffer_load_dwordx4 v16, s[16:19], s34 offen offset:384 lds
    v_mfma_f32_16x16x32_bf16 v[72:75], a[32:35], v[36:39], v[72:75]
    ds_read_b128 v[60:63], v18 offset:19456
    v_mfma_f32_16x16x32_bf16 v[76:79], a[36:39], v[36:39], v[76:79]
    s_waitcnt lgkmcnt(4)
    v_mfma_f32_16x16x32_bf16 v[64:67], a[40:43], v[40:43], v[64:67]
    ds_read_b128 v[32:35], v17 offset:4096
    v_mfma_f32_16x16x32_bf16 v[68:71], a[44:47], v[40:43], v[68:71]
    v_cvt_pk_bf16_f32 v100, v88, v89
    v_cvt_pk_bf16_f32 v101, v90, v91
    v_mfma_f32_16x16x32_bf16 v[72:75], a[40:43], v[44:47], v[72:75]
    ds_read_b128 v[36:39], v17 offset:20480
    v_mfma_f32_16x16x32_bf16 v[76:79], a[44:47], v[44:47], v[76:79]
    v_cvt_pk_bf16_f32 v102, v92, v93
    v_cvt_pk_bf16_f32 v103, v94, v95
    s_waitcnt lgkmcnt(4)
    v_mfma_f32_16x16x32_bf16 v[64:67], a[48:51], v[48:51], v[64:67]
    ds_read_b128 v[40:43], v18 offset:4096
    s_add_u32 m0, s29, 101888
    v_mfma_f32_16x16x32_bf16 v[68:71], a[52:55], v[48:51], v[68:71]
    buffer_load_dwordx4 v16, s[16:19], s34 offen offset:512 lds
    v_mfma_f32_16x16x32_bf16 v[72:75], a[48:51], v[52:55], v[72:75]
    ds_read_b128 v[44:47], v18 offset:20480
    v_mfma_f32_16x16x32_bf16 v[76:79], a[52:55], v[52:55], v[76:79]
    s_waitcnt lgkmcnt(4)
    v_mfma_f32_16x16x32_bf16 v[64:67], a[56:59], v[56:59], v[64:67]
    ds_read_b128 v[48:51], v17 offset:5120
    v_mfma_f32_16x16x32_bf16 v[68:71], a[60:63], v[56:59], v[68:71]
    buffer_store_dwordx4 v[100:103], v21, s[8:11], s38 offen sc1
    v_mfma_f32_16x16x32_bf16 v[72:75], a[56:59], v[60:63], v[72:75]
    ds_read_b128 v[52:55], v17 offset:21504
    v_mfma_f32_16x16x32_bf16 v[76:79], a[60:63], v[60:63], v[76:79]
    s_waitcnt lgkmcnt(4)
    v_mfma_f32_16x16x32_bf16 v[64:67], a[64:67], v[32:35], v[64:67]
    ds_read_b128 v[56:59], v18 offset:5120
    s_add_u32 m0, s29, 102784
    v_mfma_f32_16x16x32_bf16 v[68:71], a[68:71], v[32:35], v[68:71]
    buffer_load_dwordx4 v16, s[16:19], s34 offen offset:640 lds
    v_mfma_f32_16x16x32_bf16 v[72:75], a[64:67], v[36:39], v[72:75]
    ds_read_b128 v[60:63], v18 offset:21504
    v_mfma_f32_16x16x32_bf16 v[76:79], a[68:71], v[36:39], v[76:79]
    s_mov_b32 exec_hi, 0
    buffer_store_dwordx4 v[24:27], v21, s[8:11], s48 offen sc1
    s_mov_b32 exec_hi, -1

    s_waitcnt lgkmcnt(4)
    v_mfma_f32_16x16x32_bf16 v[64:67], a[72:75], v[40:43], v[64:67]
    ds_read_b128 v[32:35], v17 offset:6144
    v_mfma_f32_16x16x32_bf16 v[68:71], a[76:79], v[40:43], v[68:71]
    s_mov_b32 s32, s39
    s_add_u32 s38, s39, 4096
    s_add_u32 s39, s39, 262144
    s_mov_b32 s48, s49
    s_add_u32 s49, s49, 196608
    v_mfma_f32_16x16x32_bf16 v[72:75], a[72:75], v[44:47], v[72:75]
    ds_read_b128 v[36:39], v17 offset:22528
    v_mfma_f32_16x16x32_bf16 v[76:79], a[76:79], v[44:47], v[76:79]
    v_add_u32 v23, 1, v23
    s_waitcnt lgkmcnt(4)
    v_mfma_f32_16x16x32_bf16 v[64:67], a[80:83], v[48:51], v[64:67]
    ds_read_b128 v[40:43], v18 offset:6144
    s_add_u32 m0, s29, 103680
    v_mfma_f32_16x16x32_bf16 v[68:71], a[84:87], v[48:51], v[68:71]
    buffer_load_dwordx4 v16, s[16:19], s34 offen offset:768 lds
    v_mfma_f32_16x16x32_bf16 v[72:75], a[80:83], v[52:55], v[72:75]
    ds_read_b128 v[44:47], v18 offset:22528
    v_mfma_f32_16x16x32_bf16 v[76:79], a[84:87], v[52:55], v[76:79]
    s_waitcnt lgkmcnt(4)
    v_mfma_f32_16x16x32_bf16 v[64:67], a[88:91], v[56:59], v[64:67]
    ds_read_b128 v[48:51], v17 offset:7168
    v_mfma_f32_16x16x32_bf16 v[68:71], a[92:95], v[56:59], v[68:71]
    v_mfma_f32_16x16x32_bf16 v[72:75], a[88:91], v[60:63], v[72:75]
    ds_read_b128 v[52:55], v17 offset:23552
    v_mfma_f32_16x16x32_bf16 v[76:79], a[92:95], v[60:63], v[76:79]
    s_mov_b64 exec, s[44:45]
    buffer_store_dwordx4 v[24:27], v28, s[8:11], s46 offen sc1
    s_mov_b64 exec, -1
    s_waitcnt lgkmcnt(4)
    v_mfma_f32_16x16x32_bf16 v[64:67], a[96:99], v[32:35], v[64:67]
    ds_read_b128 v[56:59], v18 offset:7168
    s_add_u32 m0, s29, 104576
    v_mfma_f32_16x16x32_bf16 v[68:71], a[100:103], v[32:35], v[68:71]
    buffer_load_dwordx4 v16, s[16:19], s34 offen offset:896 lds
    v_mfma_f32_16x16x32_bf16 v[72:75], a[96:99], v[36:39], v[72:75]
    ds_read_b128 v[60:63], v18 offset:23552
    v_mfma_f32_16x16x32_bf16 v[76:79], a[100:103], v[36:39], v[76:79]
    s_waitcnt lgkmcnt(4)
    v_mfma_f32_16x16x32_bf16 v[64:67], a[104:107], v[40:43], v[64:67]
    s_add_u32 s34, s34, 64512
    s_min_u32 s34, s34, 4128768
    v_mfma_f32_16x16x32_bf16 v[68:71], a[108:111], v[40:43], v[68:71]
    v_mfma_f32_16x16x32_bf16 v[72:75], a[104:107], v[44:47], v[72:75]
    v_mfma_f32_16x16x32_bf16 v[76:79], a[108:111], v[44:47], v[76:79]
    s_waitcnt lgkmcnt(0)
    s_waitcnt vmcnt(19)
    s_barrier
    ds_read_b128 v[32:35], v17 offset:32768
    ds_read_b128 v[36:39], v17 offset:49152
    v_mfma_f32_16x16x32_bf16 v[64:67], a[112:115], v[48:51], v[64:67]
    ds_read_b128 v[40:43], v18 offset:32768
    s_add_u32 m0, s29, 0
    v_mfma_f32_16x16x32_bf16 v[68:71], a[116:119], v[48:51], v[68:71]
    buffer_load_dwordx4 v16, s[16:19], s34 offen offset:0 lds
    v_mfma_f32_16x16x32_bf16 v[72:75], a[112:115], v[52:55], v[72:75]
    ds_read_b128 v[44:47], v18 offset:49152
    v_mfma_f32_16x16x32_bf16 v[76:79], a[116:119], v[52:55], v[76:79]
    v_mfma_f32_16x16x32_bf16 v[64:67], a[120:123], v[56:59], v[64:67]
    ds_read_b128 v[48:51], v17 offset:33792
    v_mfma_f32_16x16x32_bf16 v[68:71], a[124:127], v[56:59], v[68:71]
    v_mfma_f32_16x16x32_bf16 v[72:75], a[120:123], v[60:63], v[72:75]
    ds_read_b128 v[52:55], v17 offset:50176
    v_mfma_f32_16x16x32_bf16 v[76:79], a[124:127], v[60:63], v[76:79]
    s_waitcnt lgkmcnt(4)
    v_mfma_f32_16x16x32_bf16 v[64:67], a[128:131], v[32:35], v[64:67]
    ds_read_b128 v[56:59], v18 offset:33792
    s_add_u32 m0, s29, 896
    v_mfma_f32_16x16x32_bf16 v[68:71], a[132:135], v[32:35], v[68:71]
    buffer_load_dwordx4 v16, s[16:19], s34 offen offset:128 lds
    v_mfma_f32_16x16x32_bf16 v[72:75], a[128:131], v[36:39], v[72:75]
    ds_read_b128 v[60:63], v18 offset:50176
    v_mfma_f32_16x16x32_bf16 v[76:79], a[132:135], v[36:39], v[76:79]
    s_waitcnt lgkmcnt(4)
    v_mfma_f32_16x16x32_bf16 v[64:67], a[136:139], v[40:43], v[64:67]
    ds_read_b128 v[32:35], v17 offset:34816
    v_mfma_f32_16x16x32_bf16 v[68:71], a[140:143], v[40:43], v[68:71]
    v_mfma_f32_16x16x32_bf16 v[72:75], a[136:139], v[44:47], v[72:75]
    ds_read_b128 v[36:39], v17 offset:51200
    v_mfma_f32_16x16x32_bf16 v[76:79], a[140:143], v[44:47], v[76:79]
    s_waitcnt lgkmcnt(4)
    v_mfma_f32_16x16x32_bf16 v[64:67], a[144:147], v[48:51], v[64:67]
    ds_read_b128 v[40:43], v18 offset:34816
    s_add_u32 m0, s29, 1792
    v_mfma_f32_16x16x32_bf16 v[68:71], a[148:151], v[48:51], v[68:71]
    buffer_load_dwordx4 v16, s[16:19], s34 offen offset:256 lds
    v_mfma_f32_16x16x32_bf16 v[72:75], a[144:147], v[52:55], v[72:75]
    ds_read_b128 v[44:47], v18 offset:51200
    v_mfma_f32_16x16x32_bf16 v[76:79], a[148:151], v[52:55], v[76:79]
    s_waitcnt lgkmcnt(4)
    v_mfma_f32_16x16x32_bf16 v[64:67], a[152:155], v[56:59], v[64:67]
    ds_read_b128 v[48:51], v17 offset:35840
    v_mfma_f32_16x16x32_bf16 v[68:71], a[156:159], v[56:59], v[68:71]
    v_mfma_f32_16x16x32_bf16 v[72:75], a[152:155], v[60:63], v[72:75]
    ds_read_b128 v[52:55], v17 offset:52224
    v_mfma_f32_16x16x32_bf16 v[76:79], a[156:159], v[60:63], v[76:79]
    s_waitcnt lgkmcnt(4)
    v_mfma_f32_16x16x32_bf16 v[64:67], a[160:163], v[32:35], v[64:67]
    ds_read_b128 v[56:59], v18 offset:35840
    s_add_u32 m0, s29, 2688
    v_mfma_f32_16x16x32_bf16 v[68:71], a[164:167], v[32:35], v[68:71]
    buffer_load_dwordx4 v16, s[16:19], s34 offen offset:384 lds
    v_mfma_f32_16x16x32_bf16 v[72:75], a[160:163], v[36:39], v[72:75]
    ds_read_b128 v[60:63], v18 offset:52224
    v_mfma_f32_16x16x32_bf16 v[76:79], a[164:167], v[36:39], v[76:79]
    s_waitcnt lgkmcnt(4)
    v_mfma_f32_16x16x32_bf16 v[64:67], a[168:171], v[40:43], v[64:67]
    ds_read_b128 v[32:35], v17 offset:36864
    v_mfma_f32_16x16x32_bf16 v[68:71], a[172:175], v[40:43], v[68:71]
    v_mfma_f32_16x16x32_bf16 v[72:75], a[168:171], v[44:47], v[72:75]
    ds_read_b128 v[36:39], v17 offset:53248
    v_mfma_f32_16x16x32_bf16 v[76:79], a[172:175], v[44:47], v[76:79]
    s_waitcnt lgkmcnt(4)
    v_mfma_f32_16x16x32_bf16 v[64:67], a[176:179], v[48:51], v[64:67]
    ds_read_b128 v[40:43], v18 offset:36864
    s_add_u32 m0, s29, 3584
    v_mfma_f32_16x16x32_bf16 v[68:71], a[180:183], v[48:51], v[68:71]
    buffer_load_dwordx4 v16, s[16:19], s34 offen offset:512 lds
    v_mfma_f32_16x16x32_bf16 v[72:75], a[176:179], v[52:55], v[72:75]
    ds_read_b128 v[44:47], v18 offset:53248
    v_mfma_f32_16x16x32_bf16 v[76:79], a[180:183], v[52:55], v[76:79]
    s_waitcnt lgkmcnt(4)
    v_mfma_f32_16x16x32_bf16 v[64:67], a[184:187], v[56:59], v[64:67]
    ds_read_b128 v[48:51], v17 offset:37888
    v_mfma_f32_16x16x32_bf16 v[68:71], a[188:191], v[56:59], v[68:71]
    v_mfma_f32_16x16x32_bf16 v[72:75], a[184:187], v[60:63], v[72:75]
    ds_read_b128 v[52:55], v17 offset:54272
    v_mfma_f32_16x16x32_bf16 v[76:79], a[188:191], v[60:63], v[76:79]
    s_waitcnt lgkmcnt(4)
    v_mfma_f32_16x16x32_bf16 v[64:67], a[192:195], v[32:35], v[64:67]
    ds_read_b128 v[56:59], v18 offset:37888
    s_add_u32 m0, s29, 4480
    v_mfma_f32_16x16x32_bf16 v[68:71], a[196:199], v[32:35], v[68:71]
    buffer_load_dwordx4 v16, s[16:19], s34 offen offset:640 lds
    v_mfma_f32_16x16x32_bf16 v[72:75], a[192:195], v[36:39], v[72:75]
    ds_read_b128 v[60:63], v18 offset:54272
    v_mfma_f32_16x16x32_bf16 v[76:79], a[196:199], v[36:39], v[76:79]
    s_waitcnt lgkmcnt(4)
    v_mfma_f32_16x16x32_bf16 v[64:67], a[200:203], v[40:43], v[64:67]
    ds_read_b128 v[32:35], v17 offset:38912
    v_mfma_f32_16x16x32_bf16 v[68:71], a[204:207], v[40:43], v[68:71]
    v_mfma_f32_16x16x32_bf16 v[72:75], a[200:203], v[44:47], v[72:75]
    ds_read_b128 v[36:39], v17 offset:55296
    v_mfma_f32_16x16x32_bf16 v[76:79], a[204:207], v[44:47], v[76:79]
    s_waitcnt lgkmcnt(4)
    v_mfma_f32_16x16x32_bf16 v[64:67], a[208:211], v[48:51], v[64:67]
    ds_read_b128 v[40:43], v18 offset:38912
    s_add_u32 m0, s29, 5376
    v_mfma_f32_16x16x32_bf16 v[68:71], a[212:215], v[48:51], v[68:71]
    buffer_load_dwordx4 v16, s[16:19], s34 offen offset:768 lds
    v_mfma_f32_16x16x32_bf16 v[72:75], a[208:211], v[52:55], v[72:75]
    ds_read_b128 v[44:47], v18 offset:55296
    v_mfma_f32_16x16x32_bf16 v[76:79], a[212:215], v[52:55], v[76:79]
    s_waitcnt lgkmcnt(4)
    v_mfma_f32_16x16x32_bf16 v[64:67], a[216:219], v[56:59], v[64:67]
    ds_read_b128 v[48:51], v17 offset:39936
    v_mfma_f32_16x16x32_bf16 v[68:71], a[220:223], v[56:59], v[68:71]
    v_mfma_f32_16x16x32_bf16 v[72:75], a[216:219], v[60:63], v[72:75]
    ds_read_b128 v[52:55], v17 offset:56320
    v_mfma_f32_16x16x32_bf16 v[76:79], a[220:223], v[60:63], v[76:79]
    s_mov_b64 exec, s[44:45]
    buffer_store_dwordx4 v[24:27], v29, s[8:11], s46 offen sc1
    s_mov_b64 exec, -1
    s_waitcnt lgkmcnt(4)
    v_mfma_f32_16x16x32_bf16 v[64:67], a[224:227], v[32:35], v[64:67]
    ds_read_b128 v[56:59], v18 offset:39936
    s_add_u32 m0, s29, 6272
    v_mfma_f32_16x16x32_bf16 v[68:71], a[228:231], v[32:35], v[68:71]
    buffer_load_dwordx4 v16, s[16:19], s34 offen offset:896 lds
    v_mfma_f32_16x16x32_bf16 v[72:75], a[224:227], v[36:39], v[72:75]
    ds_read_b128 v[60:63], v18 offset:56320
    v_mfma_f32_16x16x32_bf16 v[76:79], a[228:231], v[36:39], v[76:79]
    s_waitcnt lgkmcnt(4)
    v_mfma_f32_16x16x32_bf16 v[64:67], a[232:235], v[40:43], v[64:67]
    s_add_u32 s34, s34, 1024
    v_mfma_f32_16x16x32_bf16 v[68:71], a[236:239], v[40:43], v[68:71]
    v_mfma_f32_16x16x32_bf16 v[72:75], a[232:235], v[44:47], v[72:75]
    v_mfma_f32_16x16x32_bf16 v[76:79], a[236:239], v[44:47], v[76:79]
    s_waitcnt lgkmcnt(0)
    s_waitcnt vmcnt(10)
    s_barrier
    ds_read_b128 v[32:35], v19 offset:0
    ds_read_b128 v[36:39], v19 offset:16384
    v_mfma_f32_16x16x32_bf16 v[64:67], a[240:243], v[48:51], v[64:67]
    ds_read_b128 v[40:43], v20 offset:0
    s_add_u32 m0, s29, 32768
    v_mfma_f32_16x16x32_bf16 v[68:71], a[244:247], v[48:51], v[68:71]
    buffer_load_dwordx4 v16, s[16:19], s34 offen offset:0 lds
    v_mfma_f32_16x16x32_bf16 v[72:75], a[240:243], v[52:55], v[72:75]
    ds_read_b128 v[44:47], v20 offset:16384
    v_mfma_f32_16x16x32_bf16 v[76:79], a[244:247], v[52:55], v[76:79]
    v_mfma_f32_16x16x32_bf16 v[64:67], a[248:251], v[56:59], v[64:67]
    ds_read_b128 v[48:51], v19 offset:1024
    v_mfma_f32_16x16x32_bf16 v[68:71], a[252:255], v[56:59], v[68:71]
    v_mfma_f32_16x16x32_bf16 v[72:75], a[248:251], v[60:63], v[72:75]
    ds_read_b128 v[52:55], v19 offset:17408
    v_mfma_f32_16x16x32_bf16 v[76:79], a[252:255], v[60:63], v[76:79]
    s_mov_b64 exec, s[36:37]
    buffer_store_dword v23, v22, s[8:11], s33 offen sc1
    s_mov_b64 exec, -1

    s_waitcnt lgkmcnt(4)
    v_mfma_f32_16x16x32_bf16 v[80:83], a[0:3], v[32:35], 0
    ds_read_b128 v[56:59], v20 offset:1024
    s_add_u32 m0, s29, 33664
    v_mfma_f32_16x16x32_bf16 v[84:87], a[4:7], v[32:35], 0
    buffer_load_dwordx4 v16, s[16:19], s34 offen offset:128 lds
    v_mfma_f32_16x16x32_bf16 v[88:91], a[0:3], v[36:39], 0
    ds_read_b128 v[60:63], v20 offset:17408
    v_mfma_f32_16x16x32_bf16 v[92:95], a[4:7], v[36:39], 0
    s_waitcnt lgkmcnt(4)
    v_mfma_f32_16x16x32_bf16 v[80:83], a[8:11], v[40:43], v[80:83]
    ds_read_b128 v[32:35], v19 offset:2048
    v_mfma_f32_16x16x32_bf16 v[84:87], a[12:15], v[40:43], v[84:87]
    v_cvt_pk_bf16_f32 v96, v64, v65
    v_cvt_pk_bf16_f32 v97, v66, v67
    v_mfma_f32_16x16x32_bf16 v[88:91], a[8:11], v[44:47], v[88:91]
    ds_read_b128 v[36:39], v19 offset:18432
    v_mfma_f32_16x16x32_bf16 v[92:95], a[12:15], v[44:47], v[92:95]
    v_cvt_pk_bf16_f32 v98, v68, v69
    v_cvt_pk_bf16_f32 v99, v70, v71
    s_waitcnt lgkmcnt(4)
    v_mfma_f32_16x16x32_bf16 v[80:83], a[16:19], v[48:51], v[80:83]
    ds_read_b128 v[40:43], v20 offset:2048
    s_add_u32 m0, s29, 34560
    v_mfma_f32_16x16x32_bf16 v[84:87], a[20:23], v[48:51], v[84:87]
    buffer_load_dwordx4 v16, s[16:19], s34 offen offset:256 lds
    v_mfma_f32_16x16x32_bf16 v[88:91], a[16:19], v[52:55], v[88:91]
    ds_read_b128 v[44:47], v20 offset:18432
    v_mfma_f32_16x16x32_bf16 v[92:95], a[20:23], v[52:55], v[92:95]
    s_waitcnt lgkmcnt(4)
    v_mfma_f32_16x16x32_bf16 v[80:83], a[24:27], v[56:59], v[80:83]
    ds_read_b128 v[48:51], v19 offset:3072
    v_mfma_f32_16x16x32_bf16 v[84:87], a[28:31], v[56:59], v[84:87]
    buffer_store_dwordx4 v[96:99], v21, s[8:11], s32 offen sc1
    v_mfma_f32_16x16x32_bf16 v[88:91], a[24:27], v[60:63], v[88:91]
    ds_read_b128 v[52:55], v19 offset:19456
    v_mfma_f32_16x16x32_bf16 v[92:95], a[28:31], v[60:63], v[92:95]
    s_waitcnt lgkmcnt(4)
    v_mfma_f32_16x16x32_bf16 v[80:83], a[32:35], v[32:35], v[80:83]
    ds_read_b128 v[56:59], v20 offset:3072
    s_add_u32 m0, s29, 35456
    v_mfma_f32_16x16x32_bf16 v[84:87], a[36:39], v[32:35], v[84:87]
    buffer_load_dwordx4 v16, s[16:19], s34 offen offset:384 lds
    v_mfma_f32_16x16x32_bf16 v[88:91], a[32:35], v[36:39], v[88:91]
    ds_read_b128 v[60:63], v20 offset:19456
    v_mfma_f32_16x16x32_bf16 v[92:95], a[36:39], v[36:39], v[92:95]
    s_waitcnt lgkmcnt(4)
    v_mfma_f32_16x16x32_bf16 v[80:83], a[40:43], v[40:43], v[80:83]
    ds_read_b128 v[32:35], v19 offset:4096
    v_mfma_f32_16x16x32_bf16 v[84:87], a[44:47], v[40:43], v[84:87]
    v_cvt_pk_bf16_f32 v100, v72, v73
    v_cvt_pk_bf16_f32 v101, v74, v75
    v_mfma_f32_16x16x32_bf16 v[88:91], a[40:43], v[44:47], v[88:91]
    ds_read_b128 v[36:39], v19 offset:20480
    v_mfma_f32_16x16x32_bf16 v[92:95], a[44:47], v[44:47], v[92:95]
    v_cvt_pk_bf16_f32 v102, v76, v77
    v_cvt_pk_bf16_f32 v103, v78, v79
    s_waitcnt lgkmcnt(4)
    v_mfma_f32_16x16x32_bf16 v[80:83], a[48:51], v[48:51], v[80:83]
    ds_read_b128 v[40:43], v20 offset:4096
    s_add_u32 m0, s29, 36352
    v_mfma_f32_16x16x32_bf16 v[84:87], a[52:55], v[48:51], v[84:87]
    buffer_load_dwordx4 v16, s[16:19], s34 offen offset:512 lds
    v_mfma_f32_16x16x32_bf16 v[88:91], a[48:51], v[52:55], v[88:91]
    ds_read_b128 v[44:47], v20 offset:20480
    v_mfma_f32_16x16x32_bf16 v[92:95], a[52:55], v[52:55], v[92:95]
    s_waitcnt lgkmcnt(4)
    v_mfma_f32_16x16x32_bf16 v[80:83], a[56:59], v[56:59], v[80:83]
    ds_read_b128 v[48:51], v19 offset:5120
    v_mfma_f32_16x16x32_bf16 v[84:87], a[60:63], v[56:59], v[84:87]
    buffer_store_dwordx4 v[100:103], v21, s[8:11], s38 offen sc1
    v_mfma_f32_16x16x32_bf16 v[88:91], a[56:59], v[60:63], v[88:91]
    ds_read_b128 v[52:55], v19 offset:21504
    v_mfma_f32_16x16x32_bf16 v[92:95], a[60:63], v[60:63], v[92:95]
    s_waitcnt lgkmcnt(4)
    v_mfma_f32_16x16x32_bf16 v[80:83], a[64:67], v[32:35], v[80:83]
    ds_read_b128 v[56:59], v20 offset:5120
    s_add_u32 m0, s29, 37248
    v_mfma_f32_16x16x32_bf16 v[84:87], a[68:71], v[32:35], v[84:87]
    buffer_load_dwordx4 v16, s[16:19], s34 offen offset:640 lds
    v_mfma_f32_16x16x32_bf16 v[88:91], a[64:67], v[36:39], v[88:91]
    ds_read_b128 v[60:63], v20 offset:21504
    v_mfma_f32_16x16x32_bf16 v[92:95], a[68:71], v[36:39], v[92:95]
    s_mov_b32 exec_hi, 0
    buffer_store_dwordx4 v[24:27], v21, s[8:11], s48 offen sc1
    s_mov_b32 exec_hi, -1

    s_waitcnt lgkmcnt(4)
    v_mfma_f32_16x16x32_bf16 v[80:83], a[72:75], v[40:43], v[80:83]
    ds_read_b128 v[32:35], v19 offset:6144
    v_mfma_f32_16x16x32_bf16 v[84:87], a[76:79], v[40:43], v[84:87]
    s_mov_b32 s32, s39
    s_add_u32 s38, s39, 4096
    s_add_u32 s39, s39, 262144
    s_mov_b32 s48, s49
    s_add_u32 s49, s49, 196608
    v_mfma_f32_16x16x32_bf16 v[88:91], a[72:75], v[44:47], v[88:91]
    ds_read_b128 v[36:39], v19 offset:22528
    v_mfma_f32_16x16x32_bf16 v[92:95], a[76:79], v[44:47], v[92:95]
    v_add_u32 v23, 1, v23
    s_waitcnt lgkmcnt(4)
    v_mfma_f32_16x16x32_bf16 v[80:83], a[80:83], v[48:51], v[80:83]
    ds_read_b128 v[40:43], v20 offset:6144
    s_add_u32 m0, s29, 38144
    v_mfma_f32_16x16x32_bf16 v[84:87], a[84:87], v[48:51], v[84:87]
    buffer_load_dwordx4 v16, s[16:19], s34 offen offset:768 lds
    v_mfma_f32_16x16x32_bf16 v[88:91], a[80:83], v[52:55], v[88:91]
    ds_read_b128 v[44:47], v20 offset:22528
    v_mfma_f32_16x16x32_bf16 v[92:95], a[84:87], v[52:55], v[92:95]
    s_waitcnt lgkmcnt(4)
    v_mfma_f32_16x16x32_bf16 v[80:83], a[88:91], v[56:59], v[80:83]
    ds_read_b128 v[48:51], v19 offset:7168
    v_mfma_f32_16x16x32_bf16 v[84:87], a[92:95], v[56:59], v[84:87]
    v_mfma_f32_16x16x32_bf16 v[88:91], a[88:91], v[60:63], v[88:91]
    ds_read_b128 v[52:55], v19 offset:23552
    v_mfma_f32_16x16x32_bf16 v[92:95], a[92:95], v[60:63], v[92:95]
    s_mov_b64 exec, s[44:45]
    buffer_store_dwordx4 v[24:27], v30, s[8:11], s46 offen sc1
    s_mov_b64 exec, -1
    s_waitcnt lgkmcnt(4)
    v_mfma_f32_16x16x32_bf16 v[80:83], a[96:99], v[32:35], v[80:83]
    ds_read_b128 v[56:59], v20 offset:7168
    s_add_u32 m0, s29, 39040
    v_mfma_f32_16x16x32_bf16 v[84:87], a[100:103], v[32:35], v[84:87]
    buffer_load_dwordx4 v16, s[16:19], s34 offen offset:896 lds
    v_mfma_f32_16x16x32_bf16 v[88:91], a[96:99], v[36:39], v[88:91]
    ds_read_b128 v[60:63], v20 offset:23552
    v_mfma_f32_16x16x32_bf16 v[92:95], a[100:103], v[36:39], v[92:95]
    s_waitcnt lgkmcnt(4)
    v_mfma_f32_16x16x32_bf16 v[80:83], a[104:107], v[40:43], v[80:83]
    s_add_u32 s34, s34, 64512
    s_min_u32 s34, s34, 4128768
    v_mfma_f32_16x16x32_bf16 v[84:87], a[108:111], v[40:43], v[84:87]
    v_mfma_f32_16x16x32_bf16 v[88:91], a[104:107], v[44:47], v[88:91]
    v_mfma_f32_16x16x32_bf16 v[92:95], a[108:111], v[44:47], v[92:95]
    s_waitcnt lgkmcnt(0)
    s_waitcnt vmcnt(19)
    s_barrier
    ds_read_b128 v[32:35], v19 offset:32768
    ds_read_b128 v[36:39], v19 offset:49152
    v_mfma_f32_16x16x32_bf16 v[80:83], a[112:115], v[48:51], v[80:83]
    ds_read_b128 v[40:43], v20 offset:32768
    s_add_u32 m0, s29, 65536
    v_mfma_f32_16x16x32_bf16 v[84:87], a[116:119], v[48:51], v[84:87]
    buffer_load_dwordx4 v16, s[16:19], s34 offen offset:0 lds
    v_mfma_f32_16x16x32_bf16 v[88:91], a[112:115], v[52:55], v[88:91]
    ds_read_b128 v[44:47], v20 offset:49152
    v_mfma_f32_16x16x32_bf16 v[92:95], a[116:119], v[52:55], v[92:95]
    v_mfma_f32_16x16x32_bf16 v[80:83], a[120:123], v[56:59], v[80:83]
    ds_read_b128 v[48:51], v19 offset:33792
    v_mfma_f32_16x16x32_bf16 v[84:87], a[124:127], v[56:59], v[84:87]
    v_mfma_f32_16x16x32_bf16 v[88:91], a[120:123], v[60:63], v[88:91]
    ds_read_b128 v[52:55], v19 offset:50176
    v_mfma_f32_16x16x32_bf16 v[92:95], a[124:127], v[60:63], v[92:95]
    s_waitcnt lgkmcnt(4)
    v_mfma_f32_16x16x32_bf16 v[80:83], a[128:131], v[32:35], v[80:83]
    ds_read_b128 v[56:59], v20 offset:33792
    s_add_u32 m0, s29, 66432
    v_mfma_f32_16x16x32_bf16 v[84:87], a[132:135], v[32:35], v[84:87]
    buffer_load_dwordx4 v16, s[16:19], s34 offen offset:128 lds
    v_mfma_f32_16x16x32_bf16 v[88:91], a[128:131], v[36:39], v[88:91]
    ds_read_b128 v[60:63], v20 offset:50176
    v_mfma_f32_16x16x32_bf16 v[92:95], a[132:135], v[36:39], v[92:95]
    s_waitcnt lgkmcnt(4)
    v_mfma_f32_16x16x32_bf16 v[80:83], a[136:139], v[40:43], v[80:83]
    ds_read_b128 v[32:35], v19 offset:34816
    v_mfma_f32_16x16x32_bf16 v[84:87], a[140:143], v[40:43], v[84:87]
    v_mfma_f32_16x16x32_bf16 v[88:91], a[136:139], v[44:47], v[88:91]
    ds_read_b128 v[36:39], v19 offset:51200
    v_mfma_f32_16x16x32_bf16 v[92:95], a[140:143], v[44:47], v[92:95]
    s_waitcnt lgkmcnt(4)
    v_mfma_f32_16x16x32_bf16 v[80:83], a[144:147], v[48:51], v[80:83]
    ds_read_b128 v[40:43], v20 offset:34816
    s_add_u32 m0, s29, 67328
    v_mfma_f32_16x16x32_bf16 v[84:87], a[148:151], v[48:51], v[84:87]
    buffer_load_dwordx4 v16, s[16:19], s34 offen offset:256 lds
    v_mfma_f32_16x16x32_bf16 v[88:91], a[144:147], v[52:55], v[88:91]
    ds_read_b128 v[44:47], v20 offset:51200
    v_mfma_f32_16x16x32_bf16 v[92:95], a[148:151], v[52:55], v[92:95]
    s_waitcnt lgkmcnt(4)
    v_mfma_f32_16x16x32_bf16 v[80:83], a[152:155], v[56:59], v[80:83]
    ds_read_b128 v[48:51], v19 offset:35840
    v_mfma_f32_16x16x32_bf16 v[84:87], a[156:159], v[56:59], v[84:87]
    v_mfma_f32_16x16x32_bf16 v[88:91], a[152:155], v[60:63], v[88:91]
    ds_read_b128 v[52:55], v19 offset:52224
    v_mfma_f32_16x16x32_bf16 v[92:95], a[156:159], v[60:63], v[92:95]
    s_waitcnt lgkmcnt(4)
    v_mfma_f32_16x16x32_bf16 v[80:83], a[160:163], v[32:35], v[80:83]
    ds_read_b128 v[56:59], v20 offset:35840
    s_add_u32 m0, s29, 68224
    v_mfma_f32_16x16x32_bf16 v[84:87], a[164:167], v[32:35], v[84:87]
    buffer_load_dwordx4 v16, s[16:19], s34 offen offset:384 lds
    v_mfma_f32_16x16x32_bf16 v[88:91], a[160:163], v[36:39], v[88:91]
    ds_read_b128 v[60:63], v20 offset:52224
    v_mfma_f32_16x16x32_bf16 v[92:95], a[164:167], v[36:39], v[92:95]
    s_waitcnt lgkmcnt(4)
    v_mfma_f32_16x16x32_bf16 v[80:83], a[168:171], v[40:43], v[80:83]
    ds_read_b128 v[32:35], v19 offset:36864
    v_mfma_f32_16x16x32_bf16 v[84:87], a[172:175], v[40:43], v[84:87]
    v_mfma_f32_16x16x32_bf16 v[88:91], a[168:171], v[44:47], v[88:91]
    ds_read_b128 v[36:39], v19 offset:53248
    v_mfma_f32_16x16x32_bf16 v[92:95], a[172:175], v[44:47], v[92:95]
    s_waitcnt lgkmcnt(4)
    v_mfma_f32_16x16x32_bf16 v[80:83], a[176:179], v[48:51], v[80:83]
    ds_read_b128 v[40:43], v20 offset:36864
    s_add_u32 m0, s29, 69120
    v_mfma_f32_16x16x32_bf16 v[84:87], a[180:183], v[48:51], v[84:87]
    buffer_load_dwordx4 v16, s[16:19], s34 offen offset:512 lds
    v_mfma_f32_16x16x32_bf16 v[88:91], a[176:179], v[52:55], v[88:91]
    ds_read_b128 v[44:47], v20 offset:53248
    v_mfma_f32_16x16x32_bf16 v[92:95], a[180:183], v[52:55], v[92:95]
    s_waitcnt lgkmcnt(4)
    v_mfma_f32_16x16x32_bf16 v[80:83], a[184:187], v[56:59], v[80:83]
    ds_read_b128 v[48:51], v19 offset:37888
    v_mfma_f32_16x16x32_bf16 v[84:87], a[188:191], v[56:59], v[84:87]
    v_mfma_f32_16x16x32_bf16 v[88:91], a[184:187], v[60:63], v[88:91]
    ds_read_b128 v[52:55], v19 offset:54272
    v_mfma_f32_16x16x32_bf16 v[92:95], a[188:191], v[60:63], v[92:95]
    s_waitcnt lgkmcnt(4)
    v_mfma_f32_16x16x32_bf16 v[80:83], a[192:195], v[32:35], v[80:83]
    ds_read_b128 v[56:59], v20 offset:37888
    s_add_u32 m0, s29, 70016
    v_mfma_f32_16x16x32_bf16 v[84:87], a[196:199], v[32:35], v[84:87]
    buffer_load_dwordx4 v16, s[16:19], s34 offen offset:640 lds
    v_mfma_f32_16x16x32_bf16 v[88:91], a[192:195], v[36:39], v[88:91]
    ds_read_b128 v[60:63], v20 offset:54272
    v_mfma_f32_16x16x32_bf16 v[92:95], a[196:199], v[36:39], v[92:95]
    s_waitcnt lgkmcnt(4)
    v_mfma_f32_16x16x32_bf16 v[80:83], a[200:203], v[40:43], v[80:83]
    ds_read_b128 v[32:35], v19 offset:38912
    v_mfma_f32_16x16x32_bf16 v[84:87], a[204:207], v[40:43], v[84:87]
    v_mfma_f32_16x16x32_bf16 v[88:91], a[200:203], v[44:47], v[88:91]
    ds_read_b128 v[36:39], v19 offset:55296
    v_mfma_f32_16x16x32_bf16 v[92:95], a[204:207], v[44:47], v[92:95]
    s_waitcnt lgkmcnt(4)
    v_mfma_f32_16x16x32_bf16 v[80:83], a[208:211], v[48:51], v[80:83]
    ds_read_b128 v[40:43], v20 offset:38912
    s_add_u32 m0, s29, 70912
    v_mfma_f32_16x16x32_bf16 v[84:87], a[212:215], v[48:51], v[84:87]
    buffer_load_dwordx4 v16, s[16:19], s34 offen offset:768 lds
    v_mfma_f32_16x16x32_bf16 v[88:91], a[208:211], v[52:55], v[88:91]
    ds_read_b128 v[44:47], v20 offset:55296
    v_mfma_f32_16x16x32_bf16 v[92:95], a[212:215], v[52:55], v[92:95]
    s_waitcnt lgkmcnt(4)
    v_mfma_f32_16x16x32_bf16 v[80:83], a[216:219], v[56:59], v[80:83]
    ds_read_b128 v[48:51], v19 offset:39936
    v_mfma_f32_16x16x32_bf16 v[84:87], a[220:223], v[56:59], v[84:87]
    s_cmp_lt_u32 s35, 21
    s_cselect_b64 s[44:45], -1, 0
    v_mfma_f32_16x16x32_bf16 v[88:91], a[216:219], v[60:63], v[88:91]
    ds_read_b128 v[52:55], v19 offset:56320
    v_mfma_f32_16x16x32_bf16 v[92:95], a[220:223], v[60:63], v[92:95]
    s_cselect_b32 s4, 0x10000, 0
    s_add_u32 s46, s46, s4
    s_waitcnt lgkmcnt(4)
    v_mfma_f32_16x16x32_bf16 v[80:83], a[224:227], v[32:35], v[80:83]
    ds_read_b128 v[56:59], v20 offset:39936
    s_add_u32 m0, s29, 71808
    v_mfma_f32_16x16x32_bf16 v[84:87], a[228:231], v[32:35], v[84:87]
    buffer_load_dwordx4 v16, s[16:19], s34 offen offset:896 lds
    v_mfma_f32_16x16x32_bf16 v[88:91], a[224:227], v[36:39], v[88:91]
    ds_read_b128 v[60:63], v20 offset:56320
    v_mfma_f32_16x16x32_bf16 v[92:95], a[228:231], v[36:39], v[92:95]
    s_waitcnt lgkmcnt(4)
    v_mfma_f32_16x16x32_bf16 v[80:83], a[232:235], v[40:43], v[80:83]
    s_add_u32 s34, s34, 1024
    v_mfma_f32_16x16x32_bf16 v[84:87], a[236:239], v[40:43], v[84:87]
    v_mfma_f32_16x16x32_bf16 v[88:91], a[232:235], v[44:47], v[88:91]
    v_mfma_f32_16x16x32_bf16 v[92:95], a[236:239], v[44:47], v[92:95]
    s_waitcnt lgkmcnt(0)
    s_waitcnt vmcnt(10)
    s_barrier
    ds_read_b128 v[32:35], v17 offset:0
    ds_read_b128 v[36:39], v17 offset:16384
    v_mfma_f32_16x16x32_bf16 v[80:83], a[240:243], v[48:51], v[80:83]
    ds_read_b128 v[40:43], v18 offset:0
    s_add_u32 m0, s29, 98304
    v_mfma_f32_16x16x32_bf16 v[84:87], a[244:247], v[48:51], v[84:87]
    buffer_load_dwordx4 v16, s[16:19], s34 offen offset:0 lds
    v_mfma_f32_16x16x32_bf16 v[88:91], a[240:243], v[52:55], v[88:91]
    ds_read_b128 v[44:47], v18 offset:16384
    v_mfma_f32_16x16x32_bf16 v[92:95], a[244:247], v[52:55], v[92:95]
    v_mfma_f32_16x16x32_bf16 v[80:83], a[248:251], v[56:59], v[80:83]
    ds_read_b128 v[48:51], v17 offset:1024
    v_mfma_f32_16x16x32_bf16 v[84:87], a[252:255], v[56:59], v[84:87]
    v_mfma_f32_16x16x32_bf16 v[88:91], a[248:251], v[60:63], v[88:91]
    ds_read_b128 v[52:55], v17 offset:17408
    v_mfma_f32_16x16x32_bf16 v[92:95], a[252:255], v[60:63], v[92:95]
    s_mov_b64 exec, s[36:37]
    buffer_store_dword v23, v22, s[8:11], s33 offen sc1
    s_mov_b64 exec, -1

    s_add_u32 s35, s35, 1
    s_cmp_lt_u32 s35, 32
    s_cbranch_scc1 .ql_380

    s_nop 7
    v_cvt_pk_bf16_f32 v96, v80, v81
    v_cvt_pk_bf16_f32 v97, v82, v83
    v_cvt_pk_bf16_f32 v98, v84, v85
    v_cvt_pk_bf16_f32 v99, v86, v87
    buffer_store_dwordx4 v[96:99], v21, s[8:11], s32 offen sc1
    v_cvt_pk_bf16_f32 v100, v88, v89
    v_cvt_pk_bf16_f32 v101, v90, v91
    v_cvt_pk_bf16_f32 v102, v92, v93
    v_cvt_pk_bf16_f32 v103, v94, v95
    buffer_store_dwordx4 v[100:103], v21, s[8:11], s38 offen sc1
    s_mov_b32 exec_hi, 0
    buffer_store_dwordx4 v[24:27], v21, s[8:11], s48 offen sc1
    s_mov_b32 exec_hi, -1

    v_mov_b32 v23, 64
    s_waitcnt vmcnt(0) lgkmcnt(0)
    s_barrier
    s_mov_b64 exec, s[36:37]
    buffer_store_dword v23, v22, s[8:11], s33 offen sc1
    s_mov_b64 exec, -1

    s_branch .qd_379
.qv_378:
    s_waitcnt vmcnt(16)
    s_barrier
    ds_read_b128 v[32:35], v17 offset:0
    ds_read_b128 v[36:39], v17 offset:16384
    ds_read_b128 v[40:43], v18 offset:0
    ds_read_b128 v[44:47], v18 offset:16384
    s_add_u32 m0, s29, 98304
    s_nop 0
    buffer_load_dwordx4 v16, s[16:19], s34 offen offset:0 lds
    ds_read_b128 v[48:51], v17 offset:1024
    ds_read_b128 v[52:55], v17 offset:17408
    s_branch .qe_383
.p2align 6
.ql_382:
.qe_383:
    s_waitcnt lgkmcnt(4)
    v_mfma_f32_16x16x32_bf16 v[64:67], v[32:35], a[0:3], 0
    ds_read_b128 v[56:59], v18 offset:1024
    s_add_u32 m0, s29, 99200
    v_mfma_f32_16x16x32_bf16 v[68:71], v[32:35], a[4:7], 0
    buffer_load_dwordx4 v16, s[16:19], s34 offen offset:128 lds
    v_mfma_f32_16x16x32_bf16 v[72:75], v[36:39], a[0:3], 0
    ds_read_b128 v[60:63], v18 offset:17408
    v_mfma_f32_16x16x32_bf16 v[76:79], v[36:39], a[4:7], 0
    s_waitcnt lgkmcnt(4)
    v_mfma_f32_16x16x32_bf16 v[64:67], v[40:43], a[8:11], v[64:67]
    ds_read_b128 v[32:35], v17 offset:2048
    v_mfma_f32_16x16x32_bf16 v[68:71], v[40:43], a[12:15], v[68:71]
    v_cvt_pk_bf16_f32 v96, v80, v81
    v_cvt_pk_bf16_f32 v97, v82, v83
    v_mfma_f32_16x16x32_bf16 v[72:75], v[44:47], a[8:11], v[72:75]
    ds_read_b128 v[36:39], v17 offset:18432
    v_mfma_f32_16x16x32_bf16 v[76:79], v[44:47], a[12:15], v[76:79]
    v_cvt_pk_bf16_f32 v98, v88, v89
    v_cvt_pk_bf16_f32 v99, v90, v91
    s_waitcnt lgkmcnt(4)
    v_mfma_f32_16x16x32_bf16 v[64:67], v[48:51], a[16:19], v[64:67]
    ds_read_b128 v[40:43], v18 offset:2048
    s_add_u32 m0, s29, 100096
    v_mfma_f32_16x16x32_bf16 v[68:71], v[48:51], a[20:23], v[68:71]
    buffer_load_dwordx4 v16, s[16:19], s34 offen offset:256 lds
    v_mfma_f32_16x16x32_bf16 v[72:75], v[52:55], a[16:19], v[72:75]
    ds_read_b128 v[44:47], v18 offset:18432
    v_mfma_f32_16x16x32_bf16 v[76:79], v[52:55], a[20:23], v[76:79]
    s_waitcnt lgkmcnt(4)
    v_mfma_f32_16x16x32_bf16 v[64:67], v[56:59], a[24:27], v[64:67]
    ds_read_b128 v[48:51], v17 offset:3072
    v_mfma_f32_16x16x32_bf16 v[68:71], v[56:59], a[28:31], v[68:71]
    buffer_store_dwordx4 v[96:99], v21, s[8:11], s32 offen offset:0 sc1
    v_mfma_f32_16x16x32_bf16 v[72:75], v[60:63], a[24:27], v[72:75]
    ds_read_b128 v[52:55], v17 offset:19456
    v_mfma_f32_16x16x32_bf16 v[76:79], v[60:63], a[28:31], v[76:79]
    s_waitcnt lgkmcnt(4)
    v_mfma_f32_16x16x32_bf16 v[64:67], v[32:35], a[32:35], v[64:67]
    ds_read_b128 v[56:59], v18 offset:3072
    s_add_u32 m0, s29, 100992
    v_mfma_f32_16x16x32_bf16 v[68:71], v[32:35], a[36:39], v[68:71]
    buffer_load_dwordx4 v16, s[16:19], s34 offen offset:384 lds
    v_mfma_f32_16x16x32_bf16 v[72:75], v[36:39], a[32:35], v[72:75]
    ds_read_b128 v[60:63], v18 offset:19456
    v_mfma_f32_16x16x32_bf16 v[76:79], v[36:39], a[36:39], v[76:79]
    s_waitcnt lgkmcnt(4)
    v_mfma_f32_16x16x32_bf16 v[64:67], v[40:43], a[40:43], v[64:67]
    ds_read_b128 v[32:35], v17 offset:4096
    v_mfma_f32_16x16x32_bf16 v[68:71], v[40:43], a[44:47], v[68:71]
    v_cvt_pk_bf16_f32 v100, v84, v85
    v_cvt_pk_bf16_f32 v101, v86, v87
    v_mfma_f32_16x16x32_bf16 v[72:75], v[44:47], a[40:43], v[72:75]
    ds_read_b128 v[36:39], v17 offset:20480
    v_mfma_f32_16x16x32_bf16 v[76:79], v[44:47], a[44:47], v[76:79]
    v_cvt_pk_bf16_f32 v102, v92, v93
    v_cvt_pk_bf16_f32 v103, v94, v95
    s_waitcnt lgkmcnt(4)
    v_mfma_f32_16x16x32_bf16 v[64:67], v[48:51], a[48:51], v[64:67]
    ds_read_b128 v[40:43], v18 offset:4096
    s_add_u32 m0, s29, 101888
    v_mfma_f32_16x16x32_bf16 v[68:71], v[48:51], a[52:55], v[68:71]
    buffer_load_dwordx4 v16, s[16:19], s34 offen offset:512 lds
    v_mfma_f32_16x16x32_bf16 v[72:75], v[52:55], a[48:51], v[72:75]
    ds_read_b128 v[44:47], v18 offset:20480
    v_mfma_f32_16x16x32_bf16 v[76:79], v[52:55], a[52:55], v[76:79]
    s_waitcnt lgkmcnt(4)
    v_mfma_f32_16x16x32_bf16 v[64:67], v[56:59], a[56:59], v[64:67]
    ds_read_b128 v[48:51], v17 offset:5120
    v_mfma_f32_16x16x32_bf16 v[68:71], v[56:59], a[60:63], v[68:71]
    buffer_store_dwordx4 v[100:103], v21, s[8:11], s32 offen offset:1024 sc1
    v_mfma_f32_16x16x32_bf16 v[72:75], v[60:63], a[56:59], v[72:75]
    ds_read_b128 v[52:55], v17 offset:21504
    v_mfma_f32_16x16x32_bf16 v[76:79], v[60:63], a[60:63], v[76:79]
    s_waitcnt lgkmcnt(4)
    v_mfma_f32_16x16x32_bf16 v[64:67], v[32:35], a[64:67], v[64:67]
    ds_read_b128 v[56:59], v18 offset:5120
    s_add_u32 m0, s29, 102784
    v_mfma_f32_16x16x32_bf16 v[68:71], v[32:35], a[68:71], v[68:71]
    buffer_load_dwordx4 v16, s[16:19], s34 offen offset:640 lds
    v_mfma_f32_16x16x32_bf16 v[72:75], v[36:39], a[64:67], v[72:75]
    ds_read_b128 v[60:63], v18 offset:21504
    v_mfma_f32_16x16x32_bf16 v[76:79], v[36:39], a[68:71], v[76:79]
    s_mov_b32 exec_hi, 0
    buffer_store_dwordx4 v[24:27], v21, s[8:11], s48 offen sc1
    s_mov_b32 exec_hi, -1

    s_waitcnt lgkmcnt(4)
    v_mfma_f32_16x16x32_bf16 v[64:67], v[40:43], a[72:75], v[64:67]
    ds_read_b128 v[32:35], v17 offset:6144
    v_mfma_f32_16x16x32_bf16 v[68:71], v[40:43], a[76:79], v[68:71]
    s_mov_b32 s32, s39
    s_add_u32 s38, s39, 4096
    s_add_u32 s39, s39, 262144
    s_mov_b32 s48, s49
    s_add_u32 s49, s49, 196608
    v_mfma_f32_16x16x32_bf16 v[72:75], v[44:47], a[72:75], v[72:75]
    ds_read_b128 v[36:39], v17 offset:22528
    v_mfma_f32_16x16x32_bf16 v[76:79], v[44:47], a[76:79], v[76:79]
    v_add_u32 v23, 1, v23
    s_waitcnt lgkmcnt(4)
    v_mfma_f32_16x16x32_bf16 v[64:67], v[48:51], a[80:83], v[64:67]
    ds_read_b128 v[40:43], v18 offset:6144
    s_add_u32 m0, s29, 103680
    v_mfma_f32_16x16x32_bf16 v[68:71], v[48:51], a[84:87], v[68:71]
    buffer_load_dwordx4 v16, s[16:19], s34 offen offset:768 lds
    v_mfma_f32_16x16x32_bf16 v[72:75], v[52:55], a[80:83], v[72:75]
    ds_read_b128 v[44:47], v18 offset:22528
    v_mfma_f32_16x16x32_bf16 v[76:79], v[52:55], a[84:87], v[76:79]
    s_waitcnt lgkmcnt(4)
    v_mfma_f32_16x16x32_bf16 v[64:67], v[56:59], a[88:91], v[64:67]
    ds_read_b128 v[48:51], v17 offset:7168
    v_mfma_f32_16x16x32_bf16 v[68:71], v[56:59], a[92:95], v[68:71]
    v_mfma_f32_16x16x32_bf16 v[72:75], v[60:63], a[88:91], v[72:75]
    ds_read_b128 v[52:55], v17 offset:23552
    v_mfma_f32_16x16x32_bf16 v[76:79], v[60:63], a[92:95], v[76:79]
    s_mov_b64 exec, s[44:45]
    buffer_store_dwordx4 v[24:27], v28, s[8:11], s46 offen sc1
    s_mov_b64 exec, -1
    s_waitcnt lgkmcnt(4)
    v_mfma_f32_16x16x32_bf16 v[64:67], v[32:35], a[96:99], v[64:67]
    ds_read_b128 v[56:59], v18 offset:7168
    s_add_u32 m0, s29, 104576
    v_mfma_f32_16x16x32_bf16 v[68:71], v[32:35], a[100:103], v[68:71]
    buffer_load_dwordx4 v16, s[16:19], s34 offen offset:896 lds
    v_mfma_f32_16x16x32_bf16 v[72:75], v[36:39], a[96:99], v[72:75]
    ds_read_b128 v[60:63], v18 offset:23552
    v_mfma_f32_16x16x32_bf16 v[76:79], v[36:39], a[100:103], v[76:79]
    s_waitcnt lgkmcnt(4)
    v_mfma_f32_16x16x32_bf16 v[64:67], v[40:43], a[104:107], v[64:67]
    s_add_u32 s34, s34, 64512
    s_min_u32 s34, s34, 4128768
    v_mfma_f32_16x16x32_bf16 v[68:71], v[40:43], a[108:111], v[68:71]
    v_mfma_f32_16x16x32_bf16 v[72:75], v[44:47], a[104:107], v[72:75]
    v_mfma_f32_16x16x32_bf16 v[76:79], v[44:47], a[108:111], v[76:79]
    s_waitcnt lgkmcnt(0)
    s_waitcnt vmcnt(19)
    s_barrier
    ds_read_b128 v[32:35], v17 offset:32768
    ds_read_b128 v[36:39], v17 offset:49152
    v_mfma_f32_16x16x32_bf16 v[64:67], v[48:51], a[112:115], v[64:67]
    ds_read_b128 v[40:43], v18 offset:32768
    s_add_u32 m0, s29, 0
    v_mfma_f32_16x16x32_bf16 v[68:71], v[48:51], a[116:119], v[68:71]
    buffer_load_dwordx4 v16, s[16:19], s34 offen offset:0 lds
    v_mfma_f32_16x16x32_bf16 v[72:75], v[52:55], a[112:115], v[72:75]
    ds_read_b128 v[44:47], v18 offset:49152
    v_mfma_f32_16x16x32_bf16 v[76:79], v[52:55], a[116:119], v[76:79]
    v_mfma_f32_16x16x32_bf16 v[64:67], v[56:59], a[120:123], v[64:67]
    ds_read_b128 v[48:51], v17 offset:33792
    v_mfma_f32_16x16x32_bf16 v[68:71], v[56:59], a[124:127], v[68:71]
    v_mfma_f32_16x16x32_bf16 v[72:75], v[60:63], a[120:123], v[72:75]
    ds_read_b128 v[52:55], v17 offset:50176
    v_mfma_f32_16x16x32_bf16 v[76:79], v[60:63], a[124:127], v[76:79]
    s_waitcnt lgkmcnt(4)
    v_mfma_f32_16x16x32_bf16 v[64:67], v[32:35], a[128:131], v[64:67]
    ds_read_b128 v[56:59], v18 offset:33792
    s_add_u32 m0, s29, 896
    v_mfma_f32_16x16x32_bf16 v[68:71], v[32:35], a[132:135], v[68:71]
    buffer_load_dwordx4 v16, s[16:19], s34 offen offset:128 lds
    v_mfma_f32_16x16x32_bf16 v[72:75], v[36:39], a[128:131], v[72:75]
    ds_read_b128 v[60:63], v18 offset:50176
    v_mfma_f32_16x16x32_bf16 v[76:79], v[36:39], a[132:135], v[76:79]
    s_waitcnt lgkmcnt(4)
    v_mfma_f32_16x16x32_bf16 v[64:67], v[40:43], a[136:139], v[64:67]
    ds_read_b128 v[32:35], v17 offset:34816
    v_mfma_f32_16x16x32_bf16 v[68:71], v[40:43], a[140:143], v[68:71]
    v_mfma_f32_16x16x32_bf16 v[72:75], v[44:47], a[136:139], v[72:75]
    ds_read_b128 v[36:39], v17 offset:51200
    v_mfma_f32_16x16x32_bf16 v[76:79], v[44:47], a[140:143], v[76:79]
    s_waitcnt lgkmcnt(4)
    v_mfma_f32_16x16x32_bf16 v[64:67], v[48:51], a[144:147], v[64:67]
    ds_read_b128 v[40:43], v18 offset:34816
    s_add_u32 m0, s29, 1792
    v_mfma_f32_16x16x32_bf16 v[68:71], v[48:51], a[148:151], v[68:71]
    buffer_load_dwordx4 v16, s[16:19], s34 offen offset:256 lds
    v_mfma_f32_16x16x32_bf16 v[72:75], v[52:55], a[144:147], v[72:75]
    ds_read_b128 v[44:47], v18 offset:51200
    v_mfma_f32_16x16x32_bf16 v[76:79], v[52:55], a[148:151], v[76:79]
    s_waitcnt lgkmcnt(4)
    v_mfma_f32_16x16x32_bf16 v[64:67], v[56:59], a[152:155], v[64:67]
    ds_read_b128 v[48:51], v17 offset:35840
    v_mfma_f32_16x16x32_bf16 v[68:71], v[56:59], a[156:159], v[68:71]
    v_mfma_f32_16x16x32_bf16 v[72:75], v[60:63], a[152:155], v[72:75]
    ds_read_b128 v[52:55], v17 offset:52224
    v_mfma_f32_16x16x32_bf16 v[76:79], v[60:63], a[156:159], v[76:79]
    s_waitcnt lgkmcnt(4)
    v_mfma_f32_16x16x32_bf16 v[64:67], v[32:35], a[160:163], v[64:67]
    ds_read_b128 v[56:59], v18 offset:35840
    s_add_u32 m0, s29, 2688
    v_mfma_f32_16x16x32_bf16 v[68:71], v[32:35], a[164:167], v[68:71]
    buffer_load_dwordx4 v16, s[16:19], s34 offen offset:384 lds
    v_mfma_f32_16x16x32_bf16 v[72:75], v[36:39], a[160:163], v[72:75]
    ds_read_b128 v[60:63], v18 offset:52224
    v_mfma_f32_16x16x32_bf16 v[76:79], v[36:39], a[164:167], v[76:79]
    s_waitcnt lgkmcnt(4)
    v_mfma_f32_16x16x32_bf16 v[64:67], v[40:43], a[168:171], v[64:67]
    ds_read_b128 v[32:35], v17 offset:36864
    v_mfma_f32_16x16x32_bf16 v[68:71], v[40:43], a[172:175], v[68:71]
    v_mfma_f32_16x16x32_bf16 v[72:75], v[44:47], a[168:171], v[72:75]
    ds_read_b128 v[36:39], v17 offset:53248
    v_mfma_f32_16x16x32_bf16 v[76:79], v[44:47], a[172:175], v[76:79]
    s_waitcnt lgkmcnt(4)
    v_mfma_f32_16x16x32_bf16 v[64:67], v[48:51], a[176:179], v[64:67]
    ds_read_b128 v[40:43], v18 offset:36864
    s_add_u32 m0, s29, 3584
    v_mfma_f32_16x16x32_bf16 v[68:71], v[48:51], a[180:183], v[68:71]
    buffer_load_dwordx4 v16, s[16:19], s34 offen offset:512 lds
    v_mfma_f32_16x16x32_bf16 v[72:75], v[52:55], a[176:179], v[72:75]
    ds_read_b128 v[44:47], v18 offset:53248
    v_mfma_f32_16x16x32_bf16 v[76:79], v[52:55], a[180:183], v[76:79]
    s_waitcnt lgkmcnt(4)
    v_mfma_f32_16x16x32_bf16 v[64:67], v[56:59], a[184:187], v[64:67]
    ds_read_b128 v[48:51], v17 offset:37888
    v_mfma_f32_16x16x32_bf16 v[68:71], v[56:59], a[188:191], v[68:71]
    v_mfma_f32_16x16x32_bf16 v[72:75], v[60:63], a[184:187], v[72:75]
    ds_read_b128 v[52:55], v17 offset:54272
    v_mfma_f32_16x16x32_bf16 v[76:79], v[60:63], a[188:191], v[76:79]
    s_waitcnt lgkmcnt(4)
    v_mfma_f32_16x16x32_bf16 v[64:67], v[32:35], a[192:195], v[64:67]
    ds_read_b128 v[56:59], v18 offset:37888
    s_add_u32 m0, s29, 4480
    v_mfma_f32_16x16x32_bf16 v[68:71], v[32:35], a[196:199], v[68:71]
    buffer_load_dwordx4 v16, s[16:19], s34 offen offset:640 lds
    v_mfma_f32_16x16x32_bf16 v[72:75], v[36:39], a[192:195], v[72:75]
    ds_read_b128 v[60:63], v18 offset:54272
    v_mfma_f32_16x16x32_bf16 v[76:79], v[36:39], a[196:199], v[76:79]
    s_waitcnt lgkmcnt(4)
    v_mfma_f32_16x16x32_bf16 v[64:67], v[40:43], a[200:203], v[64:67]
    ds_read_b128 v[32:35], v17 offset:38912
    v_mfma_f32_16x16x32_bf16 v[68:71], v[40:43], a[204:207], v[68:71]
    v_mfma_f32_16x16x32_bf16 v[72:75], v[44:47], a[200:203], v[72:75]
    ds_read_b128 v[36:39], v17 offset:55296
    v_mfma_f32_16x16x32_bf16 v[76:79], v[44:47], a[204:207], v[76:79]
    s_waitcnt lgkmcnt(4)
    v_mfma_f32_16x16x32_bf16 v[64:67], v[48:51], a[208:211], v[64:67]
    ds_read_b128 v[40:43], v18 offset:38912
    s_add_u32 m0, s29, 5376
    v_mfma_f32_16x16x32_bf16 v[68:71], v[48:51], a[212:215], v[68:71]
    buffer_load_dwordx4 v16, s[16:19], s34 offen offset:768 lds
    v_mfma_f32_16x16x32_bf16 v[72:75], v[52:55], a[208:211], v[72:75]
    ds_read_b128 v[44:47], v18 offset:55296
    v_mfma_f32_16x16x32_bf16 v[76:79], v[52:55], a[212:215], v[76:79]
    s_waitcnt lgkmcnt(4)
    v_mfma_f32_16x16x32_bf16 v[64:67], v[56:59], a[216:219], v[64:67]
    ds_read_b128 v[48:51], v17 offset:39936
    v_mfma_f32_16x16x32_bf16 v[68:71], v[56:59], a[220:223], v[68:71]
    v_mfma_f32_16x16x32_bf16 v[72:75], v[60:63], a[216:219], v[72:75]
    ds_read_b128 v[52:55], v17 offset:56320
    v_mfma_f32_16x16x32_bf16 v[76:79], v[60:63], a[220:223], v[76:79]
    s_mov_b64 exec, s[44:45]
    buffer_store_dwordx4 v[24:27], v29, s[8:11], s46 offen sc1
    s_mov_b64 exec, -1
    s_waitcnt lgkmcnt(4)
    v_mfma_f32_16x16x32_bf16 v[64:67], v[32:35], a[224:227], v[64:67]
    ds_read_b128 v[56:59], v18 offset:39936
    s_add_u32 m0, s29, 6272
    v_mfma_f32_16x16x32_bf16 v[68:71], v[32:35], a[228:231], v[68:71]
    buffer_load_dwordx4 v16, s[16:19], s34 offen offset:896 lds
    v_mfma_f32_16x16x32_bf16 v[72:75], v[36:39], a[224:227], v[72:75]
    ds_read_b128 v[60:63], v18 offset:56320
    v_mfma_f32_16x16x32_bf16 v[76:79], v[36:39], a[228:231], v[76:79]
    s_waitcnt lgkmcnt(4)
    v_mfma_f32_16x16x32_bf16 v[64:67], v[40:43], a[232:235], v[64:67]
    s_add_u32 s34, s34, 1024
    v_mfma_f32_16x16x32_bf16 v[68:71], v[40:43], a[236:239], v[68:71]
    v_mfma_f32_16x16x32_bf16 v[72:75], v[44:47], a[232:235], v[72:75]
    v_mfma_f32_16x16x32_bf16 v[76:79], v[44:47], a[236:239], v[76:79]
    s_waitcnt lgkmcnt(0)
    s_waitcnt vmcnt(10)
    s_barrier
    ds_read_b128 v[32:35], v19 offset:0
    ds_read_b128 v[36:39], v19 offset:16384
    v_mfma_f32_16x16x32_bf16 v[64:67], v[48:51], a[240:243], v[64:67]
    ds_read_b128 v[40:43], v20 offset:0
    s_add_u32 m0, s29, 32768
    v_mfma_f32_16x16x32_bf16 v[68:71], v[48:51], a[244:247], v[68:71]
    buffer_load_dwordx4 v16, s[16:19], s34 offen offset:0 lds
    v_mfma_f32_16x16x32_bf16 v[72:75], v[52:55], a[240:243], v[72:75]
    ds_read_b128 v[44:47], v20 offset:16384
    v_mfma_f32_16x16x32_bf16 v[76:79], v[52:55], a[244:247], v[76:79]
    v_mfma_f32_16x16x32_bf16 v[64:67], v[56:59], a[248:251], v[64:67]
    ds_read_b128 v[48:51], v19 offset:1024
    v_mfma_f32_16x16x32_bf16 v[68:71], v[56:59], a[252:255], v[68:71]
    v_mfma_f32_16x16x32_bf16 v[72:75], v[60:63], a[248:251], v[72:75]
    ds_read_b128 v[52:55], v19 offset:17408
    v_mfma_f32_16x16x32_bf16 v[76:79], v[60:63], a[252:255], v[76:79]
    s_mov_b64 exec, s[36:37]
    buffer_store_dword v23, v22, s[8:11], s33 offen sc1
    s_mov_b64 exec, -1

    s_waitcnt lgkmcnt(4)
    v_mfma_f32_16x16x32_bf16 v[80:83], v[32:35], a[0:3], 0
    ds_read_b128 v[56:59], v20 offset:1024
    s_add_u32 m0, s29, 33664
    v_mfma_f32_16x16x32_bf16 v[84:87], v[32:35], a[4:7], 0
    buffer_load_dwordx4 v16, s[16:19], s34 offen offset:128 lds
    v_mfma_f32_16x16x32_bf16 v[88:91], v[36:39], a[0:3], 0
    ds_read_b128 v[60:63], v20 offset:17408
    v_mfma_f32_16x16x32_bf16 v[92:95], v[36:39], a[4:7], 0
    s_waitcnt lgkmcnt(4)
    v_mfma_f32_16x16x32_bf16 v[80:83], v[40:43], a[8:11], v[80:83]
    ds_read_b128 v[32:35], v19 offset:2048
    v_mfma_f32_16x16x32_bf16 v[84:87], v[40:43], a[12:15], v[84:87]
    v_cvt_pk_bf16_f32 v96, v64, v65
    v_cvt_pk_bf16_f32 v97, v66, v67
    v_mfma_f32_16x16x32_bf16 v[88:91], v[44:47], a[8:11], v[88:91]
    ds_read_b128 v[36:39], v19 offset:18432
    v_mfma_f32_16x16x32_bf16 v[92:95], v[44:47], a[12:15], v[92:95]
    v_cvt_pk_bf16_f32 v98, v72, v73
    v_cvt_pk_bf16_f32 v99, v74, v75
    s_waitcnt lgkmcnt(4)
    v_mfma_f32_16x16x32_bf16 v[80:83], v[48:51], a[16:19], v[80:83]
    ds_read_b128 v[40:43], v20 offset:2048
    s_add_u32 m0, s29, 34560
    v_mfma_f32_16x16x32_bf16 v[84:87], v[48:51], a[20:23], v[84:87]
    buffer_load_dwordx4 v16, s[16:19], s34 offen offset:256 lds
    v_mfma_f32_16x16x32_bf16 v[88:91], v[52:55], a[16:19], v[88:91]
    ds_read_b128 v[44:47], v20 offset:18432
    v_mfma_f32_16x16x32_bf16 v[92:95], v[52:55], a[20:23], v[92:95]
    s_waitcnt lgkmcnt(4)
    v_mfma_f32_16x16x32_bf16 v[80:83], v[56:59], a[24:27], v[80:83]
    ds_read_b128 v[48:51], v19 offset:3072
    v_mfma_f32_16x16x32_bf16 v[84:87], v[56:59], a[28:31], v[84:87]
    buffer_store_dwordx4 v[96:99], v21, s[8:11], s32 offen offset:0 sc1
    v_mfma_f32_16x16x32_bf16 v[88:91], v[60:63], a[24:27], v[88:91]
    ds_read_b128 v[52:55], v19 offset:19456
    v_mfma_f32_16x16x32_bf16 v[92:95], v[60:63], a[28:31], v[92:95]
    s_waitcnt lgkmcnt(4)
    v_mfma_f32_16x16x32_bf16 v[80:83], v[32:35], a[32:35], v[80:83]
    ds_read_b128 v[56:59], v20 offset:3072
    s_add_u32 m0, s29, 35456
    v_mfma_f32_16x16x32_bf16 v[84:87], v[32:35], a[36:39], v[84:87]
    buffer_load_dwordx4 v16, s[16:19], s34 offen offset:384 lds
    v_mfma_f32_16x16x32_bf16 v[88:91], v[36:39], a[32:35], v[88:91]
    ds_read_b128 v[60:63], v20 offset:19456
    v_mfma_f32_16x16x32_bf16 v[92:95], v[36:39], a[36:39], v[92:95]
    s_waitcnt lgkmcnt(4)
    v_mfma_f32_16x16x32_bf16 v[80:83], v[40:43], a[40:43], v[80:83]
    ds_read_b128 v[32:35], v19 offset:4096
    v_mfma_f32_16x16x32_bf16 v[84:87], v[40:43], a[44:47], v[84:87]
    v_cvt_pk_bf16_f32 v100, v68, v69
    v_cvt_pk_bf16_f32 v101, v70, v71
    v_mfma_f32_16x16x32_bf16 v[88:91], v[44:47], a[40:43], v[88:91]
    ds_read_b128 v[36:39], v19 offset:20480
    v_mfma_f32_16x16x32_bf16 v[92:95], v[44:47], a[44:47], v[92:95]
    v_cvt_pk_bf16_f32 v102, v76, v77
    v_cvt_pk_bf16_f32 v103, v78, v79
    s_waitcnt lgkmcnt(4)
    v_mfma_f32_16x16x32_bf16 v[80:83], v[48:51], a[48:51], v[80:83]
    ds_read_b128 v[40:43], v20 offset:4096
    s_add_u32 m0, s29, 36352
    v_mfma_f32_16x16x32_bf16 v[84:87], v[48:51], a[52:55], v[84:87]
    buffer_load_dwordx4 v16, s[16:19], s34 offen offset:512 lds
    v_mfma_f32_16x16x32_bf16 v[88:91], v[52:55], a[48:51], v[88:91]
    ds_read_b128 v[44:47], v20 offset:20480
    v_mfma_f32_16x16x32_bf16 v[92:95], v[52:55], a[52:55], v[92:95]
    s_waitcnt lgkmcnt(4)
    v_mfma_f32_16x16x32_bf16 v[80:83], v[56:59], a[56:59], v[80:83]
    ds_read_b128 v[48:51], v19 offset:5120
    v_mfma_f32_16x16x32_bf16 v[84:87], v[56:59], a[60:63], v[84:87]
    buffer_store_dwordx4 v[100:103], v21, s[8:11], s32 offen offset:1024 sc1
    v_mfma_f32_16x16x32_bf16 v[88:91], v[60:63], a[56:59], v[88:91]
    ds_read_b128 v[52:55], v19 offset:21504
    v_mfma_f32_16x16x32_bf16 v[92:95], v[60:63], a[60:63], v[92:95]
    s_waitcnt lgkmcnt(4)
    v_mfma_f32_16x16x32_bf16 v[80:83], v[32:35], a[64:67], v[80:83]
    ds_read_b128 v[56:59], v20 offset:5120
    s_add_u32 m0, s29, 37248
    v_mfma_f32_16x16x32_bf16 v[84:87], v[32:35], a[68:71], v[84:87]
    buffer_load_dwordx4 v16, s[16:19], s34 offen offset:640 lds
    v_mfma_f32_16x16x32_bf16 v[88:91], v[36:39], a[64:67], v[88:91]
    ds_read_b128 v[60:63], v20 offset:21504
    v_mfma_f32_16x16x32_bf16 v[92:95], v[36:39], a[68:71], v[92:95]
    s_mov_b32 exec_hi, 0
    buffer_store_dwordx4 v[24:27], v21, s[8:11], s48 offen sc1
    s_mov_b32 exec_hi, -1

    s_waitcnt lgkmcnt(4)
    v_mfma_f32_16x16x32_bf16 v[80:83], v[40:43], a[72:75], v[80:83]
    ds_read_b128 v[32:35], v19 offset:6144
    v_mfma_f32_16x16x32_bf16 v[84:87], v[40:43], a[76:79], v[84:87]
    s_mov_b32 s32, s39
    s_add_u32 s38, s39, 4096
    s_add_u32 s39, s39, 262144
    s_mov_b32 s48, s49
    s_add_u32 s49, s49, 196608
    v_mfma_f32_16x16x32_bf16 v[88:91], v[44:47], a[72:75], v[88:91]
    ds_read_b128 v[36:39], v19 offset:22528
    v_mfma_f32_16x16x32_bf16 v[92:95], v[44:47], a[76:79], v[92:95]
    v_add_u32 v23, 1, v23
    s_waitcnt lgkmcnt(4)
    v_mfma_f32_16x16x32_bf16 v[80:83], v[48:51], a[80:83], v[80:83]
    ds_read_b128 v[40:43], v20 offset:6144
    s_add_u32 m0, s29, 38144
    v_mfma_f32_16x16x32_bf16 v[84:87], v[48:51], a[84:87], v[84:87]
    buffer_load_dwordx4 v16, s[16:19], s34 offen offset:768 lds
    v_mfma_f32_16x16x32_bf16 v[88:91], v[52:55], a[80:83], v[88:91]
    ds_read_b128 v[44:47], v20 offset:22528
    v_mfma_f32_16x16x32_bf16 v[92:95], v[52:55], a[84:87], v[92:95]
    s_waitcnt lgkmcnt(4)
    v_mfma_f32_16x16x32_bf16 v[80:83], v[56:59], a[88:91], v[80:83]
    ds_read_b128 v[48:51], v19 offset:7168
    v_mfma_f32_16x16x32_bf16 v[84:87], v[56:59], a[92:95], v[84:87]
    v_mfma_f32_16x16x32_bf16 v[88:91], v[60:63], a[88:91], v[88:91]
    ds_read_b128 v[52:55], v19 offset:23552
    v_mfma_f32_16x16x32_bf16 v[92:95], v[60:63], a[92:95], v[92:95]
    s_mov_b64 exec, s[44:45]
    buffer_store_dwordx4 v[24:27], v30, s[8:11], s46 offen sc1
    s_mov_b64 exec, -1
    s_waitcnt lgkmcnt(4)
    v_mfma_f32_16x16x32_bf16 v[80:83], v[32:35], a[96:99], v[80:83]
    ds_read_b128 v[56:59], v20 offset:7168
    s_add_u32 m0, s29, 39040
    v_mfma_f32_16x16x32_bf16 v[84:87], v[32:35], a[100:103], v[84:87]
    buffer_load_dwordx4 v16, s[16:19], s34 offen offset:896 lds
    v_mfma_f32_16x16x32_bf16 v[88:91], v[36:39], a[96:99], v[88:91]
    ds_read_b128 v[60:63], v20 offset:23552
    v_mfma_f32_16x16x32_bf16 v[92:95], v[36:39], a[100:103], v[92:95]
    s_waitcnt lgkmcnt(4)
    v_mfma_f32_16x16x32_bf16 v[80:83], v[40:43], a[104:107], v[80:83]
    s_add_u32 s34, s34, 64512
    s_min_u32 s34, s34, 4128768
    v_mfma_f32_16x16x32_bf16 v[84:87], v[40:43], a[108:111], v[84:87]
    v_mfma_f32_16x16x32_bf16 v[88:91], v[44:47], a[104:107], v[88:91]
    v_mfma_f32_16x16x32_bf16 v[92:95], v[44:47], a[108:111], v[92:95]
    s_waitcnt lgkmcnt(0)
    s_waitcnt vmcnt(19)
    s_barrier
    ds_read_b128 v[32:35], v19 offset:32768
    ds_read_b128 v[36:39], v19 offset:49152
    v_mfma_f32_16x16x32_bf16 v[80:83], v[48:51], a[112:115], v[80:83]
    ds_read_b128 v[40:43], v20 offset:32768
    s_add_u32 m0, s29, 65536
    v_mfma_f32_16x16x32_bf16 v[84:87], v[48:51], a[116:119], v[84:87]
    buffer_load_dwordx4 v16, s[16:19], s34 offen offset:0 lds
    v_mfma_f32_16x16x32_bf16 v[88:91], v[52:55], a[112:115], v[88:91]
    ds_read_b128 v[44:47], v20 offset:49152
    v_mfma_f32_16x16x32_bf16 v[92:95], v[52:55], a[116:119], v[92:95]
    v_mfma_f32_16x16x32_bf16 v[80:83], v[56:59], a[120:123], v[80:83]
    ds_read_b128 v[48:51], v19 offset:33792
    v_mfma_f32_16x16x32_bf16 v[84:87], v[56:59], a[124:127], v[84:87]
    v_mfma_f32_16x16x32_bf16 v[88:91], v[60:63], a[120:123], v[88:91]
    ds_read_b128 v[52:55], v19 offset:50176
    v_mfma_f32_16x16x32_bf16 v[92:95], v[60:63], a[124:127], v[92:95]
    s_waitcnt lgkmcnt(4)
    v_mfma_f32_16x16x32_bf16 v[80:83], v[32:35], a[128:131], v[80:83]
    ds_read_b128 v[56:59], v20 offset:33792
    s_add_u32 m0, s29, 66432
    v_mfma_f32_16x16x32_bf16 v[84:87], v[32:35], a[132:135], v[84:87]
    buffer_load_dwordx4 v16, s[16:19], s34 offen offset:128 lds
    v_mfma_f32_16x16x32_bf16 v[88:91], v[36:39], a[128:131], v[88:91]
    ds_read_b128 v[60:63], v20 offset:50176
    v_mfma_f32_16x16x32_bf16 v[92:95], v[36:39], a[132:135], v[92:95]
    s_waitcnt lgkmcnt(4)
    v_mfma_f32_16x16x32_bf16 v[80:83], v[40:43], a[136:139], v[80:83]
    ds_read_b128 v[32:35], v19 offset:34816
    v_mfma_f32_16x16x32_bf16 v[84:87], v[40:43], a[140:143], v[84:87]
    v_mfma_f32_16x16x32_bf16 v[88:91], v[44:47], a[136:139], v[88:91]
    ds_read_b128 v[36:39], v19 offset:51200
    v_mfma_f32_16x16x32_bf16 v[92:95], v[44:47], a[140:143], v[92:95]
    s_waitcnt lgkmcnt(4)
    v_mfma_f32_16x16x32_bf16 v[80:83], v[48:51], a[144:147], v[80:83]
    ds_read_b128 v[40:43], v20 offset:34816
    s_add_u32 m0, s29, 67328
    v_mfma_f32_16x16x32_bf16 v[84:87], v[48:51], a[148:151], v[84:87]
    buffer_load_dwordx4 v16, s[16:19], s34 offen offset:256 lds
    v_mfma_f32_16x16x32_bf16 v[88:91], v[52:55], a[144:147], v[88:91]
    ds_read_b128 v[44:47], v20 offset:51200
    v_mfma_f32_16x16x32_bf16 v[92:95], v[52:55], a[148:151], v[92:95]
    s_waitcnt lgkmcnt(4)
    v_mfma_f32_16x16x32_bf16 v[80:83], v[56:59], a[152:155], v[80:83]
    ds_read_b128 v[48:51], v19 offset:35840
    v_mfma_f32_16x16x32_bf16 v[84:87], v[56:59], a[156:159], v[84:87]
    v_mfma_f32_16x16x32_bf16 v[88:91], v[60:63], a[152:155], v[88:91]
    ds_read_b128 v[52:55], v19 offset:52224
    v_mfma_f32_16x16x32_bf16 v[92:95], v[60:63], a[156:159], v[92:95]
    s_waitcnt lgkmcnt(4)
    v_mfma_f32_16x16x32_bf16 v[80:83], v[32:35], a[160:163], v[80:83]
    ds_read_b128 v[56:59], v20 offset:35840
    s_add_u32 m0, s29, 68224
    v_mfma_f32_16x16x32_bf16 v[84:87], v[32:35], a[164:167], v[84:87]
    buffer_load_dwordx4 v16, s[16:19], s34 offen offset:384 lds
    v_mfma_f32_16x16x32_bf16 v[88:91], v[36:39], a[160:163], v[88:91]
    ds_read_b128 v[60:63], v20 offset:52224
    v_mfma_f32_16x16x32_bf16 v[92:95], v[36:39], a[164:167], v[92:95]
    s_waitcnt lgkmcnt(4)
    v_mfma_f32_16x16x32_bf16 v[80:83], v[40:43], a[168:171], v[80:83]
    ds_read_b128 v[32:35], v19 offset:36864
    v_mfma_f32_16x16x32_bf16 v[84:87], v[40:43], a[172:175], v[84:87]
    v_mfma_f32_16x16x32_bf16 v[88:91], v[44:47], a[168:171], v[88:91]
    ds_read_b128 v[36:39], v19 offset:53248
    v_mfma_f32_16x16x32_bf16 v[92:95], v[44:47], a[172:175], v[92:95]
    s_waitcnt lgkmcnt(4)
    v_mfma_f32_16x16x32_bf16 v[80:83], v[48:51], a[176:179], v[80:83]
    ds_read_b128 v[40:43], v20 offset:36864
    s_add_u32 m0, s29, 69120
    v_mfma_f32_16x16x32_bf16 v[84:87], v[48:51], a[180:183], v[84:87]
    buffer_load_dwordx4 v16, s[16:19], s34 offen offset:512 lds
    v_mfma_f32_16x16x32_bf16 v[88:91], v[52:55], a[176:179], v[88:91]
    ds_read_b128 v[44:47], v20 offset:53248
    v_mfma_f32_16x16x32_bf16 v[92:95], v[52:55], a[180:183], v[92:95]
    s_waitcnt lgkmcnt(4)
    v_mfma_f32_16x16x32_bf16 v[80:83], v[56:59], a[184:187], v[80:83]
    ds_read_b128 v[48:51], v19 offset:37888
    v_mfma_f32_16x16x32_bf16 v[84:87], v[56:59], a[188:191], v[84:87]
    v_mfma_f32_16x16x32_bf16 v[88:91], v[60:63], a[184:187], v[88:91]
    ds_read_b128 v[52:55], v19 offset:54272
    v_mfma_f32_16x16x32_bf16 v[92:95], v[60:63], a[188:191], v[92:95]
    s_waitcnt lgkmcnt(4)
    v_mfma_f32_16x16x32_bf16 v[80:83], v[32:35], a[192:195], v[80:83]
    ds_read_b128 v[56:59], v20 offset:37888
    s_add_u32 m0, s29, 70016
    v_mfma_f32_16x16x32_bf16 v[84:87], v[32:35], a[196:199], v[84:87]
    buffer_load_dwordx4 v16, s[16:19], s34 offen offset:640 lds
    v_mfma_f32_16x16x32_bf16 v[88:91], v[36:39], a[192:195], v[88:91]
    ds_read_b128 v[60:63], v20 offset:54272
    v_mfma_f32_16x16x32_bf16 v[92:95], v[36:39], a[196:199], v[92:95]
    s_waitcnt lgkmcnt(4)
    v_mfma_f32_16x16x32_bf16 v[80:83], v[40:43], a[200:203], v[80:83]
    ds_read_b128 v[32:35], v19 offset:38912
    v_mfma_f32_16x16x32_bf16 v[84:87], v[40:43], a[204:207], v[84:87]
    v_mfma_f32_16x16x32_bf16 v[88:91], v[44:47], a[200:203], v[88:91]
    ds_read_b128 v[36:39], v19 offset:55296
    v_mfma_f32_16x16x32_bf16 v[92:95], v[44:47], a[204:207], v[92:95]
    s_waitcnt lgkmcnt(4)
    v_mfma_f32_16x16x32_bf16 v[80:83], v[48:51], a[208:211], v[80:83]
    ds_read_b128 v[40:43], v20 offset:38912
    s_add_u32 m0, s29, 70912
    v_mfma_f32_16x16x32_bf16 v[84:87], v[48:51], a[212:215], v[84:87]
    buffer_load_dwordx4 v16, s[16:19], s34 offen offset:768 lds
    v_mfma_f32_16x16x32_bf16 v[88:91], v[52:55], a[208:211], v[88:91]
    ds_read_b128 v[44:47], v20 offset:55296
    v_mfma_f32_16x16x32_bf16 v[92:95], v[52:55], a[212:215], v[92:95]
    s_waitcnt lgkmcnt(4)
    v_mfma_f32_16x16x32_bf16 v[80:83], v[56:59], a[216:219], v[80:83]
    ds_read_b128 v[48:51], v19 offset:39936
    v_mfma_f32_16x16x32_bf16 v[84:87], v[56:59], a[220:223], v[84:87]
    s_cmp_lt_u32 s35, 21
    s_cselect_b64 s[44:45], -1, 0
    v_mfma_f32_16x16x32_bf16 v[88:91], v[60:63], a[216:219], v[88:91]
    ds_read_b128 v[52:55], v19 offset:56320
    v_mfma_f32_16x16x32_bf16 v[92:95], v[60:63], a[220:223], v[92:95]
    s_cselect_b32 s4, 0x10000, 0
    s_add_u32 s46, s46, s4
    s_waitcnt lgkmcnt(4)
    v_mfma_f32_16x16x32_bf16 v[80:83], v[32:35], a[224:227], v[80:83]
    ds_read_b128 v[56:59], v20 offset:39936
    s_add_u32 m0, s29, 71808
    v_mfma_f32_16x16x32_bf16 v[84:87], v[32:35], a[228:231], v[84:87]
    buffer_load_dwordx4 v16, s[16:19], s34 offen offset:896 lds
    v_mfma_f32_16x16x32_bf16 v[88:91], v[36:39], a[224:227], v[88:91]
    ds_read_b128 v[60:63], v20 offset:56320
    v_mfma_f32_16x16x32_bf16 v[92:95], v[36:39], a[228:231], v[92:95]
    s_waitcnt lgkmcnt(4)
    v_mfma_f32_16x16x32_bf16 v[80:83], v[40:43], a[232:235], v[80:83]
    s_add_u32 s34, s34, 1024
    v_mfma_f32_16x16x32_bf16 v[84:87], v[40:43], a[236:239], v[84:87]
    v_mfma_f32_16x16x32_bf16 v[88:91], v[44:47], a[232:235], v[88:91]
    v_mfma_f32_16x16x32_bf16 v[92:95], v[44:47], a[236:239], v[92:95]
    s_waitcnt lgkmcnt(0)
    s_waitcnt vmcnt(10)
    s_barrier
    ds_read_b128 v[32:35], v17 offset:0
    ds_read_b128 v[36:39], v17 offset:16384
    v_mfma_f32_16x16x32_bf16 v[80:83], v[48:51], a[240:243], v[80:83]
    ds_read_b128 v[40:43], v18 offset:0
    s_add_u32 m0, s29, 98304
    v_mfma_f32_16x16x32_bf16 v[84:87], v[48:51], a[244:247], v[84:87]
    buffer_load_dwordx4 v16, s[16:19], s34 offen offset:0 lds
    v_mfma_f32_16x16x32_bf16 v[88:91], v[52:55], a[240:243], v[88:91]
    ds_read_b128 v[44:47], v18 offset:16384
    v_mfma_f32_16x16x32_bf16 v[92:95], v[52:55], a[244:247], v[92:95]
    v_mfma_f32_16x16x32_bf16 v[80:83], v[56:59], a[248:251], v[80:83]
    ds_read_b128 v[48:51], v17 offset:1024
    v_mfma_f32_16x16x32_bf16 v[84:87], v[56:59], a[252:255], v[84:87]
    v_mfma_f32_16x16x32_bf16 v[88:91], v[60:63], a[248:251], v[88:91]
    ds_read_b128 v[52:55], v17 offset:17408
    v_mfma_f32_16x16x32_bf16 v[92:95], v[60:63], a[252:255], v[92:95]
    s_mov_b64 exec, s[36:37]
    buffer_store_dword v23, v22, s[8:11], s33 offen sc1
    s_mov_b64 exec, -1

    s_add_u32 s35, s35, 1
    s_cmp_lt_u32 s35, 32
    s_cbranch_scc1 .ql_382

    s_nop 7
    v_cvt_pk_bf16_f32 v96, v80, v81
    v_cvt_pk_bf16_f32 v97, v82, v83
    v_cvt_pk_bf16_f32 v98, v88, v89
    v_cvt_pk_bf16_f32 v99, v90, v91
    buffer_store_dwordx4 v[96:99], v21, s[8:11], s32 offen offset:0 sc1
    v_cvt_pk_bf16_f32 v100, v84, v85
    v_cvt_pk_bf16_f32 v101, v86, v87
    v_cvt_pk_bf16_f32 v102, v92, v93
    v_cvt_pk_bf16_f32 v103, v94, v95
    buffer_store_dwordx4 v[100:103], v21, s[8:11], s32 offen offset:1024 sc1
    s_mov_b32 exec_hi, 0
    buffer_store_dwordx4 v[24:27], v21, s[8:11], s48 offen sc1
    s_mov_b32 exec_hi, -1

    v_mov_b32 v23, 64
    s_waitcnt vmcnt(0) lgkmcnt(0)
    s_barrier
    s_mov_b64 exec, s[36:37]
    buffer_store_dword v23, v22, s[8:11], s33 offen sc1
    s_mov_b64 exec, -1

.qd_379:
    s_load_dwordx2 s[40:41], s[0:1], 88
    s_load_dwordx2 s[42:43], s[0:1], 112
    s_and_b32 s4, s33, 0xffffe7ff
    s_mov_b32 s57, s4
    s_mov_b32 s34, s47
    s_and_b32 s30, s26, 7
    s_lshr_b32 s31, s26, 3
    s_lshl_b32 s28, s91, 21
    s_lshl_b32 s4, s30, 8
    s_add_u32 s28, s28, s4
    s_waitcnt lgkmcnt(0)

    s_mov_b32 s12, s40
    s_and_b32 s13, s41, 0xffff
    s_mov_b32 s14, 0x800000
    s_mov_b32 s15, 0x00020000

    s_mov_b32 s44, s42
    s_and_b32 s45, s43, 0xffff
    s_mov_b32 s46, 0x400000
    s_mov_b32 s47, 0x00020000

    v_lshrrev_b32 v4, 1, v2
    v_xor_b32 v4, v4, v3
    v_lshlrev_b32 v4, 1, v4
    v_and_b32 v5, 1, v1
    v_or_b32 v4, v4, v5
    v_lshlrev_b32 v4, 4, v4
    v_lshlrev_b32 v5, 11, v3
    v_add_u32 v10, v4, v5
    v_xor_b32 v11, 0x80, v10
    s_lshl_b32 s4, s24, 16
    s_add_u32 s28, s28, s4
    s_lshl_b32 s29, s24, 13
    v_lshrrev_b32 v4, 2, v2
    v_and_b32 v5, 1, v3
    v_lshl_or_b32 v5, v5, 2, v4
    s_lshl_b32 s4, s24, 1
    v_xor_b32 v5, s4, v5
    v_lshlrev_b32 v5, 5, v5
    v_lshl_add_u32 v4, v3, 2, v4
    v_lshl_add_u32 v5, v4, 8, v5
    v_and_b32 v4, 3, v2
    v_lshl_add_u32 v12, v4, 3, v5
    v_xor_b32 v13, 32, v12
    v_add_u32 v14, 0x10000, v12
    v_add_u32 v15, 0x10000, v13

    s_and_b32 s4, s91, 1
    s_lshl_b32 s4, s4, 5
    v_xor_b32 v12, s4, v12
    v_xor_b32 v13, s4, v13
    v_xor_b32 v14, s4, v14
    v_xor_b32 v15, s4, v15

    s_and_b32 s4, s26, 7
    s_lshl_b32 s4, s4, 1
    s_lshr_b32 s5, s24, 1
    s_add_u32 s4, s4, s5
    s_lshl_b32 s4, s4, 6
    v_add_u32 v4, s4, v1
    v_lshlrev_b32 v4, 11, v4
    s_and_b32 s4, s24, 1
    s_lshl_b32 s4, s4, 10
    s_lshl_b32 s5, s91, 21
    s_add_u32 s4, s4, s5
    buffer_load_dword v31, v4, s[12:15], s4 offen offset:384

    s_add_u32 m0, s29, 0
    s_add_u32 s4, s28, 0
    buffer_load_dwordx4 v10, s[12:15], s4 offen lds

    s_add_u32 m0, s29, 1024
    s_add_u32 s4, s28, 8192
    buffer_load_dwordx4 v11, s[12:15], s4 offen lds

    s_add_u32 m0, s29, 2048
    s_add_u32 s4, s28, 16384
    buffer_load_dwordx4 v10, s[12:15], s4 offen lds

    s_add_u32 m0, s29, 3072
    s_add_u32 s4, s28, 24576
    buffer_load_dwordx4 v11, s[12:15], s4 offen lds

    s_add_u32 m0, s29, 4096
    s_add_u32 s4, s28, 32768
    buffer_load_dwordx4 v10, s[12:15], s4 offen lds

    s_add_u32 m0, s29, 5120
    s_add_u32 s4, s28, 40960
    buffer_load_dwordx4 v11, s[12:15], s4 offen lds

    s_add_u32 m0, s29, 6144
    s_add_u32 s4, s28, 49152
    buffer_load_dwordx4 v10, s[12:15], s4 offen lds

    s_add_u32 m0, s29, 7168
    s_add_u32 s4, s28, 57344
    buffer_load_dwordx4 v11, s[12:15], s4 offen lds

    s_add_u32 m0, s29, 32768
    s_add_u32 s4, s28, 262144
    buffer_load_dwordx4 v10, s[12:15], s4 offen lds

    s_add_u32 m0, s29, 33792
    s_add_u32 s4, s28, 270336
    buffer_load_dwordx4 v11, s[12:15], s4 offen lds

    s_add_u32 m0, s29, 34816
    s_add_u32 s4, s28, 278528
    buffer_load_dwordx4 v10, s[12:15], s4 offen lds

    s_add_u32 m0, s29, 35840
    s_add_u32 s4, s28, 286720
    buffer_load_dwordx4 v11, s[12:15], s4 offen lds

    s_add_u32 m0, s29, 36864
    s_add_u32 s4, s28, 294912
    buffer_load_dwordx4 v10, s[12:15], s4 offen lds

    s_add_u32 m0, s29, 37888
    s_add_u32 s4, s28, 303104
    buffer_load_dwordx4 v11, s[12:15], s4 offen lds

    s_add_u32 m0, s29, 38912
    s_add_u32 s4, s28, 311296
    buffer_load_dwordx4 v10, s[12:15], s4 offen lds

    s_add_u32 m0, s29, 39936
    s_add_u32 s4, s28, 319488
    buffer_load_dwordx4 v11, s[12:15], s4 offen lds

    s_add_u32 m0, s29, 65536
    s_add_u32 s4, s28, 524288
    buffer_load_dwordx4 v10, s[12:15], s4 offen lds

    s_add_u32 m0, s29, 66560
    s_add_u32 s4, s28, 532480
    buffer_load_dwordx4 v11, s[12:15], s4 offen lds

    s_add_u32 m0, s29, 67584
    s_add_u32 s4, s28, 540672
    buffer_load_dwordx4 v10, s[12:15], s4 offen lds

    s_add_u32 m0, s29, 68608
    s_add_u32 s4, s28, 548864
    buffer_load_dwordx4 v11, s[12:15], s4 offen lds

    s_add_u32 m0, s29, 69632
    s_add_u32 s4, s28, 557056
    buffer_load_dwordx4 v10, s[12:15], s4 offen lds

    s_add_u32 m0, s29, 70656
    s_add_u32 s4, s28, 565248
    buffer_load_dwordx4 v11, s[12:15], s4 offen lds

    s_add_u32 m0, s29, 71680
    s_add_u32 s4, s28, 573440
    buffer_load_dwordx4 v10, s[12:15], s4 offen lds

    s_add_u32 m0, s29, 72704
    s_add_u32 s4, s28, 581632
    buffer_load_dwordx4 v11, s[12:15], s4 offen lds

    s_add_u32 m0, s29, 98304
    s_add_u32 s4, s28, 786432
    buffer_load_dwordx4 v10, s[12:15], s4 offen lds

    s_add_u32 m0, s29, 99328
    s_add_u32 s4, s28, 794624
    buffer_load_dwordx4 v11, s[12:15], s4 offen lds

    s_add_u32 m0, s29, 100352
    s_add_u32 s4, s28, 802816
    buffer_load_dwordx4 v10, s[12:15], s4 offen lds

    s_add_u32 m0, s29, 101376
    s_add_u32 s4, s28, 811008
    buffer_load_dwordx4 v11, s[12:15], s4 offen lds

    s_add_u32 m0, s29, 102400
    s_add_u32 s4, s28, 819200
    buffer_load_dwordx4 v10, s[12:15], s4 offen lds

    s_add_u32 m0, s29, 103424
    s_add_u32 s4, s28, 827392
    buffer_load_dwordx4 v11, s[12:15], s4 offen lds

    s_add_u32 m0, s29, 104448
    s_add_u32 s4, s28, 835584
    buffer_load_dwordx4 v10, s[12:15], s4 offen lds

    s_add_u32 m0, s29, 105472
    s_add_u32 s4, s28, 843776
    buffer_load_dwordx4 v11, s[12:15], s4 offen lds

    s_waitcnt vmcnt(24)
    s_barrier
    ds_read_b64_tr_b16 a[0:1], v12 offset:0
    ds_read_b64_tr_b16 a[2:3], v12 offset:4096
    ds_read_b64_tr_b16 a[4:5], v13 offset:0
    ds_read_b64_tr_b16 a[6:7], v13 offset:4096
    ds_read_b64_tr_b16 a[8:9], v12 offset:8192
    ds_read_b64_tr_b16 a[10:11], v12 offset:12288
    ds_read_b64_tr_b16 a[12:13], v13 offset:8192
    ds_read_b64_tr_b16 a[14:15], v13 offset:12288
    ds_read_b64_tr_b16 a[16:17], v12 offset:16384
    ds_read_b64_tr_b16 a[18:19], v12 offset:20480
    ds_read_b64_tr_b16 a[20:21], v13 offset:16384
    ds_read_b64_tr_b16 a[22:23], v13 offset:20480
    ds_read_b64_tr_b16 a[24:25], v12 offset:24576
    ds_read_b64_tr_b16 a[26:27], v12 offset:28672
    ds_read_b64_tr_b16 a[28:29], v13 offset:24576
    ds_read_b64_tr_b16 a[30:31], v13 offset:28672
    s_waitcnt lgkmcnt(0)
    s_barrier
    s_add_u32 m0, s29, 0
    s_add_u32 s4, s28, 1048576
    buffer_load_dwordx4 v10, s[12:15], s4 offen lds

    s_add_u32 m0, s29, 1024
    s_add_u32 s4, s28, 1056768
    buffer_load_dwordx4 v11, s[12:15], s4 offen lds

    s_add_u32 m0, s29, 2048
    s_add_u32 s4, s28, 1064960
    buffer_load_dwordx4 v10, s[12:15], s4 offen lds

    s_add_u32 m0, s29, 3072
    s_add_u32 s4, s28, 1073152
    buffer_load_dwordx4 v11, s[12:15], s4 offen lds

    s_add_u32 m0, s29, 4096
    s_add_u32 s4, s28, 1081344
    buffer_load_dwordx4 v10, s[12:15], s4 offen lds

    s_add_u32 m0, s29, 5120
    s_add_u32 s4, s28, 1089536
    buffer_load_dwordx4 v11, s[12:15], s4 offen lds

    s_add_u32 m0, s29, 6144
    s_add_u32 s4, s28, 1097728
    buffer_load_dwordx4 v10, s[12:15], s4 offen lds

    s_add_u32 m0, s29, 7168
    s_add_u32 s4, s28, 1105920
    buffer_load_dwordx4 v11, s[12:15], s4 offen lds

    s_waitcnt vmcnt(24)
    s_barrier
    ds_read_b64_tr_b16 a[32:33], v12 offset:32768
    ds_read_b64_tr_b16 a[34:35], v12 offset:36864
    ds_read_b64_tr_b16 a[36:37], v13 offset:32768
    ds_read_b64_tr_b16 a[38:39], v13 offset:36864
    ds_read_b64_tr_b16 a[40:41], v12 offset:40960
    ds_read_b64_tr_b16 a[42:43], v12 offset:45056
    ds_read_b64_tr_b16 a[44:45], v13 offset:40960
    ds_read_b64_tr_b16 a[46:47], v13 offset:45056
    ds_read_b64_tr_b16 a[48:49], v12 offset:49152
    ds_read_b64_tr_b16 a[50:51], v12 offset:53248
    ds_read_b64_tr_b16 a[52:53], v13 offset:49152
    ds_read_b64_tr_b16 a[54:55], v13 offset:53248
    ds_read_b64_tr_b16 a[56:57], v12 offset:57344
    ds_read_b64_tr_b16 a[58:59], v12 offset:61440
    ds_read_b64_tr_b16 a[60:61], v13 offset:57344
    ds_read_b64_tr_b16 a[62:63], v13 offset:61440
    s_waitcnt lgkmcnt(0)
    s_barrier
    s_add_u32 m0, s29, 32768
    s_add_u32 s4, s28, 1310720
    buffer_load_dwordx4 v10, s[12:15], s4 offen lds

    s_add_u32 m0, s29, 33792
    s_add_u32 s4, s28, 1318912
    buffer_load_dwordx4 v11, s[12:15], s4 offen lds

    s_add_u32 m0, s29, 34816
    s_add_u32 s4, s28, 1327104
    buffer_load_dwordx4 v10, s[12:15], s4 offen lds

    s_add_u32 m0, s29, 35840
    s_add_u32 s4, s28, 1335296
    buffer_load_dwordx4 v11, s[12:15], s4 offen lds

    s_add_u32 m0, s29, 36864
    s_add_u32 s4, s28, 1343488
    buffer_load_dwordx4 v10, s[12:15], s4 offen lds

    s_add_u32 m0, s29, 37888
    s_add_u32 s4, s28, 1351680
    buffer_load_dwordx4 v11, s[12:15], s4 offen lds

    s_add_u32 m0, s29, 38912
    s_add_u32 s4, s28, 1359872
    buffer_load_dwordx4 v10, s[12:15], s4 offen lds

    s_add_u32 m0, s29, 39936
    s_add_u32 s4, s28, 1368064
    buffer_load_dwordx4 v11, s[12:15], s4 offen lds

    s_waitcnt vmcnt(24)
    s_barrier
    ds_read_b64_tr_b16 a[64:65], v14 offset:0
    ds_read_b64_tr_b16 a[66:67], v14 offset:4096
    ds_read_b64_tr_b16 a[68:69], v15 offset:0
    ds_read_b64_tr_b16 a[70:71], v15 offset:4096
    ds_read_b64_tr_b16 a[72:73], v14 offset:8192
    ds_read_b64_tr_b16 a[74:75], v14 offset:12288
    ds_read_b64_tr_b16 a[76:77], v15 offset:8192
    ds_read_b64_tr_b16 a[78:79], v15 offset:12288
    ds_read_b64_tr_b16 a[80:81], v14 offset:16384
    ds_read_b64_tr_b16 a[82:83], v14 offset:20480
    ds_read_b64_tr_b16 a[84:85], v15 offset:16384
    ds_read_b64_tr_b16 a[86:87], v15 offset:20480
    ds_read_b64_tr_b16 a[88:89], v14 offset:24576
    ds_read_b64_tr_b16 a[90:91], v14 offset:28672
    ds_read_b64_tr_b16 a[92:93], v15 offset:24576
    ds_read_b64_tr_b16 a[94:95], v15 offset:28672
    s_waitcnt lgkmcnt(0)
    s_barrier
    s_add_u32 m0, s29, 65536
    s_add_u32 s4, s28, 1572864
    buffer_load_dwordx4 v10, s[12:15], s4 offen lds

    s_add_u32 m0, s29, 66560
    s_add_u32 s4, s28, 1581056
    buffer_load_dwordx4 v11, s[12:15], s4 offen lds

    s_add_u32 m0, s29, 67584
    s_add_u32 s4, s28, 1589248
    buffer_load_dwordx4 v10, s[12:15], s4 offen lds

    s_add_u32 m0, s29, 68608
    s_add_u32 s4, s28, 1597440
    buffer_load_dwordx4 v11, s[12:15], s4 offen lds

    s_add_u32 m0, s29, 69632
    s_add_u32 s4, s28, 1605632
    buffer_load_dwordx4 v10, s[12:15], s4 offen lds

    s_add_u32 m0, s29, 70656
    s_add_u32 s4, s28, 1613824
    buffer_load_dwordx4 v11, s[12:15], s4 offen lds

    s_add_u32 m0, s29, 71680
    s_add_u32 s4, s28, 1622016
    buffer_load_dwordx4 v10, s[12:15], s4 offen lds

    s_add_u32 m0, s29, 72704
    s_add_u32 s4, s28, 1630208
    buffer_load_dwordx4 v11, s[12:15], s4 offen lds

    s_waitcnt vmcnt(24)
    s_barrier
    ds_read_b64_tr_b16 a[96:97], v14 offset:32768
    ds_read_b64_tr_b16 a[98:99], v14 offset:36864
    ds_read_b64_tr_b16 a[100:101], v15 offset:32768
    ds_read_b64_tr_b16 a[102:103], v15 offset:36864
    ds_read_b64_tr_b16 a[104:105], v14 offset:40960
    ds_read_b64_tr_b16 a[106:107], v14 offset:45056
    ds_read_b64_tr_b16 a[108:109], v15 offset:40960
    ds_read_b64_tr_b16 a[110:111], v15 offset:45056
    ds_read_b64_tr_b16 a[112:113], v14 offset:49152
    ds_read_b64_tr_b16 a[114:115], v14 offset:53248
    ds_read_b64_tr_b16 a[116:117], v15 offset:49152
    ds_read_b64_tr_b16 a[118:119], v15 offset:53248
    ds_read_b64_tr_b16 a[120:121], v14 offset:57344
    ds_read_b64_tr_b16 a[122:123], v14 offset:61440
    ds_read_b64_tr_b16 a[124:125], v15 offset:57344
    ds_read_b64_tr_b16 a[126:127], v15 offset:61440
    s_waitcnt lgkmcnt(0)
    s_barrier
    s_add_u32 m0, s29, 98304
    s_add_u32 s4, s28, 1835008
    buffer_load_dwordx4 v10, s[12:15], s4 offen lds

    s_add_u32 m0, s29, 99328
    s_add_u32 s4, s28, 1843200
    buffer_load_dwordx4 v11, s[12:15], s4 offen lds

    s_add_u32 m0, s29, 100352
    s_add_u32 s4, s28, 1851392
    buffer_load_dwordx4 v10, s[12:15], s4 offen lds

    s_add_u32 m0, s29, 101376
    s_add_u32 s4, s28, 1859584
    buffer_load_dwordx4 v11, s[12:15], s4 offen lds

    s_add_u32 m0, s29, 102400
    s_add_u32 s4, s28, 1867776
    buffer_load_dwordx4 v10, s[12:15], s4 offen lds

    s_add_u32 m0, s29, 103424
    s_add_u32 s4, s28, 1875968
    buffer_load_dwordx4 v11, s[12:15], s4 offen lds

    s_add_u32 m0, s29, 104448
    s_add_u32 s4, s28, 1884160
    buffer_load_dwordx4 v10, s[12:15], s4 offen lds

    s_add_u32 m0, s29, 105472
    s_add_u32 s4, s28, 1892352
    buffer_load_dwordx4 v11, s[12:15], s4 offen lds

    s_waitcnt vmcnt(24)
    s_barrier
    ds_read_b64_tr_b16 a[128:129], v12 offset:0
    ds_read_b64_tr_b16 a[130:131], v12 offset:4096
    ds_read_b64_tr_b16 a[132:133], v13 offset:0
    ds_read_b64_tr_b16 a[134:135], v13 offset:4096
    ds_read_b64_tr_b16 a[136:137], v12 offset:8192
    ds_read_b64_tr_b16 a[138:139], v12 offset:12288
    ds_read_b64_tr_b16 a[140:141], v13 offset:8192
    ds_read_b64_tr_b16 a[142:143], v13 offset:12288
    ds_read_b64_tr_b16 a[144:145], v12 offset:16384
    ds_read_b64_tr_b16 a[146:147], v12 offset:20480
    ds_read_b64_tr_b16 a[148:149], v13 offset:16384
    ds_read_b64_tr_b16 a[150:151], v13 offset:20480
    ds_read_b64_tr_b16 a[152:153], v12 offset:24576
    ds_read_b64_tr_b16 a[154:155], v12 offset:28672
    ds_read_b64_tr_b16 a[156:157], v13 offset:24576
    ds_read_b64_tr_b16 a[158:159], v13 offset:28672
    s_waitcnt lgkmcnt(0)
    s_barrier
    s_waitcnt vmcnt(16)
    s_barrier
    ds_read_b64_tr_b16 a[160:161], v12 offset:32768
    ds_read_b64_tr_b16 a[162:163], v12 offset:36864
    ds_read_b64_tr_b16 a[164:165], v13 offset:32768
    ds_read_b64_tr_b16 a[166:167], v13 offset:36864
    ds_read_b64_tr_b16 a[168:169], v12 offset:40960
    ds_read_b64_tr_b16 a[170:171], v12 offset:45056
    ds_read_b64_tr_b16 a[172:173], v13 offset:40960
    ds_read_b64_tr_b16 a[174:175], v13 offset:45056
    ds_read_b64_tr_b16 a[176:177], v12 offset:49152
    ds_read_b64_tr_b16 a[178:179], v12 offset:53248
    ds_read_b64_tr_b16 a[180:181], v13 offset:49152
    ds_read_b64_tr_b16 a[182:183], v13 offset:53248
    ds_read_b64_tr_b16 a[184:185], v12 offset:57344
    ds_read_b64_tr_b16 a[186:187], v12 offset:61440
    ds_read_b64_tr_b16 a[188:189], v13 offset:57344
    ds_read_b64_tr_b16 a[190:191], v13 offset:61440
    s_waitcnt lgkmcnt(0)
    s_barrier
    s_waitcnt vmcnt(8)
    s_barrier
    ds_read_b64_tr_b16 a[192:193], v14 offset:0
    ds_read_b64_tr_b16 a[194:195], v14 offset:4096
    ds_read_b64_tr_b16 a[196:197], v15 offset:0
    ds_read_b64_tr_b16 a[198:199], v15 offset:4096
    ds_read_b64_tr_b16 a[200:201], v14 offset:8192
    ds_read_b64_tr_b16 a[202:203], v14 offset:12288
    ds_read_b64_tr_b16 a[204:205], v15 offset:8192
    ds_read_b64_tr_b16 a[206:207], v15 offset:12288
    ds_read_b64_tr_b16 a[208:209], v14 offset:16384
    ds_read_b64_tr_b16 a[210:211], v14 offset:20480
    ds_read_b64_tr_b16 a[212:213], v15 offset:16384
    ds_read_b64_tr_b16 a[214:215], v15 offset:20480
    ds_read_b64_tr_b16 a[216:217], v14 offset:24576
    ds_read_b64_tr_b16 a[218:219], v14 offset:28672
    ds_read_b64_tr_b16 a[220:221], v15 offset:24576
    ds_read_b64_tr_b16 a[222:223], v15 offset:28672
    s_waitcnt lgkmcnt(0)
    s_barrier
    s_waitcnt vmcnt(0)
    s_barrier
    ds_read_b64_tr_b16 a[224:225], v14 offset:32768
    ds_read_b64_tr_b16 a[226:227], v14 offset:36864
    ds_read_b64_tr_b16 a[228:229], v15 offset:32768
    ds_read_b64_tr_b16 a[230:231], v15 offset:36864
    ds_read_b64_tr_b16 a[232:233], v14 offset:40960
    ds_read_b64_tr_b16 a[234:235], v14 offset:45056
    ds_read_b64_tr_b16 a[236:237], v15 offset:40960
    ds_read_b64_tr_b16 a[238:239], v15 offset:45056
    ds_read_b64_tr_b16 a[240:241], v14 offset:49152
    ds_read_b64_tr_b16 a[242:243], v14 offset:53248
    ds_read_b64_tr_b16 a[244:245], v15 offset:49152
    ds_read_b64_tr_b16 a[246:247], v15 offset:53248
    ds_read_b64_tr_b16 a[248:249], v14 offset:57344
    ds_read_b64_tr_b16 a[250:251], v14 offset:61440
    ds_read_b64_tr_b16 a[252:253], v15 offset:57344
    ds_read_b64_tr_b16 a[254:255], v15 offset:61440
    s_waitcnt lgkmcnt(0)
    s_barrier
    v_lshlrev_b32 v21, 4, v1
    s_lshr_b32 s4, s91, 1
    s_lshl_b32 s5, s4, 12
    v_add_u32 v17, s5, v21
    v_xor_b32 v18, 0x1000, v17
    s_lshl_b32 s4, s4, 4
    v_add_u32 v4, s4, v2
    s_lshl_b32 s5, s30, 5
    s_lshl_b32 s6, s24, 3
    s_add_u32 s5, s5, s6
    s_and_b32 s6, s91, 1
    s_lshl_b32 s6, s6, 2
    s_add_u32 s5, s5, s6
    v_add_u32 v5, s5, v3
    v_lshlrev_b32 v6, 3, v5
    v_lshl_add_u32 v22, v4, 11, v6
    v_lshlrev_b32 v6, 14, v5
    v_lshl_add_u32 v23, v4, 2, v6
    v_lshlrev_b32 v16, 2, v4
    v_bfe_u32 v4, v1, 2, 3
    v_lshlrev_b32 v19, 8, v4
    v_and_b32 v4, 3, v1
    v_lshl_add_u32 v19, v4, 2, v19
    s_lshl_b32 s33, s91, 11
    s_add_u32 s33, s33, 92299264
    s_lshl_b32 s35, s24, 10
    s_lshl_b32 s36, s91, 16
    s_add_u32 s36, s36, s35
    s_add_u32 s36, s36, 0
    s_mov_b32 s37, 0
    s_lshl_b32 s4, s91, 3
    s_add_u32 s4, s4, s30
    s_lshl_b32 s4, s4, 2
    s_add_u32 s4, s4, s24
    s_lshl_b32 s4, s4, 11
    s_add_u32 s4, s4, 0
    v_lshlrev_b32 v111, 5, v1
    v_add_u32 v111, s4, v111
    s_mov_b32 s52, 0
    s_mov_b32 s39, 0
    v_lshlrev_b32 v6, 11, v1

    s_mov_b32 s62, 0
    s_mov_b64 exec, 15
.wf_384:
    buffer_load_dword v4, v6, s[8:11], s57 offen sc1
    s_waitcnt vmcnt(0)
    v_cmp_gt_u32 vcc, 64, v4
    s_cbranch_vccz .wfd_385
    s_sleep 2
    s_add_u32 s62, s62, 1
    s_cmp_gt_u32 s62, 0x400000
    s_cbranch_scc1 .mg_end_1
    s_branch .wf_384

.wfd_385:
    s_mov_b64 exec, -1
    v_mov_b32 v5, 0
    s_mov_b32 s62, 0
    s_mov_b32 s5, 160
.wc_386:
    buffer_load_dword v4, v5, s[20:23], s5 offen sc1
    s_waitcnt vmcnt(0)
    v_readfirstlane_b32 s4, v4
    s_lshr_b32 s4, s4, 0
    s_and_b32 s4, s4, 0xffff
    s_cmp_ge_u32 s4, 32
    s_cbranch_scc1 .wcd_387
    s_sleep 6
    s_add_u32 s62, s62, 1
    s_cmp_gt_u32 s62, 0x400000
    s_cbranch_scc1 .mg_end_1
    s_branch .wc_386

.wcd_387:
.g2blk_388:
    s_mov_b32 s62, 0
    s_mov_b64 s[64:65], 0
    s_mov_b32 s38, 0
.g2bw_396:
    buffer_load_dword v20, v19, s[8:11], s33 offen sc1
    s_waitcnt vmcnt(0)
    s_lshr_b32 s6, s31, 2
    s_and_b32 s4, s31, 3
    v_cmp_ge_u32 vcc, s6, v20
    s_lshl_b32 s4, s4, 3
    s_lshr_b32 s5, vcc_lo, s4
    s_and_b32 s5, s5, 0xff
    s_cmp_eq_u32 s5, 0

    s_cbranch_scc1 .g2rd_397
    s_lshl_b64 exec, 0xff, s4

    s_add_u32 s62, s62, 1
    s_cmp_gt_u32 s62, 0x400000
    s_cbranch_scc1 .mg_end_1
    s_branch .g2bw_396

.g2rd_397:
    s_mov_b64 exec, -1
    s_lshl_b32 s48, s31, 18
    s_add_u32 s48, s48, s36
    s_add_u32 s49, s39, s35
    s_xor_b32 s39, s39, 0x10000

    s_add_u32 m0, s49, 0
    s_add_u32 s50, s48, 0
    buffer_load_dwordx4 v21, s[8:11], s50 offen offset:0 sc1 lds
    s_add_u32 m0, s49, 4096
    s_add_u32 s50, s48, 4096
    buffer_load_dwordx4 v21, s[8:11], s50 offen offset:0 sc1 lds
    s_add_u32 m0, s49, 8192
    s_add_u32 s50, s48, 8192
    buffer_load_dwordx4 v21, s[8:11], s50 offen offset:0 sc1 lds
    s_add_u32 m0, s49, 12288
    s_add_u32 s50, s48, 12288
    buffer_load_dwordx4 v21, s[8:11], s50 offen offset:0 sc1 lds
    s_add_u32 m0, s49, 16384
    s_add_u32 s50, s48, 16384
    buffer_load_dwordx4 v21, s[8:11], s50 offen offset:0 sc1 lds
    s_add_u32 m0, s49, 20480
    s_add_u32 s50, s48, 20480
    buffer_load_dwordx4 v21, s[8:11], s50 offen offset:0 sc1 lds
    s_add_u32 m0, s49, 24576
    s_add_u32 s50, s48, 24576
    buffer_load_dwordx4 v21, s[8:11], s50 offen offset:0 sc1 lds
    s_add_u32 m0, s49, 28672
    s_add_u32 s50, s48, 28672
    buffer_load_dwordx4 v21, s[8:11], s50 offen offset:0 sc1 lds
    s_add_u32 s53, s31, 3
    s_lshr_b32 s6, s53, 2
    s_and_b32 s4, s53, 3
    v_cmp_ge_u32 vcc, s6, v20
    s_lshl_b32 s4, s4, 3
    s_lshr_b32 s5, vcc_lo, s4
    s_and_b32 s5, s5, 0xff
    s_cmp_eq_u32 s5, 0

    s_cselect_b32 s56, 1, 0
    s_cmp_lt_u32 s53, 64
    s_cselect_b32 s56, s56, 0
    s_cmp_eq_u32 s56, 0
    s_cbranch_scc1 .g2fb_398
    s_add_u32 m0, s49, 32768
    s_add_u32 s50, s48, 32768
    buffer_load_dwordx4 v21, s[8:11], s50 offen offset:0 sc1 lds
    s_add_u32 m0, s49, 36864
    s_add_u32 s50, s48, 36864
    buffer_load_dwordx4 v21, s[8:11], s50 offen offset:0 sc1 lds
    s_add_u32 m0, s49, 40960
    s_add_u32 s50, s48, 40960
    buffer_load_dwordx4 v21, s[8:11], s50 offen offset:0 sc1 lds
    s_add_u32 m0, s49, 45056
    s_add_u32 s50, s48, 45056
    buffer_load_dwordx4 v21, s[8:11], s50 offen offset:0 sc1 lds
    s_add_u32 m0, s49, 49152
    s_add_u32 s50, s48, 49152
    buffer_load_dwordx4 v21, s[8:11], s50 offen offset:0 sc1 lds
    s_add_u32 m0, s49, 53248
    s_add_u32 s50, s48, 53248
    buffer_load_dwordx4 v21, s[8:11], s50 offen offset:0 sc1 lds
    s_add_u32 m0, s49, 57344
    s_add_u32 s50, s48, 57344
    buffer_load_dwordx4 v21, s[8:11], s50 offen offset:0 sc1 lds
    s_add_u32 m0, s49, 61440
    s_add_u32 s50, s48, 61440
    buffer_load_dwordx4 v21, s[8:11], s50 offen offset:0 sc1 lds
    s_waitcnt vmcnt(0)
.g2go_389:
    s_barrier
    ds_read_b128 v[32:35], v17 offset:0
    ds_read_b128 v[36:39], v18 offset:0
    ds_read_b128 v[40:43], v17 offset:1024
    ds_read_b128 v[44:47], v18 offset:1024
    ds_read_b128 v[48:51], v17 offset:2048
    ds_read_b128 v[52:55], v18 offset:2048
    s_add_u32 s53, s31, 3
    s_sub_u32 s54, s31, 3
    s_max_i32 s54, s54, 0
    s_sub_u32 s55, s37, 0x10000
    s_add_u32 s61, s31, 6
    s_lshr_b32 s6, s53, 2
    s_and_b32 s4, s53, 3
    v_cmp_ge_u32 vcc, s6, v20
    s_lshl_b32 s4, s4, 3
    s_lshr_b32 s5, vcc_lo, s4
    s_and_b32 s5, s5, 0xff
    s_cmp_eq_u32 s5, 0

    s_cselect_b32 s56, 1, 0
    s_cmp_lt_u32 s53, 64
    s_cselect_b32 s56, s56, 0
    s_cmp_eq_u32 s56, 0
    s_cbranch_scc1 .g2nd_392
    s_lshr_b32 s6, s61, 2
    s_and_b32 s4, s61, 3
    v_cmp_ge_u32 vcc, s6, v20
    s_lshl_b32 s4, s4, 3
    s_lshr_b32 s5, vcc_lo, s4
    s_and_b32 s5, s5, 0xff
    s_cmp_eq_u32 s5, 0

    s_cbranch_scc1 .g2nf_391
    buffer_load_dword v20, v19, s[8:11], s33 offen sc1
    s_branch .g2pd_400
.g2nf_391:
    s_lshl_b32 s4, s61, 18
    buffer_load_dword v31, v111, s[8:11], s4 offen
.g2pd_400:
    s_lshl_b32 s48, s53, 18
    s_add_u32 s48, s48, s36
    s_add_u32 s49, s39, s35
    s_xor_b32 s39, s39, 0x10000

    s_waitcnt lgkmcnt(4)
    v_mfma_f32_16x16x32_bf16 v[64:67], a[0:3], v[32:35], 0
    ds_read_b128 v[56:59], v17 offset:3072
    s_add_u32 m0, s49, 0
    s_add_u32 s50, s48, 0
    v_mfma_f32_16x16x32_bf16 v[68:71], a[4:7], v[32:35], 0
    buffer_load_dwordx4 v21, s[8:11], s50 offen offset:0 sc1 lds
    v_mfma_f32_16x16x32_bf16 v[72:75], a[0:3], v[36:39], 0
    ds_read_b128 v[60:63], v18 offset:3072
    v_mfma_f32_16x16x32_bf16 v[76:79], a[4:7], v[36:39], 0
    s_waitcnt lgkmcnt(4)
    v_mfma_f32_16x16x32_bf16 v[64:67], a[8:11], v[40:43], v[64:67]
    ds_read_b128 v[32:35], v17 offset:8192
    v_mfma_f32_16x16x32_bf16 v[68:71], a[12:15], v[40:43], v[68:71]
    v_mfma_f32_16x16x32_bf16 v[72:75], a[8:11], v[44:47], v[72:75]
    ds_read_b128 v[36:39], v18 offset:8192
    s_add_u32 m0, s49, 4096
    s_add_u32 s50, s48, 4096
    v_mfma_f32_16x16x32_bf16 v[76:79], a[12:15], v[44:47], v[76:79]
    buffer_load_dwordx4 v21, s[8:11], s50 offen offset:0 sc1 lds
    s_waitcnt lgkmcnt(4)
    v_mfma_f32_16x16x32_bf16 v[64:67], a[16:19], v[48:51], v[64:67]
    ds_read_b128 v[40:43], v17 offset:9216
    v_mfma_f32_16x16x32_bf16 v[68:71], a[20:23], v[48:51], v[68:71]
    v_mfma_f32_16x16x32_bf16 v[72:75], a[16:19], v[52:55], v[72:75]
    ds_read_b128 v[44:47], v18 offset:9216
    v_mfma_f32_16x16x32_bf16 v[76:79], a[20:23], v[52:55], v[76:79]
    s_waitcnt lgkmcnt(4)
    v_mfma_f32_16x16x32_bf16 v[64:67], a[24:27], v[56:59], v[64:67]
    ds_read_b128 v[48:51], v17 offset:10240
    s_add_u32 m0, s49, 8192
    s_add_u32 s50, s48, 8192
    v_mfma_f32_16x16x32_bf16 v[68:71], a[28:31], v[56:59], v[68:71]
    buffer_load_dwordx4 v21, s[8:11], s50 offen offset:0 sc1 lds
    v_mfma_f32_16x16x32_bf16 v[72:75], a[24:27], v[60:63], v[72:75]
    ds_read_b128 v[52:55], v18 offset:10240
    v_mfma_f32_16x16x32_bf16 v[76:79], a[28:31], v[60:63], v[76:79]
    s_waitcnt lgkmcnt(4)
    v_mfma_f32_16x16x32_bf16 v[64:67], a[32:35], v[32:35], v[64:67]
    ds_read_b128 v[56:59], v17 offset:11264
    v_mfma_f32_16x16x32_bf16 v[68:71], a[36:39], v[32:35], v[68:71]
    v_mfma_f32_16x16x32_bf16 v[72:75], a[32:35], v[36:39], v[72:75]
    ds_read_b128 v[60:63], v18 offset:11264
    s_add_u32 m0, s49, 12288
    s_add_u32 s50, s48, 12288
    v_mfma_f32_16x16x32_bf16 v[76:79], a[36:39], v[36:39], v[76:79]
    buffer_load_dwordx4 v21, s[8:11], s50 offen offset:0 sc1 lds
    s_waitcnt lgkmcnt(4)
    v_mfma_f32_16x16x32_bf16 v[64:67], a[40:43], v[40:43], v[64:67]
    s_barrier
    ds_read_b128 v[32:35], v17 offset:16384
    v_mfma_f32_16x16x32_bf16 v[68:71], a[44:47], v[40:43], v[68:71]
    v_mfma_f32_16x16x32_bf16 v[72:75], a[40:43], v[44:47], v[72:75]
    ds_read_b128 v[36:39], v18 offset:16384
    v_mfma_f32_16x16x32_bf16 v[76:79], a[44:47], v[44:47], v[76:79]
    s_waitcnt lgkmcnt(4)
    v_mfma_f32_16x16x32_bf16 v[64:67], a[48:51], v[48:51], v[64:67]
    ds_read_b128 v[40:43], v17 offset:17408
    s_add_u32 m0, s49, 16384
    s_add_u32 s50, s48, 16384
    v_mfma_f32_16x16x32_bf16 v[68:71], a[52:55], v[48:51], v[68:71]
    buffer_load_dwordx4 v21, s[8:11], s50 offen offset:0 sc1 lds
    v_mfma_f32_16x16x32_bf16 v[72:75], a[48:51], v[52:55], v[72:75]
    ds_read_b128 v[44:47], v18 offset:17408
    v_mfma_f32_16x16x32_bf16 v[76:79], a[52:55], v[52:55], v[76:79]
    s_waitcnt lgkmcnt(4)
    v_mfma_f32_16x16x32_bf16 v[64:67], a[56:59], v[56:59], v[64:67]
    ds_read_b128 v[48:51], v17 offset:18432
    v_mfma_f32_16x16x32_bf16 v[68:71], a[60:63], v[56:59], v[68:71]
    v_mfma_f32_16x16x32_bf16 v[72:75], a[56:59], v[60:63], v[72:75]
    ds_read_b128 v[52:55], v18 offset:18432
    s_add_u32 m0, s49, 20480
    s_add_u32 s50, s48, 20480
    v_mfma_f32_16x16x32_bf16 v[76:79], a[60:63], v[60:63], v[76:79]
    buffer_load_dwordx4 v21, s[8:11], s50 offen offset:0 sc1 lds
    s_waitcnt lgkmcnt(4)
    v_mfma_f32_16x16x32_bf16 v[64:67], a[64:67], v[32:35], v[64:67]
    ds_read_b128 v[56:59], v17 offset:19456
    v_mfma_f32_16x16x32_bf16 v[68:71], a[68:71], v[32:35], v[68:71]
    v_mfma_f32_16x16x32_bf16 v[72:75], a[64:67], v[36:39], v[72:75]
    ds_read_b128 v[60:63], v18 offset:19456
    v_mfma_f32_16x16x32_bf16 v[76:79], a[68:71], v[36:39], v[76:79]
    s_waitcnt lgkmcnt(4)
    v_mfma_f32_16x16x32_bf16 v[64:67], a[72:75], v[40:43], v[64:67]
    ds_read_b128 v[32:35], v17 offset:24576
    s_add_u32 m0, s49, 24576
    s_add_u32 s50, s48, 24576
    v_mfma_f32_16x16x32_bf16 v[68:71], a[76:79], v[40:43], v[68:71]
    buffer_load_dwordx4 v21, s[8:11], s50 offen offset:0 sc1 lds
    v_mfma_f32_16x16x32_bf16 v[72:75], a[72:75], v[44:47], v[72:75]
    ds_read_b128 v[36:39], v18 offset:24576
    v_mfma_f32_16x16x32_bf16 v[76:79], a[76:79], v[44:47], v[76:79]
    s_waitcnt lgkmcnt(4)
    v_mfma_f32_16x16x32_bf16 v[64:67], a[80:83], v[48:51], v[64:67]
    ds_read_b128 v[40:43], v17 offset:25600
    v_mfma_f32_16x16x32_bf16 v[68:71], a[84:87], v[48:51], v[68:71]
    s_waitcnt vmcnt(11)
    v_mfma_f32_16x16x32_bf16 v[72:75], a[80:83], v[52:55], v[72:75]
    ds_read_b128 v[44:47], v18 offset:25600
    s_add_u32 m0, s49, 28672
    s_add_u32 s50, s48, 28672
    v_mfma_f32_16x16x32_bf16 v[76:79], a[84:87], v[52:55], v[76:79]
    buffer_load_dwordx4 v21, s[8:11], s50 offen offset:0 sc1 lds
    s_mov_b32 s62, 0
.cc_401:
    v_max3_u32 v4, v84, v88, v92
    v_cmp_eq_u32 vcc, -1, v4
    s_and_b64 vcc, vcc, s[64:65]
    s_cbranch_vccnz .cf_402
    s_waitcnt lgkmcnt(4)
    v_mfma_f32_16x16x32_bf16 v[64:67], a[88:91], v[56:59], v[64:67]
    ds_read_b128 v[48:51], v17 offset:26624
    v_mfma_f32_16x16x32_bf16 v[68:71], a[92:95], v[56:59], v[68:71]
    v_add_f32 v84, v84, v88
    v_add_f32 v92, v112, v92
    v_mfma_f32_16x16x32_bf16 v[72:75], a[88:91], v[60:63], v[72:75]
    ds_read_b128 v[52:55], v18 offset:26624
    v_mfma_f32_16x16x32_bf16 v[76:79], a[92:95], v[60:63], v[76:79]
    v_add_f32 v85, v85, v89
    v_add_f32 v93, v113, v93
    s_waitcnt lgkmcnt(4)
    v_mfma_f32_16x16x32_bf16 v[64:67], a[96:99], v[32:35], v[64:67]
    ds_read_b128 v[56:59], v17 offset:27648
    s_add_u32 m0, s49, 32768
    s_add_u32 s50, s48, 32768
    v_mfma_f32_16x16x32_bf16 v[68:71], a[100:103], v[32:35], v[68:71]
    buffer_load_dwordx4 v21, s[8:11], s50 offen offset:0 sc1 lds
    v_add_f32 v86, v86, v90
    v_add_f32 v94, v114, v94
    v_mfma_f32_16x16x32_bf16 v[72:75], a[96:99], v[36:39], v[72:75]
    ds_read_b128 v[60:63], v18 offset:27648
    v_mfma_f32_16x16x32_bf16 v[76:79], a[100:103], v[36:39], v[76:79]
    v_add_f32 v87, v87, v91
    v_add_f32 v95, v115, v95
    s_waitcnt lgkmcnt(4)
    v_mfma_f32_16x16x32_bf16 v[64:67], a[104:107], v[40:43], v[64:67]
    s_barrier
    ds_read_b128 v[32:35], v17 offset:32768
    v_mfma_f32_16x16x32_bf16 v[68:71], a[108:111], v[40:43], v[68:71]
    v_add_f32 v84, v92, v84
    v_add_f32 v85, v93, v85
    v_mfma_f32_16x16x32_bf16 v[72:75], a[104:107], v[44:47], v[72:75]
    ds_read_b128 v[36:39], v18 offset:32768
    s_add_u32 m0, s49, 36864
    s_add_u32 s50, s48, 36864
    v_mfma_f32_16x16x32_bf16 v[76:79], a[108:111], v[44:47], v[76:79]
    buffer_load_dwordx4 v21, s[8:11], s50 offen offset:0 sc1 lds
    v_add_f32 v86, v94, v86
    v_add_f32 v87, v95, v87
    s_waitcnt lgkmcnt(4)
    v_mfma_f32_16x16x32_bf16 v[64:67], a[112:115], v[48:51], v[64:67]
    ds_read_b128 v[40:43], v17 offset:33792
    v_mfma_f32_16x16x32_bf16 v[68:71], a[116:119], v[48:51], v[68:71]
    v_sub_f32 v104, 1.0, v100
    v_cvt_pk_bf16_f32 v104, v104, v104
    v_mfma_f32_16x16x32_bf16 v[72:75], a[112:115], v[52:55], v[72:75]
    ds_read_b128 v[44:47], v18 offset:33792
    v_mfma_f32_16x16x32_bf16 v[76:79], a[116:119], v[52:55], v[76:79]
    v_lshlrev_b32 v104, 16, v104
    v_cvt_pk_bf16_f32 v105, v84, v85
    s_waitcnt lgkmcnt(4)
    v_mfma_f32_16x16x32_bf16 v[64:67], a[120:123], v[56:59], v[64:67]
    ds_read_b128 v[48:51], v17 offset:34816
    s_add_u32 m0, s49, 40960
    s_add_u32 s50, s48, 40960
    v_mfma_f32_16x16x32_bf16 v[68:71], a[124:127], v[56:59], v[68:71]
    buffer_load_dwordx4 v21, s[8:11], s50 offen offset:0 sc1 lds
    v_lshlrev_b32 v107, 16, v96
    v_and_b32 v108, 0xffff0000, v96
    v_mfma_f32_16x16x32_bf16 v[72:75], a[120:123], v[60:63], v[72:75]
    ds_read_b128 v[52:55], v18 offset:34816
    v_mfma_f32_16x16x32_bf16 v[76:79], a[124:127], v[60:63], v[76:79]
    v_lshlrev_b32 v109, 16, v98
    v_and_b32 v110, 0xffff0000, v98
    s_waitcnt lgkmcnt(4)
    v_mfma_f32_16x16x32_bf16 v[64:67], a[128:131], v[32:35], v[64:67]
    ds_read_b128 v[56:59], v17 offset:35840
    v_mfma_f32_16x16x32_bf16 v[68:71], a[132:135], v[32:35], v[68:71]
    v_and_b32 v106, 0xffff0000, v105
    v_lshlrev_b32 v105, 16, v105
    v_mfma_f32_16x16x32_bf16 v[72:75], a[128:131], v[36:39], v[72:75]
    ds_read_b128 v[60:63], v18 offset:35840
    s_add_u32 m0, s49, 45056
    s_add_u32 s50, s48, 45056
    v_mfma_f32_16x16x32_bf16 v[76:79], a[132:135], v[36:39], v[76:79]
    buffer_load_dwordx4 v21, s[8:11], s50 offen offset:0 sc1 lds
    v_mul_f32 v107, v107, v109
    v_mul_f32 v108, v108, v110
    s_waitcnt lgkmcnt(4)
    v_mfma_f32_16x16x32_bf16 v[64:67], a[136:139], v[40:43], v[64:67]
    ds_read_b128 v[32:35], v17 offset:40960
    v_mfma_f32_16x16x32_bf16 v[68:71], a[140:143], v[40:43], v[68:71]
    v_mul_f32 v105, v104, v105
    v_mul_f32 v106, v104, v106
    v_mfma_f32_16x16x32_bf16 v[72:75], a[136:139], v[44:47], v[72:75]
    ds_read_b128 v[36:39], v18 offset:40960
    v_mfma_f32_16x16x32_bf16 v[76:79], a[140:143], v[44:47], v[76:79]
    v_cvt_pk_bf16_f32 v107, v107, v108
    v_cvt_pk_bf16_f32 v105, v105, v106
    s_waitcnt lgkmcnt(4)
    v_mfma_f32_16x16x32_bf16 v[64:67], a[144:147], v[48:51], v[64:67]
    ds_read_b128 v[40:43], v17 offset:41984
    s_add_u32 m0, s49, 49152
    s_add_u32 s50, s48, 49152
    v_mfma_f32_16x16x32_bf16 v[68:71], a[148:151], v[48:51], v[68:71]
    buffer_load_dwordx4 v21, s[8:11], s50 offen offset:0 sc1 lds
    v_and_b32 v108, 0xffff0000, v107
    v_lshlrev_b32 v107, 16, v107
    v_mfma_f32_16x16x32_bf16 v[72:75], a[144:147], v[52:55], v[72:75]
    ds_read_b128 v[44:47], v18 offset:41984
    v_mfma_f32_16x16x32_bf16 v[76:79], a[148:151], v[52:55], v[76:79]
    v_and_b32 v106, 0xffff0000, v105
    v_lshlrev_b32 v105, 16, v105
    s_waitcnt lgkmcnt(4)
    v_mfma_f32_16x16x32_bf16 v[64:67], a[152:155], v[56:59], v[64:67]
    ds_read_b128 v[48:51], v17 offset:43008
    v_mfma_f32_16x16x32_bf16 v[68:71], a[156:159], v[56:59], v[68:71]
    v_mul_f32 v107, v100, v107
    v_mul_f32 v108, v100, v108
    v_mfma_f32_16x16x32_bf16 v[72:75], a[152:155], v[60:63], v[72:75]
    ds_read_b128 v[52:55], v18 offset:43008
    s_add_u32 m0, s49, 53248
    s_add_u32 s50, s48, 53248
    v_mfma_f32_16x16x32_bf16 v[76:79], a[156:159], v[60:63], v[76:79]
    buffer_load_dwordx4 v21, s[8:11], s50 offen offset:0 sc1 lds
    v_cvt_pk_bf16_f32 v107, v107, v108
    v_and_b32 v108, 0xffff0000, v107
    s_waitcnt lgkmcnt(4)
    v_mfma_f32_16x16x32_bf16 v[64:67], a[160:163], v[32:35], v[64:67]
    ds_read_b128 v[56:59], v17 offset:44032
    v_mfma_f32_16x16x32_bf16 v[68:71], a[164:167], v[32:35], v[68:71]
    v_lshlrev_b32 v107, 16, v107
    v_add_f32 v105, v105, v107
    v_mfma_f32_16x16x32_bf16 v[72:75], a[160:163], v[36:39], v[72:75]
    ds_read_b128 v[60:63], v18 offset:44032
    v_mfma_f32_16x16x32_bf16 v[76:79], a[164:167], v[36:39], v[76:79]
    v_add_f32 v106, v106, v108
    v_cvt_pk_bf16_f32 v102, v105, v106
    s_waitcnt lgkmcnt(4)
    v_mfma_f32_16x16x32_bf16 v[64:67], a[168:171], v[40:43], v[64:67]
    s_barrier
    ds_read_b128 v[32:35], v17 offset:49152
    s_add_u32 m0, s49, 57344
    s_add_u32 s50, s48, 57344
    v_mfma_f32_16x16x32_bf16 v[68:71], a[172:175], v[40:43], v[68:71]
    buffer_load_dwordx4 v21, s[8:11], s50 offen offset:0 sc1 lds
    v_cvt_pk_bf16_f32 v105, v86, v87
    v_lshlrev_b32 v107, 16, v97
    v_mfma_f32_16x16x32_bf16 v[72:75], a[168:171], v[44:47], v[72:75]
    ds_read_b128 v[36:39], v18 offset:49152
    v_mfma_f32_16x16x32_bf16 v[76:79], a[172:175], v[44:47], v[76:79]
    v_and_b32 v108, 0xffff0000, v97
    v_lshlrev_b32 v109, 16, v99
    s_waitcnt lgkmcnt(4)
    v_mfma_f32_16x16x32_bf16 v[64:67], a[176:179], v[48:51], v[64:67]
    ds_read_b128 v[40:43], v17 offset:50176
    v_mfma_f32_16x16x32_bf16 v[68:71], a[180:183], v[48:51], v[68:71]
    v_and_b32 v110, 0xffff0000, v99
    v_and_b32 v106, 0xffff0000, v105
    v_mfma_f32_16x16x32_bf16 v[72:75], a[176:179], v[52:55], v[72:75]
    ds_read_b128 v[44:47], v18 offset:50176
    s_add_u32 m0, s49, 61440
    s_add_u32 s50, s48, 61440
    v_mfma_f32_16x16x32_bf16 v[76:79], a[180:183], v[52:55], v[76:79]
    buffer_load_dwordx4 v21, s[8:11], s50 offen offset:0 sc1 lds
    v_lshlrev_b32 v105, 16, v105
    v_mul_f32 v107, v107, v109
    s_waitcnt lgkmcnt(4)
    v_mfma_f32_16x16x32_bf16 v[64:67], a[184:187], v[56:59], v[64:67]
    ds_read_b128 v[48:51], v17 offset:51200
    v_mfma_f32_16x16x32_bf16 v[68:71], a[188:191], v[56:59], v[68:71]
    v_mul_f32 v108, v108, v110
    v_mul_f32 v105, v104, v105
    v_mfma_f32_16x16x32_bf16 v[72:75], a[184:187], v[60:63], v[72:75]
    ds_read_b128 v[52:55], v18 offset:51200
    v_mfma_f32_16x16x32_bf16 v[76:79], a[188:191], v[60:63], v[76:79]
    v_mul_f32 v106, v104, v106
    v_cvt_pk_bf16_f32 v107, v107, v108
    s_waitcnt lgkmcnt(4)
    v_mfma_f32_16x16x32_bf16 v[64:67], a[192:195], v[32:35], v[64:67]
    ds_read_b128 v[56:59], v17 offset:52224
    v_mfma_f32_16x16x32_bf16 v[68:71], a[196:199], v[32:35], v[68:71]
    v_cvt_pk_bf16_f32 v105, v105, v106
    v_and_b32 v108, 0xffff0000, v107
    v_mfma_f32_16x16x32_bf16 v[72:75], a[192:195], v[36:39], v[72:75]
    ds_read_b128 v[60:63], v18 offset:52224
    v_mfma_f32_16x16x32_bf16 v[76:79], a[196:199], v[36:39], v[76:79]
    v_lshlrev_b32 v107, 16, v107
    v_and_b32 v106, 0xffff0000, v105
    s_waitcnt lgkmcnt(4)
    v_mfma_f32_16x16x32_bf16 v[64:67], a[200:203], v[40:43], v[64:67]
    ds_read_b128 v[32:35], v17 offset:57344
    v_mfma_f32_16x16x32_bf16 v[68:71], a[204:207], v[40:43], v[68:71]
    v_lshlrev_b32 v105, 16, v105
    v_mul_f32 v107, v100, v107
    v_mfma_f32_16x16x32_bf16 v[72:75], a[200:203], v[44:47], v[72:75]
    ds_read_b128 v[36:39], v18 offset:57344
    v_mfma_f32_16x16x32_bf16 v[76:79], a[204:207], v[44:47], v[76:79]
    v_mul_f32 v108, v100, v108
    v_cvt_pk_bf16_f32 v107, v107, v108
    s_waitcnt lgkmcnt(4)
    v_mfma_f32_16x16x32_bf16 v[64:67], a[208:211], v[48:51], v[64:67]
    ds_read_b128 v[40:43], v17 offset:58368
    v_mfma_f32_16x16x32_bf16 v[68:71], a[212:215], v[48:51], v[68:71]
    v_and_b32 v108, 0xffff0000, v107
    v_lshlrev_b32 v107, 16, v107
    v_mfma_f32_16x16x32_bf16 v[72:75], a[208:211], v[52:55], v[72:75]
    ds_read_b128 v[44:47], v18 offset:58368
    v_mfma_f32_16x16x32_bf16 v[76:79], a[212:215], v[52:55], v[76:79]
    v_add_f32 v105, v105, v107
    v_add_f32 v106, v106, v108
    s_waitcnt lgkmcnt(4)
    v_mfma_f32_16x16x32_bf16 v[64:67], a[216:219], v[56:59], v[64:67]
    ds_read_b128 v[48:51], v17 offset:59392
    v_mfma_f32_16x16x32_bf16 v[68:71], a[220:223], v[56:59], v[68:71]
    v_cvt_pk_bf16_f32 v103, v105, v106
    s_mov_b64 exec, s[64:65]
    buffer_store_dwordx2 v[102:103], v22, s[44:47], s52 offen
    s_mov_b64 exec, -1
    v_mfma_f32_16x16x32_bf16 v[72:75], a[216:219], v[60:63], v[72:75]
    ds_read_b128 v[52:55], v18 offset:59392
    v_mfma_f32_16x16x32_bf16 v[76:79], a[220:223], v[60:63], v[76:79]
    s_add_u32 s51, s34, s55
    s_lshl_b32 s52, s54, 16
    s_lshl_b32 s60, s54, 7
    s_add_u32 s58, s60, 117440512
    s_add_u32 s59, s60, 117448704
    s_add_u32 s60, s60, 121634816

    s_cmp_eq_u32 s38, 0
    s_waitcnt lgkmcnt(4)
    v_mfma_f32_16x16x32_bf16 v[64:67], a[224:227], v[32:35], v[64:67]
    ds_read_b128 v[56:59], v17 offset:60416
    v_mfma_f32_16x16x32_bf16 v[68:71], a[228:231], v[32:35], v[68:71]
    s_cbranch_scc1 .cs_403
    buffer_load_dwordx2 v[96:97], v22, s[16:19], s52 offen
.cs_403:
    v_mfma_f32_16x16x32_bf16 v[72:75], a[224:227], v[36:39], v[72:75]
    ds_read_b128 v[60:63], v18 offset:60416
    v_mfma_f32_16x16x32_bf16 v[76:79], a[228:231], v[36:39], v[76:79]
    s_cbranch_scc1 .cs_404
    buffer_load_dword v98, v23, s[8:11], s58 offen
.cs_404:
    s_waitcnt lgkmcnt(4)
    v_mfma_f32_16x16x32_bf16 v[64:67], a[232:235], v[40:43], v[64:67]
    v_mfma_f32_16x16x32_bf16 v[68:71], a[236:239], v[40:43], v[68:71]
    s_cbranch_scc1 .cs_405
    buffer_load_dword v99, v23, s[8:11], s59 offen
.cs_405:
    v_mfma_f32_16x16x32_bf16 v[72:75], a[232:235], v[44:47], v[72:75]
    v_mfma_f32_16x16x32_bf16 v[76:79], a[236:239], v[44:47], v[76:79]
    s_cbranch_scc1 .cs_406
    buffer_load_dword v100, v16, s[8:11], s60 offen
.cs_406:
    s_waitcnt lgkmcnt(2)
    v_mfma_f32_16x16x32_bf16 v[64:67], a[240:243], v[48:51], v[64:67]
    v_mfma_f32_16x16x32_bf16 v[68:71], a[244:247], v[48:51], v[68:71]
    s_cbranch_scc1 .cs_407
    buffer_load_dwordx4 v[84:87], v7, s[8:11], s51 offen sc1
.cs_407:
    v_mfma_f32_16x16x32_bf16 v[72:75], a[240:243], v[52:55], v[72:75]
    v_mfma_f32_16x16x32_bf16 v[76:79], a[244:247], v[52:55], v[76:79]
    s_cbranch_scc1 .cs_408
    buffer_load_dwordx4 v[88:91], v8, s[8:11], s51 offen sc1
.cs_408:
    s_waitcnt lgkmcnt(0)
    v_mfma_f32_16x16x32_bf16 v[64:67], a[248:251], v[56:59], v[64:67]
    v_mfma_f32_16x16x32_bf16 v[68:71], a[252:255], v[56:59], v[68:71]
    s_cbranch_scc1 .cs_409
    buffer_load_dwordx4 v[92:95], v9, s[8:11], s51 offen sc1
.cs_409:
    v_mfma_f32_16x16x32_bf16 v[72:75], a[248:251], v[60:63], v[72:75]
    v_mfma_f32_16x16x32_bf16 v[76:79], a[252:255], v[60:63], v[76:79]
    v_xor_b32 v17, 0x10000, v17
    v_xor_b32 v18, 0x10000, v18
    s_cselect_b64 s[64:65], 0, -1
    s_add_u32 s4, s34, s37

    v_mov_b32 v112, v80
    v_mov_b32 v113, v81
    v_mov_b32 v114, v82
    v_mov_b32 v115, v83
    s_branch .g2st_393
.g2nd_392:
    s_waitcnt lgkmcnt(4)
    v_mfma_f32_16x16x32_bf16 v[64:67], a[0:3], v[32:35], 0
    ds_read_b128 v[56:59], v17 offset:3072
    v_mfma_f32_16x16x32_bf16 v[68:71], a[4:7], v[32:35], 0
    v_mfma_f32_16x16x32_bf16 v[72:75], a[0:3], v[36:39], 0
    ds_read_b128 v[60:63], v18 offset:3072
    v_mfma_f32_16x16x32_bf16 v[76:79], a[4:7], v[36:39], 0
    s_waitcnt lgkmcnt(4)
    v_mfma_f32_16x16x32_bf16 v[64:67], a[8:11], v[40:43], v[64:67]
    ds_read_b128 v[32:35], v17 offset:8192
    v_mfma_f32_16x16x32_bf16 v[68:71], a[12:15], v[40:43], v[68:71]
    v_mfma_f32_16x16x32_bf16 v[72:75], a[8:11], v[44:47], v[72:75]
    ds_read_b128 v[36:39], v18 offset:8192
    v_mfma_f32_16x16x32_bf16 v[76:79], a[12:15], v[44:47], v[76:79]
    s_waitcnt lgkmcnt(4)
    v_mfma_f32_16x16x32_bf16 v[64:67], a[16:19], v[48:51], v[64:67]
    ds_read_b128 v[40:43], v17 offset:9216
    v_mfma_f32_16x16x32_bf16 v[68:71], a[20:23], v[48:51], v[68:71]
    v_mfma_f32_16x16x32_bf16 v[72:75], a[16:19], v[52:55], v[72:75]
    ds_read_b128 v[44:47], v18 offset:9216
    v_mfma_f32_16x16x32_bf16 v[76:79], a[20:23], v[52:55], v[76:79]
    s_waitcnt lgkmcnt(4)
    v_mfma_f32_16x16x32_bf16 v[64:67], a[24:27], v[56:59], v[64:67]
    ds_read_b128 v[48:51], v17 offset:10240
    v_mfma_f32_16x16x32_bf16 v[68:71], a[28:31], v[56:59], v[68:71]
    v_mfma_f32_16x16x32_bf16 v[72:75], a[24:27], v[60:63], v[72:75]
    ds_read_b128 v[52:55], v18 offset:10240
    v_mfma_f32_16x16x32_bf16 v[76:79], a[28:31], v[60:63], v[76:79]
    s_waitcnt lgkmcnt(4)
    v_mfma_f32_16x16x32_bf16 v[64:67], a[32:35], v[32:35], v[64:67]
    ds_read_b128 v[56:59], v17 offset:11264
    v_mfma_f32_16x16x32_bf16 v[68:71], a[36:39], v[32:35], v[68:71]
    v_mfma_f32_16x16x32_bf16 v[72:75], a[32:35], v[36:39], v[72:75]
    ds_read_b128 v[60:63], v18 offset:11264
    v_mfma_f32_16x16x32_bf16 v[76:79], a[36:39], v[36:39], v[76:79]
    s_waitcnt lgkmcnt(4)
    v_mfma_f32_16x16x32_bf16 v[64:67], a[40:43], v[40:43], v[64:67]
    s_barrier
    ds_read_b128 v[32:35], v17 offset:16384
    v_mfma_f32_16x16x32_bf16 v[68:71], a[44:47], v[40:43], v[68:71]
    v_mfma_f32_16x16x32_bf16 v[72:75], a[40:43], v[44:47], v[72:75]
    ds_read_b128 v[36:39], v18 offset:16384
    v_mfma_f32_16x16x32_bf16 v[76:79], a[44:47], v[44:47], v[76:79]
    s_waitcnt lgkmcnt(4)
    v_mfma_f32_16x16x32_bf16 v[64:67], a[48:51], v[48:51], v[64:67]
    ds_read_b128 v[40:43], v17 offset:17408
    v_mfma_f32_16x16x32_bf16 v[68:71], a[52:55], v[48:51], v[68:71]
    v_mfma_f32_16x16x32_bf16 v[72:75], a[48:51], v[52:55], v[72:75]
    ds_read_b128 v[44:47], v18 offset:17408
    v_mfma_f32_16x16x32_bf16 v[76:79], a[52:55], v[52:55], v[76:79]
    s_waitcnt lgkmcnt(4)
    v_mfma_f32_16x16x32_bf16 v[64:67], a[56:59], v[56:59], v[64:67]
    ds_read_b128 v[48:51], v17 offset:18432
    v_mfma_f32_16x16x32_bf16 v[68:71], a[60:63], v[56:59], v[68:71]
    v_mfma_f32_16x16x32_bf16 v[72:75], a[56:59], v[60:63], v[72:75]
    ds_read_b128 v[52:55], v18 offset:18432
    v_mfma_f32_16x16x32_bf16 v[76:79], a[60:63], v[60:63], v[76:79]
    s_waitcnt lgkmcnt(4)
    v_mfma_f32_16x16x32_bf16 v[64:67], a[64:67], v[32:35], v[64:67]
    ds_read_b128 v[56:59], v17 offset:19456
    v_mfma_f32_16x16x32_bf16 v[68:71], a[68:71], v[32:35], v[68:71]
    v_mfma_f32_16x16x32_bf16 v[72:75], a[64:67], v[36:39], v[72:75]
    ds_read_b128 v[60:63], v18 offset:19456
    v_mfma_f32_16x16x32_bf16 v[76:79], a[68:71], v[36:39], v[76:79]
    s_waitcnt lgkmcnt(4)
    v_mfma_f32_16x16x32_bf16 v[64:67], a[72:75], v[40:43], v[64:67]
    ds_read_b128 v[32:35], v17 offset:24576
    v_mfma_f32_16x16x32_bf16 v[68:71], a[76:79], v[40:43], v[68:71]
    v_mfma_f32_16x16x32_bf16 v[72:75], a[72:75], v[44:47], v[72:75]
    ds_read_b128 v[36:39], v18 offset:24576
    v_mfma_f32_16x16x32_bf16 v[76:79], a[76:79], v[44:47], v[76:79]
    s_waitcnt lgkmcnt(4)
    v_mfma_f32_16x16x32_bf16 v[64:67], a[80:83], v[48:51], v[64:67]
    ds_read_b128 v[40:43], v17 offset:25600
    v_mfma_f32_16x16x32_bf16 v[68:71], a[84:87], v[48:51], v[68:71]
    s_waitcnt vmcnt(3)
    v_mfma_f32_16x16x32_bf16 v[72:75], a[80:83], v[52:55], v[72:75]
    ds_read_b128 v[44:47], v18 offset:25600
    v_mfma_f32_16x16x32_bf16 v[76:79], a[84:87], v[52:55], v[76:79]
    s_mov_b32 s62, 0
.cc_410:
    v_max3_u32 v4, v84, v88, v92
    v_cmp_eq_u32 vcc, -1, v4
    s_and_b64 vcc, vcc, s[64:65]
    s_cbranch_vccnz .cf_411
    s_waitcnt lgkmcnt(4)
    v_mfma_f32_16x16x32_bf16 v[64:67], a[88:91], v[56:59], v[64:67]
    ds_read_b128 v[48:51], v17 offset:26624
    v_mfma_f32_16x16x32_bf16 v[68:71], a[92:95], v[56:59], v[68:71]
    v_add_f32 v84, v84, v88
    v_add_f32 v92, v112, v92
    v_mfma_f32_16x16x32_bf16 v[72:75], a[88:91], v[60:63], v[72:75]
    ds_read_b128 v[52:55], v18 offset:26624
    v_mfma_f32_16x16x32_bf16 v[76:79], a[92:95], v[60:63], v[76:79]
    v_add_f32 v85, v85, v89
    v_add_f32 v93, v113, v93
    s_waitcnt lgkmcnt(4)
    v_mfma_f32_16x16x32_bf16 v[64:67], a[96:99], v[32:35], v[64:67]
    ds_read_b128 v[56:59], v17 offset:27648
    v_mfma_f32_16x16x32_bf16 v[68:71], a[100:103], v[32:35], v[68:71]
    v_add_f32 v86, v86, v90
    v_add_f32 v94, v114, v94
    v_mfma_f32_16x16x32_bf16 v[72:75], a[96:99], v[36:39], v[72:75]
    ds_read_b128 v[60:63], v18 offset:27648
    v_mfma_f32_16x16x32_bf16 v[76:79], a[100:103], v[36:39], v[76:79]
    v_add_f32 v87, v87, v91
    v_add_f32 v95, v115, v95
    s_waitcnt lgkmcnt(4)
    v_mfma_f32_16x16x32_bf16 v[64:67], a[104:107], v[40:43], v[64:67]
    s_barrier
    ds_read_b128 v[32:35], v17 offset:32768
    v_mfma_f32_16x16x32_bf16 v[68:71], a[108:111], v[40:43], v[68:71]
    v_add_f32 v84, v92, v84
    v_add_f32 v85, v93, v85
    v_mfma_f32_16x16x32_bf16 v[72:75], a[104:107], v[44:47], v[72:75]
    ds_read_b128 v[36:39], v18 offset:32768
    v_mfma_f32_16x16x32_bf16 v[76:79], a[108:111], v[44:47], v[76:79]
    v_add_f32 v86, v94, v86
    v_add_f32 v87, v95, v87
    s_waitcnt lgkmcnt(4)
    v_mfma_f32_16x16x32_bf16 v[64:67], a[112:115], v[48:51], v[64:67]
    ds_read_b128 v[40:43], v17 offset:33792
    v_mfma_f32_16x16x32_bf16 v[68:71], a[116:119], v[48:51], v[68:71]
    v_sub_f32 v104, 1.0, v100
    v_cvt_pk_bf16_f32 v104, v104, v104
    v_mfma_f32_16x16x32_bf16 v[72:75], a[112:115], v[52:55], v[72:75]
    ds_read_b128 v[44:47], v18 offset:33792
    v_mfma_f32_16x16x32_bf16 v[76:79], a[116:119], v[52:55], v[76:79]
    v_lshlrev_b32 v104, 16, v104
    v_cvt_pk_bf16_f32 v105, v84, v85
    s_waitcnt lgkmcnt(4)
    v_mfma_f32_16x16x32_bf16 v[64:67], a[120:123], v[56:59], v[64:67]
    ds_read_b128 v[48:51], v17 offset:34816
    v_mfma_f32_16x16x32_bf16 v[68:71], a[124:127], v[56:59], v[68:71]
    v_lshlrev_b32 v107, 16, v96
    v_and_b32 v108, 0xffff0000, v96
    v_mfma_f32_16x16x32_bf16 v[72:75], a[120:123], v[60:63], v[72:75]
    ds_read_b128 v[52:55], v18 offset:34816
    v_mfma_f32_16x16x32_bf16 v[76:79], a[124:127], v[60:63], v[76:79]
    v_lshlrev_b32 v109, 16, v98
    v_and_b32 v110, 0xffff0000, v98
    s_waitcnt lgkmcnt(4)
    v_mfma_f32_16x16x32_bf16 v[64:67], a[128:131], v[32:35], v[64:67]
    ds_read_b128 v[56:59], v17 offset:35840
    v_mfma_f32_16x16x32_bf16 v[68:71], a[132:135], v[32:35], v[68:71]
    v_and_b32 v106, 0xffff0000, v105
    v_lshlrev_b32 v105, 16, v105
    v_mfma_f32_16x16x32_bf16 v[72:75], a[128:131], v[36:39], v[72:75]
    ds_read_b128 v[60:63], v18 offset:35840
    v_mfma_f32_16x16x32_bf16 v[76:79], a[132:135], v[36:39], v[76:79]
    v_mul_f32 v107, v107, v109
    v_mul_f32 v108, v108, v110
    s_waitcnt lgkmcnt(4)
    v_mfma_f32_16x16x32_bf16 v[64:67], a[136:139], v[40:43], v[64:67]
    ds_read_b128 v[32:35], v17 offset:40960
    v_mfma_f32_16x16x32_bf16 v[68:71], a[140:143], v[40:43], v[68:71]
    v_mul_f32 v105, v104, v105
    v_mul_f32 v106, v104, v106
    v_mfma_f32_16x16x32_bf16 v[72:75], a[136:139], v[44:47], v[72:75]
    ds_read_b128 v[36:39], v18 offset:40960
    v_mfma_f32_16x16x32_bf16 v[76:79], a[140:143], v[44:47], v[76:79]
    v_cvt_pk_bf16_f32 v107, v107, v108
    v_cvt_pk_bf16_f32 v105, v105, v106
    s_waitcnt lgkmcnt(4)
    v_mfma_f32_16x16x32_bf16 v[64:67], a[144:147], v[48:51], v[64:67]
    ds_read_b128 v[40:43], v17 offset:41984
    v_mfma_f32_16x16x32_bf16 v[68:71], a[148:151], v[48:51], v[68:71]
    v_and_b32 v108, 0xffff0000, v107
    v_lshlrev_b32 v107, 16, v107
    v_mfma_f32_16x16x32_bf16 v[72:75], a[144:147], v[52:55], v[72:75]
    ds_read_b128 v[44:47], v18 offset:41984
    v_mfma_f32_16x16x32_bf16 v[76:79], a[148:151], v[52:55], v[76:79]
    v_and_b32 v106, 0xffff0000, v105
    v_lshlrev_b32 v105, 16, v105
    s_waitcnt lgkmcnt(4)
    v_mfma_f32_16x16x32_bf16 v[64:67], a[152:155], v[56:59], v[64:67]
    ds_read_b128 v[48:51], v17 offset:43008
    v_mfma_f32_16x16x32_bf16 v[68:71], a[156:159], v[56:59], v[68:71]
    v_mul_f32 v107, v100, v107
    v_mul_f32 v108, v100, v108
    v_mfma_f32_16x16x32_bf16 v[72:75], a[152:155], v[60:63], v[72:75]
    ds_read_b128 v[52:55], v18 offset:43008
    v_mfma_f32_16x16x32_bf16 v[76:79], a[156:159], v[60:63], v[76:79]
    v_cvt_pk_bf16_f32 v107, v107, v108
    v_and_b32 v108, 0xffff0000, v107
    s_waitcnt lgkmcnt(4)
    v_mfma_f32_16x16x32_bf16 v[64:67], a[160:163], v[32:35], v[64:67]
    ds_read_b128 v[56:59], v17 offset:44032
    v_mfma_f32_16x16x32_bf16 v[68:71], a[164:167], v[32:35], v[68:71]
    v_lshlrev_b32 v107, 16, v107
    v_add_f32 v105, v105, v107
    v_mfma_f32_16x16x32_bf16 v[72:75], a[160:163], v[36:39], v[72:75]
    ds_read_b128 v[60:63], v18 offset:44032
    v_mfma_f32_16x16x32_bf16 v[76:79], a[164:167], v[36:39], v[76:79]
    v_add_f32 v106, v106, v108
    v_cvt_pk_bf16_f32 v102, v105, v106
    s_waitcnt lgkmcnt(4)
    v_mfma_f32_16x16x32_bf16 v[64:67], a[168:171], v[40:43], v[64:67]
    s_barrier
    ds_read_b128 v[32:35], v17 offset:49152
    v_mfma_f32_16x16x32_bf16 v[68:71], a[172:175], v[40:43], v[68:71]
    v_cvt_pk_bf16_f32 v105, v86, v87
    v_lshlrev_b32 v107, 16, v97
    v_mfma_f32_16x16x32_bf16 v[72:75], a[168:171], v[44:47], v[72:75]
    ds_read_b128 v[36:39], v18 offset:49152
    v_mfma_f32_16x16x32_bf16 v[76:79], a[172:175], v[44:47], v[76:79]
    v_and_b32 v108, 0xffff0000, v97
    v_lshlrev_b32 v109, 16, v99
    s_waitcnt lgkmcnt(4)
    v_mfma_f32_16x16x32_bf16 v[64:67], a[176:179], v[48:51], v[64:67]
    ds_read_b128 v[40:43], v17 offset:50176
    v_mfma_f32_16x16x32_bf16 v[68:71], a[180:183], v[48:51], v[68:71]
    v_and_b32 v110, 0xffff0000, v99
    v_and_b32 v106, 0xffff0000, v105
    v_mfma_f32_16x16x32_bf16 v[72:75], a[176:179], v[52:55], v[72:75]
    ds_read_b128 v[44:47], v18 offset:50176
    v_mfma_f32_16x16x32_bf16 v[76:79], a[180:183], v[52:55], v[76:79]
    v_lshlrev_b32 v105, 16, v105
    v_mul_f32 v107, v107, v109
    s_waitcnt lgkmcnt(4)
    v_mfma_f32_16x16x32_bf16 v[64:67], a[184:187], v[56:59], v[64:67]
    ds_read_b128 v[48:51], v17 offset:51200
    v_mfma_f32_16x16x32_bf16 v[68:71], a[188:191], v[56:59], v[68:71]
    v_mul_f32 v108, v108, v110
    v_mul_f32 v105, v104, v105
    v_mfma_f32_16x16x32_bf16 v[72:75], a[184:187], v[60:63], v[72:75]
    ds_read_b128 v[52:55], v18 offset:51200
    v_mfma_f32_16x16x32_bf16 v[76:79], a[188:191], v[60:63], v[76:79]
    v_mul_f32 v106, v104, v106
    v_cvt_pk_bf16_f32 v107, v107, v108
    s_waitcnt lgkmcnt(4)
    v_mfma_f32_16x16x32_bf16 v[64:67], a[192:195], v[32:35], v[64:67]
    ds_read_b128 v[56:59], v17 offset:52224
    v_mfma_f32_16x16x32_bf16 v[68:71], a[196:199], v[32:35], v[68:71]
    v_cvt_pk_bf16_f32 v105, v105, v106
    v_and_b32 v108, 0xffff0000, v107
    v_mfma_f32_16x16x32_bf16 v[72:75], a[192:195], v[36:39], v[72:75]
    ds_read_b128 v[60:63], v18 offset:52224
    v_mfma_f32_16x16x32_bf16 v[76:79], a[196:199], v[36:39], v[76:79]
    v_lshlrev_b32 v107, 16, v107
    v_and_b32 v106, 0xffff0000, v105
    s_waitcnt lgkmcnt(4)
    v_mfma_f32_16x16x32_bf16 v[64:67], a[200:203], v[40:43], v[64:67]
    ds_read_b128 v[32:35], v17 offset:57344
    v_mfma_f32_16x16x32_bf16 v[68:71], a[204:207], v[40:43], v[68:71]
    v_lshlrev_b32 v105, 16, v105
    v_mul_f32 v107, v100, v107
    v_mfma_f32_16x16x32_bf16 v[72:75], a[200:203], v[44:47], v[72:75]
    ds_read_b128 v[36:39], v18 offset:57344
    v_mfma_f32_16x16x32_bf16 v[76:79], a[204:207], v[44:47], v[76:79]
    v_mul_f32 v108, v100, v108
    v_cvt_pk_bf16_f32 v107, v107, v108
    s_waitcnt lgkmcnt(4)
    v_mfma_f32_16x16x32_bf16 v[64:67], a[208:211], v[48:51], v[64:67]
    ds_read_b128 v[40:43], v17 offset:58368
    v_mfma_f32_16x16x32_bf16 v[68:71], a[212:215], v[48:51], v[68:71]
    v_and_b32 v108, 0xffff0000, v107
    v_lshlrev_b32 v107, 16, v107
    v_mfma_f32_16x16x32_bf16 v[72:75], a[208:211], v[52:55], v[72:75]
    ds_read_b128 v[44:47], v18 offset:58368
    v_mfma_f32_16x16x32_bf16 v[76:79], a[212:215], v[52:55], v[76:79]
    v_add_f32 v105, v105, v107
    v_add_f32 v106, v106, v108
    s_waitcnt lgkmcnt(4)
    v_mfma_f32_16x16x32_bf16 v[64:67], a[216:219], v[56:59], v[64:67]
    ds_read_b128 v[48:51], v17 offset:59392
    v_mfma_f32_16x16x32_bf16 v[68:71], a[220:223], v[56:59], v[68:71]
    v_cvt_pk_bf16_f32 v103, v105, v106
    s_mov_b64 exec, s[64:65]
    buffer_store_dwordx2 v[102:103], v22, s[44:47], s52 offen
    s_mov_b64 exec, -1
    v_mfma_f32_16x16x32_bf16 v[72:75], a[216:219], v[60:63], v[72:75]
    ds_read_b128 v[52:55], v18 offset:59392
    v_mfma_f32_16x16x32_bf16 v[76:79], a[220:223], v[60:63], v[76:79]
    s_add_u32 s51, s34, s55
    s_lshl_b32 s52, s54, 16
    s_lshl_b32 s60, s54, 7
    s_add_u32 s58, s60, 117440512
    s_add_u32 s59, s60, 117448704
    s_add_u32 s60, s60, 121634816

    s_cmp_eq_u32 s38, 0
    s_waitcnt lgkmcnt(4)
    v_mfma_f32_16x16x32_bf16 v[64:67], a[224:227], v[32:35], v[64:67]
    ds_read_b128 v[56:59], v17 offset:60416
    v_mfma_f32_16x16x32_bf16 v[68:71], a[228:231], v[32:35], v[68:71]
    s_cbranch_scc1 .cs_412
    buffer_load_dwordx2 v[96:97], v22, s[16:19], s52 offen
.cs_412:
    v_mfma_f32_16x16x32_bf16 v[72:75], a[224:227], v[36:39], v[72:75]
    ds_read_b128 v[60:63], v18 offset:60416
    v_mfma_f32_16x16x32_bf16 v[76:79], a[228:231], v[36:39], v[76:79]
    s_cbranch_scc1 .cs_413
    buffer_load_dword v98, v23, s[8:11], s58 offen
.cs_413:
    s_waitcnt lgkmcnt(4)
    v_mfma_f32_16x16x32_bf16 v[64:67], a[232:235], v[40:43], v[64:67]
    v_mfma_f32_16x16x32_bf16 v[68:71], a[236:239], v[40:43], v[68:71]
    s_cbranch_scc1 .cs_414
    buffer_load_dword v99, v23, s[8:11], s59 offen
.cs_414:
    v_mfma_f32_16x16x32_bf16 v[72:75], a[232:235], v[44:47], v[72:75]
    v_mfma_f32_16x16x32_bf16 v[76:79], a[236:239], v[44:47], v[76:79]
    s_cbranch_scc1 .cs_415
    buffer_load_dword v100, v16, s[8:11], s60 offen
.cs_415:
    s_waitcnt lgkmcnt(2)
    v_mfma_f32_16x16x32_bf16 v[64:67], a[240:243], v[48:51], v[64:67]
    v_mfma_f32_16x16x32_bf16 v[68:71], a[244:247], v[48:51], v[68:71]
    s_cbranch_scc1 .cs_416
    buffer_load_dwordx4 v[84:87], v7, s[8:11], s51 offen sc1
.cs_416:
    v_mfma_f32_16x16x32_bf16 v[72:75], a[240:243], v[52:55], v[72:75]
    v_mfma_f32_16x16x32_bf16 v[76:79], a[244:247], v[52:55], v[76:79]
    s_cbranch_scc1 .cs_417
    buffer_load_dwordx4 v[88:91], v8, s[8:11], s51 offen sc1
.cs_417:
    s_waitcnt lgkmcnt(0)
    v_mfma_f32_16x16x32_bf16 v[64:67], a[248:251], v[56:59], v[64:67]
    v_mfma_f32_16x16x32_bf16 v[68:71], a[252:255], v[56:59], v[68:71]
    s_cbranch_scc1 .cs_418
    buffer_load_dwordx4 v[92:95], v9, s[8:11], s51 offen sc1
.cs_418:
    v_mfma_f32_16x16x32_bf16 v[72:75], a[248:251], v[60:63], v[72:75]
    v_mfma_f32_16x16x32_bf16 v[76:79], a[252:255], v[60:63], v[76:79]
    v_xor_b32 v17, 0x10000, v17
    v_xor_b32 v18, 0x10000, v18
    s_cselect_b64 s[64:65], 0, -1
    s_add_u32 s4, s34, s37

    v_mov_b32 v112, v80
    v_mov_b32 v113, v81
    v_mov_b32 v114, v82
    v_mov_b32 v115, v83
.g2st_393:
    v_min_u32 v68, 0xfffffffe, v68
    buffer_store_dwordx4 v[68:71], v28, s[8:11], s4 offen sc1
    v_min_u32 v72, 0xfffffffe, v72
    buffer_store_dwordx4 v[72:75], v29, s[8:11], s4 offen sc1
    v_min_u32 v76, 0xfffffffe, v76
    buffer_store_dwordx4 v[76:79], v30, s[8:11], s4 offen sc1
    v_mov_b32 v80, v64
    v_mov_b32 v81, v65
    v_mov_b32 v82, v66
    v_mov_b32 v83, v67
    s_cmp_lg_u32 s56, 0
    s_cbranch_scc1 .g2pf_419
    s_cmp_eq_u32 s38, 0
    s_cbranch_scc1 .g2nc_394
    s_waitcnt vmcnt(0)
    s_mov_b32 s62, 0
.cc_420:
    v_max3_u32 v4, v84, v88, v92
    v_cmp_eq_u32 vcc, -1, v4
    s_cbranch_vccnz .cf_421
    v_add_f32 v84, v84, v88
    v_add_f32 v92, v112, v92
    v_add_f32 v85, v85, v89
    v_add_f32 v93, v113, v93
    v_add_f32 v86, v86, v90
    v_add_f32 v94, v114, v94
    v_add_f32 v87, v87, v91
    v_add_f32 v95, v115, v95
    v_add_f32 v84, v92, v84
    v_add_f32 v85, v93, v85
    v_add_f32 v86, v94, v86
    v_add_f32 v87, v95, v87
    v_sub_f32 v104, 1.0, v100
    v_cvt_pk_bf16_f32 v104, v104, v104
    v_lshlrev_b32 v104, 16, v104
    v_cvt_pk_bf16_f32 v105, v84, v85
    v_lshlrev_b32 v107, 16, v96
    v_and_b32 v108, 0xffff0000, v96
    v_lshlrev_b32 v109, 16, v98
    v_and_b32 v110, 0xffff0000, v98
    v_and_b32 v106, 0xffff0000, v105
    v_lshlrev_b32 v105, 16, v105
    v_mul_f32 v107, v107, v109
    v_mul_f32 v108, v108, v110
    v_mul_f32 v105, v104, v105
    v_mul_f32 v106, v104, v106
    v_cvt_pk_bf16_f32 v107, v107, v108
    v_cvt_pk_bf16_f32 v105, v105, v106
    v_and_b32 v108, 0xffff0000, v107
    v_lshlrev_b32 v107, 16, v107
    v_and_b32 v106, 0xffff0000, v105
    v_lshlrev_b32 v105, 16, v105
    v_mul_f32 v107, v100, v107
    v_mul_f32 v108, v100, v108
    v_cvt_pk_bf16_f32 v107, v107, v108
    v_and_b32 v108, 0xffff0000, v107
    v_lshlrev_b32 v107, 16, v107
    v_add_f32 v105, v105, v107
    v_add_f32 v106, v106, v108
    v_cvt_pk_bf16_f32 v102, v105, v106
    v_cvt_pk_bf16_f32 v105, v86, v87
    v_lshlrev_b32 v107, 16, v97
    v_and_b32 v108, 0xffff0000, v97
    v_lshlrev_b32 v109, 16, v99
    v_and_b32 v110, 0xffff0000, v99
    v_and_b32 v106, 0xffff0000, v105
    v_lshlrev_b32 v105, 16, v105
    v_mul_f32 v107, v107, v109
    v_mul_f32 v108, v108, v110
    v_mul_f32 v105, v104, v105
    v_mul_f32 v106, v104, v106
    v_cvt_pk_bf16_f32 v107, v107, v108
    v_cvt_pk_bf16_f32 v105, v105, v106
    v_and_b32 v108, 0xffff0000, v107
    v_lshlrev_b32 v107, 16, v107
    v_and_b32 v106, 0xffff0000, v105
    v_lshlrev_b32 v105, 16, v105
    v_mul_f32 v107, v100, v107
    v_mul_f32 v108, v100, v108
    v_cvt_pk_bf16_f32 v107, v107, v108
    v_and_b32 v108, 0xffff0000, v107
    v_lshlrev_b32 v107, 16, v107
    v_add_f32 v105, v105, v107
    v_add_f32 v106, v106, v108
    v_cvt_pk_bf16_f32 v103, v105, v106
    buffer_store_dwordx2 v[102:103], v22, s[44:47], s52 offen
.g2nc_394:
    s_add_u32 s51, s34, s37
    s_lshl_b32 s52, s31, 16
    s_lshl_b32 s60, s31, 7
    s_add_u32 s58, s60, 117440512
    s_add_u32 s59, s60, 117448704
    s_add_u32 s60, s60, 121634816

    buffer_load_dwordx2 v[96:97], v22, s[16:19], s52 offen
    buffer_load_dword v98, v23, s[8:11], s58 offen
    buffer_load_dword v99, v23, s[8:11], s59 offen
    buffer_load_dword v100, v16, s[8:11], s60 offen
    buffer_load_dwordx4 v[84:87], v7, s[8:11], s51 offen sc1
    buffer_load_dwordx4 v[88:91], v8, s[8:11], s51 offen sc1
    buffer_load_dwordx4 v[92:95], v9, s[8:11], s51 offen sc1
    s_waitcnt vmcnt(0)
    s_mov_b32 s62, 0
.cc_422:
    v_max3_u32 v4, v84, v88, v92
    v_cmp_eq_u32 vcc, -1, v4
    s_cbranch_vccnz .cf_423
    v_add_f32 v84, v84, v88
    v_add_f32 v92, v80, v92
    v_add_f32 v85, v85, v89
    v_add_f32 v93, v81, v93
    v_add_f32 v86, v86, v90
    v_add_f32 v94, v82, v94
    v_add_f32 v87, v87, v91
    v_add_f32 v95, v83, v95
    v_add_f32 v84, v92, v84
    v_add_f32 v85, v93, v85
    v_add_f32 v86, v94, v86
    v_add_f32 v87, v95, v87
    v_sub_f32 v104, 1.0, v100
    v_cvt_pk_bf16_f32 v104, v104, v104
    v_lshlrev_b32 v104, 16, v104
    v_cvt_pk_bf16_f32 v105, v84, v85
    v_lshlrev_b32 v107, 16, v96
    v_and_b32 v108, 0xffff0000, v96
    v_lshlrev_b32 v109, 16, v98
    v_and_b32 v110, 0xffff0000, v98
    v_and_b32 v106, 0xffff0000, v105
    v_lshlrev_b32 v105, 16, v105
    v_mul_f32 v107, v107, v109
    v_mul_f32 v108, v108, v110
    v_mul_f32 v105, v104, v105
    v_mul_f32 v106, v104, v106
    v_cvt_pk_bf16_f32 v107, v107, v108
    v_cvt_pk_bf16_f32 v105, v105, v106
    v_and_b32 v108, 0xffff0000, v107
    v_lshlrev_b32 v107, 16, v107
    v_and_b32 v106, 0xffff0000, v105
    v_lshlrev_b32 v105, 16, v105
    v_mul_f32 v107, v100, v107
    v_mul_f32 v108, v100, v108
    v_cvt_pk_bf16_f32 v107, v107, v108
    v_and_b32 v108, 0xffff0000, v107
    v_lshlrev_b32 v107, 16, v107
    v_add_f32 v105, v105, v107
    v_add_f32 v106, v106, v108
    v_cvt_pk_bf16_f32 v102, v105, v106
    v_cvt_pk_bf16_f32 v105, v86, v87
    v_lshlrev_b32 v107, 16, v97
    v_and_b32 v108, 0xffff0000, v97
    v_lshlrev_b32 v109, 16, v99
    v_and_b32 v110, 0xffff0000, v99
    v_and_b32 v106, 0xffff0000, v105
    v_lshlrev_b32 v105, 16, v105
    v_mul_f32 v107, v107, v109
    v_mul_f32 v108, v108, v110
    v_mul_f32 v105, v104, v105
    v_mul_f32 v106, v104, v106
    v_cvt_pk_bf16_f32 v107, v107, v108
    v_cvt_pk_bf16_f32 v105, v105, v106
    v_and_b32 v108, 0xffff0000, v107
    v_lshlrev_b32 v107, 16, v107
    v_and_b32 v106, 0xffff0000, v105
    v_lshlrev_b32 v105, 16, v105
    v_mul_f32 v107, v100, v107
    v_mul_f32 v108, v100, v108
    v_cvt_pk_bf16_f32 v107, v107, v108
    v_and_b32 v108, 0xffff0000, v107
    v_lshlrev_b32 v107, 16, v107
    v_add_f32 v105, v105, v107
    v_add_f32 v106, v106, v108
    v_cvt_pk_bf16_f32 v103, v105, v106
    buffer_store_dwordx2 v[102:103], v22, s[44:47], s52 offen
.g2nx_399:
    s_mov_b32 s31, s53
    s_add_u32 s37, s37, 0x10000
    s_cmp_lt_u32 s31, 64
    s_cbranch_scc1 .g2blk_388
    s_branch .g2fin_395

.g2pf_419:
    s_mov_b32 s31, s53
    s_add_u32 s37, s37, 0x10000
    s_cmp_eq_u32 s38, 0
    s_mov_b32 s38, 1
    s_cbranch_scc1 .g2w3_390
    s_waitcnt vmcnt(10)
    s_branch .g2go_389

.g2w3_390:
    s_waitcnt vmcnt(3)
    s_branch .g2go_389
.g2fb_398:
    s_add_u32 s51, s34, s37
    s_lshl_b32 s52, s31, 16
    s_lshl_b32 s60, s31, 7
    s_add_u32 s58, s60, 117440512
    s_add_u32 s59, s60, 117448704
    s_add_u32 s60, s60, 121634816

    s_waitcnt vmcnt(4)
    s_barrier
    ds_read_b128 v[32:35], v17 offset:0
    ds_read_b128 v[36:39], v18 offset:0
    ds_read_b128 v[40:43], v17 offset:1024
    ds_read_b128 v[44:47], v18 offset:1024
    ds_read_b128 v[48:51], v17 offset:2048
    ds_read_b128 v[52:55], v18 offset:2048
    s_waitcnt lgkmcnt(4)
    v_mfma_f32_16x16x32_bf16 v[64:67], a[0:3], v[32:35], 0
    ds_read_b128 v[56:59], v17 offset:3072
    v_mfma_f32_16x16x32_bf16 v[68:71], a[4:7], v[32:35], 0
    s_add_u32 m0, s49, 32768
    s_add_u32 s50, s48, 32768
    v_mfma_f32_16x16x32_bf16 v[72:75], a[0:3], v[36:39], 0
    ds_read_b128 v[60:63], v18 offset:3072
    v_mfma_f32_16x16x32_bf16 v[76:79], a[4:7], v[36:39], 0
    buffer_load_dwordx4 v21, s[8:11], s50 offen offset:0 sc1 lds
    s_waitcnt lgkmcnt(4)
    v_mfma_f32_16x16x32_bf16 v[64:67], a[8:11], v[40:43], v[64:67]
    ds_read_b128 v[32:35], v17 offset:8192
    v_mfma_f32_16x16x32_bf16 v[68:71], a[12:15], v[40:43], v[68:71]
    s_add_u32 m0, s49, 36864
    s_add_u32 s50, s48, 36864
    v_mfma_f32_16x16x32_bf16 v[72:75], a[8:11], v[44:47], v[72:75]
    ds_read_b128 v[36:39], v18 offset:8192
    v_mfma_f32_16x16x32_bf16 v[76:79], a[12:15], v[44:47], v[76:79]
    buffer_load_dwordx4 v21, s[8:11], s50 offen offset:0 sc1 lds
    s_waitcnt lgkmcnt(4)
    v_mfma_f32_16x16x32_bf16 v[64:67], a[16:19], v[48:51], v[64:67]
    ds_read_b128 v[40:43], v17 offset:9216
    v_mfma_f32_16x16x32_bf16 v[68:71], a[20:23], v[48:51], v[68:71]
    s_add_u32 m0, s49, 40960
    s_add_u32 s50, s48, 40960
    v_mfma_f32_16x16x32_bf16 v[72:75], a[16:19], v[52:55], v[72:75]
    ds_read_b128 v[44:47], v18 offset:9216
    v_mfma_f32_16x16x32_bf16 v[76:79], a[20:23], v[52:55], v[76:79]
    buffer_load_dwordx4 v21, s[8:11], s50 offen offset:0 sc1 lds
    s_waitcnt lgkmcnt(4)
    v_mfma_f32_16x16x32_bf16 v[64:67], a[24:27], v[56:59], v[64:67]
    ds_read_b128 v[48:51], v17 offset:10240
    v_mfma_f32_16x16x32_bf16 v[68:71], a[28:31], v[56:59], v[68:71]
    s_add_u32 m0, s49, 45056
    s_add_u32 s50, s48, 45056
    v_mfma_f32_16x16x32_bf16 v[72:75], a[24:27], v[60:63], v[72:75]
    ds_read_b128 v[52:55], v18 offset:10240
    v_mfma_f32_16x16x32_bf16 v[76:79], a[28:31], v[60:63], v[76:79]
    buffer_load_dwordx4 v21, s[8:11], s50 offen offset:0 sc1 lds
    s_waitcnt lgkmcnt(4)
    v_mfma_f32_16x16x32_bf16 v[64:67], a[32:35], v[32:35], v[64:67]
    ds_read_b128 v[56:59], v17 offset:11264
    v_mfma_f32_16x16x32_bf16 v[68:71], a[36:39], v[32:35], v[68:71]
    s_add_u32 m0, s49, 49152
    s_add_u32 s50, s48, 49152
    v_mfma_f32_16x16x32_bf16 v[72:75], a[32:35], v[36:39], v[72:75]
    ds_read_b128 v[60:63], v18 offset:11264
    v_mfma_f32_16x16x32_bf16 v[76:79], a[36:39], v[36:39], v[76:79]
    buffer_load_dwordx4 v21, s[8:11], s50 offen offset:0 sc1 lds
    s_waitcnt lgkmcnt(4)
    v_mfma_f32_16x16x32_bf16 v[64:67], a[40:43], v[40:43], v[64:67]
    s_waitcnt vmcnt(5)
    s_barrier
    ds_read_b128 v[32:35], v17 offset:16384
    v_mfma_f32_16x16x32_bf16 v[68:71], a[44:47], v[40:43], v[68:71]
    s_add_u32 m0, s49, 53248
    s_add_u32 s50, s48, 53248
    v_mfma_f32_16x16x32_bf16 v[72:75], a[40:43], v[44:47], v[72:75]
    ds_read_b128 v[36:39], v18 offset:16384
    v_mfma_f32_16x16x32_bf16 v[76:79], a[44:47], v[44:47], v[76:79]
    buffer_load_dwordx4 v21, s[8:11], s50 offen offset:0 sc1 lds
    s_waitcnt lgkmcnt(4)
    v_mfma_f32_16x16x32_bf16 v[64:67], a[48:51], v[48:51], v[64:67]
    ds_read_b128 v[40:43], v17 offset:17408
    v_mfma_f32_16x16x32_bf16 v[68:71], a[52:55], v[48:51], v[68:71]
    s_add_u32 m0, s49, 57344
    s_add_u32 s50, s48, 57344
    v_mfma_f32_16x16x32_bf16 v[72:75], a[48:51], v[52:55], v[72:75]
    ds_read_b128 v[44:47], v18 offset:17408
    v_mfma_f32_16x16x32_bf16 v[76:79], a[52:55], v[52:55], v[76:79]
    buffer_load_dwordx4 v21, s[8:11], s50 offen offset:0 sc1 lds
    s_waitcnt lgkmcnt(4)
    v_mfma_f32_16x16x32_bf16 v[64:67], a[56:59], v[56:59], v[64:67]
    ds_read_b128 v[48:51], v17 offset:18432
    v_mfma_f32_16x16x32_bf16 v[68:71], a[60:63], v[56:59], v[68:71]
    s_add_u32 m0, s49, 61440
    s_add_u32 s50, s48, 61440
    v_mfma_f32_16x16x32_bf16 v[72:75], a[56:59], v[60:63], v[72:75]
    ds_read_b128 v[52:55], v18 offset:18432
    v_mfma_f32_16x16x32_bf16 v[76:79], a[60:63], v[60:63], v[76:79]
    buffer_load_dwordx4 v21, s[8:11], s50 offen offset:0 sc1 lds
    s_waitcnt lgkmcnt(4)
    v_mfma_f32_16x16x32_bf16 v[64:67], a[64:67], v[32:35], v[64:67]
    ds_read_b128 v[56:59], v17 offset:19456
    v_mfma_f32_16x16x32_bf16 v[68:71], a[68:71], v[32:35], v[68:71]
    v_mfma_f32_16x16x32_bf16 v[72:75], a[64:67], v[36:39], v[72:75]
    ds_read_b128 v[60:63], v18 offset:19456
    v_mfma_f32_16x16x32_bf16 v[76:79], a[68:71], v[36:39], v[76:79]
    buffer_load_dwordx2 v[96:97], v22, s[16:19], s52 offen
    s_waitcnt lgkmcnt(4)
    v_mfma_f32_16x16x32_bf16 v[64:67], a[72:75], v[40:43], v[64:67]
    ds_read_b128 v[32:35], v17 offset:24576
    v_mfma_f32_16x16x32_bf16 v[68:71], a[76:79], v[40:43], v[68:71]
    v_mfma_f32_16x16x32_bf16 v[72:75], a[72:75], v[44:47], v[72:75]
    ds_read_b128 v[36:39], v18 offset:24576
    v_mfma_f32_16x16x32_bf16 v[76:79], a[76:79], v[44:47], v[76:79]
    buffer_load_dword v98, v23, s[8:11], s58 offen
    s_waitcnt lgkmcnt(4)
    v_mfma_f32_16x16x32_bf16 v[64:67], a[80:83], v[48:51], v[64:67]
    ds_read_b128 v[40:43], v17 offset:25600
    v_mfma_f32_16x16x32_bf16 v[68:71], a[84:87], v[48:51], v[68:71]
    v_mfma_f32_16x16x32_bf16 v[72:75], a[80:83], v[52:55], v[72:75]
    ds_read_b128 v[44:47], v18 offset:25600
    v_mfma_f32_16x16x32_bf16 v[76:79], a[84:87], v[52:55], v[76:79]
    buffer_load_dword v99, v23, s[8:11], s59 offen
    s_waitcnt lgkmcnt(4)
    v_mfma_f32_16x16x32_bf16 v[64:67], a[88:91], v[56:59], v[64:67]
    ds_read_b128 v[48:51], v17 offset:26624
    v_mfma_f32_16x16x32_bf16 v[68:71], a[92:95], v[56:59], v[68:71]
    v_mfma_f32_16x16x32_bf16 v[72:75], a[88:91], v[60:63], v[72:75]
    ds_read_b128 v[52:55], v18 offset:26624
    v_mfma_f32_16x16x32_bf16 v[76:79], a[92:95], v[60:63], v[76:79]
    buffer_load_dword v100, v16, s[8:11], s60 offen
    s_waitcnt lgkmcnt(4)
    v_mfma_f32_16x16x32_bf16 v[64:67], a[96:99], v[32:35], v[64:67]
    ds_read_b128 v[56:59], v17 offset:27648
    v_mfma_f32_16x16x32_bf16 v[68:71], a[100:103], v[32:35], v[68:71]
    v_mfma_f32_16x16x32_bf16 v[72:75], a[96:99], v[36:39], v[72:75]
    ds_read_b128 v[60:63], v18 offset:27648
    v_mfma_f32_16x16x32_bf16 v[76:79], a[100:103], v[36:39], v[76:79]
    s_waitcnt lgkmcnt(4)
    v_mfma_f32_16x16x32_bf16 v[64:67], a[104:107], v[40:43], v[64:67]
    s_waitcnt vmcnt(8)
    s_barrier
    ds_read_b128 v[32:35], v17 offset:32768
    v_mfma_f32_16x16x32_bf16 v[68:71], a[108:111], v[40:43], v[68:71]
    v_mfma_f32_16x16x32_bf16 v[72:75], a[104:107], v[44:47], v[72:75]
    ds_read_b128 v[36:39], v18 offset:32768
    v_mfma_f32_16x16x32_bf16 v[76:79], a[108:111], v[44:47], v[76:79]
    s_waitcnt lgkmcnt(4)
    v_mfma_f32_16x16x32_bf16 v[64:67], a[112:115], v[48:51], v[64:67]
    ds_read_b128 v[40:43], v17 offset:33792
    v_mfma_f32_16x16x32_bf16 v[68:71], a[116:119], v[48:51], v[68:71]
    v_mfma_f32_16x16x32_bf16 v[72:75], a[112:115], v[52:55], v[72:75]
    ds_read_b128 v[44:47], v18 offset:33792
    v_mfma_f32_16x16x32_bf16 v[76:79], a[116:119], v[52:55], v[76:79]
    s_waitcnt lgkmcnt(4)
    v_mfma_f32_16x16x32_bf16 v[64:67], a[120:123], v[56:59], v[64:67]
    ds_read_b128 v[48:51], v17 offset:34816
    v_mfma_f32_16x16x32_bf16 v[68:71], a[124:127], v[56:59], v[68:71]
    v_mfma_f32_16x16x32_bf16 v[72:75], a[120:123], v[60:63], v[72:75]
    ds_read_b128 v[52:55], v18 offset:34816
    v_mfma_f32_16x16x32_bf16 v[76:79], a[124:127], v[60:63], v[76:79]
    s_waitcnt lgkmcnt(4)
    v_mfma_f32_16x16x32_bf16 v[64:67], a[128:131], v[32:35], v[64:67]
    ds_read_b128 v[56:59], v17 offset:35840
    v_mfma_f32_16x16x32_bf16 v[68:71], a[132:135], v[32:35], v[68:71]
    v_mfma_f32_16x16x32_bf16 v[72:75], a[128:131], v[36:39], v[72:75]
    ds_read_b128 v[60:63], v18 offset:35840
    v_mfma_f32_16x16x32_bf16 v[76:79], a[132:135], v[36:39], v[76:79]
    s_waitcnt lgkmcnt(4)
    v_mfma_f32_16x16x32_bf16 v[64:67], a[136:139], v[40:43], v[64:67]
    ds_read_b128 v[32:35], v17 offset:40960
    v_mfma_f32_16x16x32_bf16 v[68:71], a[140:143], v[40:43], v[68:71]
    v_mfma_f32_16x16x32_bf16 v[72:75], a[136:139], v[44:47], v[72:75]
    ds_read_b128 v[36:39], v18 offset:40960
    v_mfma_f32_16x16x32_bf16 v[76:79], a[140:143], v[44:47], v[76:79]
    s_waitcnt lgkmcnt(4)
    v_mfma_f32_16x16x32_bf16 v[64:67], a[144:147], v[48:51], v[64:67]
    ds_read_b128 v[40:43], v17 offset:41984
    v_mfma_f32_16x16x32_bf16 v[68:71], a[148:151], v[48:51], v[68:71]
    v_mfma_f32_16x16x32_bf16 v[72:75], a[144:147], v[52:55], v[72:75]
    ds_read_b128 v[44:47], v18 offset:41984
    v_mfma_f32_16x16x32_bf16 v[76:79], a[148:151], v[52:55], v[76:79]
    s_waitcnt lgkmcnt(4)
    v_mfma_f32_16x16x32_bf16 v[64:67], a[152:155], v[56:59], v[64:67]
    ds_read_b128 v[48:51], v17 offset:43008
    v_mfma_f32_16x16x32_bf16 v[68:71], a[156:159], v[56:59], v[68:71]
    v_mfma_f32_16x16x32_bf16 v[72:75], a[152:155], v[60:63], v[72:75]
    ds_read_b128 v[52:55], v18 offset:43008
    v_mfma_f32_16x16x32_bf16 v[76:79], a[156:159], v[60:63], v[76:79]
    s_waitcnt lgkmcnt(4)
    v_mfma_f32_16x16x32_bf16 v[64:67], a[160:163], v[32:35], v[64:67]
    ds_read_b128 v[56:59], v17 offset:44032
    v_mfma_f32_16x16x32_bf16 v[68:71], a[164:167], v[32:35], v[68:71]
    v_mfma_f32_16x16x32_bf16 v[72:75], a[160:163], v[36:39], v[72:75]
    ds_read_b128 v[60:63], v18 offset:44032
    v_mfma_f32_16x16x32_bf16 v[76:79], a[164:167], v[36:39], v[76:79]
    s_waitcnt lgkmcnt(4)
    v_mfma_f32_16x16x32_bf16 v[64:67], a[168:171], v[40:43], v[64:67]
    s_waitcnt vmcnt(4)
    s_barrier
    ds_read_b128 v[32:35], v17 offset:49152
    v_mfma_f32_16x16x32_bf16 v[68:71], a[172:175], v[40:43], v[68:71]
    v_mfma_f32_16x16x32_bf16 v[72:75], a[168:171], v[44:47], v[72:75]
    ds_read_b128 v[36:39], v18 offset:49152
    v_mfma_f32_16x16x32_bf16 v[76:79], a[172:175], v[44:47], v[76:79]
    s_waitcnt lgkmcnt(4)
    v_mfma_f32_16x16x32_bf16 v[64:67], a[176:179], v[48:51], v[64:67]
    ds_read_b128 v[40:43], v17 offset:50176
    v_mfma_f32_16x16x32_bf16 v[68:71], a[180:183], v[48:51], v[68:71]
    v_mfma_f32_16x16x32_bf16 v[72:75], a[176:179], v[52:55], v[72:75]
    ds_read_b128 v[44:47], v18 offset:50176
    v_mfma_f32_16x16x32_bf16 v[76:79], a[180:183], v[52:55], v[76:79]
    s_waitcnt lgkmcnt(4)
    v_mfma_f32_16x16x32_bf16 v[64:67], a[184:187], v[56:59], v[64:67]
    ds_read_b128 v[48:51], v17 offset:51200
    v_mfma_f32_16x16x32_bf16 v[68:71], a[188:191], v[56:59], v[68:71]
    v_mfma_f32_16x16x32_bf16 v[72:75], a[184:187], v[60:63], v[72:75]
    ds_read_b128 v[52:55], v18 offset:51200
    v_mfma_f32_16x16x32_bf16 v[76:79], a[188:191], v[60:63], v[76:79]
    s_waitcnt lgkmcnt(4)
    v_mfma_f32_16x16x32_bf16 v[64:67], a[192:195], v[32:35], v[64:67]
    ds_read_b128 v[56:59], v17 offset:52224
    v_mfma_f32_16x16x32_bf16 v[68:71], a[196:199], v[32:35], v[68:71]
    v_mfma_f32_16x16x32_bf16 v[72:75], a[192:195], v[36:39], v[72:75]
    ds_read_b128 v[60:63], v18 offset:52224
    v_mfma_f32_16x16x32_bf16 v[76:79], a[196:199], v[36:39], v[76:79]
    s_waitcnt lgkmcnt(4)
    v_mfma_f32_16x16x32_bf16 v[64:67], a[200:203], v[40:43], v[64:67]
    ds_read_b128 v[32:35], v17 offset:57344
    v_mfma_f32_16x16x32_bf16 v[68:71], a[204:207], v[40:43], v[68:71]
    v_mfma_f32_16x16x32_bf16 v[72:75], a[200:203], v[44:47], v[72:75]
    ds_read_b128 v[36:39], v18 offset:57344
    v_mfma_f32_16x16x32_bf16 v[76:79], a[204:207], v[44:47], v[76:79]
    s_waitcnt lgkmcnt(4)
    v_mfma_f32_16x16x32_bf16 v[64:67], a[208:211], v[48:51], v[64:67]
    ds_read_b128 v[40:43], v17 offset:58368
    v_mfma_f32_16x16x32_bf16 v[68:71], a[212:215], v[48:51], v[68:71]
    v_mfma_f32_16x16x32_bf16 v[72:75], a[208:211], v[52:55], v[72:75]
    ds_read_b128 v[44:47], v18 offset:58368
    v_mfma_f32_16x16x32_bf16 v[76:79], a[212:215], v[52:55], v[76:79]
    s_waitcnt lgkmcnt(4)
    v_mfma_f32_16x16x32_bf16 v[64:67], a[216:219], v[56:59], v[64:67]
    ds_read_b128 v[48:51], v17 offset:59392
    v_mfma_f32_16x16x32_bf16 v[68:71], a[220:223], v[56:59], v[68:71]
    v_mfma_f32_16x16x32_bf16 v[72:75], a[216:219], v[60:63], v[72:75]
    ds_read_b128 v[52:55], v18 offset:59392
    v_mfma_f32_16x16x32_bf16 v[76:79], a[220:223], v[60:63], v[76:79]
    s_waitcnt lgkmcnt(4)
    v_mfma_f32_16x16x32_bf16 v[64:67], a[224:227], v[32:35], v[64:67]
    ds_read_b128 v[56:59], v17 offset:60416
    v_mfma_f32_16x16x32_bf16 v[68:71], a[228:231], v[32:35], v[68:71]
    v_mfma_f32_16x16x32_bf16 v[72:75], a[224:227], v[36:39], v[72:75]
    ds_read_b128 v[60:63], v18 offset:60416
    v_mfma_f32_16x16x32_bf16 v[76:79], a[228:231], v[36:39], v[76:79]
    s_waitcnt lgkmcnt(4)
    v_mfma_f32_16x16x32_bf16 v[64:67], a[232:235], v[40:43], v[64:67]
    v_mfma_f32_16x16x32_bf16 v[68:71], a[236:239], v[40:43], v[68:71]
    v_mfma_f32_16x16x32_bf16 v[72:75], a[232:235], v[44:47], v[72:75]
    v_mfma_f32_16x16x32_bf16 v[76:79], a[236:239], v[44:47], v[76:79]
    s_waitcnt lgkmcnt(2)
    v_mfma_f32_16x16x32_bf16 v[64:67], a[240:243], v[48:51], v[64:67]
    v_mfma_f32_16x16x32_bf16 v[68:71], a[244:247], v[48:51], v[68:71]
    v_mfma_f32_16x16x32_bf16 v[72:75], a[240:243], v[52:55], v[72:75]
    v_mfma_f32_16x16x32_bf16 v[76:79], a[244:247], v[52:55], v[76:79]
    s_waitcnt lgkmcnt(0)
    v_mfma_f32_16x16x32_bf16 v[64:67], a[248:251], v[56:59], v[64:67]
    v_mfma_f32_16x16x32_bf16 v[68:71], a[252:255], v[56:59], v[68:71]
    v_mfma_f32_16x16x32_bf16 v[72:75], a[248:251], v[60:63], v[72:75]
    v_mfma_f32_16x16x32_bf16 v[76:79], a[252:255], v[60:63], v[76:79]
    v_xor_b32 v17, 0x10000, v17
    v_xor_b32 v18, 0x10000, v18
    s_nop 3
    v_min_u32 v68, 0xfffffffe, v68
    buffer_store_dwordx4 v[68:71], v28, s[8:11], s51 offen sc1
    v_min_u32 v72, 0xfffffffe, v72
    buffer_store_dwordx4 v[72:75], v29, s[8:11], s51 offen sc1
    v_min_u32 v76, 0xfffffffe, v76
    buffer_store_dwordx4 v[76:79], v30, s[8:11], s51 offen sc1
    s_waitcnt vmcnt(3)
    v_sub_f32 v104, 1.0, v100
    v_cvt_pk_bf16_f32 v104, v104, v104
    v_lshlrev_b32 v104, 16, v104
    v_lshlrev_b32 v107, 16, v96
    v_and_b32 v108, 0xffff0000, v96
    v_lshlrev_b32 v109, 16, v98
    v_and_b32 v110, 0xffff0000, v98
    v_mul_f32 v107, v107, v109
    v_mul_f32 v108, v108, v110
    v_cvt_pk_bf16_f32 v107, v107, v108
    v_and_b32 v108, 0xffff0000, v107
    v_lshlrev_b32 v107, 16, v107
    v_mul_f32 v107, v100, v107
    v_mul_f32 v108, v100, v108
    v_cvt_pk_bf16_f32 v107, v107, v108
    v_and_b32 v113, 0xffff0000, v107
    v_lshlrev_b32 v112, 16, v107
    v_lshlrev_b32 v107, 16, v97
    v_and_b32 v108, 0xffff0000, v97
    v_lshlrev_b32 v109, 16, v99
    v_and_b32 v110, 0xffff0000, v99
    v_mul_f32 v107, v107, v109
    v_mul_f32 v108, v108, v110
    v_cvt_pk_bf16_f32 v107, v107, v108
    v_and_b32 v108, 0xffff0000, v107
    v_lshlrev_b32 v107, 16, v107
    v_mul_f32 v107, v100, v107
    v_mul_f32 v108, v100, v108
    v_cvt_pk_bf16_f32 v107, v107, v108
    v_and_b32 v115, 0xffff0000, v107
    v_lshlrev_b32 v114, 16, v107
    s_waitcnt vmcnt(0)
    buffer_load_dwordx4 v[84:87], v7, s[8:11], s51 offen sc1
    buffer_load_dwordx4 v[88:91], v8, s[8:11], s51 offen sc1
    buffer_load_dwordx4 v[92:95], v9, s[8:11], s51 offen sc1
    s_waitcnt vmcnt(0)
    s_mov_b32 s62, 0
.cc_424:
    v_max3_u32 v4, v84, v88, v92
    v_cmp_eq_u32 vcc, -1, v4
    s_cbranch_vccnz .cf_425
    v_add_f32 v84, v84, v88
    v_add_f32 v92, v64, v92
    v_add_f32 v85, v85, v89
    v_add_f32 v93, v65, v93
    v_add_f32 v86, v86, v90
    v_add_f32 v94, v66, v94
    v_add_f32 v87, v87, v91
    v_add_f32 v95, v67, v95
    v_add_f32 v84, v92, v84
    v_add_f32 v85, v93, v85
    v_add_f32 v86, v94, v86
    v_add_f32 v87, v95, v87
    v_cvt_pk_bf16_f32 v105, v84, v85
    v_cvt_pk_bf16_f32 v107, v86, v87
    v_and_b32 v106, 0xffff0000, v105
    v_lshlrev_b32 v105, 16, v105
    v_and_b32 v108, 0xffff0000, v107
    v_lshlrev_b32 v107, 16, v107
    v_mul_f32 v105, v104, v105
    v_mul_f32 v106, v104, v106
    v_mul_f32 v107, v104, v107
    v_mul_f32 v108, v104, v108
    v_cvt_pk_bf16_f32 v105, v105, v106
    v_cvt_pk_bf16_f32 v107, v107, v108
    v_and_b32 v106, 0xffff0000, v105
    v_lshlrev_b32 v105, 16, v105
    v_and_b32 v108, 0xffff0000, v107
    v_lshlrev_b32 v107, 16, v107
    v_add_f32 v105, v105, v112
    v_add_f32 v106, v106, v113
    v_add_f32 v107, v107, v114
    v_add_f32 v108, v108, v115
    v_cvt_pk_bf16_f32 v102, v105, v106
    v_cvt_pk_bf16_f32 v103, v107, v108
    buffer_store_dwordx2 v[102:103], v22, s[44:47], s52 offen
    s_branch .g2nx_399
.cf_402:
    buffer_load_dwordx4 v[84:87], v7, s[8:11], s51 offen sc1
    buffer_load_dwordx4 v[88:91], v8, s[8:11], s51 offen sc1
    buffer_load_dwordx4 v[92:95], v9, s[8:11], s51 offen sc1
    s_add_u32 s62, s62, 1
    s_cmp_gt_u32 s62, 0x400000
    s_cbranch_scc1 .mg_end_1
    s_waitcnt vmcnt(0)
    s_branch .cc_401

.cf_411:
    buffer_load_dwordx4 v[84:87], v7, s[8:11], s51 offen sc1
    buffer_load_dwordx4 v[88:91], v8, s[8:11], s51 offen sc1
    buffer_load_dwordx4 v[92:95], v9, s[8:11], s51 offen sc1
    s_add_u32 s62, s62, 1
    s_cmp_gt_u32 s62, 0x400000
    s_cbranch_scc1 .mg_end_1
    s_waitcnt vmcnt(0)
    s_branch .cc_410

.cf_421:
    buffer_load_dwordx4 v[84:87], v7, s[8:11], s51 offen sc1
    buffer_load_dwordx4 v[88:91], v8, s[8:11], s51 offen sc1
    buffer_load_dwordx4 v[92:95], v9, s[8:11], s51 offen sc1
    s_add_u32 s62, s62, 1
    s_cmp_gt_u32 s62, 0x400000
    s_cbranch_scc1 .mg_end_1
    s_waitcnt vmcnt(0)
    s_branch .cc_420

.cf_423:
    buffer_load_dwordx4 v[84:87], v7, s[8:11], s51 offen sc1
    buffer_load_dwordx4 v[88:91], v8, s[8:11], s51 offen sc1
    buffer_load_dwordx4 v[92:95], v9, s[8:11], s51 offen sc1
    s_add_u32 s62, s62, 1
    s_cmp_gt_u32 s62, 0x400000
    s_cbranch_scc1 .mg_end_1
    s_waitcnt vmcnt(0)
    s_branch .cc_422

.cf_425:
    buffer_load_dwordx4 v[84:87], v7, s[8:11], s51 offen sc1
    buffer_load_dwordx4 v[88:91], v8, s[8:11], s51 offen sc1
    buffer_load_dwordx4 v[92:95], v9, s[8:11], s51 offen sc1
    s_add_u32 s62, s62, 1
    s_cmp_gt_u32 s62, 0x400000
    s_cbranch_scc1 .mg_end_1
    s_waitcnt vmcnt(0)
    s_branch .cc_424

.g2fin_395:
    s_endpgm
.cvrole_369:
    s_lshl_b32 s4, s91, 3
    s_add_u32 s4, s4, s26
    s_add_u32 s4, s4, 72
    s_lshl_b32 s4, s4, 8
    s_add_u32 s92, s4, 92274688
    s_lshl_b32 s4, s24, 2
    s_add_u32 s92, s92, s4
    v_mov_b32 v4, 0
    s_mov_b64 exec, 1
    buffer_store_dword v4, v4, s[8:11], s92 offen sc1
    s_mov_b64 exec, -1

    s_waitcnt vmcnt(0)
    s_barrier
    v_mov_b32 v243, s99
    v_mov_b32 v242, 0
    s_cmp_lg_u32 s24, 0
    s_cbranch_scc1 .a1_426
    s_mov_b64 exec, 1
    buffer_atomic_add v243, v242, s[20:23], s97 offen sc1
    s_mov_b64 exec, -1

.a1_426:
    s_waitcnt vmcnt(0)
    s_cmp_lg_u32 s24, 0
    s_cbranch_scc1 .pm_428
    s_lshl_b32 s93, s91, 3
    s_add_u32 s93, s93, s26
    s_sub_u32 s93, s93, 24
    s_and_b32 s94, s93, 1
    s_sub_u32 s5, 0, s100
    s_and_b32 s5, s5, 0x1fffff
    s_add_u32 s5, s5, 100663296
    s_lshl_b32 s4, s94, 21
    s_add_u32 s5, s5, s4
    s_lshl_b32 s4, s93, 8
    s_add_u32 s5, s5, s4
    s_add_u32 s6, s5, 8192
    v_and_b32 v4, 63, v0
    v_lshlrev_b32 v4, 2, v4
    v_mov_b32 v5, -1
    s_mov_b32 s82, 0x7fffffff
    s_mov_b32 s83, 0x7fffffff
    buffer_store_dword v5, v4, s[8:11], s5 offen sc1
    s_waitcnt vmcnt(0)

    s_memtime s[72:73]
    s_waitcnt lgkmcnt(0)
    buffer_store_dword v5, v4, s[8:11], s6 offen sc1
    s_waitcnt vmcnt(0)
    s_memtime s[84:85]
    s_waitcnt lgkmcnt(0)
    s_sub_u32 s84, s84, s72
    s_min_u32 s83, s83, s84

    s_memtime s[72:73]
    s_waitcnt lgkmcnt(0)
    buffer_store_dword v5, v4, s[8:11], s5 offen sc1
    s_waitcnt vmcnt(0)
    s_memtime s[84:85]
    s_waitcnt lgkmcnt(0)
    s_sub_u32 s84, s84, s72
    s_min_u32 s82, s82, s84

    s_memtime s[72:73]
    s_waitcnt lgkmcnt(0)
    buffer_store_dword v5, v4, s[8:11], s6 offen sc1
    s_waitcnt vmcnt(0)
    s_memtime s[84:85]
    s_waitcnt lgkmcnt(0)
    s_sub_u32 s84, s84, s72
    s_min_u32 s83, s83, s84

    s_memtime s[72:73]
    s_waitcnt lgkmcnt(0)
    buffer_store_dword v5, v4, s[8:11], s5 offen sc1
    s_waitcnt vmcnt(0)
    s_memtime s[84:85]
    s_waitcnt lgkmcnt(0)
    s_sub_u32 s84, s84, s72
    s_min_u32 s82, s82, s84

    s_memtime s[72:73]
    s_waitcnt lgkmcnt(0)
    buffer_store_dword v5, v4, s[8:11], s6 offen sc1
    s_waitcnt vmcnt(0)
    s_memtime s[84:85]
    s_waitcnt lgkmcnt(0)
    s_sub_u32 s84, s84, s72
    s_min_u32 s83, s83, s84

    s_memtime s[72:73]
    s_waitcnt lgkmcnt(0)
    buffer_store_dword v5, v4, s[8:11], s5 offen sc1
    s_waitcnt vmcnt(0)
    s_memtime s[84:85]
    s_waitcnt lgkmcnt(0)
    s_sub_u32 s84, s84, s72
    s_min_u32 s82, s82, s84

    s_memtime s[72:73]
    s_waitcnt lgkmcnt(0)
    buffer_store_dword v5, v4, s[8:11], s6 offen sc1
    s_waitcnt vmcnt(0)
    s_memtime s[84:85]
    s_waitcnt lgkmcnt(0)
    s_sub_u32 s84, s84, s72
    s_min_u32 s83, s83, s84

    s_memtime s[72:73]
    s_waitcnt lgkmcnt(0)
    buffer_store_dword v5, v4, s[8:11], s5 offen sc1
    s_waitcnt vmcnt(0)
    s_memtime s[84:85]
    s_waitcnt lgkmcnt(0)
    s_sub_u32 s84, s84, s72
    s_min_u32 s82, s82, s84

    s_cmp_lt_u32 s82, s83
    s_cselect_b32 s4, 1, 0
    s_mul_i32 s94, s94, 6
    s_lshl_b32 s4, s4, s94
    s_add_u32 s95, s4, 0x1000000

.pm_428:
    s_cmp_lg_u32 s24, 0
    s_cbranch_scc1 .pv_429
    s_mov_b64 exec, 1
    v_mov_b32 v4, s95
    v_mov_b32 v5, 4
    buffer_atomic_add v4, v5, s[20:23], s97 offen sc1
    s_mov_b64 exec, -1

.pv_429:
    s_barrier
    s_lshl_b32 s93, s91, 3
    s_add_u32 s93, s93, s26
    s_sub_u32 s93, s93, 24

    s_load_dwordx2 s[40:41], s[0:1], 0
    s_load_dwordx2 s[42:43], s[0:1], 104

    v_and_b32 v1, 63, v0
    v_and_b32 v2, 15, v1
    v_lshrrev_b32 v3, 4, v1

    s_waitcnt lgkmcnt(0)
    s_mov_b32 s12, s40
    s_and_b32 s13, s41, 0xffff
    s_mov_b32 s14, 0x400000
    s_mov_b32 s15, 0x00020000

    s_mov_b32 s16, s42
    s_and_b32 s17, s43, 0xffff
    s_mov_b32 s18, 0x800
    s_mov_b32 s19, 0x00020000

    s_lshl_b32 s3, s93, 6
    s_lshl_b32 s4, s24, 4
    s_add_u32 s3, s3, s4
    v_lshlrev_b32 v8, 4, v1
    buffer_load_dwordx4 v[16:19], v8, s[16:19], 0 offen
    buffer_load_dwordx4 v[20:23], v8, s[16:19], 0 offen offset:1024
    s_lshl_b32 s5, s3, 11

    buffer_load_dwordx4 v[64:67], v8, s[12:15], s5 offen
    buffer_load_dwordx4 v[68:71], v8, s[12:15], s5 offen offset:1024
    s_add_u32 s5, s5, 2048

    buffer_load_dwordx4 v[72:75], v8, s[12:15], s5 offen
    buffer_load_dwordx4 v[76:79], v8, s[12:15], s5 offen offset:1024
    s_add_u32 s5, s5, 2048

    buffer_load_dwordx4 v[80:83], v8, s[12:15], s5 offen
    buffer_load_dwordx4 v[84:87], v8, s[12:15], s5 offen offset:1024
    s_add_u32 s5, s5, 2048

    buffer_load_dwordx4 v[88:91], v8, s[12:15], s5 offen
    buffer_load_dwordx4 v[92:95], v8, s[12:15], s5 offen offset:1024
    s_add_u32 s5, s5, 2048

    buffer_load_dwordx4 v[96:99], v8, s[12:15], s5 offen
    buffer_load_dwordx4 v[100:103], v8, s[12:15], s5 offen offset:1024
    s_add_u32 s5, s5, 2048

    buffer_load_dwordx4 v[104:107], v8, s[12:15], s5 offen
    buffer_load_dwordx4 v[108:111], v8, s[12:15], s5 offen offset:1024
    s_add_u32 s5, s5, 2048

    buffer_load_dwordx4 v[112:115], v8, s[12:15], s5 offen
    buffer_load_dwordx4 v[116:119], v8, s[12:15], s5 offen offset:1024
    s_add_u32 s5, s5, 2048

    buffer_load_dwordx4 v[120:123], v8, s[12:15], s5 offen
    buffer_load_dwordx4 v[124:127], v8, s[12:15], s5 offen offset:1024
    s_add_u32 s5, s5, 2048

    buffer_load_dwordx4 v[128:131], v8, s[12:15], s5 offen
    buffer_load_dwordx4 v[132:135], v8, s[12:15], s5 offen offset:1024
    s_add_u32 s5, s5, 2048

    buffer_load_dwordx4 v[136:139], v8, s[12:15], s5 offen
    buffer_load_dwordx4 v[140:143], v8, s[12:15], s5 offen offset:1024
    s_add_u32 s5, s5, 2048

    buffer_load_dwordx4 v[144:147], v8, s[12:15], s5 offen
    buffer_load_dwordx4 v[148:151], v8, s[12:15], s5 offen offset:1024
    s_add_u32 s5, s5, 2048

    buffer_load_dwordx4 v[152:155], v8, s[12:15], s5 offen
    buffer_load_dwordx4 v[156:159], v8, s[12:15], s5 offen offset:1024
    s_add_u32 s5, s5, 2048

    buffer_load_dwordx4 v[160:163], v8, s[12:15], s5 offen
    buffer_load_dwordx4 v[164:167], v8, s[12:15], s5 offen offset:1024
    s_add_u32 s5, s5, 2048

    buffer_load_dwordx4 v[168:171], v8, s[12:15], s5 offen
    buffer_load_dwordx4 v[172:175], v8, s[12:15], s5 offen offset:1024
    s_add_u32 s5, s5, 2048

    buffer_load_dwordx4 v[176:179], v8, s[12:15], s5 offen
    buffer_load_dwordx4 v[180:183], v8, s[12:15], s5 offen offset:1024
    s_add_u32 s5, s5, 2048

    buffer_load_dwordx4 v[184:187], v8, s[12:15], s5 offen
    buffer_load_dwordx4 v[188:191], v8, s[12:15], s5 offen offset:1024
    s_add_u32 s5, s5, 2048

    v_and_b32 v241, 3, v0
    v_lshlrev_b32 v241, 2, v241
    buffer_load_dword v240, v241, s[20:23], s97 offen sc1

    s_waitcnt vmcnt(29)
    v_dot2_f32_bf16 v24, v64, v16, 0
    v_dot2_f32_bf16 v25, v72, v16, 0
    v_dot2_f32_bf16 v24, v65, v17, v24
    v_dot2_f32_bf16 v25, v73, v17, v25
    v_dot2_f32_bf16 v24, v66, v18, v24
    v_dot2_f32_bf16 v25, v74, v18, v25
    v_dot2_f32_bf16 v24, v67, v19, v24
    v_dot2_f32_bf16 v25, v75, v19, v25
    v_dot2_f32_bf16 v24, v68, v20, v24
    v_dot2_f32_bf16 v25, v76, v20, v25
    v_dot2_f32_bf16 v24, v69, v21, v24
    v_dot2_f32_bf16 v25, v77, v21, v25
    v_dot2_f32_bf16 v24, v70, v22, v24
    v_dot2_f32_bf16 v25, v78, v22, v25
    v_dot2_f32_bf16 v24, v71, v23, v24
    v_dot2_f32_bf16 v25, v79, v23, v25
    s_waitcnt vmcnt(25)
    v_dot2_f32_bf16 v26, v80, v16, 0
    v_dot2_f32_bf16 v27, v88, v16, 0
    v_dot2_f32_bf16 v26, v81, v17, v26
    v_dot2_f32_bf16 v27, v89, v17, v27
    v_dot2_f32_bf16 v26, v82, v18, v26
    v_dot2_f32_bf16 v27, v90, v18, v27
    v_dot2_f32_bf16 v26, v83, v19, v26
    v_dot2_f32_bf16 v27, v91, v19, v27
    v_dot2_f32_bf16 v26, v84, v20, v26
    v_dot2_f32_bf16 v27, v92, v20, v27
    v_dot2_f32_bf16 v26, v85, v21, v26
    v_dot2_f32_bf16 v27, v93, v21, v27
    v_dot2_f32_bf16 v26, v86, v22, v26
    v_dot2_f32_bf16 v27, v94, v22, v27
    v_dot2_f32_bf16 v26, v87, v23, v26
    v_dot2_f32_bf16 v27, v95, v23, v27
    s_waitcnt vmcnt(21)
    v_dot2_f32_bf16 v28, v96, v16, 0
    v_dot2_f32_bf16 v29, v104, v16, 0
    v_dot2_f32_bf16 v28, v97, v17, v28
    v_dot2_f32_bf16 v29, v105, v17, v29
    v_dot2_f32_bf16 v28, v98, v18, v28
    v_dot2_f32_bf16 v29, v106, v18, v29
    v_dot2_f32_bf16 v28, v99, v19, v28
    v_dot2_f32_bf16 v29, v107, v19, v29
    v_dot2_f32_bf16 v28, v100, v20, v28
    v_dot2_f32_bf16 v29, v108, v20, v29
    v_dot2_f32_bf16 v28, v101, v21, v28
    v_dot2_f32_bf16 v29, v109, v21, v29
    v_dot2_f32_bf16 v28, v102, v22, v28
    v_dot2_f32_bf16 v29, v110, v22, v29
    v_dot2_f32_bf16 v28, v103, v23, v28
    v_dot2_f32_bf16 v29, v111, v23, v29
    s_waitcnt vmcnt(17)
    v_dot2_f32_bf16 v30, v112, v16, 0
    v_dot2_f32_bf16 v31, v120, v16, 0
    v_dot2_f32_bf16 v30, v113, v17, v30
    v_dot2_f32_bf16 v31, v121, v17, v31
    v_dot2_f32_bf16 v30, v114, v18, v30
    v_dot2_f32_bf16 v31, v122, v18, v31
    v_dot2_f32_bf16 v30, v115, v19, v30
    v_dot2_f32_bf16 v31, v123, v19, v31
    v_dot2_f32_bf16 v30, v116, v20, v30
    v_dot2_f32_bf16 v31, v124, v20, v31
    v_dot2_f32_bf16 v30, v117, v21, v30
    v_dot2_f32_bf16 v31, v125, v21, v31
    v_dot2_f32_bf16 v30, v118, v22, v30
    v_dot2_f32_bf16 v31, v126, v22, v31
    v_dot2_f32_bf16 v30, v119, v23, v30
    v_dot2_f32_bf16 v31, v127, v23, v31
    s_waitcnt vmcnt(13)
    v_dot2_f32_bf16 v32, v128, v16, 0
    v_dot2_f32_bf16 v33, v136, v16, 0
    v_dot2_f32_bf16 v32, v129, v17, v32
    v_dot2_f32_bf16 v33, v137, v17, v33
    v_dot2_f32_bf16 v32, v130, v18, v32
    v_dot2_f32_bf16 v33, v138, v18, v33
    v_dot2_f32_bf16 v32, v131, v19, v32
    v_dot2_f32_bf16 v33, v139, v19, v33
    v_dot2_f32_bf16 v32, v132, v20, v32
    v_dot2_f32_bf16 v33, v140, v20, v33
    v_dot2_f32_bf16 v32, v133, v21, v32
    v_dot2_f32_bf16 v33, v141, v21, v33
    v_dot2_f32_bf16 v32, v134, v22, v32
    v_dot2_f32_bf16 v33, v142, v22, v33
    v_dot2_f32_bf16 v32, v135, v23, v32
    v_dot2_f32_bf16 v33, v143, v23, v33
    s_waitcnt vmcnt(9)
    v_dot2_f32_bf16 v34, v144, v16, 0
    v_dot2_f32_bf16 v35, v152, v16, 0
    v_dot2_f32_bf16 v34, v145, v17, v34
    v_dot2_f32_bf16 v35, v153, v17, v35
    v_dot2_f32_bf16 v34, v146, v18, v34
    v_dot2_f32_bf16 v35, v154, v18, v35
    v_dot2_f32_bf16 v34, v147, v19, v34
    v_dot2_f32_bf16 v35, v155, v19, v35
    v_dot2_f32_bf16 v34, v148, v20, v34
    v_dot2_f32_bf16 v35, v156, v20, v35
    v_dot2_f32_bf16 v34, v149, v21, v34
    v_dot2_f32_bf16 v35, v157, v21, v35
    v_dot2_f32_bf16 v34, v150, v22, v34
    v_dot2_f32_bf16 v35, v158, v22, v35
    v_dot2_f32_bf16 v34, v151, v23, v34
    v_dot2_f32_bf16 v35, v159, v23, v35
    s_waitcnt vmcnt(5)
    v_dot2_f32_bf16 v36, v160, v16, 0
    v_dot2_f32_bf16 v37, v168, v16, 0
    v_dot2_f32_bf16 v36, v161, v17, v36
    v_dot2_f32_bf16 v37, v169, v17, v37
    v_dot2_f32_bf16 v36, v162, v18, v36
    v_dot2_f32_bf16 v37, v170, v18, v37
    v_dot2_f32_bf16 v36, v163, v19, v36
    v_dot2_f32_bf16 v37, v171, v19, v37
    v_dot2_f32_bf16 v36, v164, v20, v36
    v_dot2_f32_bf16 v37, v172, v20, v37
    v_dot2_f32_bf16 v36, v165, v21, v36
    v_dot2_f32_bf16 v37, v173, v21, v37
    v_dot2_f32_bf16 v36, v166, v22, v36
    v_dot2_f32_bf16 v37, v174, v22, v37
    v_dot2_f32_bf16 v36, v167, v23, v36
    v_dot2_f32_bf16 v37, v175, v23, v37
    s_waitcnt vmcnt(1)
    v_dot2_f32_bf16 v38, v176, v16, 0
    v_dot2_f32_bf16 v39, v184, v16, 0
    v_dot2_f32_bf16 v38, v177, v17, v38
    v_dot2_f32_bf16 v39, v185, v17, v39
    v_dot2_f32_bf16 v38, v178, v18, v38
    v_dot2_f32_bf16 v39, v186, v18, v39
    v_dot2_f32_bf16 v38, v179, v19, v38
    v_dot2_f32_bf16 v39, v187, v19, v39
    v_dot2_f32_bf16 v38, v180, v20, v38
    v_dot2_f32_bf16 v39, v188, v20, v39
    v_dot2_f32_bf16 v38, v181, v21, v38
    v_dot2_f32_bf16 v39, v189, v21, v39
    v_dot2_f32_bf16 v38, v182, v22, v38
    v_dot2_f32_bf16 v39, v190, v22, v39
    v_dot2_f32_bf16 v38, v183, v23, v38
    v_dot2_f32_bf16 v39, v191, v23, v39
    s_waitcnt vmcnt(0)
    s_mov_b32 s62, 0
.vp_430:
    v_readlane_b32 s4, v240, 0
    v_readlane_b32 s7, v240, 1
    v_readlane_b32 s6, v240, 2

    s_cmp_ge_u32 s4, 256
    s_cbranch_scc1 .vd_431
    s_cmp_lg_u32 s6, 0
    s_cbranch_scc1 .vs_432
    s_add_u32 s62, s62, 1
    s_cmp_gt_u32 s62, 0x100000
    s_cbranch_scc1 .mg_end_1
    s_sleep 8
    buffer_load_dword v240, v241, s[20:23], s97 offen sc1
    s_waitcnt vmcnt(0)
    s_branch .vp_430

.vs_432:
    s_lshr_b32 s25, s2, 5
    s_and_b32 s26, s2, 31
    s_mov_b32 s27, 1
    s_mov_b32 s99, 1
    s_mov_b32 s97, 144
    s_waitcnt vmcnt(0) lgkmcnt(0)
    s_barrier
    s_branch .mg_role_3

.vd_431:
    v_permlane32_swap_b32 v24, v26
    v_permlane32_swap_b32 v25, v27
    v_permlane32_swap_b32 v28, v30
    v_permlane32_swap_b32 v29, v31
    v_permlane32_swap_b32 v32, v34
    v_permlane32_swap_b32 v33, v35
    v_permlane32_swap_b32 v36, v38
    v_permlane32_swap_b32 v37, v39
    v_add_f32 v24, v24, v26
    v_add_f32 v25, v25, v27
    v_add_f32 v28, v28, v30
    v_add_f32 v29, v29, v31
    v_add_f32 v32, v32, v34
    v_add_f32 v33, v33, v35
    v_add_f32 v36, v36, v38
    v_add_f32 v37, v37, v39
    s_nop 0
    v_permlane16_swap_b32 v24, v25
    v_permlane16_swap_b32 v28, v29
    v_permlane16_swap_b32 v32, v33
    v_permlane16_swap_b32 v36, v37
    v_add_f32 v24, v24, v25
    v_add_f32 v28, v28, v29
    v_add_f32 v32, v32, v33
    v_add_f32 v36, v36, v37
    v_add_f32_dpp v24, v24, v24 row_ror:8 row_mask:0xf bank_mask:0xf
    v_add_f32_dpp v28, v28, v28 row_ror:8 row_mask:0xf bank_mask:0xf
    v_add_f32_dpp v32, v32, v32 row_ror:8 row_mask:0xf bank_mask:0xf
    v_add_f32_dpp v36, v36, v36 row_ror:8 row_mask:0xf bank_mask:0xf
    v_add_f32_dpp v24, v24, v24 row_ror:4 row_mask:0xf bank_mask:0xf
    v_add_f32_dpp v28, v28, v28 row_ror:4 row_mask:0xf bank_mask:0xf
    v_add_f32_dpp v32, v32, v32 row_ror:4 row_mask:0xf bank_mask:0xf
    v_add_f32_dpp v36, v36, v36 row_ror:4 row_mask:0xf bank_mask:0xf
    v_add_f32_dpp v24, v24, v24 row_ror:2 row_mask:0xf bank_mask:0xf
    v_add_f32_dpp v28, v28, v28 row_ror:2 row_mask:0xf bank_mask:0xf
    v_add_f32_dpp v32, v32, v32 row_ror:2 row_mask:0xf bank_mask:0xf
    v_add_f32_dpp v36, v36, v36 row_ror:2 row_mask:0xf bank_mask:0xf
    v_add_f32_dpp v24, v24, v24 row_ror:1 row_mask:0xf bank_mask:0xf
    v_add_f32_dpp v28, v28, v28 row_ror:1 row_mask:0xf bank_mask:0xf
    v_add_f32_dpp v32, v32, v32 row_ror:1 row_mask:0xf bank_mask:0xf
    v_add_f32_dpp v36, v36, v36 row_ror:1 row_mask:0xf bank_mask:0xf
    v_cmp_eq_u32 vcc, 1, v2
    s_nop 1
    v_cndmask_b32 v24, v24, v28, vcc
    v_cmp_eq_u32 vcc, 2, v2
    s_nop 1
    v_cndmask_b32 v24, v24, v32, vcc
    v_cmp_eq_u32 vcc, 3, v2
    s_nop 1
    v_cndmask_b32 v24, v24, v36, vcc
    v_cvt_pk_bf16_f32 v24, v24, v24
    s_mov_b32 s38, 0xbfb8aa3b
    v_lshlrev_b32 v24, 16, v24
    v_mul_f32 v24, s38, v24
    v_exp_f32 v24, v24
    v_lshlrev_b32 v8, 4, v2
    v_add_f32 v24, 1.0, v24
    v_rcp_f32 v24, v24
    v_lshl_add_u32 v8, v3, 2, v8
    v_cvt_pk_bf16_f32 v24, v24, v24
    v_cmp_gt_u32 vcc, 4, v2
    s_lshl_b32 s5, s3, 2
    s_add_u32 s5, s5, 121634816
    v_lshlrev_b32 v24, 16, v24
    s_mov_b64 exec, vcc
    buffer_store_dword v24, v8, s[8:11], s5 offen sc1
    s_mov_b64 exec, -1

    s_load_dwordx4 s[52:55], s[0:1], 8
    s_load_dwordx2 s[56:57], s[0:1], 24

    v_and_b32 v1, 63, v0
    v_and_b32 v2, 15, v1
    v_lshrrev_b32 v3, 4, v1

    v_lshrrev_b32 v4, 2, v1
    v_and_b32 v5, 3, v1
    v_lshlrev_b32 v10, 11, v4
    v_lshl_add_u32 v10, v5, 4, v10
    s_lshl_b32 s4, s93, 6
    v_add_u32 v10, s4, v10
    s_lshl_b32 s70, s24, 20
    s_mul_i32 s71, s24, 33280
    v_lshrrev_b32 v4, 2, v2
    v_lshl_add_u32 v4, v3, 5, v4
    v_lshlrev_b32 v4, 6, v4
    v_lshl_add_u32 v11, v5, 3, v4
    v_add_u32 v11, s71, v11
    s_lshl_b32 s4, s93, 17
    s_lshl_b32 s5, s24, 8
    s_add_u32 s72, s4, s5
    s_add_u32 s72, s72, 125829120
    v_lshlrev_b32 v12, 12, v2
    v_lshl_add_u32 v12, v3, 4, v12
    v_lshlrev_b32 v13, 3, v2
    s_lshl_b32 s6, s93, 8
    s_waitcnt lgkmcnt(0)

    s_mov_b32 s80, s52
    s_and_b32 s81, s53, 0xffff
    s_mov_b32 s82, 0x400000
    s_mov_b32 s83, 0x00020000

    s_mov_b32 s84, s54
    s_and_b32 s85, s55, 0xffff
    s_mov_b32 s86, 0x400000
    s_mov_b32 s87, 0x00020000

    s_mov_b32 s76, s56
    s_and_b32 s77, s57, 0xffff
    s_mov_b32 s78, 0x2000
    s_mov_b32 s79, 0x00020000

    buffer_load_dwordx2 v[196:197], v13, s[76:79], s6 offen
    buffer_load_dwordx2 v[198:199], v13, s[76:79], s6 offen offset:128

    s_add_u32 s4, s70, 0
    s_add_u32 m0, s71, 0
    s_sub_u32 s5, s4, 8192
    s_max_i32 s5, s5, 0
    s_mov_b64 exec, 0xffff
    buffer_load_dwordx4 v10, s[80:83], s5 offen lds
    s_mov_b64 exec, -1

    s_add_u32 m0, s71, 256
    s_nop 0
    buffer_load_dwordx4 v10, s[80:83], s4 offen lds
    s_add_u32 m0, s71, 8448
    s_nop 0
    buffer_load_dwordx4 v10, s[84:87], s4 offen lds
    s_add_u32 m0, s71, 1280
    s_add_u32 s4, s4, 32768
    buffer_load_dwordx4 v10, s[80:83], s4 offen lds
    s_add_u32 m0, s71, 9472
    s_nop 0
    buffer_load_dwordx4 v10, s[84:87], s4 offen lds
    s_add_u32 m0, s71, 2304
    s_add_u32 s4, s4, 32768
    buffer_load_dwordx4 v10, s[80:83], s4 offen lds
    s_add_u32 m0, s71, 10496
    s_nop 0
    buffer_load_dwordx4 v10, s[84:87], s4 offen lds
    s_add_u32 m0, s71, 3328
    s_add_u32 s4, s4, 32768
    buffer_load_dwordx4 v10, s[80:83], s4 offen lds
    s_add_u32 m0, s71, 11520
    s_nop 0
    buffer_load_dwordx4 v10, s[84:87], s4 offen lds
    s_add_u32 m0, s71, 4352
    s_add_u32 s4, s4, 32768
    buffer_load_dwordx4 v10, s[80:83], s4 offen lds
    s_add_u32 m0, s71, 12544
    s_nop 0
    buffer_load_dwordx4 v10, s[84:87], s4 offen lds
    s_add_u32 m0, s71, 5376
    s_add_u32 s4, s4, 32768
    buffer_load_dwordx4 v10, s[80:83], s4 offen lds
    s_add_u32 m0, s71, 13568
    s_nop 0
    buffer_load_dwordx4 v10, s[84:87], s4 offen lds
    s_add_u32 m0, s71, 6400
    s_add_u32 s4, s4, 32768
    buffer_load_dwordx4 v10, s[80:83], s4 offen lds
    s_add_u32 m0, s71, 14592
    s_nop 0
    buffer_load_dwordx4 v10, s[84:87], s4 offen lds
    s_add_u32 m0, s71, 7424
    s_add_u32 s4, s4, 32768
    buffer_load_dwordx4 v10, s[80:83], s4 offen lds
    s_add_u32 m0, s71, 15616
    s_nop 0
    buffer_load_dwordx4 v10, s[84:87], s4 offen lds
    s_add_u32 s4, s70, 262144
    s_add_u32 m0, s71, 16640
    s_sub_u32 s5, s4, 8192
    s_max_i32 s5, s5, 0
    s_mov_b64 exec, 0xffff
    buffer_load_dwordx4 v10, s[80:83], s5 offen lds
    s_mov_b64 exec, -1

    s_add_u32 m0, s71, 16896
    s_nop 0
    buffer_load_dwordx4 v10, s[80:83], s4 offen lds
    s_add_u32 m0, s71, 25088
    s_nop 0
    buffer_load_dwordx4 v10, s[84:87], s4 offen lds
    s_add_u32 m0, s71, 17920
    s_add_u32 s4, s4, 32768
    buffer_load_dwordx4 v10, s[80:83], s4 offen lds
    s_add_u32 m0, s71, 26112
    s_nop 0
    buffer_load_dwordx4 v10, s[84:87], s4 offen lds
    s_add_u32 m0, s71, 18944
    s_add_u32 s4, s4, 32768
    buffer_load_dwordx4 v10, s[80:83], s4 offen lds
    s_add_u32 m0, s71, 27136
    s_nop 0
    buffer_load_dwordx4 v10, s[84:87], s4 offen lds
    s_add_u32 m0, s71, 19968
    s_add_u32 s4, s4, 32768
    buffer_load_dwordx4 v10, s[80:83], s4 offen lds
    s_add_u32 m0, s71, 28160
    s_nop 0
    buffer_load_dwordx4 v10, s[84:87], s4 offen lds
    s_add_u32 m0, s71, 20992
    s_add_u32 s4, s4, 32768
    buffer_load_dwordx4 v10, s[80:83], s4 offen lds
    s_add_u32 m0, s71, 29184
    s_nop 0
    buffer_load_dwordx4 v10, s[84:87], s4 offen lds
    s_add_u32 m0, s71, 22016
    s_add_u32 s4, s4, 32768
    buffer_load_dwordx4 v10, s[80:83], s4 offen lds
    s_add_u32 m0, s71, 30208
    s_nop 0
    buffer_load_dwordx4 v10, s[84:87], s4 offen lds
    s_add_u32 m0, s71, 23040
    s_add_u32 s4, s4, 32768
    buffer_load_dwordx4 v10, s[80:83], s4 offen lds
    s_add_u32 m0, s71, 31232
    s_nop 0
    buffer_load_dwordx4 v10, s[84:87], s4 offen lds
    s_add_u32 m0, s71, 24064
    s_add_u32 s4, s4, 32768
    buffer_load_dwordx4 v10, s[80:83], s4 offen lds
    s_add_u32 m0, s71, 32256
    s_nop 0
    buffer_load_dwordx4 v10, s[84:87], s4 offen lds
    s_waitcnt vmcnt(17)
    v_alignbit_b32 v196, v196, v196, 16
    v_alignbit_b32 v197, v197, v197, 16
    v_alignbit_b32 v198, v198, v198, 16
    v_alignbit_b32 v199, v199, v199, 16
    ds_read_b64_tr_b16 v[16:17], v11 offset:0
    ds_read_b64_tr_b16 v[18:19], v11 offset:256
    ds_read_b64_tr_b16 v[20:21], v11 offset:512
    ds_read_b64_tr_b16 v[22:23], v11 offset:768
    ds_read_b64_tr_b16 v[24:25], v11 offset:1024
    ds_read_b64_tr_b16 v[26:27], v11 offset:1280
    ds_read_b64_tr_b16 v[28:29], v11 offset:1536
    ds_read_b64_tr_b16 v[30:31], v11 offset:1792
    ds_read_b64_tr_b16 v[32:33], v11 offset:2048
    ds_read_b64_tr_b16 v[34:35], v11 offset:8448
    ds_read_b64_tr_b16 v[36:37], v11 offset:8704
    ds_read_b64_tr_b16 v[38:39], v11 offset:8960
    ds_read_b64_tr_b16 v[40:41], v11 offset:9216
    ds_read_b64_tr_b16 v[42:43], v11 offset:9472
    ds_read_b64_tr_b16 v[44:45], v11 offset:9728
    ds_read_b64_tr_b16 v[46:47], v11 offset:9984
    ds_read_b64_tr_b16 v[48:49], v11 offset:10240
    ds_read_b64_tr_b16 v[50:51], v11 offset:32
    ds_read_b64_tr_b16 v[52:53], v11 offset:288
    ds_read_b64_tr_b16 v[54:55], v11 offset:544
    ds_read_b64_tr_b16 v[56:57], v11 offset:800
    ds_read_b64_tr_b16 v[58:59], v11 offset:1056
    ds_read_b64_tr_b16 v[60:61], v11 offset:1312
    ds_read_b64_tr_b16 v[62:63], v11 offset:1568
    ds_read_b64_tr_b16 v[64:65], v11 offset:1824
    ds_read_b64_tr_b16 v[66:67], v11 offset:2080
    ds_read_b64_tr_b16 v[68:69], v11 offset:8480
    ds_read_b64_tr_b16 v[70:71], v11 offset:8736
    ds_read_b64_tr_b16 v[72:73], v11 offset:8992
    ds_read_b64_tr_b16 v[74:75], v11 offset:9248
    ds_read_b64_tr_b16 v[76:77], v11 offset:9504
    ds_read_b64_tr_b16 v[78:79], v11 offset:9760
    ds_read_b64_tr_b16 v[80:81], v11 offset:10016
    ds_read_b64_tr_b16 v[82:83], v11 offset:10272
    s_waitcnt lgkmcnt(0)
    s_cmp_eq_u32 s24, 0
    s_cselect_b32 exec_lo, 0xffff, 0
    s_mov_b32 exec_hi, 0
    v_mov_b32 v16, 0
    v_mov_b32 v17, 0
    v_mov_b32 v50, 0
    v_mov_b32 v51, 0
    s_mov_b64 exec, -1
    s_add_u32 s4, s70, 524288
    s_add_u32 m0, s71, 0
    s_sub_u32 s5, s4, 8192
    s_max_i32 s5, s5, 0
    s_mov_b64 exec, 0xffff
    buffer_load_dwordx4 v10, s[80:83], s5 offen lds
    s_mov_b64 exec, -1

    s_add_u32 m0, s71, 256
    s_nop 0
    buffer_load_dwordx4 v10, s[80:83], s4 offen lds
    s_add_u32 m0, s71, 8448
    s_nop 0
    buffer_load_dwordx4 v10, s[84:87], s4 offen lds
    s_add_u32 m0, s71, 1280
    s_add_u32 s4, s4, 32768
    buffer_load_dwordx4 v10, s[80:83], s4 offen lds
    s_add_u32 m0, s71, 9472
    s_nop 0
    buffer_load_dwordx4 v10, s[84:87], s4 offen lds
    s_add_u32 m0, s71, 2304
    s_add_u32 s4, s4, 32768
    buffer_load_dwordx4 v10, s[80:83], s4 offen lds
    s_add_u32 m0, s71, 10496
    s_nop 0
    buffer_load_dwordx4 v10, s[84:87], s4 offen lds
    s_add_u32 m0, s71, 3328
    s_add_u32 s4, s4, 32768
    buffer_load_dwordx4 v10, s[80:83], s4 offen lds
    s_add_u32 m0, s71, 11520
    s_nop 0
    buffer_load_dwordx4 v10, s[84:87], s4 offen lds
    s_add_u32 m0, s71, 4352
    s_add_u32 s4, s4, 32768
    buffer_load_dwordx4 v10, s[80:83], s4 offen lds
    s_add_u32 m0, s71, 12544
    s_nop 0
    buffer_load_dwordx4 v10, s[84:87], s4 offen lds
    s_add_u32 m0, s71, 5376
    s_add_u32 s4, s4, 32768
    buffer_load_dwordx4 v10, s[80:83], s4 offen lds
    s_add_u32 m0, s71, 13568
    s_nop 0
    buffer_load_dwordx4 v10, s[84:87], s4 offen lds
    s_add_u32 m0, s71, 6400
    s_add_u32 s4, s4, 32768
    buffer_load_dwordx4 v10, s[80:83], s4 offen lds
    s_add_u32 m0, s71, 14592
    s_nop 0
    buffer_load_dwordx4 v10, s[84:87], s4 offen lds
    s_add_u32 m0, s71, 7424
    s_add_u32 s4, s4, 32768
    buffer_load_dwordx4 v10, s[80:83], s4 offen lds
    s_add_u32 m0, s71, 15616
    s_nop 0
    buffer_load_dwordx4 v10, s[84:87], s4 offen lds
    v_alignbit_b32 v84, v17, v16, 16
    v_alignbit_b32 v85, v18, v17, 16
    v_alignbit_b32 v86, v19, v18, 16
    v_alignbit_b32 v87, v20, v19, 16
    v_alignbit_b32 v88, v21, v20, 16
    v_alignbit_b32 v89, v22, v21, 16
    v_alignbit_b32 v90, v23, v22, 16
    v_alignbit_b32 v91, v24, v23, 16
    v_alignbit_b32 v92, v25, v24, 16
    v_alignbit_b32 v93, v26, v25, 16
    v_alignbit_b32 v94, v27, v26, 16
    v_alignbit_b32 v95, v28, v27, 16
    v_alignbit_b32 v96, v29, v28, 16
    v_alignbit_b32 v97, v30, v29, 16
    v_alignbit_b32 v98, v31, v30, 16
    v_alignbit_b32 v99, v32, v31, 16
    v_alignbit_b32 v100, v33, v32, 16
    v_dot2_f32_bf16 v102, v84, v197, 0
    v_dot2_f32_bf16 v103, v17, v197, 0
    v_dot2_f32_bf16 v106, v85, v197, 0
    v_dot2_f32_bf16 v107, v18, v197, 0
    v_dot2_f32_bf16 v110, v86, v197, 0
    v_dot2_f32_bf16 v111, v19, v197, 0
    v_dot2_f32_bf16 v114, v87, v197, 0
    v_dot2_f32_bf16 v115, v20, v197, 0
    v_dot2_f32_bf16 v102, v85, v196, v102
    v_dot2_f32_bf16 v103, v18, v196, v103
    v_dot2_f32_bf16 v106, v86, v196, v106
    v_dot2_f32_bf16 v107, v19, v196, v107
    v_dot2_f32_bf16 v110, v87, v196, v110
    v_dot2_f32_bf16 v111, v20, v196, v111
    v_dot2_f32_bf16 v114, v88, v196, v114
    v_dot2_f32_bf16 v115, v21, v196, v115
    v_lshlrev_b32 v104, 16, v34
    v_and_b32 v105, 0xffff0000, v34
    v_lshlrev_b32 v108, 16, v35
    v_and_b32 v109, 0xffff0000, v35
    v_lshlrev_b32 v112, 16, v36
    v_and_b32 v113, 0xffff0000, v36
    v_lshlrev_b32 v116, 16, v37
    v_and_b32 v117, 0xffff0000, v37
    v_mul_f32 v102, v102, v104
    v_mul_f32 v103, v103, v105
    v_mul_f32 v106, v106, v108
    v_mul_f32 v107, v107, v109
    v_mul_f32 v110, v110, v112
    v_mul_f32 v111, v111, v113
    v_mul_f32 v114, v114, v116
    v_mul_f32 v115, v115, v117
    v_cvt_pk_bf16_f32 v137, v103, v102
    v_cvt_pk_bf16_f32 v136, v107, v106
    v_cvt_pk_bf16_f32 v135, v111, v110
    v_cvt_pk_bf16_f32 v134, v115, v114
    s_add_u32 s4, s72, 0
    buffer_store_dwordx4 v[134:137], v12, s[8:11], s4 offen offset:0
    v_dot2_f32_bf16 v118, v88, v197, 0
    v_dot2_f32_bf16 v119, v21, v197, 0
    v_dot2_f32_bf16 v122, v89, v197, 0
    v_dot2_f32_bf16 v123, v22, v197, 0
    v_dot2_f32_bf16 v126, v90, v197, 0
    v_dot2_f32_bf16 v127, v23, v197, 0
    v_dot2_f32_bf16 v130, v91, v197, 0
    v_dot2_f32_bf16 v131, v24, v197, 0
    v_dot2_f32_bf16 v118, v89, v196, v118
    v_dot2_f32_bf16 v119, v22, v196, v119
    v_dot2_f32_bf16 v122, v90, v196, v122
    v_dot2_f32_bf16 v123, v23, v196, v123
    v_dot2_f32_bf16 v126, v91, v196, v126
    v_dot2_f32_bf16 v127, v24, v196, v127
    v_dot2_f32_bf16 v130, v92, v196, v130
    v_dot2_f32_bf16 v131, v25, v196, v131
    v_lshlrev_b32 v120, 16, v38
    v_and_b32 v121, 0xffff0000, v38
    v_lshlrev_b32 v124, 16, v39
    v_and_b32 v125, 0xffff0000, v39
    v_lshlrev_b32 v128, 16, v40
    v_and_b32 v129, 0xffff0000, v40
    v_lshlrev_b32 v132, 16, v41
    v_and_b32 v133, 0xffff0000, v41
    v_mul_f32 v118, v118, v120
    v_mul_f32 v119, v119, v121
    v_mul_f32 v122, v122, v124
    v_mul_f32 v123, v123, v125
    v_mul_f32 v126, v126, v128
    v_mul_f32 v127, v127, v129
    v_mul_f32 v130, v130, v132
    v_mul_f32 v131, v131, v133
    v_cvt_pk_bf16_f32 v141, v119, v118
    v_cvt_pk_bf16_f32 v140, v123, v122
    v_cvt_pk_bf16_f32 v139, v127, v126
    v_cvt_pk_bf16_f32 v138, v131, v130
    buffer_store_dwordx4 v[138:141], v12, s[8:11], s4 offen offset:1024
    v_dot2_f32_bf16 v102, v92, v197, 0
    v_dot2_f32_bf16 v103, v25, v197, 0
    v_dot2_f32_bf16 v106, v93, v197, 0
    v_dot2_f32_bf16 v107, v26, v197, 0
    v_dot2_f32_bf16 v110, v94, v197, 0
    v_dot2_f32_bf16 v111, v27, v197, 0
    v_dot2_f32_bf16 v114, v95, v197, 0
    v_dot2_f32_bf16 v115, v28, v197, 0
    v_dot2_f32_bf16 v102, v93, v196, v102
    v_dot2_f32_bf16 v103, v26, v196, v103
    v_dot2_f32_bf16 v106, v94, v196, v106
    v_dot2_f32_bf16 v107, v27, v196, v107
    v_dot2_f32_bf16 v110, v95, v196, v110
    v_dot2_f32_bf16 v111, v28, v196, v111
    v_dot2_f32_bf16 v114, v96, v196, v114
    v_dot2_f32_bf16 v115, v29, v196, v115
    v_lshlrev_b32 v104, 16, v42
    v_and_b32 v105, 0xffff0000, v42
    v_lshlrev_b32 v108, 16, v43
    v_and_b32 v109, 0xffff0000, v43
    v_lshlrev_b32 v112, 16, v44
    v_and_b32 v113, 0xffff0000, v44
    v_lshlrev_b32 v116, 16, v45
    v_and_b32 v117, 0xffff0000, v45
    v_mul_f32 v102, v102, v104
    v_mul_f32 v103, v103, v105
    v_mul_f32 v106, v106, v108
    v_mul_f32 v107, v107, v109
    v_mul_f32 v110, v110, v112
    v_mul_f32 v111, v111, v113
    v_mul_f32 v114, v114, v116
    v_mul_f32 v115, v115, v117
    v_cvt_pk_bf16_f32 v145, v103, v102
    v_cvt_pk_bf16_f32 v144, v107, v106
    v_cvt_pk_bf16_f32 v143, v111, v110
    v_cvt_pk_bf16_f32 v142, v115, v114
    buffer_store_dwordx4 v[142:145], v12, s[8:11], s4 offen offset:2048
    v_dot2_f32_bf16 v118, v96, v197, 0
    v_dot2_f32_bf16 v119, v29, v197, 0
    v_dot2_f32_bf16 v122, v97, v197, 0
    v_dot2_f32_bf16 v123, v30, v197, 0
    v_dot2_f32_bf16 v126, v98, v197, 0
    v_dot2_f32_bf16 v127, v31, v197, 0
    v_dot2_f32_bf16 v130, v99, v197, 0
    v_dot2_f32_bf16 v131, v32, v197, 0
    v_dot2_f32_bf16 v118, v97, v196, v118
    v_dot2_f32_bf16 v119, v30, v196, v119
    v_dot2_f32_bf16 v122, v98, v196, v122
    v_dot2_f32_bf16 v123, v31, v196, v123
    v_dot2_f32_bf16 v126, v99, v196, v126
    v_dot2_f32_bf16 v127, v32, v196, v127
    v_dot2_f32_bf16 v130, v100, v196, v130
    v_dot2_f32_bf16 v131, v33, v196, v131
    v_lshlrev_b32 v120, 16, v46
    v_and_b32 v121, 0xffff0000, v46
    v_lshlrev_b32 v124, 16, v47
    v_and_b32 v125, 0xffff0000, v47
    v_lshlrev_b32 v128, 16, v48
    v_and_b32 v129, 0xffff0000, v48
    v_lshlrev_b32 v132, 16, v49
    v_and_b32 v133, 0xffff0000, v49
    v_mul_f32 v118, v118, v120
    v_mul_f32 v119, v119, v121
    v_mul_f32 v122, v122, v124
    v_mul_f32 v123, v123, v125
    v_mul_f32 v126, v126, v128
    v_mul_f32 v127, v127, v129
    v_mul_f32 v130, v130, v132
    v_mul_f32 v131, v131, v133
    v_cvt_pk_bf16_f32 v149, v119, v118
    v_cvt_pk_bf16_f32 v148, v123, v122
    v_cvt_pk_bf16_f32 v147, v127, v126
    v_cvt_pk_bf16_f32 v146, v131, v130
    buffer_store_dwordx4 v[146:149], v12, s[8:11], s4 offen offset:3072
    v_alignbit_b32 v84, v51, v50, 16
    v_alignbit_b32 v85, v52, v51, 16
    v_alignbit_b32 v86, v53, v52, 16
    v_alignbit_b32 v87, v54, v53, 16
    v_alignbit_b32 v88, v55, v54, 16
    v_alignbit_b32 v89, v56, v55, 16
    v_alignbit_b32 v90, v57, v56, 16
    v_alignbit_b32 v91, v58, v57, 16
    v_alignbit_b32 v92, v59, v58, 16
    v_alignbit_b32 v93, v60, v59, 16
    v_alignbit_b32 v94, v61, v60, 16
    v_alignbit_b32 v95, v62, v61, 16
    v_alignbit_b32 v96, v63, v62, 16
    v_alignbit_b32 v97, v64, v63, 16
    v_alignbit_b32 v98, v65, v64, 16
    v_alignbit_b32 v99, v66, v65, 16
    v_alignbit_b32 v100, v67, v66, 16
    v_dot2_f32_bf16 v102, v84, v199, 0
    v_dot2_f32_bf16 v103, v51, v199, 0
    v_dot2_f32_bf16 v106, v85, v199, 0
    v_dot2_f32_bf16 v107, v52, v199, 0
    v_dot2_f32_bf16 v110, v86, v199, 0
    v_dot2_f32_bf16 v111, v53, v199, 0
    v_dot2_f32_bf16 v114, v87, v199, 0
    v_dot2_f32_bf16 v115, v54, v199, 0
    v_dot2_f32_bf16 v102, v85, v198, v102
    v_dot2_f32_bf16 v103, v52, v198, v103
    v_dot2_f32_bf16 v106, v86, v198, v106
    v_dot2_f32_bf16 v107, v53, v198, v107
    v_dot2_f32_bf16 v110, v87, v198, v110
    v_dot2_f32_bf16 v111, v54, v198, v111
    v_dot2_f32_bf16 v114, v88, v198, v114
    v_dot2_f32_bf16 v115, v55, v198, v115
    v_lshlrev_b32 v104, 16, v68
    v_and_b32 v105, 0xffff0000, v68
    v_lshlrev_b32 v108, 16, v69
    v_and_b32 v109, 0xffff0000, v69
    v_lshlrev_b32 v112, 16, v70
    v_and_b32 v113, 0xffff0000, v70
    v_lshlrev_b32 v116, 16, v71
    v_and_b32 v117, 0xffff0000, v71
    v_mul_f32 v102, v102, v104
    v_mul_f32 v103, v103, v105
    v_mul_f32 v106, v106, v108
    v_mul_f32 v107, v107, v109
    v_mul_f32 v110, v110, v112
    v_mul_f32 v111, v111, v113
    v_mul_f32 v114, v114, v116
    v_mul_f32 v115, v115, v117
    v_cvt_pk_bf16_f32 v153, v103, v102
    v_cvt_pk_bf16_f32 v152, v107, v106
    v_cvt_pk_bf16_f32 v151, v111, v110
    v_cvt_pk_bf16_f32 v150, v115, v114
    s_add_u32 s4, s72, 65536
    buffer_store_dwordx4 v[150:153], v12, s[8:11], s4 offen offset:0
    v_dot2_f32_bf16 v118, v88, v199, 0
    v_dot2_f32_bf16 v119, v55, v199, 0
    v_dot2_f32_bf16 v122, v89, v199, 0
    v_dot2_f32_bf16 v123, v56, v199, 0
    v_dot2_f32_bf16 v126, v90, v199, 0
    v_dot2_f32_bf16 v127, v57, v199, 0
    v_dot2_f32_bf16 v130, v91, v199, 0
    v_dot2_f32_bf16 v131, v58, v199, 0
    v_dot2_f32_bf16 v118, v89, v198, v118
    v_dot2_f32_bf16 v119, v56, v198, v119
    v_dot2_f32_bf16 v122, v90, v198, v122
    v_dot2_f32_bf16 v123, v57, v198, v123
    v_dot2_f32_bf16 v126, v91, v198, v126
    v_dot2_f32_bf16 v127, v58, v198, v127
    v_dot2_f32_bf16 v130, v92, v198, v130
    v_dot2_f32_bf16 v131, v59, v198, v131
    v_lshlrev_b32 v120, 16, v72
    v_and_b32 v121, 0xffff0000, v72
    v_lshlrev_b32 v124, 16, v73
    v_and_b32 v125, 0xffff0000, v73
    v_lshlrev_b32 v128, 16, v74
    v_and_b32 v129, 0xffff0000, v74
    v_lshlrev_b32 v132, 16, v75
    v_and_b32 v133, 0xffff0000, v75
    v_mul_f32 v118, v118, v120
    v_mul_f32 v119, v119, v121
    v_mul_f32 v122, v122, v124
    v_mul_f32 v123, v123, v125
    v_mul_f32 v126, v126, v128
    v_mul_f32 v127, v127, v129
    v_mul_f32 v130, v130, v132
    v_mul_f32 v131, v131, v133
    v_cvt_pk_bf16_f32 v157, v119, v118
    v_cvt_pk_bf16_f32 v156, v123, v122
    v_cvt_pk_bf16_f32 v155, v127, v126
    v_cvt_pk_bf16_f32 v154, v131, v130
    buffer_store_dwordx4 v[154:157], v12, s[8:11], s4 offen offset:1024
    v_dot2_f32_bf16 v102, v92, v199, 0
    v_dot2_f32_bf16 v103, v59, v199, 0
    v_dot2_f32_bf16 v106, v93, v199, 0
    v_dot2_f32_bf16 v107, v60, v199, 0
    v_dot2_f32_bf16 v110, v94, v199, 0
    v_dot2_f32_bf16 v111, v61, v199, 0
    v_dot2_f32_bf16 v114, v95, v199, 0
    v_dot2_f32_bf16 v115, v62, v199, 0
    v_dot2_f32_bf16 v102, v93, v198, v102
    v_dot2_f32_bf16 v103, v60, v198, v103
    v_dot2_f32_bf16 v106, v94, v198, v106
    v_dot2_f32_bf16 v107, v61, v198, v107
    v_dot2_f32_bf16 v110, v95, v198, v110
    v_dot2_f32_bf16 v111, v62, v198, v111
    v_dot2_f32_bf16 v114, v96, v198, v114
    v_dot2_f32_bf16 v115, v63, v198, v115
    v_lshlrev_b32 v104, 16, v76
    v_and_b32 v105, 0xffff0000, v76
    v_lshlrev_b32 v108, 16, v77
    v_and_b32 v109, 0xffff0000, v77
    v_lshlrev_b32 v112, 16, v78
    v_and_b32 v113, 0xffff0000, v78
    v_lshlrev_b32 v116, 16, v79
    v_and_b32 v117, 0xffff0000, v79
    v_mul_f32 v102, v102, v104
    v_mul_f32 v103, v103, v105
    v_mul_f32 v106, v106, v108
    v_mul_f32 v107, v107, v109
    v_mul_f32 v110, v110, v112
    v_mul_f32 v111, v111, v113
    v_mul_f32 v114, v114, v116
    v_mul_f32 v115, v115, v117
    v_cvt_pk_bf16_f32 v161, v103, v102
    v_cvt_pk_bf16_f32 v160, v107, v106
    v_cvt_pk_bf16_f32 v159, v111, v110
    v_cvt_pk_bf16_f32 v158, v115, v114
    buffer_store_dwordx4 v[158:161], v12, s[8:11], s4 offen offset:2048
    v_dot2_f32_bf16 v118, v96, v199, 0
    v_dot2_f32_bf16 v119, v63, v199, 0
    v_dot2_f32_bf16 v122, v97, v199, 0
    v_dot2_f32_bf16 v123, v64, v199, 0
    v_dot2_f32_bf16 v126, v98, v199, 0
    v_dot2_f32_bf16 v127, v65, v199, 0
    v_dot2_f32_bf16 v130, v99, v199, 0
    v_dot2_f32_bf16 v131, v66, v199, 0
    v_dot2_f32_bf16 v118, v97, v198, v118
    v_dot2_f32_bf16 v119, v64, v198, v119
    v_dot2_f32_bf16 v122, v98, v198, v122
    v_dot2_f32_bf16 v123, v65, v198, v123
    v_dot2_f32_bf16 v126, v99, v198, v126
    v_dot2_f32_bf16 v127, v66, v198, v127
    v_dot2_f32_bf16 v130, v100, v198, v130
    v_dot2_f32_bf16 v131, v67, v198, v131
    v_lshlrev_b32 v120, 16, v80
    v_and_b32 v121, 0xffff0000, v80
    v_lshlrev_b32 v124, 16, v81
    v_and_b32 v125, 0xffff0000, v81
    v_lshlrev_b32 v128, 16, v82
    v_and_b32 v129, 0xffff0000, v82
    v_lshlrev_b32 v132, 16, v83
    v_and_b32 v133, 0xffff0000, v83
    v_mul_f32 v118, v118, v120
    v_mul_f32 v119, v119, v121
    v_mul_f32 v122, v122, v124
    v_mul_f32 v123, v123, v125
    v_mul_f32 v126, v126, v128
    v_mul_f32 v127, v127, v129
    v_mul_f32 v130, v130, v132
    v_mul_f32 v131, v131, v133
    v_cvt_pk_bf16_f32 v165, v119, v118
    v_cvt_pk_bf16_f32 v164, v123, v122
    v_cvt_pk_bf16_f32 v163, v127, v126
    v_cvt_pk_bf16_f32 v162, v131, v130
    buffer_store_dwordx4 v[162:165], v12, s[8:11], s4 offen offset:3072
    s_waitcnt vmcnt(25)
    ds_read_b64_tr_b16 v[16:17], v11 offset:16640
    ds_read_b64_tr_b16 v[18:19], v11 offset:16896
    ds_read_b64_tr_b16 v[20:21], v11 offset:17152
    ds_read_b64_tr_b16 v[22:23], v11 offset:17408
    ds_read_b64_tr_b16 v[24:25], v11 offset:17664
    ds_read_b64_tr_b16 v[26:27], v11 offset:17920
    ds_read_b64_tr_b16 v[28:29], v11 offset:18176
    ds_read_b64_tr_b16 v[30:31], v11 offset:18432
    ds_read_b64_tr_b16 v[32:33], v11 offset:18688
    ds_read_b64_tr_b16 v[34:35], v11 offset:25088
    ds_read_b64_tr_b16 v[36:37], v11 offset:25344
    ds_read_b64_tr_b16 v[38:39], v11 offset:25600
    ds_read_b64_tr_b16 v[40:41], v11 offset:25856
    ds_read_b64_tr_b16 v[42:43], v11 offset:26112
    ds_read_b64_tr_b16 v[44:45], v11 offset:26368
    ds_read_b64_tr_b16 v[46:47], v11 offset:26624
    ds_read_b64_tr_b16 v[48:49], v11 offset:26880
    ds_read_b64_tr_b16 v[50:51], v11 offset:16672
    ds_read_b64_tr_b16 v[52:53], v11 offset:16928
    ds_read_b64_tr_b16 v[54:55], v11 offset:17184
    ds_read_b64_tr_b16 v[56:57], v11 offset:17440
    ds_read_b64_tr_b16 v[58:59], v11 offset:17696
    ds_read_b64_tr_b16 v[60:61], v11 offset:17952
    ds_read_b64_tr_b16 v[62:63], v11 offset:18208
    ds_read_b64_tr_b16 v[64:65], v11 offset:18464
    ds_read_b64_tr_b16 v[66:67], v11 offset:18720
    ds_read_b64_tr_b16 v[68:69], v11 offset:25120
    ds_read_b64_tr_b16 v[70:71], v11 offset:25376
    ds_read_b64_tr_b16 v[72:73], v11 offset:25632
    ds_read_b64_tr_b16 v[74:75], v11 offset:25888
    ds_read_b64_tr_b16 v[76:77], v11 offset:26144
    ds_read_b64_tr_b16 v[78:79], v11 offset:26400
    ds_read_b64_tr_b16 v[80:81], v11 offset:26656
    ds_read_b64_tr_b16 v[82:83], v11 offset:26912
    s_waitcnt lgkmcnt(0)
    s_add_u32 s4, s70, 786432
    s_add_u32 m0, s71, 16640
    s_sub_u32 s5, s4, 8192
    s_max_i32 s5, s5, 0
    s_mov_b64 exec, 0xffff
    buffer_load_dwordx4 v10, s[80:83], s5 offen lds
    s_mov_b64 exec, -1

    s_add_u32 m0, s71, 16896
    s_nop 0
    buffer_load_dwordx4 v10, s[80:83], s4 offen lds
    s_add_u32 m0, s71, 25088
    s_nop 0
    buffer_load_dwordx4 v10, s[84:87], s4 offen lds
    s_add_u32 m0, s71, 17920
    s_add_u32 s4, s4, 32768
    buffer_load_dwordx4 v10, s[80:83], s4 offen lds
    s_add_u32 m0, s71, 26112
    s_nop 0
    buffer_load_dwordx4 v10, s[84:87], s4 offen lds
    s_add_u32 m0, s71, 18944
    s_add_u32 s4, s4, 32768
    buffer_load_dwordx4 v10, s[80:83], s4 offen lds
    s_add_u32 m0, s71, 27136
    s_nop 0
    buffer_load_dwordx4 v10, s[84:87], s4 offen lds
    s_add_u32 m0, s71, 19968
    s_add_u32 s4, s4, 32768
    buffer_load_dwordx4 v10, s[80:83], s4 offen lds
    s_add_u32 m0, s71, 28160
    s_nop 0
    buffer_load_dwordx4 v10, s[84:87], s4 offen lds
    s_add_u32 m0, s71, 20992
    s_add_u32 s4, s4, 32768
    buffer_load_dwordx4 v10, s[80:83], s4 offen lds
    s_add_u32 m0, s71, 29184
    s_nop 0
    buffer_load_dwordx4 v10, s[84:87], s4 offen lds
    s_add_u32 m0, s71, 22016
    s_add_u32 s4, s4, 32768
    buffer_load_dwordx4 v10, s[80:83], s4 offen lds
    s_add_u32 m0, s71, 30208
    s_nop 0
    buffer_load_dwordx4 v10, s[84:87], s4 offen lds
    s_add_u32 m0, s71, 23040
    s_add_u32 s4, s4, 32768
    buffer_load_dwordx4 v10, s[80:83], s4 offen lds
    s_add_u32 m0, s71, 31232
    s_nop 0
    buffer_load_dwordx4 v10, s[84:87], s4 offen lds
    s_add_u32 m0, s71, 24064
    s_add_u32 s4, s4, 32768
    buffer_load_dwordx4 v10, s[80:83], s4 offen lds
    s_add_u32 m0, s71, 32256
    s_nop 0
    buffer_load_dwordx4 v10, s[84:87], s4 offen lds
    v_alignbit_b32 v84, v17, v16, 16
    v_alignbit_b32 v85, v18, v17, 16
    v_alignbit_b32 v86, v19, v18, 16
    v_alignbit_b32 v87, v20, v19, 16
    v_alignbit_b32 v88, v21, v20, 16
    v_alignbit_b32 v89, v22, v21, 16
    v_alignbit_b32 v90, v23, v22, 16
    v_alignbit_b32 v91, v24, v23, 16
    v_alignbit_b32 v92, v25, v24, 16
    v_alignbit_b32 v93, v26, v25, 16
    v_alignbit_b32 v94, v27, v26, 16
    v_alignbit_b32 v95, v28, v27, 16
    v_alignbit_b32 v96, v29, v28, 16
    v_alignbit_b32 v97, v30, v29, 16
    v_alignbit_b32 v98, v31, v30, 16
    v_alignbit_b32 v99, v32, v31, 16
    v_alignbit_b32 v100, v33, v32, 16
    v_dot2_f32_bf16 v102, v84, v197, 0
    v_dot2_f32_bf16 v103, v17, v197, 0
    v_dot2_f32_bf16 v106, v85, v197, 0
    v_dot2_f32_bf16 v107, v18, v197, 0
    v_dot2_f32_bf16 v110, v86, v197, 0
    v_dot2_f32_bf16 v111, v19, v197, 0
    v_dot2_f32_bf16 v114, v87, v197, 0
    v_dot2_f32_bf16 v115, v20, v197, 0
    v_dot2_f32_bf16 v102, v85, v196, v102
    v_dot2_f32_bf16 v103, v18, v196, v103
    v_dot2_f32_bf16 v106, v86, v196, v106
    v_dot2_f32_bf16 v107, v19, v196, v107
    v_dot2_f32_bf16 v110, v87, v196, v110
    v_dot2_f32_bf16 v111, v20, v196, v111
    v_dot2_f32_bf16 v114, v88, v196, v114
    v_dot2_f32_bf16 v115, v21, v196, v115
    v_lshlrev_b32 v104, 16, v34
    v_and_b32 v105, 0xffff0000, v34
    v_lshlrev_b32 v108, 16, v35
    v_and_b32 v109, 0xffff0000, v35
    v_lshlrev_b32 v112, 16, v36
    v_and_b32 v113, 0xffff0000, v36
    v_lshlrev_b32 v116, 16, v37
    v_and_b32 v117, 0xffff0000, v37
    v_mul_f32 v102, v102, v104
    v_mul_f32 v103, v103, v105
    v_mul_f32 v106, v106, v108
    v_mul_f32 v107, v107, v109
    v_mul_f32 v110, v110, v112
    v_mul_f32 v111, v111, v113
    v_mul_f32 v114, v114, v116
    v_mul_f32 v115, v115, v117
    v_cvt_pk_bf16_f32 v137, v103, v102
    v_cvt_pk_bf16_f32 v136, v107, v106
    v_cvt_pk_bf16_f32 v135, v111, v110
    v_cvt_pk_bf16_f32 v134, v115, v114
    s_add_u32 s4, s72, 64
    buffer_store_dwordx4 v[134:137], v12, s[8:11], s4 offen offset:0
    v_dot2_f32_bf16 v118, v88, v197, 0
    v_dot2_f32_bf16 v119, v21, v197, 0
    v_dot2_f32_bf16 v122, v89, v197, 0
    v_dot2_f32_bf16 v123, v22, v197, 0
    v_dot2_f32_bf16 v126, v90, v197, 0
    v_dot2_f32_bf16 v127, v23, v197, 0
    v_dot2_f32_bf16 v130, v91, v197, 0
    v_dot2_f32_bf16 v131, v24, v197, 0
    v_dot2_f32_bf16 v118, v89, v196, v118
    v_dot2_f32_bf16 v119, v22, v196, v119
    v_dot2_f32_bf16 v122, v90, v196, v122
    v_dot2_f32_bf16 v123, v23, v196, v123
    v_dot2_f32_bf16 v126, v91, v196, v126
    v_dot2_f32_bf16 v127, v24, v196, v127
    v_dot2_f32_bf16 v130, v92, v196, v130
    v_dot2_f32_bf16 v131, v25, v196, v131
    v_lshlrev_b32 v120, 16, v38
    v_and_b32 v121, 0xffff0000, v38
    v_lshlrev_b32 v124, 16, v39
    v_and_b32 v125, 0xffff0000, v39
    v_lshlrev_b32 v128, 16, v40
    v_and_b32 v129, 0xffff0000, v40
    v_lshlrev_b32 v132, 16, v41
    v_and_b32 v133, 0xffff0000, v41
    v_mul_f32 v118, v118, v120
    v_mul_f32 v119, v119, v121
    v_mul_f32 v122, v122, v124
    v_mul_f32 v123, v123, v125
    v_mul_f32 v126, v126, v128
    v_mul_f32 v127, v127, v129
    v_mul_f32 v130, v130, v132
    v_mul_f32 v131, v131, v133
    v_cvt_pk_bf16_f32 v141, v119, v118
    v_cvt_pk_bf16_f32 v140, v123, v122
    v_cvt_pk_bf16_f32 v139, v127, v126
    v_cvt_pk_bf16_f32 v138, v131, v130
    buffer_store_dwordx4 v[138:141], v12, s[8:11], s4 offen offset:1024
    v_dot2_f32_bf16 v102, v92, v197, 0
    v_dot2_f32_bf16 v103, v25, v197, 0
    v_dot2_f32_bf16 v106, v93, v197, 0
    v_dot2_f32_bf16 v107, v26, v197, 0
    v_dot2_f32_bf16 v110, v94, v197, 0
    v_dot2_f32_bf16 v111, v27, v197, 0
    v_dot2_f32_bf16 v114, v95, v197, 0
    v_dot2_f32_bf16 v115, v28, v197, 0
    v_dot2_f32_bf16 v102, v93, v196, v102
    v_dot2_f32_bf16 v103, v26, v196, v103
    v_dot2_f32_bf16 v106, v94, v196, v106
    v_dot2_f32_bf16 v107, v27, v196, v107
    v_dot2_f32_bf16 v110, v95, v196, v110
    v_dot2_f32_bf16 v111, v28, v196, v111
    v_dot2_f32_bf16 v114, v96, v196, v114
    v_dot2_f32_bf16 v115, v29, v196, v115
    v_lshlrev_b32 v104, 16, v42
    v_and_b32 v105, 0xffff0000, v42
    v_lshlrev_b32 v108, 16, v43
    v_and_b32 v109, 0xffff0000, v43
    v_lshlrev_b32 v112, 16, v44
    v_and_b32 v113, 0xffff0000, v44
    v_lshlrev_b32 v116, 16, v45
    v_and_b32 v117, 0xffff0000, v45
    v_mul_f32 v102, v102, v104
    v_mul_f32 v103, v103, v105
    v_mul_f32 v106, v106, v108
    v_mul_f32 v107, v107, v109
    v_mul_f32 v110, v110, v112
    v_mul_f32 v111, v111, v113
    v_mul_f32 v114, v114, v116
    v_mul_f32 v115, v115, v117
    v_cvt_pk_bf16_f32 v145, v103, v102
    v_cvt_pk_bf16_f32 v144, v107, v106
    v_cvt_pk_bf16_f32 v143, v111, v110
    v_cvt_pk_bf16_f32 v142, v115, v114
    buffer_store_dwordx4 v[142:145], v12, s[8:11], s4 offen offset:2048
    v_dot2_f32_bf16 v118, v96, v197, 0
    v_dot2_f32_bf16 v119, v29, v197, 0
    v_dot2_f32_bf16 v122, v97, v197, 0
    v_dot2_f32_bf16 v123, v30, v197, 0
    v_dot2_f32_bf16 v126, v98, v197, 0
    v_dot2_f32_bf16 v127, v31, v197, 0
    v_dot2_f32_bf16 v130, v99, v197, 0
    v_dot2_f32_bf16 v131, v32, v197, 0
    v_dot2_f32_bf16 v118, v97, v196, v118
    v_dot2_f32_bf16 v119, v30, v196, v119
    v_dot2_f32_bf16 v122, v98, v196, v122
    v_dot2_f32_bf16 v123, v31, v196, v123
    v_dot2_f32_bf16 v126, v99, v196, v126
    v_dot2_f32_bf16 v127, v32, v196, v127
    v_dot2_f32_bf16 v130, v100, v196, v130
    v_dot2_f32_bf16 v131, v33, v196, v131
    v_lshlrev_b32 v120, 16, v46
    v_and_b32 v121, 0xffff0000, v46
    v_lshlrev_b32 v124, 16, v47
    v_and_b32 v125, 0xffff0000, v47
    v_lshlrev_b32 v128, 16, v48
    v_and_b32 v129, 0xffff0000, v48
    v_lshlrev_b32 v132, 16, v49
    v_and_b32 v133, 0xffff0000, v49
    v_mul_f32 v118, v118, v120
    v_mul_f32 v119, v119, v121
    v_mul_f32 v122, v122, v124
    v_mul_f32 v123, v123, v125
    v_mul_f32 v126, v126, v128
    v_mul_f32 v127, v127, v129
    v_mul_f32 v130, v130, v132
    v_mul_f32 v131, v131, v133
    v_cvt_pk_bf16_f32 v149, v119, v118
    v_cvt_pk_bf16_f32 v148, v123, v122
    v_cvt_pk_bf16_f32 v147, v127, v126
    v_cvt_pk_bf16_f32 v146, v131, v130
    buffer_store_dwordx4 v[146:149], v12, s[8:11], s4 offen offset:3072
    v_alignbit_b32 v84, v51, v50, 16
    v_alignbit_b32 v85, v52, v51, 16
    v_alignbit_b32 v86, v53, v52, 16
    v_alignbit_b32 v87, v54, v53, 16
    v_alignbit_b32 v88, v55, v54, 16
    v_alignbit_b32 v89, v56, v55, 16
    v_alignbit_b32 v90, v57, v56, 16
    v_alignbit_b32 v91, v58, v57, 16
    v_alignbit_b32 v92, v59, v58, 16
    v_alignbit_b32 v93, v60, v59, 16
    v_alignbit_b32 v94, v61, v60, 16
    v_alignbit_b32 v95, v62, v61, 16
    v_alignbit_b32 v96, v63, v62, 16
    v_alignbit_b32 v97, v64, v63, 16
    v_alignbit_b32 v98, v65, v64, 16
    v_alignbit_b32 v99, v66, v65, 16
    v_alignbit_b32 v100, v67, v66, 16
    v_dot2_f32_bf16 v102, v84, v199, 0
    v_dot2_f32_bf16 v103, v51, v199, 0
    v_dot2_f32_bf16 v106, v85, v199, 0
    v_dot2_f32_bf16 v107, v52, v199, 0
    v_dot2_f32_bf16 v110, v86, v199, 0
    v_dot2_f32_bf16 v111, v53, v199, 0
    v_dot2_f32_bf16 v114, v87, v199, 0
    v_dot2_f32_bf16 v115, v54, v199, 0
    v_dot2_f32_bf16 v102, v85, v198, v102
    v_dot2_f32_bf16 v103, v52, v198, v103
    v_dot2_f32_bf16 v106, v86, v198, v106
    v_dot2_f32_bf16 v107, v53, v198, v107
    v_dot2_f32_bf16 v110, v87, v198, v110
    v_dot2_f32_bf16 v111, v54, v198, v111
    v_dot2_f32_bf16 v114, v88, v198, v114
    v_dot2_f32_bf16 v115, v55, v198, v115
    v_lshlrev_b32 v104, 16, v68
    v_and_b32 v105, 0xffff0000, v68
    v_lshlrev_b32 v108, 16, v69
    v_and_b32 v109, 0xffff0000, v69
    v_lshlrev_b32 v112, 16, v70
    v_and_b32 v113, 0xffff0000, v70
    v_lshlrev_b32 v116, 16, v71
    v_and_b32 v117, 0xffff0000, v71
    v_mul_f32 v102, v102, v104
    v_mul_f32 v103, v103, v105
    v_mul_f32 v106, v106, v108
    v_mul_f32 v107, v107, v109
    v_mul_f32 v110, v110, v112
    v_mul_f32 v111, v111, v113
    v_mul_f32 v114, v114, v116
    v_mul_f32 v115, v115, v117
    v_cvt_pk_bf16_f32 v153, v103, v102
    v_cvt_pk_bf16_f32 v152, v107, v106
    v_cvt_pk_bf16_f32 v151, v111, v110
    v_cvt_pk_bf16_f32 v150, v115, v114
    s_add_u32 s4, s72, 65600
    buffer_store_dwordx4 v[150:153], v12, s[8:11], s4 offen offset:0
    v_dot2_f32_bf16 v118, v88, v199, 0
    v_dot2_f32_bf16 v119, v55, v199, 0
    v_dot2_f32_bf16 v122, v89, v199, 0
    v_dot2_f32_bf16 v123, v56, v199, 0
    v_dot2_f32_bf16 v126, v90, v199, 0
    v_dot2_f32_bf16 v127, v57, v199, 0
    v_dot2_f32_bf16 v130, v91, v199, 0
    v_dot2_f32_bf16 v131, v58, v199, 0
    v_dot2_f32_bf16 v118, v89, v198, v118
    v_dot2_f32_bf16 v119, v56, v198, v119
    v_dot2_f32_bf16 v122, v90, v198, v122
    v_dot2_f32_bf16 v123, v57, v198, v123
    v_dot2_f32_bf16 v126, v91, v198, v126
    v_dot2_f32_bf16 v127, v58, v198, v127
    v_dot2_f32_bf16 v130, v92, v198, v130
    v_dot2_f32_bf16 v131, v59, v198, v131
    v_lshlrev_b32 v120, 16, v72
    v_and_b32 v121, 0xffff0000, v72
    v_lshlrev_b32 v124, 16, v73
    v_and_b32 v125, 0xffff0000, v73
    v_lshlrev_b32 v128, 16, v74
    v_and_b32 v129, 0xffff0000, v74
    v_lshlrev_b32 v132, 16, v75
    v_and_b32 v133, 0xffff0000, v75
    v_mul_f32 v118, v118, v120
    v_mul_f32 v119, v119, v121
    v_mul_f32 v122, v122, v124
    v_mul_f32 v123, v123, v125
    v_mul_f32 v126, v126, v128
    v_mul_f32 v127, v127, v129
    v_mul_f32 v130, v130, v132
    v_mul_f32 v131, v131, v133
    v_cvt_pk_bf16_f32 v157, v119, v118
    v_cvt_pk_bf16_f32 v156, v123, v122
    v_cvt_pk_bf16_f32 v155, v127, v126
    v_cvt_pk_bf16_f32 v154, v131, v130
    buffer_store_dwordx4 v[154:157], v12, s[8:11], s4 offen offset:1024
    v_dot2_f32_bf16 v102, v92, v199, 0
    v_dot2_f32_bf16 v103, v59, v199, 0
    v_dot2_f32_bf16 v106, v93, v199, 0
    v_dot2_f32_bf16 v107, v60, v199, 0
    v_dot2_f32_bf16 v110, v94, v199, 0
    v_dot2_f32_bf16 v111, v61, v199, 0
    v_dot2_f32_bf16 v114, v95, v199, 0
    v_dot2_f32_bf16 v115, v62, v199, 0
    v_dot2_f32_bf16 v102, v93, v198, v102
    v_dot2_f32_bf16 v103, v60, v198, v103
    v_dot2_f32_bf16 v106, v94, v198, v106
    v_dot2_f32_bf16 v107, v61, v198, v107
    v_dot2_f32_bf16 v110, v95, v198, v110
    v_dot2_f32_bf16 v111, v62, v198, v111
    v_dot2_f32_bf16 v114, v96, v198, v114
    v_dot2_f32_bf16 v115, v63, v198, v115
    v_lshlrev_b32 v104, 16, v76
    v_and_b32 v105, 0xffff0000, v76
    v_lshlrev_b32 v108, 16, v77
    v_and_b32 v109, 0xffff0000, v77
    v_lshlrev_b32 v112, 16, v78
    v_and_b32 v113, 0xffff0000, v78
    v_lshlrev_b32 v116, 16, v79
    v_and_b32 v117, 0xffff0000, v79
    v_mul_f32 v102, v102, v104
    v_mul_f32 v103, v103, v105
    v_mul_f32 v106, v106, v108
    v_mul_f32 v107, v107, v109
    v_mul_f32 v110, v110, v112
    v_mul_f32 v111, v111, v113
    v_mul_f32 v114, v114, v116
    v_mul_f32 v115, v115, v117
    v_cvt_pk_bf16_f32 v161, v103, v102
    v_cvt_pk_bf16_f32 v160, v107, v106
    v_cvt_pk_bf16_f32 v159, v111, v110
    v_cvt_pk_bf16_f32 v158, v115, v114
    buffer_store_dwordx4 v[158:161], v12, s[8:11], s4 offen offset:2048
    v_dot2_f32_bf16 v118, v96, v199, 0
    v_dot2_f32_bf16 v119, v63, v199, 0
    v_dot2_f32_bf16 v122, v97, v199, 0
    v_dot2_f32_bf16 v123, v64, v199, 0
    v_dot2_f32_bf16 v126, v98, v199, 0
    v_dot2_f32_bf16 v127, v65, v199, 0
    v_dot2_f32_bf16 v130, v99, v199, 0
    v_dot2_f32_bf16 v131, v66, v199, 0
    v_dot2_f32_bf16 v118, v97, v198, v118
    v_dot2_f32_bf16 v119, v64, v198, v119
    v_dot2_f32_bf16 v122, v98, v198, v122
    v_dot2_f32_bf16 v123, v65, v198, v123
    v_dot2_f32_bf16 v126, v99, v198, v126
    v_dot2_f32_bf16 v127, v66, v198, v127
    v_dot2_f32_bf16 v130, v100, v198, v130
    v_dot2_f32_bf16 v131, v67, v198, v131
    v_lshlrev_b32 v120, 16, v80
    v_and_b32 v121, 0xffff0000, v80
    v_lshlrev_b32 v124, 16, v81
    v_and_b32 v125, 0xffff0000, v81
    v_lshlrev_b32 v128, 16, v82
    v_and_b32 v129, 0xffff0000, v82
    v_lshlrev_b32 v132, 16, v83
    v_and_b32 v133, 0xffff0000, v83
    v_mul_f32 v118, v118, v120
    v_mul_f32 v119, v119, v121
    v_mul_f32 v122, v122, v124
    v_mul_f32 v123, v123, v125
    v_mul_f32 v126, v126, v128
    v_mul_f32 v127, v127, v129
    v_mul_f32 v130, v130, v132
    v_mul_f32 v131, v131, v133
    v_cvt_pk_bf16_f32 v165, v119, v118
    v_cvt_pk_bf16_f32 v164, v123, v122
    v_cvt_pk_bf16_f32 v163, v127, v126
    v_cvt_pk_bf16_f32 v162, v131, v130
    buffer_store_dwordx4 v[162:165], v12, s[8:11], s4 offen offset:3072
    s_waitcnt vmcnt(25)
    ds_read_b64_tr_b16 v[16:17], v11 offset:0
    ds_read_b64_tr_b16 v[18:19], v11 offset:256
    ds_read_b64_tr_b16 v[20:21], v11 offset:512
    ds_read_b64_tr_b16 v[22:23], v11 offset:768
    ds_read_b64_tr_b16 v[24:25], v11 offset:1024
    ds_read_b64_tr_b16 v[26:27], v11 offset:1280
    ds_read_b64_tr_b16 v[28:29], v11 offset:1536
    ds_read_b64_tr_b16 v[30:31], v11 offset:1792
    ds_read_b64_tr_b16 v[32:33], v11 offset:2048
    ds_read_b64_tr_b16 v[34:35], v11 offset:8448
    ds_read_b64_tr_b16 v[36:37], v11 offset:8704
    ds_read_b64_tr_b16 v[38:39], v11 offset:8960
    ds_read_b64_tr_b16 v[40:41], v11 offset:9216
    ds_read_b64_tr_b16 v[42:43], v11 offset:9472
    ds_read_b64_tr_b16 v[44:45], v11 offset:9728
    ds_read_b64_tr_b16 v[46:47], v11 offset:9984
    ds_read_b64_tr_b16 v[48:49], v11 offset:10240
    ds_read_b64_tr_b16 v[50:51], v11 offset:32
    ds_read_b64_tr_b16 v[52:53], v11 offset:288
    ds_read_b64_tr_b16 v[54:55], v11 offset:544
    ds_read_b64_tr_b16 v[56:57], v11 offset:800
    ds_read_b64_tr_b16 v[58:59], v11 offset:1056
    ds_read_b64_tr_b16 v[60:61], v11 offset:1312
    ds_read_b64_tr_b16 v[62:63], v11 offset:1568
    ds_read_b64_tr_b16 v[64:65], v11 offset:1824
    ds_read_b64_tr_b16 v[66:67], v11 offset:2080
    ds_read_b64_tr_b16 v[68:69], v11 offset:8480
    ds_read_b64_tr_b16 v[70:71], v11 offset:8736
    ds_read_b64_tr_b16 v[72:73], v11 offset:8992
    ds_read_b64_tr_b16 v[74:75], v11 offset:9248
    ds_read_b64_tr_b16 v[76:77], v11 offset:9504
    ds_read_b64_tr_b16 v[78:79], v11 offset:9760
    ds_read_b64_tr_b16 v[80:81], v11 offset:10016
    ds_read_b64_tr_b16 v[82:83], v11 offset:10272
    s_waitcnt lgkmcnt(0)
    v_alignbit_b32 v84, v17, v16, 16
    v_alignbit_b32 v85, v18, v17, 16
    v_alignbit_b32 v86, v19, v18, 16
    v_alignbit_b32 v87, v20, v19, 16
    v_alignbit_b32 v88, v21, v20, 16
    v_alignbit_b32 v89, v22, v21, 16
    v_alignbit_b32 v90, v23, v22, 16
    v_alignbit_b32 v91, v24, v23, 16
    v_alignbit_b32 v92, v25, v24, 16
    v_alignbit_b32 v93, v26, v25, 16
    v_alignbit_b32 v94, v27, v26, 16
    v_alignbit_b32 v95, v28, v27, 16
    v_alignbit_b32 v96, v29, v28, 16
    v_alignbit_b32 v97, v30, v29, 16
    v_alignbit_b32 v98, v31, v30, 16
    v_alignbit_b32 v99, v32, v31, 16
    v_alignbit_b32 v100, v33, v32, 16
    v_dot2_f32_bf16 v102, v84, v197, 0
    v_dot2_f32_bf16 v103, v17, v197, 0
    v_dot2_f32_bf16 v106, v85, v197, 0
    v_dot2_f32_bf16 v107, v18, v197, 0
    v_dot2_f32_bf16 v110, v86, v197, 0
    v_dot2_f32_bf16 v111, v19, v197, 0
    v_dot2_f32_bf16 v114, v87, v197, 0
    v_dot2_f32_bf16 v115, v20, v197, 0
    v_dot2_f32_bf16 v102, v85, v196, v102
    v_dot2_f32_bf16 v103, v18, v196, v103
    v_dot2_f32_bf16 v106, v86, v196, v106
    v_dot2_f32_bf16 v107, v19, v196, v107
    v_dot2_f32_bf16 v110, v87, v196, v110
    v_dot2_f32_bf16 v111, v20, v196, v111
    v_dot2_f32_bf16 v114, v88, v196, v114
    v_dot2_f32_bf16 v115, v21, v196, v115
    v_lshlrev_b32 v104, 16, v34
    v_and_b32 v105, 0xffff0000, v34
    v_lshlrev_b32 v108, 16, v35
    v_and_b32 v109, 0xffff0000, v35
    v_lshlrev_b32 v112, 16, v36
    v_and_b32 v113, 0xffff0000, v36
    v_lshlrev_b32 v116, 16, v37
    v_and_b32 v117, 0xffff0000, v37
    v_mul_f32 v102, v102, v104
    v_mul_f32 v103, v103, v105
    v_mul_f32 v106, v106, v108
    v_mul_f32 v107, v107, v109
    v_mul_f32 v110, v110, v112
    v_mul_f32 v111, v111, v113
    v_mul_f32 v114, v114, v116
    v_mul_f32 v115, v115, v117
    v_cvt_pk_bf16_f32 v137, v103, v102
    v_cvt_pk_bf16_f32 v136, v107, v106
    v_cvt_pk_bf16_f32 v135, v111, v110
    v_cvt_pk_bf16_f32 v134, v115, v114
    s_add_u32 s4, s72, 128
    buffer_store_dwordx4 v[134:137], v12, s[8:11], s4 offen offset:0
    v_dot2_f32_bf16 v118, v88, v197, 0
    v_dot2_f32_bf16 v119, v21, v197, 0
    v_dot2_f32_bf16 v122, v89, v197, 0
    v_dot2_f32_bf16 v123, v22, v197, 0
    v_dot2_f32_bf16 v126, v90, v197, 0
    v_dot2_f32_bf16 v127, v23, v197, 0
    v_dot2_f32_bf16 v130, v91, v197, 0
    v_dot2_f32_bf16 v131, v24, v197, 0
    v_dot2_f32_bf16 v118, v89, v196, v118
    v_dot2_f32_bf16 v119, v22, v196, v119
    v_dot2_f32_bf16 v122, v90, v196, v122
    v_dot2_f32_bf16 v123, v23, v196, v123
    v_dot2_f32_bf16 v126, v91, v196, v126
    v_dot2_f32_bf16 v127, v24, v196, v127
    v_dot2_f32_bf16 v130, v92, v196, v130
    v_dot2_f32_bf16 v131, v25, v196, v131
    v_lshlrev_b32 v120, 16, v38
    v_and_b32 v121, 0xffff0000, v38
    v_lshlrev_b32 v124, 16, v39
    v_and_b32 v125, 0xffff0000, v39
    v_lshlrev_b32 v128, 16, v40
    v_and_b32 v129, 0xffff0000, v40
    v_lshlrev_b32 v132, 16, v41
    v_and_b32 v133, 0xffff0000, v41
    v_mul_f32 v118, v118, v120
    v_mul_f32 v119, v119, v121
    v_mul_f32 v122, v122, v124
    v_mul_f32 v123, v123, v125
    v_mul_f32 v126, v126, v128
    v_mul_f32 v127, v127, v129
    v_mul_f32 v130, v130, v132
    v_mul_f32 v131, v131, v133
    v_cvt_pk_bf16_f32 v141, v119, v118
    v_cvt_pk_bf16_f32 v140, v123, v122
    v_cvt_pk_bf16_f32 v139, v127, v126
    v_cvt_pk_bf16_f32 v138, v131, v130
    buffer_store_dwordx4 v[138:141], v12, s[8:11], s4 offen offset:1024
    v_dot2_f32_bf16 v102, v92, v197, 0
    v_dot2_f32_bf16 v103, v25, v197, 0
    v_dot2_f32_bf16 v106, v93, v197, 0
    v_dot2_f32_bf16 v107, v26, v197, 0
    v_dot2_f32_bf16 v110, v94, v197, 0
    v_dot2_f32_bf16 v111, v27, v197, 0
    v_dot2_f32_bf16 v114, v95, v197, 0
    v_dot2_f32_bf16 v115, v28, v197, 0
    v_dot2_f32_bf16 v102, v93, v196, v102
    v_dot2_f32_bf16 v103, v26, v196, v103
    v_dot2_f32_bf16 v106, v94, v196, v106
    v_dot2_f32_bf16 v107, v27, v196, v107
    v_dot2_f32_bf16 v110, v95, v196, v110
    v_dot2_f32_bf16 v111, v28, v196, v111
    v_dot2_f32_bf16 v114, v96, v196, v114
    v_dot2_f32_bf16 v115, v29, v196, v115
    v_lshlrev_b32 v104, 16, v42
    v_and_b32 v105, 0xffff0000, v42
    v_lshlrev_b32 v108, 16, v43
    v_and_b32 v109, 0xffff0000, v43
    v_lshlrev_b32 v112, 16, v44
    v_and_b32 v113, 0xffff0000, v44
    v_lshlrev_b32 v116, 16, v45
    v_and_b32 v117, 0xffff0000, v45
    v_mul_f32 v102, v102, v104
    v_mul_f32 v103, v103, v105
    v_mul_f32 v106, v106, v108
    v_mul_f32 v107, v107, v109
    v_mul_f32 v110, v110, v112
    v_mul_f32 v111, v111, v113
    v_mul_f32 v114, v114, v116
    v_mul_f32 v115, v115, v117
    v_cvt_pk_bf16_f32 v145, v103, v102
    v_cvt_pk_bf16_f32 v144, v107, v106
    v_cvt_pk_bf16_f32 v143, v111, v110
    v_cvt_pk_bf16_f32 v142, v115, v114
    buffer_store_dwordx4 v[142:145], v12, s[8:11], s4 offen offset:2048
    v_dot2_f32_bf16 v118, v96, v197, 0
    v_dot2_f32_bf16 v119, v29, v197, 0
    v_dot2_f32_bf16 v122, v97, v197, 0
    v_dot2_f32_bf16 v123, v30, v197, 0
    v_dot2_f32_bf16 v126, v98, v197, 0
    v_dot2_f32_bf16 v127, v31, v197, 0
    v_dot2_f32_bf16 v130, v99, v197, 0
    v_dot2_f32_bf16 v131, v32, v197, 0
    v_dot2_f32_bf16 v118, v97, v196, v118
    v_dot2_f32_bf16 v119, v30, v196, v119
    v_dot2_f32_bf16 v122, v98, v196, v122
    v_dot2_f32_bf16 v123, v31, v196, v123
    v_dot2_f32_bf16 v126, v99, v196, v126
    v_dot2_f32_bf16 v127, v32, v196, v127
    v_dot2_f32_bf16 v130, v100, v196, v130
    v_dot2_f32_bf16 v131, v33, v196, v131
    v_lshlrev_b32 v120, 16, v46
    v_and_b32 v121, 0xffff0000, v46
    v_lshlrev_b32 v124, 16, v47
    v_and_b32 v125, 0xffff0000, v47
    v_lshlrev_b32 v128, 16, v48
    v_and_b32 v129, 0xffff0000, v48
    v_lshlrev_b32 v132, 16, v49
    v_and_b32 v133, 0xffff0000, v49
    v_mul_f32 v118, v118, v120
    v_mul_f32 v119, v119, v121
    v_mul_f32 v122, v122, v124
    v_mul_f32 v123, v123, v125
    v_mul_f32 v126, v126, v128
    v_mul_f32 v127, v127, v129
    v_mul_f32 v130, v130, v132
    v_mul_f32 v131, v131, v133
    v_cvt_pk_bf16_f32 v149, v119, v118
    v_cvt_pk_bf16_f32 v148, v123, v122
    v_cvt_pk_bf16_f32 v147, v127, v126
    v_cvt_pk_bf16_f32 v146, v131, v130
    buffer_store_dwordx4 v[146:149], v12, s[8:11], s4 offen offset:3072
    v_alignbit_b32 v84, v51, v50, 16
    v_alignbit_b32 v85, v52, v51, 16
    v_alignbit_b32 v86, v53, v52, 16
    v_alignbit_b32 v87, v54, v53, 16
    v_alignbit_b32 v88, v55, v54, 16
    v_alignbit_b32 v89, v56, v55, 16
    v_alignbit_b32 v90, v57, v56, 16
    v_alignbit_b32 v91, v58, v57, 16
    v_alignbit_b32 v92, v59, v58, 16
    v_alignbit_b32 v93, v60, v59, 16
    v_alignbit_b32 v94, v61, v60, 16
    v_alignbit_b32 v95, v62, v61, 16
    v_alignbit_b32 v96, v63, v62, 16
    v_alignbit_b32 v97, v64, v63, 16
    v_alignbit_b32 v98, v65, v64, 16
    v_alignbit_b32 v99, v66, v65, 16
    v_alignbit_b32 v100, v67, v66, 16
    v_dot2_f32_bf16 v102, v84, v199, 0
    v_dot2_f32_bf16 v103, v51, v199, 0
    v_dot2_f32_bf16 v106, v85, v199, 0
    v_dot2_f32_bf16 v107, v52, v199, 0
    v_dot2_f32_bf16 v110, v86, v199, 0
    v_dot2_f32_bf16 v111, v53, v199, 0
    v_dot2_f32_bf16 v114, v87, v199, 0
    v_dot2_f32_bf16 v115, v54, v199, 0
    v_dot2_f32_bf16 v102, v85, v198, v102
    v_dot2_f32_bf16 v103, v52, v198, v103
    v_dot2_f32_bf16 v106, v86, v198, v106
    v_dot2_f32_bf16 v107, v53, v198, v107
    v_dot2_f32_bf16 v110, v87, v198, v110
    v_dot2_f32_bf16 v111, v54, v198, v111
    v_dot2_f32_bf16 v114, v88, v198, v114
    v_dot2_f32_bf16 v115, v55, v198, v115
    v_lshlrev_b32 v104, 16, v68
    v_and_b32 v105, 0xffff0000, v68
    v_lshlrev_b32 v108, 16, v69
    v_and_b32 v109, 0xffff0000, v69
    v_lshlrev_b32 v112, 16, v70
    v_and_b32 v113, 0xffff0000, v70
    v_lshlrev_b32 v116, 16, v71
    v_and_b32 v117, 0xffff0000, v71
    v_mul_f32 v102, v102, v104
    v_mul_f32 v103, v103, v105
    v_mul_f32 v106, v106, v108
    v_mul_f32 v107, v107, v109
    v_mul_f32 v110, v110, v112
    v_mul_f32 v111, v111, v113
    v_mul_f32 v114, v114, v116
    v_mul_f32 v115, v115, v117
    v_cvt_pk_bf16_f32 v153, v103, v102
    v_cvt_pk_bf16_f32 v152, v107, v106
    v_cvt_pk_bf16_f32 v151, v111, v110
    v_cvt_pk_bf16_f32 v150, v115, v114
    s_add_u32 s4, s72, 65664
    buffer_store_dwordx4 v[150:153], v12, s[8:11], s4 offen offset:0
    v_dot2_f32_bf16 v118, v88, v199, 0
    v_dot2_f32_bf16 v119, v55, v199, 0
    v_dot2_f32_bf16 v122, v89, v199, 0
    v_dot2_f32_bf16 v123, v56, v199, 0
    v_dot2_f32_bf16 v126, v90, v199, 0
    v_dot2_f32_bf16 v127, v57, v199, 0
    v_dot2_f32_bf16 v130, v91, v199, 0
    v_dot2_f32_bf16 v131, v58, v199, 0
    v_dot2_f32_bf16 v118, v89, v198, v118
    v_dot2_f32_bf16 v119, v56, v198, v119
    v_dot2_f32_bf16 v122, v90, v198, v122
    v_dot2_f32_bf16 v123, v57, v198, v123
    v_dot2_f32_bf16 v126, v91, v198, v126
    v_dot2_f32_bf16 v127, v58, v198, v127
    v_dot2_f32_bf16 v130, v92, v198, v130
    v_dot2_f32_bf16 v131, v59, v198, v131
    v_lshlrev_b32 v120, 16, v72
    v_and_b32 v121, 0xffff0000, v72
    v_lshlrev_b32 v124, 16, v73
    v_and_b32 v125, 0xffff0000, v73
    v_lshlrev_b32 v128, 16, v74
    v_and_b32 v129, 0xffff0000, v74
    v_lshlrev_b32 v132, 16, v75
    v_and_b32 v133, 0xffff0000, v75
    v_mul_f32 v118, v118, v120
    v_mul_f32 v119, v119, v121
    v_mul_f32 v122, v122, v124
    v_mul_f32 v123, v123, v125
    v_mul_f32 v126, v126, v128
    v_mul_f32 v127, v127, v129
    v_mul_f32 v130, v130, v132
    v_mul_f32 v131, v131, v133
    v_cvt_pk_bf16_f32 v157, v119, v118
    v_cvt_pk_bf16_f32 v156, v123, v122
    v_cvt_pk_bf16_f32 v155, v127, v126
    v_cvt_pk_bf16_f32 v154, v131, v130
    buffer_store_dwordx4 v[154:157], v12, s[8:11], s4 offen offset:1024
    v_dot2_f32_bf16 v102, v92, v199, 0
    v_dot2_f32_bf16 v103, v59, v199, 0
    v_dot2_f32_bf16 v106, v93, v199, 0
    v_dot2_f32_bf16 v107, v60, v199, 0
    v_dot2_f32_bf16 v110, v94, v199, 0
    v_dot2_f32_bf16 v111, v61, v199, 0
    v_dot2_f32_bf16 v114, v95, v199, 0
    v_dot2_f32_bf16 v115, v62, v199, 0
    v_dot2_f32_bf16 v102, v93, v198, v102
    v_dot2_f32_bf16 v103, v60, v198, v103
    v_dot2_f32_bf16 v106, v94, v198, v106
    v_dot2_f32_bf16 v107, v61, v198, v107
    v_dot2_f32_bf16 v110, v95, v198, v110
    v_dot2_f32_bf16 v111, v62, v198, v111
    v_dot2_f32_bf16 v114, v96, v198, v114
    v_dot2_f32_bf16 v115, v63, v198, v115
    v_lshlrev_b32 v104, 16, v76
    v_and_b32 v105, 0xffff0000, v76
    v_lshlrev_b32 v108, 16, v77
    v_and_b32 v109, 0xffff0000, v77
    v_lshlrev_b32 v112, 16, v78
    v_and_b32 v113, 0xffff0000, v78
    v_lshlrev_b32 v116, 16, v79
    v_and_b32 v117, 0xffff0000, v79
    v_mul_f32 v102, v102, v104
    v_mul_f32 v103, v103, v105
    v_mul_f32 v106, v106, v108
    v_mul_f32 v107, v107, v109
    v_mul_f32 v110, v110, v112
    v_mul_f32 v111, v111, v113
    v_mul_f32 v114, v114, v116
    v_mul_f32 v115, v115, v117
    v_cvt_pk_bf16_f32 v161, v103, v102
    v_cvt_pk_bf16_f32 v160, v107, v106
    v_cvt_pk_bf16_f32 v159, v111, v110
    v_cvt_pk_bf16_f32 v158, v115, v114
    buffer_store_dwordx4 v[158:161], v12, s[8:11], s4 offen offset:2048
    v_dot2_f32_bf16 v118, v96, v199, 0
    v_dot2_f32_bf16 v119, v63, v199, 0
    v_dot2_f32_bf16 v122, v97, v199, 0
    v_dot2_f32_bf16 v123, v64, v199, 0
    v_dot2_f32_bf16 v126, v98, v199, 0
    v_dot2_f32_bf16 v127, v65, v199, 0
    v_dot2_f32_bf16 v130, v99, v199, 0
    v_dot2_f32_bf16 v131, v66, v199, 0
    v_dot2_f32_bf16 v118, v97, v198, v118
    v_dot2_f32_bf16 v119, v64, v198, v119
    v_dot2_f32_bf16 v122, v98, v198, v122
    v_dot2_f32_bf16 v123, v65, v198, v123
    v_dot2_f32_bf16 v126, v99, v198, v126
    v_dot2_f32_bf16 v127, v66, v198, v127
    v_dot2_f32_bf16 v130, v100, v198, v130
    v_dot2_f32_bf16 v131, v67, v198, v131
    v_lshlrev_b32 v120, 16, v80
    v_and_b32 v121, 0xffff0000, v80
    v_lshlrev_b32 v124, 16, v81
    v_and_b32 v125, 0xffff0000, v81
    v_lshlrev_b32 v128, 16, v82
    v_and_b32 v129, 0xffff0000, v82
    v_lshlrev_b32 v132, 16, v83
    v_and_b32 v133, 0xffff0000, v83
    v_mul_f32 v118, v118, v120
    v_mul_f32 v119, v119, v121
    v_mul_f32 v122, v122, v124
    v_mul_f32 v123, v123, v125
    v_mul_f32 v126, v126, v128
    v_mul_f32 v127, v127, v129
    v_mul_f32 v130, v130, v132
    v_mul_f32 v131, v131, v133
    v_cvt_pk_bf16_f32 v165, v119, v118
    v_cvt_pk_bf16_f32 v164, v123, v122
    v_cvt_pk_bf16_f32 v163, v127, v126
    v_cvt_pk_bf16_f32 v162, v131, v130
    buffer_store_dwordx4 v[162:165], v12, s[8:11], s4 offen offset:3072
    s_waitcnt vmcnt(8)
    ds_read_b64_tr_b16 v[16:17], v11 offset:16640
    ds_read_b64_tr_b16 v[18:19], v11 offset:16896
    ds_read_b64_tr_b16 v[20:21], v11 offset:17152
    ds_read_b64_tr_b16 v[22:23], v11 offset:17408
    ds_read_b64_tr_b16 v[24:25], v11 offset:17664
    ds_read_b64_tr_b16 v[26:27], v11 offset:17920
    ds_read_b64_tr_b16 v[28:29], v11 offset:18176
    ds_read_b64_tr_b16 v[30:31], v11 offset:18432
    ds_read_b64_tr_b16 v[32:33], v11 offset:18688
    ds_read_b64_tr_b16 v[34:35], v11 offset:25088
    ds_read_b64_tr_b16 v[36:37], v11 offset:25344
    ds_read_b64_tr_b16 v[38:39], v11 offset:25600
    ds_read_b64_tr_b16 v[40:41], v11 offset:25856
    ds_read_b64_tr_b16 v[42:43], v11 offset:26112
    ds_read_b64_tr_b16 v[44:45], v11 offset:26368
    ds_read_b64_tr_b16 v[46:47], v11 offset:26624
    ds_read_b64_tr_b16 v[48:49], v11 offset:26880
    ds_read_b64_tr_b16 v[50:51], v11 offset:16672
    ds_read_b64_tr_b16 v[52:53], v11 offset:16928
    ds_read_b64_tr_b16 v[54:55], v11 offset:17184
    ds_read_b64_tr_b16 v[56:57], v11 offset:17440
    ds_read_b64_tr_b16 v[58:59], v11 offset:17696
    ds_read_b64_tr_b16 v[60:61], v11 offset:17952
    ds_read_b64_tr_b16 v[62:63], v11 offset:18208
    ds_read_b64_tr_b16 v[64:65], v11 offset:18464
    ds_read_b64_tr_b16 v[66:67], v11 offset:18720
    ds_read_b64_tr_b16 v[68:69], v11 offset:25120
    ds_read_b64_tr_b16 v[70:71], v11 offset:25376
    ds_read_b64_tr_b16 v[72:73], v11 offset:25632
    ds_read_b64_tr_b16 v[74:75], v11 offset:25888
    ds_read_b64_tr_b16 v[76:77], v11 offset:26144
    ds_read_b64_tr_b16 v[78:79], v11 offset:26400
    ds_read_b64_tr_b16 v[80:81], v11 offset:26656
    ds_read_b64_tr_b16 v[82:83], v11 offset:26912
    s_waitcnt lgkmcnt(0)
    v_alignbit_b32 v84, v17, v16, 16
    v_alignbit_b32 v85, v18, v17, 16
    v_alignbit_b32 v86, v19, v18, 16
    v_alignbit_b32 v87, v20, v19, 16
    v_alignbit_b32 v88, v21, v20, 16
    v_alignbit_b32 v89, v22, v21, 16
    v_alignbit_b32 v90, v23, v22, 16
    v_alignbit_b32 v91, v24, v23, 16
    v_alignbit_b32 v92, v25, v24, 16
    v_alignbit_b32 v93, v26, v25, 16
    v_alignbit_b32 v94, v27, v26, 16
    v_alignbit_b32 v95, v28, v27, 16
    v_alignbit_b32 v96, v29, v28, 16
    v_alignbit_b32 v97, v30, v29, 16
    v_alignbit_b32 v98, v31, v30, 16
    v_alignbit_b32 v99, v32, v31, 16
    v_alignbit_b32 v100, v33, v32, 16
    v_dot2_f32_bf16 v102, v84, v197, 0
    v_dot2_f32_bf16 v103, v17, v197, 0
    v_dot2_f32_bf16 v106, v85, v197, 0
    v_dot2_f32_bf16 v107, v18, v197, 0
    v_dot2_f32_bf16 v110, v86, v197, 0
    v_dot2_f32_bf16 v111, v19, v197, 0
    v_dot2_f32_bf16 v114, v87, v197, 0
    v_dot2_f32_bf16 v115, v20, v197, 0
    v_dot2_f32_bf16 v102, v85, v196, v102
    v_dot2_f32_bf16 v103, v18, v196, v103
    v_dot2_f32_bf16 v106, v86, v196, v106
    v_dot2_f32_bf16 v107, v19, v196, v107
    v_dot2_f32_bf16 v110, v87, v196, v110
    v_dot2_f32_bf16 v111, v20, v196, v111
    v_dot2_f32_bf16 v114, v88, v196, v114
    v_dot2_f32_bf16 v115, v21, v196, v115
    v_lshlrev_b32 v104, 16, v34
    v_and_b32 v105, 0xffff0000, v34
    v_lshlrev_b32 v108, 16, v35
    v_and_b32 v109, 0xffff0000, v35
    v_lshlrev_b32 v112, 16, v36
    v_and_b32 v113, 0xffff0000, v36
    v_lshlrev_b32 v116, 16, v37
    v_and_b32 v117, 0xffff0000, v37
    v_mul_f32 v102, v102, v104
    v_mul_f32 v103, v103, v105
    v_mul_f32 v106, v106, v108
    v_mul_f32 v107, v107, v109
    v_mul_f32 v110, v110, v112
    v_mul_f32 v111, v111, v113
    v_mul_f32 v114, v114, v116
    v_mul_f32 v115, v115, v117
    v_cvt_pk_bf16_f32 v137, v103, v102
    v_cvt_pk_bf16_f32 v136, v107, v106
    v_cvt_pk_bf16_f32 v135, v111, v110
    v_cvt_pk_bf16_f32 v134, v115, v114
    s_add_u32 s4, s72, 192
    buffer_store_dwordx4 v[134:137], v12, s[8:11], s4 offen offset:0
    v_dot2_f32_bf16 v118, v88, v197, 0
    v_dot2_f32_bf16 v119, v21, v197, 0
    v_dot2_f32_bf16 v122, v89, v197, 0
    v_dot2_f32_bf16 v123, v22, v197, 0
    v_dot2_f32_bf16 v126, v90, v197, 0
    v_dot2_f32_bf16 v127, v23, v197, 0
    v_dot2_f32_bf16 v130, v91, v197, 0
    v_dot2_f32_bf16 v131, v24, v197, 0
    v_dot2_f32_bf16 v118, v89, v196, v118
    v_dot2_f32_bf16 v119, v22, v196, v119
    v_dot2_f32_bf16 v122, v90, v196, v122
    v_dot2_f32_bf16 v123, v23, v196, v123
    v_dot2_f32_bf16 v126, v91, v196, v126
    v_dot2_f32_bf16 v127, v24, v196, v127
    v_dot2_f32_bf16 v130, v92, v196, v130
    v_dot2_f32_bf16 v131, v25, v196, v131
    v_lshlrev_b32 v120, 16, v38
    v_and_b32 v121, 0xffff0000, v38
    v_lshlrev_b32 v124, 16, v39
    v_and_b32 v125, 0xffff0000, v39
    v_lshlrev_b32 v128, 16, v40
    v_and_b32 v129, 0xffff0000, v40
    v_lshlrev_b32 v132, 16, v41
    v_and_b32 v133, 0xffff0000, v41
    v_mul_f32 v118, v118, v120
    v_mul_f32 v119, v119, v121
    v_mul_f32 v122, v122, v124
    v_mul_f32 v123, v123, v125
    v_mul_f32 v126, v126, v128
    v_mul_f32 v127, v127, v129
    v_mul_f32 v130, v130, v132
    v_mul_f32 v131, v131, v133
    v_cvt_pk_bf16_f32 v141, v119, v118
    v_cvt_pk_bf16_f32 v140, v123, v122
    v_cvt_pk_bf16_f32 v139, v127, v126
    v_cvt_pk_bf16_f32 v138, v131, v130
    buffer_store_dwordx4 v[138:141], v12, s[8:11], s4 offen offset:1024
    v_dot2_f32_bf16 v102, v92, v197, 0
    v_dot2_f32_bf16 v103, v25, v197, 0
    v_dot2_f32_bf16 v106, v93, v197, 0
    v_dot2_f32_bf16 v107, v26, v197, 0
    v_dot2_f32_bf16 v110, v94, v197, 0
    v_dot2_f32_bf16 v111, v27, v197, 0
    v_dot2_f32_bf16 v114, v95, v197, 0
    v_dot2_f32_bf16 v115, v28, v197, 0
    v_dot2_f32_bf16 v102, v93, v196, v102
    v_dot2_f32_bf16 v103, v26, v196, v103
    v_dot2_f32_bf16 v106, v94, v196, v106
    v_dot2_f32_bf16 v107, v27, v196, v107
    v_dot2_f32_bf16 v110, v95, v196, v110
    v_dot2_f32_bf16 v111, v28, v196, v111
    v_dot2_f32_bf16 v114, v96, v196, v114
    v_dot2_f32_bf16 v115, v29, v196, v115
    v_lshlrev_b32 v104, 16, v42
    v_and_b32 v105, 0xffff0000, v42
    v_lshlrev_b32 v108, 16, v43
    v_and_b32 v109, 0xffff0000, v43
    v_lshlrev_b32 v112, 16, v44
    v_and_b32 v113, 0xffff0000, v44
    v_lshlrev_b32 v116, 16, v45
    v_and_b32 v117, 0xffff0000, v45
    v_mul_f32 v102, v102, v104
    v_mul_f32 v103, v103, v105
    v_mul_f32 v106, v106, v108
    v_mul_f32 v107, v107, v109
    v_mul_f32 v110, v110, v112
    v_mul_f32 v111, v111, v113
    v_mul_f32 v114, v114, v116
    v_mul_f32 v115, v115, v117
    v_cvt_pk_bf16_f32 v145, v103, v102
    v_cvt_pk_bf16_f32 v144, v107, v106
    v_cvt_pk_bf16_f32 v143, v111, v110
    v_cvt_pk_bf16_f32 v142, v115, v114
    buffer_store_dwordx4 v[142:145], v12, s[8:11], s4 offen offset:2048
    v_dot2_f32_bf16 v118, v96, v197, 0
    v_dot2_f32_bf16 v119, v29, v197, 0
    v_dot2_f32_bf16 v122, v97, v197, 0
    v_dot2_f32_bf16 v123, v30, v197, 0
    v_dot2_f32_bf16 v126, v98, v197, 0
    v_dot2_f32_bf16 v127, v31, v197, 0
    v_dot2_f32_bf16 v130, v99, v197, 0
    v_dot2_f32_bf16 v131, v32, v197, 0
    v_dot2_f32_bf16 v118, v97, v196, v118
    v_dot2_f32_bf16 v119, v30, v196, v119
    v_dot2_f32_bf16 v122, v98, v196, v122
    v_dot2_f32_bf16 v123, v31, v196, v123
    v_dot2_f32_bf16 v126, v99, v196, v126
    v_dot2_f32_bf16 v127, v32, v196, v127
    v_dot2_f32_bf16 v130, v100, v196, v130
    v_dot2_f32_bf16 v131, v33, v196, v131
    v_lshlrev_b32 v120, 16, v46
    v_and_b32 v121, 0xffff0000, v46
    v_lshlrev_b32 v124, 16, v47
    v_and_b32 v125, 0xffff0000, v47
    v_lshlrev_b32 v128, 16, v48
    v_and_b32 v129, 0xffff0000, v48
    v_lshlrev_b32 v132, 16, v49
    v_and_b32 v133, 0xffff0000, v49
    v_mul_f32 v118, v118, v120
    v_mul_f32 v119, v119, v121
    v_mul_f32 v122, v122, v124
    v_mul_f32 v123, v123, v125
    v_mul_f32 v126, v126, v128
    v_mul_f32 v127, v127, v129
    v_mul_f32 v130, v130, v132
    v_mul_f32 v131, v131, v133
    v_cvt_pk_bf16_f32 v149, v119, v118
    v_cvt_pk_bf16_f32 v148, v123, v122
    v_cvt_pk_bf16_f32 v147, v127, v126
    v_cvt_pk_bf16_f32 v146, v131, v130
    buffer_store_dwordx4 v[146:149], v12, s[8:11], s4 offen offset:3072
    v_alignbit_b32 v84, v51, v50, 16
    v_alignbit_b32 v85, v52, v51, 16
    v_alignbit_b32 v86, v53, v52, 16
    v_alignbit_b32 v87, v54, v53, 16
    v_alignbit_b32 v88, v55, v54, 16
    v_alignbit_b32 v89, v56, v55, 16
    v_alignbit_b32 v90, v57, v56, 16
    v_alignbit_b32 v91, v58, v57, 16
    v_alignbit_b32 v92, v59, v58, 16
    v_alignbit_b32 v93, v60, v59, 16
    v_alignbit_b32 v94, v61, v60, 16
    v_alignbit_b32 v95, v62, v61, 16
    v_alignbit_b32 v96, v63, v62, 16
    v_alignbit_b32 v97, v64, v63, 16
    v_alignbit_b32 v98, v65, v64, 16
    v_alignbit_b32 v99, v66, v65, 16
    v_alignbit_b32 v100, v67, v66, 16
    v_dot2_f32_bf16 v102, v84, v199, 0
    v_dot2_f32_bf16 v103, v51, v199, 0
    v_dot2_f32_bf16 v106, v85, v199, 0
    v_dot2_f32_bf16 v107, v52, v199, 0
    v_dot2_f32_bf16 v110, v86, v199, 0
    v_dot2_f32_bf16 v111, v53, v199, 0
    v_dot2_f32_bf16 v114, v87, v199, 0
    v_dot2_f32_bf16 v115, v54, v199, 0
    v_dot2_f32_bf16 v102, v85, v198, v102
    v_dot2_f32_bf16 v103, v52, v198, v103
    v_dot2_f32_bf16 v106, v86, v198, v106
    v_dot2_f32_bf16 v107, v53, v198, v107
    v_dot2_f32_bf16 v110, v87, v198, v110
    v_dot2_f32_bf16 v111, v54, v198, v111
    v_dot2_f32_bf16 v114, v88, v198, v114
    v_dot2_f32_bf16 v115, v55, v198, v115
    v_lshlrev_b32 v104, 16, v68
    v_and_b32 v105, 0xffff0000, v68
    v_lshlrev_b32 v108, 16, v69
    v_and_b32 v109, 0xffff0000, v69
    v_lshlrev_b32 v112, 16, v70
    v_and_b32 v113, 0xffff0000, v70
    v_lshlrev_b32 v116, 16, v71
    v_and_b32 v117, 0xffff0000, v71
    v_mul_f32 v102, v102, v104
    v_mul_f32 v103, v103, v105
    v_mul_f32 v106, v106, v108
    v_mul_f32 v107, v107, v109
    v_mul_f32 v110, v110, v112
    v_mul_f32 v111, v111, v113
    v_mul_f32 v114, v114, v116
    v_mul_f32 v115, v115, v117
    v_cvt_pk_bf16_f32 v153, v103, v102
    v_cvt_pk_bf16_f32 v152, v107, v106
    v_cvt_pk_bf16_f32 v151, v111, v110
    v_cvt_pk_bf16_f32 v150, v115, v114
    s_add_u32 s4, s72, 65728
    buffer_store_dwordx4 v[150:153], v12, s[8:11], s4 offen offset:0
    v_dot2_f32_bf16 v118, v88, v199, 0
    v_dot2_f32_bf16 v119, v55, v199, 0
    v_dot2_f32_bf16 v122, v89, v199, 0
    v_dot2_f32_bf16 v123, v56, v199, 0
    v_dot2_f32_bf16 v126, v90, v199, 0
    v_dot2_f32_bf16 v127, v57, v199, 0
    v_dot2_f32_bf16 v130, v91, v199, 0
    v_dot2_f32_bf16 v131, v58, v199, 0
    v_dot2_f32_bf16 v118, v89, v198, v118
    v_dot2_f32_bf16 v119, v56, v198, v119
    v_dot2_f32_bf16 v122, v90, v198, v122
    v_dot2_f32_bf16 v123, v57, v198, v123
    v_dot2_f32_bf16 v126, v91, v198, v126
    v_dot2_f32_bf16 v127, v58, v198, v127
    v_dot2_f32_bf16 v130, v92, v198, v130
    v_dot2_f32_bf16 v131, v59, v198, v131
    v_lshlrev_b32 v120, 16, v72
    v_and_b32 v121, 0xffff0000, v72
    v_lshlrev_b32 v124, 16, v73
    v_and_b32 v125, 0xffff0000, v73
    v_lshlrev_b32 v128, 16, v74
    v_and_b32 v129, 0xffff0000, v74
    v_lshlrev_b32 v132, 16, v75
    v_and_b32 v133, 0xffff0000, v75
    v_mul_f32 v118, v118, v120
    v_mul_f32 v119, v119, v121
    v_mul_f32 v122, v122, v124
    v_mul_f32 v123, v123, v125
    v_mul_f32 v126, v126, v128
    v_mul_f32 v127, v127, v129
    v_mul_f32 v130, v130, v132
    v_mul_f32 v131, v131, v133
    v_cvt_pk_bf16_f32 v157, v119, v118
    v_cvt_pk_bf16_f32 v156, v123, v122
    v_cvt_pk_bf16_f32 v155, v127, v126
    v_cvt_pk_bf16_f32 v154, v131, v130
    buffer_store_dwordx4 v[154:157], v12, s[8:11], s4 offen offset:1024
    v_dot2_f32_bf16 v102, v92, v199, 0
    v_dot2_f32_bf16 v103, v59, v199, 0
    v_dot2_f32_bf16 v106, v93, v199, 0
    v_dot2_f32_bf16 v107, v60, v199, 0
    v_dot2_f32_bf16 v110, v94, v199, 0
    v_dot2_f32_bf16 v111, v61, v199, 0
    v_dot2_f32_bf16 v114, v95, v199, 0
    v_dot2_f32_bf16 v115, v62, v199, 0
    v_dot2_f32_bf16 v102, v93, v198, v102
    v_dot2_f32_bf16 v103, v60, v198, v103
    v_dot2_f32_bf16 v106, v94, v198, v106
    v_dot2_f32_bf16 v107, v61, v198, v107
    v_dot2_f32_bf16 v110, v95, v198, v110
    v_dot2_f32_bf16 v111, v62, v198, v111
    v_dot2_f32_bf16 v114, v96, v198, v114
    v_dot2_f32_bf16 v115, v63, v198, v115
    v_lshlrev_b32 v104, 16, v76
    v_and_b32 v105, 0xffff0000, v76
    v_lshlrev_b32 v108, 16, v77
    v_and_b32 v109, 0xffff0000, v77
    v_lshlrev_b32 v112, 16, v78
    v_and_b32 v113, 0xffff0000, v78
    v_lshlrev_b32 v116, 16, v79
    v_and_b32 v117, 0xffff0000, v79
    v_mul_f32 v102, v102, v104
    v_mul_f32 v103, v103, v105
    v_mul_f32 v106, v106, v108
    v_mul_f32 v107, v107, v109
    v_mul_f32 v110, v110, v112
    v_mul_f32 v111, v111, v113
    v_mul_f32 v114, v114, v116
    v_mul_f32 v115, v115, v117
    v_cvt_pk_bf16_f32 v161, v103, v102
    v_cvt_pk_bf16_f32 v160, v107, v106
    v_cvt_pk_bf16_f32 v159, v111, v110
    v_cvt_pk_bf16_f32 v158, v115, v114
    buffer_store_dwordx4 v[158:161], v12, s[8:11], s4 offen offset:2048
    v_dot2_f32_bf16 v118, v96, v199, 0
    v_dot2_f32_bf16 v119, v63, v199, 0
    v_dot2_f32_bf16 v122, v97, v199, 0
    v_dot2_f32_bf16 v123, v64, v199, 0
    v_dot2_f32_bf16 v126, v98, v199, 0
    v_dot2_f32_bf16 v127, v65, v199, 0
    v_dot2_f32_bf16 v130, v99, v199, 0
    v_dot2_f32_bf16 v131, v66, v199, 0
    v_dot2_f32_bf16 v118, v97, v198, v118
    v_dot2_f32_bf16 v119, v64, v198, v119
    v_dot2_f32_bf16 v122, v98, v198, v122
    v_dot2_f32_bf16 v123, v65, v198, v123
    v_dot2_f32_bf16 v126, v99, v198, v126
    v_dot2_f32_bf16 v127, v66, v198, v127
    v_dot2_f32_bf16 v130, v100, v198, v130
    v_dot2_f32_bf16 v131, v67, v198, v131
    v_lshlrev_b32 v120, 16, v80
    v_and_b32 v121, 0xffff0000, v80
    v_lshlrev_b32 v124, 16, v81
    v_and_b32 v125, 0xffff0000, v81
    v_lshlrev_b32 v128, 16, v82
    v_and_b32 v129, 0xffff0000, v82
    v_lshlrev_b32 v132, 16, v83
    v_and_b32 v133, 0xffff0000, v83
    v_mul_f32 v118, v118, v120
    v_mul_f32 v119, v119, v121
    v_mul_f32 v122, v122, v124
    v_mul_f32 v123, v123, v125
    v_mul_f32 v126, v126, v128
    v_mul_f32 v127, v127, v129
    v_mul_f32 v130, v130, v132
    v_mul_f32 v131, v131, v133
    v_cvt_pk_bf16_f32 v165, v119, v118
    v_cvt_pk_bf16_f32 v164, v123, v122
    v_cvt_pk_bf16_f32 v163, v127, v126
    v_cvt_pk_bf16_f32 v162, v131, v130
    buffer_store_dwordx4 v[162:165], v12, s[8:11], s4 offen offset:3072
    s_waitcnt vmcnt(0)
    s_barrier
    s_load_dwordx4 s[52:55], s[0:1], 32
    s_lshl_b32 s3, s93, 5
    s_lshl_b32 s4, s24, 3
    s_add_u32 s3, s3, s4
    s_lshl_b32 s4, s3, 1
    s_waitcnt lgkmcnt(0)
    s_load_dwordx4 s[64:67], s[54:55], s4

    s_mov_b32 s28, s52
    s_and_b32 s29, s53, 0xffff
    s_mov_b32 s30, 0x400000
    s_mov_b32 s31, 0x00020000

    v_and_b32 v1, 63, v0
    v_and_b32 v2, 15, v1
    v_lshrrev_b32 v3, 4, v1

    s_lshl_b32 s32, s3, 12
    s_add_u32 s33, s32, 28672
    s_mul_i32 s34, s24, 38400
    s_add_u32 s35, s34, 33536
    s_add_u32 s38, s32, 117440512
    v_lshlrev_b32 v4, 4, v1
    v_add_u32 v5, s34, v4
    v_add_u32 v5, 64, v5
    v_sub_u32 v6, 7, v2
    v_and_b32 v6, 7, v6
    v_mul_u32_u24 v6, 4160, v6
    v_lshrrev_b32 v7, 3, v2
    v_sub_u32 v7, v7, v3
    v_add_u32 v7, 4, v7
    v_lshl_add_u32 v6, v7, 4, v6
    v_add_u32 v6, s34, v6
    v_mul_u32_u24 v7, 80, v3
    v_add_u32 v7, v7, v2
    v_lshlrev_b32 v7, 4, v7
    v_add_u32 v7, s34, v7
    v_add_u32 v7, 33296, v7
    v_lshlrev_b32 v228, 7, v2
    v_lshl_add_u32 v228, v3, 4, v228
    v_subrev_u32 v229, 16, v4
    v_max_i32 v230, 0, v229
    v_sub_u32 v232, 7, v2
    v_and_b32 v232, 7, v232
    v_and_b32 v233, 1, v232
    v_lshlrev_b32 v233, 4, v233
    v_mov_b32 v234, 0xffff
    v_lshlrev_b32 v233, v233, v234
    v_lshrrev_b32 v232, 1, v232
    v_lshrrev_b32 v234, 3, v2
    v_sub_u32 v234, v3, v234
    v_lshl_add_u32 v232, v234, 1, v232
    v_and_b32 v234, 1, v234
    v_lshl_add_u32 v232, v234, 8, v232

    v_cmp_eq_u32 vcc, 0, v232
    s_nop 1
    v_cndmask_b32 v8, 0, v233, vcc
    v_cmp_eq_u32 vcc, 1, v232
    s_nop 1
    v_cndmask_b32 v9, 0, v233, vcc
    v_cmp_eq_u32 vcc, 2, v232
    s_nop 1
    v_cndmask_b32 v10, 0, v233, vcc
    v_cmp_eq_u32 vcc, 3, v232
    s_nop 1
    v_cndmask_b32 v11, 0, v233, vcc
    v_cmp_eq_u32 vcc, 4, v232
    s_nop 1
    v_cndmask_b32 v12, 0, v233, vcc
    v_cmp_eq_u32 vcc, 5, v232
    s_nop 1
    v_cndmask_b32 v13, 0, v233, vcc
    v_cmp_eq_u32 vcc, 6, v232
    s_nop 1
    v_cndmask_b32 v14, 0, v233, vcc
    v_cmp_eq_u32 vcc, 7, v232
    s_nop 1
    v_cndmask_b32 v15, 0, v233, vcc
    v_mov_b32 v208, 0
    v_mov_b32 v209, 0
    v_mov_b32 v210, 0
    v_mov_b32 v211, 0
    v_lshrrev_b32 v232, 2, v1
    v_and_b32 v232, 7, v232
    v_mul_u32_u24 v232, 4160, v232
    v_and_b32 v233, 3, v1
    v_lshl_add_u32 v232, v233, 4, v232
    v_add_u32 v232, s34, v232
    ds_write_b128 v232, v[208:211]
    v_subrev_u32 v233, 16, v7
    ds_write_b128 v233, v[208:211]

    s_add_u32 s39, s32, 125829120
    buffer_load_dwordx4 v[176:179], v230, s[28:31], s32 offen offset:0
    buffer_load_dwordx4 v[180:183], v4, s[28:31], s32 offen offset:0
    buffer_load_dwordx4 v[184:187], v4, s[28:31], s32 offen offset:1008
    buffer_load_dwordx4 v[188:191], v4, s[28:31], s32 offen offset:1024
    buffer_load_dwordx4 v[192:195], v4, s[28:31], s32 offen offset:2032
    buffer_load_dwordx4 v[196:199], v4, s[28:31], s32 offen offset:2048
    buffer_load_dwordx4 v[200:203], v4, s[28:31], s32 offen offset:3056
    buffer_load_dwordx4 v[204:207], v4, s[28:31], s32 offen offset:3072
    s_add_u32 m0, s35, 0
    s_nop 0
    buffer_load_dwordx4 v4, s[8:11], s39 offen offset:0 lds
    s_add_u32 m0, s35, 256
    s_nop 0
    buffer_load_dwordx4 v4, s[8:11], s39 offen offset:1024 lds
    s_add_u32 m0, s35, 512
    s_nop 0
    buffer_load_dwordx4 v4, s[8:11], s39 offen offset:2048 lds
    s_add_u32 m0, s35, 768
    s_nop 0
    buffer_load_dwordx4 v4, s[8:11], s39 offen offset:3072 lds
    s_waitcnt vmcnt(0) lgkmcnt(0)
    s_pack_ll_b32_b16 s40, s64, s64
    s_add_u32 s36, s32, 4096
    s_add_u32 s37, s32, 8192
    s_add_u32 s39, s36, 125829120
    s_mov_b64 exec, 1
    v_mov_b32 v176, 0
    v_mov_b32 v177, 0
    v_mov_b32 v178, 0
    v_mov_b32 v179, 0
    s_mov_b64 exec, -1
    ds_write_b128 v5, v[180:183] offset:0
    ds_write_b128 v5, v[178:181] offset:16640
    v_mov_b32 v208, v177
    v_mov_b32 v209, v178
    v_mov_b32 v210, v179
    v_mov_b32 v211, v180
    ds_write_b128 v5, v[208:211] offset:24960
    v_mov_b32 v212, v181
    v_mov_b32 v213, v182
    ds_write_b128 v5, v[210:213] offset:8320
    v_alignbit_b32 v214, v177, v176, 16
    v_alignbit_b32 v215, v178, v177, 16
    v_alignbit_b32 v216, v179, v178, 16
    v_alignbit_b32 v217, v180, v179, 16
    ds_write_b128 v5, v[214:217] offset:29120
    v_alignbit_b32 v218, v181, v180, 16
    v_alignbit_b32 v219, v182, v181, 16
    ds_write_b128 v5, v[216:219] offset:12480
    v_alignbit_b32 v220, v178, v177, 16
    v_alignbit_b32 v221, v179, v178, 16
    v_alignbit_b32 v222, v180, v179, 16
    v_alignbit_b32 v223, v181, v180, 16
    ds_write_b128 v5, v[220:223] offset:20800
    v_alignbit_b32 v224, v182, v181, 16
    v_alignbit_b32 v225, v183, v182, 16
    ds_write_b128 v5, v[222:225] offset:4160
    buffer_load_dwordx4 v[176:179], v230, s[28:31], s36 offen offset:0
    buffer_load_dwordx4 v[180:183], v4, s[28:31], s36 offen offset:0
    ds_write_b128 v5, v[188:191] offset:1024
    ds_write_b128 v5, v[186:189] offset:17664
    v_mov_b32 v208, v185
    v_mov_b32 v209, v186
    v_mov_b32 v210, v187
    v_mov_b32 v211, v188
    ds_write_b128 v5, v[208:211] offset:25984
    v_mov_b32 v212, v189
    v_mov_b32 v213, v190
    ds_write_b128 v5, v[210:213] offset:9344
    v_alignbit_b32 v214, v185, v184, 16
    v_alignbit_b32 v215, v186, v185, 16
    v_alignbit_b32 v216, v187, v186, 16
    v_alignbit_b32 v217, v188, v187, 16
    ds_write_b128 v5, v[214:217] offset:30144
    v_alignbit_b32 v218, v189, v188, 16
    v_alignbit_b32 v219, v190, v189, 16
    ds_write_b128 v5, v[216:219] offset:13504
    v_alignbit_b32 v220, v186, v185, 16
    v_alignbit_b32 v221, v187, v186, 16
    v_alignbit_b32 v222, v188, v187, 16
    v_alignbit_b32 v223, v189, v188, 16
    ds_write_b128 v5, v[220:223] offset:21824
    v_alignbit_b32 v224, v190, v189, 16
    v_alignbit_b32 v225, v191, v190, 16
    ds_write_b128 v5, v[222:225] offset:5184
    buffer_load_dwordx4 v[184:187], v4, s[28:31], s36 offen offset:1008
    buffer_load_dwordx4 v[188:191], v4, s[28:31], s36 offen offset:1024
    v_and_b32 v236, s40, v8
    v_and_b32 v237, s40, v9
    v_and_b32 v238, s40, v10
    v_and_b32 v239, s40, v11
    v_and_b32 v240, s40, v12
    v_and_b32 v241, s40, v13
    v_and_b32 v242, s40, v14
    v_and_b32 v243, s40, v15
    ds_read_b128 a[60:63], v7 offset:240
    ds_read_b128 a[124:127], v7 offset:496
    ds_read_b128 a[188:191], v7 offset:752
    ds_read_b128 a[252:255], v7 offset:1008
    ds_read_b128 v[168:171], v6 offset:0
    ds_read_b128 v[172:175], v6 offset:32
    s_waitcnt vmcnt(0) lgkmcnt(0)
    s_mov_b32 s42, 0
.cvl_433:
    s_waitcnt lgkmcnt(5)
    v_mfma_f32_16x16x32_bf16 v[16:19], v[236:239], a[60:63], 0
    v_mfma_f32_16x16x32_bf16 v[32:35], v[240:243], a[60:63], 0
    s_waitcnt lgkmcnt(4)
    v_mfma_f32_16x16x32_bf16 v[20:23], v[236:239], a[124:127], 0
    v_mfma_f32_16x16x32_bf16 v[36:39], v[240:243], a[124:127], 0
    s_waitcnt lgkmcnt(3)
    v_mfma_f32_16x16x32_bf16 v[24:27], v[236:239], a[188:191], 0
    v_mfma_f32_16x16x32_bf16 v[40:43], v[240:243], a[188:191], 0
    ds_read_b128 a[56:59], v7 offset:224
    s_waitcnt lgkmcnt(3)
    v_mfma_f32_16x16x32_bf16 v[28:31], v[236:239], a[252:255], 0
    ds_read_b128 v[112:115], v6 offset:64
    v_mfma_f32_16x16x32_bf16 v[44:47], v[240:243], a[252:255], 0
    ds_read_b128 v[116:119], v6 offset:96
    s_waitcnt lgkmcnt(4)
    v_mfma_f32_16x16x32_bf16 v[16:19], v[168:171], a[60:63], v[16:19]
    ds_read_b128 a[120:123], v7 offset:480
    s_waitcnt lgkmcnt(4)
    v_mfma_f32_16x16x32_bf16 v[32:35], v[172:175], a[60:63], v[32:35]
    s_waitcnt vmcnt(18)
    v_mfma_f32_16x16x32_bf16 v[20:23], v[168:171], a[124:127], v[20:23]
    ds_read_b128 a[184:187], v7 offset:736
    v_mfma_f32_16x16x32_bf16 v[36:39], v[172:175], a[124:127], v[36:39]
    ds_write_b128 v5, v[196:199] offset:2048
    v_mfma_f32_16x16x32_bf16 v[24:27], v[168:171], a[188:191], v[24:27]
    ds_read_b128 a[248:251], v7 offset:992
    v_mfma_f32_16x16x32_bf16 v[40:43], v[172:175], a[188:191], v[40:43]
    ds_read_b128 a[52:55], v7 offset:208
    v_mfma_f32_16x16x32_bf16 v[28:31], v[168:171], a[252:255], v[28:31]
    ds_read_b128 v[120:123], v6 offset:128
    v_mfma_f32_16x16x32_bf16 v[44:47], v[172:175], a[252:255], v[44:47]
    ds_read_b128 v[124:127], v6 offset:160
    s_waitcnt lgkmcnt(8)
    v_mfma_f32_16x16x32_bf16 v[16:19], v[112:115], a[56:59], v[16:19]
    ds_read_b128 a[116:119], v7 offset:464
    s_waitcnt lgkmcnt(8)
    v_mfma_f32_16x16x32_bf16 v[32:35], v[116:119], a[56:59], v[32:35]
    ds_write_b128 v5, v[194:197] offset:18688
    s_waitcnt lgkmcnt(8)
    v_mfma_f32_16x16x32_bf16 v[20:23], v[112:115], a[120:123], v[20:23]
    ds_read_b128 a[180:183], v7 offset:720
    v_mfma_f32_16x16x32_bf16 v[36:39], v[116:119], a[120:123], v[36:39]
    v_mov_b32 v208, v193
    v_mov_b32 v209, v194
    s_waitcnt lgkmcnt(8)
    v_mfma_f32_16x16x32_bf16 v[24:27], v[112:115], a[184:187], v[24:27]
    ds_read_b128 a[244:247], v7 offset:976
    v_mfma_f32_16x16x32_bf16 v[40:43], v[116:119], a[184:187], v[40:43]
    ds_read_b128 a[48:51], v7 offset:192
    s_waitcnt lgkmcnt(8)
    v_mfma_f32_16x16x32_bf16 v[28:31], v[112:115], a[248:251], v[28:31]
    ds_read_b128 v[128:131], v6 offset:192
    v_mfma_f32_16x16x32_bf16 v[44:47], v[116:119], a[248:251], v[44:47]
    ds_read_b128 v[132:135], v6 offset:224
    s_waitcnt lgkmcnt(8)
    v_mfma_f32_16x16x32_bf16 v[16:19], v[120:123], a[52:55], v[16:19]
    ds_read_b128 a[112:115], v7 offset:448
    s_waitcnt lgkmcnt(8)
    v_mfma_f32_16x16x32_bf16 v[32:35], v[124:127], a[52:55], v[32:35]
    v_mov_b32 v210, v195
    v_mov_b32 v211, v196
    s_waitcnt lgkmcnt(7)
    v_mfma_f32_16x16x32_bf16 v[20:23], v[120:123], a[116:119], v[20:23]
    ds_read_b128 a[176:179], v7 offset:704
    v_mfma_f32_16x16x32_bf16 v[36:39], v[124:127], a[116:119], v[36:39]
    ds_write_b128 v5, v[208:211] offset:27008
    s_waitcnt lgkmcnt(7)
    v_mfma_f32_16x16x32_bf16 v[24:27], v[120:123], a[180:183], v[24:27]
    ds_read_b128 a[240:243], v7 offset:960
    v_mfma_f32_16x16x32_bf16 v[40:43], v[124:127], a[180:183], v[40:43]
    ds_read_b128 a[44:47], v7 offset:176
    s_waitcnt lgkmcnt(8)
    v_mfma_f32_16x16x32_bf16 v[28:31], v[120:123], a[244:247], v[28:31]
    ds_read_b128 v[136:139], v6 offset:256
    v_mfma_f32_16x16x32_bf16 v[44:47], v[124:127], a[244:247], v[44:47]
    ds_read_b128 v[140:143], v6 offset:288
    s_waitcnt lgkmcnt(8)
    v_mfma_f32_16x16x32_bf16 v[16:19], v[128:131], a[48:51], v[16:19]
    ds_read_b128 a[108:111], v7 offset:432
    s_waitcnt lgkmcnt(8)
    v_mfma_f32_16x16x32_bf16 v[32:35], v[132:135], a[48:51], v[32:35]
    v_mov_b32 v212, v197
    v_mov_b32 v213, v198
    s_waitcnt lgkmcnt(7)
    v_mfma_f32_16x16x32_bf16 v[20:23], v[128:131], a[112:115], v[20:23]
    ds_read_b128 a[172:175], v7 offset:688
    v_mfma_f32_16x16x32_bf16 v[36:39], v[132:135], a[112:115], v[36:39]
    ds_write_b128 v5, v[210:213] offset:10368
    s_waitcnt lgkmcnt(8)
    v_mfma_f32_16x16x32_bf16 v[24:27], v[128:131], a[176:179], v[24:27]
    ds_read_b128 a[236:239], v7 offset:944
    v_mfma_f32_16x16x32_bf16 v[40:43], v[132:135], a[176:179], v[40:43]
    ds_read_b128 a[40:43], v7 offset:160
    s_waitcnt lgkmcnt(8)
    v_mfma_f32_16x16x32_bf16 v[28:31], v[128:131], a[240:243], v[28:31]
    ds_read_b128 v[144:147], v6 offset:320
    v_mfma_f32_16x16x32_bf16 v[44:47], v[132:135], a[240:243], v[44:47]
    ds_read_b128 v[148:151], v6 offset:352
    s_waitcnt lgkmcnt(8)
    v_mfma_f32_16x16x32_bf16 v[16:19], v[136:139], a[44:47], v[16:19]
    ds_read_b128 a[104:107], v7 offset:416
    s_waitcnt lgkmcnt(8)
    v_mfma_f32_16x16x32_bf16 v[32:35], v[140:143], a[44:47], v[32:35]
    v_alignbit_b32 v214, v193, v192, 16
    v_alignbit_b32 v215, v194, v193, 16
    s_waitcnt lgkmcnt(7)
    v_mfma_f32_16x16x32_bf16 v[20:23], v[136:139], a[108:111], v[20:23]
    ds_read_b128 a[168:171], v7 offset:672
    v_mfma_f32_16x16x32_bf16 v[36:39], v[140:143], a[108:111], v[36:39]
    v_alignbit_b32 v216, v195, v194, 16
    v_alignbit_b32 v217, v196, v195, 16
    s_waitcnt lgkmcnt(7)
    v_mfma_f32_16x16x32_bf16 v[24:27], v[136:139], a[172:175], v[24:27]
    ds_read_b128 a[232:235], v7 offset:928
    v_mfma_f32_16x16x32_bf16 v[40:43], v[140:143], a[172:175], v[40:43]
    ds_read_b128 a[36:39], v7 offset:144
    s_waitcnt lgkmcnt(7)
    v_mfma_f32_16x16x32_bf16 v[28:31], v[136:139], a[236:239], v[28:31]
    ds_read_b128 v[152:155], v6 offset:384
    v_mfma_f32_16x16x32_bf16 v[44:47], v[140:143], a[236:239], v[44:47]
    ds_read_b128 v[156:159], v6 offset:416
    s_waitcnt lgkmcnt(7)
    v_mfma_f32_16x16x32_bf16 v[16:19], v[144:147], a[40:43], v[16:19]
    ds_read_b128 a[100:103], v7 offset:400
    s_waitcnt lgkmcnt(7)
    v_mfma_f32_16x16x32_bf16 v[32:35], v[148:151], a[40:43], v[32:35]
    ds_write_b128 v5, v[214:217] offset:31168
    s_waitcnt lgkmcnt(7)
    v_mfma_f32_16x16x32_bf16 v[20:23], v[144:147], a[104:107], v[20:23]
    ds_read_b128 a[164:167], v7 offset:656
    v_mfma_f32_16x16x32_bf16 v[36:39], v[148:151], a[104:107], v[36:39]
    v_alignbit_b32 v218, v197, v196, 16
    v_alignbit_b32 v219, v198, v197, 16
    s_waitcnt lgkmcnt(7)
    v_mfma_f32_16x16x32_bf16 v[24:27], v[144:147], a[168:171], v[24:27]
    ds_read_b128 a[228:231], v7 offset:912
    v_mfma_f32_16x16x32_bf16 v[40:43], v[148:151], a[168:171], v[40:43]
    ds_read_b128 a[32:35], v7 offset:128
    s_waitcnt lgkmcnt(8)
    v_mfma_f32_16x16x32_bf16 v[28:31], v[144:147], a[232:235], v[28:31]
    ds_read_b128 v[160:163], v6 offset:448
    v_mfma_f32_16x16x32_bf16 v[44:47], v[148:151], a[232:235], v[44:47]
    ds_read_b128 v[164:167], v6 offset:480
    s_waitcnt lgkmcnt(8)
    v_mfma_f32_16x16x32_bf16 v[16:19], v[152:155], a[36:39], v[16:19]
    ds_read_b128 a[96:99], v7 offset:384
    s_waitcnt lgkmcnt(8)
    v_mfma_f32_16x16x32_bf16 v[32:35], v[156:159], a[36:39], v[32:35]
    ds_write_b128 v5, v[216:219] offset:14528
    s_waitcnt lgkmcnt(8)
    v_mfma_f32_16x16x32_bf16 v[20:23], v[152:155], a[100:103], v[20:23]
    ds_read_b128 a[160:163], v7 offset:640
    v_mfma_f32_16x16x32_bf16 v[36:39], v[156:159], a[100:103], v[36:39]
    v_alignbit_b32 v220, v194, v193, 16
    v_alignbit_b32 v221, v195, v194, 16
    s_waitcnt lgkmcnt(7)
    v_mfma_f32_16x16x32_bf16 v[24:27], v[152:155], a[164:167], v[24:27]
    ds_read_b128 a[224:227], v7 offset:896
    v_mfma_f32_16x16x32_bf16 v[40:43], v[156:159], a[164:167], v[40:43]
    ds_read_b128 a[28:31], v7 offset:112
    s_waitcnt lgkmcnt(8)
    v_mfma_f32_16x16x32_bf16 v[28:31], v[152:155], a[228:231], v[28:31]
    ds_read_b128 v[168:171], v6 offset:512
    v_mfma_f32_16x16x32_bf16 v[44:47], v[156:159], a[228:231], v[44:47]
    ds_read_b128 v[172:175], v6 offset:544
    s_waitcnt lgkmcnt(8)
    v_mfma_f32_16x16x32_bf16 v[16:19], v[160:163], a[32:35], v[16:19]
    ds_read_b128 a[92:95], v7 offset:368
    s_waitcnt lgkmcnt(8)
    v_mfma_f32_16x16x32_bf16 v[32:35], v[164:167], a[32:35], v[32:35]
    v_alignbit_b32 v222, v196, v195, 16
    v_alignbit_b32 v223, v197, v196, 16
    s_waitcnt lgkmcnt(7)
    v_mfma_f32_16x16x32_bf16 v[20:23], v[160:163], a[96:99], v[20:23]
    ds_read_b128 a[156:159], v7 offset:624
    v_mfma_f32_16x16x32_bf16 v[36:39], v[164:167], a[96:99], v[36:39]
    ds_write_b128 v5, v[220:223] offset:22848
    s_waitcnt lgkmcnt(7)
    v_mfma_f32_16x16x32_bf16 v[24:27], v[160:163], a[160:163], v[24:27]
    ds_read_b128 a[220:223], v7 offset:880
    v_mfma_f32_16x16x32_bf16 v[40:43], v[164:167], a[160:163], v[40:43]
    ds_read_b128 a[24:27], v7 offset:96
    s_waitcnt lgkmcnt(8)
    v_mfma_f32_16x16x32_bf16 v[28:31], v[160:163], a[224:227], v[28:31]
    ds_read_b128 v[112:115], v6 offset:576
    v_mfma_f32_16x16x32_bf16 v[44:47], v[164:167], a[224:227], v[44:47]
    ds_read_b128 v[116:119], v6 offset:608
    s_waitcnt lgkmcnt(8)
    v_mfma_f32_16x16x32_bf16 v[16:19], v[168:171], a[28:31], v[16:19]
    ds_read_b128 a[88:91], v7 offset:352
    s_waitcnt lgkmcnt(8)
    v_mfma_f32_16x16x32_bf16 v[32:35], v[172:175], a[28:31], v[32:35]
    v_alignbit_b32 v224, v198, v197, 16
    v_alignbit_b32 v225, v199, v198, 16
    s_waitcnt lgkmcnt(7)
    v_mfma_f32_16x16x32_bf16 v[20:23], v[168:171], a[92:95], v[20:23]
    ds_read_b128 a[152:155], v7 offset:608
    v_mfma_f32_16x16x32_bf16 v[36:39], v[172:175], a[92:95], v[36:39]
    ds_write_b128 v5, v[222:225] offset:6208
    s_waitcnt lgkmcnt(8)
    v_mfma_f32_16x16x32_bf16 v[24:27], v[168:171], a[156:159], v[24:27]
    ds_read_b128 a[216:219], v7 offset:864
    v_mfma_f32_16x16x32_bf16 v[40:43], v[172:175], a[156:159], v[40:43]
    ds_read_b128 a[20:23], v7 offset:80
    s_waitcnt lgkmcnt(8)
    v_mfma_f32_16x16x32_bf16 v[28:31], v[168:171], a[220:223], v[28:31]
    ds_read_b128 v[120:123], v6 offset:640
    v_mfma_f32_16x16x32_bf16 v[44:47], v[172:175], a[220:223], v[44:47]
    ds_read_b128 v[124:127], v6 offset:672
    s_waitcnt lgkmcnt(8)
    v_mfma_f32_16x16x32_bf16 v[16:19], v[112:115], a[24:27], v[16:19]
    ds_read_b128 a[84:87], v7 offset:336
    s_waitcnt lgkmcnt(8)
    v_mfma_f32_16x16x32_bf16 v[32:35], v[116:119], a[24:27], v[32:35]
    buffer_load_dwordx4 v[192:195], v4, s[28:31], s36 offen offset:2032
    s_waitcnt lgkmcnt(7)
    v_mfma_f32_16x16x32_bf16 v[20:23], v[112:115], a[88:91], v[20:23]
    ds_read_b128 a[148:151], v7 offset:592
    v_mfma_f32_16x16x32_bf16 v[36:39], v[116:119], a[88:91], v[36:39]
    buffer_load_dwordx4 v[196:199], v4, s[28:31], s36 offen offset:2048
    s_waitcnt lgkmcnt(7)
    v_mfma_f32_16x16x32_bf16 v[24:27], v[112:115], a[152:155], v[24:27]
    ds_read_b128 a[212:215], v7 offset:848
    v_mfma_f32_16x16x32_bf16 v[40:43], v[116:119], a[152:155], v[40:43]
    ds_read_b128 a[16:19], v7 offset:64
    s_waitcnt lgkmcnt(7)
    v_mfma_f32_16x16x32_bf16 v[28:31], v[112:115], a[216:219], v[28:31]
    ds_read_b128 v[128:131], v6 offset:704
    v_mfma_f32_16x16x32_bf16 v[44:47], v[116:119], a[216:219], v[44:47]
    ds_read_b128 v[132:135], v6 offset:736
    s_waitcnt lgkmcnt(7)
    v_mfma_f32_16x16x32_bf16 v[16:19], v[120:123], a[20:23], v[16:19]
    ds_read_b128 a[80:83], v7 offset:320
    s_waitcnt lgkmcnt(7)
    v_mfma_f32_16x16x32_bf16 v[32:35], v[124:127], a[20:23], v[32:35]
    s_waitcnt vmcnt(18)
    s_waitcnt lgkmcnt(6)
    v_mfma_f32_16x16x32_bf16 v[20:23], v[120:123], a[84:87], v[20:23]
    ds_read_b128 a[144:147], v7 offset:576
    v_mfma_f32_16x16x32_bf16 v[36:39], v[124:127], a[84:87], v[36:39]
    ds_write_b128 v5, v[204:207] offset:3072
    s_waitcnt lgkmcnt(7)
    v_mfma_f32_16x16x32_bf16 v[24:27], v[120:123], a[148:151], v[24:27]
    ds_read_b128 a[208:211], v7 offset:832
    v_mfma_f32_16x16x32_bf16 v[40:43], v[124:127], a[148:151], v[40:43]
    ds_read_b128 a[12:15], v7 offset:48
    s_waitcnt lgkmcnt(8)
    v_mfma_f32_16x16x32_bf16 v[28:31], v[120:123], a[212:215], v[28:31]
    ds_read_b128 v[136:139], v6 offset:768
    v_mfma_f32_16x16x32_bf16 v[44:47], v[124:127], a[212:215], v[44:47]
    ds_read_b128 v[140:143], v6 offset:800
    s_waitcnt lgkmcnt(8)
    v_mfma_f32_16x16x32_bf16 v[16:19], v[128:131], a[16:19], v[16:19]
    ds_read_b128 a[76:79], v7 offset:304
    s_waitcnt lgkmcnt(8)
    v_mfma_f32_16x16x32_bf16 v[32:35], v[132:135], a[16:19], v[32:35]
    ds_write_b128 v5, v[202:205] offset:19712
    s_waitcnt lgkmcnt(8)
    v_mfma_f32_16x16x32_bf16 v[20:23], v[128:131], a[80:83], v[20:23]
    ds_read_b128 a[140:143], v7 offset:560
    v_mfma_f32_16x16x32_bf16 v[36:39], v[132:135], a[80:83], v[36:39]
    v_mov_b32 v208, v201
    v_mov_b32 v209, v202
    s_waitcnt lgkmcnt(8)
    v_mfma_f32_16x16x32_bf16 v[24:27], v[128:131], a[144:147], v[24:27]
    ds_read_b128 a[204:207], v7 offset:816
    v_mfma_f32_16x16x32_bf16 v[40:43], v[132:135], a[144:147], v[40:43]
    ds_read_b128 a[8:11], v7 offset:32
    s_waitcnt lgkmcnt(8)
    v_mfma_f32_16x16x32_bf16 v[28:31], v[128:131], a[208:211], v[28:31]
    ds_read_b128 v[144:147], v6 offset:832
    v_mfma_f32_16x16x32_bf16 v[44:47], v[132:135], a[208:211], v[44:47]
    ds_read_b128 v[148:151], v6 offset:864
    s_waitcnt lgkmcnt(8)
    v_mfma_f32_16x16x32_bf16 v[16:19], v[136:139], a[12:15], v[16:19]
    ds_read_b128 a[72:75], v7 offset:288
    s_waitcnt lgkmcnt(8)
    v_mfma_f32_16x16x32_bf16 v[32:35], v[140:143], a[12:15], v[32:35]
    v_mov_b32 v210, v203
    v_mov_b32 v211, v204
    s_waitcnt lgkmcnt(7)
    v_mfma_f32_16x16x32_bf16 v[20:23], v[136:139], a[76:79], v[20:23]
    ds_read_b128 a[136:139], v7 offset:544
    v_mfma_f32_16x16x32_bf16 v[36:39], v[140:143], a[76:79], v[36:39]
    ds_write_b128 v5, v[208:211] offset:28032
    s_waitcnt lgkmcnt(7)
    v_mfma_f32_16x16x32_bf16 v[24:27], v[136:139], a[140:143], v[24:27]
    ds_read_b128 a[200:203], v7 offset:800
    v_mfma_f32_16x16x32_bf16 v[40:43], v[140:143], a[140:143], v[40:43]
    ds_read_b128 a[4:7], v7 offset:16
    s_waitcnt lgkmcnt(8)
    v_mfma_f32_16x16x32_bf16 v[28:31], v[136:139], a[204:207], v[28:31]
    ds_read_b128 v[152:155], v6 offset:896
    v_mfma_f32_16x16x32_bf16 v[44:47], v[140:143], a[204:207], v[44:47]
    ds_read_b128 v[156:159], v6 offset:928
    s_waitcnt lgkmcnt(8)
    v_mfma_f32_16x16x32_bf16 v[16:19], v[144:147], a[8:11], v[16:19]
    ds_read_b128 a[68:71], v7 offset:272
    s_waitcnt lgkmcnt(8)
    v_mfma_f32_16x16x32_bf16 v[32:35], v[148:151], a[8:11], v[32:35]
    v_mov_b32 v212, v205
    v_mov_b32 v213, v206
    s_waitcnt lgkmcnt(7)
    v_mfma_f32_16x16x32_bf16 v[20:23], v[144:147], a[72:75], v[20:23]
    ds_read_b128 a[132:135], v7 offset:528
    v_mfma_f32_16x16x32_bf16 v[36:39], v[148:151], a[72:75], v[36:39]
    ds_write_b128 v5, v[210:213] offset:11392
    s_waitcnt lgkmcnt(8)
    v_mfma_f32_16x16x32_bf16 v[24:27], v[144:147], a[136:139], v[24:27]
    ds_read_b128 a[196:199], v7 offset:784
    v_mfma_f32_16x16x32_bf16 v[40:43], v[148:151], a[136:139], v[40:43]
    ds_read_b128 a[0:3], v7 offset:0
    s_waitcnt lgkmcnt(8)
    v_mfma_f32_16x16x32_bf16 v[28:31], v[144:147], a[200:203], v[28:31]
    ds_read_b128 v[160:163], v6 offset:960
    v_mfma_f32_16x16x32_bf16 v[44:47], v[148:151], a[200:203], v[44:47]
    ds_read_b128 v[164:167], v6 offset:992
    s_waitcnt lgkmcnt(8)
    v_mfma_f32_16x16x32_bf16 v[16:19], v[152:155], a[4:7], v[16:19]
    ds_read_b128 a[64:67], v7 offset:256
    s_waitcnt lgkmcnt(8)
    v_mfma_f32_16x16x32_bf16 v[32:35], v[156:159], a[4:7], v[32:35]
    v_alignbit_b32 v214, v201, v200, 16
    v_alignbit_b32 v215, v202, v201, 16
    s_waitcnt lgkmcnt(7)
    v_mfma_f32_16x16x32_bf16 v[20:23], v[152:155], a[68:71], v[20:23]
    ds_read_b128 a[128:131], v7 offset:512
    v_mfma_f32_16x16x32_bf16 v[36:39], v[156:159], a[68:71], v[36:39]
    v_alignbit_b32 v216, v203, v202, 16
    v_alignbit_b32 v217, v204, v203, 16
    s_waitcnt lgkmcnt(7)
    v_mfma_f32_16x16x32_bf16 v[24:27], v[152:155], a[132:135], v[24:27]
    ds_read_b128 a[192:195], v7 offset:768
    v_mfma_f32_16x16x32_bf16 v[40:43], v[156:159], a[132:135], v[40:43]
    ds_write_b128 v5, v[214:217] offset:32192
    s_waitcnt lgkmcnt(7)
    v_mfma_f32_16x16x32_bf16 v[28:31], v[152:155], a[196:199], v[28:31]
    ds_read_b128 v[168:171], v6 offset:1024
    v_mfma_f32_16x16x32_bf16 v[44:47], v[156:159], a[196:199], v[44:47]
    ds_read_b128 v[172:175], v6 offset:1056
    s_waitcnt lgkmcnt(7)
    v_mfma_f32_16x16x32_bf16 v[16:19], v[160:163], a[0:3], v[16:19]
    v_alignbit_b32 v218, v205, v204, 16
    v_alignbit_b32 v219, v206, v205, 16
    s_waitcnt lgkmcnt(6)
    v_mfma_f32_16x16x32_bf16 v[32:35], v[164:167], a[0:3], v[32:35]
    ds_write_b128 v5, v[216:219] offset:15552
    s_waitcnt lgkmcnt(6)
    v_mfma_f32_16x16x32_bf16 v[20:23], v[160:163], a[64:67], v[20:23]
    v_alignbit_b32 v220, v202, v201, 16
    v_alignbit_b32 v221, v203, v202, 16
    v_mfma_f32_16x16x32_bf16 v[36:39], v[164:167], a[64:67], v[36:39]
    v_alignbit_b32 v222, v204, v203, 16
    v_alignbit_b32 v223, v205, v204, 16
    s_waitcnt lgkmcnt(5)
    v_mfma_f32_16x16x32_bf16 v[24:27], v[160:163], a[128:131], v[24:27]
    ds_read_b128 v[112:115], v6 offset:1088
    v_mfma_f32_16x16x32_bf16 v[40:43], v[164:167], a[128:131], v[40:43]
    ds_read_b128 v[116:119], v6 offset:1120
    s_waitcnt lgkmcnt(6)
    v_mfma_f32_16x16x32_bf16 v[28:31], v[160:163], a[192:195], v[28:31]
    ds_write_b128 v5, v[220:223] offset:23872
    v_mfma_f32_16x16x32_bf16 v[44:47], v[164:167], a[192:195], v[44:47]
    v_alignbit_b32 v224, v206, v205, 16
    v_alignbit_b32 v225, v207, v206, 16
    s_waitcnt lgkmcnt(5)
    v_mfma_f32_16x16x32_bf16 v[20:23], v[168:171], a[60:63], v[20:23]
    ds_write_b128 v5, v[222:225] offset:7232
    s_waitcnt lgkmcnt(5)
    v_mfma_f32_16x16x32_bf16 v[36:39], v[172:175], a[60:63], v[36:39]
    buffer_load_dwordx4 v[200:203], v4, s[28:31], s36 offen offset:3056
    v_mfma_f32_16x16x32_bf16 v[24:27], v[168:171], a[124:127], v[24:27]
    ds_read_b128 v[120:123], v6 offset:1152
    v_mfma_f32_16x16x32_bf16 v[40:43], v[172:175], a[124:127], v[40:43]
    ds_read_b128 v[124:127], v6 offset:1184
    v_mfma_f32_16x16x32_bf16 v[28:31], v[168:171], a[188:191], v[28:31]
    buffer_load_dwordx4 v[204:207], v4, s[28:31], s36 offen offset:3072
    v_mfma_f32_16x16x32_bf16 v[44:47], v[172:175], a[188:191], v[44:47]
    s_waitcnt vmcnt(18)
    s_mov_b64 exec, 1
    v_mov_b32 v176, 0
    v_mov_b32 v177, 0
    v_mov_b32 v178, 0
    v_mov_b32 v179, 0
    s_mov_b64 exec, -1
    s_waitcnt lgkmcnt(5)
    v_mfma_f32_16x16x32_bf16 v[20:23], v[112:115], a[56:59], v[20:23]
    ds_write_b128 v5, v[180:183] offset:0
    s_waitcnt lgkmcnt(5)
    v_mfma_f32_16x16x32_bf16 v[36:39], v[116:119], a[56:59], v[36:39]
    ds_write_b128 v5, v[178:181] offset:16640
    v_mfma_f32_16x16x32_bf16 v[24:27], v[112:115], a[120:123], v[24:27]
    ds_read_b128 v[128:131], v6 offset:1216
    v_mfma_f32_16x16x32_bf16 v[40:43], v[116:119], a[120:123], v[40:43]
    ds_read_b128 v[132:135], v6 offset:1248
    v_mfma_f32_16x16x32_bf16 v[28:31], v[112:115], a[184:187], v[28:31]
    v_mov_b32 v208, v177
    v_mov_b32 v209, v178
    v_mfma_f32_16x16x32_bf16 v[44:47], v[116:119], a[184:187], v[44:47]
    v_mov_b32 v210, v179
    v_mov_b32 v211, v180
    s_waitcnt lgkmcnt(5)
    v_mfma_f32_16x16x32_bf16 v[20:23], v[120:123], a[52:55], v[20:23]
    ds_write_b128 v5, v[208:211] offset:24960
    s_waitcnt lgkmcnt(5)
    v_mfma_f32_16x16x32_bf16 v[36:39], v[124:127], a[52:55], v[36:39]
    v_mov_b32 v212, v181
    v_mov_b32 v213, v182
    v_mfma_f32_16x16x32_bf16 v[24:27], v[120:123], a[116:119], v[24:27]
    ds_read_b128 v[136:139], v6 offset:1280
    v_mfma_f32_16x16x32_bf16 v[40:43], v[124:127], a[116:119], v[40:43]
    ds_read_b128 v[140:143], v6 offset:1312
    v_mfma_f32_16x16x32_bf16 v[28:31], v[120:123], a[180:183], v[28:31]
    ds_write_b128 v5, v[210:213] offset:8320
    v_mfma_f32_16x16x32_bf16 v[44:47], v[124:127], a[180:183], v[44:47]
    v_alignbit_b32 v214, v177, v176, 16
    v_alignbit_b32 v215, v178, v177, 16
    s_waitcnt lgkmcnt(5)
    v_mfma_f32_16x16x32_bf16 v[20:23], v[128:131], a[48:51], v[20:23]
    v_alignbit_b32 v216, v179, v178, 16
    v_alignbit_b32 v217, v180, v179, 16
    s_waitcnt lgkmcnt(4)
    v_mfma_f32_16x16x32_bf16 v[36:39], v[132:135], a[48:51], v[36:39]
    ds_write_b128 v5, v[214:217] offset:29120
    v_mfma_f32_16x16x32_bf16 v[24:27], v[128:131], a[112:115], v[24:27]
    ds_read_b128 v[144:147], v6 offset:1344
    v_mfma_f32_16x16x32_bf16 v[40:43], v[132:135], a[112:115], v[40:43]
    ds_read_b128 v[148:151], v6 offset:1376
    v_mfma_f32_16x16x32_bf16 v[28:31], v[128:131], a[176:179], v[28:31]
    v_alignbit_b32 v218, v181, v180, 16
    v_alignbit_b32 v219, v182, v181, 16
    v_mfma_f32_16x16x32_bf16 v[44:47], v[132:135], a[176:179], v[44:47]
    ds_write_b128 v5, v[216:219] offset:12480
    s_waitcnt lgkmcnt(6)
    v_mfma_f32_16x16x32_bf16 v[20:23], v[136:139], a[44:47], v[20:23]
    v_alignbit_b32 v220, v178, v177, 16
    v_alignbit_b32 v221, v179, v178, 16
    s_waitcnt lgkmcnt(5)
    v_mfma_f32_16x16x32_bf16 v[36:39], v[140:143], a[44:47], v[36:39]
    v_alignbit_b32 v222, v180, v179, 16
    v_alignbit_b32 v223, v181, v180, 16
    v_mfma_f32_16x16x32_bf16 v[24:27], v[136:139], a[108:111], v[24:27]
    ds_read_b128 v[152:155], v6 offset:1408
    v_mfma_f32_16x16x32_bf16 v[40:43], v[140:143], a[108:111], v[40:43]
    ds_read_b128 v[156:159], v6 offset:1440
    v_mfma_f32_16x16x32_bf16 v[28:31], v[136:139], a[172:175], v[28:31]
    ds_write_b128 v5, v[220:223] offset:20800
    v_mfma_f32_16x16x32_bf16 v[44:47], v[140:143], a[172:175], v[44:47]
    v_alignbit_b32 v224, v182, v181, 16
    v_alignbit_b32 v225, v183, v182, 16
    s_waitcnt lgkmcnt(5)
    v_mfma_f32_16x16x32_bf16 v[20:23], v[144:147], a[40:43], v[20:23]
    ds_write_b128 v5, v[222:225] offset:4160
    s_waitcnt lgkmcnt(5)
    v_mfma_f32_16x16x32_bf16 v[36:39], v[148:151], a[40:43], v[36:39]
    buffer_load_dwordx4 v[176:179], v230, s[28:31], s37 offen offset:0
    v_mfma_f32_16x16x32_bf16 v[24:27], v[144:147], a[104:107], v[24:27]
    ds_read_b128 v[160:163], v6 offset:1472
    v_mfma_f32_16x16x32_bf16 v[40:43], v[148:151], a[104:107], v[40:43]
    ds_read_b128 v[164:167], v6 offset:1504
    v_mfma_f32_16x16x32_bf16 v[28:31], v[144:147], a[168:171], v[28:31]
    buffer_load_dwordx4 v[180:183], v4, s[28:31], s37 offen offset:0
    v_mfma_f32_16x16x32_bf16 v[44:47], v[148:151], a[168:171], v[44:47]
    s_add_u32 m0, s35, 0
    s_waitcnt lgkmcnt(5)
    v_mfma_f32_16x16x32_bf16 v[20:23], v[152:155], a[36:39], v[20:23]
    buffer_load_dwordx4 v4, s[8:11], s39 offen offset:0 lds
    s_waitcnt lgkmcnt(4)
    v_mfma_f32_16x16x32_bf16 v[36:39], v[156:159], a[36:39], v[36:39]
    s_add_u32 m0, s35, 256
    v_mfma_f32_16x16x32_bf16 v[24:27], v[152:155], a[100:103], v[24:27]
    ds_read_b128 v[168:171], v6 offset:1536
    v_mfma_f32_16x16x32_bf16 v[40:43], v[156:159], a[100:103], v[40:43]
    ds_read_b128 v[172:175], v6 offset:1568
    v_mfma_f32_16x16x32_bf16 v[28:31], v[152:155], a[164:167], v[28:31]
    buffer_load_dwordx4 v4, s[8:11], s39 offen offset:1024 lds
    v_mfma_f32_16x16x32_bf16 v[44:47], v[156:159], a[164:167], v[44:47]
    s_add_u32 m0, s35, 512
    s_waitcnt lgkmcnt(3)
    v_mfma_f32_16x16x32_bf16 v[20:23], v[160:163], a[32:35], v[20:23]
    buffer_load_dwordx4 v4, s[8:11], s39 offen offset:2048 lds
    s_waitcnt lgkmcnt(2)
    v_mfma_f32_16x16x32_bf16 v[36:39], v[164:167], a[32:35], v[36:39]
    s_add_u32 m0, s35, 768
    v_mfma_f32_16x16x32_bf16 v[24:27], v[160:163], a[96:99], v[24:27]
    ds_read_b128 v[112:115], v6 offset:1600
    v_mfma_f32_16x16x32_bf16 v[40:43], v[164:167], a[96:99], v[40:43]
    ds_read_b128 v[116:119], v6 offset:1632
    v_mfma_f32_16x16x32_bf16 v[28:31], v[160:163], a[160:163], v[28:31]
    buffer_load_dwordx4 v4, s[8:11], s39 offen offset:3072 lds
    v_mfma_f32_16x16x32_bf16 v[44:47], v[164:167], a[160:163], v[44:47]
    s_waitcnt lgkmcnt(3)
    v_mfma_f32_16x16x32_bf16 v[20:23], v[168:171], a[28:31], v[20:23]
    s_waitcnt lgkmcnt(2)
    v_mfma_f32_16x16x32_bf16 v[36:39], v[172:175], a[28:31], v[36:39]
    v_mfma_f32_16x16x32_bf16 v[24:27], v[168:171], a[92:95], v[24:27]
    ds_read_b128 v[120:123], v6 offset:1664
    v_mfma_f32_16x16x32_bf16 v[40:43], v[172:175], a[92:95], v[40:43]
    ds_read_b128 v[124:127], v6 offset:1696
    v_mfma_f32_16x16x32_bf16 v[28:31], v[168:171], a[156:159], v[28:31]
    v_mfma_f32_16x16x32_bf16 v[44:47], v[172:175], a[156:159], v[44:47]
    s_waitcnt lgkmcnt(3)
    v_mfma_f32_16x16x32_bf16 v[20:23], v[112:115], a[24:27], v[20:23]
    s_waitcnt lgkmcnt(2)
    v_mfma_f32_16x16x32_bf16 v[36:39], v[116:119], a[24:27], v[36:39]
    v_mfma_f32_16x16x32_bf16 v[24:27], v[112:115], a[88:91], v[24:27]
    ds_read_b128 v[128:131], v6 offset:1728
    v_mfma_f32_16x16x32_bf16 v[40:43], v[116:119], a[88:91], v[40:43]
    ds_read_b128 v[132:135], v6 offset:1760
    v_mfma_f32_16x16x32_bf16 v[28:31], v[112:115], a[152:155], v[28:31]
    v_mfma_f32_16x16x32_bf16 v[44:47], v[116:119], a[152:155], v[44:47]
    s_waitcnt lgkmcnt(3)
    v_mfma_f32_16x16x32_bf16 v[20:23], v[120:123], a[20:23], v[20:23]
    s_waitcnt lgkmcnt(2)
    v_mfma_f32_16x16x32_bf16 v[36:39], v[124:127], a[20:23], v[36:39]
    v_mfma_f32_16x16x32_bf16 v[24:27], v[120:123], a[84:87], v[24:27]
    ds_read_b128 v[136:139], v6 offset:1792
    v_mfma_f32_16x16x32_bf16 v[40:43], v[124:127], a[84:87], v[40:43]
    ds_read_b128 v[140:143], v6 offset:1824
    v_mfma_f32_16x16x32_bf16 v[28:31], v[120:123], a[148:151], v[28:31]
    v_mfma_f32_16x16x32_bf16 v[44:47], v[124:127], a[148:151], v[44:47]
    s_waitcnt lgkmcnt(3)
    v_mfma_f32_16x16x32_bf16 v[20:23], v[128:131], a[16:19], v[20:23]
    s_waitcnt lgkmcnt(2)
    v_mfma_f32_16x16x32_bf16 v[36:39], v[132:135], a[16:19], v[36:39]
    v_mfma_f32_16x16x32_bf16 v[24:27], v[128:131], a[80:83], v[24:27]
    ds_read_b128 v[144:147], v6 offset:1856
    v_mfma_f32_16x16x32_bf16 v[40:43], v[132:135], a[80:83], v[40:43]
    ds_read_b128 v[148:151], v6 offset:1888
    v_mfma_f32_16x16x32_bf16 v[28:31], v[128:131], a[144:147], v[28:31]
    v_mfma_f32_16x16x32_bf16 v[44:47], v[132:135], a[144:147], v[44:47]
    s_waitcnt lgkmcnt(3)
    v_mfma_f32_16x16x32_bf16 v[20:23], v[136:139], a[12:15], v[20:23]
    s_waitcnt lgkmcnt(2)
    v_mfma_f32_16x16x32_bf16 v[36:39], v[140:143], a[12:15], v[36:39]
    v_mfma_f32_16x16x32_bf16 v[24:27], v[136:139], a[76:79], v[24:27]
    ds_read_b128 v[152:155], v6 offset:1920
    v_mfma_f32_16x16x32_bf16 v[40:43], v[140:143], a[76:79], v[40:43]
    ds_read_b128 v[156:159], v6 offset:1952
    v_mfma_f32_16x16x32_bf16 v[28:31], v[136:139], a[140:143], v[28:31]
    v_mfma_f32_16x16x32_bf16 v[44:47], v[140:143], a[140:143], v[44:47]
    s_waitcnt lgkmcnt(3)
    v_mfma_f32_16x16x32_bf16 v[20:23], v[144:147], a[8:11], v[20:23]
    s_waitcnt lgkmcnt(2)
    v_mfma_f32_16x16x32_bf16 v[36:39], v[148:151], a[8:11], v[36:39]
    v_mfma_f32_16x16x32_bf16 v[24:27], v[144:147], a[72:75], v[24:27]
    ds_read_b128 v[160:163], v6 offset:1984
    v_mfma_f32_16x16x32_bf16 v[40:43], v[148:151], a[72:75], v[40:43]
    ds_read_b128 v[164:167], v6 offset:2016
    v_mfma_f32_16x16x32_bf16 v[28:31], v[144:147], a[136:139], v[28:31]
    v_mfma_f32_16x16x32_bf16 v[44:47], v[148:151], a[136:139], v[44:47]
    s_waitcnt lgkmcnt(3)
    v_mfma_f32_16x16x32_bf16 v[20:23], v[152:155], a[4:7], v[20:23]
    s_waitcnt lgkmcnt(2)
    v_mfma_f32_16x16x32_bf16 v[36:39], v[156:159], a[4:7], v[36:39]
    v_mfma_f32_16x16x32_bf16 v[24:27], v[152:155], a[68:71], v[24:27]
    ds_read_b128 v[168:171], v6 offset:2048
    v_mfma_f32_16x16x32_bf16 v[40:43], v[156:159], a[68:71], v[40:43]
    ds_read_b128 v[172:175], v6 offset:2080
    v_mfma_f32_16x16x32_bf16 v[28:31], v[152:155], a[132:135], v[28:31]
    s_waitcnt vmcnt(18)
    v_mfma_f32_16x16x32_bf16 v[44:47], v[156:159], a[132:135], v[44:47]
    ds_write_b128 v5, v[188:191] offset:1024
    s_waitcnt lgkmcnt(4)
    v_mfma_f32_16x16x32_bf16 v[20:23], v[160:163], a[0:3], v[20:23]
    ds_read_b128 v[112:115], v6 offset:2112
    s_waitcnt lgkmcnt(4)
    v_mfma_f32_16x16x32_bf16 v[36:39], v[164:167], a[0:3], v[36:39]
    ds_read_b128 v[116:119], v6 offset:2144
    v_mfma_f32_16x16x32_bf16 v[24:27], v[160:163], a[64:67], v[24:27]
    ds_write_b128 v5, v[186:189] offset:17664
    v_mfma_f32_16x16x32_bf16 v[40:43], v[164:167], a[64:67], v[40:43]
    v_mov_b32 v208, v185
    v_mov_b32 v209, v186
    v_mfma_f32_16x16x32_bf16 v[28:31], v[160:163], a[128:131], v[28:31]
    ds_read_b128 v[120:123], v6 offset:2176
    v_mfma_f32_16x16x32_bf16 v[44:47], v[164:167], a[128:131], v[44:47]
    ds_read_b128 v[124:127], v6 offset:2208
    s_waitcnt lgkmcnt(7)
    v_mfma_f32_16x16x32_bf16 v[24:27], v[168:171], a[60:63], v[24:27]
    v_mov_b32 v210, v187
    v_mov_b32 v211, v188
    s_waitcnt lgkmcnt(6)
    v_mfma_f32_16x16x32_bf16 v[40:43], v[172:175], a[60:63], v[40:43]
    ds_write_b128 v5, v[208:211] offset:25984
    v_mfma_f32_16x16x32_bf16 v[28:31], v[168:171], a[124:127], v[28:31]
    ds_read_b128 v[128:131], v6 offset:2240
    v_mfma_f32_16x16x32_bf16 v[44:47], v[172:175], a[124:127], v[44:47]
    ds_read_b128 v[132:135], v6 offset:2272
    s_waitcnt lgkmcnt(7)
    v_mfma_f32_16x16x32_bf16 v[24:27], v[112:115], a[56:59], v[24:27]
    v_mov_b32 v212, v189
    v_mov_b32 v213, v190
    s_waitcnt lgkmcnt(6)
    v_mfma_f32_16x16x32_bf16 v[40:43], v[116:119], a[56:59], v[40:43]
    ds_write_b128 v5, v[210:213] offset:9344
    v_mfma_f32_16x16x32_bf16 v[28:31], v[112:115], a[120:123], v[28:31]
    ds_read_b128 v[136:139], v6 offset:2304
    v_mfma_f32_16x16x32_bf16 v[44:47], v[116:119], a[120:123], v[44:47]
    ds_read_b128 v[140:143], v6 offset:2336
    s_waitcnt lgkmcnt(7)
    v_mfma_f32_16x16x32_bf16 v[24:27], v[120:123], a[52:55], v[24:27]
    v_alignbit_b32 v214, v185, v184, 16
    v_alignbit_b32 v215, v186, v185, 16
    s_waitcnt lgkmcnt(6)
    v_mfma_f32_16x16x32_bf16 v[40:43], v[124:127], a[52:55], v[40:43]
    v_alignbit_b32 v216, v187, v186, 16
    v_alignbit_b32 v217, v188, v187, 16
    v_mfma_f32_16x16x32_bf16 v[28:31], v[120:123], a[116:119], v[28:31]
    ds_read_b128 v[144:147], v6 offset:2368
    v_mfma_f32_16x16x32_bf16 v[44:47], v[124:127], a[116:119], v[44:47]
    ds_read_b128 v[148:151], v6 offset:2400
    s_waitcnt lgkmcnt(6)
    v_mfma_f32_16x16x32_bf16 v[24:27], v[128:131], a[48:51], v[24:27]
    ds_write_b128 v5, v[214:217] offset:30144
    s_waitcnt lgkmcnt(6)
    v_mfma_f32_16x16x32_bf16 v[40:43], v[132:135], a[48:51], v[40:43]
    v_alignbit_b32 v218, v189, v188, 16
    v_alignbit_b32 v219, v190, v189, 16
    v_mfma_f32_16x16x32_bf16 v[28:31], v[128:131], a[112:115], v[28:31]
    ds_read_b128 v[152:155], v6 offset:2432
    v_mfma_f32_16x16x32_bf16 v[44:47], v[132:135], a[112:115], v[44:47]
    ds_read_b128 v[156:159], v6 offset:2464
    s_waitcnt lgkmcnt(6)
    v_mfma_f32_16x16x32_bf16 v[24:27], v[136:139], a[44:47], v[24:27]
    ds_write_b128 v5, v[216:219] offset:13504
    s_waitcnt lgkmcnt(6)
    v_mfma_f32_16x16x32_bf16 v[40:43], v[140:143], a[44:47], v[40:43]
    v_alignbit_b32 v220, v186, v185, 16
    v_alignbit_b32 v221, v187, v186, 16
    v_mfma_f32_16x16x32_bf16 v[28:31], v[136:139], a[108:111], v[28:31]
    ds_read_b128 v[160:163], v6 offset:2496
    v_mfma_f32_16x16x32_bf16 v[44:47], v[140:143], a[108:111], v[44:47]
    ds_read_b128 v[164:167], v6 offset:2528
    s_waitcnt lgkmcnt(7)
    v_mfma_f32_16x16x32_bf16 v[24:27], v[144:147], a[40:43], v[24:27]
    v_alignbit_b32 v222, v188, v187, 16
    v_alignbit_b32 v223, v189, v188, 16
    s_waitcnt lgkmcnt(6)
    v_mfma_f32_16x16x32_bf16 v[40:43], v[148:151], a[40:43], v[40:43]
    ds_write_b128 v5, v[220:223] offset:21824
    v_mfma_f32_16x16x32_bf16 v[28:31], v[144:147], a[104:107], v[28:31]
    ds_read_b128 v[168:171], v6 offset:2560
    v_mfma_f32_16x16x32_bf16 v[44:47], v[148:151], a[104:107], v[44:47]
    ds_read_b128 v[172:175], v6 offset:2592
    s_waitcnt lgkmcnt(7)
    v_mfma_f32_16x16x32_bf16 v[24:27], v[152:155], a[36:39], v[24:27]
    v_alignbit_b32 v224, v190, v189, 16
    v_alignbit_b32 v225, v191, v190, 16
    s_waitcnt lgkmcnt(6)
    v_mfma_f32_16x16x32_bf16 v[40:43], v[156:159], a[36:39], v[40:43]
    ds_write_b128 v5, v[222:225] offset:5184
    v_mfma_f32_16x16x32_bf16 v[28:31], v[152:155], a[100:103], v[28:31]
    ds_read_b128 v[112:115], v6 offset:2624
    v_mfma_f32_16x16x32_bf16 v[44:47], v[156:159], a[100:103], v[44:47]
    ds_read_b128 v[116:119], v6 offset:2656
    s_waitcnt lgkmcnt(7)
    v_mfma_f32_16x16x32_bf16 v[24:27], v[160:163], a[32:35], v[24:27]
    buffer_load_dwordx4 v[184:187], v4, s[28:31], s37 offen offset:1008
    s_waitcnt lgkmcnt(6)
    v_mfma_f32_16x16x32_bf16 v[40:43], v[164:167], a[32:35], v[40:43]
    buffer_load_dwordx4 v[188:191], v4, s[28:31], s37 offen offset:1024
    v_mfma_f32_16x16x32_bf16 v[28:31], v[160:163], a[96:99], v[28:31]
    ds_read_b128 v[120:123], v6 offset:2688
    v_mfma_f32_16x16x32_bf16 v[44:47], v[164:167], a[96:99], v[44:47]
    ds_read_b128 v[124:127], v6 offset:2720
    s_waitcnt lgkmcnt(6)
    v_mfma_f32_16x16x32_bf16 v[24:27], v[168:171], a[28:31], v[24:27]
    s_mov_b32 s36, s37
    s_add_u32 s39, s37, 125829120
    s_add_u32 s37, s37, 4096
    s_min_u32 s37, s37, s33

    s_pack_hh_b32_b16 s40, s64, s64
    v_and_b32 v236, s40, v8
    s_waitcnt lgkmcnt(5)
    v_mfma_f32_16x16x32_bf16 v[40:43], v[172:175], a[28:31], v[40:43]
    v_and_b32 v237, s40, v9
    v_and_b32 v238, s40, v10
    v_mfma_f32_16x16x32_bf16 v[28:31], v[168:171], a[92:95], v[28:31]
    ds_read_b128 v[128:131], v6 offset:2752
    v_mfma_f32_16x16x32_bf16 v[44:47], v[172:175], a[92:95], v[44:47]
    ds_read_b128 v[132:135], v6 offset:2784
    s_waitcnt lgkmcnt(5)
    v_mfma_f32_16x16x32_bf16 v[24:27], v[112:115], a[24:27], v[24:27]
    v_and_b32 v239, s40, v11
    v_and_b32 v240, s40, v12
    s_waitcnt lgkmcnt(4)
    v_mfma_f32_16x16x32_bf16 v[40:43], v[116:119], a[24:27], v[40:43]
    v_and_b32 v241, s40, v13
    v_and_b32 v242, s40, v14
    v_mfma_f32_16x16x32_bf16 v[28:31], v[112:115], a[88:91], v[28:31]
    ds_read_b128 v[136:139], v6 offset:2816
    v_mfma_f32_16x16x32_bf16 v[44:47], v[116:119], a[88:91], v[44:47]
    ds_read_b128 v[140:143], v6 offset:2848
    s_waitcnt lgkmcnt(5)
    v_mfma_f32_16x16x32_bf16 v[24:27], v[120:123], a[20:23], v[24:27]
    v_and_b32 v243, s40, v15
    s_waitcnt lgkmcnt(4)
    v_mfma_f32_16x16x32_bf16 v[40:43], v[124:127], a[20:23], v[40:43]
    v_mfma_f32_16x16x32_bf16 v[28:31], v[120:123], a[84:87], v[28:31]
    ds_read_b128 v[144:147], v6 offset:2880
    v_mfma_f32_16x16x32_bf16 v[44:47], v[124:127], a[84:87], v[44:47]
    ds_read_b128 v[148:151], v6 offset:2912
    s_waitcnt lgkmcnt(5)
    v_mfma_f32_16x16x32_bf16 v[24:27], v[128:131], a[16:19], v[24:27]
    s_waitcnt lgkmcnt(4)
    v_mfma_f32_16x16x32_bf16 v[40:43], v[132:135], a[16:19], v[40:43]
    v_mfma_f32_16x16x32_bf16 v[28:31], v[128:131], a[80:83], v[28:31]
    ds_read_b128 v[152:155], v6 offset:2944
    v_mfma_f32_16x16x32_bf16 v[44:47], v[132:135], a[80:83], v[44:47]
    ds_read_b128 v[156:159], v6 offset:2976
    s_waitcnt lgkmcnt(5)
    v_mfma_f32_16x16x32_bf16 v[24:27], v[136:139], a[12:15], v[24:27]
    s_waitcnt lgkmcnt(4)
    v_mfma_f32_16x16x32_bf16 v[40:43], v[140:143], a[12:15], v[40:43]
    v_mfma_f32_16x16x32_bf16 v[28:31], v[136:139], a[76:79], v[28:31]
    ds_read_b128 v[160:163], v6 offset:3008
    v_mfma_f32_16x16x32_bf16 v[44:47], v[140:143], a[76:79], v[44:47]
    ds_read_b128 v[164:167], v6 offset:3040
    s_waitcnt lgkmcnt(5)
    v_mfma_f32_16x16x32_bf16 v[24:27], v[144:147], a[8:11], v[24:27]
    s_waitcnt lgkmcnt(4)
    v_mfma_f32_16x16x32_bf16 v[40:43], v[148:151], a[8:11], v[40:43]
    v_mfma_f32_16x16x32_bf16 v[28:31], v[144:147], a[72:75], v[28:31]
    ds_read_b128 v[168:171], v6 offset:3072
    v_mfma_f32_16x16x32_bf16 v[44:47], v[148:151], a[72:75], v[44:47]
    ds_read_b128 v[172:175], v6 offset:3104
    s_waitcnt lgkmcnt(5)
    v_mfma_f32_16x16x32_bf16 v[24:27], v[152:155], a[4:7], v[24:27]
    ds_read_b128 v[112:115], v6 offset:3136
    s_waitcnt lgkmcnt(5)
    v_mfma_f32_16x16x32_bf16 v[40:43], v[156:159], a[4:7], v[40:43]
    ds_read_b128 v[116:119], v6 offset:3168
    v_mfma_f32_16x16x32_bf16 v[28:31], v[152:155], a[68:71], v[28:31]
    ds_read_b128 v[120:123], v6 offset:3200
    v_mfma_f32_16x16x32_bf16 v[44:47], v[156:159], a[68:71], v[44:47]
    ds_read_b128 v[124:127], v6 offset:3232
    s_waitcnt lgkmcnt(7)
    v_mfma_f32_16x16x32_bf16 v[24:27], v[160:163], a[0:3], v[24:27]
    ds_read_b128 v[128:131], v6 offset:3264
    s_waitcnt lgkmcnt(7)
    v_mfma_f32_16x16x32_bf16 v[40:43], v[164:167], a[0:3], v[40:43]
    ds_read_b128 v[132:135], v6 offset:3296
    v_mfma_f32_16x16x32_bf16 v[28:31], v[160:163], a[64:67], v[28:31]
    ds_read_b128 v[136:139], v6 offset:3328
    v_mfma_f32_16x16x32_bf16 v[44:47], v[164:167], a[64:67], v[44:47]
    ds_read_b128 v[140:143], v6 offset:3360
    s_waitcnt lgkmcnt(9)
    v_mfma_f32_16x16x32_bf16 v[28:31], v[168:171], a[60:63], v[28:31]
    ds_read_b128 v[144:147], v6 offset:3392
    s_waitcnt lgkmcnt(9)
    v_mfma_f32_16x16x32_bf16 v[44:47], v[172:175], a[60:63], v[44:47]
    ds_read_b128 v[148:151], v6 offset:3424
    s_waitcnt lgkmcnt(9)
    v_mfma_f32_16x16x32_bf16 v[28:31], v[112:115], a[56:59], v[28:31]
    ds_read_b128 v[152:155], v6 offset:3456
    s_waitcnt lgkmcnt(9)
    v_mfma_f32_16x16x32_bf16 v[44:47], v[116:119], a[56:59], v[44:47]
    ds_read_b128 v[156:159], v6 offset:3488
    s_waitcnt lgkmcnt(9)
    v_mfma_f32_16x16x32_bf16 v[28:31], v[120:123], a[52:55], v[28:31]
    ds_read_b128 v[160:163], v6 offset:3520
    s_waitcnt lgkmcnt(9)
    v_mfma_f32_16x16x32_bf16 v[44:47], v[124:127], a[52:55], v[44:47]
    ds_read_b128 v[164:167], v6 offset:3552
    s_waitcnt lgkmcnt(9)
    v_mfma_f32_16x16x32_bf16 v[28:31], v[128:131], a[48:51], v[28:31]
    ds_read_b128 v[168:171], v6 offset:3584
    s_waitcnt lgkmcnt(9)
    v_mfma_f32_16x16x32_bf16 v[44:47], v[132:135], a[48:51], v[44:47]
    ds_read_b128 v[172:175], v6 offset:3616
    s_waitcnt lgkmcnt(9)
    v_mfma_f32_16x16x32_bf16 v[28:31], v[136:139], a[44:47], v[28:31]
    ds_read_b128 v[112:115], v6 offset:3648
    s_waitcnt lgkmcnt(9)
    v_mfma_f32_16x16x32_bf16 v[44:47], v[140:143], a[44:47], v[44:47]
    ds_read_b128 v[116:119], v6 offset:3680
    s_waitcnt lgkmcnt(9)
    v_mfma_f32_16x16x32_bf16 v[28:31], v[144:147], a[40:43], v[28:31]
    ds_read_b128 v[120:123], v6 offset:3712
    s_waitcnt lgkmcnt(9)
    v_mfma_f32_16x16x32_bf16 v[44:47], v[148:151], a[40:43], v[44:47]
    ds_read_b128 v[124:127], v6 offset:3744
    s_waitcnt lgkmcnt(9)
    v_mfma_f32_16x16x32_bf16 v[28:31], v[152:155], a[36:39], v[28:31]
    ds_read_b128 v[128:131], v6 offset:3776
    s_waitcnt lgkmcnt(9)
    v_mfma_f32_16x16x32_bf16 v[44:47], v[156:159], a[36:39], v[44:47]
    ds_read_b128 v[132:135], v6 offset:3808
    s_waitcnt lgkmcnt(9)
    v_mfma_f32_16x16x32_bf16 v[28:31], v[160:163], a[32:35], v[28:31]
    ds_read_b128 v[136:139], v6 offset:3840
    s_waitcnt lgkmcnt(9)
    v_mfma_f32_16x16x32_bf16 v[44:47], v[164:167], a[32:35], v[44:47]
    ds_read_b128 v[140:143], v6 offset:3872
    s_waitcnt lgkmcnt(9)
    v_mfma_f32_16x16x32_bf16 v[28:31], v[168:171], a[28:31], v[28:31]
    ds_read_b128 v[144:147], v6 offset:3904
    s_waitcnt lgkmcnt(9)
    v_mfma_f32_16x16x32_bf16 v[44:47], v[172:175], a[28:31], v[44:47]
    ds_read_b128 v[148:151], v6 offset:3936
    s_waitcnt lgkmcnt(9)
    v_mfma_f32_16x16x32_bf16 v[28:31], v[112:115], a[24:27], v[28:31]
    ds_read_b128 v[152:155], v6 offset:3968
    s_waitcnt lgkmcnt(9)
    v_mfma_f32_16x16x32_bf16 v[44:47], v[116:119], a[24:27], v[44:47]
    ds_read_b128 v[156:159], v6 offset:4000
    s_waitcnt lgkmcnt(9)
    v_mfma_f32_16x16x32_bf16 v[28:31], v[120:123], a[20:23], v[28:31]
    ds_read_b128 v[160:163], v6 offset:4032
    s_waitcnt lgkmcnt(9)
    v_mfma_f32_16x16x32_bf16 v[44:47], v[124:127], a[20:23], v[44:47]
    ds_read_b128 v[164:167], v6 offset:4064
    s_waitcnt lgkmcnt(9)
    v_mfma_f32_16x16x32_bf16 v[28:31], v[128:131], a[16:19], v[28:31]
    s_waitcnt vmcnt(2)
    ds_read_b128 a[60:63], v7 offset:240
    s_waitcnt lgkmcnt(9)
    v_mfma_f32_16x16x32_bf16 v[44:47], v[132:135], a[16:19], v[44:47]
    s_waitcnt lgkmcnt(8)
    v_mfma_f32_16x16x32_bf16 v[28:31], v[136:139], a[12:15], v[28:31]
    ds_read_b128 a[124:127], v7 offset:496
    s_waitcnt lgkmcnt(8)
    v_mfma_f32_16x16x32_bf16 v[44:47], v[140:143], a[12:15], v[44:47]
    s_waitcnt lgkmcnt(7)
    v_mfma_f32_16x16x32_bf16 v[28:31], v[144:147], a[8:11], v[28:31]
    ds_read_b128 a[188:191], v7 offset:752
    s_waitcnt lgkmcnt(7)
    v_mfma_f32_16x16x32_bf16 v[44:47], v[148:151], a[8:11], v[44:47]
    s_waitcnt lgkmcnt(6)
    v_mfma_f32_16x16x32_bf16 v[28:31], v[152:155], a[4:7], v[28:31]
    ds_read_b128 a[252:255], v7 offset:1008
    s_waitcnt lgkmcnt(6)
    v_mfma_f32_16x16x32_bf16 v[44:47], v[156:159], a[4:7], v[44:47]
    s_waitcnt lgkmcnt(5)
    v_mfma_f32_16x16x32_bf16 v[28:31], v[160:163], a[0:3], v[28:31]
    ds_read_b128 v[168:171], v6 offset:0
    s_waitcnt lgkmcnt(5)
    v_mfma_f32_16x16x32_bf16 v[44:47], v[164:167], a[0:3], v[44:47]
    ds_read_b128 v[172:175], v6 offset:32
    s_waitcnt lgkmcnt(5)
    v_mfma_f32_16x16x32_bf16 v[48:51], v[236:239], a[60:63], 0
    v_mfma_f32_16x16x32_bf16 v[64:67], v[240:243], a[60:63], 0
    s_waitcnt lgkmcnt(4)
    v_mfma_f32_16x16x32_bf16 v[52:55], v[236:239], a[124:127], 0
    v_mfma_f32_16x16x32_bf16 v[68:71], v[240:243], a[124:127], 0
    s_waitcnt lgkmcnt(3)
    v_mfma_f32_16x16x32_bf16 v[56:59], v[236:239], a[188:191], 0
    v_mfma_f32_16x16x32_bf16 v[72:75], v[240:243], a[188:191], 0
    ds_read_b128 a[56:59], v7 offset:224
    s_waitcnt lgkmcnt(3)
    v_mfma_f32_16x16x32_bf16 v[60:63], v[236:239], a[252:255], 0
    ds_read_b128 v[112:115], v6 offset:64
    v_mfma_f32_16x16x32_bf16 v[76:79], v[240:243], a[252:255], 0
    ds_read_b128 v[116:119], v6 offset:96
    s_waitcnt lgkmcnt(4)
    v_mfma_f32_16x16x32_bf16 v[48:51], v[168:171], a[60:63], v[48:51]
    ds_read_b128 a[120:123], v7 offset:480
    s_waitcnt lgkmcnt(4)
    v_mfma_f32_16x16x32_bf16 v[64:67], v[172:175], a[60:63], v[64:67]
    s_waitcnt vmcnt(10)
    v_mfma_f32_16x16x32_bf16 v[52:55], v[168:171], a[124:127], v[52:55]
    ds_read_b128 a[184:187], v7 offset:736
    v_mfma_f32_16x16x32_bf16 v[68:71], v[172:175], a[124:127], v[68:71]
    ds_write_b128 v5, v[196:199] offset:2048
    v_mfma_f32_16x16x32_bf16 v[56:59], v[168:171], a[188:191], v[56:59]
    ds_read_b128 a[248:251], v7 offset:992
    v_mfma_f32_16x16x32_bf16 v[72:75], v[172:175], a[188:191], v[72:75]
    ds_read_b128 a[52:55], v7 offset:208
    v_mfma_f32_16x16x32_bf16 v[60:63], v[168:171], a[252:255], v[60:63]
    ds_read_b128 v[120:123], v6 offset:128
    v_mfma_f32_16x16x32_bf16 v[76:79], v[172:175], a[252:255], v[76:79]
    ds_read_b128 v[124:127], v6 offset:160
    s_waitcnt lgkmcnt(8)
    v_mfma_f32_16x16x32_bf16 v[48:51], v[112:115], a[56:59], v[48:51]
    ds_read_b128 a[116:119], v7 offset:464
    s_waitcnt lgkmcnt(8)
    v_mfma_f32_16x16x32_bf16 v[64:67], v[116:119], a[56:59], v[64:67]
    ds_write_b128 v5, v[194:197] offset:18688
    s_waitcnt lgkmcnt(8)
    v_mfma_f32_16x16x32_bf16 v[52:55], v[112:115], a[120:123], v[52:55]
    ds_read_b128 a[180:183], v7 offset:720
    v_mfma_f32_16x16x32_bf16 v[68:71], v[116:119], a[120:123], v[68:71]
    v_mov_b32 v208, v193
    v_mov_b32 v209, v194
    s_waitcnt lgkmcnt(8)
    v_mfma_f32_16x16x32_bf16 v[56:59], v[112:115], a[184:187], v[56:59]
    ds_read_b128 a[244:247], v7 offset:976
    v_mfma_f32_16x16x32_bf16 v[72:75], v[116:119], a[184:187], v[72:75]
    ds_read_b128 a[48:51], v7 offset:192
    s_waitcnt lgkmcnt(8)
    v_mfma_f32_16x16x32_bf16 v[60:63], v[112:115], a[248:251], v[60:63]
    ds_read_b128 v[128:131], v6 offset:192
    v_mfma_f32_16x16x32_bf16 v[76:79], v[116:119], a[248:251], v[76:79]
    ds_read_b128 v[132:135], v6 offset:224
    s_waitcnt lgkmcnt(8)
    v_mfma_f32_16x16x32_bf16 v[48:51], v[120:123], a[52:55], v[48:51]
    ds_read_b128 a[112:115], v7 offset:448
    s_waitcnt lgkmcnt(8)
    v_mfma_f32_16x16x32_bf16 v[64:67], v[124:127], a[52:55], v[64:67]
    v_mov_b32 v210, v195
    v_mov_b32 v211, v196
    s_waitcnt lgkmcnt(7)
    v_mfma_f32_16x16x32_bf16 v[52:55], v[120:123], a[116:119], v[52:55]
    ds_read_b128 a[176:179], v7 offset:704
    v_mfma_f32_16x16x32_bf16 v[68:71], v[124:127], a[116:119], v[68:71]
    ds_write_b128 v5, v[208:211] offset:27008
    s_waitcnt lgkmcnt(7)
    v_mfma_f32_16x16x32_bf16 v[56:59], v[120:123], a[180:183], v[56:59]
    ds_read_b128 a[240:243], v7 offset:960
    v_mfma_f32_16x16x32_bf16 v[72:75], v[124:127], a[180:183], v[72:75]
    ds_read_b128 a[44:47], v7 offset:176
    s_waitcnt lgkmcnt(8)
    v_mfma_f32_16x16x32_bf16 v[60:63], v[120:123], a[244:247], v[60:63]
    ds_read_b128 v[136:139], v6 offset:256
    v_mfma_f32_16x16x32_bf16 v[76:79], v[124:127], a[244:247], v[76:79]
    ds_read_b128 v[140:143], v6 offset:288
    s_waitcnt lgkmcnt(8)
    v_mfma_f32_16x16x32_bf16 v[48:51], v[128:131], a[48:51], v[48:51]
    ds_read_b128 a[108:111], v7 offset:432
    s_waitcnt lgkmcnt(8)
    v_mfma_f32_16x16x32_bf16 v[64:67], v[132:135], a[48:51], v[64:67]
    v_mov_b32 v212, v197
    v_mov_b32 v213, v198
    s_waitcnt lgkmcnt(7)
    v_mfma_f32_16x16x32_bf16 v[52:55], v[128:131], a[112:115], v[52:55]
    ds_read_b128 a[172:175], v7 offset:688
    v_mfma_f32_16x16x32_bf16 v[68:71], v[132:135], a[112:115], v[68:71]
    ds_write_b128 v5, v[210:213] offset:10368
    s_waitcnt lgkmcnt(8)
    v_mfma_f32_16x16x32_bf16 v[56:59], v[128:131], a[176:179], v[56:59]
    ds_read_b128 a[236:239], v7 offset:944
    v_mfma_f32_16x16x32_bf16 v[72:75], v[132:135], a[176:179], v[72:75]
    ds_read_b128 a[40:43], v7 offset:160
    s_waitcnt lgkmcnt(8)
    v_mfma_f32_16x16x32_bf16 v[60:63], v[128:131], a[240:243], v[60:63]
    ds_read_b128 v[144:147], v6 offset:320
    v_mfma_f32_16x16x32_bf16 v[76:79], v[132:135], a[240:243], v[76:79]
    ds_read_b128 v[148:151], v6 offset:352
    s_waitcnt lgkmcnt(8)
    v_mfma_f32_16x16x32_bf16 v[48:51], v[136:139], a[44:47], v[48:51]
    ds_read_b128 a[104:107], v7 offset:416
    s_waitcnt lgkmcnt(8)
    v_mfma_f32_16x16x32_bf16 v[64:67], v[140:143], a[44:47], v[64:67]
    v_alignbit_b32 v214, v193, v192, 16
    v_alignbit_b32 v215, v194, v193, 16
    s_waitcnt lgkmcnt(7)
    v_mfma_f32_16x16x32_bf16 v[52:55], v[136:139], a[108:111], v[52:55]
    ds_read_b128 a[168:171], v7 offset:672
    v_mfma_f32_16x16x32_bf16 v[68:71], v[140:143], a[108:111], v[68:71]
    v_alignbit_b32 v216, v195, v194, 16
    v_alignbit_b32 v217, v196, v195, 16
    s_waitcnt lgkmcnt(7)
    v_mfma_f32_16x16x32_bf16 v[56:59], v[136:139], a[172:175], v[56:59]
    ds_read_b128 a[232:235], v7 offset:928
    v_mfma_f32_16x16x32_bf16 v[72:75], v[140:143], a[172:175], v[72:75]
    ds_read_b128 a[36:39], v7 offset:144
    s_waitcnt lgkmcnt(7)
    v_mfma_f32_16x16x32_bf16 v[60:63], v[136:139], a[236:239], v[60:63]
    ds_read_b128 v[152:155], v6 offset:384
    v_mfma_f32_16x16x32_bf16 v[76:79], v[140:143], a[236:239], v[76:79]
    ds_read_b128 v[156:159], v6 offset:416
    s_waitcnt lgkmcnt(7)
    v_mfma_f32_16x16x32_bf16 v[48:51], v[144:147], a[40:43], v[48:51]
    ds_read_b128 a[100:103], v7 offset:400
    s_waitcnt lgkmcnt(7)
    v_mfma_f32_16x16x32_bf16 v[64:67], v[148:151], a[40:43], v[64:67]
    ds_write_b128 v5, v[214:217] offset:31168
    s_waitcnt lgkmcnt(7)
    v_mfma_f32_16x16x32_bf16 v[52:55], v[144:147], a[104:107], v[52:55]
    ds_read_b128 a[164:167], v7 offset:656
    v_mfma_f32_16x16x32_bf16 v[68:71], v[148:151], a[104:107], v[68:71]
    v_alignbit_b32 v218, v197, v196, 16
    v_alignbit_b32 v219, v198, v197, 16
    s_waitcnt lgkmcnt(7)
    v_mfma_f32_16x16x32_bf16 v[56:59], v[144:147], a[168:171], v[56:59]
    ds_read_b128 a[228:231], v7 offset:912
    v_mfma_f32_16x16x32_bf16 v[72:75], v[148:151], a[168:171], v[72:75]
    ds_read_b128 a[32:35], v7 offset:128
    s_waitcnt lgkmcnt(8)
    v_mfma_f32_16x16x32_bf16 v[60:63], v[144:147], a[232:235], v[60:63]
    ds_read_b128 v[160:163], v6 offset:448
    v_mfma_f32_16x16x32_bf16 v[76:79], v[148:151], a[232:235], v[76:79]
    ds_read_b128 v[164:167], v6 offset:480
    s_waitcnt lgkmcnt(8)
    v_mfma_f32_16x16x32_bf16 v[48:51], v[152:155], a[36:39], v[48:51]
    ds_read_b128 a[96:99], v7 offset:384
    s_waitcnt lgkmcnt(8)
    v_mfma_f32_16x16x32_bf16 v[64:67], v[156:159], a[36:39], v[64:67]
    ds_write_b128 v5, v[216:219] offset:14528
    s_waitcnt lgkmcnt(8)
    v_mfma_f32_16x16x32_bf16 v[52:55], v[152:155], a[100:103], v[52:55]
    ds_read_b128 a[160:163], v7 offset:640
    v_mfma_f32_16x16x32_bf16 v[68:71], v[156:159], a[100:103], v[68:71]
    v_alignbit_b32 v220, v194, v193, 16
    v_alignbit_b32 v221, v195, v194, 16
    s_waitcnt lgkmcnt(7)
    v_mfma_f32_16x16x32_bf16 v[56:59], v[152:155], a[164:167], v[56:59]
    ds_read_b128 a[224:227], v7 offset:896
    v_mfma_f32_16x16x32_bf16 v[72:75], v[156:159], a[164:167], v[72:75]
    ds_read_b128 a[28:31], v7 offset:112
    s_waitcnt lgkmcnt(8)
    v_mfma_f32_16x16x32_bf16 v[60:63], v[152:155], a[228:231], v[60:63]
    ds_read_b128 v[168:171], v6 offset:512
    v_mfma_f32_16x16x32_bf16 v[76:79], v[156:159], a[228:231], v[76:79]
    ds_read_b128 v[172:175], v6 offset:544
    s_waitcnt lgkmcnt(8)
    v_mfma_f32_16x16x32_bf16 v[48:51], v[160:163], a[32:35], v[48:51]
    ds_read_b128 a[92:95], v7 offset:368
    s_waitcnt lgkmcnt(8)
    v_mfma_f32_16x16x32_bf16 v[64:67], v[164:167], a[32:35], v[64:67]
    v_alignbit_b32 v222, v196, v195, 16
    v_alignbit_b32 v223, v197, v196, 16
    s_waitcnt lgkmcnt(7)
    v_mfma_f32_16x16x32_bf16 v[52:55], v[160:163], a[96:99], v[52:55]
    ds_read_b128 a[156:159], v7 offset:624
    v_mfma_f32_16x16x32_bf16 v[68:71], v[164:167], a[96:99], v[68:71]
    ds_write_b128 v5, v[220:223] offset:22848
    s_waitcnt lgkmcnt(7)
    v_mfma_f32_16x16x32_bf16 v[56:59], v[160:163], a[160:163], v[56:59]
    ds_read_b128 a[220:223], v7 offset:880
    v_mfma_f32_16x16x32_bf16 v[72:75], v[164:167], a[160:163], v[72:75]
    ds_read_b128 a[24:27], v7 offset:96
    s_waitcnt lgkmcnt(8)
    v_mfma_f32_16x16x32_bf16 v[60:63], v[160:163], a[224:227], v[60:63]
    ds_read_b128 v[112:115], v6 offset:576
    v_mfma_f32_16x16x32_bf16 v[76:79], v[164:167], a[224:227], v[76:79]
    ds_read_b128 v[116:119], v6 offset:608
    s_waitcnt lgkmcnt(8)
    v_mfma_f32_16x16x32_bf16 v[48:51], v[168:171], a[28:31], v[48:51]
    ds_read_b128 a[88:91], v7 offset:352
    s_waitcnt lgkmcnt(8)
    v_mfma_f32_16x16x32_bf16 v[64:67], v[172:175], a[28:31], v[64:67]
    v_alignbit_b32 v224, v198, v197, 16
    v_alignbit_b32 v225, v199, v198, 16
    s_waitcnt lgkmcnt(7)
    v_mfma_f32_16x16x32_bf16 v[52:55], v[168:171], a[92:95], v[52:55]
    ds_read_b128 a[152:155], v7 offset:608
    v_mfma_f32_16x16x32_bf16 v[68:71], v[172:175], a[92:95], v[68:71]
    ds_write_b128 v5, v[222:225] offset:6208
    s_waitcnt lgkmcnt(8)
    v_mfma_f32_16x16x32_bf16 v[56:59], v[168:171], a[156:159], v[56:59]
    ds_read_b128 a[216:219], v7 offset:864
    v_mfma_f32_16x16x32_bf16 v[72:75], v[172:175], a[156:159], v[72:75]
    ds_read_b128 a[20:23], v7 offset:80
    s_waitcnt lgkmcnt(8)
    v_mfma_f32_16x16x32_bf16 v[60:63], v[168:171], a[220:223], v[60:63]
    ds_read_b128 v[120:123], v6 offset:640
    v_mfma_f32_16x16x32_bf16 v[76:79], v[172:175], a[220:223], v[76:79]
    ds_read_b128 v[124:127], v6 offset:672
    s_waitcnt lgkmcnt(8)
    v_mfma_f32_16x16x32_bf16 v[48:51], v[112:115], a[24:27], v[48:51]
    ds_read_b128 a[84:87], v7 offset:336
    s_waitcnt lgkmcnt(8)
    v_mfma_f32_16x16x32_bf16 v[64:67], v[116:119], a[24:27], v[64:67]
    buffer_load_dwordx4 v[192:195], v4, s[28:31], s36 offen offset:2032
    s_waitcnt lgkmcnt(7)
    v_mfma_f32_16x16x32_bf16 v[52:55], v[112:115], a[88:91], v[52:55]
    ds_read_b128 a[148:151], v7 offset:592
    v_mfma_f32_16x16x32_bf16 v[68:71], v[116:119], a[88:91], v[68:71]
    buffer_load_dwordx4 v[196:199], v4, s[28:31], s36 offen offset:2048
    s_waitcnt lgkmcnt(7)
    v_mfma_f32_16x16x32_bf16 v[56:59], v[112:115], a[152:155], v[56:59]
    ds_read_b128 a[212:215], v7 offset:848
    v_mfma_f32_16x16x32_bf16 v[72:75], v[116:119], a[152:155], v[72:75]
    ds_read_b128 a[16:19], v7 offset:64
    s_waitcnt lgkmcnt(7)
    v_mfma_f32_16x16x32_bf16 v[60:63], v[112:115], a[216:219], v[60:63]
    ds_read_b128 v[128:131], v6 offset:704
    v_mfma_f32_16x16x32_bf16 v[76:79], v[116:119], a[216:219], v[76:79]
    ds_read_b128 v[132:135], v6 offset:736
    s_waitcnt lgkmcnt(7)
    v_mfma_f32_16x16x32_bf16 v[48:51], v[120:123], a[20:23], v[48:51]
    ds_read_b128 a[80:83], v7 offset:320
    s_waitcnt lgkmcnt(7)
    v_mfma_f32_16x16x32_bf16 v[64:67], v[124:127], a[20:23], v[64:67]
    s_waitcnt vmcnt(10)
    s_waitcnt lgkmcnt(6)
    v_mfma_f32_16x16x32_bf16 v[52:55], v[120:123], a[84:87], v[52:55]
    ds_read_b128 a[144:147], v7 offset:576
    v_mfma_f32_16x16x32_bf16 v[68:71], v[124:127], a[84:87], v[68:71]
    ds_write_b128 v5, v[204:207] offset:3072
    s_waitcnt lgkmcnt(7)
    v_mfma_f32_16x16x32_bf16 v[56:59], v[120:123], a[148:151], v[56:59]
    ds_read_b128 a[208:211], v7 offset:832
    v_mfma_f32_16x16x32_bf16 v[72:75], v[124:127], a[148:151], v[72:75]
    ds_read_b128 a[12:15], v7 offset:48
    s_waitcnt lgkmcnt(8)
    v_mfma_f32_16x16x32_bf16 v[60:63], v[120:123], a[212:215], v[60:63]
    ds_read_b128 v[136:139], v6 offset:768
    v_mfma_f32_16x16x32_bf16 v[76:79], v[124:127], a[212:215], v[76:79]
    ds_read_b128 v[140:143], v6 offset:800
    s_waitcnt lgkmcnt(8)
    v_mfma_f32_16x16x32_bf16 v[48:51], v[128:131], a[16:19], v[48:51]
    ds_read_b128 a[76:79], v7 offset:304
    s_waitcnt lgkmcnt(8)
    v_mfma_f32_16x16x32_bf16 v[64:67], v[132:135], a[16:19], v[64:67]
    ds_write_b128 v5, v[202:205] offset:19712
    s_waitcnt lgkmcnt(8)
    v_mfma_f32_16x16x32_bf16 v[52:55], v[128:131], a[80:83], v[52:55]
    ds_read_b128 a[140:143], v7 offset:560
    v_mfma_f32_16x16x32_bf16 v[68:71], v[132:135], a[80:83], v[68:71]
    v_mov_b32 v208, v201
    v_mov_b32 v209, v202
    s_waitcnt lgkmcnt(8)
    v_mfma_f32_16x16x32_bf16 v[56:59], v[128:131], a[144:147], v[56:59]
    ds_read_b128 a[204:207], v7 offset:816
    v_mfma_f32_16x16x32_bf16 v[72:75], v[132:135], a[144:147], v[72:75]
    ds_read_b128 a[8:11], v7 offset:32
    s_waitcnt lgkmcnt(8)
    v_mfma_f32_16x16x32_bf16 v[60:63], v[128:131], a[208:211], v[60:63]
    ds_read_b128 v[144:147], v6 offset:832
    v_mfma_f32_16x16x32_bf16 v[76:79], v[132:135], a[208:211], v[76:79]
    ds_read_b128 v[148:151], v6 offset:864
    s_waitcnt lgkmcnt(8)
    v_mfma_f32_16x16x32_bf16 v[48:51], v[136:139], a[12:15], v[48:51]
    ds_read_b128 a[72:75], v7 offset:288
    s_waitcnt lgkmcnt(8)
    v_mfma_f32_16x16x32_bf16 v[64:67], v[140:143], a[12:15], v[64:67]
    v_mov_b32 v210, v203
    v_mov_b32 v211, v204
    s_waitcnt lgkmcnt(7)
    v_mfma_f32_16x16x32_bf16 v[52:55], v[136:139], a[76:79], v[52:55]
    ds_read_b128 a[136:139], v7 offset:544
    v_mfma_f32_16x16x32_bf16 v[68:71], v[140:143], a[76:79], v[68:71]
    ds_write_b128 v5, v[208:211] offset:28032
    s_waitcnt lgkmcnt(7)
    v_mfma_f32_16x16x32_bf16 v[56:59], v[136:139], a[140:143], v[56:59]
    ds_read_b128 a[200:203], v7 offset:800
    v_mfma_f32_16x16x32_bf16 v[72:75], v[140:143], a[140:143], v[72:75]
    ds_read_b128 a[4:7], v7 offset:16
    s_waitcnt lgkmcnt(8)
    v_mfma_f32_16x16x32_bf16 v[60:63], v[136:139], a[204:207], v[60:63]
    ds_read_b128 v[152:155], v6 offset:896
    v_mfma_f32_16x16x32_bf16 v[76:79], v[140:143], a[204:207], v[76:79]
    ds_read_b128 v[156:159], v6 offset:928
    s_waitcnt lgkmcnt(8)
    v_mfma_f32_16x16x32_bf16 v[48:51], v[144:147], a[8:11], v[48:51]
    ds_read_b128 a[68:71], v7 offset:272
    s_waitcnt lgkmcnt(8)
    v_mfma_f32_16x16x32_bf16 v[64:67], v[148:151], a[8:11], v[64:67]
    v_mov_b32 v212, v205
    v_mov_b32 v213, v206
    s_waitcnt lgkmcnt(7)
    v_mfma_f32_16x16x32_bf16 v[52:55], v[144:147], a[72:75], v[52:55]
    ds_read_b128 a[132:135], v7 offset:528
    v_mfma_f32_16x16x32_bf16 v[68:71], v[148:151], a[72:75], v[68:71]
    ds_write_b128 v5, v[210:213] offset:11392
    s_waitcnt lgkmcnt(8)
    v_mfma_f32_16x16x32_bf16 v[56:59], v[144:147], a[136:139], v[56:59]
    ds_read_b128 a[196:199], v7 offset:784
    v_mfma_f32_16x16x32_bf16 v[72:75], v[148:151], a[136:139], v[72:75]
    ds_read_b128 a[0:3], v7 offset:0
    s_waitcnt lgkmcnt(8)
    v_mfma_f32_16x16x32_bf16 v[60:63], v[144:147], a[200:203], v[60:63]
    ds_read_b128 v[160:163], v6 offset:960
    v_mfma_f32_16x16x32_bf16 v[76:79], v[148:151], a[200:203], v[76:79]
    ds_read_b128 v[164:167], v6 offset:992
    s_waitcnt lgkmcnt(8)
    v_mfma_f32_16x16x32_bf16 v[48:51], v[152:155], a[4:7], v[48:51]
    ds_read_b128 a[64:67], v7 offset:256
    s_waitcnt lgkmcnt(8)
    v_mfma_f32_16x16x32_bf16 v[64:67], v[156:159], a[4:7], v[64:67]
    v_alignbit_b32 v214, v201, v200, 16
    v_alignbit_b32 v215, v202, v201, 16
    s_waitcnt lgkmcnt(7)
    v_mfma_f32_16x16x32_bf16 v[52:55], v[152:155], a[68:71], v[52:55]
    ds_read_b128 a[128:131], v7 offset:512
    v_mfma_f32_16x16x32_bf16 v[68:71], v[156:159], a[68:71], v[68:71]
    v_alignbit_b32 v216, v203, v202, 16
    v_alignbit_b32 v217, v204, v203, 16
    s_waitcnt lgkmcnt(7)
    v_mfma_f32_16x16x32_bf16 v[56:59], v[152:155], a[132:135], v[56:59]
    ds_read_b128 a[192:195], v7 offset:768
    v_mfma_f32_16x16x32_bf16 v[72:75], v[156:159], a[132:135], v[72:75]
    ds_write_b128 v5, v[214:217] offset:32192
    s_waitcnt lgkmcnt(7)
    v_mfma_f32_16x16x32_bf16 v[60:63], v[152:155], a[196:199], v[60:63]
    ds_read_b128 v[168:171], v6 offset:1024
    v_mfma_f32_16x16x32_bf16 v[76:79], v[156:159], a[196:199], v[76:79]
    ds_read_b128 v[172:175], v6 offset:1056
    s_waitcnt lgkmcnt(7)
    v_mfma_f32_16x16x32_bf16 v[48:51], v[160:163], a[0:3], v[48:51]
    v_alignbit_b32 v218, v205, v204, 16
    v_alignbit_b32 v219, v206, v205, 16
    s_waitcnt lgkmcnt(6)
    v_mfma_f32_16x16x32_bf16 v[64:67], v[164:167], a[0:3], v[64:67]
    ds_write_b128 v5, v[216:219] offset:15552
    s_waitcnt lgkmcnt(6)
    v_mfma_f32_16x16x32_bf16 v[52:55], v[160:163], a[64:67], v[52:55]
    v_alignbit_b32 v220, v202, v201, 16
    v_alignbit_b32 v221, v203, v202, 16
    v_mfma_f32_16x16x32_bf16 v[68:71], v[164:167], a[64:67], v[68:71]
    v_alignbit_b32 v222, v204, v203, 16
    v_alignbit_b32 v223, v205, v204, 16
    s_waitcnt lgkmcnt(5)
    v_mfma_f32_16x16x32_bf16 v[56:59], v[160:163], a[128:131], v[56:59]
    ds_read_b128 v[112:115], v6 offset:1088
    v_mfma_f32_16x16x32_bf16 v[72:75], v[164:167], a[128:131], v[72:75]
    ds_read_b128 v[116:119], v6 offset:1120
    s_waitcnt lgkmcnt(6)
    v_mfma_f32_16x16x32_bf16 v[60:63], v[160:163], a[192:195], v[60:63]
    ds_write_b128 v5, v[220:223] offset:23872
    v_mfma_f32_16x16x32_bf16 v[76:79], v[164:167], a[192:195], v[76:79]
    v_alignbit_b32 v224, v206, v205, 16
    v_alignbit_b32 v225, v207, v206, 16
    s_waitcnt lgkmcnt(5)
    v_mfma_f32_16x16x32_bf16 v[52:55], v[168:171], a[60:63], v[52:55]
    ds_write_b128 v5, v[222:225] offset:7232
    s_waitcnt lgkmcnt(5)
    v_mfma_f32_16x16x32_bf16 v[68:71], v[172:175], a[60:63], v[68:71]
    buffer_load_dwordx4 v[200:203], v4, s[28:31], s36 offen offset:3056
    v_mfma_f32_16x16x32_bf16 v[56:59], v[168:171], a[124:127], v[56:59]
    ds_read_b128 v[120:123], v6 offset:1152
    v_mfma_f32_16x16x32_bf16 v[72:75], v[172:175], a[124:127], v[72:75]
    ds_read_b128 v[124:127], v6 offset:1184
    v_mfma_f32_16x16x32_bf16 v[60:63], v[168:171], a[188:191], v[60:63]
    buffer_load_dwordx4 v[204:207], v4, s[28:31], s36 offen offset:3072
    v_mfma_f32_16x16x32_bf16 v[76:79], v[172:175], a[188:191], v[76:79]
    s_waitcnt vmcnt(10)
    s_mov_b64 exec, 1
    v_mov_b32 v176, 0
    v_mov_b32 v177, 0
    v_mov_b32 v178, 0
    v_mov_b32 v179, 0
    s_mov_b64 exec, -1
    s_waitcnt lgkmcnt(5)
    v_mfma_f32_16x16x32_bf16 v[52:55], v[112:115], a[56:59], v[52:55]
    ds_write_b128 v5, v[180:183] offset:0
    s_waitcnt lgkmcnt(5)
    v_mfma_f32_16x16x32_bf16 v[68:71], v[116:119], a[56:59], v[68:71]
    ds_write_b128 v5, v[178:181] offset:16640
    v_mfma_f32_16x16x32_bf16 v[56:59], v[112:115], a[120:123], v[56:59]
    ds_read_b128 v[128:131], v6 offset:1216
    v_mfma_f32_16x16x32_bf16 v[72:75], v[116:119], a[120:123], v[72:75]
    ds_read_b128 v[132:135], v6 offset:1248
    v_mfma_f32_16x16x32_bf16 v[60:63], v[112:115], a[184:187], v[60:63]
    v_mov_b32 v208, v177
    v_mov_b32 v209, v178
    v_mfma_f32_16x16x32_bf16 v[76:79], v[116:119], a[184:187], v[76:79]
    v_mov_b32 v210, v179
    v_mov_b32 v211, v180
    s_waitcnt lgkmcnt(5)
    v_mfma_f32_16x16x32_bf16 v[52:55], v[120:123], a[52:55], v[52:55]
    ds_write_b128 v5, v[208:211] offset:24960
    s_waitcnt lgkmcnt(5)
    v_mfma_f32_16x16x32_bf16 v[68:71], v[124:127], a[52:55], v[68:71]
    v_mov_b32 v212, v181
    v_mov_b32 v213, v182
    v_mfma_f32_16x16x32_bf16 v[56:59], v[120:123], a[116:119], v[56:59]
    ds_read_b128 v[136:139], v6 offset:1280
    v_mfma_f32_16x16x32_bf16 v[72:75], v[124:127], a[116:119], v[72:75]
    ds_read_b128 v[140:143], v6 offset:1312
    v_mfma_f32_16x16x32_bf16 v[60:63], v[120:123], a[180:183], v[60:63]
    ds_write_b128 v5, v[210:213] offset:8320
    v_mfma_f32_16x16x32_bf16 v[76:79], v[124:127], a[180:183], v[76:79]
    v_alignbit_b32 v214, v177, v176, 16
    v_alignbit_b32 v215, v178, v177, 16
    s_waitcnt lgkmcnt(5)
    v_mfma_f32_16x16x32_bf16 v[52:55], v[128:131], a[48:51], v[52:55]
    v_alignbit_b32 v216, v179, v178, 16
    v_alignbit_b32 v217, v180, v179, 16
    s_waitcnt lgkmcnt(4)
    v_mfma_f32_16x16x32_bf16 v[68:71], v[132:135], a[48:51], v[68:71]
    ds_write_b128 v5, v[214:217] offset:29120
    v_mfma_f32_16x16x32_bf16 v[56:59], v[128:131], a[112:115], v[56:59]
    ds_read_b128 v[144:147], v6 offset:1344
    v_mfma_f32_16x16x32_bf16 v[72:75], v[132:135], a[112:115], v[72:75]
    ds_read_b128 v[148:151], v6 offset:1376
    v_mfma_f32_16x16x32_bf16 v[60:63], v[128:131], a[176:179], v[60:63]
    v_alignbit_b32 v218, v181, v180, 16
    v_alignbit_b32 v219, v182, v181, 16
    v_mfma_f32_16x16x32_bf16 v[76:79], v[132:135], a[176:179], v[76:79]
    ds_write_b128 v5, v[216:219] offset:12480
    s_waitcnt lgkmcnt(6)
    v_mfma_f32_16x16x32_bf16 v[52:55], v[136:139], a[44:47], v[52:55]
    v_alignbit_b32 v220, v178, v177, 16
    v_alignbit_b32 v221, v179, v178, 16
    s_waitcnt lgkmcnt(5)
    v_mfma_f32_16x16x32_bf16 v[68:71], v[140:143], a[44:47], v[68:71]
    v_alignbit_b32 v222, v180, v179, 16
    v_alignbit_b32 v223, v181, v180, 16
    v_mfma_f32_16x16x32_bf16 v[56:59], v[136:139], a[108:111], v[56:59]
    ds_read_b128 v[152:155], v6 offset:1408
    v_mfma_f32_16x16x32_bf16 v[72:75], v[140:143], a[108:111], v[72:75]
    ds_read_b128 v[156:159], v6 offset:1440
    v_mfma_f32_16x16x32_bf16 v[60:63], v[136:139], a[172:175], v[60:63]
    ds_write_b128 v5, v[220:223] offset:20800
    v_mfma_f32_16x16x32_bf16 v[76:79], v[140:143], a[172:175], v[76:79]
    v_alignbit_b32 v224, v182, v181, 16
    v_alignbit_b32 v225, v183, v182, 16
    s_waitcnt lgkmcnt(5)
    v_mfma_f32_16x16x32_bf16 v[52:55], v[144:147], a[40:43], v[52:55]
    ds_write_b128 v5, v[222:225] offset:4160
    s_waitcnt lgkmcnt(5)
    v_mfma_f32_16x16x32_bf16 v[68:71], v[148:151], a[40:43], v[68:71]
    buffer_load_dwordx4 v[176:179], v230, s[28:31], s37 offen offset:0
    v_mfma_f32_16x16x32_bf16 v[56:59], v[144:147], a[104:107], v[56:59]
    ds_read_b128 v[160:163], v6 offset:1472
    v_mfma_f32_16x16x32_bf16 v[72:75], v[148:151], a[104:107], v[72:75]
    ds_read_b128 v[164:167], v6 offset:1504
    v_mfma_f32_16x16x32_bf16 v[60:63], v[144:147], a[168:171], v[60:63]
    buffer_load_dwordx4 v[180:183], v4, s[28:31], s37 offen offset:0
    v_mfma_f32_16x16x32_bf16 v[76:79], v[148:151], a[168:171], v[76:79]
    s_add_u32 m0, s35, 0
    s_waitcnt lgkmcnt(5)
    v_mfma_f32_16x16x32_bf16 v[52:55], v[152:155], a[36:39], v[52:55]
    buffer_load_dwordx4 v4, s[8:11], s39 offen offset:0 lds
    s_waitcnt lgkmcnt(4)
    v_mfma_f32_16x16x32_bf16 v[68:71], v[156:159], a[36:39], v[68:71]
    s_add_u32 m0, s35, 256
    v_mfma_f32_16x16x32_bf16 v[56:59], v[152:155], a[100:103], v[56:59]
    ds_read_b128 v[168:171], v6 offset:1536
    v_mfma_f32_16x16x32_bf16 v[72:75], v[156:159], a[100:103], v[72:75]
    ds_read_b128 v[172:175], v6 offset:1568
    v_mfma_f32_16x16x32_bf16 v[60:63], v[152:155], a[164:167], v[60:63]
    buffer_load_dwordx4 v4, s[8:11], s39 offen offset:1024 lds
    v_mfma_f32_16x16x32_bf16 v[76:79], v[156:159], a[164:167], v[76:79]
    s_add_u32 m0, s35, 512
    s_waitcnt lgkmcnt(3)
    v_mfma_f32_16x16x32_bf16 v[52:55], v[160:163], a[32:35], v[52:55]
    buffer_load_dwordx4 v4, s[8:11], s39 offen offset:2048 lds
    s_waitcnt lgkmcnt(2)
    v_mfma_f32_16x16x32_bf16 v[68:71], v[164:167], a[32:35], v[68:71]
    s_add_u32 m0, s35, 768
    v_mfma_f32_16x16x32_bf16 v[56:59], v[160:163], a[96:99], v[56:59]
    ds_read_b128 v[112:115], v6 offset:1600
    v_mfma_f32_16x16x32_bf16 v[72:75], v[164:167], a[96:99], v[72:75]
    ds_read_b128 v[116:119], v6 offset:1632
    v_mfma_f32_16x16x32_bf16 v[60:63], v[160:163], a[160:163], v[60:63]
    buffer_load_dwordx4 v4, s[8:11], s39 offen offset:3072 lds
    v_mfma_f32_16x16x32_bf16 v[76:79], v[164:167], a[160:163], v[76:79]
    s_waitcnt lgkmcnt(3)
    v_mfma_f32_16x16x32_bf16 v[52:55], v[168:171], a[28:31], v[52:55]
    s_waitcnt lgkmcnt(2)
    v_mfma_f32_16x16x32_bf16 v[68:71], v[172:175], a[28:31], v[68:71]
    v_mfma_f32_16x16x32_bf16 v[56:59], v[168:171], a[92:95], v[56:59]
    ds_read_b128 v[120:123], v6 offset:1664
    v_mfma_f32_16x16x32_bf16 v[72:75], v[172:175], a[92:95], v[72:75]
    ds_read_b128 v[124:127], v6 offset:1696
    v_mfma_f32_16x16x32_bf16 v[60:63], v[168:171], a[156:159], v[60:63]
    v_mfma_f32_16x16x32_bf16 v[76:79], v[172:175], a[156:159], v[76:79]
    s_waitcnt lgkmcnt(3)
    v_mfma_f32_16x16x32_bf16 v[52:55], v[112:115], a[24:27], v[52:55]
    s_waitcnt lgkmcnt(2)
    v_mfma_f32_16x16x32_bf16 v[68:71], v[116:119], a[24:27], v[68:71]
    v_mfma_f32_16x16x32_bf16 v[56:59], v[112:115], a[88:91], v[56:59]
    ds_read_b128 v[128:131], v6 offset:1728
    v_mfma_f32_16x16x32_bf16 v[72:75], v[116:119], a[88:91], v[72:75]
    ds_read_b128 v[132:135], v6 offset:1760
    v_mfma_f32_16x16x32_bf16 v[60:63], v[112:115], a[152:155], v[60:63]
    v_mfma_f32_16x16x32_bf16 v[76:79], v[116:119], a[152:155], v[76:79]
    s_waitcnt lgkmcnt(3)
    v_mfma_f32_16x16x32_bf16 v[52:55], v[120:123], a[20:23], v[52:55]
    s_waitcnt lgkmcnt(2)
    v_mfma_f32_16x16x32_bf16 v[68:71], v[124:127], a[20:23], v[68:71]
    v_mfma_f32_16x16x32_bf16 v[56:59], v[120:123], a[84:87], v[56:59]
    ds_read_b128 v[136:139], v6 offset:1792
    v_mfma_f32_16x16x32_bf16 v[72:75], v[124:127], a[84:87], v[72:75]
    ds_read_b128 v[140:143], v6 offset:1824
    v_mfma_f32_16x16x32_bf16 v[60:63], v[120:123], a[148:151], v[60:63]
    v_mfma_f32_16x16x32_bf16 v[76:79], v[124:127], a[148:151], v[76:79]
    s_waitcnt lgkmcnt(3)
    v_mfma_f32_16x16x32_bf16 v[52:55], v[128:131], a[16:19], v[52:55]
    s_waitcnt lgkmcnt(2)
    v_mfma_f32_16x16x32_bf16 v[68:71], v[132:135], a[16:19], v[68:71]
    v_mfma_f32_16x16x32_bf16 v[56:59], v[128:131], a[80:83], v[56:59]
    ds_read_b128 v[144:147], v6 offset:1856
    v_mfma_f32_16x16x32_bf16 v[72:75], v[132:135], a[80:83], v[72:75]
    ds_read_b128 v[148:151], v6 offset:1888
    v_mfma_f32_16x16x32_bf16 v[60:63], v[128:131], a[144:147], v[60:63]
    v_mfma_f32_16x16x32_bf16 v[76:79], v[132:135], a[144:147], v[76:79]
    s_waitcnt lgkmcnt(3)
    v_mfma_f32_16x16x32_bf16 v[52:55], v[136:139], a[12:15], v[52:55]
    s_waitcnt lgkmcnt(2)
    v_mfma_f32_16x16x32_bf16 v[68:71], v[140:143], a[12:15], v[68:71]
    v_mfma_f32_16x16x32_bf16 v[56:59], v[136:139], a[76:79], v[56:59]
    ds_read_b128 v[152:155], v6 offset:1920
    v_mfma_f32_16x16x32_bf16 v[72:75], v[140:143], a[76:79], v[72:75]
    ds_read_b128 v[156:159], v6 offset:1952
    v_mfma_f32_16x16x32_bf16 v[60:63], v[136:139], a[140:143], v[60:63]
    v_mfma_f32_16x16x32_bf16 v[76:79], v[140:143], a[140:143], v[76:79]
    s_waitcnt lgkmcnt(3)
    v_mfma_f32_16x16x32_bf16 v[52:55], v[144:147], a[8:11], v[52:55]
    s_waitcnt lgkmcnt(2)
    v_mfma_f32_16x16x32_bf16 v[68:71], v[148:151], a[8:11], v[68:71]
    v_mfma_f32_16x16x32_bf16 v[56:59], v[144:147], a[72:75], v[56:59]
    ds_read_b128 v[160:163], v6 offset:1984
    v_mfma_f32_16x16x32_bf16 v[72:75], v[148:151], a[72:75], v[72:75]
    ds_read_b128 v[164:167], v6 offset:2016
    v_mfma_f32_16x16x32_bf16 v[60:63], v[144:147], a[136:139], v[60:63]
    v_mfma_f32_16x16x32_bf16 v[76:79], v[148:151], a[136:139], v[76:79]
    s_waitcnt lgkmcnt(3)
    v_mfma_f32_16x16x32_bf16 v[52:55], v[152:155], a[4:7], v[52:55]
    s_waitcnt lgkmcnt(2)
    v_mfma_f32_16x16x32_bf16 v[68:71], v[156:159], a[4:7], v[68:71]
    v_mfma_f32_16x16x32_bf16 v[56:59], v[152:155], a[68:71], v[56:59]
    ds_read_b128 v[168:171], v6 offset:2048
    v_mfma_f32_16x16x32_bf16 v[72:75], v[156:159], a[68:71], v[72:75]
    ds_read_b128 v[172:175], v6 offset:2080
    v_mfma_f32_16x16x32_bf16 v[60:63], v[152:155], a[132:135], v[60:63]
    s_waitcnt vmcnt(10)
    v_mfma_f32_16x16x32_bf16 v[76:79], v[156:159], a[132:135], v[76:79]
    ds_write_b128 v5, v[188:191] offset:1024
    s_waitcnt lgkmcnt(4)
    v_mfma_f32_16x16x32_bf16 v[52:55], v[160:163], a[0:3], v[52:55]
    ds_read_b128 v[112:115], v6 offset:2112
    s_waitcnt lgkmcnt(4)
    v_mfma_f32_16x16x32_bf16 v[68:71], v[164:167], a[0:3], v[68:71]
    ds_read_b128 v[116:119], v6 offset:2144
    v_mfma_f32_16x16x32_bf16 v[56:59], v[160:163], a[64:67], v[56:59]
    ds_write_b128 v5, v[186:189] offset:17664
    v_mfma_f32_16x16x32_bf16 v[72:75], v[164:167], a[64:67], v[72:75]
    v_mov_b32 v208, v185
    v_mov_b32 v209, v186
    v_mfma_f32_16x16x32_bf16 v[60:63], v[160:163], a[128:131], v[60:63]
    ds_read_b128 v[120:123], v6 offset:2176
    v_mfma_f32_16x16x32_bf16 v[76:79], v[164:167], a[128:131], v[76:79]
    ds_read_b128 v[124:127], v6 offset:2208
    s_waitcnt lgkmcnt(7)
    v_mfma_f32_16x16x32_bf16 v[56:59], v[168:171], a[60:63], v[56:59]
    v_mov_b32 v210, v187
    v_mov_b32 v211, v188
    s_waitcnt lgkmcnt(6)
    v_mfma_f32_16x16x32_bf16 v[72:75], v[172:175], a[60:63], v[72:75]
    ds_write_b128 v5, v[208:211] offset:25984
    v_mfma_f32_16x16x32_bf16 v[60:63], v[168:171], a[124:127], v[60:63]
    ds_read_b128 v[128:131], v6 offset:2240
    v_mfma_f32_16x16x32_bf16 v[76:79], v[172:175], a[124:127], v[76:79]
    ds_read_b128 v[132:135], v6 offset:2272
    s_waitcnt lgkmcnt(7)
    v_mfma_f32_16x16x32_bf16 v[56:59], v[112:115], a[56:59], v[56:59]
    v_mov_b32 v212, v189
    v_mov_b32 v213, v190
    s_waitcnt lgkmcnt(6)
    v_mfma_f32_16x16x32_bf16 v[72:75], v[116:119], a[56:59], v[72:75]
    ds_write_b128 v5, v[210:213] offset:9344
    v_mfma_f32_16x16x32_bf16 v[60:63], v[112:115], a[120:123], v[60:63]
    ds_read_b128 v[136:139], v6 offset:2304
    v_mfma_f32_16x16x32_bf16 v[76:79], v[116:119], a[120:123], v[76:79]
    ds_read_b128 v[140:143], v6 offset:2336
    s_waitcnt lgkmcnt(7)
    v_mfma_f32_16x16x32_bf16 v[56:59], v[120:123], a[52:55], v[56:59]
    v_alignbit_b32 v214, v185, v184, 16
    v_alignbit_b32 v215, v186, v185, 16
    s_waitcnt lgkmcnt(6)
    v_mfma_f32_16x16x32_bf16 v[72:75], v[124:127], a[52:55], v[72:75]
    v_alignbit_b32 v216, v187, v186, 16
    v_alignbit_b32 v217, v188, v187, 16
    v_mfma_f32_16x16x32_bf16 v[60:63], v[120:123], a[116:119], v[60:63]
    ds_read_b128 v[144:147], v6 offset:2368
    v_mfma_f32_16x16x32_bf16 v[76:79], v[124:127], a[116:119], v[76:79]
    ds_read_b128 v[148:151], v6 offset:2400
    s_waitcnt lgkmcnt(6)
    v_mfma_f32_16x16x32_bf16 v[56:59], v[128:131], a[48:51], v[56:59]
    ds_write_b128 v5, v[214:217] offset:30144
    s_waitcnt lgkmcnt(6)
    v_mfma_f32_16x16x32_bf16 v[72:75], v[132:135], a[48:51], v[72:75]
    v_alignbit_b32 v218, v189, v188, 16
    v_alignbit_b32 v219, v190, v189, 16
    v_mfma_f32_16x16x32_bf16 v[60:63], v[128:131], a[112:115], v[60:63]
    ds_read_b128 v[152:155], v6 offset:2432
    v_mfma_f32_16x16x32_bf16 v[76:79], v[132:135], a[112:115], v[76:79]
    ds_read_b128 v[156:159], v6 offset:2464
    s_waitcnt lgkmcnt(6)
    v_mfma_f32_16x16x32_bf16 v[56:59], v[136:139], a[44:47], v[56:59]
    ds_write_b128 v5, v[216:219] offset:13504
    s_waitcnt lgkmcnt(6)
    v_mfma_f32_16x16x32_bf16 v[72:75], v[140:143], a[44:47], v[72:75]
    v_alignbit_b32 v220, v186, v185, 16
    v_alignbit_b32 v221, v187, v186, 16
    v_mfma_f32_16x16x32_bf16 v[60:63], v[136:139], a[108:111], v[60:63]
    ds_read_b128 v[160:163], v6 offset:2496
    v_mfma_f32_16x16x32_bf16 v[76:79], v[140:143], a[108:111], v[76:79]
    ds_read_b128 v[164:167], v6 offset:2528
    s_waitcnt lgkmcnt(7)
    v_mfma_f32_16x16x32_bf16 v[56:59], v[144:147], a[40:43], v[56:59]
    v_alignbit_b32 v222, v188, v187, 16
    v_alignbit_b32 v223, v189, v188, 16
    s_waitcnt lgkmcnt(6)
    v_mfma_f32_16x16x32_bf16 v[72:75], v[148:151], a[40:43], v[72:75]
    ds_write_b128 v5, v[220:223] offset:21824
    v_mfma_f32_16x16x32_bf16 v[60:63], v[144:147], a[104:107], v[60:63]
    ds_read_b128 v[168:171], v6 offset:2560
    v_mfma_f32_16x16x32_bf16 v[76:79], v[148:151], a[104:107], v[76:79]
    ds_read_b128 v[172:175], v6 offset:2592
    s_waitcnt lgkmcnt(7)
    v_mfma_f32_16x16x32_bf16 v[56:59], v[152:155], a[36:39], v[56:59]
    v_alignbit_b32 v224, v190, v189, 16
    v_alignbit_b32 v225, v191, v190, 16
    s_waitcnt lgkmcnt(6)
    v_mfma_f32_16x16x32_bf16 v[72:75], v[156:159], a[36:39], v[72:75]
    ds_write_b128 v5, v[222:225] offset:5184
    v_mfma_f32_16x16x32_bf16 v[60:63], v[152:155], a[100:103], v[60:63]
    ds_read_b128 v[112:115], v6 offset:2624
    v_mfma_f32_16x16x32_bf16 v[76:79], v[156:159], a[100:103], v[76:79]
    ds_read_b128 v[116:119], v6 offset:2656
    s_waitcnt lgkmcnt(7)
    v_mfma_f32_16x16x32_bf16 v[56:59], v[160:163], a[32:35], v[56:59]
    buffer_load_dwordx4 v[184:187], v4, s[28:31], s37 offen offset:1008
    s_waitcnt lgkmcnt(6)
    v_mfma_f32_16x16x32_bf16 v[72:75], v[164:167], a[32:35], v[72:75]
    buffer_load_dwordx4 v[188:191], v4, s[28:31], s37 offen offset:1024
    v_mfma_f32_16x16x32_bf16 v[60:63], v[160:163], a[96:99], v[60:63]
    ds_read_b128 v[120:123], v6 offset:2688
    v_mfma_f32_16x16x32_bf16 v[76:79], v[164:167], a[96:99], v[76:79]
    ds_read_b128 v[124:127], v6 offset:2720
    s_waitcnt lgkmcnt(6)
    v_mfma_f32_16x16x32_bf16 v[56:59], v[168:171], a[28:31], v[56:59]
    s_mov_b32 s36, s37
    s_add_u32 s39, s37, 125829120
    s_add_u32 s37, s37, 4096
    s_min_u32 s37, s37, s33

    s_pack_ll_b32_b16 s40, s65, s65
    s_mov_b32 s64, s65
    s_mov_b32 s65, s66
    s_mov_b32 s66, s67
    v_and_b32 v236, s40, v8
    s_waitcnt lgkmcnt(5)
    v_mfma_f32_16x16x32_bf16 v[72:75], v[172:175], a[28:31], v[72:75]
    v_and_b32 v237, s40, v9
    v_and_b32 v238, s40, v10
    v_mfma_f32_16x16x32_bf16 v[60:63], v[168:171], a[92:95], v[60:63]
    ds_read_b128 v[128:131], v6 offset:2752
    v_mfma_f32_16x16x32_bf16 v[76:79], v[172:175], a[92:95], v[76:79]
    ds_read_b128 v[132:135], v6 offset:2784
    s_waitcnt lgkmcnt(5)
    v_mfma_f32_16x16x32_bf16 v[56:59], v[112:115], a[24:27], v[56:59]
    v_and_b32 v239, s40, v11
    v_and_b32 v240, s40, v12
    s_waitcnt lgkmcnt(4)
    v_mfma_f32_16x16x32_bf16 v[72:75], v[116:119], a[24:27], v[72:75]
    v_and_b32 v241, s40, v13
    v_and_b32 v242, s40, v14
    v_mfma_f32_16x16x32_bf16 v[60:63], v[112:115], a[88:91], v[60:63]
    ds_read_b128 v[136:139], v6 offset:2816
    v_mfma_f32_16x16x32_bf16 v[76:79], v[116:119], a[88:91], v[76:79]
    ds_read_b128 v[140:143], v6 offset:2848
    s_waitcnt lgkmcnt(5)
    v_mfma_f32_16x16x32_bf16 v[56:59], v[120:123], a[20:23], v[56:59]
    v_and_b32 v243, s40, v15
    s_waitcnt lgkmcnt(4)
    v_mfma_f32_16x16x32_bf16 v[72:75], v[124:127], a[20:23], v[72:75]
    v_mfma_f32_16x16x32_bf16 v[60:63], v[120:123], a[84:87], v[60:63]
    ds_read_b128 v[144:147], v6 offset:2880
    v_mfma_f32_16x16x32_bf16 v[76:79], v[124:127], a[84:87], v[76:79]
    ds_read_b128 v[148:151], v6 offset:2912
    s_waitcnt lgkmcnt(5)
    v_mfma_f32_16x16x32_bf16 v[56:59], v[128:131], a[16:19], v[56:59]
    s_waitcnt lgkmcnt(4)
    v_mfma_f32_16x16x32_bf16 v[72:75], v[132:135], a[16:19], v[72:75]
    v_mfma_f32_16x16x32_bf16 v[60:63], v[128:131], a[80:83], v[60:63]
    ds_read_b128 v[152:155], v6 offset:2944
    v_mfma_f32_16x16x32_bf16 v[76:79], v[132:135], a[80:83], v[76:79]
    ds_read_b128 v[156:159], v6 offset:2976
    s_waitcnt lgkmcnt(5)
    v_mfma_f32_16x16x32_bf16 v[56:59], v[136:139], a[12:15], v[56:59]
    s_waitcnt lgkmcnt(4)
    v_mfma_f32_16x16x32_bf16 v[72:75], v[140:143], a[12:15], v[72:75]
    v_mfma_f32_16x16x32_bf16 v[60:63], v[136:139], a[76:79], v[60:63]
    ds_read_b128 v[160:163], v6 offset:3008
    v_mfma_f32_16x16x32_bf16 v[76:79], v[140:143], a[76:79], v[76:79]
    ds_read_b128 v[164:167], v6 offset:3040
    s_waitcnt lgkmcnt(5)
    v_mfma_f32_16x16x32_bf16 v[56:59], v[144:147], a[8:11], v[56:59]
    s_waitcnt lgkmcnt(4)
    v_mfma_f32_16x16x32_bf16 v[72:75], v[148:151], a[8:11], v[72:75]
    v_mfma_f32_16x16x32_bf16 v[60:63], v[144:147], a[72:75], v[60:63]
    ds_read_b128 v[168:171], v6 offset:3072
    v_mfma_f32_16x16x32_bf16 v[76:79], v[148:151], a[72:75], v[76:79]
    ds_read_b128 v[172:175], v6 offset:3104
    s_waitcnt lgkmcnt(5)
    v_mfma_f32_16x16x32_bf16 v[56:59], v[152:155], a[4:7], v[56:59]
    ds_read_b128 v[112:115], v6 offset:3136
    s_waitcnt lgkmcnt(5)
    v_mfma_f32_16x16x32_bf16 v[72:75], v[156:159], a[4:7], v[72:75]
    ds_read_b128 v[116:119], v6 offset:3168
    v_mfma_f32_16x16x32_bf16 v[60:63], v[152:155], a[68:71], v[60:63]
    ds_read_b128 v[120:123], v6 offset:3200
    v_mfma_f32_16x16x32_bf16 v[76:79], v[156:159], a[68:71], v[76:79]
    ds_read_b128 v[124:127], v6 offset:3232
    s_waitcnt lgkmcnt(7)
    v_mfma_f32_16x16x32_bf16 v[56:59], v[160:163], a[0:3], v[56:59]
    ds_read_b128 v[128:131], v6 offset:3264
    s_waitcnt lgkmcnt(7)
    v_mfma_f32_16x16x32_bf16 v[72:75], v[164:167], a[0:3], v[72:75]
    ds_read_b128 v[132:135], v6 offset:3296
    v_mfma_f32_16x16x32_bf16 v[60:63], v[160:163], a[64:67], v[60:63]
    ds_read_b128 v[136:139], v6 offset:3328
    v_mfma_f32_16x16x32_bf16 v[76:79], v[164:167], a[64:67], v[76:79]
    ds_read_b128 v[140:143], v6 offset:3360
    s_waitcnt lgkmcnt(9)
    v_mfma_f32_16x16x32_bf16 v[60:63], v[168:171], a[60:63], v[60:63]
    ds_read_b128 v[144:147], v6 offset:3392
    s_waitcnt lgkmcnt(9)
    v_mfma_f32_16x16x32_bf16 v[76:79], v[172:175], a[60:63], v[76:79]
    ds_read_b128 v[148:151], v6 offset:3424
    s_waitcnt lgkmcnt(9)
    v_mfma_f32_16x16x32_bf16 v[60:63], v[112:115], a[56:59], v[60:63]
    ds_read_b128 v[152:155], v6 offset:3456
    s_waitcnt lgkmcnt(9)
    v_mfma_f32_16x16x32_bf16 v[76:79], v[116:119], a[56:59], v[76:79]
    ds_read_b128 v[156:159], v6 offset:3488
    s_waitcnt lgkmcnt(9)
    v_mfma_f32_16x16x32_bf16 v[60:63], v[120:123], a[52:55], v[60:63]
    ds_read_b128 v[160:163], v6 offset:3520
    s_waitcnt lgkmcnt(9)
    v_mfma_f32_16x16x32_bf16 v[76:79], v[124:127], a[52:55], v[76:79]
    ds_read_b128 v[164:167], v6 offset:3552
    s_waitcnt lgkmcnt(9)
    v_mfma_f32_16x16x32_bf16 v[60:63], v[128:131], a[48:51], v[60:63]
    ds_read_b128 v[168:171], v6 offset:3584
    s_waitcnt lgkmcnt(9)
    v_mfma_f32_16x16x32_bf16 v[76:79], v[132:135], a[48:51], v[76:79]
    ds_read_b128 v[172:175], v6 offset:3616
    s_waitcnt lgkmcnt(9)
    v_mfma_f32_16x16x32_bf16 v[60:63], v[136:139], a[44:47], v[60:63]
    ds_read_b128 v[112:115], v6 offset:3648
    s_waitcnt lgkmcnt(9)
    v_mfma_f32_16x16x32_bf16 v[76:79], v[140:143], a[44:47], v[76:79]
    ds_read_b128 v[116:119], v6 offset:3680
    s_waitcnt lgkmcnt(9)
    v_mfma_f32_16x16x32_bf16 v[60:63], v[144:147], a[40:43], v[60:63]
    ds_read_b128 v[120:123], v6 offset:3712
    s_waitcnt lgkmcnt(9)
    v_mfma_f32_16x16x32_bf16 v[76:79], v[148:151], a[40:43], v[76:79]
    ds_read_b128 v[124:127], v6 offset:3744
    s_waitcnt lgkmcnt(9)
    v_mfma_f32_16x16x32_bf16 v[60:63], v[152:155], a[36:39], v[60:63]
    ds_read_b128 v[128:131], v6 offset:3776
    s_waitcnt lgkmcnt(9)
    v_mfma_f32_16x16x32_bf16 v[76:79], v[156:159], a[36:39], v[76:79]
    ds_read_b128 v[132:135], v6 offset:3808
    s_waitcnt lgkmcnt(9)
    v_mfma_f32_16x16x32_bf16 v[60:63], v[160:163], a[32:35], v[60:63]
    ds_read_b128 v[136:139], v6 offset:3840
    s_waitcnt lgkmcnt(9)
    v_mfma_f32_16x16x32_bf16 v[76:79], v[164:167], a[32:35], v[76:79]
    ds_read_b128 v[140:143], v6 offset:3872
    s_waitcnt lgkmcnt(9)
    v_mfma_f32_16x16x32_bf16 v[60:63], v[168:171], a[28:31], v[60:63]
    ds_read_b128 v[144:147], v6 offset:3904
    s_waitcnt lgkmcnt(9)
    v_mfma_f32_16x16x32_bf16 v[76:79], v[172:175], a[28:31], v[76:79]
    ds_read_b128 v[148:151], v6 offset:3936
    s_waitcnt lgkmcnt(9)
    v_mfma_f32_16x16x32_bf16 v[60:63], v[112:115], a[24:27], v[60:63]
    ds_read_b128 v[152:155], v6 offset:3968
    s_waitcnt lgkmcnt(9)
    v_mfma_f32_16x16x32_bf16 v[76:79], v[116:119], a[24:27], v[76:79]
    ds_read_b128 v[156:159], v6 offset:4000
    s_waitcnt lgkmcnt(9)
    v_mfma_f32_16x16x32_bf16 v[60:63], v[120:123], a[20:23], v[60:63]
    ds_read_b128 v[160:163], v6 offset:4032
    s_waitcnt lgkmcnt(9)
    v_mfma_f32_16x16x32_bf16 v[76:79], v[124:127], a[20:23], v[76:79]
    ds_read_b128 v[164:167], v6 offset:4064
    s_waitcnt lgkmcnt(9)
    v_mfma_f32_16x16x32_bf16 v[60:63], v[128:131], a[16:19], v[60:63]
    s_waitcnt vmcnt(2)
    ds_read_b128 a[60:63], v7 offset:240
    s_waitcnt lgkmcnt(9)
    v_mfma_f32_16x16x32_bf16 v[76:79], v[132:135], a[16:19], v[76:79]
    s_waitcnt lgkmcnt(8)
    v_mfma_f32_16x16x32_bf16 v[60:63], v[136:139], a[12:15], v[60:63]
    ds_read_b128 a[124:127], v7 offset:496
    s_waitcnt lgkmcnt(8)
    v_mfma_f32_16x16x32_bf16 v[76:79], v[140:143], a[12:15], v[76:79]
    s_waitcnt lgkmcnt(7)
    v_mfma_f32_16x16x32_bf16 v[60:63], v[144:147], a[8:11], v[60:63]
    ds_read_b128 a[188:191], v7 offset:752
    s_waitcnt lgkmcnt(7)
    v_mfma_f32_16x16x32_bf16 v[76:79], v[148:151], a[8:11], v[76:79]
    s_waitcnt lgkmcnt(6)
    v_mfma_f32_16x16x32_bf16 v[60:63], v[152:155], a[4:7], v[60:63]
    ds_read_b128 a[252:255], v7 offset:1008
    s_waitcnt lgkmcnt(6)
    v_mfma_f32_16x16x32_bf16 v[76:79], v[156:159], a[4:7], v[76:79]
    s_waitcnt lgkmcnt(5)
    v_mfma_f32_16x16x32_bf16 v[60:63], v[160:163], a[0:3], v[60:63]
    ds_read_b128 v[168:171], v6 offset:0
    s_waitcnt lgkmcnt(5)
    v_mfma_f32_16x16x32_bf16 v[76:79], v[164:167], a[0:3], v[76:79]
    ds_read_b128 v[172:175], v6 offset:32
    s_add_u32 s41, s38, 4096
    v_cvt_pk_bf16_f32 v80, v16, v48
    v_cvt_pk_bf16_f32 v81, v17, v49
    v_cvt_pk_bf16_f32 v82, v18, v50
    v_cvt_pk_bf16_f32 v83, v19, v51
    buffer_store_dwordx4 v[80:83], v228, s[8:11], s38 offen offset:0 sc1
    v_cvt_pk_bf16_f32 v84, v32, v64
    v_cvt_pk_bf16_f32 v85, v33, v65
    v_cvt_pk_bf16_f32 v86, v34, v66
    v_cvt_pk_bf16_f32 v87, v35, v67
    buffer_store_dwordx4 v[84:87], v228, s[8:11], s38 offen offset:64 sc1
    v_cvt_pk_bf16_f32 v88, v20, v52
    v_cvt_pk_bf16_f32 v89, v21, v53
    v_cvt_pk_bf16_f32 v90, v22, v54
    v_cvt_pk_bf16_f32 v91, v23, v55
    buffer_store_dwordx4 v[88:91], v228, s[8:11], s38 offen offset:2048 sc1
    v_cvt_pk_bf16_f32 v92, v36, v68
    v_cvt_pk_bf16_f32 v93, v37, v69
    v_cvt_pk_bf16_f32 v94, v38, v70
    v_cvt_pk_bf16_f32 v95, v39, v71
    buffer_store_dwordx4 v[92:95], v228, s[8:11], s38 offen offset:2112 sc1
    v_cvt_pk_bf16_f32 v96, v24, v56
    v_cvt_pk_bf16_f32 v97, v25, v57
    v_cvt_pk_bf16_f32 v98, v26, v58
    v_cvt_pk_bf16_f32 v99, v27, v59
    buffer_store_dwordx4 v[96:99], v228, s[8:11], s41 offen offset:0 sc1
    v_cvt_pk_bf16_f32 v100, v40, v72
    v_cvt_pk_bf16_f32 v101, v41, v73
    v_cvt_pk_bf16_f32 v102, v42, v74
    v_cvt_pk_bf16_f32 v103, v43, v75
    buffer_store_dwordx4 v[100:103], v228, s[8:11], s41 offen offset:64 sc1
    v_cvt_pk_bf16_f32 v104, v28, v60
    v_cvt_pk_bf16_f32 v105, v29, v61
    v_cvt_pk_bf16_f32 v106, v30, v62
    v_cvt_pk_bf16_f32 v107, v31, v63
    buffer_store_dwordx4 v[104:107], v228, s[8:11], s41 offen offset:2048 sc1
    v_cvt_pk_bf16_f32 v108, v44, v76
    v_cvt_pk_bf16_f32 v109, v45, v77
    v_cvt_pk_bf16_f32 v110, v46, v78
    v_cvt_pk_bf16_f32 v111, v47, v79
    buffer_store_dwordx4 v[108:111], v228, s[8:11], s41 offen offset:2112 sc1
    s_add_u32 s38, s38, 8192
    s_add_u32 s42, s42, 1
    s_cmp_lt_u32 s42, 4
    s_cbranch_scc1 .cvl_433

    s_waitcnt vmcnt(0) lgkmcnt(0)
    s_barrier
    s_mov_b32 s5, 160
    s_cmp_lg_u32 s24, 0
    s_cbranch_scc1 .sg_434
    s_mov_b64 exec, 1
    v_mov_b32 v4, 1
    v_mov_b32 v5, 0
    buffer_atomic_add v4, v5, s[20:23], s5 offen sc1
    s_mov_b64 exec, -1

.sg_434:
    v_and_b32 v1, 63, v0
    v_and_b32 v2, 15, v1
    v_lshrrev_b32 v3, 4, v1

    s_sub_u32 s4, s26, 24
    s_lshr_b32 s25, s4, 1
    s_and_b32 s4, s4, 1
    s_lshl_b32 s4, s4, 2
    s_lshl_b32 s5, s91, 3
    s_add_u32 s4, s4, s5
    s_add_u32 s26, s4, s24
    s_lshl_b32 s35, s26, 8
    s_add_u32 s35, s35, 92274688
    s_mov_b32 s37, 0x3db504f3
    s_mov_b32 s38, 0x3fb8aa3b
    v_lshlrev_b32 v8, 4, v1
    v_min_u32 v9, 2, v1
    v_lshlrev_b32 v9, 13, v9
    v_lshlrev_b32 v6, 4, v3
    v_and_b32 v5, 7, v2
    v_add_u32 v10, v6, v5
    v_lshlrev_b32 v10, 4, v10
    v_lshlrev_b32 v11, 4, v2
    v_lshlrev_b32 v5, 3, v3
    v_add_u32 v11, v11, v5
    v_cmp_gt_u32 s[60:61], 32, v1
    v_lshlrev_b32 v5, 2, v3
    v_mov_b32 v12, 0
    v_mov_b32 v13, 0
    v_mov_b32 v14, 0xff800000
    v_lshlrev_b32 v204, 9, v1
    v_add_u32 v204, 4604, v204
    s_lshl_b32 s4, s25, 5
    s_add_u32 s4, s4, s26
    s_lshl_b32 s27, s4, 13
    s_mul_i32 s33, s4, 6144
    s_add_u32 s33, s33, 67108864
    s_add_u32 s36, s25, 1

    v_add_u32 v7, 0, v5
    v_cmp_le_u32 s[40:41], v7, v2
    v_add_u32 v7, 1, v5
    v_cmp_le_u32 s[42:43], v7, v2
    v_add_u32 v7, 2, v5
    v_cmp_le_u32 s[44:45], v7, v2
    v_add_u32 v7, 3, v5
    v_cmp_le_u32 s[46:47], v7, v2
    v_mov_b32 v112, 0
    v_mov_b32 v113, 0
    v_mov_b32 v114, 0
    v_mov_b32 v115, 0
    v_mov_b32 v116, 0
    v_mov_b32 v117, 0
    v_mov_b32 v118, 0
    v_mov_b32 v119, 0
    v_mov_b32 v120, 0
    v_mov_b32 v121, 0
    v_mov_b32 v122, 0
    v_mov_b32 v123, 0
    v_mov_b32 v124, 0
    v_mov_b32 v125, 0
    v_mov_b32 v126, 0
    v_mov_b32 v127, 0
    v_mov_b32 v128, 0
    v_mov_b32 v129, 0
    v_mov_b32 v130, 0
    v_mov_b32 v131, 0
    v_mov_b32 v132, 0
    v_mov_b32 v133, 0
    v_mov_b32 v134, 0
    v_mov_b32 v135, 0
    v_mov_b32 v136, 0
    v_mov_b32 v137, 0
    v_mov_b32 v138, 0
    v_mov_b32 v139, 0
    v_mov_b32 v140, 0
    v_mov_b32 v141, 0
    v_mov_b32 v142, 0
    v_mov_b32 v143, 0
    s_bitcmp1_b32 s97, 4
    s_cselect_b32 s96, 999, 64
    v_mov_b32 v15, -1
    s_mov_b32 s62, 0
    s_mov_b64 exec, 7
.wf_435:
    buffer_load_dword v15, v9, s[8:11], s35 offen sc1
    s_waitcnt vmcnt(0)
    v_cmp_gt_u32 vcc, s36, v15
    s_cbranch_vccz .wfd_436
    s_sleep 2
    s_add_u32 s62, s62, 1
    s_cmp_gt_u32 s62, 0x400000
    s_cbranch_scc1 .mg_end_1
    s_branch .wf_435

.wfd_436:
    s_mov_b64 exec, -1
    s_add_u32 s28, s27, 4096
    s_add_u32 s29, s27, 16777216
    s_add_u32 s30, s27, 16781312
    s_add_u32 s31, s27, 33554432
    s_add_u32 s32, s27, 33558528

    buffer_load_dwordx4 a[0:3], v8, s[8:11], s27 offen offset:0
    buffer_load_dwordx4 a[16:19], v8, s[8:11], s28 offen offset:0
    buffer_load_dwordx4 a[32:35], v8, s[8:11], s29 offen offset:0
    buffer_load_dwordx4 a[48:51], v8, s[8:11], s30 offen offset:0
    buffer_load_dwordx4 a[4:7], v8, s[8:11], s27 offen offset:1024
    buffer_load_dwordx4 a[20:23], v8, s[8:11], s28 offen offset:1024
    buffer_load_dwordx4 a[36:39], v8, s[8:11], s29 offen offset:1024
    buffer_load_dwordx4 a[52:55], v8, s[8:11], s30 offen offset:1024
    buffer_load_dwordx4 a[8:11], v8, s[8:11], s27 offen offset:2048
    buffer_load_dwordx4 a[24:27], v8, s[8:11], s28 offen offset:2048
    buffer_load_dwordx4 a[40:43], v8, s[8:11], s29 offen offset:2048
    buffer_load_dwordx4 a[56:59], v8, s[8:11], s30 offen offset:2048
    buffer_load_dwordx4 a[12:15], v8, s[8:11], s27 offen offset:3072
    buffer_load_dwordx4 a[28:31], v8, s[8:11], s28 offen offset:3072
    buffer_load_dwordx4 a[44:47], v8, s[8:11], s29 offen offset:3072
    buffer_load_dwordx4 a[60:63], v8, s[8:11], s30 offen offset:3072
    buffer_load_dwordx4 a[64:67], v8, s[8:11], s31 offen offset:0
    buffer_load_dwordx4 a[68:71], v8, s[8:11], s31 offen offset:1024
    buffer_load_dwordx4 a[72:75], v8, s[8:11], s31 offen offset:2048
    buffer_load_dwordx4 a[76:79], v8, s[8:11], s31 offen offset:3072
    buffer_load_dwordx4 a[80:83], v8, s[8:11], s32 offen offset:0
    buffer_load_dwordx4 a[84:87], v8, s[8:11], s32 offen offset:1024
    buffer_load_dwordx4 a[88:91], v8, s[8:11], s32 offen offset:2048
    buffer_load_dwordx4 a[92:95], v8, s[8:11], s32 offen offset:3072
    buffer_load_dwordx4 v[80:83], v10, s[8:11], s33 offen offset:2048 sc1
    buffer_load_dwordx4 v[84:87], v10, s[8:11], s33 offen offset:2176 sc1
    buffer_load_dwordx4 v[88:91], v10, s[8:11], s33 offen offset:3072 sc1
    buffer_load_dwordx4 v[92:95], v10, s[8:11], s33 offen offset:3200 sc1
    s_add_u32 s4, s33, 4096
    s_mov_b64 exec, s[60:61]
    buffer_load_dwordx2 v[128:129], v11, s[8:11], s4 offen offset:0 sc1
    buffer_load_dwordx2 v[130:131], v11, s[8:11], s4 offen offset:256 sc1
    buffer_load_dwordx2 v[132:133], v11, s[8:11], s4 offen offset:512 sc1
    buffer_load_dwordx2 v[134:135], v11, s[8:11], s4 offen offset:768 sc1
    buffer_load_dwordx2 v[136:137], v11, s[8:11], s4 offen offset:1024 sc1
    buffer_load_dwordx2 v[138:139], v11, s[8:11], s4 offen offset:1280 sc1
    buffer_load_dwordx2 v[140:141], v11, s[8:11], s4 offen offset:1536 sc1
    buffer_load_dwordx2 v[142:143], v11, s[8:11], s4 offen offset:1792 sc1
    s_mov_b64 exec, -1
    s_waitcnt vmcnt(0)
.att_437:
    s_mov_b32 s34, s33
    s_add_u32 s50, s27, 0
    s_add_u32 s51, s27, 4096
    s_cmp_lt_u32 s25, 60
    s_cselect_b32 s4, 4, 0
    s_cselect_b32 s5, 1048576, 0
    s_cselect_b32 s6, 786432, 0
    s_add_u32 s36, s36, s4
    s_add_u32 s27, s27, s5
    s_add_u32 s33, s33, s6
    s_waitcnt vmcnt(8)

    v_cmp_gt_u32 vcc, s36, v15
    s_cbranch_vccnz .atw_438
.atb_439:
    s_add_u32 s28, s27, 4096
    s_add_u32 s29, s27, 16777216
    s_add_u32 s30, s27, 16781312
    s_add_u32 s31, s27, 33554432
    s_add_u32 s32, s27, 33558528

    buffer_load_dwordx4 a[96:99], v8, s[8:11], s27 offen offset:0
    buffer_load_dwordx4 a[112:115], v8, s[8:11], s28 offen offset:0
    buffer_load_dwordx4 a[128:131], v8, s[8:11], s29 offen offset:0
    buffer_load_dwordx4 a[144:147], v8, s[8:11], s30 offen offset:0
    buffer_load_dwordx4 a[100:103], v8, s[8:11], s27 offen offset:1024
    buffer_load_dwordx4 a[116:119], v8, s[8:11], s28 offen offset:1024
    buffer_load_dwordx4 a[132:135], v8, s[8:11], s29 offen offset:1024
    buffer_load_dwordx4 a[148:151], v8, s[8:11], s30 offen offset:1024
    buffer_load_dwordx4 a[104:107], v8, s[8:11], s27 offen offset:2048
    buffer_load_dwordx4 a[120:123], v8, s[8:11], s28 offen offset:2048
    buffer_load_dwordx4 a[136:139], v8, s[8:11], s29 offen offset:2048
    buffer_load_dwordx4 a[152:155], v8, s[8:11], s30 offen offset:2048
    buffer_load_dwordx4 a[108:111], v8, s[8:11], s27 offen offset:3072
    buffer_load_dwordx4 a[124:127], v8, s[8:11], s28 offen offset:3072
    buffer_load_dwordx4 a[140:143], v8, s[8:11], s29 offen offset:3072
    buffer_load_dwordx4 a[156:159], v8, s[8:11], s30 offen offset:3072
    buffer_load_dwordx4 a[160:163], v8, s[8:11], s31 offen offset:0
    buffer_load_dwordx4 a[164:167], v8, s[8:11], s31 offen offset:1024
    buffer_load_dwordx4 a[168:171], v8, s[8:11], s31 offen offset:2048
    buffer_load_dwordx4 a[172:175], v8, s[8:11], s31 offen offset:3072
    buffer_load_dwordx4 a[176:179], v8, s[8:11], s32 offen offset:0
    buffer_load_dwordx4 a[180:183], v8, s[8:11], s32 offen offset:1024
    buffer_load_dwordx4 a[184:187], v8, s[8:11], s32 offen offset:2048
    buffer_load_dwordx4 a[188:191], v8, s[8:11], s32 offen offset:3072
    buffer_load_dwordx4 v[96:99], v10, s[8:11], s33 offen offset:2048 sc1
    buffer_load_dwordx4 v[100:103], v10, s[8:11], s33 offen offset:2176 sc1
    buffer_load_dwordx4 v[104:107], v10, s[8:11], s33 offen offset:3072 sc1
    buffer_load_dwordx4 v[108:111], v10, s[8:11], s33 offen offset:3200 sc1
    s_add_u32 s4, s33, 4096
    s_mov_b64 exec, s[60:61]
    buffer_load_dwordx2 v[112:113], v11, s[8:11], s4 offen offset:0 sc1
    buffer_load_dwordx2 v[114:115], v11, s[8:11], s4 offen offset:256 sc1
    buffer_load_dwordx2 v[116:117], v11, s[8:11], s4 offen offset:512 sc1
    buffer_load_dwordx2 v[118:119], v11, s[8:11], s4 offen offset:768 sc1
    buffer_load_dwordx2 v[120:121], v11, s[8:11], s4 offen offset:1024 sc1
    buffer_load_dwordx2 v[122:123], v11, s[8:11], s4 offen offset:1280 sc1
    buffer_load_dwordx2 v[124:125], v11, s[8:11], s4 offen offset:1536 sc1
    buffer_load_dwordx2 v[126:127], v11, s[8:11], s4 offen offset:1792 sc1
    s_mov_b64 exec, -1
    v_mfma_f32_16x16x32_bf16 v[144:147], a[32:35], a[0:3], 0
    v_mfma_f32_16x16x32_bf16 v[156:159], a[32:35], a[16:19], 0
    v_mfma_f32_16x16x32_bf16 v[160:163], a[48:51], a[16:19], 0
    v_mfma_f32_16x16x32_bf16 v[144:147], a[36:39], a[4:7], v[144:147]
    v_mfma_f32_16x16x32_bf16 v[156:159], a[36:39], a[20:23], v[156:159]
    v_mfma_f32_16x16x32_bf16 v[160:163], a[52:55], a[20:23], v[160:163]
    v_mfma_f32_16x16x32_bf16 v[144:147], a[40:43], a[8:11], v[144:147]
    v_mfma_f32_16x16x32_bf16 v[156:159], a[40:43], a[24:27], v[156:159]
    v_mfma_f32_16x16x32_bf16 v[160:163], a[56:59], a[24:27], v[160:163]
    v_mfma_f32_16x16x32_bf16 v[144:147], a[44:47], a[12:15], v[144:147]
    v_mfma_f32_16x16x32_bf16 v[156:159], a[44:47], a[28:31], v[156:159]
    v_mfma_f32_16x16x32_bf16 v[160:163], a[60:63], a[28:31], v[160:163]
    s_nop 7
    v_cvt_pk_bf16_f32 v168, v144, v145
    v_cvt_pk_bf16_f32 v170, v146, v147
    v_and_b32 v169, 0xffff0000, v168
    v_lshlrev_b32 v168, 16, v168
    v_and_b32 v171, 0xffff0000, v170
    v_lshlrev_b32 v170, 16, v170
    v_mul_f32 v168, s37, v168
    v_mul_f32 v169, s37, v169
    v_mul_f32 v170, s37, v170
    v_mul_f32 v171, s37, v171
    v_cvt_pk_bf16_f32 v144, v168, v169
    v_cvt_pk_bf16_f32 v146, v170, v171
    v_and_b32 v145, 0xffff0000, v144
    v_lshlrev_b32 v144, 16, v144
    v_and_b32 v147, 0xffff0000, v146
    v_lshlrev_b32 v146, 16, v146
    v_cvt_pk_bf16_f32 v192, v156, v157
    v_cvt_pk_bf16_f32 v194, v158, v159
    v_cvt_pk_bf16_f32 v196, v160, v161
    v_cvt_pk_bf16_f32 v198, v162, v163
    v_and_b32 v193, 0xffff0000, v192
    v_lshlrev_b32 v192, 16, v192
    v_and_b32 v195, 0xffff0000, v194
    v_lshlrev_b32 v194, 16, v194
    v_and_b32 v197, 0xffff0000, v196
    v_lshlrev_b32 v196, 16, v196
    v_and_b32 v199, 0xffff0000, v198
    v_lshlrev_b32 v198, 16, v198
    v_mul_f32 v192, s37, v192
    v_mul_f32 v193, s37, v193
    v_mul_f32 v194, s37, v194
    v_mul_f32 v195, s37, v195
    v_mul_f32 v196, s37, v196
    v_mul_f32 v197, s37, v197
    v_mul_f32 v198, s37, v198
    v_mul_f32 v199, s37, v199
    v_cvt_pk_bf16_f32 v156, v192, v193
    v_cvt_pk_bf16_f32 v158, v194, v195
    v_cvt_pk_bf16_f32 v160, v196, v197
    v_cvt_pk_bf16_f32 v162, v198, v199
    v_and_b32 v157, 0xffff0000, v156
    v_lshlrev_b32 v156, 16, v156
    v_and_b32 v159, 0xffff0000, v158
    v_lshlrev_b32 v158, 16, v158
    v_and_b32 v161, 0xffff0000, v160
    v_lshlrev_b32 v160, 16, v160
    v_and_b32 v163, 0xffff0000, v162
    v_lshlrev_b32 v162, 16, v162
    v_cndmask_b32 v144, v14, v144, s[40:41]
    v_cndmask_b32 v145, v14, v145, s[42:43]
    v_cndmask_b32 v146, v14, v146, s[44:45]
    v_cndmask_b32 v147, v14, v147, s[46:47]
    v_cndmask_b32 v160, v14, v160, s[40:41]
    v_cndmask_b32 v161, v14, v161, s[42:43]
    v_cndmask_b32 v162, v14, v162, s[44:45]
    v_cndmask_b32 v163, v14, v163, s[46:47]
    s_mov_b32 s62, 0
.kmp_440:
    v_max3_u32 v4, v80, v81, v82
    v_max3_u32 v5, v83, v84, v85
    v_max3_u32 v4, v4, v86, v87
    v_max3_u32 v5, v5, v88, v89
    v_max3_u32 v4, v4, v90, v91
    v_max3_u32 v5, v5, v92, v93
    v_max3_u32 v4, v4, v94, v95
    v_max3_u32 v5, v5, v128, v129
    v_max3_u32 v4, v4, v130, v131
    v_max3_u32 v5, v5, v132, v133
    v_max3_u32 v4, v4, v134, v135
    v_max3_u32 v5, v5, v136, v137
    v_max3_u32 v4, v4, v138, v139
    v_max3_u32 v5, v5, v140, v141
    v_max3_u32 v4, v4, v142, v143
    v_max_u32 v4, v4, v5
    v_cmp_eq_u32 vcc, -1, v4
    s_cbranch_vccnz .kmf_441

    v_mfma_f32_16x16x32_bf16 v[152:155], v[80:83], a[0:3], 0
    v_mfma_f32_16x16x32_bf16 v[164:167], v[80:83], a[16:19], 0
    v_mfma_f32_16x16x32_bf16 v[152:155], v[84:87], a[4:7], v[152:155]
    v_mfma_f32_16x16x32_bf16 v[164:167], v[84:87], a[20:23], v[164:167]
    v_mfma_f32_16x16x32_bf16 v[152:155], v[88:91], a[8:11], v[152:155]
    v_mfma_f32_16x16x32_bf16 v[164:167], v[88:91], a[24:27], v[164:167]
    v_mfma_f32_16x16x32_bf16 v[152:155], v[92:95], a[12:15], v[152:155]
    v_mfma_f32_16x16x32_bf16 v[164:167], v[92:95], a[28:31], v[164:167]
    s_nop 5
    v_cvt_pk_bf16_f32 v176, v152, v153
    v_cvt_pk_bf16_f32 v178, v154, v155
    v_and_b32 v177, 0xffff0000, v176
    v_lshlrev_b32 v176, 16, v176
    v_and_b32 v179, 0xffff0000, v178
    v_lshlrev_b32 v178, 16, v178
    v_mul_f32 v176, s37, v176
    v_mul_f32 v177, s37, v177
    v_mul_f32 v178, s37, v178
    v_mul_f32 v179, s37, v179
    v_cvt_pk_bf16_f32 v152, v176, v177
    v_cvt_pk_bf16_f32 v154, v178, v179
    v_and_b32 v153, 0xffff0000, v152
    v_lshlrev_b32 v152, 16, v152
    v_and_b32 v155, 0xffff0000, v154
    v_lshlrev_b32 v154, 16, v154
    v_cndmask_b32 v152, v14, v152, s[60:61]
    v_cndmask_b32 v153, v14, v153, s[60:61]
    v_cndmask_b32 v154, v14, v154, s[60:61]
    v_cndmask_b32 v155, v14, v155, s[60:61]
    v_cvt_pk_bf16_f32 v200, v164, v165
    v_cvt_pk_bf16_f32 v202, v166, v167
    v_and_b32 v201, 0xffff0000, v200
    v_lshlrev_b32 v200, 16, v200
    v_and_b32 v203, 0xffff0000, v202
    v_lshlrev_b32 v202, 16, v202
    v_mul_f32 v200, s37, v200
    v_mul_f32 v201, s37, v201
    v_mul_f32 v202, s37, v202
    v_mul_f32 v203, s37, v203
    v_cvt_pk_bf16_f32 v164, v200, v201
    v_cvt_pk_bf16_f32 v166, v202, v203
    v_and_b32 v165, 0xffff0000, v164
    v_lshlrev_b32 v164, 16, v164
    v_and_b32 v167, 0xffff0000, v166
    v_lshlrev_b32 v166, 16, v166
    v_cndmask_b32 v164, v14, v164, s[60:61]
    v_cndmask_b32 v165, v14, v165, s[60:61]
    v_cndmask_b32 v166, v14, v166, s[60:61]
    v_cndmask_b32 v167, v14, v167, s[60:61]
    v_max3_f32 v4, v144, v145, v146
    v_max3_f32 v5, v147, v152, v153
    v_max3_f32 v4, v4, v154, v155
    v_max_f32 v4, v4, v5

    v_max3_f32 v6, v156, v157, v158
    v_max3_f32 v7, v159, v160, v161
    v_max3_f32 v6, v6, v162, v163
    v_max3_f32 v7, v7, v164, v165
    v_max3_f32 v6, v6, v166, v167
    v_max_f32 v6, v6, v7

    v_mov_b32 v5, v4
    v_mov_b32 v7, v6
    s_nop 0
    v_permlane32_swap_b32 v4, v5
    v_permlane32_swap_b32 v6, v7
    v_max_f32 v4, v4, v5
    v_max_f32 v6, v6, v7

    v_mov_b32 v5, v4
    v_mov_b32 v7, v6
    s_nop 0
    v_permlane16_swap_b32 v4, v5
    v_permlane16_swap_b32 v6, v7
    v_max_f32 v4, v4, v5
    v_max_f32 v6, v6, v7

    v_mul_f32 v4, s38, v4
    v_mul_f32 v6, s38, v6
    v_fma_f32 v168, v144, s38, -v4
    v_fma_f32 v169, v145, s38, -v4
    v_fma_f32 v170, v146, s38, -v4
    v_fma_f32 v171, v147, s38, -v4
    v_fma_f32 v176, v152, s38, -v4
    v_fma_f32 v177, v153, s38, -v4
    v_fma_f32 v178, v154, s38, -v4
    v_fma_f32 v179, v155, s38, -v4
    v_fma_f32 v192, v156, s38, -v6
    v_fma_f32 v193, v157, s38, -v6
    v_fma_f32 v194, v158, s38, -v6
    v_fma_f32 v195, v159, s38, -v6
    v_fma_f32 v196, v160, s38, -v6
    v_fma_f32 v197, v161, s38, -v6
    v_fma_f32 v198, v162, s38, -v6
    v_fma_f32 v199, v163, s38, -v6
    v_fma_f32 v200, v164, s38, -v6
    v_fma_f32 v201, v165, s38, -v6
    v_fma_f32 v202, v166, s38, -v6
    v_fma_f32 v203, v167, s38, -v6
    v_exp_f32 v168, v168
    v_exp_f32 v169, v169
    v_exp_f32 v170, v170
    v_exp_f32 v171, v171
    v_exp_f32 v176, v176
    v_exp_f32 v177, v177
    v_exp_f32 v178, v178
    v_exp_f32 v179, v179
    v_exp_f32 v192, v192
    v_exp_f32 v193, v193
    v_exp_f32 v194, v194
    v_exp_f32 v195, v195
    v_exp_f32 v196, v196
    v_exp_f32 v197, v197
    v_exp_f32 v198, v198
    v_exp_f32 v199, v199
    v_exp_f32 v200, v200
    v_exp_f32 v201, v201
    v_exp_f32 v202, v202
    v_exp_f32 v203, v203
    v_add_f32 v4, v168, v169
    v_add_f32 v5, v170, v171
    v_add_f32 v4, v4, v176
    v_add_f32 v5, v5, v177
    v_add_f32 v4, v4, v178
    v_add_f32 v5, v5, v179
    v_add_f32 v4, v4, v5
    v_add_f32 v6, v192, v193
    v_add_f32 v7, v194, v195
    v_add_f32 v6, v6, v196
    v_add_f32 v7, v7, v197
    v_add_f32 v6, v6, v198
    v_add_f32 v7, v7, v199
    v_add_f32 v6, v6, v200
    v_add_f32 v7, v7, v201
    v_add_f32 v6, v6, v202
    v_add_f32 v7, v7, v203
    v_add_f32 v6, v6, v7
    v_mov_b32 v5, v4
    v_mov_b32 v7, v6
    s_nop 0
    v_permlane32_swap_b32 v4, v5
    v_permlane32_swap_b32 v6, v7
    v_add_f32 v4, v4, v5
    v_add_f32 v6, v6, v7

    v_mov_b32 v5, v4
    v_mov_b32 v7, v6
    s_nop 0
    v_permlane16_swap_b32 v4, v5
    v_permlane16_swap_b32 v6, v7
    v_add_f32 v4, v4, v5
    v_add_f32 v6, v6, v7

    v_rcp_f32 v4, v4
    v_rcp_f32 v6, v6
    v_mov_b32 v182, 0
    v_mov_b32 v183, 0
    v_mul_f32 v168, v4, v168
    v_mul_f32 v169, v4, v169
    v_mul_f32 v170, v4, v170
    v_mul_f32 v171, v4, v171
    v_mul_f32 v176, v4, v176
    v_mul_f32 v177, v4, v177
    v_mul_f32 v178, v4, v178
    v_mul_f32 v179, v4, v179
    v_cvt_pk_bf16_f32 v180, v168, v169
    v_cvt_pk_bf16_f32 v181, v170, v171
    v_cvt_pk_bf16_f32 v184, v176, v177
    v_cvt_pk_bf16_f32 v185, v178, v179
    v_mul_f32 v192, v6, v192
    v_mul_f32 v193, v6, v193
    v_mul_f32 v194, v6, v194
    v_mul_f32 v195, v6, v195
    v_mul_f32 v196, v6, v196
    v_mul_f32 v197, v6, v197
    v_mul_f32 v198, v6, v198
    v_mul_f32 v199, v6, v199
    v_mul_f32 v200, v6, v200
    v_mul_f32 v201, v6, v201
    v_mul_f32 v202, v6, v202
    v_mul_f32 v203, v6, v203
    v_cvt_pk_bf16_f32 v186, v192, v193
    v_cvt_pk_bf16_f32 v187, v194, v195
    v_cvt_pk_bf16_f32 v188, v196, v197
    v_cvt_pk_bf16_f32 v189, v198, v199
    v_cvt_pk_bf16_f32 v190, v200, v201
    v_cvt_pk_bf16_f32 v191, v202, v203
    s_add_u32 s25, s25, 4

    v_mfma_f32_16x16x32_bf16 v[16:19], a[64:67], v[180:183], 0
    v_mfma_f32_16x16x32_bf16 v[20:23], a[68:71], v[180:183], 0
    v_mfma_f32_16x16x32_bf16 v[24:27], a[72:75], v[180:183], 0
    v_mfma_f32_16x16x32_bf16 v[28:31], a[76:79], v[180:183], 0
    v_mfma_f32_16x16x32_bf16 v[32:35], a[80:83], v[180:183], 0
    v_mfma_f32_16x16x32_bf16 v[36:39], a[84:87], v[180:183], 0
    v_mfma_f32_16x16x32_bf16 v[40:43], a[88:91], v[180:183], 0
    v_mfma_f32_16x16x32_bf16 v[44:47], a[92:95], v[180:183], 0
    v_mfma_f32_16x16x32_bf16 v[48:51], a[64:67], v[186:189], 0
    v_mfma_f32_16x16x32_bf16 v[52:55], a[68:71], v[186:189], 0
    v_mfma_f32_16x16x32_bf16 v[56:59], a[72:75], v[186:189], 0
    v_mfma_f32_16x16x32_bf16 v[60:63], a[76:79], v[186:189], 0
    v_mfma_f32_16x16x32_bf16 v[64:67], a[80:83], v[186:189], 0
    v_mfma_f32_16x16x32_bf16 v[68:71], a[84:87], v[186:189], 0
    v_mfma_f32_16x16x32_bf16 v[72:75], a[88:91], v[186:189], 0
    v_mfma_f32_16x16x32_bf16 v[76:79], a[92:95], v[186:189], 0
    s_waitcnt vmcnt(36)
    s_bitcmp1_b32 s97, 4
    s_mov_b64 exec, 1
    s_cbranch_scc1 .fs_442
    buffer_store_dword v12, v13, s[8:11], s92 offen
.fj_443:
    s_mov_b64 exec, -1
    s_cmp_lt_u32 s25, s96
    s_cbranch_scc1 .os_444
    v_mfma_f32_16x16x16_bf16 v[16:19], v[128:129], v[184:185], v[16:19]
    v_mfma_f32_16x16x16_bf16 v[20:23], v[130:131], v[184:185], v[20:23]
    v_add_u32 v12, 1, v12
    v_mfma_f32_16x16x16_bf16 v[24:27], v[132:133], v[184:185], v[24:27]
    v_mfma_f32_16x16x16_bf16 v[28:31], v[134:135], v[184:185], v[28:31]
    v_mfma_f32_16x16x16_bf16 v[32:35], v[136:137], v[184:185], v[32:35]
    v_mfma_f32_16x16x16_bf16 v[36:39], v[138:139], v[184:185], v[36:39]
    v_cvt_pk_bf16_f32 v208, v16, v17
    v_cvt_pk_bf16_f32 v209, v18, v19
    v_cvt_pk_bf16_f32 v210, v20, v21
    v_cvt_pk_bf16_f32 v211, v22, v23
    buffer_store_dwordx4 v[208:211], v8, s[8:11], s50 offen offset:0
    v_mfma_f32_16x16x16_bf16 v[40:43], v[140:141], v[184:185], v[40:43]
    v_mfma_f32_16x16x16_bf16 v[44:47], v[142:143], v[184:185], v[44:47]
    v_cvt_pk_bf16_f32 v212, v24, v25
    v_cvt_pk_bf16_f32 v213, v26, v27
    v_cvt_pk_bf16_f32 v214, v28, v29
    v_cvt_pk_bf16_f32 v215, v30, v31
    buffer_store_dwordx4 v[212:215], v8, s[8:11], s50 offen offset:1024
    v_mfma_f32_16x16x16_bf16 v[48:51], v[128:129], v[190:191], v[48:51]
    v_mfma_f32_16x16x16_bf16 v[52:55], v[130:131], v[190:191], v[52:55]
    v_cvt_pk_bf16_f32 v216, v32, v33
    v_cvt_pk_bf16_f32 v217, v34, v35
    v_cvt_pk_bf16_f32 v218, v36, v37
    v_cvt_pk_bf16_f32 v219, v38, v39
    buffer_store_dwordx4 v[216:219], v8, s[8:11], s50 offen offset:2048
    v_mfma_f32_16x16x16_bf16 v[56:59], v[132:133], v[190:191], v[56:59]
    v_mfma_f32_16x16x16_bf16 v[60:63], v[134:135], v[190:191], v[60:63]
    v_cvt_pk_bf16_f32 v220, v40, v41
    v_cvt_pk_bf16_f32 v221, v42, v43
    v_cvt_pk_bf16_f32 v222, v44, v45
    v_cvt_pk_bf16_f32 v223, v46, v47
    buffer_store_dwordx4 v[220:223], v8, s[8:11], s50 offen offset:3072
    v_mfma_f32_16x16x16_bf16 v[64:67], v[136:137], v[190:191], v[64:67]
    v_mfma_f32_16x16x16_bf16 v[68:71], v[138:139], v[190:191], v[68:71]
    v_cvt_pk_bf16_f32 v224, v48, v49
    v_cvt_pk_bf16_f32 v225, v50, v51
    v_cvt_pk_bf16_f32 v226, v52, v53
    v_cvt_pk_bf16_f32 v227, v54, v55
    buffer_store_dwordx4 v[224:227], v8, s[8:11], s51 offen offset:0
    v_mfma_f32_16x16x16_bf16 v[72:75], v[140:141], v[190:191], v[72:75]
    v_mfma_f32_16x16x16_bf16 v[76:79], v[142:143], v[190:191], v[76:79]
    v_cvt_pk_bf16_f32 v228, v56, v57
    v_cvt_pk_bf16_f32 v229, v58, v59
    v_cvt_pk_bf16_f32 v230, v60, v61
    v_cvt_pk_bf16_f32 v231, v62, v63
    buffer_store_dwordx4 v[228:231], v8, s[8:11], s51 offen offset:1024
    s_nop 3
    v_cvt_pk_bf16_f32 v232, v64, v65
    v_cvt_pk_bf16_f32 v233, v66, v67
    v_cvt_pk_bf16_f32 v234, v68, v69
    v_cvt_pk_bf16_f32 v235, v70, v71
    buffer_store_dwordx4 v[232:235], v8, s[8:11], s51 offen offset:2048
    v_cvt_pk_bf16_f32 v236, v72, v73
    v_cvt_pk_bf16_f32 v237, v74, v75
    v_cvt_pk_bf16_f32 v238, v76, v77
    v_cvt_pk_bf16_f32 v239, v78, v79
    buffer_store_dwordx4 v[236:239], v8, s[8:11], s51 offen offset:3072
.oj_445:
    s_mov_b32 s34, s33
    s_add_u32 s50, s27, 0
    s_add_u32 s51, s27, 4096
    s_cmp_lt_u32 s25, 60
    s_cselect_b32 s4, 4, 0
    s_cselect_b32 s5, 1048576, 0
    s_cselect_b32 s6, 786432, 0
    s_add_u32 s36, s36, s4
    s_add_u32 s27, s27, s5
    s_add_u32 s33, s33, s6
    s_waitcnt vmcnt(8)

    v_cmp_gt_u32 vcc, s36, v15
    s_cbranch_vccnz .atw_446
.atb_447:
    s_add_u32 s28, s27, 4096
    s_add_u32 s29, s27, 16777216
    s_add_u32 s30, s27, 16781312
    s_add_u32 s31, s27, 33554432
    s_add_u32 s32, s27, 33558528

    buffer_load_dwordx4 a[0:3], v8, s[8:11], s27 offen offset:0
    buffer_load_dwordx4 a[16:19], v8, s[8:11], s28 offen offset:0
    buffer_load_dwordx4 a[32:35], v8, s[8:11], s29 offen offset:0
    buffer_load_dwordx4 a[48:51], v8, s[8:11], s30 offen offset:0
    buffer_load_dwordx4 a[4:7], v8, s[8:11], s27 offen offset:1024
    buffer_load_dwordx4 a[20:23], v8, s[8:11], s28 offen offset:1024
    buffer_load_dwordx4 a[36:39], v8, s[8:11], s29 offen offset:1024
    buffer_load_dwordx4 a[52:55], v8, s[8:11], s30 offen offset:1024
    buffer_load_dwordx4 a[8:11], v8, s[8:11], s27 offen offset:2048
    buffer_load_dwordx4 a[24:27], v8, s[8:11], s28 offen offset:2048
    buffer_load_dwordx4 a[40:43], v8, s[8:11], s29 offen offset:2048
    buffer_load_dwordx4 a[56:59], v8, s[8:11], s30 offen offset:2048
    buffer_load_dwordx4 a[12:15], v8, s[8:11], s27 offen offset:3072
    buffer_load_dwordx4 a[28:31], v8, s[8:11], s28 offen offset:3072
    buffer_load_dwordx4 a[44:47], v8, s[8:11], s29 offen offset:3072
    buffer_load_dwordx4 a[60:63], v8, s[8:11], s30 offen offset:3072
    buffer_load_dwordx4 a[64:67], v8, s[8:11], s31 offen offset:0
    buffer_load_dwordx4 a[68:71], v8, s[8:11], s31 offen offset:1024
    buffer_load_dwordx4 a[72:75], v8, s[8:11], s31 offen offset:2048
    buffer_load_dwordx4 a[76:79], v8, s[8:11], s31 offen offset:3072
    buffer_load_dwordx4 a[80:83], v8, s[8:11], s32 offen offset:0
    buffer_load_dwordx4 a[84:87], v8, s[8:11], s32 offen offset:1024
    buffer_load_dwordx4 a[88:91], v8, s[8:11], s32 offen offset:2048
    buffer_load_dwordx4 a[92:95], v8, s[8:11], s32 offen offset:3072
    buffer_load_dwordx4 v[80:83], v10, s[8:11], s33 offen offset:2048 sc1
    buffer_load_dwordx4 v[84:87], v10, s[8:11], s33 offen offset:2176 sc1
    buffer_load_dwordx4 v[88:91], v10, s[8:11], s33 offen offset:3072 sc1
    buffer_load_dwordx4 v[92:95], v10, s[8:11], s33 offen offset:3200 sc1
    s_add_u32 s4, s33, 4096
    s_mov_b64 exec, s[60:61]
    buffer_load_dwordx2 v[128:129], v11, s[8:11], s4 offen offset:0 sc1
    buffer_load_dwordx2 v[130:131], v11, s[8:11], s4 offen offset:256 sc1
    buffer_load_dwordx2 v[132:133], v11, s[8:11], s4 offen offset:512 sc1
    buffer_load_dwordx2 v[134:135], v11, s[8:11], s4 offen offset:768 sc1
    buffer_load_dwordx2 v[136:137], v11, s[8:11], s4 offen offset:1024 sc1
    buffer_load_dwordx2 v[138:139], v11, s[8:11], s4 offen offset:1280 sc1
    buffer_load_dwordx2 v[140:141], v11, s[8:11], s4 offen offset:1536 sc1
    buffer_load_dwordx2 v[142:143], v11, s[8:11], s4 offen offset:1792 sc1
    s_mov_b64 exec, -1
    v_mfma_f32_16x16x32_bf16 v[144:147], a[128:131], a[96:99], 0
    v_mfma_f32_16x16x32_bf16 v[156:159], a[128:131], a[112:115], 0
    v_mfma_f32_16x16x32_bf16 v[160:163], a[144:147], a[112:115], 0
    v_mfma_f32_16x16x32_bf16 v[144:147], a[132:135], a[100:103], v[144:147]
    v_mfma_f32_16x16x32_bf16 v[156:159], a[132:135], a[116:119], v[156:159]
    v_mfma_f32_16x16x32_bf16 v[160:163], a[148:151], a[116:119], v[160:163]
    v_mfma_f32_16x16x32_bf16 v[144:147], a[136:139], a[104:107], v[144:147]
    v_mfma_f32_16x16x32_bf16 v[156:159], a[136:139], a[120:123], v[156:159]
    v_mfma_f32_16x16x32_bf16 v[160:163], a[152:155], a[120:123], v[160:163]
    v_mfma_f32_16x16x32_bf16 v[144:147], a[140:143], a[108:111], v[144:147]
    v_mfma_f32_16x16x32_bf16 v[156:159], a[140:143], a[124:127], v[156:159]
    v_mfma_f32_16x16x32_bf16 v[160:163], a[156:159], a[124:127], v[160:163]
    s_nop 7
    v_cvt_pk_bf16_f32 v168, v144, v145
    v_cvt_pk_bf16_f32 v170, v146, v147
    v_and_b32 v169, 0xffff0000, v168
    v_lshlrev_b32 v168, 16, v168
    v_and_b32 v171, 0xffff0000, v170
    v_lshlrev_b32 v170, 16, v170
    v_mul_f32 v168, s37, v168
    v_mul_f32 v169, s37, v169
    v_mul_f32 v170, s37, v170
    v_mul_f32 v171, s37, v171
    v_cvt_pk_bf16_f32 v144, v168, v169
    v_cvt_pk_bf16_f32 v146, v170, v171
    v_and_b32 v145, 0xffff0000, v144
    v_lshlrev_b32 v144, 16, v144
    v_and_b32 v147, 0xffff0000, v146
    v_lshlrev_b32 v146, 16, v146
    v_cvt_pk_bf16_f32 v192, v156, v157
    v_cvt_pk_bf16_f32 v194, v158, v159
    v_cvt_pk_bf16_f32 v196, v160, v161
    v_cvt_pk_bf16_f32 v198, v162, v163
    v_and_b32 v193, 0xffff0000, v192
    v_lshlrev_b32 v192, 16, v192
    v_and_b32 v195, 0xffff0000, v194
    v_lshlrev_b32 v194, 16, v194
    v_and_b32 v197, 0xffff0000, v196
    v_lshlrev_b32 v196, 16, v196
    v_and_b32 v199, 0xffff0000, v198
    v_lshlrev_b32 v198, 16, v198
    v_mul_f32 v192, s37, v192
    v_mul_f32 v193, s37, v193
    v_mul_f32 v194, s37, v194
    v_mul_f32 v195, s37, v195
    v_mul_f32 v196, s37, v196
    v_mul_f32 v197, s37, v197
    v_mul_f32 v198, s37, v198
    v_mul_f32 v199, s37, v199
    v_cvt_pk_bf16_f32 v156, v192, v193
    v_cvt_pk_bf16_f32 v158, v194, v195
    v_cvt_pk_bf16_f32 v160, v196, v197
    v_cvt_pk_bf16_f32 v162, v198, v199
    v_and_b32 v157, 0xffff0000, v156
    v_lshlrev_b32 v156, 16, v156
    v_and_b32 v159, 0xffff0000, v158
    v_lshlrev_b32 v158, 16, v158
    v_and_b32 v161, 0xffff0000, v160
    v_lshlrev_b32 v160, 16, v160
    v_and_b32 v163, 0xffff0000, v162
    v_lshlrev_b32 v162, 16, v162
    v_cndmask_b32 v144, v14, v144, s[40:41]
    v_cndmask_b32 v145, v14, v145, s[42:43]
    v_cndmask_b32 v146, v14, v146, s[44:45]
    v_cndmask_b32 v147, v14, v147, s[46:47]
    v_cndmask_b32 v160, v14, v160, s[40:41]
    v_cndmask_b32 v161, v14, v161, s[42:43]
    v_cndmask_b32 v162, v14, v162, s[44:45]
    v_cndmask_b32 v163, v14, v163, s[46:47]
    s_mov_b32 s62, 0
.kmp_448:
    v_max3_u32 v4, v96, v97, v98
    v_max3_u32 v5, v99, v100, v101
    v_max3_u32 v4, v4, v102, v103
    v_max3_u32 v5, v5, v104, v105
    v_max3_u32 v4, v4, v106, v107
    v_max3_u32 v5, v5, v108, v109
    v_max3_u32 v4, v4, v110, v111
    v_max3_u32 v5, v5, v112, v113
    v_max3_u32 v4, v4, v114, v115
    v_max3_u32 v5, v5, v116, v117
    v_max3_u32 v4, v4, v118, v119
    v_max3_u32 v5, v5, v120, v121
    v_max3_u32 v4, v4, v122, v123
    v_max3_u32 v5, v5, v124, v125
    v_max3_u32 v4, v4, v126, v127
    v_max_u32 v4, v4, v5
    v_cmp_eq_u32 vcc, -1, v4
    s_cbranch_vccnz .kmf_449

    v_mfma_f32_16x16x32_bf16 v[152:155], v[96:99], a[96:99], 0
    v_mfma_f32_16x16x32_bf16 v[164:167], v[96:99], a[112:115], 0
    v_mfma_f32_16x16x32_bf16 v[152:155], v[100:103], a[100:103], v[152:155]
    v_mfma_f32_16x16x32_bf16 v[164:167], v[100:103], a[116:119], v[164:167]
    v_mfma_f32_16x16x32_bf16 v[152:155], v[104:107], a[104:107], v[152:155]
    v_mfma_f32_16x16x32_bf16 v[164:167], v[104:107], a[120:123], v[164:167]
    v_mfma_f32_16x16x32_bf16 v[152:155], v[108:111], a[108:111], v[152:155]
    v_mfma_f32_16x16x32_bf16 v[164:167], v[108:111], a[124:127], v[164:167]
    s_nop 5
    v_cvt_pk_bf16_f32 v176, v152, v153
    v_cvt_pk_bf16_f32 v178, v154, v155
    v_and_b32 v177, 0xffff0000, v176
    v_lshlrev_b32 v176, 16, v176
    v_and_b32 v179, 0xffff0000, v178
    v_lshlrev_b32 v178, 16, v178
    v_mul_f32 v176, s37, v176
    v_mul_f32 v177, s37, v177
    v_mul_f32 v178, s37, v178
    v_mul_f32 v179, s37, v179
    v_cvt_pk_bf16_f32 v152, v176, v177
    v_cvt_pk_bf16_f32 v154, v178, v179
    v_and_b32 v153, 0xffff0000, v152
    v_lshlrev_b32 v152, 16, v152
    v_and_b32 v155, 0xffff0000, v154
    v_lshlrev_b32 v154, 16, v154
    v_cndmask_b32 v152, v14, v152, s[60:61]
    v_cndmask_b32 v153, v14, v153, s[60:61]
    v_cndmask_b32 v154, v14, v154, s[60:61]
    v_cndmask_b32 v155, v14, v155, s[60:61]
    v_cvt_pk_bf16_f32 v200, v164, v165
    v_cvt_pk_bf16_f32 v202, v166, v167
    v_and_b32 v201, 0xffff0000, v200
    v_lshlrev_b32 v200, 16, v200
    v_and_b32 v203, 0xffff0000, v202
    v_lshlrev_b32 v202, 16, v202
    v_mul_f32 v200, s37, v200
    v_mul_f32 v201, s37, v201
    v_mul_f32 v202, s37, v202
    v_mul_f32 v203, s37, v203
    v_cvt_pk_bf16_f32 v164, v200, v201
    v_cvt_pk_bf16_f32 v166, v202, v203
    v_and_b32 v165, 0xffff0000, v164
    v_lshlrev_b32 v164, 16, v164
    v_and_b32 v167, 0xffff0000, v166
    v_lshlrev_b32 v166, 16, v166
    v_cndmask_b32 v164, v14, v164, s[60:61]
    v_cndmask_b32 v165, v14, v165, s[60:61]
    v_cndmask_b32 v166, v14, v166, s[60:61]
    v_cndmask_b32 v167, v14, v167, s[60:61]
    v_max3_f32 v4, v144, v145, v146
    v_max3_f32 v5, v147, v152, v153
    v_max3_f32 v4, v4, v154, v155
    v_max_f32 v4, v4, v5

    v_max3_f32 v6, v156, v157, v158
    v_max3_f32 v7, v159, v160, v161
    v_max3_f32 v6, v6, v162, v163
    v_max3_f32 v7, v7, v164, v165
    v_max3_f32 v6, v6, v166, v167
    v_max_f32 v6, v6, v7

    v_mov_b32 v5, v4
    v_mov_b32 v7, v6
    s_nop 0
    v_permlane32_swap_b32 v4, v5
    v_permlane32_swap_b32 v6, v7
    v_max_f32 v4, v4, v5
    v_max_f32 v6, v6, v7

    v_mov_b32 v5, v4
    v_mov_b32 v7, v6
    s_nop 0
    v_permlane16_swap_b32 v4, v5
    v_permlane16_swap_b32 v6, v7
    v_max_f32 v4, v4, v5
    v_max_f32 v6, v6, v7

    v_mul_f32 v4, s38, v4
    v_mul_f32 v6, s38, v6
    v_fma_f32 v168, v144, s38, -v4
    v_fma_f32 v169, v145, s38, -v4
    v_fma_f32 v170, v146, s38, -v4
    v_fma_f32 v171, v147, s38, -v4
    v_fma_f32 v176, v152, s38, -v4
    v_fma_f32 v177, v153, s38, -v4
    v_fma_f32 v178, v154, s38, -v4
    v_fma_f32 v179, v155, s38, -v4
    v_fma_f32 v192, v156, s38, -v6
    v_fma_f32 v193, v157, s38, -v6
    v_fma_f32 v194, v158, s38, -v6
    v_fma_f32 v195, v159, s38, -v6
    v_fma_f32 v196, v160, s38, -v6
    v_fma_f32 v197, v161, s38, -v6
    v_fma_f32 v198, v162, s38, -v6
    v_fma_f32 v199, v163, s38, -v6
    v_fma_f32 v200, v164, s38, -v6
    v_fma_f32 v201, v165, s38, -v6
    v_fma_f32 v202, v166, s38, -v6
    v_fma_f32 v203, v167, s38, -v6
    v_exp_f32 v168, v168
    v_exp_f32 v169, v169
    v_exp_f32 v170, v170
    v_exp_f32 v171, v171
    v_exp_f32 v176, v176
    v_exp_f32 v177, v177
    v_exp_f32 v178, v178
    v_exp_f32 v179, v179
    v_exp_f32 v192, v192
    v_exp_f32 v193, v193
    v_exp_f32 v194, v194
    v_exp_f32 v195, v195
    v_exp_f32 v196, v196
    v_exp_f32 v197, v197
    v_exp_f32 v198, v198
    v_exp_f32 v199, v199
    v_exp_f32 v200, v200
    v_exp_f32 v201, v201
    v_exp_f32 v202, v202
    v_exp_f32 v203, v203
    v_add_f32 v4, v168, v169
    v_add_f32 v5, v170, v171
    v_add_f32 v4, v4, v176
    v_add_f32 v5, v5, v177
    v_add_f32 v4, v4, v178
    v_add_f32 v5, v5, v179
    v_add_f32 v4, v4, v5
    v_add_f32 v6, v192, v193
    v_add_f32 v7, v194, v195
    v_add_f32 v6, v6, v196
    v_add_f32 v7, v7, v197
    v_add_f32 v6, v6, v198
    v_add_f32 v7, v7, v199
    v_add_f32 v6, v6, v200
    v_add_f32 v7, v7, v201
    v_add_f32 v6, v6, v202
    v_add_f32 v7, v7, v203
    v_add_f32 v6, v6, v7
    v_mov_b32 v5, v4
    v_mov_b32 v7, v6
    s_nop 0
    v_permlane32_swap_b32 v4, v5
    v_permlane32_swap_b32 v6, v7
    v_add_f32 v4, v4, v5
    v_add_f32 v6, v6, v7

    v_mov_b32 v5, v4
    v_mov_b32 v7, v6
    s_nop 0
    v_permlane16_swap_b32 v4, v5
    v_permlane16_swap_b32 v6, v7
    v_add_f32 v4, v4, v5
    v_add_f32 v6, v6, v7

    v_rcp_f32 v4, v4
    v_rcp_f32 v6, v6
    v_mov_b32 v182, 0
    v_mov_b32 v183, 0
    v_mul_f32 v168, v4, v168
    v_mul_f32 v169, v4, v169
    v_mul_f32 v170, v4, v170
    v_mul_f32 v171, v4, v171
    v_mul_f32 v176, v4, v176
    v_mul_f32 v177, v4, v177
    v_mul_f32 v178, v4, v178
    v_mul_f32 v179, v4, v179
    v_cvt_pk_bf16_f32 v180, v168, v169
    v_cvt_pk_bf16_f32 v181, v170, v171
    v_cvt_pk_bf16_f32 v184, v176, v177
    v_cvt_pk_bf16_f32 v185, v178, v179
    v_mul_f32 v192, v6, v192
    v_mul_f32 v193, v6, v193
    v_mul_f32 v194, v6, v194
    v_mul_f32 v195, v6, v195
    v_mul_f32 v196, v6, v196
    v_mul_f32 v197, v6, v197
    v_mul_f32 v198, v6, v198
    v_mul_f32 v199, v6, v199
    v_mul_f32 v200, v6, v200
    v_mul_f32 v201, v6, v201
    v_mul_f32 v202, v6, v202
    v_mul_f32 v203, v6, v203
    v_cvt_pk_bf16_f32 v186, v192, v193
    v_cvt_pk_bf16_f32 v187, v194, v195
    v_cvt_pk_bf16_f32 v188, v196, v197
    v_cvt_pk_bf16_f32 v189, v198, v199
    v_cvt_pk_bf16_f32 v190, v200, v201
    v_cvt_pk_bf16_f32 v191, v202, v203
    s_add_u32 s25, s25, 4

    v_mfma_f32_16x16x32_bf16 v[16:19], a[160:163], v[180:183], 0
    v_mfma_f32_16x16x32_bf16 v[20:23], a[164:167], v[180:183], 0
    v_mfma_f32_16x16x32_bf16 v[24:27], a[168:171], v[180:183], 0
    v_mfma_f32_16x16x32_bf16 v[28:31], a[172:175], v[180:183], 0
    v_mfma_f32_16x16x32_bf16 v[32:35], a[176:179], v[180:183], 0
    v_mfma_f32_16x16x32_bf16 v[36:39], a[180:183], v[180:183], 0
    v_mfma_f32_16x16x32_bf16 v[40:43], a[184:187], v[180:183], 0
    v_mfma_f32_16x16x32_bf16 v[44:47], a[188:191], v[180:183], 0
    v_mfma_f32_16x16x32_bf16 v[48:51], a[160:163], v[186:189], 0
    v_mfma_f32_16x16x32_bf16 v[52:55], a[164:167], v[186:189], 0
    v_mfma_f32_16x16x32_bf16 v[56:59], a[168:171], v[186:189], 0
    v_mfma_f32_16x16x32_bf16 v[60:63], a[172:175], v[186:189], 0
    v_mfma_f32_16x16x32_bf16 v[64:67], a[176:179], v[186:189], 0
    v_mfma_f32_16x16x32_bf16 v[68:71], a[180:183], v[186:189], 0
    v_mfma_f32_16x16x32_bf16 v[72:75], a[184:187], v[186:189], 0
    v_mfma_f32_16x16x32_bf16 v[76:79], a[188:191], v[186:189], 0
    s_waitcnt vmcnt(36)
    s_bitcmp1_b32 s97, 4
    s_mov_b64 exec, 1
    s_cbranch_scc1 .fs_450
    buffer_store_dword v12, v13, s[8:11], s92 offen
.fj_451:
    s_mov_b64 exec, -1
    s_cmp_lt_u32 s25, s96
    s_cbranch_scc1 .os_452
    v_mfma_f32_16x16x16_bf16 v[16:19], v[112:113], v[184:185], v[16:19]
    v_mfma_f32_16x16x16_bf16 v[20:23], v[114:115], v[184:185], v[20:23]
    v_add_u32 v12, 1, v12
    v_mfma_f32_16x16x16_bf16 v[24:27], v[116:117], v[184:185], v[24:27]
    v_mfma_f32_16x16x16_bf16 v[28:31], v[118:119], v[184:185], v[28:31]
    v_mfma_f32_16x16x16_bf16 v[32:35], v[120:121], v[184:185], v[32:35]
    v_mfma_f32_16x16x16_bf16 v[36:39], v[122:123], v[184:185], v[36:39]
    v_cvt_pk_bf16_f32 v208, v16, v17
    v_cvt_pk_bf16_f32 v209, v18, v19
    v_cvt_pk_bf16_f32 v210, v20, v21
    v_cvt_pk_bf16_f32 v211, v22, v23
    buffer_store_dwordx4 v[208:211], v8, s[8:11], s50 offen offset:0
    v_mfma_f32_16x16x16_bf16 v[40:43], v[124:125], v[184:185], v[40:43]
    v_mfma_f32_16x16x16_bf16 v[44:47], v[126:127], v[184:185], v[44:47]
    v_cvt_pk_bf16_f32 v212, v24, v25
    v_cvt_pk_bf16_f32 v213, v26, v27
    v_cvt_pk_bf16_f32 v214, v28, v29
    v_cvt_pk_bf16_f32 v215, v30, v31
    buffer_store_dwordx4 v[212:215], v8, s[8:11], s50 offen offset:1024
    v_mfma_f32_16x16x16_bf16 v[48:51], v[112:113], v[190:191], v[48:51]
    v_mfma_f32_16x16x16_bf16 v[52:55], v[114:115], v[190:191], v[52:55]
    v_cvt_pk_bf16_f32 v216, v32, v33
    v_cvt_pk_bf16_f32 v217, v34, v35
    v_cvt_pk_bf16_f32 v218, v36, v37
    v_cvt_pk_bf16_f32 v219, v38, v39
    buffer_store_dwordx4 v[216:219], v8, s[8:11], s50 offen offset:2048
    v_mfma_f32_16x16x16_bf16 v[56:59], v[116:117], v[190:191], v[56:59]
    v_mfma_f32_16x16x16_bf16 v[60:63], v[118:119], v[190:191], v[60:63]
    v_cvt_pk_bf16_f32 v220, v40, v41
    v_cvt_pk_bf16_f32 v221, v42, v43
    v_cvt_pk_bf16_f32 v222, v44, v45
    v_cvt_pk_bf16_f32 v223, v46, v47
    buffer_store_dwordx4 v[220:223], v8, s[8:11], s50 offen offset:3072
    v_mfma_f32_16x16x16_bf16 v[64:67], v[120:121], v[190:191], v[64:67]
    v_mfma_f32_16x16x16_bf16 v[68:71], v[122:123], v[190:191], v[68:71]
    v_cvt_pk_bf16_f32 v224, v48, v49
    v_cvt_pk_bf16_f32 v225, v50, v51
    v_cvt_pk_bf16_f32 v226, v52, v53
    v_cvt_pk_bf16_f32 v227, v54, v55
    buffer_store_dwordx4 v[224:227], v8, s[8:11], s51 offen offset:0
    v_mfma_f32_16x16x16_bf16 v[72:75], v[124:125], v[190:191], v[72:75]
    v_mfma_f32_16x16x16_bf16 v[76:79], v[126:127], v[190:191], v[76:79]
    v_cvt_pk_bf16_f32 v228, v56, v57
    v_cvt_pk_bf16_f32 v229, v58, v59
    v_cvt_pk_bf16_f32 v230, v60, v61
    v_cvt_pk_bf16_f32 v231, v62, v63
    buffer_store_dwordx4 v[228:231], v8, s[8:11], s51 offen offset:1024
    s_nop 3
    v_cvt_pk_bf16_f32 v232, v64, v65
    v_cvt_pk_bf16_f32 v233, v66, v67
    v_cvt_pk_bf16_f32 v234, v68, v69
    v_cvt_pk_bf16_f32 v235, v70, v71
    buffer_store_dwordx4 v[232:235], v8, s[8:11], s51 offen offset:2048
    v_cvt_pk_bf16_f32 v236, v72, v73
    v_cvt_pk_bf16_f32 v237, v74, v75
    v_cvt_pk_bf16_f32 v238, v76, v77
    v_cvt_pk_bf16_f32 v239, v78, v79
    buffer_store_dwordx4 v[236:239], v8, s[8:11], s51 offen offset:3072
.oj_453:
    s_cmp_lt_u32 s25, 64
    s_cbranch_scc1 .att_437
    s_waitcnt vmcnt(0)

    s_bitcmp1_b32 s97, 4
    s_mov_b64 exec, 1
    s_cbranch_scc1 .fs_455
    buffer_store_dword v12, v13, s[8:11], s92 offen
.fj_456:
    s_mov_b64 exec, -1
    s_branch .ate_454
.atw_438:
    s_mov_b32 s62, 0
    s_mov_b64 exec, 7
.wf_457:
    buffer_load_dword v15, v9, s[8:11], s35 offen sc1
    s_waitcnt vmcnt(0)
    v_cmp_gt_u32 vcc, s36, v15
    s_cbranch_vccz .wfd_458
    s_sleep 2
    s_add_u32 s62, s62, 1
    s_cmp_gt_u32 s62, 0x400000
    s_cbranch_scc1 .mg_end_1
    s_branch .wf_457

.wfd_458:
    s_mov_b64 exec, -1
    s_branch .atb_439
.kmf_441:
    s_cmp_lg_u32 s62, 0
    s_cbranch_scc1 .kmn_459
    s_waitcnt vmcnt(36)
    s_bitcmp1_b32 s97, 4
    s_mov_b64 exec, 1
    s_cbranch_scc1 .fs_460
    buffer_store_dword v12, v13, s[8:11], s92 offen
.fj_461:
    s_mov_b64 exec, -1
    s_cmp_lt_u32 s25, 60
    s_cselect_b32 s5, 0, 196608
    s_sub_u32 s5, s34, s5
    s_mov_b64 exec, 15

.kml_462:
    s_sleep 4
    buffer_load_dword v4, v204, s[8:11], s5 offen sc1
    s_add_u32 s62, s62, 1
    s_cmp_gt_u32 s62, 0x200000
    s_cbranch_scc1 .mg_end_1
    s_waitcnt vmcnt(0)
    v_cmp_eq_u32 vcc, -1, v4
    s_cbranch_vccnz .kml_462
    s_mov_b64 exec, -1

.kmn_459:
    s_sleep 1
    buffer_load_dwordx4 v[80:83], v10, s[8:11], s34 offen offset:2048 sc1
    buffer_load_dwordx4 v[84:87], v10, s[8:11], s34 offen offset:2176 sc1
    buffer_load_dwordx4 v[88:91], v10, s[8:11], s34 offen offset:3072 sc1
    buffer_load_dwordx4 v[92:95], v10, s[8:11], s34 offen offset:3200 sc1
    s_add_u32 s4, s34, 4096
    s_mov_b64 exec, s[60:61]
    buffer_load_dwordx2 v[128:129], v11, s[8:11], s4 offen offset:0 sc1
    buffer_load_dwordx2 v[130:131], v11, s[8:11], s4 offen offset:256 sc1
    buffer_load_dwordx2 v[132:133], v11, s[8:11], s4 offen offset:512 sc1
    buffer_load_dwordx2 v[134:135], v11, s[8:11], s4 offen offset:768 sc1
    buffer_load_dwordx2 v[136:137], v11, s[8:11], s4 offen offset:1024 sc1
    buffer_load_dwordx2 v[138:139], v11, s[8:11], s4 offen offset:1280 sc1
    buffer_load_dwordx2 v[140:141], v11, s[8:11], s4 offen offset:1536 sc1
    buffer_load_dwordx2 v[142:143], v11, s[8:11], s4 offen offset:1792 sc1
    s_mov_b64 exec, -1
    s_add_u32 s62, s62, 1
    s_cmp_gt_u32 s62, 0x200000
    s_cbranch_scc1 .mg_end_1
    s_waitcnt vmcnt(0)
    s_branch .kmp_440

.fs_442:
    buffer_store_dword v12, v13, s[8:11], s92 offen sc1
    s_branch .fj_443
.os_444:
    v_mfma_f32_16x16x16_bf16 v[16:19], v[128:129], v[184:185], v[16:19]
    v_mfma_f32_16x16x16_bf16 v[20:23], v[130:131], v[184:185], v[20:23]
    v_add_u32 v12, 1, v12
    v_mfma_f32_16x16x16_bf16 v[24:27], v[132:133], v[184:185], v[24:27]
    v_mfma_f32_16x16x16_bf16 v[28:31], v[134:135], v[184:185], v[28:31]
    v_mfma_f32_16x16x16_bf16 v[32:35], v[136:137], v[184:185], v[32:35]
    v_mfma_f32_16x16x16_bf16 v[36:39], v[138:139], v[184:185], v[36:39]
    v_cvt_pk_bf16_f32 v208, v16, v17
    v_cvt_pk_bf16_f32 v209, v18, v19
    v_cvt_pk_bf16_f32 v210, v20, v21
    v_cvt_pk_bf16_f32 v211, v22, v23
    buffer_store_dwordx4 v[208:211], v8, s[8:11], s50 offen offset:0 sc1
    v_mfma_f32_16x16x16_bf16 v[40:43], v[140:141], v[184:185], v[40:43]
    v_mfma_f32_16x16x16_bf16 v[44:47], v[142:143], v[184:185], v[44:47]
    v_cvt_pk_bf16_f32 v212, v24, v25
    v_cvt_pk_bf16_f32 v213, v26, v27
    v_cvt_pk_bf16_f32 v214, v28, v29
    v_cvt_pk_bf16_f32 v215, v30, v31
    buffer_store_dwordx4 v[212:215], v8, s[8:11], s50 offen offset:1024 sc1
    v_mfma_f32_16x16x16_bf16 v[48:51], v[128:129], v[190:191], v[48:51]
    v_mfma_f32_16x16x16_bf16 v[52:55], v[130:131], v[190:191], v[52:55]
    v_cvt_pk_bf16_f32 v216, v32, v33
    v_cvt_pk_bf16_f32 v217, v34, v35
    v_cvt_pk_bf16_f32 v218, v36, v37
    v_cvt_pk_bf16_f32 v219, v38, v39
    buffer_store_dwordx4 v[216:219], v8, s[8:11], s50 offen offset:2048 sc1
    v_mfma_f32_16x16x16_bf16 v[56:59], v[132:133], v[190:191], v[56:59]
    v_mfma_f32_16x16x16_bf16 v[60:63], v[134:135], v[190:191], v[60:63]
    v_cvt_pk_bf16_f32 v220, v40, v41
    v_cvt_pk_bf16_f32 v221, v42, v43
    v_cvt_pk_bf16_f32 v222, v44, v45
    v_cvt_pk_bf16_f32 v223, v46, v47
    buffer_store_dwordx4 v[220:223], v8, s[8:11], s50 offen offset:3072 sc1
    v_mfma_f32_16x16x16_bf16 v[64:67], v[136:137], v[190:191], v[64:67]
    v_mfma_f32_16x16x16_bf16 v[68:71], v[138:139], v[190:191], v[68:71]
    v_cvt_pk_bf16_f32 v224, v48, v49
    v_cvt_pk_bf16_f32 v225, v50, v51
    v_cvt_pk_bf16_f32 v226, v52, v53
    v_cvt_pk_bf16_f32 v227, v54, v55
    buffer_store_dwordx4 v[224:227], v8, s[8:11], s51 offen offset:0 sc1
    v_mfma_f32_16x16x16_bf16 v[72:75], v[140:141], v[190:191], v[72:75]
    v_mfma_f32_16x16x16_bf16 v[76:79], v[142:143], v[190:191], v[76:79]
    v_cvt_pk_bf16_f32 v228, v56, v57
    v_cvt_pk_bf16_f32 v229, v58, v59
    v_cvt_pk_bf16_f32 v230, v60, v61
    v_cvt_pk_bf16_f32 v231, v62, v63
    buffer_store_dwordx4 v[228:231], v8, s[8:11], s51 offen offset:1024 sc1
    s_nop 3
    v_cvt_pk_bf16_f32 v232, v64, v65
    v_cvt_pk_bf16_f32 v233, v66, v67
    v_cvt_pk_bf16_f32 v234, v68, v69
    v_cvt_pk_bf16_f32 v235, v70, v71
    buffer_store_dwordx4 v[232:235], v8, s[8:11], s51 offen offset:2048 sc1
    v_cvt_pk_bf16_f32 v236, v72, v73
    v_cvt_pk_bf16_f32 v237, v74, v75
    v_cvt_pk_bf16_f32 v238, v76, v77
    v_cvt_pk_bf16_f32 v239, v78, v79
    buffer_store_dwordx4 v[236:239], v8, s[8:11], s51 offen offset:3072 sc1
    s_branch .oj_445
.atw_446:
    s_mov_b32 s62, 0
    s_mov_b64 exec, 7
.wf_463:
    buffer_load_dword v15, v9, s[8:11], s35 offen sc1
    s_waitcnt vmcnt(0)
    v_cmp_gt_u32 vcc, s36, v15
    s_cbranch_vccz .wfd_464
    s_sleep 2
    s_add_u32 s62, s62, 1
    s_cmp_gt_u32 s62, 0x400000
    s_cbranch_scc1 .mg_end_1
    s_branch .wf_463

.wfd_464:
    s_mov_b64 exec, -1
    s_branch .atb_447
.kmf_449:
    s_cmp_lg_u32 s62, 0
    s_cbranch_scc1 .kmn_465
    s_waitcnt vmcnt(36)
    s_bitcmp1_b32 s97, 4
    s_mov_b64 exec, 1
    s_cbranch_scc1 .fs_466
    buffer_store_dword v12, v13, s[8:11], s92 offen
.fj_467:
    s_mov_b64 exec, -1
    s_cmp_lt_u32 s25, 60
    s_cselect_b32 s5, 0, 196608
    s_sub_u32 s5, s34, s5
    s_mov_b64 exec, 15

.kml_468:
    s_sleep 4
    buffer_load_dword v4, v204, s[8:11], s5 offen sc1
    s_add_u32 s62, s62, 1
    s_cmp_gt_u32 s62, 0x200000
    s_cbranch_scc1 .mg_end_1
    s_waitcnt vmcnt(0)
    v_cmp_eq_u32 vcc, -1, v4
    s_cbranch_vccnz .kml_468
    s_mov_b64 exec, -1

.kmn_465:
    s_sleep 1
    buffer_load_dwordx4 v[96:99], v10, s[8:11], s34 offen offset:2048 sc1
    buffer_load_dwordx4 v[100:103], v10, s[8:11], s34 offen offset:2176 sc1
    buffer_load_dwordx4 v[104:107], v10, s[8:11], s34 offen offset:3072 sc1
    buffer_load_dwordx4 v[108:111], v10, s[8:11], s34 offen offset:3200 sc1
    s_add_u32 s4, s34, 4096
    s_mov_b64 exec, s[60:61]
    buffer_load_dwordx2 v[112:113], v11, s[8:11], s4 offen offset:0 sc1
    buffer_load_dwordx2 v[114:115], v11, s[8:11], s4 offen offset:256 sc1
    buffer_load_dwordx2 v[116:117], v11, s[8:11], s4 offen offset:512 sc1
    buffer_load_dwordx2 v[118:119], v11, s[8:11], s4 offen offset:768 sc1
    buffer_load_dwordx2 v[120:121], v11, s[8:11], s4 offen offset:1024 sc1
    buffer_load_dwordx2 v[122:123], v11, s[8:11], s4 offen offset:1280 sc1
    buffer_load_dwordx2 v[124:125], v11, s[8:11], s4 offen offset:1536 sc1
    buffer_load_dwordx2 v[126:127], v11, s[8:11], s4 offen offset:1792 sc1
    s_mov_b64 exec, -1
    s_add_u32 s62, s62, 1
    s_cmp_gt_u32 s62, 0x200000
    s_cbranch_scc1 .mg_end_1
    s_waitcnt vmcnt(0)
    s_branch .kmp_448

.fs_450:
    buffer_store_dword v12, v13, s[8:11], s92 offen sc1
    s_branch .fj_451
.os_452:
    v_mfma_f32_16x16x16_bf16 v[16:19], v[112:113], v[184:185], v[16:19]
    v_mfma_f32_16x16x16_bf16 v[20:23], v[114:115], v[184:185], v[20:23]
    v_add_u32 v12, 1, v12
    v_mfma_f32_16x16x16_bf16 v[24:27], v[116:117], v[184:185], v[24:27]
    v_mfma_f32_16x16x16_bf16 v[28:31], v[118:119], v[184:185], v[28:31]
    v_mfma_f32_16x16x16_bf16 v[32:35], v[120:121], v[184:185], v[32:35]
    v_mfma_f32_16x16x16_bf16 v[36:39], v[122:123], v[184:185], v[36:39]
    v_cvt_pk_bf16_f32 v208, v16, v17
    v_cvt_pk_bf16_f32 v209, v18, v19
    v_cvt_pk_bf16_f32 v210, v20, v21
    v_cvt_pk_bf16_f32 v211, v22, v23
    buffer_store_dwordx4 v[208:211], v8, s[8:11], s50 offen offset:0 sc1
    v_mfma_f32_16x16x16_bf16 v[40:43], v[124:125], v[184:185], v[40:43]
    v_mfma_f32_16x16x16_bf16 v[44:47], v[126:127], v[184:185], v[44:47]
    v_cvt_pk_bf16_f32 v212, v24, v25
    v_cvt_pk_bf16_f32 v213, v26, v27
    v_cvt_pk_bf16_f32 v214, v28, v29
    v_cvt_pk_bf16_f32 v215, v30, v31
    buffer_store_dwordx4 v[212:215], v8, s[8:11], s50 offen offset:1024 sc1
    v_mfma_f32_16x16x16_bf16 v[48:51], v[112:113], v[190:191], v[48:51]
    v_mfma_f32_16x16x16_bf16 v[52:55], v[114:115], v[190:191], v[52:55]
    v_cvt_pk_bf16_f32 v216, v32, v33
    v_cvt_pk_bf16_f32 v217, v34, v35
    v_cvt_pk_bf16_f32 v218, v36, v37
    v_cvt_pk_bf16_f32 v219, v38, v39
    buffer_store_dwordx4 v[216:219], v8, s[8:11], s50 offen offset:2048 sc1
    v_mfma_f32_16x16x16_bf16 v[56:59], v[116:117], v[190:191], v[56:59]
    v_mfma_f32_16x16x16_bf16 v[60:63], v[118:119], v[190:191], v[60:63]
    v_cvt_pk_bf16_f32 v220, v40, v41
    v_cvt_pk_bf16_f32 v221, v42, v43
    v_cvt_pk_bf16_f32 v222, v44, v45
    v_cvt_pk_bf16_f32 v223, v46, v47
    buffer_store_dwordx4 v[220:223], v8, s[8:11], s50 offen offset:3072 sc1
    v_mfma_f32_16x16x16_bf16 v[64:67], v[120:121], v[190:191], v[64:67]
    v_mfma_f32_16x16x16_bf16 v[68:71], v[122:123], v[190:191], v[68:71]
    v_cvt_pk_bf16_f32 v224, v48, v49
    v_cvt_pk_bf16_f32 v225, v50, v51
    v_cvt_pk_bf16_f32 v226, v52, v53
    v_cvt_pk_bf16_f32 v227, v54, v55
    buffer_store_dwordx4 v[224:227], v8, s[8:11], s51 offen offset:0 sc1
    v_mfma_f32_16x16x16_bf16 v[72:75], v[124:125], v[190:191], v[72:75]
    v_mfma_f32_16x16x16_bf16 v[76:79], v[126:127], v[190:191], v[76:79]
    v_cvt_pk_bf16_f32 v228, v56, v57
    v_cvt_pk_bf16_f32 v229, v58, v59
    v_cvt_pk_bf16_f32 v230, v60, v61
    v_cvt_pk_bf16_f32 v231, v62, v63
    buffer_store_dwordx4 v[228:231], v8, s[8:11], s51 offen offset:1024 sc1
    s_nop 3
    v_cvt_pk_bf16_f32 v232, v64, v65
    v_cvt_pk_bf16_f32 v233, v66, v67
    v_cvt_pk_bf16_f32 v234, v68, v69
    v_cvt_pk_bf16_f32 v235, v70, v71
    buffer_store_dwordx4 v[232:235], v8, s[8:11], s51 offen offset:2048 sc1
    v_cvt_pk_bf16_f32 v236, v72, v73
    v_cvt_pk_bf16_f32 v237, v74, v75
    v_cvt_pk_bf16_f32 v238, v76, v77
    v_cvt_pk_bf16_f32 v239, v78, v79
    buffer_store_dwordx4 v[236:239], v8, s[8:11], s51 offen offset:3072 sc1
    s_branch .oj_453
.fs_455:
    buffer_store_dword v12, v13, s[8:11], s92 offen sc1
    s_branch .fj_456
.fs_460:
    buffer_store_dword v12, v13, s[8:11], s92 offen sc1
    s_branch .fj_461
.fs_466:
    buffer_store_dword v12, v13, s[8:11], s92 offen sc1
    s_branch .fj_467
.ate_454:
.mg_end_1:
    s_endpgm
.section .rodata,"a"
.p2align 6
.amdhsa_kernel mega_kernel
  .amdhsa_next_free_vgpr 512
  .amdhsa_next_free_sgpr 102
  .amdhsa_accum_offset 256
  .amdhsa_group_segment_fixed_size 0
  .amdhsa_kernarg_size 136
  .amdhsa_user_sgpr_count 2
  .amdhsa_user_sgpr_kernarg_segment_ptr 1
  .amdhsa_system_sgpr_workgroup_id_x 1
.end_amdhsa_kernel
```

```asm
; @launch kernel=mega_kernel grid=(256,1,1) block=(256,1,1) lds=163840
.amdgcn_target "amdgcn-amd-amdhsa--gfx950"
.text
.globl mega_kernel
.p2align 8
.type mega_kernel,@function
mega_kernel:
    s_cmp_ge_u32 s2, 256
    s_cbranch_scc1 .mg_end_1

    s_load_dwordx4 s[52:55], s[0:1], 120
    s_load_dwordx2 s[40:41], s[0:1], 56
    s_getreg_b32 s3, hwreg(HW_REG_XCC_ID)
    v_and_b32 v1, 63, v0
    v_lshrrev_b32 v4, 6, v0
    s_and_b32 s3, s3, 7
    v_readfirstlane_b32 s24, v4
    s_waitcnt lgkmcnt(0)

    s_mov_b32 s8, s54
    s_and_b32 s9, s55, 0xffff
    s_mov_b32 s10, 0x10000000
    s_mov_b32 s11, 0x00020000

    s_mov_b32 s20, s52
    s_and_b32 s21, s53, 0xffff
    s_mov_b32 s22, 0x100
    s_mov_b32 s23, 0x00020000

    s_mov_b32 s100, s54
    s_cmp_lg_u32 s24, 0
    s_cbranch_scc1 .noat_4
    s_mov_b64 exec, 1
    v_mov_b32 v5, 1
    s_lshl_b32 s4, s3, 2
    s_lshl_b32 s4, s3, 5
    s_add_u32 s4, s4, 28
    v_mov_b32 v6, s4
    buffer_atomic_add v5, v6, s[20:23], 0 offen sc0 sc1
    v_mov_b32 v7, 163776
    s_waitcnt vmcnt(0)
    ds_write_b32 v7, v5
    v_cmp_lt_u32 vcc, 31, v5
    s_cbranch_vccz .nb_5
    v_mov_b32 v6, 136
    buffer_store_dword v7, v6, s[20:23], 0 offen sc1

.nb_5:
    s_waitcnt lgkmcnt(0)
    s_mov_b64 exec, -1

.noat_4:
    s_barrier
    v_mov_b32 v7, 163776
    ds_read_b32 v5, v7
    s_waitcnt lgkmcnt(0)
    v_readfirstlane_b32 s26, v5
    s_mov_b32 s25, s3
    s_mov_b32 s27, 0
    s_mov_b32 s97, 128
    s_cmp_lt_u32 s26, 32
    s_cselect_b32 s99, 1, 0
    s_and_b32 s26, s26, 31

.mg_role_3:
    s_cmp_ge_u32 s25, 4
    s_cbranch_scc1 .mg_bg_2

    s_load_dwordx8 s[44:51], s[0:1], 64
    s_load_dwordx2 s[40:41], s[0:1], 56
    v_and_b32 v1, 63, v0
    v_and_b32 v2, 15, v1
    v_lshrrev_b32 v3, 4, v1

    s_lshr_b32 s79, s26, 2
    s_xor_b32 s63, s26, 4
    s_and_b32 s78, s24, 1
    s_lshl_b32 s34, s25, 19
    s_add_u32 s34, s34, 83886080
    v_lshlrev_b32 v14, 4, v1
    v_lshrrev_b32 v6, 1, v3
    s_sub_u32 s101, 0, s100
    s_and_b32 s101, s101, 0x1fffff
    s_add_u32 s101, s101, 100663296

    v_mov_b32 v188, -1
    v_mov_b32 v189, -1
    v_mov_b32 v190, -1
    v_mov_b32 v191, -1
    s_lshl_b32 s5, s26, 10
    s_add_u32 s5, s5, 40960
    v_add_u32 v235, s5, v14
    s_lshr_b32 s4, s63, 3
    s_mul_i32 s4, s4, 1024
    s_lshl_b32 s5, s63, 9
    s_add_u32 s76, s4, s5
    s_lshl_b32 s5, s26, 9
    s_xor_b32 s5, s5, 1024
    s_lshr_b32 s4, s26, 4
    s_mul_i32 s4, s4, 0
    s_add_u32 s77, s4, s5
    s_add_u32 s77, s77, 20480
    s_sub_u32 s4, s77, s76
    v_and_b32 v4, 31, v1
    v_lshlrev_b32 v236, 4, v4
    v_mad_u32_u24 v236, v6, s4, v236
    v_add_u32 v236, s76, v236
    s_and_b32 s5, s63, 7
    s_lshl_b32 s4, s5, 10
    s_lshr_b32 s5, s63, 3
    s_lshl_b32 s5, s5, 14
    s_add_u32 s4, s4, s5
    s_add_u32 s35, s4, s101
    s_lshl_b32 s5, s25, 16
    v_add_u32 v238, s5, v14
    s_lshl_b32 s4, s25, 3
    s_add_u32 s7, s4, s79
    s_mul_i32 s36, s7, 6144
    s_add_u32 s36, s36, 67108864

    s_cmp_eq_u32 s78, 0
    s_cselect_b64 vcc, -1, 0
    s_lshr_b32 s6, s24, 1
    s_lshl_b32 s4, s6, 17
    s_add_u32 s4, s4, s34
    v_cndmask_b32 v4, v235, v236, vcc
    s_mul_i32 s5, s6, 1048576
    s_lshl_b32 s6, s78, 13
    buffer_store_dwordx4 v[188:191], v4, s[8:11], s4 offen sc1
    s_add_u32 s5, s5, s6
    s_add_u32 s5, s5, s35

    buffer_store_dwordx4 v[188:191], v238, s[8:11], s5 offen sc1
    s_add_u32 s5, s5, 262144
    buffer_store_dwordx4 v[188:191], v238, s[8:11], s5 offen sc1
    s_add_u32 s5, s5, 262144
    s_lshl_b32 s4, s25, 11
    s_lshl_b32 s5, s26, 6
    s_add_u32 s4, s4, s5
    s_lshl_b32 s5, s24, 21
    s_add_u32 s4, s4, s5
    v_lshrrev_b32 v4, 2, v1
    v_and_b32 v5, 3, v1
    v_lshlrev_b32 v5, 4, v5
    v_lshlrev_b32 v6, 13, v4
    v_add_u32 v6, v6, v5
    v_add_u32 v240, s4, v6
    s_lshl_b32 s4, s25, 2
    s_and_b32 s5, s24, 1
    s_lshl_b32 s5, s5, 1
    s_add_u32 s4, s4, s5
    s_lshr_b32 s5, s24, 1
    s_lshl_b32 s80, s5, 1
    s_lshl_b32 s4, s4, 19
    s_lshl_b32 s5, s63, 6
    s_add_u32 s4, s4, s5
    v_xor_b32 v224, 128, v240
    v_lshlrev_b32 v6, 11, v4
    v_add_u32 v6, v6, v5
    v_add_u32 v241, s4, v6
    s_lshl_b32 s98, s24, 15
    s_waitcnt lgkmcnt(0)

    s_add_u32 s80, s80, s79
    s_add_u32 s81, s80, 2
    s_add_u32 s80, s80, 1
    s_and_b32 s80, s80, 3
    s_and_b32 s81, s81, 3
    s_lshl_b32 s80, s80, 18
    s_lshl_b32 s81, s81, 18

    s_barrier
    s_bitcmp1_b32 s26, 0
    s_cbranch_scc1 .po_7
    s_mov_b32 s16, s44
    s_and_b32 s17, s45, 0xffff
    s_mov_b32 s18, 0x800000
    s_mov_b32 s19, 0x00020000

    s_add_u32 m0, s98, 0
    s_mov_b32 s5, 0
    buffer_load_dwordx4 v240, s[16:19], s5 offen  lds

    s_add_u32 m0, s98, 1024
    s_mov_b32 s5, 131072
    buffer_load_dwordx4 v240, s[16:19], s5 offen  lds

    s_add_u32 m0, s98, 2048
    s_mov_b32 s5, 262144
    buffer_load_dwordx4 v240, s[16:19], s5 offen  lds

    s_add_u32 m0, s98, 3072
    s_mov_b32 s5, 393216
    buffer_load_dwordx4 v240, s[16:19], s5 offen  lds

    s_add_u32 m0, s98, 4096
    s_mov_b32 s5, 524288
    buffer_load_dwordx4 v240, s[16:19], s5 offen  lds

    s_add_u32 m0, s98, 5120
    s_mov_b32 s5, 655360
    buffer_load_dwordx4 v240, s[16:19], s5 offen  lds

    s_add_u32 m0, s98, 6144
    s_mov_b32 s5, 786432
    buffer_load_dwordx4 v240, s[16:19], s5 offen  lds

    s_add_u32 m0, s98, 7168
    s_mov_b32 s5, 917504
    buffer_load_dwordx4 v240, s[16:19], s5 offen  lds

    s_branch .pj_8
.po_7:
    s_mov_b32 s16, s44
    s_and_b32 s17, s45, 0xffff
    s_mov_b32 s18, 0x800000
    s_mov_b32 s19, 0x00020000

    s_add_u32 m0, s98, 8192
    s_mov_b32 s5, 1048576
    buffer_load_dwordx4 v240, s[16:19], s5 offen  lds

    s_add_u32 m0, s98, 9216
    s_mov_b32 s5, 1179648
    buffer_load_dwordx4 v240, s[16:19], s5 offen  lds

    s_add_u32 m0, s98, 10240
    s_mov_b32 s5, 1310720
    buffer_load_dwordx4 v240, s[16:19], s5 offen  lds

    s_add_u32 m0, s98, 11264
    s_mov_b32 s5, 1441792
    buffer_load_dwordx4 v240, s[16:19], s5 offen  lds

    s_add_u32 m0, s98, 12288
    s_mov_b32 s5, 1572864
    buffer_load_dwordx4 v240, s[16:19], s5 offen  lds

    s_add_u32 m0, s98, 13312
    s_mov_b32 s5, 1703936
    buffer_load_dwordx4 v240, s[16:19], s5 offen  lds

    s_add_u32 m0, s98, 14336
    s_mov_b32 s5, 1835008
    buffer_load_dwordx4 v240, s[16:19], s5 offen  lds

    s_add_u32 m0, s98, 15360
    s_mov_b32 s5, 1966080
    buffer_load_dwordx4 v240, s[16:19], s5 offen  lds

.pj_8:
    s_waitcnt vmcnt(8)
    s_barrier
    v_mov_b32 v243, s99
    v_mov_b32 v242, 0
    s_cmp_lg_u32 s24, 3
    s_cbranch_scc1 .a1_9
    v_mov_b32 v242, s26
    v_lshlrev_b32 v242, 6, v242
    v_add_u32 v242, s97, v242
    v_and_b32 v242, 255, v242
    s_mov_b64 exec, 1
    buffer_atomic_add v243, v242, s[20:23], 0 offen sc1
    s_mov_b64 exec, -1

.a1_9:
    s_bitcmp1_b32 s26, 0
    s_cbranch_scc1 .po_11
    s_add_u32 m0, s98, 8192
    s_mov_b32 s5, 1048576
    buffer_load_dwordx4 v240, s[16:19], s5 offen  lds

    s_add_u32 m0, s98, 9216
    s_mov_b32 s5, 1179648
    buffer_load_dwordx4 v240, s[16:19], s5 offen  lds

    s_add_u32 m0, s98, 10240
    s_mov_b32 s5, 1310720
    buffer_load_dwordx4 v240, s[16:19], s5 offen  lds

    s_add_u32 m0, s98, 11264
    s_mov_b32 s5, 1441792
    buffer_load_dwordx4 v240, s[16:19], s5 offen  lds

    s_add_u32 m0, s98, 12288
    s_mov_b32 s5, 1572864
    buffer_load_dwordx4 v240, s[16:19], s5 offen  lds

    s_add_u32 m0, s98, 13312
    s_mov_b32 s5, 1703936
    buffer_load_dwordx4 v240, s[16:19], s5 offen  lds

    s_add_u32 m0, s98, 14336
    s_mov_b32 s5, 1835008
    buffer_load_dwordx4 v240, s[16:19], s5 offen  lds

    s_add_u32 m0, s98, 15360
    s_mov_b32 s5, 1966080
    buffer_load_dwordx4 v240, s[16:19], s5 offen  lds

    s_mov_b32 s16, s46
    s_and_b32 s17, s47, 0xffff
    s_mov_b32 s18, 0x800000
    s_mov_b32 s19, 0x00020000

    s_add_u32 m0, s98, 16384
    s_mov_b32 s5, 0
    buffer_load_dwordx4 v240, s[16:19], s5 offen  lds

    s_add_u32 m0, s98, 17408
    s_mov_b32 s5, 131072
    buffer_load_dwordx4 v240, s[16:19], s5 offen  lds

    s_add_u32 m0, s98, 18432
    s_mov_b32 s5, 262144
    buffer_load_dwordx4 v240, s[16:19], s5 offen  lds

    s_add_u32 m0, s98, 19456
    s_mov_b32 s5, 393216
    buffer_load_dwordx4 v240, s[16:19], s5 offen  lds

    s_add_u32 m0, s98, 20480
    s_mov_b32 s5, 524288
    buffer_load_dwordx4 v240, s[16:19], s5 offen  lds

    s_add_u32 m0, s98, 21504
    s_mov_b32 s5, 655360
    buffer_load_dwordx4 v240, s[16:19], s5 offen  lds

    s_add_u32 m0, s98, 22528
    s_mov_b32 s5, 786432
    buffer_load_dwordx4 v240, s[16:19], s5 offen  lds

    s_add_u32 m0, s98, 23552
    s_mov_b32 s5, 917504
    buffer_load_dwordx4 v240, s[16:19], s5 offen  lds

    s_add_u32 m0, s98, 24576
    s_mov_b32 s5, 1048576
    buffer_load_dwordx4 v240, s[16:19], s5 offen  lds

    s_add_u32 m0, s98, 25600
    s_mov_b32 s5, 1179648
    buffer_load_dwordx4 v240, s[16:19], s5 offen  lds

    s_add_u32 m0, s98, 26624
    s_mov_b32 s5, 1310720
    buffer_load_dwordx4 v240, s[16:19], s5 offen  lds

    s_add_u32 m0, s98, 27648
    s_mov_b32 s5, 1441792
    buffer_load_dwordx4 v240, s[16:19], s5 offen  lds

    s_add_u32 m0, s98, 28672
    s_mov_b32 s5, 1572864
    buffer_load_dwordx4 v240, s[16:19], s5 offen  lds

    s_add_u32 m0, s98, 29696
    s_mov_b32 s5, 1703936
    buffer_load_dwordx4 v240, s[16:19], s5 offen  lds

    s_add_u32 m0, s98, 30720
    s_mov_b32 s5, 1835008
    buffer_load_dwordx4 v240, s[16:19], s5 offen  lds

    s_add_u32 m0, s98, 31744
    s_mov_b32 s5, 1966080
    buffer_load_dwordx4 v240, s[16:19], s5 offen  lds

    s_branch .pj_12
.po_11:
    s_add_u32 m0, s98, 0
    s_mov_b32 s5, 0
    buffer_load_dwordx4 v240, s[16:19], s5 offen  lds

    s_add_u32 m0, s98, 1024
    s_mov_b32 s5, 131072
    buffer_load_dwordx4 v240, s[16:19], s5 offen  lds

    s_add_u32 m0, s98, 2048
    s_mov_b32 s5, 262144
    buffer_load_dwordx4 v240, s[16:19], s5 offen  lds

    s_add_u32 m0, s98, 3072
    s_mov_b32 s5, 393216
    buffer_load_dwordx4 v240, s[16:19], s5 offen  lds

    s_add_u32 m0, s98, 4096
    s_mov_b32 s5, 524288
    buffer_load_dwordx4 v240, s[16:19], s5 offen  lds

    s_add_u32 m0, s98, 5120
    s_mov_b32 s5, 655360
    buffer_load_dwordx4 v240, s[16:19], s5 offen  lds

    s_add_u32 m0, s98, 6144
    s_mov_b32 s5, 786432
    buffer_load_dwordx4 v240, s[16:19], s5 offen  lds

    s_add_u32 m0, s98, 7168
    s_mov_b32 s5, 917504
    buffer_load_dwordx4 v240, s[16:19], s5 offen  lds

    s_mov_b32 s16, s46
    s_and_b32 s17, s47, 0xffff
    s_mov_b32 s18, 0x800000
    s_mov_b32 s19, 0x00020000

    s_add_u32 m0, s98, 24576
    s_mov_b32 s5, 1048576
    buffer_load_dwordx4 v240, s[16:19], s5 offen  lds

    s_add_u32 m0, s98, 25600
    s_mov_b32 s5, 1179648
    buffer_load_dwordx4 v240, s[16:19], s5 offen  lds

    s_add_u32 m0, s98, 26624
    s_mov_b32 s5, 1310720
    buffer_load_dwordx4 v240, s[16:19], s5 offen  lds

    s_add_u32 m0, s98, 27648
    s_mov_b32 s5, 1441792
    buffer_load_dwordx4 v240, s[16:19], s5 offen  lds

    s_add_u32 m0, s98, 28672
    s_mov_b32 s5, 1572864
    buffer_load_dwordx4 v240, s[16:19], s5 offen  lds

    s_add_u32 m0, s98, 29696
    s_mov_b32 s5, 1703936
    buffer_load_dwordx4 v240, s[16:19], s5 offen  lds

    s_add_u32 m0, s98, 30720
    s_mov_b32 s5, 1835008
    buffer_load_dwordx4 v240, s[16:19], s5 offen  lds

    s_add_u32 m0, s98, 31744
    s_mov_b32 s5, 1966080
    buffer_load_dwordx4 v240, s[16:19], s5 offen  lds

    s_add_u32 m0, s98, 16384
    s_mov_b32 s5, 0
    buffer_load_dwordx4 v240, s[16:19], s5 offen  lds

    s_add_u32 m0, s98, 17408
    s_mov_b32 s5, 131072
    buffer_load_dwordx4 v240, s[16:19], s5 offen  lds

    s_add_u32 m0, s98, 18432
    s_mov_b32 s5, 262144
    buffer_load_dwordx4 v240, s[16:19], s5 offen  lds

    s_add_u32 m0, s98, 19456
    s_mov_b32 s5, 393216
    buffer_load_dwordx4 v240, s[16:19], s5 offen  lds

    s_add_u32 m0, s98, 20480
    s_mov_b32 s5, 524288
    buffer_load_dwordx4 v240, s[16:19], s5 offen  lds

    s_add_u32 m0, s98, 21504
    s_mov_b32 s5, 655360
    buffer_load_dwordx4 v240, s[16:19], s5 offen  lds

    s_add_u32 m0, s98, 22528
    s_mov_b32 s5, 786432
    buffer_load_dwordx4 v240, s[16:19], s5 offen  lds

    s_add_u32 m0, s98, 23552
    s_mov_b32 s5, 917504
    buffer_load_dwordx4 v240, s[16:19], s5 offen  lds

.pj_12:
    s_mov_b32 s12, s40
    s_and_b32 s13, s41, 0xffff
    s_mov_b32 s14, 0x4000
    s_mov_b32 s15, 0x00020000

    v_bfe_u32 v4, v2, 2, 1
    v_lshrrev_b32 v5, 3, v2
    v_lshrrev_b32 v8, 1, v3
    v_and_b32 v9, 1, v3
    v_lshl_add_u32 v6, v5, 3, v4
    v_lshl_add_u32 v6, v8, 4, v6
    v_lshl_add_u32 v6, v9, 2, v6
    v_lshl_add_u32 v7, v5, 2, v4
    v_lshl_add_u32 v7, v8, 3, v7
    v_lshl_add_u32 v7, v9, 4, v7
    v_and_b32 v5, 3, v2
    v_lshlrev_b32 v5, 3, v5
    v_lshl_add_u32 v6, v6, 6, v5
    v_lshl_add_u32 v7, v7, 6, v5
    v_add_u32 v254, s98, v6
    v_add_u32 v255, s98, v7
    v_sub_u32 v252, v254, v5
    v_and_b32 v5, 1, v2
    v_lshl_add_u32 v252, v5, 5, v252
    v_bfe_u32 v5, v2, 1, 1
    v_lshl_add_u32 v252, v5, 3, v252

    s_and_b32 s96, s26, 3
    s_lshl_b32 s4, s25, 3
    s_add_u32 s7, s4, s79
    s_mul_i32 s5, s24, 5120
    v_add_u32 v8, s5, v14
    v_and_b32 v5, 7, v2
    v_lshrrev_b32 v6, 1, v3
    v_and_b32 v7, 1, v3
    v_lshlrev_b32 v7, 3, v7
    v_lshlrev_b32 v17, 11, v5
    v_lshl_add_u32 v17, v3, 5, v17
    v_lshrrev_b32 v4, 3, v2
    v_lshl_add_u32 v17, v4, 4, v17
    s_lshl_b32 s5, s24, 9
    v_add_u32 v17, s5, v17

    buffer_load_dwordx4 v[20:23], v17, s[12:15], 0 offen offset:0
    buffer_load_dwordx4 v[24:27], v17, s[12:15], 0 offen offset:128
    buffer_load_dwordx4 v[28:31], v17, s[12:15], 0 offen offset:256
    buffer_load_dwordx4 v[32:35], v17, s[12:15], 0 offen offset:384
    v_lshlrev_b32 v4, 7, v2
    v_lshl_add_u32 v18, s26, 10, v4
    v_add_u32 v18, 40960, v18
    v_and_b32 v4, 0x180, v4
    v_add_u32 v4, s76, v4
    v_bfe_u32 v19, v2, 2, 1
    s_sub_u32 s4, s77, s76
    v_mad_u32_u24 v4, v19, s4, v4
    v_cmp_gt_u32 vcc, 8, v2
    s_lshl_b32 s4, s24, 17
    s_add_u32 s4, s4, s34
    v_cndmask_b32 v4, v4, v18, vcc
    s_mov_b64 exec, 0xffff
    buffer_load_dword v227, v4, s[8:11], s4 offen
    s_mov_b64 exec, -1

    s_lshl_b32 s4, s79, 12
    s_add_u32 s4, s4, 40960

    s_add_u32 s5, s96, 1
    s_and_b32 s5, s5, 3
    s_lshl_b32 s5, s5, 10
    s_add_u32 s5, s5, s4
    v_add_u32 v232, s5, v14

    s_add_u32 s5, s96, 2
    s_and_b32 s5, s5, 3
    s_lshl_b32 s5, s5, 10
    s_add_u32 s5, s5, s4
    v_add_u32 v233, s5, v14

    s_add_u32 s5, s96, 3
    s_and_b32 s5, s5, 3
    s_lshl_b32 s5, s5, 10
    s_add_u32 s5, s5, s4
    v_add_u32 v234, s5, v14

    s_lshl_b32 s5, s78, 9
    v_lshlrev_b32 v10, 8, v6
    v_lshl_add_u32 v10, v2, 4, v10
    v_add_u32 v10, v10, v7
    v_add_u32 v10, s5, v10
    v_add_u32 v18, 16384, v10
    s_lshl_b32 s5, s26, 10
    s_add_u32 s5, s5, 40960
    v_add_u32 v10, s5, v10
    v_lshlrev_b32 v11, 8, v3
    v_lshl_add_u32 v11, v5, 4, v11
    s_lshr_b32 s4, s96, 1
    s_lshl_b32 s4, s4, 10
    s_and_b32 s5, s96, 1
    s_lshl_b32 s5, s5, 7
    s_add_u32 s4, s4, s5
    s_add_u32 s4, s4, 2048
    v_add_u32 v11, s4, v11
    v_lshlrev_b32 v12, 8, v6
    v_lshl_add_u32 v12, v2, 4, v12
    s_lshl_b32 s4, s96, 9
    s_xor_b32 s4, s4, 5120
    v_add_u32 v12, s4, v12
    v_lshlrev_b32 v13, 7, v3
    v_lshl_add_u32 v13, v5, 4, v13
    v_add_u32 v13, s77, v13
    v_lshlrev_b32 v15, 7, v6
    v_lshl_add_u32 v15, v5, 4, v15
    v_add_u32 v15, v15, v7
    s_lshl_b32 s5, s78, 8
    s_add_u32 s5, s5, s76
    v_add_u32 v15, s5, v15
    v_lshlrev_b32 v16, 8, v6
    v_lshl_add_u32 v16, v2, 4, v16
    v_add_u32 v16, v16, v7
    s_lshl_b32 s5, s24, 9
    v_add_u32 v16, s5, v16
    s_lshl_b32 s5, s24, 11
    v_add_u32 v17, s5, v14
    v_cmp_gt_u32 s[58:59], 8, v2
    v_cmp_gt_u32 s[60:61], 32, v1
    v_mov_b32 v4, 0x4444
    v_mov_b32 v9, 0xeeee
    v_cndmask_b32 v9, v9, v4, s[58:59]
    s_not_b64 s[66:67], s[58:59]
    s_cmp_lt_u32 s24, 2
    s_cselect_b64 s[64:65], s[66:67], s[58:59]
    s_mov_b32 s56, 0x0000ffff
    s_mov_b32 s57, 0x0000ffff
    s_cmp_eq_u32 s24, 1
    s_cselect_b64 vcc, -1, 0
    s_cselect_b64 s[66:67], s[56:57], s[66:67]
    s_lshl_b32 s5, s78, 10
    v_add_u32 v19, s5, v14
    v_cndmask_b32 v11, v11, v12, vcc
    v_cndmask_b32 v235, v235, v236, vcc
    v_mov_b32 v4, 0xff800000
    v_cndmask_b32 v116, 0, v4, s[60:61]
    v_mov_b32 v117, v116
    v_mov_b32 v118, v116
    v_mov_b32 v119, v116
    s_mul_i32 s5, s78, 8192
    v_add_u32 v246, s5, v14
    v_lshlrev_b32 v247, 9, v6
    v_lshl_add_u32 v247, v2, 4, v247
    s_lshl_b32 s5, s78, 8
    s_add_u32 s5, s5, 12288
    v_add_u32 v247, s5, v247
    v_and_b32 v4, 31, v1
    v_lshlrev_b32 v248, 4, v4
    s_lshl_b32 s5, s78, 9
    s_add_u32 s5, s5, 12288
    v_add_u32 v248, s5, v248
    s_lshl_b32 s5, s25, 16
    v_and_b32 v7, 1, v3
    v_lshlrev_b32 v237, 18, v7
    v_lshl_add_u32 v237, v6, 8, v237
    v_lshl_add_u32 v237, v2, 4, v237
    v_add_u32 v237, s5, v237
    s_lshl_b32 s6, s78, 9
    v_add_u32 v237, s6, v237
    s_lshl_b32 s6, s78, 8
    v_lshlrev_b32 v249, 9, v7
    v_lshl_add_u32 v249, v2, 4, v249
    v_add_u32 v249, s6, v249
    v_add_u32 v4, s25, v6
    v_add_u32 v4, 1, v4
    v_and_b32 v4, 3, v4
    v_lshl_add_u32 v239, v4, 16, v249
    s_add_u32 s6, s25, 3
    s_and_b32 s6, s6, 3
    s_lshl_b32 s6, s6, 16
    v_add_u32 v249, s6, v249
    v_and_b32 v4, 1, v5
    v_lshlrev_b32 v4, 4, v4
    v_mov_b32 v6, 0x3f80
    v_lshlrev_b32 v6, v4, v6
    v_lshrrev_b32 v4, 1, v5

    v_cmp_eq_u32 vcc, 0, v4
    s_nop 1
    v_cndmask_b32 v84, 0, v6, vcc
    v_cmp_eq_u32 vcc, 1, v4
    s_nop 1
    v_cndmask_b32 v85, 0, v6, vcc
    v_cmp_eq_u32 vcc, 2, v4
    s_nop 1
    v_cndmask_b32 v86, 0, v6, vcc
    v_cmp_eq_u32 vcc, 3, v4
    s_nop 1
    v_cndmask_b32 v87, 0, v6, vcc
    v_mov_b32 v120, 0x3f803f80
    v_cndmask_b32 v112, 0, v84, s[60:61]
    v_mov_b32 v121, 0x3f803f80
    v_cndmask_b32 v113, 0, v85, s[60:61]
    v_mov_b32 v122, 0x3f803f80
    v_cndmask_b32 v114, 0, v86, s[60:61]
    v_mov_b32 v123, 0x3f803f80
    v_cndmask_b32 v115, 0, v87, s[60:61]
    v_mov_b32 v170, 0
    v_mov_b32 v171, 0
    v_mov_b32 v174, 0
    v_mov_b32 v175, 0
    v_mov_b32 v182, 0
    v_mov_b32 v183, 0
    s_add_u32 s5, s96, 0
    s_and_b32 s5, s5, 3
    s_lshl_b32 s5, s5, 10
    s_add_u32 s5, s5, 20480
    v_add_u32 v228, s5, v14

    s_add_u32 s5, s96, 1
    s_and_b32 s5, s5, 3
    s_lshl_b32 s5, s5, 10
    s_add_u32 s5, s5, 20480
    v_add_u32 v229, s5, v14

    s_add_u32 s5, s96, 2
    s_and_b32 s5, s5, 3
    s_lshl_b32 s5, s5, 10
    s_add_u32 s5, s5, 20480
    v_add_u32 v230, s5, v14

    s_add_u32 s5, s96, 3
    s_and_b32 s5, s5, 3
    s_lshl_b32 s5, s5, 10
    s_add_u32 s5, s5, 20480
    v_add_u32 v231, s5, v14

    s_lshl_b32 s89, s7, 8
    s_add_u32 s89, s89, 92282880
    v_lshlrev_b32 v253, 13, v1
    s_lshl_b32 s4, s7, 13
    s_add_u32 s38, s4, 16777216
    s_lshl_b32 s5, s96, 11
    s_add_u32 s39, s4, s5
    s_add_u32 s30, s39, 17039360
    s_xor_b32 s39, s39, 4096
    s_add_u32 s39, s39, 33554432
    s_lshl_b32 s5, s78, 24
    s_add_u32 s30, s30, s5
    s_lshl_b32 s5, s78, 12
    s_add_u32 s38, s38, s5
    s_add_u32 s90, s5, 20480
    s_lshl_b32 s5, s78, 10
    s_add_u32 s39, s39, s5
    s_add_u32 s91, s5, 28672
    s_mov_b32 s37, 0x3e0293ee
    s_mov_b32 s28, 0

    v_and_b32 v4, 31, v1
    v_lshlrev_b32 v225, 6, v4
    v_lshrrev_b32 v4, 5, v1
    v_lshl_add_u32 v225, v4, 24, v225

    v_mov_b32 v52, 0
    v_mov_b32 v53, 0
    v_mov_b32 v54, 0
    v_mov_b32 v55, 0
    v_mov_b32 v56, 0
    v_mov_b32 v57, 0
    v_mov_b32 v58, 0
    v_mov_b32 v59, 0
    v_mov_b32 v60, 0
    v_mov_b32 v61, 0
    v_mov_b32 v62, 0
    v_mov_b32 v63, 0
    v_mov_b32 v64, 0
    v_mov_b32 v65, 0
    v_mov_b32 v66, 0
    v_mov_b32 v67, 0
    v_mov_b32 v68, 0
    v_mov_b32 v69, 0
    v_mov_b32 v70, 0
    v_mov_b32 v71, 0
    v_mov_b32 v72, 0
    v_mov_b32 v73, 0
    v_mov_b32 v74, 0
    v_mov_b32 v75, 0
    v_mov_b32 v76, 0
    v_mov_b32 v77, 0
    v_mov_b32 v78, 0
    v_mov_b32 v79, 0
    v_mov_b32 v80, 0
    v_mov_b32 v81, 0
    v_mov_b32 v82, 0
    v_mov_b32 v83, 0
    v_mov_b32 v92, -1
    v_mov_b32 v93, -1
    v_mov_b32 v94, -1
    v_mov_b32 v95, -1
    v_mov_b32 v96, -1
    v_mov_b32 v97, -1
    v_mov_b32 v98, -1
    v_mov_b32 v99, -1
    v_mov_b32 v100, -1
    v_mov_b32 v101, -1
    v_mov_b32 v102, -1
    v_mov_b32 v103, -1
    v_mov_b32 v192, -1
    v_mov_b32 v193, -1
    v_mov_b32 v194, -1
    v_mov_b32 v195, -1
    v_mov_b32 v196, -1
    v_mov_b32 v197, -1
    v_mov_b32 v198, -1
    v_mov_b32 v199, -1
    v_mov_b32 v200, -1
    v_mov_b32 v201, -1
    v_mov_b32 v202, -1
    v_mov_b32 v203, -1
    v_mov_b32 v204, -1
    v_mov_b32 v205, -1
    v_mov_b32 v206, -1
    v_mov_b32 v207, -1
    v_mov_b32 v208, -1
    v_mov_b32 v209, -1
    v_mov_b32 v210, -1
    v_mov_b32 v211, -1
    v_mov_b32 v212, -1
    v_mov_b32 v213, -1
    v_mov_b32 v214, -1
    v_mov_b32 v215, -1
    v_mov_b32 v216, -1
    v_mov_b32 v217, -1
    v_mov_b32 v218, -1
    v_mov_b32 v219, -1
    v_mov_b32 v220, -1
    v_mov_b32 v221, -1
    v_mov_b32 v222, -1
    v_mov_b32 v223, -1
    s_bitcmp1_b32 s26, 0
    s_cbranch_scc1 .po_13
    s_waitcnt vmcnt(29)
    ds_read_b64_tr_b16 a[0:1], v252 offset:0
    ds_read_b64_tr_b16 a[2:3], v252 offset:128
    ds_read_b64_tr_b16 a[4:5], v252 offset:2048
    ds_read_b64_tr_b16 a[6:7], v252 offset:2176
    ds_read_b64_tr_b16 a[8:9], v252 offset:4096
    ds_read_b64_tr_b16 a[10:11], v252 offset:4224
    ds_read_b64_tr_b16 a[12:13], v252 offset:6144
    ds_read_b64_tr_b16 a[14:15], v252 offset:6272
    ds_read_b64_tr_b16 a[32:33], v252 offset:16
    ds_read_b64_tr_b16 a[34:35], v252 offset:144
    ds_read_b64_tr_b16 a[36:37], v252 offset:2064
    ds_read_b64_tr_b16 a[38:39], v252 offset:2192
    ds_read_b64_tr_b16 a[40:41], v252 offset:4112
    ds_read_b64_tr_b16 a[42:43], v252 offset:4240
    ds_read_b64_tr_b16 a[44:45], v252 offset:6160
    ds_read_b64_tr_b16 a[46:47], v252 offset:6288
    s_waitcnt lgkmcnt(0)
    s_mov_b32 s16, s48
    s_and_b32 s17, s49, 0xffff
    s_mov_b32 s18, 0x800000
    s_mov_b32 s19, 0x00020000

    s_add_u32 m0, s98, 0
    s_mov_b32 s5, 0
    buffer_load_dwordx4 v224, s[16:19], s5 offen  lds

    s_add_u32 m0, s98, 1024
    s_mov_b32 s5, 131072
    buffer_load_dwordx4 v224, s[16:19], s5 offen  lds

    s_add_u32 m0, s98, 2048
    s_mov_b32 s5, 262144
    buffer_load_dwordx4 v224, s[16:19], s5 offen  lds

    s_add_u32 m0, s98, 3072
    s_mov_b32 s5, 393216
    buffer_load_dwordx4 v224, s[16:19], s5 offen  lds

    s_add_u32 m0, s98, 4096
    s_mov_b32 s5, 524288
    buffer_load_dwordx4 v224, s[16:19], s5 offen  lds

    s_add_u32 m0, s98, 5120
    s_mov_b32 s5, 655360
    buffer_load_dwordx4 v224, s[16:19], s5 offen  lds

    s_add_u32 m0, s98, 6144
    s_mov_b32 s5, 786432
    buffer_load_dwordx4 v224, s[16:19], s5 offen  lds

    s_add_u32 m0, s98, 7168
    s_mov_b32 s5, 917504
    buffer_load_dwordx4 v224, s[16:19], s5 offen  lds

    s_waitcnt vmcnt(29)
    ds_read_b64_tr_b16 a[16:17], v252 offset:8192
    ds_read_b64_tr_b16 a[18:19], v252 offset:8320
    ds_read_b64_tr_b16 a[20:21], v252 offset:10240
    ds_read_b64_tr_b16 a[22:23], v252 offset:10368
    ds_read_b64_tr_b16 a[24:25], v252 offset:12288
    ds_read_b64_tr_b16 a[26:27], v252 offset:12416
    ds_read_b64_tr_b16 a[28:29], v252 offset:14336
    ds_read_b64_tr_b16 a[30:31], v252 offset:14464
    ds_read_b64_tr_b16 a[48:49], v252 offset:8208
    ds_read_b64_tr_b16 a[50:51], v252 offset:8336
    ds_read_b64_tr_b16 a[52:53], v252 offset:10256
    ds_read_b64_tr_b16 a[54:55], v252 offset:10384
    ds_read_b64_tr_b16 a[56:57], v252 offset:12304
    ds_read_b64_tr_b16 a[58:59], v252 offset:12432
    ds_read_b64_tr_b16 a[60:61], v252 offset:14352
    ds_read_b64_tr_b16 a[62:63], v252 offset:14480
    s_waitcnt lgkmcnt(0)
    s_add_u32 m0, s98, 8192
    s_mov_b32 s5, 1048576
    buffer_load_dwordx4 v224, s[16:19], s5 offen  lds

    s_add_u32 m0, s98, 9216
    s_mov_b32 s5, 1179648
    buffer_load_dwordx4 v224, s[16:19], s5 offen  lds

    s_add_u32 m0, s98, 10240
    s_mov_b32 s5, 1310720
    buffer_load_dwordx4 v224, s[16:19], s5 offen  lds

    s_add_u32 m0, s98, 11264
    s_mov_b32 s5, 1441792
    buffer_load_dwordx4 v224, s[16:19], s5 offen  lds

    s_add_u32 m0, s98, 12288
    s_mov_b32 s5, 1572864
    buffer_load_dwordx4 v224, s[16:19], s5 offen  lds

    s_add_u32 m0, s98, 13312
    s_mov_b32 s5, 1703936
    buffer_load_dwordx4 v224, s[16:19], s5 offen  lds

    s_add_u32 m0, s98, 14336
    s_mov_b32 s5, 1835008
    buffer_load_dwordx4 v224, s[16:19], s5 offen  lds

    s_add_u32 m0, s98, 15360
    s_mov_b32 s5, 1966080
    buffer_load_dwordx4 v224, s[16:19], s5 offen  lds

    s_waitcnt vmcnt(29)
    ds_read_b64_tr_b16 a[64:65], v252 offset:16384
    ds_read_b64_tr_b16 a[66:67], v252 offset:16512
    ds_read_b64_tr_b16 a[68:69], v252 offset:18432
    ds_read_b64_tr_b16 a[70:71], v252 offset:18560
    ds_read_b64_tr_b16 a[72:73], v252 offset:20480
    ds_read_b64_tr_b16 a[74:75], v252 offset:20608
    ds_read_b64_tr_b16 a[76:77], v252 offset:22528
    ds_read_b64_tr_b16 a[78:79], v252 offset:22656
    ds_read_b64_tr_b16 a[96:97], v252 offset:16400
    ds_read_b64_tr_b16 a[98:99], v252 offset:16528
    ds_read_b64_tr_b16 a[100:101], v252 offset:18448
    ds_read_b64_tr_b16 a[102:103], v252 offset:18576
    ds_read_b64_tr_b16 a[104:105], v252 offset:20496
    ds_read_b64_tr_b16 a[106:107], v252 offset:20624
    ds_read_b64_tr_b16 a[108:109], v252 offset:22544
    ds_read_b64_tr_b16 a[110:111], v252 offset:22672
    s_waitcnt lgkmcnt(0)
    s_mov_b32 s16, s50
    s_and_b32 s17, s51, 0xffff
    s_mov_b32 s18, 0x800000
    s_mov_b32 s19, 0x00020000

    s_add_u32 m0, s98, 16384
    s_add_u32 s5, s80, 0
    buffer_load_dwordx4 v241, s[16:19], s5 offen  lds

    s_add_u32 m0, s98, 17408
    s_add_u32 s5, s80, 32768
    buffer_load_dwordx4 v241, s[16:19], s5 offen  lds

    s_add_u32 m0, s98, 18432
    s_add_u32 s5, s80, 65536
    buffer_load_dwordx4 v241, s[16:19], s5 offen  lds

    s_add_u32 m0, s98, 19456
    s_add_u32 s5, s80, 98304
    buffer_load_dwordx4 v241, s[16:19], s5 offen  lds

    s_add_u32 m0, s98, 20480
    s_add_u32 s5, s80, 131072
    buffer_load_dwordx4 v241, s[16:19], s5 offen  lds

    s_add_u32 m0, s98, 21504
    s_add_u32 s5, s80, 163840
    buffer_load_dwordx4 v241, s[16:19], s5 offen  lds

    s_add_u32 m0, s98, 22528
    s_add_u32 s5, s80, 196608
    buffer_load_dwordx4 v241, s[16:19], s5 offen  lds

    s_add_u32 m0, s98, 23552
    s_add_u32 s5, s80, 229376
    buffer_load_dwordx4 v241, s[16:19], s5 offen  lds

    s_waitcnt vmcnt(29)
    ds_read_b64_tr_b16 a[80:81], v252 offset:24576
    ds_read_b64_tr_b16 a[82:83], v252 offset:24704
    ds_read_b64_tr_b16 a[84:85], v252 offset:26624
    ds_read_b64_tr_b16 a[86:87], v252 offset:26752
    ds_read_b64_tr_b16 a[88:89], v252 offset:28672
    ds_read_b64_tr_b16 a[90:91], v252 offset:28800
    ds_read_b64_tr_b16 a[92:93], v252 offset:30720
    ds_read_b64_tr_b16 a[94:95], v252 offset:30848
    ds_read_b64_tr_b16 a[112:113], v252 offset:24592
    ds_read_b64_tr_b16 a[114:115], v252 offset:24720
    ds_read_b64_tr_b16 a[116:117], v252 offset:26640
    ds_read_b64_tr_b16 a[118:119], v252 offset:26768
    ds_read_b64_tr_b16 a[120:121], v252 offset:28688
    ds_read_b64_tr_b16 a[122:123], v252 offset:28816
    ds_read_b64_tr_b16 a[124:125], v252 offset:30736
    ds_read_b64_tr_b16 a[126:127], v252 offset:30864
    s_waitcnt lgkmcnt(0)
    s_add_u32 m0, s98, 24576
    s_add_u32 s5, s81, 0
    buffer_load_dwordx4 v241, s[16:19], s5 offen  lds

    s_add_u32 m0, s98, 25600
    s_add_u32 s5, s81, 32768
    buffer_load_dwordx4 v241, s[16:19], s5 offen  lds

    s_add_u32 m0, s98, 26624
    s_add_u32 s5, s81, 65536
    buffer_load_dwordx4 v241, s[16:19], s5 offen  lds

    s_add_u32 m0, s98, 27648
    s_add_u32 s5, s81, 98304
    buffer_load_dwordx4 v241, s[16:19], s5 offen  lds

    s_add_u32 m0, s98, 28672
    s_add_u32 s5, s81, 131072
    buffer_load_dwordx4 v241, s[16:19], s5 offen  lds

    s_add_u32 m0, s98, 29696
    s_add_u32 s5, s81, 163840
    buffer_load_dwordx4 v241, s[16:19], s5 offen  lds

    s_add_u32 m0, s98, 30720
    s_add_u32 s5, s81, 196608
    buffer_load_dwordx4 v241, s[16:19], s5 offen  lds

    s_add_u32 m0, s98, 31744
    s_add_u32 s5, s81, 229376
    buffer_load_dwordx4 v241, s[16:19], s5 offen  lds

    v_and_b32 v241, 3, v0
    v_lshlrev_b32 v241, 2, v241

    v_and_b32 v240, 12, v0
    v_lshl_add_u32 v241, v240, 4, v241
    v_add_u32 v241, s97, v241
    v_and_b32 v241, 255, v241

    buffer_load_dword v240, v241, s[20:23], 0 offen sc1
    s_waitcnt vmcnt(25)
    ds_read_b64_tr_b16 a[128:129], v254 offset:0
    ds_read_b64_tr_b16 a[130:131], v254 offset:128
    ds_read_b64_tr_b16 a[132:133], v254 offset:2048
    ds_read_b64_tr_b16 a[134:135], v254 offset:2176
    ds_read_b64_tr_b16 a[136:137], v254 offset:4096
    ds_read_b64_tr_b16 a[138:139], v254 offset:4224
    ds_read_b64_tr_b16 a[140:141], v254 offset:6144
    ds_read_b64_tr_b16 a[142:143], v254 offset:6272
    ds_read_b64_tr_b16 a[160:161], v254 offset:32
    ds_read_b64_tr_b16 a[162:163], v254 offset:160
    ds_read_b64_tr_b16 a[164:165], v254 offset:2080
    ds_read_b64_tr_b16 a[166:167], v254 offset:2208
    ds_read_b64_tr_b16 a[168:169], v254 offset:4128
    ds_read_b64_tr_b16 a[170:171], v254 offset:4256
    ds_read_b64_tr_b16 a[172:173], v254 offset:6176
    ds_read_b64_tr_b16 a[174:175], v254 offset:6304
    s_waitcnt vmcnt(17)
    ds_read_b64_tr_b16 a[144:145], v254 offset:8192
    ds_read_b64_tr_b16 a[146:147], v254 offset:8320
    ds_read_b64_tr_b16 a[148:149], v254 offset:10240
    ds_read_b64_tr_b16 a[150:151], v254 offset:10368
    ds_read_b64_tr_b16 a[152:153], v254 offset:12288
    ds_read_b64_tr_b16 a[154:155], v254 offset:12416
    ds_read_b64_tr_b16 a[156:157], v254 offset:14336
    ds_read_b64_tr_b16 a[158:159], v254 offset:14464
    ds_read_b64_tr_b16 a[176:177], v254 offset:8224
    ds_read_b64_tr_b16 a[178:179], v254 offset:8352
    ds_read_b64_tr_b16 a[180:181], v254 offset:10272
    ds_read_b64_tr_b16 a[182:183], v254 offset:10400
    ds_read_b64_tr_b16 a[184:185], v254 offset:12320
    ds_read_b64_tr_b16 a[186:187], v254 offset:12448
    ds_read_b64_tr_b16 a[188:189], v254 offset:14368
    ds_read_b64_tr_b16 a[190:191], v254 offset:14496
    s_waitcnt vmcnt(9)
    ds_read_b64_tr_b16 a[192:193], v255 offset:16384
    ds_read_b64_tr_b16 a[194:195], v255 offset:16512
    ds_read_b64_tr_b16 a[196:197], v255 offset:18432
    ds_read_b64_tr_b16 a[198:199], v255 offset:18560
    ds_read_b64_tr_b16 a[200:201], v255 offset:20480
    ds_read_b64_tr_b16 a[202:203], v255 offset:20608
    ds_read_b64_tr_b16 a[204:205], v255 offset:22528
    ds_read_b64_tr_b16 a[206:207], v255 offset:22656
    ds_read_b64_tr_b16 a[224:225], v255 offset:16416
    ds_read_b64_tr_b16 a[226:227], v255 offset:16544
    ds_read_b64_tr_b16 a[228:229], v255 offset:18464
    ds_read_b64_tr_b16 a[230:231], v255 offset:18592
    ds_read_b64_tr_b16 a[232:233], v255 offset:20512
    ds_read_b64_tr_b16 a[234:235], v255 offset:20640
    ds_read_b64_tr_b16 a[236:237], v255 offset:22560
    ds_read_b64_tr_b16 a[238:239], v255 offset:22688
    s_waitcnt vmcnt(1)
    ds_read_b64_tr_b16 a[208:209], v255 offset:24576
    ds_read_b64_tr_b16 a[210:211], v255 offset:24704
    ds_read_b64_tr_b16 a[212:213], v255 offset:26624
    ds_read_b64_tr_b16 a[214:215], v255 offset:26752
    ds_read_b64_tr_b16 a[216:217], v255 offset:28672
    ds_read_b64_tr_b16 a[218:219], v255 offset:28800
    ds_read_b64_tr_b16 a[220:221], v255 offset:30720
    ds_read_b64_tr_b16 a[222:223], v255 offset:30848
    ds_read_b64_tr_b16 a[240:241], v255 offset:24608
    ds_read_b64_tr_b16 a[242:243], v255 offset:24736
    ds_read_b64_tr_b16 a[244:245], v255 offset:26656
    ds_read_b64_tr_b16 a[246:247], v255 offset:26784
    ds_read_b64_tr_b16 a[248:249], v255 offset:28704
    ds_read_b64_tr_b16 a[250:251], v255 offset:28832
    ds_read_b64_tr_b16 a[252:253], v255 offset:30752
    ds_read_b64_tr_b16 a[254:255], v255 offset:30880
    s_branch .pj_14
.po_13:
    s_waitcnt vmcnt(29)
    ds_read_b64_tr_b16 a[16:17], v252 offset:8192
    ds_read_b64_tr_b16 a[18:19], v252 offset:8320
    ds_read_b64_tr_b16 a[20:21], v252 offset:10240
    ds_read_b64_tr_b16 a[22:23], v252 offset:10368
    ds_read_b64_tr_b16 a[24:25], v252 offset:12288
    ds_read_b64_tr_b16 a[26:27], v252 offset:12416
    ds_read_b64_tr_b16 a[28:29], v252 offset:14336
    ds_read_b64_tr_b16 a[30:31], v252 offset:14464
    ds_read_b64_tr_b16 a[48:49], v252 offset:8208
    ds_read_b64_tr_b16 a[50:51], v252 offset:8336
    ds_read_b64_tr_b16 a[52:53], v252 offset:10256
    ds_read_b64_tr_b16 a[54:55], v252 offset:10384
    ds_read_b64_tr_b16 a[56:57], v252 offset:12304
    ds_read_b64_tr_b16 a[58:59], v252 offset:12432
    ds_read_b64_tr_b16 a[60:61], v252 offset:14352
    ds_read_b64_tr_b16 a[62:63], v252 offset:14480
    s_waitcnt lgkmcnt(0)
    s_mov_b32 s16, s48
    s_and_b32 s17, s49, 0xffff
    s_mov_b32 s18, 0x800000
    s_mov_b32 s19, 0x00020000

    s_add_u32 m0, s98, 8192
    s_mov_b32 s5, 1048576
    buffer_load_dwordx4 v224, s[16:19], s5 offen  lds

    s_add_u32 m0, s98, 9216
    s_mov_b32 s5, 1179648
    buffer_load_dwordx4 v224, s[16:19], s5 offen  lds

    s_add_u32 m0, s98, 10240
    s_mov_b32 s5, 1310720
    buffer_load_dwordx4 v224, s[16:19], s5 offen  lds

    s_add_u32 m0, s98, 11264
    s_mov_b32 s5, 1441792
    buffer_load_dwordx4 v224, s[16:19], s5 offen  lds

    s_add_u32 m0, s98, 12288
    s_mov_b32 s5, 1572864
    buffer_load_dwordx4 v224, s[16:19], s5 offen  lds

    s_add_u32 m0, s98, 13312
    s_mov_b32 s5, 1703936
    buffer_load_dwordx4 v224, s[16:19], s5 offen  lds

    s_add_u32 m0, s98, 14336
    s_mov_b32 s5, 1835008
    buffer_load_dwordx4 v224, s[16:19], s5 offen  lds

    s_add_u32 m0, s98, 15360
    s_mov_b32 s5, 1966080
    buffer_load_dwordx4 v224, s[16:19], s5 offen  lds

    s_waitcnt vmcnt(29)
    ds_read_b64_tr_b16 a[0:1], v252 offset:0
    ds_read_b64_tr_b16 a[2:3], v252 offset:128
    ds_read_b64_tr_b16 a[4:5], v252 offset:2048
    ds_read_b64_tr_b16 a[6:7], v252 offset:2176
    ds_read_b64_tr_b16 a[8:9], v252 offset:4096
    ds_read_b64_tr_b16 a[10:11], v252 offset:4224
    ds_read_b64_tr_b16 a[12:13], v252 offset:6144
    ds_read_b64_tr_b16 a[14:15], v252 offset:6272
    ds_read_b64_tr_b16 a[32:33], v252 offset:16
    ds_read_b64_tr_b16 a[34:35], v252 offset:144
    ds_read_b64_tr_b16 a[36:37], v252 offset:2064
    ds_read_b64_tr_b16 a[38:39], v252 offset:2192
    ds_read_b64_tr_b16 a[40:41], v252 offset:4112
    ds_read_b64_tr_b16 a[42:43], v252 offset:4240
    ds_read_b64_tr_b16 a[44:45], v252 offset:6160
    ds_read_b64_tr_b16 a[46:47], v252 offset:6288
    s_waitcnt lgkmcnt(0)
    s_add_u32 m0, s98, 0
    s_mov_b32 s5, 0
    buffer_load_dwordx4 v224, s[16:19], s5 offen  lds

    s_add_u32 m0, s98, 1024
    s_mov_b32 s5, 131072
    buffer_load_dwordx4 v224, s[16:19], s5 offen  lds

    s_add_u32 m0, s98, 2048
    s_mov_b32 s5, 262144
    buffer_load_dwordx4 v224, s[16:19], s5 offen  lds

    s_add_u32 m0, s98, 3072
    s_mov_b32 s5, 393216
    buffer_load_dwordx4 v224, s[16:19], s5 offen  lds

    s_add_u32 m0, s98, 4096
    s_mov_b32 s5, 524288
    buffer_load_dwordx4 v224, s[16:19], s5 offen  lds

    s_add_u32 m0, s98, 5120
    s_mov_b32 s5, 655360
    buffer_load_dwordx4 v224, s[16:19], s5 offen  lds

    s_add_u32 m0, s98, 6144
    s_mov_b32 s5, 786432
    buffer_load_dwordx4 v224, s[16:19], s5 offen  lds

    s_add_u32 m0, s98, 7168
    s_mov_b32 s5, 917504
    buffer_load_dwordx4 v224, s[16:19], s5 offen  lds

    s_waitcnt vmcnt(29)
    ds_read_b64_tr_b16 a[80:81], v252 offset:24576
    ds_read_b64_tr_b16 a[82:83], v252 offset:24704
    ds_read_b64_tr_b16 a[84:85], v252 offset:26624
    ds_read_b64_tr_b16 a[86:87], v252 offset:26752
    ds_read_b64_tr_b16 a[88:89], v252 offset:28672
    ds_read_b64_tr_b16 a[90:91], v252 offset:28800
    ds_read_b64_tr_b16 a[92:93], v252 offset:30720
    ds_read_b64_tr_b16 a[94:95], v252 offset:30848
    ds_read_b64_tr_b16 a[112:113], v252 offset:24592
    ds_read_b64_tr_b16 a[114:115], v252 offset:24720
    ds_read_b64_tr_b16 a[116:117], v252 offset:26640
    ds_read_b64_tr_b16 a[118:119], v252 offset:26768
    ds_read_b64_tr_b16 a[120:121], v252 offset:28688
    ds_read_b64_tr_b16 a[122:123], v252 offset:28816
    ds_read_b64_tr_b16 a[124:125], v252 offset:30736
    ds_read_b64_tr_b16 a[126:127], v252 offset:30864
    s_waitcnt lgkmcnt(0)
    s_mov_b32 s16, s50
    s_and_b32 s17, s51, 0xffff
    s_mov_b32 s18, 0x800000
    s_mov_b32 s19, 0x00020000

    s_add_u32 m0, s98, 24576
    s_add_u32 s5, s81, 0
    buffer_load_dwordx4 v241, s[16:19], s5 offen  lds

    s_add_u32 m0, s98, 25600
    s_add_u32 s5, s81, 32768
    buffer_load_dwordx4 v241, s[16:19], s5 offen  lds

    s_add_u32 m0, s98, 26624
    s_add_u32 s5, s81, 65536
    buffer_load_dwordx4 v241, s[16:19], s5 offen  lds

    s_add_u32 m0, s98, 27648
    s_add_u32 s5, s81, 98304
    buffer_load_dwordx4 v241, s[16:19], s5 offen  lds

    s_add_u32 m0, s98, 28672
    s_add_u32 s5, s81, 131072
    buffer_load_dwordx4 v241, s[16:19], s5 offen  lds

    s_add_u32 m0, s98, 29696
    s_add_u32 s5, s81, 163840
    buffer_load_dwordx4 v241, s[16:19], s5 offen  lds

    s_add_u32 m0, s98, 30720
    s_add_u32 s5, s81, 196608
    buffer_load_dwordx4 v241, s[16:19], s5 offen  lds

    s_add_u32 m0, s98, 31744
    s_add_u32 s5, s81, 229376
    buffer_load_dwordx4 v241, s[16:19], s5 offen  lds

    s_waitcnt vmcnt(29)
    ds_read_b64_tr_b16 a[64:65], v252 offset:16384
    ds_read_b64_tr_b16 a[66:67], v252 offset:16512
    ds_read_b64_tr_b16 a[68:69], v252 offset:18432
    ds_read_b64_tr_b16 a[70:71], v252 offset:18560
    ds_read_b64_tr_b16 a[72:73], v252 offset:20480
    ds_read_b64_tr_b16 a[74:75], v252 offset:20608
    ds_read_b64_tr_b16 a[76:77], v252 offset:22528
    ds_read_b64_tr_b16 a[78:79], v252 offset:22656
    ds_read_b64_tr_b16 a[96:97], v252 offset:16400
    ds_read_b64_tr_b16 a[98:99], v252 offset:16528
    ds_read_b64_tr_b16 a[100:101], v252 offset:18448
    ds_read_b64_tr_b16 a[102:103], v252 offset:18576
    ds_read_b64_tr_b16 a[104:105], v252 offset:20496
    ds_read_b64_tr_b16 a[106:107], v252 offset:20624
    ds_read_b64_tr_b16 a[108:109], v252 offset:22544
    ds_read_b64_tr_b16 a[110:111], v252 offset:22672
    s_waitcnt lgkmcnt(0)
    s_add_u32 m0, s98, 16384
    s_add_u32 s5, s80, 0
    buffer_load_dwordx4 v241, s[16:19], s5 offen  lds

    s_add_u32 m0, s98, 17408
    s_add_u32 s5, s80, 32768
    buffer_load_dwordx4 v241, s[16:19], s5 offen  lds

    s_add_u32 m0, s98, 18432
    s_add_u32 s5, s80, 65536
    buffer_load_dwordx4 v241, s[16:19], s5 offen  lds

    s_add_u32 m0, s98, 19456
    s_add_u32 s5, s80, 98304
    buffer_load_dwordx4 v241, s[16:19], s5 offen  lds

    s_add_u32 m0, s98, 20480
    s_add_u32 s5, s80, 131072
    buffer_load_dwordx4 v241, s[16:19], s5 offen  lds

    s_add_u32 m0, s98, 21504
    s_add_u32 s5, s80, 163840
    buffer_load_dwordx4 v241, s[16:19], s5 offen  lds

    s_add_u32 m0, s98, 22528
    s_add_u32 s5, s80, 196608
    buffer_load_dwordx4 v241, s[16:19], s5 offen  lds

    s_add_u32 m0, s98, 23552
    s_add_u32 s5, s80, 229376
    buffer_load_dwordx4 v241, s[16:19], s5 offen  lds

    v_and_b32 v241, 3, v0
    v_lshlrev_b32 v241, 2, v241

    v_and_b32 v240, 12, v0
    v_lshl_add_u32 v241, v240, 4, v241
    v_add_u32 v241, s97, v241
    v_and_b32 v241, 255, v241

    buffer_load_dword v240, v241, s[20:23], 0 offen sc1
    s_waitcnt vmcnt(25)
    ds_read_b64_tr_b16 a[144:145], v254 offset:8192
    ds_read_b64_tr_b16 a[146:147], v254 offset:8320
    ds_read_b64_tr_b16 a[148:149], v254 offset:10240
    ds_read_b64_tr_b16 a[150:151], v254 offset:10368
    ds_read_b64_tr_b16 a[152:153], v254 offset:12288
    ds_read_b64_tr_b16 a[154:155], v254 offset:12416
    ds_read_b64_tr_b16 a[156:157], v254 offset:14336
    ds_read_b64_tr_b16 a[158:159], v254 offset:14464
    ds_read_b64_tr_b16 a[176:177], v254 offset:8224
    ds_read_b64_tr_b16 a[178:179], v254 offset:8352
    ds_read_b64_tr_b16 a[180:181], v254 offset:10272
    ds_read_b64_tr_b16 a[182:183], v254 offset:10400
    ds_read_b64_tr_b16 a[184:185], v254 offset:12320
    ds_read_b64_tr_b16 a[186:187], v254 offset:12448
    ds_read_b64_tr_b16 a[188:189], v254 offset:14368
    ds_read_b64_tr_b16 a[190:191], v254 offset:14496
    s_waitcnt vmcnt(17)
    ds_read_b64_tr_b16 a[128:129], v254 offset:0
    ds_read_b64_tr_b16 a[130:131], v254 offset:128
    ds_read_b64_tr_b16 a[132:133], v254 offset:2048
    ds_read_b64_tr_b16 a[134:135], v254 offset:2176
    ds_read_b64_tr_b16 a[136:137], v254 offset:4096
    ds_read_b64_tr_b16 a[138:139], v254 offset:4224
    ds_read_b64_tr_b16 a[140:141], v254 offset:6144
    ds_read_b64_tr_b16 a[142:143], v254 offset:6272
    ds_read_b64_tr_b16 a[160:161], v254 offset:32
    ds_read_b64_tr_b16 a[162:163], v254 offset:160
    ds_read_b64_tr_b16 a[164:165], v254 offset:2080
    ds_read_b64_tr_b16 a[166:167], v254 offset:2208
    ds_read_b64_tr_b16 a[168:169], v254 offset:4128
    ds_read_b64_tr_b16 a[170:171], v254 offset:4256
    ds_read_b64_tr_b16 a[172:173], v254 offset:6176
    ds_read_b64_tr_b16 a[174:175], v254 offset:6304
    s_waitcnt vmcnt(9)
    ds_read_b64_tr_b16 a[208:209], v255 offset:24576
    ds_read_b64_tr_b16 a[210:211], v255 offset:24704
    ds_read_b64_tr_b16 a[212:213], v255 offset:26624
    ds_read_b64_tr_b16 a[214:215], v255 offset:26752
    ds_read_b64_tr_b16 a[216:217], v255 offset:28672
    ds_read_b64_tr_b16 a[218:219], v255 offset:28800
    ds_read_b64_tr_b16 a[220:221], v255 offset:30720
    ds_read_b64_tr_b16 a[222:223], v255 offset:30848
    ds_read_b64_tr_b16 a[240:241], v255 offset:24608
    ds_read_b64_tr_b16 a[242:243], v255 offset:24736
    ds_read_b64_tr_b16 a[244:245], v255 offset:26656
    ds_read_b64_tr_b16 a[246:247], v255 offset:26784
    ds_read_b64_tr_b16 a[248:249], v255 offset:28704
    ds_read_b64_tr_b16 a[250:251], v255 offset:28832
    ds_read_b64_tr_b16 a[252:253], v255 offset:30752
    ds_read_b64_tr_b16 a[254:255], v255 offset:30880
    s_waitcnt vmcnt(1)
    ds_read_b64_tr_b16 a[192:193], v255 offset:16384
    ds_read_b64_tr_b16 a[194:195], v255 offset:16512
    ds_read_b64_tr_b16 a[196:197], v255 offset:18432
    ds_read_b64_tr_b16 a[198:199], v255 offset:18560
    ds_read_b64_tr_b16 a[200:201], v255 offset:20480
    ds_read_b64_tr_b16 a[202:203], v255 offset:20608
    ds_read_b64_tr_b16 a[204:205], v255 offset:22528
    ds_read_b64_tr_b16 a[206:207], v255 offset:22656
    ds_read_b64_tr_b16 a[224:225], v255 offset:16416
    ds_read_b64_tr_b16 a[226:227], v255 offset:16544
    ds_read_b64_tr_b16 a[228:229], v255 offset:18464
    ds_read_b64_tr_b16 a[230:231], v255 offset:18592
    ds_read_b64_tr_b16 a[232:233], v255 offset:20512
    ds_read_b64_tr_b16 a[234:235], v255 offset:20640
    ds_read_b64_tr_b16 a[236:237], v255 offset:22560
    ds_read_b64_tr_b16 a[238:239], v255 offset:22688
.pj_14:
    v_min_u32 v20, 0xfffffffe, v20
    v_min_u32 v21, 0xfffffffe, v21
    v_min_u32 v22, 0xfffffffe, v22
    v_min_u32 v23, 0xfffffffe, v23
    v_min_u32 v24, 0xfffffffe, v24
    v_min_u32 v25, 0xfffffffe, v25
    v_min_u32 v26, 0xfffffffe, v26
    v_min_u32 v27, 0xfffffffe, v27
    v_min_u32 v28, 0xfffffffe, v28
    v_min_u32 v29, 0xfffffffe, v29
    v_min_u32 v30, 0xfffffffe, v30
    v_min_u32 v31, 0xfffffffe, v31
    v_min_u32 v32, 0xfffffffe, v32
    v_min_u32 v33, 0xfffffffe, v33
    v_min_u32 v34, 0xfffffffe, v34
    v_min_u32 v35, 0xfffffffe, v35
    s_barrier
    s_cmp_ge_u32 s24, 2
    s_cbranch_scc1 .px_15
    v_xor_b32 v255, 0x10000, v255
    ds_read_b64_tr_b16 v[124:125], v255 offset:16384
    ds_read_b64_tr_b16 v[126:127], v255 offset:16512
    ds_read_b64_tr_b16 v[128:129], v255 offset:18432
    ds_read_b64_tr_b16 v[130:131], v255 offset:18560
    ds_read_b64_tr_b16 v[132:133], v255 offset:20480
    ds_read_b64_tr_b16 v[134:135], v255 offset:20608
    ds_read_b64_tr_b16 v[136:137], v255 offset:22528
    ds_read_b64_tr_b16 v[138:139], v255 offset:22656
    ds_read_b64_tr_b16 v[156:157], v255 offset:16416
    ds_read_b64_tr_b16 v[158:159], v255 offset:16544
    ds_read_b64_tr_b16 v[160:161], v255 offset:18464
    ds_read_b64_tr_b16 v[162:163], v255 offset:18592
    ds_read_b64_tr_b16 v[164:165], v255 offset:20512
    ds_read_b64_tr_b16 v[166:167], v255 offset:20640
    ds_read_b64_tr_b16 v[168:169], v255 offset:22560
    ds_read_b64_tr_b16 v[170:171], v255 offset:22688
    ds_read_b64_tr_b16 v[140:141], v255 offset:24576
    ds_read_b64_tr_b16 v[142:143], v255 offset:24704
    ds_read_b64_tr_b16 v[144:145], v255 offset:26624
    ds_read_b64_tr_b16 v[146:147], v255 offset:26752
    ds_read_b64_tr_b16 v[148:149], v255 offset:28672
    ds_read_b64_tr_b16 v[150:151], v255 offset:28800
    ds_read_b64_tr_b16 v[152:153], v255 offset:30720
    ds_read_b64_tr_b16 v[154:155], v255 offset:30848
    ds_read_b64_tr_b16 v[172:173], v255 offset:24608
    ds_read_b64_tr_b16 v[174:175], v255 offset:24736
    ds_read_b64_tr_b16 v[176:177], v255 offset:26656
    ds_read_b64_tr_b16 v[178:179], v255 offset:26784
    ds_read_b64_tr_b16 v[180:181], v255 offset:28704
    ds_read_b64_tr_b16 v[182:183], v255 offset:28832
    ds_read_b64_tr_b16 v[184:185], v255 offset:30752
    ds_read_b64_tr_b16 v[186:187], v255 offset:30880
.px_15:
    s_waitcnt vmcnt(0)
    s_mov_b32 s62, 0
.vp_18:
    v_readlane_b32 s4, v240, 0
    v_readlane_b32 s7, v240, 1
    v_readlane_b32 s6, v240, 2

    v_readlane_b32 s5, v240, 4
    s_add_u32 s4, s4, s5
    v_readlane_b32 s5, v240, 8
    s_add_u32 s4, s4, s5
    v_readlane_b32 s5, v240, 12
    s_add_u32 s4, s4, s5
    s_lshr_b32 s5, s7, 21
    s_min_u32 s4, s4, s5
    s_cmp_ge_u32 s4, 256
    s_cbranch_scc1 .vd_19
    s_cmp_lg_u32 s6, 0
    s_cbranch_scc1 .vs_20
    s_add_u32 s62, s62, 1
    s_cmp_gt_u32 s62, 0x100000
    s_cbranch_scc1 .mg_end_1
    s_sleep 8
    buffer_load_dword v240, v241, s[20:23], 0 offen sc1
    s_waitcnt vmcnt(0)
    s_branch .vp_18

.vs_20:
    s_lshr_b32 s25, s2, 5
    s_and_b32 s26, s2, 31
    s_mov_b32 s27, 1
    s_mov_b32 s99, 1
    s_mov_b32 s97, 144
    s_waitcnt vmcnt(0) lgkmcnt(0)
    s_barrier
    s_branch .mg_role_3

.vd_19:
    s_waitcnt lgkmcnt(0)
    s_barrier
    s_add_u32 s4, s79, 1
    s_and_b32 s4, s4, 3
    s_lshl_b32 s4, s4, 11
    v_add_u32 v243, s4, v246
    s_add_u32 s4, s79, 2
    s_and_b32 s4, s4, 3
    s_lshl_b32 s4, s4, 11
    v_add_u32 v252, s4, v246
    s_add_u32 s4, s79, 3
    s_and_b32 s4, s4, 3
    s_lshl_b32 s4, s4, 11
    v_add_u32 v254, s4, v246
    s_add_u32 s4, s79, 4
    s_and_b32 s4, s4, 3
    s_lshl_b32 s4, s4, 11
    v_add_u32 v246, s4, v246
    s_bfe_u32 s4, s7, 393216
    s_cmp_gt_u32 s4, 8
    s_cselect_b32 s4, 8192, 0
    s_add_u32 s4, s4, s35
    s_add_u32 s68, s4, 0

    s_bfe_u32 s4, s7, 393216
    s_cmp_gt_u32 s4, 8
    s_cselect_b32 s4, 8192, 0
    s_add_u32 s4, s4, s35
    s_add_u32 s69, s4, 1048576

    s_bfe_u32 s4, s7, 393222
    s_cmp_gt_u32 s4, 8
    s_cselect_b32 s4, 8192, 0
    s_add_u32 s4, s4, s35
    s_add_u32 s70, s4, 2097152

    s_bfe_u32 s4, s7, 393222
    s_cmp_gt_u32 s4, 8
    s_cselect_b32 s4, 8192, 0
    s_add_u32 s4, s4, s35
    s_add_u32 s71, s4, 3145728

    s_mov_b32 s62, 0x1000000
    s_cmp_ge_u32 s24, 2
    s_cbranch_scc1 .nd_21
    s_mov_b32 s62, 0
    s_mov_b64 exec, 3
.wf_22:
    buffer_load_dword v244, v253, s[8:11], s89 offen sc1
    s_waitcnt vmcnt(0)
    v_cmp_gt_u32 vcc, 1, v244
    s_cbranch_vccz .wfd_23
    s_sleep 2
    s_add_u32 s62, s62, 1
    s_cmp_gt_u32 s62, 0x400000
    s_cbranch_scc1 .mg_end_1
    s_branch .wf_22

.wfd_23:
    s_mov_b64 exec, -1
    v_readlane_b32 s4, v244, 0
    v_readlane_b32 s93, v244, 1
    s_min_u32 s93, s93, s4
    s_mov_b32 s62, 0x1000000
    s_mov_b32 m0, s90
    s_nop 0
    buffer_load_dwordx4 v14, s[8:11], s38 offen offset:0 lds
    buffer_load_dwordx4 v14, s[8:11], s38 offen offset:1024 lds
    buffer_load_dwordx4 v14, s[8:11], s38 offen offset:2048 lds
    buffer_load_dwordx4 v14, s[8:11], s38 offen offset:3072 lds
    s_mov_b32 m0, s91
    s_nop 0
    buffer_load_dwordx4 v14, s[8:11], s39 offen lds
    v_mov_b32 v4, s93
    v_mov_b32 v5, 19968
    ds_write_b32 v5, v4
    s_waitcnt vmcnt(0) lgkmcnt(0)
.nd_21:
    s_add_u32 s38, s38, 262144
    s_add_u32 s39, s39, 262144
    s_and_b32 s4, s28, 3
    s_lshl_b32 s5, s4, 17
    s_add_u32 s29, s5, s34
    s_xor_b32 s6, s5, 262144
    s_add_u32 s31, s6, s34
    s_add_u32 s32, s29, 20480
    s_add_u32 s33, s29, 24576
    s_mov_b64 s[14:15], 0
    s_barrier
    s_cmp_lt_u32 s24, 2
    s_cbranch_scc1 .k0_26
    ds_read_b128 v[128:131], v228 offset:0
    ds_read_b128 v[144:147], v228 offset:4096
    ds_read_b128 v[132:135], v229 offset:0
    ds_read_b128 v[148:151], v229 offset:4096
    ds_read_b128 v[136:139], v230 offset:0
    ds_read_b128 v[152:155], v230 offset:4096
    ds_read_b128 v[140:143], v231 offset:0
    ds_read_b128 v[156:159], v231 offset:4096
    ds_read_b128 v[160:163], v14 offset:28672
    ds_read_b128 v[164:167], v14 offset:29696
.k0_26:
    s_cmp_lg_u32 s27, 0
    s_cbranch_scc1 .ent1_25
    s_branch .ent0_24
.p2align 6
.top_27:
    s_barrier
    buffer_load_dwordx4 v[20:23], v8, s[8:11], s29 offen offset:0 sc1
    v_mov_b32 v52, 0
    buffer_load_dwordx4 v[24:27], v8, s[8:11], s29 offen offset:1024 sc1
    v_mov_b32 v53, 0
    buffer_load_dwordx4 v[28:31], v8, s[8:11], s29 offen offset:2048 sc1
    v_mov_b32 v54, 0
    buffer_load_dwordx4 v[32:35], v8, s[8:11], s29 offen offset:3072 sc1
.ent0_24:
    s_waitcnt vmcnt(3)
    v_max3_u32 v4, v20, v21, v22
    v_max_u32 v4, v4, v23
    v_cmp_eq_u32 vcc, -1, v4
    s_cbranch_vccnz .A_32
.W_33:
    v_smfmac_f32_16x16x64_bf16 v[52:55], v[20:23], a[0:7], v9
    v_smfmac_f32_16x16x64_bf16 v[56:59], v[20:23], a[32:39], v9
    s_waitcnt vmcnt(2)
    v_max3_u32 v4, v24, v25, v26
    v_max_u32 v4, v4, v27
    v_smfmac_f32_16x16x64_bf16 v[60:63], v[20:23], a[64:71], v9
    v_cmp_eq_u32 vcc, -1, v4
    v_smfmac_f32_16x16x64_bf16 v[64:67], v[20:23], a[96:103], v9
    s_cbranch_vccnz .A_34
.W_35:
    v_smfmac_f32_16x16x64_bf16 v[52:55], v[24:27], a[8:15], v9
    v_smfmac_f32_16x16x64_bf16 v[56:59], v[24:27], a[40:47], v9
    s_waitcnt vmcnt(1)
    v_max3_u32 v4, v28, v29, v30
    v_max_u32 v4, v4, v31
    v_smfmac_f32_16x16x64_bf16 v[60:63], v[24:27], a[72:79], v9
    v_cmp_eq_u32 vcc, -1, v4
    v_smfmac_f32_16x16x64_bf16 v[64:67], v[24:27], a[104:111], v9
    s_cbranch_vccnz .A_36
.W_37:
    v_smfmac_f32_16x16x64_bf16 v[52:55], v[28:31], a[16:23], v9
    v_smfmac_f32_16x16x64_bf16 v[56:59], v[28:31], a[48:55], v9
    s_waitcnt vmcnt(0)
    v_max3_u32 v4, v32, v33, v34
    v_max_u32 v4, v4, v35
    v_smfmac_f32_16x16x64_bf16 v[60:63], v[28:31], a[80:87], v9
    v_cmp_eq_u32 vcc, -1, v4
    v_smfmac_f32_16x16x64_bf16 v[64:67], v[28:31], a[112:119], v9
    s_cbranch_vccnz .A_38
.W_39:
    v_smfmac_f32_16x16x64_bf16 v[52:55], v[32:35], a[24:31], v9
    v_smfmac_f32_16x16x64_bf16 v[56:59], v[32:35], a[56:63], v9
    v_smfmac_f32_16x16x64_bf16 v[60:63], v[32:35], a[88:95], v9
    v_smfmac_f32_16x16x64_bf16 v[64:67], v[32:35], a[120:127], v9
.mj_31:
    v_cvt_pk_bf16_f32 v104, v52, v53
    v_cvt_pk_bf16_f32 v105, v54, v55
    v_cvt_pk_bf16_f32 v106, v56, v57
    v_cvt_pk_bf16_f32 v107, v58, v59
    ds_write_b64 v16, v[104:105] offset:4096
    v_cvt_pk_bf16_f32 v108, v60, v61
    v_cvt_pk_bf16_f32 v109, v62, v63
    ds_write_b64 v16, v[106:107] offset:6144
    ds_write_b64 v16, v[108:109] offset:0
    v_cvt_pk_bf16_f32 v110, v64, v65
    v_cvt_pk_bf16_f32 v111, v66, v67
    ds_write_b64 v16, v[110:111] offset:2048
    v_smfmac_f32_16x16x64_bf16 v[68:71], v[20:23], a[128:135], v9
    v_smfmac_f32_16x16x64_bf16 v[72:75], v[20:23], a[160:167], v9
    s_waitcnt lgkmcnt(0)
    s_barrier
    ds_read_b128 v[36:39], v17 offset:0
    ds_read_b128 v[40:43], v17 offset:1024
    v_smfmac_f32_16x16x64_bf16 v[68:71], v[24:27], a[136:143], v9
    v_smfmac_f32_16x16x64_bf16 v[72:75], v[24:27], a[168:175], v9
    s_waitcnt lgkmcnt(1)
    v_mfma_f32_16x16x32_bf16 v[44:47], v[36:39], v[84:87], 0
    s_waitcnt lgkmcnt(0)
    v_mfma_f32_16x16x32_bf16 v[44:47], v[40:43], v[84:87], v[44:47]
    v_smfmac_f32_16x16x64_bf16 v[68:71], v[28:31], a[144:151], v9
    v_smfmac_f32_16x16x64_bf16 v[72:75], v[28:31], a[176:183], v9
    s_mov_b64 exec, s[64:65]
    v_cvt_pk_bf16_f32 v48, v44, v45
    v_cvt_pk_bf16_f32 v49, v46, v47
    v_min_u32 v48, 0xfffffffe, v48
    v_min_u32 v49, 0xfffffffe, v49
    buffer_store_dwordx2 v[48:49], v10, s[8:11], s29 offen

    ds_write_b64 v18, v[48:49]
    s_mov_b64 exec, -1

    v_smfmac_f32_16x16x64_bf16 v[68:71], v[32:35], a[152:159], v9
    v_smfmac_f32_16x16x64_bf16 v[72:75], v[32:35], a[184:191], v9
    s_nop 3
    v_cvt_pk_bf16_f32 v104, v68, v69
    v_cvt_pk_bf16_f32 v105, v70, v71
    ds_write_b64 v16, v[104:105] offset:8192
    s_nop 0
    v_cvt_pk_bf16_f32 v106, v72, v73
    v_cvt_pk_bf16_f32 v107, v74, v75
    ds_write_b64 v16, v[106:107] offset:10240
    s_cmp_lg_u32 s24, 2
    s_waitcnt lgkmcnt(0)
    s_barrier
    s_cbranch_scc1 .oth_28
    buffer_load_dwordx4 v[92:95], v232, s[8:11], s29 offen sc1
    buffer_load_dwordx4 v[96:99], v233, s[8:11], s29 offen sc1
    buffer_load_dwordx4 v[100:103], v234, s[8:11], s29 offen sc1
    ds_read_b128 v[88:91], v14 offset:16384
    s_cmp_eq_u32 s28, 63
    s_cbranch_scc1 .rec_fin_6
    s_waitcnt lgkmcnt(0)
    v_mfma_f32_16x16x32_bf16 v[208:211], v[128:131], v[88:91], 0
    v_mfma_f32_16x16x32_bf16 v[212:215], v[144:147], v[88:91], 0
    v_mfma_f32_16x16x32_bf16 v[216:219], v[88:91], v[88:91], v[116:119]
    s_waitcnt vmcnt(2)
    v_max3_u32 v4, v92, v93, v94
    v_max_u32 v4, v4, v95
    v_cmp_eq_u32 vcc, -1, v4
    s_cbranch_vccnz .A_41
.W_42:
    v_mfma_f32_16x16x32_bf16 v[208:211], v[132:135], v[92:95], v[208:211]
    s_waitcnt vmcnt(1)
    v_max3_u32 v4, v96, v97, v98
    v_max_u32 v4, v4, v99
    v_mfma_f32_16x16x32_bf16 v[212:215], v[148:151], v[92:95], v[212:215]
    v_cmp_eq_u32 vcc, -1, v4
    v_mfma_f32_16x16x32_bf16 v[216:219], v[92:95], v[92:95], v[216:219]
    s_cbranch_vccnz .A_43
.W_44:
    v_mfma_f32_16x16x32_bf16 v[208:211], v[136:139], v[96:99], v[208:211]
    s_waitcnt vmcnt(0)
    v_max3_u32 v4, v100, v101, v102
    v_max_u32 v4, v4, v103
    v_mfma_f32_16x16x32_bf16 v[212:215], v[152:155], v[96:99], v[212:215]
    v_cmp_eq_u32 vcc, -1, v4
    v_mfma_f32_16x16x32_bf16 v[216:219], v[96:99], v[96:99], v[216:219]
    s_cbranch_vccnz .A_45
.W_46:
    v_mfma_f32_16x16x32_bf16 v[208:211], v[140:143], v[100:103], v[208:211]
    v_mfma_f32_16x16x32_bf16 v[212:215], v[156:159], v[100:103], v[212:215]
    v_mfma_f32_16x16x32_bf16 v[216:219], v[100:103], v[100:103], v[216:219]
.mj_40:
    s_barrier
    ds_read_b64 v[168:169], v14 offset:18432
    ds_read_b64 v[172:173], v14 offset:18440
    s_nop 0

    v_mov_b32_dpp v208, v212 row_ror:8 row_mask:0xf bank_mask:0xc
    v_mov_b32_dpp v209, v213 row_ror:8 row_mask:0xf bank_mask:0xc
    v_mov_b32_dpp v210, v214 row_ror:8 row_mask:0xf bank_mask:0xc
    v_mov_b32_dpp v211, v215 row_ror:8 row_mask:0xf bank_mask:0xc
    v_mov_b32_dpp v216, v218 row_ror:8 row_mask:0xf bank_mask:0xc
    v_mov_b32_dpp v217, v219 row_ror:8 row_mask:0xf bank_mask:0xc
    v_max3_f32 v4, v208, v209, v210
    v_max3_f32 v5, v211, v216, v217
    v_max_f32 v6, v4, v5
    v_max_f32 v4, v4, v5
    s_nop 1
    v_permlane32_swap_b32 v4, v6
    v_max_f32 v5, v4, v6
    v_max_f32 v4, v4, v6
    s_nop 1
    v_permlane16_swap_b32 v4, v5
    v_max_f32 v4, v4, v5
    s_nop 1
    v_max_f32_dpp v4, v4, v4 row_ror:8 row_mask:0xf bank_mask:0xf
    v_mul_f32 v4, s37, v4

    v_fma_f32 v104, v208, s37, -v4
    v_fma_f32 v105, v209, s37, -v4
    v_fma_f32 v106, v210, s37, -v4
    v_fma_f32 v107, v211, s37, -v4
    v_fma_f32 v108, v216, s37, -v4
    v_fma_f32 v109, v217, s37, -v4
    v_exp_f32 v104, v104
    v_exp_f32 v105, v105
    v_exp_f32 v106, v106
    v_exp_f32 v107, v107
    v_exp_f32 v108, v108
    v_exp_f32 v109, v109
    v_cvt_pk_bf16_f32 v176, v104, v105
    v_cvt_pk_bf16_f32 v177, v106, v107
    v_cvt_pk_bf16_f32 v180, v108, v109
    v_mov_b32_dpp v178, v176 row_ror:8 row_mask:0xf bank_mask:0xf
    v_mov_b32_dpp v179, v177 row_ror:8 row_mask:0xf bank_mask:0xf
    v_mov_b32_dpp v181, v180 row_ror:8 row_mask:0xf bank_mask:0xf
    s_waitcnt lgkmcnt(0)

    v_mfma_f32_16x16x32_bf16 v[208:211], v[120:123], v[176:179], 0
    v_mfma_f32_16x16x32_bf16 v[208:211], v[120:123], v[180:183], v[208:211]
    v_mfma_f32_16x16x32_bf16 v[212:215], v[160:163], v[176:179], 0
    v_mfma_f32_16x16x32_bf16 v[216:219], v[164:167], v[176:179], 0
    v_mfma_f32_16x16x32_bf16 v[212:215], v[168:171], v[180:183], v[212:215]
    v_rcp_f32 v4, v208
    v_mfma_f32_16x16x32_bf16 v[216:219], v[172:175], v[180:183], v[216:219]
    s_mov_b64 exec, s[58:59]
    s_nop 2
    v_mul_f32 v212, v4, v212
    v_mul_f32 v213, v4, v213
    v_mul_f32 v214, v4, v214
    v_mul_f32 v215, v4, v215
    v_cvt_pk_bf16_f32 v184, v212, v213
    v_cvt_pk_bf16_f32 v185, v214, v215
    v_mul_f32 v216, v4, v216
    v_mul_f32 v217, v4, v217
    v_min_u32 v184, 0xfffffffe, v184
    v_min_u32 v185, 0xfffffffe, v185
    v_mul_f32 v218, v4, v218
    v_mul_f32 v219, v4, v219
    v_cvt_pk_bf16_f32 v186, v216, v217
    v_cvt_pk_bf16_f32 v187, v218, v219
    v_min_u32 v186, 0xfffffffe, v186
    v_min_u32 v187, 0xfffffffe, v187
    buffer_store_dwordx4 v[184:187], v13, s[8:11], s29 offen
    s_mov_b64 exec, -1

.gp_30:
    s_barrier
    v_mov_b32 v5, 19968
    ds_read_b32 v4, v5
    s_mov_b32 s99, s68
    s_waitcnt vmcnt(0)
    s_cmp_eq_u32 s24, 3
    s_cbranch_scc1 .u3_47
    s_add_u32 s6, s28, 3
    s_add_u32 s7, s30, 262144
    s_waitcnt lgkmcnt(0)
    v_readfirstlane_b32 s5, v4
    s_cmp_lt_u32 s5, s6
    s_barrier
    s_cbranch_scc1 .np_49
    buffer_load_dword v226, v225, s[8:11], s7 offen

.np_49:
    s_add_u32 s4, s70, 0
    buffer_store_dwordx4 v[188:191], v238, s[8:11], s4 offen sc1
    s_add_u32 s4, s70, 262144
    buffer_store_dwordx4 v[188:191], v238, s[8:11], s4 offen sc1
    s_branch .u4_48
.u3_47:
    s_sub_u32 s4, s36, 0
    s_barrier
    s_mov_b64 exec, s[66:67]
    buffer_store_dwordx4 v[88:91], v11, s[8:11], s4 offen sc1
    s_mov_b64 exec, s[56:57]
    buffer_store_dwordx4 v[172:175], v12, s[8:11], s4 offen sc1
    s_mov_b64 exec, -1

.u4_48:
    s_barrier
    s_add_u32 s28, s28, 1
    s_add_u32 s36, s36, 196608
    s_cmp_lt_u32 s28, 63
    s_cselect_b32 s4, 262144, 0
    s_add_u32 s38, s38, s4
    s_add_u32 s39, s39, s4
    s_add_u32 s30, s30, s4
    s_mov_b32 s4, s68
    s_mov_b32 s68, s69
    s_mov_b32 s69, s70
    s_mov_b32 s70, s71
    s_mov_b32 s71, s4
    s_and_b32 s4, s28, 3
    s_lshl_b32 s5, s4, 17
    s_add_u32 s29, s5, s34
    s_xor_b32 s6, s5, 262144
    s_add_u32 s31, s6, s34
    s_add_u32 s32, s29, 20480
    s_add_u32 s33, s29, 24576
    v_mov_b32 v55, 0
    v_mov_b32 v56, 0
    v_mov_b32 v57, 0
    v_mov_b32 v58, 0
    v_mov_b32 v59, 0
    v_mov_b32 v60, 0
    v_mov_b32 v61, 0
    v_mov_b32 v62, 0
    v_mov_b32 v63, 0
    v_mov_b32 v64, 0
    v_mov_b32 v65, 0
    v_mov_b32 v66, 0
    v_mov_b32 v67, 0
    v_mov_b32 v68, 0
    v_mov_b32 v69, 0
    v_mov_b32 v70, 0
    v_mov_b32 v71, 0
    v_mov_b32 v72, 0
    v_mov_b32 v73, 0
    v_mov_b32 v74, 0
    v_mov_b32 v75, 0
    v_mov_b32 v20, -1
    v_mov_b32 v21, -1
    v_mov_b32 v22, -1
    v_mov_b32 v23, -1
    v_mov_b32 v24, -1
    v_mov_b32 v25, -1
    v_mov_b32 v26, -1
    v_mov_b32 v27, -1
    v_mov_b32 v28, -1
    v_mov_b32 v29, -1
    v_mov_b32 v30, -1
    v_mov_b32 v31, -1
    v_mov_b32 v32, -1
    v_mov_b32 v33, -1
    v_mov_b32 v34, -1
    v_mov_b32 v35, -1
    v_mov_b32 v92, -1
    v_mov_b32 v93, -1
    v_mov_b32 v94, -1
    v_mov_b32 v95, -1
    v_mov_b32 v96, -1
    v_mov_b32 v97, -1
    v_mov_b32 v98, -1
    v_mov_b32 v99, -1
    v_mov_b32 v100, -1
    v_mov_b32 v101, -1
    v_mov_b32 v102, -1
    v_mov_b32 v103, -1
    s_add_u32 s4, s99, 0
    buffer_load_dwordx4 v[192:195], v239, s[8:11], s4 offen sc1
    buffer_load_dwordx4 v[196:199], v249, s[8:11], s4 offen sc1

    ds_read_b128 v[128:131], v228 offset:0
    ds_read_b128 v[144:147], v228 offset:4096
    ds_read_b128 v[132:135], v229 offset:0
    ds_read_b128 v[148:151], v229 offset:4096
    ds_read_b128 v[136:139], v230 offset:0
    ds_read_b128 v[152:155], v230 offset:4096
    ds_read_b128 v[140:143], v231 offset:0
    ds_read_b128 v[156:159], v231 offset:4096
    ds_read_b128 v[160:163], v14 offset:28672
    ds_read_b128 v[164:167], v14 offset:29696
    ds_read_b128 v[108:111], v248
    s_waitcnt lgkmcnt(0)
    v_mfma_f32_16x16x32_bf16 v[76:79], v[108:111], v[112:115], 0
    s_add_u32 s4, s99, 262144
    buffer_load_dwordx4 v[200:203], v239, s[8:11], s4 offen sc1
    buffer_load_dwordx4 v[204:207], v249, s[8:11], s4 offen sc1

.gc_50:
    s_waitcnt vmcnt(2)

    v_max_u32 v4, v192, v196
    v_cmp_eq_u32 vcc, -1, v4
    s_cbranch_vccnz .gf_51
    v_mfma_f32_16x16x32_bf16 v[76:79], v[192:195], v[84:87], v[76:79]
    v_mfma_f32_16x16x32_bf16 v[76:79], v[196:199], v[112:115], v[76:79]
    s_mov_b64 exec, s[58:59]
    s_nop 6
    v_cvt_pk_bf16_f32 v104, v76, v77
    v_cvt_pk_bf16_f32 v105, v78, v79
    v_min_u32 v104, 0xfffffffe, v104
    v_min_u32 v105, 0xfffffffe, v105
    buffer_store_dwordx2 v[104:105], v15, s[8:11], s29 offen
    s_mov_b64 exec, -1

    s_branch .top_27
.gf_51:
    s_add_u32 s4, s99, 0
    buffer_load_dwordx4 v[192:195], v239, s[8:11], s4 offen sc1
    buffer_load_dwordx4 v[196:199], v249, s[8:11], s4 offen sc1

    s_waitcnt vmcnt(2)

    v_max_u32 v4, v200, v204
    v_cmp_eq_u32 vcc, -1, v4
    s_cbranch_vccnz .gf_52
    v_mfma_f32_16x16x32_bf16 v[76:79], v[200:203], v[84:87], v[76:79]
    v_mfma_f32_16x16x32_bf16 v[76:79], v[204:207], v[112:115], v[76:79]
    s_mov_b64 exec, s[58:59]
    s_nop 6
    v_cvt_pk_bf16_f32 v104, v76, v77
    v_cvt_pk_bf16_f32 v105, v78, v79
    v_min_u32 v104, 0xfffffffe, v104
    v_min_u32 v105, 0xfffffffe, v105
    buffer_store_dwordx2 v[104:105], v15, s[8:11], s29 offen
    s_mov_b64 exec, -1

    s_branch .top_27
.gf_52:
    s_add_u32 s4, s99, 262144
    buffer_load_dwordx4 v[200:203], v239, s[8:11], s4 offen sc1
    buffer_load_dwordx4 v[204:207], v249, s[8:11], s4 offen sc1

    s_sub_u32 s62, s62, 1
    s_cbranch_scc1 .mg_end_1
    s_branch .gc_50
.oth_28:
    s_cmp_eq_u32 s24, 3
    s_cbranch_scc1 .w3_29
    s_cmp_eq_u32 s28, 63
    s_cbranch_scc1 .rec_fin_6
    s_add_u32 s6, s28, 4
    s_cmp_ge_u32 s93, s6
    s_cbranch_scc1 .nl_53
    s_buffer_load_dword s14, s[8:11], s89 glc
    s_buffer_load_dword s15, s[8:11], s89 offset:8192 glc

.nl_53:
    s_waitcnt vmcnt(0)
    v_mov_b32 v71, 0
    v_mov_b32 v72, 0
    v_mov_b32 v73, 0
    v_mov_b32 v74, 0
    v_mov_b32 v75, 0
    s_barrier
    s_add_u32 s6, s28, 2
    s_min_u32 s6, s6, 64
    s_cmp_lt_u32 s93, s6
    s_cbranch_scc1 .kf_54
.kb_55:
    s_mov_b32 m0, s90
    s_nop 0
    buffer_load_dwordx4 v14, s[8:11], s38 offen offset:0 lds
    buffer_load_dwordx4 v14, s[8:11], s38 offen offset:1024 lds
    buffer_load_dwordx4 v14, s[8:11], s38 offen offset:2048 lds
    buffer_load_dwordx4 v14, s[8:11], s38 offen offset:3072 lds
    s_mov_b32 m0, s91
    s_nop 0
    buffer_load_dwordx4 v14, s[8:11], s39 offen lds
    s_barrier
    v_mov_b32 v20, -1
    v_mov_b32 v21, -1
    v_mov_b32 v22, -1
    v_mov_b32 v23, -1
    v_mov_b32 v24, -1
    v_mov_b32 v25, -1
    v_mov_b32 v26, -1
    v_mov_b32 v27, -1
    v_mov_b32 v28, -1
    v_mov_b32 v29, -1
    v_mov_b32 v30, -1
    v_mov_b32 v31, -1
    v_mov_b32 v32, -1
    v_mov_b32 v33, -1
    v_mov_b32 v34, -1
    v_mov_b32 v35, -1
    v_mov_b32 v55, 0
    v_mov_b32 v56, 0
    v_mov_b32 v57, 0
    v_mov_b32 v58, 0
    v_mov_b32 v59, 0
    v_mov_b32 v60, 0
    v_mov_b32 v61, 0
    v_mov_b32 v62, 0
    v_mov_b32 v63, 0
    v_mov_b32 v64, 0
    v_mov_b32 v65, 0
    v_mov_b32 v66, 0
    v_mov_b32 v67, 0
    v_mov_b32 v68, 0
    v_mov_b32 v69, 0
    v_mov_b32 v70, 0
    buffer_load_dwordx4 v[192:195], v243, s[8:11], s32 offen offset:0 sc1
    buffer_load_dwordx4 v[196:199], v243, s[8:11], s32 offen offset:1024 sc1
    v_mov_b32 v76, 0
    buffer_load_dwordx4 v[200:203], v252, s[8:11], s32 offen offset:0 sc1
    buffer_load_dwordx4 v[204:207], v252, s[8:11], s32 offen offset:1024 sc1
    v_mov_b32 v77, 0
    buffer_load_dwordx4 v[208:211], v254, s[8:11], s32 offen offset:0 sc1
    buffer_load_dwordx4 v[212:215], v254, s[8:11], s32 offen offset:1024 sc1
    v_mov_b32 v78, 0
    buffer_load_dwordx4 v[216:219], v246, s[8:11], s32 offen offset:0 sc1
    buffer_load_dwordx4 v[220:223], v246, s[8:11], s32 offen offset:1024 sc1
    s_waitcnt vmcnt(6)
    v_max3_u32 v4, v192, v193, v194
    v_max3_u32 v5, v195, v196, v197
    v_max3_u32 v4, v4, v198, v199
    v_max_u32 v4, v4, v5
    v_cmp_eq_u32 vcc, -1, v4
    s_cbranch_vccnz .A_57
.W_58:
    v_smfmac_f32_16x16x64_bf16 v[76:79], v[192:195], a[192:199], v9
    v_smfmac_f32_16x16x64_bf16 v[80:83], v[192:195], a[224:231], v9
    s_waitcnt vmcnt(4)
    v_max3_u32 v4, v200, v201, v202
    v_max3_u32 v5, v203, v204, v205
    v_max3_u32 v4, v4, v206, v207
    v_smfmac_f32_16x16x64_bf16 v[76:79], v[196:199], a[200:207], v9
    v_max_u32 v4, v4, v5
    v_cmp_eq_u32 vcc, -1, v4
    v_smfmac_f32_16x16x64_bf16 v[80:83], v[196:199], a[232:239], v9
    s_cbranch_vccnz .A_59
.W_60:
    v_smfmac_f32_16x16x64_bf16 v[76:79], v[200:203], a[208:215], v9
    v_smfmac_f32_16x16x64_bf16 v[80:83], v[200:203], a[240:247], v9
    s_waitcnt vmcnt(2)
    v_max3_u32 v4, v208, v209, v210
    v_max3_u32 v5, v211, v212, v213
    v_max3_u32 v4, v4, v214, v215
    v_smfmac_f32_16x16x64_bf16 v[76:79], v[204:207], a[216:223], v9
    v_max_u32 v4, v4, v5
    v_cmp_eq_u32 vcc, -1, v4
    v_smfmac_f32_16x16x64_bf16 v[80:83], v[204:207], a[248:255], v9
    s_cbranch_vccnz .A_61
.W_62:
    v_smfmac_f32_16x16x64_bf16 v[76:79], v[208:211], v[124:131], v9
    v_smfmac_f32_16x16x64_bf16 v[80:83], v[208:211], v[156:163], v9
    s_waitcnt vmcnt(0)
    v_max3_u32 v4, v216, v217, v218
    v_max3_u32 v5, v219, v220, v221
    v_max3_u32 v4, v4, v222, v223
    v_smfmac_f32_16x16x64_bf16 v[76:79], v[212:215], v[132:139], v9
    v_max_u32 v4, v4, v5
    v_cmp_eq_u32 vcc, -1, v4
    v_smfmac_f32_16x16x64_bf16 v[80:83], v[212:215], v[164:171], v9
    s_cbranch_vccnz .A_63
.W_64:
    v_smfmac_f32_16x16x64_bf16 v[76:79], v[216:219], v[140:147], v9
    v_smfmac_f32_16x16x64_bf16 v[80:83], v[216:219], v[172:179], v9
    v_smfmac_f32_16x16x64_bf16 v[76:79], v[220:223], v[148:155], v9
    v_smfmac_f32_16x16x64_bf16 v[80:83], v[220:223], v[180:187], v9
.mj_56:
    s_barrier
    s_nop 7
    v_permlane32_swap_b32 v76, v80
    v_permlane32_swap_b32 v77, v81
    v_permlane32_swap_b32 v78, v82
    v_permlane32_swap_b32 v79, v83
    v_add_f32 v76, v76, v80
    v_add_f32 v77, v77, v81
    v_add_f32 v78, v78, v82
    v_add_f32 v79, v79, v83
    v_cvt_pk_bf16_f32 v104, v76, v77
    v_cvt_pk_bf16_f32 v106, v76, v77
    v_cvt_pk_bf16_f32 v105, v78, v79
    v_cvt_pk_bf16_f32 v107, v78, v79
    v_permlane16_swap_b32 v104, v106
    s_nop 0
    v_permlane16_swap_b32 v105, v107
    v_min_u32 v104, 0xfffffffe, v104
    buffer_store_dwordx4 v[104:107], v237, s[8:11], s68 offen sc1

    ds_write_b128 v247, v[104:107]
    s_waitcnt lgkmcnt(0)
    s_barrier
    s_min_u32 s4, s14, s15
    s_max_u32 s93, s93, s4
    v_mov_b32 v4, s93
    v_mov_b32 v5, 19968
    ds_write_b32 v5, v4
    v_mov_b32 v79, 0
    v_mov_b32 v80, 0
    v_mov_b32 v81, 0
    v_mov_b32 v82, 0
    v_mov_b32 v83, 0
    s_waitcnt vmcnt(1)
    v_mov_b32 v192, -1
    v_mov_b32 v193, -1
    v_mov_b32 v194, -1
    v_mov_b32 v195, -1
    v_mov_b32 v196, -1
    v_mov_b32 v197, -1
    v_mov_b32 v198, -1
    v_mov_b32 v199, -1
    v_mov_b32 v200, -1
    v_mov_b32 v201, -1
    v_mov_b32 v202, -1
    v_mov_b32 v203, -1
    v_mov_b32 v204, -1
    v_mov_b32 v205, -1
    v_mov_b32 v206, -1
    v_mov_b32 v207, -1
    v_mov_b32 v208, -1
    v_mov_b32 v209, -1
    v_mov_b32 v210, -1
    v_mov_b32 v211, -1
    v_mov_b32 v212, -1
    v_mov_b32 v213, -1
    v_mov_b32 v214, -1
    v_mov_b32 v215, -1
    v_mov_b32 v216, -1
    v_mov_b32 v217, -1
    v_mov_b32 v218, -1
    v_mov_b32 v219, -1
    v_mov_b32 v220, -1
    v_mov_b32 v221, -1
    v_mov_b32 v222, -1
    v_mov_b32 v223, -1
    s_add_u32 s28, s28, 1
    s_add_u32 s36, s36, 196608
    s_cmp_lt_u32 s28, 63
    s_cselect_b32 s4, 262144, 0
    s_add_u32 s38, s38, s4
    s_add_u32 s39, s39, s4
    s_add_u32 s30, s30, s4
    s_mov_b32 s4, s68
    s_mov_b32 s68, s69
    s_mov_b32 s69, s70
    s_mov_b32 s70, s71
    s_mov_b32 s71, s4
    s_and_b32 s4, s28, 3
    s_lshl_b32 s5, s4, 17
    s_add_u32 s29, s5, s34
    s_xor_b32 s6, s5, 262144
    s_add_u32 s31, s6, s34
    s_add_u32 s32, s29, 20480
    s_add_u32 s33, s29, 24576
    s_branch .top_27
.w3_29:
    ds_read_b128 v[36:39], v14 offset:8192
    ds_read_b128 v[40:43], v14 offset:9216
    ds_read_b128 v[44:47], v14 offset:10240
    ds_read_b128 v[48:51], v14 offset:11264
    ds_read_b128 v[88:91], v14 offset:16384
    s_waitcnt lgkmcnt(0)
    v_mfma_f32_16x16x32_bf16 v[104:107], v[84:87], v[36:39], 0
    v_mfma_f32_16x16x32_bf16 v[108:111], v[84:87], v[44:47], 0
    v_mfma_f32_16x16x32_bf16 v[104:107], v[84:87], v[40:43], v[104:107]
    v_mfma_f32_16x16x32_bf16 v[108:111], v[84:87], v[48:51], v[108:111]
    s_nop 7
    v_cvt_pk_bf16_f32 v168, v104, v105
    v_cvt_pk_bf16_f32 v169, v106, v107
    v_cvt_pk_bf16_f32 v170, v108, v109
    v_cvt_pk_bf16_f32 v171, v110, v111
    ds_write_b128 v14, v[168:171] offset:18432
    v_cndmask_b32 v172, v170, v168, s[60:61]
    v_cndmask_b32 v173, v171, v169, s[60:61]
    v_min_u32 v172, 0xfffffffe, v172
    v_min_u32 v173, 0xfffffffe, v173
    v_mov_b32 v174, v172
    v_mov_b32 v175, v173
    s_cmp_eq_u32 s28, 63
    s_nop 0
    v_permlane16_swap_b32 v172, v174
    v_permlane16_swap_b32 v173, v175
    ds_write_b128 v14, v[172:175] offset:17408

    s_cbranch_scc1 .sk_65
    s_waitcnt lgkmcnt(0)
    s_barrier
    buffer_store_dwordx4 v[188:191], v235, s[8:11], s31 offen
    buffer_store_dwordx4 v[188:191], v236, s[8:11], s31 offen

    s_branch .gp_30
.A_66:
    s_mov_b64 exec, vcc
    buffer_load_dwordx4 v[32:35], v8, s[8:11], s29 offen offset:3072 sc1
    s_mov_b64 exec, -1
    s_sub_u32 s62, s62, 1
    s_cbranch_scc1 .mg_end_1
    s_waitcnt vmcnt(3)
    v_max3_u32 v4, v20, v21, v22
    v_max_u32 v4, v4, v23
    v_cmp_eq_u32 vcc, -1, v4
    s_cbranch_vccz .W_33
.A_32:
    s_mov_b64 exec, vcc
    buffer_load_dwordx4 v[20:23], v8, s[8:11], s29 offen offset:0 sc1
    s_mov_b64 exec, -1
    s_waitcnt vmcnt(3)
    v_max3_u32 v4, v24, v25, v26
    v_max_u32 v4, v4, v27
    v_cmp_eq_u32 vcc, -1, v4
    s_cbranch_vccz .W_67
.A_68:
    s_mov_b64 exec, vcc
    buffer_load_dwordx4 v[24:27], v8, s[8:11], s29 offen offset:1024 sc1
    s_mov_b64 exec, -1
    s_waitcnt vmcnt(3)
    v_max3_u32 v4, v28, v29, v30
    v_max_u32 v4, v4, v31
    v_cmp_eq_u32 vcc, -1, v4
    s_cbranch_vccz .W_69
.A_70:
    s_mov_b64 exec, vcc
    buffer_load_dwordx4 v[28:31], v8, s[8:11], s29 offen offset:2048 sc1
    s_mov_b64 exec, -1
    s_waitcnt vmcnt(3)
    v_max3_u32 v4, v32, v33, v34
    v_max_u32 v4, v4, v35
    v_cmp_eq_u32 vcc, -1, v4
    s_cbranch_vccnz .A_66
.W_71:
    v_smfmac_f32_16x16x64_bf16 v[52:55], v[32:35], a[24:31], v9
    v_smfmac_f32_16x16x64_bf16 v[56:59], v[32:35], a[56:63], v9
    s_waitcnt vmcnt(2)
    v_max3_u32 v4, v20, v21, v22
    v_max_u32 v4, v4, v23
    v_smfmac_f32_16x16x64_bf16 v[60:63], v[32:35], a[88:95], v9
    v_cmp_eq_u32 vcc, -1, v4
    v_smfmac_f32_16x16x64_bf16 v[64:67], v[32:35], a[120:127], v9
    s_cbranch_vccnz .A_72
.W_73:
    v_smfmac_f32_16x16x64_bf16 v[52:55], v[20:23], a[0:7], v9
    v_smfmac_f32_16x16x64_bf16 v[56:59], v[20:23], a[32:39], v9
    s_waitcnt vmcnt(1)
    v_max3_u32 v4, v24, v25, v26
    v_max_u32 v4, v4, v27
    v_smfmac_f32_16x16x64_bf16 v[60:63], v[20:23], a[64:71], v9
    v_cmp_eq_u32 vcc, -1, v4
    v_smfmac_f32_16x16x64_bf16 v[64:67], v[20:23], a[96:103], v9
    s_cbranch_vccnz .A_74
.W_75:
    v_smfmac_f32_16x16x64_bf16 v[52:55], v[24:27], a[8:15], v9
    v_smfmac_f32_16x16x64_bf16 v[56:59], v[24:27], a[40:47], v9
    s_waitcnt vmcnt(0)
    v_max3_u32 v4, v28, v29, v30
    v_max_u32 v4, v4, v31
    v_smfmac_f32_16x16x64_bf16 v[60:63], v[24:27], a[72:79], v9
    v_cmp_eq_u32 vcc, -1, v4
    v_smfmac_f32_16x16x64_bf16 v[64:67], v[24:27], a[104:111], v9
    s_cbranch_vccnz .A_76
.W_77:
    v_smfmac_f32_16x16x64_bf16 v[52:55], v[28:31], a[16:23], v9
    v_smfmac_f32_16x16x64_bf16 v[56:59], v[28:31], a[48:55], v9
    v_smfmac_f32_16x16x64_bf16 v[60:63], v[28:31], a[80:87], v9
    v_smfmac_f32_16x16x64_bf16 v[64:67], v[28:31], a[112:119], v9
    s_branch .mj_31
.W_67:
    v_smfmac_f32_16x16x64_bf16 v[52:55], v[24:27], a[8:15], v9
    v_smfmac_f32_16x16x64_bf16 v[56:59], v[24:27], a[40:47], v9
    s_waitcnt vmcnt(2)
    v_max3_u32 v4, v28, v29, v30
    v_max_u32 v4, v4, v31
    v_smfmac_f32_16x16x64_bf16 v[60:63], v[24:27], a[72:79], v9
    v_cmp_eq_u32 vcc, -1, v4
    v_smfmac_f32_16x16x64_bf16 v[64:67], v[24:27], a[104:111], v9
    s_cbranch_vccnz .A_78
.W_79:
    v_smfmac_f32_16x16x64_bf16 v[52:55], v[28:31], a[16:23], v9
    v_smfmac_f32_16x16x64_bf16 v[56:59], v[28:31], a[48:55], v9
    s_waitcnt vmcnt(1)
    v_max3_u32 v4, v32, v33, v34
    v_max_u32 v4, v4, v35
    v_smfmac_f32_16x16x64_bf16 v[60:63], v[28:31], a[80:87], v9
    v_cmp_eq_u32 vcc, -1, v4
    v_smfmac_f32_16x16x64_bf16 v[64:67], v[28:31], a[112:119], v9
    s_cbranch_vccnz .A_80
.W_81:
    v_smfmac_f32_16x16x64_bf16 v[52:55], v[32:35], a[24:31], v9
    v_smfmac_f32_16x16x64_bf16 v[56:59], v[32:35], a[56:63], v9
    s_waitcnt vmcnt(0)
    v_max3_u32 v4, v20, v21, v22
    v_max_u32 v4, v4, v23
    v_smfmac_f32_16x16x64_bf16 v[60:63], v[32:35], a[88:95], v9
    v_cmp_eq_u32 vcc, -1, v4
    v_smfmac_f32_16x16x64_bf16 v[64:67], v[32:35], a[120:127], v9
    s_cbranch_vccnz .A_82
.W_83:
    v_smfmac_f32_16x16x64_bf16 v[52:55], v[20:23], a[0:7], v9
    v_smfmac_f32_16x16x64_bf16 v[56:59], v[20:23], a[32:39], v9
    v_smfmac_f32_16x16x64_bf16 v[60:63], v[20:23], a[64:71], v9
    v_smfmac_f32_16x16x64_bf16 v[64:67], v[20:23], a[96:103], v9
    s_branch .mj_31
.W_69:
    v_smfmac_f32_16x16x64_bf16 v[52:55], v[28:31], a[16:23], v9
    v_smfmac_f32_16x16x64_bf16 v[56:59], v[28:31], a[48:55], v9
    s_waitcnt vmcnt(2)
    v_max3_u32 v4, v32, v33, v34
    v_max_u32 v4, v4, v35
    v_smfmac_f32_16x16x64_bf16 v[60:63], v[28:31], a[80:87], v9
    v_cmp_eq_u32 vcc, -1, v4
    v_smfmac_f32_16x16x64_bf16 v[64:67], v[28:31], a[112:119], v9
    s_cbranch_vccnz .A_84
.W_85:
    v_smfmac_f32_16x16x64_bf16 v[52:55], v[32:35], a[24:31], v9
    v_smfmac_f32_16x16x64_bf16 v[56:59], v[32:35], a[56:63], v9
    s_waitcnt vmcnt(1)
    v_max3_u32 v4, v20, v21, v22
    v_max_u32 v4, v4, v23
    v_smfmac_f32_16x16x64_bf16 v[60:63], v[32:35], a[88:95], v9
    v_cmp_eq_u32 vcc, -1, v4
    v_smfmac_f32_16x16x64_bf16 v[64:67], v[32:35], a[120:127], v9
    s_cbranch_vccnz .A_86
.W_87:
    v_smfmac_f32_16x16x64_bf16 v[52:55], v[20:23], a[0:7], v9
    v_smfmac_f32_16x16x64_bf16 v[56:59], v[20:23], a[32:39], v9
    s_waitcnt vmcnt(0)
    v_max3_u32 v4, v24, v25, v26
    v_max_u32 v4, v4, v27
    v_smfmac_f32_16x16x64_bf16 v[60:63], v[20:23], a[64:71], v9
    v_cmp_eq_u32 vcc, -1, v4
    v_smfmac_f32_16x16x64_bf16 v[64:67], v[20:23], a[96:103], v9
    s_cbranch_vccnz .A_88
.W_89:
    v_smfmac_f32_16x16x64_bf16 v[52:55], v[24:27], a[8:15], v9
    v_smfmac_f32_16x16x64_bf16 v[56:59], v[24:27], a[40:47], v9
    v_smfmac_f32_16x16x64_bf16 v[60:63], v[24:27], a[72:79], v9
    v_smfmac_f32_16x16x64_bf16 v[64:67], v[24:27], a[104:111], v9
    s_branch .mj_31
.A_90:
    s_mov_b64 exec, vcc
    buffer_load_dwordx4 v[28:31], v8, s[8:11], s29 offen offset:2048 sc1
    s_mov_b64 exec, -1
    s_sub_u32 s62, s62, 1
    s_cbranch_scc1 .mg_end_1
    s_waitcnt vmcnt(2)
    v_max3_u32 v4, v20, v21, v22
    v_max_u32 v4, v4, v23
    v_cmp_eq_u32 vcc, -1, v4
    s_cbranch_vccz .W_73
.A_72:
    s_mov_b64 exec, vcc
    buffer_load_dwordx4 v[20:23], v8, s[8:11], s29 offen offset:0 sc1
    s_mov_b64 exec, -1
    s_waitcnt vmcnt(2)
    v_max3_u32 v4, v24, v25, v26
    v_max_u32 v4, v4, v27
    v_cmp_eq_u32 vcc, -1, v4
    s_cbranch_vccz .W_91
.A_92:
    s_mov_b64 exec, vcc
    buffer_load_dwordx4 v[24:27], v8, s[8:11], s29 offen offset:1024 sc1
    s_mov_b64 exec, -1
    s_waitcnt vmcnt(2)
    v_max3_u32 v4, v28, v29, v30
    v_max_u32 v4, v4, v31
    v_cmp_eq_u32 vcc, -1, v4
    s_cbranch_vccnz .A_90
.W_93:
    v_smfmac_f32_16x16x64_bf16 v[52:55], v[28:31], a[16:23], v9
    v_smfmac_f32_16x16x64_bf16 v[56:59], v[28:31], a[48:55], v9
    s_waitcnt vmcnt(1)
    v_max3_u32 v4, v20, v21, v22
    v_max_u32 v4, v4, v23
    v_smfmac_f32_16x16x64_bf16 v[60:63], v[28:31], a[80:87], v9
    v_cmp_eq_u32 vcc, -1, v4
    v_smfmac_f32_16x16x64_bf16 v[64:67], v[28:31], a[112:119], v9
    s_cbranch_vccz .W_87
    s_branch .A_86
.W_91:
    v_smfmac_f32_16x16x64_bf16 v[52:55], v[24:27], a[8:15], v9
    v_smfmac_f32_16x16x64_bf16 v[56:59], v[24:27], a[40:47], v9
    s_waitcnt vmcnt(1)
    v_max3_u32 v4, v28, v29, v30
    v_max_u32 v4, v4, v31
    v_smfmac_f32_16x16x64_bf16 v[60:63], v[24:27], a[72:79], v9
    v_cmp_eq_u32 vcc, -1, v4
    v_smfmac_f32_16x16x64_bf16 v[64:67], v[24:27], a[104:111], v9
    s_cbranch_vccnz .A_94
.W_95:
    v_smfmac_f32_16x16x64_bf16 v[52:55], v[28:31], a[16:23], v9
    v_smfmac_f32_16x16x64_bf16 v[56:59], v[28:31], a[48:55], v9
    s_waitcnt vmcnt(0)
    v_max3_u32 v4, v20, v21, v22
    v_max_u32 v4, v4, v23
    v_smfmac_f32_16x16x64_bf16 v[60:63], v[28:31], a[80:87], v9
    v_cmp_eq_u32 vcc, -1, v4
    v_smfmac_f32_16x16x64_bf16 v[64:67], v[28:31], a[112:119], v9
    s_cbranch_vccz .W_83
    s_branch .A_82
.A_96:
    s_mov_b64 exec, vcc
    buffer_load_dwordx4 v[24:27], v8, s[8:11], s29 offen offset:1024 sc1
    s_mov_b64 exec, -1
    s_sub_u32 s62, s62, 1
    s_cbranch_scc1 .mg_end_1
    s_waitcnt vmcnt(2)
    v_max3_u32 v4, v32, v33, v34
    v_max_u32 v4, v4, v35
    v_cmp_eq_u32 vcc, -1, v4
    s_cbranch_vccz .W_85
.A_84:
    s_mov_b64 exec, vcc
    buffer_load_dwordx4 v[32:35], v8, s[8:11], s29 offen offset:3072 sc1
    s_mov_b64 exec, -1
    s_waitcnt vmcnt(2)
    v_max3_u32 v4, v20, v21, v22
    v_max_u32 v4, v4, v23
    v_cmp_eq_u32 vcc, -1, v4
    s_cbranch_vccz .W_97
.A_98:
    s_mov_b64 exec, vcc
    buffer_load_dwordx4 v[20:23], v8, s[8:11], s29 offen offset:0 sc1
    s_mov_b64 exec, -1
    s_waitcnt vmcnt(2)
    v_max3_u32 v4, v24, v25, v26
    v_max_u32 v4, v4, v27
    v_cmp_eq_u32 vcc, -1, v4
    s_cbranch_vccnz .A_96
.W_99:
    v_smfmac_f32_16x16x64_bf16 v[52:55], v[24:27], a[8:15], v9
    v_smfmac_f32_16x16x64_bf16 v[56:59], v[24:27], a[40:47], v9
    s_waitcnt vmcnt(1)
    v_max3_u32 v4, v32, v33, v34
    v_max_u32 v4, v4, v35
    v_smfmac_f32_16x16x64_bf16 v[60:63], v[24:27], a[72:79], v9
    v_cmp_eq_u32 vcc, -1, v4
    v_smfmac_f32_16x16x64_bf16 v[64:67], v[24:27], a[104:111], v9
    s_cbranch_vccz .W_81
    s_branch .A_80
.W_97:
    v_smfmac_f32_16x16x64_bf16 v[52:55], v[20:23], a[0:7], v9
    v_smfmac_f32_16x16x64_bf16 v[56:59], v[20:23], a[32:39], v9
    s_waitcnt vmcnt(1)
    v_max3_u32 v4, v24, v25, v26
    v_max_u32 v4, v4, v27
    v_smfmac_f32_16x16x64_bf16 v[60:63], v[20:23], a[64:71], v9
    v_cmp_eq_u32 vcc, -1, v4
    v_smfmac_f32_16x16x64_bf16 v[64:67], v[20:23], a[96:103], v9
    s_cbranch_vccnz .A_100
.W_101:
    v_smfmac_f32_16x16x64_bf16 v[52:55], v[24:27], a[8:15], v9
    v_smfmac_f32_16x16x64_bf16 v[56:59], v[24:27], a[40:47], v9
    s_waitcnt vmcnt(0)
    v_max3_u32 v4, v32, v33, v34
    v_max_u32 v4, v4, v35
    v_smfmac_f32_16x16x64_bf16 v[60:63], v[24:27], a[72:79], v9
    v_cmp_eq_u32 vcc, -1, v4
    v_smfmac_f32_16x16x64_bf16 v[64:67], v[24:27], a[104:111], v9
    s_cbranch_vccz .W_39
    s_branch .A_38
.A_102:
    s_mov_b64 exec, vcc
    buffer_load_dwordx4 v[32:35], v8, s[8:11], s29 offen offset:3072 sc1
    s_mov_b64 exec, -1
    s_sub_u32 s62, s62, 1
    s_cbranch_scc1 .mg_end_1
    s_waitcnt vmcnt(2)
    v_max3_u32 v4, v20, v21, v22
    v_max_u32 v4, v4, v23
    v_cmp_eq_u32 vcc, -1, v4
    s_cbranch_vccz .W_103
.A_104:
    s_mov_b64 exec, vcc
    buffer_load_dwordx4 v[20:23], v8, s[8:11], s29 offen offset:0 sc1
    s_mov_b64 exec, -1
    s_waitcnt vmcnt(2)
    v_max3_u32 v4, v28, v29, v30
    v_max_u32 v4, v4, v31
    v_cmp_eq_u32 vcc, -1, v4
    s_cbranch_vccz .W_79
.A_78:
    s_mov_b64 exec, vcc
    buffer_load_dwordx4 v[28:31], v8, s[8:11], s29 offen offset:2048 sc1
    s_mov_b64 exec, -1
    s_waitcnt vmcnt(2)
    v_max3_u32 v4, v32, v33, v34
    v_max_u32 v4, v4, v35
    v_cmp_eq_u32 vcc, -1, v4
    s_cbranch_vccnz .A_102
.W_105:
    v_smfmac_f32_16x16x64_bf16 v[52:55], v[32:35], a[24:31], v9
    v_smfmac_f32_16x16x64_bf16 v[56:59], v[32:35], a[56:63], v9
    s_waitcnt vmcnt(1)
    v_max3_u32 v4, v20, v21, v22
    v_max_u32 v4, v4, v23
    v_smfmac_f32_16x16x64_bf16 v[60:63], v[32:35], a[88:95], v9
    v_cmp_eq_u32 vcc, -1, v4
    v_smfmac_f32_16x16x64_bf16 v[64:67], v[32:35], a[120:127], v9
    s_cbranch_vccnz .A_106
.W_107:
    v_smfmac_f32_16x16x64_bf16 v[52:55], v[20:23], a[0:7], v9
    v_smfmac_f32_16x16x64_bf16 v[56:59], v[20:23], a[32:39], v9
    s_waitcnt vmcnt(0)
    v_max3_u32 v4, v28, v29, v30
    v_max_u32 v4, v4, v31
    v_smfmac_f32_16x16x64_bf16 v[60:63], v[20:23], a[64:71], v9
    v_cmp_eq_u32 vcc, -1, v4
    v_smfmac_f32_16x16x64_bf16 v[64:67], v[20:23], a[96:103], v9
    s_cbranch_vccz .W_77
    s_branch .A_76
.W_103:
    v_smfmac_f32_16x16x64_bf16 v[52:55], v[20:23], a[0:7], v9
    v_smfmac_f32_16x16x64_bf16 v[56:59], v[20:23], a[32:39], v9
    s_waitcnt vmcnt(1)
    v_max3_u32 v4, v28, v29, v30
    v_max_u32 v4, v4, v31
    v_smfmac_f32_16x16x64_bf16 v[60:63], v[20:23], a[64:71], v9
    v_cmp_eq_u32 vcc, -1, v4
    v_smfmac_f32_16x16x64_bf16 v[64:67], v[20:23], a[96:103], v9
    s_cbranch_vccz .W_37
    s_branch .A_36
.A_108:
    s_mov_b64 exec, vcc
    buffer_load_dwordx4 v[32:35], v8, s[8:11], s29 offen offset:3072 sc1
    s_mov_b64 exec, -1
    s_sub_u32 s62, s62, 1
    s_cbranch_scc1 .mg_end_1
    s_waitcnt vmcnt(2)
    v_max3_u32 v4, v24, v25, v26
    v_max_u32 v4, v4, v27
    v_cmp_eq_u32 vcc, -1, v4
    s_cbranch_vccz .W_35
.A_34:
    s_mov_b64 exec, vcc
    buffer_load_dwordx4 v[24:27], v8, s[8:11], s29 offen offset:1024 sc1
    s_mov_b64 exec, -1
    s_waitcnt vmcnt(2)
    v_max3_u32 v4, v28, v29, v30
    v_max_u32 v4, v4, v31
    v_cmp_eq_u32 vcc, -1, v4
    s_cbranch_vccz .W_109
.A_110:
    s_mov_b64 exec, vcc
    buffer_load_dwordx4 v[28:31], v8, s[8:11], s29 offen offset:2048 sc1
    s_mov_b64 exec, -1
    s_waitcnt vmcnt(2)
    v_max3_u32 v4, v32, v33, v34
    v_max_u32 v4, v4, v35
    v_cmp_eq_u32 vcc, -1, v4
    s_cbranch_vccnz .A_108
.W_111:
    v_smfmac_f32_16x16x64_bf16 v[52:55], v[32:35], a[24:31], v9
    v_smfmac_f32_16x16x64_bf16 v[56:59], v[32:35], a[56:63], v9
    s_waitcnt vmcnt(1)
    v_max3_u32 v4, v24, v25, v26
    v_max_u32 v4, v4, v27
    v_smfmac_f32_16x16x64_bf16 v[60:63], v[32:35], a[88:95], v9
    v_cmp_eq_u32 vcc, -1, v4
    v_smfmac_f32_16x16x64_bf16 v[64:67], v[32:35], a[120:127], v9
    s_cbranch_vccz .W_75
    s_branch .A_74
.W_109:
    v_smfmac_f32_16x16x64_bf16 v[52:55], v[28:31], a[16:23], v9
    v_smfmac_f32_16x16x64_bf16 v[56:59], v[28:31], a[48:55], v9
    s_waitcnt vmcnt(1)
    v_max3_u32 v4, v32, v33, v34
    v_max_u32 v4, v4, v35
    v_smfmac_f32_16x16x64_bf16 v[60:63], v[28:31], a[80:87], v9
    v_cmp_eq_u32 vcc, -1, v4
    v_smfmac_f32_16x16x64_bf16 v[64:67], v[28:31], a[112:119], v9
    s_cbranch_vccnz .A_112
.W_113:
    v_smfmac_f32_16x16x64_bf16 v[52:55], v[32:35], a[24:31], v9
    v_smfmac_f32_16x16x64_bf16 v[56:59], v[32:35], a[56:63], v9
    s_waitcnt vmcnt(0)
    v_max3_u32 v4, v24, v25, v26
    v_max_u32 v4, v4, v27
    v_smfmac_f32_16x16x64_bf16 v[60:63], v[32:35], a[88:95], v9
    v_cmp_eq_u32 vcc, -1, v4
    v_smfmac_f32_16x16x64_bf16 v[64:67], v[32:35], a[120:127], v9
    s_cbranch_vccz .W_89
    s_branch .A_88
.A_114:
    s_mov_b64 exec, vcc
    buffer_load_dwordx4 v[24:27], v8, s[8:11], s29 offen offset:1024 sc1
    s_mov_b64 exec, -1
    s_sub_u32 s62, s62, 1
    s_cbranch_scc1 .mg_end_1
    s_waitcnt vmcnt(1)
    v_max3_u32 v4, v20, v21, v22
    v_max_u32 v4, v4, v23
    v_cmp_eq_u32 vcc, -1, v4
    s_cbranch_vccz .W_87
.A_86:
    s_mov_b64 exec, vcc
    buffer_load_dwordx4 v[20:23], v8, s[8:11], s29 offen offset:0 sc1
    s_mov_b64 exec, -1
    s_waitcnt vmcnt(1)
    v_max3_u32 v4, v24, v25, v26
    v_max_u32 v4, v4, v27
    v_cmp_eq_u32 vcc, -1, v4
    s_cbranch_vccnz .A_114
.W_115:
    v_smfmac_f32_16x16x64_bf16 v[52:55], v[24:27], a[8:15], v9
    v_smfmac_f32_16x16x64_bf16 v[56:59], v[24:27], a[40:47], v9
    s_waitcnt vmcnt(0)
    v_max3_u32 v4, v20, v21, v22
    v_max_u32 v4, v4, v23
    v_smfmac_f32_16x16x64_bf16 v[60:63], v[24:27], a[72:79], v9
    v_cmp_eq_u32 vcc, -1, v4
    v_smfmac_f32_16x16x64_bf16 v[64:67], v[24:27], a[104:111], v9
    s_cbranch_vccz .W_83
    s_branch .A_82
.A_94:
    s_mov_b64 exec, vcc
    buffer_load_dwordx4 v[28:31], v8, s[8:11], s29 offen offset:2048 sc1
    s_mov_b64 exec, -1
    s_sub_u32 s62, s62, 1
    s_cbranch_scc1 .mg_end_1
    s_waitcnt vmcnt(1)
    v_max3_u32 v4, v20, v21, v22
    v_max_u32 v4, v4, v23
    v_cmp_eq_u32 vcc, -1, v4
    s_cbranch_vccz .W_107
.A_106:
    s_mov_b64 exec, vcc
    buffer_load_dwordx4 v[20:23], v8, s[8:11], s29 offen offset:0 sc1
    s_mov_b64 exec, -1
    s_waitcnt vmcnt(1)
    v_max3_u32 v4, v28, v29, v30
    v_max_u32 v4, v4, v31
    v_cmp_eq_u32 vcc, -1, v4
    s_cbranch_vccnz .A_94
    s_branch .W_95
.A_116:
    s_mov_b64 exec, vcc
    buffer_load_dwordx4 v[20:23], v8, s[8:11], s29 offen offset:0 sc1
    s_mov_b64 exec, -1
    s_sub_u32 s62, s62, 1
    s_cbranch_scc1 .mg_end_1
    s_waitcnt vmcnt(1)
    v_max3_u32 v4, v32, v33, v34
    v_max_u32 v4, v4, v35
    v_cmp_eq_u32 vcc, -1, v4
    s_cbranch_vccz .W_81
.A_80:
    s_mov_b64 exec, vcc
    buffer_load_dwordx4 v[32:35], v8, s[8:11], s29 offen offset:3072 sc1
    s_mov_b64 exec, -1
    s_waitcnt vmcnt(1)
    v_max3_u32 v4, v20, v21, v22
    v_max_u32 v4, v4, v23
    v_cmp_eq_u32 vcc, -1, v4
    s_cbranch_vccnz .A_116
.W_117:
    v_smfmac_f32_16x16x64_bf16 v[52:55], v[20:23], a[0:7], v9
    v_smfmac_f32_16x16x64_bf16 v[56:59], v[20:23], a[32:39], v9
    s_waitcnt vmcnt(0)
    v_max3_u32 v4, v32, v33, v34
    v_max_u32 v4, v4, v35
    v_smfmac_f32_16x16x64_bf16 v[60:63], v[20:23], a[64:71], v9
    v_cmp_eq_u32 vcc, -1, v4
    v_smfmac_f32_16x16x64_bf16 v[64:67], v[20:23], a[96:103], v9
    s_cbranch_vccz .W_39
    s_branch .A_38
.A_118:
    s_mov_b64 exec, vcc
    buffer_load_dwordx4 v[28:31], v8, s[8:11], s29 offen offset:2048 sc1
    s_mov_b64 exec, -1
    s_sub_u32 s62, s62, 1
    s_cbranch_scc1 .mg_end_1
    s_waitcnt vmcnt(1)
    v_max3_u32 v4, v24, v25, v26
    v_max_u32 v4, v4, v27
    v_cmp_eq_u32 vcc, -1, v4
    s_cbranch_vccz .W_75
.A_74:
    s_mov_b64 exec, vcc
    buffer_load_dwordx4 v[24:27], v8, s[8:11], s29 offen offset:1024 sc1
    s_mov_b64 exec, -1
    s_waitcnt vmcnt(1)
    v_max3_u32 v4, v28, v29, v30
    v_max_u32 v4, v4, v31
    v_cmp_eq_u32 vcc, -1, v4
    s_cbranch_vccnz .A_118
.W_119:
    v_smfmac_f32_16x16x64_bf16 v[52:55], v[28:31], a[16:23], v9
    v_smfmac_f32_16x16x64_bf16 v[56:59], v[28:31], a[48:55], v9
    s_waitcnt vmcnt(0)
    v_max3_u32 v4, v24, v25, v26
    v_max_u32 v4, v4, v27
    v_smfmac_f32_16x16x64_bf16 v[60:63], v[28:31], a[80:87], v9
    v_cmp_eq_u32 vcc, -1, v4
    v_smfmac_f32_16x16x64_bf16 v[64:67], v[28:31], a[112:119], v9
    s_cbranch_vccz .W_89
    s_branch .A_88
.A_112:
    s_mov_b64 exec, vcc
    buffer_load_dwordx4 v[32:35], v8, s[8:11], s29 offen offset:3072 sc1
    s_mov_b64 exec, -1
    s_sub_u32 s62, s62, 1
    s_cbranch_scc1 .mg_end_1
    s_waitcnt vmcnt(1)
    v_max3_u32 v4, v24, v25, v26
    v_max_u32 v4, v4, v27
    v_cmp_eq_u32 vcc, -1, v4
    s_cbranch_vccz .W_101
.A_100:
    s_mov_b64 exec, vcc
    buffer_load_dwordx4 v[24:27], v8, s[8:11], s29 offen offset:1024 sc1
    s_mov_b64 exec, -1
    s_waitcnt vmcnt(1)
    v_max3_u32 v4, v32, v33, v34
    v_max_u32 v4, v4, v35
    v_cmp_eq_u32 vcc, -1, v4
    s_cbranch_vccnz .A_112
    s_branch .W_113
.A_120:
    s_mov_b64 exec, vcc
    buffer_load_dwordx4 v[32:35], v8, s[8:11], s29 offen offset:3072 sc1
    s_mov_b64 exec, -1
    s_sub_u32 s62, s62, 1
    s_cbranch_scc1 .mg_end_1
    s_waitcnt vmcnt(1)
    v_max3_u32 v4, v28, v29, v30
    v_max_u32 v4, v4, v31
    v_cmp_eq_u32 vcc, -1, v4
    s_cbranch_vccz .W_37
.A_36:
    s_mov_b64 exec, vcc
    buffer_load_dwordx4 v[28:31], v8, s[8:11], s29 offen offset:2048 sc1
    s_mov_b64 exec, -1
    s_waitcnt vmcnt(1)
    v_max3_u32 v4, v32, v33, v34
    v_max_u32 v4, v4, v35
    v_cmp_eq_u32 vcc, -1, v4
    s_cbranch_vccnz .A_120
.W_121:
    v_smfmac_f32_16x16x64_bf16 v[52:55], v[32:35], a[24:31], v9
    v_smfmac_f32_16x16x64_bf16 v[56:59], v[32:35], a[56:63], v9
    s_waitcnt vmcnt(0)
    v_max3_u32 v4, v28, v29, v30
    v_max_u32 v4, v4, v31
    v_smfmac_f32_16x16x64_bf16 v[60:63], v[32:35], a[88:95], v9
    v_cmp_eq_u32 vcc, -1, v4
    v_smfmac_f32_16x16x64_bf16 v[64:67], v[32:35], a[120:127], v9
    s_cbranch_vccz .W_77
    s_branch .A_76
.A_82:
    s_mov_b64 exec, vcc
    buffer_load_dwordx4 v[20:23], v8, s[8:11], s29 offen offset:0 sc1
    s_mov_b64 exec, -1
    s_sub_u32 s62, s62, 1
    s_cbranch_scc1 .mg_end_1
    s_waitcnt vmcnt(1)
    v_max3_u32 v4, v20, v21, v22
    v_max_u32 v4, v4, v23
    v_cmp_eq_u32 vcc, -1, v4
    s_cbranch_vccnz .A_82
    v_smfmac_f32_16x16x64_bf16 v[52:55], v[20:23], a[0:7], v9
    v_smfmac_f32_16x16x64_bf16 v[56:59], v[20:23], a[32:39], v9
    v_smfmac_f32_16x16x64_bf16 v[60:63], v[20:23], a[64:71], v9
    v_smfmac_f32_16x16x64_bf16 v[64:67], v[20:23], a[96:103], v9
    s_branch .mj_31
.A_88:
    s_mov_b64 exec, vcc
    buffer_load_dwordx4 v[24:27], v8, s[8:11], s29 offen offset:1024 sc1
    s_mov_b64 exec, -1
    s_sub_u32 s62, s62, 1
    s_cbranch_scc1 .mg_end_1
    s_waitcnt vmcnt(1)
    v_max3_u32 v4, v24, v25, v26
    v_max_u32 v4, v4, v27
    v_cmp_eq_u32 vcc, -1, v4
    s_cbranch_vccnz .A_88
    v_smfmac_f32_16x16x64_bf16 v[52:55], v[24:27], a[8:15], v9
    v_smfmac_f32_16x16x64_bf16 v[56:59], v[24:27], a[40:47], v9
    v_smfmac_f32_16x16x64_bf16 v[60:63], v[24:27], a[72:79], v9
    v_smfmac_f32_16x16x64_bf16 v[64:67], v[24:27], a[104:111], v9
    s_branch .mj_31
.A_76:
    s_mov_b64 exec, vcc
    buffer_load_dwordx4 v[28:31], v8, s[8:11], s29 offen offset:2048 sc1
    s_mov_b64 exec, -1
    s_sub_u32 s62, s62, 1
    s_cbranch_scc1 .mg_end_1
    s_waitcnt vmcnt(1)
    v_max3_u32 v4, v28, v29, v30
    v_max_u32 v4, v4, v31
    v_cmp_eq_u32 vcc, -1, v4
    s_cbranch_vccnz .A_76
    v_smfmac_f32_16x16x64_bf16 v[52:55], v[28:31], a[16:23], v9
    v_smfmac_f32_16x16x64_bf16 v[56:59], v[28:31], a[48:55], v9
    v_smfmac_f32_16x16x64_bf16 v[60:63], v[28:31], a[80:87], v9
    v_smfmac_f32_16x16x64_bf16 v[64:67], v[28:31], a[112:119], v9
    s_branch .mj_31
.A_38:
    s_mov_b64 exec, vcc
    buffer_load_dwordx4 v[32:35], v8, s[8:11], s29 offen offset:3072 sc1
    s_mov_b64 exec, -1
    s_sub_u32 s62, s62, 1
    s_cbranch_scc1 .mg_end_1
    s_waitcnt vmcnt(1)
    v_max3_u32 v4, v32, v33, v34
    v_max_u32 v4, v4, v35
    v_cmp_eq_u32 vcc, -1, v4
    s_cbranch_vccnz .A_38
    v_smfmac_f32_16x16x64_bf16 v[52:55], v[32:35], a[24:31], v9
    v_smfmac_f32_16x16x64_bf16 v[56:59], v[32:35], a[56:63], v9
    v_smfmac_f32_16x16x64_bf16 v[60:63], v[32:35], a[88:95], v9
    v_smfmac_f32_16x16x64_bf16 v[64:67], v[32:35], a[120:127], v9
    s_branch .mj_31
.A_122:
    buffer_load_dwordx4 v[100:103], v234, s[8:11], s29 offen sc1
    s_sub_u32 s62, s62, 1
    s_cbranch_scc1 .mg_end_1
    s_waitcnt vmcnt(2)
    v_max3_u32 v4, v92, v93, v94
    v_max_u32 v4, v4, v95
    v_cmp_eq_u32 vcc, -1, v4
    s_cbranch_vccz .W_42
.A_41:
    buffer_load_dwordx4 v[92:95], v232, s[8:11], s29 offen sc1
    s_waitcnt vmcnt(2)
    v_max3_u32 v4, v96, v97, v98
    v_max_u32 v4, v4, v99
    v_cmp_eq_u32 vcc, -1, v4
    s_cbranch_vccz .W_123
.A_124:
    buffer_load_dwordx4 v[96:99], v233, s[8:11], s29 offen sc1
    s_waitcnt vmcnt(2)
    v_max3_u32 v4, v100, v101, v102
    v_max_u32 v4, v4, v103
    v_cmp_eq_u32 vcc, -1, v4
    s_cbranch_vccnz .A_122
.W_125:
    v_mfma_f32_16x16x32_bf16 v[208:211], v[140:143], v[100:103], v[208:211]
    s_waitcnt vmcnt(1)
    v_max3_u32 v4, v92, v93, v94
    v_max_u32 v4, v4, v95
    v_mfma_f32_16x16x32_bf16 v[212:215], v[156:159], v[100:103], v[212:215]
    v_cmp_eq_u32 vcc, -1, v4
    v_mfma_f32_16x16x32_bf16 v[216:219], v[100:103], v[100:103], v[216:219]
    s_cbranch_vccnz .A_126
.W_127:
    v_mfma_f32_16x16x32_bf16 v[208:211], v[132:135], v[92:95], v[208:211]
    s_waitcnt vmcnt(0)
    v_max3_u32 v4, v96, v97, v98
    v_max_u32 v4, v4, v99
    v_mfma_f32_16x16x32_bf16 v[212:215], v[148:151], v[92:95], v[212:215]
    v_cmp_eq_u32 vcc, -1, v4
    v_mfma_f32_16x16x32_bf16 v[216:219], v[92:95], v[92:95], v[216:219]
    s_cbranch_vccnz .A_128
.W_129:
    v_mfma_f32_16x16x32_bf16 v[208:211], v[136:139], v[96:99], v[208:211]
    v_mfma_f32_16x16x32_bf16 v[212:215], v[152:155], v[96:99], v[212:215]
    v_mfma_f32_16x16x32_bf16 v[216:219], v[96:99], v[96:99], v[216:219]
    s_branch .mj_40
.W_123:
    v_mfma_f32_16x16x32_bf16 v[208:211], v[136:139], v[96:99], v[208:211]
    s_waitcnt vmcnt(1)
    v_max3_u32 v4, v100, v101, v102
    v_max_u32 v4, v4, v103
    v_mfma_f32_16x16x32_bf16 v[212:215], v[152:155], v[96:99], v[212:215]
    v_cmp_eq_u32 vcc, -1, v4
    v_mfma_f32_16x16x32_bf16 v[216:219], v[96:99], v[96:99], v[216:219]
    s_cbranch_vccnz .A_130
.W_131:
    v_mfma_f32_16x16x32_bf16 v[208:211], v[140:143], v[100:103], v[208:211]
    s_waitcnt vmcnt(0)
    v_max3_u32 v4, v92, v93, v94
    v_max_u32 v4, v4, v95
    v_mfma_f32_16x16x32_bf16 v[212:215], v[156:159], v[100:103], v[212:215]
    v_cmp_eq_u32 vcc, -1, v4
    v_mfma_f32_16x16x32_bf16 v[216:219], v[100:103], v[100:103], v[216:219]
    s_cbranch_vccnz .A_132
.W_133:
    v_mfma_f32_16x16x32_bf16 v[208:211], v[132:135], v[92:95], v[208:211]
    v_mfma_f32_16x16x32_bf16 v[212:215], v[148:151], v[92:95], v[212:215]
    v_mfma_f32_16x16x32_bf16 v[216:219], v[92:95], v[92:95], v[216:219]
    s_branch .mj_40
.A_134:
    buffer_load_dwordx4 v[96:99], v233, s[8:11], s29 offen sc1
    s_sub_u32 s62, s62, 1
    s_cbranch_scc1 .mg_end_1
    s_waitcnt vmcnt(1)
    v_max3_u32 v4, v92, v93, v94
    v_max_u32 v4, v4, v95
    v_cmp_eq_u32 vcc, -1, v4
    s_cbranch_vccz .W_127
.A_126:
    buffer_load_dwordx4 v[92:95], v232, s[8:11], s29 offen sc1
    s_waitcnt vmcnt(1)
    v_max3_u32 v4, v96, v97, v98
    v_max_u32 v4, v4, v99
    v_cmp_eq_u32 vcc, -1, v4
    s_cbranch_vccnz .A_134
.W_135:
    v_mfma_f32_16x16x32_bf16 v[208:211], v[136:139], v[96:99], v[208:211]
    s_waitcnt vmcnt(0)
    v_max3_u32 v4, v92, v93, v94
    v_max_u32 v4, v4, v95
    v_mfma_f32_16x16x32_bf16 v[212:215], v[152:155], v[96:99], v[212:215]
    v_cmp_eq_u32 vcc, -1, v4
    v_mfma_f32_16x16x32_bf16 v[216:219], v[96:99], v[96:99], v[216:219]
    s_cbranch_vccz .W_133
    s_branch .A_132
.A_136:
    buffer_load_dwordx4 v[92:95], v232, s[8:11], s29 offen sc1
    s_sub_u32 s62, s62, 1
    s_cbranch_scc1 .mg_end_1
    s_waitcnt vmcnt(1)
    v_max3_u32 v4, v100, v101, v102
    v_max_u32 v4, v4, v103
    v_cmp_eq_u32 vcc, -1, v4
    s_cbranch_vccz .W_131
.A_130:
    buffer_load_dwordx4 v[100:103], v234, s[8:11], s29 offen sc1
    s_waitcnt vmcnt(1)
    v_max3_u32 v4, v92, v93, v94
    v_max_u32 v4, v4, v95
    v_cmp_eq_u32 vcc, -1, v4
    s_cbranch_vccnz .A_136
.W_137:
    v_mfma_f32_16x16x32_bf16 v[208:211], v[132:135], v[92:95], v[208:211]
    s_waitcnt vmcnt(0)
    v_max3_u32 v4, v100, v101, v102
    v_max_u32 v4, v4, v103
    v_mfma_f32_16x16x32_bf16 v[212:215], v[148:151], v[92:95], v[212:215]
    v_cmp_eq_u32 vcc, -1, v4
    v_mfma_f32_16x16x32_bf16 v[216:219], v[92:95], v[92:95], v[216:219]
    s_cbranch_vccz .W_46
    s_branch .A_45
.A_138:
    buffer_load_dwordx4 v[100:103], v234, s[8:11], s29 offen sc1
    s_sub_u32 s62, s62, 1
    s_cbranch_scc1 .mg_end_1
    s_waitcnt vmcnt(1)
    v_max3_u32 v4, v96, v97, v98
    v_max_u32 v4, v4, v99
    v_cmp_eq_u32 vcc, -1, v4
    s_cbranch_vccz .W_44
.A_43:
    buffer_load_dwordx4 v[96:99], v233, s[8:11], s29 offen sc1
    s_waitcnt vmcnt(1)
    v_max3_u32 v4, v100, v101, v102
    v_max_u32 v4, v4, v103
    v_cmp_eq_u32 vcc, -1, v4
    s_cbranch_vccnz .A_138
.W_139:
    v_mfma_f32_16x16x32_bf16 v[208:211], v[140:143], v[100:103], v[208:211]
    s_waitcnt vmcnt(0)
    v_max3_u32 v4, v96, v97, v98
    v_max_u32 v4, v4, v99
    v_mfma_f32_16x16x32_bf16 v[212:215], v[156:159], v[100:103], v[212:215]
    v_cmp_eq_u32 vcc, -1, v4
    v_mfma_f32_16x16x32_bf16 v[216:219], v[100:103], v[100:103], v[216:219]
    s_cbranch_vccz .W_129
    s_branch .A_128
.A_132:
    buffer_load_dwordx4 v[92:95], v232, s[8:11], s29 offen sc1
    s_sub_u32 s62, s62, 1
    s_cbranch_scc1 .mg_end_1
    s_waitcnt vmcnt(1)
    v_max3_u32 v4, v92, v93, v94
    v_max_u32 v4, v4, v95
    v_cmp_eq_u32 vcc, -1, v4
    s_cbranch_vccnz .A_132
    v_mfma_f32_16x16x32_bf16 v[208:211], v[132:135], v[92:95], v[208:211]
    v_mfma_f32_16x16x32_bf16 v[212:215], v[148:151], v[92:95], v[212:215]
    v_mfma_f32_16x16x32_bf16 v[216:219], v[92:95], v[92:95], v[216:219]
    s_branch .mj_40
.A_128:
    buffer_load_dwordx4 v[96:99], v233, s[8:11], s29 offen sc1
    s_sub_u32 s62, s62, 1
    s_cbranch_scc1 .mg_end_1
    s_waitcnt vmcnt(1)
    v_max3_u32 v4, v96, v97, v98
    v_max_u32 v4, v4, v99
    v_cmp_eq_u32 vcc, -1, v4
    s_cbranch_vccnz .A_128
    v_mfma_f32_16x16x32_bf16 v[208:211], v[136:139], v[96:99], v[208:211]
    v_mfma_f32_16x16x32_bf16 v[212:215], v[152:155], v[96:99], v[212:215]
    v_mfma_f32_16x16x32_bf16 v[216:219], v[96:99], v[96:99], v[216:219]
    s_branch .mj_40
.A_45:
    buffer_load_dwordx4 v[100:103], v234, s[8:11], s29 offen sc1
    s_sub_u32 s62, s62, 1
    s_cbranch_scc1 .mg_end_1
    s_waitcnt vmcnt(1)
    v_max3_u32 v4, v100, v101, v102
    v_max_u32 v4, v4, v103
    v_cmp_eq_u32 vcc, -1, v4
    s_cbranch_vccnz .A_45
    v_mfma_f32_16x16x32_bf16 v[208:211], v[140:143], v[100:103], v[208:211]
    v_mfma_f32_16x16x32_bf16 v[212:215], v[156:159], v[100:103], v[212:215]
    v_mfma_f32_16x16x32_bf16 v[216:219], v[100:103], v[100:103], v[216:219]
    s_branch .mj_40
.kf_54:
    s_mov_b32 s62, 0
    s_mov_b64 exec, 3
.wf_140:
    buffer_load_dword v244, v253, s[8:11], s89 offen sc1
    s_waitcnt vmcnt(0)
    v_cmp_gt_u32 vcc, s6, v244
    s_cbranch_vccz .wfd_141
    s_sleep 2
    s_add_u32 s62, s62, 1
    s_cmp_gt_u32 s62, 0x400000
    s_cbranch_scc1 .mg_end_1
    s_branch .wf_140

.wfd_141:
    s_mov_b64 exec, -1
    v_readlane_b32 s4, v244, 0
    v_readlane_b32 s93, v244, 1
    s_min_u32 s93, s93, s4
    s_mov_b32 s62, 0x1000000
    s_branch .kb_55
.A_142:
    buffer_load_dwordx4 v[216:219], v246, s[8:11], s32 offen offset:0 sc1
    buffer_load_dwordx4 v[220:223], v246, s[8:11], s32 offen offset:1024 sc1
    s_sub_u32 s62, s62, 1
    s_cbranch_scc1 .mg_end_1
    s_waitcnt vmcnt(6)
    v_max3_u32 v4, v192, v193, v194
    v_max3_u32 v5, v195, v196, v197
    v_max3_u32 v4, v4, v198, v199
    v_max_u32 v4, v4, v5
    v_cmp_eq_u32 vcc, -1, v4
    s_cbranch_vccz .W_58
.A_57:
    buffer_load_dwordx4 v[192:195], v243, s[8:11], s32 offen offset:0 sc1
    buffer_load_dwordx4 v[196:199], v243, s[8:11], s32 offen offset:1024 sc1
    s_waitcnt vmcnt(6)
    v_max3_u32 v4, v200, v201, v202
    v_max3_u32 v5, v203, v204, v205
    v_max3_u32 v4, v4, v206, v207
    v_max_u32 v4, v4, v5
    v_cmp_eq_u32 vcc, -1, v4
    s_cbranch_vccz .W_143
.A_144:
    buffer_load_dwordx4 v[200:203], v252, s[8:11], s32 offen offset:0 sc1
    buffer_load_dwordx4 v[204:207], v252, s[8:11], s32 offen offset:1024 sc1
    s_waitcnt vmcnt(6)
    v_max3_u32 v4, v208, v209, v210
    v_max3_u32 v5, v211, v212, v213
    v_max3_u32 v4, v4, v214, v215
    v_max_u32 v4, v4, v5
    v_cmp_eq_u32 vcc, -1, v4
    s_cbranch_vccz .W_145
.A_146:
    buffer_load_dwordx4 v[208:211], v254, s[8:11], s32 offen offset:0 sc1
    buffer_load_dwordx4 v[212:215], v254, s[8:11], s32 offen offset:1024 sc1
    s_waitcnt vmcnt(6)
    v_max3_u32 v4, v216, v217, v218
    v_max3_u32 v5, v219, v220, v221
    v_max3_u32 v4, v4, v222, v223
    v_max_u32 v4, v4, v5
    v_cmp_eq_u32 vcc, -1, v4
    s_cbranch_vccnz .A_142
.W_147:
    v_smfmac_f32_16x16x64_bf16 v[76:79], v[216:219], v[140:147], v9
    v_smfmac_f32_16x16x64_bf16 v[80:83], v[216:219], v[172:179], v9
    s_waitcnt vmcnt(4)
    v_max3_u32 v4, v192, v193, v194
    v_max3_u32 v5, v195, v196, v197
    v_max3_u32 v4, v4, v198, v199
    v_smfmac_f32_16x16x64_bf16 v[76:79], v[220:223], v[148:155], v9
    v_max_u32 v4, v4, v5
    v_cmp_eq_u32 vcc, -1, v4
    v_smfmac_f32_16x16x64_bf16 v[80:83], v[220:223], v[180:187], v9
    s_cbranch_vccnz .A_148
.W_149:
    v_smfmac_f32_16x16x64_bf16 v[76:79], v[192:195], a[192:199], v9
    v_smfmac_f32_16x16x64_bf16 v[80:83], v[192:195], a[224:231], v9
    s_waitcnt vmcnt(2)
    v_max3_u32 v4, v200, v201, v202
    v_max3_u32 v5, v203, v204, v205
    v_max3_u32 v4, v4, v206, v207
    v_smfmac_f32_16x16x64_bf16 v[76:79], v[196:199], a[200:207], v9
    v_max_u32 v4, v4, v5
    v_cmp_eq_u32 vcc, -1, v4
    v_smfmac_f32_16x16x64_bf16 v[80:83], v[196:199], a[232:239], v9
    s_cbranch_vccnz .A_150
.W_151:
    v_smfmac_f32_16x16x64_bf16 v[76:79], v[200:203], a[208:215], v9
    v_smfmac_f32_16x16x64_bf16 v[80:83], v[200:203], a[240:247], v9
    s_waitcnt vmcnt(0)
    v_max3_u32 v4, v208, v209, v210
    v_max3_u32 v5, v211, v212, v213
    v_max3_u32 v4, v4, v214, v215
    v_smfmac_f32_16x16x64_bf16 v[76:79], v[204:207], a[216:223], v9
    v_max_u32 v4, v4, v5
    v_cmp_eq_u32 vcc, -1, v4
    v_smfmac_f32_16x16x64_bf16 v[80:83], v[204:207], a[248:255], v9
    s_cbranch_vccnz .A_152
.W_153:
    v_smfmac_f32_16x16x64_bf16 v[76:79], v[208:211], v[124:131], v9
    v_smfmac_f32_16x16x64_bf16 v[80:83], v[208:211], v[156:163], v9
    v_smfmac_f32_16x16x64_bf16 v[76:79], v[212:215], v[132:139], v9
    v_smfmac_f32_16x16x64_bf16 v[80:83], v[212:215], v[164:171], v9
    s_branch .mj_56
.W_143:
    v_smfmac_f32_16x16x64_bf16 v[76:79], v[200:203], a[208:215], v9
    v_smfmac_f32_16x16x64_bf16 v[80:83], v[200:203], a[240:247], v9
    s_waitcnt vmcnt(4)
    v_max3_u32 v4, v208, v209, v210
    v_max3_u32 v5, v211, v212, v213
    v_max3_u32 v4, v4, v214, v215
    v_smfmac_f32_16x16x64_bf16 v[76:79], v[204:207], a[216:223], v9
    v_max_u32 v4, v4, v5
    v_cmp_eq_u32 vcc, -1, v4
    v_smfmac_f32_16x16x64_bf16 v[80:83], v[204:207], a[248:255], v9
    s_cbranch_vccnz .A_154
.W_155:
    v_smfmac_f32_16x16x64_bf16 v[76:79], v[208:211], v[124:131], v9
    v_smfmac_f32_16x16x64_bf16 v[80:83], v[208:211], v[156:163], v9
    s_waitcnt vmcnt(2)
    v_max3_u32 v4, v216, v217, v218
    v_max3_u32 v5, v219, v220, v221
    v_max3_u32 v4, v4, v222, v223
    v_smfmac_f32_16x16x64_bf16 v[76:79], v[212:215], v[132:139], v9
    v_max_u32 v4, v4, v5
    v_cmp_eq_u32 vcc, -1, v4
    v_smfmac_f32_16x16x64_bf16 v[80:83], v[212:215], v[164:171], v9
    s_cbranch_vccnz .A_156
.W_157:
    v_smfmac_f32_16x16x64_bf16 v[76:79], v[216:219], v[140:147], v9
    v_smfmac_f32_16x16x64_bf16 v[80:83], v[216:219], v[172:179], v9
    s_waitcnt vmcnt(0)
    v_max3_u32 v4, v192, v193, v194
    v_max3_u32 v5, v195, v196, v197
    v_max3_u32 v4, v4, v198, v199
    v_smfmac_f32_16x16x64_bf16 v[76:79], v[220:223], v[148:155], v9
    v_max_u32 v4, v4, v5
    v_cmp_eq_u32 vcc, -1, v4
    v_smfmac_f32_16x16x64_bf16 v[80:83], v[220:223], v[180:187], v9
    s_cbranch_vccnz .A_158
.W_159:
    v_smfmac_f32_16x16x64_bf16 v[76:79], v[192:195], a[192:199], v9
    v_smfmac_f32_16x16x64_bf16 v[80:83], v[192:195], a[224:231], v9
    v_smfmac_f32_16x16x64_bf16 v[76:79], v[196:199], a[200:207], v9
    v_smfmac_f32_16x16x64_bf16 v[80:83], v[196:199], a[232:239], v9
    s_branch .mj_56
.W_145:
    v_smfmac_f32_16x16x64_bf16 v[76:79], v[208:211], v[124:131], v9
    v_smfmac_f32_16x16x64_bf16 v[80:83], v[208:211], v[156:163], v9
    s_waitcnt vmcnt(4)
    v_max3_u32 v4, v216, v217, v218
    v_max3_u32 v5, v219, v220, v221
    v_max3_u32 v4, v4, v222, v223
    v_smfmac_f32_16x16x64_bf16 v[76:79], v[212:215], v[132:139], v9
    v_max_u32 v4, v4, v5
    v_cmp_eq_u32 vcc, -1, v4
    v_smfmac_f32_16x16x64_bf16 v[80:83], v[212:215], v[164:171], v9
    s_cbranch_vccnz .A_160
.W_161:
    v_smfmac_f32_16x16x64_bf16 v[76:79], v[216:219], v[140:147], v9
    v_smfmac_f32_16x16x64_bf16 v[80:83], v[216:219], v[172:179], v9
    s_waitcnt vmcnt(2)
    v_max3_u32 v4, v192, v193, v194
    v_max3_u32 v5, v195, v196, v197
    v_max3_u32 v4, v4, v198, v199
    v_smfmac_f32_16x16x64_bf16 v[76:79], v[220:223], v[148:155], v9
    v_max_u32 v4, v4, v5
    v_cmp_eq_u32 vcc, -1, v4
    v_smfmac_f32_16x16x64_bf16 v[80:83], v[220:223], v[180:187], v9
    s_cbranch_vccnz .A_162
.W_163:
    v_smfmac_f32_16x16x64_bf16 v[76:79], v[192:195], a[192:199], v9
    v_smfmac_f32_16x16x64_bf16 v[80:83], v[192:195], a[224:231], v9
    s_waitcnt vmcnt(0)
    v_max3_u32 v4, v200, v201, v202
    v_max3_u32 v5, v203, v204, v205
    v_max3_u32 v4, v4, v206, v207
    v_smfmac_f32_16x16x64_bf16 v[76:79], v[196:199], a[200:207], v9
    v_max_u32 v4, v4, v5
    v_cmp_eq_u32 vcc, -1, v4
    v_smfmac_f32_16x16x64_bf16 v[80:83], v[196:199], a[232:239], v9
    s_cbranch_vccnz .A_164
.W_165:
    v_smfmac_f32_16x16x64_bf16 v[76:79], v[200:203], a[208:215], v9
    v_smfmac_f32_16x16x64_bf16 v[80:83], v[200:203], a[240:247], v9
    v_smfmac_f32_16x16x64_bf16 v[76:79], v[204:207], a[216:223], v9
    v_smfmac_f32_16x16x64_bf16 v[80:83], v[204:207], a[248:255], v9
    s_branch .mj_56
.A_166:
    buffer_load_dwordx4 v[208:211], v254, s[8:11], s32 offen offset:0 sc1
    buffer_load_dwordx4 v[212:215], v254, s[8:11], s32 offen offset:1024 sc1
    s_sub_u32 s62, s62, 1
    s_cbranch_scc1 .mg_end_1
    s_waitcnt vmcnt(4)
    v_max3_u32 v4, v192, v193, v194
    v_max3_u32 v5, v195, v196, v197
    v_max3_u32 v4, v4, v198, v199
    v_max_u32 v4, v4, v5
    v_cmp_eq_u32 vcc, -1, v4
    s_cbranch_vccz .W_149
.A_148:
    buffer_load_dwordx4 v[192:195], v243, s[8:11], s32 offen offset:0 sc1
    buffer_load_dwordx4 v[196:199], v243, s[8:11], s32 offen offset:1024 sc1
    s_waitcnt vmcnt(4)
    v_max3_u32 v4, v200, v201, v202
    v_max3_u32 v5, v203, v204, v205
    v_max3_u32 v4, v4, v206, v207
    v_max_u32 v4, v4, v5
    v_cmp_eq_u32 vcc, -1, v4
    s_cbranch_vccz .W_167
.A_168:
    buffer_load_dwordx4 v[200:203], v252, s[8:11], s32 offen offset:0 sc1
    buffer_load_dwordx4 v[204:207], v252, s[8:11], s32 offen offset:1024 sc1
    s_waitcnt vmcnt(4)
    v_max3_u32 v4, v208, v209, v210
    v_max3_u32 v5, v211, v212, v213
    v_max3_u32 v4, v4, v214, v215
    v_max_u32 v4, v4, v5
    v_cmp_eq_u32 vcc, -1, v4
    s_cbranch_vccnz .A_166
.W_169:
    v_smfmac_f32_16x16x64_bf16 v[76:79], v[208:211], v[124:131], v9
    v_smfmac_f32_16x16x64_bf16 v[80:83], v[208:211], v[156:163], v9
    s_waitcnt vmcnt(2)
    v_max3_u32 v4, v192, v193, v194
    v_max3_u32 v5, v195, v196, v197
    v_max3_u32 v4, v4, v198, v199
    v_smfmac_f32_16x16x64_bf16 v[76:79], v[212:215], v[132:139], v9
    v_max_u32 v4, v4, v5
    v_cmp_eq_u32 vcc, -1, v4
    v_smfmac_f32_16x16x64_bf16 v[80:83], v[212:215], v[164:171], v9
    s_cbranch_vccz .W_163
    s_branch .A_162
.W_167:
    v_smfmac_f32_16x16x64_bf16 v[76:79], v[200:203], a[208:215], v9
    v_smfmac_f32_16x16x64_bf16 v[80:83], v[200:203], a[240:247], v9
    s_waitcnt vmcnt(2)
    v_max3_u32 v4, v208, v209, v210
    v_max3_u32 v5, v211, v212, v213
    v_max3_u32 v4, v4, v214, v215
    v_smfmac_f32_16x16x64_bf16 v[76:79], v[204:207], a[216:223], v9
    v_max_u32 v4, v4, v5
    v_cmp_eq_u32 vcc, -1, v4
    v_smfmac_f32_16x16x64_bf16 v[80:83], v[204:207], a[248:255], v9
    s_cbranch_vccnz .A_170
.W_171:
    v_smfmac_f32_16x16x64_bf16 v[76:79], v[208:211], v[124:131], v9
    v_smfmac_f32_16x16x64_bf16 v[80:83], v[208:211], v[156:163], v9
    s_waitcnt vmcnt(0)
    v_max3_u32 v4, v192, v193, v194
    v_max3_u32 v5, v195, v196, v197
    v_max3_u32 v4, v4, v198, v199
    v_smfmac_f32_16x16x64_bf16 v[76:79], v[212:215], v[132:139], v9
    v_max_u32 v4, v4, v5
    v_cmp_eq_u32 vcc, -1, v4
    v_smfmac_f32_16x16x64_bf16 v[80:83], v[212:215], v[164:171], v9
    s_cbranch_vccz .W_159
    s_branch .A_158
.A_172:
    buffer_load_dwordx4 v[200:203], v252, s[8:11], s32 offen offset:0 sc1
    buffer_load_dwordx4 v[204:207], v252, s[8:11], s32 offen offset:1024 sc1
    s_sub_u32 s62, s62, 1
    s_cbranch_scc1 .mg_end_1
    s_waitcnt vmcnt(4)
    v_max3_u32 v4, v216, v217, v218
    v_max3_u32 v5, v219, v220, v221
    v_max3_u32 v4, v4, v222, v223
    v_max_u32 v4, v4, v5
    v_cmp_eq_u32 vcc, -1, v4
    s_cbranch_vccz .W_161
.A_160:
    buffer_load_dwordx4 v[216:219], v246, s[8:11], s32 offen offset:0 sc1
    buffer_load_dwordx4 v[220:223], v246, s[8:11], s32 offen offset:1024 sc1
    s_waitcnt vmcnt(4)
    v_max3_u32 v4, v192, v193, v194
    v_max3_u32 v5, v195, v196, v197
    v_max3_u32 v4, v4, v198, v199
    v_max_u32 v4, v4, v5
    v_cmp_eq_u32 vcc, -1, v4
    s_cbranch_vccz .W_173
.A_174:
    buffer_load_dwordx4 v[192:195], v243, s[8:11], s32 offen offset:0 sc1
    buffer_load_dwordx4 v[196:199], v243, s[8:11], s32 offen offset:1024 sc1
    s_waitcnt vmcnt(4)
    v_max3_u32 v4, v200, v201, v202
    v_max3_u32 v5, v203, v204, v205
    v_max3_u32 v4, v4, v206, v207
    v_max_u32 v4, v4, v5
    v_cmp_eq_u32 vcc, -1, v4
    s_cbranch_vccnz .A_172
.W_175:
    v_smfmac_f32_16x16x64_bf16 v[76:79], v[200:203], a[208:215], v9
    v_smfmac_f32_16x16x64_bf16 v[80:83], v[200:203], a[240:247], v9
    s_waitcnt vmcnt(2)
    v_max3_u32 v4, v216, v217, v218
    v_max3_u32 v5, v219, v220, v221
    v_max3_u32 v4, v4, v222, v223
    v_smfmac_f32_16x16x64_bf16 v[76:79], v[204:207], a[216:223], v9
    v_max_u32 v4, v4, v5
    v_cmp_eq_u32 vcc, -1, v4
    v_smfmac_f32_16x16x64_bf16 v[80:83], v[204:207], a[248:255], v9
    s_cbranch_vccz .W_157
    s_branch .A_156
.W_173:
    v_smfmac_f32_16x16x64_bf16 v[76:79], v[192:195], a[192:199], v9
    v_smfmac_f32_16x16x64_bf16 v[80:83], v[192:195], a[224:231], v9
    s_waitcnt vmcnt(2)
    v_max3_u32 v4, v200, v201, v202
    v_max3_u32 v5, v203, v204, v205
    v_max3_u32 v4, v4, v206, v207
    v_smfmac_f32_16x16x64_bf16 v[76:79], v[196:199], a[200:207], v9
    v_max_u32 v4, v4, v5
    v_cmp_eq_u32 vcc, -1, v4
    v_smfmac_f32_16x16x64_bf16 v[80:83], v[196:199], a[232:239], v9
    s_cbranch_vccnz .A_176
.W_177:
    v_smfmac_f32_16x16x64_bf16 v[76:79], v[200:203], a[208:215], v9
    v_smfmac_f32_16x16x64_bf16 v[80:83], v[200:203], a[240:247], v9
    s_waitcnt vmcnt(0)
    v_max3_u32 v4, v216, v217, v218
    v_max3_u32 v5, v219, v220, v221
    v_max3_u32 v4, v4, v222, v223
    v_smfmac_f32_16x16x64_bf16 v[76:79], v[204:207], a[216:223], v9
    v_max_u32 v4, v4, v5
    v_cmp_eq_u32 vcc, -1, v4
    v_smfmac_f32_16x16x64_bf16 v[80:83], v[204:207], a[248:255], v9
    s_cbranch_vccz .W_64
    s_branch .A_63
.A_178:
    buffer_load_dwordx4 v[216:219], v246, s[8:11], s32 offen offset:0 sc1
    buffer_load_dwordx4 v[220:223], v246, s[8:11], s32 offen offset:1024 sc1
    s_sub_u32 s62, s62, 1
    s_cbranch_scc1 .mg_end_1
    s_waitcnt vmcnt(4)
    v_max3_u32 v4, v192, v193, v194
    v_max3_u32 v5, v195, v196, v197
    v_max3_u32 v4, v4, v198, v199
    v_max_u32 v4, v4, v5
    v_cmp_eq_u32 vcc, -1, v4
    s_cbranch_vccz .W_179
.A_180:
    buffer_load_dwordx4 v[192:195], v243, s[8:11], s32 offen offset:0 sc1
    buffer_load_dwordx4 v[196:199], v243, s[8:11], s32 offen offset:1024 sc1
    s_waitcnt vmcnt(4)
    v_max3_u32 v4, v208, v209, v210
    v_max3_u32 v5, v211, v212, v213
    v_max3_u32 v4, v4, v214, v215
    v_max_u32 v4, v4, v5
    v_cmp_eq_u32 vcc, -1, v4
    s_cbranch_vccz .W_155
.A_154:
    buffer_load_dwordx4 v[208:211], v254, s[8:11], s32 offen offset:0 sc1
    buffer_load_dwordx4 v[212:215], v254, s[8:11], s32 offen offset:1024 sc1
    s_waitcnt vmcnt(4)
    v_max3_u32 v4, v216, v217, v218
    v_max3_u32 v5, v219, v220, v221
    v_max3_u32 v4, v4, v222, v223
    v_max_u32 v4, v4, v5
    v_cmp_eq_u32 vcc, -1, v4
    s_cbranch_vccnz .A_178
.W_181:
    v_smfmac_f32_16x16x64_bf16 v[76:79], v[216:219], v[140:147], v9
    v_smfmac_f32_16x16x64_bf16 v[80:83], v[216:219], v[172:179], v9
    s_waitcnt vmcnt(2)
    v_max3_u32 v4, v192, v193, v194
    v_max3_u32 v5, v195, v196, v197
    v_max3_u32 v4, v4, v198, v199
    v_smfmac_f32_16x16x64_bf16 v[76:79], v[220:223], v[148:155], v9
    v_max_u32 v4, v4, v5
    v_cmp_eq_u32 vcc, -1, v4
    v_smfmac_f32_16x16x64_bf16 v[80:83], v[220:223], v[180:187], v9
    s_cbranch_vccnz .A_182
.W_183:
    v_smfmac_f32_16x16x64_bf16 v[76:79], v[192:195], a[192:199], v9
    v_smfmac_f32_16x16x64_bf16 v[80:83], v[192:195], a[224:231], v9
    s_waitcnt vmcnt(0)
    v_max3_u32 v4, v208, v209, v210
    v_max3_u32 v5, v211, v212, v213
    v_max3_u32 v4, v4, v214, v215
    v_smfmac_f32_16x16x64_bf16 v[76:79], v[196:199], a[200:207], v9
    v_max_u32 v4, v4, v5
    v_cmp_eq_u32 vcc, -1, v4
    v_smfmac_f32_16x16x64_bf16 v[80:83], v[196:199], a[232:239], v9
    s_cbranch_vccz .W_153
    s_branch .A_152
.W_179:
    v_smfmac_f32_16x16x64_bf16 v[76:79], v[192:195], a[192:199], v9
    v_smfmac_f32_16x16x64_bf16 v[80:83], v[192:195], a[224:231], v9
    s_waitcnt vmcnt(2)
    v_max3_u32 v4, v208, v209, v210
    v_max3_u32 v5, v211, v212, v213
    v_max3_u32 v4, v4, v214, v215
    v_smfmac_f32_16x16x64_bf16 v[76:79], v[196:199], a[200:207], v9
    v_max_u32 v4, v4, v5
    v_cmp_eq_u32 vcc, -1, v4
    v_smfmac_f32_16x16x64_bf16 v[80:83], v[196:199], a[232:239], v9
    s_cbranch_vccz .W_62
    s_branch .A_61
.A_184:
    buffer_load_dwordx4 v[216:219], v246, s[8:11], s32 offen offset:0 sc1
    buffer_load_dwordx4 v[220:223], v246, s[8:11], s32 offen offset:1024 sc1
    s_sub_u32 s62, s62, 1
    s_cbranch_scc1 .mg_end_1
    s_waitcnt vmcnt(4)
    v_max3_u32 v4, v200, v201, v202
    v_max3_u32 v5, v203, v204, v205
    v_max3_u32 v4, v4, v206, v207
    v_max_u32 v4, v4, v5
    v_cmp_eq_u32 vcc, -1, v4
    s_cbranch_vccz .W_60
.A_59:
    buffer_load_dwordx4 v[200:203], v252, s[8:11], s32 offen offset:0 sc1
    buffer_load_dwordx4 v[204:207], v252, s[8:11], s32 offen offset:1024 sc1
    s_waitcnt vmcnt(4)
    v_max3_u32 v4, v208, v209, v210
    v_max3_u32 v5, v211, v212, v213
    v_max3_u32 v4, v4, v214, v215
    v_max_u32 v4, v4, v5
    v_cmp_eq_u32 vcc, -1, v4
    s_cbranch_vccz .W_185
.A_186:
    buffer_load_dwordx4 v[208:211], v254, s[8:11], s32 offen offset:0 sc1
    buffer_load_dwordx4 v[212:215], v254, s[8:11], s32 offen offset:1024 sc1
    s_waitcnt vmcnt(4)
    v_max3_u32 v4, v216, v217, v218
    v_max3_u32 v5, v219, v220, v221
    v_max3_u32 v4, v4, v222, v223
    v_max_u32 v4, v4, v5
    v_cmp_eq_u32 vcc, -1, v4
    s_cbranch_vccnz .A_184
.W_187:
    v_smfmac_f32_16x16x64_bf16 v[76:79], v[216:219], v[140:147], v9
    v_smfmac_f32_16x16x64_bf16 v[80:83], v[216:219], v[172:179], v9
    s_waitcnt vmcnt(2)
    v_max3_u32 v4, v200, v201, v202
    v_max3_u32 v5, v203, v204, v205
    v_max3_u32 v4, v4, v206, v207
    v_smfmac_f32_16x16x64_bf16 v[76:79], v[220:223], v[148:155], v9
    v_max_u32 v4, v4, v5
    v_cmp_eq_u32 vcc, -1, v4
    v_smfmac_f32_16x16x64_bf16 v[80:83], v[220:223], v[180:187], v9
    s_cbranch_vccz .W_151
    s_branch .A_150
.W_185:
    v_smfmac_f32_16x16x64_bf16 v[76:79], v[208:211], v[124:131], v9
    v_smfmac_f32_16x16x64_bf16 v[80:83], v[208:211], v[156:163], v9
    s_waitcnt vmcnt(2)
    v_max3_u32 v4, v216, v217, v218
    v_max3_u32 v5, v219, v220, v221
    v_max3_u32 v4, v4, v222, v223
    v_smfmac_f32_16x16x64_bf16 v[76:79], v[212:215], v[132:139], v9
    v_max_u32 v4, v4, v5
    v_cmp_eq_u32 vcc, -1, v4
    v_smfmac_f32_16x16x64_bf16 v[80:83], v[212:215], v[164:171], v9
    s_cbranch_vccnz .A_188
.W_189:
    v_smfmac_f32_16x16x64_bf16 v[76:79], v[216:219], v[140:147], v9
    v_smfmac_f32_16x16x64_bf16 v[80:83], v[216:219], v[172:179], v9
    s_waitcnt vmcnt(0)
    v_max3_u32 v4, v200, v201, v202
    v_max3_u32 v5, v203, v204, v205
    v_max3_u32 v4, v4, v206, v207
    v_smfmac_f32_16x16x64_bf16 v[76:79], v[220:223], v[148:155], v9
    v_max_u32 v4, v4, v5
    v_cmp_eq_u32 vcc, -1, v4
    v_smfmac_f32_16x16x64_bf16 v[80:83], v[220:223], v[180:187], v9
    s_cbranch_vccz .W_165
    s_branch .A_164
.A_190:
    buffer_load_dwordx4 v[200:203], v252, s[8:11], s32 offen offset:0 sc1
    buffer_load_dwordx4 v[204:207], v252, s[8:11], s32 offen offset:1024 sc1
    s_sub_u32 s62, s62, 1
    s_cbranch_scc1 .mg_end_1
    s_waitcnt vmcnt(2)
    v_max3_u32 v4, v192, v193, v194
    v_max3_u32 v5, v195, v196, v197
    v_max3_u32 v4, v4, v198, v199
    v_max_u32 v4, v4, v5
    v_cmp_eq_u32 vcc, -1, v4
    s_cbranch_vccz .W_163
.A_162:
    buffer_load_dwordx4 v[192:195], v243, s[8:11], s32 offen offset:0 sc1
    buffer_load_dwordx4 v[196:199], v243, s[8:11], s32 offen offset:1024 sc1
    s_waitcnt vmcnt(2)
    v_max3_u32 v4, v200, v201, v202
    v_max3_u32 v5, v203, v204, v205
    v_max3_u32 v4, v4, v206, v207
    v_max_u32 v4, v4, v5
    v_cmp_eq_u32 vcc, -1, v4
    s_cbranch_vccnz .A_190
.W_191:
    v_smfmac_f32_16x16x64_bf16 v[76:79], v[200:203], a[208:215], v9
    v_smfmac_f32_16x16x64_bf16 v[80:83], v[200:203], a[240:247], v9
    s_waitcnt vmcnt(0)
    v_max3_u32 v4, v192, v193, v194
    v_max3_u32 v5, v195, v196, v197
    v_max3_u32 v4, v4, v198, v199
    v_smfmac_f32_16x16x64_bf16 v[76:79], v[204:207], a[216:223], v9
    v_max_u32 v4, v4, v5
    v_cmp_eq_u32 vcc, -1, v4
    v_smfmac_f32_16x16x64_bf16 v[80:83], v[204:207], a[248:255], v9
    s_cbranch_vccz .W_159
    s_branch .A_158
.A_170:
    buffer_load_dwordx4 v[208:211], v254, s[8:11], s32 offen offset:0 sc1
    buffer_load_dwordx4 v[212:215], v254, s[8:11], s32 offen offset:1024 sc1
    s_sub_u32 s62, s62, 1
    s_cbranch_scc1 .mg_end_1
    s_waitcnt vmcnt(2)
    v_max3_u32 v4, v192, v193, v194
    v_max3_u32 v5, v195, v196, v197
    v_max3_u32 v4, v4, v198, v199
    v_max_u32 v4, v4, v5
    v_cmp_eq_u32 vcc, -1, v4
    s_cbranch_vccz .W_183
.A_182:
    buffer_load_dwordx4 v[192:195], v243, s[8:11], s32 offen offset:0 sc1
    buffer_load_dwordx4 v[196:199], v243, s[8:11], s32 offen offset:1024 sc1
    s_waitcnt vmcnt(2)
    v_max3_u32 v4, v208, v209, v210
    v_max3_u32 v5, v211, v212, v213
    v_max3_u32 v4, v4, v214, v215
    v_max_u32 v4, v4, v5
    v_cmp_eq_u32 vcc, -1, v4
    s_cbranch_vccnz .A_170
    s_branch .W_171
.A_192:
    buffer_load_dwordx4 v[192:195], v243, s[8:11], s32 offen offset:0 sc1
    buffer_load_dwordx4 v[196:199], v243, s[8:11], s32 offen offset:1024 sc1
    s_sub_u32 s62, s62, 1
    s_cbranch_scc1 .mg_end_1
    s_waitcnt vmcnt(2)
    v_max3_u32 v4, v216, v217, v218
    v_max3_u32 v5, v219, v220, v221
    v_max3_u32 v4, v4, v222, v223
    v_max_u32 v4, v4, v5
    v_cmp_eq_u32 vcc, -1, v4
    s_cbranch_vccz .W_157
.A_156:
    buffer_load_dwordx4 v[216:219], v246, s[8:11], s32 offen offset:0 sc1
    buffer_load_dwordx4 v[220:223], v246, s[8:11], s32 offen offset:1024 sc1
    s_waitcnt vmcnt(2)
    v_max3_u32 v4, v192, v193, v194
    v_max3_u32 v5, v195, v196, v197
    v_max3_u32 v4, v4, v198, v199
    v_max_u32 v4, v4, v5
    v_cmp_eq_u32 vcc, -1, v4
    s_cbranch_vccnz .A_192
.W_193:
    v_smfmac_f32_16x16x64_bf16 v[76:79], v[192:195], a[192:199], v9
    v_smfmac_f32_16x16x64_bf16 v[80:83], v[192:195], a[224:231], v9
    s_waitcnt vmcnt(0)
    v_max3_u32 v4, v216, v217, v218
    v_max3_u32 v5, v219, v220, v221
    v_max3_u32 v4, v4, v222, v223
    v_smfmac_f32_16x16x64_bf16 v[76:79], v[196:199], a[200:207], v9
    v_max_u32 v4, v4, v5
    v_cmp_eq_u32 vcc, -1, v4
    v_smfmac_f32_16x16x64_bf16 v[80:83], v[196:199], a[232:239], v9
    s_cbranch_vccz .W_64
    s_branch .A_63
.A_194:
    buffer_load_dwordx4 v[208:211], v254, s[8:11], s32 offen offset:0 sc1
    buffer_load_dwordx4 v[212:215], v254, s[8:11], s32 offen offset:1024 sc1
    s_sub_u32 s62, s62, 1
    s_cbranch_scc1 .mg_end_1
    s_waitcnt vmcnt(2)
    v_max3_u32 v4, v200, v201, v202
    v_max3_u32 v5, v203, v204, v205
    v_max3_u32 v4, v4, v206, v207
    v_max_u32 v4, v4, v5
    v_cmp_eq_u32 vcc, -1, v4
    s_cbranch_vccz .W_151
.A_150:
    buffer_load_dwordx4 v[200:203], v252, s[8:11], s32 offen offset:0 sc1
    buffer_load_dwordx4 v[204:207], v252, s[8:11], s32 offen offset:1024 sc1
    s_waitcnt vmcnt(2)
    v_max3_u32 v4, v208, v209, v210
    v_max3_u32 v5, v211, v212, v213
    v_max3_u32 v4, v4, v214, v215
    v_max_u32 v4, v4, v5
    v_cmp_eq_u32 vcc, -1, v4
    s_cbranch_vccnz .A_194
.W_195:
    v_smfmac_f32_16x16x64_bf16 v[76:79], v[208:211], v[124:131], v9
    v_smfmac_f32_16x16x64_bf16 v[80:83], v[208:211], v[156:163], v9
    s_waitcnt vmcnt(0)
    v_max3_u32 v4, v200, v201, v202
    v_max3_u32 v5, v203, v204, v205
    v_max3_u32 v4, v4, v206, v207
    v_smfmac_f32_16x16x64_bf16 v[76:79], v[212:215], v[132:139], v9
    v_max_u32 v4, v4, v5
    v_cmp_eq_u32 vcc, -1, v4
    v_smfmac_f32_16x16x64_bf16 v[80:83], v[212:215], v[164:171], v9
    s_cbranch_vccz .W_165
    s_branch .A_164
.A_188:
    buffer_load_dwordx4 v[216:219], v246, s[8:11], s32 offen offset:0 sc1
    buffer_load_dwordx4 v[220:223], v246, s[8:11], s32 offen offset:1024 sc1
    s_sub_u32 s62, s62, 1
    s_cbranch_scc1 .mg_end_1
    s_waitcnt vmcnt(2)
    v_max3_u32 v4, v200, v201, v202
    v_max3_u32 v5, v203, v204, v205
    v_max3_u32 v4, v4, v206, v207
    v_max_u32 v4, v4, v5
    v_cmp_eq_u32 vcc, -1, v4
    s_cbranch_vccz .W_177
.A_176:
    buffer_load_dwordx4 v[200:203], v252, s[8:11], s32 offen offset:0 sc1
    buffer_load_dwordx4 v[204:207], v252, s[8:11], s32 offen offset:1024 sc1
    s_waitcnt vmcnt(2)
    v_max3_u32 v4, v216, v217, v218
    v_max3_u32 v5, v219, v220, v221
    v_max3_u32 v4, v4, v222, v223
    v_max_u32 v4, v4, v5
    v_cmp_eq_u32 vcc, -1, v4
    s_cbranch_vccnz .A_188
    s_branch .W_189
.A_196:
    buffer_load_dwordx4 v[216:219], v246, s[8:11], s32 offen offset:0 sc1
    buffer_load_dwordx4 v[220:223], v246, s[8:11], s32 offen offset:1024 sc1
    s_sub_u32 s62, s62, 1
    s_cbranch_scc1 .mg_end_1
    s_waitcnt vmcnt(2)
    v_max3_u32 v4, v208, v209, v210
    v_max3_u32 v5, v211, v212, v213
    v_max3_u32 v4, v4, v214, v215
    v_max_u32 v4, v4, v5
    v_cmp_eq_u32 vcc, -1, v4
    s_cbranch_vccz .W_62
.A_61:
    buffer_load_dwordx4 v[208:211], v254, s[8:11], s32 offen offset:0 sc1
    buffer_load_dwordx4 v[212:215], v254, s[8:11], s32 offen offset:1024 sc1
    s_waitcnt vmcnt(2)
    v_max3_u32 v4, v216, v217, v218
    v_max3_u32 v5, v219, v220, v221
    v_max3_u32 v4, v4, v222, v223
    v_max_u32 v4, v4, v5
    v_cmp_eq_u32 vcc, -1, v4
    s_cbranch_vccnz .A_196
.W_197:
    v_smfmac_f32_16x16x64_bf16 v[76:79], v[216:219], v[140:147], v9
    v_smfmac_f32_16x16x64_bf16 v[80:83], v[216:219], v[172:179], v9
    s_waitcnt vmcnt(0)
    v_max3_u32 v4, v208, v209, v210
    v_max3_u32 v5, v211, v212, v213
    v_max3_u32 v4, v4, v214, v215
    v_smfmac_f32_16x16x64_bf16 v[76:79], v[220:223], v[148:155], v9
    v_max_u32 v4, v4, v5
    v_cmp_eq_u32 vcc, -1, v4
    v_smfmac_f32_16x16x64_bf16 v[80:83], v[220:223], v[180:187], v9
    s_cbranch_vccz .W_153
    s_branch .A_152
.A_158:
    buffer_load_dwordx4 v[192:195], v243, s[8:11], s32 offen offset:0 sc1
    buffer_load_dwordx4 v[196:199], v243, s[8:11], s32 offen offset:1024 sc1
    s_sub_u32 s62, s62, 1
    s_cbranch_scc1 .mg_end_1
    s_waitcnt vmcnt(2)
    v_max3_u32 v4, v192, v193, v194
    v_max3_u32 v5, v195, v196, v197
    v_max3_u32 v4, v4, v198, v199
    v_max_u32 v4, v4, v5
    v_cmp_eq_u32 vcc, -1, v4
    s_cbranch_vccnz .A_158
    v_smfmac_f32_16x16x64_bf16 v[76:79], v[192:195], a[192:199], v9
    v_smfmac_f32_16x16x64_bf16 v[80:83], v[192:195], a[224:231], v9
    v_smfmac_f32_16x16x64_bf16 v[76:79], v[196:199], a[200:207], v9
    v_smfmac_f32_16x16x64_bf16 v[80:83], v[196:199], a[232:239], v9
    s_branch .mj_56
.A_164:
    buffer_load_dwordx4 v[200:203], v252, s[8:11], s32 offen offset:0 sc1
    buffer_load_dwordx4 v[204:207], v252, s[8:11], s32 offen offset:1024 sc1
    s_sub_u32 s62, s62, 1
    s_cbranch_scc1 .mg_end_1
    s_waitcnt vmcnt(2)
    v_max3_u32 v4, v200, v201, v202
    v_max3_u32 v5, v203, v204, v205
    v_max3_u32 v4, v4, v206, v207
    v_max_u32 v4, v4, v5
    v_cmp_eq_u32 vcc, -1, v4
    s_cbranch_vccnz .A_164
    v_smfmac_f32_16x16x64_bf16 v[76:79], v[200:203], a[208:215], v9
    v_smfmac_f32_16x16x64_bf16 v[80:83], v[200:203], a[240:247], v9
    v_smfmac_f32_16x16x64_bf16 v[76:79], v[204:207], a[216:223], v9
    v_smfmac_f32_16x16x64_bf16 v[80:83], v[204:207], a[248:255], v9
    s_branch .mj_56
.A_152:
    buffer_load_dwordx4 v[208:211], v254, s[8:11], s32 offen offset:0 sc1
    buffer_load_dwordx4 v[212:215], v254, s[8:11], s32 offen offset:1024 sc1
    s_sub_u32 s62, s62, 1
    s_cbranch_scc1 .mg_end_1
    s_waitcnt vmcnt(2)
    v_max3_u32 v4, v208, v209, v210
    v_max3_u32 v5, v211, v212, v213
    v_max3_u32 v4, v4, v214, v215
    v_max_u32 v4, v4, v5
    v_cmp_eq_u32 vcc, -1, v4
    s_cbranch_vccnz .A_152
    v_smfmac_f32_16x16x64_bf16 v[76:79], v[208:211], v[124:131], v9
    v_smfmac_f32_16x16x64_bf16 v[80:83], v[208:211], v[156:163], v9
    v_smfmac_f32_16x16x64_bf16 v[76:79], v[212:215], v[132:139], v9
    v_smfmac_f32_16x16x64_bf16 v[80:83], v[212:215], v[164:171], v9
    s_branch .mj_56
.A_63:
    buffer_load_dwordx4 v[216:219], v246, s[8:11], s32 offen offset:0 sc1
    buffer_load_dwordx4 v[220:223], v246, s[8:11], s32 offen offset:1024 sc1
    s_sub_u32 s62, s62, 1
    s_cbranch_scc1 .mg_end_1
    s_waitcnt vmcnt(2)
    v_max3_u32 v4, v216, v217, v218
    v_max3_u32 v5, v219, v220, v221
    v_max3_u32 v4, v4, v222, v223
    v_max_u32 v4, v4, v5
    v_cmp_eq_u32 vcc, -1, v4
    s_cbranch_vccnz .A_63
    v_smfmac_f32_16x16x64_bf16 v[76:79], v[216:219], v[140:147], v9
    v_smfmac_f32_16x16x64_bf16 v[80:83], v[216:219], v[172:179], v9
    v_smfmac_f32_16x16x64_bf16 v[76:79], v[220:223], v[148:155], v9
    v_smfmac_f32_16x16x64_bf16 v[80:83], v[220:223], v[180:187], v9
    s_branch .mj_56
.sk_65:
    s_mov_b64 exec, s[66:67]
    buffer_store_dwordx4 v[88:91], v11, s[8:11], s36 offen sc1
    s_mov_b64 exec, s[56:57]
    buffer_store_dwordx4 v[172:175], v12, s[8:11], s36 offen sc1
    s_mov_b64 exec, -1

    s_branch .rec_fin_6
.p2align 6
.top_198:
    s_barrier
    buffer_load_dwordx4 v[20:23], v8, s[8:11], s29 offen offset:0 sc1
    v_mov_b32 v52, 0
    buffer_load_dwordx4 v[24:27], v8, s[8:11], s29 offen offset:1024 sc1
    v_mov_b32 v53, 0
    buffer_load_dwordx4 v[28:31], v8, s[8:11], s29 offen offset:2048 sc1
    v_mov_b32 v54, 0
    buffer_load_dwordx4 v[32:35], v8, s[8:11], s29 offen offset:3072 sc1
.ent1_25:
    s_waitcnt vmcnt(3)
    v_max3_u32 v4, v20, v21, v22
    v_max_u32 v4, v4, v23
    v_cmp_eq_u32 vcc, -1, v4
    s_cbranch_vccnz .A_203
.W_204:
    v_smfmac_f32_16x16x64_bf16 v[52:55], v[20:23], a[0:7], v9
    v_smfmac_f32_16x16x64_bf16 v[56:59], v[20:23], a[32:39], v9
    s_waitcnt vmcnt(2)
    v_max3_u32 v4, v24, v25, v26
    v_max_u32 v4, v4, v27
    v_smfmac_f32_16x16x64_bf16 v[60:63], v[20:23], a[64:71], v9
    v_cmp_eq_u32 vcc, -1, v4
    v_smfmac_f32_16x16x64_bf16 v[64:67], v[20:23], a[96:103], v9
    s_cbranch_vccnz .A_205
.W_206:
    v_smfmac_f32_16x16x64_bf16 v[52:55], v[24:27], a[8:15], v9
    v_smfmac_f32_16x16x64_bf16 v[56:59], v[24:27], a[40:47], v9
    s_waitcnt vmcnt(1)
    v_max3_u32 v4, v28, v29, v30
    v_max_u32 v4, v4, v31
    v_smfmac_f32_16x16x64_bf16 v[60:63], v[24:27], a[72:79], v9
    v_cmp_eq_u32 vcc, -1, v4
    v_smfmac_f32_16x16x64_bf16 v[64:67], v[24:27], a[104:111], v9
    s_cbranch_vccnz .A_207
.W_208:
    v_smfmac_f32_16x16x64_bf16 v[52:55], v[28:31], a[16:23], v9
    v_smfmac_f32_16x16x64_bf16 v[56:59], v[28:31], a[48:55], v9
    s_waitcnt vmcnt(0)
    v_max3_u32 v4, v32, v33, v34
    v_max_u32 v4, v4, v35
    v_smfmac_f32_16x16x64_bf16 v[60:63], v[28:31], a[80:87], v9
    v_cmp_eq_u32 vcc, -1, v4
    v_smfmac_f32_16x16x64_bf16 v[64:67], v[28:31], a[112:119], v9
    s_cbranch_vccnz .A_209
.W_210:
    v_smfmac_f32_16x16x64_bf16 v[52:55], v[32:35], a[24:31], v9
    v_smfmac_f32_16x16x64_bf16 v[56:59], v[32:35], a[56:63], v9
    v_smfmac_f32_16x16x64_bf16 v[60:63], v[32:35], a[88:95], v9
    v_smfmac_f32_16x16x64_bf16 v[64:67], v[32:35], a[120:127], v9
.mj_202:
    v_cvt_pk_bf16_f32 v104, v52, v53
    v_cvt_pk_bf16_f32 v105, v54, v55
    v_cvt_pk_bf16_f32 v106, v56, v57
    v_cvt_pk_bf16_f32 v107, v58, v59
    ds_write_b64 v16, v[104:105] offset:4096
    v_cvt_pk_bf16_f32 v108, v60, v61
    v_cvt_pk_bf16_f32 v109, v62, v63
    ds_write_b64 v16, v[106:107] offset:6144
    ds_write_b64 v16, v[108:109] offset:0
    v_cvt_pk_bf16_f32 v110, v64, v65
    v_cvt_pk_bf16_f32 v111, v66, v67
    ds_write_b64 v16, v[110:111] offset:2048
    v_smfmac_f32_16x16x64_bf16 v[68:71], v[20:23], a[128:135], v9
    v_smfmac_f32_16x16x64_bf16 v[72:75], v[20:23], a[160:167], v9
    s_waitcnt lgkmcnt(0)
    s_barrier
    ds_read_b128 v[36:39], v17 offset:0
    ds_read_b128 v[40:43], v17 offset:1024
    v_smfmac_f32_16x16x64_bf16 v[68:71], v[24:27], a[136:143], v9
    v_smfmac_f32_16x16x64_bf16 v[72:75], v[24:27], a[168:175], v9
    s_waitcnt lgkmcnt(1)
    v_mfma_f32_16x16x32_bf16 v[44:47], v[36:39], v[84:87], 0
    s_waitcnt lgkmcnt(0)
    v_mfma_f32_16x16x32_bf16 v[44:47], v[40:43], v[84:87], v[44:47]
    v_smfmac_f32_16x16x64_bf16 v[68:71], v[28:31], a[144:151], v9
    v_smfmac_f32_16x16x64_bf16 v[72:75], v[28:31], a[176:183], v9
    s_mov_b64 exec, s[64:65]
    v_cvt_pk_bf16_f32 v48, v44, v45
    v_cvt_pk_bf16_f32 v49, v46, v47
    v_min_u32 v48, 0xfffffffe, v48
    v_min_u32 v49, 0xfffffffe, v49
    buffer_store_dwordx2 v[48:49], v10, s[8:11], s29 offen sc1

    ds_write_b64 v18, v[48:49]
    s_mov_b64 exec, -1

    v_smfmac_f32_16x16x64_bf16 v[68:71], v[32:35], a[152:159], v9
    v_smfmac_f32_16x16x64_bf16 v[72:75], v[32:35], a[184:191], v9
    s_nop 3
    v_cvt_pk_bf16_f32 v104, v68, v69
    v_cvt_pk_bf16_f32 v105, v70, v71
    ds_write_b64 v16, v[104:105] offset:8192
    s_nop 0
    v_cvt_pk_bf16_f32 v106, v72, v73
    v_cvt_pk_bf16_f32 v107, v74, v75
    ds_write_b64 v16, v[106:107] offset:10240
    s_cmp_lg_u32 s24, 2
    s_waitcnt lgkmcnt(0)
    s_barrier
    s_cbranch_scc1 .oth_199
    buffer_load_dwordx4 v[92:95], v232, s[8:11], s29 offen sc1
    buffer_load_dwordx4 v[96:99], v233, s[8:11], s29 offen sc1
    buffer_load_dwordx4 v[100:103], v234, s[8:11], s29 offen sc1
    ds_read_b128 v[88:91], v14 offset:16384
    s_cmp_eq_u32 s28, 63
    s_cbranch_scc1 .rec_fin_6
    s_waitcnt lgkmcnt(0)
    v_mfma_f32_16x16x32_bf16 v[208:211], v[128:131], v[88:91], 0
    v_mfma_f32_16x16x32_bf16 v[212:215], v[144:147], v[88:91], 0
    v_mfma_f32_16x16x32_bf16 v[216:219], v[88:91], v[88:91], v[116:119]
    s_waitcnt vmcnt(2)
    v_max3_u32 v4, v92, v93, v94
    v_max_u32 v4, v4, v95
    v_cmp_eq_u32 vcc, -1, v4
    s_cbranch_vccnz .A_212
.W_213:
    v_mfma_f32_16x16x32_bf16 v[208:211], v[132:135], v[92:95], v[208:211]
    s_waitcnt vmcnt(1)
    v_max3_u32 v4, v96, v97, v98
    v_max_u32 v4, v4, v99
    v_mfma_f32_16x16x32_bf16 v[212:215], v[148:151], v[92:95], v[212:215]
    v_cmp_eq_u32 vcc, -1, v4
    v_mfma_f32_16x16x32_bf16 v[216:219], v[92:95], v[92:95], v[216:219]
    s_cbranch_vccnz .A_214
.W_215:
    v_mfma_f32_16x16x32_bf16 v[208:211], v[136:139], v[96:99], v[208:211]
    s_waitcnt vmcnt(0)
    v_max3_u32 v4, v100, v101, v102
    v_max_u32 v4, v4, v103
    v_mfma_f32_16x16x32_bf16 v[212:215], v[152:155], v[96:99], v[212:215]
    v_cmp_eq_u32 vcc, -1, v4
    v_mfma_f32_16x16x32_bf16 v[216:219], v[96:99], v[96:99], v[216:219]
    s_cbranch_vccnz .A_216
.W_217:
    v_mfma_f32_16x16x32_bf16 v[208:211], v[140:143], v[100:103], v[208:211]
    v_mfma_f32_16x16x32_bf16 v[212:215], v[156:159], v[100:103], v[212:215]
    v_mfma_f32_16x16x32_bf16 v[216:219], v[100:103], v[100:103], v[216:219]
.mj_211:
    s_barrier
    ds_read_b64 v[168:169], v14 offset:18432
    ds_read_b64 v[172:173], v14 offset:18440
    s_nop 0

    v_mov_b32_dpp v208, v212 row_ror:8 row_mask:0xf bank_mask:0xc
    v_mov_b32_dpp v209, v213 row_ror:8 row_mask:0xf bank_mask:0xc
    v_mov_b32_dpp v210, v214 row_ror:8 row_mask:0xf bank_mask:0xc
    v_mov_b32_dpp v211, v215 row_ror:8 row_mask:0xf bank_mask:0xc
    v_mov_b32_dpp v216, v218 row_ror:8 row_mask:0xf bank_mask:0xc
    v_mov_b32_dpp v217, v219 row_ror:8 row_mask:0xf bank_mask:0xc
    v_max3_f32 v4, v208, v209, v210
    v_max3_f32 v5, v211, v216, v217
    v_max_f32 v6, v4, v5
    v_max_f32 v4, v4, v5
    s_nop 1
    v_permlane32_swap_b32 v4, v6
    v_max_f32 v5, v4, v6
    v_max_f32 v4, v4, v6
    s_nop 1
    v_permlane16_swap_b32 v4, v5
    v_max_f32 v4, v4, v5
    s_nop 1
    v_max_f32_dpp v4, v4, v4 row_ror:8 row_mask:0xf bank_mask:0xf
    v_mul_f32 v4, s37, v4

    v_fma_f32 v104, v208, s37, -v4
    v_fma_f32 v105, v209, s37, -v4
    v_fma_f32 v106, v210, s37, -v4
    v_fma_f32 v107, v211, s37, -v4
    v_fma_f32 v108, v216, s37, -v4
    v_fma_f32 v109, v217, s37, -v4
    v_exp_f32 v104, v104
    v_exp_f32 v105, v105
    v_exp_f32 v106, v106
    v_exp_f32 v107, v107
    v_exp_f32 v108, v108
    v_exp_f32 v109, v109
    v_cvt_pk_bf16_f32 v176, v104, v105
    v_cvt_pk_bf16_f32 v177, v106, v107
    v_cvt_pk_bf16_f32 v180, v108, v109
    v_mov_b32_dpp v178, v176 row_ror:8 row_mask:0xf bank_mask:0xf
    v_mov_b32_dpp v179, v177 row_ror:8 row_mask:0xf bank_mask:0xf
    v_mov_b32_dpp v181, v180 row_ror:8 row_mask:0xf bank_mask:0xf
    s_waitcnt lgkmcnt(0)

    v_mfma_f32_16x16x32_bf16 v[208:211], v[120:123], v[176:179], 0
    v_mfma_f32_16x16x32_bf16 v[208:211], v[120:123], v[180:183], v[208:211]
    v_mfma_f32_16x16x32_bf16 v[212:215], v[160:163], v[176:179], 0
    v_mfma_f32_16x16x32_bf16 v[216:219], v[164:167], v[176:179], 0
    v_mfma_f32_16x16x32_bf16 v[212:215], v[168:171], v[180:183], v[212:215]
    v_rcp_f32 v4, v208
    v_mfma_f32_16x16x32_bf16 v[216:219], v[172:175], v[180:183], v[216:219]
    s_mov_b64 exec, s[58:59]
    s_nop 2
    v_mul_f32 v212, v4, v212
    v_mul_f32 v213, v4, v213
    v_mul_f32 v214, v4, v214
    v_mul_f32 v215, v4, v215
    v_cvt_pk_bf16_f32 v184, v212, v213
    v_cvt_pk_bf16_f32 v185, v214, v215
    v_mul_f32 v216, v4, v216
    v_mul_f32 v217, v4, v217
    v_min_u32 v184, 0xfffffffe, v184
    v_min_u32 v185, 0xfffffffe, v185
    v_mul_f32 v218, v4, v218
    v_mul_f32 v219, v4, v219
    v_cvt_pk_bf16_f32 v186, v216, v217
    v_cvt_pk_bf16_f32 v187, v218, v219
    v_min_u32 v186, 0xfffffffe, v186
    v_min_u32 v187, 0xfffffffe, v187
    buffer_store_dwordx4 v[184:187], v13, s[8:11], s29 offen sc1
    s_mov_b64 exec, -1

.gp_201:
    s_barrier
    v_mov_b32 v5, 19968
    ds_read_b32 v4, v5
    s_mov_b32 s99, s68
    s_waitcnt vmcnt(0)
    s_cmp_eq_u32 s24, 3
    s_cbranch_scc1 .u3_218
    s_add_u32 s6, s28, 3
    s_add_u32 s7, s30, 262144
    s_waitcnt lgkmcnt(0)
    v_readfirstlane_b32 s5, v4
    s_cmp_lt_u32 s5, s6
    s_barrier
    s_cbranch_scc1 .np_220
    buffer_load_dword v226, v225, s[8:11], s7 offen

.np_220:
    s_add_u32 s4, s70, 0
    buffer_store_dwordx4 v[188:191], v238, s[8:11], s4 offen sc1
    s_add_u32 s4, s70, 262144
    buffer_store_dwordx4 v[188:191], v238, s[8:11], s4 offen sc1
    s_branch .u4_219
.u3_218:
    s_sub_u32 s4, s36, 0
    s_barrier
    s_mov_b64 exec, s[66:67]
    buffer_store_dwordx4 v[88:91], v11, s[8:11], s4 offen sc1
    s_mov_b64 exec, s[56:57]
    buffer_store_dwordx4 v[172:175], v12, s[8:11], s4 offen sc1
    s_mov_b64 exec, -1

.u4_219:
    s_barrier
    s_add_u32 s28, s28, 1
    s_add_u32 s36, s36, 196608
    s_cmp_lt_u32 s28, 63
    s_cselect_b32 s4, 262144, 0
    s_add_u32 s38, s38, s4
    s_add_u32 s39, s39, s4
    s_add_u32 s30, s30, s4
    s_mov_b32 s4, s68
    s_mov_b32 s68, s69
    s_mov_b32 s69, s70
    s_mov_b32 s70, s71
    s_mov_b32 s71, s4
    s_and_b32 s4, s28, 3
    s_lshl_b32 s5, s4, 17
    s_add_u32 s29, s5, s34
    s_xor_b32 s6, s5, 262144
    s_add_u32 s31, s6, s34
    s_add_u32 s32, s29, 20480
    s_add_u32 s33, s29, 24576
    v_mov_b32 v55, 0
    v_mov_b32 v56, 0
    v_mov_b32 v57, 0
    v_mov_b32 v58, 0
    v_mov_b32 v59, 0
    v_mov_b32 v60, 0
    v_mov_b32 v61, 0
    v_mov_b32 v62, 0
    v_mov_b32 v63, 0
    v_mov_b32 v64, 0
    v_mov_b32 v65, 0
    v_mov_b32 v66, 0
    v_mov_b32 v67, 0
    v_mov_b32 v68, 0
    v_mov_b32 v69, 0
    v_mov_b32 v70, 0
    v_mov_b32 v71, 0
    v_mov_b32 v72, 0
    v_mov_b32 v73, 0
    v_mov_b32 v74, 0
    v_mov_b32 v75, 0
    v_mov_b32 v20, -1
    v_mov_b32 v21, -1
    v_mov_b32 v22, -1
    v_mov_b32 v23, -1
    v_mov_b32 v24, -1
    v_mov_b32 v25, -1
    v_mov_b32 v26, -1
    v_mov_b32 v27, -1
    v_mov_b32 v28, -1
    v_mov_b32 v29, -1
    v_mov_b32 v30, -1
    v_mov_b32 v31, -1
    v_mov_b32 v32, -1
    v_mov_b32 v33, -1
    v_mov_b32 v34, -1
    v_mov_b32 v35, -1
    v_mov_b32 v92, -1
    v_mov_b32 v93, -1
    v_mov_b32 v94, -1
    v_mov_b32 v95, -1
    v_mov_b32 v96, -1
    v_mov_b32 v97, -1
    v_mov_b32 v98, -1
    v_mov_b32 v99, -1
    v_mov_b32 v100, -1
    v_mov_b32 v101, -1
    v_mov_b32 v102, -1
    v_mov_b32 v103, -1
    s_add_u32 s4, s99, 0
    buffer_load_dwordx4 v[192:195], v239, s[8:11], s4 offen sc1
    buffer_load_dwordx4 v[196:199], v249, s[8:11], s4 offen sc1

    ds_read_b128 v[128:131], v228 offset:0
    ds_read_b128 v[144:147], v228 offset:4096
    ds_read_b128 v[132:135], v229 offset:0
    ds_read_b128 v[148:151], v229 offset:4096
    ds_read_b128 v[136:139], v230 offset:0
    ds_read_b128 v[152:155], v230 offset:4096
    ds_read_b128 v[140:143], v231 offset:0
    ds_read_b128 v[156:159], v231 offset:4096
    ds_read_b128 v[160:163], v14 offset:28672
    ds_read_b128 v[164:167], v14 offset:29696
    ds_read_b128 v[108:111], v248
    s_waitcnt lgkmcnt(0)
    v_mfma_f32_16x16x32_bf16 v[76:79], v[108:111], v[112:115], 0
    s_add_u32 s4, s99, 262144
    buffer_load_dwordx4 v[200:203], v239, s[8:11], s4 offen sc1
    buffer_load_dwordx4 v[204:207], v249, s[8:11], s4 offen sc1

.gc_221:
    s_waitcnt vmcnt(2)

    v_max_u32 v4, v192, v196
    v_cmp_eq_u32 vcc, -1, v4
    s_cbranch_vccnz .gf_222
    v_mfma_f32_16x16x32_bf16 v[76:79], v[192:195], v[84:87], v[76:79]
    v_mfma_f32_16x16x32_bf16 v[76:79], v[196:199], v[112:115], v[76:79]
    s_mov_b64 exec, s[58:59]
    s_nop 6
    v_cvt_pk_bf16_f32 v104, v76, v77
    v_cvt_pk_bf16_f32 v105, v78, v79
    v_min_u32 v104, 0xfffffffe, v104
    v_min_u32 v105, 0xfffffffe, v105
    buffer_store_dwordx2 v[104:105], v15, s[8:11], s29 offen sc1
    s_mov_b64 exec, -1

    s_branch .top_198
.gf_222:
    s_add_u32 s4, s99, 0
    buffer_load_dwordx4 v[192:195], v239, s[8:11], s4 offen sc1
    buffer_load_dwordx4 v[196:199], v249, s[8:11], s4 offen sc1

    s_waitcnt vmcnt(2)

    v_max_u32 v4, v200, v204
    v_cmp_eq_u32 vcc, -1, v4
    s_cbranch_vccnz .gf_223
    v_mfma_f32_16x16x32_bf16 v[76:79], v[200:203], v[84:87], v[76:79]
    v_mfma_f32_16x16x32_bf16 v[76:79], v[204:207], v[112:115], v[76:79]
    s_mov_b64 exec, s[58:59]
    s_nop 6
    v_cvt_pk_bf16_f32 v104, v76, v77
    v_cvt_pk_bf16_f32 v105, v78, v79
    v_min_u32 v104, 0xfffffffe, v104
    v_min_u32 v105, 0xfffffffe, v105
    buffer_store_dwordx2 v[104:105], v15, s[8:11], s29 offen sc1
    s_mov_b64 exec, -1

    s_branch .top_198
.gf_223:
    s_add_u32 s4, s99, 262144
    buffer_load_dwordx4 v[200:203], v239, s[8:11], s4 offen sc1
    buffer_load_dwordx4 v[204:207], v249, s[8:11], s4 offen sc1

    s_sub_u32 s62, s62, 1
    s_cbranch_scc1 .mg_end_1
    s_branch .gc_221
.oth_199:
    s_cmp_eq_u32 s24, 3
    s_cbranch_scc1 .w3_200
    s_cmp_eq_u32 s28, 63
    s_cbranch_scc1 .rec_fin_6
    s_add_u32 s6, s28, 4
    s_cmp_ge_u32 s93, s6
    s_cbranch_scc1 .nl_224
    s_buffer_load_dword s14, s[8:11], s89 glc
    s_buffer_load_dword s15, s[8:11], s89 offset:8192 glc

.nl_224:
    s_waitcnt vmcnt(0)
    v_mov_b32 v71, 0
    v_mov_b32 v72, 0
    v_mov_b32 v73, 0
    v_mov_b32 v74, 0
    v_mov_b32 v75, 0
    s_barrier
    s_add_u32 s6, s28, 2
    s_min_u32 s6, s6, 64
    s_cmp_lt_u32 s93, s6
    s_cbranch_scc1 .kf_225
.kb_226:
    s_mov_b32 m0, s90
    s_nop 0
    buffer_load_dwordx4 v14, s[8:11], s38 offen offset:0 lds
    buffer_load_dwordx4 v14, s[8:11], s38 offen offset:1024 lds
    buffer_load_dwordx4 v14, s[8:11], s38 offen offset:2048 lds
    buffer_load_dwordx4 v14, s[8:11], s38 offen offset:3072 lds
    s_mov_b32 m0, s91
    s_nop 0
    buffer_load_dwordx4 v14, s[8:11], s39 offen lds
    s_barrier
    v_mov_b32 v20, -1
    v_mov_b32 v21, -1
    v_mov_b32 v22, -1
    v_mov_b32 v23, -1
    v_mov_b32 v24, -1
    v_mov_b32 v25, -1
    v_mov_b32 v26, -1
    v_mov_b32 v27, -1
    v_mov_b32 v28, -1
    v_mov_b32 v29, -1
    v_mov_b32 v30, -1
    v_mov_b32 v31, -1
    v_mov_b32 v32, -1
    v_mov_b32 v33, -1
    v_mov_b32 v34, -1
    v_mov_b32 v35, -1
    v_mov_b32 v55, 0
    v_mov_b32 v56, 0
    v_mov_b32 v57, 0
    v_mov_b32 v58, 0
    v_mov_b32 v59, 0
    v_mov_b32 v60, 0
    v_mov_b32 v61, 0
    v_mov_b32 v62, 0
    v_mov_b32 v63, 0
    v_mov_b32 v64, 0
    v_mov_b32 v65, 0
    v_mov_b32 v66, 0
    v_mov_b32 v67, 0
    v_mov_b32 v68, 0
    v_mov_b32 v69, 0
    v_mov_b32 v70, 0
    buffer_load_dwordx4 v[192:195], v243, s[8:11], s32 offen offset:0 sc1
    buffer_load_dwordx4 v[196:199], v243, s[8:11], s32 offen offset:1024 sc1
    v_mov_b32 v76, 0
    buffer_load_dwordx4 v[200:203], v252, s[8:11], s32 offen offset:0 sc1
    buffer_load_dwordx4 v[204:207], v252, s[8:11], s32 offen offset:1024 sc1
    v_mov_b32 v77, 0
    buffer_load_dwordx4 v[208:211], v254, s[8:11], s32 offen offset:0 sc1
    buffer_load_dwordx4 v[212:215], v254, s[8:11], s32 offen offset:1024 sc1
    v_mov_b32 v78, 0
    buffer_load_dwordx4 v[216:219], v246, s[8:11], s32 offen offset:0 sc1
    buffer_load_dwordx4 v[220:223], v246, s[8:11], s32 offen offset:1024 sc1
    s_waitcnt vmcnt(6)
    v_max3_u32 v4, v192, v193, v194
    v_max3_u32 v5, v195, v196, v197
    v_max3_u32 v4, v4, v198, v199
    v_max_u32 v4, v4, v5
    v_cmp_eq_u32 vcc, -1, v4
    s_cbranch_vccnz .A_228
.W_229:
    v_smfmac_f32_16x16x64_bf16 v[76:79], v[192:195], a[192:199], v9
    v_smfmac_f32_16x16x64_bf16 v[80:83], v[192:195], a[224:231], v9
    s_waitcnt vmcnt(4)
    v_max3_u32 v4, v200, v201, v202
    v_max3_u32 v5, v203, v204, v205
    v_max3_u32 v4, v4, v206, v207
    v_smfmac_f32_16x16x64_bf16 v[76:79], v[196:199], a[200:207], v9
    v_max_u32 v4, v4, v5
    v_cmp_eq_u32 vcc, -1, v4
    v_smfmac_f32_16x16x64_bf16 v[80:83], v[196:199], a[232:239], v9
    s_cbranch_vccnz .A_230
.W_231:
    v_smfmac_f32_16x16x64_bf16 v[76:79], v[200:203], a[208:215], v9
    v_smfmac_f32_16x16x64_bf16 v[80:83], v[200:203], a[240:247], v9
    s_waitcnt vmcnt(2)
    v_max3_u32 v4, v208, v209, v210
    v_max3_u32 v5, v211, v212, v213
    v_max3_u32 v4, v4, v214, v215
    v_smfmac_f32_16x16x64_bf16 v[76:79], v[204:207], a[216:223], v9
    v_max_u32 v4, v4, v5
    v_cmp_eq_u32 vcc, -1, v4
    v_smfmac_f32_16x16x64_bf16 v[80:83], v[204:207], a[248:255], v9
    s_cbranch_vccnz .A_232
.W_233:
    v_smfmac_f32_16x16x64_bf16 v[76:79], v[208:211], v[124:131], v9
    v_smfmac_f32_16x16x64_bf16 v[80:83], v[208:211], v[156:163], v9
    s_waitcnt vmcnt(0)
    v_max3_u32 v4, v216, v217, v218
    v_max3_u32 v5, v219, v220, v221
    v_max3_u32 v4, v4, v222, v223
    v_smfmac_f32_16x16x64_bf16 v[76:79], v[212:215], v[132:139], v9
    v_max_u32 v4, v4, v5
    v_cmp_eq_u32 vcc, -1, v4
    v_smfmac_f32_16x16x64_bf16 v[80:83], v[212:215], v[164:171], v9
    s_cbranch_vccnz .A_234
.W_235:
    v_smfmac_f32_16x16x64_bf16 v[76:79], v[216:219], v[140:147], v9
    v_smfmac_f32_16x16x64_bf16 v[80:83], v[216:219], v[172:179], v9
    v_smfmac_f32_16x16x64_bf16 v[76:79], v[220:223], v[148:155], v9
    v_smfmac_f32_16x16x64_bf16 v[80:83], v[220:223], v[180:187], v9
.mj_227:
    s_barrier
    s_nop 7
    v_permlane32_swap_b32 v76, v80
    v_permlane32_swap_b32 v77, v81
    v_permlane32_swap_b32 v78, v82
    v_permlane32_swap_b32 v79, v83
    v_add_f32 v76, v76, v80
    v_add_f32 v77, v77, v81
    v_add_f32 v78, v78, v82
    v_add_f32 v79, v79, v83
    v_cvt_pk_bf16_f32 v104, v76, v77
    v_cvt_pk_bf16_f32 v106, v76, v77
    v_cvt_pk_bf16_f32 v105, v78, v79
    v_cvt_pk_bf16_f32 v107, v78, v79
    v_permlane16_swap_b32 v104, v106
    s_nop 0
    v_permlane16_swap_b32 v105, v107
    v_min_u32 v104, 0xfffffffe, v104
    buffer_store_dwordx4 v[104:107], v237, s[8:11], s68 offen sc1

    ds_write_b128 v247, v[104:107]
    s_waitcnt lgkmcnt(0)
    s_barrier
    s_min_u32 s4, s14, s15
    s_max_u32 s93, s93, s4
    v_mov_b32 v4, s93
    v_mov_b32 v5, 19968
    ds_write_b32 v5, v4
    v_mov_b32 v79, 0
    v_mov_b32 v80, 0
    v_mov_b32 v81, 0
    v_mov_b32 v82, 0
    v_mov_b32 v83, 0
    s_waitcnt vmcnt(1)
    v_mov_b32 v192, -1
    v_mov_b32 v193, -1
    v_mov_b32 v194, -1
    v_mov_b32 v195, -1
    v_mov_b32 v196, -1
    v_mov_b32 v197, -1
    v_mov_b32 v198, -1
    v_mov_b32 v199, -1
    v_mov_b32 v200, -1
    v_mov_b32 v201, -1
    v_mov_b32 v202, -1
    v_mov_b32 v203, -1
    v_mov_b32 v204, -1
    v_mov_b32 v205, -1
    v_mov_b32 v206, -1
    v_mov_b32 v207, -1
    v_mov_b32 v208, -1
    v_mov_b32 v209, -1
    v_mov_b32 v210, -1
    v_mov_b32 v211, -1
    v_mov_b32 v212, -1
    v_mov_b32 v213, -1
    v_mov_b32 v214, -1
    v_mov_b32 v215, -1
    v_mov_b32 v216, -1
    v_mov_b32 v217, -1
    v_mov_b32 v218, -1
    v_mov_b32 v219, -1
    v_mov_b32 v220, -1
    v_mov_b32 v221, -1
    v_mov_b32 v222, -1
    v_mov_b32 v223, -1
    s_add_u32 s28, s28, 1
    s_add_u32 s36, s36, 196608
    s_cmp_lt_u32 s28, 63
    s_cselect_b32 s4, 262144, 0
    s_add_u32 s38, s38, s4
    s_add_u32 s39, s39, s4
    s_add_u32 s30, s30, s4
    s_mov_b32 s4, s68
    s_mov_b32 s68, s69
    s_mov_b32 s69, s70
    s_mov_b32 s70, s71
    s_mov_b32 s71, s4
    s_and_b32 s4, s28, 3
    s_lshl_b32 s5, s4, 17
    s_add_u32 s29, s5, s34
    s_xor_b32 s6, s5, 262144
    s_add_u32 s31, s6, s34
    s_add_u32 s32, s29, 20480
    s_add_u32 s33, s29, 24576
    s_branch .top_198
.w3_200:
    ds_read_b128 v[36:39], v14 offset:8192
    ds_read_b128 v[40:43], v14 offset:9216
    ds_read_b128 v[44:47], v14 offset:10240
    ds_read_b128 v[48:51], v14 offset:11264
    ds_read_b128 v[88:91], v14 offset:16384
    s_waitcnt lgkmcnt(0)
    v_mfma_f32_16x16x32_bf16 v[104:107], v[84:87], v[36:39], 0
    v_mfma_f32_16x16x32_bf16 v[108:111], v[84:87], v[44:47], 0
    v_mfma_f32_16x16x32_bf16 v[104:107], v[84:87], v[40:43], v[104:107]
    v_mfma_f32_16x16x32_bf16 v[108:111], v[84:87], v[48:51], v[108:111]
    s_nop 7
    v_cvt_pk_bf16_f32 v168, v104, v105
    v_cvt_pk_bf16_f32 v169, v106, v107
    v_cvt_pk_bf16_f32 v170, v108, v109
    v_cvt_pk_bf16_f32 v171, v110, v111
    ds_write_b128 v14, v[168:171] offset:18432
    v_cndmask_b32 v172, v170, v168, s[60:61]
    v_cndmask_b32 v173, v171, v169, s[60:61]
    v_min_u32 v172, 0xfffffffe, v172
    v_min_u32 v173, 0xfffffffe, v173
    v_mov_b32 v174, v172
    v_mov_b32 v175, v173
    s_cmp_eq_u32 s28, 63
    s_nop 0
    v_permlane16_swap_b32 v172, v174
    v_permlane16_swap_b32 v173, v175
    ds_write_b128 v14, v[172:175] offset:17408

    s_cbranch_scc1 .sk_236
    s_waitcnt lgkmcnt(0)
    s_barrier
    buffer_store_dwordx4 v[188:191], v235, s[8:11], s31 offen sc1
    buffer_store_dwordx4 v[188:191], v236, s[8:11], s31 offen sc1

    s_branch .gp_201
.A_237:
    s_mov_b64 exec, vcc
    buffer_load_dwordx4 v[32:35], v8, s[8:11], s29 offen offset:3072 sc1
    s_mov_b64 exec, -1
    s_sub_u32 s62, s62, 1
    s_cbranch_scc1 .mg_end_1
    s_waitcnt vmcnt(3)
    v_max3_u32 v4, v20, v21, v22
    v_max_u32 v4, v4, v23
    v_cmp_eq_u32 vcc, -1, v4
    s_cbranch_vccz .W_204
.A_203:
    s_mov_b64 exec, vcc
    buffer_load_dwordx4 v[20:23], v8, s[8:11], s29 offen offset:0 sc1
    s_mov_b64 exec, -1
    s_waitcnt vmcnt(3)
    v_max3_u32 v4, v24, v25, v26
    v_max_u32 v4, v4, v27
    v_cmp_eq_u32 vcc, -1, v4
    s_cbranch_vccz .W_238
.A_239:
    s_mov_b64 exec, vcc
    buffer_load_dwordx4 v[24:27], v8, s[8:11], s29 offen offset:1024 sc1
    s_mov_b64 exec, -1
    s_waitcnt vmcnt(3)
    v_max3_u32 v4, v28, v29, v30
    v_max_u32 v4, v4, v31
    v_cmp_eq_u32 vcc, -1, v4
    s_cbranch_vccz .W_240
.A_241:
    s_mov_b64 exec, vcc
    buffer_load_dwordx4 v[28:31], v8, s[8:11], s29 offen offset:2048 sc1
    s_mov_b64 exec, -1
    s_waitcnt vmcnt(3)
    v_max3_u32 v4, v32, v33, v34
    v_max_u32 v4, v4, v35
    v_cmp_eq_u32 vcc, -1, v4
    s_cbranch_vccnz .A_237
.W_242:
    v_smfmac_f32_16x16x64_bf16 v[52:55], v[32:35], a[24:31], v9
    v_smfmac_f32_16x16x64_bf16 v[56:59], v[32:35], a[56:63], v9
    s_waitcnt vmcnt(2)
    v_max3_u32 v4, v20, v21, v22
    v_max_u32 v4, v4, v23
    v_smfmac_f32_16x16x64_bf16 v[60:63], v[32:35], a[88:95], v9
    v_cmp_eq_u32 vcc, -1, v4
    v_smfmac_f32_16x16x64_bf16 v[64:67], v[32:35], a[120:127], v9
    s_cbranch_vccnz .A_243
.W_244:
    v_smfmac_f32_16x16x64_bf16 v[52:55], v[20:23], a[0:7], v9
    v_smfmac_f32_16x16x64_bf16 v[56:59], v[20:23], a[32:39], v9
    s_waitcnt vmcnt(1)
    v_max3_u32 v4, v24, v25, v26
    v_max_u32 v4, v4, v27
    v_smfmac_f32_16x16x64_bf16 v[60:63], v[20:23], a[64:71], v9
    v_cmp_eq_u32 vcc, -1, v4
    v_smfmac_f32_16x16x64_bf16 v[64:67], v[20:23], a[96:103], v9
    s_cbranch_vccnz .A_245
.W_246:
    v_smfmac_f32_16x16x64_bf16 v[52:55], v[24:27], a[8:15], v9
    v_smfmac_f32_16x16x64_bf16 v[56:59], v[24:27], a[40:47], v9
    s_waitcnt vmcnt(0)
    v_max3_u32 v4, v28, v29, v30
    v_max_u32 v4, v4, v31
    v_smfmac_f32_16x16x64_bf16 v[60:63], v[24:27], a[72:79], v9
    v_cmp_eq_u32 vcc, -1, v4
    v_smfmac_f32_16x16x64_bf16 v[64:67], v[24:27], a[104:111], v9
    s_cbranch_vccnz .A_247
.W_248:
    v_smfmac_f32_16x16x64_bf16 v[52:55], v[28:31], a[16:23], v9
    v_smfmac_f32_16x16x64_bf16 v[56:59], v[28:31], a[48:55], v9
    v_smfmac_f32_16x16x64_bf16 v[60:63], v[28:31], a[80:87], v9
    v_smfmac_f32_16x16x64_bf16 v[64:67], v[28:31], a[112:119], v9
    s_branch .mj_202
.W_238:
    v_smfmac_f32_16x16x64_bf16 v[52:55], v[24:27], a[8:15], v9
    v_smfmac_f32_16x16x64_bf16 v[56:59], v[24:27], a[40:47], v9
    s_waitcnt vmcnt(2)
    v_max3_u32 v4, v28, v29, v30
    v_max_u32 v4, v4, v31
    v_smfmac_f32_16x16x64_bf16 v[60:63], v[24:27], a[72:79], v9
    v_cmp_eq_u32 vcc, -1, v4
    v_smfmac_f32_16x16x64_bf16 v[64:67], v[24:27], a[104:111], v9
    s_cbranch_vccnz .A_249
.W_250:
    v_smfmac_f32_16x16x64_bf16 v[52:55], v[28:31], a[16:23], v9
    v_smfmac_f32_16x16x64_bf16 v[56:59], v[28:31], a[48:55], v9
    s_waitcnt vmcnt(1)
    v_max3_u32 v4, v32, v33, v34
    v_max_u32 v4, v4, v35
    v_smfmac_f32_16x16x64_bf16 v[60:63], v[28:31], a[80:87], v9
    v_cmp_eq_u32 vcc, -1, v4
    v_smfmac_f32_16x16x64_bf16 v[64:67], v[28:31], a[112:119], v9
    s_cbranch_vccnz .A_251
.W_252:
    v_smfmac_f32_16x16x64_bf16 v[52:55], v[32:35], a[24:31], v9
    v_smfmac_f32_16x16x64_bf16 v[56:59], v[32:35], a[56:63], v9
    s_waitcnt vmcnt(0)
    v_max3_u32 v4, v20, v21, v22
    v_max_u32 v4, v4, v23
    v_smfmac_f32_16x16x64_bf16 v[60:63], v[32:35], a[88:95], v9
    v_cmp_eq_u32 vcc, -1, v4
    v_smfmac_f32_16x16x64_bf16 v[64:67], v[32:35], a[120:127], v9
    s_cbranch_vccnz .A_253
.W_254:
    v_smfmac_f32_16x16x64_bf16 v[52:55], v[20:23], a[0:7], v9
    v_smfmac_f32_16x16x64_bf16 v[56:59], v[20:23], a[32:39], v9
    v_smfmac_f32_16x16x64_bf16 v[60:63], v[20:23], a[64:71], v9
    v_smfmac_f32_16x16x64_bf16 v[64:67], v[20:23], a[96:103], v9
    s_branch .mj_202
.W_240:
    v_smfmac_f32_16x16x64_bf16 v[52:55], v[28:31], a[16:23], v9
    v_smfmac_f32_16x16x64_bf16 v[56:59], v[28:31], a[48:55], v9
    s_waitcnt vmcnt(2)
    v_max3_u32 v4, v32, v33, v34
    v_max_u32 v4, v4, v35
    v_smfmac_f32_16x16x64_bf16 v[60:63], v[28:31], a[80:87], v9
    v_cmp_eq_u32 vcc, -1, v4
    v_smfmac_f32_16x16x64_bf16 v[64:67], v[28:31], a[112:119], v9
    s_cbranch_vccnz .A_255
.W_256:
    v_smfmac_f32_16x16x64_bf16 v[52:55], v[32:35], a[24:31], v9
    v_smfmac_f32_16x16x64_bf16 v[56:59], v[32:35], a[56:63], v9
    s_waitcnt vmcnt(1)
    v_max3_u32 v4, v20, v21, v22
    v_max_u32 v4, v4, v23
    v_smfmac_f32_16x16x64_bf16 v[60:63], v[32:35], a[88:95], v9
    v_cmp_eq_u32 vcc, -1, v4
    v_smfmac_f32_16x16x64_bf16 v[64:67], v[32:35], a[120:127], v9
    s_cbranch_vccnz .A_257
.W_258:
    v_smfmac_f32_16x16x64_bf16 v[52:55], v[20:23], a[0:7], v9
    v_smfmac_f32_16x16x64_bf16 v[56:59], v[20:23], a[32:39], v9
    s_waitcnt vmcnt(0)
    v_max3_u32 v4, v24, v25, v26
    v_max_u32 v4, v4, v27
    v_smfmac_f32_16x16x64_bf16 v[60:63], v[20:23], a[64:71], v9
    v_cmp_eq_u32 vcc, -1, v4
    v_smfmac_f32_16x16x64_bf16 v[64:67], v[20:23], a[96:103], v9
    s_cbranch_vccnz .A_259
.W_260:
    v_smfmac_f32_16x16x64_bf16 v[52:55], v[24:27], a[8:15], v9
    v_smfmac_f32_16x16x64_bf16 v[56:59], v[24:27], a[40:47], v9
    v_smfmac_f32_16x16x64_bf16 v[60:63], v[24:27], a[72:79], v9
    v_smfmac_f32_16x16x64_bf16 v[64:67], v[24:27], a[104:111], v9
    s_branch .mj_202
.A_261:
    s_mov_b64 exec, vcc
    buffer_load_dwordx4 v[28:31], v8, s[8:11], s29 offen offset:2048 sc1
    s_mov_b64 exec, -1
    s_sub_u32 s62, s62, 1
    s_cbranch_scc1 .mg_end_1
    s_waitcnt vmcnt(2)
    v_max3_u32 v4, v20, v21, v22
    v_max_u32 v4, v4, v23
    v_cmp_eq_u32 vcc, -1, v4
    s_cbranch_vccz .W_244
.A_243:
    s_mov_b64 exec, vcc
    buffer_load_dwordx4 v[20:23], v8, s[8:11], s29 offen offset:0 sc1
    s_mov_b64 exec, -1
    s_waitcnt vmcnt(2)
    v_max3_u32 v4, v24, v25, v26
    v_max_u32 v4, v4, v27
    v_cmp_eq_u32 vcc, -1, v4
    s_cbranch_vccz .W_262
.A_263:
    s_mov_b64 exec, vcc
    buffer_load_dwordx4 v[24:27], v8, s[8:11], s29 offen offset:1024 sc1
    s_mov_b64 exec, -1
    s_waitcnt vmcnt(2)
    v_max3_u32 v4, v28, v29, v30
    v_max_u32 v4, v4, v31
    v_cmp_eq_u32 vcc, -1, v4
    s_cbranch_vccnz .A_261
.W_264:
    v_smfmac_f32_16x16x64_bf16 v[52:55], v[28:31], a[16:23], v9
    v_smfmac_f32_16x16x64_bf16 v[56:59], v[28:31], a[48:55], v9
    s_waitcnt vmcnt(1)
    v_max3_u32 v4, v20, v21, v22
    v_max_u32 v4, v4, v23
    v_smfmac_f32_16x16x64_bf16 v[60:63], v[28:31], a[80:87], v9
    v_cmp_eq_u32 vcc, -1, v4
    v_smfmac_f32_16x16x64_bf16 v[64:67], v[28:31], a[112:119], v9
    s_cbranch_vccz .W_258
    s_branch .A_257
.W_262:
    v_smfmac_f32_16x16x64_bf16 v[52:55], v[24:27], a[8:15], v9
    v_smfmac_f32_16x16x64_bf16 v[56:59], v[24:27], a[40:47], v9
    s_waitcnt vmcnt(1)
    v_max3_u32 v4, v28, v29, v30
    v_max_u32 v4, v4, v31
    v_smfmac_f32_16x16x64_bf16 v[60:63], v[24:27], a[72:79], v9
    v_cmp_eq_u32 vcc, -1, v4
    v_smfmac_f32_16x16x64_bf16 v[64:67], v[24:27], a[104:111], v9
    s_cbranch_vccnz .A_265
.W_266:
    v_smfmac_f32_16x16x64_bf16 v[52:55], v[28:31], a[16:23], v9
    v_smfmac_f32_16x16x64_bf16 v[56:59], v[28:31], a[48:55], v9
    s_waitcnt vmcnt(0)
    v_max3_u32 v4, v20, v21, v22
    v_max_u32 v4, v4, v23
    v_smfmac_f32_16x16x64_bf16 v[60:63], v[28:31], a[80:87], v9
    v_cmp_eq_u32 vcc, -1, v4
    v_smfmac_f32_16x16x64_bf16 v[64:67], v[28:31], a[112:119], v9
    s_cbranch_vccz .W_254
    s_branch .A_253
.A_267:
    s_mov_b64 exec, vcc
    buffer_load_dwordx4 v[24:27], v8, s[8:11], s29 offen offset:1024 sc1
    s_mov_b64 exec, -1
    s_sub_u32 s62, s62, 1
    s_cbranch_scc1 .mg_end_1
    s_waitcnt vmcnt(2)
    v_max3_u32 v4, v32, v33, v34
    v_max_u32 v4, v4, v35
    v_cmp_eq_u32 vcc, -1, v4
    s_cbranch_vccz .W_256
.A_255:
    s_mov_b64 exec, vcc
    buffer_load_dwordx4 v[32:35], v8, s[8:11], s29 offen offset:3072 sc1
    s_mov_b64 exec, -1
    s_waitcnt vmcnt(2)
    v_max3_u32 v4, v20, v21, v22
    v_max_u32 v4, v4, v23
    v_cmp_eq_u32 vcc, -1, v4
    s_cbranch_vccz .W_268
.A_269:
    s_mov_b64 exec, vcc
    buffer_load_dwordx4 v[20:23], v8, s[8:11], s29 offen offset:0 sc1
    s_mov_b64 exec, -1
    s_waitcnt vmcnt(2)
    v_max3_u32 v4, v24, v25, v26
    v_max_u32 v4, v4, v27
    v_cmp_eq_u32 vcc, -1, v4
    s_cbranch_vccnz .A_267
.W_270:
    v_smfmac_f32_16x16x64_bf16 v[52:55], v[24:27], a[8:15], v9
    v_smfmac_f32_16x16x64_bf16 v[56:59], v[24:27], a[40:47], v9
    s_waitcnt vmcnt(1)
    v_max3_u32 v4, v32, v33, v34
    v_max_u32 v4, v4, v35
    v_smfmac_f32_16x16x64_bf16 v[60:63], v[24:27], a[72:79], v9
    v_cmp_eq_u32 vcc, -1, v4
    v_smfmac_f32_16x16x64_bf16 v[64:67], v[24:27], a[104:111], v9
    s_cbranch_vccz .W_252
    s_branch .A_251
.W_268:
    v_smfmac_f32_16x16x64_bf16 v[52:55], v[20:23], a[0:7], v9
    v_smfmac_f32_16x16x64_bf16 v[56:59], v[20:23], a[32:39], v9
    s_waitcnt vmcnt(1)
    v_max3_u32 v4, v24, v25, v26
    v_max_u32 v4, v4, v27
    v_smfmac_f32_16x16x64_bf16 v[60:63], v[20:23], a[64:71], v9
    v_cmp_eq_u32 vcc, -1, v4
    v_smfmac_f32_16x16x64_bf16 v[64:67], v[20:23], a[96:103], v9
    s_cbranch_vccnz .A_271
.W_272:
    v_smfmac_f32_16x16x64_bf16 v[52:55], v[24:27], a[8:15], v9
    v_smfmac_f32_16x16x64_bf16 v[56:59], v[24:27], a[40:47], v9
    s_waitcnt vmcnt(0)
    v_max3_u32 v4, v32, v33, v34
    v_max_u32 v4, v4, v35
    v_smfmac_f32_16x16x64_bf16 v[60:63], v[24:27], a[72:79], v9
    v_cmp_eq_u32 vcc, -1, v4
    v_smfmac_f32_16x16x64_bf16 v[64:67], v[24:27], a[104:111], v9
    s_cbranch_vccz .W_210
    s_branch .A_209
.A_273:
    s_mov_b64 exec, vcc
    buffer_load_dwordx4 v[32:35], v8, s[8:11], s29 offen offset:3072 sc1
    s_mov_b64 exec, -1
    s_sub_u32 s62, s62, 1
    s_cbranch_scc1 .mg_end_1
    s_waitcnt vmcnt(2)
    v_max3_u32 v4, v20, v21, v22
    v_max_u32 v4, v4, v23
    v_cmp_eq_u32 vcc, -1, v4
    s_cbranch_vccz .W_274
.A_275:
    s_mov_b64 exec, vcc
    buffer_load_dwordx4 v[20:23], v8, s[8:11], s29 offen offset:0 sc1
    s_mov_b64 exec, -1
    s_waitcnt vmcnt(2)
    v_max3_u32 v4, v28, v29, v30
    v_max_u32 v4, v4, v31
    v_cmp_eq_u32 vcc, -1, v4
    s_cbranch_vccz .W_250
.A_249:
    s_mov_b64 exec, vcc
    buffer_load_dwordx4 v[28:31], v8, s[8:11], s29 offen offset:2048 sc1
    s_mov_b64 exec, -1
    s_waitcnt vmcnt(2)
    v_max3_u32 v4, v32, v33, v34
    v_max_u32 v4, v4, v35
    v_cmp_eq_u32 vcc, -1, v4
    s_cbranch_vccnz .A_273
.W_276:
    v_smfmac_f32_16x16x64_bf16 v[52:55], v[32:35], a[24:31], v9
    v_smfmac_f32_16x16x64_bf16 v[56:59], v[32:35], a[56:63], v9
    s_waitcnt vmcnt(1)
    v_max3_u32 v4, v20, v21, v22
    v_max_u32 v4, v4, v23
    v_smfmac_f32_16x16x64_bf16 v[60:63], v[32:35], a[88:95], v9
    v_cmp_eq_u32 vcc, -1, v4
    v_smfmac_f32_16x16x64_bf16 v[64:67], v[32:35], a[120:127], v9
    s_cbranch_vccnz .A_277
.W_278:
    v_smfmac_f32_16x16x64_bf16 v[52:55], v[20:23], a[0:7], v9
    v_smfmac_f32_16x16x64_bf16 v[56:59], v[20:23], a[32:39], v9
    s_waitcnt vmcnt(0)
    v_max3_u32 v4, v28, v29, v30
    v_max_u32 v4, v4, v31
    v_smfmac_f32_16x16x64_bf16 v[60:63], v[20:23], a[64:71], v9
    v_cmp_eq_u32 vcc, -1, v4
    v_smfmac_f32_16x16x64_bf16 v[64:67], v[20:23], a[96:103], v9
    s_cbranch_vccz .W_248
    s_branch .A_247
.W_274:
    v_smfmac_f32_16x16x64_bf16 v[52:55], v[20:23], a[0:7], v9
    v_smfmac_f32_16x16x64_bf16 v[56:59], v[20:23], a[32:39], v9
    s_waitcnt vmcnt(1)
    v_max3_u32 v4, v28, v29, v30
    v_max_u32 v4, v4, v31
    v_smfmac_f32_16x16x64_bf16 v[60:63], v[20:23], a[64:71], v9
    v_cmp_eq_u32 vcc, -1, v4
    v_smfmac_f32_16x16x64_bf16 v[64:67], v[20:23], a[96:103], v9
    s_cbranch_vccz .W_208
    s_branch .A_207
.A_279:
    s_mov_b64 exec, vcc
    buffer_load_dwordx4 v[32:35], v8, s[8:11], s29 offen offset:3072 sc1
    s_mov_b64 exec, -1
    s_sub_u32 s62, s62, 1
    s_cbranch_scc1 .mg_end_1
    s_waitcnt vmcnt(2)
    v_max3_u32 v4, v24, v25, v26
    v_max_u32 v4, v4, v27
    v_cmp_eq_u32 vcc, -1, v4
    s_cbranch_vccz .W_206
.A_205:
    s_mov_b64 exec, vcc
    buffer_load_dwordx4 v[24:27], v8, s[8:11], s29 offen offset:1024 sc1
    s_mov_b64 exec, -1
    s_waitcnt vmcnt(2)
    v_max3_u32 v4, v28, v29, v30
    v_max_u32 v4, v4, v31
    v_cmp_eq_u32 vcc, -1, v4
    s_cbranch_vccz .W_280
.A_281:
    s_mov_b64 exec, vcc
    buffer_load_dwordx4 v[28:31], v8, s[8:11], s29 offen offset:2048 sc1
    s_mov_b64 exec, -1
    s_waitcnt vmcnt(2)
    v_max3_u32 v4, v32, v33, v34
    v_max_u32 v4, v4, v35
    v_cmp_eq_u32 vcc, -1, v4
    s_cbranch_vccnz .A_279
.W_282:
    v_smfmac_f32_16x16x64_bf16 v[52:55], v[32:35], a[24:31], v9
    v_smfmac_f32_16x16x64_bf16 v[56:59], v[32:35], a[56:63], v9
    s_waitcnt vmcnt(1)
    v_max3_u32 v4, v24, v25, v26
    v_max_u32 v4, v4, v27
    v_smfmac_f32_16x16x64_bf16 v[60:63], v[32:35], a[88:95], v9
    v_cmp_eq_u32 vcc, -1, v4
    v_smfmac_f32_16x16x64_bf16 v[64:67], v[32:35], a[120:127], v9
    s_cbranch_vccz .W_246
    s_branch .A_245
.W_280:
    v_smfmac_f32_16x16x64_bf16 v[52:55], v[28:31], a[16:23], v9
    v_smfmac_f32_16x16x64_bf16 v[56:59], v[28:31], a[48:55], v9
    s_waitcnt vmcnt(1)
    v_max3_u32 v4, v32, v33, v34
    v_max_u32 v4, v4, v35
    v_smfmac_f32_16x16x64_bf16 v[60:63], v[28:31], a[80:87], v9
    v_cmp_eq_u32 vcc, -1, v4
    v_smfmac_f32_16x16x64_bf16 v[64:67], v[28:31], a[112:119], v9
    s_cbranch_vccnz .A_283
.W_284:
    v_smfmac_f32_16x16x64_bf16 v[52:55], v[32:35], a[24:31], v9
    v_smfmac_f32_16x16x64_bf16 v[56:59], v[32:35], a[56:63], v9
    s_waitcnt vmcnt(0)
    v_max3_u32 v4, v24, v25, v26
    v_max_u32 v4, v4, v27
    v_smfmac_f32_16x16x64_bf16 v[60:63], v[32:35], a[88:95], v9
    v_cmp_eq_u32 vcc, -1, v4
    v_smfmac_f32_16x16x64_bf16 v[64:67], v[32:35], a[120:127], v9
    s_cbranch_vccz .W_260
    s_branch .A_259
.A_285:
    s_mov_b64 exec, vcc
    buffer_load_dwordx4 v[24:27], v8, s[8:11], s29 offen offset:1024 sc1
    s_mov_b64 exec, -1
    s_sub_u32 s62, s62, 1
    s_cbranch_scc1 .mg_end_1
    s_waitcnt vmcnt(1)
    v_max3_u32 v4, v20, v21, v22
    v_max_u32 v4, v4, v23
    v_cmp_eq_u32 vcc, -1, v4
    s_cbranch_vccz .W_258
.A_257:
    s_mov_b64 exec, vcc
    buffer_load_dwordx4 v[20:23], v8, s[8:11], s29 offen offset:0 sc1
    s_mov_b64 exec, -1
    s_waitcnt vmcnt(1)
    v_max3_u32 v4, v24, v25, v26
    v_max_u32 v4, v4, v27
    v_cmp_eq_u32 vcc, -1, v4
    s_cbranch_vccnz .A_285
.W_286:
    v_smfmac_f32_16x16x64_bf16 v[52:55], v[24:27], a[8:15], v9
    v_smfmac_f32_16x16x64_bf16 v[56:59], v[24:27], a[40:47], v9
    s_waitcnt vmcnt(0)
    v_max3_u32 v4, v20, v21, v22
    v_max_u32 v4, v4, v23
    v_smfmac_f32_16x16x64_bf16 v[60:63], v[24:27], a[72:79], v9
    v_cmp_eq_u32 vcc, -1, v4
    v_smfmac_f32_16x16x64_bf16 v[64:67], v[24:27], a[104:111], v9
    s_cbranch_vccz .W_254
    s_branch .A_253
.A_265:
    s_mov_b64 exec, vcc
    buffer_load_dwordx4 v[28:31], v8, s[8:11], s29 offen offset:2048 sc1
    s_mov_b64 exec, -1
    s_sub_u32 s62, s62, 1
    s_cbranch_scc1 .mg_end_1
    s_waitcnt vmcnt(1)
    v_max3_u32 v4, v20, v21, v22
    v_max_u32 v4, v4, v23
    v_cmp_eq_u32 vcc, -1, v4
    s_cbranch_vccz .W_278
.A_277:
    s_mov_b64 exec, vcc
    buffer_load_dwordx4 v[20:23], v8, s[8:11], s29 offen offset:0 sc1
    s_mov_b64 exec, -1
    s_waitcnt vmcnt(1)
    v_max3_u32 v4, v28, v29, v30
    v_max_u32 v4, v4, v31
    v_cmp_eq_u32 vcc, -1, v4
    s_cbranch_vccnz .A_265
    s_branch .W_266
.A_287:
    s_mov_b64 exec, vcc
    buffer_load_dwordx4 v[20:23], v8, s[8:11], s29 offen offset:0 sc1
    s_mov_b64 exec, -1
    s_sub_u32 s62, s62, 1
    s_cbranch_scc1 .mg_end_1
    s_waitcnt vmcnt(1)
    v_max3_u32 v4, v32, v33, v34
    v_max_u32 v4, v4, v35
    v_cmp_eq_u32 vcc, -1, v4
    s_cbranch_vccz .W_252
.A_251:
    s_mov_b64 exec, vcc
    buffer_load_dwordx4 v[32:35], v8, s[8:11], s29 offen offset:3072 sc1
    s_mov_b64 exec, -1
    s_waitcnt vmcnt(1)
    v_max3_u32 v4, v20, v21, v22
    v_max_u32 v4, v4, v23
    v_cmp_eq_u32 vcc, -1, v4
    s_cbranch_vccnz .A_287
.W_288:
    v_smfmac_f32_16x16x64_bf16 v[52:55], v[20:23], a[0:7], v9
    v_smfmac_f32_16x16x64_bf16 v[56:59], v[20:23], a[32:39], v9
    s_waitcnt vmcnt(0)
    v_max3_u32 v4, v32, v33, v34
    v_max_u32 v4, v4, v35
    v_smfmac_f32_16x16x64_bf16 v[60:63], v[20:23], a[64:71], v9
    v_cmp_eq_u32 vcc, -1, v4
    v_smfmac_f32_16x16x64_bf16 v[64:67], v[20:23], a[96:103], v9
    s_cbranch_vccz .W_210
    s_branch .A_209
.A_289:
    s_mov_b64 exec, vcc
    buffer_load_dwordx4 v[28:31], v8, s[8:11], s29 offen offset:2048 sc1
    s_mov_b64 exec, -1
    s_sub_u32 s62, s62, 1
    s_cbranch_scc1 .mg_end_1
    s_waitcnt vmcnt(1)
    v_max3_u32 v4, v24, v25, v26
    v_max_u32 v4, v4, v27
    v_cmp_eq_u32 vcc, -1, v4
    s_cbranch_vccz .W_246
.A_245:
    s_mov_b64 exec, vcc
    buffer_load_dwordx4 v[24:27], v8, s[8:11], s29 offen offset:1024 sc1
    s_mov_b64 exec, -1
    s_waitcnt vmcnt(1)
    v_max3_u32 v4, v28, v29, v30
    v_max_u32 v4, v4, v31
    v_cmp_eq_u32 vcc, -1, v4
    s_cbranch_vccnz .A_289
.W_290:
    v_smfmac_f32_16x16x64_bf16 v[52:55], v[28:31], a[16:23], v9
    v_smfmac_f32_16x16x64_bf16 v[56:59], v[28:31], a[48:55], v9
    s_waitcnt vmcnt(0)
    v_max3_u32 v4, v24, v25, v26
    v_max_u32 v4, v4, v27
    v_smfmac_f32_16x16x64_bf16 v[60:63], v[28:31], a[80:87], v9
    v_cmp_eq_u32 vcc, -1, v4
    v_smfmac_f32_16x16x64_bf16 v[64:67], v[28:31], a[112:119], v9
    s_cbranch_vccz .W_260
    s_branch .A_259
.A_283:
    s_mov_b64 exec, vcc
    buffer_load_dwordx4 v[32:35], v8, s[8:11], s29 offen offset:3072 sc1
    s_mov_b64 exec, -1
    s_sub_u32 s62, s62, 1
    s_cbranch_scc1 .mg_end_1
    s_waitcnt vmcnt(1)
    v_max3_u32 v4, v24, v25, v26
    v_max_u32 v4, v4, v27
    v_cmp_eq_u32 vcc, -1, v4
    s_cbranch_vccz .W_272
.A_271:
    s_mov_b64 exec, vcc
    buffer_load_dwordx4 v[24:27], v8, s[8:11], s29 offen offset:1024 sc1
    s_mov_b64 exec, -1
    s_waitcnt vmcnt(1)
    v_max3_u32 v4, v32, v33, v34
    v_max_u32 v4, v4, v35
    v_cmp_eq_u32 vcc, -1, v4
    s_cbranch_vccnz .A_283
    s_branch .W_284
.A_291:
    s_mov_b64 exec, vcc
    buffer_load_dwordx4 v[32:35], v8, s[8:11], s29 offen offset:3072 sc1
    s_mov_b64 exec, -1
    s_sub_u32 s62, s62, 1
    s_cbranch_scc1 .mg_end_1
    s_waitcnt vmcnt(1)
    v_max3_u32 v4, v28, v29, v30
    v_max_u32 v4, v4, v31
    v_cmp_eq_u32 vcc, -1, v4
    s_cbranch_vccz .W_208
.A_207:
    s_mov_b64 exec, vcc
    buffer_load_dwordx4 v[28:31], v8, s[8:11], s29 offen offset:2048 sc1
    s_mov_b64 exec, -1
    s_waitcnt vmcnt(1)
    v_max3_u32 v4, v32, v33, v34
    v_max_u32 v4, v4, v35
    v_cmp_eq_u32 vcc, -1, v4
    s_cbranch_vccnz .A_291
.W_292:
    v_smfmac_f32_16x16x64_bf16 v[52:55], v[32:35], a[24:31], v9
    v_smfmac_f32_16x16x64_bf16 v[56:59], v[32:35], a[56:63], v9
    s_waitcnt vmcnt(0)
    v_max3_u32 v4, v28, v29, v30
    v_max_u32 v4, v4, v31
    v_smfmac_f32_16x16x64_bf16 v[60:63], v[32:35], a[88:95], v9
    v_cmp_eq_u32 vcc, -1, v4
    v_smfmac_f32_16x16x64_bf16 v[64:67], v[32:35], a[120:127], v9
    s_cbranch_vccz .W_248
    s_branch .A_247
.A_253:
    s_mov_b64 exec, vcc
    buffer_load_dwordx4 v[20:23], v8, s[8:11], s29 offen offset:0 sc1
    s_mov_b64 exec, -1
    s_sub_u32 s62, s62, 1
    s_cbranch_scc1 .mg_end_1
    s_waitcnt vmcnt(1)
    v_max3_u32 v4, v20, v21, v22
    v_max_u32 v4, v4, v23
    v_cmp_eq_u32 vcc, -1, v4
    s_cbranch_vccnz .A_253
    v_smfmac_f32_16x16x64_bf16 v[52:55], v[20:23], a[0:7], v9
    v_smfmac_f32_16x16x64_bf16 v[56:59], v[20:23], a[32:39], v9
    v_smfmac_f32_16x16x64_bf16 v[60:63], v[20:23], a[64:71], v9
    v_smfmac_f32_16x16x64_bf16 v[64:67], v[20:23], a[96:103], v9
    s_branch .mj_202
.A_259:
    s_mov_b64 exec, vcc
    buffer_load_dwordx4 v[24:27], v8, s[8:11], s29 offen offset:1024 sc1
    s_mov_b64 exec, -1
    s_sub_u32 s62, s62, 1
    s_cbranch_scc1 .mg_end_1
    s_waitcnt vmcnt(1)
    v_max3_u32 v4, v24, v25, v26
    v_max_u32 v4, v4, v27
    v_cmp_eq_u32 vcc, -1, v4
    s_cbranch_vccnz .A_259
    v_smfmac_f32_16x16x64_bf16 v[52:55], v[24:27], a[8:15], v9
    v_smfmac_f32_16x16x64_bf16 v[56:59], v[24:27], a[40:47], v9
    v_smfmac_f32_16x16x64_bf16 v[60:63], v[24:27], a[72:79], v9
    v_smfmac_f32_16x16x64_bf16 v[64:67], v[24:27], a[104:111], v9
    s_branch .mj_202
.A_247:
    s_mov_b64 exec, vcc
    buffer_load_dwordx4 v[28:31], v8, s[8:11], s29 offen offset:2048 sc1
    s_mov_b64 exec, -1
    s_sub_u32 s62, s62, 1
    s_cbranch_scc1 .mg_end_1
    s_waitcnt vmcnt(1)
    v_max3_u32 v4, v28, v29, v30
    v_max_u32 v4, v4, v31
    v_cmp_eq_u32 vcc, -1, v4
    s_cbranch_vccnz .A_247
    v_smfmac_f32_16x16x64_bf16 v[52:55], v[28:31], a[16:23], v9
    v_smfmac_f32_16x16x64_bf16 v[56:59], v[28:31], a[48:55], v9
    v_smfmac_f32_16x16x64_bf16 v[60:63], v[28:31], a[80:87], v9
    v_smfmac_f32_16x16x64_bf16 v[64:67], v[28:31], a[112:119], v9
    s_branch .mj_202
.A_209:
    s_mov_b64 exec, vcc
    buffer_load_dwordx4 v[32:35], v8, s[8:11], s29 offen offset:3072 sc1
    s_mov_b64 exec, -1
    s_sub_u32 s62, s62, 1
    s_cbranch_scc1 .mg_end_1
    s_waitcnt vmcnt(1)
    v_max3_u32 v4, v32, v33, v34
    v_max_u32 v4, v4, v35
    v_cmp_eq_u32 vcc, -1, v4
    s_cbranch_vccnz .A_209
    v_smfmac_f32_16x16x64_bf16 v[52:55], v[32:35], a[24:31], v9
    v_smfmac_f32_16x16x64_bf16 v[56:59], v[32:35], a[56:63], v9
    v_smfmac_f32_16x16x64_bf16 v[60:63], v[32:35], a[88:95], v9
    v_smfmac_f32_16x16x64_bf16 v[64:67], v[32:35], a[120:127], v9
    s_branch .mj_202
.A_293:
    buffer_load_dwordx4 v[100:103], v234, s[8:11], s29 offen sc1
    s_sub_u32 s62, s62, 1
    s_cbranch_scc1 .mg_end_1
    s_waitcnt vmcnt(2)
    v_max3_u32 v4, v92, v93, v94
    v_max_u32 v4, v4, v95
    v_cmp_eq_u32 vcc, -1, v4
    s_cbranch_vccz .W_213
.A_212:
    buffer_load_dwordx4 v[92:95], v232, s[8:11], s29 offen sc1
    s_waitcnt vmcnt(2)
    v_max3_u32 v4, v96, v97, v98
    v_max_u32 v4, v4, v99
    v_cmp_eq_u32 vcc, -1, v4
    s_cbranch_vccz .W_294
.A_295:
    buffer_load_dwordx4 v[96:99], v233, s[8:11], s29 offen sc1
    s_waitcnt vmcnt(2)
    v_max3_u32 v4, v100, v101, v102
    v_max_u32 v4, v4, v103
    v_cmp_eq_u32 vcc, -1, v4
    s_cbranch_vccnz .A_293
.W_296:
    v_mfma_f32_16x16x32_bf16 v[208:211], v[140:143], v[100:103], v[208:211]
    s_waitcnt vmcnt(1)
    v_max3_u32 v4, v92, v93, v94
    v_max_u32 v4, v4, v95
    v_mfma_f32_16x16x32_bf16 v[212:215], v[156:159], v[100:103], v[212:215]
    v_cmp_eq_u32 vcc, -1, v4
    v_mfma_f32_16x16x32_bf16 v[216:219], v[100:103], v[100:103], v[216:219]
    s_cbranch_vccnz .A_297
.W_298:
    v_mfma_f32_16x16x32_bf16 v[208:211], v[132:135], v[92:95], v[208:211]
    s_waitcnt vmcnt(0)
    v_max3_u32 v4, v96, v97, v98
    v_max_u32 v4, v4, v99
    v_mfma_f32_16x16x32_bf16 v[212:215], v[148:151], v[92:95], v[212:215]
    v_cmp_eq_u32 vcc, -1, v4
    v_mfma_f32_16x16x32_bf16 v[216:219], v[92:95], v[92:95], v[216:219]
    s_cbranch_vccnz .A_299
.W_300:
    v_mfma_f32_16x16x32_bf16 v[208:211], v[136:139], v[96:99], v[208:211]
    v_mfma_f32_16x16x32_bf16 v[212:215], v[152:155], v[96:99], v[212:215]
    v_mfma_f32_16x16x32_bf16 v[216:219], v[96:99], v[96:99], v[216:219]
    s_branch .mj_211
.W_294:
    v_mfma_f32_16x16x32_bf16 v[208:211], v[136:139], v[96:99], v[208:211]
    s_waitcnt vmcnt(1)
    v_max3_u32 v4, v100, v101, v102
    v_max_u32 v4, v4, v103
    v_mfma_f32_16x16x32_bf16 v[212:215], v[152:155], v[96:99], v[212:215]
    v_cmp_eq_u32 vcc, -1, v4
    v_mfma_f32_16x16x32_bf16 v[216:219], v[96:99], v[96:99], v[216:219]
    s_cbranch_vccnz .A_301
.W_302:
    v_mfma_f32_16x16x32_bf16 v[208:211], v[140:143], v[100:103], v[208:211]
    s_waitcnt vmcnt(0)
    v_max3_u32 v4, v92, v93, v94
    v_max_u32 v4, v4, v95
    v_mfma_f32_16x16x32_bf16 v[212:215], v[156:159], v[100:103], v[212:215]
    v_cmp_eq_u32 vcc, -1, v4
    v_mfma_f32_16x16x32_bf16 v[216:219], v[100:103], v[100:103], v[216:219]
    s_cbranch_vccnz .A_303
.W_304:
    v_mfma_f32_16x16x32_bf16 v[208:211], v[132:135], v[92:95], v[208:211]
    v_mfma_f32_16x16x32_bf16 v[212:215], v[148:151], v[92:95], v[212:215]
    v_mfma_f32_16x16x32_bf16 v[216:219], v[92:95], v[92:95], v[216:219]
    s_branch .mj_211
.A_305:
    buffer_load_dwordx4 v[96:99], v233, s[8:11], s29 offen sc1
    s_sub_u32 s62, s62, 1
    s_cbranch_scc1 .mg_end_1
    s_waitcnt vmcnt(1)
    v_max3_u32 v4, v92, v93, v94
    v_max_u32 v4, v4, v95
    v_cmp_eq_u32 vcc, -1, v4
    s_cbranch_vccz .W_298
.A_297:
    buffer_load_dwordx4 v[92:95], v232, s[8:11], s29 offen sc1
    s_waitcnt vmcnt(1)
    v_max3_u32 v4, v96, v97, v98
    v_max_u32 v4, v4, v99
    v_cmp_eq_u32 vcc, -1, v4
    s_cbranch_vccnz .A_305
.W_306:
    v_mfma_f32_16x16x32_bf16 v[208:211], v[136:139], v[96:99], v[208:211]
    s_waitcnt vmcnt(0)
    v_max3_u32 v4, v92, v93, v94
    v_max_u32 v4, v4, v95
    v_mfma_f32_16x16x32_bf16 v[212:215], v[152:155], v[96:99], v[212:215]
    v_cmp_eq_u32 vcc, -1, v4
    v_mfma_f32_16x16x32_bf16 v[216:219], v[96:99], v[96:99], v[216:219]
    s_cbranch_vccz .W_304
    s_branch .A_303
.A_307:
    buffer_load_dwordx4 v[92:95], v232, s[8:11], s29 offen sc1
    s_sub_u32 s62, s62, 1
    s_cbranch_scc1 .mg_end_1
    s_waitcnt vmcnt(1)
    v_max3_u32 v4, v100, v101, v102
    v_max_u32 v4, v4, v103
    v_cmp_eq_u32 vcc, -1, v4
    s_cbranch_vccz .W_302
.A_301:
    buffer_load_dwordx4 v[100:103], v234, s[8:11], s29 offen sc1
    s_waitcnt vmcnt(1)
    v_max3_u32 v4, v92, v93, v94
    v_max_u32 v4, v4, v95
    v_cmp_eq_u32 vcc, -1, v4
    s_cbranch_vccnz .A_307
.W_308:
    v_mfma_f32_16x16x32_bf16 v[208:211], v[132:135], v[92:95], v[208:211]
    s_waitcnt vmcnt(0)
    v_max3_u32 v4, v100, v101, v102
    v_max_u32 v4, v4, v103
    v_mfma_f32_16x16x32_bf16 v[212:215], v[148:151], v[92:95], v[212:215]
    v_cmp_eq_u32 vcc, -1, v4
    v_mfma_f32_16x16x32_bf16 v[216:219], v[92:95], v[92:95], v[216:219]
    s_cbranch_vccz .W_217
    s_branch .A_216
.A_309:
    buffer_load_dwordx4 v[100:103], v234, s[8:11], s29 offen sc1
    s_sub_u32 s62, s62, 1
    s_cbranch_scc1 .mg_end_1
    s_waitcnt vmcnt(1)
    v_max3_u32 v4, v96, v97, v98
    v_max_u32 v4, v4, v99
    v_cmp_eq_u32 vcc, -1, v4
    s_cbranch_vccz .W_215
.A_214:
    buffer_load_dwordx4 v[96:99], v233, s[8:11], s29 offen sc1
    s_waitcnt vmcnt(1)
    v_max3_u32 v4, v100, v101, v102
    v_max_u32 v4, v4, v103
    v_cmp_eq_u32 vcc, -1, v4
    s_cbranch_vccnz .A_309
.W_310:
    v_mfma_f32_16x16x32_bf16 v[208:211], v[140:143], v[100:103], v[208:211]
    s_waitcnt vmcnt(0)
    v_max3_u32 v4, v96, v97, v98
    v_max_u32 v4, v4, v99
    v_mfma_f32_16x16x32_bf16 v[212:215], v[156:159], v[100:103], v[212:215]
    v_cmp_eq_u32 vcc, -1, v4
    v_mfma_f32_16x16x32_bf16 v[216:219], v[100:103], v[100:103], v[216:219]
    s_cbranch_vccz .W_300
    s_branch .A_299
.A_303:
    buffer_load_dwordx4 v[92:95], v232, s[8:11], s29 offen sc1
    s_sub_u32 s62, s62, 1
    s_cbranch_scc1 .mg_end_1
    s_waitcnt vmcnt(1)
    v_max3_u32 v4, v92, v93, v94
    v_max_u32 v4, v4, v95
    v_cmp_eq_u32 vcc, -1, v4
    s_cbranch_vccnz .A_303
    v_mfma_f32_16x16x32_bf16 v[208:211], v[132:135], v[92:95], v[208:211]
    v_mfma_f32_16x16x32_bf16 v[212:215], v[148:151], v[92:95], v[212:215]
    v_mfma_f32_16x16x32_bf16 v[216:219], v[92:95], v[92:95], v[216:219]
    s_branch .mj_211
.A_299:
    buffer_load_dwordx4 v[96:99], v233, s[8:11], s29 offen sc1
    s_sub_u32 s62, s62, 1
    s_cbranch_scc1 .mg_end_1
    s_waitcnt vmcnt(1)
    v_max3_u32 v4, v96, v97, v98
    v_max_u32 v4, v4, v99
    v_cmp_eq_u32 vcc, -1, v4
    s_cbranch_vccnz .A_299
    v_mfma_f32_16x16x32_bf16 v[208:211], v[136:139], v[96:99], v[208:211]
    v_mfma_f32_16x16x32_bf16 v[212:215], v[152:155], v[96:99], v[212:215]
    v_mfma_f32_16x16x32_bf16 v[216:219], v[96:99], v[96:99], v[216:219]
    s_branch .mj_211
.A_216:
    buffer_load_dwordx4 v[100:103], v234, s[8:11], s29 offen sc1
    s_sub_u32 s62, s62, 1
    s_cbranch_scc1 .mg_end_1
    s_waitcnt vmcnt(1)
    v_max3_u32 v4, v100, v101, v102
    v_max_u32 v4, v4, v103
    v_cmp_eq_u32 vcc, -1, v4
    s_cbranch_vccnz .A_216
    v_mfma_f32_16x16x32_bf16 v[208:211], v[140:143], v[100:103], v[208:211]
    v_mfma_f32_16x16x32_bf16 v[212:215], v[156:159], v[100:103], v[212:215]
    v_mfma_f32_16x16x32_bf16 v[216:219], v[100:103], v[100:103], v[216:219]
    s_branch .mj_211
.kf_225:
    s_mov_b32 s62, 0
    s_mov_b64 exec, 3
.wf_311:
    buffer_load_dword v244, v253, s[8:11], s89 offen sc1
    s_waitcnt vmcnt(0)
    v_cmp_gt_u32 vcc, s6, v244
    s_cbranch_vccz .wfd_312
    s_sleep 2
    s_add_u32 s62, s62, 1
    s_cmp_gt_u32 s62, 0x400000
    s_cbranch_scc1 .mg_end_1
    s_branch .wf_311

.wfd_312:
    s_mov_b64 exec, -1
    v_readlane_b32 s4, v244, 0
    v_readlane_b32 s93, v244, 1
    s_min_u32 s93, s93, s4
    s_mov_b32 s62, 0x1000000
    s_branch .kb_226
.A_313:
    buffer_load_dwordx4 v[216:219], v246, s[8:11], s32 offen offset:0 sc1
    buffer_load_dwordx4 v[220:223], v246, s[8:11], s32 offen offset:1024 sc1
    s_sub_u32 s62, s62, 1
    s_cbranch_scc1 .mg_end_1
    s_waitcnt vmcnt(6)
    v_max3_u32 v4, v192, v193, v194
    v_max3_u32 v5, v195, v196, v197
    v_max3_u32 v4, v4, v198, v199
    v_max_u32 v4, v4, v5
    v_cmp_eq_u32 vcc, -1, v4
    s_cbranch_vccz .W_229
.A_228:
    buffer_load_dwordx4 v[192:195], v243, s[8:11], s32 offen offset:0 sc1
    buffer_load_dwordx4 v[196:199], v243, s[8:11], s32 offen offset:1024 sc1
    s_waitcnt vmcnt(6)
    v_max3_u32 v4, v200, v201, v202
    v_max3_u32 v5, v203, v204, v205
    v_max3_u32 v4, v4, v206, v207
    v_max_u32 v4, v4, v5
    v_cmp_eq_u32 vcc, -1, v4
    s_cbranch_vccz .W_314
.A_315:
    buffer_load_dwordx4 v[200:203], v252, s[8:11], s32 offen offset:0 sc1
    buffer_load_dwordx4 v[204:207], v252, s[8:11], s32 offen offset:1024 sc1
    s_waitcnt vmcnt(6)
    v_max3_u32 v4, v208, v209, v210
    v_max3_u32 v5, v211, v212, v213
    v_max3_u32 v4, v4, v214, v215
    v_max_u32 v4, v4, v5
    v_cmp_eq_u32 vcc, -1, v4
    s_cbranch_vccz .W_316
.A_317:
    buffer_load_dwordx4 v[208:211], v254, s[8:11], s32 offen offset:0 sc1
    buffer_load_dwordx4 v[212:215], v254, s[8:11], s32 offen offset:1024 sc1
    s_waitcnt vmcnt(6)
    v_max3_u32 v4, v216, v217, v218
    v_max3_u32 v5, v219, v220, v221
    v_max3_u32 v4, v4, v222, v223
    v_max_u32 v4, v4, v5
    v_cmp_eq_u32 vcc, -1, v4
    s_cbranch_vccnz .A_313
.W_318:
    v_smfmac_f32_16x16x64_bf16 v[76:79], v[216:219], v[140:147], v9
    v_smfmac_f32_16x16x64_bf16 v[80:83], v[216:219], v[172:179], v9
    s_waitcnt vmcnt(4)
    v_max3_u32 v4, v192, v193, v194
    v_max3_u32 v5, v195, v196, v197
    v_max3_u32 v4, v4, v198, v199
    v_smfmac_f32_16x16x64_bf16 v[76:79], v[220:223], v[148:155], v9
    v_max_u32 v4, v4, v5
    v_cmp_eq_u32 vcc, -1, v4
    v_smfmac_f32_16x16x64_bf16 v[80:83], v[220:223], v[180:187], v9
    s_cbranch_vccnz .A_319
.W_320:
    v_smfmac_f32_16x16x64_bf16 v[76:79], v[192:195], a[192:199], v9
    v_smfmac_f32_16x16x64_bf16 v[80:83], v[192:195], a[224:231], v9
    s_waitcnt vmcnt(2)
    v_max3_u32 v4, v200, v201, v202
    v_max3_u32 v5, v203, v204, v205
    v_max3_u32 v4, v4, v206, v207
    v_smfmac_f32_16x16x64_bf16 v[76:79], v[196:199], a[200:207], v9
    v_max_u32 v4, v4, v5
    v_cmp_eq_u32 vcc, -1, v4
    v_smfmac_f32_16x16x64_bf16 v[80:83], v[196:199], a[232:239], v9
    s_cbranch_vccnz .A_321
.W_322:
    v_smfmac_f32_16x16x64_bf16 v[76:79], v[200:203], a[208:215], v9
    v_smfmac_f32_16x16x64_bf16 v[80:83], v[200:203], a[240:247], v9
    s_waitcnt vmcnt(0)
    v_max3_u32 v4, v208, v209, v210
    v_max3_u32 v5, v211, v212, v213
    v_max3_u32 v4, v4, v214, v215
    v_smfmac_f32_16x16x64_bf16 v[76:79], v[204:207], a[216:223], v9
    v_max_u32 v4, v4, v5
    v_cmp_eq_u32 vcc, -1, v4
    v_smfmac_f32_16x16x64_bf16 v[80:83], v[204:207], a[248:255], v9
    s_cbranch_vccnz .A_323
.W_324:
    v_smfmac_f32_16x16x64_bf16 v[76:79], v[208:211], v[124:131], v9
    v_smfmac_f32_16x16x64_bf16 v[80:83], v[208:211], v[156:163], v9
    v_smfmac_f32_16x16x64_bf16 v[76:79], v[212:215], v[132:139], v9
    v_smfmac_f32_16x16x64_bf16 v[80:83], v[212:215], v[164:171], v9
    s_branch .mj_227
.W_314:
    v_smfmac_f32_16x16x64_bf16 v[76:79], v[200:203], a[208:215], v9
    v_smfmac_f32_16x16x64_bf16 v[80:83], v[200:203], a[240:247], v9
    s_waitcnt vmcnt(4)
    v_max3_u32 v4, v208, v209, v210
    v_max3_u32 v5, v211, v212, v213
    v_max3_u32 v4, v4, v214, v215
    v_smfmac_f32_16x16x64_bf16 v[76:79], v[204:207], a[216:223], v9
    v_max_u32 v4, v4, v5
    v_cmp_eq_u32 vcc, -1, v4
    v_smfmac_f32_16x16x64_bf16 v[80:83], v[204:207], a[248:255], v9
    s_cbranch_vccnz .A_325
.W_326:
    v_smfmac_f32_16x16x64_bf16 v[76:79], v[208:211], v[124:131], v9
    v_smfmac_f32_16x16x64_bf16 v[80:83], v[208:211], v[156:163], v9
    s_waitcnt vmcnt(2)
    v_max3_u32 v4, v216, v217, v218
    v_max3_u32 v5, v219, v220, v221
    v_max3_u32 v4, v4, v222, v223
    v_smfmac_f32_16x16x64_bf16 v[76:79], v[212:215], v[132:139], v9
    v_max_u32 v4, v4, v5
    v_cmp_eq_u32 vcc, -1, v4
    v_smfmac_f32_16x16x64_bf16 v[80:83], v[212:215], v[164:171], v9
    s_cbranch_vccnz .A_327
.W_328:
    v_smfmac_f32_16x16x64_bf16 v[76:79], v[216:219], v[140:147], v9
    v_smfmac_f32_16x16x64_bf16 v[80:83], v[216:219], v[172:179], v9
    s_waitcnt vmcnt(0)
    v_max3_u32 v4, v192, v193, v194
    v_max3_u32 v5, v195, v196, v197
    v_max3_u32 v4, v4, v198, v199
    v_smfmac_f32_16x16x64_bf16 v[76:79], v[220:223], v[148:155], v9
    v_max_u32 v4, v4, v5
    v_cmp_eq_u32 vcc, -1, v4
    v_smfmac_f32_16x16x64_bf16 v[80:83], v[220:223], v[180:187], v9
    s_cbranch_vccnz .A_329
.W_330:
    v_smfmac_f32_16x16x64_bf16 v[76:79], v[192:195], a[192:199], v9
    v_smfmac_f32_16x16x64_bf16 v[80:83], v[192:195], a[224:231], v9
    v_smfmac_f32_16x16x64_bf16 v[76:79], v[196:199], a[200:207], v9
    v_smfmac_f32_16x16x64_bf16 v[80:83], v[196:199], a[232:239], v9
    s_branch .mj_227
.W_316:
    v_smfmac_f32_16x16x64_bf16 v[76:79], v[208:211], v[124:131], v9
    v_smfmac_f32_16x16x64_bf16 v[80:83], v[208:211], v[156:163], v9
    s_waitcnt vmcnt(4)
    v_max3_u32 v4, v216, v217, v218
    v_max3_u32 v5, v219, v220, v221
    v_max3_u32 v4, v4, v222, v223
    v_smfmac_f32_16x16x64_bf16 v[76:79], v[212:215], v[132:139], v9
    v_max_u32 v4, v4, v5
    v_cmp_eq_u32 vcc, -1, v4
    v_smfmac_f32_16x16x64_bf16 v[80:83], v[212:215], v[164:171], v9
    s_cbranch_vccnz .A_331
.W_332:
    v_smfmac_f32_16x16x64_bf16 v[76:79], v[216:219], v[140:147], v9
    v_smfmac_f32_16x16x64_bf16 v[80:83], v[216:219], v[172:179], v9
    s_waitcnt vmcnt(2)
    v_max3_u32 v4, v192, v193, v194
    v_max3_u32 v5, v195, v196, v197
    v_max3_u32 v4, v4, v198, v199
    v_smfmac_f32_16x16x64_bf16 v[76:79], v[220:223], v[148:155], v9
    v_max_u32 v4, v4, v5
    v_cmp_eq_u32 vcc, -1, v4
    v_smfmac_f32_16x16x64_bf16 v[80:83], v[220:223], v[180:187], v9
    s_cbranch_vccnz .A_333
.W_334:
    v_smfmac_f32_16x16x64_bf16 v[76:79], v[192:195], a[192:199], v9
    v_smfmac_f32_16x16x64_bf16 v[80:83], v[192:195], a[224:231], v9
    s_waitcnt vmcnt(0)
    v_max3_u32 v4, v200, v201, v202
    v_max3_u32 v5, v203, v204, v205
    v_max3_u32 v4, v4, v206, v207
    v_smfmac_f32_16x16x64_bf16 v[76:79], v[196:199], a[200:207], v9
    v_max_u32 v4, v4, v5
    v_cmp_eq_u32 vcc, -1, v4
    v_smfmac_f32_16x16x64_bf16 v[80:83], v[196:199], a[232:239], v9
    s_cbranch_vccnz .A_335
.W_336:
    v_smfmac_f32_16x16x64_bf16 v[76:79], v[200:203], a[208:215], v9
    v_smfmac_f32_16x16x64_bf16 v[80:83], v[200:203], a[240:247], v9
    v_smfmac_f32_16x16x64_bf16 v[76:79], v[204:207], a[216:223], v9
    v_smfmac_f32_16x16x64_bf16 v[80:83], v[204:207], a[248:255], v9
    s_branch .mj_227
.A_337:
    buffer_load_dwordx4 v[208:211], v254, s[8:11], s32 offen offset:0 sc1
    buffer_load_dwordx4 v[212:215], v254, s[8:11], s32 offen offset:1024 sc1
    s_sub_u32 s62, s62, 1
    s_cbranch_scc1 .mg_end_1
    s_waitcnt vmcnt(4)
    v_max3_u32 v4, v192, v193, v194
    v_max3_u32 v5, v195, v196, v197
    v_max3_u32 v4, v4, v198, v199
    v_max_u32 v4, v4, v5
    v_cmp_eq_u32 vcc, -1, v4
    s_cbranch_vccz .W_320
.A_319:
    buffer_load_dwordx4 v[192:195], v243, s[8:11], s32 offen offset:0 sc1
    buffer_load_dwordx4 v[196:199], v243, s[8:11], s32 offen offset:1024 sc1
    s_waitcnt vmcnt(4)
    v_max3_u32 v4, v200, v201, v202
    v_max3_u32 v5, v203, v204, v205
    v_max3_u32 v4, v4, v206, v207
    v_max_u32 v4, v4, v5
    v_cmp_eq_u32 vcc, -1, v4
    s_cbranch_vccz .W_338
.A_339:
    buffer_load_dwordx4 v[200:203], v252, s[8:11], s32 offen offset:0 sc1
    buffer_load_dwordx4 v[204:207], v252, s[8:11], s32 offen offset:1024 sc1
    s_waitcnt vmcnt(4)
    v_max3_u32 v4, v208, v209, v210
    v_max3_u32 v5, v211, v212, v213
    v_max3_u32 v4, v4, v214, v215
    v_max_u32 v4, v4, v5
    v_cmp_eq_u32 vcc, -1, v4
    s_cbranch_vccnz .A_337
.W_340:
    v_smfmac_f32_16x16x64_bf16 v[76:79], v[208:211], v[124:131], v9
    v_smfmac_f32_16x16x64_bf16 v[80:83], v[208:211], v[156:163], v9
    s_waitcnt vmcnt(2)
    v_max3_u32 v4, v192, v193, v194
    v_max3_u32 v5, v195, v196, v197
    v_max3_u32 v4, v4, v198, v199
    v_smfmac_f32_16x16x64_bf16 v[76:79], v[212:215], v[132:139], v9
    v_max_u32 v4, v4, v5
    v_cmp_eq_u32 vcc, -1, v4
    v_smfmac_f32_16x16x64_bf16 v[80:83], v[212:215], v[164:171], v9
    s_cbranch_vccz .W_334
    s_branch .A_333
.W_338:
    v_smfmac_f32_16x16x64_bf16 v[76:79], v[200:203], a[208:215], v9
    v_smfmac_f32_16x16x64_bf16 v[80:83], v[200:203], a[240:247], v9
    s_waitcnt vmcnt(2)
    v_max3_u32 v4, v208, v209, v210
    v_max3_u32 v5, v211, v212, v213
    v_max3_u32 v4, v4, v214, v215
    v_smfmac_f32_16x16x64_bf16 v[76:79], v[204:207], a[216:223], v9
    v_max_u32 v4, v4, v5
    v_cmp_eq_u32 vcc, -1, v4
    v_smfmac_f32_16x16x64_bf16 v[80:83], v[204:207], a[248:255], v9
    s_cbranch_vccnz .A_341
.W_342:
    v_smfmac_f32_16x16x64_bf16 v[76:79], v[208:211], v[124:131], v9
    v_smfmac_f32_16x16x64_bf16 v[80:83], v[208:211], v[156:163], v9
    s_waitcnt vmcnt(0)
    v_max3_u32 v4, v192, v193, v194
    v_max3_u32 v5, v195, v196, v197
    v_max3_u32 v4, v4, v198, v199
    v_smfmac_f32_16x16x64_bf16 v[76:79], v[212:215], v[132:139], v9
    v_max_u32 v4, v4, v5
    v_cmp_eq_u32 vcc, -1, v4
    v_smfmac_f32_16x16x64_bf16 v[80:83], v[212:215], v[164:171], v9
    s_cbranch_vccz .W_330
    s_branch .A_329
.A_343:
    buffer_load_dwordx4 v[200:203], v252, s[8:11], s32 offen offset:0 sc1
    buffer_load_dwordx4 v[204:207], v252, s[8:11], s32 offen offset:1024 sc1
    s_sub_u32 s62, s62, 1
    s_cbranch_scc1 .mg_end_1
    s_waitcnt vmcnt(4)
    v_max3_u32 v4, v216, v217, v218
    v_max3_u32 v5, v219, v220, v221
    v_max3_u32 v4, v4, v222, v223
    v_max_u32 v4, v4, v5
    v_cmp_eq_u32 vcc, -1, v4
    s_cbranch_vccz .W_332
.A_331:
    buffer_load_dwordx4 v[216:219], v246, s[8:11], s32 offen offset:0 sc1
    buffer_load_dwordx4 v[220:223], v246, s[8:11], s32 offen offset:1024 sc1
    s_waitcnt vmcnt(4)
    v_max3_u32 v4, v192, v193, v194
    v_max3_u32 v5, v195, v196, v197
    v_max3_u32 v4, v4, v198, v199
    v_max_u32 v4, v4, v5
    v_cmp_eq_u32 vcc, -1, v4
    s_cbranch_vccz .W_344
.A_345:
    buffer_load_dwordx4 v[192:195], v243, s[8:11], s32 offen offset:0 sc1
    buffer_load_dwordx4 v[196:199], v243, s[8:11], s32 offen offset:1024 sc1
    s_waitcnt vmcnt(4)
    v_max3_u32 v4, v200, v201, v202
    v_max3_u32 v5, v203, v204, v205
    v_max3_u32 v4, v4, v206, v207
    v_max_u32 v4, v4, v5
    v_cmp_eq_u32 vcc, -1, v4
    s_cbranch_vccnz .A_343
.W_346:
    v_smfmac_f32_16x16x64_bf16 v[76:79], v[200:203], a[208:215], v9
    v_smfmac_f32_16x16x64_bf16 v[80:83], v[200:203], a[240:247], v9
    s_waitcnt vmcnt(2)
    v_max3_u32 v4, v216, v217, v218
    v_max3_u32 v5, v219, v220, v221
    v_max3_u32 v4, v4, v222, v223
    v_smfmac_f32_16x16x64_bf16 v[76:79], v[204:207], a[216:223], v9
    v_max_u32 v4, v4, v5
    v_cmp_eq_u32 vcc, -1, v4
    v_smfmac_f32_16x16x64_bf16 v[80:83], v[204:207], a[248:255], v9
    s_cbranch_vccz .W_328
    s_branch .A_327
.W_344:
    v_smfmac_f32_16x16x64_bf16 v[76:79], v[192:195], a[192:199], v9
    v_smfmac_f32_16x16x64_bf16 v[80:83], v[192:195], a[224:231], v9
    s_waitcnt vmcnt(2)
    v_max3_u32 v4, v200, v201, v202
    v_max3_u32 v5, v203, v204, v205
    v_max3_u32 v4, v4, v206, v207
    v_smfmac_f32_16x16x64_bf16 v[76:79], v[196:199], a[200:207], v9
    v_max_u32 v4, v4, v5
    v_cmp_eq_u32 vcc, -1, v4
    v_smfmac_f32_16x16x64_bf16 v[80:83], v[196:199], a[232:239], v9
    s_cbranch_vccnz .A_347
.W_348:
    v_smfmac_f32_16x16x64_bf16 v[76:79], v[200:203], a[208:215], v9
    v_smfmac_f32_16x16x64_bf16 v[80:83], v[200:203], a[240:247], v9
    s_waitcnt vmcnt(0)
    v_max3_u32 v4, v216, v217, v218
    v_max3_u32 v5, v219, v220, v221
    v_max3_u32 v4, v4, v222, v223
    v_smfmac_f32_16x16x64_bf16 v[76:79], v[204:207], a[216:223], v9
    v_max_u32 v4, v4, v5
    v_cmp_eq_u32 vcc, -1, v4
    v_smfmac_f32_16x16x64_bf16 v[80:83], v[204:207], a[248:255], v9
    s_cbranch_vccz .W_235
    s_branch .A_234
.A_349:
    buffer_load_dwordx4 v[216:219], v246, s[8:11], s32 offen offset:0 sc1
    buffer_load_dwordx4 v[220:223], v246, s[8:11], s32 offen offset:1024 sc1
    s_sub_u32 s62, s62, 1
    s_cbranch_scc1 .mg_end_1
    s_waitcnt vmcnt(4)
    v_max3_u32 v4, v192, v193, v194
    v_max3_u32 v5, v195, v196, v197
    v_max3_u32 v4, v4, v198, v199
    v_max_u32 v4, v4, v5
    v_cmp_eq_u32 vcc, -1, v4
    s_cbranch_vccz .W_350
.A_351:
    buffer_load_dwordx4 v[192:195], v243, s[8:11], s32 offen offset:0 sc1
    buffer_load_dwordx4 v[196:199], v243, s[8:11], s32 offen offset:1024 sc1
    s_waitcnt vmcnt(4)
    v_max3_u32 v4, v208, v209, v210
    v_max3_u32 v5, v211, v212, v213
    v_max3_u32 v4, v4, v214, v215
    v_max_u32 v4, v4, v5
    v_cmp_eq_u32 vcc, -1, v4
    s_cbranch_vccz .W_326
.A_325:
    buffer_load_dwordx4 v[208:211], v254, s[8:11], s32 offen offset:0 sc1
    buffer_load_dwordx4 v[212:215], v254, s[8:11], s32 offen offset:1024 sc1
    s_waitcnt vmcnt(4)
    v_max3_u32 v4, v216, v217, v218
    v_max3_u32 v5, v219, v220, v221
    v_max3_u32 v4, v4, v222, v223
    v_max_u32 v4, v4, v5
    v_cmp_eq_u32 vcc, -1, v4
    s_cbranch_vccnz .A_349
.W_352:
    v_smfmac_f32_16x16x64_bf16 v[76:79], v[216:219], v[140:147], v9
    v_smfmac_f32_16x16x64_bf16 v[80:83], v[216:219], v[172:179], v9
    s_waitcnt vmcnt(2)
    v_max3_u32 v4, v192, v193, v194
    v_max3_u32 v5, v195, v196, v197
    v_max3_u32 v4, v4, v198, v199
    v_smfmac_f32_16x16x64_bf16 v[76:79], v[220:223], v[148:155], v9
    v_max_u32 v4, v4, v5
    v_cmp_eq_u32 vcc, -1, v4
    v_smfmac_f32_16x16x64_bf16 v[80:83], v[220:223], v[180:187], v9
    s_cbranch_vccnz .A_353
.W_354:
    v_smfmac_f32_16x16x64_bf16 v[76:79], v[192:195], a[192:199], v9
    v_smfmac_f32_16x16x64_bf16 v[80:83], v[192:195], a[224:231], v9
    s_waitcnt vmcnt(0)
    v_max3_u32 v4, v208, v209, v210
    v_max3_u32 v5, v211, v212, v213
    v_max3_u32 v4, v4, v214, v215
    v_smfmac_f32_16x16x64_bf16 v[76:79], v[196:199], a[200:207], v9
    v_max_u32 v4, v4, v5
    v_cmp_eq_u32 vcc, -1, v4
    v_smfmac_f32_16x16x64_bf16 v[80:83], v[196:199], a[232:239], v9
    s_cbranch_vccz .W_324
    s_branch .A_323
.W_350:
    v_smfmac_f32_16x16x64_bf16 v[76:79], v[192:195], a[192:199], v9
    v_smfmac_f32_16x16x64_bf16 v[80:83], v[192:195], a[224:231], v9
    s_waitcnt vmcnt(2)
    v_max3_u32 v4, v208, v209, v210
    v_max3_u32 v5, v211, v212, v213
    v_max3_u32 v4, v4, v214, v215
    v_smfmac_f32_16x16x64_bf16 v[76:79], v[196:199], a[200:207], v9
    v_max_u32 v4, v4, v5
    v_cmp_eq_u32 vcc, -1, v4
    v_smfmac_f32_16x16x64_bf16 v[80:83], v[196:199], a[232:239], v9
    s_cbranch_vccz .W_233
    s_branch .A_232
.A_355:
    buffer_load_dwordx4 v[216:219], v246, s[8:11], s32 offen offset:0 sc1
    buffer_load_dwordx4 v[220:223], v246, s[8:11], s32 offen offset:1024 sc1
    s_sub_u32 s62, s62, 1
    s_cbranch_scc1 .mg_end_1
    s_waitcnt vmcnt(4)
    v_max3_u32 v4, v200, v201, v202
    v_max3_u32 v5, v203, v204, v205
    v_max3_u32 v4, v4, v206, v207
    v_max_u32 v4, v4, v5
    v_cmp_eq_u32 vcc, -1, v4
    s_cbranch_vccz .W_231
.A_230:
    buffer_load_dwordx4 v[200:203], v252, s[8:11], s32 offen offset:0 sc1
    buffer_load_dwordx4 v[204:207], v252, s[8:11], s32 offen offset:1024 sc1
    s_waitcnt vmcnt(4)
    v_max3_u32 v4, v208, v209, v210
    v_max3_u32 v5, v211, v212, v213
    v_max3_u32 v4, v4, v214, v215
    v_max_u32 v4, v4, v5
    v_cmp_eq_u32 vcc, -1, v4
    s_cbranch_vccz .W_356
.A_357:
    buffer_load_dwordx4 v[208:211], v254, s[8:11], s32 offen offset:0 sc1
    buffer_load_dwordx4 v[212:215], v254, s[8:11], s32 offen offset:1024 sc1
    s_waitcnt vmcnt(4)
    v_max3_u32 v4, v216, v217, v218
    v_max3_u32 v5, v219, v220, v221
    v_max3_u32 v4, v4, v222, v223
    v_max_u32 v4, v4, v5
    v_cmp_eq_u32 vcc, -1, v4
    s_cbranch_vccnz .A_355
.W_358:
    v_smfmac_f32_16x16x64_bf16 v[76:79], v[216:219], v[140:147], v9
    v_smfmac_f32_16x16x64_bf16 v[80:83], v[216:219], v[172:179], v9
    s_waitcnt vmcnt(2)
    v_max3_u32 v4, v200, v201, v202
    v_max3_u32 v5, v203, v204, v205
    v_max3_u32 v4, v4, v206, v207
    v_smfmac_f32_16x16x64_bf16 v[76:79], v[220:223], v[148:155], v9
    v_max_u32 v4, v4, v5
    v_cmp_eq_u32 vcc, -1, v4
    v_smfmac_f32_16x16x64_bf16 v[80:83], v[220:223], v[180:187], v9
    s_cbranch_vccz .W_322
    s_branch .A_321
.W_356:
    v_smfmac_f32_16x16x64_bf16 v[76:79], v[208:211], v[124:131], v9
    v_smfmac_f32_16x16x64_bf16 v[80:83], v[208:211], v[156:163], v9
    s_waitcnt vmcnt(2)
    v_max3_u32 v4, v216, v217, v218
    v_max3_u32 v5, v219, v220, v221
    v_max3_u32 v4, v4, v222, v223
    v_smfmac_f32_16x16x64_bf16 v[76:79], v[212:215], v[132:139], v9
    v_max_u32 v4, v4, v5
    v_cmp_eq_u32 vcc, -1, v4
    v_smfmac_f32_16x16x64_bf16 v[80:83], v[212:215], v[164:171], v9
    s_cbranch_vccnz .A_359
.W_360:
    v_smfmac_f32_16x16x64_bf16 v[76:79], v[216:219], v[140:147], v9
    v_smfmac_f32_16x16x64_bf16 v[80:83], v[216:219], v[172:179], v9
    s_waitcnt vmcnt(0)
    v_max3_u32 v4, v200, v201, v202
    v_max3_u32 v5, v203, v204, v205
    v_max3_u32 v4, v4, v206, v207
    v_smfmac_f32_16x16x64_bf16 v[76:79], v[220:223], v[148:155], v9
    v_max_u32 v4, v4, v5
    v_cmp_eq_u32 vcc, -1, v4
    v_smfmac_f32_16x16x64_bf16 v[80:83], v[220:223], v[180:187], v9
    s_cbranch_vccz .W_336
    s_branch .A_335
.A_361:
    buffer_load_dwordx4 v[200:203], v252, s[8:11], s32 offen offset:0 sc1
    buffer_load_dwordx4 v[204:207], v252, s[8:11], s32 offen offset:1024 sc1
    s_sub_u32 s62, s62, 1
    s_cbranch_scc1 .mg_end_1
    s_waitcnt vmcnt(2)
    v_max3_u32 v4, v192, v193, v194
    v_max3_u32 v5, v195, v196, v197
    v_max3_u32 v4, v4, v198, v199
    v_max_u32 v4, v4, v5
    v_cmp_eq_u32 vcc, -1, v4
    s_cbranch_vccz .W_334
.A_333:
    buffer_load_dwordx4 v[192:195], v243, s[8:11], s32 offen offset:0 sc1
    buffer_load_dwordx4 v[196:199], v243, s[8:11], s32 offen offset:1024 sc1
    s_waitcnt vmcnt(2)
    v_max3_u32 v4, v200, v201, v202
    v_max3_u32 v5, v203, v204, v205
    v_max3_u32 v4, v4, v206, v207
    v_max_u32 v4, v4, v5
    v_cmp_eq_u32 vcc, -1, v4
    s_cbranch_vccnz .A_361
.W_362:
    v_smfmac_f32_16x16x64_bf16 v[76:79], v[200:203], a[208:215], v9
    v_smfmac_f32_16x16x64_bf16 v[80:83], v[200:203], a[240:247], v9
    s_waitcnt vmcnt(0)
    v_max3_u32 v4, v192, v193, v194
    v_max3_u32 v5, v195, v196, v197
    v_max3_u32 v4, v4, v198, v199
    v_smfmac_f32_16x16x64_bf16 v[76:79], v[204:207], a[216:223], v9
    v_max_u32 v4, v4, v5
    v_cmp_eq_u32 vcc, -1, v4
    v_smfmac_f32_16x16x64_bf16 v[80:83], v[204:207], a[248:255], v9
    s_cbranch_vccz .W_330
    s_branch .A_329
.A_341:
    buffer_load_dwordx4 v[208:211], v254, s[8:11], s32 offen offset:0 sc1
    buffer_load_dwordx4 v[212:215], v254, s[8:11], s32 offen offset:1024 sc1
    s_sub_u32 s62, s62, 1
    s_cbranch_scc1 .mg_end_1
    s_waitcnt vmcnt(2)
    v_max3_u32 v4, v192, v193, v194
    v_max3_u32 v5, v195, v196, v197
    v_max3_u32 v4, v4, v198, v199
    v_max_u32 v4, v4, v5
    v_cmp_eq_u32 vcc, -1, v4
    s_cbranch_vccz .W_354
.A_353:
    buffer_load_dwordx4 v[192:195], v243, s[8:11], s32 offen offset:0 sc1
    buffer_load_dwordx4 v[196:199], v243, s[8:11], s32 offen offset:1024 sc1
    s_waitcnt vmcnt(2)
    v_max3_u32 v4, v208, v209, v210
    v_max3_u32 v5, v211, v212, v213
    v_max3_u32 v4, v4, v214, v215
    v_max_u32 v4, v4, v5
    v_cmp_eq_u32 vcc, -1, v4
    s_cbranch_vccnz .A_341
    s_branch .W_342
.A_363:
    buffer_load_dwordx4 v[192:195], v243, s[8:11], s32 offen offset:0 sc1
    buffer_load_dwordx4 v[196:199], v243, s[8:11], s32 offen offset:1024 sc1
    s_sub_u32 s62, s62, 1
    s_cbranch_scc1 .mg_end_1
    s_waitcnt vmcnt(2)
    v_max3_u32 v4, v216, v217, v218
    v_max3_u32 v5, v219, v220, v221
    v_max3_u32 v4, v4, v222, v223
    v_max_u32 v4, v4, v5
    v_cmp_eq_u32 vcc, -1, v4
    s_cbranch_vccz .W_328
.A_327:
    buffer_load_dwordx4 v[216:219], v246, s[8:11], s32 offen offset:0 sc1
    buffer_load_dwordx4 v[220:223], v246, s[8:11], s32 offen offset:1024 sc1
    s_waitcnt vmcnt(2)
    v_max3_u32 v4, v192, v193, v194
    v_max3_u32 v5, v195, v196, v197
    v_max3_u32 v4, v4, v198, v199
    v_max_u32 v4, v4, v5
    v_cmp_eq_u32 vcc, -1, v4
    s_cbranch_vccnz .A_363
.W_364:
    v_smfmac_f32_16x16x64_bf16 v[76:79], v[192:195], a[192:199], v9
    v_smfmac_f32_16x16x64_bf16 v[80:83], v[192:195], a[224:231], v9
    s_waitcnt vmcnt(0)
    v_max3_u32 v4, v216, v217, v218
    v_max3_u32 v5, v219, v220, v221
    v_max3_u32 v4, v4, v222, v223
    v_smfmac_f32_16x16x64_bf16 v[76:79], v[196:199], a[200:207], v9
    v_max_u32 v4, v4, v5
    v_cmp_eq_u32 vcc, -1, v4
    v_smfmac_f32_16x16x64_bf16 v[80:83], v[196:199], a[232:239], v9
    s_cbranch_vccz .W_235
    s_branch .A_234
.A_365:
    buffer_load_dwordx4 v[208:211], v254, s[8:11], s32 offen offset:0 sc1
    buffer_load_dwordx4 v[212:215], v254, s[8:11], s32 offen offset:1024 sc1
    s_sub_u32 s62, s62, 1
    s_cbranch_scc1 .mg_end_1
    s_waitcnt vmcnt(2)
    v_max3_u32 v4, v200, v201, v202
    v_max3_u32 v5, v203, v204, v205
    v_max3_u32 v4, v4, v206, v207
    v_max_u32 v4, v4, v5
    v_cmp_eq_u32 vcc, -1, v4
    s_cbranch_vccz .W_322
.A_321:
    buffer_load_dwordx4 v[200:203], v252, s[8:11], s32 offen offset:0 sc1
    buffer_load_dwordx4 v[204:207], v252, s[8:11], s32 offen offset:1024 sc1
    s_waitcnt vmcnt(2)
    v_max3_u32 v4, v208, v209, v210
    v_max3_u32 v5, v211, v212, v213
    v_max3_u32 v4, v4, v214, v215
    v_max_u32 v4, v4, v5
    v_cmp_eq_u32 vcc, -1, v4
    s_cbranch_vccnz .A_365
.W_366:
    v_smfmac_f32_16x16x64_bf16 v[76:79], v[208:211], v[124:131], v9
    v_smfmac_f32_16x16x64_bf16 v[80:83], v[208:211], v[156:163], v9
    s_waitcnt vmcnt(0)
    v_max3_u32 v4, v200, v201, v202
    v_max3_u32 v5, v203, v204, v205
    v_max3_u32 v4, v4, v206, v207
    v_smfmac_f32_16x16x64_bf16 v[76:79], v[212:215], v[132:139], v9
    v_max_u32 v4, v4, v5
    v_cmp_eq_u32 vcc, -1, v4
    v_smfmac_f32_16x16x64_bf16 v[80:83], v[212:215], v[164:171], v9
    s_cbranch_vccz .W_336
    s_branch .A_335
.A_359:
    buffer_load_dwordx4 v[216:219], v246, s[8:11], s32 offen offset:0 sc1
    buffer_load_dwordx4 v[220:223], v246, s[8:11], s32 offen offset:1024 sc1
    s_sub_u32 s62, s62, 1
    s_cbranch_scc1 .mg_end_1
    s_waitcnt vmcnt(2)
    v_max3_u32 v4, v200, v201, v202
    v_max3_u32 v5, v203, v204, v205
    v_max3_u32 v4, v4, v206, v207
    v_max_u32 v4, v4, v5
    v_cmp_eq_u32 vcc, -1, v4
    s_cbranch_vccz .W_348
.A_347:
    buffer_load_dwordx4 v[200:203], v252, s[8:11], s32 offen offset:0 sc1
    buffer_load_dwordx4 v[204:207], v252, s[8:11], s32 offen offset:1024 sc1
    s_waitcnt vmcnt(2)
    v_max3_u32 v4, v216, v217, v218
    v_max3_u32 v5, v219, v220, v221
    v_max3_u32 v4, v4, v222, v223
    v_max_u32 v4, v4, v5
    v_cmp_eq_u32 vcc, -1, v4
    s_cbranch_vccnz .A_359
    s_branch .W_360
.A_367:
    buffer_load_dwordx4 v[216:219], v246, s[8:11], s32 offen offset:0 sc1
    buffer_load_dwordx4 v[220:223], v246, s[8:11], s32 offen offset:1024 sc1
    s_sub_u32 s62, s62, 1
    s_cbranch_scc1 .mg_end_1
    s_waitcnt vmcnt(2)
    v_max3_u32 v4, v208, v209, v210
    v_max3_u32 v5, v211, v212, v213
    v_max3_u32 v4, v4, v214, v215
    v_max_u32 v4, v4, v5
    v_cmp_eq_u32 vcc, -1, v4
    s_cbranch_vccz .W_233
.A_232:
    buffer_load_dwordx4 v[208:211], v254, s[8:11], s32 offen offset:0 sc1
    buffer_load_dwordx4 v[212:215], v254, s[8:11], s32 offen offset:1024 sc1
    s_waitcnt vmcnt(2)
    v_max3_u32 v4, v216, v217, v218
    v_max3_u32 v5, v219, v220, v221
    v_max3_u32 v4, v4, v222, v223
    v_max_u32 v4, v4, v5
    v_cmp_eq_u32 vcc, -1, v4
    s_cbranch_vccnz .A_367
.W_368:
    v_smfmac_f32_16x16x64_bf16 v[76:79], v[216:219], v[140:147], v9
    v_smfmac_f32_16x16x64_bf16 v[80:83], v[216:219], v[172:179], v9
    s_waitcnt vmcnt(0)
    v_max3_u32 v4, v208, v209, v210
    v_max3_u32 v5, v211, v212, v213
    v_max3_u32 v4, v4, v214, v215
    v_smfmac_f32_16x16x64_bf16 v[76:79], v[220:223], v[148:155], v9
    v_max_u32 v4, v4, v5
    v_cmp_eq_u32 vcc, -1, v4
    v_smfmac_f32_16x16x64_bf16 v[80:83], v[220:223], v[180:187], v9
    s_cbranch_vccz .W_324
    s_branch .A_323
.A_329:
    buffer_load_dwordx4 v[192:195], v243, s[8:11], s32 offen offset:0 sc1
    buffer_load_dwordx4 v[196:199], v243, s[8:11], s32 offen offset:1024 sc1
    s_sub_u32 s62, s62, 1
    s_cbranch_scc1 .mg_end_1
    s_waitcnt vmcnt(2)
    v_max3_u32 v4, v192, v193, v194
    v_max3_u32 v5, v195, v196, v197
    v_max3_u32 v4, v4, v198, v199
    v_max_u32 v4, v4, v5
    v_cmp_eq_u32 vcc, -1, v4
    s_cbranch_vccnz .A_329
    v_smfmac_f32_16x16x64_bf16 v[76:79], v[192:195], a[192:199], v9
    v_smfmac_f32_16x16x64_bf16 v[80:83], v[192:195], a[224:231], v9
    v_smfmac_f32_16x16x64_bf16 v[76:79], v[196:199], a[200:207], v9
    v_smfmac_f32_16x16x64_bf16 v[80:83], v[196:199], a[232:239], v9
    s_branch .mj_227
.A_335:
    buffer_load_dwordx4 v[200:203], v252, s[8:11], s32 offen offset:0 sc1
    buffer_load_dwordx4 v[204:207], v252, s[8:11], s32 offen offset:1024 sc1
    s_sub_u32 s62, s62, 1
    s_cbranch_scc1 .mg_end_1
    s_waitcnt vmcnt(2)
    v_max3_u32 v4, v200, v201, v202
    v_max3_u32 v5, v203, v204, v205
    v_max3_u32 v4, v4, v206, v207
    v_max_u32 v4, v4, v5
    v_cmp_eq_u32 vcc, -1, v4
    s_cbranch_vccnz .A_335
    v_smfmac_f32_16x16x64_bf16 v[76:79], v[200:203], a[208:215], v9
    v_smfmac_f32_16x16x64_bf16 v[80:83], v[200:203], a[240:247], v9
    v_smfmac_f32_16x16x64_bf16 v[76:79], v[204:207], a[216:223], v9
    v_smfmac_f32_16x16x64_bf16 v[80:83], v[204:207], a[248:255], v9
    s_branch .mj_227
.A_323:
    buffer_load_dwordx4 v[208:211], v254, s[8:11], s32 offen offset:0 sc1
    buffer_load_dwordx4 v[212:215], v254, s[8:11], s32 offen offset:1024 sc1
    s_sub_u32 s62, s62, 1
    s_cbranch_scc1 .mg_end_1
    s_waitcnt vmcnt(2)
    v_max3_u32 v4, v208, v209, v210
    v_max3_u32 v5, v211, v212, v213
    v_max3_u32 v4, v4, v214, v215
    v_max_u32 v4, v4, v5
    v_cmp_eq_u32 vcc, -1, v4
    s_cbranch_vccnz .A_323
    v_smfmac_f32_16x16x64_bf16 v[76:79], v[208:211], v[124:131], v9
    v_smfmac_f32_16x16x64_bf16 v[80:83], v[208:211], v[156:163], v9
    v_smfmac_f32_16x16x64_bf16 v[76:79], v[212:215], v[132:139], v9
    v_smfmac_f32_16x16x64_bf16 v[80:83], v[212:215], v[164:171], v9
    s_branch .mj_227
.A_234:
    buffer_load_dwordx4 v[216:219], v246, s[8:11], s32 offen offset:0 sc1
    buffer_load_dwordx4 v[220:223], v246, s[8:11], s32 offen offset:1024 sc1
    s_sub_u32 s62, s62, 1
    s_cbranch_scc1 .mg_end_1
    s_waitcnt vmcnt(2)
    v_max3_u32 v4, v216, v217, v218
    v_max3_u32 v5, v219, v220, v221
    v_max3_u32 v4, v4, v222, v223
    v_max_u32 v4, v4, v5
    v_cmp_eq_u32 vcc, -1, v4
    s_cbranch_vccnz .A_234
    v_smfmac_f32_16x16x64_bf16 v[76:79], v[216:219], v[140:147], v9
    v_smfmac_f32_16x16x64_bf16 v[80:83], v[216:219], v[172:179], v9
    v_smfmac_f32_16x16x64_bf16 v[76:79], v[220:223], v[148:155], v9
    v_smfmac_f32_16x16x64_bf16 v[80:83], v[220:223], v[180:187], v9
    s_branch .mj_227
.sk_236:
    s_mov_b64 exec, s[66:67]
    buffer_store_dwordx4 v[88:91], v11, s[8:11], s36 offen sc1
    s_mov_b64 exec, s[56:57]
    buffer_store_dwordx4 v[172:175], v12, s[8:11], s36 offen sc1
    s_mov_b64 exec, -1

    s_branch .rec_fin_6
.rec_fin_6:
    s_mov_b64 exec, -1
    s_endpgm
.mg_bg_2:
    s_sub_u32 s91, s25, 4
    s_lshl_b32 s90, s91, 5
    s_add_u32 s90, s90, s26
    s_cmp_ge_u32 s26, 24
    s_cbranch_scc1 .cvrole_369
    s_lshr_b32 s30, s26, 3
    s_sub_u32 s30, 2, s30
    s_and_b32 s31, s26, 7
    s_lshl_b32 s4, s91, 3
    s_add_u32 s31, s31, s4

    s_lshl_b32 s4, s30, 5
    s_add_u32 s4, s4, s31
    s_lshl_b32 s4, s4, 8
    s_add_u32 s4, s4, 92274688
    v_mov_b32 v4, 0
    s_mov_b64 exec, 1
    buffer_store_dword v4, v4, s[8:11], s4 offen sc1
    s_mov_b64 exec, -1

    s_load_dwordx2 s[40:41], s[0:1], 0
    s_load_dwordx4 s[44:47], s[0:1], 64
    s_load_dwordx2 s[42:43], s[0:1], 80

    v_and_b32 v1, 63, v0
    v_and_b32 v2, 15, v1
    v_lshrrev_b32 v3, 4, v1

    s_lshl_b32 s28, s31, 8
    s_waitcnt lgkmcnt(0)
    s_mov_b64 s[48:49], s[42:43]
    s_cmp_eq_u32 s30, 0
    s_cselect_b64 s[42:43], s[44:45], s[42:43]
    s_cmp_eq_u32 s30, 1
    s_cselect_b64 s[42:43], s[46:47], s[42:43]

    s_mov_b32 s16, s40
    s_and_b32 s17, s41, 0xffff
    s_mov_b32 s18, 0x400000
    s_mov_b32 s19, 0x00020000

    s_mov_b32 s12, s42
    s_and_b32 s13, s43, 0xffff
    s_mov_b32 s14, 0x800000
    s_mov_b32 s15, 0x00020000

    v_lshrrev_b32 v4, 1, v2
    v_xor_b32 v4, v4, v3
    v_lshlrev_b32 v4, 1, v4
    v_and_b32 v5, 1, v1
    v_or_b32 v4, v4, v5
    v_lshlrev_b32 v4, 4, v4
    v_lshlrev_b32 v5, 13, v3
    v_add_u32 v10, v4, v5
    v_xor_b32 v11, 0x80, v10
    s_lshl_b32 s4, s24, 18
    s_add_u32 s28, s28, s4
    s_lshl_b32 s29, s24, 13
    v_lshrrev_b32 v4, 2, v2
    v_and_b32 v5, 1, v3
    v_lshl_or_b32 v5, v5, 2, v4
    s_lshl_b32 s4, s24, 1
    v_xor_b32 v5, s4, v5
    v_lshlrev_b32 v5, 5, v5
    v_lshl_add_u32 v4, v3, 3, v4
    v_lshl_add_u32 v5, v4, 8, v5
    v_and_b32 v4, 3, v2
    v_lshl_add_u32 v12, v4, 3, v5
    v_xor_b32 v13, 32, v12
    v_add_u32 v14, 0x10000, v12
    v_add_u32 v15, 0x10000, v13

    s_mov_b32 s63, 0
    s_cmp_lg_u32 s30, 0
    s_cbranch_scc1 .qh_370
    s_cmp_lt_u32 s24, 2
    s_cselect_b64 s[48:49], s[46:47], s[48:49]

    s_mov_b32 s64, s48
    s_and_b32 s65, s49, 0xffff
    s_mov_b32 s66, 0x800000
    s_mov_b32 s67, 0x00020000

    v_lshlrev_b32 v4, 13, v1
    s_and_b32 s4, s24, 1
    s_lshl_b32 s4, s4, 7
    s_lshl_b32 s5, s31, 8
    s_add_u32 s4, s4, s5
    s_add_u32 s4, s4, 4194304
    s_waitcnt vmcnt(0)

    v_mov_b32 v243, s99
    v_mov_b32 v242, 0
    s_cmp_lg_u32 s24, 0
    s_cbranch_scc1 .a1_371
    v_mov_b32 v242, s26
    v_lshlrev_b32 v242, 6, v242
    v_add_u32 v242, s97, v242
    v_and_b32 v242, 255, v242
    s_mov_b64 exec, 1
    buffer_atomic_add v243, v242, s[20:23], 0 offen sc1
    s_mov_b64 exec, -1

.a1_371:
    buffer_load_dword v31, v4, s[64:67], s4 offen
    s_add_u32 s4, s4, 524288
    buffer_load_dword v31, v4, s[64:67], s4 offen
    s_add_u32 s4, s4, 524288
    buffer_load_dword v31, v4, s[64:67], s4 offen
    s_add_u32 s4, s4, 524288
    buffer_load_dword v31, v4, s[64:67], s4 offen
    s_add_u32 s4, s4, 524288
    buffer_load_dword v31, v4, s[64:67], s4 offen
    s_add_u32 s4, s4, 524288
    buffer_load_dword v31, v4, s[64:67], s4 offen
    s_add_u32 s4, s4, 524288
    buffer_load_dword v31, v4, s[64:67], s4 offen
    s_add_u32 s4, s4, 524288
    buffer_load_dword v31, v4, s[64:67], s4 offen
    s_add_u32 s4, s4, 524288
    s_waitcnt vmcnt(0)
    s_mov_b32 s63, 99
.qh_370:
    s_and_b32 s4, s26, 7
    s_lshl_b32 s4, s4, 1
    s_lshr_b32 s5, s24, 1
    s_add_u32 s4, s4, s5
    s_lshl_b32 s4, s4, 6
    v_add_u32 v4, s4, v1
    v_lshlrev_b32 v4, 13, v4
    s_and_b32 s4, s24, 1
    s_lshl_b32 s4, s4, 10
    s_lshl_b32 s5, s91, 11
    s_add_u32 s4, s4, s5
    buffer_load_dword v31, v4, s[12:15], s4 offen offset:384

    s_add_u32 m0, s29, 98304
    s_add_u32 s4, s28, 0
    buffer_load_dwordx4 v10, s[12:15], s4 offen lds

    s_add_u32 m0, s29, 99328
    s_add_u32 s4, s28, 32768
    buffer_load_dwordx4 v10, s[12:15], s4 offen lds

    s_add_u32 m0, s29, 100352
    s_add_u32 s4, s28, 65536
    buffer_load_dwordx4 v11, s[12:15], s4 offen lds

    s_add_u32 m0, s29, 101376
    s_add_u32 s4, s28, 98304
    buffer_load_dwordx4 v11, s[12:15], s4 offen lds

    s_add_u32 m0, s29, 102400
    s_add_u32 s4, s28, 131072
    buffer_load_dwordx4 v10, s[12:15], s4 offen lds

    s_add_u32 m0, s29, 103424
    s_add_u32 s4, s28, 163840
    buffer_load_dwordx4 v10, s[12:15], s4 offen lds

    s_add_u32 m0, s29, 104448
    s_add_u32 s4, s28, 196608
    buffer_load_dwordx4 v11, s[12:15], s4 offen lds

    s_add_u32 m0, s29, 105472
    s_add_u32 s4, s28, 229376
    buffer_load_dwordx4 v11, s[12:15], s4 offen lds

    s_waitcnt vmcnt(9)
    v_mov_b32 v243, s99
    v_mov_b32 v242, 0
    s_cmp_lg_u32 s24, s63
    s_cbranch_scc1 .a1_373
    v_mov_b32 v242, s26
    v_lshlrev_b32 v242, 6, v242
    v_add_u32 v242, s97, v242
    v_and_b32 v242, 255, v242
    s_mov_b64 exec, 1
    buffer_atomic_add v243, v242, s[20:23], 0 offen sc1
    s_mov_b64 exec, -1

.a1_373:
    v_lshrrev_b32 v4, 3, v1
    v_and_b32 v5, 7, v1
    v_xor_b32 v5, v5, v4
    v_lshlrev_b32 v5, 4, v5
    v_lshl_add_u32 v16, v4, 11, v5
    s_lshl_b32 s4, s24, 14
    v_add_u32 v16, s4, v16
    v_and_b32 v4, 7, v2
    v_xor_b32 v5, v4, v3
    v_lshlrev_b32 v5, 4, v5
    v_lshl_add_u32 v5, v4, 7, v5
    v_lshrrev_b32 v4, 3, v2
    v_lshl_add_u32 v17, v4, 13, v5
    v_xor_b32 v18, 64, v17
    v_add_u32 v19, 0x10000, v17
    v_add_u32 v20, 0x10000, v18
    v_lshlrev_b32 v21, 4, v1
    s_lshl_b32 s32, s30, 24
    s_lshl_b32 s4, s31, 13
    s_add_u32 s32, s32, s4
    s_lshr_b32 s5, s30, 1
    s_add_u32 s5, s5, 10
    s_lshl_b32 s4, s24, s5
    s_add_u32 s39, s32, s4
    s_mov_b32 s32, s39
    s_add_u32 s38, s39, 4096
    s_mul_i32 s49, s31, 6144
    s_lshl_b32 s4, s30, 11
    s_add_u32 s49, s49, s4
    s_lshl_b32 s4, s24, 9
    s_add_u32 s49, s49, s4
    s_add_u32 s49, s49, 67108864
    s_mov_b32 s48, s49
    v_mov_b32 v23, -1
    s_lshl_b32 s4, s30, 5
    s_add_u32 s4, s4, s31
    s_lshl_b32 s4, s4, 8
    s_add_u32 s33, s4, 92274688
    s_cmp_eq_u32 s24, 0
    s_cselect_b32 s36, 1, 0
    s_mov_b32 s37, 0
    v_mov_b32 v22, 0
    s_mov_b32 s34, 0
    s_mov_b32 s35, 0
    s_and_b32 s4, s26, 7
    s_lshl_b32 s4, s4, 2
    s_add_u32 s4, s4, s24
    s_lshl_b32 s4, s4, 11
    v_lshlrev_b32 v111, 5, v1
    v_add_u32 v111, s4, v111

    s_mul_i32 s47, s26, 1441792
    s_lshl_b32 s4, s24, 10
    s_add_u32 s47, s47, s4
    s_add_u32 s47, s47, 184549376
    v_mov_b32 v24, -1
    v_mov_b32 v25, -1
    v_mov_b32 v26, -1
    v_mov_b32 v27, -1

    s_xor_b32 s4, s91, 1
    s_lshl_b32 s5, s4, 14
    s_lshl_b32 s6, s91, 12
    s_add_u32 s5, s5, s6
    v_add_u32 v28, s5, v21
    s_lshl_b32 s5, s91, 14
    s_lshl_b32 s6, s4, 12
    s_add_u32 s5, s5, s6
    v_add_u32 v7, s5, v21

    s_xor_b32 s4, s91, 2
    s_lshl_b32 s5, s4, 14
    s_lshl_b32 s6, s91, 12
    s_add_u32 s5, s5, s6
    v_add_u32 v29, s5, v21
    s_lshl_b32 s5, s91, 14
    s_lshl_b32 s6, s4, 12
    s_add_u32 s5, s5, s6
    v_add_u32 v8, s5, v21

    s_xor_b32 s4, s91, 3
    s_lshl_b32 s5, s4, 14
    s_lshl_b32 s6, s91, 12
    s_add_u32 s5, s5, s6
    v_add_u32 v30, s5, v21
    s_lshl_b32 s5, s91, 14
    s_lshl_b32 s6, s4, 12
    s_add_u32 s5, s5, s6
    v_add_u32 v9, s5, v21

    s_mov_b64 s[44:45], -1
    s_mov_b32 s46, s47
    s_add_u32 s39, s39, 262144
    s_add_u32 s49, s49, 196608
    v_mov_b32 v23, 0
    v_add_u32 v113, 0x20000, v17
    v_add_u32 v114, 0x20000, v18
    s_barrier

    s_add_u32 m0, s29, 131072
    s_nop 0
    buffer_load_dwordx4 v16, s[16:19], s34 offen offset:0 lds
    s_add_u32 m0, s29, 131968
    s_nop 0
    buffer_load_dwordx4 v16, s[16:19], s34 offen offset:128 lds
    s_add_u32 m0, s29, 132864
    s_nop 0
    buffer_load_dwordx4 v16, s[16:19], s34 offen offset:256 lds
    s_add_u32 m0, s29, 133760
    s_nop 0
    buffer_load_dwordx4 v16, s[16:19], s34 offen offset:384 lds
    s_add_u32 m0, s29, 134656
    s_nop 0
    buffer_load_dwordx4 v16, s[16:19], s34 offen offset:512 lds
    s_add_u32 m0, s29, 135552
    s_nop 0
    buffer_load_dwordx4 v16, s[16:19], s34 offen offset:640 lds
    s_add_u32 m0, s29, 136448
    s_nop 0
    buffer_load_dwordx4 v16, s[16:19], s34 offen offset:768 lds
    s_add_u32 m0, s29, 137344
    s_nop 0
    buffer_load_dwordx4 v16, s[16:19], s34 offen offset:896 lds
    s_add_u32 s34, s34, 1024
    s_add_u32 m0, s29, 0
    s_add_u32 s4, s28, 1048576
    buffer_load_dwordx4 v10, s[12:15], s4 offen lds

    s_add_u32 m0, s29, 1024
    s_add_u32 s4, s28, 1081344
    buffer_load_dwordx4 v10, s[12:15], s4 offen lds

    s_add_u32 m0, s29, 2048
    s_add_u32 s4, s28, 1114112
    buffer_load_dwordx4 v11, s[12:15], s4 offen lds

    s_add_u32 m0, s29, 3072
    s_add_u32 s4, s28, 1146880
    buffer_load_dwordx4 v11, s[12:15], s4 offen lds

    s_add_u32 m0, s29, 4096
    s_add_u32 s4, s28, 1179648
    buffer_load_dwordx4 v10, s[12:15], s4 offen lds

    s_add_u32 m0, s29, 5120
    s_add_u32 s4, s28, 1212416
    buffer_load_dwordx4 v10, s[12:15], s4 offen lds

    s_add_u32 m0, s29, 6144
    s_add_u32 s4, s28, 1245184
    buffer_load_dwordx4 v11, s[12:15], s4 offen lds

    s_add_u32 m0, s29, 7168
    s_add_u32 s4, s28, 1277952
    buffer_load_dwordx4 v11, s[12:15], s4 offen lds

    s_add_u32 m0, s29, 65536
    s_add_u32 s4, s28, 2097152
    buffer_load_dwordx4 v10, s[12:15], s4 offen lds

    s_add_u32 m0, s29, 66560
    s_add_u32 s4, s28, 2129920
    buffer_load_dwordx4 v10, s[12:15], s4 offen lds

    s_add_u32 m0, s29, 67584
    s_add_u32 s4, s28, 2162688
    buffer_load_dwordx4 v11, s[12:15], s4 offen lds

    s_add_u32 m0, s29, 68608
    s_add_u32 s4, s28, 2195456
    buffer_load_dwordx4 v11, s[12:15], s4 offen lds

    s_add_u32 m0, s29, 69632
    s_add_u32 s4, s28, 2228224
    buffer_load_dwordx4 v10, s[12:15], s4 offen lds

    s_add_u32 m0, s29, 70656
    s_add_u32 s4, s28, 2260992
    buffer_load_dwordx4 v10, s[12:15], s4 offen lds

    s_add_u32 m0, s29, 71680
    s_add_u32 s4, s28, 2293760
    buffer_load_dwordx4 v11, s[12:15], s4 offen lds

    s_add_u32 m0, s29, 72704
    s_add_u32 s4, s28, 2326528
    buffer_load_dwordx4 v11, s[12:15], s4 offen lds

    s_waitcnt vmcnt(16)
    s_barrier
    ds_read_b64_tr_b16 a[0:1], v14 offset:32768
    ds_read_b64_tr_b16 a[2:3], v14 offset:33792
    ds_read_b64_tr_b16 a[4:5], v15 offset:32768
    ds_read_b64_tr_b16 a[6:7], v15 offset:33792
    ds_read_b64_tr_b16 a[8:9], v14 offset:40960
    ds_read_b64_tr_b16 a[10:11], v14 offset:41984
    ds_read_b64_tr_b16 a[12:13], v15 offset:40960
    ds_read_b64_tr_b16 a[14:15], v15 offset:41984
    ds_read_b64_tr_b16 a[16:17], v14 offset:49152
    ds_read_b64_tr_b16 a[18:19], v14 offset:50176
    ds_read_b64_tr_b16 a[20:21], v15 offset:49152
    ds_read_b64_tr_b16 a[22:23], v15 offset:50176
    ds_read_b64_tr_b16 a[24:25], v14 offset:57344
    ds_read_b64_tr_b16 a[26:27], v14 offset:58368
    ds_read_b64_tr_b16 a[28:29], v15 offset:57344
    ds_read_b64_tr_b16 a[30:31], v15 offset:58368
    ds_read_b128 v[32:35], v113 offset:0
    ds_read_b128 v[36:39], v113 offset:16384
    ds_read_b128 v[40:43], v114 offset:0
    ds_read_b128 v[44:47], v114 offset:16384
    ds_read_b128 v[48:51], v113 offset:1024
    ds_read_b128 v[52:55], v113 offset:17408
    ds_read_b128 v[56:59], v114 offset:1024
    ds_read_b128 v[60:63], v114 offset:17408
    s_waitcnt lgkmcnt(0)
    s_barrier
    s_add_u32 m0, s29, 98304
    s_add_u32 s4, s28, 3145728
    buffer_load_dwordx4 v10, s[12:15], s4 offen lds

    s_add_u32 m0, s29, 99328
    s_add_u32 s4, s28, 3178496
    buffer_load_dwordx4 v10, s[12:15], s4 offen lds

    s_add_u32 m0, s29, 100352
    s_add_u32 s4, s28, 3211264
    buffer_load_dwordx4 v11, s[12:15], s4 offen lds

    s_add_u32 m0, s29, 101376
    s_add_u32 s4, s28, 3244032
    buffer_load_dwordx4 v11, s[12:15], s4 offen lds

    s_add_u32 m0, s29, 102400
    s_add_u32 s4, s28, 3276800
    buffer_load_dwordx4 v10, s[12:15], s4 offen lds

    s_add_u32 m0, s29, 103424
    s_add_u32 s4, s28, 3309568
    buffer_load_dwordx4 v10, s[12:15], s4 offen lds

    s_add_u32 m0, s29, 104448
    s_add_u32 s4, s28, 3342336
    buffer_load_dwordx4 v11, s[12:15], s4 offen lds

    s_add_u32 m0, s29, 105472
    s_add_u32 s4, s28, 3375104
    buffer_load_dwordx4 v11, s[12:15], s4 offen lds

    s_add_u32 m0, s29, 32768
    s_nop 0
    buffer_load_dwordx4 v16, s[16:19], s34 offen offset:0 lds
    s_add_u32 m0, s29, 33664
    s_nop 0
    buffer_load_dwordx4 v16, s[16:19], s34 offen offset:128 lds
    s_add_u32 m0, s29, 34560
    s_nop 0
    buffer_load_dwordx4 v16, s[16:19], s34 offen offset:256 lds
    s_add_u32 m0, s29, 35456
    s_nop 0
    buffer_load_dwordx4 v16, s[16:19], s34 offen offset:384 lds
    s_add_u32 m0, s29, 36352
    s_nop 0
    buffer_load_dwordx4 v16, s[16:19], s34 offen offset:512 lds
    s_add_u32 m0, s29, 37248
    s_nop 0
    buffer_load_dwordx4 v16, s[16:19], s34 offen offset:640 lds
    s_add_u32 m0, s29, 38144
    s_nop 0
    buffer_load_dwordx4 v16, s[16:19], s34 offen offset:768 lds
    s_add_u32 m0, s29, 39040
    s_nop 0
    buffer_load_dwordx4 v16, s[16:19], s34 offen offset:896 lds
    s_add_u32 s34, s34, 64512
    s_min_u32 s34, s34, 4128768
    s_cmp_eq_u32 s30, 2
    s_cbranch_scc1 .s0v_377
    v_mfma_f32_16x16x32_bf16 v[64:67], a[0:3], v[32:35], 0
    v_mfma_f32_16x16x32_bf16 v[68:71], a[4:7], v[32:35], 0
    v_mfma_f32_16x16x32_bf16 v[72:75], a[0:3], v[36:39], 0
    v_mfma_f32_16x16x32_bf16 v[76:79], a[4:7], v[36:39], 0
    v_mfma_f32_16x16x32_bf16 v[64:67], a[8:11], v[40:43], v[64:67]
    v_mfma_f32_16x16x32_bf16 v[68:71], a[12:15], v[40:43], v[68:71]
    v_mfma_f32_16x16x32_bf16 v[72:75], a[8:11], v[44:47], v[72:75]
    v_mfma_f32_16x16x32_bf16 v[76:79], a[12:15], v[44:47], v[76:79]
    v_mfma_f32_16x16x32_bf16 v[64:67], a[16:19], v[48:51], v[64:67]
    v_mfma_f32_16x16x32_bf16 v[68:71], a[20:23], v[48:51], v[68:71]
    v_mfma_f32_16x16x32_bf16 v[72:75], a[16:19], v[52:55], v[72:75]
    v_mfma_f32_16x16x32_bf16 v[76:79], a[20:23], v[52:55], v[76:79]
    v_mfma_f32_16x16x32_bf16 v[64:67], a[24:27], v[56:59], v[64:67]
    v_mfma_f32_16x16x32_bf16 v[68:71], a[28:31], v[56:59], v[68:71]
    v_mfma_f32_16x16x32_bf16 v[72:75], a[24:27], v[60:63], v[72:75]
    v_mfma_f32_16x16x32_bf16 v[76:79], a[28:31], v[60:63], v[76:79]
    s_branch .s0j_378
.s0v_377:
    v_mfma_f32_16x16x32_bf16 v[64:67], v[32:35], a[0:3], 0
    v_mfma_f32_16x16x32_bf16 v[68:71], v[32:35], a[4:7], 0
    v_mfma_f32_16x16x32_bf16 v[72:75], v[36:39], a[0:3], 0
    v_mfma_f32_16x16x32_bf16 v[76:79], v[36:39], a[4:7], 0
    v_mfma_f32_16x16x32_bf16 v[64:67], v[40:43], a[8:11], v[64:67]
    v_mfma_f32_16x16x32_bf16 v[68:71], v[40:43], a[12:15], v[68:71]
    v_mfma_f32_16x16x32_bf16 v[72:75], v[44:47], a[8:11], v[72:75]
    v_mfma_f32_16x16x32_bf16 v[76:79], v[44:47], a[12:15], v[76:79]
    v_mfma_f32_16x16x32_bf16 v[64:67], v[48:51], a[16:19], v[64:67]
    v_mfma_f32_16x16x32_bf16 v[68:71], v[48:51], a[20:23], v[68:71]
    v_mfma_f32_16x16x32_bf16 v[72:75], v[52:55], a[16:19], v[72:75]
    v_mfma_f32_16x16x32_bf16 v[76:79], v[52:55], a[20:23], v[76:79]
    v_mfma_f32_16x16x32_bf16 v[64:67], v[56:59], a[24:27], v[64:67]
    v_mfma_f32_16x16x32_bf16 v[68:71], v[56:59], a[28:31], v[68:71]
    v_mfma_f32_16x16x32_bf16 v[72:75], v[60:63], a[24:27], v[72:75]
    v_mfma_f32_16x16x32_bf16 v[76:79], v[60:63], a[28:31], v[76:79]
.s0j_378:
    s_waitcnt vmcnt(24)
    s_barrier
    ds_read_b64_tr_b16 a[32:33], v12 offset:0
    ds_read_b64_tr_b16 a[34:35], v12 offset:1024
    ds_read_b64_tr_b16 a[36:37], v13 offset:0
    ds_read_b64_tr_b16 a[38:39], v13 offset:1024
    ds_read_b64_tr_b16 a[40:41], v12 offset:8192
    ds_read_b64_tr_b16 a[42:43], v12 offset:9216
    ds_read_b64_tr_b16 a[44:45], v13 offset:8192
    ds_read_b64_tr_b16 a[46:47], v13 offset:9216
    ds_read_b64_tr_b16 a[48:49], v12 offset:16384
    ds_read_b64_tr_b16 a[50:51], v12 offset:17408
    ds_read_b64_tr_b16 a[52:53], v13 offset:16384
    ds_read_b64_tr_b16 a[54:55], v13 offset:17408
    ds_read_b64_tr_b16 a[56:57], v12 offset:24576
    ds_read_b64_tr_b16 a[58:59], v12 offset:25600
    ds_read_b64_tr_b16 a[60:61], v13 offset:24576
    ds_read_b64_tr_b16 a[62:63], v13 offset:25600
    ds_read_b128 v[32:35], v113 offset:2048
    ds_read_b128 v[36:39], v113 offset:18432
    ds_read_b128 v[40:43], v114 offset:2048
    ds_read_b128 v[44:47], v114 offset:18432
    ds_read_b128 v[48:51], v113 offset:3072
    ds_read_b128 v[52:55], v113 offset:19456
    ds_read_b128 v[56:59], v114 offset:3072
    ds_read_b128 v[60:63], v114 offset:19456
    s_waitcnt lgkmcnt(0)
    s_barrier
    s_add_u32 m0, s29, 0
    s_add_u32 s4, s28, 4194304
    buffer_load_dwordx4 v10, s[12:15], s4 offen lds

    s_add_u32 m0, s29, 1024
    s_add_u32 s4, s28, 4227072
    buffer_load_dwordx4 v10, s[12:15], s4 offen lds

    s_add_u32 m0, s29, 2048
    s_add_u32 s4, s28, 4259840
    buffer_load_dwordx4 v11, s[12:15], s4 offen lds

    s_add_u32 m0, s29, 3072
    s_add_u32 s4, s28, 4292608
    buffer_load_dwordx4 v11, s[12:15], s4 offen lds

    s_add_u32 m0, s29, 4096
    s_add_u32 s4, s28, 4325376
    buffer_load_dwordx4 v10, s[12:15], s4 offen lds

    s_add_u32 m0, s29, 5120
    s_add_u32 s4, s28, 4358144
    buffer_load_dwordx4 v10, s[12:15], s4 offen lds

    s_add_u32 m0, s29, 6144
    s_add_u32 s4, s28, 4390912
    buffer_load_dwordx4 v11, s[12:15], s4 offen lds

    s_add_u32 m0, s29, 7168
    s_add_u32 s4, s28, 4423680
    buffer_load_dwordx4 v11, s[12:15], s4 offen lds

    s_cmp_eq_u32 s30, 2
    s_cbranch_scc1 .s0v_379
    v_mfma_f32_16x16x32_bf16 v[64:67], a[32:35], v[32:35], v[64:67]
    v_mfma_f32_16x16x32_bf16 v[68:71], a[36:39], v[32:35], v[68:71]
    v_mfma_f32_16x16x32_bf16 v[72:75], a[32:35], v[36:39], v[72:75]
    v_mfma_f32_16x16x32_bf16 v[76:79], a[36:39], v[36:39], v[76:79]
    v_mfma_f32_16x16x32_bf16 v[64:67], a[40:43], v[40:43], v[64:67]
    v_mfma_f32_16x16x32_bf16 v[68:71], a[44:47], v[40:43], v[68:71]
    v_mfma_f32_16x16x32_bf16 v[72:75], a[40:43], v[44:47], v[72:75]
    v_mfma_f32_16x16x32_bf16 v[76:79], a[44:47], v[44:47], v[76:79]
    v_mfma_f32_16x16x32_bf16 v[64:67], a[48:51], v[48:51], v[64:67]
    v_mfma_f32_16x16x32_bf16 v[68:71], a[52:55], v[48:51], v[68:71]
    v_mfma_f32_16x16x32_bf16 v[72:75], a[48:51], v[52:55], v[72:75]
    v_mfma_f32_16x16x32_bf16 v[76:79], a[52:55], v[52:55], v[76:79]
    v_mfma_f32_16x16x32_bf16 v[64:67], a[56:59], v[56:59], v[64:67]
    v_mfma_f32_16x16x32_bf16 v[68:71], a[60:63], v[56:59], v[68:71]
    v_mfma_f32_16x16x32_bf16 v[72:75], a[56:59], v[60:63], v[72:75]
    v_mfma_f32_16x16x32_bf16 v[76:79], a[60:63], v[60:63], v[76:79]
    s_branch .s0j_380
.s0v_379:
    v_mfma_f32_16x16x32_bf16 v[64:67], v[32:35], a[32:35], v[64:67]
    v_mfma_f32_16x16x32_bf16 v[68:71], v[32:35], a[36:39], v[68:71]
    v_mfma_f32_16x16x32_bf16 v[72:75], v[36:39], a[32:35], v[72:75]
    v_mfma_f32_16x16x32_bf16 v[76:79], v[36:39], a[36:39], v[76:79]
    v_mfma_f32_16x16x32_bf16 v[64:67], v[40:43], a[40:43], v[64:67]
    v_mfma_f32_16x16x32_bf16 v[68:71], v[40:43], a[44:47], v[68:71]
    v_mfma_f32_16x16x32_bf16 v[72:75], v[44:47], a[40:43], v[72:75]
    v_mfma_f32_16x16x32_bf16 v[76:79], v[44:47], a[44:47], v[76:79]
    v_mfma_f32_16x16x32_bf16 v[64:67], v[48:51], a[48:51], v[64:67]
    v_mfma_f32_16x16x32_bf16 v[68:71], v[48:51], a[52:55], v[68:71]
    v_mfma_f32_16x16x32_bf16 v[72:75], v[52:55], a[48:51], v[72:75]
    v_mfma_f32_16x16x32_bf16 v[76:79], v[52:55], a[52:55], v[76:79]
    v_mfma_f32_16x16x32_bf16 v[64:67], v[56:59], a[56:59], v[64:67]
    v_mfma_f32_16x16x32_bf16 v[68:71], v[56:59], a[60:63], v[68:71]
    v_mfma_f32_16x16x32_bf16 v[72:75], v[60:63], a[56:59], v[72:75]
    v_mfma_f32_16x16x32_bf16 v[76:79], v[60:63], a[60:63], v[76:79]
.s0j_380:
    s_waitcnt vmcnt(24)
    s_barrier
    ds_read_b64_tr_b16 a[64:65], v14 offset:0
    ds_read_b64_tr_b16 a[66:67], v14 offset:1024
    ds_read_b64_tr_b16 a[68:69], v15 offset:0
    ds_read_b64_tr_b16 a[70:71], v15 offset:1024
    ds_read_b64_tr_b16 a[72:73], v14 offset:8192
    ds_read_b64_tr_b16 a[74:75], v14 offset:9216
    ds_read_b64_tr_b16 a[76:77], v15 offset:8192
    ds_read_b64_tr_b16 a[78:79], v15 offset:9216
    ds_read_b64_tr_b16 a[80:81], v14 offset:16384
    ds_read_b64_tr_b16 a[82:83], v14 offset:17408
    ds_read_b64_tr_b16 a[84:85], v15 offset:16384
    ds_read_b64_tr_b16 a[86:87], v15 offset:17408
    ds_read_b64_tr_b16 a[88:89], v14 offset:24576
    ds_read_b64_tr_b16 a[90:91], v14 offset:25600
    ds_read_b64_tr_b16 a[92:93], v15 offset:24576
    ds_read_b64_tr_b16 a[94:95], v15 offset:25600
    ds_read_b128 v[32:35], v113 offset:4096
    ds_read_b128 v[36:39], v113 offset:20480
    ds_read_b128 v[40:43], v114 offset:4096
    ds_read_b128 v[44:47], v114 offset:20480
    ds_read_b128 v[48:51], v113 offset:5120
    ds_read_b128 v[52:55], v113 offset:21504
    ds_read_b128 v[56:59], v114 offset:5120
    ds_read_b128 v[60:63], v114 offset:21504
    s_waitcnt lgkmcnt(0)
    s_barrier
    s_add_u32 m0, s29, 65536
    s_add_u32 s4, s28, 5242880
    buffer_load_dwordx4 v10, s[12:15], s4 offen lds

    s_add_u32 m0, s29, 66560
    s_add_u32 s4, s28, 5275648
    buffer_load_dwordx4 v10, s[12:15], s4 offen lds

    s_add_u32 m0, s29, 67584
    s_add_u32 s4, s28, 5308416
    buffer_load_dwordx4 v11, s[12:15], s4 offen lds

    s_add_u32 m0, s29, 68608
    s_add_u32 s4, s28, 5341184
    buffer_load_dwordx4 v11, s[12:15], s4 offen lds

    s_add_u32 m0, s29, 69632
    s_add_u32 s4, s28, 5373952
    buffer_load_dwordx4 v10, s[12:15], s4 offen lds

    s_add_u32 m0, s29, 70656
    s_add_u32 s4, s28, 5406720
    buffer_load_dwordx4 v10, s[12:15], s4 offen lds

    s_add_u32 m0, s29, 71680
    s_add_u32 s4, s28, 5439488
    buffer_load_dwordx4 v11, s[12:15], s4 offen lds

    s_add_u32 m0, s29, 72704
    s_add_u32 s4, s28, 5472256
    buffer_load_dwordx4 v11, s[12:15], s4 offen lds

    s_cmp_eq_u32 s30, 2
    s_cbranch_scc1 .s0v_381
    v_mfma_f32_16x16x32_bf16 v[64:67], a[64:67], v[32:35], v[64:67]
    v_mfma_f32_16x16x32_bf16 v[68:71], a[68:71], v[32:35], v[68:71]
    v_mfma_f32_16x16x32_bf16 v[72:75], a[64:67], v[36:39], v[72:75]
    v_mfma_f32_16x16x32_bf16 v[76:79], a[68:71], v[36:39], v[76:79]
    v_mfma_f32_16x16x32_bf16 v[64:67], a[72:75], v[40:43], v[64:67]
    v_mfma_f32_16x16x32_bf16 v[68:71], a[76:79], v[40:43], v[68:71]
    v_mfma_f32_16x16x32_bf16 v[72:75], a[72:75], v[44:47], v[72:75]
    v_mfma_f32_16x16x32_bf16 v[76:79], a[76:79], v[44:47], v[76:79]
    v_mfma_f32_16x16x32_bf16 v[64:67], a[80:83], v[48:51], v[64:67]
    v_mfma_f32_16x16x32_bf16 v[68:71], a[84:87], v[48:51], v[68:71]
    v_mfma_f32_16x16x32_bf16 v[72:75], a[80:83], v[52:55], v[72:75]
    v_mfma_f32_16x16x32_bf16 v[76:79], a[84:87], v[52:55], v[76:79]
    v_mfma_f32_16x16x32_bf16 v[64:67], a[88:91], v[56:59], v[64:67]
    v_mfma_f32_16x16x32_bf16 v[68:71], a[92:95], v[56:59], v[68:71]
    v_mfma_f32_16x16x32_bf16 v[72:75], a[88:91], v[60:63], v[72:75]
    v_mfma_f32_16x16x32_bf16 v[76:79], a[92:95], v[60:63], v[76:79]
    s_branch .s0j_382
.s0v_381:
    v_mfma_f32_16x16x32_bf16 v[64:67], v[32:35], a[64:67], v[64:67]
    v_mfma_f32_16x16x32_bf16 v[68:71], v[32:35], a[68:71], v[68:71]
    v_mfma_f32_16x16x32_bf16 v[72:75], v[36:39], a[64:67], v[72:75]
    v_mfma_f32_16x16x32_bf16 v[76:79], v[36:39], a[68:71], v[76:79]
    v_mfma_f32_16x16x32_bf16 v[64:67], v[40:43], a[72:75], v[64:67]
    v_mfma_f32_16x16x32_bf16 v[68:71], v[40:43], a[76:79], v[68:71]
    v_mfma_f32_16x16x32_bf16 v[72:75], v[44:47], a[72:75], v[72:75]
    v_mfma_f32_16x16x32_bf16 v[76:79], v[44:47], a[76:79], v[76:79]
    v_mfma_f32_16x16x32_bf16 v[64:67], v[48:51], a[80:83], v[64:67]
    v_mfma_f32_16x16x32_bf16 v[68:71], v[48:51], a[84:87], v[68:71]
    v_mfma_f32_16x16x32_bf16 v[72:75], v[52:55], a[80:83], v[72:75]
    v_mfma_f32_16x16x32_bf16 v[76:79], v[52:55], a[84:87], v[76:79]
    v_mfma_f32_16x16x32_bf16 v[64:67], v[56:59], a[88:91], v[64:67]
    v_mfma_f32_16x16x32_bf16 v[68:71], v[56:59], a[92:95], v[68:71]
    v_mfma_f32_16x16x32_bf16 v[72:75], v[60:63], a[88:91], v[72:75]
    v_mfma_f32_16x16x32_bf16 v[76:79], v[60:63], a[92:95], v[76:79]
.s0j_382:
    s_waitcnt vmcnt(24)
    s_barrier
    ds_read_b64_tr_b16 a[96:97], v14 offset:32768
    ds_read_b64_tr_b16 a[98:99], v14 offset:33792
    ds_read_b64_tr_b16 a[100:101], v15 offset:32768
    ds_read_b64_tr_b16 a[102:103], v15 offset:33792
    ds_read_b64_tr_b16 a[104:105], v14 offset:40960
    ds_read_b64_tr_b16 a[106:107], v14 offset:41984
    ds_read_b64_tr_b16 a[108:109], v15 offset:40960
    ds_read_b64_tr_b16 a[110:111], v15 offset:41984
    ds_read_b64_tr_b16 a[112:113], v14 offset:49152
    ds_read_b64_tr_b16 a[114:115], v14 offset:50176
    ds_read_b64_tr_b16 a[116:117], v15 offset:49152
    ds_read_b64_tr_b16 a[118:119], v15 offset:50176
    ds_read_b64_tr_b16 a[120:121], v14 offset:57344
    ds_read_b64_tr_b16 a[122:123], v14 offset:58368
    ds_read_b64_tr_b16 a[124:125], v15 offset:57344
    ds_read_b64_tr_b16 a[126:127], v15 offset:58368
    ds_read_b128 v[32:35], v113 offset:6144
    ds_read_b128 v[36:39], v113 offset:22528
    ds_read_b128 v[40:43], v114 offset:6144
    ds_read_b128 v[44:47], v114 offset:22528
    ds_read_b128 v[48:51], v113 offset:7168
    ds_read_b128 v[52:55], v113 offset:23552
    ds_read_b128 v[56:59], v114 offset:7168
    ds_read_b128 v[60:63], v114 offset:23552
    s_waitcnt lgkmcnt(0)
    s_barrier
    s_add_u32 m0, s29, 98304
    s_add_u32 s4, s28, 6291456
    buffer_load_dwordx4 v10, s[12:15], s4 offen lds

    s_add_u32 m0, s29, 99328
    s_add_u32 s4, s28, 6324224
    buffer_load_dwordx4 v10, s[12:15], s4 offen lds

    s_add_u32 m0, s29, 100352
    s_add_u32 s4, s28, 6356992
    buffer_load_dwordx4 v11, s[12:15], s4 offen lds

    s_add_u32 m0, s29, 101376
    s_add_u32 s4, s28, 6389760
    buffer_load_dwordx4 v11, s[12:15], s4 offen lds

    s_add_u32 m0, s29, 102400
    s_add_u32 s4, s28, 6422528
    buffer_load_dwordx4 v10, s[12:15], s4 offen lds

    s_add_u32 m0, s29, 103424
    s_add_u32 s4, s28, 6455296
    buffer_load_dwordx4 v10, s[12:15], s4 offen lds

    s_add_u32 m0, s29, 104448
    s_add_u32 s4, s28, 6488064
    buffer_load_dwordx4 v11, s[12:15], s4 offen lds

    s_add_u32 m0, s29, 105472
    s_add_u32 s4, s28, 6520832
    buffer_load_dwordx4 v11, s[12:15], s4 offen lds

    v_and_b32 v241, 3, v0
    v_lshlrev_b32 v241, 2, v241

    v_and_b32 v240, 12, v0
    v_lshl_add_u32 v241, v240, 4, v241
    v_add_u32 v241, s97, v241
    v_and_b32 v241, 255, v241

    buffer_load_dword v240, v241, s[20:23], 0 offen sc1
    s_cmp_eq_u32 s30, 2
    s_cbranch_scc1 .s0v_383
    v_mfma_f32_16x16x32_bf16 v[64:67], a[96:99], v[32:35], v[64:67]
    v_mfma_f32_16x16x32_bf16 v[68:71], a[100:103], v[32:35], v[68:71]
    v_mfma_f32_16x16x32_bf16 v[72:75], a[96:99], v[36:39], v[72:75]
    v_mfma_f32_16x16x32_bf16 v[76:79], a[100:103], v[36:39], v[76:79]
    v_mfma_f32_16x16x32_bf16 v[64:67], a[104:107], v[40:43], v[64:67]
    v_mfma_f32_16x16x32_bf16 v[68:71], a[108:111], v[40:43], v[68:71]
    v_mfma_f32_16x16x32_bf16 v[72:75], a[104:107], v[44:47], v[72:75]
    v_mfma_f32_16x16x32_bf16 v[76:79], a[108:111], v[44:47], v[76:79]
    v_mfma_f32_16x16x32_bf16 v[64:67], a[112:115], v[48:51], v[64:67]
    v_mfma_f32_16x16x32_bf16 v[68:71], a[116:119], v[48:51], v[68:71]
    v_mfma_f32_16x16x32_bf16 v[72:75], a[112:115], v[52:55], v[72:75]
    v_mfma_f32_16x16x32_bf16 v[76:79], a[116:119], v[52:55], v[76:79]
    v_mfma_f32_16x16x32_bf16 v[64:67], a[120:123], v[56:59], v[64:67]
    v_mfma_f32_16x16x32_bf16 v[68:71], a[124:127], v[56:59], v[68:71]
    v_mfma_f32_16x16x32_bf16 v[72:75], a[120:123], v[60:63], v[72:75]
    v_mfma_f32_16x16x32_bf16 v[76:79], a[124:127], v[60:63], v[76:79]
    s_branch .s0j_384
.s0v_383:
    v_mfma_f32_16x16x32_bf16 v[64:67], v[32:35], a[96:99], v[64:67]
    v_mfma_f32_16x16x32_bf16 v[68:71], v[32:35], a[100:103], v[68:71]
    v_mfma_f32_16x16x32_bf16 v[72:75], v[36:39], a[96:99], v[72:75]
    v_mfma_f32_16x16x32_bf16 v[76:79], v[36:39], a[100:103], v[76:79]
    v_mfma_f32_16x16x32_bf16 v[64:67], v[40:43], a[104:107], v[64:67]
    v_mfma_f32_16x16x32_bf16 v[68:71], v[40:43], a[108:111], v[68:71]
    v_mfma_f32_16x16x32_bf16 v[72:75], v[44:47], a[104:107], v[72:75]
    v_mfma_f32_16x16x32_bf16 v[76:79], v[44:47], a[108:111], v[76:79]
    v_mfma_f32_16x16x32_bf16 v[64:67], v[48:51], a[112:115], v[64:67]
    v_mfma_f32_16x16x32_bf16 v[68:71], v[48:51], a[116:119], v[68:71]
    v_mfma_f32_16x16x32_bf16 v[72:75], v[52:55], a[112:115], v[72:75]
    v_mfma_f32_16x16x32_bf16 v[76:79], v[52:55], a[116:119], v[76:79]
    v_mfma_f32_16x16x32_bf16 v[64:67], v[56:59], a[120:123], v[64:67]
    v_mfma_f32_16x16x32_bf16 v[68:71], v[56:59], a[124:127], v[68:71]
    v_mfma_f32_16x16x32_bf16 v[72:75], v[60:63], a[120:123], v[72:75]
    v_mfma_f32_16x16x32_bf16 v[76:79], v[60:63], a[124:127], v[76:79]
.s0j_384:
    s_waitcnt vmcnt(17)
    s_barrier
    ds_read_b64_tr_b16 a[128:129], v12 offset:0
    ds_read_b64_tr_b16 a[130:131], v12 offset:1024
    ds_read_b64_tr_b16 a[132:133], v13 offset:0
    ds_read_b64_tr_b16 a[134:135], v13 offset:1024
    ds_read_b64_tr_b16 a[136:137], v12 offset:8192
    ds_read_b64_tr_b16 a[138:139], v12 offset:9216
    ds_read_b64_tr_b16 a[140:141], v13 offset:8192
    ds_read_b64_tr_b16 a[142:143], v13 offset:9216
    ds_read_b64_tr_b16 a[144:145], v12 offset:16384
    ds_read_b64_tr_b16 a[146:147], v12 offset:17408
    ds_read_b64_tr_b16 a[148:149], v13 offset:16384
    ds_read_b64_tr_b16 a[150:151], v13 offset:17408
    ds_read_b64_tr_b16 a[152:153], v12 offset:24576
    ds_read_b64_tr_b16 a[154:155], v12 offset:25600
    ds_read_b64_tr_b16 a[156:157], v13 offset:24576
    ds_read_b64_tr_b16 a[158:159], v13 offset:25600
    ds_read_b128 v[32:35], v17 offset:32768
    ds_read_b128 v[36:39], v17 offset:49152
    ds_read_b128 v[40:43], v18 offset:32768
    ds_read_b128 v[44:47], v18 offset:49152
    ds_read_b128 v[48:51], v17 offset:33792
    ds_read_b128 v[52:55], v17 offset:50176
    ds_read_b128 v[56:59], v18 offset:33792
    ds_read_b128 v[60:63], v18 offset:50176
    s_waitcnt lgkmcnt(0)
    s_barrier
    s_add_u32 m0, s29, 0
    s_add_u32 s4, s28, 7340032
    buffer_load_dwordx4 v10, s[12:15], s4 offen lds

    s_add_u32 m0, s29, 1024
    s_add_u32 s4, s28, 7372800
    buffer_load_dwordx4 v10, s[12:15], s4 offen lds

    s_add_u32 m0, s29, 2048
    s_add_u32 s4, s28, 7405568
    buffer_load_dwordx4 v11, s[12:15], s4 offen lds

    s_add_u32 m0, s29, 3072
    s_add_u32 s4, s28, 7438336
    buffer_load_dwordx4 v11, s[12:15], s4 offen lds

    s_add_u32 m0, s29, 4096
    s_add_u32 s4, s28, 7471104
    buffer_load_dwordx4 v10, s[12:15], s4 offen lds

    s_add_u32 m0, s29, 5120
    s_add_u32 s4, s28, 7503872
    buffer_load_dwordx4 v10, s[12:15], s4 offen lds

    s_add_u32 m0, s29, 6144
    s_add_u32 s4, s28, 7536640
    buffer_load_dwordx4 v11, s[12:15], s4 offen lds

    s_add_u32 m0, s29, 7168
    s_add_u32 s4, s28, 7569408
    buffer_load_dwordx4 v11, s[12:15], s4 offen lds

    s_cmp_eq_u32 s30, 2
    s_cbranch_scc1 .s0v_385
    v_mfma_f32_16x16x32_bf16 v[64:67], a[128:131], v[32:35], v[64:67]
    v_mfma_f32_16x16x32_bf16 v[68:71], a[132:135], v[32:35], v[68:71]
    v_mfma_f32_16x16x32_bf16 v[72:75], a[128:131], v[36:39], v[72:75]
    v_mfma_f32_16x16x32_bf16 v[76:79], a[132:135], v[36:39], v[76:79]
    v_mfma_f32_16x16x32_bf16 v[64:67], a[136:139], v[40:43], v[64:67]
    v_mfma_f32_16x16x32_bf16 v[68:71], a[140:143], v[40:43], v[68:71]
    v_mfma_f32_16x16x32_bf16 v[72:75], a[136:139], v[44:47], v[72:75]
    v_mfma_f32_16x16x32_bf16 v[76:79], a[140:143], v[44:47], v[76:79]
    v_mfma_f32_16x16x32_bf16 v[64:67], a[144:147], v[48:51], v[64:67]
    v_mfma_f32_16x16x32_bf16 v[68:71], a[148:151], v[48:51], v[68:71]
    v_mfma_f32_16x16x32_bf16 v[72:75], a[144:147], v[52:55], v[72:75]
    v_mfma_f32_16x16x32_bf16 v[76:79], a[148:151], v[52:55], v[76:79]
    v_mfma_f32_16x16x32_bf16 v[64:67], a[152:155], v[56:59], v[64:67]
    v_mfma_f32_16x16x32_bf16 v[68:71], a[156:159], v[56:59], v[68:71]
    v_mfma_f32_16x16x32_bf16 v[72:75], a[152:155], v[60:63], v[72:75]
    v_mfma_f32_16x16x32_bf16 v[76:79], a[156:159], v[60:63], v[76:79]
    s_branch .s0j_386
.s0v_385:
    v_mfma_f32_16x16x32_bf16 v[64:67], v[32:35], a[128:131], v[64:67]
    v_mfma_f32_16x16x32_bf16 v[68:71], v[32:35], a[132:135], v[68:71]
    v_mfma_f32_16x16x32_bf16 v[72:75], v[36:39], a[128:131], v[72:75]
    v_mfma_f32_16x16x32_bf16 v[76:79], v[36:39], a[132:135], v[76:79]
    v_mfma_f32_16x16x32_bf16 v[64:67], v[40:43], a[136:139], v[64:67]
    v_mfma_f32_16x16x32_bf16 v[68:71], v[40:43], a[140:143], v[68:71]
    v_mfma_f32_16x16x32_bf16 v[72:75], v[44:47], a[136:139], v[72:75]
    v_mfma_f32_16x16x32_bf16 v[76:79], v[44:47], a[140:143], v[76:79]
    v_mfma_f32_16x16x32_bf16 v[64:67], v[48:51], a[144:147], v[64:67]
    v_mfma_f32_16x16x32_bf16 v[68:71], v[48:51], a[148:151], v[68:71]
    v_mfma_f32_16x16x32_bf16 v[72:75], v[52:55], a[144:147], v[72:75]
    v_mfma_f32_16x16x32_bf16 v[76:79], v[52:55], a[148:151], v[76:79]
    v_mfma_f32_16x16x32_bf16 v[64:67], v[56:59], a[152:155], v[64:67]
    v_mfma_f32_16x16x32_bf16 v[68:71], v[56:59], a[156:159], v[68:71]
    v_mfma_f32_16x16x32_bf16 v[72:75], v[60:63], a[152:155], v[72:75]
    v_mfma_f32_16x16x32_bf16 v[76:79], v[60:63], a[156:159], v[76:79]
.s0j_386:
    s_waitcnt vmcnt(17)
    s_barrier
    ds_read_b64_tr_b16 a[160:161], v14 offset:0
    ds_read_b64_tr_b16 a[162:163], v14 offset:1024
    ds_read_b64_tr_b16 a[164:165], v15 offset:0
    ds_read_b64_tr_b16 a[166:167], v15 offset:1024
    ds_read_b64_tr_b16 a[168:169], v14 offset:8192
    ds_read_b64_tr_b16 a[170:171], v14 offset:9216
    ds_read_b64_tr_b16 a[172:173], v15 offset:8192
    ds_read_b64_tr_b16 a[174:175], v15 offset:9216
    ds_read_b64_tr_b16 a[176:177], v14 offset:16384
    ds_read_b64_tr_b16 a[178:179], v14 offset:17408
    ds_read_b64_tr_b16 a[180:181], v15 offset:16384
    ds_read_b64_tr_b16 a[182:183], v15 offset:17408
    ds_read_b64_tr_b16 a[184:185], v14 offset:24576
    ds_read_b64_tr_b16 a[186:187], v14 offset:25600
    ds_read_b64_tr_b16 a[188:189], v15 offset:24576
    ds_read_b64_tr_b16 a[190:191], v15 offset:25600
    ds_read_b128 v[32:35], v17 offset:34816
    ds_read_b128 v[36:39], v17 offset:51200
    ds_read_b128 v[40:43], v18 offset:34816
    ds_read_b128 v[44:47], v18 offset:51200
    ds_read_b128 v[48:51], v17 offset:35840
    ds_read_b128 v[52:55], v17 offset:52224
    ds_read_b128 v[56:59], v18 offset:35840
    ds_read_b128 v[60:63], v18 offset:52224
    s_waitcnt lgkmcnt(0)
    s_barrier
    s_add_u32 m0, s29, 65536
    s_nop 0
    buffer_load_dwordx4 v16, s[16:19], s34 offen offset:0 lds
    s_add_u32 m0, s29, 66432
    s_nop 0
    buffer_load_dwordx4 v16, s[16:19], s34 offen offset:128 lds
    s_add_u32 m0, s29, 67328
    s_nop 0
    buffer_load_dwordx4 v16, s[16:19], s34 offen offset:256 lds
    s_add_u32 m0, s29, 68224
    s_nop 0
    buffer_load_dwordx4 v16, s[16:19], s34 offen offset:384 lds
    s_add_u32 m0, s29, 69120
    s_nop 0
    buffer_load_dwordx4 v16, s[16:19], s34 offen offset:512 lds
    s_add_u32 m0, s29, 70016
    s_nop 0
    buffer_load_dwordx4 v16, s[16:19], s34 offen offset:640 lds
    s_add_u32 m0, s29, 70912
    s_nop 0
    buffer_load_dwordx4 v16, s[16:19], s34 offen offset:768 lds
    s_add_u32 m0, s29, 71808
    s_nop 0
    buffer_load_dwordx4 v16, s[16:19], s34 offen offset:896 lds
    s_add_u32 s34, s34, 1024
    s_cmp_eq_u32 s30, 2
    s_cbranch_scc1 .s0v_387
    v_mfma_f32_16x16x32_bf16 v[64:67], a[160:163], v[32:35], v[64:67]
    v_mfma_f32_16x16x32_bf16 v[68:71], a[164:167], v[32:35], v[68:71]
    v_mfma_f32_16x16x32_bf16 v[72:75], a[160:163], v[36:39], v[72:75]
    v_mfma_f32_16x16x32_bf16 v[76:79], a[164:167], v[36:39], v[76:79]
    v_mfma_f32_16x16x32_bf16 v[64:67], a[168:171], v[40:43], v[64:67]
    v_mfma_f32_16x16x32_bf16 v[68:71], a[172:175], v[40:43], v[68:71]
    v_mfma_f32_16x16x32_bf16 v[72:75], a[168:171], v[44:47], v[72:75]
    v_mfma_f32_16x16x32_bf16 v[76:79], a[172:175], v[44:47], v[76:79]
    v_mfma_f32_16x16x32_bf16 v[64:67], a[176:179], v[48:51], v[64:67]
    v_mfma_f32_16x16x32_bf16 v[68:71], a[180:183], v[48:51], v[68:71]
    v_mfma_f32_16x16x32_bf16 v[72:75], a[176:179], v[52:55], v[72:75]
    v_mfma_f32_16x16x32_bf16 v[76:79], a[180:183], v[52:55], v[76:79]
    v_mfma_f32_16x16x32_bf16 v[64:67], a[184:187], v[56:59], v[64:67]
    v_mfma_f32_16x16x32_bf16 v[68:71], a[188:191], v[56:59], v[68:71]
    v_mfma_f32_16x16x32_bf16 v[72:75], a[184:187], v[60:63], v[72:75]
    v_mfma_f32_16x16x32_bf16 v[76:79], a[188:191], v[60:63], v[76:79]
    s_branch .s0j_388
.s0v_387:
    v_mfma_f32_16x16x32_bf16 v[64:67], v[32:35], a[160:163], v[64:67]
    v_mfma_f32_16x16x32_bf16 v[68:71], v[32:35], a[164:167], v[68:71]
    v_mfma_f32_16x16x32_bf16 v[72:75], v[36:39], a[160:163], v[72:75]
    v_mfma_f32_16x16x32_bf16 v[76:79], v[36:39], a[164:167], v[76:79]
    v_mfma_f32_16x16x32_bf16 v[64:67], v[40:43], a[168:171], v[64:67]
    v_mfma_f32_16x16x32_bf16 v[68:71], v[40:43], a[172:175], v[68:71]
    v_mfma_f32_16x16x32_bf16 v[72:75], v[44:47], a[168:171], v[72:75]
    v_mfma_f32_16x16x32_bf16 v[76:79], v[44:47], a[172:175], v[76:79]
    v_mfma_f32_16x16x32_bf16 v[64:67], v[48:51], a[176:179], v[64:67]
    v_mfma_f32_16x16x32_bf16 v[68:71], v[48:51], a[180:183], v[68:71]
    v_mfma_f32_16x16x32_bf16 v[72:75], v[52:55], a[176:179], v[72:75]
    v_mfma_f32_16x16x32_bf16 v[76:79], v[52:55], a[180:183], v[76:79]
    v_mfma_f32_16x16x32_bf16 v[64:67], v[56:59], a[184:187], v[64:67]
    v_mfma_f32_16x16x32_bf16 v[68:71], v[56:59], a[188:191], v[68:71]
    v_mfma_f32_16x16x32_bf16 v[72:75], v[60:63], a[184:187], v[72:75]
    v_mfma_f32_16x16x32_bf16 v[76:79], v[60:63], a[188:191], v[76:79]
.s0j_388:
    s_waitcnt vmcnt(17)
    s_barrier
    ds_read_b64_tr_b16 a[192:193], v14 offset:32768
    ds_read_b64_tr_b16 a[194:195], v14 offset:33792
    ds_read_b64_tr_b16 a[196:197], v15 offset:32768
    ds_read_b64_tr_b16 a[198:199], v15 offset:33792
    ds_read_b64_tr_b16 a[200:201], v14 offset:40960
    ds_read_b64_tr_b16 a[202:203], v14 offset:41984
    ds_read_b64_tr_b16 a[204:205], v15 offset:40960
    ds_read_b64_tr_b16 a[206:207], v15 offset:41984
    ds_read_b64_tr_b16 a[208:209], v14 offset:49152
    ds_read_b64_tr_b16 a[210:211], v14 offset:50176
    ds_read_b64_tr_b16 a[212:213], v15 offset:49152
    ds_read_b64_tr_b16 a[214:215], v15 offset:50176
    ds_read_b64_tr_b16 a[216:217], v14 offset:57344
    ds_read_b64_tr_b16 a[218:219], v14 offset:58368
    ds_read_b64_tr_b16 a[220:221], v15 offset:57344
    ds_read_b64_tr_b16 a[222:223], v15 offset:58368
    ds_read_b128 v[32:35], v17 offset:36864
    ds_read_b128 v[36:39], v17 offset:53248
    ds_read_b128 v[40:43], v18 offset:36864
    ds_read_b128 v[44:47], v18 offset:53248
    ds_read_b128 v[48:51], v17 offset:37888
    ds_read_b128 v[52:55], v17 offset:54272
    ds_read_b128 v[56:59], v18 offset:37888
    ds_read_b128 v[60:63], v18 offset:54272
    s_waitcnt lgkmcnt(0)
    s_barrier
    s_add_u32 m0, s29, 98304
    s_nop 0
    buffer_load_dwordx4 v16, s[16:19], s34 offen offset:0 lds
    s_add_u32 m0, s29, 99200
    s_nop 0
    buffer_load_dwordx4 v16, s[16:19], s34 offen offset:128 lds
    s_add_u32 m0, s29, 100096
    s_nop 0
    buffer_load_dwordx4 v16, s[16:19], s34 offen offset:256 lds
    s_add_u32 m0, s29, 100992
    s_nop 0
    buffer_load_dwordx4 v16, s[16:19], s34 offen offset:384 lds
    s_add_u32 m0, s29, 101888
    s_nop 0
    buffer_load_dwordx4 v16, s[16:19], s34 offen offset:512 lds
    s_add_u32 m0, s29, 102784
    s_nop 0
    buffer_load_dwordx4 v16, s[16:19], s34 offen offset:640 lds
    s_add_u32 m0, s29, 103680
    s_nop 0
    buffer_load_dwordx4 v16, s[16:19], s34 offen offset:768 lds
    s_add_u32 m0, s29, 104576
    s_nop 0
    buffer_load_dwordx4 v16, s[16:19], s34 offen offset:896 lds
    s_add_u32 s34, s34, 64512
    s_min_u32 s34, s34, 4128768
    s_cmp_eq_u32 s30, 2
    s_cbranch_scc1 .s0v_389
    v_mfma_f32_16x16x32_bf16 v[64:67], a[192:195], v[32:35], v[64:67]
    v_mfma_f32_16x16x32_bf16 v[68:71], a[196:199], v[32:35], v[68:71]
    v_mfma_f32_16x16x32_bf16 v[72:75], a[192:195], v[36:39], v[72:75]
    v_mfma_f32_16x16x32_bf16 v[76:79], a[196:199], v[36:39], v[76:79]
    v_mfma_f32_16x16x32_bf16 v[64:67], a[200:203], v[40:43], v[64:67]
    v_mfma_f32_16x16x32_bf16 v[68:71], a[204:207], v[40:43], v[68:71]
    v_mfma_f32_16x16x32_bf16 v[72:75], a[200:203], v[44:47], v[72:75]
    v_mfma_f32_16x16x32_bf16 v[76:79], a[204:207], v[44:47], v[76:79]
    v_mfma_f32_16x16x32_bf16 v[64:67], a[208:211], v[48:51], v[64:67]
    v_mfma_f32_16x16x32_bf16 v[68:71], a[212:215], v[48:51], v[68:71]
    v_mfma_f32_16x16x32_bf16 v[72:75], a[208:211], v[52:55], v[72:75]
    v_mfma_f32_16x16x32_bf16 v[76:79], a[212:215], v[52:55], v[76:79]
    v_mfma_f32_16x16x32_bf16 v[64:67], a[216:219], v[56:59], v[64:67]
    v_mfma_f32_16x16x32_bf16 v[68:71], a[220:223], v[56:59], v[68:71]
    v_mfma_f32_16x16x32_bf16 v[72:75], a[216:219], v[60:63], v[72:75]
    v_mfma_f32_16x16x32_bf16 v[76:79], a[220:223], v[60:63], v[76:79]
    s_branch .s0j_390
.s0v_389:
    v_mfma_f32_16x16x32_bf16 v[64:67], v[32:35], a[192:195], v[64:67]
    v_mfma_f32_16x16x32_bf16 v[68:71], v[32:35], a[196:199], v[68:71]
    v_mfma_f32_16x16x32_bf16 v[72:75], v[36:39], a[192:195], v[72:75]
    v_mfma_f32_16x16x32_bf16 v[76:79], v[36:39], a[196:199], v[76:79]
    v_mfma_f32_16x16x32_bf16 v[64:67], v[40:43], a[200:203], v[64:67]
    v_mfma_f32_16x16x32_bf16 v[68:71], v[40:43], a[204:207], v[68:71]
    v_mfma_f32_16x16x32_bf16 v[72:75], v[44:47], a[200:203], v[72:75]
    v_mfma_f32_16x16x32_bf16 v[76:79], v[44:47], a[204:207], v[76:79]
    v_mfma_f32_16x16x32_bf16 v[64:67], v[48:51], a[208:211], v[64:67]
    v_mfma_f32_16x16x32_bf16 v[68:71], v[48:51], a[212:215], v[68:71]
    v_mfma_f32_16x16x32_bf16 v[72:75], v[52:55], a[208:211], v[72:75]
    v_mfma_f32_16x16x32_bf16 v[76:79], v[52:55], a[212:215], v[76:79]
    v_mfma_f32_16x16x32_bf16 v[64:67], v[56:59], a[216:219], v[64:67]
    v_mfma_f32_16x16x32_bf16 v[68:71], v[56:59], a[220:223], v[68:71]
    v_mfma_f32_16x16x32_bf16 v[72:75], v[60:63], a[216:219], v[72:75]
    v_mfma_f32_16x16x32_bf16 v[76:79], v[60:63], a[220:223], v[76:79]
.s0j_390:
    s_waitcnt vmcnt(16)
    s_barrier
    ds_read_b64_tr_b16 a[224:225], v12 offset:0
    ds_read_b64_tr_b16 a[226:227], v12 offset:1024
    ds_read_b64_tr_b16 a[228:229], v13 offset:0
    ds_read_b64_tr_b16 a[230:231], v13 offset:1024
    ds_read_b64_tr_b16 a[232:233], v12 offset:8192
    ds_read_b64_tr_b16 a[234:235], v12 offset:9216
    ds_read_b64_tr_b16 a[236:237], v13 offset:8192
    ds_read_b64_tr_b16 a[238:239], v13 offset:9216
    ds_read_b64_tr_b16 a[240:241], v12 offset:16384
    ds_read_b64_tr_b16 a[242:243], v12 offset:17408
    ds_read_b64_tr_b16 a[244:245], v13 offset:16384
    ds_read_b64_tr_b16 a[246:247], v13 offset:17408
    ds_read_b64_tr_b16 a[248:249], v12 offset:24576
    ds_read_b64_tr_b16 a[250:251], v12 offset:25600
    ds_read_b64_tr_b16 a[252:253], v13 offset:24576
    ds_read_b64_tr_b16 a[254:255], v13 offset:25600
    ds_read_b128 v[32:35], v17 offset:38912
    ds_read_b128 v[36:39], v17 offset:55296
    ds_read_b128 v[40:43], v18 offset:38912
    ds_read_b128 v[44:47], v18 offset:55296
    ds_read_b128 v[48:51], v17 offset:39936
    ds_read_b128 v[52:55], v17 offset:56320
    ds_read_b128 v[56:59], v18 offset:39936
    ds_read_b128 v[60:63], v18 offset:56320
    s_mov_b32 s62, 0
.vp_391:
    v_readlane_b32 s4, v240, 0
    v_readlane_b32 s7, v240, 1
    v_readlane_b32 s6, v240, 2

    v_readlane_b32 s5, v240, 4
    s_add_u32 s4, s4, s5
    v_readlane_b32 s5, v240, 8
    s_add_u32 s4, s4, s5
    v_readlane_b32 s5, v240, 12
    s_add_u32 s4, s4, s5
    s_cmp_ge_u32 s4, 256
    s_cbranch_scc1 .vd_392
    s_cmp_lg_u32 s6, 0
    s_cbranch_scc1 .vs_393
    s_add_u32 s62, s62, 1
    s_cmp_gt_u32 s62, 0x100000
    s_cbranch_scc1 .mg_end_1
    s_sleep 8
    buffer_load_dword v240, v241, s[20:23], 0 offen sc1
    s_waitcnt vmcnt(0)
    s_branch .vp_391

.vs_393:
    s_lshr_b32 s25, s2, 5
    s_and_b32 s26, s2, 31
    s_mov_b32 s27, 1
    s_mov_b32 s99, 1
    s_mov_b32 s97, 144
    s_waitcnt vmcnt(0) lgkmcnt(0)
    s_barrier
    s_branch .mg_role_3

.vd_392:
    s_waitcnt lgkmcnt(0)
    s_barrier
    s_add_u32 m0, s29, 0
    s_nop 0
    buffer_load_dwordx4 v16, s[16:19], s34 offen offset:0 lds
    s_add_u32 m0, s29, 896
    s_nop 0
    buffer_load_dwordx4 v16, s[16:19], s34 offen offset:128 lds
    s_add_u32 m0, s29, 1792
    s_nop 0
    buffer_load_dwordx4 v16, s[16:19], s34 offen offset:256 lds
    s_add_u32 m0, s29, 2688
    s_nop 0
    buffer_load_dwordx4 v16, s[16:19], s34 offen offset:384 lds
    s_add_u32 m0, s29, 3584
    s_nop 0
    buffer_load_dwordx4 v16, s[16:19], s34 offen offset:512 lds
    s_add_u32 m0, s29, 4480
    s_nop 0
    buffer_load_dwordx4 v16, s[16:19], s34 offen offset:640 lds
    s_add_u32 m0, s29, 5376
    s_nop 0
    buffer_load_dwordx4 v16, s[16:19], s34 offen offset:768 lds
    s_add_u32 m0, s29, 6272
    s_nop 0
    buffer_load_dwordx4 v16, s[16:19], s34 offen offset:896 lds
    s_add_u32 s34, s34, 1024
    s_cmp_eq_u32 s30, 2
    s_cbranch_scc1 .s0v_394
    v_mfma_f32_16x16x32_bf16 v[64:67], a[224:227], v[32:35], v[64:67]
    v_mfma_f32_16x16x32_bf16 v[68:71], a[228:231], v[32:35], v[68:71]
    v_mfma_f32_16x16x32_bf16 v[72:75], a[224:227], v[36:39], v[72:75]
    v_mfma_f32_16x16x32_bf16 v[76:79], a[228:231], v[36:39], v[76:79]
    v_mfma_f32_16x16x32_bf16 v[64:67], a[232:235], v[40:43], v[64:67]
    v_mfma_f32_16x16x32_bf16 v[68:71], a[236:239], v[40:43], v[68:71]
    v_mfma_f32_16x16x32_bf16 v[72:75], a[232:235], v[44:47], v[72:75]
    v_mfma_f32_16x16x32_bf16 v[76:79], a[236:239], v[44:47], v[76:79]
    v_mfma_f32_16x16x32_bf16 v[64:67], a[240:243], v[48:51], v[64:67]
    v_mfma_f32_16x16x32_bf16 v[68:71], a[244:247], v[48:51], v[68:71]
    v_mfma_f32_16x16x32_bf16 v[72:75], a[240:243], v[52:55], v[72:75]
    v_mfma_f32_16x16x32_bf16 v[76:79], a[244:247], v[52:55], v[76:79]
    v_mfma_f32_16x16x32_bf16 v[64:67], a[248:251], v[56:59], v[64:67]
    v_mfma_f32_16x16x32_bf16 v[68:71], a[252:255], v[56:59], v[68:71]
    v_mfma_f32_16x16x32_bf16 v[72:75], a[248:251], v[60:63], v[72:75]
    v_mfma_f32_16x16x32_bf16 v[76:79], a[252:255], v[60:63], v[76:79]
    s_branch .s0j_395
.s0v_394:
    v_mfma_f32_16x16x32_bf16 v[64:67], v[32:35], a[224:227], v[64:67]
    v_mfma_f32_16x16x32_bf16 v[68:71], v[32:35], a[228:231], v[68:71]
    v_mfma_f32_16x16x32_bf16 v[72:75], v[36:39], a[224:227], v[72:75]
    v_mfma_f32_16x16x32_bf16 v[76:79], v[36:39], a[228:231], v[76:79]
    v_mfma_f32_16x16x32_bf16 v[64:67], v[40:43], a[232:235], v[64:67]
    v_mfma_f32_16x16x32_bf16 v[68:71], v[40:43], a[236:239], v[68:71]
    v_mfma_f32_16x16x32_bf16 v[72:75], v[44:47], a[232:235], v[72:75]
    v_mfma_f32_16x16x32_bf16 v[76:79], v[44:47], a[236:239], v[76:79]
    v_mfma_f32_16x16x32_bf16 v[64:67], v[48:51], a[240:243], v[64:67]
    v_mfma_f32_16x16x32_bf16 v[68:71], v[48:51], a[244:247], v[68:71]
    v_mfma_f32_16x16x32_bf16 v[72:75], v[52:55], a[240:243], v[72:75]
    v_mfma_f32_16x16x32_bf16 v[76:79], v[52:55], a[244:247], v[76:79]
    v_mfma_f32_16x16x32_bf16 v[64:67], v[56:59], a[248:251], v[64:67]
    v_mfma_f32_16x16x32_bf16 v[68:71], v[56:59], a[252:255], v[68:71]
    v_mfma_f32_16x16x32_bf16 v[72:75], v[60:63], a[248:251], v[72:75]
    v_mfma_f32_16x16x32_bf16 v[76:79], v[60:63], a[252:255], v[76:79]
.s0j_395:
    buffer_store_dwordx4 v[24:27], v28, s[8:11], s46 offen sc1
    buffer_store_dwordx4 v[24:27], v29, s[8:11], s46 offen sc1
    s_cmp_eq_u32 s30, 2
    s_cbranch_scc1 .qv_375
    s_waitcnt vmcnt(16)
    s_barrier
    ds_read_b128 v[32:35], v19 offset:0
    ds_read_b128 v[36:39], v19 offset:16384
    ds_read_b128 v[40:43], v20 offset:0
    ds_read_b128 v[44:47], v20 offset:16384
    s_add_u32 m0, s29, 32768
    s_nop 0
    buffer_load_dwordx4 v16, s[16:19], s34 offen offset:0 lds
    ds_read_b128 v[48:51], v19 offset:1024
    ds_read_b128 v[52:55], v19 offset:17408
    s_branch .qe_397
.p2align 6
.ql_396:
    s_waitcnt lgkmcnt(4)
    v_mfma_f32_16x16x32_bf16 v[64:67], a[0:3], v[32:35], 0
    ds_read_b128 v[56:59], v18 offset:1024
    s_add_u32 m0, s29, 99200
    v_mfma_f32_16x16x32_bf16 v[68:71], a[4:7], v[32:35], 0
    buffer_load_dwordx4 v16, s[16:19], s34 offen offset:128 lds
    v_mfma_f32_16x16x32_bf16 v[72:75], a[0:3], v[36:39], 0
    ds_read_b128 v[60:63], v18 offset:17408
    v_mfma_f32_16x16x32_bf16 v[76:79], a[4:7], v[36:39], 0
    s_mov_b32 exec_hi, 0
    buffer_store_dwordx4 v[24:27], v21, s[8:11], s48 offen sc1
    s_mov_b32 exec_hi, -1

    s_waitcnt lgkmcnt(4)
    v_mfma_f32_16x16x32_bf16 v[64:67], a[8:11], v[40:43], v[64:67]
    ds_read_b128 v[32:35], v17 offset:2048
    v_mfma_f32_16x16x32_bf16 v[68:71], a[12:15], v[40:43], v[68:71]
    v_cvt_pk_bf16_f32 v96, v80, v81
    v_cvt_pk_bf16_f32 v97, v82, v83
    v_cvt_pk_bf16_f32 v98, v84, v85
    v_mfma_f32_16x16x32_bf16 v[72:75], a[8:11], v[44:47], v[72:75]
    ds_read_b128 v[36:39], v17 offset:18432
    v_mfma_f32_16x16x32_bf16 v[76:79], a[12:15], v[44:47], v[76:79]
    v_cvt_pk_bf16_f32 v99, v86, v87
    v_cvt_pk_bf16_f32 v100, v88, v89
    buffer_store_dwordx4 v[96:99], v21, s[8:11], s32 offen sc1
    s_waitcnt lgkmcnt(4)
    v_mfma_f32_16x16x32_bf16 v[64:67], a[16:19], v[48:51], v[64:67]
    ds_read_b128 v[40:43], v18 offset:2048
    s_add_u32 m0, s29, 100096
    v_mfma_f32_16x16x32_bf16 v[68:71], a[20:23], v[48:51], v[68:71]
    buffer_load_dwordx4 v16, s[16:19], s34 offen offset:256 lds
    v_mfma_f32_16x16x32_bf16 v[72:75], a[16:19], v[52:55], v[72:75]
    ds_read_b128 v[44:47], v18 offset:18432
    v_mfma_f32_16x16x32_bf16 v[76:79], a[20:23], v[52:55], v[76:79]
    v_cvt_pk_bf16_f32 v101, v90, v91
    v_cvt_pk_bf16_f32 v102, v92, v93
    v_cvt_pk_bf16_f32 v103, v94, v95
    s_waitcnt lgkmcnt(4)
    v_mfma_f32_16x16x32_bf16 v[64:67], a[24:27], v[56:59], v[64:67]
    ds_read_b128 v[48:51], v17 offset:3072
    v_mfma_f32_16x16x32_bf16 v[68:71], a[28:31], v[56:59], v[68:71]
    buffer_store_dwordx4 v[100:103], v21, s[8:11], s38 offen sc1
    v_mfma_f32_16x16x32_bf16 v[72:75], a[24:27], v[60:63], v[72:75]
    ds_read_b128 v[52:55], v17 offset:19456
    v_mfma_f32_16x16x32_bf16 v[76:79], a[28:31], v[60:63], v[76:79]
    s_waitcnt lgkmcnt(4)
    v_mfma_f32_16x16x32_bf16 v[64:67], a[32:35], v[32:35], v[64:67]
    ds_read_b128 v[56:59], v18 offset:3072
    s_add_u32 m0, s29, 100992
    v_mfma_f32_16x16x32_bf16 v[68:71], a[36:39], v[32:35], v[68:71]
    buffer_load_dwordx4 v16, s[16:19], s34 offen offset:384 lds
    v_mfma_f32_16x16x32_bf16 v[72:75], a[32:35], v[36:39], v[72:75]
    ds_read_b128 v[60:63], v18 offset:19456
    v_mfma_f32_16x16x32_bf16 v[76:79], a[36:39], v[36:39], v[76:79]
    s_waitcnt lgkmcnt(4)
    v_mfma_f32_16x16x32_bf16 v[64:67], a[40:43], v[40:43], v[64:67]
    ds_read_b128 v[32:35], v17 offset:4096
    v_mfma_f32_16x16x32_bf16 v[68:71], a[44:47], v[40:43], v[68:71]
    v_mfma_f32_16x16x32_bf16 v[72:75], a[40:43], v[44:47], v[72:75]
    ds_read_b128 v[36:39], v17 offset:20480
    v_mfma_f32_16x16x32_bf16 v[76:79], a[44:47], v[44:47], v[76:79]
    s_waitcnt lgkmcnt(4)
    v_mfma_f32_16x16x32_bf16 v[64:67], a[48:51], v[48:51], v[64:67]
    ds_read_b128 v[40:43], v18 offset:4096
    s_add_u32 m0, s29, 101888
    v_mfma_f32_16x16x32_bf16 v[68:71], a[52:55], v[48:51], v[68:71]
    buffer_load_dwordx4 v16, s[16:19], s34 offen offset:512 lds
    v_mfma_f32_16x16x32_bf16 v[72:75], a[48:51], v[52:55], v[72:75]
    ds_read_b128 v[44:47], v18 offset:20480
    v_mfma_f32_16x16x32_bf16 v[76:79], a[52:55], v[52:55], v[76:79]
    s_waitcnt lgkmcnt(4)
    v_mfma_f32_16x16x32_bf16 v[64:67], a[56:59], v[56:59], v[64:67]
    ds_read_b128 v[48:51], v17 offset:5120
    v_mfma_f32_16x16x32_bf16 v[68:71], a[60:63], v[56:59], v[68:71]
    v_mfma_f32_16x16x32_bf16 v[72:75], a[56:59], v[60:63], v[72:75]
    ds_read_b128 v[52:55], v17 offset:21504
    v_mfma_f32_16x16x32_bf16 v[76:79], a[60:63], v[60:63], v[76:79]
    s_waitcnt lgkmcnt(4)
    v_mfma_f32_16x16x32_bf16 v[64:67], a[64:67], v[32:35], v[64:67]
    ds_read_b128 v[56:59], v18 offset:5120
    s_add_u32 m0, s29, 102784
    v_mfma_f32_16x16x32_bf16 v[68:71], a[68:71], v[32:35], v[68:71]
    buffer_load_dwordx4 v16, s[16:19], s34 offen offset:640 lds
    v_mfma_f32_16x16x32_bf16 v[72:75], a[64:67], v[36:39], v[72:75]
    ds_read_b128 v[60:63], v18 offset:21504
    v_mfma_f32_16x16x32_bf16 v[76:79], a[68:71], v[36:39], v[76:79]
    s_waitcnt lgkmcnt(4)
    v_mfma_f32_16x16x32_bf16 v[64:67], a[72:75], v[40:43], v[64:67]
    ds_read_b128 v[32:35], v17 offset:6144
    v_mfma_f32_16x16x32_bf16 v[68:71], a[76:79], v[40:43], v[68:71]
    s_mov_b32 s32, s39
    s_add_u32 s38, s39, 4096
    s_add_u32 s39, s39, 262144
    s_mov_b32 s48, s49
    s_add_u32 s49, s49, 196608
    v_mfma_f32_16x16x32_bf16 v[72:75], a[72:75], v[44:47], v[72:75]
    ds_read_b128 v[36:39], v17 offset:22528
    v_mfma_f32_16x16x32_bf16 v[76:79], a[76:79], v[44:47], v[76:79]
    v_add_u32 v23, 1, v23
    s_waitcnt lgkmcnt(4)
    v_mfma_f32_16x16x32_bf16 v[64:67], a[80:83], v[48:51], v[64:67]
    ds_read_b128 v[40:43], v18 offset:6144
    s_add_u32 m0, s29, 103680
    v_mfma_f32_16x16x32_bf16 v[68:71], a[84:87], v[48:51], v[68:71]
    buffer_load_dwordx4 v16, s[16:19], s34 offen offset:768 lds
    v_mfma_f32_16x16x32_bf16 v[72:75], a[80:83], v[52:55], v[72:75]
    ds_read_b128 v[44:47], v18 offset:22528
    v_mfma_f32_16x16x32_bf16 v[76:79], a[84:87], v[52:55], v[76:79]
    s_waitcnt lgkmcnt(4)
    v_mfma_f32_16x16x32_bf16 v[64:67], a[88:91], v[56:59], v[64:67]
    ds_read_b128 v[48:51], v17 offset:7168
    v_mfma_f32_16x16x32_bf16 v[68:71], a[92:95], v[56:59], v[68:71]
    v_mfma_f32_16x16x32_bf16 v[72:75], a[88:91], v[60:63], v[72:75]
    ds_read_b128 v[52:55], v17 offset:23552
    v_mfma_f32_16x16x32_bf16 v[76:79], a[92:95], v[60:63], v[76:79]
    s_mov_b64 exec, s[44:45]
    buffer_store_dwordx4 v[24:27], v28, s[8:11], s46 offen sc1
    s_mov_b64 exec, -1
    s_waitcnt lgkmcnt(4)
    v_mfma_f32_16x16x32_bf16 v[64:67], a[96:99], v[32:35], v[64:67]
    ds_read_b128 v[56:59], v18 offset:7168
    s_add_u32 m0, s29, 104576
    v_mfma_f32_16x16x32_bf16 v[68:71], a[100:103], v[32:35], v[68:71]
    buffer_load_dwordx4 v16, s[16:19], s34 offen offset:896 lds
    v_mfma_f32_16x16x32_bf16 v[72:75], a[96:99], v[36:39], v[72:75]
    ds_read_b128 v[60:63], v18 offset:23552
    v_mfma_f32_16x16x32_bf16 v[76:79], a[100:103], v[36:39], v[76:79]
    s_waitcnt lgkmcnt(4)
    v_mfma_f32_16x16x32_bf16 v[64:67], a[104:107], v[40:43], v[64:67]
    s_add_u32 s34, s34, 64512
    s_min_u32 s34, s34, 4128768
    v_mfma_f32_16x16x32_bf16 v[68:71], a[108:111], v[40:43], v[68:71]
    v_mfma_f32_16x16x32_bf16 v[72:75], a[104:107], v[44:47], v[72:75]
    v_mfma_f32_16x16x32_bf16 v[76:79], a[108:111], v[44:47], v[76:79]
    s_waitcnt lgkmcnt(0)
    s_cmp_lt_u32 s35, 2
    s_cselect_b64 s[70:71], s[36:37], 0
    s_cbranch_scc0 .ef_398
    s_waitcnt vmcnt(5)
.ef_398:
    s_waitcnt vmcnt(19)
    s_barrier
    ds_read_b128 v[32:35], v17 offset:32768
    ds_read_b128 v[36:39], v17 offset:49152
    v_mfma_f32_16x16x32_bf16 v[64:67], a[112:115], v[48:51], v[64:67]
    ds_read_b128 v[40:43], v18 offset:32768
    s_add_u32 m0, s29, 0
    v_mfma_f32_16x16x32_bf16 v[68:71], a[116:119], v[48:51], v[68:71]
    buffer_load_dwordx4 v16, s[16:19], s34 offen offset:0 lds
    v_mfma_f32_16x16x32_bf16 v[72:75], a[112:115], v[52:55], v[72:75]
    ds_read_b128 v[44:47], v18 offset:49152
    v_mfma_f32_16x16x32_bf16 v[76:79], a[116:119], v[52:55], v[76:79]
    v_mfma_f32_16x16x32_bf16 v[64:67], a[120:123], v[56:59], v[64:67]
    ds_read_b128 v[48:51], v17 offset:33792
    v_mfma_f32_16x16x32_bf16 v[68:71], a[124:127], v[56:59], v[68:71]
    v_mfma_f32_16x16x32_bf16 v[72:75], a[120:123], v[60:63], v[72:75]
    ds_read_b128 v[52:55], v17 offset:50176
    v_mfma_f32_16x16x32_bf16 v[76:79], a[124:127], v[60:63], v[76:79]
    s_mov_b64 exec, s[70:71]
    buffer_store_dword v23, v22, s[8:11], s33 offen sc1
    s_mov_b64 exec, -1

    s_waitcnt lgkmcnt(4)
    v_mfma_f32_16x16x32_bf16 v[64:67], a[128:131], v[32:35], v[64:67]
    ds_read_b128 v[56:59], v18 offset:33792
    s_add_u32 m0, s29, 896
    v_mfma_f32_16x16x32_bf16 v[68:71], a[132:135], v[32:35], v[68:71]
    buffer_load_dwordx4 v16, s[16:19], s34 offen offset:128 lds
    v_mfma_f32_16x16x32_bf16 v[72:75], a[128:131], v[36:39], v[72:75]
    ds_read_b128 v[60:63], v18 offset:50176
    v_mfma_f32_16x16x32_bf16 v[76:79], a[132:135], v[36:39], v[76:79]
    s_waitcnt lgkmcnt(4)
    v_mfma_f32_16x16x32_bf16 v[64:67], a[136:139], v[40:43], v[64:67]
    ds_read_b128 v[32:35], v17 offset:34816
    v_mfma_f32_16x16x32_bf16 v[68:71], a[140:143], v[40:43], v[68:71]
    v_mfma_f32_16x16x32_bf16 v[72:75], a[136:139], v[44:47], v[72:75]
    ds_read_b128 v[36:39], v17 offset:51200
    v_mfma_f32_16x16x32_bf16 v[76:79], a[140:143], v[44:47], v[76:79]
    s_waitcnt lgkmcnt(4)
    v_mfma_f32_16x16x32_bf16 v[64:67], a[144:147], v[48:51], v[64:67]
    ds_read_b128 v[40:43], v18 offset:34816
    s_add_u32 m0, s29, 1792
    v_mfma_f32_16x16x32_bf16 v[68:71], a[148:151], v[48:51], v[68:71]
    buffer_load_dwordx4 v16, s[16:19], s34 offen offset:256 lds
    v_mfma_f32_16x16x32_bf16 v[72:75], a[144:147], v[52:55], v[72:75]
    ds_read_b128 v[44:47], v18 offset:51200
    v_mfma_f32_16x16x32_bf16 v[76:79], a[148:151], v[52:55], v[76:79]
    s_waitcnt lgkmcnt(4)
    v_mfma_f32_16x16x32_bf16 v[64:67], a[152:155], v[56:59], v[64:67]
    ds_read_b128 v[48:51], v17 offset:35840
    v_mfma_f32_16x16x32_bf16 v[68:71], a[156:159], v[56:59], v[68:71]
    v_mfma_f32_16x16x32_bf16 v[72:75], a[152:155], v[60:63], v[72:75]
    ds_read_b128 v[52:55], v17 offset:52224
    v_mfma_f32_16x16x32_bf16 v[76:79], a[156:159], v[60:63], v[76:79]
    s_waitcnt lgkmcnt(4)
    v_mfma_f32_16x16x32_bf16 v[64:67], a[160:163], v[32:35], v[64:67]
    ds_read_b128 v[56:59], v18 offset:35840
    s_add_u32 m0, s29, 2688
    v_mfma_f32_16x16x32_bf16 v[68:71], a[164:167], v[32:35], v[68:71]
    buffer_load_dwordx4 v16, s[16:19], s34 offen offset:384 lds
    v_mfma_f32_16x16x32_bf16 v[72:75], a[160:163], v[36:39], v[72:75]
    ds_read_b128 v[60:63], v18 offset:52224
    v_mfma_f32_16x16x32_bf16 v[76:79], a[164:167], v[36:39], v[76:79]
    s_waitcnt lgkmcnt(4)
    v_mfma_f32_16x16x32_bf16 v[64:67], a[168:171], v[40:43], v[64:67]
    ds_read_b128 v[32:35], v17 offset:36864
    v_mfma_f32_16x16x32_bf16 v[68:71], a[172:175], v[40:43], v[68:71]
    v_mfma_f32_16x16x32_bf16 v[72:75], a[168:171], v[44:47], v[72:75]
    ds_read_b128 v[36:39], v17 offset:53248
    v_mfma_f32_16x16x32_bf16 v[76:79], a[172:175], v[44:47], v[76:79]
    s_waitcnt lgkmcnt(4)
    v_mfma_f32_16x16x32_bf16 v[64:67], a[176:179], v[48:51], v[64:67]
    ds_read_b128 v[40:43], v18 offset:36864
    s_add_u32 m0, s29, 3584
    v_mfma_f32_16x16x32_bf16 v[68:71], a[180:183], v[48:51], v[68:71]
    buffer_load_dwordx4 v16, s[16:19], s34 offen offset:512 lds
    v_mfma_f32_16x16x32_bf16 v[72:75], a[176:179], v[52:55], v[72:75]
    ds_read_b128 v[44:47], v18 offset:53248
    v_mfma_f32_16x16x32_bf16 v[76:79], a[180:183], v[52:55], v[76:79]
    s_waitcnt lgkmcnt(4)
    v_mfma_f32_16x16x32_bf16 v[64:67], a[184:187], v[56:59], v[64:67]
    ds_read_b128 v[48:51], v17 offset:37888
    v_mfma_f32_16x16x32_bf16 v[68:71], a[188:191], v[56:59], v[68:71]
    v_mfma_f32_16x16x32_bf16 v[72:75], a[184:187], v[60:63], v[72:75]
    ds_read_b128 v[52:55], v17 offset:54272
    v_mfma_f32_16x16x32_bf16 v[76:79], a[188:191], v[60:63], v[76:79]
    s_waitcnt lgkmcnt(4)
    v_mfma_f32_16x16x32_bf16 v[64:67], a[192:195], v[32:35], v[64:67]
    ds_read_b128 v[56:59], v18 offset:37888
    s_add_u32 m0, s29, 4480
    v_mfma_f32_16x16x32_bf16 v[68:71], a[196:199], v[32:35], v[68:71]
    buffer_load_dwordx4 v16, s[16:19], s34 offen offset:640 lds
    v_mfma_f32_16x16x32_bf16 v[72:75], a[192:195], v[36:39], v[72:75]
    ds_read_b128 v[60:63], v18 offset:54272
    v_mfma_f32_16x16x32_bf16 v[76:79], a[196:199], v[36:39], v[76:79]
    s_waitcnt lgkmcnt(4)
    v_mfma_f32_16x16x32_bf16 v[64:67], a[200:203], v[40:43], v[64:67]
    ds_read_b128 v[32:35], v17 offset:38912
    v_mfma_f32_16x16x32_bf16 v[68:71], a[204:207], v[40:43], v[68:71]
    v_mfma_f32_16x16x32_bf16 v[72:75], a[200:203], v[44:47], v[72:75]
    ds_read_b128 v[36:39], v17 offset:55296
    v_mfma_f32_16x16x32_bf16 v[76:79], a[204:207], v[44:47], v[76:79]
    s_waitcnt lgkmcnt(4)
    v_mfma_f32_16x16x32_bf16 v[64:67], a[208:211], v[48:51], v[64:67]
    ds_read_b128 v[40:43], v18 offset:38912
    s_add_u32 m0, s29, 5376
    v_mfma_f32_16x16x32_bf16 v[68:71], a[212:215], v[48:51], v[68:71]
    buffer_load_dwordx4 v16, s[16:19], s34 offen offset:768 lds
    v_mfma_f32_16x16x32_bf16 v[72:75], a[208:211], v[52:55], v[72:75]
    ds_read_b128 v[44:47], v18 offset:55296
    v_mfma_f32_16x16x32_bf16 v[76:79], a[212:215], v[52:55], v[76:79]
    s_waitcnt lgkmcnt(4)
    v_mfma_f32_16x16x32_bf16 v[64:67], a[216:219], v[56:59], v[64:67]
    ds_read_b128 v[48:51], v17 offset:39936
    v_mfma_f32_16x16x32_bf16 v[68:71], a[220:223], v[56:59], v[68:71]
    v_mfma_f32_16x16x32_bf16 v[72:75], a[216:219], v[60:63], v[72:75]
    ds_read_b128 v[52:55], v17 offset:56320
    v_mfma_f32_16x16x32_bf16 v[76:79], a[220:223], v[60:63], v[76:79]
    s_mov_b64 exec, s[44:45]
    buffer_store_dwordx4 v[24:27], v29, s[8:11], s46 offen sc1
    s_mov_b64 exec, -1
    s_waitcnt lgkmcnt(4)
    v_mfma_f32_16x16x32_bf16 v[64:67], a[224:227], v[32:35], v[64:67]
    ds_read_b128 v[56:59], v18 offset:39936
    s_add_u32 m0, s29, 6272
    v_mfma_f32_16x16x32_bf16 v[68:71], a[228:231], v[32:35], v[68:71]
    buffer_load_dwordx4 v16, s[16:19], s34 offen offset:896 lds
    v_mfma_f32_16x16x32_bf16 v[72:75], a[224:227], v[36:39], v[72:75]
    ds_read_b128 v[60:63], v18 offset:56320
    v_mfma_f32_16x16x32_bf16 v[76:79], a[228:231], v[36:39], v[76:79]
    s_waitcnt lgkmcnt(4)
    v_mfma_f32_16x16x32_bf16 v[64:67], a[232:235], v[40:43], v[64:67]
    s_add_u32 s34, s34, 1024
    v_mfma_f32_16x16x32_bf16 v[68:71], a[236:239], v[40:43], v[68:71]
    v_mfma_f32_16x16x32_bf16 v[72:75], a[232:235], v[44:47], v[72:75]
    v_mfma_f32_16x16x32_bf16 v[76:79], a[236:239], v[44:47], v[76:79]
    s_waitcnt lgkmcnt(0)
    s_waitcnt vmcnt(13)
    s_barrier
    ds_read_b128 v[32:35], v19 offset:0
    ds_read_b128 v[36:39], v19 offset:16384
    v_mfma_f32_16x16x32_bf16 v[64:67], a[240:243], v[48:51], v[64:67]
    ds_read_b128 v[40:43], v20 offset:0
    s_add_u32 m0, s29, 32768
    v_mfma_f32_16x16x32_bf16 v[68:71], a[244:247], v[48:51], v[68:71]
    buffer_load_dwordx4 v16, s[16:19], s34 offen offset:0 lds
    v_mfma_f32_16x16x32_bf16 v[72:75], a[240:243], v[52:55], v[72:75]
    ds_read_b128 v[44:47], v20 offset:16384
    v_mfma_f32_16x16x32_bf16 v[76:79], a[244:247], v[52:55], v[76:79]
    v_mfma_f32_16x16x32_bf16 v[64:67], a[248:251], v[56:59], v[64:67]
    ds_read_b128 v[48:51], v19 offset:1024
    v_mfma_f32_16x16x32_bf16 v[68:71], a[252:255], v[56:59], v[68:71]
    v_mfma_f32_16x16x32_bf16 v[72:75], a[248:251], v[60:63], v[72:75]
    ds_read_b128 v[52:55], v19 offset:17408
    v_mfma_f32_16x16x32_bf16 v[76:79], a[252:255], v[60:63], v[76:79]
    s_mov_b64 exec, s[36:37]
    buffer_store_dword v23, v22, s[8:11], s33 offen sc1
    s_mov_b64 exec, -1

.qe_397:
    s_waitcnt lgkmcnt(4)
    v_mfma_f32_16x16x32_bf16 v[80:83], a[0:3], v[32:35], 0
    ds_read_b128 v[56:59], v20 offset:1024
    s_add_u32 m0, s29, 33664
    v_mfma_f32_16x16x32_bf16 v[84:87], a[4:7], v[32:35], 0
    buffer_load_dwordx4 v16, s[16:19], s34 offen offset:128 lds
    v_mfma_f32_16x16x32_bf16 v[88:91], a[0:3], v[36:39], 0
    ds_read_b128 v[60:63], v20 offset:17408
    v_mfma_f32_16x16x32_bf16 v[92:95], a[4:7], v[36:39], 0
    s_mov_b32 exec_hi, 0
    buffer_store_dwordx4 v[24:27], v21, s[8:11], s48 offen sc1
    s_mov_b32 exec_hi, -1

    s_waitcnt lgkmcnt(4)
    v_mfma_f32_16x16x32_bf16 v[80:83], a[8:11], v[40:43], v[80:83]
    ds_read_b128 v[32:35], v19 offset:2048
    v_mfma_f32_16x16x32_bf16 v[84:87], a[12:15], v[40:43], v[84:87]
    v_cvt_pk_bf16_f32 v96, v64, v65
    v_cvt_pk_bf16_f32 v97, v66, v67
    v_cvt_pk_bf16_f32 v98, v68, v69
    v_mfma_f32_16x16x32_bf16 v[88:91], a[8:11], v[44:47], v[88:91]
    ds_read_b128 v[36:39], v19 offset:18432
    v_mfma_f32_16x16x32_bf16 v[92:95], a[12:15], v[44:47], v[92:95]
    v_cvt_pk_bf16_f32 v99, v70, v71
    v_cvt_pk_bf16_f32 v100, v72, v73
    buffer_store_dwordx4 v[96:99], v21, s[8:11], s32 offen sc1
    s_waitcnt lgkmcnt(4)
    v_mfma_f32_16x16x32_bf16 v[80:83], a[16:19], v[48:51], v[80:83]
    ds_read_b128 v[40:43], v20 offset:2048
    s_add_u32 m0, s29, 34560
    v_mfma_f32_16x16x32_bf16 v[84:87], a[20:23], v[48:51], v[84:87]
    buffer_load_dwordx4 v16, s[16:19], s34 offen offset:256 lds
    v_mfma_f32_16x16x32_bf16 v[88:91], a[16:19], v[52:55], v[88:91]
    ds_read_b128 v[44:47], v20 offset:18432
    v_mfma_f32_16x16x32_bf16 v[92:95], a[20:23], v[52:55], v[92:95]
    v_cvt_pk_bf16_f32 v101, v74, v75
    v_cvt_pk_bf16_f32 v102, v76, v77
    v_cvt_pk_bf16_f32 v103, v78, v79
    s_waitcnt lgkmcnt(4)
    v_mfma_f32_16x16x32_bf16 v[80:83], a[24:27], v[56:59], v[80:83]
    ds_read_b128 v[48:51], v19 offset:3072
    v_mfma_f32_16x16x32_bf16 v[84:87], a[28:31], v[56:59], v[84:87]
    buffer_store_dwordx4 v[100:103], v21, s[8:11], s38 offen sc1
    v_mfma_f32_16x16x32_bf16 v[88:91], a[24:27], v[60:63], v[88:91]
    ds_read_b128 v[52:55], v19 offset:19456
    v_mfma_f32_16x16x32_bf16 v[92:95], a[28:31], v[60:63], v[92:95]
    s_waitcnt lgkmcnt(4)
    v_mfma_f32_16x16x32_bf16 v[80:83], a[32:35], v[32:35], v[80:83]
    ds_read_b128 v[56:59], v20 offset:3072
    s_add_u32 m0, s29, 35456
    v_mfma_f32_16x16x32_bf16 v[84:87], a[36:39], v[32:35], v[84:87]
    buffer_load_dwordx4 v16, s[16:19], s34 offen offset:384 lds
    v_mfma_f32_16x16x32_bf16 v[88:91], a[32:35], v[36:39], v[88:91]
    ds_read_b128 v[60:63], v20 offset:19456
    v_mfma_f32_16x16x32_bf16 v[92:95], a[36:39], v[36:39], v[92:95]
    s_waitcnt lgkmcnt(4)
    v_mfma_f32_16x16x32_bf16 v[80:83], a[40:43], v[40:43], v[80:83]
    ds_read_b128 v[32:35], v19 offset:4096
    v_mfma_f32_16x16x32_bf16 v[84:87], a[44:47], v[40:43], v[84:87]
    v_mfma_f32_16x16x32_bf16 v[88:91], a[40:43], v[44:47], v[88:91]
    ds_read_b128 v[36:39], v19 offset:20480
    v_mfma_f32_16x16x32_bf16 v[92:95], a[44:47], v[44:47], v[92:95]
    s_waitcnt lgkmcnt(4)
    v_mfma_f32_16x16x32_bf16 v[80:83], a[48:51], v[48:51], v[80:83]
    ds_read_b128 v[40:43], v20 offset:4096
    s_add_u32 m0, s29, 36352
    v_mfma_f32_16x16x32_bf16 v[84:87], a[52:55], v[48:51], v[84:87]
    buffer_load_dwordx4 v16, s[16:19], s34 offen offset:512 lds
    v_mfma_f32_16x16x32_bf16 v[88:91], a[48:51], v[52:55], v[88:91]
    ds_read_b128 v[44:47], v20 offset:20480
    v_mfma_f32_16x16x32_bf16 v[92:95], a[52:55], v[52:55], v[92:95]
    s_waitcnt lgkmcnt(4)
    v_mfma_f32_16x16x32_bf16 v[80:83], a[56:59], v[56:59], v[80:83]
    ds_read_b128 v[48:51], v19 offset:5120
    v_mfma_f32_16x16x32_bf16 v[84:87], a[60:63], v[56:59], v[84:87]
    v_mfma_f32_16x16x32_bf16 v[88:91], a[56:59], v[60:63], v[88:91]
    ds_read_b128 v[52:55], v19 offset:21504
    v_mfma_f32_16x16x32_bf16 v[92:95], a[60:63], v[60:63], v[92:95]
    s_waitcnt lgkmcnt(4)
    v_mfma_f32_16x16x32_bf16 v[80:83], a[64:67], v[32:35], v[80:83]
    ds_read_b128 v[56:59], v20 offset:5120
    s_add_u32 m0, s29, 37248
    v_mfma_f32_16x16x32_bf16 v[84:87], a[68:71], v[32:35], v[84:87]
    buffer_load_dwordx4 v16, s[16:19], s34 offen offset:640 lds
    v_mfma_f32_16x16x32_bf16 v[88:91], a[64:67], v[36:39], v[88:91]
    ds_read_b128 v[60:63], v20 offset:21504
    v_mfma_f32_16x16x32_bf16 v[92:95], a[68:71], v[36:39], v[92:95]
    s_waitcnt lgkmcnt(4)
    v_mfma_f32_16x16x32_bf16 v[80:83], a[72:75], v[40:43], v[80:83]
    ds_read_b128 v[32:35], v19 offset:6144
    v_mfma_f32_16x16x32_bf16 v[84:87], a[76:79], v[40:43], v[84:87]
    s_mov_b32 s32, s39
    s_add_u32 s38, s39, 4096
    s_add_u32 s39, s39, 262144
    s_mov_b32 s48, s49
    s_add_u32 s49, s49, 196608
    v_mfma_f32_16x16x32_bf16 v[88:91], a[72:75], v[44:47], v[88:91]
    ds_read_b128 v[36:39], v19 offset:22528
    v_mfma_f32_16x16x32_bf16 v[92:95], a[76:79], v[44:47], v[92:95]
    v_add_u32 v23, 1, v23
    s_waitcnt lgkmcnt(4)
    v_mfma_f32_16x16x32_bf16 v[80:83], a[80:83], v[48:51], v[80:83]
    ds_read_b128 v[40:43], v20 offset:6144
    s_add_u32 m0, s29, 38144
    v_mfma_f32_16x16x32_bf16 v[84:87], a[84:87], v[48:51], v[84:87]
    buffer_load_dwordx4 v16, s[16:19], s34 offen offset:768 lds
    v_mfma_f32_16x16x32_bf16 v[88:91], a[80:83], v[52:55], v[88:91]
    ds_read_b128 v[44:47], v20 offset:22528
    v_mfma_f32_16x16x32_bf16 v[92:95], a[84:87], v[52:55], v[92:95]
    s_waitcnt lgkmcnt(4)
    v_mfma_f32_16x16x32_bf16 v[80:83], a[88:91], v[56:59], v[80:83]
    ds_read_b128 v[48:51], v19 offset:7168
    v_mfma_f32_16x16x32_bf16 v[84:87], a[92:95], v[56:59], v[84:87]
    v_mfma_f32_16x16x32_bf16 v[88:91], a[88:91], v[60:63], v[88:91]
    ds_read_b128 v[52:55], v19 offset:23552
    v_mfma_f32_16x16x32_bf16 v[92:95], a[92:95], v[60:63], v[92:95]
    s_mov_b64 exec, s[44:45]
    buffer_store_dwordx4 v[24:27], v30, s[8:11], s46 offen sc1
    s_mov_b64 exec, -1
    s_waitcnt lgkmcnt(4)
    v_mfma_f32_16x16x32_bf16 v[80:83], a[96:99], v[32:35], v[80:83]
    ds_read_b128 v[56:59], v20 offset:7168
    s_add_u32 m0, s29, 39040
    v_mfma_f32_16x16x32_bf16 v[84:87], a[100:103], v[32:35], v[84:87]
    buffer_load_dwordx4 v16, s[16:19], s34 offen offset:896 lds
    v_mfma_f32_16x16x32_bf16 v[88:91], a[96:99], v[36:39], v[88:91]
    ds_read_b128 v[60:63], v20 offset:23552
    v_mfma_f32_16x16x32_bf16 v[92:95], a[100:103], v[36:39], v[92:95]
    s_waitcnt lgkmcnt(4)
    v_mfma_f32_16x16x32_bf16 v[80:83], a[104:107], v[40:43], v[80:83]
    s_add_u32 s34, s34, 64512
    s_min_u32 s34, s34, 4128768
    v_mfma_f32_16x16x32_bf16 v[84:87], a[108:111], v[40:43], v[84:87]
    v_mfma_f32_16x16x32_bf16 v[88:91], a[104:107], v[44:47], v[88:91]
    v_mfma_f32_16x16x32_bf16 v[92:95], a[108:111], v[44:47], v[92:95]
    s_waitcnt lgkmcnt(0)
    s_cmp_lt_u32 s35, 2
    s_cselect_b64 s[70:71], s[36:37], 0
    s_cbranch_scc0 .ef_399
    s_waitcnt vmcnt(5)
.ef_399:
    s_waitcnt vmcnt(19)
    s_barrier
    ds_read_b128 v[32:35], v19 offset:32768
    ds_read_b128 v[36:39], v19 offset:49152
    v_mfma_f32_16x16x32_bf16 v[80:83], a[112:115], v[48:51], v[80:83]
    ds_read_b128 v[40:43], v20 offset:32768
    s_add_u32 m0, s29, 65536
    v_mfma_f32_16x16x32_bf16 v[84:87], a[116:119], v[48:51], v[84:87]
    buffer_load_dwordx4 v16, s[16:19], s34 offen offset:0 lds
    v_mfma_f32_16x16x32_bf16 v[88:91], a[112:115], v[52:55], v[88:91]
    ds_read_b128 v[44:47], v20 offset:49152
    v_mfma_f32_16x16x32_bf16 v[92:95], a[116:119], v[52:55], v[92:95]
    v_mfma_f32_16x16x32_bf16 v[80:83], a[120:123], v[56:59], v[80:83]
    ds_read_b128 v[48:51], v19 offset:33792
    v_mfma_f32_16x16x32_bf16 v[84:87], a[124:127], v[56:59], v[84:87]
    v_mfma_f32_16x16x32_bf16 v[88:91], a[120:123], v[60:63], v[88:91]
    ds_read_b128 v[52:55], v19 offset:50176
    v_mfma_f32_16x16x32_bf16 v[92:95], a[124:127], v[60:63], v[92:95]
    s_mov_b64 exec, s[70:71]
    buffer_store_dword v23, v22, s[8:11], s33 offen sc1
    s_mov_b64 exec, -1

    s_waitcnt lgkmcnt(4)
    v_mfma_f32_16x16x32_bf16 v[80:83], a[128:131], v[32:35], v[80:83]
    ds_read_b128 v[56:59], v20 offset:33792
    s_add_u32 m0, s29, 66432
    v_mfma_f32_16x16x32_bf16 v[84:87], a[132:135], v[32:35], v[84:87]
    buffer_load_dwordx4 v16, s[16:19], s34 offen offset:128 lds
    v_mfma_f32_16x16x32_bf16 v[88:91], a[128:131], v[36:39], v[88:91]
    ds_read_b128 v[60:63], v20 offset:50176
    v_mfma_f32_16x16x32_bf16 v[92:95], a[132:135], v[36:39], v[92:95]
    s_waitcnt lgkmcnt(4)
    v_mfma_f32_16x16x32_bf16 v[80:83], a[136:139], v[40:43], v[80:83]
    ds_read_b128 v[32:35], v19 offset:34816
    v_mfma_f32_16x16x32_bf16 v[84:87], a[140:143], v[40:43], v[84:87]
    v_mfma_f32_16x16x32_bf16 v[88:91], a[136:139], v[44:47], v[88:91]
    ds_read_b128 v[36:39], v19 offset:51200
    v_mfma_f32_16x16x32_bf16 v[92:95], a[140:143], v[44:47], v[92:95]
    s_waitcnt lgkmcnt(4)
    v_mfma_f32_16x16x32_bf16 v[80:83], a[144:147], v[48:51], v[80:83]
    ds_read_b128 v[40:43], v20 offset:34816
    s_add_u32 m0, s29, 67328
    v_mfma_f32_16x16x32_bf16 v[84:87], a[148:151], v[48:51], v[84:87]
    buffer_load_dwordx4 v16, s[16:19], s34 offen offset:256 lds
    v_mfma_f32_16x16x32_bf16 v[88:91], a[144:147], v[52:55], v[88:91]
    ds_read_b128 v[44:47], v20 offset:51200
    v_mfma_f32_16x16x32_bf16 v[92:95], a[148:151], v[52:55], v[92:95]
    s_waitcnt lgkmcnt(4)
    v_mfma_f32_16x16x32_bf16 v[80:83], a[152:155], v[56:59], v[80:83]
    ds_read_b128 v[48:51], v19 offset:35840
    v_mfma_f32_16x16x32_bf16 v[84:87], a[156:159], v[56:59], v[84:87]
    v_mfma_f32_16x16x32_bf16 v[88:91], a[152:155], v[60:63], v[88:91]
    ds_read_b128 v[52:55], v19 offset:52224
    v_mfma_f32_16x16x32_bf16 v[92:95], a[156:159], v[60:63], v[92:95]
    s_waitcnt lgkmcnt(4)
    v_mfma_f32_16x16x32_bf16 v[80:83], a[160:163], v[32:35], v[80:83]
    ds_read_b128 v[56:59], v20 offset:35840
    s_add_u32 m0, s29, 68224
    v_mfma_f32_16x16x32_bf16 v[84:87], a[164:167], v[32:35], v[84:87]
    buffer_load_dwordx4 v16, s[16:19], s34 offen offset:384 lds
    v_mfma_f32_16x16x32_bf16 v[88:91], a[160:163], v[36:39], v[88:91]
    ds_read_b128 v[60:63], v20 offset:52224
    v_mfma_f32_16x16x32_bf16 v[92:95], a[164:167], v[36:39], v[92:95]
    s_waitcnt lgkmcnt(4)
    v_mfma_f32_16x16x32_bf16 v[80:83], a[168:171], v[40:43], v[80:83]
    ds_read_b128 v[32:35], v19 offset:36864
    v_mfma_f32_16x16x32_bf16 v[84:87], a[172:175], v[40:43], v[84:87]
    v_mfma_f32_16x16x32_bf16 v[88:91], a[168:171], v[44:47], v[88:91]
    ds_read_b128 v[36:39], v19 offset:53248
    v_mfma_f32_16x16x32_bf16 v[92:95], a[172:175], v[44:47], v[92:95]
    s_waitcnt lgkmcnt(4)
    v_mfma_f32_16x16x32_bf16 v[80:83], a[176:179], v[48:51], v[80:83]
    ds_read_b128 v[40:43], v20 offset:36864
    s_add_u32 m0, s29, 69120
    v_mfma_f32_16x16x32_bf16 v[84:87], a[180:183], v[48:51], v[84:87]
    buffer_load_dwordx4 v16, s[16:19], s34 offen offset:512 lds
    v_mfma_f32_16x16x32_bf16 v[88:91], a[176:179], v[52:55], v[88:91]
    ds_read_b128 v[44:47], v20 offset:53248
    v_mfma_f32_16x16x32_bf16 v[92:95], a[180:183], v[52:55], v[92:95]
    s_waitcnt lgkmcnt(4)
    v_mfma_f32_16x16x32_bf16 v[80:83], a[184:187], v[56:59], v[80:83]
    ds_read_b128 v[48:51], v19 offset:37888
    v_mfma_f32_16x16x32_bf16 v[84:87], a[188:191], v[56:59], v[84:87]
    v_mfma_f32_16x16x32_bf16 v[88:91], a[184:187], v[60:63], v[88:91]
    ds_read_b128 v[52:55], v19 offset:54272
    v_mfma_f32_16x16x32_bf16 v[92:95], a[188:191], v[60:63], v[92:95]
    s_waitcnt lgkmcnt(4)
    v_mfma_f32_16x16x32_bf16 v[80:83], a[192:195], v[32:35], v[80:83]
    ds_read_b128 v[56:59], v20 offset:37888
    s_add_u32 m0, s29, 70016
    v_mfma_f32_16x16x32_bf16 v[84:87], a[196:199], v[32:35], v[84:87]
    buffer_load_dwordx4 v16, s[16:19], s34 offen offset:640 lds
    v_mfma_f32_16x16x32_bf16 v[88:91], a[192:195], v[36:39], v[88:91]
    ds_read_b128 v[60:63], v20 offset:54272
    v_mfma_f32_16x16x32_bf16 v[92:95], a[196:199], v[36:39], v[92:95]
    s_waitcnt lgkmcnt(4)
    v_mfma_f32_16x16x32_bf16 v[80:83], a[200:203], v[40:43], v[80:83]
    ds_read_b128 v[32:35], v19 offset:38912
    v_mfma_f32_16x16x32_bf16 v[84:87], a[204:207], v[40:43], v[84:87]
    v_mfma_f32_16x16x32_bf16 v[88:91], a[200:203], v[44:47], v[88:91]
    ds_read_b128 v[36:39], v19 offset:55296
    v_mfma_f32_16x16x32_bf16 v[92:95], a[204:207], v[44:47], v[92:95]
    s_waitcnt lgkmcnt(4)
    v_mfma_f32_16x16x32_bf16 v[80:83], a[208:211], v[48:51], v[80:83]
    ds_read_b128 v[40:43], v20 offset:38912
    s_add_u32 m0, s29, 70912
    v_mfma_f32_16x16x32_bf16 v[84:87], a[212:215], v[48:51], v[84:87]
    buffer_load_dwordx4 v16, s[16:19], s34 offen offset:768 lds
    v_mfma_f32_16x16x32_bf16 v[88:91], a[208:211], v[52:55], v[88:91]
    ds_read_b128 v[44:47], v20 offset:55296
    v_mfma_f32_16x16x32_bf16 v[92:95], a[212:215], v[52:55], v[92:95]
    s_waitcnt lgkmcnt(4)
    v_mfma_f32_16x16x32_bf16 v[80:83], a[216:219], v[56:59], v[80:83]
    ds_read_b128 v[48:51], v19 offset:39936
    v_mfma_f32_16x16x32_bf16 v[84:87], a[220:223], v[56:59], v[84:87]
    s_cmp_lt_u32 s35, 21
    s_cselect_b64 s[44:45], -1, 0
    v_mfma_f32_16x16x32_bf16 v[88:91], a[216:219], v[60:63], v[88:91]
    ds_read_b128 v[52:55], v19 offset:56320
    v_mfma_f32_16x16x32_bf16 v[92:95], a[220:223], v[60:63], v[92:95]
    s_cselect_b32 s4, 0x10000, 0
    s_add_u32 s46, s46, s4
    s_waitcnt lgkmcnt(4)
    v_mfma_f32_16x16x32_bf16 v[80:83], a[224:227], v[32:35], v[80:83]
    ds_read_b128 v[56:59], v20 offset:39936
    s_add_u32 m0, s29, 71808
    v_mfma_f32_16x16x32_bf16 v[84:87], a[228:231], v[32:35], v[84:87]
    buffer_load_dwordx4 v16, s[16:19], s34 offen offset:896 lds
    v_mfma_f32_16x16x32_bf16 v[88:91], a[224:227], v[36:39], v[88:91]
    ds_read_b128 v[60:63], v20 offset:56320
    v_mfma_f32_16x16x32_bf16 v[92:95], a[228:231], v[36:39], v[92:95]
    s_waitcnt lgkmcnt(4)
    v_mfma_f32_16x16x32_bf16 v[80:83], a[232:235], v[40:43], v[80:83]
    s_add_u32 s34, s34, 1024
    v_mfma_f32_16x16x32_bf16 v[84:87], a[236:239], v[40:43], v[84:87]
    v_mfma_f32_16x16x32_bf16 v[88:91], a[232:235], v[44:47], v[88:91]
    v_mfma_f32_16x16x32_bf16 v[92:95], a[236:239], v[44:47], v[92:95]
    s_waitcnt lgkmcnt(0)
    s_waitcnt vmcnt(13)
    s_barrier
    ds_read_b128 v[32:35], v17 offset:0
    ds_read_b128 v[36:39], v17 offset:16384
    v_mfma_f32_16x16x32_bf16 v[80:83], a[240:243], v[48:51], v[80:83]
    ds_read_b128 v[40:43], v18 offset:0
    s_add_u32 m0, s29, 98304
    v_mfma_f32_16x16x32_bf16 v[84:87], a[244:247], v[48:51], v[84:87]
    buffer_load_dwordx4 v16, s[16:19], s34 offen offset:0 lds
    v_mfma_f32_16x16x32_bf16 v[88:91], a[240:243], v[52:55], v[88:91]
    ds_read_b128 v[44:47], v18 offset:16384
    v_mfma_f32_16x16x32_bf16 v[92:95], a[244:247], v[52:55], v[92:95]
    v_mfma_f32_16x16x32_bf16 v[80:83], a[248:251], v[56:59], v[80:83]
    ds_read_b128 v[48:51], v17 offset:1024
    v_mfma_f32_16x16x32_bf16 v[84:87], a[252:255], v[56:59], v[84:87]
    v_mfma_f32_16x16x32_bf16 v[88:91], a[248:251], v[60:63], v[88:91]
    ds_read_b128 v[52:55], v17 offset:17408
    v_mfma_f32_16x16x32_bf16 v[92:95], a[252:255], v[60:63], v[92:95]
    s_mov_b64 exec, s[36:37]
    buffer_store_dword v23, v22, s[8:11], s33 offen sc1
    s_mov_b64 exec, -1

    s_add_u32 s35, s35, 1
    s_cmp_lt_u32 s35, 32
    s_cbranch_scc1 .ql_396

    s_nop 7
    v_cvt_pk_bf16_f32 v96, v80, v81
    v_cvt_pk_bf16_f32 v97, v82, v83
    v_cvt_pk_bf16_f32 v98, v84, v85
    v_cvt_pk_bf16_f32 v99, v86, v87
    buffer_store_dwordx4 v[96:99], v21, s[8:11], s32 offen sc1
    v_cvt_pk_bf16_f32 v100, v88, v89
    v_cvt_pk_bf16_f32 v101, v90, v91
    v_cvt_pk_bf16_f32 v102, v92, v93
    v_cvt_pk_bf16_f32 v103, v94, v95
    buffer_store_dwordx4 v[100:103], v21, s[8:11], s38 offen sc1
    s_mov_b32 exec_hi, 0
    buffer_store_dwordx4 v[24:27], v21, s[8:11], s48 offen sc1
    s_mov_b32 exec_hi, -1

    v_mov_b32 v23, 64
    s_waitcnt vmcnt(0) lgkmcnt(0)
    s_barrier
    s_mov_b64 exec, s[36:37]
    buffer_store_dword v23, v22, s[8:11], s33 offen sc1
    s_mov_b64 exec, -1

    s_branch .qd_376
.qv_375:
    s_waitcnt vmcnt(16)
    s_barrier
    ds_read_b128 v[32:35], v19 offset:0
    ds_read_b128 v[36:39], v19 offset:16384
    ds_read_b128 v[40:43], v20 offset:0
    ds_read_b128 v[44:47], v20 offset:16384
    s_add_u32 m0, s29, 32768
    s_nop 0
    buffer_load_dwordx4 v16, s[16:19], s34 offen offset:0 lds
    ds_read_b128 v[48:51], v19 offset:1024
    ds_read_b128 v[52:55], v19 offset:17408
    s_branch .qe_401
.p2align 6
.ql_400:
    s_waitcnt lgkmcnt(4)
    v_mfma_f32_16x16x32_bf16 v[64:67], v[32:35], a[0:3], 0
    ds_read_b128 v[56:59], v18 offset:1024
    s_add_u32 m0, s29, 99200
    v_mfma_f32_16x16x32_bf16 v[68:71], v[32:35], a[4:7], 0
    buffer_load_dwordx4 v16, s[16:19], s34 offen offset:128 lds
    v_mfma_f32_16x16x32_bf16 v[72:75], v[36:39], a[0:3], 0
    ds_read_b128 v[60:63], v18 offset:17408
    v_mfma_f32_16x16x32_bf16 v[76:79], v[36:39], a[4:7], 0
    s_mov_b32 exec_hi, 0
    buffer_store_dwordx4 v[24:27], v21, s[8:11], s48 offen sc1
    s_mov_b32 exec_hi, -1

    s_waitcnt lgkmcnt(4)
    v_mfma_f32_16x16x32_bf16 v[64:67], v[40:43], a[8:11], v[64:67]
    ds_read_b128 v[32:35], v17 offset:2048
    v_mfma_f32_16x16x32_bf16 v[68:71], v[40:43], a[12:15], v[68:71]
    v_cvt_pk_bf16_f32 v96, v80, v81
    v_cvt_pk_bf16_f32 v97, v82, v83
    v_cvt_pk_bf16_f32 v98, v88, v89
    v_mfma_f32_16x16x32_bf16 v[72:75], v[44:47], a[8:11], v[72:75]
    ds_read_b128 v[36:39], v17 offset:18432
    v_mfma_f32_16x16x32_bf16 v[76:79], v[44:47], a[12:15], v[76:79]
    v_cvt_pk_bf16_f32 v99, v90, v91
    v_cvt_pk_bf16_f32 v100, v84, v85
    buffer_store_dwordx4 v[96:99], v21, s[8:11], s32 offen offset:0 sc1
    s_waitcnt lgkmcnt(4)
    v_mfma_f32_16x16x32_bf16 v[64:67], v[48:51], a[16:19], v[64:67]
    ds_read_b128 v[40:43], v18 offset:2048
    s_add_u32 m0, s29, 100096
    v_mfma_f32_16x16x32_bf16 v[68:71], v[48:51], a[20:23], v[68:71]
    buffer_load_dwordx4 v16, s[16:19], s34 offen offset:256 lds
    v_mfma_f32_16x16x32_bf16 v[72:75], v[52:55], a[16:19], v[72:75]
    ds_read_b128 v[44:47], v18 offset:18432
    v_mfma_f32_16x16x32_bf16 v[76:79], v[52:55], a[20:23], v[76:79]
    v_cvt_pk_bf16_f32 v101, v86, v87
    v_cvt_pk_bf16_f32 v102, v92, v93
    v_cvt_pk_bf16_f32 v103, v94, v95
    s_waitcnt lgkmcnt(4)
    v_mfma_f32_16x16x32_bf16 v[64:67], v[56:59], a[24:27], v[64:67]
    ds_read_b128 v[48:51], v17 offset:3072
    v_mfma_f32_16x16x32_bf16 v[68:71], v[56:59], a[28:31], v[68:71]
    buffer_store_dwordx4 v[100:103], v21, s[8:11], s32 offen offset:1024 sc1
    v_mfma_f32_16x16x32_bf16 v[72:75], v[60:63], a[24:27], v[72:75]
    ds_read_b128 v[52:55], v17 offset:19456
    v_mfma_f32_16x16x32_bf16 v[76:79], v[60:63], a[28:31], v[76:79]
    s_waitcnt lgkmcnt(4)
    v_mfma_f32_16x16x32_bf16 v[64:67], v[32:35], a[32:35], v[64:67]
    ds_read_b128 v[56:59], v18 offset:3072
    s_add_u32 m0, s29, 100992
    v_mfma_f32_16x16x32_bf16 v[68:71], v[32:35], a[36:39], v[68:71]
    buffer_load_dwordx4 v16, s[16:19], s34 offen offset:384 lds
    v_mfma_f32_16x16x32_bf16 v[72:75], v[36:39], a[32:35], v[72:75]
    ds_read_b128 v[60:63], v18 offset:19456
    v_mfma_f32_16x16x32_bf16 v[76:79], v[36:39], a[36:39], v[76:79]
    s_waitcnt lgkmcnt(4)
    v_mfma_f32_16x16x32_bf16 v[64:67], v[40:43], a[40:43], v[64:67]
    ds_read_b128 v[32:35], v17 offset:4096
    v_mfma_f32_16x16x32_bf16 v[68:71], v[40:43], a[44:47], v[68:71]
    v_mfma_f32_16x16x32_bf16 v[72:75], v[44:47], a[40:43], v[72:75]
    ds_read_b128 v[36:39], v17 offset:20480
    v_mfma_f32_16x16x32_bf16 v[76:79], v[44:47], a[44:47], v[76:79]
    s_waitcnt lgkmcnt(4)
    v_mfma_f32_16x16x32_bf16 v[64:67], v[48:51], a[48:51], v[64:67]
    ds_read_b128 v[40:43], v18 offset:4096
    s_add_u32 m0, s29, 101888
    v_mfma_f32_16x16x32_bf16 v[68:71], v[48:51], a[52:55], v[68:71]
    buffer_load_dwordx4 v16, s[16:19], s34 offen offset:512 lds
    v_mfma_f32_16x16x32_bf16 v[72:75], v[52:55], a[48:51], v[72:75]
    ds_read_b128 v[44:47], v18 offset:20480
    v_mfma_f32_16x16x32_bf16 v[76:79], v[52:55], a[52:55], v[76:79]
    s_waitcnt lgkmcnt(4)
    v_mfma_f32_16x16x32_bf16 v[64:67], v[56:59], a[56:59], v[64:67]
    ds_read_b128 v[48:51], v17 offset:5120
    v_mfma_f32_16x16x32_bf16 v[68:71], v[56:59], a[60:63], v[68:71]
    v_mfma_f32_16x16x32_bf16 v[72:75], v[60:63], a[56:59], v[72:75]
    ds_read_b128 v[52:55], v17 offset:21504
    v_mfma_f32_16x16x32_bf16 v[76:79], v[60:63], a[60:63], v[76:79]
    s_waitcnt lgkmcnt(4)
    v_mfma_f32_16x16x32_bf16 v[64:67], v[32:35], a[64:67], v[64:67]
    ds_read_b128 v[56:59], v18 offset:5120
    s_add_u32 m0, s29, 102784
    v_mfma_f32_16x16x32_bf16 v[68:71], v[32:35], a[68:71], v[68:71]
    buffer_load_dwordx4 v16, s[16:19], s34 offen offset:640 lds
    v_mfma_f32_16x16x32_bf16 v[72:75], v[36:39], a[64:67], v[72:75]
    ds_read_b128 v[60:63], v18 offset:21504
    v_mfma_f32_16x16x32_bf16 v[76:79], v[36:39], a[68:71], v[76:79]
    s_waitcnt lgkmcnt(4)
    v_mfma_f32_16x16x32_bf16 v[64:67], v[40:43], a[72:75], v[64:67]
    ds_read_b128 v[32:35], v17 offset:6144
    v_mfma_f32_16x16x32_bf16 v[68:71], v[40:43], a[76:79], v[68:71]
    s_mov_b32 s32, s39
    s_add_u32 s38, s39, 4096
    s_add_u32 s39, s39, 262144
    s_mov_b32 s48, s49
    s_add_u32 s49, s49, 196608
    v_mfma_f32_16x16x32_bf16 v[72:75], v[44:47], a[72:75], v[72:75]
    ds_read_b128 v[36:39], v17 offset:22528
    v_mfma_f32_16x16x32_bf16 v[76:79], v[44:47], a[76:79], v[76:79]
    v_add_u32 v23, 1, v23
    s_waitcnt lgkmcnt(4)
    v_mfma_f32_16x16x32_bf16 v[64:67], v[48:51], a[80:83], v[64:67]
    ds_read_b128 v[40:43], v18 offset:6144
    s_add_u32 m0, s29, 103680
    v_mfma_f32_16x16x32_bf16 v[68:71], v[48:51], a[84:87], v[68:71]
    buffer_load_dwordx4 v16, s[16:19], s34 offen offset:768 lds
    v_mfma_f32_16x16x32_bf16 v[72:75], v[52:55], a[80:83], v[72:75]
    ds_read_b128 v[44:47], v18 offset:22528
    v_mfma_f32_16x16x32_bf16 v[76:79], v[52:55], a[84:87], v[76:79]
    s_waitcnt lgkmcnt(4)
    v_mfma_f32_16x16x32_bf16 v[64:67], v[56:59], a[88:91], v[64:67]
    ds_read_b128 v[48:51], v17 offset:7168
    v_mfma_f32_16x16x32_bf16 v[68:71], v[56:59], a[92:95], v[68:71]
    v_mfma_f32_16x16x32_bf16 v[72:75], v[60:63], a[88:91], v[72:75]
    ds_read_b128 v[52:55], v17 offset:23552
    v_mfma_f32_16x16x32_bf16 v[76:79], v[60:63], a[92:95], v[76:79]
    s_mov_b64 exec, s[44:45]
    buffer_store_dwordx4 v[24:27], v28, s[8:11], s46 offen sc1
    s_mov_b64 exec, -1
    s_waitcnt lgkmcnt(4)
    v_mfma_f32_16x16x32_bf16 v[64:67], v[32:35], a[96:99], v[64:67]
    ds_read_b128 v[56:59], v18 offset:7168
    s_add_u32 m0, s29, 104576
    v_mfma_f32_16x16x32_bf16 v[68:71], v[32:35], a[100:103], v[68:71]
    buffer_load_dwordx4 v16, s[16:19], s34 offen offset:896 lds
    v_mfma_f32_16x16x32_bf16 v[72:75], v[36:39], a[96:99], v[72:75]
    ds_read_b128 v[60:63], v18 offset:23552
    v_mfma_f32_16x16x32_bf16 v[76:79], v[36:39], a[100:103], v[76:79]
    s_waitcnt lgkmcnt(4)
    v_mfma_f32_16x16x32_bf16 v[64:67], v[40:43], a[104:107], v[64:67]
    s_add_u32 s34, s34, 64512
    s_min_u32 s34, s34, 4128768
    v_mfma_f32_16x16x32_bf16 v[68:71], v[40:43], a[108:111], v[68:71]
    v_mfma_f32_16x16x32_bf16 v[72:75], v[44:47], a[104:107], v[72:75]
    v_mfma_f32_16x16x32_bf16 v[76:79], v[44:47], a[108:111], v[76:79]
    s_waitcnt lgkmcnt(0)
    s_cmp_lt_u32 s35, 2
    s_cselect_b64 s[70:71], s[36:37], 0
    s_cbranch_scc0 .ef_402
    s_waitcnt vmcnt(5)
.ef_402:
    s_waitcnt vmcnt(19)
    s_barrier
    ds_read_b128 v[32:35], v17 offset:32768
    ds_read_b128 v[36:39], v17 offset:49152
    v_mfma_f32_16x16x32_bf16 v[64:67], v[48:51], a[112:115], v[64:67]
    ds_read_b128 v[40:43], v18 offset:32768
    s_add_u32 m0, s29, 0
    v_mfma_f32_16x16x32_bf16 v[68:71], v[48:51], a[116:119], v[68:71]
    buffer_load_dwordx4 v16, s[16:19], s34 offen offset:0 lds
    v_mfma_f32_16x16x32_bf16 v[72:75], v[52:55], a[112:115], v[72:75]
    ds_read_b128 v[44:47], v18 offset:49152
    v_mfma_f32_16x16x32_bf16 v[76:79], v[52:55], a[116:119], v[76:79]
    v_mfma_f32_16x16x32_bf16 v[64:67], v[56:59], a[120:123], v[64:67]
    ds_read_b128 v[48:51], v17 offset:33792
    v_mfma_f32_16x16x32_bf16 v[68:71], v[56:59], a[124:127], v[68:71]
    v_mfma_f32_16x16x32_bf16 v[72:75], v[60:63], a[120:123], v[72:75]
    ds_read_b128 v[52:55], v17 offset:50176
    v_mfma_f32_16x16x32_bf16 v[76:79], v[60:63], a[124:127], v[76:79]
    s_mov_b64 exec, s[70:71]
    buffer_store_dword v23, v22, s[8:11], s33 offen sc1
    s_mov_b64 exec, -1

    s_waitcnt lgkmcnt(4)
    v_mfma_f32_16x16x32_bf16 v[64:67], v[32:35], a[128:131], v[64:67]
    ds_read_b128 v[56:59], v18 offset:33792
    s_add_u32 m0, s29, 896
    v_mfma_f32_16x16x32_bf16 v[68:71], v[32:35], a[132:135], v[68:71]
    buffer_load_dwordx4 v16, s[16:19], s34 offen offset:128 lds
    v_mfma_f32_16x16x32_bf16 v[72:75], v[36:39], a[128:131], v[72:75]
    ds_read_b128 v[60:63], v18 offset:50176
    v_mfma_f32_16x16x32_bf16 v[76:79], v[36:39], a[132:135], v[76:79]
    s_waitcnt lgkmcnt(4)
    v_mfma_f32_16x16x32_bf16 v[64:67], v[40:43], a[136:139], v[64:67]
    ds_read_b128 v[32:35], v17 offset:34816
    v_mfma_f32_16x16x32_bf16 v[68:71], v[40:43], a[140:143], v[68:71]
    v_mfma_f32_16x16x32_bf16 v[72:75], v[44:47], a[136:139], v[72:75]
    ds_read_b128 v[36:39], v17 offset:51200
    v_mfma_f32_16x16x32_bf16 v[76:79], v[44:47], a[140:143], v[76:79]
    s_waitcnt lgkmcnt(4)
    v_mfma_f32_16x16x32_bf16 v[64:67], v[48:51], a[144:147], v[64:67]
    ds_read_b128 v[40:43], v18 offset:34816
    s_add_u32 m0, s29, 1792
    v_mfma_f32_16x16x32_bf16 v[68:71], v[48:51], a[148:151], v[68:71]
    buffer_load_dwordx4 v16, s[16:19], s34 offen offset:256 lds
    v_mfma_f32_16x16x32_bf16 v[72:75], v[52:55], a[144:147], v[72:75]
    ds_read_b128 v[44:47], v18 offset:51200
    v_mfma_f32_16x16x32_bf16 v[76:79], v[52:55], a[148:151], v[76:79]
    s_waitcnt lgkmcnt(4)
    v_mfma_f32_16x16x32_bf16 v[64:67], v[56:59], a[152:155], v[64:67]
    ds_read_b128 v[48:51], v17 offset:35840
    v_mfma_f32_16x16x32_bf16 v[68:71], v[56:59], a[156:159], v[68:71]
    v_mfma_f32_16x16x32_bf16 v[72:75], v[60:63], a[152:155], v[72:75]
    ds_read_b128 v[52:55], v17 offset:52224
    v_mfma_f32_16x16x32_bf16 v[76:79], v[60:63], a[156:159], v[76:79]
    s_waitcnt lgkmcnt(4)
    v_mfma_f32_16x16x32_bf16 v[64:67], v[32:35], a[160:163], v[64:67]
    ds_read_b128 v[56:59], v18 offset:35840
    s_add_u32 m0, s29, 2688
    v_mfma_f32_16x16x32_bf16 v[68:71], v[32:35], a[164:167], v[68:71]
    buffer_load_dwordx4 v16, s[16:19], s34 offen offset:384 lds
    v_mfma_f32_16x16x32_bf16 v[72:75], v[36:39], a[160:163], v[72:75]
    ds_read_b128 v[60:63], v18 offset:52224
    v_mfma_f32_16x16x32_bf16 v[76:79], v[36:39], a[164:167], v[76:79]
    s_waitcnt lgkmcnt(4)
    v_mfma_f32_16x16x32_bf16 v[64:67], v[40:43], a[168:171], v[64:67]
    ds_read_b128 v[32:35], v17 offset:36864
    v_mfma_f32_16x16x32_bf16 v[68:71], v[40:43], a[172:175], v[68:71]
    v_mfma_f32_16x16x32_bf16 v[72:75], v[44:47], a[168:171], v[72:75]
    ds_read_b128 v[36:39], v17 offset:53248
    v_mfma_f32_16x16x32_bf16 v[76:79], v[44:47], a[172:175], v[76:79]
    s_waitcnt lgkmcnt(4)
    v_mfma_f32_16x16x32_bf16 v[64:67], v[48:51], a[176:179], v[64:67]
    ds_read_b128 v[40:43], v18 offset:36864
    s_add_u32 m0, s29, 3584
    v_mfma_f32_16x16x32_bf16 v[68:71], v[48:51], a[180:183], v[68:71]
    buffer_load_dwordx4 v16, s[16:19], s34 offen offset:512 lds
    v_mfma_f32_16x16x32_bf16 v[72:75], v[52:55], a[176:179], v[72:75]
    ds_read_b128 v[44:47], v18 offset:53248
    v_mfma_f32_16x16x32_bf16 v[76:79], v[52:55], a[180:183], v[76:79]
    s_waitcnt lgkmcnt(4)
    v_mfma_f32_16x16x32_bf16 v[64:67], v[56:59], a[184:187], v[64:67]
    ds_read_b128 v[48:51], v17 offset:37888
    v_mfma_f32_16x16x32_bf16 v[68:71], v[56:59], a[188:191], v[68:71]
    v_mfma_f32_16x16x32_bf16 v[72:75], v[60:63], a[184:187], v[72:75]
    ds_read_b128 v[52:55], v17 offset:54272
    v_mfma_f32_16x16x32_bf16 v[76:79], v[60:63], a[188:191], v[76:79]
    s_waitcnt lgkmcnt(4)
    v_mfma_f32_16x16x32_bf16 v[64:67], v[32:35], a[192:195], v[64:67]
    ds_read_b128 v[56:59], v18 offset:37888
    s_add_u32 m0, s29, 4480
    v_mfma_f32_16x16x32_bf16 v[68:71], v[32:35], a[196:199], v[68:71]
    buffer_load_dwordx4 v16, s[16:19], s34 offen offset:640 lds
    v_mfma_f32_16x16x32_bf16 v[72:75], v[36:39], a[192:195], v[72:75]
    ds_read_b128 v[60:63], v18 offset:54272
    v_mfma_f32_16x16x32_bf16 v[76:79], v[36:39], a[196:199], v[76:79]
    s_waitcnt lgkmcnt(4)
    v_mfma_f32_16x16x32_bf16 v[64:67], v[40:43], a[200:203], v[64:67]
    ds_read_b128 v[32:35], v17 offset:38912
    v_mfma_f32_16x16x32_bf16 v[68:71], v[40:43], a[204:207], v[68:71]
    v_mfma_f32_16x16x32_bf16 v[72:75], v[44:47], a[200:203], v[72:75]
    ds_read_b128 v[36:39], v17 offset:55296
    v_mfma_f32_16x16x32_bf16 v[76:79], v[44:47], a[204:207], v[76:79]
    s_waitcnt lgkmcnt(4)
    v_mfma_f32_16x16x32_bf16 v[64:67], v[48:51], a[208:211], v[64:67]
    ds_read_b128 v[40:43], v18 offset:38912
    s_add_u32 m0, s29, 5376
    v_mfma_f32_16x16x32_bf16 v[68:71], v[48:51], a[212:215], v[68:71]
    buffer_load_dwordx4 v16, s[16:19], s34 offen offset:768 lds
    v_mfma_f32_16x16x32_bf16 v[72:75], v[52:55], a[208:211], v[72:75]
    ds_read_b128 v[44:47], v18 offset:55296
    v_mfma_f32_16x16x32_bf16 v[76:79], v[52:55], a[212:215], v[76:79]
    s_waitcnt lgkmcnt(4)
    v_mfma_f32_16x16x32_bf16 v[64:67], v[56:59], a[216:219], v[64:67]
    ds_read_b128 v[48:51], v17 offset:39936
    v_mfma_f32_16x16x32_bf16 v[68:71], v[56:59], a[220:223], v[68:71]
    v_mfma_f32_16x16x32_bf16 v[72:75], v[60:63], a[216:219], v[72:75]
    ds_read_b128 v[52:55], v17 offset:56320
    v_mfma_f32_16x16x32_bf16 v[76:79], v[60:63], a[220:223], v[76:79]
    s_mov_b64 exec, s[44:45]
    buffer_store_dwordx4 v[24:27], v29, s[8:11], s46 offen sc1
    s_mov_b64 exec, -1
    s_waitcnt lgkmcnt(4)
    v_mfma_f32_16x16x32_bf16 v[64:67], v[32:35], a[224:227], v[64:67]
    ds_read_b128 v[56:59], v18 offset:39936
    s_add_u32 m0, s29, 6272
    v_mfma_f32_16x16x32_bf16 v[68:71], v[32:35], a[228:231], v[68:71]
    buffer_load_dwordx4 v16, s[16:19], s34 offen offset:896 lds
    v_mfma_f32_16x16x32_bf16 v[72:75], v[36:39], a[224:227], v[72:75]
    ds_read_b128 v[60:63], v18 offset:56320
    v_mfma_f32_16x16x32_bf16 v[76:79], v[36:39], a[228:231], v[76:79]
    s_waitcnt lgkmcnt(4)
    v_mfma_f32_16x16x32_bf16 v[64:67], v[40:43], a[232:235], v[64:67]
    s_add_u32 s34, s34, 1024
    v_mfma_f32_16x16x32_bf16 v[68:71], v[40:43], a[236:239], v[68:71]
    v_mfma_f32_16x16x32_bf16 v[72:75], v[44:47], a[232:235], v[72:75]
    v_mfma_f32_16x16x32_bf16 v[76:79], v[44:47], a[236:239], v[76:79]
    s_waitcnt lgkmcnt(0)
    s_waitcnt vmcnt(13)
    s_barrier
    ds_read_b128 v[32:35], v19 offset:0
    ds_read_b128 v[36:39], v19 offset:16384
    v_mfma_f32_16x16x32_bf16 v[64:67], v[48:51], a[240:243], v[64:67]
    ds_read_b128 v[40:43], v20 offset:0
    s_add_u32 m0, s29, 32768
    v_mfma_f32_16x16x32_bf16 v[68:71], v[48:51], a[244:247], v[68:71]
    buffer_load_dwordx4 v16, s[16:19], s34 offen offset:0 lds
    v_mfma_f32_16x16x32_bf16 v[72:75], v[52:55], a[240:243], v[72:75]
    ds_read_b128 v[44:47], v20 offset:16384
    v_mfma_f32_16x16x32_bf16 v[76:79], v[52:55], a[244:247], v[76:79]
    v_mfma_f32_16x16x32_bf16 v[64:67], v[56:59], a[248:251], v[64:67]
    ds_read_b128 v[48:51], v19 offset:1024
    v_mfma_f32_16x16x32_bf16 v[68:71], v[56:59], a[252:255], v[68:71]
    v_mfma_f32_16x16x32_bf16 v[72:75], v[60:63], a[248:251], v[72:75]
    ds_read_b128 v[52:55], v19 offset:17408
    v_mfma_f32_16x16x32_bf16 v[76:79], v[60:63], a[252:255], v[76:79]
    s_mov_b64 exec, s[36:37]
    buffer_store_dword v23, v22, s[8:11], s33 offen sc1
    s_mov_b64 exec, -1

.qe_401:
    s_waitcnt lgkmcnt(4)
    v_mfma_f32_16x16x32_bf16 v[80:83], v[32:35], a[0:3], 0
    ds_read_b128 v[56:59], v20 offset:1024
    s_add_u32 m0, s29, 33664
    v_mfma_f32_16x16x32_bf16 v[84:87], v[32:35], a[4:7], 0
    buffer_load_dwordx4 v16, s[16:19], s34 offen offset:128 lds
    v_mfma_f32_16x16x32_bf16 v[88:91], v[36:39], a[0:3], 0
    ds_read_b128 v[60:63], v20 offset:17408
    v_mfma_f32_16x16x32_bf16 v[92:95], v[36:39], a[4:7], 0
    s_mov_b32 exec_hi, 0
    buffer_store_dwordx4 v[24:27], v21, s[8:11], s48 offen sc1
    s_mov_b32 exec_hi, -1

    s_waitcnt lgkmcnt(4)
    v_mfma_f32_16x16x32_bf16 v[80:83], v[40:43], a[8:11], v[80:83]
    ds_read_b128 v[32:35], v19 offset:2048
    v_mfma_f32_16x16x32_bf16 v[84:87], v[40:43], a[12:15], v[84:87]
    v_cvt_pk_bf16_f32 v96, v64, v65
    v_cvt_pk_bf16_f32 v97, v66, v67
    v_cvt_pk_bf16_f32 v98, v72, v73
    v_mfma_f32_16x16x32_bf16 v[88:91], v[44:47], a[8:11], v[88:91]
    ds_read_b128 v[36:39], v19 offset:18432
    v_mfma_f32_16x16x32_bf16 v[92:95], v[44:47], a[12:15], v[92:95]
    v_cvt_pk_bf16_f32 v99, v74, v75
    v_cvt_pk_bf16_f32 v100, v68, v69
    buffer_store_dwordx4 v[96:99], v21, s[8:11], s32 offen offset:0 sc1
    s_waitcnt lgkmcnt(4)
    v_mfma_f32_16x16x32_bf16 v[80:83], v[48:51], a[16:19], v[80:83]
    ds_read_b128 v[40:43], v20 offset:2048
    s_add_u32 m0, s29, 34560
    v_mfma_f32_16x16x32_bf16 v[84:87], v[48:51], a[20:23], v[84:87]
    buffer_load_dwordx4 v16, s[16:19], s34 offen offset:256 lds
    v_mfma_f32_16x16x32_bf16 v[88:91], v[52:55], a[16:19], v[88:91]
    ds_read_b128 v[44:47], v20 offset:18432
    v_mfma_f32_16x16x32_bf16 v[92:95], v[52:55], a[20:23], v[92:95]
    v_cvt_pk_bf16_f32 v101, v70, v71
    v_cvt_pk_bf16_f32 v102, v76, v77
    v_cvt_pk_bf16_f32 v103, v78, v79
    s_waitcnt lgkmcnt(4)
    v_mfma_f32_16x16x32_bf16 v[80:83], v[56:59], a[24:27], v[80:83]
    ds_read_b128 v[48:51], v19 offset:3072
    v_mfma_f32_16x16x32_bf16 v[84:87], v[56:59], a[28:31], v[84:87]
    buffer_store_dwordx4 v[100:103], v21, s[8:11], s32 offen offset:1024 sc1
    v_mfma_f32_16x16x32_bf16 v[88:91], v[60:63], a[24:27], v[88:91]
    ds_read_b128 v[52:55], v19 offset:19456
    v_mfma_f32_16x16x32_bf16 v[92:95], v[60:63], a[28:31], v[92:95]
    s_waitcnt lgkmcnt(4)
    v_mfma_f32_16x16x32_bf16 v[80:83], v[32:35], a[32:35], v[80:83]
    ds_read_b128 v[56:59], v20 offset:3072
    s_add_u32 m0, s29, 35456
    v_mfma_f32_16x16x32_bf16 v[84:87], v[32:35], a[36:39], v[84:87]
    buffer_load_dwordx4 v16, s[16:19], s34 offen offset:384 lds
    v_mfma_f32_16x16x32_bf16 v[88:91], v[36:39], a[32:35], v[88:91]
    ds_read_b128 v[60:63], v20 offset:19456
    v_mfma_f32_16x16x32_bf16 v[92:95], v[36:39], a[36:39], v[92:95]
    s_waitcnt lgkmcnt(4)
    v_mfma_f32_16x16x32_bf16 v[80:83], v[40:43], a[40:43], v[80:83]
    ds_read_b128 v[32:35], v19 offset:4096
    v_mfma_f32_16x16x32_bf16 v[84:87], v[40:43], a[44:47], v[84:87]
    v_mfma_f32_16x16x32_bf16 v[88:91], v[44:47], a[40:43], v[88:91]
    ds_read_b128 v[36:39], v19 offset:20480
    v_mfma_f32_16x16x32_bf16 v[92:95], v[44:47], a[44:47], v[92:95]
    s_waitcnt lgkmcnt(4)
    v_mfma_f32_16x16x32_bf16 v[80:83], v[48:51], a[48:51], v[80:83]
    ds_read_b128 v[40:43], v20 offset:4096
    s_add_u32 m0, s29, 36352
    v_mfma_f32_16x16x32_bf16 v[84:87], v[48:51], a[52:55], v[84:87]
    buffer_load_dwordx4 v16, s[16:19], s34 offen offset:512 lds
    v_mfma_f32_16x16x32_bf16 v[88:91], v[52:55], a[48:51], v[88:91]
    ds_read_b128 v[44:47], v20 offset:20480
    v_mfma_f32_16x16x32_bf16 v[92:95], v[52:55], a[52:55], v[92:95]
    s_waitcnt lgkmcnt(4)
    v_mfma_f32_16x16x32_bf16 v[80:83], v[56:59], a[56:59], v[80:83]
    ds_read_b128 v[48:51], v19 offset:5120
    v_mfma_f32_16x16x32_bf16 v[84:87], v[56:59], a[60:63], v[84:87]
    v_mfma_f32_16x16x32_bf16 v[88:91], v[60:63], a[56:59], v[88:91]
    ds_read_b128 v[52:55], v19 offset:21504
    v_mfma_f32_16x16x32_bf16 v[92:95], v[60:63], a[60:63], v[92:95]
    s_waitcnt lgkmcnt(4)
    v_mfma_f32_16x16x32_bf16 v[80:83], v[32:35], a[64:67], v[80:83]
    ds_read_b128 v[56:59], v20 offset:5120
    s_add_u32 m0, s29, 37248
    v_mfma_f32_16x16x32_bf16 v[84:87], v[32:35], a[68:71], v[84:87]
    buffer_load_dwordx4 v16, s[16:19], s34 offen offset:640 lds
    v_mfma_f32_16x16x32_bf16 v[88:91], v[36:39], a[64:67], v[88:91]
    ds_read_b128 v[60:63], v20 offset:21504
    v_mfma_f32_16x16x32_bf16 v[92:95], v[36:39], a[68:71], v[92:95]
    s_waitcnt lgkmcnt(4)
    v_mfma_f32_16x16x32_bf16 v[80:83], v[40:43], a[72:75], v[80:83]
    ds_read_b128 v[32:35], v19 offset:6144
    v_mfma_f32_16x16x32_bf16 v[84:87], v[40:43], a[76:79], v[84:87]
    s_mov_b32 s32, s39
    s_add_u32 s38, s39, 4096
    s_add_u32 s39, s39, 262144
    s_mov_b32 s48, s49
    s_add_u32 s49, s49, 196608
    v_mfma_f32_16x16x32_bf16 v[88:91], v[44:47], a[72:75], v[88:91]
    ds_read_b128 v[36:39], v19 offset:22528
    v_mfma_f32_16x16x32_bf16 v[92:95], v[44:47], a[76:79], v[92:95]
    v_add_u32 v23, 1, v23
    s_waitcnt lgkmcnt(4)
    v_mfma_f32_16x16x32_bf16 v[80:83], v[48:51], a[80:83], v[80:83]
    ds_read_b128 v[40:43], v20 offset:6144
    s_add_u32 m0, s29, 38144
    v_mfma_f32_16x16x32_bf16 v[84:87], v[48:51], a[84:87], v[84:87]
    buffer_load_dwordx4 v16, s[16:19], s34 offen offset:768 lds
    v_mfma_f32_16x16x32_bf16 v[88:91], v[52:55], a[80:83], v[88:91]
    ds_read_b128 v[44:47], v20 offset:22528
    v_mfma_f32_16x16x32_bf16 v[92:95], v[52:55], a[84:87], v[92:95]
    s_waitcnt lgkmcnt(4)
    v_mfma_f32_16x16x32_bf16 v[80:83], v[56:59], a[88:91], v[80:83]
    ds_read_b128 v[48:51], v19 offset:7168
    v_mfma_f32_16x16x32_bf16 v[84:87], v[56:59], a[92:95], v[84:87]
    v_mfma_f32_16x16x32_bf16 v[88:91], v[60:63], a[88:91], v[88:91]
    ds_read_b128 v[52:55], v19 offset:23552
    v_mfma_f32_16x16x32_bf16 v[92:95], v[60:63], a[92:95], v[92:95]
    s_mov_b64 exec, s[44:45]
    buffer_store_dwordx4 v[24:27], v30, s[8:11], s46 offen sc1
    s_mov_b64 exec, -1
    s_waitcnt lgkmcnt(4)
    v_mfma_f32_16x16x32_bf16 v[80:83], v[32:35], a[96:99], v[80:83]
    ds_read_b128 v[56:59], v20 offset:7168
    s_add_u32 m0, s29, 39040
    v_mfma_f32_16x16x32_bf16 v[84:87], v[32:35], a[100:103], v[84:87]
    buffer_load_dwordx4 v16, s[16:19], s34 offen offset:896 lds
    v_mfma_f32_16x16x32_bf16 v[88:91], v[36:39], a[96:99], v[88:91]
    ds_read_b128 v[60:63], v20 offset:23552
    v_mfma_f32_16x16x32_bf16 v[92:95], v[36:39], a[100:103], v[92:95]
    s_waitcnt lgkmcnt(4)
    v_mfma_f32_16x16x32_bf16 v[80:83], v[40:43], a[104:107], v[80:83]
    s_add_u32 s34, s34, 64512
    s_min_u32 s34, s34, 4128768
    v_mfma_f32_16x16x32_bf16 v[84:87], v[40:43], a[108:111], v[84:87]
    v_mfma_f32_16x16x32_bf16 v[88:91], v[44:47], a[104:107], v[88:91]
    v_mfma_f32_16x16x32_bf16 v[92:95], v[44:47], a[108:111], v[92:95]
    s_waitcnt lgkmcnt(0)
    s_cmp_lt_u32 s35, 2
    s_cselect_b64 s[70:71], s[36:37], 0
    s_cbranch_scc0 .ef_403
    s_waitcnt vmcnt(5)
.ef_403:
    s_waitcnt vmcnt(19)
    s_barrier
    ds_read_b128 v[32:35], v19 offset:32768
    ds_read_b128 v[36:39], v19 offset:49152
    v_mfma_f32_16x16x32_bf16 v[80:83], v[48:51], a[112:115], v[80:83]
    ds_read_b128 v[40:43], v20 offset:32768
    s_add_u32 m0, s29, 65536
    v_mfma_f32_16x16x32_bf16 v[84:87], v[48:51], a[116:119], v[84:87]
    buffer_load_dwordx4 v16, s[16:19], s34 offen offset:0 lds
    v_mfma_f32_16x16x32_bf16 v[88:91], v[52:55], a[112:115], v[88:91]
    ds_read_b128 v[44:47], v20 offset:49152
    v_mfma_f32_16x16x32_bf16 v[92:95], v[52:55], a[116:119], v[92:95]
    v_mfma_f32_16x16x32_bf16 v[80:83], v[56:59], a[120:123], v[80:83]
    ds_read_b128 v[48:51], v19 offset:33792
    v_mfma_f32_16x16x32_bf16 v[84:87], v[56:59], a[124:127], v[84:87]
    v_mfma_f32_16x16x32_bf16 v[88:91], v[60:63], a[120:123], v[88:91]
    ds_read_b128 v[52:55], v19 offset:50176
    v_mfma_f32_16x16x32_bf16 v[92:95], v[60:63], a[124:127], v[92:95]
    s_mov_b64 exec, s[70:71]
    buffer_store_dword v23, v22, s[8:11], s33 offen sc1
    s_mov_b64 exec, -1

    s_waitcnt lgkmcnt(4)
    v_mfma_f32_16x16x32_bf16 v[80:83], v[32:35], a[128:131], v[80:83]
    ds_read_b128 v[56:59], v20 offset:33792
    s_add_u32 m0, s29, 66432
    v_mfma_f32_16x16x32_bf16 v[84:87], v[32:35], a[132:135], v[84:87]
    buffer_load_dwordx4 v16, s[16:19], s34 offen offset:128 lds
    v_mfma_f32_16x16x32_bf16 v[88:91], v[36:39], a[128:131], v[88:91]
    ds_read_b128 v[60:63], v20 offset:50176
    v_mfma_f32_16x16x32_bf16 v[92:95], v[36:39], a[132:135], v[92:95]
    s_waitcnt lgkmcnt(4)
    v_mfma_f32_16x16x32_bf16 v[80:83], v[40:43], a[136:139], v[80:83]
    ds_read_b128 v[32:35], v19 offset:34816
    v_mfma_f32_16x16x32_bf16 v[84:87], v[40:43], a[140:143], v[84:87]
    v_mfma_f32_16x16x32_bf16 v[88:91], v[44:47], a[136:139], v[88:91]
    ds_read_b128 v[36:39], v19 offset:51200
    v_mfma_f32_16x16x32_bf16 v[92:95], v[44:47], a[140:143], v[92:95]
    s_waitcnt lgkmcnt(4)
    v_mfma_f32_16x16x32_bf16 v[80:83], v[48:51], a[144:147], v[80:83]
    ds_read_b128 v[40:43], v20 offset:34816
    s_add_u32 m0, s29, 67328
    v_mfma_f32_16x16x32_bf16 v[84:87], v[48:51], a[148:151], v[84:87]
    buffer_load_dwordx4 v16, s[16:19], s34 offen offset:256 lds
    v_mfma_f32_16x16x32_bf16 v[88:91], v[52:55], a[144:147], v[88:91]
    ds_read_b128 v[44:47], v20 offset:51200
    v_mfma_f32_16x16x32_bf16 v[92:95], v[52:55], a[148:151], v[92:95]
    s_waitcnt lgkmcnt(4)
    v_mfma_f32_16x16x32_bf16 v[80:83], v[56:59], a[152:155], v[80:83]
    ds_read_b128 v[48:51], v19 offset:35840
    v_mfma_f32_16x16x32_bf16 v[84:87], v[56:59], a[156:159], v[84:87]
    v_mfma_f32_16x16x32_bf16 v[88:91], v[60:63], a[152:155], v[88:91]
    ds_read_b128 v[52:55], v19 offset:52224
    v_mfma_f32_16x16x32_bf16 v[92:95], v[60:63], a[156:159], v[92:95]
    s_waitcnt lgkmcnt(4)
    v_mfma_f32_16x16x32_bf16 v[80:83], v[32:35], a[160:163], v[80:83]
    ds_read_b128 v[56:59], v20 offset:35840
    s_add_u32 m0, s29, 68224
    v_mfma_f32_16x16x32_bf16 v[84:87], v[32:35], a[164:167], v[84:87]
    buffer_load_dwordx4 v16, s[16:19], s34 offen offset:384 lds
    v_mfma_f32_16x16x32_bf16 v[88:91], v[36:39], a[160:163], v[88:91]
    ds_read_b128 v[60:63], v20 offset:52224
    v_mfma_f32_16x16x32_bf16 v[92:95], v[36:39], a[164:167], v[92:95]
    s_waitcnt lgkmcnt(4)
    v_mfma_f32_16x16x32_bf16 v[80:83], v[40:43], a[168:171], v[80:83]
    ds_read_b128 v[32:35], v19 offset:36864
    v_mfma_f32_16x16x32_bf16 v[84:87], v[40:43], a[172:175], v[84:87]
    v_mfma_f32_16x16x32_bf16 v[88:91], v[44:47], a[168:171], v[88:91]
    ds_read_b128 v[36:39], v19 offset:53248
    v_mfma_f32_16x16x32_bf16 v[92:95], v[44:47], a[172:175], v[92:95]
    s_waitcnt lgkmcnt(4)
    v_mfma_f32_16x16x32_bf16 v[80:83], v[48:51], a[176:179], v[80:83]
    ds_read_b128 v[40:43], v20 offset:36864
    s_add_u32 m0, s29, 69120
    v_mfma_f32_16x16x32_bf16 v[84:87], v[48:51], a[180:183], v[84:87]
    buffer_load_dwordx4 v16, s[16:19], s34 offen offset:512 lds
    v_mfma_f32_16x16x32_bf16 v[88:91], v[52:55], a[176:179], v[88:91]
    ds_read_b128 v[44:47], v20 offset:53248
    v_mfma_f32_16x16x32_bf16 v[92:95], v[52:55], a[180:183], v[92:95]
    s_waitcnt lgkmcnt(4)
    v_mfma_f32_16x16x32_bf16 v[80:83], v[56:59], a[184:187], v[80:83]
    ds_read_b128 v[48:51], v19 offset:37888
    v_mfma_f32_16x16x32_bf16 v[84:87], v[56:59], a[188:191], v[84:87]
    v_mfma_f32_16x16x32_bf16 v[88:91], v[60:63], a[184:187], v[88:91]
    ds_read_b128 v[52:55], v19 offset:54272
    v_mfma_f32_16x16x32_bf16 v[92:95], v[60:63], a[188:191], v[92:95]
    s_waitcnt lgkmcnt(4)
    v_mfma_f32_16x16x32_bf16 v[80:83], v[32:35], a[192:195], v[80:83]
    ds_read_b128 v[56:59], v20 offset:37888
    s_add_u32 m0, s29, 70016
    v_mfma_f32_16x16x32_bf16 v[84:87], v[32:35], a[196:199], v[84:87]
    buffer_load_dwordx4 v16, s[16:19], s34 offen offset:640 lds
    v_mfma_f32_16x16x32_bf16 v[88:91], v[36:39], a[192:195], v[88:91]
    ds_read_b128 v[60:63], v20 offset:54272
    v_mfma_f32_16x16x32_bf16 v[92:95], v[36:39], a[196:199], v[92:95]
    s_waitcnt lgkmcnt(4)
    v_mfma_f32_16x16x32_bf16 v[80:83], v[40:43], a[200:203], v[80:83]
    ds_read_b128 v[32:35], v19 offset:38912
    v_mfma_f32_16x16x32_bf16 v[84:87], v[40:43], a[204:207], v[84:87]
    v_mfma_f32_16x16x32_bf16 v[88:91], v[44:47], a[200:203], v[88:91]
    ds_read_b128 v[36:39], v19 offset:55296
    v_mfma_f32_16x16x32_bf16 v[92:95], v[44:47], a[204:207], v[92:95]
    s_waitcnt lgkmcnt(4)
    v_mfma_f32_16x16x32_bf16 v[80:83], v[48:51], a[208:211], v[80:83]
    ds_read_b128 v[40:43], v20 offset:38912
    s_add_u32 m0, s29, 70912
    v_mfma_f32_16x16x32_bf16 v[84:87], v[48:51], a[212:215], v[84:87]
    buffer_load_dwordx4 v16, s[16:19], s34 offen offset:768 lds
    v_mfma_f32_16x16x32_bf16 v[88:91], v[52:55], a[208:211], v[88:91]
    ds_read_b128 v[44:47], v20 offset:55296
    v_mfma_f32_16x16x32_bf16 v[92:95], v[52:55], a[212:215], v[92:95]
    s_waitcnt lgkmcnt(4)
    v_mfma_f32_16x16x32_bf16 v[80:83], v[56:59], a[216:219], v[80:83]
    ds_read_b128 v[48:51], v19 offset:39936
    v_mfma_f32_16x16x32_bf16 v[84:87], v[56:59], a[220:223], v[84:87]
    s_cmp_lt_u32 s35, 21
    s_cselect_b64 s[44:45], -1, 0
    v_mfma_f32_16x16x32_bf16 v[88:91], v[60:63], a[216:219], v[88:91]
    ds_read_b128 v[52:55], v19 offset:56320
    v_mfma_f32_16x16x32_bf16 v[92:95], v[60:63], a[220:223], v[92:95]
    s_cselect_b32 s4, 0x10000, 0
    s_add_u32 s46, s46, s4
    s_waitcnt lgkmcnt(4)
    v_mfma_f32_16x16x32_bf16 v[80:83], v[32:35], a[224:227], v[80:83]
    ds_read_b128 v[56:59], v20 offset:39936
    s_add_u32 m0, s29, 71808
    v_mfma_f32_16x16x32_bf16 v[84:87], v[32:35], a[228:231], v[84:87]
    buffer_load_dwordx4 v16, s[16:19], s34 offen offset:896 lds
    v_mfma_f32_16x16x32_bf16 v[88:91], v[36:39], a[224:227], v[88:91]
    ds_read_b128 v[60:63], v20 offset:56320
    v_mfma_f32_16x16x32_bf16 v[92:95], v[36:39], a[228:231], v[92:95]
    s_waitcnt lgkmcnt(4)
    v_mfma_f32_16x16x32_bf16 v[80:83], v[40:43], a[232:235], v[80:83]
    s_add_u32 s34, s34, 1024
    v_mfma_f32_16x16x32_bf16 v[84:87], v[40:43], a[236:239], v[84:87]
    v_mfma_f32_16x16x32_bf16 v[88:91], v[44:47], a[232:235], v[88:91]
    v_mfma_f32_16x16x32_bf16 v[92:95], v[44:47], a[236:239], v[92:95]
    s_waitcnt lgkmcnt(0)
    s_waitcnt vmcnt(13)
    s_barrier
    ds_read_b128 v[32:35], v17 offset:0
    ds_read_b128 v[36:39], v17 offset:16384
    v_mfma_f32_16x16x32_bf16 v[80:83], v[48:51], a[240:243], v[80:83]
    ds_read_b128 v[40:43], v18 offset:0
    s_add_u32 m0, s29, 98304
    v_mfma_f32_16x16x32_bf16 v[84:87], v[48:51], a[244:247], v[84:87]
    buffer_load_dwordx4 v16, s[16:19], s34 offen offset:0 lds
    v_mfma_f32_16x16x32_bf16 v[88:91], v[52:55], a[240:243], v[88:91]
    ds_read_b128 v[44:47], v18 offset:16384
    v_mfma_f32_16x16x32_bf16 v[92:95], v[52:55], a[244:247], v[92:95]
    v_mfma_f32_16x16x32_bf16 v[80:83], v[56:59], a[248:251], v[80:83]
    ds_read_b128 v[48:51], v17 offset:1024
    v_mfma_f32_16x16x32_bf16 v[84:87], v[56:59], a[252:255], v[84:87]
    v_mfma_f32_16x16x32_bf16 v[88:91], v[60:63], a[248:251], v[88:91]
    ds_read_b128 v[52:55], v17 offset:17408
    v_mfma_f32_16x16x32_bf16 v[92:95], v[60:63], a[252:255], v[92:95]
    s_mov_b64 exec, s[36:37]
    buffer_store_dword v23, v22, s[8:11], s33 offen sc1
    s_mov_b64 exec, -1

    s_add_u32 s35, s35, 1
    s_cmp_lt_u32 s35, 32
    s_cbranch_scc1 .ql_400

    s_nop 7
    v_cvt_pk_bf16_f32 v96, v80, v81
    v_cvt_pk_bf16_f32 v97, v82, v83
    v_cvt_pk_bf16_f32 v98, v88, v89
    v_cvt_pk_bf16_f32 v99, v90, v91
    buffer_store_dwordx4 v[96:99], v21, s[8:11], s32 offen offset:0 sc1
    v_cvt_pk_bf16_f32 v100, v84, v85
    v_cvt_pk_bf16_f32 v101, v86, v87
    v_cvt_pk_bf16_f32 v102, v92, v93
    v_cvt_pk_bf16_f32 v103, v94, v95
    buffer_store_dwordx4 v[100:103], v21, s[8:11], s32 offen offset:1024 sc1
    s_mov_b32 exec_hi, 0
    buffer_store_dwordx4 v[24:27], v21, s[8:11], s48 offen sc1
    s_mov_b32 exec_hi, -1

    v_mov_b32 v23, 64
    s_waitcnt vmcnt(0) lgkmcnt(0)
    s_barrier
    s_mov_b64 exec, s[36:37]
    buffer_store_dword v23, v22, s[8:11], s33 offen sc1
    s_mov_b64 exec, -1

.qd_376:
    s_load_dwordx2 s[40:41], s[0:1], 88
    s_load_dwordx2 s[42:43], s[0:1], 112
    s_and_b32 s4, s33, 0xffffe7ff
    s_mov_b32 s57, s4
    s_mov_b32 s34, s47
    s_and_b32 s30, s26, 7
    s_lshr_b32 s31, s26, 3
    s_lshl_b32 s28, s91, 21
    s_lshl_b32 s4, s30, 8
    s_add_u32 s28, s28, s4
    s_waitcnt lgkmcnt(0)

    s_mov_b32 s12, s40
    s_and_b32 s13, s41, 0xffff
    s_mov_b32 s14, 0x800000
    s_mov_b32 s15, 0x00020000

    s_mov_b32 s44, s42
    s_and_b32 s45, s43, 0xffff
    s_mov_b32 s46, 0x400000
    s_mov_b32 s47, 0x00020000

    v_lshrrev_b32 v4, 1, v2
    v_xor_b32 v4, v4, v3
    v_lshlrev_b32 v4, 1, v4
    v_and_b32 v5, 1, v1
    v_or_b32 v4, v4, v5
    v_lshlrev_b32 v4, 4, v4
    v_lshlrev_b32 v5, 11, v3
    v_add_u32 v10, v4, v5
    v_xor_b32 v11, 0x80, v10
    s_lshl_b32 s4, s24, 16
    s_add_u32 s28, s28, s4
    s_lshl_b32 s29, s24, 13
    v_lshrrev_b32 v4, 2, v2
    v_and_b32 v5, 1, v3
    v_lshl_or_b32 v5, v5, 2, v4
    s_lshl_b32 s4, s24, 1
    v_xor_b32 v5, s4, v5
    v_lshlrev_b32 v5, 5, v5
    v_lshl_add_u32 v4, v3, 2, v4
    v_lshl_add_u32 v5, v4, 8, v5
    v_and_b32 v4, 3, v2
    v_lshl_add_u32 v12, v4, 3, v5
    v_xor_b32 v13, 32, v12
    v_add_u32 v14, 0x10000, v12
    v_add_u32 v15, 0x10000, v13

    s_and_b32 s4, s91, 1
    s_lshl_b32 s4, s4, 5
    v_xor_b32 v12, s4, v12
    v_xor_b32 v13, s4, v13
    v_xor_b32 v14, s4, v14
    v_xor_b32 v15, s4, v15

    s_and_b32 s4, s26, 7
    s_lshl_b32 s4, s4, 1
    s_lshr_b32 s5, s24, 1
    s_add_u32 s4, s4, s5
    s_lshl_b32 s4, s4, 6
    v_add_u32 v4, s4, v1
    v_lshlrev_b32 v4, 11, v4
    s_and_b32 s4, s24, 1
    s_lshl_b32 s4, s4, 10
    s_lshl_b32 s5, s91, 21
    s_add_u32 s4, s4, s5
    buffer_load_dword v31, v4, s[12:15], s4 offen offset:384

    s_add_u32 m0, s29, 0
    s_add_u32 s4, s28, 0
    buffer_load_dwordx4 v10, s[12:15], s4 offen lds

    s_add_u32 m0, s29, 1024
    s_add_u32 s4, s28, 8192
    buffer_load_dwordx4 v11, s[12:15], s4 offen lds

    s_add_u32 m0, s29, 2048
    s_add_u32 s4, s28, 16384
    buffer_load_dwordx4 v10, s[12:15], s4 offen lds

    s_add_u32 m0, s29, 3072
    s_add_u32 s4, s28, 24576
    buffer_load_dwordx4 v11, s[12:15], s4 offen lds

    s_add_u32 m0, s29, 4096
    s_add_u32 s4, s28, 32768
    buffer_load_dwordx4 v10, s[12:15], s4 offen lds

    s_add_u32 m0, s29, 5120
    s_add_u32 s4, s28, 40960
    buffer_load_dwordx4 v11, s[12:15], s4 offen lds

    s_add_u32 m0, s29, 6144
    s_add_u32 s4, s28, 49152
    buffer_load_dwordx4 v10, s[12:15], s4 offen lds

    s_add_u32 m0, s29, 7168
    s_add_u32 s4, s28, 57344
    buffer_load_dwordx4 v11, s[12:15], s4 offen lds

    s_add_u32 m0, s29, 32768
    s_add_u32 s4, s28, 262144
    buffer_load_dwordx4 v10, s[12:15], s4 offen lds

    s_add_u32 m0, s29, 33792
    s_add_u32 s4, s28, 270336
    buffer_load_dwordx4 v11, s[12:15], s4 offen lds

    s_add_u32 m0, s29, 34816
    s_add_u32 s4, s28, 278528
    buffer_load_dwordx4 v10, s[12:15], s4 offen lds

    s_add_u32 m0, s29, 35840
    s_add_u32 s4, s28, 286720
    buffer_load_dwordx4 v11, s[12:15], s4 offen lds

    s_add_u32 m0, s29, 36864
    s_add_u32 s4, s28, 294912
    buffer_load_dwordx4 v10, s[12:15], s4 offen lds

    s_add_u32 m0, s29, 37888
    s_add_u32 s4, s28, 303104
    buffer_load_dwordx4 v11, s[12:15], s4 offen lds

    s_add_u32 m0, s29, 38912
    s_add_u32 s4, s28, 311296
    buffer_load_dwordx4 v10, s[12:15], s4 offen lds

    s_add_u32 m0, s29, 39936
    s_add_u32 s4, s28, 319488
    buffer_load_dwordx4 v11, s[12:15], s4 offen lds

    s_add_u32 m0, s29, 65536
    s_add_u32 s4, s28, 524288
    buffer_load_dwordx4 v10, s[12:15], s4 offen lds

    s_add_u32 m0, s29, 66560
    s_add_u32 s4, s28, 532480
    buffer_load_dwordx4 v11, s[12:15], s4 offen lds

    s_add_u32 m0, s29, 67584
    s_add_u32 s4, s28, 540672
    buffer_load_dwordx4 v10, s[12:15], s4 offen lds

    s_add_u32 m0, s29, 68608
    s_add_u32 s4, s28, 548864
    buffer_load_dwordx4 v11, s[12:15], s4 offen lds

    s_add_u32 m0, s29, 69632
    s_add_u32 s4, s28, 557056
    buffer_load_dwordx4 v10, s[12:15], s4 offen lds

    s_add_u32 m0, s29, 70656
    s_add_u32 s4, s28, 565248
    buffer_load_dwordx4 v11, s[12:15], s4 offen lds

    s_add_u32 m0, s29, 71680
    s_add_u32 s4, s28, 573440
    buffer_load_dwordx4 v10, s[12:15], s4 offen lds

    s_add_u32 m0, s29, 72704
    s_add_u32 s4, s28, 581632
    buffer_load_dwordx4 v11, s[12:15], s4 offen lds

    s_add_u32 m0, s29, 98304
    s_add_u32 s4, s28, 786432
    buffer_load_dwordx4 v10, s[12:15], s4 offen lds

    s_add_u32 m0, s29, 99328
    s_add_u32 s4, s28, 794624
    buffer_load_dwordx4 v11, s[12:15], s4 offen lds

    s_add_u32 m0, s29, 100352
    s_add_u32 s4, s28, 802816
    buffer_load_dwordx4 v10, s[12:15], s4 offen lds

    s_add_u32 m0, s29, 101376
    s_add_u32 s4, s28, 811008
    buffer_load_dwordx4 v11, s[12:15], s4 offen lds

    s_add_u32 m0, s29, 102400
    s_add_u32 s4, s28, 819200
    buffer_load_dwordx4 v10, s[12:15], s4 offen lds

    s_add_u32 m0, s29, 103424
    s_add_u32 s4, s28, 827392
    buffer_load_dwordx4 v11, s[12:15], s4 offen lds

    s_add_u32 m0, s29, 104448
    s_add_u32 s4, s28, 835584
    buffer_load_dwordx4 v10, s[12:15], s4 offen lds

    s_add_u32 m0, s29, 105472
    s_add_u32 s4, s28, 843776
    buffer_load_dwordx4 v11, s[12:15], s4 offen lds

    s_waitcnt vmcnt(24)
    s_barrier
    ds_read_b64_tr_b16 a[0:1], v12 offset:0
    ds_read_b64_tr_b16 a[2:3], v12 offset:4096
    ds_read_b64_tr_b16 a[4:5], v13 offset:0
    ds_read_b64_tr_b16 a[6:7], v13 offset:4096
    ds_read_b64_tr_b16 a[8:9], v12 offset:8192
    ds_read_b64_tr_b16 a[10:11], v12 offset:12288
    ds_read_b64_tr_b16 a[12:13], v13 offset:8192
    ds_read_b64_tr_b16 a[14:15], v13 offset:12288
    ds_read_b64_tr_b16 a[16:17], v12 offset:16384
    ds_read_b64_tr_b16 a[18:19], v12 offset:20480
    ds_read_b64_tr_b16 a[20:21], v13 offset:16384
    ds_read_b64_tr_b16 a[22:23], v13 offset:20480
    ds_read_b64_tr_b16 a[24:25], v12 offset:24576
    ds_read_b64_tr_b16 a[26:27], v12 offset:28672
    ds_read_b64_tr_b16 a[28:29], v13 offset:24576
    ds_read_b64_tr_b16 a[30:31], v13 offset:28672
    s_waitcnt lgkmcnt(0)
    s_barrier
    s_add_u32 m0, s29, 0
    s_add_u32 s4, s28, 1048576
    buffer_load_dwordx4 v10, s[12:15], s4 offen lds

    s_add_u32 m0, s29, 1024
    s_add_u32 s4, s28, 1056768
    buffer_load_dwordx4 v11, s[12:15], s4 offen lds

    s_add_u32 m0, s29, 2048
    s_add_u32 s4, s28, 1064960
    buffer_load_dwordx4 v10, s[12:15], s4 offen lds

    s_add_u32 m0, s29, 3072
    s_add_u32 s4, s28, 1073152
    buffer_load_dwordx4 v11, s[12:15], s4 offen lds

    s_add_u32 m0, s29, 4096
    s_add_u32 s4, s28, 1081344
    buffer_load_dwordx4 v10, s[12:15], s4 offen lds

    s_add_u32 m0, s29, 5120
    s_add_u32 s4, s28, 1089536
    buffer_load_dwordx4 v11, s[12:15], s4 offen lds

    s_add_u32 m0, s29, 6144
    s_add_u32 s4, s28, 1097728
    buffer_load_dwordx4 v10, s[12:15], s4 offen lds

    s_add_u32 m0, s29, 7168
    s_add_u32 s4, s28, 1105920
    buffer_load_dwordx4 v11, s[12:15], s4 offen lds

    s_waitcnt vmcnt(24)
    s_barrier
    ds_read_b64_tr_b16 a[32:33], v12 offset:32768
    ds_read_b64_tr_b16 a[34:35], v12 offset:36864
    ds_read_b64_tr_b16 a[36:37], v13 offset:32768
    ds_read_b64_tr_b16 a[38:39], v13 offset:36864
    ds_read_b64_tr_b16 a[40:41], v12 offset:40960
    ds_read_b64_tr_b16 a[42:43], v12 offset:45056
    ds_read_b64_tr_b16 a[44:45], v13 offset:40960
    ds_read_b64_tr_b16 a[46:47], v13 offset:45056
    ds_read_b64_tr_b16 a[48:49], v12 offset:49152
    ds_read_b64_tr_b16 a[50:51], v12 offset:53248
    ds_read_b64_tr_b16 a[52:53], v13 offset:49152
    ds_read_b64_tr_b16 a[54:55], v13 offset:53248
    ds_read_b64_tr_b16 a[56:57], v12 offset:57344
    ds_read_b64_tr_b16 a[58:59], v12 offset:61440
    ds_read_b64_tr_b16 a[60:61], v13 offset:57344
    ds_read_b64_tr_b16 a[62:63], v13 offset:61440
    s_waitcnt lgkmcnt(0)
    s_barrier
    s_add_u32 m0, s29, 32768
    s_add_u32 s4, s28, 1310720
    buffer_load_dwordx4 v10, s[12:15], s4 offen lds

    s_add_u32 m0, s29, 33792
    s_add_u32 s4, s28, 1318912
    buffer_load_dwordx4 v11, s[12:15], s4 offen lds

    s_add_u32 m0, s29, 34816
    s_add_u32 s4, s28, 1327104
    buffer_load_dwordx4 v10, s[12:15], s4 offen lds

    s_add_u32 m0, s29, 35840
    s_add_u32 s4, s28, 1335296
    buffer_load_dwordx4 v11, s[12:15], s4 offen lds

    s_add_u32 m0, s29, 36864
    s_add_u32 s4, s28, 1343488
    buffer_load_dwordx4 v10, s[12:15], s4 offen lds

    s_add_u32 m0, s29, 37888
    s_add_u32 s4, s28, 1351680
    buffer_load_dwordx4 v11, s[12:15], s4 offen lds

    s_add_u32 m0, s29, 38912
    s_add_u32 s4, s28, 1359872
    buffer_load_dwordx4 v10, s[12:15], s4 offen lds

    s_add_u32 m0, s29, 39936
    s_add_u32 s4, s28, 1368064
    buffer_load_dwordx4 v11, s[12:15], s4 offen lds

    s_waitcnt vmcnt(24)
    s_barrier
    ds_read_b64_tr_b16 a[64:65], v14 offset:0
    ds_read_b64_tr_b16 a[66:67], v14 offset:4096
    ds_read_b64_tr_b16 a[68:69], v15 offset:0
    ds_read_b64_tr_b16 a[70:71], v15 offset:4096
    ds_read_b64_tr_b16 a[72:73], v14 offset:8192
    ds_read_b64_tr_b16 a[74:75], v14 offset:12288
    ds_read_b64_tr_b16 a[76:77], v15 offset:8192
    ds_read_b64_tr_b16 a[78:79], v15 offset:12288
    ds_read_b64_tr_b16 a[80:81], v14 offset:16384
    ds_read_b64_tr_b16 a[82:83], v14 offset:20480
    ds_read_b64_tr_b16 a[84:85], v15 offset:16384
    ds_read_b64_tr_b16 a[86:87], v15 offset:20480
    ds_read_b64_tr_b16 a[88:89], v14 offset:24576
    ds_read_b64_tr_b16 a[90:91], v14 offset:28672
    ds_read_b64_tr_b16 a[92:93], v15 offset:24576
    ds_read_b64_tr_b16 a[94:95], v15 offset:28672
    s_waitcnt lgkmcnt(0)
    s_barrier
    s_add_u32 m0, s29, 65536
    s_add_u32 s4, s28, 1572864
    buffer_load_dwordx4 v10, s[12:15], s4 offen lds

    s_add_u32 m0, s29, 66560
    s_add_u32 s4, s28, 1581056
    buffer_load_dwordx4 v11, s[12:15], s4 offen lds

    s_add_u32 m0, s29, 67584
    s_add_u32 s4, s28, 1589248
    buffer_load_dwordx4 v10, s[12:15], s4 offen lds

    s_add_u32 m0, s29, 68608
    s_add_u32 s4, s28, 1597440
    buffer_load_dwordx4 v11, s[12:15], s4 offen lds

    s_add_u32 m0, s29, 69632
    s_add_u32 s4, s28, 1605632
    buffer_load_dwordx4 v10, s[12:15], s4 offen lds

    s_add_u32 m0, s29, 70656
    s_add_u32 s4, s28, 1613824
    buffer_load_dwordx4 v11, s[12:15], s4 offen lds

    s_add_u32 m0, s29, 71680
    s_add_u32 s4, s28, 1622016
    buffer_load_dwordx4 v10, s[12:15], s4 offen lds

    s_add_u32 m0, s29, 72704
    s_add_u32 s4, s28, 1630208
    buffer_load_dwordx4 v11, s[12:15], s4 offen lds

    s_waitcnt vmcnt(24)
    s_barrier
    ds_read_b64_tr_b16 a[96:97], v14 offset:32768
    ds_read_b64_tr_b16 a[98:99], v14 offset:36864
    ds_read_b64_tr_b16 a[100:101], v15 offset:32768
    ds_read_b64_tr_b16 a[102:103], v15 offset:36864
    ds_read_b64_tr_b16 a[104:105], v14 offset:40960
    ds_read_b64_tr_b16 a[106:107], v14 offset:45056
    ds_read_b64_tr_b16 a[108:109], v15 offset:40960
    ds_read_b64_tr_b16 a[110:111], v15 offset:45056
    ds_read_b64_tr_b16 a[112:113], v14 offset:49152
    ds_read_b64_tr_b16 a[114:115], v14 offset:53248
    ds_read_b64_tr_b16 a[116:117], v15 offset:49152
    ds_read_b64_tr_b16 a[118:119], v15 offset:53248
    ds_read_b64_tr_b16 a[120:121], v14 offset:57344
    ds_read_b64_tr_b16 a[122:123], v14 offset:61440
    ds_read_b64_tr_b16 a[124:125], v15 offset:57344
    ds_read_b64_tr_b16 a[126:127], v15 offset:61440
    s_waitcnt lgkmcnt(0)
    s_barrier
    s_add_u32 m0, s29, 98304
    s_add_u32 s4, s28, 1835008
    buffer_load_dwordx4 v10, s[12:15], s4 offen lds

    s_add_u32 m0, s29, 99328
    s_add_u32 s4, s28, 1843200
    buffer_load_dwordx4 v11, s[12:15], s4 offen lds

    s_add_u32 m0, s29, 100352
    s_add_u32 s4, s28, 1851392
    buffer_load_dwordx4 v10, s[12:15], s4 offen lds

    s_add_u32 m0, s29, 101376
    s_add_u32 s4, s28, 1859584
    buffer_load_dwordx4 v11, s[12:15], s4 offen lds

    s_add_u32 m0, s29, 102400
    s_add_u32 s4, s28, 1867776
    buffer_load_dwordx4 v10, s[12:15], s4 offen lds

    s_add_u32 m0, s29, 103424
    s_add_u32 s4, s28, 1875968
    buffer_load_dwordx4 v11, s[12:15], s4 offen lds

    s_add_u32 m0, s29, 104448
    s_add_u32 s4, s28, 1884160
    buffer_load_dwordx4 v10, s[12:15], s4 offen lds

    s_add_u32 m0, s29, 105472
    s_add_u32 s4, s28, 1892352
    buffer_load_dwordx4 v11, s[12:15], s4 offen lds

    s_waitcnt vmcnt(24)
    s_barrier
    ds_read_b64_tr_b16 a[128:129], v12 offset:0
    ds_read_b64_tr_b16 a[130:131], v12 offset:4096
    ds_read_b64_tr_b16 a[132:133], v13 offset:0
    ds_read_b64_tr_b16 a[134:135], v13 offset:4096
    ds_read_b64_tr_b16 a[136:137], v12 offset:8192
    ds_read_b64_tr_b16 a[138:139], v12 offset:12288
    ds_read_b64_tr_b16 a[140:141], v13 offset:8192
    ds_read_b64_tr_b16 a[142:143], v13 offset:12288
    ds_read_b64_tr_b16 a[144:145], v12 offset:16384
    ds_read_b64_tr_b16 a[146:147], v12 offset:20480
    ds_read_b64_tr_b16 a[148:149], v13 offset:16384
    ds_read_b64_tr_b16 a[150:151], v13 offset:20480
    ds_read_b64_tr_b16 a[152:153], v12 offset:24576
    ds_read_b64_tr_b16 a[154:155], v12 offset:28672
    ds_read_b64_tr_b16 a[156:157], v13 offset:24576
    ds_read_b64_tr_b16 a[158:159], v13 offset:28672
    s_waitcnt lgkmcnt(0)
    s_barrier
    s_waitcnt vmcnt(16)
    s_barrier
    ds_read_b64_tr_b16 a[160:161], v12 offset:32768
    ds_read_b64_tr_b16 a[162:163], v12 offset:36864
    ds_read_b64_tr_b16 a[164:165], v13 offset:32768
    ds_read_b64_tr_b16 a[166:167], v13 offset:36864
    ds_read_b64_tr_b16 a[168:169], v12 offset:40960
    ds_read_b64_tr_b16 a[170:171], v12 offset:45056
    ds_read_b64_tr_b16 a[172:173], v13 offset:40960
    ds_read_b64_tr_b16 a[174:175], v13 offset:45056
    ds_read_b64_tr_b16 a[176:177], v12 offset:49152
    ds_read_b64_tr_b16 a[178:179], v12 offset:53248
    ds_read_b64_tr_b16 a[180:181], v13 offset:49152
    ds_read_b64_tr_b16 a[182:183], v13 offset:53248
    ds_read_b64_tr_b16 a[184:185], v12 offset:57344
    ds_read_b64_tr_b16 a[186:187], v12 offset:61440
    ds_read_b64_tr_b16 a[188:189], v13 offset:57344
    ds_read_b64_tr_b16 a[190:191], v13 offset:61440
    s_waitcnt lgkmcnt(0)
    s_barrier
    s_waitcnt vmcnt(8)
    s_barrier
    ds_read_b64_tr_b16 a[192:193], v14 offset:0
    ds_read_b64_tr_b16 a[194:195], v14 offset:4096
    ds_read_b64_tr_b16 a[196:197], v15 offset:0
    ds_read_b64_tr_b16 a[198:199], v15 offset:4096
    ds_read_b64_tr_b16 a[200:201], v14 offset:8192
    ds_read_b64_tr_b16 a[202:203], v14 offset:12288
    ds_read_b64_tr_b16 a[204:205], v15 offset:8192
    ds_read_b64_tr_b16 a[206:207], v15 offset:12288
    ds_read_b64_tr_b16 a[208:209], v14 offset:16384
    ds_read_b64_tr_b16 a[210:211], v14 offset:20480
    ds_read_b64_tr_b16 a[212:213], v15 offset:16384
    ds_read_b64_tr_b16 a[214:215], v15 offset:20480
    ds_read_b64_tr_b16 a[216:217], v14 offset:24576
    ds_read_b64_tr_b16 a[218:219], v14 offset:28672
    ds_read_b64_tr_b16 a[220:221], v15 offset:24576
    ds_read_b64_tr_b16 a[222:223], v15 offset:28672
    s_waitcnt lgkmcnt(0)
    s_barrier
    s_waitcnt vmcnt(0)
    s_barrier
    ds_read_b64_tr_b16 a[224:225], v14 offset:32768
    ds_read_b64_tr_b16 a[226:227], v14 offset:36864
    ds_read_b64_tr_b16 a[228:229], v15 offset:32768
    ds_read_b64_tr_b16 a[230:231], v15 offset:36864
    ds_read_b64_tr_b16 a[232:233], v14 offset:40960
    ds_read_b64_tr_b16 a[234:235], v14 offset:45056
    ds_read_b64_tr_b16 a[236:237], v15 offset:40960
    ds_read_b64_tr_b16 a[238:239], v15 offset:45056
    ds_read_b64_tr_b16 a[240:241], v14 offset:49152
    ds_read_b64_tr_b16 a[242:243], v14 offset:53248
    ds_read_b64_tr_b16 a[244:245], v15 offset:49152
    ds_read_b64_tr_b16 a[246:247], v15 offset:53248
    ds_read_b64_tr_b16 a[248:249], v14 offset:57344
    ds_read_b64_tr_b16 a[250:251], v14 offset:61440
    ds_read_b64_tr_b16 a[252:253], v15 offset:57344
    ds_read_b64_tr_b16 a[254:255], v15 offset:61440
    s_waitcnt lgkmcnt(0)
    s_barrier
    v_lshlrev_b32 v21, 4, v1
    s_lshr_b32 s4, s91, 1
    s_lshl_b32 s5, s4, 12
    v_add_u32 v17, s5, v21
    v_xor_b32 v18, 0x1000, v17
    s_lshl_b32 s4, s4, 4
    v_add_u32 v4, s4, v2
    s_lshl_b32 s5, s30, 5
    s_lshl_b32 s6, s24, 3
    s_add_u32 s5, s5, s6
    s_and_b32 s6, s91, 1
    s_lshl_b32 s6, s6, 2
    s_add_u32 s5, s5, s6
    v_add_u32 v5, s5, v3
    v_lshlrev_b32 v6, 3, v5
    v_lshl_add_u32 v22, v4, 11, v6
    v_lshlrev_b32 v6, 14, v5
    v_lshl_add_u32 v23, v4, 2, v6
    v_lshlrev_b32 v16, 2, v4
    v_bfe_u32 v4, v1, 2, 3
    v_lshlrev_b32 v19, 8, v4
    v_and_b32 v4, 3, v1
    v_lshl_add_u32 v19, v4, 2, v19
    s_lshl_b32 s33, s91, 11
    s_add_u32 s33, s33, 92299264
    s_lshl_b32 s35, s24, 10
    s_lshl_b32 s36, s91, 16
    s_add_u32 s36, s36, s35
    s_add_u32 s36, s36, 0
    s_mov_b32 s37, 0
    s_lshl_b32 s4, s91, 3
    s_add_u32 s4, s4, s30
    s_lshl_b32 s4, s4, 2
    s_add_u32 s4, s4, s24
    s_lshl_b32 s4, s4, 11
    s_add_u32 s4, s4, 0
    v_lshlrev_b32 v111, 5, v1
    v_add_u32 v111, s4, v111
    s_mov_b32 s52, 0
    s_mov_b32 s39, 0
    v_lshlrev_b32 v6, 11, v1

    s_mov_b32 s62, 0
    s_mov_b64 exec, 15
.wf_404:
    buffer_load_dword v4, v6, s[8:11], s57 offen sc1
    s_waitcnt vmcnt(0)
    v_cmp_gt_u32 vcc, 64, v4
    s_cbranch_vccz .wfd_405
    s_sleep 2
    s_add_u32 s62, s62, 1
    s_cmp_gt_u32 s62, 0x400000
    s_cbranch_scc1 .mg_end_1
    s_branch .wf_404

.wfd_405:
    s_mov_b64 exec, -1
    v_mov_b32 v5, 0
    s_mov_b32 s62, 0
    s_mov_b32 s5, 160
.wc_406:
    buffer_load_dword v4, v5, s[20:23], s5 offen sc1
    s_waitcnt vmcnt(0)
    v_readfirstlane_b32 s4, v4
    s_lshr_b32 s4, s4, 0
    s_and_b32 s4, s4, 0xffff
    s_cmp_ge_u32 s4, 32
    s_cbranch_scc1 .wcd_407
    s_sleep 6
    s_add_u32 s62, s62, 1
    s_cmp_gt_u32 s62, 0x400000
    s_cbranch_scc1 .mg_end_1
    s_branch .wc_406

.wcd_407:
.g2blk_408:
    s_mov_b32 s62, 0
    s_mov_b64 s[64:65], 0
    s_mov_b32 s38, 0
.g2bw_416:
    buffer_load_dword v20, v19, s[8:11], s33 offen sc1
    s_waitcnt vmcnt(0)
    s_lshr_b32 s6, s31, 2
    s_and_b32 s4, s31, 3
    v_cmp_ge_u32 vcc, s6, v20
    s_lshl_b32 s4, s4, 3
    s_lshr_b32 s5, vcc_lo, s4
    s_and_b32 s5, s5, 0xff
    s_cmp_eq_u32 s5, 0

    s_cbranch_scc1 .g2rd_417
    s_lshl_b64 exec, 0xff, s4

    s_add_u32 s62, s62, 1
    s_cmp_gt_u32 s62, 0x400000
    s_cbranch_scc1 .mg_end_1
    s_branch .g2bw_416

.g2rd_417:
    s_mov_b64 exec, -1
    s_lshl_b32 s48, s31, 18
    s_add_u32 s48, s48, s36
    s_add_u32 s49, s39, s35
    s_xor_b32 s39, s39, 0x10000

    s_add_u32 m0, s49, 0
    s_add_u32 s50, s48, 0
    buffer_load_dwordx4 v21, s[8:11], s50 offen offset:0 sc1 lds
    s_add_u32 m0, s49, 4096
    s_add_u32 s50, s48, 4096
    buffer_load_dwordx4 v21, s[8:11], s50 offen offset:0 sc1 lds
    s_add_u32 m0, s49, 8192
    s_add_u32 s50, s48, 8192
    buffer_load_dwordx4 v21, s[8:11], s50 offen offset:0 sc1 lds
    s_add_u32 m0, s49, 12288
    s_add_u32 s50, s48, 12288
    buffer_load_dwordx4 v21, s[8:11], s50 offen offset:0 sc1 lds
    s_add_u32 m0, s49, 16384
    s_add_u32 s50, s48, 16384
    buffer_load_dwordx4 v21, s[8:11], s50 offen offset:0 sc1 lds
    s_add_u32 m0, s49, 20480
    s_add_u32 s50, s48, 20480
    buffer_load_dwordx4 v21, s[8:11], s50 offen offset:0 sc1 lds
    s_add_u32 m0, s49, 24576
    s_add_u32 s50, s48, 24576
    buffer_load_dwordx4 v21, s[8:11], s50 offen offset:0 sc1 lds
    s_add_u32 m0, s49, 28672
    s_add_u32 s50, s48, 28672
    buffer_load_dwordx4 v21, s[8:11], s50 offen offset:0 sc1 lds
    s_add_u32 s53, s31, 3
    s_lshr_b32 s6, s53, 2
    s_and_b32 s4, s53, 3
    v_cmp_ge_u32 vcc, s6, v20
    s_lshl_b32 s4, s4, 3
    s_lshr_b32 s5, vcc_lo, s4
    s_and_b32 s5, s5, 0xff
    s_cmp_eq_u32 s5, 0

    s_cselect_b32 s56, 1, 0
    s_cmp_lt_u32 s53, 64
    s_cselect_b32 s56, s56, 0
    s_cmp_eq_u32 s56, 0
    s_cbranch_scc1 .g2fb_418
    s_add_u32 m0, s49, 32768
    s_add_u32 s50, s48, 32768
    buffer_load_dwordx4 v21, s[8:11], s50 offen offset:0 sc1 lds
    s_add_u32 m0, s49, 36864
    s_add_u32 s50, s48, 36864
    buffer_load_dwordx4 v21, s[8:11], s50 offen offset:0 sc1 lds
    s_add_u32 m0, s49, 40960
    s_add_u32 s50, s48, 40960
    buffer_load_dwordx4 v21, s[8:11], s50 offen offset:0 sc1 lds
    s_add_u32 m0, s49, 45056
    s_add_u32 s50, s48, 45056
    buffer_load_dwordx4 v21, s[8:11], s50 offen offset:0 sc1 lds
    s_add_u32 m0, s49, 49152
    s_add_u32 s50, s48, 49152
    buffer_load_dwordx4 v21, s[8:11], s50 offen offset:0 sc1 lds
    s_add_u32 m0, s49, 53248
    s_add_u32 s50, s48, 53248
    buffer_load_dwordx4 v21, s[8:11], s50 offen offset:0 sc1 lds
    s_add_u32 m0, s49, 57344
    s_add_u32 s50, s48, 57344
    buffer_load_dwordx4 v21, s[8:11], s50 offen offset:0 sc1 lds
    s_add_u32 m0, s49, 61440
    s_add_u32 s50, s48, 61440
    buffer_load_dwordx4 v21, s[8:11], s50 offen offset:0 sc1 lds
    s_waitcnt vmcnt(0)
.g2go_409:
    s_barrier
    ds_read_b128 v[32:35], v17 offset:0
    ds_read_b128 v[36:39], v18 offset:0
    ds_read_b128 v[40:43], v17 offset:1024
    ds_read_b128 v[44:47], v18 offset:1024
    ds_read_b128 v[48:51], v17 offset:2048
    ds_read_b128 v[52:55], v18 offset:2048
    s_add_u32 s53, s31, 3
    s_sub_u32 s54, s31, 3
    s_max_i32 s54, s54, 0
    s_sub_u32 s55, s37, 0x10000
    s_add_u32 s61, s31, 6
    s_lshr_b32 s6, s53, 2
    s_and_b32 s4, s53, 3
    v_cmp_ge_u32 vcc, s6, v20
    s_lshl_b32 s4, s4, 3
    s_lshr_b32 s5, vcc_lo, s4
    s_and_b32 s5, s5, 0xff
    s_cmp_eq_u32 s5, 0

    s_cselect_b32 s56, 1, 0
    s_cmp_lt_u32 s53, 64
    s_cselect_b32 s56, s56, 0
    s_cmp_eq_u32 s56, 0
    s_cbranch_scc1 .g2nd_412
    s_lshr_b32 s6, s61, 2
    s_and_b32 s4, s61, 3
    v_cmp_ge_u32 vcc, s6, v20
    s_lshl_b32 s4, s4, 3
    s_lshr_b32 s5, vcc_lo, s4
    s_and_b32 s5, s5, 0xff
    s_cmp_eq_u32 s5, 0

    s_cbranch_scc1 .g2nf_411
    buffer_load_dword v20, v19, s[8:11], s33 offen sc1
    s_branch .g2pd_420
.g2nf_411:
    s_lshl_b32 s4, s61, 18
    buffer_load_dword v31, v111, s[8:11], s4 offen
.g2pd_420:
    s_lshl_b32 s48, s53, 18
    s_add_u32 s48, s48, s36
    s_add_u32 s49, s39, s35
    s_xor_b32 s39, s39, 0x10000

    s_waitcnt lgkmcnt(4)
    v_mfma_f32_16x16x32_bf16 v[64:67], a[0:3], v[32:35], 0
    ds_read_b128 v[56:59], v17 offset:3072
    s_add_u32 m0, s49, 0
    s_add_u32 s50, s48, 0
    v_mfma_f32_16x16x32_bf16 v[68:71], a[4:7], v[32:35], 0
    buffer_load_dwordx4 v21, s[8:11], s50 offen offset:0 sc1 lds
    v_mfma_f32_16x16x32_bf16 v[72:75], a[0:3], v[36:39], 0
    ds_read_b128 v[60:63], v18 offset:3072
    v_mfma_f32_16x16x32_bf16 v[76:79], a[4:7], v[36:39], 0
    s_waitcnt lgkmcnt(4)
    v_mfma_f32_16x16x32_bf16 v[64:67], a[8:11], v[40:43], v[64:67]
    ds_read_b128 v[32:35], v17 offset:8192
    v_mfma_f32_16x16x32_bf16 v[68:71], a[12:15], v[40:43], v[68:71]
    v_mfma_f32_16x16x32_bf16 v[72:75], a[8:11], v[44:47], v[72:75]
    ds_read_b128 v[36:39], v18 offset:8192
    s_add_u32 m0, s49, 4096
    s_add_u32 s50, s48, 4096
    v_mfma_f32_16x16x32_bf16 v[76:79], a[12:15], v[44:47], v[76:79]
    buffer_load_dwordx4 v21, s[8:11], s50 offen offset:0 sc1 lds
    s_waitcnt lgkmcnt(4)
    v_mfma_f32_16x16x32_bf16 v[64:67], a[16:19], v[48:51], v[64:67]
    ds_read_b128 v[40:43], v17 offset:9216
    v_mfma_f32_16x16x32_bf16 v[68:71], a[20:23], v[48:51], v[68:71]
    v_mfma_f32_16x16x32_bf16 v[72:75], a[16:19], v[52:55], v[72:75]
    ds_read_b128 v[44:47], v18 offset:9216
    v_mfma_f32_16x16x32_bf16 v[76:79], a[20:23], v[52:55], v[76:79]
    s_waitcnt lgkmcnt(4)
    v_mfma_f32_16x16x32_bf16 v[64:67], a[24:27], v[56:59], v[64:67]
    ds_read_b128 v[48:51], v17 offset:10240
    s_add_u32 m0, s49, 8192
    s_add_u32 s50, s48, 8192
    v_mfma_f32_16x16x32_bf16 v[68:71], a[28:31], v[56:59], v[68:71]
    buffer_load_dwordx4 v21, s[8:11], s50 offen offset:0 sc1 lds
    v_mfma_f32_16x16x32_bf16 v[72:75], a[24:27], v[60:63], v[72:75]
    ds_read_b128 v[52:55], v18 offset:10240
    v_mfma_f32_16x16x32_bf16 v[76:79], a[28:31], v[60:63], v[76:79]
    s_waitcnt lgkmcnt(4)
    v_mfma_f32_16x16x32_bf16 v[64:67], a[32:35], v[32:35], v[64:67]
    ds_read_b128 v[56:59], v17 offset:11264
    v_mfma_f32_16x16x32_bf16 v[68:71], a[36:39], v[32:35], v[68:71]
    v_mfma_f32_16x16x32_bf16 v[72:75], a[32:35], v[36:39], v[72:75]
    ds_read_b128 v[60:63], v18 offset:11264
    s_add_u32 m0, s49, 12288
    s_add_u32 s50, s48, 12288
    v_mfma_f32_16x16x32_bf16 v[76:79], a[36:39], v[36:39], v[76:79]
    buffer_load_dwordx4 v21, s[8:11], s50 offen offset:0 sc1 lds
    s_waitcnt lgkmcnt(4)
    v_mfma_f32_16x16x32_bf16 v[64:67], a[40:43], v[40:43], v[64:67]
    s_barrier
    ds_read_b128 v[32:35], v17 offset:16384
    v_mfma_f32_16x16x32_bf16 v[68:71], a[44:47], v[40:43], v[68:71]
    v_mfma_f32_16x16x32_bf16 v[72:75], a[40:43], v[44:47], v[72:75]
    ds_read_b128 v[36:39], v18 offset:16384
    v_mfma_f32_16x16x32_bf16 v[76:79], a[44:47], v[44:47], v[76:79]
    s_waitcnt lgkmcnt(4)
    v_mfma_f32_16x16x32_bf16 v[64:67], a[48:51], v[48:51], v[64:67]
    ds_read_b128 v[40:43], v17 offset:17408
    s_add_u32 m0, s49, 16384
    s_add_u32 s50, s48, 16384
    v_mfma_f32_16x16x32_bf16 v[68:71], a[52:55], v[48:51], v[68:71]
    buffer_load_dwordx4 v21, s[8:11], s50 offen offset:0 sc1 lds
    v_mfma_f32_16x16x32_bf16 v[72:75], a[48:51], v[52:55], v[72:75]
    ds_read_b128 v[44:47], v18 offset:17408
    v_mfma_f32_16x16x32_bf16 v[76:79], a[52:55], v[52:55], v[76:79]
    s_waitcnt lgkmcnt(4)
    v_mfma_f32_16x16x32_bf16 v[64:67], a[56:59], v[56:59], v[64:67]
    ds_read_b128 v[48:51], v17 offset:18432
    v_mfma_f32_16x16x32_bf16 v[68:71], a[60:63], v[56:59], v[68:71]
    v_mfma_f32_16x16x32_bf16 v[72:75], a[56:59], v[60:63], v[72:75]
    ds_read_b128 v[52:55], v18 offset:18432
    s_add_u32 m0, s49, 20480
    s_add_u32 s50, s48, 20480
    v_mfma_f32_16x16x32_bf16 v[76:79], a[60:63], v[60:63], v[76:79]
    buffer_load_dwordx4 v21, s[8:11], s50 offen offset:0 sc1 lds
    s_waitcnt lgkmcnt(4)
    v_mfma_f32_16x16x32_bf16 v[64:67], a[64:67], v[32:35], v[64:67]
    ds_read_b128 v[56:59], v17 offset:19456
    v_mfma_f32_16x16x32_bf16 v[68:71], a[68:71], v[32:35], v[68:71]
    v_mfma_f32_16x16x32_bf16 v[72:75], a[64:67], v[36:39], v[72:75]
    ds_read_b128 v[60:63], v18 offset:19456
    v_mfma_f32_16x16x32_bf16 v[76:79], a[68:71], v[36:39], v[76:79]
    s_waitcnt lgkmcnt(4)
    v_mfma_f32_16x16x32_bf16 v[64:67], a[72:75], v[40:43], v[64:67]
    ds_read_b128 v[32:35], v17 offset:24576
    s_add_u32 m0, s49, 24576
    s_add_u32 s50, s48, 24576
    v_mfma_f32_16x16x32_bf16 v[68:71], a[76:79], v[40:43], v[68:71]
    buffer_load_dwordx4 v21, s[8:11], s50 offen offset:0 sc1 lds
    v_mfma_f32_16x16x32_bf16 v[72:75], a[72:75], v[44:47], v[72:75]
    ds_read_b128 v[36:39], v18 offset:24576
    v_mfma_f32_16x16x32_bf16 v[76:79], a[76:79], v[44:47], v[76:79]
    s_waitcnt lgkmcnt(4)
    v_mfma_f32_16x16x32_bf16 v[64:67], a[80:83], v[48:51], v[64:67]
    ds_read_b128 v[40:43], v17 offset:25600
    v_mfma_f32_16x16x32_bf16 v[68:71], a[84:87], v[48:51], v[68:71]
    s_waitcnt vmcnt(11)
    v_mfma_f32_16x16x32_bf16 v[72:75], a[80:83], v[52:55], v[72:75]
    ds_read_b128 v[44:47], v18 offset:25600
    s_add_u32 m0, s49, 28672
    s_add_u32 s50, s48, 28672
    v_mfma_f32_16x16x32_bf16 v[76:79], a[84:87], v[52:55], v[76:79]
    buffer_load_dwordx4 v21, s[8:11], s50 offen offset:0 sc1 lds
    s_mov_b32 s62, 0
.cc_421:
    v_max3_u32 v4, v84, v88, v92
    v_cmp_eq_u32 vcc, -1, v4
    s_and_b64 vcc, vcc, s[64:65]
    s_cbranch_vccnz .cf_422
    s_waitcnt lgkmcnt(4)
    v_mfma_f32_16x16x32_bf16 v[64:67], a[88:91], v[56:59], v[64:67]
    ds_read_b128 v[48:51], v17 offset:26624
    v_mfma_f32_16x16x32_bf16 v[68:71], a[92:95], v[56:59], v[68:71]
    v_add_f32 v84, v84, v88
    v_add_f32 v92, v112, v92
    v_mfma_f32_16x16x32_bf16 v[72:75], a[88:91], v[60:63], v[72:75]
    ds_read_b128 v[52:55], v18 offset:26624
    v_mfma_f32_16x16x32_bf16 v[76:79], a[92:95], v[60:63], v[76:79]
    v_add_f32 v85, v85, v89
    v_add_f32 v93, v113, v93
    s_waitcnt lgkmcnt(4)
    v_mfma_f32_16x16x32_bf16 v[64:67], a[96:99], v[32:35], v[64:67]
    ds_read_b128 v[56:59], v17 offset:27648
    s_add_u32 m0, s49, 32768
    s_add_u32 s50, s48, 32768
    v_mfma_f32_16x16x32_bf16 v[68:71], a[100:103], v[32:35], v[68:71]
    buffer_load_dwordx4 v21, s[8:11], s50 offen offset:0 sc1 lds
    v_add_f32 v86, v86, v90
    v_add_f32 v94, v114, v94
    v_mfma_f32_16x16x32_bf16 v[72:75], a[96:99], v[36:39], v[72:75]
    ds_read_b128 v[60:63], v18 offset:27648
    v_mfma_f32_16x16x32_bf16 v[76:79], a[100:103], v[36:39], v[76:79]
    v_add_f32 v87, v87, v91
    v_add_f32 v95, v115, v95
    s_waitcnt lgkmcnt(4)
    v_mfma_f32_16x16x32_bf16 v[64:67], a[104:107], v[40:43], v[64:67]
    s_barrier
    ds_read_b128 v[32:35], v17 offset:32768
    v_mfma_f32_16x16x32_bf16 v[68:71], a[108:111], v[40:43], v[68:71]
    v_add_f32 v84, v92, v84
    v_add_f32 v85, v93, v85
    v_mfma_f32_16x16x32_bf16 v[72:75], a[104:107], v[44:47], v[72:75]
    ds_read_b128 v[36:39], v18 offset:32768
    s_add_u32 m0, s49, 36864
    s_add_u32 s50, s48, 36864
    v_mfma_f32_16x16x32_bf16 v[76:79], a[108:111], v[44:47], v[76:79]
    buffer_load_dwordx4 v21, s[8:11], s50 offen offset:0 sc1 lds
    v_add_f32 v86, v94, v86
    v_add_f32 v87, v95, v87
    s_waitcnt lgkmcnt(4)
    v_mfma_f32_16x16x32_bf16 v[64:67], a[112:115], v[48:51], v[64:67]
    ds_read_b128 v[40:43], v17 offset:33792
    v_mfma_f32_16x16x32_bf16 v[68:71], a[116:119], v[48:51], v[68:71]
    v_sub_f32 v104, 1.0, v100
    v_cvt_pk_bf16_f32 v104, v104, v104
    v_mfma_f32_16x16x32_bf16 v[72:75], a[112:115], v[52:55], v[72:75]
    ds_read_b128 v[44:47], v18 offset:33792
    v_mfma_f32_16x16x32_bf16 v[76:79], a[116:119], v[52:55], v[76:79]
    v_lshlrev_b32 v104, 16, v104
    v_cvt_pk_bf16_f32 v105, v84, v85
    s_waitcnt lgkmcnt(4)
    v_mfma_f32_16x16x32_bf16 v[64:67], a[120:123], v[56:59], v[64:67]
    ds_read_b128 v[48:51], v17 offset:34816
    s_add_u32 m0, s49, 40960
    s_add_u32 s50, s48, 40960
    v_mfma_f32_16x16x32_bf16 v[68:71], a[124:127], v[56:59], v[68:71]
    buffer_load_dwordx4 v21, s[8:11], s50 offen offset:0 sc1 lds
    v_lshlrev_b32 v107, 16, v96
    v_and_b32 v108, 0xffff0000, v96
    v_mfma_f32_16x16x32_bf16 v[72:75], a[120:123], v[60:63], v[72:75]
    ds_read_b128 v[52:55], v18 offset:34816
    v_mfma_f32_16x16x32_bf16 v[76:79], a[124:127], v[60:63], v[76:79]
    v_lshlrev_b32 v109, 16, v98
    v_and_b32 v110, 0xffff0000, v98
    s_waitcnt lgkmcnt(4)
    v_mfma_f32_16x16x32_bf16 v[64:67], a[128:131], v[32:35], v[64:67]
    ds_read_b128 v[56:59], v17 offset:35840
    v_mfma_f32_16x16x32_bf16 v[68:71], a[132:135], v[32:35], v[68:71]
    v_and_b32 v106, 0xffff0000, v105
    v_lshlrev_b32 v105, 16, v105
    v_mfma_f32_16x16x32_bf16 v[72:75], a[128:131], v[36:39], v[72:75]
    ds_read_b128 v[60:63], v18 offset:35840
    s_add_u32 m0, s49, 45056
    s_add_u32 s50, s48, 45056
    v_mfma_f32_16x16x32_bf16 v[76:79], a[132:135], v[36:39], v[76:79]
    buffer_load_dwordx4 v21, s[8:11], s50 offen offset:0 sc1 lds
    v_mul_f32 v107, v107, v109
    v_mul_f32 v108, v108, v110
    s_waitcnt lgkmcnt(4)
    v_mfma_f32_16x16x32_bf16 v[64:67], a[136:139], v[40:43], v[64:67]
    ds_read_b128 v[32:35], v17 offset:40960
    v_mfma_f32_16x16x32_bf16 v[68:71], a[140:143], v[40:43], v[68:71]
    v_mul_f32 v105, v104, v105
    v_mul_f32 v106, v104, v106
    v_mfma_f32_16x16x32_bf16 v[72:75], a[136:139], v[44:47], v[72:75]
    ds_read_b128 v[36:39], v18 offset:40960
    v_mfma_f32_16x16x32_bf16 v[76:79], a[140:143], v[44:47], v[76:79]
    v_cvt_pk_bf16_f32 v107, v107, v108
    v_cvt_pk_bf16_f32 v105, v105, v106
    s_waitcnt lgkmcnt(4)
    v_mfma_f32_16x16x32_bf16 v[64:67], a[144:147], v[48:51], v[64:67]
    ds_read_b128 v[40:43], v17 offset:41984
    s_add_u32 m0, s49, 49152
    s_add_u32 s50, s48, 49152
    v_mfma_f32_16x16x32_bf16 v[68:71], a[148:151], v[48:51], v[68:71]
    buffer_load_dwordx4 v21, s[8:11], s50 offen offset:0 sc1 lds
    v_and_b32 v108, 0xffff0000, v107
    v_lshlrev_b32 v107, 16, v107
    v_mfma_f32_16x16x32_bf16 v[72:75], a[144:147], v[52:55], v[72:75]
    ds_read_b128 v[44:47], v18 offset:41984
    v_mfma_f32_16x16x32_bf16 v[76:79], a[148:151], v[52:55], v[76:79]
    v_and_b32 v106, 0xffff0000, v105
    v_lshlrev_b32 v105, 16, v105
    s_waitcnt lgkmcnt(4)
    v_mfma_f32_16x16x32_bf16 v[64:67], a[152:155], v[56:59], v[64:67]
    ds_read_b128 v[48:51], v17 offset:43008
    v_mfma_f32_16x16x32_bf16 v[68:71], a[156:159], v[56:59], v[68:71]
    v_mul_f32 v107, v100, v107
    v_mul_f32 v108, v100, v108
    v_mfma_f32_16x16x32_bf16 v[72:75], a[152:155], v[60:63], v[72:75]
    ds_read_b128 v[52:55], v18 offset:43008
    s_add_u32 m0, s49, 53248
    s_add_u32 s50, s48, 53248
    v_mfma_f32_16x16x32_bf16 v[76:79], a[156:159], v[60:63], v[76:79]
    buffer_load_dwordx4 v21, s[8:11], s50 offen offset:0 sc1 lds
    v_cvt_pk_bf16_f32 v107, v107, v108
    v_and_b32 v108, 0xffff0000, v107
    s_waitcnt lgkmcnt(4)
    v_mfma_f32_16x16x32_bf16 v[64:67], a[160:163], v[32:35], v[64:67]
    ds_read_b128 v[56:59], v17 offset:44032
    v_mfma_f32_16x16x32_bf16 v[68:71], a[164:167], v[32:35], v[68:71]
    v_lshlrev_b32 v107, 16, v107
    v_add_f32 v105, v105, v107
    v_mfma_f32_16x16x32_bf16 v[72:75], a[160:163], v[36:39], v[72:75]
    ds_read_b128 v[60:63], v18 offset:44032
    v_mfma_f32_16x16x32_bf16 v[76:79], a[164:167], v[36:39], v[76:79]
    v_add_f32 v106, v106, v108
    v_cvt_pk_bf16_f32 v102, v105, v106
    s_waitcnt lgkmcnt(4)
    v_mfma_f32_16x16x32_bf16 v[64:67], a[168:171], v[40:43], v[64:67]
    s_barrier
    ds_read_b128 v[32:35], v17 offset:49152
    s_add_u32 m0, s49, 57344
    s_add_u32 s50, s48, 57344
    v_mfma_f32_16x16x32_bf16 v[68:71], a[172:175], v[40:43], v[68:71]
    buffer_load_dwordx4 v21, s[8:11], s50 offen offset:0 sc1 lds
    v_cvt_pk_bf16_f32 v105, v86, v87
    v_lshlrev_b32 v107, 16, v97
    v_mfma_f32_16x16x32_bf16 v[72:75], a[168:171], v[44:47], v[72:75]
    ds_read_b128 v[36:39], v18 offset:49152
    v_mfma_f32_16x16x32_bf16 v[76:79], a[172:175], v[44:47], v[76:79]
    v_and_b32 v108, 0xffff0000, v97
    v_lshlrev_b32 v109, 16, v99
    s_waitcnt lgkmcnt(4)
    v_mfma_f32_16x16x32_bf16 v[64:67], a[176:179], v[48:51], v[64:67]
    ds_read_b128 v[40:43], v17 offset:50176
    v_mfma_f32_16x16x32_bf16 v[68:71], a[180:183], v[48:51], v[68:71]
    v_and_b32 v110, 0xffff0000, v99
    v_and_b32 v106, 0xffff0000, v105
    v_mfma_f32_16x16x32_bf16 v[72:75], a[176:179], v[52:55], v[72:75]
    ds_read_b128 v[44:47], v18 offset:50176
    s_add_u32 m0, s49, 61440
    s_add_u32 s50, s48, 61440
    v_mfma_f32_16x16x32_bf16 v[76:79], a[180:183], v[52:55], v[76:79]
    buffer_load_dwordx4 v21, s[8:11], s50 offen offset:0 sc1 lds
    v_lshlrev_b32 v105, 16, v105
    v_mul_f32 v107, v107, v109
    s_waitcnt lgkmcnt(4)
    v_mfma_f32_16x16x32_bf16 v[64:67], a[184:187], v[56:59], v[64:67]
    ds_read_b128 v[48:51], v17 offset:51200
    v_mfma_f32_16x16x32_bf16 v[68:71], a[188:191], v[56:59], v[68:71]
    v_mul_f32 v108, v108, v110
    v_mul_f32 v105, v104, v105
    v_mfma_f32_16x16x32_bf16 v[72:75], a[184:187], v[60:63], v[72:75]
    ds_read_b128 v[52:55], v18 offset:51200
    v_mfma_f32_16x16x32_bf16 v[76:79], a[188:191], v[60:63], v[76:79]
    v_mul_f32 v106, v104, v106
    v_cvt_pk_bf16_f32 v107, v107, v108
    s_waitcnt lgkmcnt(4)
    v_mfma_f32_16x16x32_bf16 v[64:67], a[192:195], v[32:35], v[64:67]
    ds_read_b128 v[56:59], v17 offset:52224
    v_mfma_f32_16x16x32_bf16 v[68:71], a[196:199], v[32:35], v[68:71]
    v_cvt_pk_bf16_f32 v105, v105, v106
    v_and_b32 v108, 0xffff0000, v107
    v_mfma_f32_16x16x32_bf16 v[72:75], a[192:195], v[36:39], v[72:75]
    ds_read_b128 v[60:63], v18 offset:52224
    v_mfma_f32_16x16x32_bf16 v[76:79], a[196:199], v[36:39], v[76:79]
    v_lshlrev_b32 v107, 16, v107
    v_and_b32 v106, 0xffff0000, v105
    s_waitcnt lgkmcnt(4)
    v_mfma_f32_16x16x32_bf16 v[64:67], a[200:203], v[40:43], v[64:67]
    ds_read_b128 v[32:35], v17 offset:57344
    v_mfma_f32_16x16x32_bf16 v[68:71], a[204:207], v[40:43], v[68:71]
    v_lshlrev_b32 v105, 16, v105
    v_mul_f32 v107, v100, v107
    v_mfma_f32_16x16x32_bf16 v[72:75], a[200:203], v[44:47], v[72:75]
    ds_read_b128 v[36:39], v18 offset:57344
    v_mfma_f32_16x16x32_bf16 v[76:79], a[204:207], v[44:47], v[76:79]
    v_mul_f32 v108, v100, v108
    v_cvt_pk_bf16_f32 v107, v107, v108
    s_waitcnt lgkmcnt(4)
    v_mfma_f32_16x16x32_bf16 v[64:67], a[208:211], v[48:51], v[64:67]
    ds_read_b128 v[40:43], v17 offset:58368
    v_mfma_f32_16x16x32_bf16 v[68:71], a[212:215], v[48:51], v[68:71]
    v_and_b32 v108, 0xffff0000, v107
    v_lshlrev_b32 v107, 16, v107
    v_mfma_f32_16x16x32_bf16 v[72:75], a[208:211], v[52:55], v[72:75]
    ds_read_b128 v[44:47], v18 offset:58368
    v_mfma_f32_16x16x32_bf16 v[76:79], a[212:215], v[52:55], v[76:79]
    v_add_f32 v105, v105, v107
    v_add_f32 v106, v106, v108
    s_waitcnt lgkmcnt(4)
    v_mfma_f32_16x16x32_bf16 v[64:67], a[216:219], v[56:59], v[64:67]
    ds_read_b128 v[48:51], v17 offset:59392
    v_mfma_f32_16x16x32_bf16 v[68:71], a[220:223], v[56:59], v[68:71]
    v_cvt_pk_bf16_f32 v103, v105, v106
    s_mov_b64 exec, s[64:65]
    buffer_store_dwordx2 v[102:103], v22, s[44:47], s52 offen
    s_mov_b64 exec, -1
    v_mfma_f32_16x16x32_bf16 v[72:75], a[216:219], v[60:63], v[72:75]
    ds_read_b128 v[52:55], v18 offset:59392
    v_mfma_f32_16x16x32_bf16 v[76:79], a[220:223], v[60:63], v[76:79]
    s_add_u32 s51, s34, s55
    s_lshl_b32 s52, s54, 16
    s_lshl_b32 s60, s54, 7
    s_add_u32 s58, s60, 117440512
    s_add_u32 s59, s60, 117448704
    s_add_u32 s60, s60, 121634816

    s_cmp_eq_u32 s38, 0
    s_waitcnt lgkmcnt(4)
    v_mfma_f32_16x16x32_bf16 v[64:67], a[224:227], v[32:35], v[64:67]
    ds_read_b128 v[56:59], v17 offset:60416
    v_mfma_f32_16x16x32_bf16 v[68:71], a[228:231], v[32:35], v[68:71]
    s_cbranch_scc1 .cs_423
    buffer_load_dwordx2 v[96:97], v22, s[16:19], s52 offen
.cs_423:
    v_mfma_f32_16x16x32_bf16 v[72:75], a[224:227], v[36:39], v[72:75]
    ds_read_b128 v[60:63], v18 offset:60416
    v_mfma_f32_16x16x32_bf16 v[76:79], a[228:231], v[36:39], v[76:79]
    s_cbranch_scc1 .cs_424
    buffer_load_dword v98, v23, s[8:11], s58 offen
.cs_424:
    s_waitcnt lgkmcnt(4)
    v_mfma_f32_16x16x32_bf16 v[64:67], a[232:235], v[40:43], v[64:67]
    v_mfma_f32_16x16x32_bf16 v[68:71], a[236:239], v[40:43], v[68:71]
    s_cbranch_scc1 .cs_425
    buffer_load_dword v99, v23, s[8:11], s59 offen
.cs_425:
    v_mfma_f32_16x16x32_bf16 v[72:75], a[232:235], v[44:47], v[72:75]
    v_mfma_f32_16x16x32_bf16 v[76:79], a[236:239], v[44:47], v[76:79]
    s_cbranch_scc1 .cs_426
    buffer_load_dword v100, v16, s[8:11], s60 offen
.cs_426:
    s_waitcnt lgkmcnt(2)
    v_mfma_f32_16x16x32_bf16 v[64:67], a[240:243], v[48:51], v[64:67]
    v_mfma_f32_16x16x32_bf16 v[68:71], a[244:247], v[48:51], v[68:71]
    s_cbranch_scc1 .cs_427
    buffer_load_dwordx4 v[84:87], v7, s[8:11], s51 offen sc1
.cs_427:
    v_mfma_f32_16x16x32_bf16 v[72:75], a[240:243], v[52:55], v[72:75]
    v_mfma_f32_16x16x32_bf16 v[76:79], a[244:247], v[52:55], v[76:79]
    s_cbranch_scc1 .cs_428
    buffer_load_dwordx4 v[88:91], v8, s[8:11], s51 offen sc1
.cs_428:
    s_waitcnt lgkmcnt(0)
    v_mfma_f32_16x16x32_bf16 v[64:67], a[248:251], v[56:59], v[64:67]
    v_mfma_f32_16x16x32_bf16 v[68:71], a[252:255], v[56:59], v[68:71]
    s_cbranch_scc1 .cs_429
    buffer_load_dwordx4 v[92:95], v9, s[8:11], s51 offen sc1
.cs_429:
    v_mfma_f32_16x16x32_bf16 v[72:75], a[248:251], v[60:63], v[72:75]
    v_mfma_f32_16x16x32_bf16 v[76:79], a[252:255], v[60:63], v[76:79]
    v_xor_b32 v17, 0x10000, v17
    v_xor_b32 v18, 0x10000, v18
    s_cselect_b64 s[64:65], 0, -1
    s_add_u32 s4, s34, s37

    v_mov_b32 v112, v80
    v_mov_b32 v113, v81
    v_mov_b32 v114, v82
    v_mov_b32 v115, v83
    s_branch .g2st_413
.g2nd_412:
    s_waitcnt lgkmcnt(4)
    v_mfma_f32_16x16x32_bf16 v[64:67], a[0:3], v[32:35], 0
    ds_read_b128 v[56:59], v17 offset:3072
    v_mfma_f32_16x16x32_bf16 v[68:71], a[4:7], v[32:35], 0
    v_mfma_f32_16x16x32_bf16 v[72:75], a[0:3], v[36:39], 0
    ds_read_b128 v[60:63], v18 offset:3072
    v_mfma_f32_16x16x32_bf16 v[76:79], a[4:7], v[36:39], 0
    s_waitcnt lgkmcnt(4)
    v_mfma_f32_16x16x32_bf16 v[64:67], a[8:11], v[40:43], v[64:67]
    ds_read_b128 v[32:35], v17 offset:8192
    v_mfma_f32_16x16x32_bf16 v[68:71], a[12:15], v[40:43], v[68:71]
    v_mfma_f32_16x16x32_bf16 v[72:75], a[8:11], v[44:47], v[72:75]
    ds_read_b128 v[36:39], v18 offset:8192
    v_mfma_f32_16x16x32_bf16 v[76:79], a[12:15], v[44:47], v[76:79]
    s_waitcnt lgkmcnt(4)
    v_mfma_f32_16x16x32_bf16 v[64:67], a[16:19], v[48:51], v[64:67]
    ds_read_b128 v[40:43], v17 offset:9216
    v_mfma_f32_16x16x32_bf16 v[68:71], a[20:23], v[48:51], v[68:71]
    v_mfma_f32_16x16x32_bf16 v[72:75], a[16:19], v[52:55], v[72:75]
    ds_read_b128 v[44:47], v18 offset:9216
    v_mfma_f32_16x16x32_bf16 v[76:79], a[20:23], v[52:55], v[76:79]
    s_waitcnt lgkmcnt(4)
    v_mfma_f32_16x16x32_bf16 v[64:67], a[24:27], v[56:59], v[64:67]
    ds_read_b128 v[48:51], v17 offset:10240
    v_mfma_f32_16x16x32_bf16 v[68:71], a[28:31], v[56:59], v[68:71]
    v_mfma_f32_16x16x32_bf16 v[72:75], a[24:27], v[60:63], v[72:75]
    ds_read_b128 v[52:55], v18 offset:10240
    v_mfma_f32_16x16x32_bf16 v[76:79], a[28:31], v[60:63], v[76:79]
    s_waitcnt lgkmcnt(4)
    v_mfma_f32_16x16x32_bf16 v[64:67], a[32:35], v[32:35], v[64:67]
    ds_read_b128 v[56:59], v17 offset:11264
    v_mfma_f32_16x16x32_bf16 v[68:71], a[36:39], v[32:35], v[68:71]
    v_mfma_f32_16x16x32_bf16 v[72:75], a[32:35], v[36:39], v[72:75]
    ds_read_b128 v[60:63], v18 offset:11264
    v_mfma_f32_16x16x32_bf16 v[76:79], a[36:39], v[36:39], v[76:79]
    s_waitcnt lgkmcnt(4)
    v_mfma_f32_16x16x32_bf16 v[64:67], a[40:43], v[40:43], v[64:67]
    s_barrier
    ds_read_b128 v[32:35], v17 offset:16384
    v_mfma_f32_16x16x32_bf16 v[68:71], a[44:47], v[40:43], v[68:71]
    v_mfma_f32_16x16x32_bf16 v[72:75], a[40:43], v[44:47], v[72:75]
    ds_read_b128 v[36:39], v18 offset:16384
    v_mfma_f32_16x16x32_bf16 v[76:79], a[44:47], v[44:47], v[76:79]
    s_waitcnt lgkmcnt(4)
    v_mfma_f32_16x16x32_bf16 v[64:67], a[48:51], v[48:51], v[64:67]
    ds_read_b128 v[40:43], v17 offset:17408
    v_mfma_f32_16x16x32_bf16 v[68:71], a[52:55], v[48:51], v[68:71]
    v_mfma_f32_16x16x32_bf16 v[72:75], a[48:51], v[52:55], v[72:75]
    ds_read_b128 v[44:47], v18 offset:17408
    v_mfma_f32_16x16x32_bf16 v[76:79], a[52:55], v[52:55], v[76:79]
    s_waitcnt lgkmcnt(4)
    v_mfma_f32_16x16x32_bf16 v[64:67], a[56:59], v[56:59], v[64:67]
    ds_read_b128 v[48:51], v17 offset:18432
    v_mfma_f32_16x16x32_bf16 v[68:71], a[60:63], v[56:59], v[68:71]
    v_mfma_f32_16x16x32_bf16 v[72:75], a[56:59], v[60:63], v[72:75]
    ds_read_b128 v[52:55], v18 offset:18432
    v_mfma_f32_16x16x32_bf16 v[76:79], a[60:63], v[60:63], v[76:79]
    s_waitcnt lgkmcnt(4)
    v_mfma_f32_16x16x32_bf16 v[64:67], a[64:67], v[32:35], v[64:67]
    ds_read_b128 v[56:59], v17 offset:19456
    v_mfma_f32_16x16x32_bf16 v[68:71], a[68:71], v[32:35], v[68:71]
    v_mfma_f32_16x16x32_bf16 v[72:75], a[64:67], v[36:39], v[72:75]
    ds_read_b128 v[60:63], v18 offset:19456
    v_mfma_f32_16x16x32_bf16 v[76:79], a[68:71], v[36:39], v[76:79]
    s_waitcnt lgkmcnt(4)
    v_mfma_f32_16x16x32_bf16 v[64:67], a[72:75], v[40:43], v[64:67]
    ds_read_b128 v[32:35], v17 offset:24576
    v_mfma_f32_16x16x32_bf16 v[68:71], a[76:79], v[40:43], v[68:71]
    v_mfma_f32_16x16x32_bf16 v[72:75], a[72:75], v[44:47], v[72:75]
    ds_read_b128 v[36:39], v18 offset:24576
    v_mfma_f32_16x16x32_bf16 v[76:79], a[76:79], v[44:47], v[76:79]
    s_waitcnt lgkmcnt(4)
    v_mfma_f32_16x16x32_bf16 v[64:67], a[80:83], v[48:51], v[64:67]
    ds_read_b128 v[40:43], v17 offset:25600
    v_mfma_f32_16x16x32_bf16 v[68:71], a[84:87], v[48:51], v[68:71]
    s_waitcnt vmcnt(3)
    v_mfma_f32_16x16x32_bf16 v[72:75], a[80:83], v[52:55], v[72:75]
    ds_read_b128 v[44:47], v18 offset:25600
    v_mfma_f32_16x16x32_bf16 v[76:79], a[84:87], v[52:55], v[76:79]
    s_mov_b32 s62, 0
.cc_430:
    v_max3_u32 v4, v84, v88, v92
    v_cmp_eq_u32 vcc, -1, v4
    s_and_b64 vcc, vcc, s[64:65]
    s_cbranch_vccnz .cf_431
    s_waitcnt lgkmcnt(4)
    v_mfma_f32_16x16x32_bf16 v[64:67], a[88:91], v[56:59], v[64:67]
    ds_read_b128 v[48:51], v17 offset:26624
    v_mfma_f32_16x16x32_bf16 v[68:71], a[92:95], v[56:59], v[68:71]
    v_add_f32 v84, v84, v88
    v_add_f32 v92, v112, v92
    v_mfma_f32_16x16x32_bf16 v[72:75], a[88:91], v[60:63], v[72:75]
    ds_read_b128 v[52:55], v18 offset:26624
    v_mfma_f32_16x16x32_bf16 v[76:79], a[92:95], v[60:63], v[76:79]
    v_add_f32 v85, v85, v89
    v_add_f32 v93, v113, v93
    s_waitcnt lgkmcnt(4)
    v_mfma_f32_16x16x32_bf16 v[64:67], a[96:99], v[32:35], v[64:67]
    ds_read_b128 v[56:59], v17 offset:27648
    v_mfma_f32_16x16x32_bf16 v[68:71], a[100:103], v[32:35], v[68:71]
    v_add_f32 v86, v86, v90
    v_add_f32 v94, v114, v94
    v_mfma_f32_16x16x32_bf16 v[72:75], a[96:99], v[36:39], v[72:75]
    ds_read_b128 v[60:63], v18 offset:27648
    v_mfma_f32_16x16x32_bf16 v[76:79], a[100:103], v[36:39], v[76:79]
    v_add_f32 v87, v87, v91
    v_add_f32 v95, v115, v95
    s_waitcnt lgkmcnt(4)
    v_mfma_f32_16x16x32_bf16 v[64:67], a[104:107], v[40:43], v[64:67]
    s_barrier
    ds_read_b128 v[32:35], v17 offset:32768
    v_mfma_f32_16x16x32_bf16 v[68:71], a[108:111], v[40:43], v[68:71]
    v_add_f32 v84, v92, v84
    v_add_f32 v85, v93, v85
    v_mfma_f32_16x16x32_bf16 v[72:75], a[104:107], v[44:47], v[72:75]
    ds_read_b128 v[36:39], v18 offset:32768
    v_mfma_f32_16x16x32_bf16 v[76:79], a[108:111], v[44:47], v[76:79]
    v_add_f32 v86, v94, v86
    v_add_f32 v87, v95, v87
    s_waitcnt lgkmcnt(4)
    v_mfma_f32_16x16x32_bf16 v[64:67], a[112:115], v[48:51], v[64:67]
    ds_read_b128 v[40:43], v17 offset:33792
    v_mfma_f32_16x16x32_bf16 v[68:71], a[116:119], v[48:51], v[68:71]
    v_sub_f32 v104, 1.0, v100
    v_cvt_pk_bf16_f32 v104, v104, v104
    v_mfma_f32_16x16x32_bf16 v[72:75], a[112:115], v[52:55], v[72:75]
    ds_read_b128 v[44:47], v18 offset:33792
    v_mfma_f32_16x16x32_bf16 v[76:79], a[116:119], v[52:55], v[76:79]
    v_lshlrev_b32 v104, 16, v104
    v_cvt_pk_bf16_f32 v105, v84, v85
    s_waitcnt lgkmcnt(4)
    v_mfma_f32_16x16x32_bf16 v[64:67], a[120:123], v[56:59], v[64:67]
    ds_read_b128 v[48:51], v17 offset:34816
    v_mfma_f32_16x16x32_bf16 v[68:71], a[124:127], v[56:59], v[68:71]
    v_lshlrev_b32 v107, 16, v96
    v_and_b32 v108, 0xffff0000, v96
    v_mfma_f32_16x16x32_bf16 v[72:75], a[120:123], v[60:63], v[72:75]
    ds_read_b128 v[52:55], v18 offset:34816
    v_mfma_f32_16x16x32_bf16 v[76:79], a[124:127], v[60:63], v[76:79]
    v_lshlrev_b32 v109, 16, v98
    v_and_b32 v110, 0xffff0000, v98
    s_waitcnt lgkmcnt(4)
    v_mfma_f32_16x16x32_bf16 v[64:67], a[128:131], v[32:35], v[64:67]
    ds_read_b128 v[56:59], v17 offset:35840
    v_mfma_f32_16x16x32_bf16 v[68:71], a[132:135], v[32:35], v[68:71]
    v_and_b32 v106, 0xffff0000, v105
    v_lshlrev_b32 v105, 16, v105
    v_mfma_f32_16x16x32_bf16 v[72:75], a[128:131], v[36:39], v[72:75]
    ds_read_b128 v[60:63], v18 offset:35840
    v_mfma_f32_16x16x32_bf16 v[76:79], a[132:135], v[36:39], v[76:79]
    v_mul_f32 v107, v107, v109
    v_mul_f32 v108, v108, v110
    s_waitcnt lgkmcnt(4)
    v_mfma_f32_16x16x32_bf16 v[64:67], a[136:139], v[40:43], v[64:67]
    ds_read_b128 v[32:35], v17 offset:40960
    v_mfma_f32_16x16x32_bf16 v[68:71], a[140:143], v[40:43], v[68:71]
    v_mul_f32 v105, v104, v105
    v_mul_f32 v106, v104, v106
    v_mfma_f32_16x16x32_bf16 v[72:75], a[136:139], v[44:47], v[72:75]
    ds_read_b128 v[36:39], v18 offset:40960
    v_mfma_f32_16x16x32_bf16 v[76:79], a[140:143], v[44:47], v[76:79]
    v_cvt_pk_bf16_f32 v107, v107, v108
    v_cvt_pk_bf16_f32 v105, v105, v106
    s_waitcnt lgkmcnt(4)
    v_mfma_f32_16x16x32_bf16 v[64:67], a[144:147], v[48:51], v[64:67]
    ds_read_b128 v[40:43], v17 offset:41984
    v_mfma_f32_16x16x32_bf16 v[68:71], a[148:151], v[48:51], v[68:71]
    v_and_b32 v108, 0xffff0000, v107
    v_lshlrev_b32 v107, 16, v107
    v_mfma_f32_16x16x32_bf16 v[72:75], a[144:147], v[52:55], v[72:75]
    ds_read_b128 v[44:47], v18 offset:41984
    v_mfma_f32_16x16x32_bf16 v[76:79], a[148:151], v[52:55], v[76:79]
    v_and_b32 v106, 0xffff0000, v105
    v_lshlrev_b32 v105, 16, v105
    s_waitcnt lgkmcnt(4)
    v_mfma_f32_16x16x32_bf16 v[64:67], a[152:155], v[56:59], v[64:67]
    ds_read_b128 v[48:51], v17 offset:43008
    v_mfma_f32_16x16x32_bf16 v[68:71], a[156:159], v[56:59], v[68:71]
    v_mul_f32 v107, v100, v107
    v_mul_f32 v108, v100, v108
    v_mfma_f32_16x16x32_bf16 v[72:75], a[152:155], v[60:63], v[72:75]
    ds_read_b128 v[52:55], v18 offset:43008
    v_mfma_f32_16x16x32_bf16 v[76:79], a[156:159], v[60:63], v[76:79]
    v_cvt_pk_bf16_f32 v107, v107, v108
    v_and_b32 v108, 0xffff0000, v107
    s_waitcnt lgkmcnt(4)
    v_mfma_f32_16x16x32_bf16 v[64:67], a[160:163], v[32:35], v[64:67]
    ds_read_b128 v[56:59], v17 offset:44032
    v_mfma_f32_16x16x32_bf16 v[68:71], a[164:167], v[32:35], v[68:71]
    v_lshlrev_b32 v107, 16, v107
    v_add_f32 v105, v105, v107
    v_mfma_f32_16x16x32_bf16 v[72:75], a[160:163], v[36:39], v[72:75]
    ds_read_b128 v[60:63], v18 offset:44032
    v_mfma_f32_16x16x32_bf16 v[76:79], a[164:167], v[36:39], v[76:79]
    v_add_f32 v106, v106, v108
    v_cvt_pk_bf16_f32 v102, v105, v106
    s_waitcnt lgkmcnt(4)
    v_mfma_f32_16x16x32_bf16 v[64:67], a[168:171], v[40:43], v[64:67]
    s_barrier
    ds_read_b128 v[32:35], v17 offset:49152
    v_mfma_f32_16x16x32_bf16 v[68:71], a[172:175], v[40:43], v[68:71]
    v_cvt_pk_bf16_f32 v105, v86, v87
    v_lshlrev_b32 v107, 16, v97
    v_mfma_f32_16x16x32_bf16 v[72:75], a[168:171], v[44:47], v[72:75]
    ds_read_b128 v[36:39], v18 offset:49152
    v_mfma_f32_16x16x32_bf16 v[76:79], a[172:175], v[44:47], v[76:79]
    v_and_b32 v108, 0xffff0000, v97
    v_lshlrev_b32 v109, 16, v99
    s_waitcnt lgkmcnt(4)
    v_mfma_f32_16x16x32_bf16 v[64:67], a[176:179], v[48:51], v[64:67]
    ds_read_b128 v[40:43], v17 offset:50176
    v_mfma_f32_16x16x32_bf16 v[68:71], a[180:183], v[48:51], v[68:71]
    v_and_b32 v110, 0xffff0000, v99
    v_and_b32 v106, 0xffff0000, v105
    v_mfma_f32_16x16x32_bf16 v[72:75], a[176:179], v[52:55], v[72:75]
    ds_read_b128 v[44:47], v18 offset:50176
    v_mfma_f32_16x16x32_bf16 v[76:79], a[180:183], v[52:55], v[76:79]
    v_lshlrev_b32 v105, 16, v105
    v_mul_f32 v107, v107, v109
    s_waitcnt lgkmcnt(4)
    v_mfma_f32_16x16x32_bf16 v[64:67], a[184:187], v[56:59], v[64:67]
    ds_read_b128 v[48:51], v17 offset:51200
    v_mfma_f32_16x16x32_bf16 v[68:71], a[188:191], v[56:59], v[68:71]
    v_mul_f32 v108, v108, v110
    v_mul_f32 v105, v104, v105
    v_mfma_f32_16x16x32_bf16 v[72:75], a[184:187], v[60:63], v[72:75]
    ds_read_b128 v[52:55], v18 offset:51200
    v_mfma_f32_16x16x32_bf16 v[76:79], a[188:191], v[60:63], v[76:79]
    v_mul_f32 v106, v104, v106
    v_cvt_pk_bf16_f32 v107, v107, v108
    s_waitcnt lgkmcnt(4)
    v_mfma_f32_16x16x32_bf16 v[64:67], a[192:195], v[32:35], v[64:67]
    ds_read_b128 v[56:59], v17 offset:52224
    v_mfma_f32_16x16x32_bf16 v[68:71], a[196:199], v[32:35], v[68:71]
    v_cvt_pk_bf16_f32 v105, v105, v106
    v_and_b32 v108, 0xffff0000, v107
    v_mfma_f32_16x16x32_bf16 v[72:75], a[192:195], v[36:39], v[72:75]
    ds_read_b128 v[60:63], v18 offset:52224
    v_mfma_f32_16x16x32_bf16 v[76:79], a[196:199], v[36:39], v[76:79]
    v_lshlrev_b32 v107, 16, v107
    v_and_b32 v106, 0xffff0000, v105
    s_waitcnt lgkmcnt(4)
    v_mfma_f32_16x16x32_bf16 v[64:67], a[200:203], v[40:43], v[64:67]
    ds_read_b128 v[32:35], v17 offset:57344
    v_mfma_f32_16x16x32_bf16 v[68:71], a[204:207], v[40:43], v[68:71]
    v_lshlrev_b32 v105, 16, v105
    v_mul_f32 v107, v100, v107
    v_mfma_f32_16x16x32_bf16 v[72:75], a[200:203], v[44:47], v[72:75]
    ds_read_b128 v[36:39], v18 offset:57344
    v_mfma_f32_16x16x32_bf16 v[76:79], a[204:207], v[44:47], v[76:79]
    v_mul_f32 v108, v100, v108
    v_cvt_pk_bf16_f32 v107, v107, v108
    s_waitcnt lgkmcnt(4)
    v_mfma_f32_16x16x32_bf16 v[64:67], a[208:211], v[48:51], v[64:67]
    ds_read_b128 v[40:43], v17 offset:58368
    v_mfma_f32_16x16x32_bf16 v[68:71], a[212:215], v[48:51], v[68:71]
    v_and_b32 v108, 0xffff0000, v107
    v_lshlrev_b32 v107, 16, v107
    v_mfma_f32_16x16x32_bf16 v[72:75], a[208:211], v[52:55], v[72:75]
    ds_read_b128 v[44:47], v18 offset:58368
    v_mfma_f32_16x16x32_bf16 v[76:79], a[212:215], v[52:55], v[76:79]
    v_add_f32 v105, v105, v107
    v_add_f32 v106, v106, v108
    s_waitcnt lgkmcnt(4)
    v_mfma_f32_16x16x32_bf16 v[64:67], a[216:219], v[56:59], v[64:67]
    ds_read_b128 v[48:51], v17 offset:59392
    v_mfma_f32_16x16x32_bf16 v[68:71], a[220:223], v[56:59], v[68:71]
    v_cvt_pk_bf16_f32 v103, v105, v106
    s_mov_b64 exec, s[64:65]
    buffer_store_dwordx2 v[102:103], v22, s[44:47], s52 offen
    s_mov_b64 exec, -1
    v_mfma_f32_16x16x32_bf16 v[72:75], a[216:219], v[60:63], v[72:75]
    ds_read_b128 v[52:55], v18 offset:59392
    v_mfma_f32_16x16x32_bf16 v[76:79], a[220:223], v[60:63], v[76:79]
    s_add_u32 s51, s34, s55
    s_lshl_b32 s52, s54, 16
    s_lshl_b32 s60, s54, 7
    s_add_u32 s58, s60, 117440512
    s_add_u32 s59, s60, 117448704
    s_add_u32 s60, s60, 121634816

    s_cmp_eq_u32 s38, 0
    s_waitcnt lgkmcnt(4)
    v_mfma_f32_16x16x32_bf16 v[64:67], a[224:227], v[32:35], v[64:67]
    ds_read_b128 v[56:59], v17 offset:60416
    v_mfma_f32_16x16x32_bf16 v[68:71], a[228:231], v[32:35], v[68:71]
    s_cbranch_scc1 .cs_432
    buffer_load_dwordx2 v[96:97], v22, s[16:19], s52 offen
.cs_432:
    v_mfma_f32_16x16x32_bf16 v[72:75], a[224:227], v[36:39], v[72:75]
    ds_read_b128 v[60:63], v18 offset:60416
    v_mfma_f32_16x16x32_bf16 v[76:79], a[228:231], v[36:39], v[76:79]
    s_cbranch_scc1 .cs_433
    buffer_load_dword v98, v23, s[8:11], s58 offen
.cs_433:
    s_waitcnt lgkmcnt(4)
    v_mfma_f32_16x16x32_bf16 v[64:67], a[232:235], v[40:43], v[64:67]
    v_mfma_f32_16x16x32_bf16 v[68:71], a[236:239], v[40:43], v[68:71]
    s_cbranch_scc1 .cs_434
    buffer_load_dword v99, v23, s[8:11], s59 offen
.cs_434:
    v_mfma_f32_16x16x32_bf16 v[72:75], a[232:235], v[44:47], v[72:75]
    v_mfma_f32_16x16x32_bf16 v[76:79], a[236:239], v[44:47], v[76:79]
    s_cbranch_scc1 .cs_435
    buffer_load_dword v100, v16, s[8:11], s60 offen
.cs_435:
    s_waitcnt lgkmcnt(2)
    v_mfma_f32_16x16x32_bf16 v[64:67], a[240:243], v[48:51], v[64:67]
    v_mfma_f32_16x16x32_bf16 v[68:71], a[244:247], v[48:51], v[68:71]
    s_cbranch_scc1 .cs_436
    buffer_load_dwordx4 v[84:87], v7, s[8:11], s51 offen sc1
.cs_436:
    v_mfma_f32_16x16x32_bf16 v[72:75], a[240:243], v[52:55], v[72:75]
    v_mfma_f32_16x16x32_bf16 v[76:79], a[244:247], v[52:55], v[76:79]
    s_cbranch_scc1 .cs_437
    buffer_load_dwordx4 v[88:91], v8, s[8:11], s51 offen sc1
.cs_437:
    s_waitcnt lgkmcnt(0)
    v_mfma_f32_16x16x32_bf16 v[64:67], a[248:251], v[56:59], v[64:67]
    v_mfma_f32_16x16x32_bf16 v[68:71], a[252:255], v[56:59], v[68:71]
    s_cbranch_scc1 .cs_438
    buffer_load_dwordx4 v[92:95], v9, s[8:11], s51 offen sc1
.cs_438:
    v_mfma_f32_16x16x32_bf16 v[72:75], a[248:251], v[60:63], v[72:75]
    v_mfma_f32_16x16x32_bf16 v[76:79], a[252:255], v[60:63], v[76:79]
    v_xor_b32 v17, 0x10000, v17
    v_xor_b32 v18, 0x10000, v18
    s_cselect_b64 s[64:65], 0, -1
    s_add_u32 s4, s34, s37

    v_mov_b32 v112, v80
    v_mov_b32 v113, v81
    v_mov_b32 v114, v82
    v_mov_b32 v115, v83
.g2st_413:
    v_min_u32 v68, 0xfffffffe, v68
    buffer_store_dwordx4 v[68:71], v28, s[8:11], s4 offen sc1
    v_min_u32 v72, 0xfffffffe, v72
    buffer_store_dwordx4 v[72:75], v29, s[8:11], s4 offen sc1
    v_min_u32 v76, 0xfffffffe, v76
    buffer_store_dwordx4 v[76:79], v30, s[8:11], s4 offen sc1
    v_mov_b32 v80, v64
    v_mov_b32 v81, v65
    v_mov_b32 v82, v66
    v_mov_b32 v83, v67
    s_cmp_lg_u32 s56, 0
    s_cbranch_scc1 .g2pf_439
    s_cmp_eq_u32 s38, 0
    s_cbranch_scc1 .g2nc_414
    s_waitcnt vmcnt(0)
    s_mov_b32 s62, 0
.cc_440:
    v_max3_u32 v4, v84, v88, v92
    v_cmp_eq_u32 vcc, -1, v4
    s_cbranch_vccnz .cf_441
    v_add_f32 v84, v84, v88
    v_add_f32 v92, v112, v92
    v_add_f32 v85, v85, v89
    v_add_f32 v93, v113, v93
    v_add_f32 v86, v86, v90
    v_add_f32 v94, v114, v94
    v_add_f32 v87, v87, v91
    v_add_f32 v95, v115, v95
    v_add_f32 v84, v92, v84
    v_add_f32 v85, v93, v85
    v_add_f32 v86, v94, v86
    v_add_f32 v87, v95, v87
    v_sub_f32 v104, 1.0, v100
    v_cvt_pk_bf16_f32 v104, v104, v104
    v_lshlrev_b32 v104, 16, v104
    v_cvt_pk_bf16_f32 v105, v84, v85
    v_lshlrev_b32 v107, 16, v96
    v_and_b32 v108, 0xffff0000, v96
    v_lshlrev_b32 v109, 16, v98
    v_and_b32 v110, 0xffff0000, v98
    v_and_b32 v106, 0xffff0000, v105
    v_lshlrev_b32 v105, 16, v105
    v_mul_f32 v107, v107, v109
    v_mul_f32 v108, v108, v110
    v_mul_f32 v105, v104, v105
    v_mul_f32 v106, v104, v106
    v_cvt_pk_bf16_f32 v107, v107, v108
    v_cvt_pk_bf16_f32 v105, v105, v106
    v_and_b32 v108, 0xffff0000, v107
    v_lshlrev_b32 v107, 16, v107
    v_and_b32 v106, 0xffff0000, v105
    v_lshlrev_b32 v105, 16, v105
    v_mul_f32 v107, v100, v107
    v_mul_f32 v108, v100, v108
    v_cvt_pk_bf16_f32 v107, v107, v108
    v_and_b32 v108, 0xffff0000, v107
    v_lshlrev_b32 v107, 16, v107
    v_add_f32 v105, v105, v107
    v_add_f32 v106, v106, v108
    v_cvt_pk_bf16_f32 v102, v105, v106
    v_cvt_pk_bf16_f32 v105, v86, v87
    v_lshlrev_b32 v107, 16, v97
    v_and_b32 v108, 0xffff0000, v97
    v_lshlrev_b32 v109, 16, v99
    v_and_b32 v110, 0xffff0000, v99
    v_and_b32 v106, 0xffff0000, v105
    v_lshlrev_b32 v105, 16, v105
    v_mul_f32 v107, v107, v109
    v_mul_f32 v108, v108, v110
    v_mul_f32 v105, v104, v105
    v_mul_f32 v106, v104, v106
    v_cvt_pk_bf16_f32 v107, v107, v108
    v_cvt_pk_bf16_f32 v105, v105, v106
    v_and_b32 v108, 0xffff0000, v107
    v_lshlrev_b32 v107, 16, v107
    v_and_b32 v106, 0xffff0000, v105
    v_lshlrev_b32 v105, 16, v105
    v_mul_f32 v107, v100, v107
    v_mul_f32 v108, v100, v108
    v_cvt_pk_bf16_f32 v107, v107, v108
    v_and_b32 v108, 0xffff0000, v107
    v_lshlrev_b32 v107, 16, v107
    v_add_f32 v105, v105, v107
    v_add_f32 v106, v106, v108
    v_cvt_pk_bf16_f32 v103, v105, v106
    buffer_store_dwordx2 v[102:103], v22, s[44:47], s52 offen
.g2nc_414:
    s_add_u32 s51, s34, s37
    s_lshl_b32 s52, s31, 16
    s_lshl_b32 s60, s31, 7
    s_add_u32 s58, s60, 117440512
    s_add_u32 s59, s60, 117448704
    s_add_u32 s60, s60, 121634816

    buffer_load_dwordx2 v[96:97], v22, s[16:19], s52 offen
    buffer_load_dword v98, v23, s[8:11], s58 offen
    buffer_load_dword v99, v23, s[8:11], s59 offen
    buffer_load_dword v100, v16, s[8:11], s60 offen
    buffer_load_dwordx4 v[84:87], v7, s[8:11], s51 offen sc1
    buffer_load_dwordx4 v[88:91], v8, s[8:11], s51 offen sc1
    buffer_load_dwordx4 v[92:95], v9, s[8:11], s51 offen sc1
    s_waitcnt vmcnt(0)
    s_mov_b32 s62, 0
.cc_442:
    v_max3_u32 v4, v84, v88, v92
    v_cmp_eq_u32 vcc, -1, v4
    s_cbranch_vccnz .cf_443
    v_add_f32 v84, v84, v88
    v_add_f32 v92, v80, v92
    v_add_f32 v85, v85, v89
    v_add_f32 v93, v81, v93
    v_add_f32 v86, v86, v90
    v_add_f32 v94, v82, v94
    v_add_f32 v87, v87, v91
    v_add_f32 v95, v83, v95
    v_add_f32 v84, v92, v84
    v_add_f32 v85, v93, v85
    v_add_f32 v86, v94, v86
    v_add_f32 v87, v95, v87
    v_sub_f32 v104, 1.0, v100
    v_cvt_pk_bf16_f32 v104, v104, v104
    v_lshlrev_b32 v104, 16, v104
    v_cvt_pk_bf16_f32 v105, v84, v85
    v_lshlrev_b32 v107, 16, v96
    v_and_b32 v108, 0xffff0000, v96
    v_lshlrev_b32 v109, 16, v98
    v_and_b32 v110, 0xffff0000, v98
    v_and_b32 v106, 0xffff0000, v105
    v_lshlrev_b32 v105, 16, v105
    v_mul_f32 v107, v107, v109
    v_mul_f32 v108, v108, v110
    v_mul_f32 v105, v104, v105
    v_mul_f32 v106, v104, v106
    v_cvt_pk_bf16_f32 v107, v107, v108
    v_cvt_pk_bf16_f32 v105, v105, v106
    v_and_b32 v108, 0xffff0000, v107
    v_lshlrev_b32 v107, 16, v107
    v_and_b32 v106, 0xffff0000, v105
    v_lshlrev_b32 v105, 16, v105
    v_mul_f32 v107, v100, v107
    v_mul_f32 v108, v100, v108
    v_cvt_pk_bf16_f32 v107, v107, v108
    v_and_b32 v108, 0xffff0000, v107
    v_lshlrev_b32 v107, 16, v107
    v_add_f32 v105, v105, v107
    v_add_f32 v106, v106, v108
    v_cvt_pk_bf16_f32 v102, v105, v106
    v_cvt_pk_bf16_f32 v105, v86, v87
    v_lshlrev_b32 v107, 16, v97
    v_and_b32 v108, 0xffff0000, v97
    v_lshlrev_b32 v109, 16, v99
    v_and_b32 v110, 0xffff0000, v99
    v_and_b32 v106, 0xffff0000, v105
    v_lshlrev_b32 v105, 16, v105
    v_mul_f32 v107, v107, v109
    v_mul_f32 v108, v108, v110
    v_mul_f32 v105, v104, v105
    v_mul_f32 v106, v104, v106
    v_cvt_pk_bf16_f32 v107, v107, v108
    v_cvt_pk_bf16_f32 v105, v105, v106
    v_and_b32 v108, 0xffff0000, v107
    v_lshlrev_b32 v107, 16, v107
    v_and_b32 v106, 0xffff0000, v105
    v_lshlrev_b32 v105, 16, v105
    v_mul_f32 v107, v100, v107
    v_mul_f32 v108, v100, v108
    v_cvt_pk_bf16_f32 v107, v107, v108
    v_and_b32 v108, 0xffff0000, v107
    v_lshlrev_b32 v107, 16, v107
    v_add_f32 v105, v105, v107
    v_add_f32 v106, v106, v108
    v_cvt_pk_bf16_f32 v103, v105, v106
    buffer_store_dwordx2 v[102:103], v22, s[44:47], s52 offen
.g2nx_419:
    s_mov_b32 s31, s53
    s_add_u32 s37, s37, 0x10000
    s_cmp_lt_u32 s31, 64
    s_cbranch_scc1 .g2blk_408
    s_branch .g2fin_415

.g2pf_439:
    s_mov_b32 s31, s53
    s_add_u32 s37, s37, 0x10000
    s_cmp_eq_u32 s38, 0
    s_mov_b32 s38, 1
    s_cbranch_scc1 .g2w3_410
    s_waitcnt vmcnt(10)
    s_branch .g2go_409

.g2w3_410:
    s_waitcnt vmcnt(3)
    s_branch .g2go_409
.g2fb_418:
    s_add_u32 s51, s34, s37
    s_lshl_b32 s52, s31, 16
    s_lshl_b32 s60, s31, 7
    s_add_u32 s58, s60, 117440512
    s_add_u32 s59, s60, 117448704
    s_add_u32 s60, s60, 121634816

    s_waitcnt vmcnt(4)
    s_barrier
    ds_read_b128 v[32:35], v17 offset:0
    ds_read_b128 v[36:39], v18 offset:0
    ds_read_b128 v[40:43], v17 offset:1024
    ds_read_b128 v[44:47], v18 offset:1024
    ds_read_b128 v[48:51], v17 offset:2048
    ds_read_b128 v[52:55], v18 offset:2048
    s_waitcnt lgkmcnt(4)
    v_mfma_f32_16x16x32_bf16 v[64:67], a[0:3], v[32:35], 0
    ds_read_b128 v[56:59], v17 offset:3072
    v_mfma_f32_16x16x32_bf16 v[68:71], a[4:7], v[32:35], 0
    s_add_u32 m0, s49, 32768
    s_add_u32 s50, s48, 32768
    v_mfma_f32_16x16x32_bf16 v[72:75], a[0:3], v[36:39], 0
    ds_read_b128 v[60:63], v18 offset:3072
    v_mfma_f32_16x16x32_bf16 v[76:79], a[4:7], v[36:39], 0
    buffer_load_dwordx4 v21, s[8:11], s50 offen offset:0 sc1 lds
    s_waitcnt lgkmcnt(4)
    v_mfma_f32_16x16x32_bf16 v[64:67], a[8:11], v[40:43], v[64:67]
    ds_read_b128 v[32:35], v17 offset:8192
    v_mfma_f32_16x16x32_bf16 v[68:71], a[12:15], v[40:43], v[68:71]
    s_add_u32 m0, s49, 36864
    s_add_u32 s50, s48, 36864
    v_mfma_f32_16x16x32_bf16 v[72:75], a[8:11], v[44:47], v[72:75]
    ds_read_b128 v[36:39], v18 offset:8192
    v_mfma_f32_16x16x32_bf16 v[76:79], a[12:15], v[44:47], v[76:79]
    buffer_load_dwordx4 v21, s[8:11], s50 offen offset:0 sc1 lds
    s_waitcnt lgkmcnt(4)
    v_mfma_f32_16x16x32_bf16 v[64:67], a[16:19], v[48:51], v[64:67]
    ds_read_b128 v[40:43], v17 offset:9216
    v_mfma_f32_16x16x32_bf16 v[68:71], a[20:23], v[48:51], v[68:71]
    s_add_u32 m0, s49, 40960
    s_add_u32 s50, s48, 40960
    v_mfma_f32_16x16x32_bf16 v[72:75], a[16:19], v[52:55], v[72:75]
    ds_read_b128 v[44:47], v18 offset:9216
    v_mfma_f32_16x16x32_bf16 v[76:79], a[20:23], v[52:55], v[76:79]
    buffer_load_dwordx4 v21, s[8:11], s50 offen offset:0 sc1 lds
    s_waitcnt lgkmcnt(4)
    v_mfma_f32_16x16x32_bf16 v[64:67], a[24:27], v[56:59], v[64:67]
    ds_read_b128 v[48:51], v17 offset:10240
    v_mfma_f32_16x16x32_bf16 v[68:71], a[28:31], v[56:59], v[68:71]
    s_add_u32 m0, s49, 45056
    s_add_u32 s50, s48, 45056
    v_mfma_f32_16x16x32_bf16 v[72:75], a[24:27], v[60:63], v[72:75]
    ds_read_b128 v[52:55], v18 offset:10240
    v_mfma_f32_16x16x32_bf16 v[76:79], a[28:31], v[60:63], v[76:79]
    buffer_load_dwordx4 v21, s[8:11], s50 offen offset:0 sc1 lds
    s_waitcnt lgkmcnt(4)
    v_mfma_f32_16x16x32_bf16 v[64:67], a[32:35], v[32:35], v[64:67]
    ds_read_b128 v[56:59], v17 offset:11264
    v_mfma_f32_16x16x32_bf16 v[68:71], a[36:39], v[32:35], v[68:71]
    s_add_u32 m0, s49, 49152
    s_add_u32 s50, s48, 49152
    v_mfma_f32_16x16x32_bf16 v[72:75], a[32:35], v[36:39], v[72:75]
    ds_read_b128 v[60:63], v18 offset:11264
    v_mfma_f32_16x16x32_bf16 v[76:79], a[36:39], v[36:39], v[76:79]
    buffer_load_dwordx4 v21, s[8:11], s50 offen offset:0 sc1 lds
    s_waitcnt lgkmcnt(4)
    v_mfma_f32_16x16x32_bf16 v[64:67], a[40:43], v[40:43], v[64:67]
    s_waitcnt vmcnt(5)
    s_barrier
    ds_read_b128 v[32:35], v17 offset:16384
    v_mfma_f32_16x16x32_bf16 v[68:71], a[44:47], v[40:43], v[68:71]
    s_add_u32 m0, s49, 53248
    s_add_u32 s50, s48, 53248
    v_mfma_f32_16x16x32_bf16 v[72:75], a[40:43], v[44:47], v[72:75]
    ds_read_b128 v[36:39], v18 offset:16384
    v_mfma_f32_16x16x32_bf16 v[76:79], a[44:47], v[44:47], v[76:79]
    buffer_load_dwordx4 v21, s[8:11], s50 offen offset:0 sc1 lds
    s_waitcnt lgkmcnt(4)
    v_mfma_f32_16x16x32_bf16 v[64:67], a[48:51], v[48:51], v[64:67]
    ds_read_b128 v[40:43], v17 offset:17408
    v_mfma_f32_16x16x32_bf16 v[68:71], a[52:55], v[48:51], v[68:71]
    s_add_u32 m0, s49, 57344
    s_add_u32 s50, s48, 57344
    v_mfma_f32_16x16x32_bf16 v[72:75], a[48:51], v[52:55], v[72:75]
    ds_read_b128 v[44:47], v18 offset:17408
    v_mfma_f32_16x16x32_bf16 v[76:79], a[52:55], v[52:55], v[76:79]
    buffer_load_dwordx4 v21, s[8:11], s50 offen offset:0 sc1 lds
    s_waitcnt lgkmcnt(4)
    v_mfma_f32_16x16x32_bf16 v[64:67], a[56:59], v[56:59], v[64:67]
    ds_read_b128 v[48:51], v17 offset:18432
    v_mfma_f32_16x16x32_bf16 v[68:71], a[60:63], v[56:59], v[68:71]
    s_add_u32 m0, s49, 61440
    s_add_u32 s50, s48, 61440
    v_mfma_f32_16x16x32_bf16 v[72:75], a[56:59], v[60:63], v[72:75]
    ds_read_b128 v[52:55], v18 offset:18432
    v_mfma_f32_16x16x32_bf16 v[76:79], a[60:63], v[60:63], v[76:79]
    buffer_load_dwordx4 v21, s[8:11], s50 offen offset:0 sc1 lds
    s_waitcnt lgkmcnt(4)
    v_mfma_f32_16x16x32_bf16 v[64:67], a[64:67], v[32:35], v[64:67]
    ds_read_b128 v[56:59], v17 offset:19456
    v_mfma_f32_16x16x32_bf16 v[68:71], a[68:71], v[32:35], v[68:71]
    v_mfma_f32_16x16x32_bf16 v[72:75], a[64:67], v[36:39], v[72:75]
    ds_read_b128 v[60:63], v18 offset:19456
    v_mfma_f32_16x16x32_bf16 v[76:79], a[68:71], v[36:39], v[76:79]
    buffer_load_dwordx2 v[96:97], v22, s[16:19], s52 offen
    s_waitcnt lgkmcnt(4)
    v_mfma_f32_16x16x32_bf16 v[64:67], a[72:75], v[40:43], v[64:67]
    ds_read_b128 v[32:35], v17 offset:24576
    v_mfma_f32_16x16x32_bf16 v[68:71], a[76:79], v[40:43], v[68:71]
    v_mfma_f32_16x16x32_bf16 v[72:75], a[72:75], v[44:47], v[72:75]
    ds_read_b128 v[36:39], v18 offset:24576
    v_mfma_f32_16x16x32_bf16 v[76:79], a[76:79], v[44:47], v[76:79]
    buffer_load_dword v98, v23, s[8:11], s58 offen
    s_waitcnt lgkmcnt(4)
    v_mfma_f32_16x16x32_bf16 v[64:67], a[80:83], v[48:51], v[64:67]
    ds_read_b128 v[40:43], v17 offset:25600
    v_mfma_f32_16x16x32_bf16 v[68:71], a[84:87], v[48:51], v[68:71]
    v_mfma_f32_16x16x32_bf16 v[72:75], a[80:83], v[52:55], v[72:75]
    ds_read_b128 v[44:47], v18 offset:25600
    v_mfma_f32_16x16x32_bf16 v[76:79], a[84:87], v[52:55], v[76:79]
    buffer_load_dword v99, v23, s[8:11], s59 offen
    s_waitcnt lgkmcnt(4)
    v_mfma_f32_16x16x32_bf16 v[64:67], a[88:91], v[56:59], v[64:67]
    ds_read_b128 v[48:51], v17 offset:26624
    v_mfma_f32_16x16x32_bf16 v[68:71], a[92:95], v[56:59], v[68:71]
    v_mfma_f32_16x16x32_bf16 v[72:75], a[88:91], v[60:63], v[72:75]
    ds_read_b128 v[52:55], v18 offset:26624
    v_mfma_f32_16x16x32_bf16 v[76:79], a[92:95], v[60:63], v[76:79]
    buffer_load_dword v100, v16, s[8:11], s60 offen
    s_waitcnt lgkmcnt(4)
    v_mfma_f32_16x16x32_bf16 v[64:67], a[96:99], v[32:35], v[64:67]
    ds_read_b128 v[56:59], v17 offset:27648
    v_mfma_f32_16x16x32_bf16 v[68:71], a[100:103], v[32:35], v[68:71]
    v_mfma_f32_16x16x32_bf16 v[72:75], a[96:99], v[36:39], v[72:75]
    ds_read_b128 v[60:63], v18 offset:27648
    v_mfma_f32_16x16x32_bf16 v[76:79], a[100:103], v[36:39], v[76:79]
    s_waitcnt lgkmcnt(4)
    v_mfma_f32_16x16x32_bf16 v[64:67], a[104:107], v[40:43], v[64:67]
    s_waitcnt vmcnt(8)
    s_barrier
    ds_read_b128 v[32:35], v17 offset:32768
    v_mfma_f32_16x16x32_bf16 v[68:71], a[108:111], v[40:43], v[68:71]
    v_mfma_f32_16x16x32_bf16 v[72:75], a[104:107], v[44:47], v[72:75]
    ds_read_b128 v[36:39], v18 offset:32768
    v_mfma_f32_16x16x32_bf16 v[76:79], a[108:111], v[44:47], v[76:79]
    s_waitcnt lgkmcnt(4)
    v_mfma_f32_16x16x32_bf16 v[64:67], a[112:115], v[48:51], v[64:67]
    ds_read_b128 v[40:43], v17 offset:33792
    v_mfma_f32_16x16x32_bf16 v[68:71], a[116:119], v[48:51], v[68:71]
    v_mfma_f32_16x16x32_bf16 v[72:75], a[112:115], v[52:55], v[72:75]
    ds_read_b128 v[44:47], v18 offset:33792
    v_mfma_f32_16x16x32_bf16 v[76:79], a[116:119], v[52:55], v[76:79]
    s_waitcnt lgkmcnt(4)
    v_mfma_f32_16x16x32_bf16 v[64:67], a[120:123], v[56:59], v[64:67]
    ds_read_b128 v[48:51], v17 offset:34816
    v_mfma_f32_16x16x32_bf16 v[68:71], a[124:127], v[56:59], v[68:71]
    v_mfma_f32_16x16x32_bf16 v[72:75], a[120:123], v[60:63], v[72:75]
    ds_read_b128 v[52:55], v18 offset:34816
    v_mfma_f32_16x16x32_bf16 v[76:79], a[124:127], v[60:63], v[76:79]
    s_waitcnt lgkmcnt(4)
    v_mfma_f32_16x16x32_bf16 v[64:67], a[128:131], v[32:35], v[64:67]
    ds_read_b128 v[56:59], v17 offset:35840
    v_mfma_f32_16x16x32_bf16 v[68:71], a[132:135], v[32:35], v[68:71]
    v_mfma_f32_16x16x32_bf16 v[72:75], a[128:131], v[36:39], v[72:75]
    ds_read_b128 v[60:63], v18 offset:35840
    v_mfma_f32_16x16x32_bf16 v[76:79], a[132:135], v[36:39], v[76:79]
    s_waitcnt lgkmcnt(4)
    v_mfma_f32_16x16x32_bf16 v[64:67], a[136:139], v[40:43], v[64:67]
    ds_read_b128 v[32:35], v17 offset:40960
    v_mfma_f32_16x16x32_bf16 v[68:71], a[140:143], v[40:43], v[68:71]
    v_mfma_f32_16x16x32_bf16 v[72:75], a[136:139], v[44:47], v[72:75]
    ds_read_b128 v[36:39], v18 offset:40960
    v_mfma_f32_16x16x32_bf16 v[76:79], a[140:143], v[44:47], v[76:79]
    s_waitcnt lgkmcnt(4)
    v_mfma_f32_16x16x32_bf16 v[64:67], a[144:147], v[48:51], v[64:67]
    ds_read_b128 v[40:43], v17 offset:41984
    v_mfma_f32_16x16x32_bf16 v[68:71], a[148:151], v[48:51], v[68:71]
    v_mfma_f32_16x16x32_bf16 v[72:75], a[144:147], v[52:55], v[72:75]
    ds_read_b128 v[44:47], v18 offset:41984
    v_mfma_f32_16x16x32_bf16 v[76:79], a[148:151], v[52:55], v[76:79]
    s_waitcnt lgkmcnt(4)
    v_mfma_f32_16x16x32_bf16 v[64:67], a[152:155], v[56:59], v[64:67]
    ds_read_b128 v[48:51], v17 offset:43008
    v_mfma_f32_16x16x32_bf16 v[68:71], a[156:159], v[56:59], v[68:71]
    v_mfma_f32_16x16x32_bf16 v[72:75], a[152:155], v[60:63], v[72:75]
    ds_read_b128 v[52:55], v18 offset:43008
    v_mfma_f32_16x16x32_bf16 v[76:79], a[156:159], v[60:63], v[76:79]
    s_waitcnt lgkmcnt(4)
    v_mfma_f32_16x16x32_bf16 v[64:67], a[160:163], v[32:35], v[64:67]
    ds_read_b128 v[56:59], v17 offset:44032
    v_mfma_f32_16x16x32_bf16 v[68:71], a[164:167], v[32:35], v[68:71]
    v_mfma_f32_16x16x32_bf16 v[72:75], a[160:163], v[36:39], v[72:75]
    ds_read_b128 v[60:63], v18 offset:44032
    v_mfma_f32_16x16x32_bf16 v[76:79], a[164:167], v[36:39], v[76:79]
    s_waitcnt lgkmcnt(4)
    v_mfma_f32_16x16x32_bf16 v[64:67], a[168:171], v[40:43], v[64:67]
    s_waitcnt vmcnt(4)
    s_barrier
    ds_read_b128 v[32:35], v17 offset:49152
    v_mfma_f32_16x16x32_bf16 v[68:71], a[172:175], v[40:43], v[68:71]
    v_mfma_f32_16x16x32_bf16 v[72:75], a[168:171], v[44:47], v[72:75]
    ds_read_b128 v[36:39], v18 offset:49152
    v_mfma_f32_16x16x32_bf16 v[76:79], a[172:175], v[44:47], v[76:79]
    s_waitcnt lgkmcnt(4)
    v_mfma_f32_16x16x32_bf16 v[64:67], a[176:179], v[48:51], v[64:67]
    ds_read_b128 v[40:43], v17 offset:50176
    v_mfma_f32_16x16x32_bf16 v[68:71], a[180:183], v[48:51], v[68:71]
    v_mfma_f32_16x16x32_bf16 v[72:75], a[176:179], v[52:55], v[72:75]
    ds_read_b128 v[44:47], v18 offset:50176
    v_mfma_f32_16x16x32_bf16 v[76:79], a[180:183], v[52:55], v[76:79]
    s_waitcnt lgkmcnt(4)
    v_mfma_f32_16x16x32_bf16 v[64:67], a[184:187], v[56:59], v[64:67]
    ds_read_b128 v[48:51], v17 offset:51200
    v_mfma_f32_16x16x32_bf16 v[68:71], a[188:191], v[56:59], v[68:71]
    v_mfma_f32_16x16x32_bf16 v[72:75], a[184:187], v[60:63], v[72:75]
    ds_read_b128 v[52:55], v18 offset:51200
    v_mfma_f32_16x16x32_bf16 v[76:79], a[188:191], v[60:63], v[76:79]
    s_waitcnt lgkmcnt(4)
    v_mfma_f32_16x16x32_bf16 v[64:67], a[192:195], v[32:35], v[64:67]
    ds_read_b128 v[56:59], v17 offset:52224
    v_mfma_f32_16x16x32_bf16 v[68:71], a[196:199], v[32:35], v[68:71]
    v_mfma_f32_16x16x32_bf16 v[72:75], a[192:195], v[36:39], v[72:75]
    ds_read_b128 v[60:63], v18 offset:52224
    v_mfma_f32_16x16x32_bf16 v[76:79], a[196:199], v[36:39], v[76:79]
    s_waitcnt lgkmcnt(4)
    v_mfma_f32_16x16x32_bf16 v[64:67], a[200:203], v[40:43], v[64:67]
    ds_read_b128 v[32:35], v17 offset:57344
    v_mfma_f32_16x16x32_bf16 v[68:71], a[204:207], v[40:43], v[68:71]
    v_mfma_f32_16x16x32_bf16 v[72:75], a[200:203], v[44:47], v[72:75]
    ds_read_b128 v[36:39], v18 offset:57344
    v_mfma_f32_16x16x32_bf16 v[76:79], a[204:207], v[44:47], v[76:79]
    s_waitcnt lgkmcnt(4)
    v_mfma_f32_16x16x32_bf16 v[64:67], a[208:211], v[48:51], v[64:67]
    ds_read_b128 v[40:43], v17 offset:58368
    v_mfma_f32_16x16x32_bf16 v[68:71], a[212:215], v[48:51], v[68:71]
    v_mfma_f32_16x16x32_bf16 v[72:75], a[208:211], v[52:55], v[72:75]
    ds_read_b128 v[44:47], v18 offset:58368
    v_mfma_f32_16x16x32_bf16 v[76:79], a[212:215], v[52:55], v[76:79]
    s_waitcnt lgkmcnt(4)
    v_mfma_f32_16x16x32_bf16 v[64:67], a[216:219], v[56:59], v[64:67]
    ds_read_b128 v[48:51], v17 offset:59392
    v_mfma_f32_16x16x32_bf16 v[68:71], a[220:223], v[56:59], v[68:71]
    v_mfma_f32_16x16x32_bf16 v[72:75], a[216:219], v[60:63], v[72:75]
    ds_read_b128 v[52:55], v18 offset:59392
    v_mfma_f32_16x16x32_bf16 v[76:79], a[220:223], v[60:63], v[76:79]
    s_waitcnt lgkmcnt(4)
    v_mfma_f32_16x16x32_bf16 v[64:67], a[224:227], v[32:35], v[64:67]
    ds_read_b128 v[56:59], v17 offset:60416
    v_mfma_f32_16x16x32_bf16 v[68:71], a[228:231], v[32:35], v[68:71]
    v_mfma_f32_16x16x32_bf16 v[72:75], a[224:227], v[36:39], v[72:75]
    ds_read_b128 v[60:63], v18 offset:60416
    v_mfma_f32_16x16x32_bf16 v[76:79], a[228:231], v[36:39], v[76:79]
    s_waitcnt lgkmcnt(4)
    v_mfma_f32_16x16x32_bf16 v[64:67], a[232:235], v[40:43], v[64:67]
    v_mfma_f32_16x16x32_bf16 v[68:71], a[236:239], v[40:43], v[68:71]
    v_mfma_f32_16x16x32_bf16 v[72:75], a[232:235], v[44:47], v[72:75]
    v_mfma_f32_16x16x32_bf16 v[76:79], a[236:239], v[44:47], v[76:79]
    s_waitcnt lgkmcnt(2)
    v_mfma_f32_16x16x32_bf16 v[64:67], a[240:243], v[48:51], v[64:67]
    v_mfma_f32_16x16x32_bf16 v[68:71], a[244:247], v[48:51], v[68:71]
    v_mfma_f32_16x16x32_bf16 v[72:75], a[240:243], v[52:55], v[72:75]
    v_mfma_f32_16x16x32_bf16 v[76:79], a[244:247], v[52:55], v[76:79]
    s_waitcnt lgkmcnt(0)
    v_mfma_f32_16x16x32_bf16 v[64:67], a[248:251], v[56:59], v[64:67]
    v_mfma_f32_16x16x32_bf16 v[68:71], a[252:255], v[56:59], v[68:71]
    v_mfma_f32_16x16x32_bf16 v[72:75], a[248:251], v[60:63], v[72:75]
    v_mfma_f32_16x16x32_bf16 v[76:79], a[252:255], v[60:63], v[76:79]
    v_xor_b32 v17, 0x10000, v17
    v_xor_b32 v18, 0x10000, v18
    s_nop 3
    v_min_u32 v68, 0xfffffffe, v68
    buffer_store_dwordx4 v[68:71], v28, s[8:11], s51 offen sc1
    v_min_u32 v72, 0xfffffffe, v72
    buffer_store_dwordx4 v[72:75], v29, s[8:11], s51 offen sc1
    v_min_u32 v76, 0xfffffffe, v76
    buffer_store_dwordx4 v[76:79], v30, s[8:11], s51 offen sc1
    s_waitcnt vmcnt(3)
    v_sub_f32 v104, 1.0, v100
    v_cvt_pk_bf16_f32 v104, v104, v104
    v_lshlrev_b32 v104, 16, v104
    v_lshlrev_b32 v107, 16, v96
    v_and_b32 v108, 0xffff0000, v96
    v_lshlrev_b32 v109, 16, v98
    v_and_b32 v110, 0xffff0000, v98
    v_mul_f32 v107, v107, v109
    v_mul_f32 v108, v108, v110
    v_cvt_pk_bf16_f32 v107, v107, v108
    v_and_b32 v108, 0xffff0000, v107
    v_lshlrev_b32 v107, 16, v107
    v_mul_f32 v107, v100, v107
    v_mul_f32 v108, v100, v108
    v_cvt_pk_bf16_f32 v107, v107, v108
    v_and_b32 v113, 0xffff0000, v107
    v_lshlrev_b32 v112, 16, v107
    v_lshlrev_b32 v107, 16, v97
    v_and_b32 v108, 0xffff0000, v97
    v_lshlrev_b32 v109, 16, v99
    v_and_b32 v110, 0xffff0000, v99
    v_mul_f32 v107, v107, v109
    v_mul_f32 v108, v108, v110
    v_cvt_pk_bf16_f32 v107, v107, v108
    v_and_b32 v108, 0xffff0000, v107
    v_lshlrev_b32 v107, 16, v107
    v_mul_f32 v107, v100, v107
    v_mul_f32 v108, v100, v108
    v_cvt_pk_bf16_f32 v107, v107, v108
    v_and_b32 v115, 0xffff0000, v107
    v_lshlrev_b32 v114, 16, v107
    s_waitcnt vmcnt(0)
    buffer_load_dwordx4 v[84:87], v7, s[8:11], s51 offen sc1
    buffer_load_dwordx4 v[88:91], v8, s[8:11], s51 offen sc1
    buffer_load_dwordx4 v[92:95], v9, s[8:11], s51 offen sc1
    s_waitcnt vmcnt(0)
    s_mov_b32 s62, 0
.cc_444:
    v_max3_u32 v4, v84, v88, v92
    v_cmp_eq_u32 vcc, -1, v4
    s_cbranch_vccnz .cf_445
    v_add_f32 v84, v84, v88
    v_add_f32 v92, v64, v92
    v_add_f32 v85, v85, v89
    v_add_f32 v93, v65, v93
    v_add_f32 v86, v86, v90
    v_add_f32 v94, v66, v94
    v_add_f32 v87, v87, v91
    v_add_f32 v95, v67, v95
    v_add_f32 v84, v92, v84
    v_add_f32 v85, v93, v85
    v_add_f32 v86, v94, v86
    v_add_f32 v87, v95, v87
    v_cvt_pk_bf16_f32 v105, v84, v85
    v_cvt_pk_bf16_f32 v107, v86, v87
    v_and_b32 v106, 0xffff0000, v105
    v_lshlrev_b32 v105, 16, v105
    v_and_b32 v108, 0xffff0000, v107
    v_lshlrev_b32 v107, 16, v107
    v_mul_f32 v105, v104, v105
    v_mul_f32 v106, v104, v106
    v_mul_f32 v107, v104, v107
    v_mul_f32 v108, v104, v108
    v_cvt_pk_bf16_f32 v105, v105, v106
    v_cvt_pk_bf16_f32 v107, v107, v108
    v_and_b32 v106, 0xffff0000, v105
    v_lshlrev_b32 v105, 16, v105
    v_and_b32 v108, 0xffff0000, v107
    v_lshlrev_b32 v107, 16, v107
    v_add_f32 v105, v105, v112
    v_add_f32 v106, v106, v113
    v_add_f32 v107, v107, v114
    v_add_f32 v108, v108, v115
    v_cvt_pk_bf16_f32 v102, v105, v106
    v_cvt_pk_bf16_f32 v103, v107, v108
    buffer_store_dwordx2 v[102:103], v22, s[44:47], s52 offen
    s_branch .g2nx_419
.cf_422:
    buffer_load_dwordx4 v[84:87], v7, s[8:11], s51 offen sc1
    buffer_load_dwordx4 v[88:91], v8, s[8:11], s51 offen sc1
    buffer_load_dwordx4 v[92:95], v9, s[8:11], s51 offen sc1
    s_add_u32 s62, s62, 1
    s_cmp_gt_u32 s62, 0x400000
    s_cbranch_scc1 .mg_end_1
    s_waitcnt vmcnt(0)
    s_branch .cc_421

.cf_431:
    buffer_load_dwordx4 v[84:87], v7, s[8:11], s51 offen sc1
    buffer_load_dwordx4 v[88:91], v8, s[8:11], s51 offen sc1
    buffer_load_dwordx4 v[92:95], v9, s[8:11], s51 offen sc1
    s_add_u32 s62, s62, 1
    s_cmp_gt_u32 s62, 0x400000
    s_cbranch_scc1 .mg_end_1
    s_waitcnt vmcnt(0)
    s_branch .cc_430

.cf_441:
    buffer_load_dwordx4 v[84:87], v7, s[8:11], s51 offen sc1
    buffer_load_dwordx4 v[88:91], v8, s[8:11], s51 offen sc1
    buffer_load_dwordx4 v[92:95], v9, s[8:11], s51 offen sc1
    s_add_u32 s62, s62, 1
    s_cmp_gt_u32 s62, 0x400000
    s_cbranch_scc1 .mg_end_1
    s_waitcnt vmcnt(0)
    s_branch .cc_440

.cf_443:
    buffer_load_dwordx4 v[84:87], v7, s[8:11], s51 offen sc1
    buffer_load_dwordx4 v[88:91], v8, s[8:11], s51 offen sc1
    buffer_load_dwordx4 v[92:95], v9, s[8:11], s51 offen sc1
    s_add_u32 s62, s62, 1
    s_cmp_gt_u32 s62, 0x400000
    s_cbranch_scc1 .mg_end_1
    s_waitcnt vmcnt(0)
    s_branch .cc_442

.cf_445:
    buffer_load_dwordx4 v[84:87], v7, s[8:11], s51 offen sc1
    buffer_load_dwordx4 v[88:91], v8, s[8:11], s51 offen sc1
    buffer_load_dwordx4 v[92:95], v9, s[8:11], s51 offen sc1
    s_add_u32 s62, s62, 1
    s_cmp_gt_u32 s62, 0x400000
    s_cbranch_scc1 .mg_end_1
    s_waitcnt vmcnt(0)
    s_branch .cc_444

.g2fin_415:
    s_endpgm
.cvrole_369:
    s_lshl_b32 s4, s91, 3
    s_add_u32 s4, s4, s26
    s_add_u32 s4, s4, 72
    s_lshl_b32 s4, s4, 8
    s_add_u32 s92, s4, 92274688
    s_lshl_b32 s4, s24, 2
    s_add_u32 s92, s92, s4
    v_mov_b32 v4, 0
    s_mov_b64 exec, 1
    buffer_store_dword v4, v4, s[8:11], s92 offen sc1
    s_mov_b64 exec, -1

    s_waitcnt vmcnt(0)
    s_barrier
    v_mov_b32 v243, s99
    v_mov_b32 v242, 0
    s_cmp_lg_u32 s24, 0
    s_cbranch_scc1 .a1_446
    v_mov_b32 v242, s26
    v_lshlrev_b32 v242, 6, v242
    v_add_u32 v242, s97, v242
    v_and_b32 v242, 255, v242
    s_mov_b64 exec, 1
    buffer_atomic_add v243, v242, s[20:23], 0 offen sc1
    s_mov_b64 exec, -1

.a1_446:
    s_waitcnt vmcnt(0)
    s_cmp_lg_u32 s24, 0
    s_cbranch_scc1 .pm_448
    s_lshl_b32 s93, s91, 3
    s_add_u32 s93, s93, s26
    s_sub_u32 s93, s93, 24
    s_and_b32 s94, s93, 1
    s_sub_u32 s5, 0, s100
    s_and_b32 s5, s5, 0x1fffff
    s_add_u32 s5, s5, 100663296
    s_lshl_b32 s4, s94, 21
    s_add_u32 s5, s5, s4
    s_lshl_b32 s4, s93, 8
    s_add_u32 s5, s5, s4
    s_add_u32 s6, s5, 8192
    v_and_b32 v4, 63, v0
    v_lshlrev_b32 v4, 2, v4
    v_mov_b32 v5, -1
    s_mov_b32 s82, 0x7fffffff
    s_mov_b32 s83, 0x7fffffff
    buffer_store_dword v5, v4, s[8:11], s5 offen sc1
    s_waitcnt vmcnt(0)

    s_memtime s[72:73]
    s_waitcnt lgkmcnt(0)
    buffer_store_dword v5, v4, s[8:11], s6 offen sc1
    s_waitcnt vmcnt(0)
    s_memtime s[84:85]
    s_waitcnt lgkmcnt(0)
    s_sub_u32 s84, s84, s72
    s_min_u32 s83, s83, s84

    s_memtime s[72:73]
    s_waitcnt lgkmcnt(0)
    buffer_store_dword v5, v4, s[8:11], s5 offen sc1
    s_waitcnt vmcnt(0)
    s_memtime s[84:85]
    s_waitcnt lgkmcnt(0)
    s_sub_u32 s84, s84, s72
    s_min_u32 s82, s82, s84

    s_memtime s[72:73]
    s_waitcnt lgkmcnt(0)
    buffer_store_dword v5, v4, s[8:11], s6 offen sc1
    s_waitcnt vmcnt(0)
    s_memtime s[84:85]
    s_waitcnt lgkmcnt(0)
    s_sub_u32 s84, s84, s72
    s_min_u32 s83, s83, s84

    s_memtime s[72:73]
    s_waitcnt lgkmcnt(0)
    buffer_store_dword v5, v4, s[8:11], s5 offen sc1
    s_waitcnt vmcnt(0)
    s_memtime s[84:85]
    s_waitcnt lgkmcnt(0)
    s_sub_u32 s84, s84, s72
    s_min_u32 s82, s82, s84

    s_memtime s[72:73]
    s_waitcnt lgkmcnt(0)
    buffer_store_dword v5, v4, s[8:11], s6 offen sc1
    s_waitcnt vmcnt(0)
    s_memtime s[84:85]
    s_waitcnt lgkmcnt(0)
    s_sub_u32 s84, s84, s72
    s_min_u32 s83, s83, s84

    s_memtime s[72:73]
    s_waitcnt lgkmcnt(0)
    buffer_store_dword v5, v4, s[8:11], s5 offen sc1
    s_waitcnt vmcnt(0)
    s_memtime s[84:85]
    s_waitcnt lgkmcnt(0)
    s_sub_u32 s84, s84, s72
    s_min_u32 s82, s82, s84

    s_memtime s[72:73]
    s_waitcnt lgkmcnt(0)
    buffer_store_dword v5, v4, s[8:11], s6 offen sc1
    s_waitcnt vmcnt(0)
    s_memtime s[84:85]
    s_waitcnt lgkmcnt(0)
    s_sub_u32 s84, s84, s72
    s_min_u32 s83, s83, s84

    s_memtime s[72:73]
    s_waitcnt lgkmcnt(0)
    buffer_store_dword v5, v4, s[8:11], s5 offen sc1
    s_waitcnt vmcnt(0)
    s_memtime s[84:85]
    s_waitcnt lgkmcnt(0)
    s_sub_u32 s84, s84, s72
    s_min_u32 s82, s82, s84

    s_cmp_lt_u32 s82, s83
    s_cselect_b32 s4, 1, 0
    s_mul_i32 s94, s94, 6
    s_lshl_b32 s4, s4, s94
    s_add_u32 s95, s4, 0x1000000

.pm_448:
    s_cmp_lg_u32 s24, 0
    s_cbranch_scc1 .pv_449
    s_mov_b64 exec, 1
    v_mov_b32 v4, s95
    v_mov_b32 v5, 4
    buffer_atomic_add v4, v5, s[20:23], s97 offen sc1
    s_mov_b64 exec, -1

.pv_449:
    s_barrier
    s_lshl_b32 s93, s91, 3
    s_add_u32 s93, s93, s26
    s_sub_u32 s93, s93, 24

    s_load_dwordx2 s[40:41], s[0:1], 0
    s_load_dwordx2 s[42:43], s[0:1], 104

    v_and_b32 v1, 63, v0
    v_and_b32 v2, 15, v1
    v_lshrrev_b32 v3, 4, v1

    s_waitcnt lgkmcnt(0)
    s_mov_b32 s12, s40
    s_and_b32 s13, s41, 0xffff
    s_mov_b32 s14, 0x400000
    s_mov_b32 s15, 0x00020000

    s_mov_b32 s16, s42
    s_and_b32 s17, s43, 0xffff
    s_mov_b32 s18, 0x800
    s_mov_b32 s19, 0x00020000

    s_lshl_b32 s3, s93, 6
    s_lshl_b32 s4, s24, 4
    s_add_u32 s3, s3, s4
    v_lshlrev_b32 v8, 4, v1
    buffer_load_dwordx4 v[16:19], v8, s[16:19], 0 offen
    buffer_load_dwordx4 v[20:23], v8, s[16:19], 0 offen offset:1024
    s_lshl_b32 s5, s3, 11

    buffer_load_dwordx4 v[64:67], v8, s[12:15], s5 offen
    buffer_load_dwordx4 v[68:71], v8, s[12:15], s5 offen offset:1024
    s_add_u32 s5, s5, 2048

    buffer_load_dwordx4 v[72:75], v8, s[12:15], s5 offen
    buffer_load_dwordx4 v[76:79], v8, s[12:15], s5 offen offset:1024
    s_add_u32 s5, s5, 2048

    buffer_load_dwordx4 v[80:83], v8, s[12:15], s5 offen
    buffer_load_dwordx4 v[84:87], v8, s[12:15], s5 offen offset:1024
    s_add_u32 s5, s5, 2048

    buffer_load_dwordx4 v[88:91], v8, s[12:15], s5 offen
    buffer_load_dwordx4 v[92:95], v8, s[12:15], s5 offen offset:1024
    s_add_u32 s5, s5, 2048

    buffer_load_dwordx4 v[96:99], v8, s[12:15], s5 offen
    buffer_load_dwordx4 v[100:103], v8, s[12:15], s5 offen offset:1024
    s_add_u32 s5, s5, 2048

    buffer_load_dwordx4 v[104:107], v8, s[12:15], s5 offen
    buffer_load_dwordx4 v[108:111], v8, s[12:15], s5 offen offset:1024
    s_add_u32 s5, s5, 2048

    buffer_load_dwordx4 v[112:115], v8, s[12:15], s5 offen
    buffer_load_dwordx4 v[116:119], v8, s[12:15], s5 offen offset:1024
    s_add_u32 s5, s5, 2048

    buffer_load_dwordx4 v[120:123], v8, s[12:15], s5 offen
    buffer_load_dwordx4 v[124:127], v8, s[12:15], s5 offen offset:1024
    s_add_u32 s5, s5, 2048

    buffer_load_dwordx4 v[128:131], v8, s[12:15], s5 offen
    buffer_load_dwordx4 v[132:135], v8, s[12:15], s5 offen offset:1024
    s_add_u32 s5, s5, 2048

    buffer_load_dwordx4 v[136:139], v8, s[12:15], s5 offen
    buffer_load_dwordx4 v[140:143], v8, s[12:15], s5 offen offset:1024
    s_add_u32 s5, s5, 2048

    buffer_load_dwordx4 v[144:147], v8, s[12:15], s5 offen
    buffer_load_dwordx4 v[148:151], v8, s[12:15], s5 offen offset:1024
    s_add_u32 s5, s5, 2048

    buffer_load_dwordx4 v[152:155], v8, s[12:15], s5 offen
    buffer_load_dwordx4 v[156:159], v8, s[12:15], s5 offen offset:1024
    s_add_u32 s5, s5, 2048

    buffer_load_dwordx4 v[160:163], v8, s[12:15], s5 offen
    buffer_load_dwordx4 v[164:167], v8, s[12:15], s5 offen offset:1024
    s_add_u32 s5, s5, 2048

    buffer_load_dwordx4 v[168:171], v8, s[12:15], s5 offen
    buffer_load_dwordx4 v[172:175], v8, s[12:15], s5 offen offset:1024
    s_add_u32 s5, s5, 2048

    buffer_load_dwordx4 v[176:179], v8, s[12:15], s5 offen
    buffer_load_dwordx4 v[180:183], v8, s[12:15], s5 offen offset:1024
    s_add_u32 s5, s5, 2048

    buffer_load_dwordx4 v[184:187], v8, s[12:15], s5 offen
    buffer_load_dwordx4 v[188:191], v8, s[12:15], s5 offen offset:1024
    s_add_u32 s5, s5, 2048

    v_and_b32 v241, 3, v0
    v_lshlrev_b32 v241, 2, v241

    v_and_b32 v240, 12, v0
    v_lshl_add_u32 v241, v240, 4, v241
    v_add_u32 v241, s97, v241
    v_and_b32 v241, 255, v241

    buffer_load_dword v240, v241, s[20:23], 0 offen sc1
    s_waitcnt vmcnt(29)
    v_dot2_f32_bf16 v24, v64, v16, 0
    v_dot2_f32_bf16 v25, v72, v16, 0
    v_dot2_f32_bf16 v24, v65, v17, v24
    v_dot2_f32_bf16 v25, v73, v17, v25
    v_dot2_f32_bf16 v24, v66, v18, v24
    v_dot2_f32_bf16 v25, v74, v18, v25
    v_dot2_f32_bf16 v24, v67, v19, v24
    v_dot2_f32_bf16 v25, v75, v19, v25
    v_dot2_f32_bf16 v24, v68, v20, v24
    v_dot2_f32_bf16 v25, v76, v20, v25
    v_dot2_f32_bf16 v24, v69, v21, v24
    v_dot2_f32_bf16 v25, v77, v21, v25
    v_dot2_f32_bf16 v24, v70, v22, v24
    v_dot2_f32_bf16 v25, v78, v22, v25
    v_dot2_f32_bf16 v24, v71, v23, v24
    v_dot2_f32_bf16 v25, v79, v23, v25
    s_waitcnt vmcnt(25)
    v_dot2_f32_bf16 v26, v80, v16, 0
    v_dot2_f32_bf16 v27, v88, v16, 0
    v_dot2_f32_bf16 v26, v81, v17, v26
    v_dot2_f32_bf16 v27, v89, v17, v27
    v_dot2_f32_bf16 v26, v82, v18, v26
    v_dot2_f32_bf16 v27, v90, v18, v27
    v_dot2_f32_bf16 v26, v83, v19, v26
    v_dot2_f32_bf16 v27, v91, v19, v27
    v_dot2_f32_bf16 v26, v84, v20, v26
    v_dot2_f32_bf16 v27, v92, v20, v27
    v_dot2_f32_bf16 v26, v85, v21, v26
    v_dot2_f32_bf16 v27, v93, v21, v27
    v_dot2_f32_bf16 v26, v86, v22, v26
    v_dot2_f32_bf16 v27, v94, v22, v27
    v_dot2_f32_bf16 v26, v87, v23, v26
    v_dot2_f32_bf16 v27, v95, v23, v27
    s_waitcnt vmcnt(21)
    v_dot2_f32_bf16 v28, v96, v16, 0
    v_dot2_f32_bf16 v29, v104, v16, 0
    v_dot2_f32_bf16 v28, v97, v17, v28
    v_dot2_f32_bf16 v29, v105, v17, v29
    v_dot2_f32_bf16 v28, v98, v18, v28
    v_dot2_f32_bf16 v29, v106, v18, v29
    v_dot2_f32_bf16 v28, v99, v19, v28
    v_dot2_f32_bf16 v29, v107, v19, v29
    v_dot2_f32_bf16 v28, v100, v20, v28
    v_dot2_f32_bf16 v29, v108, v20, v29
    v_dot2_f32_bf16 v28, v101, v21, v28
    v_dot2_f32_bf16 v29, v109, v21, v29
    v_dot2_f32_bf16 v28, v102, v22, v28
    v_dot2_f32_bf16 v29, v110, v22, v29
    v_dot2_f32_bf16 v28, v103, v23, v28
    v_dot2_f32_bf16 v29, v111, v23, v29
    s_waitcnt vmcnt(17)
    v_dot2_f32_bf16 v30, v112, v16, 0
    v_dot2_f32_bf16 v31, v120, v16, 0
    v_dot2_f32_bf16 v30, v113, v17, v30
    v_dot2_f32_bf16 v31, v121, v17, v31
    v_dot2_f32_bf16 v30, v114, v18, v30
    v_dot2_f32_bf16 v31, v122, v18, v31
    v_dot2_f32_bf16 v30, v115, v19, v30
    v_dot2_f32_bf16 v31, v123, v19, v31
    v_dot2_f32_bf16 v30, v116, v20, v30
    v_dot2_f32_bf16 v31, v124, v20, v31
    v_dot2_f32_bf16 v30, v117, v21, v30
    v_dot2_f32_bf16 v31, v125, v21, v31
    v_dot2_f32_bf16 v30, v118, v22, v30
    v_dot2_f32_bf16 v31, v126, v22, v31
    v_dot2_f32_bf16 v30, v119, v23, v30
    v_dot2_f32_bf16 v31, v127, v23, v31
    s_waitcnt vmcnt(13)
    v_dot2_f32_bf16 v32, v128, v16, 0
    v_dot2_f32_bf16 v33, v136, v16, 0
    v_dot2_f32_bf16 v32, v129, v17, v32
    v_dot2_f32_bf16 v33, v137, v17, v33
    v_dot2_f32_bf16 v32, v130, v18, v32
    v_dot2_f32_bf16 v33, v138, v18, v33
    v_dot2_f32_bf16 v32, v131, v19, v32
    v_dot2_f32_bf16 v33, v139, v19, v33
    v_dot2_f32_bf16 v32, v132, v20, v32
    v_dot2_f32_bf16 v33, v140, v20, v33
    v_dot2_f32_bf16 v32, v133, v21, v32
    v_dot2_f32_bf16 v33, v141, v21, v33
    v_dot2_f32_bf16 v32, v134, v22, v32
    v_dot2_f32_bf16 v33, v142, v22, v33
    v_dot2_f32_bf16 v32, v135, v23, v32
    v_dot2_f32_bf16 v33, v143, v23, v33
    s_waitcnt vmcnt(9)
    v_dot2_f32_bf16 v34, v144, v16, 0
    v_dot2_f32_bf16 v35, v152, v16, 0
    v_dot2_f32_bf16 v34, v145, v17, v34
    v_dot2_f32_bf16 v35, v153, v17, v35
    v_dot2_f32_bf16 v34, v146, v18, v34
    v_dot2_f32_bf16 v35, v154, v18, v35
    v_dot2_f32_bf16 v34, v147, v19, v34
    v_dot2_f32_bf16 v35, v155, v19, v35
    v_dot2_f32_bf16 v34, v148, v20, v34
    v_dot2_f32_bf16 v35, v156, v20, v35
    v_dot2_f32_bf16 v34, v149, v21, v34
    v_dot2_f32_bf16 v35, v157, v21, v35
    v_dot2_f32_bf16 v34, v150, v22, v34
    v_dot2_f32_bf16 v35, v158, v22, v35
    v_dot2_f32_bf16 v34, v151, v23, v34
    v_dot2_f32_bf16 v35, v159, v23, v35
    s_waitcnt vmcnt(5)
    v_dot2_f32_bf16 v36, v160, v16, 0
    v_dot2_f32_bf16 v37, v168, v16, 0
    v_dot2_f32_bf16 v36, v161, v17, v36
    v_dot2_f32_bf16 v37, v169, v17, v37
    v_dot2_f32_bf16 v36, v162, v18, v36
    v_dot2_f32_bf16 v37, v170, v18, v37
    v_dot2_f32_bf16 v36, v163, v19, v36
    v_dot2_f32_bf16 v37, v171, v19, v37
    v_dot2_f32_bf16 v36, v164, v20, v36
    v_dot2_f32_bf16 v37, v172, v20, v37
    v_dot2_f32_bf16 v36, v165, v21, v36
    v_dot2_f32_bf16 v37, v173, v21, v37
    v_dot2_f32_bf16 v36, v166, v22, v36
    v_dot2_f32_bf16 v37, v174, v22, v37
    v_dot2_f32_bf16 v36, v167, v23, v36
    v_dot2_f32_bf16 v37, v175, v23, v37
    s_waitcnt vmcnt(1)
    v_dot2_f32_bf16 v38, v176, v16, 0
    v_dot2_f32_bf16 v39, v184, v16, 0
    v_dot2_f32_bf16 v38, v177, v17, v38
    v_dot2_f32_bf16 v39, v185, v17, v39
    v_dot2_f32_bf16 v38, v178, v18, v38
    v_dot2_f32_bf16 v39, v186, v18, v39
    v_dot2_f32_bf16 v38, v179, v19, v38
    v_dot2_f32_bf16 v39, v187, v19, v39
    v_dot2_f32_bf16 v38, v180, v20, v38
    v_dot2_f32_bf16 v39, v188, v20, v39
    v_dot2_f32_bf16 v38, v181, v21, v38
    v_dot2_f32_bf16 v39, v189, v21, v39
    v_dot2_f32_bf16 v38, v182, v22, v38
    v_dot2_f32_bf16 v39, v190, v22, v39
    v_dot2_f32_bf16 v38, v183, v23, v38
    v_dot2_f32_bf16 v39, v191, v23, v39
    s_waitcnt vmcnt(0)
    s_mov_b32 s62, 0
.vp_450:
    v_readlane_b32 s4, v240, 0
    v_readlane_b32 s7, v240, 1
    v_readlane_b32 s6, v240, 2

    v_readlane_b32 s5, v240, 4
    s_add_u32 s4, s4, s5
    v_readlane_b32 s5, v240, 8
    s_add_u32 s4, s4, s5
    v_readlane_b32 s5, v240, 12
    s_add_u32 s4, s4, s5
    s_cmp_ge_u32 s4, 256
    s_cbranch_scc1 .vd_451
    s_cmp_lg_u32 s6, 0
    s_cbranch_scc1 .vs_452
    s_add_u32 s62, s62, 1
    s_cmp_gt_u32 s62, 0x100000
    s_cbranch_scc1 .mg_end_1
    s_sleep 8
    buffer_load_dword v240, v241, s[20:23], 0 offen sc1
    s_waitcnt vmcnt(0)
    s_branch .vp_450

.vs_452:
    s_lshr_b32 s25, s2, 5
    s_and_b32 s26, s2, 31
    s_mov_b32 s27, 1
    s_mov_b32 s99, 1
    s_mov_b32 s97, 144
    s_waitcnt vmcnt(0) lgkmcnt(0)
    s_barrier
    s_branch .mg_role_3

.vd_451:
    v_permlane32_swap_b32 v24, v26
    v_permlane32_swap_b32 v25, v27
    v_permlane32_swap_b32 v28, v30
    v_permlane32_swap_b32 v29, v31
    v_permlane32_swap_b32 v32, v34
    v_permlane32_swap_b32 v33, v35
    v_permlane32_swap_b32 v36, v38
    v_permlane32_swap_b32 v37, v39
    v_add_f32 v24, v24, v26
    v_add_f32 v25, v25, v27
    v_add_f32 v28, v28, v30
    v_add_f32 v29, v29, v31
    v_add_f32 v32, v32, v34
    v_add_f32 v33, v33, v35
    v_add_f32 v36, v36, v38
    v_add_f32 v37, v37, v39
    s_nop 0
    v_permlane16_swap_b32 v24, v25
    v_permlane16_swap_b32 v28, v29
    v_permlane16_swap_b32 v32, v33
    v_permlane16_swap_b32 v36, v37
    v_add_f32 v24, v24, v25
    v_add_f32 v28, v28, v29
    v_add_f32 v32, v32, v33
    v_add_f32 v36, v36, v37
    v_add_f32_dpp v24, v24, v24 row_ror:8 row_mask:0xf bank_mask:0xf
    v_add_f32_dpp v28, v28, v28 row_ror:8 row_mask:0xf bank_mask:0xf
    v_add_f32_dpp v32, v32, v32 row_ror:8 row_mask:0xf bank_mask:0xf
    v_add_f32_dpp v36, v36, v36 row_ror:8 row_mask:0xf bank_mask:0xf
    v_add_f32_dpp v24, v24, v24 row_ror:4 row_mask:0xf bank_mask:0xf
    v_add_f32_dpp v28, v28, v28 row_ror:4 row_mask:0xf bank_mask:0xf
    v_add_f32_dpp v32, v32, v32 row_ror:4 row_mask:0xf bank_mask:0xf
    v_add_f32_dpp v36, v36, v36 row_ror:4 row_mask:0xf bank_mask:0xf
    v_add_f32_dpp v24, v24, v24 row_ror:2 row_mask:0xf bank_mask:0xf
    v_add_f32_dpp v28, v28, v28 row_ror:2 row_mask:0xf bank_mask:0xf
    v_add_f32_dpp v32, v32, v32 row_ror:2 row_mask:0xf bank_mask:0xf
    v_add_f32_dpp v36, v36, v36 row_ror:2 row_mask:0xf bank_mask:0xf
    v_add_f32_dpp v24, v24, v24 row_ror:1 row_mask:0xf bank_mask:0xf
    v_add_f32_dpp v28, v28, v28 row_ror:1 row_mask:0xf bank_mask:0xf
    v_add_f32_dpp v32, v32, v32 row_ror:1 row_mask:0xf bank_mask:0xf
    v_add_f32_dpp v36, v36, v36 row_ror:1 row_mask:0xf bank_mask:0xf
    v_cmp_eq_u32 vcc, 1, v2
    s_nop 1
    v_cndmask_b32 v24, v24, v28, vcc
    v_cmp_eq_u32 vcc, 2, v2
    s_nop 1
    v_cndmask_b32 v24, v24, v32, vcc
    v_cmp_eq_u32 vcc, 3, v2
    s_nop 1
    v_cndmask_b32 v24, v24, v36, vcc
    v_cvt_pk_bf16_f32 v24, v24, v24
    s_mov_b32 s38, 0xbfb8aa3b
    v_lshlrev_b32 v24, 16, v24
    v_mul_f32 v24, s38, v24
    v_exp_f32 v24, v24
    v_lshlrev_b32 v8, 4, v2
    v_add_f32 v24, 1.0, v24
    v_rcp_f32 v24, v24
    v_lshl_add_u32 v8, v3, 2, v8
    v_cvt_pk_bf16_f32 v24, v24, v24
    v_cmp_gt_u32 vcc, 4, v2
    s_lshl_b32 s5, s3, 2
    s_add_u32 s5, s5, 121634816
    v_lshlrev_b32 v24, 16, v24
    s_mov_b64 exec, vcc
    buffer_store_dword v24, v8, s[8:11], s5 offen sc1
    s_mov_b64 exec, -1

    s_load_dwordx4 s[52:55], s[0:1], 8
    s_load_dwordx2 s[56:57], s[0:1], 24

    v_and_b32 v1, 63, v0
    v_and_b32 v2, 15, v1
    v_lshrrev_b32 v3, 4, v1

    v_lshrrev_b32 v4, 2, v1
    v_and_b32 v5, 3, v1
    v_lshlrev_b32 v10, 11, v4
    v_lshl_add_u32 v10, v5, 4, v10
    s_lshl_b32 s4, s93, 6
    v_add_u32 v10, s4, v10
    s_lshl_b32 s70, s24, 20
    s_mul_i32 s71, s24, 33280
    v_lshrrev_b32 v4, 2, v2
    v_lshl_add_u32 v4, v3, 5, v4
    v_lshlrev_b32 v4, 6, v4
    v_lshl_add_u32 v11, v5, 3, v4
    v_add_u32 v11, s71, v11
    s_lshl_b32 s4, s93, 17
    s_lshl_b32 s5, s24, 8
    s_add_u32 s72, s4, s5
    s_add_u32 s72, s72, 125829120
    v_lshlrev_b32 v12, 12, v2
    v_lshl_add_u32 v12, v3, 4, v12
    v_lshlrev_b32 v13, 3, v2
    s_lshl_b32 s6, s93, 8
    s_waitcnt lgkmcnt(0)

    s_mov_b32 s80, s52
    s_and_b32 s81, s53, 0xffff
    s_mov_b32 s82, 0x400000
    s_mov_b32 s83, 0x00020000

    s_mov_b32 s84, s54
    s_and_b32 s85, s55, 0xffff
    s_mov_b32 s86, 0x400000
    s_mov_b32 s87, 0x00020000

    s_mov_b32 s76, s56
    s_and_b32 s77, s57, 0xffff
    s_mov_b32 s78, 0x2000
    s_mov_b32 s79, 0x00020000

    buffer_load_dwordx2 v[196:197], v13, s[76:79], s6 offen
    buffer_load_dwordx2 v[198:199], v13, s[76:79], s6 offen offset:128

    s_add_u32 s4, s70, 0
    s_add_u32 m0, s71, 0
    s_sub_u32 s5, s4, 8192
    s_max_i32 s5, s5, 0
    s_mov_b64 exec, 0xffff
    buffer_load_dwordx4 v10, s[80:83], s5 offen lds
    s_mov_b64 exec, -1

    s_add_u32 m0, s71, 256
    s_nop 0
    buffer_load_dwordx4 v10, s[80:83], s4 offen lds
    s_add_u32 m0, s71, 8448
    s_nop 0
    buffer_load_dwordx4 v10, s[84:87], s4 offen lds
    s_add_u32 m0, s71, 1280
    s_add_u32 s4, s4, 32768
    buffer_load_dwordx4 v10, s[80:83], s4 offen lds
    s_add_u32 m0, s71, 9472
    s_nop 0
    buffer_load_dwordx4 v10, s[84:87], s4 offen lds
    s_add_u32 m0, s71, 2304
    s_add_u32 s4, s4, 32768
    buffer_load_dwordx4 v10, s[80:83], s4 offen lds
    s_add_u32 m0, s71, 10496
    s_nop 0
    buffer_load_dwordx4 v10, s[84:87], s4 offen lds
    s_add_u32 m0, s71, 3328
    s_add_u32 s4, s4, 32768
    buffer_load_dwordx4 v10, s[80:83], s4 offen lds
    s_add_u32 m0, s71, 11520
    s_nop 0
    buffer_load_dwordx4 v10, s[84:87], s4 offen lds
    s_add_u32 m0, s71, 4352
    s_add_u32 s4, s4, 32768
    buffer_load_dwordx4 v10, s[80:83], s4 offen lds
    s_add_u32 m0, s71, 12544
    s_nop 0
    buffer_load_dwordx4 v10, s[84:87], s4 offen lds
    s_add_u32 m0, s71, 5376
    s_add_u32 s4, s4, 32768
    buffer_load_dwordx4 v10, s[80:83], s4 offen lds
    s_add_u32 m0, s71, 13568
    s_nop 0
    buffer_load_dwordx4 v10, s[84:87], s4 offen lds
    s_add_u32 m0, s71, 6400
    s_add_u32 s4, s4, 32768
    buffer_load_dwordx4 v10, s[80:83], s4 offen lds
    s_add_u32 m0, s71, 14592
    s_nop 0
    buffer_load_dwordx4 v10, s[84:87], s4 offen lds
    s_add_u32 m0, s71, 7424
    s_add_u32 s4, s4, 32768
    buffer_load_dwordx4 v10, s[80:83], s4 offen lds
    s_add_u32 m0, s71, 15616
    s_nop 0
    buffer_load_dwordx4 v10, s[84:87], s4 offen lds
    s_add_u32 s4, s70, 262144
    s_add_u32 m0, s71, 16640
    s_sub_u32 s5, s4, 8192
    s_max_i32 s5, s5, 0
    s_mov_b64 exec, 0xffff
    buffer_load_dwordx4 v10, s[80:83], s5 offen lds
    s_mov_b64 exec, -1

    s_add_u32 m0, s71, 16896
    s_nop 0
    buffer_load_dwordx4 v10, s[80:83], s4 offen lds
    s_add_u32 m0, s71, 25088
    s_nop 0
    buffer_load_dwordx4 v10, s[84:87], s4 offen lds
    s_add_u32 m0, s71, 17920
    s_add_u32 s4, s4, 32768
    buffer_load_dwordx4 v10, s[80:83], s4 offen lds
    s_add_u32 m0, s71, 26112
    s_nop 0
    buffer_load_dwordx4 v10, s[84:87], s4 offen lds
    s_add_u32 m0, s71, 18944
    s_add_u32 s4, s4, 32768
    buffer_load_dwordx4 v10, s[80:83], s4 offen lds
    s_add_u32 m0, s71, 27136
    s_nop 0
    buffer_load_dwordx4 v10, s[84:87], s4 offen lds
    s_add_u32 m0, s71, 19968
    s_add_u32 s4, s4, 32768
    buffer_load_dwordx4 v10, s[80:83], s4 offen lds
    s_add_u32 m0, s71, 28160
    s_nop 0
    buffer_load_dwordx4 v10, s[84:87], s4 offen lds
    s_add_u32 m0, s71, 20992
    s_add_u32 s4, s4, 32768
    buffer_load_dwordx4 v10, s[80:83], s4 offen lds
    s_add_u32 m0, s71, 29184
    s_nop 0
    buffer_load_dwordx4 v10, s[84:87], s4 offen lds
    s_add_u32 m0, s71, 22016
    s_add_u32 s4, s4, 32768
    buffer_load_dwordx4 v10, s[80:83], s4 offen lds
    s_add_u32 m0, s71, 30208
    s_nop 0
    buffer_load_dwordx4 v10, s[84:87], s4 offen lds
    s_add_u32 m0, s71, 23040
    s_add_u32 s4, s4, 32768
    buffer_load_dwordx4 v10, s[80:83], s4 offen lds
    s_add_u32 m0, s71, 31232
    s_nop 0
    buffer_load_dwordx4 v10, s[84:87], s4 offen lds
    s_add_u32 m0, s71, 24064
    s_add_u32 s4, s4, 32768
    buffer_load_dwordx4 v10, s[80:83], s4 offen lds
    s_add_u32 m0, s71, 32256
    s_nop 0
    buffer_load_dwordx4 v10, s[84:87], s4 offen lds
    s_waitcnt vmcnt(17)
    v_alignbit_b32 v196, v196, v196, 16
    v_alignbit_b32 v197, v197, v197, 16
    v_alignbit_b32 v198, v198, v198, 16
    v_alignbit_b32 v199, v199, v199, 16
    ds_read_b64_tr_b16 v[16:17], v11 offset:0
    ds_read_b64_tr_b16 v[18:19], v11 offset:256
    ds_read_b64_tr_b16 v[20:21], v11 offset:512
    ds_read_b64_tr_b16 v[22:23], v11 offset:768
    ds_read_b64_tr_b16 v[24:25], v11 offset:1024
    ds_read_b64_tr_b16 v[26:27], v11 offset:1280
    ds_read_b64_tr_b16 v[28:29], v11 offset:1536
    ds_read_b64_tr_b16 v[30:31], v11 offset:1792
    ds_read_b64_tr_b16 v[32:33], v11 offset:2048
    ds_read_b64_tr_b16 v[34:35], v11 offset:8448
    ds_read_b64_tr_b16 v[36:37], v11 offset:8704
    ds_read_b64_tr_b16 v[38:39], v11 offset:8960
    ds_read_b64_tr_b16 v[40:41], v11 offset:9216
    ds_read_b64_tr_b16 v[42:43], v11 offset:9472
    ds_read_b64_tr_b16 v[44:45], v11 offset:9728
    ds_read_b64_tr_b16 v[46:47], v11 offset:9984
    ds_read_b64_tr_b16 v[48:49], v11 offset:10240
    ds_read_b64_tr_b16 v[50:51], v11 offset:32
    ds_read_b64_tr_b16 v[52:53], v11 offset:288
    ds_read_b64_tr_b16 v[54:55], v11 offset:544
    ds_read_b64_tr_b16 v[56:57], v11 offset:800
    ds_read_b64_tr_b16 v[58:59], v11 offset:1056
    ds_read_b64_tr_b16 v[60:61], v11 offset:1312
    ds_read_b64_tr_b16 v[62:63], v11 offset:1568
    ds_read_b64_tr_b16 v[64:65], v11 offset:1824
    ds_read_b64_tr_b16 v[66:67], v11 offset:2080
    ds_read_b64_tr_b16 v[68:69], v11 offset:8480
    ds_read_b64_tr_b16 v[70:71], v11 offset:8736
    ds_read_b64_tr_b16 v[72:73], v11 offset:8992
    ds_read_b64_tr_b16 v[74:75], v11 offset:9248
    ds_read_b64_tr_b16 v[76:77], v11 offset:9504
    ds_read_b64_tr_b16 v[78:79], v11 offset:9760
    ds_read_b64_tr_b16 v[80:81], v11 offset:10016
    ds_read_b64_tr_b16 v[82:83], v11 offset:10272
    s_waitcnt lgkmcnt(0)
    s_cmp_eq_u32 s24, 0
    s_cselect_b32 exec_lo, 0xffff, 0
    s_mov_b32 exec_hi, 0
    v_mov_b32 v16, 0
    v_mov_b32 v17, 0
    v_mov_b32 v50, 0
    v_mov_b32 v51, 0
    s_mov_b64 exec, -1
    s_add_u32 s4, s70, 524288
    s_add_u32 m0, s71, 0
    s_sub_u32 s5, s4, 8192
    s_max_i32 s5, s5, 0
    s_mov_b64 exec, 0xffff
    buffer_load_dwordx4 v10, s[80:83], s5 offen lds
    s_mov_b64 exec, -1

    s_add_u32 m0, s71, 256
    s_nop 0
    buffer_load_dwordx4 v10, s[80:83], s4 offen lds
    s_add_u32 m0, s71, 8448
    s_nop 0
    buffer_load_dwordx4 v10, s[84:87], s4 offen lds
    s_add_u32 m0, s71, 1280
    s_add_u32 s4, s4, 32768
    buffer_load_dwordx4 v10, s[80:83], s4 offen lds
    s_add_u32 m0, s71, 9472
    s_nop 0
    buffer_load_dwordx4 v10, s[84:87], s4 offen lds
    s_add_u32 m0, s71, 2304
    s_add_u32 s4, s4, 32768
    buffer_load_dwordx4 v10, s[80:83], s4 offen lds
    s_add_u32 m0, s71, 10496
    s_nop 0
    buffer_load_dwordx4 v10, s[84:87], s4 offen lds
    s_add_u32 m0, s71, 3328
    s_add_u32 s4, s4, 32768
    buffer_load_dwordx4 v10, s[80:83], s4 offen lds
    s_add_u32 m0, s71, 11520
    s_nop 0
    buffer_load_dwordx4 v10, s[84:87], s4 offen lds
    s_add_u32 m0, s71, 4352
    s_add_u32 s4, s4, 32768
    buffer_load_dwordx4 v10, s[80:83], s4 offen lds
    s_add_u32 m0, s71, 12544
    s_nop 0
    buffer_load_dwordx4 v10, s[84:87], s4 offen lds
    s_add_u32 m0, s71, 5376
    s_add_u32 s4, s4, 32768
    buffer_load_dwordx4 v10, s[80:83], s4 offen lds
    s_add_u32 m0, s71, 13568
    s_nop 0
    buffer_load_dwordx4 v10, s[84:87], s4 offen lds
    s_add_u32 m0, s71, 6400
    s_add_u32 s4, s4, 32768
    buffer_load_dwordx4 v10, s[80:83], s4 offen lds
    s_add_u32 m0, s71, 14592
    s_nop 0
    buffer_load_dwordx4 v10, s[84:87], s4 offen lds
    s_add_u32 m0, s71, 7424
    s_add_u32 s4, s4, 32768
    buffer_load_dwordx4 v10, s[80:83], s4 offen lds
    s_add_u32 m0, s71, 15616
    s_nop 0
    buffer_load_dwordx4 v10, s[84:87], s4 offen lds
    v_alignbit_b32 v84, v17, v16, 16
    v_alignbit_b32 v85, v18, v17, 16
    v_alignbit_b32 v86, v19, v18, 16
    v_alignbit_b32 v87, v20, v19, 16
    v_alignbit_b32 v88, v21, v20, 16
    v_alignbit_b32 v89, v22, v21, 16
    v_alignbit_b32 v90, v23, v22, 16
    v_alignbit_b32 v91, v24, v23, 16
    v_alignbit_b32 v92, v25, v24, 16
    v_alignbit_b32 v93, v26, v25, 16
    v_alignbit_b32 v94, v27, v26, 16
    v_alignbit_b32 v95, v28, v27, 16
    v_alignbit_b32 v96, v29, v28, 16
    v_alignbit_b32 v97, v30, v29, 16
    v_alignbit_b32 v98, v31, v30, 16
    v_alignbit_b32 v99, v32, v31, 16
    v_alignbit_b32 v100, v33, v32, 16
    v_dot2_f32_bf16 v102, v84, v197, 0
    v_dot2_f32_bf16 v103, v17, v197, 0
    v_dot2_f32_bf16 v106, v85, v197, 0
    v_dot2_f32_bf16 v107, v18, v197, 0
    v_dot2_f32_bf16 v110, v86, v197, 0
    v_dot2_f32_bf16 v111, v19, v197, 0
    v_dot2_f32_bf16 v114, v87, v197, 0
    v_dot2_f32_bf16 v115, v20, v197, 0
    v_dot2_f32_bf16 v102, v85, v196, v102
    v_dot2_f32_bf16 v103, v18, v196, v103
    v_dot2_f32_bf16 v106, v86, v196, v106
    v_dot2_f32_bf16 v107, v19, v196, v107
    v_dot2_f32_bf16 v110, v87, v196, v110
    v_dot2_f32_bf16 v111, v20, v196, v111
    v_dot2_f32_bf16 v114, v88, v196, v114
    v_dot2_f32_bf16 v115, v21, v196, v115
    v_lshlrev_b32 v104, 16, v34
    v_and_b32 v105, 0xffff0000, v34
    v_lshlrev_b32 v108, 16, v35
    v_and_b32 v109, 0xffff0000, v35
    v_lshlrev_b32 v112, 16, v36
    v_and_b32 v113, 0xffff0000, v36
    v_lshlrev_b32 v116, 16, v37
    v_and_b32 v117, 0xffff0000, v37
    v_mul_f32 v102, v102, v104
    v_mul_f32 v103, v103, v105
    v_mul_f32 v106, v106, v108
    v_mul_f32 v107, v107, v109
    v_mul_f32 v110, v110, v112
    v_mul_f32 v111, v111, v113
    v_mul_f32 v114, v114, v116
    v_mul_f32 v115, v115, v117
    v_cvt_pk_bf16_f32 v137, v103, v102
    v_cvt_pk_bf16_f32 v136, v107, v106
    v_cvt_pk_bf16_f32 v135, v111, v110
    v_cvt_pk_bf16_f32 v134, v115, v114
    s_add_u32 s4, s72, 0
    buffer_store_dwordx4 v[134:137], v12, s[8:11], s4 offen offset:0
    v_dot2_f32_bf16 v118, v88, v197, 0
    v_dot2_f32_bf16 v119, v21, v197, 0
    v_dot2_f32_bf16 v122, v89, v197, 0
    v_dot2_f32_bf16 v123, v22, v197, 0
    v_dot2_f32_bf16 v126, v90, v197, 0
    v_dot2_f32_bf16 v127, v23, v197, 0
    v_dot2_f32_bf16 v130, v91, v197, 0
    v_dot2_f32_bf16 v131, v24, v197, 0
    v_dot2_f32_bf16 v118, v89, v196, v118
    v_dot2_f32_bf16 v119, v22, v196, v119
    v_dot2_f32_bf16 v122, v90, v196, v122
    v_dot2_f32_bf16 v123, v23, v196, v123
    v_dot2_f32_bf16 v126, v91, v196, v126
    v_dot2_f32_bf16 v127, v24, v196, v127
    v_dot2_f32_bf16 v130, v92, v196, v130
    v_dot2_f32_bf16 v131, v25, v196, v131
    v_lshlrev_b32 v120, 16, v38
    v_and_b32 v121, 0xffff0000, v38
    v_lshlrev_b32 v124, 16, v39
    v_and_b32 v125, 0xffff0000, v39
    v_lshlrev_b32 v128, 16, v40
    v_and_b32 v129, 0xffff0000, v40
    v_lshlrev_b32 v132, 16, v41
    v_and_b32 v133, 0xffff0000, v41
    v_mul_f32 v118, v118, v120
    v_mul_f32 v119, v119, v121
    v_mul_f32 v122, v122, v124
    v_mul_f32 v123, v123, v125
    v_mul_f32 v126, v126, v128
    v_mul_f32 v127, v127, v129
    v_mul_f32 v130, v130, v132
    v_mul_f32 v131, v131, v133
    v_cvt_pk_bf16_f32 v141, v119, v118
    v_cvt_pk_bf16_f32 v140, v123, v122
    v_cvt_pk_bf16_f32 v139, v127, v126
    v_cvt_pk_bf16_f32 v138, v131, v130
    buffer_store_dwordx4 v[138:141], v12, s[8:11], s4 offen offset:1024
    v_dot2_f32_bf16 v102, v92, v197, 0
    v_dot2_f32_bf16 v103, v25, v197, 0
    v_dot2_f32_bf16 v106, v93, v197, 0
    v_dot2_f32_bf16 v107, v26, v197, 0
    v_dot2_f32_bf16 v110, v94, v197, 0
    v_dot2_f32_bf16 v111, v27, v197, 0
    v_dot2_f32_bf16 v114, v95, v197, 0
    v_dot2_f32_bf16 v115, v28, v197, 0
    v_dot2_f32_bf16 v102, v93, v196, v102
    v_dot2_f32_bf16 v103, v26, v196, v103
    v_dot2_f32_bf16 v106, v94, v196, v106
    v_dot2_f32_bf16 v107, v27, v196, v107
    v_dot2_f32_bf16 v110, v95, v196, v110
    v_dot2_f32_bf16 v111, v28, v196, v111
    v_dot2_f32_bf16 v114, v96, v196, v114
    v_dot2_f32_bf16 v115, v29, v196, v115
    v_lshlrev_b32 v104, 16, v42
    v_and_b32 v105, 0xffff0000, v42
    v_lshlrev_b32 v108, 16, v43
    v_and_b32 v109, 0xffff0000, v43
    v_lshlrev_b32 v112, 16, v44
    v_and_b32 v113, 0xffff0000, v44
    v_lshlrev_b32 v116, 16, v45
    v_and_b32 v117, 0xffff0000, v45
    v_mul_f32 v102, v102, v104
    v_mul_f32 v103, v103, v105
    v_mul_f32 v106, v106, v108
    v_mul_f32 v107, v107, v109
    v_mul_f32 v110, v110, v112
    v_mul_f32 v111, v111, v113
    v_mul_f32 v114, v114, v116
    v_mul_f32 v115, v115, v117
    v_cvt_pk_bf16_f32 v145, v103, v102
    v_cvt_pk_bf16_f32 v144, v107, v106
    v_cvt_pk_bf16_f32 v143, v111, v110
    v_cvt_pk_bf16_f32 v142, v115, v114
    buffer_store_dwordx4 v[142:145], v12, s[8:11], s4 offen offset:2048
    v_dot2_f32_bf16 v118, v96, v197, 0
    v_dot2_f32_bf16 v119, v29, v197, 0
    v_dot2_f32_bf16 v122, v97, v197, 0
    v_dot2_f32_bf16 v123, v30, v197, 0
    v_dot2_f32_bf16 v126, v98, v197, 0
    v_dot2_f32_bf16 v127, v31, v197, 0
    v_dot2_f32_bf16 v130, v99, v197, 0
    v_dot2_f32_bf16 v131, v32, v197, 0
    v_dot2_f32_bf16 v118, v97, v196, v118
    v_dot2_f32_bf16 v119, v30, v196, v119
    v_dot2_f32_bf16 v122, v98, v196, v122
    v_dot2_f32_bf16 v123, v31, v196, v123
    v_dot2_f32_bf16 v126, v99, v196, v126
    v_dot2_f32_bf16 v127, v32, v196, v127
    v_dot2_f32_bf16 v130, v100, v196, v130
    v_dot2_f32_bf16 v131, v33, v196, v131
    v_lshlrev_b32 v120, 16, v46
    v_and_b32 v121, 0xffff0000, v46
    v_lshlrev_b32 v124, 16, v47
    v_and_b32 v125, 0xffff0000, v47
    v_lshlrev_b32 v128, 16, v48
    v_and_b32 v129, 0xffff0000, v48
    v_lshlrev_b32 v132, 16, v49
    v_and_b32 v133, 0xffff0000, v49
    v_mul_f32 v118, v118, v120
    v_mul_f32 v119, v119, v121
    v_mul_f32 v122, v122, v124
    v_mul_f32 v123, v123, v125
    v_mul_f32 v126, v126, v128
    v_mul_f32 v127, v127, v129
    v_mul_f32 v130, v130, v132
    v_mul_f32 v131, v131, v133
    v_cvt_pk_bf16_f32 v149, v119, v118
    v_cvt_pk_bf16_f32 v148, v123, v122
    v_cvt_pk_bf16_f32 v147, v127, v126
    v_cvt_pk_bf16_f32 v146, v131, v130
    buffer_store_dwordx4 v[146:149], v12, s[8:11], s4 offen offset:3072
    v_alignbit_b32 v84, v51, v50, 16
    v_alignbit_b32 v85, v52, v51, 16
    v_alignbit_b32 v86, v53, v52, 16
    v_alignbit_b32 v87, v54, v53, 16
    v_alignbit_b32 v88, v55, v54, 16
    v_alignbit_b32 v89, v56, v55, 16
    v_alignbit_b32 v90, v57, v56, 16
    v_alignbit_b32 v91, v58, v57, 16
    v_alignbit_b32 v92, v59, v58, 16
    v_alignbit_b32 v93, v60, v59, 16
    v_alignbit_b32 v94, v61, v60, 16
    v_alignbit_b32 v95, v62, v61, 16
    v_alignbit_b32 v96, v63, v62, 16
    v_alignbit_b32 v97, v64, v63, 16
    v_alignbit_b32 v98, v65, v64, 16
    v_alignbit_b32 v99, v66, v65, 16
    v_alignbit_b32 v100, v67, v66, 16
    v_dot2_f32_bf16 v102, v84, v199, 0
    v_dot2_f32_bf16 v103, v51, v199, 0
    v_dot2_f32_bf16 v106, v85, v199, 0
    v_dot2_f32_bf16 v107, v52, v199, 0
    v_dot2_f32_bf16 v110, v86, v199, 0
    v_dot2_f32_bf16 v111, v53, v199, 0
    v_dot2_f32_bf16 v114, v87, v199, 0
    v_dot2_f32_bf16 v115, v54, v199, 0
    v_dot2_f32_bf16 v102, v85, v198, v102
    v_dot2_f32_bf16 v103, v52, v198, v103
    v_dot2_f32_bf16 v106, v86, v198, v106
    v_dot2_f32_bf16 v107, v53, v198, v107
    v_dot2_f32_bf16 v110, v87, v198, v110
    v_dot2_f32_bf16 v111, v54, v198, v111
    v_dot2_f32_bf16 v114, v88, v198, v114
    v_dot2_f32_bf16 v115, v55, v198, v115
    v_lshlrev_b32 v104, 16, v68
    v_and_b32 v105, 0xffff0000, v68
    v_lshlrev_b32 v108, 16, v69
    v_and_b32 v109, 0xffff0000, v69
    v_lshlrev_b32 v112, 16, v70
    v_and_b32 v113, 0xffff0000, v70
    v_lshlrev_b32 v116, 16, v71
    v_and_b32 v117, 0xffff0000, v71
    v_mul_f32 v102, v102, v104
    v_mul_f32 v103, v103, v105
    v_mul_f32 v106, v106, v108
    v_mul_f32 v107, v107, v109
    v_mul_f32 v110, v110, v112
    v_mul_f32 v111, v111, v113
    v_mul_f32 v114, v114, v116
    v_mul_f32 v115, v115, v117
    v_cvt_pk_bf16_f32 v153, v103, v102
    v_cvt_pk_bf16_f32 v152, v107, v106
    v_cvt_pk_bf16_f32 v151, v111, v110
    v_cvt_pk_bf16_f32 v150, v115, v114
    s_add_u32 s4, s72, 65536
    buffer_store_dwordx4 v[150:153], v12, s[8:11], s4 offen offset:0
    v_dot2_f32_bf16 v118, v88, v199, 0
    v_dot2_f32_bf16 v119, v55, v199, 0
    v_dot2_f32_bf16 v122, v89, v199, 0
    v_dot2_f32_bf16 v123, v56, v199, 0
    v_dot2_f32_bf16 v126, v90, v199, 0
    v_dot2_f32_bf16 v127, v57, v199, 0
    v_dot2_f32_bf16 v130, v91, v199, 0
    v_dot2_f32_bf16 v131, v58, v199, 0
    v_dot2_f32_bf16 v118, v89, v198, v118
    v_dot2_f32_bf16 v119, v56, v198, v119
    v_dot2_f32_bf16 v122, v90, v198, v122
    v_dot2_f32_bf16 v123, v57, v198, v123
    v_dot2_f32_bf16 v126, v91, v198, v126
    v_dot2_f32_bf16 v127, v58, v198, v127
    v_dot2_f32_bf16 v130, v92, v198, v130
    v_dot2_f32_bf16 v131, v59, v198, v131
    v_lshlrev_b32 v120, 16, v72
    v_and_b32 v121, 0xffff0000, v72
    v_lshlrev_b32 v124, 16, v73
    v_and_b32 v125, 0xffff0000, v73
    v_lshlrev_b32 v128, 16, v74
    v_and_b32 v129, 0xffff0000, v74
    v_lshlrev_b32 v132, 16, v75
    v_and_b32 v133, 0xffff0000, v75
    v_mul_f32 v118, v118, v120
    v_mul_f32 v119, v119, v121
    v_mul_f32 v122, v122, v124
    v_mul_f32 v123, v123, v125
    v_mul_f32 v126, v126, v128
    v_mul_f32 v127, v127, v129
    v_mul_f32 v130, v130, v132
    v_mul_f32 v131, v131, v133
    v_cvt_pk_bf16_f32 v157, v119, v118
    v_cvt_pk_bf16_f32 v156, v123, v122
    v_cvt_pk_bf16_f32 v155, v127, v126
    v_cvt_pk_bf16_f32 v154, v131, v130
    buffer_store_dwordx4 v[154:157], v12, s[8:11], s4 offen offset:1024
    v_dot2_f32_bf16 v102, v92, v199, 0
    v_dot2_f32_bf16 v103, v59, v199, 0
    v_dot2_f32_bf16 v106, v93, v199, 0
    v_dot2_f32_bf16 v107, v60, v199, 0
    v_dot2_f32_bf16 v110, v94, v199, 0
    v_dot2_f32_bf16 v111, v61, v199, 0
    v_dot2_f32_bf16 v114, v95, v199, 0
    v_dot2_f32_bf16 v115, v62, v199, 0
    v_dot2_f32_bf16 v102, v93, v198, v102
    v_dot2_f32_bf16 v103, v60, v198, v103
    v_dot2_f32_bf16 v106, v94, v198, v106
    v_dot2_f32_bf16 v107, v61, v198, v107
    v_dot2_f32_bf16 v110, v95, v198, v110
    v_dot2_f32_bf16 v111, v62, v198, v111
    v_dot2_f32_bf16 v114, v96, v198, v114
    v_dot2_f32_bf16 v115, v63, v198, v115
    v_lshlrev_b32 v104, 16, v76
    v_and_b32 v105, 0xffff0000, v76
    v_lshlrev_b32 v108, 16, v77
    v_and_b32 v109, 0xffff0000, v77
    v_lshlrev_b32 v112, 16, v78
    v_and_b32 v113, 0xffff0000, v78
    v_lshlrev_b32 v116, 16, v79
    v_and_b32 v117, 0xffff0000, v79
    v_mul_f32 v102, v102, v104
    v_mul_f32 v103, v103, v105
    v_mul_f32 v106, v106, v108
    v_mul_f32 v107, v107, v109
    v_mul_f32 v110, v110, v112
    v_mul_f32 v111, v111, v113
    v_mul_f32 v114, v114, v116
    v_mul_f32 v115, v115, v117
    v_cvt_pk_bf16_f32 v161, v103, v102
    v_cvt_pk_bf16_f32 v160, v107, v106
    v_cvt_pk_bf16_f32 v159, v111, v110
    v_cvt_pk_bf16_f32 v158, v115, v114
    buffer_store_dwordx4 v[158:161], v12, s[8:11], s4 offen offset:2048
    v_dot2_f32_bf16 v118, v96, v199, 0
    v_dot2_f32_bf16 v119, v63, v199, 0
    v_dot2_f32_bf16 v122, v97, v199, 0
    v_dot2_f32_bf16 v123, v64, v199, 0
    v_dot2_f32_bf16 v126, v98, v199, 0
    v_dot2_f32_bf16 v127, v65, v199, 0
    v_dot2_f32_bf16 v130, v99, v199, 0
    v_dot2_f32_bf16 v131, v66, v199, 0
    v_dot2_f32_bf16 v118, v97, v198, v118
    v_dot2_f32_bf16 v119, v64, v198, v119
    v_dot2_f32_bf16 v122, v98, v198, v122
    v_dot2_f32_bf16 v123, v65, v198, v123
    v_dot2_f32_bf16 v126, v99, v198, v126
    v_dot2_f32_bf16 v127, v66, v198, v127
    v_dot2_f32_bf16 v130, v100, v198, v130
    v_dot2_f32_bf16 v131, v67, v198, v131
    v_lshlrev_b32 v120, 16, v80
    v_and_b32 v121, 0xffff0000, v80
    v_lshlrev_b32 v124, 16, v81
    v_and_b32 v125, 0xffff0000, v81
    v_lshlrev_b32 v128, 16, v82
    v_and_b32 v129, 0xffff0000, v82
    v_lshlrev_b32 v132, 16, v83
    v_and_b32 v133, 0xffff0000, v83
    v_mul_f32 v118, v118, v120
    v_mul_f32 v119, v119, v121
    v_mul_f32 v122, v122, v124
    v_mul_f32 v123, v123, v125
    v_mul_f32 v126, v126, v128
    v_mul_f32 v127, v127, v129
    v_mul_f32 v130, v130, v132
    v_mul_f32 v131, v131, v133
    v_cvt_pk_bf16_f32 v165, v119, v118
    v_cvt_pk_bf16_f32 v164, v123, v122
    v_cvt_pk_bf16_f32 v163, v127, v126
    v_cvt_pk_bf16_f32 v162, v131, v130
    buffer_store_dwordx4 v[162:165], v12, s[8:11], s4 offen offset:3072
    s_waitcnt vmcnt(25)
    ds_read_b64_tr_b16 v[16:17], v11 offset:16640
    ds_read_b64_tr_b16 v[18:19], v11 offset:16896
    ds_read_b64_tr_b16 v[20:21], v11 offset:17152
    ds_read_b64_tr_b16 v[22:23], v11 offset:17408
    ds_read_b64_tr_b16 v[24:25], v11 offset:17664
    ds_read_b64_tr_b16 v[26:27], v11 offset:17920
    ds_read_b64_tr_b16 v[28:29], v11 offset:18176
    ds_read_b64_tr_b16 v[30:31], v11 offset:18432
    ds_read_b64_tr_b16 v[32:33], v11 offset:18688
    ds_read_b64_tr_b16 v[34:35], v11 offset:25088
    ds_read_b64_tr_b16 v[36:37], v11 offset:25344
    ds_read_b64_tr_b16 v[38:39], v11 offset:25600
    ds_read_b64_tr_b16 v[40:41], v11 offset:25856
    ds_read_b64_tr_b16 v[42:43], v11 offset:26112
    ds_read_b64_tr_b16 v[44:45], v11 offset:26368
    ds_read_b64_tr_b16 v[46:47], v11 offset:26624
    ds_read_b64_tr_b16 v[48:49], v11 offset:26880
    ds_read_b64_tr_b16 v[50:51], v11 offset:16672
    ds_read_b64_tr_b16 v[52:53], v11 offset:16928
    ds_read_b64_tr_b16 v[54:55], v11 offset:17184
    ds_read_b64_tr_b16 v[56:57], v11 offset:17440
    ds_read_b64_tr_b16 v[58:59], v11 offset:17696
    ds_read_b64_tr_b16 v[60:61], v11 offset:17952
    ds_read_b64_tr_b16 v[62:63], v11 offset:18208
    ds_read_b64_tr_b16 v[64:65], v11 offset:18464
    ds_read_b64_tr_b16 v[66:67], v11 offset:18720
    ds_read_b64_tr_b16 v[68:69], v11 offset:25120
    ds_read_b64_tr_b16 v[70:71], v11 offset:25376
    ds_read_b64_tr_b16 v[72:73], v11 offset:25632
    ds_read_b64_tr_b16 v[74:75], v11 offset:25888
    ds_read_b64_tr_b16 v[76:77], v11 offset:26144
    ds_read_b64_tr_b16 v[78:79], v11 offset:26400
    ds_read_b64_tr_b16 v[80:81], v11 offset:26656
    ds_read_b64_tr_b16 v[82:83], v11 offset:26912
    s_waitcnt lgkmcnt(0)
    s_add_u32 s4, s70, 786432
    s_add_u32 m0, s71, 16640
    s_sub_u32 s5, s4, 8192
    s_max_i32 s5, s5, 0
    s_mov_b64 exec, 0xffff
    buffer_load_dwordx4 v10, s[80:83], s5 offen lds
    s_mov_b64 exec, -1

    s_add_u32 m0, s71, 16896
    s_nop 0
    buffer_load_dwordx4 v10, s[80:83], s4 offen lds
    s_add_u32 m0, s71, 25088
    s_nop 0
    buffer_load_dwordx4 v10, s[84:87], s4 offen lds
    s_add_u32 m0, s71, 17920
    s_add_u32 s4, s4, 32768
    buffer_load_dwordx4 v10, s[80:83], s4 offen lds
    s_add_u32 m0, s71, 26112
    s_nop 0
    buffer_load_dwordx4 v10, s[84:87], s4 offen lds
    s_add_u32 m0, s71, 18944
    s_add_u32 s4, s4, 32768
    buffer_load_dwordx4 v10, s[80:83], s4 offen lds
    s_add_u32 m0, s71, 27136
    s_nop 0
    buffer_load_dwordx4 v10, s[84:87], s4 offen lds
    s_add_u32 m0, s71, 19968
    s_add_u32 s4, s4, 32768
    buffer_load_dwordx4 v10, s[80:83], s4 offen lds
    s_add_u32 m0, s71, 28160
    s_nop 0
    buffer_load_dwordx4 v10, s[84:87], s4 offen lds
    s_add_u32 m0, s71, 20992
    s_add_u32 s4, s4, 32768
    buffer_load_dwordx4 v10, s[80:83], s4 offen lds
    s_add_u32 m0, s71, 29184
    s_nop 0
    buffer_load_dwordx4 v10, s[84:87], s4 offen lds
    s_add_u32 m0, s71, 22016
    s_add_u32 s4, s4, 32768
    buffer_load_dwordx4 v10, s[80:83], s4 offen lds
    s_add_u32 m0, s71, 30208
    s_nop 0
    buffer_load_dwordx4 v10, s[84:87], s4 offen lds
    s_add_u32 m0, s71, 23040
    s_add_u32 s4, s4, 32768
    buffer_load_dwordx4 v10, s[80:83], s4 offen lds
    s_add_u32 m0, s71, 31232
    s_nop 0
    buffer_load_dwordx4 v10, s[84:87], s4 offen lds
    s_add_u32 m0, s71, 24064
    s_add_u32 s4, s4, 32768
    buffer_load_dwordx4 v10, s[80:83], s4 offen lds
    s_add_u32 m0, s71, 32256
    s_nop 0
    buffer_load_dwordx4 v10, s[84:87], s4 offen lds
    v_alignbit_b32 v84, v17, v16, 16
    v_alignbit_b32 v85, v18, v17, 16
    v_alignbit_b32 v86, v19, v18, 16
    v_alignbit_b32 v87, v20, v19, 16
    v_alignbit_b32 v88, v21, v20, 16
    v_alignbit_b32 v89, v22, v21, 16
    v_alignbit_b32 v90, v23, v22, 16
    v_alignbit_b32 v91, v24, v23, 16
    v_alignbit_b32 v92, v25, v24, 16
    v_alignbit_b32 v93, v26, v25, 16
    v_alignbit_b32 v94, v27, v26, 16
    v_alignbit_b32 v95, v28, v27, 16
    v_alignbit_b32 v96, v29, v28, 16
    v_alignbit_b32 v97, v30, v29, 16
    v_alignbit_b32 v98, v31, v30, 16
    v_alignbit_b32 v99, v32, v31, 16
    v_alignbit_b32 v100, v33, v32, 16
    v_dot2_f32_bf16 v102, v84, v197, 0
    v_dot2_f32_bf16 v103, v17, v197, 0
    v_dot2_f32_bf16 v106, v85, v197, 0
    v_dot2_f32_bf16 v107, v18, v197, 0
    v_dot2_f32_bf16 v110, v86, v197, 0
    v_dot2_f32_bf16 v111, v19, v197, 0
    v_dot2_f32_bf16 v114, v87, v197, 0
    v_dot2_f32_bf16 v115, v20, v197, 0
    v_dot2_f32_bf16 v102, v85, v196, v102
    v_dot2_f32_bf16 v103, v18, v196, v103
    v_dot2_f32_bf16 v106, v86, v196, v106
    v_dot2_f32_bf16 v107, v19, v196, v107
    v_dot2_f32_bf16 v110, v87, v196, v110
    v_dot2_f32_bf16 v111, v20, v196, v111
    v_dot2_f32_bf16 v114, v88, v196, v114
    v_dot2_f32_bf16 v115, v21, v196, v115
    v_lshlrev_b32 v104, 16, v34
    v_and_b32 v105, 0xffff0000, v34
    v_lshlrev_b32 v108, 16, v35
    v_and_b32 v109, 0xffff0000, v35
    v_lshlrev_b32 v112, 16, v36
    v_and_b32 v113, 0xffff0000, v36
    v_lshlrev_b32 v116, 16, v37
    v_and_b32 v117, 0xffff0000, v37
    v_mul_f32 v102, v102, v104
    v_mul_f32 v103, v103, v105
    v_mul_f32 v106, v106, v108
    v_mul_f32 v107, v107, v109
    v_mul_f32 v110, v110, v112
    v_mul_f32 v111, v111, v113
    v_mul_f32 v114, v114, v116
    v_mul_f32 v115, v115, v117
    v_cvt_pk_bf16_f32 v137, v103, v102
    v_cvt_pk_bf16_f32 v136, v107, v106
    v_cvt_pk_bf16_f32 v135, v111, v110
    v_cvt_pk_bf16_f32 v134, v115, v114
    s_add_u32 s4, s72, 64
    buffer_store_dwordx4 v[134:137], v12, s[8:11], s4 offen offset:0
    v_dot2_f32_bf16 v118, v88, v197, 0
    v_dot2_f32_bf16 v119, v21, v197, 0
    v_dot2_f32_bf16 v122, v89, v197, 0
    v_dot2_f32_bf16 v123, v22, v197, 0
    v_dot2_f32_bf16 v126, v90, v197, 0
    v_dot2_f32_bf16 v127, v23, v197, 0
    v_dot2_f32_bf16 v130, v91, v197, 0
    v_dot2_f32_bf16 v131, v24, v197, 0
    v_dot2_f32_bf16 v118, v89, v196, v118
    v_dot2_f32_bf16 v119, v22, v196, v119
    v_dot2_f32_bf16 v122, v90, v196, v122
    v_dot2_f32_bf16 v123, v23, v196, v123
    v_dot2_f32_bf16 v126, v91, v196, v126
    v_dot2_f32_bf16 v127, v24, v196, v127
    v_dot2_f32_bf16 v130, v92, v196, v130
    v_dot2_f32_bf16 v131, v25, v196, v131
    v_lshlrev_b32 v120, 16, v38
    v_and_b32 v121, 0xffff0000, v38
    v_lshlrev_b32 v124, 16, v39
    v_and_b32 v125, 0xffff0000, v39
    v_lshlrev_b32 v128, 16, v40
    v_and_b32 v129, 0xffff0000, v40
    v_lshlrev_b32 v132, 16, v41
    v_and_b32 v133, 0xffff0000, v41
    v_mul_f32 v118, v118, v120
    v_mul_f32 v119, v119, v121
    v_mul_f32 v122, v122, v124
    v_mul_f32 v123, v123, v125
    v_mul_f32 v126, v126, v128
    v_mul_f32 v127, v127, v129
    v_mul_f32 v130, v130, v132
    v_mul_f32 v131, v131, v133
    v_cvt_pk_bf16_f32 v141, v119, v118
    v_cvt_pk_bf16_f32 v140, v123, v122
    v_cvt_pk_bf16_f32 v139, v127, v126
    v_cvt_pk_bf16_f32 v138, v131, v130
    buffer_store_dwordx4 v[138:141], v12, s[8:11], s4 offen offset:1024
    v_dot2_f32_bf16 v102, v92, v197, 0
    v_dot2_f32_bf16 v103, v25, v197, 0
    v_dot2_f32_bf16 v106, v93, v197, 0
    v_dot2_f32_bf16 v107, v26, v197, 0
    v_dot2_f32_bf16 v110, v94, v197, 0
    v_dot2_f32_bf16 v111, v27, v197, 0
    v_dot2_f32_bf16 v114, v95, v197, 0
    v_dot2_f32_bf16 v115, v28, v197, 0
    v_dot2_f32_bf16 v102, v93, v196, v102
    v_dot2_f32_bf16 v103, v26, v196, v103
    v_dot2_f32_bf16 v106, v94, v196, v106
    v_dot2_f32_bf16 v107, v27, v196, v107
    v_dot2_f32_bf16 v110, v95, v196, v110
    v_dot2_f32_bf16 v111, v28, v196, v111
    v_dot2_f32_bf16 v114, v96, v196, v114
    v_dot2_f32_bf16 v115, v29, v196, v115
    v_lshlrev_b32 v104, 16, v42
    v_and_b32 v105, 0xffff0000, v42
    v_lshlrev_b32 v108, 16, v43
    v_and_b32 v109, 0xffff0000, v43
    v_lshlrev_b32 v112, 16, v44
    v_and_b32 v113, 0xffff0000, v44
    v_lshlrev_b32 v116, 16, v45
    v_and_b32 v117, 0xffff0000, v45
    v_mul_f32 v102, v102, v104
    v_mul_f32 v103, v103, v105
    v_mul_f32 v106, v106, v108
    v_mul_f32 v107, v107, v109
    v_mul_f32 v110, v110, v112
    v_mul_f32 v111, v111, v113
    v_mul_f32 v114, v114, v116
    v_mul_f32 v115, v115, v117
    v_cvt_pk_bf16_f32 v145, v103, v102
    v_cvt_pk_bf16_f32 v144, v107, v106
    v_cvt_pk_bf16_f32 v143, v111, v110
    v_cvt_pk_bf16_f32 v142, v115, v114
    buffer_store_dwordx4 v[142:145], v12, s[8:11], s4 offen offset:2048
    v_dot2_f32_bf16 v118, v96, v197, 0
    v_dot2_f32_bf16 v119, v29, v197, 0
    v_dot2_f32_bf16 v122, v97, v197, 0
    v_dot2_f32_bf16 v123, v30, v197, 0
    v_dot2_f32_bf16 v126, v98, v197, 0
    v_dot2_f32_bf16 v127, v31, v197, 0
    v_dot2_f32_bf16 v130, v99, v197, 0
    v_dot2_f32_bf16 v131, v32, v197, 0
    v_dot2_f32_bf16 v118, v97, v196, v118
    v_dot2_f32_bf16 v119, v30, v196, v119
    v_dot2_f32_bf16 v122, v98, v196, v122
    v_dot2_f32_bf16 v123, v31, v196, v123
    v_dot2_f32_bf16 v126, v99, v196, v126
    v_dot2_f32_bf16 v127, v32, v196, v127
    v_dot2_f32_bf16 v130, v100, v196, v130
    v_dot2_f32_bf16 v131, v33, v196, v131
    v_lshlrev_b32 v120, 16, v46
    v_and_b32 v121, 0xffff0000, v46
    v_lshlrev_b32 v124, 16, v47
    v_and_b32 v125, 0xffff0000, v47
    v_lshlrev_b32 v128, 16, v48
    v_and_b32 v129, 0xffff0000, v48
    v_lshlrev_b32 v132, 16, v49
    v_and_b32 v133, 0xffff0000, v49
    v_mul_f32 v118, v118, v120
    v_mul_f32 v119, v119, v121
    v_mul_f32 v122, v122, v124
    v_mul_f32 v123, v123, v125
    v_mul_f32 v126, v126, v128
    v_mul_f32 v127, v127, v129
    v_mul_f32 v130, v130, v132
    v_mul_f32 v131, v131, v133
    v_cvt_pk_bf16_f32 v149, v119, v118
    v_cvt_pk_bf16_f32 v148, v123, v122
    v_cvt_pk_bf16_f32 v147, v127, v126
    v_cvt_pk_bf16_f32 v146, v131, v130
    buffer_store_dwordx4 v[146:149], v12, s[8:11], s4 offen offset:3072
    v_alignbit_b32 v84, v51, v50, 16
    v_alignbit_b32 v85, v52, v51, 16
    v_alignbit_b32 v86, v53, v52, 16
    v_alignbit_b32 v87, v54, v53, 16
    v_alignbit_b32 v88, v55, v54, 16
    v_alignbit_b32 v89, v56, v55, 16
    v_alignbit_b32 v90, v57, v56, 16
    v_alignbit_b32 v91, v58, v57, 16
    v_alignbit_b32 v92, v59, v58, 16
    v_alignbit_b32 v93, v60, v59, 16
    v_alignbit_b32 v94, v61, v60, 16
    v_alignbit_b32 v95, v62, v61, 16
    v_alignbit_b32 v96, v63, v62, 16
    v_alignbit_b32 v97, v64, v63, 16
    v_alignbit_b32 v98, v65, v64, 16
    v_alignbit_b32 v99, v66, v65, 16
    v_alignbit_b32 v100, v67, v66, 16
    v_dot2_f32_bf16 v102, v84, v199, 0
    v_dot2_f32_bf16 v103, v51, v199, 0
    v_dot2_f32_bf16 v106, v85, v199, 0
    v_dot2_f32_bf16 v107, v52, v199, 0
    v_dot2_f32_bf16 v110, v86, v199, 0
    v_dot2_f32_bf16 v111, v53, v199, 0
    v_dot2_f32_bf16 v114, v87, v199, 0
    v_dot2_f32_bf16 v115, v54, v199, 0
    v_dot2_f32_bf16 v102, v85, v198, v102
    v_dot2_f32_bf16 v103, v52, v198, v103
    v_dot2_f32_bf16 v106, v86, v198, v106
    v_dot2_f32_bf16 v107, v53, v198, v107
    v_dot2_f32_bf16 v110, v87, v198, v110
    v_dot2_f32_bf16 v111, v54, v198, v111
    v_dot2_f32_bf16 v114, v88, v198, v114
    v_dot2_f32_bf16 v115, v55, v198, v115
    v_lshlrev_b32 v104, 16, v68
    v_and_b32 v105, 0xffff0000, v68
    v_lshlrev_b32 v108, 16, v69
    v_and_b32 v109, 0xffff0000, v69
    v_lshlrev_b32 v112, 16, v70
    v_and_b32 v113, 0xffff0000, v70
    v_lshlrev_b32 v116, 16, v71
    v_and_b32 v117, 0xffff0000, v71
    v_mul_f32 v102, v102, v104
    v_mul_f32 v103, v103, v105
    v_mul_f32 v106, v106, v108
    v_mul_f32 v107, v107, v109
    v_mul_f32 v110, v110, v112
    v_mul_f32 v111, v111, v113
    v_mul_f32 v114, v114, v116
    v_mul_f32 v115, v115, v117
    v_cvt_pk_bf16_f32 v153, v103, v102
    v_cvt_pk_bf16_f32 v152, v107, v106
    v_cvt_pk_bf16_f32 v151, v111, v110
    v_cvt_pk_bf16_f32 v150, v115, v114
    s_add_u32 s4, s72, 65600
    buffer_store_dwordx4 v[150:153], v12, s[8:11], s4 offen offset:0
    v_dot2_f32_bf16 v118, v88, v199, 0
    v_dot2_f32_bf16 v119, v55, v199, 0
    v_dot2_f32_bf16 v122, v89, v199, 0
    v_dot2_f32_bf16 v123, v56, v199, 0
    v_dot2_f32_bf16 v126, v90, v199, 0
    v_dot2_f32_bf16 v127, v57, v199, 0
    v_dot2_f32_bf16 v130, v91, v199, 0
    v_dot2_f32_bf16 v131, v58, v199, 0
    v_dot2_f32_bf16 v118, v89, v198, v118
    v_dot2_f32_bf16 v119, v56, v198, v119
    v_dot2_f32_bf16 v122, v90, v198, v122
    v_dot2_f32_bf16 v123, v57, v198, v123
    v_dot2_f32_bf16 v126, v91, v198, v126
    v_dot2_f32_bf16 v127, v58, v198, v127
    v_dot2_f32_bf16 v130, v92, v198, v130
    v_dot2_f32_bf16 v131, v59, v198, v131
    v_lshlrev_b32 v120, 16, v72
    v_and_b32 v121, 0xffff0000, v72
    v_lshlrev_b32 v124, 16, v73
    v_and_b32 v125, 0xffff0000, v73
    v_lshlrev_b32 v128, 16, v74
    v_and_b32 v129, 0xffff0000, v74
    v_lshlrev_b32 v132, 16, v75
    v_and_b32 v133, 0xffff0000, v75
    v_mul_f32 v118, v118, v120
    v_mul_f32 v119, v119, v121
    v_mul_f32 v122, v122, v124
    v_mul_f32 v123, v123, v125
    v_mul_f32 v126, v126, v128
    v_mul_f32 v127, v127, v129
    v_mul_f32 v130, v130, v132
    v_mul_f32 v131, v131, v133
    v_cvt_pk_bf16_f32 v157, v119, v118
    v_cvt_pk_bf16_f32 v156, v123, v122
    v_cvt_pk_bf16_f32 v155, v127, v126
    v_cvt_pk_bf16_f32 v154, v131, v130
    buffer_store_dwordx4 v[154:157], v12, s[8:11], s4 offen offset:1024
    v_dot2_f32_bf16 v102, v92, v199, 0
    v_dot2_f32_bf16 v103, v59, v199, 0
    v_dot2_f32_bf16 v106, v93, v199, 0
    v_dot2_f32_bf16 v107, v60, v199, 0
    v_dot2_f32_bf16 v110, v94, v199, 0
    v_dot2_f32_bf16 v111, v61, v199, 0
    v_dot2_f32_bf16 v114, v95, v199, 0
    v_dot2_f32_bf16 v115, v62, v199, 0
    v_dot2_f32_bf16 v102, v93, v198, v102
    v_dot2_f32_bf16 v103, v60, v198, v103
    v_dot2_f32_bf16 v106, v94, v198, v106
    v_dot2_f32_bf16 v107, v61, v198, v107
    v_dot2_f32_bf16 v110, v95, v198, v110
    v_dot2_f32_bf16 v111, v62, v198, v111
    v_dot2_f32_bf16 v114, v96, v198, v114
    v_dot2_f32_bf16 v115, v63, v198, v115
    v_lshlrev_b32 v104, 16, v76
    v_and_b32 v105, 0xffff0000, v76
    v_lshlrev_b32 v108, 16, v77
    v_and_b32 v109, 0xffff0000, v77
    v_lshlrev_b32 v112, 16, v78
    v_and_b32 v113, 0xffff0000, v78
    v_lshlrev_b32 v116, 16, v79
    v_and_b32 v117, 0xffff0000, v79
    v_mul_f32 v102, v102, v104
    v_mul_f32 v103, v103, v105
    v_mul_f32 v106, v106, v108
    v_mul_f32 v107, v107, v109
    v_mul_f32 v110, v110, v112
    v_mul_f32 v111, v111, v113
    v_mul_f32 v114, v114, v116
    v_mul_f32 v115, v115, v117
    v_cvt_pk_bf16_f32 v161, v103, v102
    v_cvt_pk_bf16_f32 v160, v107, v106
    v_cvt_pk_bf16_f32 v159, v111, v110
    v_cvt_pk_bf16_f32 v158, v115, v114
    buffer_store_dwordx4 v[158:161], v12, s[8:11], s4 offen offset:2048
    v_dot2_f32_bf16 v118, v96, v199, 0
    v_dot2_f32_bf16 v119, v63, v199, 0
    v_dot2_f32_bf16 v122, v97, v199, 0
    v_dot2_f32_bf16 v123, v64, v199, 0
    v_dot2_f32_bf16 v126, v98, v199, 0
    v_dot2_f32_bf16 v127, v65, v199, 0
    v_dot2_f32_bf16 v130, v99, v199, 0
    v_dot2_f32_bf16 v131, v66, v199, 0
    v_dot2_f32_bf16 v118, v97, v198, v118
    v_dot2_f32_bf16 v119, v64, v198, v119
    v_dot2_f32_bf16 v122, v98, v198, v122
    v_dot2_f32_bf16 v123, v65, v198, v123
    v_dot2_f32_bf16 v126, v99, v198, v126
    v_dot2_f32_bf16 v127, v66, v198, v127
    v_dot2_f32_bf16 v130, v100, v198, v130
    v_dot2_f32_bf16 v131, v67, v198, v131
    v_lshlrev_b32 v120, 16, v80
    v_and_b32 v121, 0xffff0000, v80
    v_lshlrev_b32 v124, 16, v81
    v_and_b32 v125, 0xffff0000, v81
    v_lshlrev_b32 v128, 16, v82
    v_and_b32 v129, 0xffff0000, v82
    v_lshlrev_b32 v132, 16, v83
    v_and_b32 v133, 0xffff0000, v83
    v_mul_f32 v118, v118, v120
    v_mul_f32 v119, v119, v121
    v_mul_f32 v122, v122, v124
    v_mul_f32 v123, v123, v125
    v_mul_f32 v126, v126, v128
    v_mul_f32 v127, v127, v129
    v_mul_f32 v130, v130, v132
    v_mul_f32 v131, v131, v133
    v_cvt_pk_bf16_f32 v165, v119, v118
    v_cvt_pk_bf16_f32 v164, v123, v122
    v_cvt_pk_bf16_f32 v163, v127, v126
    v_cvt_pk_bf16_f32 v162, v131, v130
    buffer_store_dwordx4 v[162:165], v12, s[8:11], s4 offen offset:3072
    s_waitcnt vmcnt(25)
    ds_read_b64_tr_b16 v[16:17], v11 offset:0
    ds_read_b64_tr_b16 v[18:19], v11 offset:256
    ds_read_b64_tr_b16 v[20:21], v11 offset:512
    ds_read_b64_tr_b16 v[22:23], v11 offset:768
    ds_read_b64_tr_b16 v[24:25], v11 offset:1024
    ds_read_b64_tr_b16 v[26:27], v11 offset:1280
    ds_read_b64_tr_b16 v[28:29], v11 offset:1536
    ds_read_b64_tr_b16 v[30:31], v11 offset:1792
    ds_read_b64_tr_b16 v[32:33], v11 offset:2048
    ds_read_b64_tr_b16 v[34:35], v11 offset:8448
    ds_read_b64_tr_b16 v[36:37], v11 offset:8704
    ds_read_b64_tr_b16 v[38:39], v11 offset:8960
    ds_read_b64_tr_b16 v[40:41], v11 offset:9216
    ds_read_b64_tr_b16 v[42:43], v11 offset:9472
    ds_read_b64_tr_b16 v[44:45], v11 offset:9728
    ds_read_b64_tr_b16 v[46:47], v11 offset:9984
    ds_read_b64_tr_b16 v[48:49], v11 offset:10240
    ds_read_b64_tr_b16 v[50:51], v11 offset:32
    ds_read_b64_tr_b16 v[52:53], v11 offset:288
    ds_read_b64_tr_b16 v[54:55], v11 offset:544
    ds_read_b64_tr_b16 v[56:57], v11 offset:800
    ds_read_b64_tr_b16 v[58:59], v11 offset:1056
    ds_read_b64_tr_b16 v[60:61], v11 offset:1312
    ds_read_b64_tr_b16 v[62:63], v11 offset:1568
    ds_read_b64_tr_b16 v[64:65], v11 offset:1824
    ds_read_b64_tr_b16 v[66:67], v11 offset:2080
    ds_read_b64_tr_b16 v[68:69], v11 offset:8480
    ds_read_b64_tr_b16 v[70:71], v11 offset:8736
    ds_read_b64_tr_b16 v[72:73], v11 offset:8992
    ds_read_b64_tr_b16 v[74:75], v11 offset:9248
    ds_read_b64_tr_b16 v[76:77], v11 offset:9504
    ds_read_b64_tr_b16 v[78:79], v11 offset:9760
    ds_read_b64_tr_b16 v[80:81], v11 offset:10016
    ds_read_b64_tr_b16 v[82:83], v11 offset:10272
    s_waitcnt lgkmcnt(0)
    v_alignbit_b32 v84, v17, v16, 16
    v_alignbit_b32 v85, v18, v17, 16
    v_alignbit_b32 v86, v19, v18, 16
    v_alignbit_b32 v87, v20, v19, 16
    v_alignbit_b32 v88, v21, v20, 16
    v_alignbit_b32 v89, v22, v21, 16
    v_alignbit_b32 v90, v23, v22, 16
    v_alignbit_b32 v91, v24, v23, 16
    v_alignbit_b32 v92, v25, v24, 16
    v_alignbit_b32 v93, v26, v25, 16
    v_alignbit_b32 v94, v27, v26, 16
    v_alignbit_b32 v95, v28, v27, 16
    v_alignbit_b32 v96, v29, v28, 16
    v_alignbit_b32 v97, v30, v29, 16
    v_alignbit_b32 v98, v31, v30, 16
    v_alignbit_b32 v99, v32, v31, 16
    v_alignbit_b32 v100, v33, v32, 16
    v_dot2_f32_bf16 v102, v84, v197, 0
    v_dot2_f32_bf16 v103, v17, v197, 0
    v_dot2_f32_bf16 v106, v85, v197, 0
    v_dot2_f32_bf16 v107, v18, v197, 0
    v_dot2_f32_bf16 v110, v86, v197, 0
    v_dot2_f32_bf16 v111, v19, v197, 0
    v_dot2_f32_bf16 v114, v87, v197, 0
    v_dot2_f32_bf16 v115, v20, v197, 0
    v_dot2_f32_bf16 v102, v85, v196, v102
    v_dot2_f32_bf16 v103, v18, v196, v103
    v_dot2_f32_bf16 v106, v86, v196, v106
    v_dot2_f32_bf16 v107, v19, v196, v107
    v_dot2_f32_bf16 v110, v87, v196, v110
    v_dot2_f32_bf16 v111, v20, v196, v111
    v_dot2_f32_bf16 v114, v88, v196, v114
    v_dot2_f32_bf16 v115, v21, v196, v115
    v_lshlrev_b32 v104, 16, v34
    v_and_b32 v105, 0xffff0000, v34
    v_lshlrev_b32 v108, 16, v35
    v_and_b32 v109, 0xffff0000, v35
    v_lshlrev_b32 v112, 16, v36
    v_and_b32 v113, 0xffff0000, v36
    v_lshlrev_b32 v116, 16, v37
    v_and_b32 v117, 0xffff0000, v37
    v_mul_f32 v102, v102, v104
    v_mul_f32 v103, v103, v105
    v_mul_f32 v106, v106, v108
    v_mul_f32 v107, v107, v109
    v_mul_f32 v110, v110, v112
    v_mul_f32 v111, v111, v113
    v_mul_f32 v114, v114, v116
    v_mul_f32 v115, v115, v117
    v_cvt_pk_bf16_f32 v137, v103, v102
    v_cvt_pk_bf16_f32 v136, v107, v106
    v_cvt_pk_bf16_f32 v135, v111, v110
    v_cvt_pk_bf16_f32 v134, v115, v114
    s_add_u32 s4, s72, 128
    buffer_store_dwordx4 v[134:137], v12, s[8:11], s4 offen offset:0
    v_dot2_f32_bf16 v118, v88, v197, 0
    v_dot2_f32_bf16 v119, v21, v197, 0
    v_dot2_f32_bf16 v122, v89, v197, 0
    v_dot2_f32_bf16 v123, v22, v197, 0
    v_dot2_f32_bf16 v126, v90, v197, 0
    v_dot2_f32_bf16 v127, v23, v197, 0
    v_dot2_f32_bf16 v130, v91, v197, 0
    v_dot2_f32_bf16 v131, v24, v197, 0
    v_dot2_f32_bf16 v118, v89, v196, v118
    v_dot2_f32_bf16 v119, v22, v196, v119
    v_dot2_f32_bf16 v122, v90, v196, v122
    v_dot2_f32_bf16 v123, v23, v196, v123
    v_dot2_f32_bf16 v126, v91, v196, v126
    v_dot2_f32_bf16 v127, v24, v196, v127
    v_dot2_f32_bf16 v130, v92, v196, v130
    v_dot2_f32_bf16 v131, v25, v196, v131
    v_lshlrev_b32 v120, 16, v38
    v_and_b32 v121, 0xffff0000, v38
    v_lshlrev_b32 v124, 16, v39
    v_and_b32 v125, 0xffff0000, v39
    v_lshlrev_b32 v128, 16, v40
    v_and_b32 v129, 0xffff0000, v40
    v_lshlrev_b32 v132, 16, v41
    v_and_b32 v133, 0xffff0000, v41
    v_mul_f32 v118, v118, v120
    v_mul_f32 v119, v119, v121
    v_mul_f32 v122, v122, v124
    v_mul_f32 v123, v123, v125
    v_mul_f32 v126, v126, v128
    v_mul_f32 v127, v127, v129
    v_mul_f32 v130, v130, v132
    v_mul_f32 v131, v131, v133
    v_cvt_pk_bf16_f32 v141, v119, v118
    v_cvt_pk_bf16_f32 v140, v123, v122
    v_cvt_pk_bf16_f32 v139, v127, v126
    v_cvt_pk_bf16_f32 v138, v131, v130
    buffer_store_dwordx4 v[138:141], v12, s[8:11], s4 offen offset:1024
    v_dot2_f32_bf16 v102, v92, v197, 0
    v_dot2_f32_bf16 v103, v25, v197, 0
    v_dot2_f32_bf16 v106, v93, v197, 0
    v_dot2_f32_bf16 v107, v26, v197, 0
    v_dot2_f32_bf16 v110, v94, v197, 0
    v_dot2_f32_bf16 v111, v27, v197, 0
    v_dot2_f32_bf16 v114, v95, v197, 0
    v_dot2_f32_bf16 v115, v28, v197, 0
    v_dot2_f32_bf16 v102, v93, v196, v102
    v_dot2_f32_bf16 v103, v26, v196, v103
    v_dot2_f32_bf16 v106, v94, v196, v106
    v_dot2_f32_bf16 v107, v27, v196, v107
    v_dot2_f32_bf16 v110, v95, v196, v110
    v_dot2_f32_bf16 v111, v28, v196, v111
    v_dot2_f32_bf16 v114, v96, v196, v114
    v_dot2_f32_bf16 v115, v29, v196, v115
    v_lshlrev_b32 v104, 16, v42
    v_and_b32 v105, 0xffff0000, v42
    v_lshlrev_b32 v108, 16, v43
    v_and_b32 v109, 0xffff0000, v43
    v_lshlrev_b32 v112, 16, v44
    v_and_b32 v113, 0xffff0000, v44
    v_lshlrev_b32 v116, 16, v45
    v_and_b32 v117, 0xffff0000, v45
    v_mul_f32 v102, v102, v104
    v_mul_f32 v103, v103, v105
    v_mul_f32 v106, v106, v108
    v_mul_f32 v107, v107, v109
    v_mul_f32 v110, v110, v112
    v_mul_f32 v111, v111, v113
    v_mul_f32 v114, v114, v116
    v_mul_f32 v115, v115, v117
    v_cvt_pk_bf16_f32 v145, v103, v102
    v_cvt_pk_bf16_f32 v144, v107, v106
    v_cvt_pk_bf16_f32 v143, v111, v110
    v_cvt_pk_bf16_f32 v142, v115, v114
    buffer_store_dwordx4 v[142:145], v12, s[8:11], s4 offen offset:2048
    v_dot2_f32_bf16 v118, v96, v197, 0
    v_dot2_f32_bf16 v119, v29, v197, 0
    v_dot2_f32_bf16 v122, v97, v197, 0
    v_dot2_f32_bf16 v123, v30, v197, 0
    v_dot2_f32_bf16 v126, v98, v197, 0
    v_dot2_f32_bf16 v127, v31, v197, 0
    v_dot2_f32_bf16 v130, v99, v197, 0
    v_dot2_f32_bf16 v131, v32, v197, 0
    v_dot2_f32_bf16 v118, v97, v196, v118
    v_dot2_f32_bf16 v119, v30, v196, v119
    v_dot2_f32_bf16 v122, v98, v196, v122
    v_dot2_f32_bf16 v123, v31, v196, v123
    v_dot2_f32_bf16 v126, v99, v196, v126
    v_dot2_f32_bf16 v127, v32, v196, v127
    v_dot2_f32_bf16 v130, v100, v196, v130
    v_dot2_f32_bf16 v131, v33, v196, v131
    v_lshlrev_b32 v120, 16, v46
    v_and_b32 v121, 0xffff0000, v46
    v_lshlrev_b32 v124, 16, v47
    v_and_b32 v125, 0xffff0000, v47
    v_lshlrev_b32 v128, 16, v48
    v_and_b32 v129, 0xffff0000, v48
    v_lshlrev_b32 v132, 16, v49
    v_and_b32 v133, 0xffff0000, v49
    v_mul_f32 v118, v118, v120
    v_mul_f32 v119, v119, v121
    v_mul_f32 v122, v122, v124
    v_mul_f32 v123, v123, v125
    v_mul_f32 v126, v126, v128
    v_mul_f32 v127, v127, v129
    v_mul_f32 v130, v130, v132
    v_mul_f32 v131, v131, v133
    v_cvt_pk_bf16_f32 v149, v119, v118
    v_cvt_pk_bf16_f32 v148, v123, v122
    v_cvt_pk_bf16_f32 v147, v127, v126
    v_cvt_pk_bf16_f32 v146, v131, v130
    buffer_store_dwordx4 v[146:149], v12, s[8:11], s4 offen offset:3072
    v_alignbit_b32 v84, v51, v50, 16
    v_alignbit_b32 v85, v52, v51, 16
    v_alignbit_b32 v86, v53, v52, 16
    v_alignbit_b32 v87, v54, v53, 16
    v_alignbit_b32 v88, v55, v54, 16
    v_alignbit_b32 v89, v56, v55, 16
    v_alignbit_b32 v90, v57, v56, 16
    v_alignbit_b32 v91, v58, v57, 16
    v_alignbit_b32 v92, v59, v58, 16
    v_alignbit_b32 v93, v60, v59, 16
    v_alignbit_b32 v94, v61, v60, 16
    v_alignbit_b32 v95, v62, v61, 16
    v_alignbit_b32 v96, v63, v62, 16
    v_alignbit_b32 v97, v64, v63, 16
    v_alignbit_b32 v98, v65, v64, 16
    v_alignbit_b32 v99, v66, v65, 16
    v_alignbit_b32 v100, v67, v66, 16
    v_dot2_f32_bf16 v102, v84, v199, 0
    v_dot2_f32_bf16 v103, v51, v199, 0
    v_dot2_f32_bf16 v106, v85, v199, 0
    v_dot2_f32_bf16 v107, v52, v199, 0
    v_dot2_f32_bf16 v110, v86, v199, 0
    v_dot2_f32_bf16 v111, v53, v199, 0
    v_dot2_f32_bf16 v114, v87, v199, 0
    v_dot2_f32_bf16 v115, v54, v199, 0
    v_dot2_f32_bf16 v102, v85, v198, v102
    v_dot2_f32_bf16 v103, v52, v198, v103
    v_dot2_f32_bf16 v106, v86, v198, v106
    v_dot2_f32_bf16 v107, v53, v198, v107
    v_dot2_f32_bf16 v110, v87, v198, v110
    v_dot2_f32_bf16 v111, v54, v198, v111
    v_dot2_f32_bf16 v114, v88, v198, v114
    v_dot2_f32_bf16 v115, v55, v198, v115
    v_lshlrev_b32 v104, 16, v68
    v_and_b32 v105, 0xffff0000, v68
    v_lshlrev_b32 v108, 16, v69
    v_and_b32 v109, 0xffff0000, v69
    v_lshlrev_b32 v112, 16, v70
    v_and_b32 v113, 0xffff0000, v70
    v_lshlrev_b32 v116, 16, v71
    v_and_b32 v117, 0xffff0000, v71
    v_mul_f32 v102, v102, v104
    v_mul_f32 v103, v103, v105
    v_mul_f32 v106, v106, v108
    v_mul_f32 v107, v107, v109
    v_mul_f32 v110, v110, v112
    v_mul_f32 v111, v111, v113
    v_mul_f32 v114, v114, v116
    v_mul_f32 v115, v115, v117
    v_cvt_pk_bf16_f32 v153, v103, v102
    v_cvt_pk_bf16_f32 v152, v107, v106
    v_cvt_pk_bf16_f32 v151, v111, v110
    v_cvt_pk_bf16_f32 v150, v115, v114
    s_add_u32 s4, s72, 65664
    buffer_store_dwordx4 v[150:153], v12, s[8:11], s4 offen offset:0
    v_dot2_f32_bf16 v118, v88, v199, 0
    v_dot2_f32_bf16 v119, v55, v199, 0
    v_dot2_f32_bf16 v122, v89, v199, 0
    v_dot2_f32_bf16 v123, v56, v199, 0
    v_dot2_f32_bf16 v126, v90, v199, 0
    v_dot2_f32_bf16 v127, v57, v199, 0
    v_dot2_f32_bf16 v130, v91, v199, 0
    v_dot2_f32_bf16 v131, v58, v199, 0
    v_dot2_f32_bf16 v118, v89, v198, v118
    v_dot2_f32_bf16 v119, v56, v198, v119
    v_dot2_f32_bf16 v122, v90, v198, v122
    v_dot2_f32_bf16 v123, v57, v198, v123
    v_dot2_f32_bf16 v126, v91, v198, v126
    v_dot2_f32_bf16 v127, v58, v198, v127
    v_dot2_f32_bf16 v130, v92, v198, v130
    v_dot2_f32_bf16 v131, v59, v198, v131
    v_lshlrev_b32 v120, 16, v72
    v_and_b32 v121, 0xffff0000, v72
    v_lshlrev_b32 v124, 16, v73
    v_and_b32 v125, 0xffff0000, v73
    v_lshlrev_b32 v128, 16, v74
    v_and_b32 v129, 0xffff0000, v74
    v_lshlrev_b32 v132, 16, v75
    v_and_b32 v133, 0xffff0000, v75
    v_mul_f32 v118, v118, v120
    v_mul_f32 v119, v119, v121
    v_mul_f32 v122, v122, v124
    v_mul_f32 v123, v123, v125
    v_mul_f32 v126, v126, v128
    v_mul_f32 v127, v127, v129
    v_mul_f32 v130, v130, v132
    v_mul_f32 v131, v131, v133
    v_cvt_pk_bf16_f32 v157, v119, v118
    v_cvt_pk_bf16_f32 v156, v123, v122
    v_cvt_pk_bf16_f32 v155, v127, v126
    v_cvt_pk_bf16_f32 v154, v131, v130
    buffer_store_dwordx4 v[154:157], v12, s[8:11], s4 offen offset:1024
    v_dot2_f32_bf16 v102, v92, v199, 0
    v_dot2_f32_bf16 v103, v59, v199, 0
    v_dot2_f32_bf16 v106, v93, v199, 0
    v_dot2_f32_bf16 v107, v60, v199, 0
    v_dot2_f32_bf16 v110, v94, v199, 0
    v_dot2_f32_bf16 v111, v61, v199, 0
    v_dot2_f32_bf16 v114, v95, v199, 0
    v_dot2_f32_bf16 v115, v62, v199, 0
    v_dot2_f32_bf16 v102, v93, v198, v102
    v_dot2_f32_bf16 v103, v60, v198, v103
    v_dot2_f32_bf16 v106, v94, v198, v106
    v_dot2_f32_bf16 v107, v61, v198, v107
    v_dot2_f32_bf16 v110, v95, v198, v110
    v_dot2_f32_bf16 v111, v62, v198, v111
    v_dot2_f32_bf16 v114, v96, v198, v114
    v_dot2_f32_bf16 v115, v63, v198, v115
    v_lshlrev_b32 v104, 16, v76
    v_and_b32 v105, 0xffff0000, v76
    v_lshlrev_b32 v108, 16, v77
    v_and_b32 v109, 0xffff0000, v77
    v_lshlrev_b32 v112, 16, v78
    v_and_b32 v113, 0xffff0000, v78
    v_lshlrev_b32 v116, 16, v79
    v_and_b32 v117, 0xffff0000, v79
    v_mul_f32 v102, v102, v104
    v_mul_f32 v103, v103, v105
    v_mul_f32 v106, v106, v108
    v_mul_f32 v107, v107, v109
    v_mul_f32 v110, v110, v112
    v_mul_f32 v111, v111, v113
    v_mul_f32 v114, v114, v116
    v_mul_f32 v115, v115, v117
    v_cvt_pk_bf16_f32 v161, v103, v102
    v_cvt_pk_bf16_f32 v160, v107, v106
    v_cvt_pk_bf16_f32 v159, v111, v110
    v_cvt_pk_bf16_f32 v158, v115, v114
    buffer_store_dwordx4 v[158:161], v12, s[8:11], s4 offen offset:2048
    v_dot2_f32_bf16 v118, v96, v199, 0
    v_dot2_f32_bf16 v119, v63, v199, 0
    v_dot2_f32_bf16 v122, v97, v199, 0
    v_dot2_f32_bf16 v123, v64, v199, 0
    v_dot2_f32_bf16 v126, v98, v199, 0
    v_dot2_f32_bf16 v127, v65, v199, 0
    v_dot2_f32_bf16 v130, v99, v199, 0
    v_dot2_f32_bf16 v131, v66, v199, 0
    v_dot2_f32_bf16 v118, v97, v198, v118
    v_dot2_f32_bf16 v119, v64, v198, v119
    v_dot2_f32_bf16 v122, v98, v198, v122
    v_dot2_f32_bf16 v123, v65, v198, v123
    v_dot2_f32_bf16 v126, v99, v198, v126
    v_dot2_f32_bf16 v127, v66, v198, v127
    v_dot2_f32_bf16 v130, v100, v198, v130
    v_dot2_f32_bf16 v131, v67, v198, v131
    v_lshlrev_b32 v120, 16, v80
    v_and_b32 v121, 0xffff0000, v80
    v_lshlrev_b32 v124, 16, v81
    v_and_b32 v125, 0xffff0000, v81
    v_lshlrev_b32 v128, 16, v82
    v_and_b32 v129, 0xffff0000, v82
    v_lshlrev_b32 v132, 16, v83
    v_and_b32 v133, 0xffff0000, v83
    v_mul_f32 v118, v118, v120
    v_mul_f32 v119, v119, v121
    v_mul_f32 v122, v122, v124
    v_mul_f32 v123, v123, v125
    v_mul_f32 v126, v126, v128
    v_mul_f32 v127, v127, v129
    v_mul_f32 v130, v130, v132
    v_mul_f32 v131, v131, v133
    v_cvt_pk_bf16_f32 v165, v119, v118
    v_cvt_pk_bf16_f32 v164, v123, v122
    v_cvt_pk_bf16_f32 v163, v127, v126
    v_cvt_pk_bf16_f32 v162, v131, v130
    buffer_store_dwordx4 v[162:165], v12, s[8:11], s4 offen offset:3072
    s_waitcnt vmcnt(8)
    ds_read_b64_tr_b16 v[16:17], v11 offset:16640
    ds_read_b64_tr_b16 v[18:19], v11 offset:16896
    ds_read_b64_tr_b16 v[20:21], v11 offset:17152
    ds_read_b64_tr_b16 v[22:23], v11 offset:17408
    ds_read_b64_tr_b16 v[24:25], v11 offset:17664
    ds_read_b64_tr_b16 v[26:27], v11 offset:17920
    ds_read_b64_tr_b16 v[28:29], v11 offset:18176
    ds_read_b64_tr_b16 v[30:31], v11 offset:18432
    ds_read_b64_tr_b16 v[32:33], v11 offset:18688
    ds_read_b64_tr_b16 v[34:35], v11 offset:25088
    ds_read_b64_tr_b16 v[36:37], v11 offset:25344
    ds_read_b64_tr_b16 v[38:39], v11 offset:25600
    ds_read_b64_tr_b16 v[40:41], v11 offset:25856
    ds_read_b64_tr_b16 v[42:43], v11 offset:26112
    ds_read_b64_tr_b16 v[44:45], v11 offset:26368
    ds_read_b64_tr_b16 v[46:47], v11 offset:26624
    ds_read_b64_tr_b16 v[48:49], v11 offset:26880
    ds_read_b64_tr_b16 v[50:51], v11 offset:16672
    ds_read_b64_tr_b16 v[52:53], v11 offset:16928
    ds_read_b64_tr_b16 v[54:55], v11 offset:17184
    ds_read_b64_tr_b16 v[56:57], v11 offset:17440
    ds_read_b64_tr_b16 v[58:59], v11 offset:17696
    ds_read_b64_tr_b16 v[60:61], v11 offset:17952
    ds_read_b64_tr_b16 v[62:63], v11 offset:18208
    ds_read_b64_tr_b16 v[64:65], v11 offset:18464
    ds_read_b64_tr_b16 v[66:67], v11 offset:18720
    ds_read_b64_tr_b16 v[68:69], v11 offset:25120
    ds_read_b64_tr_b16 v[70:71], v11 offset:25376
    ds_read_b64_tr_b16 v[72:73], v11 offset:25632
    ds_read_b64_tr_b16 v[74:75], v11 offset:25888
    ds_read_b64_tr_b16 v[76:77], v11 offset:26144
    ds_read_b64_tr_b16 v[78:79], v11 offset:26400
    ds_read_b64_tr_b16 v[80:81], v11 offset:26656
    ds_read_b64_tr_b16 v[82:83], v11 offset:26912
    s_waitcnt lgkmcnt(0)
    v_alignbit_b32 v84, v17, v16, 16
    v_alignbit_b32 v85, v18, v17, 16
    v_alignbit_b32 v86, v19, v18, 16
    v_alignbit_b32 v87, v20, v19, 16
    v_alignbit_b32 v88, v21, v20, 16
    v_alignbit_b32 v89, v22, v21, 16
    v_alignbit_b32 v90, v23, v22, 16
    v_alignbit_b32 v91, v24, v23, 16
    v_alignbit_b32 v92, v25, v24, 16
    v_alignbit_b32 v93, v26, v25, 16
    v_alignbit_b32 v94, v27, v26, 16
    v_alignbit_b32 v95, v28, v27, 16
    v_alignbit_b32 v96, v29, v28, 16
    v_alignbit_b32 v97, v30, v29, 16
    v_alignbit_b32 v98, v31, v30, 16
    v_alignbit_b32 v99, v32, v31, 16
    v_alignbit_b32 v100, v33, v32, 16
    v_dot2_f32_bf16 v102, v84, v197, 0
    v_dot2_f32_bf16 v103, v17, v197, 0
    v_dot2_f32_bf16 v106, v85, v197, 0
    v_dot2_f32_bf16 v107, v18, v197, 0
    v_dot2_f32_bf16 v110, v86, v197, 0
    v_dot2_f32_bf16 v111, v19, v197, 0
    v_dot2_f32_bf16 v114, v87, v197, 0
    v_dot2_f32_bf16 v115, v20, v197, 0
    v_dot2_f32_bf16 v102, v85, v196, v102
    v_dot2_f32_bf16 v103, v18, v196, v103
    v_dot2_f32_bf16 v106, v86, v196, v106
    v_dot2_f32_bf16 v107, v19, v196, v107
    v_dot2_f32_bf16 v110, v87, v196, v110
    v_dot2_f32_bf16 v111, v20, v196, v111
    v_dot2_f32_bf16 v114, v88, v196, v114
    v_dot2_f32_bf16 v115, v21, v196, v115
    v_lshlrev_b32 v104, 16, v34
    v_and_b32 v105, 0xffff0000, v34
    v_lshlrev_b32 v108, 16, v35
    v_and_b32 v109, 0xffff0000, v35
    v_lshlrev_b32 v112, 16, v36
    v_and_b32 v113, 0xffff0000, v36
    v_lshlrev_b32 v116, 16, v37
    v_and_b32 v117, 0xffff0000, v37
    v_mul_f32 v102, v102, v104
    v_mul_f32 v103, v103, v105
    v_mul_f32 v106, v106, v108
    v_mul_f32 v107, v107, v109
    v_mul_f32 v110, v110, v112
    v_mul_f32 v111, v111, v113
    v_mul_f32 v114, v114, v116
    v_mul_f32 v115, v115, v117
    v_cvt_pk_bf16_f32 v137, v103, v102
    v_cvt_pk_bf16_f32 v136, v107, v106
    v_cvt_pk_bf16_f32 v135, v111, v110
    v_cvt_pk_bf16_f32 v134, v115, v114
    s_add_u32 s4, s72, 192
    buffer_store_dwordx4 v[134:137], v12, s[8:11], s4 offen offset:0
    v_dot2_f32_bf16 v118, v88, v197, 0
    v_dot2_f32_bf16 v119, v21, v197, 0
    v_dot2_f32_bf16 v122, v89, v197, 0
    v_dot2_f32_bf16 v123, v22, v197, 0
    v_dot2_f32_bf16 v126, v90, v197, 0
    v_dot2_f32_bf16 v127, v23, v197, 0
    v_dot2_f32_bf16 v130, v91, v197, 0
    v_dot2_f32_bf16 v131, v24, v197, 0
    v_dot2_f32_bf16 v118, v89, v196, v118
    v_dot2_f32_bf16 v119, v22, v196, v119
    v_dot2_f32_bf16 v122, v90, v196, v122
    v_dot2_f32_bf16 v123, v23, v196, v123
    v_dot2_f32_bf16 v126, v91, v196, v126
    v_dot2_f32_bf16 v127, v24, v196, v127
    v_dot2_f32_bf16 v130, v92, v196, v130
    v_dot2_f32_bf16 v131, v25, v196, v131
    v_lshlrev_b32 v120, 16, v38
    v_and_b32 v121, 0xffff0000, v38
    v_lshlrev_b32 v124, 16, v39
    v_and_b32 v125, 0xffff0000, v39
    v_lshlrev_b32 v128, 16, v40
    v_and_b32 v129, 0xffff0000, v40
    v_lshlrev_b32 v132, 16, v41
    v_and_b32 v133, 0xffff0000, v41
    v_mul_f32 v118, v118, v120
    v_mul_f32 v119, v119, v121
    v_mul_f32 v122, v122, v124
    v_mul_f32 v123, v123, v125
    v_mul_f32 v126, v126, v128
    v_mul_f32 v127, v127, v129
    v_mul_f32 v130, v130, v132
    v_mul_f32 v131, v131, v133
    v_cvt_pk_bf16_f32 v141, v119, v118
    v_cvt_pk_bf16_f32 v140, v123, v122
    v_cvt_pk_bf16_f32 v139, v127, v126
    v_cvt_pk_bf16_f32 v138, v131, v130
    buffer_store_dwordx4 v[138:141], v12, s[8:11], s4 offen offset:1024
    v_dot2_f32_bf16 v102, v92, v197, 0
    v_dot2_f32_bf16 v103, v25, v197, 0
    v_dot2_f32_bf16 v106, v93, v197, 0
    v_dot2_f32_bf16 v107, v26, v197, 0
    v_dot2_f32_bf16 v110, v94, v197, 0
    v_dot2_f32_bf16 v111, v27, v197, 0
    v_dot2_f32_bf16 v114, v95, v197, 0
    v_dot2_f32_bf16 v115, v28, v197, 0
    v_dot2_f32_bf16 v102, v93, v196, v102
    v_dot2_f32_bf16 v103, v26, v196, v103
    v_dot2_f32_bf16 v106, v94, v196, v106
    v_dot2_f32_bf16 v107, v27, v196, v107
    v_dot2_f32_bf16 v110, v95, v196, v110
    v_dot2_f32_bf16 v111, v28, v196, v111
    v_dot2_f32_bf16 v114, v96, v196, v114
    v_dot2_f32_bf16 v115, v29, v196, v115
    v_lshlrev_b32 v104, 16, v42
    v_and_b32 v105, 0xffff0000, v42
    v_lshlrev_b32 v108, 16, v43
    v_and_b32 v109, 0xffff0000, v43
    v_lshlrev_b32 v112, 16, v44
    v_and_b32 v113, 0xffff0000, v44
    v_lshlrev_b32 v116, 16, v45
    v_and_b32 v117, 0xffff0000, v45
    v_mul_f32 v102, v102, v104
    v_mul_f32 v103, v103, v105
    v_mul_f32 v106, v106, v108
    v_mul_f32 v107, v107, v109
    v_mul_f32 v110, v110, v112
    v_mul_f32 v111, v111, v113
    v_mul_f32 v114, v114, v116
    v_mul_f32 v115, v115, v117
    v_cvt_pk_bf16_f32 v145, v103, v102
    v_cvt_pk_bf16_f32 v144, v107, v106
    v_cvt_pk_bf16_f32 v143, v111, v110
    v_cvt_pk_bf16_f32 v142, v115, v114
    buffer_store_dwordx4 v[142:145], v12, s[8:11], s4 offen offset:2048
    v_dot2_f32_bf16 v118, v96, v197, 0
    v_dot2_f32_bf16 v119, v29, v197, 0
    v_dot2_f32_bf16 v122, v97, v197, 0
    v_dot2_f32_bf16 v123, v30, v197, 0
    v_dot2_f32_bf16 v126, v98, v197, 0
    v_dot2_f32_bf16 v127, v31, v197, 0
    v_dot2_f32_bf16 v130, v99, v197, 0
    v_dot2_f32_bf16 v131, v32, v197, 0
    v_dot2_f32_bf16 v118, v97, v196, v118
    v_dot2_f32_bf16 v119, v30, v196, v119
    v_dot2_f32_bf16 v122, v98, v196, v122
    v_dot2_f32_bf16 v123, v31, v196, v123
    v_dot2_f32_bf16 v126, v99, v196, v126
    v_dot2_f32_bf16 v127, v32, v196, v127
    v_dot2_f32_bf16 v130, v100, v196, v130
    v_dot2_f32_bf16 v131, v33, v196, v131
    v_lshlrev_b32 v120, 16, v46
    v_and_b32 v121, 0xffff0000, v46
    v_lshlrev_b32 v124, 16, v47
    v_and_b32 v125, 0xffff0000, v47
    v_lshlrev_b32 v128, 16, v48
    v_and_b32 v129, 0xffff0000, v48
    v_lshlrev_b32 v132, 16, v49
    v_and_b32 v133, 0xffff0000, v49
    v_mul_f32 v118, v118, v120
    v_mul_f32 v119, v119, v121
    v_mul_f32 v122, v122, v124
    v_mul_f32 v123, v123, v125
    v_mul_f32 v126, v126, v128
    v_mul_f32 v127, v127, v129
    v_mul_f32 v130, v130, v132
    v_mul_f32 v131, v131, v133
    v_cvt_pk_bf16_f32 v149, v119, v118
    v_cvt_pk_bf16_f32 v148, v123, v122
    v_cvt_pk_bf16_f32 v147, v127, v126
    v_cvt_pk_bf16_f32 v146, v131, v130
    buffer_store_dwordx4 v[146:149], v12, s[8:11], s4 offen offset:3072
    v_alignbit_b32 v84, v51, v50, 16
    v_alignbit_b32 v85, v52, v51, 16
    v_alignbit_b32 v86, v53, v52, 16
    v_alignbit_b32 v87, v54, v53, 16
    v_alignbit_b32 v88, v55, v54, 16
    v_alignbit_b32 v89, v56, v55, 16
    v_alignbit_b32 v90, v57, v56, 16
    v_alignbit_b32 v91, v58, v57, 16
    v_alignbit_b32 v92, v59, v58, 16
    v_alignbit_b32 v93, v60, v59, 16
    v_alignbit_b32 v94, v61, v60, 16
    v_alignbit_b32 v95, v62, v61, 16
    v_alignbit_b32 v96, v63, v62, 16
    v_alignbit_b32 v97, v64, v63, 16
    v_alignbit_b32 v98, v65, v64, 16
    v_alignbit_b32 v99, v66, v65, 16
    v_alignbit_b32 v100, v67, v66, 16
    v_dot2_f32_bf16 v102, v84, v199, 0
    v_dot2_f32_bf16 v103, v51, v199, 0
    v_dot2_f32_bf16 v106, v85, v199, 0
    v_dot2_f32_bf16 v107, v52, v199, 0
    v_dot2_f32_bf16 v110, v86, v199, 0
    v_dot2_f32_bf16 v111, v53, v199, 0
    v_dot2_f32_bf16 v114, v87, v199, 0
    v_dot2_f32_bf16 v115, v54, v199, 0
    v_dot2_f32_bf16 v102, v85, v198, v102
    v_dot2_f32_bf16 v103, v52, v198, v103
    v_dot2_f32_bf16 v106, v86, v198, v106
    v_dot2_f32_bf16 v107, v53, v198, v107
    v_dot2_f32_bf16 v110, v87, v198, v110
    v_dot2_f32_bf16 v111, v54, v198, v111
    v_dot2_f32_bf16 v114, v88, v198, v114
    v_dot2_f32_bf16 v115, v55, v198, v115
    v_lshlrev_b32 v104, 16, v68
    v_and_b32 v105, 0xffff0000, v68
    v_lshlrev_b32 v108, 16, v69
    v_and_b32 v109, 0xffff0000, v69
    v_lshlrev_b32 v112, 16, v70
    v_and_b32 v113, 0xffff0000, v70
    v_lshlrev_b32 v116, 16, v71
    v_and_b32 v117, 0xffff0000, v71
    v_mul_f32 v102, v102, v104
    v_mul_f32 v103, v103, v105
    v_mul_f32 v106, v106, v108
    v_mul_f32 v107, v107, v109
    v_mul_f32 v110, v110, v112
    v_mul_f32 v111, v111, v113
    v_mul_f32 v114, v114, v116
    v_mul_f32 v115, v115, v117
    v_cvt_pk_bf16_f32 v153, v103, v102
    v_cvt_pk_bf16_f32 v152, v107, v106
    v_cvt_pk_bf16_f32 v151, v111, v110
    v_cvt_pk_bf16_f32 v150, v115, v114
    s_add_u32 s4, s72, 65728
    buffer_store_dwordx4 v[150:153], v12, s[8:11], s4 offen offset:0
    v_dot2_f32_bf16 v118, v88, v199, 0
    v_dot2_f32_bf16 v119, v55, v199, 0
    v_dot2_f32_bf16 v122, v89, v199, 0
    v_dot2_f32_bf16 v123, v56, v199, 0
    v_dot2_f32_bf16 v126, v90, v199, 0
    v_dot2_f32_bf16 v127, v57, v199, 0
    v_dot2_f32_bf16 v130, v91, v199, 0
    v_dot2_f32_bf16 v131, v58, v199, 0
    v_dot2_f32_bf16 v118, v89, v198, v118
    v_dot2_f32_bf16 v119, v56, v198, v119
    v_dot2_f32_bf16 v122, v90, v198, v122
    v_dot2_f32_bf16 v123, v57, v198, v123
    v_dot2_f32_bf16 v126, v91, v198, v126
    v_dot2_f32_bf16 v127, v58, v198, v127
    v_dot2_f32_bf16 v130, v92, v198, v130
    v_dot2_f32_bf16 v131, v59, v198, v131
    v_lshlrev_b32 v120, 16, v72
    v_and_b32 v121, 0xffff0000, v72
    v_lshlrev_b32 v124, 16, v73
    v_and_b32 v125, 0xffff0000, v73
    v_lshlrev_b32 v128, 16, v74
    v_and_b32 v129, 0xffff0000, v74
    v_lshlrev_b32 v132, 16, v75
    v_and_b32 v133, 0xffff0000, v75
    v_mul_f32 v118, v118, v120
    v_mul_f32 v119, v119, v121
    v_mul_f32 v122, v122, v124
    v_mul_f32 v123, v123, v125
    v_mul_f32 v126, v126, v128
    v_mul_f32 v127, v127, v129
    v_mul_f32 v130, v130, v132
    v_mul_f32 v131, v131, v133
    v_cvt_pk_bf16_f32 v157, v119, v118
    v_cvt_pk_bf16_f32 v156, v123, v122
    v_cvt_pk_bf16_f32 v155, v127, v126
    v_cvt_pk_bf16_f32 v154, v131, v130
    buffer_store_dwordx4 v[154:157], v12, s[8:11], s4 offen offset:1024
    v_dot2_f32_bf16 v102, v92, v199, 0
    v_dot2_f32_bf16 v103, v59, v199, 0
    v_dot2_f32_bf16 v106, v93, v199, 0
    v_dot2_f32_bf16 v107, v60, v199, 0
    v_dot2_f32_bf16 v110, v94, v199, 0
    v_dot2_f32_bf16 v111, v61, v199, 0
    v_dot2_f32_bf16 v114, v95, v199, 0
    v_dot2_f32_bf16 v115, v62, v199, 0
    v_dot2_f32_bf16 v102, v93, v198, v102
    v_dot2_f32_bf16 v103, v60, v198, v103
    v_dot2_f32_bf16 v106, v94, v198, v106
    v_dot2_f32_bf16 v107, v61, v198, v107
    v_dot2_f32_bf16 v110, v95, v198, v110
    v_dot2_f32_bf16 v111, v62, v198, v111
    v_dot2_f32_bf16 v114, v96, v198, v114
    v_dot2_f32_bf16 v115, v63, v198, v115
    v_lshlrev_b32 v104, 16, v76
    v_and_b32 v105, 0xffff0000, v76
    v_lshlrev_b32 v108, 16, v77
    v_and_b32 v109, 0xffff0000, v77
    v_lshlrev_b32 v112, 16, v78
    v_and_b32 v113, 0xffff0000, v78
    v_lshlrev_b32 v116, 16, v79
    v_and_b32 v117, 0xffff0000, v79
    v_mul_f32 v102, v102, v104
    v_mul_f32 v103, v103, v105
    v_mul_f32 v106, v106, v108
    v_mul_f32 v107, v107, v109
    v_mul_f32 v110, v110, v112
    v_mul_f32 v111, v111, v113
    v_mul_f32 v114, v114, v116
    v_mul_f32 v115, v115, v117
    v_cvt_pk_bf16_f32 v161, v103, v102
    v_cvt_pk_bf16_f32 v160, v107, v106
    v_cvt_pk_bf16_f32 v159, v111, v110
    v_cvt_pk_bf16_f32 v158, v115, v114
    buffer_store_dwordx4 v[158:161], v12, s[8:11], s4 offen offset:2048
    v_dot2_f32_bf16 v118, v96, v199, 0
    v_dot2_f32_bf16 v119, v63, v199, 0
    v_dot2_f32_bf16 v122, v97, v199, 0
    v_dot2_f32_bf16 v123, v64, v199, 0
    v_dot2_f32_bf16 v126, v98, v199, 0
    v_dot2_f32_bf16 v127, v65, v199, 0
    v_dot2_f32_bf16 v130, v99, v199, 0
    v_dot2_f32_bf16 v131, v66, v199, 0
    v_dot2_f32_bf16 v118, v97, v198, v118
    v_dot2_f32_bf16 v119, v64, v198, v119
    v_dot2_f32_bf16 v122, v98, v198, v122
    v_dot2_f32_bf16 v123, v65, v198, v123
    v_dot2_f32_bf16 v126, v99, v198, v126
    v_dot2_f32_bf16 v127, v66, v198, v127
    v_dot2_f32_bf16 v130, v100, v198, v130
    v_dot2_f32_bf16 v131, v67, v198, v131
    v_lshlrev_b32 v120, 16, v80
    v_and_b32 v121, 0xffff0000, v80
    v_lshlrev_b32 v124, 16, v81
    v_and_b32 v125, 0xffff0000, v81
    v_lshlrev_b32 v128, 16, v82
    v_and_b32 v129, 0xffff0000, v82
    v_lshlrev_b32 v132, 16, v83
    v_and_b32 v133, 0xffff0000, v83
    v_mul_f32 v118, v118, v120
    v_mul_f32 v119, v119, v121
    v_mul_f32 v122, v122, v124
    v_mul_f32 v123, v123, v125
    v_mul_f32 v126, v126, v128
    v_mul_f32 v127, v127, v129
    v_mul_f32 v130, v130, v132
    v_mul_f32 v131, v131, v133
    v_cvt_pk_bf16_f32 v165, v119, v118
    v_cvt_pk_bf16_f32 v164, v123, v122
    v_cvt_pk_bf16_f32 v163, v127, v126
    v_cvt_pk_bf16_f32 v162, v131, v130
    buffer_store_dwordx4 v[162:165], v12, s[8:11], s4 offen offset:3072
    s_waitcnt vmcnt(0)
    s_barrier
    s_load_dwordx4 s[52:55], s[0:1], 32
    s_lshl_b32 s3, s93, 5
    s_lshl_b32 s4, s24, 3
    s_add_u32 s3, s3, s4
    s_lshl_b32 s4, s3, 1
    s_waitcnt lgkmcnt(0)
    s_load_dwordx4 s[64:67], s[54:55], s4

    s_mov_b32 s28, s52
    s_and_b32 s29, s53, 0xffff
    s_mov_b32 s30, 0x400000
    s_mov_b32 s31, 0x00020000

    v_and_b32 v1, 63, v0
    v_and_b32 v2, 15, v1
    v_lshrrev_b32 v3, 4, v1

    s_lshl_b32 s32, s3, 12
    s_add_u32 s33, s32, 28672
    s_mul_i32 s34, s24, 38400
    s_add_u32 s35, s34, 33536
    s_add_u32 s38, s32, 117440512
    v_lshlrev_b32 v4, 4, v1
    v_add_u32 v5, s34, v4
    v_add_u32 v5, 64, v5
    v_sub_u32 v6, 7, v2
    v_and_b32 v6, 7, v6
    v_mul_u32_u24 v6, 4160, v6
    v_lshrrev_b32 v7, 3, v2
    v_sub_u32 v7, v7, v3
    v_add_u32 v7, 4, v7
    v_lshl_add_u32 v6, v7, 4, v6
    v_add_u32 v6, s34, v6
    v_mul_u32_u24 v7, 80, v3
    v_add_u32 v7, v7, v2
    v_lshlrev_b32 v7, 4, v7
    v_add_u32 v7, s34, v7
    v_add_u32 v7, 33296, v7
    v_lshlrev_b32 v228, 7, v2
    v_lshl_add_u32 v228, v3, 4, v228
    v_subrev_u32 v229, 16, v4
    v_max_i32 v230, 0, v229
    v_sub_u32 v232, 7, v2
    v_and_b32 v232, 7, v232
    v_and_b32 v233, 1, v232
    v_lshlrev_b32 v233, 4, v233
    v_mov_b32 v234, 0xffff
    v_lshlrev_b32 v233, v233, v234
    v_lshrrev_b32 v232, 1, v232
    v_lshrrev_b32 v234, 3, v2
    v_sub_u32 v234, v3, v234
    v_lshl_add_u32 v232, v234, 1, v232
    v_and_b32 v234, 1, v234
    v_lshl_add_u32 v232, v234, 8, v232

    v_cmp_eq_u32 vcc, 0, v232
    s_nop 1
    v_cndmask_b32 v8, 0, v233, vcc
    v_cmp_eq_u32 vcc, 1, v232
    s_nop 1
    v_cndmask_b32 v9, 0, v233, vcc
    v_cmp_eq_u32 vcc, 2, v232
    s_nop 1
    v_cndmask_b32 v10, 0, v233, vcc
    v_cmp_eq_u32 vcc, 3, v232
    s_nop 1
    v_cndmask_b32 v11, 0, v233, vcc
    v_cmp_eq_u32 vcc, 4, v232
    s_nop 1
    v_cndmask_b32 v12, 0, v233, vcc
    v_cmp_eq_u32 vcc, 5, v232
    s_nop 1
    v_cndmask_b32 v13, 0, v233, vcc
    v_cmp_eq_u32 vcc, 6, v232
    s_nop 1
    v_cndmask_b32 v14, 0, v233, vcc
    v_cmp_eq_u32 vcc, 7, v232
    s_nop 1
    v_cndmask_b32 v15, 0, v233, vcc
    v_mov_b32 v208, 0
    v_mov_b32 v209, 0
    v_mov_b32 v210, 0
    v_mov_b32 v211, 0
    v_lshrrev_b32 v232, 2, v1
    v_and_b32 v232, 7, v232
    v_mul_u32_u24 v232, 4160, v232
    v_and_b32 v233, 3, v1
    v_lshl_add_u32 v232, v233, 4, v232
    v_add_u32 v232, s34, v232
    ds_write_b128 v232, v[208:211]
    v_subrev_u32 v233, 16, v7
    ds_write_b128 v233, v[208:211]

    s_add_u32 s39, s32, 125829120
    buffer_load_dwordx4 v[176:179], v230, s[28:31], s32 offen offset:0
    buffer_load_dwordx4 v[180:183], v4, s[28:31], s32 offen offset:0
    buffer_load_dwordx4 v[184:187], v4, s[28:31], s32 offen offset:1008
    buffer_load_dwordx4 v[188:191], v4, s[28:31], s32 offen offset:1024
    buffer_load_dwordx4 v[192:195], v4, s[28:31], s32 offen offset:2032
    buffer_load_dwordx4 v[196:199], v4, s[28:31], s32 offen offset:2048
    buffer_load_dwordx4 v[200:203], v4, s[28:31], s32 offen offset:3056
    buffer_load_dwordx4 v[204:207], v4, s[28:31], s32 offen offset:3072
    s_add_u32 m0, s35, 0
    s_nop 0
    buffer_load_dwordx4 v4, s[8:11], s39 offen offset:0 lds
    s_add_u32 m0, s35, 256
    s_nop 0
    buffer_load_dwordx4 v4, s[8:11], s39 offen offset:1024 lds
    s_add_u32 m0, s35, 512
    s_nop 0
    buffer_load_dwordx4 v4, s[8:11], s39 offen offset:2048 lds
    s_add_u32 m0, s35, 768
    s_nop 0
    buffer_load_dwordx4 v4, s[8:11], s39 offen offset:3072 lds
    s_waitcnt vmcnt(0) lgkmcnt(0)
    s_pack_ll_b32_b16 s40, s64, s64
    s_add_u32 s36, s32, 4096
    s_add_u32 s37, s32, 8192
    s_add_u32 s39, s36, 125829120
    s_mov_b64 exec, 1
    v_mov_b32 v176, 0
    v_mov_b32 v177, 0
    v_mov_b32 v178, 0
    v_mov_b32 v179, 0
    s_mov_b64 exec, -1
    ds_write_b128 v5, v[180:183] offset:0
    ds_write_b128 v5, v[178:181] offset:16640
    v_mov_b32 v208, v177
    v_mov_b32 v209, v178
    v_mov_b32 v210, v179
    v_mov_b32 v211, v180
    ds_write_b128 v5, v[208:211] offset:24960
    v_mov_b32 v212, v181
    v_mov_b32 v213, v182
    ds_write_b128 v5, v[210:213] offset:8320
    v_alignbit_b32 v214, v177, v176, 16
    v_alignbit_b32 v215, v178, v177, 16
    v_alignbit_b32 v216, v179, v178, 16
    v_alignbit_b32 v217, v180, v179, 16
    ds_write_b128 v5, v[214:217] offset:29120
    v_alignbit_b32 v218, v181, v180, 16
    v_alignbit_b32 v219, v182, v181, 16
    ds_write_b128 v5, v[216:219] offset:12480
    v_alignbit_b32 v220, v178, v177, 16
    v_alignbit_b32 v221, v179, v178, 16
    v_alignbit_b32 v222, v180, v179, 16
    v_alignbit_b32 v223, v181, v180, 16
    ds_write_b128 v5, v[220:223] offset:20800
    v_alignbit_b32 v224, v182, v181, 16
    v_alignbit_b32 v225, v183, v182, 16
    ds_write_b128 v5, v[222:225] offset:4160
    buffer_load_dwordx4 v[176:179], v230, s[28:31], s36 offen offset:0
    buffer_load_dwordx4 v[180:183], v4, s[28:31], s36 offen offset:0
    ds_write_b128 v5, v[188:191] offset:1024
    ds_write_b128 v5, v[186:189] offset:17664
    v_mov_b32 v208, v185
    v_mov_b32 v209, v186
    v_mov_b32 v210, v187
    v_mov_b32 v211, v188
    ds_write_b128 v5, v[208:211] offset:25984
    v_mov_b32 v212, v189
    v_mov_b32 v213, v190
    ds_write_b128 v5, v[210:213] offset:9344
    v_alignbit_b32 v214, v185, v184, 16
    v_alignbit_b32 v215, v186, v185, 16
    v_alignbit_b32 v216, v187, v186, 16
    v_alignbit_b32 v217, v188, v187, 16
    ds_write_b128 v5, v[214:217] offset:30144
    v_alignbit_b32 v218, v189, v188, 16
    v_alignbit_b32 v219, v190, v189, 16
    ds_write_b128 v5, v[216:219] offset:13504
    v_alignbit_b32 v220, v186, v185, 16
    v_alignbit_b32 v221, v187, v186, 16
    v_alignbit_b32 v222, v188, v187, 16
    v_alignbit_b32 v223, v189, v188, 16
    ds_write_b128 v5, v[220:223] offset:21824
    v_alignbit_b32 v224, v190, v189, 16
    v_alignbit_b32 v225, v191, v190, 16
    ds_write_b128 v5, v[222:225] offset:5184
    buffer_load_dwordx4 v[184:187], v4, s[28:31], s36 offen offset:1008
    buffer_load_dwordx4 v[188:191], v4, s[28:31], s36 offen offset:1024
    v_and_b32 v236, s40, v8
    v_and_b32 v237, s40, v9
    v_and_b32 v238, s40, v10
    v_and_b32 v239, s40, v11
    v_and_b32 v240, s40, v12
    v_and_b32 v241, s40, v13
    v_and_b32 v242, s40, v14
    v_and_b32 v243, s40, v15
    ds_read_b128 a[60:63], v7 offset:240
    ds_read_b128 a[124:127], v7 offset:496
    ds_read_b128 a[188:191], v7 offset:752
    ds_read_b128 a[252:255], v7 offset:1008
    ds_read_b128 v[168:171], v6 offset:0
    ds_read_b128 v[172:175], v6 offset:32
    s_waitcnt vmcnt(0) lgkmcnt(0)
    s_mov_b32 s42, 0
.cvl_453:
    s_waitcnt lgkmcnt(5)
    v_mfma_f32_16x16x32_bf16 v[16:19], v[236:239], a[60:63], 0
    v_mfma_f32_16x16x32_bf16 v[32:35], v[240:243], a[60:63], 0
    s_waitcnt lgkmcnt(4)
    v_mfma_f32_16x16x32_bf16 v[20:23], v[236:239], a[124:127], 0
    v_mfma_f32_16x16x32_bf16 v[36:39], v[240:243], a[124:127], 0
    s_waitcnt lgkmcnt(3)
    v_mfma_f32_16x16x32_bf16 v[24:27], v[236:239], a[188:191], 0
    v_mfma_f32_16x16x32_bf16 v[40:43], v[240:243], a[188:191], 0
    ds_read_b128 a[56:59], v7 offset:224
    s_waitcnt lgkmcnt(3)
    v_mfma_f32_16x16x32_bf16 v[28:31], v[236:239], a[252:255], 0
    ds_read_b128 v[112:115], v6 offset:64
    v_mfma_f32_16x16x32_bf16 v[44:47], v[240:243], a[252:255], 0
    ds_read_b128 v[116:119], v6 offset:96
    s_waitcnt lgkmcnt(4)
    v_mfma_f32_16x16x32_bf16 v[16:19], v[168:171], a[60:63], v[16:19]
    ds_read_b128 a[120:123], v7 offset:480
    s_waitcnt lgkmcnt(4)
    v_mfma_f32_16x16x32_bf16 v[32:35], v[172:175], a[60:63], v[32:35]
    s_waitcnt vmcnt(18)
    v_mfma_f32_16x16x32_bf16 v[20:23], v[168:171], a[124:127], v[20:23]
    ds_read_b128 a[184:187], v7 offset:736
    v_mfma_f32_16x16x32_bf16 v[36:39], v[172:175], a[124:127], v[36:39]
    ds_write_b128 v5, v[196:199] offset:2048
    v_mfma_f32_16x16x32_bf16 v[24:27], v[168:171], a[188:191], v[24:27]
    ds_read_b128 a[248:251], v7 offset:992
    v_mfma_f32_16x16x32_bf16 v[40:43], v[172:175], a[188:191], v[40:43]
    ds_read_b128 a[52:55], v7 offset:208
    v_mfma_f32_16x16x32_bf16 v[28:31], v[168:171], a[252:255], v[28:31]
    ds_read_b128 v[120:123], v6 offset:128
    v_mfma_f32_16x16x32_bf16 v[44:47], v[172:175], a[252:255], v[44:47]
    ds_read_b128 v[124:127], v6 offset:160
    s_waitcnt lgkmcnt(8)
    v_mfma_f32_16x16x32_bf16 v[16:19], v[112:115], a[56:59], v[16:19]
    ds_read_b128 a[116:119], v7 offset:464
    s_waitcnt lgkmcnt(8)
    v_mfma_f32_16x16x32_bf16 v[32:35], v[116:119], a[56:59], v[32:35]
    ds_write_b128 v5, v[194:197] offset:18688
    s_waitcnt lgkmcnt(8)
    v_mfma_f32_16x16x32_bf16 v[20:23], v[112:115], a[120:123], v[20:23]
    ds_read_b128 a[180:183], v7 offset:720
    v_mfma_f32_16x16x32_bf16 v[36:39], v[116:119], a[120:123], v[36:39]
    v_mov_b32 v208, v193
    v_mov_b32 v209, v194
    s_waitcnt lgkmcnt(8)
    v_mfma_f32_16x16x32_bf16 v[24:27], v[112:115], a[184:187], v[24:27]
    ds_read_b128 a[244:247], v7 offset:976
    v_mfma_f32_16x16x32_bf16 v[40:43], v[116:119], a[184:187], v[40:43]
    ds_read_b128 a[48:51], v7 offset:192
    s_waitcnt lgkmcnt(8)
    v_mfma_f32_16x16x32_bf16 v[28:31], v[112:115], a[248:251], v[28:31]
    ds_read_b128 v[128:131], v6 offset:192
    v_mfma_f32_16x16x32_bf16 v[44:47], v[116:119], a[248:251], v[44:47]
    ds_read_b128 v[132:135], v6 offset:224
    s_waitcnt lgkmcnt(8)
    v_mfma_f32_16x16x32_bf16 v[16:19], v[120:123], a[52:55], v[16:19]
    ds_read_b128 a[112:115], v7 offset:448
    s_waitcnt lgkmcnt(8)
    v_mfma_f32_16x16x32_bf16 v[32:35], v[124:127], a[52:55], v[32:35]
    v_mov_b32 v210, v195
    v_mov_b32 v211, v196
    s_waitcnt lgkmcnt(7)
    v_mfma_f32_16x16x32_bf16 v[20:23], v[120:123], a[116:119], v[20:23]
    ds_read_b128 a[176:179], v7 offset:704
    v_mfma_f32_16x16x32_bf16 v[36:39], v[124:127], a[116:119], v[36:39]
    ds_write_b128 v5, v[208:211] offset:27008
    s_waitcnt lgkmcnt(7)
    v_mfma_f32_16x16x32_bf16 v[24:27], v[120:123], a[180:183], v[24:27]
    ds_read_b128 a[240:243], v7 offset:960
    v_mfma_f32_16x16x32_bf16 v[40:43], v[124:127], a[180:183], v[40:43]
    ds_read_b128 a[44:47], v7 offset:176
    s_waitcnt lgkmcnt(8)
    v_mfma_f32_16x16x32_bf16 v[28:31], v[120:123], a[244:247], v[28:31]
    ds_read_b128 v[136:139], v6 offset:256
    v_mfma_f32_16x16x32_bf16 v[44:47], v[124:127], a[244:247], v[44:47]
    ds_read_b128 v[140:143], v6 offset:288
    s_waitcnt lgkmcnt(8)
    v_mfma_f32_16x16x32_bf16 v[16:19], v[128:131], a[48:51], v[16:19]
    ds_read_b128 a[108:111], v7 offset:432
    s_waitcnt lgkmcnt(8)
    v_mfma_f32_16x16x32_bf16 v[32:35], v[132:135], a[48:51], v[32:35]
    v_mov_b32 v212, v197
    v_mov_b32 v213, v198
    s_waitcnt lgkmcnt(7)
    v_mfma_f32_16x16x32_bf16 v[20:23], v[128:131], a[112:115], v[20:23]
    ds_read_b128 a[172:175], v7 offset:688
    v_mfma_f32_16x16x32_bf16 v[36:39], v[132:135], a[112:115], v[36:39]
    ds_write_b128 v5, v[210:213] offset:10368
    s_waitcnt lgkmcnt(8)
    v_mfma_f32_16x16x32_bf16 v[24:27], v[128:131], a[176:179], v[24:27]
    ds_read_b128 a[236:239], v7 offset:944
    v_mfma_f32_16x16x32_bf16 v[40:43], v[132:135], a[176:179], v[40:43]
    ds_read_b128 a[40:43], v7 offset:160
    s_waitcnt lgkmcnt(8)
    v_mfma_f32_16x16x32_bf16 v[28:31], v[128:131], a[240:243], v[28:31]
    ds_read_b128 v[144:147], v6 offset:320
    v_mfma_f32_16x16x32_bf16 v[44:47], v[132:135], a[240:243], v[44:47]
    ds_read_b128 v[148:151], v6 offset:352
    s_waitcnt lgkmcnt(8)
    v_mfma_f32_16x16x32_bf16 v[16:19], v[136:139], a[44:47], v[16:19]
    ds_read_b128 a[104:107], v7 offset:416
    s_waitcnt lgkmcnt(8)
    v_mfma_f32_16x16x32_bf16 v[32:35], v[140:143], a[44:47], v[32:35]
    v_alignbit_b32 v214, v193, v192, 16
    v_alignbit_b32 v215, v194, v193, 16
    s_waitcnt lgkmcnt(7)
    v_mfma_f32_16x16x32_bf16 v[20:23], v[136:139], a[108:111], v[20:23]
    ds_read_b128 a[168:171], v7 offset:672
    v_mfma_f32_16x16x32_bf16 v[36:39], v[140:143], a[108:111], v[36:39]
    v_alignbit_b32 v216, v195, v194, 16
    v_alignbit_b32 v217, v196, v195, 16
    s_waitcnt lgkmcnt(7)
    v_mfma_f32_16x16x32_bf16 v[24:27], v[136:139], a[172:175], v[24:27]
    ds_read_b128 a[232:235], v7 offset:928
    v_mfma_f32_16x16x32_bf16 v[40:43], v[140:143], a[172:175], v[40:43]
    ds_read_b128 a[36:39], v7 offset:144
    s_waitcnt lgkmcnt(7)
    v_mfma_f32_16x16x32_bf16 v[28:31], v[136:139], a[236:239], v[28:31]
    ds_read_b128 v[152:155], v6 offset:384
    v_mfma_f32_16x16x32_bf16 v[44:47], v[140:143], a[236:239], v[44:47]
    ds_read_b128 v[156:159], v6 offset:416
    s_waitcnt lgkmcnt(7)
    v_mfma_f32_16x16x32_bf16 v[16:19], v[144:147], a[40:43], v[16:19]
    ds_read_b128 a[100:103], v7 offset:400
    s_waitcnt lgkmcnt(7)
    v_mfma_f32_16x16x32_bf16 v[32:35], v[148:151], a[40:43], v[32:35]
    ds_write_b128 v5, v[214:217] offset:31168
    s_waitcnt lgkmcnt(7)
    v_mfma_f32_16x16x32_bf16 v[20:23], v[144:147], a[104:107], v[20:23]
    ds_read_b128 a[164:167], v7 offset:656
    v_mfma_f32_16x16x32_bf16 v[36:39], v[148:151], a[104:107], v[36:39]
    v_alignbit_b32 v218, v197, v196, 16
    v_alignbit_b32 v219, v198, v197, 16
    s_waitcnt lgkmcnt(7)
    v_mfma_f32_16x16x32_bf16 v[24:27], v[144:147], a[168:171], v[24:27]
    ds_read_b128 a[228:231], v7 offset:912
    v_mfma_f32_16x16x32_bf16 v[40:43], v[148:151], a[168:171], v[40:43]
    ds_read_b128 a[32:35], v7 offset:128
    s_waitcnt lgkmcnt(8)
    v_mfma_f32_16x16x32_bf16 v[28:31], v[144:147], a[232:235], v[28:31]
    ds_read_b128 v[160:163], v6 offset:448
    v_mfma_f32_16x16x32_bf16 v[44:47], v[148:151], a[232:235], v[44:47]
    ds_read_b128 v[164:167], v6 offset:480
    s_waitcnt lgkmcnt(8)
    v_mfma_f32_16x16x32_bf16 v[16:19], v[152:155], a[36:39], v[16:19]
    ds_read_b128 a[96:99], v7 offset:384
    s_waitcnt lgkmcnt(8)
    v_mfma_f32_16x16x32_bf16 v[32:35], v[156:159], a[36:39], v[32:35]
    ds_write_b128 v5, v[216:219] offset:14528
    s_waitcnt lgkmcnt(8)
    v_mfma_f32_16x16x32_bf16 v[20:23], v[152:155], a[100:103], v[20:23]
    ds_read_b128 a[160:163], v7 offset:640
    v_mfma_f32_16x16x32_bf16 v[36:39], v[156:159], a[100:103], v[36:39]
    v_alignbit_b32 v220, v194, v193, 16
    v_alignbit_b32 v221, v195, v194, 16
    s_waitcnt lgkmcnt(7)
    v_mfma_f32_16x16x32_bf16 v[24:27], v[152:155], a[164:167], v[24:27]
    ds_read_b128 a[224:227], v7 offset:896
    v_mfma_f32_16x16x32_bf16 v[40:43], v[156:159], a[164:167], v[40:43]
    ds_read_b128 a[28:31], v7 offset:112
    s_waitcnt lgkmcnt(8)
    v_mfma_f32_16x16x32_bf16 v[28:31], v[152:155], a[228:231], v[28:31]
    ds_read_b128 v[168:171], v6 offset:512
    v_mfma_f32_16x16x32_bf16 v[44:47], v[156:159], a[228:231], v[44:47]
    ds_read_b128 v[172:175], v6 offset:544
    s_waitcnt lgkmcnt(8)
    v_mfma_f32_16x16x32_bf16 v[16:19], v[160:163], a[32:35], v[16:19]
    ds_read_b128 a[92:95], v7 offset:368
    s_waitcnt lgkmcnt(8)
    v_mfma_f32_16x16x32_bf16 v[32:35], v[164:167], a[32:35], v[32:35]
    v_alignbit_b32 v222, v196, v195, 16
    v_alignbit_b32 v223, v197, v196, 16
    s_waitcnt lgkmcnt(7)
    v_mfma_f32_16x16x32_bf16 v[20:23], v[160:163], a[96:99], v[20:23]
    ds_read_b128 a[156:159], v7 offset:624
    v_mfma_f32_16x16x32_bf16 v[36:39], v[164:167], a[96:99], v[36:39]
    ds_write_b128 v5, v[220:223] offset:22848
    s_waitcnt lgkmcnt(7)
    v_mfma_f32_16x16x32_bf16 v[24:27], v[160:163], a[160:163], v[24:27]
    ds_read_b128 a[220:223], v7 offset:880
    v_mfma_f32_16x16x32_bf16 v[40:43], v[164:167], a[160:163], v[40:43]
    ds_read_b128 a[24:27], v7 offset:96
    s_waitcnt lgkmcnt(8)
    v_mfma_f32_16x16x32_bf16 v[28:31], v[160:163], a[224:227], v[28:31]
    ds_read_b128 v[112:115], v6 offset:576
    v_mfma_f32_16x16x32_bf16 v[44:47], v[164:167], a[224:227], v[44:47]
    ds_read_b128 v[116:119], v6 offset:608
    s_waitcnt lgkmcnt(8)
    v_mfma_f32_16x16x32_bf16 v[16:19], v[168:171], a[28:31], v[16:19]
    ds_read_b128 a[88:91], v7 offset:352
    s_waitcnt lgkmcnt(8)
    v_mfma_f32_16x16x32_bf16 v[32:35], v[172:175], a[28:31], v[32:35]
    v_alignbit_b32 v224, v198, v197, 16
    v_alignbit_b32 v225, v199, v198, 16
    s_waitcnt lgkmcnt(7)
    v_mfma_f32_16x16x32_bf16 v[20:23], v[168:171], a[92:95], v[20:23]
    ds_read_b128 a[152:155], v7 offset:608
    v_mfma_f32_16x16x32_bf16 v[36:39], v[172:175], a[92:95], v[36:39]
    ds_write_b128 v5, v[222:225] offset:6208
    s_waitcnt lgkmcnt(8)
    v_mfma_f32_16x16x32_bf16 v[24:27], v[168:171], a[156:159], v[24:27]
    ds_read_b128 a[216:219], v7 offset:864
    v_mfma_f32_16x16x32_bf16 v[40:43], v[172:175], a[156:159], v[40:43]
    ds_read_b128 a[20:23], v7 offset:80
    s_waitcnt lgkmcnt(8)
    v_mfma_f32_16x16x32_bf16 v[28:31], v[168:171], a[220:223], v[28:31]
    ds_read_b128 v[120:123], v6 offset:640
    v_mfma_f32_16x16x32_bf16 v[44:47], v[172:175], a[220:223], v[44:47]
    ds_read_b128 v[124:127], v6 offset:672
    s_waitcnt lgkmcnt(8)
    v_mfma_f32_16x16x32_bf16 v[16:19], v[112:115], a[24:27], v[16:19]
    ds_read_b128 a[84:87], v7 offset:336
    s_waitcnt lgkmcnt(8)
    v_mfma_f32_16x16x32_bf16 v[32:35], v[116:119], a[24:27], v[32:35]
    buffer_load_dwordx4 v[192:195], v4, s[28:31], s36 offen offset:2032
    s_waitcnt lgkmcnt(7)
    v_mfma_f32_16x16x32_bf16 v[20:23], v[112:115], a[88:91], v[20:23]
    ds_read_b128 a[148:151], v7 offset:592
    v_mfma_f32_16x16x32_bf16 v[36:39], v[116:119], a[88:91], v[36:39]
    buffer_load_dwordx4 v[196:199], v4, s[28:31], s36 offen offset:2048
    s_waitcnt lgkmcnt(7)
    v_mfma_f32_16x16x32_bf16 v[24:27], v[112:115], a[152:155], v[24:27]
    ds_read_b128 a[212:215], v7 offset:848
    v_mfma_f32_16x16x32_bf16 v[40:43], v[116:119], a[152:155], v[40:43]
    ds_read_b128 a[16:19], v7 offset:64
    s_waitcnt lgkmcnt(7)
    v_mfma_f32_16x16x32_bf16 v[28:31], v[112:115], a[216:219], v[28:31]
    ds_read_b128 v[128:131], v6 offset:704
    v_mfma_f32_16x16x32_bf16 v[44:47], v[116:119], a[216:219], v[44:47]
    ds_read_b128 v[132:135], v6 offset:736
    s_waitcnt lgkmcnt(7)
    v_mfma_f32_16x16x32_bf16 v[16:19], v[120:123], a[20:23], v[16:19]
    ds_read_b128 a[80:83], v7 offset:320
    s_waitcnt lgkmcnt(7)
    v_mfma_f32_16x16x32_bf16 v[32:35], v[124:127], a[20:23], v[32:35]
    s_waitcnt vmcnt(18)
    s_waitcnt lgkmcnt(6)
    v_mfma_f32_16x16x32_bf16 v[20:23], v[120:123], a[84:87], v[20:23]
    ds_read_b128 a[144:147], v7 offset:576
    v_mfma_f32_16x16x32_bf16 v[36:39], v[124:127], a[84:87], v[36:39]
    ds_write_b128 v5, v[204:207] offset:3072
    s_waitcnt lgkmcnt(7)
    v_mfma_f32_16x16x32_bf16 v[24:27], v[120:123], a[148:151], v[24:27]
    ds_read_b128 a[208:211], v7 offset:832
    v_mfma_f32_16x16x32_bf16 v[40:43], v[124:127], a[148:151], v[40:43]
    ds_read_b128 a[12:15], v7 offset:48
    s_waitcnt lgkmcnt(8)
    v_mfma_f32_16x16x32_bf16 v[28:31], v[120:123], a[212:215], v[28:31]
    ds_read_b128 v[136:139], v6 offset:768
    v_mfma_f32_16x16x32_bf16 v[44:47], v[124:127], a[212:215], v[44:47]
    ds_read_b128 v[140:143], v6 offset:800
    s_waitcnt lgkmcnt(8)
    v_mfma_f32_16x16x32_bf16 v[16:19], v[128:131], a[16:19], v[16:19]
    ds_read_b128 a[76:79], v7 offset:304
    s_waitcnt lgkmcnt(8)
    v_mfma_f32_16x16x32_bf16 v[32:35], v[132:135], a[16:19], v[32:35]
    ds_write_b128 v5, v[202:205] offset:19712
    s_waitcnt lgkmcnt(8)
    v_mfma_f32_16x16x32_bf16 v[20:23], v[128:131], a[80:83], v[20:23]
    ds_read_b128 a[140:143], v7 offset:560
    v_mfma_f32_16x16x32_bf16 v[36:39], v[132:135], a[80:83], v[36:39]
    v_mov_b32 v208, v201
    v_mov_b32 v209, v202
    s_waitcnt lgkmcnt(8)
    v_mfma_f32_16x16x32_bf16 v[24:27], v[128:131], a[144:147], v[24:27]
    ds_read_b128 a[204:207], v7 offset:816
    v_mfma_f32_16x16x32_bf16 v[40:43], v[132:135], a[144:147], v[40:43]
    ds_read_b128 a[8:11], v7 offset:32
    s_waitcnt lgkmcnt(8)
    v_mfma_f32_16x16x32_bf16 v[28:31], v[128:131], a[208:211], v[28:31]
    ds_read_b128 v[144:147], v6 offset:832
    v_mfma_f32_16x16x32_bf16 v[44:47], v[132:135], a[208:211], v[44:47]
    ds_read_b128 v[148:151], v6 offset:864
    s_waitcnt lgkmcnt(8)
    v_mfma_f32_16x16x32_bf16 v[16:19], v[136:139], a[12:15], v[16:19]
    ds_read_b128 a[72:75], v7 offset:288
    s_waitcnt lgkmcnt(8)
    v_mfma_f32_16x16x32_bf16 v[32:35], v[140:143], a[12:15], v[32:35]
    v_mov_b32 v210, v203
    v_mov_b32 v211, v204
    s_waitcnt lgkmcnt(7)
    v_mfma_f32_16x16x32_bf16 v[20:23], v[136:139], a[76:79], v[20:23]
    ds_read_b128 a[136:139], v7 offset:544
    v_mfma_f32_16x16x32_bf16 v[36:39], v[140:143], a[76:79], v[36:39]
    ds_write_b128 v5, v[208:211] offset:28032
    s_waitcnt lgkmcnt(7)
    v_mfma_f32_16x16x32_bf16 v[24:27], v[136:139], a[140:143], v[24:27]
    ds_read_b128 a[200:203], v7 offset:800
    v_mfma_f32_16x16x32_bf16 v[40:43], v[140:143], a[140:143], v[40:43]
    ds_read_b128 a[4:7], v7 offset:16
    s_waitcnt lgkmcnt(8)
    v_mfma_f32_16x16x32_bf16 v[28:31], v[136:139], a[204:207], v[28:31]
    ds_read_b128 v[152:155], v6 offset:896
    v_mfma_f32_16x16x32_bf16 v[44:47], v[140:143], a[204:207], v[44:47]
    ds_read_b128 v[156:159], v6 offset:928
    s_waitcnt lgkmcnt(8)
    v_mfma_f32_16x16x32_bf16 v[16:19], v[144:147], a[8:11], v[16:19]
    ds_read_b128 a[68:71], v7 offset:272
    s_waitcnt lgkmcnt(8)
    v_mfma_f32_16x16x32_bf16 v[32:35], v[148:151], a[8:11], v[32:35]
    v_mov_b32 v212, v205
    v_mov_b32 v213, v206
    s_waitcnt lgkmcnt(7)
    v_mfma_f32_16x16x32_bf16 v[20:23], v[144:147], a[72:75], v[20:23]
    ds_read_b128 a[132:135], v7 offset:528
    v_mfma_f32_16x16x32_bf16 v[36:39], v[148:151], a[72:75], v[36:39]
    ds_write_b128 v5, v[210:213] offset:11392
    s_waitcnt lgkmcnt(8)
    v_mfma_f32_16x16x32_bf16 v[24:27], v[144:147], a[136:139], v[24:27]
    ds_read_b128 a[196:199], v7 offset:784
    v_mfma_f32_16x16x32_bf16 v[40:43], v[148:151], a[136:139], v[40:43]
    ds_read_b128 a[0:3], v7 offset:0
    s_waitcnt lgkmcnt(8)
    v_mfma_f32_16x16x32_bf16 v[28:31], v[144:147], a[200:203], v[28:31]
    ds_read_b128 v[160:163], v6 offset:960
    v_mfma_f32_16x16x32_bf16 v[44:47], v[148:151], a[200:203], v[44:47]
    ds_read_b128 v[164:167], v6 offset:992
    s_waitcnt lgkmcnt(8)
    v_mfma_f32_16x16x32_bf16 v[16:19], v[152:155], a[4:7], v[16:19]
    ds_read_b128 a[64:67], v7 offset:256
    s_waitcnt lgkmcnt(8)
    v_mfma_f32_16x16x32_bf16 v[32:35], v[156:159], a[4:7], v[32:35]
    v_alignbit_b32 v214, v201, v200, 16
    v_alignbit_b32 v215, v202, v201, 16
    s_waitcnt lgkmcnt(7)
    v_mfma_f32_16x16x32_bf16 v[20:23], v[152:155], a[68:71], v[20:23]
    ds_read_b128 a[128:131], v7 offset:512
    v_mfma_f32_16x16x32_bf16 v[36:39], v[156:159], a[68:71], v[36:39]
    v_alignbit_b32 v216, v203, v202, 16
    v_alignbit_b32 v217, v204, v203, 16
    s_waitcnt lgkmcnt(7)
    v_mfma_f32_16x16x32_bf16 v[24:27], v[152:155], a[132:135], v[24:27]
    ds_read_b128 a[192:195], v7 offset:768
    v_mfma_f32_16x16x32_bf16 v[40:43], v[156:159], a[132:135], v[40:43]
    ds_write_b128 v5, v[214:217] offset:32192
    s_waitcnt lgkmcnt(7)
    v_mfma_f32_16x16x32_bf16 v[28:31], v[152:155], a[196:199], v[28:31]
    ds_read_b128 v[168:171], v6 offset:1024
    v_mfma_f32_16x16x32_bf16 v[44:47], v[156:159], a[196:199], v[44:47]
    ds_read_b128 v[172:175], v6 offset:1056
    s_waitcnt lgkmcnt(7)
    v_mfma_f32_16x16x32_bf16 v[16:19], v[160:163], a[0:3], v[16:19]
    v_alignbit_b32 v218, v205, v204, 16
    v_alignbit_b32 v219, v206, v205, 16
    s_waitcnt lgkmcnt(6)
    v_mfma_f32_16x16x32_bf16 v[32:35], v[164:167], a[0:3], v[32:35]
    ds_write_b128 v5, v[216:219] offset:15552
    s_waitcnt lgkmcnt(6)
    v_mfma_f32_16x16x32_bf16 v[20:23], v[160:163], a[64:67], v[20:23]
    v_alignbit_b32 v220, v202, v201, 16
    v_alignbit_b32 v221, v203, v202, 16
    v_mfma_f32_16x16x32_bf16 v[36:39], v[164:167], a[64:67], v[36:39]
    v_alignbit_b32 v222, v204, v203, 16
    v_alignbit_b32 v223, v205, v204, 16
    s_waitcnt lgkmcnt(5)
    v_mfma_f32_16x16x32_bf16 v[24:27], v[160:163], a[128:131], v[24:27]
    ds_read_b128 v[112:115], v6 offset:1088
    v_mfma_f32_16x16x32_bf16 v[40:43], v[164:167], a[128:131], v[40:43]
    ds_read_b128 v[116:119], v6 offset:1120
    s_waitcnt lgkmcnt(6)
    v_mfma_f32_16x16x32_bf16 v[28:31], v[160:163], a[192:195], v[28:31]
    ds_write_b128 v5, v[220:223] offset:23872
    v_mfma_f32_16x16x32_bf16 v[44:47], v[164:167], a[192:195], v[44:47]
    v_alignbit_b32 v224, v206, v205, 16
    v_alignbit_b32 v225, v207, v206, 16
    s_waitcnt lgkmcnt(5)
    v_mfma_f32_16x16x32_bf16 v[20:23], v[168:171], a[60:63], v[20:23]
    ds_write_b128 v5, v[222:225] offset:7232
    s_waitcnt lgkmcnt(5)
    v_mfma_f32_16x16x32_bf16 v[36:39], v[172:175], a[60:63], v[36:39]
    buffer_load_dwordx4 v[200:203], v4, s[28:31], s36 offen offset:3056
    v_mfma_f32_16x16x32_bf16 v[24:27], v[168:171], a[124:127], v[24:27]
    ds_read_b128 v[120:123], v6 offset:1152
    v_mfma_f32_16x16x32_bf16 v[40:43], v[172:175], a[124:127], v[40:43]
    ds_read_b128 v[124:127], v6 offset:1184
    v_mfma_f32_16x16x32_bf16 v[28:31], v[168:171], a[188:191], v[28:31]
    buffer_load_dwordx4 v[204:207], v4, s[28:31], s36 offen offset:3072
    v_mfma_f32_16x16x32_bf16 v[44:47], v[172:175], a[188:191], v[44:47]
    s_waitcnt vmcnt(18)
    s_mov_b64 exec, 1
    v_mov_b32 v176, 0
    v_mov_b32 v177, 0
    v_mov_b32 v178, 0
    v_mov_b32 v179, 0
    s_mov_b64 exec, -1
    s_waitcnt lgkmcnt(5)
    v_mfma_f32_16x16x32_bf16 v[20:23], v[112:115], a[56:59], v[20:23]
    ds_write_b128 v5, v[180:183] offset:0
    s_waitcnt lgkmcnt(5)
    v_mfma_f32_16x16x32_bf16 v[36:39], v[116:119], a[56:59], v[36:39]
    ds_write_b128 v5, v[178:181] offset:16640
    v_mfma_f32_16x16x32_bf16 v[24:27], v[112:115], a[120:123], v[24:27]
    ds_read_b128 v[128:131], v6 offset:1216
    v_mfma_f32_16x16x32_bf16 v[40:43], v[116:119], a[120:123], v[40:43]
    ds_read_b128 v[132:135], v6 offset:1248
    v_mfma_f32_16x16x32_bf16 v[28:31], v[112:115], a[184:187], v[28:31]
    v_mov_b32 v208, v177
    v_mov_b32 v209, v178
    v_mfma_f32_16x16x32_bf16 v[44:47], v[116:119], a[184:187], v[44:47]
    v_mov_b32 v210, v179
    v_mov_b32 v211, v180
    s_waitcnt lgkmcnt(5)
    v_mfma_f32_16x16x32_bf16 v[20:23], v[120:123], a[52:55], v[20:23]
    ds_write_b128 v5, v[208:211] offset:24960
    s_waitcnt lgkmcnt(5)
    v_mfma_f32_16x16x32_bf16 v[36:39], v[124:127], a[52:55], v[36:39]
    v_mov_b32 v212, v181
    v_mov_b32 v213, v182
    v_mfma_f32_16x16x32_bf16 v[24:27], v[120:123], a[116:119], v[24:27]
    ds_read_b128 v[136:139], v6 offset:1280
    v_mfma_f32_16x16x32_bf16 v[40:43], v[124:127], a[116:119], v[40:43]
    ds_read_b128 v[140:143], v6 offset:1312
    v_mfma_f32_16x16x32_bf16 v[28:31], v[120:123], a[180:183], v[28:31]
    ds_write_b128 v5, v[210:213] offset:8320
    v_mfma_f32_16x16x32_bf16 v[44:47], v[124:127], a[180:183], v[44:47]
    v_alignbit_b32 v214, v177, v176, 16
    v_alignbit_b32 v215, v178, v177, 16
    s_waitcnt lgkmcnt(5)
    v_mfma_f32_16x16x32_bf16 v[20:23], v[128:131], a[48:51], v[20:23]
    v_alignbit_b32 v216, v179, v178, 16
    v_alignbit_b32 v217, v180, v179, 16
    s_waitcnt lgkmcnt(4)
    v_mfma_f32_16x16x32_bf16 v[36:39], v[132:135], a[48:51], v[36:39]
    ds_write_b128 v5, v[214:217] offset:29120
    v_mfma_f32_16x16x32_bf16 v[24:27], v[128:131], a[112:115], v[24:27]
    ds_read_b128 v[144:147], v6 offset:1344
    v_mfma_f32_16x16x32_bf16 v[40:43], v[132:135], a[112:115], v[40:43]
    ds_read_b128 v[148:151], v6 offset:1376
    v_mfma_f32_16x16x32_bf16 v[28:31], v[128:131], a[176:179], v[28:31]
    v_alignbit_b32 v218, v181, v180, 16
    v_alignbit_b32 v219, v182, v181, 16
    v_mfma_f32_16x16x32_bf16 v[44:47], v[132:135], a[176:179], v[44:47]
    ds_write_b128 v5, v[216:219] offset:12480
    s_waitcnt lgkmcnt(6)
    v_mfma_f32_16x16x32_bf16 v[20:23], v[136:139], a[44:47], v[20:23]
    v_alignbit_b32 v220, v178, v177, 16
    v_alignbit_b32 v221, v179, v178, 16
    s_waitcnt lgkmcnt(5)
    v_mfma_f32_16x16x32_bf16 v[36:39], v[140:143], a[44:47], v[36:39]
    v_alignbit_b32 v222, v180, v179, 16
    v_alignbit_b32 v223, v181, v180, 16
    v_mfma_f32_16x16x32_bf16 v[24:27], v[136:139], a[108:111], v[24:27]
    ds_read_b128 v[152:155], v6 offset:1408
    v_mfma_f32_16x16x32_bf16 v[40:43], v[140:143], a[108:111], v[40:43]
    ds_read_b128 v[156:159], v6 offset:1440
    v_mfma_f32_16x16x32_bf16 v[28:31], v[136:139], a[172:175], v[28:31]
    ds_write_b128 v5, v[220:223] offset:20800
    v_mfma_f32_16x16x32_bf16 v[44:47], v[140:143], a[172:175], v[44:47]
    v_alignbit_b32 v224, v182, v181, 16
    v_alignbit_b32 v225, v183, v182, 16
    s_waitcnt lgkmcnt(5)
    v_mfma_f32_16x16x32_bf16 v[20:23], v[144:147], a[40:43], v[20:23]
    ds_write_b128 v5, v[222:225] offset:4160
    s_waitcnt lgkmcnt(5)
    v_mfma_f32_16x16x32_bf16 v[36:39], v[148:151], a[40:43], v[36:39]
    buffer_load_dwordx4 v[176:179], v230, s[28:31], s37 offen offset:0
    v_mfma_f32_16x16x32_bf16 v[24:27], v[144:147], a[104:107], v[24:27]
    ds_read_b128 v[160:163], v6 offset:1472
    v_mfma_f32_16x16x32_bf16 v[40:43], v[148:151], a[104:107], v[40:43]
    ds_read_b128 v[164:167], v6 offset:1504
    v_mfma_f32_16x16x32_bf16 v[28:31], v[144:147], a[168:171], v[28:31]
    buffer_load_dwordx4 v[180:183], v4, s[28:31], s37 offen offset:0
    v_mfma_f32_16x16x32_bf16 v[44:47], v[148:151], a[168:171], v[44:47]
    s_add_u32 m0, s35, 0
    s_waitcnt lgkmcnt(5)
    v_mfma_f32_16x16x32_bf16 v[20:23], v[152:155], a[36:39], v[20:23]
    buffer_load_dwordx4 v4, s[8:11], s39 offen offset:0 lds
    s_waitcnt lgkmcnt(4)
    v_mfma_f32_16x16x32_bf16 v[36:39], v[156:159], a[36:39], v[36:39]
    s_add_u32 m0, s35, 256
    v_mfma_f32_16x16x32_bf16 v[24:27], v[152:155], a[100:103], v[24:27]
    ds_read_b128 v[168:171], v6 offset:1536
    v_mfma_f32_16x16x32_bf16 v[40:43], v[156:159], a[100:103], v[40:43]
    ds_read_b128 v[172:175], v6 offset:1568
    v_mfma_f32_16x16x32_bf16 v[28:31], v[152:155], a[164:167], v[28:31]
    buffer_load_dwordx4 v4, s[8:11], s39 offen offset:1024 lds
    v_mfma_f32_16x16x32_bf16 v[44:47], v[156:159], a[164:167], v[44:47]
    s_add_u32 m0, s35, 512
    s_waitcnt lgkmcnt(3)
    v_mfma_f32_16x16x32_bf16 v[20:23], v[160:163], a[32:35], v[20:23]
    buffer_load_dwordx4 v4, s[8:11], s39 offen offset:2048 lds
    s_waitcnt lgkmcnt(2)
    v_mfma_f32_16x16x32_bf16 v[36:39], v[164:167], a[32:35], v[36:39]
    s_add_u32 m0, s35, 768
    v_mfma_f32_16x16x32_bf16 v[24:27], v[160:163], a[96:99], v[24:27]
    ds_read_b128 v[112:115], v6 offset:1600
    v_mfma_f32_16x16x32_bf16 v[40:43], v[164:167], a[96:99], v[40:43]
    ds_read_b128 v[116:119], v6 offset:1632
    v_mfma_f32_16x16x32_bf16 v[28:31], v[160:163], a[160:163], v[28:31]
    buffer_load_dwordx4 v4, s[8:11], s39 offen offset:3072 lds
    v_mfma_f32_16x16x32_bf16 v[44:47], v[164:167], a[160:163], v[44:47]
    s_waitcnt lgkmcnt(3)
    v_mfma_f32_16x16x32_bf16 v[20:23], v[168:171], a[28:31], v[20:23]
    s_waitcnt lgkmcnt(2)
    v_mfma_f32_16x16x32_bf16 v[36:39], v[172:175], a[28:31], v[36:39]
    v_mfma_f32_16x16x32_bf16 v[24:27], v[168:171], a[92:95], v[24:27]
    ds_read_b128 v[120:123], v6 offset:1664
    v_mfma_f32_16x16x32_bf16 v[40:43], v[172:175], a[92:95], v[40:43]
    ds_read_b128 v[124:127], v6 offset:1696
    v_mfma_f32_16x16x32_bf16 v[28:31], v[168:171], a[156:159], v[28:31]
    v_mfma_f32_16x16x32_bf16 v[44:47], v[172:175], a[156:159], v[44:47]
    s_waitcnt lgkmcnt(3)
    v_mfma_f32_16x16x32_bf16 v[20:23], v[112:115], a[24:27], v[20:23]
    s_waitcnt lgkmcnt(2)
    v_mfma_f32_16x16x32_bf16 v[36:39], v[116:119], a[24:27], v[36:39]
    v_mfma_f32_16x16x32_bf16 v[24:27], v[112:115], a[88:91], v[24:27]
    ds_read_b128 v[128:131], v6 offset:1728
    v_mfma_f32_16x16x32_bf16 v[40:43], v[116:119], a[88:91], v[40:43]
    ds_read_b128 v[132:135], v6 offset:1760
    v_mfma_f32_16x16x32_bf16 v[28:31], v[112:115], a[152:155], v[28:31]
    v_mfma_f32_16x16x32_bf16 v[44:47], v[116:119], a[152:155], v[44:47]
    s_waitcnt lgkmcnt(3)
    v_mfma_f32_16x16x32_bf16 v[20:23], v[120:123], a[20:23], v[20:23]
    s_waitcnt lgkmcnt(2)
    v_mfma_f32_16x16x32_bf16 v[36:39], v[124:127], a[20:23], v[36:39]
    v_mfma_f32_16x16x32_bf16 v[24:27], v[120:123], a[84:87], v[24:27]
    ds_read_b128 v[136:139], v6 offset:1792
    v_mfma_f32_16x16x32_bf16 v[40:43], v[124:127], a[84:87], v[40:43]
    ds_read_b128 v[140:143], v6 offset:1824
    v_mfma_f32_16x16x32_bf16 v[28:31], v[120:123], a[148:151], v[28:31]
    v_mfma_f32_16x16x32_bf16 v[44:47], v[124:127], a[148:151], v[44:47]
    s_waitcnt lgkmcnt(3)
    v_mfma_f32_16x16x32_bf16 v[20:23], v[128:131], a[16:19], v[20:23]
    s_waitcnt lgkmcnt(2)
    v_mfma_f32_16x16x32_bf16 v[36:39], v[132:135], a[16:19], v[36:39]
    v_mfma_f32_16x16x32_bf16 v[24:27], v[128:131], a[80:83], v[24:27]
    ds_read_b128 v[144:147], v6 offset:1856
    v_mfma_f32_16x16x32_bf16 v[40:43], v[132:135], a[80:83], v[40:43]
    ds_read_b128 v[148:151], v6 offset:1888
    v_mfma_f32_16x16x32_bf16 v[28:31], v[128:131], a[144:147], v[28:31]
    v_mfma_f32_16x16x32_bf16 v[44:47], v[132:135], a[144:147], v[44:47]
    s_waitcnt lgkmcnt(3)
    v_mfma_f32_16x16x32_bf16 v[20:23], v[136:139], a[12:15], v[20:23]
    s_waitcnt lgkmcnt(2)
    v_mfma_f32_16x16x32_bf16 v[36:39], v[140:143], a[12:15], v[36:39]
    v_mfma_f32_16x16x32_bf16 v[24:27], v[136:139], a[76:79], v[24:27]
    ds_read_b128 v[152:155], v6 offset:1920
    v_mfma_f32_16x16x32_bf16 v[40:43], v[140:143], a[76:79], v[40:43]
    ds_read_b128 v[156:159], v6 offset:1952
    v_mfma_f32_16x16x32_bf16 v[28:31], v[136:139], a[140:143], v[28:31]
    v_mfma_f32_16x16x32_bf16 v[44:47], v[140:143], a[140:143], v[44:47]
    s_waitcnt lgkmcnt(3)
    v_mfma_f32_16x16x32_bf16 v[20:23], v[144:147], a[8:11], v[20:23]
    s_waitcnt lgkmcnt(2)
    v_mfma_f32_16x16x32_bf16 v[36:39], v[148:151], a[8:11], v[36:39]
    v_mfma_f32_16x16x32_bf16 v[24:27], v[144:147], a[72:75], v[24:27]
    ds_read_b128 v[160:163], v6 offset:1984
    v_mfma_f32_16x16x32_bf16 v[40:43], v[148:151], a[72:75], v[40:43]
    ds_read_b128 v[164:167], v6 offset:2016
    v_mfma_f32_16x16x32_bf16 v[28:31], v[144:147], a[136:139], v[28:31]
    v_mfma_f32_16x16x32_bf16 v[44:47], v[148:151], a[136:139], v[44:47]
    s_waitcnt lgkmcnt(3)
    v_mfma_f32_16x16x32_bf16 v[20:23], v[152:155], a[4:7], v[20:23]
    s_waitcnt lgkmcnt(2)
    v_mfma_f32_16x16x32_bf16 v[36:39], v[156:159], a[4:7], v[36:39]
    v_mfma_f32_16x16x32_bf16 v[24:27], v[152:155], a[68:71], v[24:27]
    ds_read_b128 v[168:171], v6 offset:2048
    v_mfma_f32_16x16x32_bf16 v[40:43], v[156:159], a[68:71], v[40:43]
    ds_read_b128 v[172:175], v6 offset:2080
    v_mfma_f32_16x16x32_bf16 v[28:31], v[152:155], a[132:135], v[28:31]
    s_waitcnt vmcnt(18)
    v_mfma_f32_16x16x32_bf16 v[44:47], v[156:159], a[132:135], v[44:47]
    ds_write_b128 v5, v[188:191] offset:1024
    s_waitcnt lgkmcnt(4)
    v_mfma_f32_16x16x32_bf16 v[20:23], v[160:163], a[0:3], v[20:23]
    ds_read_b128 v[112:115], v6 offset:2112
    s_waitcnt lgkmcnt(4)
    v_mfma_f32_16x16x32_bf16 v[36:39], v[164:167], a[0:3], v[36:39]
    ds_read_b128 v[116:119], v6 offset:2144
    v_mfma_f32_16x16x32_bf16 v[24:27], v[160:163], a[64:67], v[24:27]
    ds_write_b128 v5, v[186:189] offset:17664
    v_mfma_f32_16x16x32_bf16 v[40:43], v[164:167], a[64:67], v[40:43]
    v_mov_b32 v208, v185
    v_mov_b32 v209, v186
    v_mfma_f32_16x16x32_bf16 v[28:31], v[160:163], a[128:131], v[28:31]
    ds_read_b128 v[120:123], v6 offset:2176
    v_mfma_f32_16x16x32_bf16 v[44:47], v[164:167], a[128:131], v[44:47]
    ds_read_b128 v[124:127], v6 offset:2208
    s_waitcnt lgkmcnt(7)
    v_mfma_f32_16x16x32_bf16 v[24:27], v[168:171], a[60:63], v[24:27]
    v_mov_b32 v210, v187
    v_mov_b32 v211, v188
    s_waitcnt lgkmcnt(6)
    v_mfma_f32_16x16x32_bf16 v[40:43], v[172:175], a[60:63], v[40:43]
    ds_write_b128 v5, v[208:211] offset:25984
    v_mfma_f32_16x16x32_bf16 v[28:31], v[168:171], a[124:127], v[28:31]
    ds_read_b128 v[128:131], v6 offset:2240
    v_mfma_f32_16x16x32_bf16 v[44:47], v[172:175], a[124:127], v[44:47]
    ds_read_b128 v[132:135], v6 offset:2272
    s_waitcnt lgkmcnt(7)
    v_mfma_f32_16x16x32_bf16 v[24:27], v[112:115], a[56:59], v[24:27]
    v_mov_b32 v212, v189
    v_mov_b32 v213, v190
    s_waitcnt lgkmcnt(6)
    v_mfma_f32_16x16x32_bf16 v[40:43], v[116:119], a[56:59], v[40:43]
    ds_write_b128 v5, v[210:213] offset:9344
    v_mfma_f32_16x16x32_bf16 v[28:31], v[112:115], a[120:123], v[28:31]
    ds_read_b128 v[136:139], v6 offset:2304
    v_mfma_f32_16x16x32_bf16 v[44:47], v[116:119], a[120:123], v[44:47]
    ds_read_b128 v[140:143], v6 offset:2336
    s_waitcnt lgkmcnt(7)
    v_mfma_f32_16x16x32_bf16 v[24:27], v[120:123], a[52:55], v[24:27]
    v_alignbit_b32 v214, v185, v184, 16
    v_alignbit_b32 v215, v186, v185, 16
    s_waitcnt lgkmcnt(6)
    v_mfma_f32_16x16x32_bf16 v[40:43], v[124:127], a[52:55], v[40:43]
    v_alignbit_b32 v216, v187, v186, 16
    v_alignbit_b32 v217, v188, v187, 16
    v_mfma_f32_16x16x32_bf16 v[28:31], v[120:123], a[116:119], v[28:31]
    ds_read_b128 v[144:147], v6 offset:2368
    v_mfma_f32_16x16x32_bf16 v[44:47], v[124:127], a[116:119], v[44:47]
    ds_read_b128 v[148:151], v6 offset:2400
    s_waitcnt lgkmcnt(6)
    v_mfma_f32_16x16x32_bf16 v[24:27], v[128:131], a[48:51], v[24:27]
    ds_write_b128 v5, v[214:217] offset:30144
    s_waitcnt lgkmcnt(6)
    v_mfma_f32_16x16x32_bf16 v[40:43], v[132:135], a[48:51], v[40:43]
    v_alignbit_b32 v218, v189, v188, 16
    v_alignbit_b32 v219, v190, v189, 16
    v_mfma_f32_16x16x32_bf16 v[28:31], v[128:131], a[112:115], v[28:31]
    ds_read_b128 v[152:155], v6 offset:2432
    v_mfma_f32_16x16x32_bf16 v[44:47], v[132:135], a[112:115], v[44:47]
    ds_read_b128 v[156:159], v6 offset:2464
    s_waitcnt lgkmcnt(6)
    v_mfma_f32_16x16x32_bf16 v[24:27], v[136:139], a[44:47], v[24:27]
    ds_write_b128 v5, v[216:219] offset:13504
    s_waitcnt lgkmcnt(6)
    v_mfma_f32_16x16x32_bf16 v[40:43], v[140:143], a[44:47], v[40:43]
    v_alignbit_b32 v220, v186, v185, 16
    v_alignbit_b32 v221, v187, v186, 16
    v_mfma_f32_16x16x32_bf16 v[28:31], v[136:139], a[108:111], v[28:31]
    ds_read_b128 v[160:163], v6 offset:2496
    v_mfma_f32_16x16x32_bf16 v[44:47], v[140:143], a[108:111], v[44:47]
    ds_read_b128 v[164:167], v6 offset:2528
    s_waitcnt lgkmcnt(7)
    v_mfma_f32_16x16x32_bf16 v[24:27], v[144:147], a[40:43], v[24:27]
    v_alignbit_b32 v222, v188, v187, 16
    v_alignbit_b32 v223, v189, v188, 16
    s_waitcnt lgkmcnt(6)
    v_mfma_f32_16x16x32_bf16 v[40:43], v[148:151], a[40:43], v[40:43]
    ds_write_b128 v5, v[220:223] offset:21824
    v_mfma_f32_16x16x32_bf16 v[28:31], v[144:147], a[104:107], v[28:31]
    ds_read_b128 v[168:171], v6 offset:2560
    v_mfma_f32_16x16x32_bf16 v[44:47], v[148:151], a[104:107], v[44:47]
    ds_read_b128 v[172:175], v6 offset:2592
    s_waitcnt lgkmcnt(7)
    v_mfma_f32_16x16x32_bf16 v[24:27], v[152:155], a[36:39], v[24:27]
    v_alignbit_b32 v224, v190, v189, 16
    v_alignbit_b32 v225, v191, v190, 16
    s_waitcnt lgkmcnt(6)
    v_mfma_f32_16x16x32_bf16 v[40:43], v[156:159], a[36:39], v[40:43]
    ds_write_b128 v5, v[222:225] offset:5184
    v_mfma_f32_16x16x32_bf16 v[28:31], v[152:155], a[100:103], v[28:31]
    ds_read_b128 v[112:115], v6 offset:2624
    v_mfma_f32_16x16x32_bf16 v[44:47], v[156:159], a[100:103], v[44:47]
    ds_read_b128 v[116:119], v6 offset:2656
    s_waitcnt lgkmcnt(7)
    v_mfma_f32_16x16x32_bf16 v[24:27], v[160:163], a[32:35], v[24:27]
    buffer_load_dwordx4 v[184:187], v4, s[28:31], s37 offen offset:1008
    s_waitcnt lgkmcnt(6)
    v_mfma_f32_16x16x32_bf16 v[40:43], v[164:167], a[32:35], v[40:43]
    buffer_load_dwordx4 v[188:191], v4, s[28:31], s37 offen offset:1024
    v_mfma_f32_16x16x32_bf16 v[28:31], v[160:163], a[96:99], v[28:31]
    ds_read_b128 v[120:123], v6 offset:2688
    v_mfma_f32_16x16x32_bf16 v[44:47], v[164:167], a[96:99], v[44:47]
    ds_read_b128 v[124:127], v6 offset:2720
    s_waitcnt lgkmcnt(6)
    v_mfma_f32_16x16x32_bf16 v[24:27], v[168:171], a[28:31], v[24:27]
    s_mov_b32 s36, s37
    s_add_u32 s39, s37, 125829120
    s_add_u32 s37, s37, 4096
    s_min_u32 s37, s37, s33

    s_pack_hh_b32_b16 s40, s64, s64
    v_and_b32 v236, s40, v8
    s_waitcnt lgkmcnt(5)
    v_mfma_f32_16x16x32_bf16 v[40:43], v[172:175], a[28:31], v[40:43]
    v_and_b32 v237, s40, v9
    v_and_b32 v238, s40, v10
    v_mfma_f32_16x16x32_bf16 v[28:31], v[168:171], a[92:95], v[28:31]
    ds_read_b128 v[128:131], v6 offset:2752
    v_mfma_f32_16x16x32_bf16 v[44:47], v[172:175], a[92:95], v[44:47]
    ds_read_b128 v[132:135], v6 offset:2784
    s_waitcnt lgkmcnt(5)
    v_mfma_f32_16x16x32_bf16 v[24:27], v[112:115], a[24:27], v[24:27]
    v_and_b32 v239, s40, v11
    v_and_b32 v240, s40, v12
    s_waitcnt lgkmcnt(4)
    v_mfma_f32_16x16x32_bf16 v[40:43], v[116:119], a[24:27], v[40:43]
    v_and_b32 v241, s40, v13
    v_and_b32 v242, s40, v14
    v_mfma_f32_16x16x32_bf16 v[28:31], v[112:115], a[88:91], v[28:31]
    ds_read_b128 v[136:139], v6 offset:2816
    v_mfma_f32_16x16x32_bf16 v[44:47], v[116:119], a[88:91], v[44:47]
    ds_read_b128 v[140:143], v6 offset:2848
    s_waitcnt lgkmcnt(5)
    v_mfma_f32_16x16x32_bf16 v[24:27], v[120:123], a[20:23], v[24:27]
    v_and_b32 v243, s40, v15
    s_waitcnt lgkmcnt(4)
    v_mfma_f32_16x16x32_bf16 v[40:43], v[124:127], a[20:23], v[40:43]
    v_mfma_f32_16x16x32_bf16 v[28:31], v[120:123], a[84:87], v[28:31]
    ds_read_b128 v[144:147], v6 offset:2880
    v_mfma_f32_16x16x32_bf16 v[44:47], v[124:127], a[84:87], v[44:47]
    ds_read_b128 v[148:151], v6 offset:2912
    s_waitcnt lgkmcnt(5)
    v_mfma_f32_16x16x32_bf16 v[24:27], v[128:131], a[16:19], v[24:27]
    s_waitcnt lgkmcnt(4)
    v_mfma_f32_16x16x32_bf16 v[40:43], v[132:135], a[16:19], v[40:43]
    v_mfma_f32_16x16x32_bf16 v[28:31], v[128:131], a[80:83], v[28:31]
    ds_read_b128 v[152:155], v6 offset:2944
    v_mfma_f32_16x16x32_bf16 v[44:47], v[132:135], a[80:83], v[44:47]
    ds_read_b128 v[156:159], v6 offset:2976
    s_waitcnt lgkmcnt(5)
    v_mfma_f32_16x16x32_bf16 v[24:27], v[136:139], a[12:15], v[24:27]
    s_waitcnt lgkmcnt(4)
    v_mfma_f32_16x16x32_bf16 v[40:43], v[140:143], a[12:15], v[40:43]
    v_mfma_f32_16x16x32_bf16 v[28:31], v[136:139], a[76:79], v[28:31]
    ds_read_b128 v[160:163], v6 offset:3008
    v_mfma_f32_16x16x32_bf16 v[44:47], v[140:143], a[76:79], v[44:47]
    ds_read_b128 v[164:167], v6 offset:3040
    s_waitcnt lgkmcnt(5)
    v_mfma_f32_16x16x32_bf16 v[24:27], v[144:147], a[8:11], v[24:27]
    s_waitcnt lgkmcnt(4)
    v_mfma_f32_16x16x32_bf16 v[40:43], v[148:151], a[8:11], v[40:43]
    v_mfma_f32_16x16x32_bf16 v[28:31], v[144:147], a[72:75], v[28:31]
    ds_read_b128 v[168:171], v6 offset:3072
    v_mfma_f32_16x16x32_bf16 v[44:47], v[148:151], a[72:75], v[44:47]
    ds_read_b128 v[172:175], v6 offset:3104
    s_waitcnt lgkmcnt(5)
    v_mfma_f32_16x16x32_bf16 v[24:27], v[152:155], a[4:7], v[24:27]
    ds_read_b128 v[112:115], v6 offset:3136
    s_waitcnt lgkmcnt(5)
    v_mfma_f32_16x16x32_bf16 v[40:43], v[156:159], a[4:7], v[40:43]
    ds_read_b128 v[116:119], v6 offset:3168
    v_mfma_f32_16x16x32_bf16 v[28:31], v[152:155], a[68:71], v[28:31]
    ds_read_b128 v[120:123], v6 offset:3200
    v_mfma_f32_16x16x32_bf16 v[44:47], v[156:159], a[68:71], v[44:47]
    ds_read_b128 v[124:127], v6 offset:3232
    s_waitcnt lgkmcnt(7)
    v_mfma_f32_16x16x32_bf16 v[24:27], v[160:163], a[0:3], v[24:27]
    ds_read_b128 v[128:131], v6 offset:3264
    s_waitcnt lgkmcnt(7)
    v_mfma_f32_16x16x32_bf16 v[40:43], v[164:167], a[0:3], v[40:43]
    ds_read_b128 v[132:135], v6 offset:3296
    v_mfma_f32_16x16x32_bf16 v[28:31], v[160:163], a[64:67], v[28:31]
    ds_read_b128 v[136:139], v6 offset:3328
    v_mfma_f32_16x16x32_bf16 v[44:47], v[164:167], a[64:67], v[44:47]
    ds_read_b128 v[140:143], v6 offset:3360
    s_waitcnt lgkmcnt(9)
    v_mfma_f32_16x16x32_bf16 v[28:31], v[168:171], a[60:63], v[28:31]
    ds_read_b128 v[144:147], v6 offset:3392
    s_waitcnt lgkmcnt(9)
    v_mfma_f32_16x16x32_bf16 v[44:47], v[172:175], a[60:63], v[44:47]
    ds_read_b128 v[148:151], v6 offset:3424
    s_waitcnt lgkmcnt(9)
    v_mfma_f32_16x16x32_bf16 v[28:31], v[112:115], a[56:59], v[28:31]
    ds_read_b128 v[152:155], v6 offset:3456
    s_waitcnt lgkmcnt(9)
    v_mfma_f32_16x16x32_bf16 v[44:47], v[116:119], a[56:59], v[44:47]
    ds_read_b128 v[156:159], v6 offset:3488
    s_waitcnt lgkmcnt(9)
    v_mfma_f32_16x16x32_bf16 v[28:31], v[120:123], a[52:55], v[28:31]
    ds_read_b128 v[160:163], v6 offset:3520
    s_waitcnt lgkmcnt(9)
    v_mfma_f32_16x16x32_bf16 v[44:47], v[124:127], a[52:55], v[44:47]
    ds_read_b128 v[164:167], v6 offset:3552
    s_waitcnt lgkmcnt(9)
    v_mfma_f32_16x16x32_bf16 v[28:31], v[128:131], a[48:51], v[28:31]
    ds_read_b128 v[168:171], v6 offset:3584
    s_waitcnt lgkmcnt(9)
    v_mfma_f32_16x16x32_bf16 v[44:47], v[132:135], a[48:51], v[44:47]
    ds_read_b128 v[172:175], v6 offset:3616
    s_waitcnt lgkmcnt(9)
    v_mfma_f32_16x16x32_bf16 v[28:31], v[136:139], a[44:47], v[28:31]
    ds_read_b128 v[112:115], v6 offset:3648
    s_waitcnt lgkmcnt(9)
    v_mfma_f32_16x16x32_bf16 v[44:47], v[140:143], a[44:47], v[44:47]
    ds_read_b128 v[116:119], v6 offset:3680
    s_waitcnt lgkmcnt(9)
    v_mfma_f32_16x16x32_bf16 v[28:31], v[144:147], a[40:43], v[28:31]
    ds_read_b128 v[120:123], v6 offset:3712
    s_waitcnt lgkmcnt(9)
    v_mfma_f32_16x16x32_bf16 v[44:47], v[148:151], a[40:43], v[44:47]
    ds_read_b128 v[124:127], v6 offset:3744
    s_waitcnt lgkmcnt(9)
    v_mfma_f32_16x16x32_bf16 v[28:31], v[152:155], a[36:39], v[28:31]
    ds_read_b128 v[128:131], v6 offset:3776
    s_waitcnt lgkmcnt(9)
    v_mfma_f32_16x16x32_bf16 v[44:47], v[156:159], a[36:39], v[44:47]
    ds_read_b128 v[132:135], v6 offset:3808
    s_waitcnt lgkmcnt(9)
    v_mfma_f32_16x16x32_bf16 v[28:31], v[160:163], a[32:35], v[28:31]
    ds_read_b128 v[136:139], v6 offset:3840
    s_waitcnt lgkmcnt(9)
    v_mfma_f32_16x16x32_bf16 v[44:47], v[164:167], a[32:35], v[44:47]
    ds_read_b128 v[140:143], v6 offset:3872
    s_waitcnt lgkmcnt(9)
    v_mfma_f32_16x16x32_bf16 v[28:31], v[168:171], a[28:31], v[28:31]
    ds_read_b128 v[144:147], v6 offset:3904
    s_waitcnt lgkmcnt(9)
    v_mfma_f32_16x16x32_bf16 v[44:47], v[172:175], a[28:31], v[44:47]
    ds_read_b128 v[148:151], v6 offset:3936
    s_waitcnt lgkmcnt(9)
    v_mfma_f32_16x16x32_bf16 v[28:31], v[112:115], a[24:27], v[28:31]
    ds_read_b128 v[152:155], v6 offset:3968
    s_waitcnt lgkmcnt(9)
    v_mfma_f32_16x16x32_bf16 v[44:47], v[116:119], a[24:27], v[44:47]
    ds_read_b128 v[156:159], v6 offset:4000
    s_waitcnt lgkmcnt(9)
    v_mfma_f32_16x16x32_bf16 v[28:31], v[120:123], a[20:23], v[28:31]
    ds_read_b128 v[160:163], v6 offset:4032
    s_waitcnt lgkmcnt(9)
    v_mfma_f32_16x16x32_bf16 v[44:47], v[124:127], a[20:23], v[44:47]
    ds_read_b128 v[164:167], v6 offset:4064
    s_waitcnt lgkmcnt(9)
    v_mfma_f32_16x16x32_bf16 v[28:31], v[128:131], a[16:19], v[28:31]
    s_waitcnt vmcnt(2)
    ds_read_b128 a[60:63], v7 offset:240
    s_waitcnt lgkmcnt(9)
    v_mfma_f32_16x16x32_bf16 v[44:47], v[132:135], a[16:19], v[44:47]
    s_waitcnt lgkmcnt(8)
    v_mfma_f32_16x16x32_bf16 v[28:31], v[136:139], a[12:15], v[28:31]
    ds_read_b128 a[124:127], v7 offset:496
    s_waitcnt lgkmcnt(8)
    v_mfma_f32_16x16x32_bf16 v[44:47], v[140:143], a[12:15], v[44:47]
    s_waitcnt lgkmcnt(7)
    v_mfma_f32_16x16x32_bf16 v[28:31], v[144:147], a[8:11], v[28:31]
    ds_read_b128 a[188:191], v7 offset:752
    s_waitcnt lgkmcnt(7)
    v_mfma_f32_16x16x32_bf16 v[44:47], v[148:151], a[8:11], v[44:47]
    s_waitcnt lgkmcnt(6)
    v_mfma_f32_16x16x32_bf16 v[28:31], v[152:155], a[4:7], v[28:31]
    ds_read_b128 a[252:255], v7 offset:1008
    s_waitcnt lgkmcnt(6)
    v_mfma_f32_16x16x32_bf16 v[44:47], v[156:159], a[4:7], v[44:47]
    s_waitcnt lgkmcnt(5)
    v_mfma_f32_16x16x32_bf16 v[28:31], v[160:163], a[0:3], v[28:31]
    ds_read_b128 v[168:171], v6 offset:0
    s_waitcnt lgkmcnt(5)
    v_mfma_f32_16x16x32_bf16 v[44:47], v[164:167], a[0:3], v[44:47]
    ds_read_b128 v[172:175], v6 offset:32
    s_waitcnt lgkmcnt(5)
    v_mfma_f32_16x16x32_bf16 v[48:51], v[236:239], a[60:63], 0
    v_mfma_f32_16x16x32_bf16 v[64:67], v[240:243], a[60:63], 0
    s_waitcnt lgkmcnt(4)
    v_mfma_f32_16x16x32_bf16 v[52:55], v[236:239], a[124:127], 0
    v_mfma_f32_16x16x32_bf16 v[68:71], v[240:243], a[124:127], 0
    s_waitcnt lgkmcnt(3)
    v_mfma_f32_16x16x32_bf16 v[56:59], v[236:239], a[188:191], 0
    v_mfma_f32_16x16x32_bf16 v[72:75], v[240:243], a[188:191], 0
    ds_read_b128 a[56:59], v7 offset:224
    s_waitcnt lgkmcnt(3)
    v_mfma_f32_16x16x32_bf16 v[60:63], v[236:239], a[252:255], 0
    ds_read_b128 v[112:115], v6 offset:64
    v_mfma_f32_16x16x32_bf16 v[76:79], v[240:243], a[252:255], 0
    ds_read_b128 v[116:119], v6 offset:96
    s_waitcnt lgkmcnt(4)
    v_mfma_f32_16x16x32_bf16 v[48:51], v[168:171], a[60:63], v[48:51]
    ds_read_b128 a[120:123], v7 offset:480
    s_waitcnt lgkmcnt(4)
    v_mfma_f32_16x16x32_bf16 v[64:67], v[172:175], a[60:63], v[64:67]
    s_waitcnt vmcnt(10)
    v_mfma_f32_16x16x32_bf16 v[52:55], v[168:171], a[124:127], v[52:55]
    ds_read_b128 a[184:187], v7 offset:736
    v_mfma_f32_16x16x32_bf16 v[68:71], v[172:175], a[124:127], v[68:71]
    ds_write_b128 v5, v[196:199] offset:2048
    v_mfma_f32_16x16x32_bf16 v[56:59], v[168:171], a[188:191], v[56:59]
    ds_read_b128 a[248:251], v7 offset:992
    v_mfma_f32_16x16x32_bf16 v[72:75], v[172:175], a[188:191], v[72:75]
    ds_read_b128 a[52:55], v7 offset:208
    v_mfma_f32_16x16x32_bf16 v[60:63], v[168:171], a[252:255], v[60:63]
    ds_read_b128 v[120:123], v6 offset:128
    v_mfma_f32_16x16x32_bf16 v[76:79], v[172:175], a[252:255], v[76:79]
    ds_read_b128 v[124:127], v6 offset:160
    s_waitcnt lgkmcnt(8)
    v_mfma_f32_16x16x32_bf16 v[48:51], v[112:115], a[56:59], v[48:51]
    ds_read_b128 a[116:119], v7 offset:464
    s_waitcnt lgkmcnt(8)
    v_mfma_f32_16x16x32_bf16 v[64:67], v[116:119], a[56:59], v[64:67]
    ds_write_b128 v5, v[194:197] offset:18688
    s_waitcnt lgkmcnt(8)
    v_mfma_f32_16x16x32_bf16 v[52:55], v[112:115], a[120:123], v[52:55]
    ds_read_b128 a[180:183], v7 offset:720
    v_mfma_f32_16x16x32_bf16 v[68:71], v[116:119], a[120:123], v[68:71]
    v_mov_b32 v208, v193
    v_mov_b32 v209, v194
    s_waitcnt lgkmcnt(8)
    v_mfma_f32_16x16x32_bf16 v[56:59], v[112:115], a[184:187], v[56:59]
    ds_read_b128 a[244:247], v7 offset:976
    v_mfma_f32_16x16x32_bf16 v[72:75], v[116:119], a[184:187], v[72:75]
    ds_read_b128 a[48:51], v7 offset:192
    s_waitcnt lgkmcnt(8)
    v_mfma_f32_16x16x32_bf16 v[60:63], v[112:115], a[248:251], v[60:63]
    ds_read_b128 v[128:131], v6 offset:192
    v_mfma_f32_16x16x32_bf16 v[76:79], v[116:119], a[248:251], v[76:79]
    ds_read_b128 v[132:135], v6 offset:224
    s_waitcnt lgkmcnt(8)
    v_mfma_f32_16x16x32_bf16 v[48:51], v[120:123], a[52:55], v[48:51]
    ds_read_b128 a[112:115], v7 offset:448
    s_waitcnt lgkmcnt(8)
    v_mfma_f32_16x16x32_bf16 v[64:67], v[124:127], a[52:55], v[64:67]
    v_mov_b32 v210, v195
    v_mov_b32 v211, v196
    s_waitcnt lgkmcnt(7)
    v_mfma_f32_16x16x32_bf16 v[52:55], v[120:123], a[116:119], v[52:55]
    ds_read_b128 a[176:179], v7 offset:704
    v_mfma_f32_16x16x32_bf16 v[68:71], v[124:127], a[116:119], v[68:71]
    ds_write_b128 v5, v[208:211] offset:27008
    s_waitcnt lgkmcnt(7)
    v_mfma_f32_16x16x32_bf16 v[56:59], v[120:123], a[180:183], v[56:59]
    ds_read_b128 a[240:243], v7 offset:960
    v_mfma_f32_16x16x32_bf16 v[72:75], v[124:127], a[180:183], v[72:75]
    ds_read_b128 a[44:47], v7 offset:176
    s_waitcnt lgkmcnt(8)
    v_mfma_f32_16x16x32_bf16 v[60:63], v[120:123], a[244:247], v[60:63]
    ds_read_b128 v[136:139], v6 offset:256
    v_mfma_f32_16x16x32_bf16 v[76:79], v[124:127], a[244:247], v[76:79]
    ds_read_b128 v[140:143], v6 offset:288
    s_waitcnt lgkmcnt(8)
    v_mfma_f32_16x16x32_bf16 v[48:51], v[128:131], a[48:51], v[48:51]
    ds_read_b128 a[108:111], v7 offset:432
    s_waitcnt lgkmcnt(8)
    v_mfma_f32_16x16x32_bf16 v[64:67], v[132:135], a[48:51], v[64:67]
    v_mov_b32 v212, v197
    v_mov_b32 v213, v198
    s_waitcnt lgkmcnt(7)
    v_mfma_f32_16x16x32_bf16 v[52:55], v[128:131], a[112:115], v[52:55]
    ds_read_b128 a[172:175], v7 offset:688
    v_mfma_f32_16x16x32_bf16 v[68:71], v[132:135], a[112:115], v[68:71]
    ds_write_b128 v5, v[210:213] offset:10368
    s_waitcnt lgkmcnt(8)
    v_mfma_f32_16x16x32_bf16 v[56:59], v[128:131], a[176:179], v[56:59]
    ds_read_b128 a[236:239], v7 offset:944
    v_mfma_f32_16x16x32_bf16 v[72:75], v[132:135], a[176:179], v[72:75]
    ds_read_b128 a[40:43], v7 offset:160
    s_waitcnt lgkmcnt(8)
    v_mfma_f32_16x16x32_bf16 v[60:63], v[128:131], a[240:243], v[60:63]
    ds_read_b128 v[144:147], v6 offset:320
    v_mfma_f32_16x16x32_bf16 v[76:79], v[132:135], a[240:243], v[76:79]
    ds_read_b128 v[148:151], v6 offset:352
    s_waitcnt lgkmcnt(8)
    v_mfma_f32_16x16x32_bf16 v[48:51], v[136:139], a[44:47], v[48:51]
    ds_read_b128 a[104:107], v7 offset:416
    s_waitcnt lgkmcnt(8)
    v_mfma_f32_16x16x32_bf16 v[64:67], v[140:143], a[44:47], v[64:67]
    v_alignbit_b32 v214, v193, v192, 16
    v_alignbit_b32 v215, v194, v193, 16
    s_waitcnt lgkmcnt(7)
    v_mfma_f32_16x16x32_bf16 v[52:55], v[136:139], a[108:111], v[52:55]
    ds_read_b128 a[168:171], v7 offset:672
    v_mfma_f32_16x16x32_bf16 v[68:71], v[140:143], a[108:111], v[68:71]
    v_alignbit_b32 v216, v195, v194, 16
    v_alignbit_b32 v217, v196, v195, 16
    s_waitcnt lgkmcnt(7)
    v_mfma_f32_16x16x32_bf16 v[56:59], v[136:139], a[172:175], v[56:59]
    ds_read_b128 a[232:235], v7 offset:928
    v_mfma_f32_16x16x32_bf16 v[72:75], v[140:143], a[172:175], v[72:75]
    ds_read_b128 a[36:39], v7 offset:144
    s_waitcnt lgkmcnt(7)
    v_mfma_f32_16x16x32_bf16 v[60:63], v[136:139], a[236:239], v[60:63]
    ds_read_b128 v[152:155], v6 offset:384
    v_mfma_f32_16x16x32_bf16 v[76:79], v[140:143], a[236:239], v[76:79]
    ds_read_b128 v[156:159], v6 offset:416
    s_waitcnt lgkmcnt(7)
    v_mfma_f32_16x16x32_bf16 v[48:51], v[144:147], a[40:43], v[48:51]
    ds_read_b128 a[100:103], v7 offset:400
    s_waitcnt lgkmcnt(7)
    v_mfma_f32_16x16x32_bf16 v[64:67], v[148:151], a[40:43], v[64:67]
    ds_write_b128 v5, v[214:217] offset:31168
    s_waitcnt lgkmcnt(7)
    v_mfma_f32_16x16x32_bf16 v[52:55], v[144:147], a[104:107], v[52:55]
    ds_read_b128 a[164:167], v7 offset:656
    v_mfma_f32_16x16x32_bf16 v[68:71], v[148:151], a[104:107], v[68:71]
    v_alignbit_b32 v218, v197, v196, 16
    v_alignbit_b32 v219, v198, v197, 16
    s_waitcnt lgkmcnt(7)
    v_mfma_f32_16x16x32_bf16 v[56:59], v[144:147], a[168:171], v[56:59]
    ds_read_b128 a[228:231], v7 offset:912
    v_mfma_f32_16x16x32_bf16 v[72:75], v[148:151], a[168:171], v[72:75]
    ds_read_b128 a[32:35], v7 offset:128
    s_waitcnt lgkmcnt(8)
    v_mfma_f32_16x16x32_bf16 v[60:63], v[144:147], a[232:235], v[60:63]
    ds_read_b128 v[160:163], v6 offset:448
    v_mfma_f32_16x16x32_bf16 v[76:79], v[148:151], a[232:235], v[76:79]
    ds_read_b128 v[164:167], v6 offset:480
    s_waitcnt lgkmcnt(8)
    v_mfma_f32_16x16x32_bf16 v[48:51], v[152:155], a[36:39], v[48:51]
    ds_read_b128 a[96:99], v7 offset:384
    s_waitcnt lgkmcnt(8)
    v_mfma_f32_16x16x32_bf16 v[64:67], v[156:159], a[36:39], v[64:67]
    ds_write_b128 v5, v[216:219] offset:14528
    s_waitcnt lgkmcnt(8)
    v_mfma_f32_16x16x32_bf16 v[52:55], v[152:155], a[100:103], v[52:55]
    ds_read_b128 a[160:163], v7 offset:640
    v_mfma_f32_16x16x32_bf16 v[68:71], v[156:159], a[100:103], v[68:71]
    v_alignbit_b32 v220, v194, v193, 16
    v_alignbit_b32 v221, v195, v194, 16
    s_waitcnt lgkmcnt(7)
    v_mfma_f32_16x16x32_bf16 v[56:59], v[152:155], a[164:167], v[56:59]
    ds_read_b128 a[224:227], v7 offset:896
    v_mfma_f32_16x16x32_bf16 v[72:75], v[156:159], a[164:167], v[72:75]
    ds_read_b128 a[28:31], v7 offset:112
    s_waitcnt lgkmcnt(8)
    v_mfma_f32_16x16x32_bf16 v[60:63], v[152:155], a[228:231], v[60:63]
    ds_read_b128 v[168:171], v6 offset:512
    v_mfma_f32_16x16x32_bf16 v[76:79], v[156:159], a[228:231], v[76:79]
    ds_read_b128 v[172:175], v6 offset:544
    s_waitcnt lgkmcnt(8)
    v_mfma_f32_16x16x32_bf16 v[48:51], v[160:163], a[32:35], v[48:51]
    ds_read_b128 a[92:95], v7 offset:368
    s_waitcnt lgkmcnt(8)
    v_mfma_f32_16x16x32_bf16 v[64:67], v[164:167], a[32:35], v[64:67]
    v_alignbit_b32 v222, v196, v195, 16
    v_alignbit_b32 v223, v197, v196, 16
    s_waitcnt lgkmcnt(7)
    v_mfma_f32_16x16x32_bf16 v[52:55], v[160:163], a[96:99], v[52:55]
    ds_read_b128 a[156:159], v7 offset:624
    v_mfma_f32_16x16x32_bf16 v[68:71], v[164:167], a[96:99], v[68:71]
    ds_write_b128 v5, v[220:223] offset:22848
    s_waitcnt lgkmcnt(7)
    v_mfma_f32_16x16x32_bf16 v[56:59], v[160:163], a[160:163], v[56:59]
    ds_read_b128 a[220:223], v7 offset:880
    v_mfma_f32_16x16x32_bf16 v[72:75], v[164:167], a[160:163], v[72:75]
    ds_read_b128 a[24:27], v7 offset:96
    s_waitcnt lgkmcnt(8)
    v_mfma_f32_16x16x32_bf16 v[60:63], v[160:163], a[224:227], v[60:63]
    ds_read_b128 v[112:115], v6 offset:576
    v_mfma_f32_16x16x32_bf16 v[76:79], v[164:167], a[224:227], v[76:79]
    ds_read_b128 v[116:119], v6 offset:608
    s_waitcnt lgkmcnt(8)
    v_mfma_f32_16x16x32_bf16 v[48:51], v[168:171], a[28:31], v[48:51]
    ds_read_b128 a[88:91], v7 offset:352
    s_waitcnt lgkmcnt(8)
    v_mfma_f32_16x16x32_bf16 v[64:67], v[172:175], a[28:31], v[64:67]
    v_alignbit_b32 v224, v198, v197, 16
    v_alignbit_b32 v225, v199, v198, 16
    s_waitcnt lgkmcnt(7)
    v_mfma_f32_16x16x32_bf16 v[52:55], v[168:171], a[92:95], v[52:55]
    ds_read_b128 a[152:155], v7 offset:608
    v_mfma_f32_16x16x32_bf16 v[68:71], v[172:175], a[92:95], v[68:71]
    ds_write_b128 v5, v[222:225] offset:6208
    s_waitcnt lgkmcnt(8)
    v_mfma_f32_16x16x32_bf16 v[56:59], v[168:171], a[156:159], v[56:59]
    ds_read_b128 a[216:219], v7 offset:864
    v_mfma_f32_16x16x32_bf16 v[72:75], v[172:175], a[156:159], v[72:75]
    ds_read_b128 a[20:23], v7 offset:80
    s_waitcnt lgkmcnt(8)
    v_mfma_f32_16x16x32_bf16 v[60:63], v[168:171], a[220:223], v[60:63]
    ds_read_b128 v[120:123], v6 offset:640
    v_mfma_f32_16x16x32_bf16 v[76:79], v[172:175], a[220:223], v[76:79]
    ds_read_b128 v[124:127], v6 offset:672
    s_waitcnt lgkmcnt(8)
    v_mfma_f32_16x16x32_bf16 v[48:51], v[112:115], a[24:27], v[48:51]
    ds_read_b128 a[84:87], v7 offset:336
    s_waitcnt lgkmcnt(8)
    v_mfma_f32_16x16x32_bf16 v[64:67], v[116:119], a[24:27], v[64:67]
    buffer_load_dwordx4 v[192:195], v4, s[28:31], s36 offen offset:2032
    s_waitcnt lgkmcnt(7)
    v_mfma_f32_16x16x32_bf16 v[52:55], v[112:115], a[88:91], v[52:55]
    ds_read_b128 a[148:151], v7 offset:592
    v_mfma_f32_16x16x32_bf16 v[68:71], v[116:119], a[88:91], v[68:71]
    buffer_load_dwordx4 v[196:199], v4, s[28:31], s36 offen offset:2048
    s_waitcnt lgkmcnt(7)
    v_mfma_f32_16x16x32_bf16 v[56:59], v[112:115], a[152:155], v[56:59]
    ds_read_b128 a[212:215], v7 offset:848
    v_mfma_f32_16x16x32_bf16 v[72:75], v[116:119], a[152:155], v[72:75]
    ds_read_b128 a[16:19], v7 offset:64
    s_waitcnt lgkmcnt(7)
    v_mfma_f32_16x16x32_bf16 v[60:63], v[112:115], a[216:219], v[60:63]
    ds_read_b128 v[128:131], v6 offset:704
    v_mfma_f32_16x16x32_bf16 v[76:79], v[116:119], a[216:219], v[76:79]
    ds_read_b128 v[132:135], v6 offset:736
    s_waitcnt lgkmcnt(7)
    v_mfma_f32_16x16x32_bf16 v[48:51], v[120:123], a[20:23], v[48:51]
    ds_read_b128 a[80:83], v7 offset:320
    s_waitcnt lgkmcnt(7)
    v_mfma_f32_16x16x32_bf16 v[64:67], v[124:127], a[20:23], v[64:67]
    s_waitcnt vmcnt(10)
    s_waitcnt lgkmcnt(6)
    v_mfma_f32_16x16x32_bf16 v[52:55], v[120:123], a[84:87], v[52:55]
    ds_read_b128 a[144:147], v7 offset:576
    v_mfma_f32_16x16x32_bf16 v[68:71], v[124:127], a[84:87], v[68:71]
    ds_write_b128 v5, v[204:207] offset:3072
    s_waitcnt lgkmcnt(7)
    v_mfma_f32_16x16x32_bf16 v[56:59], v[120:123], a[148:151], v[56:59]
    ds_read_b128 a[208:211], v7 offset:832
    v_mfma_f32_16x16x32_bf16 v[72:75], v[124:127], a[148:151], v[72:75]
    ds_read_b128 a[12:15], v7 offset:48
    s_waitcnt lgkmcnt(8)
    v_mfma_f32_16x16x32_bf16 v[60:63], v[120:123], a[212:215], v[60:63]
    ds_read_b128 v[136:139], v6 offset:768
    v_mfma_f32_16x16x32_bf16 v[76:79], v[124:127], a[212:215], v[76:79]
    ds_read_b128 v[140:143], v6 offset:800
    s_waitcnt lgkmcnt(8)
    v_mfma_f32_16x16x32_bf16 v[48:51], v[128:131], a[16:19], v[48:51]
    ds_read_b128 a[76:79], v7 offset:304
    s_waitcnt lgkmcnt(8)
    v_mfma_f32_16x16x32_bf16 v[64:67], v[132:135], a[16:19], v[64:67]
    ds_write_b128 v5, v[202:205] offset:19712
    s_waitcnt lgkmcnt(8)
    v_mfma_f32_16x16x32_bf16 v[52:55], v[128:131], a[80:83], v[52:55]
    ds_read_b128 a[140:143], v7 offset:560
    v_mfma_f32_16x16x32_bf16 v[68:71], v[132:135], a[80:83], v[68:71]
    v_mov_b32 v208, v201
    v_mov_b32 v209, v202
    s_waitcnt lgkmcnt(8)
    v_mfma_f32_16x16x32_bf16 v[56:59], v[128:131], a[144:147], v[56:59]
    ds_read_b128 a[204:207], v7 offset:816
    v_mfma_f32_16x16x32_bf16 v[72:75], v[132:135], a[144:147], v[72:75]
    ds_read_b128 a[8:11], v7 offset:32
    s_waitcnt lgkmcnt(8)
    v_mfma_f32_16x16x32_bf16 v[60:63], v[128:131], a[208:211], v[60:63]
    ds_read_b128 v[144:147], v6 offset:832
    v_mfma_f32_16x16x32_bf16 v[76:79], v[132:135], a[208:211], v[76:79]
    ds_read_b128 v[148:151], v6 offset:864
    s_waitcnt lgkmcnt(8)
    v_mfma_f32_16x16x32_bf16 v[48:51], v[136:139], a[12:15], v[48:51]
    ds_read_b128 a[72:75], v7 offset:288
    s_waitcnt lgkmcnt(8)
    v_mfma_f32_16x16x32_bf16 v[64:67], v[140:143], a[12:15], v[64:67]
    v_mov_b32 v210, v203
    v_mov_b32 v211, v204
    s_waitcnt lgkmcnt(7)
    v_mfma_f32_16x16x32_bf16 v[52:55], v[136:139], a[76:79], v[52:55]
    ds_read_b128 a[136:139], v7 offset:544
    v_mfma_f32_16x16x32_bf16 v[68:71], v[140:143], a[76:79], v[68:71]
    ds_write_b128 v5, v[208:211] offset:28032
    s_waitcnt lgkmcnt(7)
    v_mfma_f32_16x16x32_bf16 v[56:59], v[136:139], a[140:143], v[56:59]
    ds_read_b128 a[200:203], v7 offset:800
    v_mfma_f32_16x16x32_bf16 v[72:75], v[140:143], a[140:143], v[72:75]
    ds_read_b128 a[4:7], v7 offset:16
    s_waitcnt lgkmcnt(8)
    v_mfma_f32_16x16x32_bf16 v[60:63], v[136:139], a[204:207], v[60:63]
    ds_read_b128 v[152:155], v6 offset:896
    v_mfma_f32_16x16x32_bf16 v[76:79], v[140:143], a[204:207], v[76:79]
    ds_read_b128 v[156:159], v6 offset:928
    s_waitcnt lgkmcnt(8)
    v_mfma_f32_16x16x32_bf16 v[48:51], v[144:147], a[8:11], v[48:51]
    ds_read_b128 a[68:71], v7 offset:272
    s_waitcnt lgkmcnt(8)
    v_mfma_f32_16x16x32_bf16 v[64:67], v[148:151], a[8:11], v[64:67]
    v_mov_b32 v212, v205
    v_mov_b32 v213, v206
    s_waitcnt lgkmcnt(7)
    v_mfma_f32_16x16x32_bf16 v[52:55], v[144:147], a[72:75], v[52:55]
    ds_read_b128 a[132:135], v7 offset:528
    v_mfma_f32_16x16x32_bf16 v[68:71], v[148:151], a[72:75], v[68:71]
    ds_write_b128 v5, v[210:213] offset:11392
    s_waitcnt lgkmcnt(8)
    v_mfma_f32_16x16x32_bf16 v[56:59], v[144:147], a[136:139], v[56:59]
    ds_read_b128 a[196:199], v7 offset:784
    v_mfma_f32_16x16x32_bf16 v[72:75], v[148:151], a[136:139], v[72:75]
    ds_read_b128 a[0:3], v7 offset:0
    s_waitcnt lgkmcnt(8)
    v_mfma_f32_16x16x32_bf16 v[60:63], v[144:147], a[200:203], v[60:63]
    ds_read_b128 v[160:163], v6 offset:960
    v_mfma_f32_16x16x32_bf16 v[76:79], v[148:151], a[200:203], v[76:79]
    ds_read_b128 v[164:167], v6 offset:992
    s_waitcnt lgkmcnt(8)
    v_mfma_f32_16x16x32_bf16 v[48:51], v[152:155], a[4:7], v[48:51]
    ds_read_b128 a[64:67], v7 offset:256
    s_waitcnt lgkmcnt(8)
    v_mfma_f32_16x16x32_bf16 v[64:67], v[156:159], a[4:7], v[64:67]
    v_alignbit_b32 v214, v201, v200, 16
    v_alignbit_b32 v215, v202, v201, 16
    s_waitcnt lgkmcnt(7)
    v_mfma_f32_16x16x32_bf16 v[52:55], v[152:155], a[68:71], v[52:55]
    ds_read_b128 a[128:131], v7 offset:512
    v_mfma_f32_16x16x32_bf16 v[68:71], v[156:159], a[68:71], v[68:71]
    v_alignbit_b32 v216, v203, v202, 16
    v_alignbit_b32 v217, v204, v203, 16
    s_waitcnt lgkmcnt(7)
    v_mfma_f32_16x16x32_bf16 v[56:59], v[152:155], a[132:135], v[56:59]
    ds_read_b128 a[192:195], v7 offset:768
    v_mfma_f32_16x16x32_bf16 v[72:75], v[156:159], a[132:135], v[72:75]
    ds_write_b128 v5, v[214:217] offset:32192
    s_waitcnt lgkmcnt(7)
    v_mfma_f32_16x16x32_bf16 v[60:63], v[152:155], a[196:199], v[60:63]
    ds_read_b128 v[168:171], v6 offset:1024
    v_mfma_f32_16x16x32_bf16 v[76:79], v[156:159], a[196:199], v[76:79]
    ds_read_b128 v[172:175], v6 offset:1056
    s_waitcnt lgkmcnt(7)
    v_mfma_f32_16x16x32_bf16 v[48:51], v[160:163], a[0:3], v[48:51]
    v_alignbit_b32 v218, v205, v204, 16
    v_alignbit_b32 v219, v206, v205, 16
    s_waitcnt lgkmcnt(6)
    v_mfma_f32_16x16x32_bf16 v[64:67], v[164:167], a[0:3], v[64:67]
    ds_write_b128 v5, v[216:219] offset:15552
    s_waitcnt lgkmcnt(6)
    v_mfma_f32_16x16x32_bf16 v[52:55], v[160:163], a[64:67], v[52:55]
    v_alignbit_b32 v220, v202, v201, 16
    v_alignbit_b32 v221, v203, v202, 16
    v_mfma_f32_16x16x32_bf16 v[68:71], v[164:167], a[64:67], v[68:71]
    v_alignbit_b32 v222, v204, v203, 16
    v_alignbit_b32 v223, v205, v204, 16
    s_waitcnt lgkmcnt(5)
    v_mfma_f32_16x16x32_bf16 v[56:59], v[160:163], a[128:131], v[56:59]
    ds_read_b128 v[112:115], v6 offset:1088
    v_mfma_f32_16x16x32_bf16 v[72:75], v[164:167], a[128:131], v[72:75]
    ds_read_b128 v[116:119], v6 offset:1120
    s_waitcnt lgkmcnt(6)
    v_mfma_f32_16x16x32_bf16 v[60:63], v[160:163], a[192:195], v[60:63]
    ds_write_b128 v5, v[220:223] offset:23872
    v_mfma_f32_16x16x32_bf16 v[76:79], v[164:167], a[192:195], v[76:79]
    v_alignbit_b32 v224, v206, v205, 16
    v_alignbit_b32 v225, v207, v206, 16
    s_waitcnt lgkmcnt(5)
    v_mfma_f32_16x16x32_bf16 v[52:55], v[168:171], a[60:63], v[52:55]
    ds_write_b128 v5, v[222:225] offset:7232
    s_waitcnt lgkmcnt(5)
    v_mfma_f32_16x16x32_bf16 v[68:71], v[172:175], a[60:63], v[68:71]
    buffer_load_dwordx4 v[200:203], v4, s[28:31], s36 offen offset:3056
    v_mfma_f32_16x16x32_bf16 v[56:59], v[168:171], a[124:127], v[56:59]
    ds_read_b128 v[120:123], v6 offset:1152
    v_mfma_f32_16x16x32_bf16 v[72:75], v[172:175], a[124:127], v[72:75]
    ds_read_b128 v[124:127], v6 offset:1184
    v_mfma_f32_16x16x32_bf16 v[60:63], v[168:171], a[188:191], v[60:63]
    buffer_load_dwordx4 v[204:207], v4, s[28:31], s36 offen offset:3072
    v_mfma_f32_16x16x32_bf16 v[76:79], v[172:175], a[188:191], v[76:79]
    s_waitcnt vmcnt(10)
    s_mov_b64 exec, 1
    v_mov_b32 v176, 0
    v_mov_b32 v177, 0
    v_mov_b32 v178, 0
    v_mov_b32 v179, 0
    s_mov_b64 exec, -1
    s_waitcnt lgkmcnt(5)
    v_mfma_f32_16x16x32_bf16 v[52:55], v[112:115], a[56:59], v[52:55]
    ds_write_b128 v5, v[180:183] offset:0
    s_waitcnt lgkmcnt(5)
    v_mfma_f32_16x16x32_bf16 v[68:71], v[116:119], a[56:59], v[68:71]
    ds_write_b128 v5, v[178:181] offset:16640
    v_mfma_f32_16x16x32_bf16 v[56:59], v[112:115], a[120:123], v[56:59]
    ds_read_b128 v[128:131], v6 offset:1216
    v_mfma_f32_16x16x32_bf16 v[72:75], v[116:119], a[120:123], v[72:75]
    ds_read_b128 v[132:135], v6 offset:1248
    v_mfma_f32_16x16x32_bf16 v[60:63], v[112:115], a[184:187], v[60:63]
    v_mov_b32 v208, v177
    v_mov_b32 v209, v178
    v_mfma_f32_16x16x32_bf16 v[76:79], v[116:119], a[184:187], v[76:79]
    v_mov_b32 v210, v179
    v_mov_b32 v211, v180
    s_waitcnt lgkmcnt(5)
    v_mfma_f32_16x16x32_bf16 v[52:55], v[120:123], a[52:55], v[52:55]
    ds_write_b128 v5, v[208:211] offset:24960
    s_waitcnt lgkmcnt(5)
    v_mfma_f32_16x16x32_bf16 v[68:71], v[124:127], a[52:55], v[68:71]
    v_mov_b32 v212, v181
    v_mov_b32 v213, v182
    v_mfma_f32_16x16x32_bf16 v[56:59], v[120:123], a[116:119], v[56:59]
    ds_read_b128 v[136:139], v6 offset:1280
    v_mfma_f32_16x16x32_bf16 v[72:75], v[124:127], a[116:119], v[72:75]
    ds_read_b128 v[140:143], v6 offset:1312
    v_mfma_f32_16x16x32_bf16 v[60:63], v[120:123], a[180:183], v[60:63]
    ds_write_b128 v5, v[210:213] offset:8320
    v_mfma_f32_16x16x32_bf16 v[76:79], v[124:127], a[180:183], v[76:79]
    v_alignbit_b32 v214, v177, v176, 16
    v_alignbit_b32 v215, v178, v177, 16
    s_waitcnt lgkmcnt(5)
    v_mfma_f32_16x16x32_bf16 v[52:55], v[128:131], a[48:51], v[52:55]
    v_alignbit_b32 v216, v179, v178, 16
    v_alignbit_b32 v217, v180, v179, 16
    s_waitcnt lgkmcnt(4)
    v_mfma_f32_16x16x32_bf16 v[68:71], v[132:135], a[48:51], v[68:71]
    ds_write_b128 v5, v[214:217] offset:29120
    v_mfma_f32_16x16x32_bf16 v[56:59], v[128:131], a[112:115], v[56:59]
    ds_read_b128 v[144:147], v6 offset:1344
    v_mfma_f32_16x16x32_bf16 v[72:75], v[132:135], a[112:115], v[72:75]
    ds_read_b128 v[148:151], v6 offset:1376
    v_mfma_f32_16x16x32_bf16 v[60:63], v[128:131], a[176:179], v[60:63]
    v_alignbit_b32 v218, v181, v180, 16
    v_alignbit_b32 v219, v182, v181, 16
    v_mfma_f32_16x16x32_bf16 v[76:79], v[132:135], a[176:179], v[76:79]
    ds_write_b128 v5, v[216:219] offset:12480
    s_waitcnt lgkmcnt(6)
    v_mfma_f32_16x16x32_bf16 v[52:55], v[136:139], a[44:47], v[52:55]
    v_alignbit_b32 v220, v178, v177, 16
    v_alignbit_b32 v221, v179, v178, 16
    s_waitcnt lgkmcnt(5)
    v_mfma_f32_16x16x32_bf16 v[68:71], v[140:143], a[44:47], v[68:71]
    v_alignbit_b32 v222, v180, v179, 16
    v_alignbit_b32 v223, v181, v180, 16
    v_mfma_f32_16x16x32_bf16 v[56:59], v[136:139], a[108:111], v[56:59]
    ds_read_b128 v[152:155], v6 offset:1408
    v_mfma_f32_16x16x32_bf16 v[72:75], v[140:143], a[108:111], v[72:75]
    ds_read_b128 v[156:159], v6 offset:1440
    v_mfma_f32_16x16x32_bf16 v[60:63], v[136:139], a[172:175], v[60:63]
    ds_write_b128 v5, v[220:223] offset:20800
    v_mfma_f32_16x16x32_bf16 v[76:79], v[140:143], a[172:175], v[76:79]
    v_alignbit_b32 v224, v182, v181, 16
    v_alignbit_b32 v225, v183, v182, 16
    s_waitcnt lgkmcnt(5)
    v_mfma_f32_16x16x32_bf16 v[52:55], v[144:147], a[40:43], v[52:55]
    ds_write_b128 v5, v[222:225] offset:4160
    s_waitcnt lgkmcnt(5)
    v_mfma_f32_16x16x32_bf16 v[68:71], v[148:151], a[40:43], v[68:71]
    buffer_load_dwordx4 v[176:179], v230, s[28:31], s37 offen offset:0
    v_mfma_f32_16x16x32_bf16 v[56:59], v[144:147], a[104:107], v[56:59]
    ds_read_b128 v[160:163], v6 offset:1472
    v_mfma_f32_16x16x32_bf16 v[72:75], v[148:151], a[104:107], v[72:75]
    ds_read_b128 v[164:167], v6 offset:1504
    v_mfma_f32_16x16x32_bf16 v[60:63], v[144:147], a[168:171], v[60:63]
    buffer_load_dwordx4 v[180:183], v4, s[28:31], s37 offen offset:0
    v_mfma_f32_16x16x32_bf16 v[76:79], v[148:151], a[168:171], v[76:79]
    s_add_u32 m0, s35, 0
    s_waitcnt lgkmcnt(5)
    v_mfma_f32_16x16x32_bf16 v[52:55], v[152:155], a[36:39], v[52:55]
    buffer_load_dwordx4 v4, s[8:11], s39 offen offset:0 lds
    s_waitcnt lgkmcnt(4)
    v_mfma_f32_16x16x32_bf16 v[68:71], v[156:159], a[36:39], v[68:71]
    s_add_u32 m0, s35, 256
    v_mfma_f32_16x16x32_bf16 v[56:59], v[152:155], a[100:103], v[56:59]
    ds_read_b128 v[168:171], v6 offset:1536
    v_mfma_f32_16x16x32_bf16 v[72:75], v[156:159], a[100:103], v[72:75]
    ds_read_b128 v[172:175], v6 offset:1568
    v_mfma_f32_16x16x32_bf16 v[60:63], v[152:155], a[164:167], v[60:63]
    buffer_load_dwordx4 v4, s[8:11], s39 offen offset:1024 lds
    v_mfma_f32_16x16x32_bf16 v[76:79], v[156:159], a[164:167], v[76:79]
    s_add_u32 m0, s35, 512
    s_waitcnt lgkmcnt(3)
    v_mfma_f32_16x16x32_bf16 v[52:55], v[160:163], a[32:35], v[52:55]
    buffer_load_dwordx4 v4, s[8:11], s39 offen offset:2048 lds
    s_waitcnt lgkmcnt(2)
    v_mfma_f32_16x16x32_bf16 v[68:71], v[164:167], a[32:35], v[68:71]
    s_add_u32 m0, s35, 768
    v_mfma_f32_16x16x32_bf16 v[56:59], v[160:163], a[96:99], v[56:59]
    ds_read_b128 v[112:115], v6 offset:1600
    v_mfma_f32_16x16x32_bf16 v[72:75], v[164:167], a[96:99], v[72:75]
    ds_read_b128 v[116:119], v6 offset:1632
    v_mfma_f32_16x16x32_bf16 v[60:63], v[160:163], a[160:163], v[60:63]
    buffer_load_dwordx4 v4, s[8:11], s39 offen offset:3072 lds
    v_mfma_f32_16x16x32_bf16 v[76:79], v[164:167], a[160:163], v[76:79]
    s_waitcnt lgkmcnt(3)
    v_mfma_f32_16x16x32_bf16 v[52:55], v[168:171], a[28:31], v[52:55]
    s_waitcnt lgkmcnt(2)
    v_mfma_f32_16x16x32_bf16 v[68:71], v[172:175], a[28:31], v[68:71]
    v_mfma_f32_16x16x32_bf16 v[56:59], v[168:171], a[92:95], v[56:59]
    ds_read_b128 v[120:123], v6 offset:1664
    v_mfma_f32_16x16x32_bf16 v[72:75], v[172:175], a[92:95], v[72:75]
    ds_read_b128 v[124:127], v6 offset:1696
    v_mfma_f32_16x16x32_bf16 v[60:63], v[168:171], a[156:159], v[60:63]
    v_mfma_f32_16x16x32_bf16 v[76:79], v[172:175], a[156:159], v[76:79]
    s_waitcnt lgkmcnt(3)
    v_mfma_f32_16x16x32_bf16 v[52:55], v[112:115], a[24:27], v[52:55]
    s_waitcnt lgkmcnt(2)
    v_mfma_f32_16x16x32_bf16 v[68:71], v[116:119], a[24:27], v[68:71]
    v_mfma_f32_16x16x32_bf16 v[56:59], v[112:115], a[88:91], v[56:59]
    ds_read_b128 v[128:131], v6 offset:1728
    v_mfma_f32_16x16x32_bf16 v[72:75], v[116:119], a[88:91], v[72:75]
    ds_read_b128 v[132:135], v6 offset:1760
    v_mfma_f32_16x16x32_bf16 v[60:63], v[112:115], a[152:155], v[60:63]
    v_mfma_f32_16x16x32_bf16 v[76:79], v[116:119], a[152:155], v[76:79]
    s_waitcnt lgkmcnt(3)
    v_mfma_f32_16x16x32_bf16 v[52:55], v[120:123], a[20:23], v[52:55]
    s_waitcnt lgkmcnt(2)
    v_mfma_f32_16x16x32_bf16 v[68:71], v[124:127], a[20:23], v[68:71]
    v_mfma_f32_16x16x32_bf16 v[56:59], v[120:123], a[84:87], v[56:59]
    ds_read_b128 v[136:139], v6 offset:1792
    v_mfma_f32_16x16x32_bf16 v[72:75], v[124:127], a[84:87], v[72:75]
    ds_read_b128 v[140:143], v6 offset:1824
    v_mfma_f32_16x16x32_bf16 v[60:63], v[120:123], a[148:151], v[60:63]
    v_mfma_f32_16x16x32_bf16 v[76:79], v[124:127], a[148:151], v[76:79]
    s_waitcnt lgkmcnt(3)
    v_mfma_f32_16x16x32_bf16 v[52:55], v[128:131], a[16:19], v[52:55]
    s_waitcnt lgkmcnt(2)
    v_mfma_f32_16x16x32_bf16 v[68:71], v[132:135], a[16:19], v[68:71]
    v_mfma_f32_16x16x32_bf16 v[56:59], v[128:131], a[80:83], v[56:59]
    ds_read_b128 v[144:147], v6 offset:1856
    v_mfma_f32_16x16x32_bf16 v[72:75], v[132:135], a[80:83], v[72:75]
    ds_read_b128 v[148:151], v6 offset:1888
    v_mfma_f32_16x16x32_bf16 v[60:63], v[128:131], a[144:147], v[60:63]
    v_mfma_f32_16x16x32_bf16 v[76:79], v[132:135], a[144:147], v[76:79]
    s_waitcnt lgkmcnt(3)
    v_mfma_f32_16x16x32_bf16 v[52:55], v[136:139], a[12:15], v[52:55]
    s_waitcnt lgkmcnt(2)
    v_mfma_f32_16x16x32_bf16 v[68:71], v[140:143], a[12:15], v[68:71]
    v_mfma_f32_16x16x32_bf16 v[56:59], v[136:139], a[76:79], v[56:59]
    ds_read_b128 v[152:155], v6 offset:1920
    v_mfma_f32_16x16x32_bf16 v[72:75], v[140:143], a[76:79], v[72:75]
    ds_read_b128 v[156:159], v6 offset:1952
    v_mfma_f32_16x16x32_bf16 v[60:63], v[136:139], a[140:143], v[60:63]
    v_mfma_f32_16x16x32_bf16 v[76:79], v[140:143], a[140:143], v[76:79]
    s_waitcnt lgkmcnt(3)
    v_mfma_f32_16x16x32_bf16 v[52:55], v[144:147], a[8:11], v[52:55]
    s_waitcnt lgkmcnt(2)
    v_mfma_f32_16x16x32_bf16 v[68:71], v[148:151], a[8:11], v[68:71]
    v_mfma_f32_16x16x32_bf16 v[56:59], v[144:147], a[72:75], v[56:59]
    ds_read_b128 v[160:163], v6 offset:1984
    v_mfma_f32_16x16x32_bf16 v[72:75], v[148:151], a[72:75], v[72:75]
    ds_read_b128 v[164:167], v6 offset:2016
    v_mfma_f32_16x16x32_bf16 v[60:63], v[144:147], a[136:139], v[60:63]
    v_mfma_f32_16x16x32_bf16 v[76:79], v[148:151], a[136:139], v[76:79]
    s_waitcnt lgkmcnt(3)
    v_mfma_f32_16x16x32_bf16 v[52:55], v[152:155], a[4:7], v[52:55]
    s_waitcnt lgkmcnt(2)
    v_mfma_f32_16x16x32_bf16 v[68:71], v[156:159], a[4:7], v[68:71]
    v_mfma_f32_16x16x32_bf16 v[56:59], v[152:155], a[68:71], v[56:59]
    ds_read_b128 v[168:171], v6 offset:2048
    v_mfma_f32_16x16x32_bf16 v[72:75], v[156:159], a[68:71], v[72:75]
    ds_read_b128 v[172:175], v6 offset:2080
    v_mfma_f32_16x16x32_bf16 v[60:63], v[152:155], a[132:135], v[60:63]
    s_waitcnt vmcnt(10)
    v_mfma_f32_16x16x32_bf16 v[76:79], v[156:159], a[132:135], v[76:79]
    ds_write_b128 v5, v[188:191] offset:1024
    s_waitcnt lgkmcnt(4)
    v_mfma_f32_16x16x32_bf16 v[52:55], v[160:163], a[0:3], v[52:55]
    ds_read_b128 v[112:115], v6 offset:2112
    s_waitcnt lgkmcnt(4)
    v_mfma_f32_16x16x32_bf16 v[68:71], v[164:167], a[0:3], v[68:71]
    ds_read_b128 v[116:119], v6 offset:2144
    v_mfma_f32_16x16x32_bf16 v[56:59], v[160:163], a[64:67], v[56:59]
    ds_write_b128 v5, v[186:189] offset:17664
    v_mfma_f32_16x16x32_bf16 v[72:75], v[164:167], a[64:67], v[72:75]
    v_mov_b32 v208, v185
    v_mov_b32 v209, v186
    v_mfma_f32_16x16x32_bf16 v[60:63], v[160:163], a[128:131], v[60:63]
    ds_read_b128 v[120:123], v6 offset:2176
    v_mfma_f32_16x16x32_bf16 v[76:79], v[164:167], a[128:131], v[76:79]
    ds_read_b128 v[124:127], v6 offset:2208
    s_waitcnt lgkmcnt(7)
    v_mfma_f32_16x16x32_bf16 v[56:59], v[168:171], a[60:63], v[56:59]
    v_mov_b32 v210, v187
    v_mov_b32 v211, v188
    s_waitcnt lgkmcnt(6)
    v_mfma_f32_16x16x32_bf16 v[72:75], v[172:175], a[60:63], v[72:75]
    ds_write_b128 v5, v[208:211] offset:25984
    v_mfma_f32_16x16x32_bf16 v[60:63], v[168:171], a[124:127], v[60:63]
    ds_read_b128 v[128:131], v6 offset:2240
    v_mfma_f32_16x16x32_bf16 v[76:79], v[172:175], a[124:127], v[76:79]
    ds_read_b128 v[132:135], v6 offset:2272
    s_waitcnt lgkmcnt(7)
    v_mfma_f32_16x16x32_bf16 v[56:59], v[112:115], a[56:59], v[56:59]
    v_mov_b32 v212, v189
    v_mov_b32 v213, v190
    s_waitcnt lgkmcnt(6)
    v_mfma_f32_16x16x32_bf16 v[72:75], v[116:119], a[56:59], v[72:75]
    ds_write_b128 v5, v[210:213] offset:9344
    v_mfma_f32_16x16x32_bf16 v[60:63], v[112:115], a[120:123], v[60:63]
    ds_read_b128 v[136:139], v6 offset:2304
    v_mfma_f32_16x16x32_bf16 v[76:79], v[116:119], a[120:123], v[76:79]
    ds_read_b128 v[140:143], v6 offset:2336
    s_waitcnt lgkmcnt(7)
    v_mfma_f32_16x16x32_bf16 v[56:59], v[120:123], a[52:55], v[56:59]
    v_alignbit_b32 v214, v185, v184, 16
    v_alignbit_b32 v215, v186, v185, 16
    s_waitcnt lgkmcnt(6)
    v_mfma_f32_16x16x32_bf16 v[72:75], v[124:127], a[52:55], v[72:75]
    v_alignbit_b32 v216, v187, v186, 16
    v_alignbit_b32 v217, v188, v187, 16
    v_mfma_f32_16x16x32_bf16 v[60:63], v[120:123], a[116:119], v[60:63]
    ds_read_b128 v[144:147], v6 offset:2368
    v_mfma_f32_16x16x32_bf16 v[76:79], v[124:127], a[116:119], v[76:79]
    ds_read_b128 v[148:151], v6 offset:2400
    s_waitcnt lgkmcnt(6)
    v_mfma_f32_16x16x32_bf16 v[56:59], v[128:131], a[48:51], v[56:59]
    ds_write_b128 v5, v[214:217] offset:30144
    s_waitcnt lgkmcnt(6)
    v_mfma_f32_16x16x32_bf16 v[72:75], v[132:135], a[48:51], v[72:75]
    v_alignbit_b32 v218, v189, v188, 16
    v_alignbit_b32 v219, v190, v189, 16
    v_mfma_f32_16x16x32_bf16 v[60:63], v[128:131], a[112:115], v[60:63]
    ds_read_b128 v[152:155], v6 offset:2432
    v_mfma_f32_16x16x32_bf16 v[76:79], v[132:135], a[112:115], v[76:79]
    ds_read_b128 v[156:159], v6 offset:2464
    s_waitcnt lgkmcnt(6)
    v_mfma_f32_16x16x32_bf16 v[56:59], v[136:139], a[44:47], v[56:59]
    ds_write_b128 v5, v[216:219] offset:13504
    s_waitcnt lgkmcnt(6)
    v_mfma_f32_16x16x32_bf16 v[72:75], v[140:143], a[44:47], v[72:75]
    v_alignbit_b32 v220, v186, v185, 16
    v_alignbit_b32 v221, v187, v186, 16
    v_mfma_f32_16x16x32_bf16 v[60:63], v[136:139], a[108:111], v[60:63]
    ds_read_b128 v[160:163], v6 offset:2496
    v_mfma_f32_16x16x32_bf16 v[76:79], v[140:143], a[108:111], v[76:79]
    ds_read_b128 v[164:167], v6 offset:2528
    s_waitcnt lgkmcnt(7)
    v_mfma_f32_16x16x32_bf16 v[56:59], v[144:147], a[40:43], v[56:59]
    v_alignbit_b32 v222, v188, v187, 16
    v_alignbit_b32 v223, v189, v188, 16
    s_waitcnt lgkmcnt(6)
    v_mfma_f32_16x16x32_bf16 v[72:75], v[148:151], a[40:43], v[72:75]
    ds_write_b128 v5, v[220:223] offset:21824
    v_mfma_f32_16x16x32_bf16 v[60:63], v[144:147], a[104:107], v[60:63]
    ds_read_b128 v[168:171], v6 offset:2560
    v_mfma_f32_16x16x32_bf16 v[76:79], v[148:151], a[104:107], v[76:79]
    ds_read_b128 v[172:175], v6 offset:2592
    s_waitcnt lgkmcnt(7)
    v_mfma_f32_16x16x32_bf16 v[56:59], v[152:155], a[36:39], v[56:59]
    v_alignbit_b32 v224, v190, v189, 16
    v_alignbit_b32 v225, v191, v190, 16
    s_waitcnt lgkmcnt(6)
    v_mfma_f32_16x16x32_bf16 v[72:75], v[156:159], a[36:39], v[72:75]
    ds_write_b128 v5, v[222:225] offset:5184
    v_mfma_f32_16x16x32_bf16 v[60:63], v[152:155], a[100:103], v[60:63]
    ds_read_b128 v[112:115], v6 offset:2624
    v_mfma_f32_16x16x32_bf16 v[76:79], v[156:159], a[100:103], v[76:79]
    ds_read_b128 v[116:119], v6 offset:2656
    s_waitcnt lgkmcnt(7)
    v_mfma_f32_16x16x32_bf16 v[56:59], v[160:163], a[32:35], v[56:59]
    buffer_load_dwordx4 v[184:187], v4, s[28:31], s37 offen offset:1008
    s_waitcnt lgkmcnt(6)
    v_mfma_f32_16x16x32_bf16 v[72:75], v[164:167], a[32:35], v[72:75]
    buffer_load_dwordx4 v[188:191], v4, s[28:31], s37 offen offset:1024
    v_mfma_f32_16x16x32_bf16 v[60:63], v[160:163], a[96:99], v[60:63]
    ds_read_b128 v[120:123], v6 offset:2688
    v_mfma_f32_16x16x32_bf16 v[76:79], v[164:167], a[96:99], v[76:79]
    ds_read_b128 v[124:127], v6 offset:2720
    s_waitcnt lgkmcnt(6)
    v_mfma_f32_16x16x32_bf16 v[56:59], v[168:171], a[28:31], v[56:59]
    s_mov_b32 s36, s37
    s_add_u32 s39, s37, 125829120
    s_add_u32 s37, s37, 4096
    s_min_u32 s37, s37, s33

    s_pack_ll_b32_b16 s40, s65, s65
    s_mov_b32 s64, s65
    s_mov_b32 s65, s66
    s_mov_b32 s66, s67
    v_and_b32 v236, s40, v8
    s_waitcnt lgkmcnt(5)
    v_mfma_f32_16x16x32_bf16 v[72:75], v[172:175], a[28:31], v[72:75]
    v_and_b32 v237, s40, v9
    v_and_b32 v238, s40, v10
    v_mfma_f32_16x16x32_bf16 v[60:63], v[168:171], a[92:95], v[60:63]
    ds_read_b128 v[128:131], v6 offset:2752
    v_mfma_f32_16x16x32_bf16 v[76:79], v[172:175], a[92:95], v[76:79]
    ds_read_b128 v[132:135], v6 offset:2784
    s_waitcnt lgkmcnt(5)
    v_mfma_f32_16x16x32_bf16 v[56:59], v[112:115], a[24:27], v[56:59]
    v_and_b32 v239, s40, v11
    v_and_b32 v240, s40, v12
    s_waitcnt lgkmcnt(4)
    v_mfma_f32_16x16x32_bf16 v[72:75], v[116:119], a[24:27], v[72:75]
    v_and_b32 v241, s40, v13
    v_and_b32 v242, s40, v14
    v_mfma_f32_16x16x32_bf16 v[60:63], v[112:115], a[88:91], v[60:63]
    ds_read_b128 v[136:139], v6 offset:2816
    v_mfma_f32_16x16x32_bf16 v[76:79], v[116:119], a[88:91], v[76:79]
    ds_read_b128 v[140:143], v6 offset:2848
    s_waitcnt lgkmcnt(5)
    v_mfma_f32_16x16x32_bf16 v[56:59], v[120:123], a[20:23], v[56:59]
    v_and_b32 v243, s40, v15
    s_waitcnt lgkmcnt(4)
    v_mfma_f32_16x16x32_bf16 v[72:75], v[124:127], a[20:23], v[72:75]
    v_mfma_f32_16x16x32_bf16 v[60:63], v[120:123], a[84:87], v[60:63]
    ds_read_b128 v[144:147], v6 offset:2880
    v_mfma_f32_16x16x32_bf16 v[76:79], v[124:127], a[84:87], v[76:79]
    ds_read_b128 v[148:151], v6 offset:2912
    s_waitcnt lgkmcnt(5)
    v_mfma_f32_16x16x32_bf16 v[56:59], v[128:131], a[16:19], v[56:59]
    s_waitcnt lgkmcnt(4)
    v_mfma_f32_16x16x32_bf16 v[72:75], v[132:135], a[16:19], v[72:75]
    v_mfma_f32_16x16x32_bf16 v[60:63], v[128:131], a[80:83], v[60:63]
    ds_read_b128 v[152:155], v6 offset:2944
    v_mfma_f32_16x16x32_bf16 v[76:79], v[132:135], a[80:83], v[76:79]
    ds_read_b128 v[156:159], v6 offset:2976
    s_waitcnt lgkmcnt(5)
    v_mfma_f32_16x16x32_bf16 v[56:59], v[136:139], a[12:15], v[56:59]
    s_waitcnt lgkmcnt(4)
    v_mfma_f32_16x16x32_bf16 v[72:75], v[140:143], a[12:15], v[72:75]
    v_mfma_f32_16x16x32_bf16 v[60:63], v[136:139], a[76:79], v[60:63]
    ds_read_b128 v[160:163], v6 offset:3008
    v_mfma_f32_16x16x32_bf16 v[76:79], v[140:143], a[76:79], v[76:79]
    ds_read_b128 v[164:167], v6 offset:3040
    s_waitcnt lgkmcnt(5)
    v_mfma_f32_16x16x32_bf16 v[56:59], v[144:147], a[8:11], v[56:59]
    s_waitcnt lgkmcnt(4)
    v_mfma_f32_16x16x32_bf16 v[72:75], v[148:151], a[8:11], v[72:75]
    v_mfma_f32_16x16x32_bf16 v[60:63], v[144:147], a[72:75], v[60:63]
    ds_read_b128 v[168:171], v6 offset:3072
    v_mfma_f32_16x16x32_bf16 v[76:79], v[148:151], a[72:75], v[76:79]
    ds_read_b128 v[172:175], v6 offset:3104
    s_waitcnt lgkmcnt(5)
    v_mfma_f32_16x16x32_bf16 v[56:59], v[152:155], a[4:7], v[56:59]
    ds_read_b128 v[112:115], v6 offset:3136
    s_waitcnt lgkmcnt(5)
    v_mfma_f32_16x16x32_bf16 v[72:75], v[156:159], a[4:7], v[72:75]
    ds_read_b128 v[116:119], v6 offset:3168
    v_mfma_f32_16x16x32_bf16 v[60:63], v[152:155], a[68:71], v[60:63]
    ds_read_b128 v[120:123], v6 offset:3200
    v_mfma_f32_16x16x32_bf16 v[76:79], v[156:159], a[68:71], v[76:79]
    ds_read_b128 v[124:127], v6 offset:3232
    s_waitcnt lgkmcnt(7)
    v_mfma_f32_16x16x32_bf16 v[56:59], v[160:163], a[0:3], v[56:59]
    ds_read_b128 v[128:131], v6 offset:3264
    s_waitcnt lgkmcnt(7)
    v_mfma_f32_16x16x32_bf16 v[72:75], v[164:167], a[0:3], v[72:75]
    ds_read_b128 v[132:135], v6 offset:3296
    v_mfma_f32_16x16x32_bf16 v[60:63], v[160:163], a[64:67], v[60:63]
    ds_read_b128 v[136:139], v6 offset:3328
    v_mfma_f32_16x16x32_bf16 v[76:79], v[164:167], a[64:67], v[76:79]
    ds_read_b128 v[140:143], v6 offset:3360
    s_waitcnt lgkmcnt(9)
    v_mfma_f32_16x16x32_bf16 v[60:63], v[168:171], a[60:63], v[60:63]
    ds_read_b128 v[144:147], v6 offset:3392
    s_waitcnt lgkmcnt(9)
    v_mfma_f32_16x16x32_bf16 v[76:79], v[172:175], a[60:63], v[76:79]
    ds_read_b128 v[148:151], v6 offset:3424
    s_waitcnt lgkmcnt(9)
    v_mfma_f32_16x16x32_bf16 v[60:63], v[112:115], a[56:59], v[60:63]
    ds_read_b128 v[152:155], v6 offset:3456
    s_waitcnt lgkmcnt(9)
    v_mfma_f32_16x16x32_bf16 v[76:79], v[116:119], a[56:59], v[76:79]
    ds_read_b128 v[156:159], v6 offset:3488
    s_waitcnt lgkmcnt(9)
    v_mfma_f32_16x16x32_bf16 v[60:63], v[120:123], a[52:55], v[60:63]
    ds_read_b128 v[160:163], v6 offset:3520
    s_waitcnt lgkmcnt(9)
    v_mfma_f32_16x16x32_bf16 v[76:79], v[124:127], a[52:55], v[76:79]
    ds_read_b128 v[164:167], v6 offset:3552
    s_waitcnt lgkmcnt(9)
    v_mfma_f32_16x16x32_bf16 v[60:63], v[128:131], a[48:51], v[60:63]
    ds_read_b128 v[168:171], v6 offset:3584
    s_waitcnt lgkmcnt(9)
    v_mfma_f32_16x16x32_bf16 v[76:79], v[132:135], a[48:51], v[76:79]
    ds_read_b128 v[172:175], v6 offset:3616
    s_waitcnt lgkmcnt(9)
    v_mfma_f32_16x16x32_bf16 v[60:63], v[136:139], a[44:47], v[60:63]
    ds_read_b128 v[112:115], v6 offset:3648
    s_waitcnt lgkmcnt(9)
    v_mfma_f32_16x16x32_bf16 v[76:79], v[140:143], a[44:47], v[76:79]
    ds_read_b128 v[116:119], v6 offset:3680
    s_waitcnt lgkmcnt(9)
    v_mfma_f32_16x16x32_bf16 v[60:63], v[144:147], a[40:43], v[60:63]
    ds_read_b128 v[120:123], v6 offset:3712
    s_waitcnt lgkmcnt(9)
    v_mfma_f32_16x16x32_bf16 v[76:79], v[148:151], a[40:43], v[76:79]
    ds_read_b128 v[124:127], v6 offset:3744
    s_waitcnt lgkmcnt(9)
    v_mfma_f32_16x16x32_bf16 v[60:63], v[152:155], a[36:39], v[60:63]
    ds_read_b128 v[128:131], v6 offset:3776
    s_waitcnt lgkmcnt(9)
    v_mfma_f32_16x16x32_bf16 v[76:79], v[156:159], a[36:39], v[76:79]
    ds_read_b128 v[132:135], v6 offset:3808
    s_waitcnt lgkmcnt(9)
    v_mfma_f32_16x16x32_bf16 v[60:63], v[160:163], a[32:35], v[60:63]
    ds_read_b128 v[136:139], v6 offset:3840
    s_waitcnt lgkmcnt(9)
    v_mfma_f32_16x16x32_bf16 v[76:79], v[164:167], a[32:35], v[76:79]
    ds_read_b128 v[140:143], v6 offset:3872
    s_waitcnt lgkmcnt(9)
    v_mfma_f32_16x16x32_bf16 v[60:63], v[168:171], a[28:31], v[60:63]
    ds_read_b128 v[144:147], v6 offset:3904
    s_waitcnt lgkmcnt(9)
    v_mfma_f32_16x16x32_bf16 v[76:79], v[172:175], a[28:31], v[76:79]
    ds_read_b128 v[148:151], v6 offset:3936
    s_waitcnt lgkmcnt(9)
    v_mfma_f32_16x16x32_bf16 v[60:63], v[112:115], a[24:27], v[60:63]
    ds_read_b128 v[152:155], v6 offset:3968
    s_waitcnt lgkmcnt(9)
    v_mfma_f32_16x16x32_bf16 v[76:79], v[116:119], a[24:27], v[76:79]
    ds_read_b128 v[156:159], v6 offset:4000
    s_waitcnt lgkmcnt(9)
    v_mfma_f32_16x16x32_bf16 v[60:63], v[120:123], a[20:23], v[60:63]
    ds_read_b128 v[160:163], v6 offset:4032
    s_waitcnt lgkmcnt(9)
    v_mfma_f32_16x16x32_bf16 v[76:79], v[124:127], a[20:23], v[76:79]
    ds_read_b128 v[164:167], v6 offset:4064
    s_waitcnt lgkmcnt(9)
    v_mfma_f32_16x16x32_bf16 v[60:63], v[128:131], a[16:19], v[60:63]
    s_waitcnt vmcnt(2)
    ds_read_b128 a[60:63], v7 offset:240
    s_waitcnt lgkmcnt(9)
    v_mfma_f32_16x16x32_bf16 v[76:79], v[132:135], a[16:19], v[76:79]
    s_waitcnt lgkmcnt(8)
    v_mfma_f32_16x16x32_bf16 v[60:63], v[136:139], a[12:15], v[60:63]
    ds_read_b128 a[124:127], v7 offset:496
    s_waitcnt lgkmcnt(8)
    v_mfma_f32_16x16x32_bf16 v[76:79], v[140:143], a[12:15], v[76:79]
    s_waitcnt lgkmcnt(7)
    v_mfma_f32_16x16x32_bf16 v[60:63], v[144:147], a[8:11], v[60:63]
    ds_read_b128 a[188:191], v7 offset:752
    s_waitcnt lgkmcnt(7)
    v_mfma_f32_16x16x32_bf16 v[76:79], v[148:151], a[8:11], v[76:79]
    s_waitcnt lgkmcnt(6)
    v_mfma_f32_16x16x32_bf16 v[60:63], v[152:155], a[4:7], v[60:63]
    ds_read_b128 a[252:255], v7 offset:1008
    s_waitcnt lgkmcnt(6)
    v_mfma_f32_16x16x32_bf16 v[76:79], v[156:159], a[4:7], v[76:79]
    s_waitcnt lgkmcnt(5)
    v_mfma_f32_16x16x32_bf16 v[60:63], v[160:163], a[0:3], v[60:63]
    ds_read_b128 v[168:171], v6 offset:0
    s_waitcnt lgkmcnt(5)
    v_mfma_f32_16x16x32_bf16 v[76:79], v[164:167], a[0:3], v[76:79]
    ds_read_b128 v[172:175], v6 offset:32
    s_add_u32 s41, s38, 4096
    v_cvt_pk_bf16_f32 v80, v16, v48
    v_cvt_pk_bf16_f32 v81, v17, v49
    v_cvt_pk_bf16_f32 v82, v18, v50
    v_cvt_pk_bf16_f32 v83, v19, v51
    buffer_store_dwordx4 v[80:83], v228, s[8:11], s38 offen offset:0 sc1
    v_cvt_pk_bf16_f32 v84, v32, v64
    v_cvt_pk_bf16_f32 v85, v33, v65
    v_cvt_pk_bf16_f32 v86, v34, v66
    v_cvt_pk_bf16_f32 v87, v35, v67
    buffer_store_dwordx4 v[84:87], v228, s[8:11], s38 offen offset:64 sc1
    v_cvt_pk_bf16_f32 v88, v20, v52
    v_cvt_pk_bf16_f32 v89, v21, v53
    v_cvt_pk_bf16_f32 v90, v22, v54
    v_cvt_pk_bf16_f32 v91, v23, v55
    buffer_store_dwordx4 v[88:91], v228, s[8:11], s38 offen offset:2048 sc1
    v_cvt_pk_bf16_f32 v92, v36, v68
    v_cvt_pk_bf16_f32 v93, v37, v69
    v_cvt_pk_bf16_f32 v94, v38, v70
    v_cvt_pk_bf16_f32 v95, v39, v71
    buffer_store_dwordx4 v[92:95], v228, s[8:11], s38 offen offset:2112 sc1
    v_cvt_pk_bf16_f32 v96, v24, v56
    v_cvt_pk_bf16_f32 v97, v25, v57
    v_cvt_pk_bf16_f32 v98, v26, v58
    v_cvt_pk_bf16_f32 v99, v27, v59
    buffer_store_dwordx4 v[96:99], v228, s[8:11], s41 offen offset:0 sc1
    v_cvt_pk_bf16_f32 v100, v40, v72
    v_cvt_pk_bf16_f32 v101, v41, v73
    v_cvt_pk_bf16_f32 v102, v42, v74
    v_cvt_pk_bf16_f32 v103, v43, v75
    buffer_store_dwordx4 v[100:103], v228, s[8:11], s41 offen offset:64 sc1
    v_cvt_pk_bf16_f32 v104, v28, v60
    v_cvt_pk_bf16_f32 v105, v29, v61
    v_cvt_pk_bf16_f32 v106, v30, v62
    v_cvt_pk_bf16_f32 v107, v31, v63
    buffer_store_dwordx4 v[104:107], v228, s[8:11], s41 offen offset:2048 sc1
    v_cvt_pk_bf16_f32 v108, v44, v76
    v_cvt_pk_bf16_f32 v109, v45, v77
    v_cvt_pk_bf16_f32 v110, v46, v78
    v_cvt_pk_bf16_f32 v111, v47, v79
    buffer_store_dwordx4 v[108:111], v228, s[8:11], s41 offen offset:2112 sc1
    s_add_u32 s38, s38, 8192
    s_add_u32 s42, s42, 1
    s_cmp_lt_u32 s42, 4
    s_cbranch_scc1 .cvl_453

    s_waitcnt vmcnt(0) lgkmcnt(0)
    s_barrier
    s_mov_b32 s5, 160
    s_cmp_lg_u32 s24, 0
    s_cbranch_scc1 .sg_454
    s_mov_b64 exec, 1
    v_mov_b32 v4, 1
    v_mov_b32 v5, 0
    buffer_atomic_add v4, v5, s[20:23], s5 offen sc1
    s_mov_b64 exec, -1

.sg_454:
    v_and_b32 v1, 63, v0
    v_and_b32 v2, 15, v1
    v_lshrrev_b32 v3, 4, v1

    s_sub_u32 s4, s26, 24
    s_lshr_b32 s25, s4, 1
    s_and_b32 s4, s4, 1
    s_lshl_b32 s4, s4, 2
    s_lshl_b32 s5, s91, 3
    s_add_u32 s4, s4, s5
    s_add_u32 s26, s4, s24
    s_lshl_b32 s35, s26, 8
    s_add_u32 s35, s35, 92274688
    s_mov_b32 s37, 0x3db504f3
    s_mov_b32 s38, 0x3fb8aa3b
    v_lshlrev_b32 v8, 4, v1
    v_min_u32 v9, 2, v1
    v_lshlrev_b32 v9, 13, v9
    v_lshlrev_b32 v6, 4, v3
    v_and_b32 v5, 7, v2
    v_add_u32 v10, v6, v5
    v_lshlrev_b32 v10, 4, v10
    v_lshlrev_b32 v11, 4, v2
    v_lshlrev_b32 v5, 3, v3
    v_add_u32 v11, v11, v5
    v_cmp_gt_u32 s[60:61], 32, v1
    v_lshlrev_b32 v5, 2, v3
    v_mov_b32 v12, 0
    v_mov_b32 v13, 0
    v_mov_b32 v14, 0xff800000
    v_lshlrev_b32 v204, 9, v1
    v_add_u32 v204, 4604, v204
    s_lshl_b32 s4, s25, 5
    s_add_u32 s4, s4, s26
    s_lshl_b32 s27, s4, 13
    s_mul_i32 s33, s4, 6144
    s_add_u32 s33, s33, 67108864
    s_add_u32 s36, s25, 1

    v_add_u32 v7, 0, v5
    v_cmp_le_u32 s[40:41], v7, v2
    v_add_u32 v7, 1, v5
    v_cmp_le_u32 s[42:43], v7, v2
    v_add_u32 v7, 2, v5
    v_cmp_le_u32 s[44:45], v7, v2
    v_add_u32 v7, 3, v5
    v_cmp_le_u32 s[46:47], v7, v2
    v_mov_b32 v112, 0
    v_mov_b32 v113, 0
    v_mov_b32 v114, 0
    v_mov_b32 v115, 0
    v_mov_b32 v116, 0
    v_mov_b32 v117, 0
    v_mov_b32 v118, 0
    v_mov_b32 v119, 0
    v_mov_b32 v120, 0
    v_mov_b32 v121, 0
    v_mov_b32 v122, 0
    v_mov_b32 v123, 0
    v_mov_b32 v124, 0
    v_mov_b32 v125, 0
    v_mov_b32 v126, 0
    v_mov_b32 v127, 0
    v_mov_b32 v128, 0
    v_mov_b32 v129, 0
    v_mov_b32 v130, 0
    v_mov_b32 v131, 0
    v_mov_b32 v132, 0
    v_mov_b32 v133, 0
    v_mov_b32 v134, 0
    v_mov_b32 v135, 0
    v_mov_b32 v136, 0
    v_mov_b32 v137, 0
    v_mov_b32 v138, 0
    v_mov_b32 v139, 0
    v_mov_b32 v140, 0
    v_mov_b32 v141, 0
    v_mov_b32 v142, 0
    v_mov_b32 v143, 0
    s_bitcmp1_b32 s97, 4
    s_cselect_b32 s96, 999, 64
    v_mov_b32 v15, -1
    s_mov_b32 s62, 0
    s_mov_b64 exec, 7
.wf_455:
    buffer_load_dword v15, v9, s[8:11], s35 offen sc1
    s_waitcnt vmcnt(0)
    v_cmp_gt_u32 vcc, s36, v15
    s_cbranch_vccz .wfd_456
    s_sleep 2
    s_add_u32 s62, s62, 1
    s_cmp_gt_u32 s62, 0x400000
    s_cbranch_scc1 .mg_end_1
    s_branch .wf_455

.wfd_456:
    s_mov_b64 exec, -1
    s_add_u32 s28, s27, 4096
    s_add_u32 s29, s27, 16777216
    s_add_u32 s30, s27, 16781312
    s_add_u32 s31, s27, 33554432
    s_add_u32 s32, s27, 33558528

    buffer_load_dwordx4 a[0:3], v8, s[8:11], s27 offen offset:0
    buffer_load_dwordx4 a[16:19], v8, s[8:11], s28 offen offset:0
    buffer_load_dwordx4 a[32:35], v8, s[8:11], s29 offen offset:0
    buffer_load_dwordx4 a[48:51], v8, s[8:11], s30 offen offset:0
    buffer_load_dwordx4 a[4:7], v8, s[8:11], s27 offen offset:1024
    buffer_load_dwordx4 a[20:23], v8, s[8:11], s28 offen offset:1024
    buffer_load_dwordx4 a[36:39], v8, s[8:11], s29 offen offset:1024
    buffer_load_dwordx4 a[52:55], v8, s[8:11], s30 offen offset:1024
    buffer_load_dwordx4 a[8:11], v8, s[8:11], s27 offen offset:2048
    buffer_load_dwordx4 a[24:27], v8, s[8:11], s28 offen offset:2048
    buffer_load_dwordx4 a[40:43], v8, s[8:11], s29 offen offset:2048
    buffer_load_dwordx4 a[56:59], v8, s[8:11], s30 offen offset:2048
    buffer_load_dwordx4 a[12:15], v8, s[8:11], s27 offen offset:3072
    buffer_load_dwordx4 a[28:31], v8, s[8:11], s28 offen offset:3072
    buffer_load_dwordx4 a[44:47], v8, s[8:11], s29 offen offset:3072
    buffer_load_dwordx4 a[60:63], v8, s[8:11], s30 offen offset:3072
    buffer_load_dwordx4 a[64:67], v8, s[8:11], s31 offen offset:0
    buffer_load_dwordx4 a[68:71], v8, s[8:11], s31 offen offset:1024
    buffer_load_dwordx4 a[72:75], v8, s[8:11], s31 offen offset:2048
    buffer_load_dwordx4 a[76:79], v8, s[8:11], s31 offen offset:3072
    buffer_load_dwordx4 a[80:83], v8, s[8:11], s32 offen offset:0
    buffer_load_dwordx4 a[84:87], v8, s[8:11], s32 offen offset:1024
    buffer_load_dwordx4 a[88:91], v8, s[8:11], s32 offen offset:2048
    buffer_load_dwordx4 a[92:95], v8, s[8:11], s32 offen offset:3072
    buffer_load_dwordx4 v[80:83], v10, s[8:11], s33 offen offset:2048 sc1
    buffer_load_dwordx4 v[84:87], v10, s[8:11], s33 offen offset:2176 sc1
    buffer_load_dwordx4 v[88:91], v10, s[8:11], s33 offen offset:3072 sc1
    buffer_load_dwordx4 v[92:95], v10, s[8:11], s33 offen offset:3200 sc1
    s_add_u32 s4, s33, 4096
    s_mov_b64 exec, s[60:61]
    buffer_load_dwordx2 v[128:129], v11, s[8:11], s4 offen offset:0 sc1
    buffer_load_dwordx2 v[130:131], v11, s[8:11], s4 offen offset:256 sc1
    buffer_load_dwordx2 v[132:133], v11, s[8:11], s4 offen offset:512 sc1
    buffer_load_dwordx2 v[134:135], v11, s[8:11], s4 offen offset:768 sc1
    buffer_load_dwordx2 v[136:137], v11, s[8:11], s4 offen offset:1024 sc1
    buffer_load_dwordx2 v[138:139], v11, s[8:11], s4 offen offset:1280 sc1
    buffer_load_dwordx2 v[140:141], v11, s[8:11], s4 offen offset:1536 sc1
    buffer_load_dwordx2 v[142:143], v11, s[8:11], s4 offen offset:1792 sc1
    s_mov_b64 exec, -1
    s_waitcnt vmcnt(0)
.att_457:
    s_mov_b32 s34, s33
    s_add_u32 s50, s27, 0
    s_add_u32 s51, s27, 4096
    s_cmp_lt_u32 s25, 60
    s_cselect_b32 s4, 4, 0
    s_cselect_b32 s5, 1048576, 0
    s_cselect_b32 s6, 786432, 0
    s_add_u32 s36, s36, s4
    s_add_u32 s27, s27, s5
    s_add_u32 s33, s33, s6
    s_waitcnt vmcnt(8)

    v_cmp_gt_u32 vcc, s36, v15
    s_cbranch_vccnz .atw_458
.atb_459:
    s_add_u32 s28, s27, 4096
    s_add_u32 s29, s27, 16777216
    s_add_u32 s30, s27, 16781312
    s_add_u32 s31, s27, 33554432
    s_add_u32 s32, s27, 33558528

    buffer_load_dwordx4 a[96:99], v8, s[8:11], s27 offen offset:0
    buffer_load_dwordx4 a[112:115], v8, s[8:11], s28 offen offset:0
    buffer_load_dwordx4 a[128:131], v8, s[8:11], s29 offen offset:0
    buffer_load_dwordx4 a[144:147], v8, s[8:11], s30 offen offset:0
    buffer_load_dwordx4 a[100:103], v8, s[8:11], s27 offen offset:1024
    buffer_load_dwordx4 a[116:119], v8, s[8:11], s28 offen offset:1024
    buffer_load_dwordx4 a[132:135], v8, s[8:11], s29 offen offset:1024
    buffer_load_dwordx4 a[148:151], v8, s[8:11], s30 offen offset:1024
    buffer_load_dwordx4 a[104:107], v8, s[8:11], s27 offen offset:2048
    buffer_load_dwordx4 a[120:123], v8, s[8:11], s28 offen offset:2048
    buffer_load_dwordx4 a[136:139], v8, s[8:11], s29 offen offset:2048
    buffer_load_dwordx4 a[152:155], v8, s[8:11], s30 offen offset:2048
    buffer_load_dwordx4 a[108:111], v8, s[8:11], s27 offen offset:3072
    buffer_load_dwordx4 a[124:127], v8, s[8:11], s28 offen offset:3072
    buffer_load_dwordx4 a[140:143], v8, s[8:11], s29 offen offset:3072
    buffer_load_dwordx4 a[156:159], v8, s[8:11], s30 offen offset:3072
    buffer_load_dwordx4 a[160:163], v8, s[8:11], s31 offen offset:0
    buffer_load_dwordx4 a[164:167], v8, s[8:11], s31 offen offset:1024
    buffer_load_dwordx4 a[168:171], v8, s[8:11], s31 offen offset:2048
    buffer_load_dwordx4 a[172:175], v8, s[8:11], s31 offen offset:3072
    buffer_load_dwordx4 a[176:179], v8, s[8:11], s32 offen offset:0
    buffer_load_dwordx4 a[180:183], v8, s[8:11], s32 offen offset:1024
    buffer_load_dwordx4 a[184:187], v8, s[8:11], s32 offen offset:2048
    buffer_load_dwordx4 a[188:191], v8, s[8:11], s32 offen offset:3072
    buffer_load_dwordx4 v[96:99], v10, s[8:11], s33 offen offset:2048 sc1
    buffer_load_dwordx4 v[100:103], v10, s[8:11], s33 offen offset:2176 sc1
    buffer_load_dwordx4 v[104:107], v10, s[8:11], s33 offen offset:3072 sc1
    buffer_load_dwordx4 v[108:111], v10, s[8:11], s33 offen offset:3200 sc1
    s_add_u32 s4, s33, 4096
    s_mov_b64 exec, s[60:61]
    buffer_load_dwordx2 v[112:113], v11, s[8:11], s4 offen offset:0 sc1
    buffer_load_dwordx2 v[114:115], v11, s[8:11], s4 offen offset:256 sc1
    buffer_load_dwordx2 v[116:117], v11, s[8:11], s4 offen offset:512 sc1
    buffer_load_dwordx2 v[118:119], v11, s[8:11], s4 offen offset:768 sc1
    buffer_load_dwordx2 v[120:121], v11, s[8:11], s4 offen offset:1024 sc1
    buffer_load_dwordx2 v[122:123], v11, s[8:11], s4 offen offset:1280 sc1
    buffer_load_dwordx2 v[124:125], v11, s[8:11], s4 offen offset:1536 sc1
    buffer_load_dwordx2 v[126:127], v11, s[8:11], s4 offen offset:1792 sc1
    s_mov_b64 exec, -1
    v_mfma_f32_16x16x32_bf16 v[144:147], a[32:35], a[0:3], 0
    v_mfma_f32_16x16x32_bf16 v[156:159], a[32:35], a[16:19], 0
    v_mfma_f32_16x16x32_bf16 v[160:163], a[48:51], a[16:19], 0
    v_mfma_f32_16x16x32_bf16 v[144:147], a[36:39], a[4:7], v[144:147]
    v_mfma_f32_16x16x32_bf16 v[156:159], a[36:39], a[20:23], v[156:159]
    v_mfma_f32_16x16x32_bf16 v[160:163], a[52:55], a[20:23], v[160:163]
    v_mfma_f32_16x16x32_bf16 v[144:147], a[40:43], a[8:11], v[144:147]
    v_mfma_f32_16x16x32_bf16 v[156:159], a[40:43], a[24:27], v[156:159]
    v_mfma_f32_16x16x32_bf16 v[160:163], a[56:59], a[24:27], v[160:163]
    v_mfma_f32_16x16x32_bf16 v[144:147], a[44:47], a[12:15], v[144:147]
    v_mfma_f32_16x16x32_bf16 v[156:159], a[44:47], a[28:31], v[156:159]
    v_mfma_f32_16x16x32_bf16 v[160:163], a[60:63], a[28:31], v[160:163]
    s_nop 7
    v_cvt_pk_bf16_f32 v168, v144, v145
    v_cvt_pk_bf16_f32 v170, v146, v147
    v_and_b32 v169, 0xffff0000, v168
    v_lshlrev_b32 v168, 16, v168
    v_and_b32 v171, 0xffff0000, v170
    v_lshlrev_b32 v170, 16, v170
    v_mul_f32 v168, s37, v168
    v_mul_f32 v169, s37, v169
    v_mul_f32 v170, s37, v170
    v_mul_f32 v171, s37, v171
    v_cvt_pk_bf16_f32 v144, v168, v169
    v_cvt_pk_bf16_f32 v146, v170, v171
    v_and_b32 v145, 0xffff0000, v144
    v_lshlrev_b32 v144, 16, v144
    v_and_b32 v147, 0xffff0000, v146
    v_lshlrev_b32 v146, 16, v146
    v_cvt_pk_bf16_f32 v192, v156, v157
    v_cvt_pk_bf16_f32 v194, v158, v159
    v_cvt_pk_bf16_f32 v196, v160, v161
    v_cvt_pk_bf16_f32 v198, v162, v163
    v_and_b32 v193, 0xffff0000, v192
    v_lshlrev_b32 v192, 16, v192
    v_and_b32 v195, 0xffff0000, v194
    v_lshlrev_b32 v194, 16, v194
    v_and_b32 v197, 0xffff0000, v196
    v_lshlrev_b32 v196, 16, v196
    v_and_b32 v199, 0xffff0000, v198
    v_lshlrev_b32 v198, 16, v198
    v_mul_f32 v192, s37, v192
    v_mul_f32 v193, s37, v193
    v_mul_f32 v194, s37, v194
    v_mul_f32 v195, s37, v195
    v_mul_f32 v196, s37, v196
    v_mul_f32 v197, s37, v197
    v_mul_f32 v198, s37, v198
    v_mul_f32 v199, s37, v199
    v_cvt_pk_bf16_f32 v156, v192, v193
    v_cvt_pk_bf16_f32 v158, v194, v195
    v_cvt_pk_bf16_f32 v160, v196, v197
    v_cvt_pk_bf16_f32 v162, v198, v199
    v_and_b32 v157, 0xffff0000, v156
    v_lshlrev_b32 v156, 16, v156
    v_and_b32 v159, 0xffff0000, v158
    v_lshlrev_b32 v158, 16, v158
    v_and_b32 v161, 0xffff0000, v160
    v_lshlrev_b32 v160, 16, v160
    v_and_b32 v163, 0xffff0000, v162
    v_lshlrev_b32 v162, 16, v162
    v_cndmask_b32 v144, v14, v144, s[40:41]
    v_cndmask_b32 v145, v14, v145, s[42:43]
    v_cndmask_b32 v146, v14, v146, s[44:45]
    v_cndmask_b32 v147, v14, v147, s[46:47]
    v_cndmask_b32 v160, v14, v160, s[40:41]
    v_cndmask_b32 v161, v14, v161, s[42:43]
    v_cndmask_b32 v162, v14, v162, s[44:45]
    v_cndmask_b32 v163, v14, v163, s[46:47]
    s_mov_b32 s62, 0
.kmp_460:
    v_max3_u32 v4, v80, v81, v82
    v_max3_u32 v5, v83, v84, v85
    v_max3_u32 v4, v4, v86, v87
    v_max3_u32 v5, v5, v88, v89
    v_max3_u32 v4, v4, v90, v91
    v_max3_u32 v5, v5, v92, v93
    v_max3_u32 v4, v4, v94, v95
    v_max3_u32 v5, v5, v128, v129
    v_max3_u32 v4, v4, v130, v131
    v_max3_u32 v5, v5, v132, v133
    v_max3_u32 v4, v4, v134, v135
    v_max3_u32 v5, v5, v136, v137
    v_max3_u32 v4, v4, v138, v139
    v_max3_u32 v5, v5, v140, v141
    v_max3_u32 v4, v4, v142, v143
    v_max_u32 v4, v4, v5
    v_cmp_eq_u32 vcc, -1, v4
    s_cbranch_vccnz .kmf_461

    v_mfma_f32_16x16x32_bf16 v[152:155], v[80:83], a[0:3], 0
    v_mfma_f32_16x16x32_bf16 v[164:167], v[80:83], a[16:19], 0
    v_mfma_f32_16x16x32_bf16 v[152:155], v[84:87], a[4:7], v[152:155]
    v_mfma_f32_16x16x32_bf16 v[164:167], v[84:87], a[20:23], v[164:167]
    v_mfma_f32_16x16x32_bf16 v[152:155], v[88:91], a[8:11], v[152:155]
    v_mfma_f32_16x16x32_bf16 v[164:167], v[88:91], a[24:27], v[164:167]
    v_mfma_f32_16x16x32_bf16 v[152:155], v[92:95], a[12:15], v[152:155]
    v_mfma_f32_16x16x32_bf16 v[164:167], v[92:95], a[28:31], v[164:167]
    s_nop 5
    v_cvt_pk_bf16_f32 v176, v152, v153
    v_cvt_pk_bf16_f32 v178, v154, v155
    v_and_b32 v177, 0xffff0000, v176
    v_lshlrev_b32 v176, 16, v176
    v_and_b32 v179, 0xffff0000, v178
    v_lshlrev_b32 v178, 16, v178
    v_mul_f32 v176, s37, v176
    v_mul_f32 v177, s37, v177
    v_mul_f32 v178, s37, v178
    v_mul_f32 v179, s37, v179
    v_cvt_pk_bf16_f32 v152, v176, v177
    v_cvt_pk_bf16_f32 v154, v178, v179
    v_and_b32 v153, 0xffff0000, v152
    v_lshlrev_b32 v152, 16, v152
    v_and_b32 v155, 0xffff0000, v154
    v_lshlrev_b32 v154, 16, v154
    v_cndmask_b32 v152, v14, v152, s[60:61]
    v_cndmask_b32 v153, v14, v153, s[60:61]
    v_cndmask_b32 v154, v14, v154, s[60:61]
    v_cndmask_b32 v155, v14, v155, s[60:61]
    v_cvt_pk_bf16_f32 v200, v164, v165
    v_cvt_pk_bf16_f32 v202, v166, v167
    v_and_b32 v201, 0xffff0000, v200
    v_lshlrev_b32 v200, 16, v200
    v_and_b32 v203, 0xffff0000, v202
    v_lshlrev_b32 v202, 16, v202
    v_mul_f32 v200, s37, v200
    v_mul_f32 v201, s37, v201
    v_mul_f32 v202, s37, v202
    v_mul_f32 v203, s37, v203
    v_cvt_pk_bf16_f32 v164, v200, v201
    v_cvt_pk_bf16_f32 v166, v202, v203
    v_and_b32 v165, 0xffff0000, v164
    v_lshlrev_b32 v164, 16, v164
    v_and_b32 v167, 0xffff0000, v166
    v_lshlrev_b32 v166, 16, v166
    v_cndmask_b32 v164, v14, v164, s[60:61]
    v_cndmask_b32 v165, v14, v165, s[60:61]
    v_cndmask_b32 v166, v14, v166, s[60:61]
    v_cndmask_b32 v167, v14, v167, s[60:61]
    v_max3_f32 v4, v144, v145, v146
    v_max3_f32 v5, v147, v152, v153
    v_max3_f32 v4, v4, v154, v155
    v_max_f32 v4, v4, v5

    v_max3_f32 v6, v156, v157, v158
    v_max3_f32 v7, v159, v160, v161
    v_max3_f32 v6, v6, v162, v163
    v_max3_f32 v7, v7, v164, v165
    v_max3_f32 v6, v6, v166, v167
    v_max_f32 v6, v6, v7

    v_mov_b32 v5, v4
    v_mov_b32 v7, v6
    s_nop 0
    v_permlane32_swap_b32 v4, v5
    v_permlane32_swap_b32 v6, v7
    v_max_f32 v4, v4, v5
    v_max_f32 v6, v6, v7

    v_mov_b32 v5, v4
    v_mov_b32 v7, v6
    s_nop 0
    v_permlane16_swap_b32 v4, v5
    v_permlane16_swap_b32 v6, v7
    v_max_f32 v4, v4, v5
    v_max_f32 v6, v6, v7

    v_mul_f32 v4, s38, v4
    v_mul_f32 v6, s38, v6
    v_fma_f32 v168, v144, s38, -v4
    v_fma_f32 v169, v145, s38, -v4
    v_fma_f32 v170, v146, s38, -v4
    v_fma_f32 v171, v147, s38, -v4
    v_fma_f32 v176, v152, s38, -v4
    v_fma_f32 v177, v153, s38, -v4
    v_fma_f32 v178, v154, s38, -v4
    v_fma_f32 v179, v155, s38, -v4
    v_fma_f32 v192, v156, s38, -v6
    v_fma_f32 v193, v157, s38, -v6
    v_fma_f32 v194, v158, s38, -v6
    v_fma_f32 v195, v159, s38, -v6
    v_fma_f32 v196, v160, s38, -v6
    v_fma_f32 v197, v161, s38, -v6
    v_fma_f32 v198, v162, s38, -v6
    v_fma_f32 v199, v163, s38, -v6
    v_fma_f32 v200, v164, s38, -v6
    v_fma_f32 v201, v165, s38, -v6
    v_fma_f32 v202, v166, s38, -v6
    v_fma_f32 v203, v167, s38, -v6
    v_exp_f32 v168, v168
    v_exp_f32 v169, v169
    v_exp_f32 v170, v170
    v_exp_f32 v171, v171
    v_exp_f32 v176, v176
    v_exp_f32 v177, v177
    v_exp_f32 v178, v178
    v_exp_f32 v179, v179
    v_exp_f32 v192, v192
    v_exp_f32 v193, v193
    v_exp_f32 v194, v194
    v_exp_f32 v195, v195
    v_exp_f32 v196, v196
    v_exp_f32 v197, v197
    v_exp_f32 v198, v198
    v_exp_f32 v199, v199
    v_exp_f32 v200, v200
    v_exp_f32 v201, v201
    v_exp_f32 v202, v202
    v_exp_f32 v203, v203
    v_add_f32 v4, v168, v169
    v_add_f32 v5, v170, v171
    v_add_f32 v4, v4, v176
    v_add_f32 v5, v5, v177
    v_add_f32 v4, v4, v178
    v_add_f32 v5, v5, v179
    v_add_f32 v4, v4, v5
    v_add_f32 v6, v192, v193
    v_add_f32 v7, v194, v195
    v_add_f32 v6, v6, v196
    v_add_f32 v7, v7, v197
    v_add_f32 v6, v6, v198
    v_add_f32 v7, v7, v199
    v_add_f32 v6, v6, v200
    v_add_f32 v7, v7, v201
    v_add_f32 v6, v6, v202
    v_add_f32 v7, v7, v203
    v_add_f32 v6, v6, v7
    v_mov_b32 v5, v4
    v_mov_b32 v7, v6
    s_nop 0
    v_permlane32_swap_b32 v4, v5
    v_permlane32_swap_b32 v6, v7
    v_add_f32 v4, v4, v5
    v_add_f32 v6, v6, v7

    v_mov_b32 v5, v4
    v_mov_b32 v7, v6
    s_nop 0
    v_permlane16_swap_b32 v4, v5
    v_permlane16_swap_b32 v6, v7
    v_add_f32 v4, v4, v5
    v_add_f32 v6, v6, v7

    v_rcp_f32 v4, v4
    v_rcp_f32 v6, v6
    v_mov_b32 v182, 0
    v_mov_b32 v183, 0
    v_mul_f32 v168, v4, v168
    v_mul_f32 v169, v4, v169
    v_mul_f32 v170, v4, v170
    v_mul_f32 v171, v4, v171
    v_mul_f32 v176, v4, v176
    v_mul_f32 v177, v4, v177
    v_mul_f32 v178, v4, v178
    v_mul_f32 v179, v4, v179
    v_cvt_pk_bf16_f32 v180, v168, v169
    v_cvt_pk_bf16_f32 v181, v170, v171
    v_cvt_pk_bf16_f32 v184, v176, v177
    v_cvt_pk_bf16_f32 v185, v178, v179
    v_mul_f32 v192, v6, v192
    v_mul_f32 v193, v6, v193
    v_mul_f32 v194, v6, v194
    v_mul_f32 v195, v6, v195
    v_mul_f32 v196, v6, v196
    v_mul_f32 v197, v6, v197
    v_mul_f32 v198, v6, v198
    v_mul_f32 v199, v6, v199
    v_mul_f32 v200, v6, v200
    v_mul_f32 v201, v6, v201
    v_mul_f32 v202, v6, v202
    v_mul_f32 v203, v6, v203
    v_cvt_pk_bf16_f32 v186, v192, v193
    v_cvt_pk_bf16_f32 v187, v194, v195
    v_cvt_pk_bf16_f32 v188, v196, v197
    v_cvt_pk_bf16_f32 v189, v198, v199
    v_cvt_pk_bf16_f32 v190, v200, v201
    v_cvt_pk_bf16_f32 v191, v202, v203
    s_add_u32 s25, s25, 4

    v_mfma_f32_16x16x32_bf16 v[16:19], a[64:67], v[180:183], 0
    v_mfma_f32_16x16x32_bf16 v[20:23], a[68:71], v[180:183], 0
    v_mfma_f32_16x16x32_bf16 v[24:27], a[72:75], v[180:183], 0
    v_mfma_f32_16x16x32_bf16 v[28:31], a[76:79], v[180:183], 0
    v_mfma_f32_16x16x32_bf16 v[32:35], a[80:83], v[180:183], 0
    v_mfma_f32_16x16x32_bf16 v[36:39], a[84:87], v[180:183], 0
    v_mfma_f32_16x16x32_bf16 v[40:43], a[88:91], v[180:183], 0
    v_mfma_f32_16x16x32_bf16 v[44:47], a[92:95], v[180:183], 0
    v_mfma_f32_16x16x32_bf16 v[48:51], a[64:67], v[186:189], 0
    v_mfma_f32_16x16x32_bf16 v[52:55], a[68:71], v[186:189], 0
    v_mfma_f32_16x16x32_bf16 v[56:59], a[72:75], v[186:189], 0
    v_mfma_f32_16x16x32_bf16 v[60:63], a[76:79], v[186:189], 0
    v_mfma_f32_16x16x32_bf16 v[64:67], a[80:83], v[186:189], 0
    v_mfma_f32_16x16x32_bf16 v[68:71], a[84:87], v[186:189], 0
    v_mfma_f32_16x16x32_bf16 v[72:75], a[88:91], v[186:189], 0
    v_mfma_f32_16x16x32_bf16 v[76:79], a[92:95], v[186:189], 0
    s_waitcnt vmcnt(36)
    s_bitcmp1_b32 s97, 4
    s_mov_b64 exec, 1
    s_cbranch_scc1 .fs_462
    buffer_store_dword v12, v13, s[8:11], s92 offen
.fj_463:
    s_mov_b64 exec, -1
    s_cmp_lt_u32 s25, s96
    s_cbranch_scc1 .os_464
    v_mfma_f32_16x16x16_bf16 v[16:19], v[128:129], v[184:185], v[16:19]
    v_mfma_f32_16x16x16_bf16 v[20:23], v[130:131], v[184:185], v[20:23]
    v_add_u32 v12, 1, v12
    v_mfma_f32_16x16x16_bf16 v[24:27], v[132:133], v[184:185], v[24:27]
    v_mfma_f32_16x16x16_bf16 v[28:31], v[134:135], v[184:185], v[28:31]
    v_mfma_f32_16x16x16_bf16 v[32:35], v[136:137], v[184:185], v[32:35]
    v_mfma_f32_16x16x16_bf16 v[36:39], v[138:139], v[184:185], v[36:39]
    v_cvt_pk_bf16_f32 v208, v16, v17
    v_cvt_pk_bf16_f32 v209, v18, v19
    v_cvt_pk_bf16_f32 v210, v20, v21
    v_cvt_pk_bf16_f32 v211, v22, v23
    buffer_store_dwordx4 v[208:211], v8, s[8:11], s50 offen offset:0
    v_mfma_f32_16x16x16_bf16 v[40:43], v[140:141], v[184:185], v[40:43]
    v_mfma_f32_16x16x16_bf16 v[44:47], v[142:143], v[184:185], v[44:47]
    v_cvt_pk_bf16_f32 v212, v24, v25
    v_cvt_pk_bf16_f32 v213, v26, v27
    v_cvt_pk_bf16_f32 v214, v28, v29
    v_cvt_pk_bf16_f32 v215, v30, v31
    buffer_store_dwordx4 v[212:215], v8, s[8:11], s50 offen offset:1024
    v_mfma_f32_16x16x16_bf16 v[48:51], v[128:129], v[190:191], v[48:51]
    v_mfma_f32_16x16x16_bf16 v[52:55], v[130:131], v[190:191], v[52:55]
    v_cvt_pk_bf16_f32 v216, v32, v33
    v_cvt_pk_bf16_f32 v217, v34, v35
    v_cvt_pk_bf16_f32 v218, v36, v37
    v_cvt_pk_bf16_f32 v219, v38, v39
    buffer_store_dwordx4 v[216:219], v8, s[8:11], s50 offen offset:2048
    v_mfma_f32_16x16x16_bf16 v[56:59], v[132:133], v[190:191], v[56:59]
    v_mfma_f32_16x16x16_bf16 v[60:63], v[134:135], v[190:191], v[60:63]
    v_cvt_pk_bf16_f32 v220, v40, v41
    v_cvt_pk_bf16_f32 v221, v42, v43
    v_cvt_pk_bf16_f32 v222, v44, v45
    v_cvt_pk_bf16_f32 v223, v46, v47
    buffer_store_dwordx4 v[220:223], v8, s[8:11], s50 offen offset:3072
    v_mfma_f32_16x16x16_bf16 v[64:67], v[136:137], v[190:191], v[64:67]
    v_mfma_f32_16x16x16_bf16 v[68:71], v[138:139], v[190:191], v[68:71]
    v_cvt_pk_bf16_f32 v224, v48, v49
    v_cvt_pk_bf16_f32 v225, v50, v51
    v_cvt_pk_bf16_f32 v226, v52, v53
    v_cvt_pk_bf16_f32 v227, v54, v55
    buffer_store_dwordx4 v[224:227], v8, s[8:11], s51 offen offset:0
    v_mfma_f32_16x16x16_bf16 v[72:75], v[140:141], v[190:191], v[72:75]
    v_mfma_f32_16x16x16_bf16 v[76:79], v[142:143], v[190:191], v[76:79]
    v_cvt_pk_bf16_f32 v228, v56, v57
    v_cvt_pk_bf16_f32 v229, v58, v59
    v_cvt_pk_bf16_f32 v230, v60, v61
    v_cvt_pk_bf16_f32 v231, v62, v63
    buffer_store_dwordx4 v[228:231], v8, s[8:11], s51 offen offset:1024
    s_nop 3
    v_cvt_pk_bf16_f32 v232, v64, v65
    v_cvt_pk_bf16_f32 v233, v66, v67
    v_cvt_pk_bf16_f32 v234, v68, v69
    v_cvt_pk_bf16_f32 v235, v70, v71
    buffer_store_dwordx4 v[232:235], v8, s[8:11], s51 offen offset:2048
    v_cvt_pk_bf16_f32 v236, v72, v73
    v_cvt_pk_bf16_f32 v237, v74, v75
    v_cvt_pk_bf16_f32 v238, v76, v77
    v_cvt_pk_bf16_f32 v239, v78, v79
    buffer_store_dwordx4 v[236:239], v8, s[8:11], s51 offen offset:3072
.oj_465:
    s_mov_b32 s34, s33
    s_add_u32 s50, s27, 0
    s_add_u32 s51, s27, 4096
    s_cmp_lt_u32 s25, 60
    s_cselect_b32 s4, 4, 0
    s_cselect_b32 s5, 1048576, 0
    s_cselect_b32 s6, 786432, 0
    s_add_u32 s36, s36, s4
    s_add_u32 s27, s27, s5
    s_add_u32 s33, s33, s6
    s_waitcnt vmcnt(8)

    v_cmp_gt_u32 vcc, s36, v15
    s_cbranch_vccnz .atw_466
.atb_467:
    s_add_u32 s28, s27, 4096
    s_add_u32 s29, s27, 16777216
    s_add_u32 s30, s27, 16781312
    s_add_u32 s31, s27, 33554432
    s_add_u32 s32, s27, 33558528

    buffer_load_dwordx4 a[0:3], v8, s[8:11], s27 offen offset:0
    buffer_load_dwordx4 a[16:19], v8, s[8:11], s28 offen offset:0
    buffer_load_dwordx4 a[32:35], v8, s[8:11], s29 offen offset:0
    buffer_load_dwordx4 a[48:51], v8, s[8:11], s30 offen offset:0
    buffer_load_dwordx4 a[4:7], v8, s[8:11], s27 offen offset:1024
    buffer_load_dwordx4 a[20:23], v8, s[8:11], s28 offen offset:1024
    buffer_load_dwordx4 a[36:39], v8, s[8:11], s29 offen offset:1024
    buffer_load_dwordx4 a[52:55], v8, s[8:11], s30 offen offset:1024
    buffer_load_dwordx4 a[8:11], v8, s[8:11], s27 offen offset:2048
    buffer_load_dwordx4 a[24:27], v8, s[8:11], s28 offen offset:2048
    buffer_load_dwordx4 a[40:43], v8, s[8:11], s29 offen offset:2048
    buffer_load_dwordx4 a[56:59], v8, s[8:11], s30 offen offset:2048
    buffer_load_dwordx4 a[12:15], v8, s[8:11], s27 offen offset:3072
    buffer_load_dwordx4 a[28:31], v8, s[8:11], s28 offen offset:3072
    buffer_load_dwordx4 a[44:47], v8, s[8:11], s29 offen offset:3072
    buffer_load_dwordx4 a[60:63], v8, s[8:11], s30 offen offset:3072
    buffer_load_dwordx4 a[64:67], v8, s[8:11], s31 offen offset:0
    buffer_load_dwordx4 a[68:71], v8, s[8:11], s31 offen offset:1024
    buffer_load_dwordx4 a[72:75], v8, s[8:11], s31 offen offset:2048
    buffer_load_dwordx4 a[76:79], v8, s[8:11], s31 offen offset:3072
    buffer_load_dwordx4 a[80:83], v8, s[8:11], s32 offen offset:0
    buffer_load_dwordx4 a[84:87], v8, s[8:11], s32 offen offset:1024
    buffer_load_dwordx4 a[88:91], v8, s[8:11], s32 offen offset:2048
    buffer_load_dwordx4 a[92:95], v8, s[8:11], s32 offen offset:3072
    buffer_load_dwordx4 v[80:83], v10, s[8:11], s33 offen offset:2048 sc1
    buffer_load_dwordx4 v[84:87], v10, s[8:11], s33 offen offset:2176 sc1
    buffer_load_dwordx4 v[88:91], v10, s[8:11], s33 offen offset:3072 sc1
    buffer_load_dwordx4 v[92:95], v10, s[8:11], s33 offen offset:3200 sc1
    s_add_u32 s4, s33, 4096
    s_mov_b64 exec, s[60:61]
    buffer_load_dwordx2 v[128:129], v11, s[8:11], s4 offen offset:0 sc1
    buffer_load_dwordx2 v[130:131], v11, s[8:11], s4 offen offset:256 sc1
    buffer_load_dwordx2 v[132:133], v11, s[8:11], s4 offen offset:512 sc1
    buffer_load_dwordx2 v[134:135], v11, s[8:11], s4 offen offset:768 sc1
    buffer_load_dwordx2 v[136:137], v11, s[8:11], s4 offen offset:1024 sc1
    buffer_load_dwordx2 v[138:139], v11, s[8:11], s4 offen offset:1280 sc1
    buffer_load_dwordx2 v[140:141], v11, s[8:11], s4 offen offset:1536 sc1
    buffer_load_dwordx2 v[142:143], v11, s[8:11], s4 offen offset:1792 sc1
    s_mov_b64 exec, -1
    v_mfma_f32_16x16x32_bf16 v[144:147], a[128:131], a[96:99], 0
    v_mfma_f32_16x16x32_bf16 v[156:159], a[128:131], a[112:115], 0
    v_mfma_f32_16x16x32_bf16 v[160:163], a[144:147], a[112:115], 0
    v_mfma_f32_16x16x32_bf16 v[144:147], a[132:135], a[100:103], v[144:147]
    v_mfma_f32_16x16x32_bf16 v[156:159], a[132:135], a[116:119], v[156:159]
    v_mfma_f32_16x16x32_bf16 v[160:163], a[148:151], a[116:119], v[160:163]
    v_mfma_f32_16x16x32_bf16 v[144:147], a[136:139], a[104:107], v[144:147]
    v_mfma_f32_16x16x32_bf16 v[156:159], a[136:139], a[120:123], v[156:159]
    v_mfma_f32_16x16x32_bf16 v[160:163], a[152:155], a[120:123], v[160:163]
    v_mfma_f32_16x16x32_bf16 v[144:147], a[140:143], a[108:111], v[144:147]
    v_mfma_f32_16x16x32_bf16 v[156:159], a[140:143], a[124:127], v[156:159]
    v_mfma_f32_16x16x32_bf16 v[160:163], a[156:159], a[124:127], v[160:163]
    s_nop 7
    v_cvt_pk_bf16_f32 v168, v144, v145
    v_cvt_pk_bf16_f32 v170, v146, v147
    v_and_b32 v169, 0xffff0000, v168
    v_lshlrev_b32 v168, 16, v168
    v_and_b32 v171, 0xffff0000, v170
    v_lshlrev_b32 v170, 16, v170
    v_mul_f32 v168, s37, v168
    v_mul_f32 v169, s37, v169
    v_mul_f32 v170, s37, v170
    v_mul_f32 v171, s37, v171
    v_cvt_pk_bf16_f32 v144, v168, v169
    v_cvt_pk_bf16_f32 v146, v170, v171
    v_and_b32 v145, 0xffff0000, v144
    v_lshlrev_b32 v144, 16, v144
    v_and_b32 v147, 0xffff0000, v146
    v_lshlrev_b32 v146, 16, v146
    v_cvt_pk_bf16_f32 v192, v156, v157
    v_cvt_pk_bf16_f32 v194, v158, v159
    v_cvt_pk_bf16_f32 v196, v160, v161
    v_cvt_pk_bf16_f32 v198, v162, v163
    v_and_b32 v193, 0xffff0000, v192
    v_lshlrev_b32 v192, 16, v192
    v_and_b32 v195, 0xffff0000, v194
    v_lshlrev_b32 v194, 16, v194
    v_and_b32 v197, 0xffff0000, v196
    v_lshlrev_b32 v196, 16, v196
    v_and_b32 v199, 0xffff0000, v198
    v_lshlrev_b32 v198, 16, v198
    v_mul_f32 v192, s37, v192
    v_mul_f32 v193, s37, v193
    v_mul_f32 v194, s37, v194
    v_mul_f32 v195, s37, v195
    v_mul_f32 v196, s37, v196
    v_mul_f32 v197, s37, v197
    v_mul_f32 v198, s37, v198
    v_mul_f32 v199, s37, v199
    v_cvt_pk_bf16_f32 v156, v192, v193
    v_cvt_pk_bf16_f32 v158, v194, v195
    v_cvt_pk_bf16_f32 v160, v196, v197
    v_cvt_pk_bf16_f32 v162, v198, v199
    v_and_b32 v157, 0xffff0000, v156
    v_lshlrev_b32 v156, 16, v156
    v_and_b32 v159, 0xffff0000, v158
    v_lshlrev_b32 v158, 16, v158
    v_and_b32 v161, 0xffff0000, v160
    v_lshlrev_b32 v160, 16, v160
    v_and_b32 v163, 0xffff0000, v162
    v_lshlrev_b32 v162, 16, v162
    v_cndmask_b32 v144, v14, v144, s[40:41]
    v_cndmask_b32 v145, v14, v145, s[42:43]
    v_cndmask_b32 v146, v14, v146, s[44:45]
    v_cndmask_b32 v147, v14, v147, s[46:47]
    v_cndmask_b32 v160, v14, v160, s[40:41]
    v_cndmask_b32 v161, v14, v161, s[42:43]
    v_cndmask_b32 v162, v14, v162, s[44:45]
    v_cndmask_b32 v163, v14, v163, s[46:47]
    s_mov_b32 s62, 0
.kmp_468:
    v_max3_u32 v4, v96, v97, v98
    v_max3_u32 v5, v99, v100, v101
    v_max3_u32 v4, v4, v102, v103
    v_max3_u32 v5, v5, v104, v105
    v_max3_u32 v4, v4, v106, v107
    v_max3_u32 v5, v5, v108, v109
    v_max3_u32 v4, v4, v110, v111
    v_max3_u32 v5, v5, v112, v113
    v_max3_u32 v4, v4, v114, v115
    v_max3_u32 v5, v5, v116, v117
    v_max3_u32 v4, v4, v118, v119
    v_max3_u32 v5, v5, v120, v121
    v_max3_u32 v4, v4, v122, v123
    v_max3_u32 v5, v5, v124, v125
    v_max3_u32 v4, v4, v126, v127
    v_max_u32 v4, v4, v5
    v_cmp_eq_u32 vcc, -1, v4
    s_cbranch_vccnz .kmf_469

    v_mfma_f32_16x16x32_bf16 v[152:155], v[96:99], a[96:99], 0
    v_mfma_f32_16x16x32_bf16 v[164:167], v[96:99], a[112:115], 0
    v_mfma_f32_16x16x32_bf16 v[152:155], v[100:103], a[100:103], v[152:155]
    v_mfma_f32_16x16x32_bf16 v[164:167], v[100:103], a[116:119], v[164:167]
    v_mfma_f32_16x16x32_bf16 v[152:155], v[104:107], a[104:107], v[152:155]
    v_mfma_f32_16x16x32_bf16 v[164:167], v[104:107], a[120:123], v[164:167]
    v_mfma_f32_16x16x32_bf16 v[152:155], v[108:111], a[108:111], v[152:155]
    v_mfma_f32_16x16x32_bf16 v[164:167], v[108:111], a[124:127], v[164:167]
    s_nop 5
    v_cvt_pk_bf16_f32 v176, v152, v153
    v_cvt_pk_bf16_f32 v178, v154, v155
    v_and_b32 v177, 0xffff0000, v176
    v_lshlrev_b32 v176, 16, v176
    v_and_b32 v179, 0xffff0000, v178
    v_lshlrev_b32 v178, 16, v178
    v_mul_f32 v176, s37, v176
    v_mul_f32 v177, s37, v177
    v_mul_f32 v178, s37, v178
    v_mul_f32 v179, s37, v179
    v_cvt_pk_bf16_f32 v152, v176, v177
    v_cvt_pk_bf16_f32 v154, v178, v179
    v_and_b32 v153, 0xffff0000, v152
    v_lshlrev_b32 v152, 16, v152
    v_and_b32 v155, 0xffff0000, v154
    v_lshlrev_b32 v154, 16, v154
    v_cndmask_b32 v152, v14, v152, s[60:61]
    v_cndmask_b32 v153, v14, v153, s[60:61]
    v_cndmask_b32 v154, v14, v154, s[60:61]
    v_cndmask_b32 v155, v14, v155, s[60:61]
    v_cvt_pk_bf16_f32 v200, v164, v165
    v_cvt_pk_bf16_f32 v202, v166, v167
    v_and_b32 v201, 0xffff0000, v200
    v_lshlrev_b32 v200, 16, v200
    v_and_b32 v203, 0xffff0000, v202
    v_lshlrev_b32 v202, 16, v202
    v_mul_f32 v200, s37, v200
    v_mul_f32 v201, s37, v201
    v_mul_f32 v202, s37, v202
    v_mul_f32 v203, s37, v203
    v_cvt_pk_bf16_f32 v164, v200, v201
    v_cvt_pk_bf16_f32 v166, v202, v203
    v_and_b32 v165, 0xffff0000, v164
    v_lshlrev_b32 v164, 16, v164
    v_and_b32 v167, 0xffff0000, v166
    v_lshlrev_b32 v166, 16, v166
    v_cndmask_b32 v164, v14, v164, s[60:61]
    v_cndmask_b32 v165, v14, v165, s[60:61]
    v_cndmask_b32 v166, v14, v166, s[60:61]
    v_cndmask_b32 v167, v14, v167, s[60:61]
    v_max3_f32 v4, v144, v145, v146
    v_max3_f32 v5, v147, v152, v153
    v_max3_f32 v4, v4, v154, v155
    v_max_f32 v4, v4, v5

    v_max3_f32 v6, v156, v157, v158
    v_max3_f32 v7, v159, v160, v161
    v_max3_f32 v6, v6, v162, v163
    v_max3_f32 v7, v7, v164, v165
    v_max3_f32 v6, v6, v166, v167
    v_max_f32 v6, v6, v7

    v_mov_b32 v5, v4
    v_mov_b32 v7, v6
    s_nop 0
    v_permlane32_swap_b32 v4, v5
    v_permlane32_swap_b32 v6, v7
    v_max_f32 v4, v4, v5
    v_max_f32 v6, v6, v7

    v_mov_b32 v5, v4
    v_mov_b32 v7, v6
    s_nop 0
    v_permlane16_swap_b32 v4, v5
    v_permlane16_swap_b32 v6, v7
    v_max_f32 v4, v4, v5
    v_max_f32 v6, v6, v7

    v_mul_f32 v4, s38, v4
    v_mul_f32 v6, s38, v6
    v_fma_f32 v168, v144, s38, -v4
    v_fma_f32 v169, v145, s38, -v4
    v_fma_f32 v170, v146, s38, -v4
    v_fma_f32 v171, v147, s38, -v4
    v_fma_f32 v176, v152, s38, -v4
    v_fma_f32 v177, v153, s38, -v4
    v_fma_f32 v178, v154, s38, -v4
    v_fma_f32 v179, v155, s38, -v4
    v_fma_f32 v192, v156, s38, -v6
    v_fma_f32 v193, v157, s38, -v6
    v_fma_f32 v194, v158, s38, -v6
    v_fma_f32 v195, v159, s38, -v6
    v_fma_f32 v196, v160, s38, -v6
    v_fma_f32 v197, v161, s38, -v6
    v_fma_f32 v198, v162, s38, -v6
    v_fma_f32 v199, v163, s38, -v6
    v_fma_f32 v200, v164, s38, -v6
    v_fma_f32 v201, v165, s38, -v6
    v_fma_f32 v202, v166, s38, -v6
    v_fma_f32 v203, v167, s38, -v6
    v_exp_f32 v168, v168
    v_exp_f32 v169, v169
    v_exp_f32 v170, v170
    v_exp_f32 v171, v171
    v_exp_f32 v176, v176
    v_exp_f32 v177, v177
    v_exp_f32 v178, v178
    v_exp_f32 v179, v179
    v_exp_f32 v192, v192
    v_exp_f32 v193, v193
    v_exp_f32 v194, v194
    v_exp_f32 v195, v195
    v_exp_f32 v196, v196
    v_exp_f32 v197, v197
    v_exp_f32 v198, v198
    v_exp_f32 v199, v199
    v_exp_f32 v200, v200
    v_exp_f32 v201, v201
    v_exp_f32 v202, v202
    v_exp_f32 v203, v203
    v_add_f32 v4, v168, v169
    v_add_f32 v5, v170, v171
    v_add_f32 v4, v4, v176
    v_add_f32 v5, v5, v177
    v_add_f32 v4, v4, v178
    v_add_f32 v5, v5, v179
    v_add_f32 v4, v4, v5
    v_add_f32 v6, v192, v193
    v_add_f32 v7, v194, v195
    v_add_f32 v6, v6, v196
    v_add_f32 v7, v7, v197
    v_add_f32 v6, v6, v198
    v_add_f32 v7, v7, v199
    v_add_f32 v6, v6, v200
    v_add_f32 v7, v7, v201
    v_add_f32 v6, v6, v202
    v_add_f32 v7, v7, v203
    v_add_f32 v6, v6, v7
    v_mov_b32 v5, v4
    v_mov_b32 v7, v6
    s_nop 0
    v_permlane32_swap_b32 v4, v5
    v_permlane32_swap_b32 v6, v7
    v_add_f32 v4, v4, v5
    v_add_f32 v6, v6, v7

    v_mov_b32 v5, v4
    v_mov_b32 v7, v6
    s_nop 0
    v_permlane16_swap_b32 v4, v5
    v_permlane16_swap_b32 v6, v7
    v_add_f32 v4, v4, v5
    v_add_f32 v6, v6, v7

    v_rcp_f32 v4, v4
    v_rcp_f32 v6, v6
    v_mov_b32 v182, 0
    v_mov_b32 v183, 0
    v_mul_f32 v168, v4, v168
    v_mul_f32 v169, v4, v169
    v_mul_f32 v170, v4, v170
    v_mul_f32 v171, v4, v171
    v_mul_f32 v176, v4, v176
    v_mul_f32 v177, v4, v177
    v_mul_f32 v178, v4, v178
    v_mul_f32 v179, v4, v179
    v_cvt_pk_bf16_f32 v180, v168, v169
    v_cvt_pk_bf16_f32 v181, v170, v171
    v_cvt_pk_bf16_f32 v184, v176, v177
    v_cvt_pk_bf16_f32 v185, v178, v179
    v_mul_f32 v192, v6, v192
    v_mul_f32 v193, v6, v193
    v_mul_f32 v194, v6, v194
    v_mul_f32 v195, v6, v195
    v_mul_f32 v196, v6, v196
    v_mul_f32 v197, v6, v197
    v_mul_f32 v198, v6, v198
    v_mul_f32 v199, v6, v199
    v_mul_f32 v200, v6, v200
    v_mul_f32 v201, v6, v201
    v_mul_f32 v202, v6, v202
    v_mul_f32 v203, v6, v203
    v_cvt_pk_bf16_f32 v186, v192, v193
    v_cvt_pk_bf16_f32 v187, v194, v195
    v_cvt_pk_bf16_f32 v188, v196, v197
    v_cvt_pk_bf16_f32 v189, v198, v199
    v_cvt_pk_bf16_f32 v190, v200, v201
    v_cvt_pk_bf16_f32 v191, v202, v203
    s_add_u32 s25, s25, 4

    v_mfma_f32_16x16x32_bf16 v[16:19], a[160:163], v[180:183], 0
    v_mfma_f32_16x16x32_bf16 v[20:23], a[164:167], v[180:183], 0
    v_mfma_f32_16x16x32_bf16 v[24:27], a[168:171], v[180:183], 0
    v_mfma_f32_16x16x32_bf16 v[28:31], a[172:175], v[180:183], 0
    v_mfma_f32_16x16x32_bf16 v[32:35], a[176:179], v[180:183], 0
    v_mfma_f32_16x16x32_bf16 v[36:39], a[180:183], v[180:183], 0
    v_mfma_f32_16x16x32_bf16 v[40:43], a[184:187], v[180:183], 0
    v_mfma_f32_16x16x32_bf16 v[44:47], a[188:191], v[180:183], 0
    v_mfma_f32_16x16x32_bf16 v[48:51], a[160:163], v[186:189], 0
    v_mfma_f32_16x16x32_bf16 v[52:55], a[164:167], v[186:189], 0
    v_mfma_f32_16x16x32_bf16 v[56:59], a[168:171], v[186:189], 0
    v_mfma_f32_16x16x32_bf16 v[60:63], a[172:175], v[186:189], 0
    v_mfma_f32_16x16x32_bf16 v[64:67], a[176:179], v[186:189], 0
    v_mfma_f32_16x16x32_bf16 v[68:71], a[180:183], v[186:189], 0
    v_mfma_f32_16x16x32_bf16 v[72:75], a[184:187], v[186:189], 0
    v_mfma_f32_16x16x32_bf16 v[76:79], a[188:191], v[186:189], 0
    s_waitcnt vmcnt(36)
    s_bitcmp1_b32 s97, 4
    s_mov_b64 exec, 1
    s_cbranch_scc1 .fs_470
    buffer_store_dword v12, v13, s[8:11], s92 offen
.fj_471:
    s_mov_b64 exec, -1
    s_cmp_lt_u32 s25, s96
    s_cbranch_scc1 .os_472
    v_mfma_f32_16x16x16_bf16 v[16:19], v[112:113], v[184:185], v[16:19]
    v_mfma_f32_16x16x16_bf16 v[20:23], v[114:115], v[184:185], v[20:23]
    v_add_u32 v12, 1, v12
    v_mfma_f32_16x16x16_bf16 v[24:27], v[116:117], v[184:185], v[24:27]
    v_mfma_f32_16x16x16_bf16 v[28:31], v[118:119], v[184:185], v[28:31]
    v_mfma_f32_16x16x16_bf16 v[32:35], v[120:121], v[184:185], v[32:35]
    v_mfma_f32_16x16x16_bf16 v[36:39], v[122:123], v[184:185], v[36:39]
    v_cvt_pk_bf16_f32 v208, v16, v17
    v_cvt_pk_bf16_f32 v209, v18, v19
    v_cvt_pk_bf16_f32 v210, v20, v21
    v_cvt_pk_bf16_f32 v211, v22, v23
    buffer_store_dwordx4 v[208:211], v8, s[8:11], s50 offen offset:0
    v_mfma_f32_16x16x16_bf16 v[40:43], v[124:125], v[184:185], v[40:43]
    v_mfma_f32_16x16x16_bf16 v[44:47], v[126:127], v[184:185], v[44:47]
    v_cvt_pk_bf16_f32 v212, v24, v25
    v_cvt_pk_bf16_f32 v213, v26, v27
    v_cvt_pk_bf16_f32 v214, v28, v29
    v_cvt_pk_bf16_f32 v215, v30, v31
    buffer_store_dwordx4 v[212:215], v8, s[8:11], s50 offen offset:1024
    v_mfma_f32_16x16x16_bf16 v[48:51], v[112:113], v[190:191], v[48:51]
    v_mfma_f32_16x16x16_bf16 v[52:55], v[114:115], v[190:191], v[52:55]
    v_cvt_pk_bf16_f32 v216, v32, v33
    v_cvt_pk_bf16_f32 v217, v34, v35
    v_cvt_pk_bf16_f32 v218, v36, v37
    v_cvt_pk_bf16_f32 v219, v38, v39
    buffer_store_dwordx4 v[216:219], v8, s[8:11], s50 offen offset:2048
    v_mfma_f32_16x16x16_bf16 v[56:59], v[116:117], v[190:191], v[56:59]
    v_mfma_f32_16x16x16_bf16 v[60:63], v[118:119], v[190:191], v[60:63]
    v_cvt_pk_bf16_f32 v220, v40, v41
    v_cvt_pk_bf16_f32 v221, v42, v43
    v_cvt_pk_bf16_f32 v222, v44, v45
    v_cvt_pk_bf16_f32 v223, v46, v47
    buffer_store_dwordx4 v[220:223], v8, s[8:11], s50 offen offset:3072
    v_mfma_f32_16x16x16_bf16 v[64:67], v[120:121], v[190:191], v[64:67]
    v_mfma_f32_16x16x16_bf16 v[68:71], v[122:123], v[190:191], v[68:71]
    v_cvt_pk_bf16_f32 v224, v48, v49
    v_cvt_pk_bf16_f32 v225, v50, v51
    v_cvt_pk_bf16_f32 v226, v52, v53
    v_cvt_pk_bf16_f32 v227, v54, v55
    buffer_store_dwordx4 v[224:227], v8, s[8:11], s51 offen offset:0
    v_mfma_f32_16x16x16_bf16 v[72:75], v[124:125], v[190:191], v[72:75]
    v_mfma_f32_16x16x16_bf16 v[76:79], v[126:127], v[190:191], v[76:79]
    v_cvt_pk_bf16_f32 v228, v56, v57
    v_cvt_pk_bf16_f32 v229, v58, v59
    v_cvt_pk_bf16_f32 v230, v60, v61
    v_cvt_pk_bf16_f32 v231, v62, v63
    buffer_store_dwordx4 v[228:231], v8, s[8:11], s51 offen offset:1024
    s_nop 3
    v_cvt_pk_bf16_f32 v232, v64, v65
    v_cvt_pk_bf16_f32 v233, v66, v67
    v_cvt_pk_bf16_f32 v234, v68, v69
    v_cvt_pk_bf16_f32 v235, v70, v71
    buffer_store_dwordx4 v[232:235], v8, s[8:11], s51 offen offset:2048
    v_cvt_pk_bf16_f32 v236, v72, v73
    v_cvt_pk_bf16_f32 v237, v74, v75
    v_cvt_pk_bf16_f32 v238, v76, v77
    v_cvt_pk_bf16_f32 v239, v78, v79
    buffer_store_dwordx4 v[236:239], v8, s[8:11], s51 offen offset:3072
.oj_473:
    s_cmp_lt_u32 s25, 64
    s_cbranch_scc1 .att_457
    s_waitcnt vmcnt(0)

    s_bitcmp1_b32 s97, 4
    s_mov_b64 exec, 1
    s_cbranch_scc1 .fs_475
    buffer_store_dword v12, v13, s[8:11], s92 offen
.fj_476:
    s_mov_b64 exec, -1
    s_branch .ate_474
.atw_458:
    s_mov_b32 s62, 0
    s_mov_b64 exec, 7
.wf_477:
    buffer_load_dword v15, v9, s[8:11], s35 offen sc1
    s_waitcnt vmcnt(0)
    v_cmp_gt_u32 vcc, s36, v15
    s_cbranch_vccz .wfd_478
    s_sleep 2
    s_add_u32 s62, s62, 1
    s_cmp_gt_u32 s62, 0x400000
    s_cbranch_scc1 .mg_end_1
    s_branch .wf_477

.wfd_478:
    s_mov_b64 exec, -1
    s_branch .atb_459
.kmf_461:
    s_cmp_lg_u32 s62, 0
    s_cbranch_scc1 .kmn_479
    s_waitcnt vmcnt(36)
    s_bitcmp1_b32 s97, 4
    s_mov_b64 exec, 1
    s_cbranch_scc1 .fs_480
    buffer_store_dword v12, v13, s[8:11], s92 offen
.fj_481:
    s_mov_b64 exec, -1
    s_cmp_lt_u32 s25, 60
    s_cselect_b32 s5, 0, 196608
    s_sub_u32 s5, s34, s5
    s_mov_b64 exec, 15

.kml_482:
    s_sleep 4
    buffer_load_dword v4, v204, s[8:11], s5 offen sc1
    s_add_u32 s62, s62, 1
    s_cmp_gt_u32 s62, 0x200000
    s_cbranch_scc1 .mg_end_1
    s_waitcnt vmcnt(0)
    v_cmp_eq_u32 vcc, -1, v4
    s_cbranch_vccnz .kml_482
    s_mov_b64 exec, -1

.kmn_479:
    s_sleep 1
    buffer_load_dwordx4 v[80:83], v10, s[8:11], s34 offen offset:2048 sc1
    buffer_load_dwordx4 v[84:87], v10, s[8:11], s34 offen offset:2176 sc1
    buffer_load_dwordx4 v[88:91], v10, s[8:11], s34 offen offset:3072 sc1
    buffer_load_dwordx4 v[92:95], v10, s[8:11], s34 offen offset:3200 sc1
    s_add_u32 s4, s34, 4096
    s_mov_b64 exec, s[60:61]
    buffer_load_dwordx2 v[128:129], v11, s[8:11], s4 offen offset:0 sc1
    buffer_load_dwordx2 v[130:131], v11, s[8:11], s4 offen offset:256 sc1
    buffer_load_dwordx2 v[132:133], v11, s[8:11], s4 offen offset:512 sc1
    buffer_load_dwordx2 v[134:135], v11, s[8:11], s4 offen offset:768 sc1
    buffer_load_dwordx2 v[136:137], v11, s[8:11], s4 offen offset:1024 sc1
    buffer_load_dwordx2 v[138:139], v11, s[8:11], s4 offen offset:1280 sc1
    buffer_load_dwordx2 v[140:141], v11, s[8:11], s4 offen offset:1536 sc1
    buffer_load_dwordx2 v[142:143], v11, s[8:11], s4 offen offset:1792 sc1
    s_mov_b64 exec, -1
    s_add_u32 s62, s62, 1
    s_cmp_gt_u32 s62, 0x200000
    s_cbranch_scc1 .mg_end_1
    s_waitcnt vmcnt(0)
    s_branch .kmp_460

.fs_462:
    buffer_store_dword v12, v13, s[8:11], s92 offen sc1
    s_branch .fj_463
.os_464:
    v_mfma_f32_16x16x16_bf16 v[16:19], v[128:129], v[184:185], v[16:19]
    v_mfma_f32_16x16x16_bf16 v[20:23], v[130:131], v[184:185], v[20:23]
    v_add_u32 v12, 1, v12
    v_mfma_f32_16x16x16_bf16 v[24:27], v[132:133], v[184:185], v[24:27]
    v_mfma_f32_16x16x16_bf16 v[28:31], v[134:135], v[184:185], v[28:31]
    v_mfma_f32_16x16x16_bf16 v[32:35], v[136:137], v[184:185], v[32:35]
    v_mfma_f32_16x16x16_bf16 v[36:39], v[138:139], v[184:185], v[36:39]
    v_cvt_pk_bf16_f32 v208, v16, v17
    v_cvt_pk_bf16_f32 v209, v18, v19
    v_cvt_pk_bf16_f32 v210, v20, v21
    v_cvt_pk_bf16_f32 v211, v22, v23
    buffer_store_dwordx4 v[208:211], v8, s[8:11], s50 offen offset:0 sc1
    v_mfma_f32_16x16x16_bf16 v[40:43], v[140:141], v[184:185], v[40:43]
    v_mfma_f32_16x16x16_bf16 v[44:47], v[142:143], v[184:185], v[44:47]
    v_cvt_pk_bf16_f32 v212, v24, v25
    v_cvt_pk_bf16_f32 v213, v26, v27
    v_cvt_pk_bf16_f32 v214, v28, v29
    v_cvt_pk_bf16_f32 v215, v30, v31
    buffer_store_dwordx4 v[212:215], v8, s[8:11], s50 offen offset:1024 sc1
    v_mfma_f32_16x16x16_bf16 v[48:51], v[128:129], v[190:191], v[48:51]
    v_mfma_f32_16x16x16_bf16 v[52:55], v[130:131], v[190:191], v[52:55]
    v_cvt_pk_bf16_f32 v216, v32, v33
    v_cvt_pk_bf16_f32 v217, v34, v35
    v_cvt_pk_bf16_f32 v218, v36, v37
    v_cvt_pk_bf16_f32 v219, v38, v39
    buffer_store_dwordx4 v[216:219], v8, s[8:11], s50 offen offset:2048 sc1
    v_mfma_f32_16x16x16_bf16 v[56:59], v[132:133], v[190:191], v[56:59]
    v_mfma_f32_16x16x16_bf16 v[60:63], v[134:135], v[190:191], v[60:63]
    v_cvt_pk_bf16_f32 v220, v40, v41
    v_cvt_pk_bf16_f32 v221, v42, v43
    v_cvt_pk_bf16_f32 v222, v44, v45
    v_cvt_pk_bf16_f32 v223, v46, v47
    buffer_store_dwordx4 v[220:223], v8, s[8:11], s50 offen offset:3072 sc1
    v_mfma_f32_16x16x16_bf16 v[64:67], v[136:137], v[190:191], v[64:67]
    v_mfma_f32_16x16x16_bf16 v[68:71], v[138:139], v[190:191], v[68:71]
    v_cvt_pk_bf16_f32 v224, v48, v49
    v_cvt_pk_bf16_f32 v225, v50, v51
    v_cvt_pk_bf16_f32 v226, v52, v53
    v_cvt_pk_bf16_f32 v227, v54, v55
    buffer_store_dwordx4 v[224:227], v8, s[8:11], s51 offen offset:0 sc1
    v_mfma_f32_16x16x16_bf16 v[72:75], v[140:141], v[190:191], v[72:75]
    v_mfma_f32_16x16x16_bf16 v[76:79], v[142:143], v[190:191], v[76:79]
    v_cvt_pk_bf16_f32 v228, v56, v57
    v_cvt_pk_bf16_f32 v229, v58, v59
    v_cvt_pk_bf16_f32 v230, v60, v61
    v_cvt_pk_bf16_f32 v231, v62, v63
    buffer_store_dwordx4 v[228:231], v8, s[8:11], s51 offen offset:1024 sc1
    s_nop 3
    v_cvt_pk_bf16_f32 v232, v64, v65
    v_cvt_pk_bf16_f32 v233, v66, v67
    v_cvt_pk_bf16_f32 v234, v68, v69
    v_cvt_pk_bf16_f32 v235, v70, v71
    buffer_store_dwordx4 v[232:235], v8, s[8:11], s51 offen offset:2048 sc1
    v_cvt_pk_bf16_f32 v236, v72, v73
    v_cvt_pk_bf16_f32 v237, v74, v75
    v_cvt_pk_bf16_f32 v238, v76, v77
    v_cvt_pk_bf16_f32 v239, v78, v79
    buffer_store_dwordx4 v[236:239], v8, s[8:11], s51 offen offset:3072 sc1
    s_branch .oj_465
.atw_466:
    s_mov_b32 s62, 0
    s_mov_b64 exec, 7
.wf_483:
    buffer_load_dword v15, v9, s[8:11], s35 offen sc1
    s_waitcnt vmcnt(0)
    v_cmp_gt_u32 vcc, s36, v15
    s_cbranch_vccz .wfd_484
    s_sleep 2
    s_add_u32 s62, s62, 1
    s_cmp_gt_u32 s62, 0x400000
    s_cbranch_scc1 .mg_end_1
    s_branch .wf_483

.wfd_484:
    s_mov_b64 exec, -1
    s_branch .atb_467
.kmf_469:
    s_cmp_lg_u32 s62, 0
    s_cbranch_scc1 .kmn_485
    s_waitcnt vmcnt(36)
    s_bitcmp1_b32 s97, 4
    s_mov_b64 exec, 1
    s_cbranch_scc1 .fs_486
    buffer_store_dword v12, v13, s[8:11], s92 offen
.fj_487:
    s_mov_b64 exec, -1
    s_cmp_lt_u32 s25, 60
    s_cselect_b32 s5, 0, 196608
    s_sub_u32 s5, s34, s5
    s_mov_b64 exec, 15

.kml_488:
    s_sleep 4
    buffer_load_dword v4, v204, s[8:11], s5 offen sc1
    s_add_u32 s62, s62, 1
    s_cmp_gt_u32 s62, 0x200000
    s_cbranch_scc1 .mg_end_1
    s_waitcnt vmcnt(0)
    v_cmp_eq_u32 vcc, -1, v4
    s_cbranch_vccnz .kml_488
    s_mov_b64 exec, -1

.kmn_485:
    s_sleep 1
    buffer_load_dwordx4 v[96:99], v10, s[8:11], s34 offen offset:2048 sc1
    buffer_load_dwordx4 v[100:103], v10, s[8:11], s34 offen offset:2176 sc1
    buffer_load_dwordx4 v[104:107], v10, s[8:11], s34 offen offset:3072 sc1
    buffer_load_dwordx4 v[108:111], v10, s[8:11], s34 offen offset:3200 sc1
    s_add_u32 s4, s34, 4096
    s_mov_b64 exec, s[60:61]
    buffer_load_dwordx2 v[112:113], v11, s[8:11], s4 offen offset:0 sc1
    buffer_load_dwordx2 v[114:115], v11, s[8:11], s4 offen offset:256 sc1
    buffer_load_dwordx2 v[116:117], v11, s[8:11], s4 offen offset:512 sc1
    buffer_load_dwordx2 v[118:119], v11, s[8:11], s4 offen offset:768 sc1
    buffer_load_dwordx2 v[120:121], v11, s[8:11], s4 offen offset:1024 sc1
    buffer_load_dwordx2 v[122:123], v11, s[8:11], s4 offen offset:1280 sc1
    buffer_load_dwordx2 v[124:125], v11, s[8:11], s4 offen offset:1536 sc1
    buffer_load_dwordx2 v[126:127], v11, s[8:11], s4 offen offset:1792 sc1
    s_mov_b64 exec, -1
    s_add_u32 s62, s62, 1
    s_cmp_gt_u32 s62, 0x200000
    s_cbranch_scc1 .mg_end_1
    s_waitcnt vmcnt(0)
    s_branch .kmp_468

.fs_470:
    buffer_store_dword v12, v13, s[8:11], s92 offen sc1
    s_branch .fj_471
.os_472:
    v_mfma_f32_16x16x16_bf16 v[16:19], v[112:113], v[184:185], v[16:19]
    v_mfma_f32_16x16x16_bf16 v[20:23], v[114:115], v[184:185], v[20:23]
    v_add_u32 v12, 1, v12
    v_mfma_f32_16x16x16_bf16 v[24:27], v[116:117], v[184:185], v[24:27]
    v_mfma_f32_16x16x16_bf16 v[28:31], v[118:119], v[184:185], v[28:31]
    v_mfma_f32_16x16x16_bf16 v[32:35], v[120:121], v[184:185], v[32:35]
    v_mfma_f32_16x16x16_bf16 v[36:39], v[122:123], v[184:185], v[36:39]
    v_cvt_pk_bf16_f32 v208, v16, v17
    v_cvt_pk_bf16_f32 v209, v18, v19
    v_cvt_pk_bf16_f32 v210, v20, v21
    v_cvt_pk_bf16_f32 v211, v22, v23
    buffer_store_dwordx4 v[208:211], v8, s[8:11], s50 offen offset:0 sc1
    v_mfma_f32_16x16x16_bf16 v[40:43], v[124:125], v[184:185], v[40:43]
    v_mfma_f32_16x16x16_bf16 v[44:47], v[126:127], v[184:185], v[44:47]
    v_cvt_pk_bf16_f32 v212, v24, v25
    v_cvt_pk_bf16_f32 v213, v26, v27
    v_cvt_pk_bf16_f32 v214, v28, v29
    v_cvt_pk_bf16_f32 v215, v30, v31
    buffer_store_dwordx4 v[212:215], v8, s[8:11], s50 offen offset:1024 sc1
    v_mfma_f32_16x16x16_bf16 v[48:51], v[112:113], v[190:191], v[48:51]
    v_mfma_f32_16x16x16_bf16 v[52:55], v[114:115], v[190:191], v[52:55]
    v_cvt_pk_bf16_f32 v216, v32, v33
    v_cvt_pk_bf16_f32 v217, v34, v35
    v_cvt_pk_bf16_f32 v218, v36, v37
    v_cvt_pk_bf16_f32 v219, v38, v39
    buffer_store_dwordx4 v[216:219], v8, s[8:11], s50 offen offset:2048 sc1
    v_mfma_f32_16x16x16_bf16 v[56:59], v[116:117], v[190:191], v[56:59]
    v_mfma_f32_16x16x16_bf16 v[60:63], v[118:119], v[190:191], v[60:63]
    v_cvt_pk_bf16_f32 v220, v40, v41
    v_cvt_pk_bf16_f32 v221, v42, v43
    v_cvt_pk_bf16_f32 v222, v44, v45
    v_cvt_pk_bf16_f32 v223, v46, v47
    buffer_store_dwordx4 v[220:223], v8, s[8:11], s50 offen offset:3072 sc1
    v_mfma_f32_16x16x16_bf16 v[64:67], v[120:121], v[190:191], v[64:67]
    v_mfma_f32_16x16x16_bf16 v[68:71], v[122:123], v[190:191], v[68:71]
    v_cvt_pk_bf16_f32 v224, v48, v49
    v_cvt_pk_bf16_f32 v225, v50, v51
    v_cvt_pk_bf16_f32 v226, v52, v53
    v_cvt_pk_bf16_f32 v227, v54, v55
    buffer_store_dwordx4 v[224:227], v8, s[8:11], s51 offen offset:0 sc1
    v_mfma_f32_16x16x16_bf16 v[72:75], v[124:125], v[190:191], v[72:75]
    v_mfma_f32_16x16x16_bf16 v[76:79], v[126:127], v[190:191], v[76:79]
    v_cvt_pk_bf16_f32 v228, v56, v57
    v_cvt_pk_bf16_f32 v229, v58, v59
    v_cvt_pk_bf16_f32 v230, v60, v61
    v_cvt_pk_bf16_f32 v231, v62, v63
    buffer_store_dwordx4 v[228:231], v8, s[8:11], s51 offen offset:1024 sc1
    s_nop 3
    v_cvt_pk_bf16_f32 v232, v64, v65
    v_cvt_pk_bf16_f32 v233, v66, v67
    v_cvt_pk_bf16_f32 v234, v68, v69
    v_cvt_pk_bf16_f32 v235, v70, v71
    buffer_store_dwordx4 v[232:235], v8, s[8:11], s51 offen offset:2048 sc1
    v_cvt_pk_bf16_f32 v236, v72, v73
    v_cvt_pk_bf16_f32 v237, v74, v75
    v_cvt_pk_bf16_f32 v238, v76, v77
    v_cvt_pk_bf16_f32 v239, v78, v79
    buffer_store_dwordx4 v[236:239], v8, s[8:11], s51 offen offset:3072 sc1
    s_branch .oj_473
.fs_475:
    buffer_store_dword v12, v13, s[8:11], s92 offen sc1
    s_branch .fj_476
.fs_480:
    buffer_store_dword v12, v13, s[8:11], s92 offen sc1
    s_branch .fj_481
.fs_486:
    buffer_store_dword v12, v13, s[8:11], s92 offen sc1
    s_branch .fj_487
.ate_474:
.mg_end_1:
    s_endpgm
.section .rodata,"a"
.p2align 6
.amdhsa_kernel mega_kernel
  .amdhsa_next_free_vgpr 512
  .amdhsa_next_free_sgpr 102
  .amdhsa_accum_offset 256
  .amdhsa_group_segment_fixed_size 0
  .amdhsa_kernarg_size 136
  .amdhsa_user_sgpr_count 2
  .amdhsa_user_sgpr_kernarg_segment_ptr 1
  .amdhsa_system_sgpr_workgroup_id_x 1
.end_amdhsa_kernel
```

```asm
; @launch kernel=mega_kernel grid=(256,1,1) block=(256,1,1) lds=163840
.amdgcn_target "amdgcn-amd-amdhsa--gfx950"
.text
.globl mega_kernel
.p2align 8
.type mega_kernel,@function
mega_kernel:
    s_cmp_ge_u32 s2, 256
    s_cbranch_scc1 .mg_end_1

    s_load_dwordx4 s[52:55], s[0:1], 120
    s_load_dwordx2 s[40:41], s[0:1], 56
    s_getreg_b32 s3, hwreg(HW_REG_XCC_ID)
    v_and_b32 v1, 63, v0
    v_lshrrev_b32 v4, 6, v0
    s_and_b32 s3, s3, 7
    v_readfirstlane_b32 s24, v4
    s_waitcnt lgkmcnt(0)

    s_mov_b32 s8, s54
    s_and_b32 s9, s55, 0xffff
    s_mov_b32 s10, 0x10000000
    s_mov_b32 s11, 0x00020000

    s_mov_b32 s20, s52
    s_and_b32 s21, s53, 0xffff
    s_mov_b32 s22, 0x100
    s_mov_b32 s23, 0x00020000

    s_mov_b32 s100, s54
    s_cmp_lg_u32 s24, 0
    s_cbranch_scc1 .noat_4
    s_mov_b64 exec, 1
    v_mov_b32 v5, 1
    s_lshl_b32 s4, s3, 2
    s_lshl_b32 s4, s3, 5
    s_add_u32 s4, s4, 28
    v_mov_b32 v6, s4
    buffer_atomic_add v5, v6, s[20:23], 0 offen sc0 sc1
    v_mov_b32 v7, 163776
    s_waitcnt vmcnt(0)
    ds_write_b32 v7, v5
    v_cmp_lt_u32 vcc, 31, v5
    s_cbranch_vccz .nb_5
    v_mov_b32 v6, 136
    buffer_store_dword v7, v6, s[20:23], 0 offen sc1

.nb_5:
    s_waitcnt lgkmcnt(0)
    s_mov_b64 exec, -1

.noat_4:
    s_barrier
    v_mov_b32 v7, 163776
    ds_read_b32 v5, v7
    s_waitcnt lgkmcnt(0)
    v_readfirstlane_b32 s26, v5
    s_mov_b32 s25, s3
    s_mov_b32 s27, 0
    s_mov_b32 s97, 128
    s_cmp_lt_u32 s26, 32
    s_cselect_b32 s99, 1, 0
    s_and_b32 s26, s26, 31

.mg_role_3:
    s_cmp_ge_u32 s25, 4
    s_cbranch_scc1 .mg_bg_2

    s_load_dwordx8 s[44:51], s[0:1], 64
    s_load_dwordx2 s[40:41], s[0:1], 56
    v_and_b32 v1, 63, v0
    v_and_b32 v2, 15, v1
    v_lshrrev_b32 v3, 4, v1

    s_lshr_b32 s79, s26, 2
    s_xor_b32 s63, s26, 4
    s_and_b32 s78, s24, 1
    s_lshl_b32 s34, s25, 19
    s_add_u32 s34, s34, 83886080
    v_lshlrev_b32 v14, 4, v1
    v_lshrrev_b32 v6, 1, v3
    s_sub_u32 s101, 0, s100
    s_and_b32 s101, s101, 0x1fffff
    s_add_u32 s101, s101, 100663296

    v_mov_b32 v188, -1
    v_mov_b32 v189, -1
    v_mov_b32 v190, -1
    v_mov_b32 v191, -1
    s_lshl_b32 s5, s26, 10
    s_add_u32 s5, s5, 40960
    v_add_u32 v235, s5, v14
    s_lshr_b32 s4, s63, 3
    s_mul_i32 s4, s4, 1024
    s_lshl_b32 s5, s63, 9
    s_add_u32 s76, s4, s5
    s_lshl_b32 s5, s26, 9
    s_xor_b32 s5, s5, 1024
    s_lshr_b32 s4, s26, 4
    s_mul_i32 s4, s4, 0
    s_add_u32 s77, s4, s5
    s_add_u32 s77, s77, 20480
    s_sub_u32 s4, s77, s76
    v_and_b32 v4, 31, v1
    v_lshlrev_b32 v236, 4, v4
    v_mad_u32_u24 v236, v6, s4, v236
    v_add_u32 v236, s76, v236
    s_and_b32 s5, s63, 7
    s_lshl_b32 s4, s5, 10
    s_lshr_b32 s5, s63, 3
    s_lshl_b32 s5, s5, 14
    s_add_u32 s4, s4, s5
    s_add_u32 s35, s4, s101
    s_lshl_b32 s5, s25, 16
    v_add_u32 v238, s5, v14
    s_lshl_b32 s4, s25, 3
    s_add_u32 s7, s4, s79
    s_mul_i32 s36, s7, 6144
    s_add_u32 s36, s36, 67108864

    s_cmp_eq_u32 s78, 0
    s_cselect_b64 vcc, -1, 0
    s_lshr_b32 s6, s24, 1
    s_lshl_b32 s4, s6, 17
    s_add_u32 s4, s4, s34
    v_cndmask_b32 v4, v235, v236, vcc
    s_mul_i32 s5, s6, 1048576
    s_lshl_b32 s6, s78, 13
    buffer_store_dwordx4 v[188:191], v4, s[8:11], s4 offen sc1
    s_add_u32 s5, s5, s6
    s_add_u32 s5, s5, s35

    buffer_store_dwordx4 v[188:191], v238, s[8:11], s5 offen sc1
    s_add_u32 s5, s5, 262144
    buffer_store_dwordx4 v[188:191], v238, s[8:11], s5 offen sc1
    s_add_u32 s5, s5, 262144
    s_lshl_b32 s4, s25, 11
    s_lshl_b32 s5, s26, 6
    s_add_u32 s4, s4, s5
    s_lshl_b32 s5, s24, 21
    s_add_u32 s4, s4, s5
    v_lshrrev_b32 v4, 2, v1
    v_and_b32 v5, 3, v1
    v_lshlrev_b32 v5, 4, v5
    v_lshlrev_b32 v6, 13, v4
    v_add_u32 v6, v6, v5
    v_add_u32 v240, s4, v6
    s_lshl_b32 s4, s25, 2
    s_and_b32 s5, s24, 1
    s_lshl_b32 s5, s5, 1
    s_add_u32 s4, s4, s5
    s_lshr_b32 s5, s24, 1
    s_lshl_b32 s80, s5, 1
    s_lshl_b32 s4, s4, 19
    s_lshl_b32 s5, s63, 6
    s_add_u32 s4, s4, s5
    v_xor_b32 v224, 128, v240
    v_lshlrev_b32 v6, 11, v4
    v_add_u32 v6, v6, v5
    v_add_u32 v241, s4, v6
    s_lshl_b32 s98, s24, 15
    s_waitcnt lgkmcnt(0)

    s_add_u32 s80, s80, s79
    s_add_u32 s81, s80, 2
    s_add_u32 s80, s80, 1
    s_and_b32 s80, s80, 3
    s_and_b32 s81, s81, 3
    s_lshl_b32 s80, s80, 18
    s_lshl_b32 s81, s81, 18

    s_barrier
    s_bitcmp1_b32 s26, 0
    s_cbranch_scc1 .po_7
    s_mov_b32 s16, s44
    s_and_b32 s17, s45, 0xffff
    s_mov_b32 s18, 0x800000
    s_mov_b32 s19, 0x00020000

    s_add_u32 m0, s98, 0
    s_mov_b32 s5, 0
    buffer_load_dwordx4 v240, s[16:19], s5 offen  lds

    s_add_u32 m0, s98, 1024
    s_mov_b32 s5, 131072
    buffer_load_dwordx4 v240, s[16:19], s5 offen  lds

    s_add_u32 m0, s98, 2048
    s_mov_b32 s5, 262144
    buffer_load_dwordx4 v240, s[16:19], s5 offen  lds

    s_add_u32 m0, s98, 3072
    s_mov_b32 s5, 393216
    buffer_load_dwordx4 v240, s[16:19], s5 offen  lds

    s_add_u32 m0, s98, 4096
    s_mov_b32 s5, 524288
    buffer_load_dwordx4 v240, s[16:19], s5 offen  lds

    s_add_u32 m0, s98, 5120
    s_mov_b32 s5, 655360
    buffer_load_dwordx4 v240, s[16:19], s5 offen  lds

    s_add_u32 m0, s98, 6144
    s_mov_b32 s5, 786432
    buffer_load_dwordx4 v240, s[16:19], s5 offen  lds

    s_add_u32 m0, s98, 7168
    s_mov_b32 s5, 917504
    buffer_load_dwordx4 v240, s[16:19], s5 offen  lds

    s_branch .pj_8
.po_7:
    s_mov_b32 s16, s44
    s_and_b32 s17, s45, 0xffff
    s_mov_b32 s18, 0x800000
    s_mov_b32 s19, 0x00020000

    s_add_u32 m0, s98, 8192
    s_mov_b32 s5, 1048576
    buffer_load_dwordx4 v240, s[16:19], s5 offen  lds

    s_add_u32 m0, s98, 9216
    s_mov_b32 s5, 1179648
    buffer_load_dwordx4 v240, s[16:19], s5 offen  lds

    s_add_u32 m0, s98, 10240
    s_mov_b32 s5, 1310720
    buffer_load_dwordx4 v240, s[16:19], s5 offen  lds

    s_add_u32 m0, s98, 11264
    s_mov_b32 s5, 1441792
    buffer_load_dwordx4 v240, s[16:19], s5 offen  lds

    s_add_u32 m0, s98, 12288
    s_mov_b32 s5, 1572864
    buffer_load_dwordx4 v240, s[16:19], s5 offen  lds

    s_add_u32 m0, s98, 13312
    s_mov_b32 s5, 1703936
    buffer_load_dwordx4 v240, s[16:19], s5 offen  lds

    s_add_u32 m0, s98, 14336
    s_mov_b32 s5, 1835008
    buffer_load_dwordx4 v240, s[16:19], s5 offen  lds

    s_add_u32 m0, s98, 15360
    s_mov_b32 s5, 1966080
    buffer_load_dwordx4 v240, s[16:19], s5 offen  lds

.pj_8:
    s_waitcnt vmcnt(8)
    s_barrier
    v_mov_b32 v243, s99
    v_mov_b32 v242, 0
    s_cmp_lg_u32 s24, 3
    s_cbranch_scc1 .a1_9
    v_mov_b32 v242, s26
    v_lshlrev_b32 v242, 6, v242
    v_add_u32 v242, s97, v242
    v_and_b32 v242, 255, v242
    s_mov_b64 exec, 1
    buffer_atomic_add v243, v242, s[20:23], 0 offen sc1
    s_mov_b64 exec, -1

.a1_9:
    s_bitcmp1_b32 s26, 0
    s_cbranch_scc1 .po_11
    s_add_u32 m0, s98, 8192
    s_mov_b32 s5, 1048576
    buffer_load_dwordx4 v240, s[16:19], s5 offen  lds

    s_add_u32 m0, s98, 9216
    s_mov_b32 s5, 1179648
    buffer_load_dwordx4 v240, s[16:19], s5 offen  lds

    s_add_u32 m0, s98, 10240
    s_mov_b32 s5, 1310720
    buffer_load_dwordx4 v240, s[16:19], s5 offen  lds

    s_add_u32 m0, s98, 11264
    s_mov_b32 s5, 1441792
    buffer_load_dwordx4 v240, s[16:19], s5 offen  lds

    s_add_u32 m0, s98, 12288
    s_mov_b32 s5, 1572864
    buffer_load_dwordx4 v240, s[16:19], s5 offen  lds

    s_add_u32 m0, s98, 13312
    s_mov_b32 s5, 1703936
    buffer_load_dwordx4 v240, s[16:19], s5 offen  lds

    s_add_u32 m0, s98, 14336
    s_mov_b32 s5, 1835008
    buffer_load_dwordx4 v240, s[16:19], s5 offen  lds

    s_add_u32 m0, s98, 15360
    s_mov_b32 s5, 1966080
    buffer_load_dwordx4 v240, s[16:19], s5 offen  lds

    s_mov_b32 s16, s46
    s_and_b32 s17, s47, 0xffff
    s_mov_b32 s18, 0x800000
    s_mov_b32 s19, 0x00020000

    s_add_u32 m0, s98, 16384
    s_mov_b32 s5, 0
    buffer_load_dwordx4 v240, s[16:19], s5 offen  lds

    s_add_u32 m0, s98, 17408
    s_mov_b32 s5, 131072
    buffer_load_dwordx4 v240, s[16:19], s5 offen  lds

    s_add_u32 m0, s98, 18432
    s_mov_b32 s5, 262144
    buffer_load_dwordx4 v240, s[16:19], s5 offen  lds

    s_add_u32 m0, s98, 19456
    s_mov_b32 s5, 393216
    buffer_load_dwordx4 v240, s[16:19], s5 offen  lds

    s_add_u32 m0, s98, 20480
    s_mov_b32 s5, 524288
    buffer_load_dwordx4 v240, s[16:19], s5 offen  lds

    s_add_u32 m0, s98, 21504
    s_mov_b32 s5, 655360
    buffer_load_dwordx4 v240, s[16:19], s5 offen  lds

    s_add_u32 m0, s98, 22528
    s_mov_b32 s5, 786432
    buffer_load_dwordx4 v240, s[16:19], s5 offen  lds

    s_add_u32 m0, s98, 23552
    s_mov_b32 s5, 917504
    buffer_load_dwordx4 v240, s[16:19], s5 offen  lds

    s_add_u32 m0, s98, 24576
    s_mov_b32 s5, 1048576
    buffer_load_dwordx4 v240, s[16:19], s5 offen  lds

    s_add_u32 m0, s98, 25600
    s_mov_b32 s5, 1179648
    buffer_load_dwordx4 v240, s[16:19], s5 offen  lds

    s_add_u32 m0, s98, 26624
    s_mov_b32 s5, 1310720
    buffer_load_dwordx4 v240, s[16:19], s5 offen  lds

    s_add_u32 m0, s98, 27648
    s_mov_b32 s5, 1441792
    buffer_load_dwordx4 v240, s[16:19], s5 offen  lds

    s_add_u32 m0, s98, 28672
    s_mov_b32 s5, 1572864
    buffer_load_dwordx4 v240, s[16:19], s5 offen  lds

    s_add_u32 m0, s98, 29696
    s_mov_b32 s5, 1703936
    buffer_load_dwordx4 v240, s[16:19], s5 offen  lds

    s_add_u32 m0, s98, 30720
    s_mov_b32 s5, 1835008
    buffer_load_dwordx4 v240, s[16:19], s5 offen  lds

    s_add_u32 m0, s98, 31744
    s_mov_b32 s5, 1966080
    buffer_load_dwordx4 v240, s[16:19], s5 offen  lds

    s_branch .pj_12
.po_11:
    s_add_u32 m0, s98, 0
    s_mov_b32 s5, 0
    buffer_load_dwordx4 v240, s[16:19], s5 offen  lds

    s_add_u32 m0, s98, 1024
    s_mov_b32 s5, 131072
    buffer_load_dwordx4 v240, s[16:19], s5 offen  lds

    s_add_u32 m0, s98, 2048
    s_mov_b32 s5, 262144
    buffer_load_dwordx4 v240, s[16:19], s5 offen  lds

    s_add_u32 m0, s98, 3072
    s_mov_b32 s5, 393216
    buffer_load_dwordx4 v240, s[16:19], s5 offen  lds

    s_add_u32 m0, s98, 4096
    s_mov_b32 s5, 524288
    buffer_load_dwordx4 v240, s[16:19], s5 offen  lds

    s_add_u32 m0, s98, 5120
    s_mov_b32 s5, 655360
    buffer_load_dwordx4 v240, s[16:19], s5 offen  lds

    s_add_u32 m0, s98, 6144
    s_mov_b32 s5, 786432
    buffer_load_dwordx4 v240, s[16:19], s5 offen  lds

    s_add_u32 m0, s98, 7168
    s_mov_b32 s5, 917504
    buffer_load_dwordx4 v240, s[16:19], s5 offen  lds

    s_mov_b32 s16, s46
    s_and_b32 s17, s47, 0xffff
    s_mov_b32 s18, 0x800000
    s_mov_b32 s19, 0x00020000

    s_add_u32 m0, s98, 24576
    s_mov_b32 s5, 1048576
    buffer_load_dwordx4 v240, s[16:19], s5 offen  lds

    s_add_u32 m0, s98, 25600
    s_mov_b32 s5, 1179648
    buffer_load_dwordx4 v240, s[16:19], s5 offen  lds

    s_add_u32 m0, s98, 26624
    s_mov_b32 s5, 1310720
    buffer_load_dwordx4 v240, s[16:19], s5 offen  lds

    s_add_u32 m0, s98, 27648
    s_mov_b32 s5, 1441792
    buffer_load_dwordx4 v240, s[16:19], s5 offen  lds

    s_add_u32 m0, s98, 28672
    s_mov_b32 s5, 1572864
    buffer_load_dwordx4 v240, s[16:19], s5 offen  lds

    s_add_u32 m0, s98, 29696
    s_mov_b32 s5, 1703936
    buffer_load_dwordx4 v240, s[16:19], s5 offen  lds

    s_add_u32 m0, s98, 30720
    s_mov_b32 s5, 1835008
    buffer_load_dwordx4 v240, s[16:19], s5 offen  lds

    s_add_u32 m0, s98, 31744
    s_mov_b32 s5, 1966080
    buffer_load_dwordx4 v240, s[16:19], s5 offen  lds

    s_add_u32 m0, s98, 16384
    s_mov_b32 s5, 0
    buffer_load_dwordx4 v240, s[16:19], s5 offen  lds

    s_add_u32 m0, s98, 17408
    s_mov_b32 s5, 131072
    buffer_load_dwordx4 v240, s[16:19], s5 offen  lds

    s_add_u32 m0, s98, 18432
    s_mov_b32 s5, 262144
    buffer_load_dwordx4 v240, s[16:19], s5 offen  lds

    s_add_u32 m0, s98, 19456
    s_mov_b32 s5, 393216
    buffer_load_dwordx4 v240, s[16:19], s5 offen  lds

    s_add_u32 m0, s98, 20480
    s_mov_b32 s5, 524288
    buffer_load_dwordx4 v240, s[16:19], s5 offen  lds

    s_add_u32 m0, s98, 21504
    s_mov_b32 s5, 655360
    buffer_load_dwordx4 v240, s[16:19], s5 offen  lds

    s_add_u32 m0, s98, 22528
    s_mov_b32 s5, 786432
    buffer_load_dwordx4 v240, s[16:19], s5 offen  lds

    s_add_u32 m0, s98, 23552
    s_mov_b32 s5, 917504
    buffer_load_dwordx4 v240, s[16:19], s5 offen  lds

.pj_12:
    s_mov_b32 s12, s40
    s_and_b32 s13, s41, 0xffff
    s_mov_b32 s14, 0x4000
    s_mov_b32 s15, 0x00020000

    v_bfe_u32 v4, v2, 2, 1
    v_lshrrev_b32 v5, 3, v2
    v_lshrrev_b32 v8, 1, v3
    v_and_b32 v9, 1, v3
    v_lshl_add_u32 v6, v5, 3, v4
    v_lshl_add_u32 v6, v8, 4, v6
    v_lshl_add_u32 v6, v9, 2, v6
    v_lshl_add_u32 v7, v5, 2, v4
    v_lshl_add_u32 v7, v8, 3, v7
    v_lshl_add_u32 v7, v9, 4, v7
    v_and_b32 v5, 3, v2
    v_lshlrev_b32 v5, 3, v5
    v_lshl_add_u32 v6, v6, 6, v5
    v_lshl_add_u32 v7, v7, 6, v5
    v_add_u32 v254, s98, v6
    v_add_u32 v255, s98, v7
    v_sub_u32 v252, v254, v5
    v_and_b32 v5, 1, v2
    v_lshl_add_u32 v252, v5, 5, v252
    v_bfe_u32 v5, v2, 1, 1
    v_lshl_add_u32 v252, v5, 3, v252

    s_and_b32 s96, s26, 3
    s_lshl_b32 s4, s25, 3
    s_add_u32 s7, s4, s79
    s_mul_i32 s5, s24, 5120
    v_add_u32 v8, s5, v14
    v_and_b32 v5, 7, v2
    v_lshrrev_b32 v6, 1, v3
    v_and_b32 v7, 1, v3
    v_lshlrev_b32 v7, 3, v7
    v_lshlrev_b32 v17, 11, v5
    v_lshl_add_u32 v17, v3, 5, v17
    v_lshrrev_b32 v4, 3, v2
    v_lshl_add_u32 v17, v4, 4, v17
    s_lshl_b32 s5, s24, 9
    v_add_u32 v17, s5, v17

    buffer_load_dwordx4 v[20:23], v17, s[12:15], 0 offen offset:0
    buffer_load_dwordx4 v[24:27], v17, s[12:15], 0 offen offset:128
    buffer_load_dwordx4 v[28:31], v17, s[12:15], 0 offen offset:256
    buffer_load_dwordx4 v[32:35], v17, s[12:15], 0 offen offset:384
    v_lshlrev_b32 v4, 7, v2
    v_lshl_add_u32 v18, s26, 10, v4
    v_add_u32 v18, 40960, v18
    v_and_b32 v4, 0x180, v4
    v_add_u32 v4, s76, v4
    v_bfe_u32 v19, v2, 2, 1
    s_sub_u32 s4, s77, s76
    v_mad_u32_u24 v4, v19, s4, v4
    v_cmp_gt_u32 vcc, 8, v2
    s_lshl_b32 s4, s24, 17
    s_add_u32 s4, s4, s34
    v_cndmask_b32 v4, v4, v18, vcc

    v_add_u32 v226, s4, v4

    s_mov_b64 exec, 0xffff
    buffer_load_dword v227, v4, s[8:11], s4 offen
    s_mov_b64 exec, -1
    s_lshl_b32 s4, s79, 12
    s_add_u32 s4, s4, 40960

    s_add_u32 s5, s96, 1
    s_and_b32 s5, s5, 3
    s_lshl_b32 s5, s5, 10
    s_add_u32 s5, s5, s4
    v_add_u32 v232, s5, v14

    s_add_u32 s5, s96, 2
    s_and_b32 s5, s5, 3
    s_lshl_b32 s5, s5, 10
    s_add_u32 s5, s5, s4
    v_add_u32 v233, s5, v14

    s_add_u32 s5, s96, 3
    s_and_b32 s5, s5, 3
    s_lshl_b32 s5, s5, 10
    s_add_u32 s5, s5, s4
    v_add_u32 v234, s5, v14

    s_lshl_b32 s5, s78, 9
    v_lshlrev_b32 v10, 8, v6
    v_lshl_add_u32 v10, v2, 4, v10
    v_add_u32 v10, v10, v7
    v_add_u32 v10, s5, v10
    v_add_u32 v18, 16384, v10
    s_lshl_b32 s5, s26, 10
    s_add_u32 s5, s5, 40960
    v_add_u32 v10, s5, v10
    v_lshlrev_b32 v11, 8, v3
    v_lshl_add_u32 v11, v5, 4, v11
    s_lshr_b32 s4, s96, 1
    s_lshl_b32 s4, s4, 10
    s_and_b32 s5, s96, 1
    s_lshl_b32 s5, s5, 7
    s_add_u32 s4, s4, s5
    s_add_u32 s4, s4, 2048
    v_add_u32 v11, s4, v11
    v_lshlrev_b32 v12, 8, v6
    v_lshl_add_u32 v12, v2, 4, v12
    s_lshl_b32 s4, s96, 9
    s_xor_b32 s4, s4, 5120
    v_add_u32 v12, s4, v12
    v_lshlrev_b32 v13, 7, v3
    v_lshl_add_u32 v13, v5, 4, v13
    v_add_u32 v13, s77, v13
    v_lshlrev_b32 v15, 7, v6
    v_lshl_add_u32 v15, v5, 4, v15
    v_add_u32 v15, v15, v7
    s_lshl_b32 s5, s78, 8
    s_add_u32 s5, s5, s76
    v_add_u32 v15, s5, v15
    v_lshlrev_b32 v16, 8, v6
    v_lshl_add_u32 v16, v2, 4, v16
    v_add_u32 v16, v16, v7
    s_lshl_b32 s5, s24, 9
    v_add_u32 v16, s5, v16
    s_lshl_b32 s5, s24, 11
    v_add_u32 v17, s5, v14
    v_cmp_gt_u32 s[58:59], 8, v2
    v_cmp_gt_u32 s[60:61], 32, v1
    v_mov_b32 v4, 0x4444
    v_mov_b32 v9, 0xeeee
    v_cndmask_b32 v9, v9, v4, s[58:59]
    s_not_b64 s[66:67], s[58:59]
    s_cmp_lt_u32 s24, 2
    s_cselect_b64 s[64:65], s[66:67], s[58:59]
    s_mov_b32 s56, 0x0000ffff
    s_mov_b32 s57, 0x0000ffff
    s_cmp_eq_u32 s24, 1
    s_cselect_b64 vcc, -1, 0
    s_cselect_b64 s[66:67], s[56:57], s[66:67]
    s_lshl_b32 s5, s78, 10
    v_add_u32 v19, s5, v14
    v_cndmask_b32 v11, v11, v12, vcc
    v_cndmask_b32 v235, v235, v236, vcc
    v_mov_b32 v4, 0xff800000
    v_cndmask_b32 v116, 0, v4, s[60:61]
    v_mov_b32 v117, v116
    v_mov_b32 v118, v116
    v_mov_b32 v119, v116
    s_mul_i32 s5, s78, 8192
    v_add_u32 v246, s5, v14
    v_lshlrev_b32 v247, 9, v6
    v_lshl_add_u32 v247, v2, 4, v247
    s_lshl_b32 s5, s78, 8
    s_add_u32 s5, s5, 12288
    v_add_u32 v247, s5, v247
    v_and_b32 v4, 31, v1
    v_lshlrev_b32 v248, 4, v4
    s_lshl_b32 s5, s78, 9
    s_add_u32 s5, s5, 12288
    v_add_u32 v248, s5, v248
    s_lshl_b32 s5, s25, 16
    v_and_b32 v7, 1, v3
    v_lshlrev_b32 v237, 18, v7
    v_lshl_add_u32 v237, v6, 8, v237
    v_lshl_add_u32 v237, v2, 4, v237
    v_add_u32 v237, s5, v237
    s_lshl_b32 s6, s78, 9
    v_add_u32 v237, s6, v237
    s_lshl_b32 s6, s78, 8
    v_lshlrev_b32 v249, 9, v7
    v_lshl_add_u32 v249, v2, 4, v249
    v_add_u32 v249, s6, v249
    v_add_u32 v4, s25, v6
    v_add_u32 v4, 1, v4
    v_and_b32 v4, 3, v4
    v_lshl_add_u32 v239, v4, 16, v249
    s_add_u32 s6, s25, 3
    s_and_b32 s6, s6, 3
    s_lshl_b32 s6, s6, 16
    v_add_u32 v249, s6, v249
    v_and_b32 v4, 1, v5
    v_lshlrev_b32 v4, 4, v4
    v_mov_b32 v6, 0x3f80
    v_lshlrev_b32 v6, v4, v6
    v_lshrrev_b32 v4, 1, v5

    v_cmp_eq_u32 vcc, 0, v4
    s_nop 1
    v_cndmask_b32 v84, 0, v6, vcc
    v_cmp_eq_u32 vcc, 1, v4
    s_nop 1
    v_cndmask_b32 v85, 0, v6, vcc
    v_cmp_eq_u32 vcc, 2, v4
    s_nop 1
    v_cndmask_b32 v86, 0, v6, vcc
    v_cmp_eq_u32 vcc, 3, v4
    s_nop 1
    v_cndmask_b32 v87, 0, v6, vcc
    v_mov_b32 v120, 0x3f803f80
    v_cndmask_b32 v112, 0, v84, s[60:61]
    v_mov_b32 v121, 0x3f803f80
    v_cndmask_b32 v113, 0, v85, s[60:61]
    v_mov_b32 v122, 0x3f803f80
    v_cndmask_b32 v114, 0, v86, s[60:61]
    v_mov_b32 v123, 0x3f803f80
    v_cndmask_b32 v115, 0, v87, s[60:61]
    v_mov_b32 v170, 0
    v_mov_b32 v171, 0
    v_mov_b32 v174, 0
    v_mov_b32 v175, 0
    v_mov_b32 v182, 0
    v_mov_b32 v183, 0
    s_add_u32 s5, s96, 0
    s_and_b32 s5, s5, 3
    s_lshl_b32 s5, s5, 10
    s_add_u32 s5, s5, 20480
    v_add_u32 v228, s5, v14

    s_add_u32 s5, s96, 1
    s_and_b32 s5, s5, 3
    s_lshl_b32 s5, s5, 10
    s_add_u32 s5, s5, 20480
    v_add_u32 v229, s5, v14

    s_add_u32 s5, s96, 2
    s_and_b32 s5, s5, 3
    s_lshl_b32 s5, s5, 10
    s_add_u32 s5, s5, 20480
    v_add_u32 v230, s5, v14

    s_add_u32 s5, s96, 3
    s_and_b32 s5, s5, 3
    s_lshl_b32 s5, s5, 10
    s_add_u32 s5, s5, 20480
    v_add_u32 v231, s5, v14

    s_lshl_b32 s89, s7, 8
    s_add_u32 s89, s89, 92282880
    v_lshlrev_b32 v253, 13, v1
    s_lshl_b32 s4, s7, 13
    s_add_u32 s38, s4, 16777216
    s_lshl_b32 s5, s96, 11
    s_add_u32 s39, s4, s5
    s_add_u32 s30, s39, 17039360
    s_xor_b32 s39, s39, 4096
    s_add_u32 s39, s39, 33554432
    s_lshl_b32 s5, s78, 24
    s_add_u32 s30, s30, s5
    s_lshl_b32 s5, s78, 12
    s_add_u32 s38, s38, s5
    s_add_u32 s90, s5, 20480
    s_lshl_b32 s5, s78, 10
    s_add_u32 s39, s39, s5
    s_add_u32 s91, s5, 28672
    s_mov_b32 s37, 0x3e0293ee
    s_mov_b32 s28, 0

    v_and_b32 v4, 31, v1
    v_lshlrev_b32 v225, 6, v4
    v_lshrrev_b32 v4, 5, v1
    v_lshl_add_u32 v225, v4, 24, v225

    v_mov_b32 v52, 0
    v_mov_b32 v53, 0
    v_mov_b32 v54, 0
    v_mov_b32 v55, 0
    v_mov_b32 v56, 0
    v_mov_b32 v57, 0
    v_mov_b32 v58, 0
    v_mov_b32 v59, 0
    v_mov_b32 v60, 0
    v_mov_b32 v61, 0
    v_mov_b32 v62, 0
    v_mov_b32 v63, 0
    v_mov_b32 v64, 0
    v_mov_b32 v65, 0
    v_mov_b32 v66, 0
    v_mov_b32 v67, 0
    v_mov_b32 v68, 0
    v_mov_b32 v69, 0
    v_mov_b32 v70, 0
    v_mov_b32 v71, 0
    v_mov_b32 v72, 0
    v_mov_b32 v73, 0
    v_mov_b32 v74, 0
    v_mov_b32 v75, 0
    v_mov_b32 v76, 0
    v_mov_b32 v77, 0
    v_mov_b32 v78, 0
    v_mov_b32 v79, 0
    v_mov_b32 v80, 0
    v_mov_b32 v81, 0
    v_mov_b32 v82, 0
    v_mov_b32 v83, 0
    v_mov_b32 v92, -1
    v_mov_b32 v93, -1
    v_mov_b32 v94, -1
    v_mov_b32 v95, -1
    v_mov_b32 v96, -1
    v_mov_b32 v97, -1
    v_mov_b32 v98, -1
    v_mov_b32 v99, -1
    v_mov_b32 v100, -1
    v_mov_b32 v101, -1
    v_mov_b32 v102, -1
    v_mov_b32 v103, -1
    v_mov_b32 v192, -1
    v_mov_b32 v193, -1
    v_mov_b32 v194, -1
    v_mov_b32 v195, -1
    v_mov_b32 v196, -1
    v_mov_b32 v197, -1
    v_mov_b32 v198, -1
    v_mov_b32 v199, -1
    v_mov_b32 v200, -1
    v_mov_b32 v201, -1
    v_mov_b32 v202, -1
    v_mov_b32 v203, -1
    v_mov_b32 v204, -1
    v_mov_b32 v205, -1
    v_mov_b32 v206, -1
    v_mov_b32 v207, -1
    v_mov_b32 v208, -1
    v_mov_b32 v209, -1
    v_mov_b32 v210, -1
    v_mov_b32 v211, -1
    v_mov_b32 v212, -1
    v_mov_b32 v213, -1
    v_mov_b32 v214, -1
    v_mov_b32 v215, -1
    v_mov_b32 v216, -1
    v_mov_b32 v217, -1
    v_mov_b32 v218, -1
    v_mov_b32 v219, -1
    v_mov_b32 v220, -1
    v_mov_b32 v221, -1
    v_mov_b32 v222, -1
    v_mov_b32 v223, -1
    s_bitcmp1_b32 s26, 0
    s_cbranch_scc1 .po_13
    s_waitcnt vmcnt(29)
    ds_read_b64_tr_b16 a[0:1], v252 offset:0
    ds_read_b64_tr_b16 a[2:3], v252 offset:128
    ds_read_b64_tr_b16 a[4:5], v252 offset:2048
    ds_read_b64_tr_b16 a[6:7], v252 offset:2176
    ds_read_b64_tr_b16 a[8:9], v252 offset:4096
    ds_read_b64_tr_b16 a[10:11], v252 offset:4224
    ds_read_b64_tr_b16 a[12:13], v252 offset:6144
    ds_read_b64_tr_b16 a[14:15], v252 offset:6272
    ds_read_b64_tr_b16 a[32:33], v252 offset:16
    ds_read_b64_tr_b16 a[34:35], v252 offset:144
    ds_read_b64_tr_b16 a[36:37], v252 offset:2064
    ds_read_b64_tr_b16 a[38:39], v252 offset:2192
    ds_read_b64_tr_b16 a[40:41], v252 offset:4112
    ds_read_b64_tr_b16 a[42:43], v252 offset:4240
    ds_read_b64_tr_b16 a[44:45], v252 offset:6160
    ds_read_b64_tr_b16 a[46:47], v252 offset:6288
    s_waitcnt lgkmcnt(0)
    s_mov_b32 s16, s48
    s_and_b32 s17, s49, 0xffff
    s_mov_b32 s18, 0x800000
    s_mov_b32 s19, 0x00020000

    s_add_u32 m0, s98, 0
    s_mov_b32 s5, 0
    buffer_load_dwordx4 v224, s[16:19], s5 offen  lds

    s_add_u32 m0, s98, 1024
    s_mov_b32 s5, 131072
    buffer_load_dwordx4 v224, s[16:19], s5 offen  lds

    s_add_u32 m0, s98, 2048
    s_mov_b32 s5, 262144
    buffer_load_dwordx4 v224, s[16:19], s5 offen  lds

    s_add_u32 m0, s98, 3072
    s_mov_b32 s5, 393216
    buffer_load_dwordx4 v224, s[16:19], s5 offen  lds

    s_add_u32 m0, s98, 4096
    s_mov_b32 s5, 524288
    buffer_load_dwordx4 v224, s[16:19], s5 offen  lds

    s_add_u32 m0, s98, 5120
    s_mov_b32 s5, 655360
    buffer_load_dwordx4 v224, s[16:19], s5 offen  lds

    s_add_u32 m0, s98, 6144
    s_mov_b32 s5, 786432
    buffer_load_dwordx4 v224, s[16:19], s5 offen  lds

    s_add_u32 m0, s98, 7168
    s_mov_b32 s5, 917504
    buffer_load_dwordx4 v224, s[16:19], s5 offen  lds

    s_waitcnt vmcnt(29)
    ds_read_b64_tr_b16 a[16:17], v252 offset:8192
    ds_read_b64_tr_b16 a[18:19], v252 offset:8320
    ds_read_b64_tr_b16 a[20:21], v252 offset:10240
    ds_read_b64_tr_b16 a[22:23], v252 offset:10368
    ds_read_b64_tr_b16 a[24:25], v252 offset:12288
    ds_read_b64_tr_b16 a[26:27], v252 offset:12416
    ds_read_b64_tr_b16 a[28:29], v252 offset:14336
    ds_read_b64_tr_b16 a[30:31], v252 offset:14464
    ds_read_b64_tr_b16 a[48:49], v252 offset:8208
    ds_read_b64_tr_b16 a[50:51], v252 offset:8336
    ds_read_b64_tr_b16 a[52:53], v252 offset:10256
    ds_read_b64_tr_b16 a[54:55], v252 offset:10384
    ds_read_b64_tr_b16 a[56:57], v252 offset:12304
    ds_read_b64_tr_b16 a[58:59], v252 offset:12432
    ds_read_b64_tr_b16 a[60:61], v252 offset:14352
    ds_read_b64_tr_b16 a[62:63], v252 offset:14480
    s_waitcnt lgkmcnt(0)
    s_add_u32 m0, s98, 8192
    s_mov_b32 s5, 1048576
    buffer_load_dwordx4 v224, s[16:19], s5 offen  lds

    s_add_u32 m0, s98, 9216
    s_mov_b32 s5, 1179648
    buffer_load_dwordx4 v224, s[16:19], s5 offen  lds

    s_add_u32 m0, s98, 10240
    s_mov_b32 s5, 1310720
    buffer_load_dwordx4 v224, s[16:19], s5 offen  lds

    s_add_u32 m0, s98, 11264
    s_mov_b32 s5, 1441792
    buffer_load_dwordx4 v224, s[16:19], s5 offen  lds

    s_add_u32 m0, s98, 12288
    s_mov_b32 s5, 1572864
    buffer_load_dwordx4 v224, s[16:19], s5 offen  lds

    s_add_u32 m0, s98, 13312
    s_mov_b32 s5, 1703936
    buffer_load_dwordx4 v224, s[16:19], s5 offen  lds

    s_add_u32 m0, s98, 14336
    s_mov_b32 s5, 1835008
    buffer_load_dwordx4 v224, s[16:19], s5 offen  lds

    s_add_u32 m0, s98, 15360
    s_mov_b32 s5, 1966080
    buffer_load_dwordx4 v224, s[16:19], s5 offen  lds

    s_waitcnt vmcnt(29)
    ds_read_b64_tr_b16 a[64:65], v252 offset:16384
    ds_read_b64_tr_b16 a[66:67], v252 offset:16512
    ds_read_b64_tr_b16 a[68:69], v252 offset:18432
    ds_read_b64_tr_b16 a[70:71], v252 offset:18560
    ds_read_b64_tr_b16 a[72:73], v252 offset:20480
    ds_read_b64_tr_b16 a[74:75], v252 offset:20608
    ds_read_b64_tr_b16 a[76:77], v252 offset:22528
    ds_read_b64_tr_b16 a[78:79], v252 offset:22656
    ds_read_b64_tr_b16 a[96:97], v252 offset:16400
    ds_read_b64_tr_b16 a[98:99], v252 offset:16528
    ds_read_b64_tr_b16 a[100:101], v252 offset:18448
    ds_read_b64_tr_b16 a[102:103], v252 offset:18576
    ds_read_b64_tr_b16 a[104:105], v252 offset:20496
    ds_read_b64_tr_b16 a[106:107], v252 offset:20624
    ds_read_b64_tr_b16 a[108:109], v252 offset:22544
    ds_read_b64_tr_b16 a[110:111], v252 offset:22672
    s_waitcnt lgkmcnt(0)
    s_mov_b32 s16, s50
    s_and_b32 s17, s51, 0xffff
    s_mov_b32 s18, 0x800000
    s_mov_b32 s19, 0x00020000

    s_add_u32 m0, s98, 16384
    s_add_u32 s5, s80, 0
    buffer_load_dwordx4 v241, s[16:19], s5 offen  lds

    s_add_u32 m0, s98, 17408
    s_add_u32 s5, s80, 32768
    buffer_load_dwordx4 v241, s[16:19], s5 offen  lds

    s_add_u32 m0, s98, 18432
    s_add_u32 s5, s80, 65536
    buffer_load_dwordx4 v241, s[16:19], s5 offen  lds

    s_add_u32 m0, s98, 19456
    s_add_u32 s5, s80, 98304
    buffer_load_dwordx4 v241, s[16:19], s5 offen  lds

    s_add_u32 m0, s98, 20480
    s_add_u32 s5, s80, 131072
    buffer_load_dwordx4 v241, s[16:19], s5 offen  lds

    s_add_u32 m0, s98, 21504
    s_add_u32 s5, s80, 163840
    buffer_load_dwordx4 v241, s[16:19], s5 offen  lds

    s_add_u32 m0, s98, 22528
    s_add_u32 s5, s80, 196608
    buffer_load_dwordx4 v241, s[16:19], s5 offen  lds

    s_add_u32 m0, s98, 23552
    s_add_u32 s5, s80, 229376
    buffer_load_dwordx4 v241, s[16:19], s5 offen  lds

    s_waitcnt vmcnt(29)
    ds_read_b64_tr_b16 a[80:81], v252 offset:24576
    ds_read_b64_tr_b16 a[82:83], v252 offset:24704
    ds_read_b64_tr_b16 a[84:85], v252 offset:26624
    ds_read_b64_tr_b16 a[86:87], v252 offset:26752
    ds_read_b64_tr_b16 a[88:89], v252 offset:28672
    ds_read_b64_tr_b16 a[90:91], v252 offset:28800
    ds_read_b64_tr_b16 a[92:93], v252 offset:30720
    ds_read_b64_tr_b16 a[94:95], v252 offset:30848
    ds_read_b64_tr_b16 a[112:113], v252 offset:24592
    ds_read_b64_tr_b16 a[114:115], v252 offset:24720
    ds_read_b64_tr_b16 a[116:117], v252 offset:26640
    ds_read_b64_tr_b16 a[118:119], v252 offset:26768
    ds_read_b64_tr_b16 a[120:121], v252 offset:28688
    ds_read_b64_tr_b16 a[122:123], v252 offset:28816
    ds_read_b64_tr_b16 a[124:125], v252 offset:30736
    ds_read_b64_tr_b16 a[126:127], v252 offset:30864
    s_waitcnt lgkmcnt(0)
    s_add_u32 m0, s98, 24576
    s_add_u32 s5, s81, 0
    buffer_load_dwordx4 v241, s[16:19], s5 offen  lds

    s_add_u32 m0, s98, 25600
    s_add_u32 s5, s81, 32768
    buffer_load_dwordx4 v241, s[16:19], s5 offen  lds

    s_add_u32 m0, s98, 26624
    s_add_u32 s5, s81, 65536
    buffer_load_dwordx4 v241, s[16:19], s5 offen  lds

    s_add_u32 m0, s98, 27648
    s_add_u32 s5, s81, 98304
    buffer_load_dwordx4 v241, s[16:19], s5 offen  lds

    s_add_u32 m0, s98, 28672
    s_add_u32 s5, s81, 131072
    buffer_load_dwordx4 v241, s[16:19], s5 offen  lds

    s_add_u32 m0, s98, 29696
    s_add_u32 s5, s81, 163840
    buffer_load_dwordx4 v241, s[16:19], s5 offen  lds

    s_add_u32 m0, s98, 30720
    s_add_u32 s5, s81, 196608
    buffer_load_dwordx4 v241, s[16:19], s5 offen  lds

    s_add_u32 m0, s98, 31744
    s_add_u32 s5, s81, 229376
    buffer_load_dwordx4 v241, s[16:19], s5 offen  lds

    v_and_b32 v241, 3, v0
    v_lshlrev_b32 v241, 2, v241

    v_and_b32 v240, 12, v0
    v_lshl_add_u32 v241, v240, 4, v241
    v_add_u32 v241, s97, v241
    v_and_b32 v241, 255, v241

    buffer_load_dword v240, v241, s[20:23], 0 offen sc1
    s_waitcnt vmcnt(25)
    ds_read_b64_tr_b16 a[128:129], v254 offset:0
    ds_read_b64_tr_b16 a[130:131], v254 offset:128
    ds_read_b64_tr_b16 a[132:133], v254 offset:2048
    ds_read_b64_tr_b16 a[134:135], v254 offset:2176
    ds_read_b64_tr_b16 a[136:137], v254 offset:4096
    ds_read_b64_tr_b16 a[138:139], v254 offset:4224
    ds_read_b64_tr_b16 a[140:141], v254 offset:6144
    ds_read_b64_tr_b16 a[142:143], v254 offset:6272
    ds_read_b64_tr_b16 a[160:161], v254 offset:32
    ds_read_b64_tr_b16 a[162:163], v254 offset:160
    ds_read_b64_tr_b16 a[164:165], v254 offset:2080
    ds_read_b64_tr_b16 a[166:167], v254 offset:2208
    ds_read_b64_tr_b16 a[168:169], v254 offset:4128
    ds_read_b64_tr_b16 a[170:171], v254 offset:4256
    ds_read_b64_tr_b16 a[172:173], v254 offset:6176
    ds_read_b64_tr_b16 a[174:175], v254 offset:6304
    s_waitcnt vmcnt(17)
    ds_read_b64_tr_b16 a[144:145], v254 offset:8192
    ds_read_b64_tr_b16 a[146:147], v254 offset:8320
    ds_read_b64_tr_b16 a[148:149], v254 offset:10240
    ds_read_b64_tr_b16 a[150:151], v254 offset:10368
    ds_read_b64_tr_b16 a[152:153], v254 offset:12288
    ds_read_b64_tr_b16 a[154:155], v254 offset:12416
    ds_read_b64_tr_b16 a[156:157], v254 offset:14336
    ds_read_b64_tr_b16 a[158:159], v254 offset:14464
    ds_read_b64_tr_b16 a[176:177], v254 offset:8224
    ds_read_b64_tr_b16 a[178:179], v254 offset:8352
    ds_read_b64_tr_b16 a[180:181], v254 offset:10272
    ds_read_b64_tr_b16 a[182:183], v254 offset:10400
    ds_read_b64_tr_b16 a[184:185], v254 offset:12320
    ds_read_b64_tr_b16 a[186:187], v254 offset:12448
    ds_read_b64_tr_b16 a[188:189], v254 offset:14368
    ds_read_b64_tr_b16 a[190:191], v254 offset:14496
    s_waitcnt vmcnt(9)
    s_mov_b64 exec, 0xffff
    s_mov_b32 exec_hi, 0
    buffer_load_dword v227, v226, s[8:11], 0 offen
    s_mov_b64 exec, -1
    ds_read_b64_tr_b16 a[192:193], v255 offset:16384
    ds_read_b64_tr_b16 a[194:195], v255 offset:16512
    ds_read_b64_tr_b16 a[196:197], v255 offset:18432
    ds_read_b64_tr_b16 a[198:199], v255 offset:18560
    ds_read_b64_tr_b16 a[200:201], v255 offset:20480
    ds_read_b64_tr_b16 a[202:203], v255 offset:20608
    ds_read_b64_tr_b16 a[204:205], v255 offset:22528
    ds_read_b64_tr_b16 a[206:207], v255 offset:22656
    ds_read_b64_tr_b16 a[224:225], v255 offset:16416
    ds_read_b64_tr_b16 a[226:227], v255 offset:16544
    ds_read_b64_tr_b16 a[228:229], v255 offset:18464
    ds_read_b64_tr_b16 a[230:231], v255 offset:18592
    ds_read_b64_tr_b16 a[232:233], v255 offset:20512
    ds_read_b64_tr_b16 a[234:235], v255 offset:20640
    ds_read_b64_tr_b16 a[236:237], v255 offset:22560
    ds_read_b64_tr_b16 a[238:239], v255 offset:22688
    s_waitcnt vmcnt(2)
    ds_read_b64_tr_b16 a[208:209], v255 offset:24576
    ds_read_b64_tr_b16 a[210:211], v255 offset:24704
    ds_read_b64_tr_b16 a[212:213], v255 offset:26624
    ds_read_b64_tr_b16 a[214:215], v255 offset:26752
    ds_read_b64_tr_b16 a[216:217], v255 offset:28672
    ds_read_b64_tr_b16 a[218:219], v255 offset:28800
    ds_read_b64_tr_b16 a[220:221], v255 offset:30720
    ds_read_b64_tr_b16 a[222:223], v255 offset:30848
    ds_read_b64_tr_b16 a[240:241], v255 offset:24608
    ds_read_b64_tr_b16 a[242:243], v255 offset:24736
    ds_read_b64_tr_b16 a[244:245], v255 offset:26656
    ds_read_b64_tr_b16 a[246:247], v255 offset:26784
    ds_read_b64_tr_b16 a[248:249], v255 offset:28704
    ds_read_b64_tr_b16 a[250:251], v255 offset:28832
    ds_read_b64_tr_b16 a[252:253], v255 offset:30752
    ds_read_b64_tr_b16 a[254:255], v255 offset:30880
    s_branch .pj_14
.po_13:
    s_waitcnt vmcnt(29)
    ds_read_b64_tr_b16 a[16:17], v252 offset:8192
    ds_read_b64_tr_b16 a[18:19], v252 offset:8320
    ds_read_b64_tr_b16 a[20:21], v252 offset:10240
    ds_read_b64_tr_b16 a[22:23], v252 offset:10368
    ds_read_b64_tr_b16 a[24:25], v252 offset:12288
    ds_read_b64_tr_b16 a[26:27], v252 offset:12416
    ds_read_b64_tr_b16 a[28:29], v252 offset:14336
    ds_read_b64_tr_b16 a[30:31], v252 offset:14464
    ds_read_b64_tr_b16 a[48:49], v252 offset:8208
    ds_read_b64_tr_b16 a[50:51], v252 offset:8336
    ds_read_b64_tr_b16 a[52:53], v252 offset:10256
    ds_read_b64_tr_b16 a[54:55], v252 offset:10384
    ds_read_b64_tr_b16 a[56:57], v252 offset:12304
    ds_read_b64_tr_b16 a[58:59], v252 offset:12432
    ds_read_b64_tr_b16 a[60:61], v252 offset:14352
    ds_read_b64_tr_b16 a[62:63], v252 offset:14480
    s_waitcnt lgkmcnt(0)
    s_mov_b32 s16, s48
    s_and_b32 s17, s49, 0xffff
    s_mov_b32 s18, 0x800000
    s_mov_b32 s19, 0x00020000

    s_add_u32 m0, s98, 8192
    s_mov_b32 s5, 1048576
    buffer_load_dwordx4 v224, s[16:19], s5 offen  lds

    s_add_u32 m0, s98, 9216
    s_mov_b32 s5, 1179648
    buffer_load_dwordx4 v224, s[16:19], s5 offen  lds

    s_add_u32 m0, s98, 10240
    s_mov_b32 s5, 1310720
    buffer_load_dwordx4 v224, s[16:19], s5 offen  lds

    s_add_u32 m0, s98, 11264
    s_mov_b32 s5, 1441792
    buffer_load_dwordx4 v224, s[16:19], s5 offen  lds

    s_add_u32 m0, s98, 12288
    s_mov_b32 s5, 1572864
    buffer_load_dwordx4 v224, s[16:19], s5 offen  lds

    s_add_u32 m0, s98, 13312
    s_mov_b32 s5, 1703936
    buffer_load_dwordx4 v224, s[16:19], s5 offen  lds

    s_add_u32 m0, s98, 14336
    s_mov_b32 s5, 1835008
    buffer_load_dwordx4 v224, s[16:19], s5 offen  lds

    s_add_u32 m0, s98, 15360
    s_mov_b32 s5, 1966080
    buffer_load_dwordx4 v224, s[16:19], s5 offen  lds

    s_waitcnt vmcnt(29)
    ds_read_b64_tr_b16 a[0:1], v252 offset:0
    ds_read_b64_tr_b16 a[2:3], v252 offset:128
    ds_read_b64_tr_b16 a[4:5], v252 offset:2048
    ds_read_b64_tr_b16 a[6:7], v252 offset:2176
    ds_read_b64_tr_b16 a[8:9], v252 offset:4096
    ds_read_b64_tr_b16 a[10:11], v252 offset:4224
    ds_read_b64_tr_b16 a[12:13], v252 offset:6144
    ds_read_b64_tr_b16 a[14:15], v252 offset:6272
    ds_read_b64_tr_b16 a[32:33], v252 offset:16
    ds_read_b64_tr_b16 a[34:35], v252 offset:144
    ds_read_b64_tr_b16 a[36:37], v252 offset:2064
    ds_read_b64_tr_b16 a[38:39], v252 offset:2192
    ds_read_b64_tr_b16 a[40:41], v252 offset:4112
    ds_read_b64_tr_b16 a[42:43], v252 offset:4240
    ds_read_b64_tr_b16 a[44:45], v252 offset:6160
    ds_read_b64_tr_b16 a[46:47], v252 offset:6288
    s_waitcnt lgkmcnt(0)
    s_add_u32 m0, s98, 0
    s_mov_b32 s5, 0
    buffer_load_dwordx4 v224, s[16:19], s5 offen  lds

    s_add_u32 m0, s98, 1024
    s_mov_b32 s5, 131072
    buffer_load_dwordx4 v224, s[16:19], s5 offen  lds

    s_add_u32 m0, s98, 2048
    s_mov_b32 s5, 262144
    buffer_load_dwordx4 v224, s[16:19], s5 offen  lds

    s_add_u32 m0, s98, 3072
    s_mov_b32 s5, 393216
    buffer_load_dwordx4 v224, s[16:19], s5 offen  lds

    s_add_u32 m0, s98, 4096
    s_mov_b32 s5, 524288
    buffer_load_dwordx4 v224, s[16:19], s5 offen  lds

    s_add_u32 m0, s98, 5120
    s_mov_b32 s5, 655360
    buffer_load_dwordx4 v224, s[16:19], s5 offen  lds

    s_add_u32 m0, s98, 6144
    s_mov_b32 s5, 786432
    buffer_load_dwordx4 v224, s[16:19], s5 offen  lds

    s_add_u32 m0, s98, 7168
    s_mov_b32 s5, 917504
    buffer_load_dwordx4 v224, s[16:19], s5 offen  lds

    s_waitcnt vmcnt(29)
    ds_read_b64_tr_b16 a[80:81], v252 offset:24576
    ds_read_b64_tr_b16 a[82:83], v252 offset:24704
    ds_read_b64_tr_b16 a[84:85], v252 offset:26624
    ds_read_b64_tr_b16 a[86:87], v252 offset:26752
    ds_read_b64_tr_b16 a[88:89], v252 offset:28672
    ds_read_b64_tr_b16 a[90:91], v252 offset:28800
    ds_read_b64_tr_b16 a[92:93], v252 offset:30720
    ds_read_b64_tr_b16 a[94:95], v252 offset:30848
    ds_read_b64_tr_b16 a[112:113], v252 offset:24592
    ds_read_b64_tr_b16 a[114:115], v252 offset:24720
    ds_read_b64_tr_b16 a[116:117], v252 offset:26640
    ds_read_b64_tr_b16 a[118:119], v252 offset:26768
    ds_read_b64_tr_b16 a[120:121], v252 offset:28688
    ds_read_b64_tr_b16 a[122:123], v252 offset:28816
    ds_read_b64_tr_b16 a[124:125], v252 offset:30736
    ds_read_b64_tr_b16 a[126:127], v252 offset:30864
    s_waitcnt lgkmcnt(0)
    s_mov_b32 s16, s50
    s_and_b32 s17, s51, 0xffff
    s_mov_b32 s18, 0x800000
    s_mov_b32 s19, 0x00020000

    s_add_u32 m0, s98, 24576
    s_add_u32 s5, s81, 0
    buffer_load_dwordx4 v241, s[16:19], s5 offen  lds

    s_add_u32 m0, s98, 25600
    s_add_u32 s5, s81, 32768
    buffer_load_dwordx4 v241, s[16:19], s5 offen  lds

    s_add_u32 m0, s98, 26624
    s_add_u32 s5, s81, 65536
    buffer_load_dwordx4 v241, s[16:19], s5 offen  lds

    s_add_u32 m0, s98, 27648
    s_add_u32 s5, s81, 98304
    buffer_load_dwordx4 v241, s[16:19], s5 offen  lds

    s_add_u32 m0, s98, 28672
    s_add_u32 s5, s81, 131072
    buffer_load_dwordx4 v241, s[16:19], s5 offen  lds

    s_add_u32 m0, s98, 29696
    s_add_u32 s5, s81, 163840
    buffer_load_dwordx4 v241, s[16:19], s5 offen  lds

    s_add_u32 m0, s98, 30720
    s_add_u32 s5, s81, 196608
    buffer_load_dwordx4 v241, s[16:19], s5 offen  lds

    s_add_u32 m0, s98, 31744
    s_add_u32 s5, s81, 229376
    buffer_load_dwordx4 v241, s[16:19], s5 offen  lds

    s_waitcnt vmcnt(29)
    ds_read_b64_tr_b16 a[64:65], v252 offset:16384
    ds_read_b64_tr_b16 a[66:67], v252 offset:16512
    ds_read_b64_tr_b16 a[68:69], v252 offset:18432
    ds_read_b64_tr_b16 a[70:71], v252 offset:18560
    ds_read_b64_tr_b16 a[72:73], v252 offset:20480
    ds_read_b64_tr_b16 a[74:75], v252 offset:20608
    ds_read_b64_tr_b16 a[76:77], v252 offset:22528
    ds_read_b64_tr_b16 a[78:79], v252 offset:22656
    ds_read_b64_tr_b16 a[96:97], v252 offset:16400
    ds_read_b64_tr_b16 a[98:99], v252 offset:16528
    ds_read_b64_tr_b16 a[100:101], v252 offset:18448
    ds_read_b64_tr_b16 a[102:103], v252 offset:18576
    ds_read_b64_tr_b16 a[104:105], v252 offset:20496
    ds_read_b64_tr_b16 a[106:107], v252 offset:20624
    ds_read_b64_tr_b16 a[108:109], v252 offset:22544
    ds_read_b64_tr_b16 a[110:111], v252 offset:22672
    s_waitcnt lgkmcnt(0)
    s_add_u32 m0, s98, 16384
    s_add_u32 s5, s80, 0
    buffer_load_dwordx4 v241, s[16:19], s5 offen  lds

    s_add_u32 m0, s98, 17408
    s_add_u32 s5, s80, 32768
    buffer_load_dwordx4 v241, s[16:19], s5 offen  lds

    s_add_u32 m0, s98, 18432
    s_add_u32 s5, s80, 65536
    buffer_load_dwordx4 v241, s[16:19], s5 offen  lds

    s_add_u32 m0, s98, 19456
    s_add_u32 s5, s80, 98304
    buffer_load_dwordx4 v241, s[16:19], s5 offen  lds

    s_add_u32 m0, s98, 20480
    s_add_u32 s5, s80, 131072
    buffer_load_dwordx4 v241, s[16:19], s5 offen  lds

    s_add_u32 m0, s98, 21504
    s_add_u32 s5, s80, 163840
    buffer_load_dwordx4 v241, s[16:19], s5 offen  lds

    s_add_u32 m0, s98, 22528
    s_add_u32 s5, s80, 196608
    buffer_load_dwordx4 v241, s[16:19], s5 offen  lds

    s_add_u32 m0, s98, 23552
    s_add_u32 s5, s80, 229376
    buffer_load_dwordx4 v241, s[16:19], s5 offen  lds

    v_and_b32 v241, 3, v0
    v_lshlrev_b32 v241, 2, v241

    v_and_b32 v240, 12, v0
    v_lshl_add_u32 v241, v240, 4, v241
    v_add_u32 v241, s97, v241
    v_and_b32 v241, 255, v241

    buffer_load_dword v240, v241, s[20:23], 0 offen sc1
    s_waitcnt vmcnt(25)
    ds_read_b64_tr_b16 a[144:145], v254 offset:8192
    ds_read_b64_tr_b16 a[146:147], v254 offset:8320
    ds_read_b64_tr_b16 a[148:149], v254 offset:10240
    ds_read_b64_tr_b16 a[150:151], v254 offset:10368
    ds_read_b64_tr_b16 a[152:153], v254 offset:12288
    ds_read_b64_tr_b16 a[154:155], v254 offset:12416
    ds_read_b64_tr_b16 a[156:157], v254 offset:14336
    ds_read_b64_tr_b16 a[158:159], v254 offset:14464
    ds_read_b64_tr_b16 a[176:177], v254 offset:8224
    ds_read_b64_tr_b16 a[178:179], v254 offset:8352
    ds_read_b64_tr_b16 a[180:181], v254 offset:10272
    ds_read_b64_tr_b16 a[182:183], v254 offset:10400
    ds_read_b64_tr_b16 a[184:185], v254 offset:12320
    ds_read_b64_tr_b16 a[186:187], v254 offset:12448
    ds_read_b64_tr_b16 a[188:189], v254 offset:14368
    ds_read_b64_tr_b16 a[190:191], v254 offset:14496
    s_waitcnt vmcnt(17)
    ds_read_b64_tr_b16 a[128:129], v254 offset:0
    ds_read_b64_tr_b16 a[130:131], v254 offset:128
    ds_read_b64_tr_b16 a[132:133], v254 offset:2048
    ds_read_b64_tr_b16 a[134:135], v254 offset:2176
    ds_read_b64_tr_b16 a[136:137], v254 offset:4096
    ds_read_b64_tr_b16 a[138:139], v254 offset:4224
    ds_read_b64_tr_b16 a[140:141], v254 offset:6144
    ds_read_b64_tr_b16 a[142:143], v254 offset:6272
    ds_read_b64_tr_b16 a[160:161], v254 offset:32
    ds_read_b64_tr_b16 a[162:163], v254 offset:160
    ds_read_b64_tr_b16 a[164:165], v254 offset:2080
    ds_read_b64_tr_b16 a[166:167], v254 offset:2208
    ds_read_b64_tr_b16 a[168:169], v254 offset:4128
    ds_read_b64_tr_b16 a[170:171], v254 offset:4256
    ds_read_b64_tr_b16 a[172:173], v254 offset:6176
    ds_read_b64_tr_b16 a[174:175], v254 offset:6304
    s_waitcnt vmcnt(9)
    s_mov_b64 exec, 0xffff
    s_mov_b32 exec_hi, 0
    buffer_load_dword v227, v226, s[8:11], 0 offen
    s_mov_b64 exec, -1
    ds_read_b64_tr_b16 a[208:209], v255 offset:24576
    ds_read_b64_tr_b16 a[210:211], v255 offset:24704
    ds_read_b64_tr_b16 a[212:213], v255 offset:26624
    ds_read_b64_tr_b16 a[214:215], v255 offset:26752
    ds_read_b64_tr_b16 a[216:217], v255 offset:28672
    ds_read_b64_tr_b16 a[218:219], v255 offset:28800
    ds_read_b64_tr_b16 a[220:221], v255 offset:30720
    ds_read_b64_tr_b16 a[222:223], v255 offset:30848
    ds_read_b64_tr_b16 a[240:241], v255 offset:24608
    ds_read_b64_tr_b16 a[242:243], v255 offset:24736
    ds_read_b64_tr_b16 a[244:245], v255 offset:26656
    ds_read_b64_tr_b16 a[246:247], v255 offset:26784
    ds_read_b64_tr_b16 a[248:249], v255 offset:28704
    ds_read_b64_tr_b16 a[250:251], v255 offset:28832
    ds_read_b64_tr_b16 a[252:253], v255 offset:30752
    ds_read_b64_tr_b16 a[254:255], v255 offset:30880
    s_waitcnt vmcnt(2)
    ds_read_b64_tr_b16 a[192:193], v255 offset:16384
    ds_read_b64_tr_b16 a[194:195], v255 offset:16512
    ds_read_b64_tr_b16 a[196:197], v255 offset:18432
    ds_read_b64_tr_b16 a[198:199], v255 offset:18560
    ds_read_b64_tr_b16 a[200:201], v255 offset:20480
    ds_read_b64_tr_b16 a[202:203], v255 offset:20608
    ds_read_b64_tr_b16 a[204:205], v255 offset:22528
    ds_read_b64_tr_b16 a[206:207], v255 offset:22656
    ds_read_b64_tr_b16 a[224:225], v255 offset:16416
    ds_read_b64_tr_b16 a[226:227], v255 offset:16544
    ds_read_b64_tr_b16 a[228:229], v255 offset:18464
    ds_read_b64_tr_b16 a[230:231], v255 offset:18592
    ds_read_b64_tr_b16 a[232:233], v255 offset:20512
    ds_read_b64_tr_b16 a[234:235], v255 offset:20640
    ds_read_b64_tr_b16 a[236:237], v255 offset:22560
    ds_read_b64_tr_b16 a[238:239], v255 offset:22688
.pj_14:
    v_min_u32 v20, 0xfffffffe, v20
    v_min_u32 v21, 0xfffffffe, v21
    v_min_u32 v22, 0xfffffffe, v22
    v_min_u32 v23, 0xfffffffe, v23
    v_min_u32 v24, 0xfffffffe, v24
    v_min_u32 v25, 0xfffffffe, v25
    v_min_u32 v26, 0xfffffffe, v26
    v_min_u32 v27, 0xfffffffe, v27
    v_min_u32 v28, 0xfffffffe, v28
    v_min_u32 v29, 0xfffffffe, v29
    v_min_u32 v30, 0xfffffffe, v30
    v_min_u32 v31, 0xfffffffe, v31
    v_min_u32 v32, 0xfffffffe, v32
    v_min_u32 v33, 0xfffffffe, v33
    v_min_u32 v34, 0xfffffffe, v34
    v_min_u32 v35, 0xfffffffe, v35
    s_barrier
    s_cmp_ge_u32 s24, 2
    s_cbranch_scc1 .px_15
    v_xor_b32 v255, 0x10000, v255
    ds_read_b64_tr_b16 v[124:125], v255 offset:16384
    ds_read_b64_tr_b16 v[126:127], v255 offset:16512
    ds_read_b64_tr_b16 v[128:129], v255 offset:18432
    ds_read_b64_tr_b16 v[130:131], v255 offset:18560
    ds_read_b64_tr_b16 v[132:133], v255 offset:20480
    ds_read_b64_tr_b16 v[134:135], v255 offset:20608
    ds_read_b64_tr_b16 v[136:137], v255 offset:22528
    ds_read_b64_tr_b16 v[138:139], v255 offset:22656
    ds_read_b64_tr_b16 v[156:157], v255 offset:16416
    ds_read_b64_tr_b16 v[158:159], v255 offset:16544
    ds_read_b64_tr_b16 v[160:161], v255 offset:18464
    ds_read_b64_tr_b16 v[162:163], v255 offset:18592
    ds_read_b64_tr_b16 v[164:165], v255 offset:20512
    ds_read_b64_tr_b16 v[166:167], v255 offset:20640
    ds_read_b64_tr_b16 v[168:169], v255 offset:22560
    ds_read_b64_tr_b16 v[170:171], v255 offset:22688
    ds_read_b64_tr_b16 v[140:141], v255 offset:24576
    ds_read_b64_tr_b16 v[142:143], v255 offset:24704
    ds_read_b64_tr_b16 v[144:145], v255 offset:26624
    ds_read_b64_tr_b16 v[146:147], v255 offset:26752
    ds_read_b64_tr_b16 v[148:149], v255 offset:28672
    ds_read_b64_tr_b16 v[150:151], v255 offset:28800
    ds_read_b64_tr_b16 v[152:153], v255 offset:30720
    ds_read_b64_tr_b16 v[154:155], v255 offset:30848
    ds_read_b64_tr_b16 v[172:173], v255 offset:24608
    ds_read_b64_tr_b16 v[174:175], v255 offset:24736
    ds_read_b64_tr_b16 v[176:177], v255 offset:26656
    ds_read_b64_tr_b16 v[178:179], v255 offset:26784
    ds_read_b64_tr_b16 v[180:181], v255 offset:28704
    ds_read_b64_tr_b16 v[182:183], v255 offset:28832
    ds_read_b64_tr_b16 v[184:185], v255 offset:30752
    ds_read_b64_tr_b16 v[186:187], v255 offset:30880
.px_15:
    s_waitcnt vmcnt(0)
    s_mov_b32 s62, 0
.vp_18:
    v_readlane_b32 s4, v240, 0
    v_readlane_b32 s7, v240, 1
    v_readlane_b32 s6, v240, 2

    v_readlane_b32 s5, v240, 4
    s_add_u32 s4, s4, s5
    v_readlane_b32 s5, v240, 8
    s_add_u32 s4, s4, s5
    v_readlane_b32 s5, v240, 12
    s_add_u32 s4, s4, s5
    s_lshr_b32 s5, s7, 21
    s_min_u32 s4, s4, s5
    s_cmp_ge_u32 s4, 256
    s_cbranch_scc1 .vd_19
    s_cmp_lg_u32 s6, 0
    s_cbranch_scc1 .vs_20
    s_add_u32 s62, s62, 1
    s_cmp_gt_u32 s62, 0x100000
    s_cbranch_scc1 .mg_end_1
    s_sleep 8
    buffer_load_dword v240, v241, s[20:23], 0 offen sc1
    s_waitcnt vmcnt(0)
    s_branch .vp_18

.vs_20:
    s_lshr_b32 s25, s2, 5
    s_and_b32 s26, s2, 31
    s_mov_b32 s27, 1
    s_mov_b32 s99, 1
    s_mov_b32 s97, 144
    s_waitcnt vmcnt(0) lgkmcnt(0)
    s_barrier
    s_branch .mg_role_3

.vd_19:
    s_waitcnt lgkmcnt(0)
    s_barrier
    s_add_u32 s4, s79, 1
    s_and_b32 s4, s4, 3
    s_lshl_b32 s4, s4, 11
    v_add_u32 v243, s4, v246
    s_add_u32 s4, s79, 2
    s_and_b32 s4, s4, 3
    s_lshl_b32 s4, s4, 11
    v_add_u32 v252, s4, v246
    s_add_u32 s4, s79, 3
    s_and_b32 s4, s4, 3
    s_lshl_b32 s4, s4, 11
    v_add_u32 v254, s4, v246
    s_add_u32 s4, s79, 4
    s_and_b32 s4, s4, 3
    s_lshl_b32 s4, s4, 11
    v_add_u32 v246, s4, v246
    s_bfe_u32 s4, s7, 393216
    s_cmp_gt_u32 s4, 8
    s_cselect_b32 s4, 8192, 0
    s_add_u32 s4, s4, s35
    s_add_u32 s68, s4, 0

    s_bfe_u32 s4, s7, 393216
    s_cmp_gt_u32 s4, 8
    s_cselect_b32 s4, 8192, 0
    s_add_u32 s4, s4, s35
    s_add_u32 s69, s4, 1048576

    s_bfe_u32 s4, s7, 393222
    s_cmp_gt_u32 s4, 8
    s_cselect_b32 s4, 8192, 0
    s_add_u32 s4, s4, s35
    s_add_u32 s70, s4, 2097152

    s_bfe_u32 s4, s7, 393222
    s_cmp_gt_u32 s4, 8
    s_cselect_b32 s4, 8192, 0
    s_add_u32 s4, s4, s35
    s_add_u32 s71, s4, 3145728

    s_mov_b32 s62, 0x1000000
    s_cmp_ge_u32 s24, 2
    s_cbranch_scc1 .nd_21
    s_mov_b32 s62, 0
    s_mov_b64 exec, 3
.wf_23:
    buffer_load_dword v244, v253, s[8:11], s89 offen sc1
    s_waitcnt vmcnt(0)
    v_cmp_gt_u32 vcc, 1, v244
    s_cbranch_vccz .wfd_24
    s_sleep 2
    s_add_u32 s62, s62, 1
    s_cmp_gt_u32 s62, 0x400000
    s_cbranch_scc1 .mg_end_1
    s_branch .wf_23

.wfd_24:
    s_mov_b64 exec, -1
    v_readlane_b32 s4, v244, 0
    v_readlane_b32 s93, v244, 1
    s_min_u32 s93, s93, s4
    s_mov_b32 s62, 0x1000000
    s_mov_b32 m0, s90
    s_nop 0
    buffer_load_dwordx4 v14, s[8:11], s38 offen offset:0 lds
    buffer_load_dwordx4 v14, s[8:11], s38 offen offset:1024 lds
    buffer_load_dwordx4 v14, s[8:11], s38 offen offset:2048 lds
    buffer_load_dwordx4 v14, s[8:11], s38 offen offset:3072 lds
    s_mov_b32 m0, s91
    s_nop 0
    buffer_load_dwordx4 v14, s[8:11], s39 offen lds
    s_mov_b64 exec, 3
    buffer_load_dword v244, v253, s[8:11], s89 offen sc1
    s_mov_b64 exec, -1
    s_waitcnt vmcnt(0)
.kd_22:
    v_readlane_b32 s4, v244, 0
    v_readlane_b32 s93, v244, 1
    s_min_u32 s93, s93, s4
    v_mov_b32 v4, s93
    v_mov_b32 v5, 19968
    ds_write_b32 v5, v4
.nd_21:
    s_waitcnt vmcnt(0) lgkmcnt(0)
    s_add_u32 s38, s38, 262144
    s_add_u32 s39, s39, 262144
    s_and_b32 s4, s28, 3
    s_lshl_b32 s5, s4, 17
    s_add_u32 s29, s5, s34
    s_xor_b32 s6, s5, 262144
    s_add_u32 s31, s6, s34
    s_add_u32 s32, s29, 20480
    s_add_u32 s33, s29, 24576
    s_mov_b64 s[14:15], 0
    s_barrier
    s_cmp_lt_u32 s24, 2
    s_cbranch_scc1 .k0_27
    ds_read_b128 v[128:131], v228 offset:0
    ds_read_b128 v[144:147], v228 offset:4096
    ds_read_b128 v[132:135], v229 offset:0
    ds_read_b128 v[148:151], v229 offset:4096
    ds_read_b128 v[136:139], v230 offset:0
    ds_read_b128 v[152:155], v230 offset:4096
    ds_read_b128 v[140:143], v231 offset:0
    ds_read_b128 v[156:159], v231 offset:4096
    ds_read_b128 v[160:163], v14 offset:28672
    ds_read_b128 v[164:167], v14 offset:29696
.k0_27:
    s_cmp_lg_u32 s27, 0
    s_cbranch_scc1 .ent1_26
    s_branch .ent0_25
.p2align 6
.top_28:
    s_barrier
    buffer_load_dwordx4 v[20:23], v8, s[8:11], s29 offen offset:0 sc1
    v_mov_b32 v52, 0
    buffer_load_dwordx4 v[24:27], v8, s[8:11], s29 offen offset:1024 sc1
    v_mov_b32 v53, 0
    buffer_load_dwordx4 v[28:31], v8, s[8:11], s29 offen offset:2048 sc1
    v_mov_b32 v54, 0
    buffer_load_dwordx4 v[32:35], v8, s[8:11], s29 offen offset:3072 sc1
.ent0_25:
    s_waitcnt vmcnt(3)
    v_max3_u32 v4, v20, v21, v22
    v_max_u32 v4, v4, v23
    v_cmp_eq_u32 vcc, -1, v4
    s_cbranch_vccnz .A_33
.W_34:
    v_smfmac_f32_16x16x64_bf16 v[52:55], v[20:23], a[0:7], v9
    v_smfmac_f32_16x16x64_bf16 v[56:59], v[20:23], a[32:39], v9
    s_waitcnt vmcnt(2)
    v_max3_u32 v4, v24, v25, v26
    v_max_u32 v4, v4, v27
    v_smfmac_f32_16x16x64_bf16 v[60:63], v[20:23], a[64:71], v9
    v_cmp_eq_u32 vcc, -1, v4
    v_smfmac_f32_16x16x64_bf16 v[64:67], v[20:23], a[96:103], v9
    s_cbranch_vccnz .A_35
.W_36:
    v_smfmac_f32_16x16x64_bf16 v[52:55], v[24:27], a[8:15], v9
    v_smfmac_f32_16x16x64_bf16 v[56:59], v[24:27], a[40:47], v9
    s_waitcnt vmcnt(1)
    v_max3_u32 v4, v28, v29, v30
    v_max_u32 v4, v4, v31
    v_smfmac_f32_16x16x64_bf16 v[60:63], v[24:27], a[72:79], v9
    v_cmp_eq_u32 vcc, -1, v4
    v_smfmac_f32_16x16x64_bf16 v[64:67], v[24:27], a[104:111], v9
    s_cbranch_vccnz .A_37
.W_38:
    v_smfmac_f32_16x16x64_bf16 v[52:55], v[28:31], a[16:23], v9
    v_smfmac_f32_16x16x64_bf16 v[56:59], v[28:31], a[48:55], v9
    s_waitcnt vmcnt(0)
    v_max3_u32 v4, v32, v33, v34
    v_max_u32 v4, v4, v35
    v_smfmac_f32_16x16x64_bf16 v[60:63], v[28:31], a[80:87], v9
    v_cmp_eq_u32 vcc, -1, v4
    v_smfmac_f32_16x16x64_bf16 v[64:67], v[28:31], a[112:119], v9
    s_cbranch_vccnz .A_39
.W_40:
    v_smfmac_f32_16x16x64_bf16 v[52:55], v[32:35], a[24:31], v9
    v_smfmac_f32_16x16x64_bf16 v[56:59], v[32:35], a[56:63], v9
    v_smfmac_f32_16x16x64_bf16 v[60:63], v[32:35], a[88:95], v9
    v_smfmac_f32_16x16x64_bf16 v[64:67], v[32:35], a[120:127], v9
.mj_32:
    v_cvt_pk_bf16_f32 v104, v52, v53
    v_cvt_pk_bf16_f32 v105, v54, v55
    v_cvt_pk_bf16_f32 v106, v56, v57
    v_cvt_pk_bf16_f32 v107, v58, v59
    ds_write_b64 v16, v[104:105] offset:4096
    v_cvt_pk_bf16_f32 v108, v60, v61
    v_cvt_pk_bf16_f32 v109, v62, v63
    ds_write_b64 v16, v[106:107] offset:6144
    ds_write_b64 v16, v[108:109] offset:0
    v_cvt_pk_bf16_f32 v110, v64, v65
    v_cvt_pk_bf16_f32 v111, v66, v67
    ds_write_b64 v16, v[110:111] offset:2048
    v_smfmac_f32_16x16x64_bf16 v[68:71], v[20:23], a[128:135], v9
    v_smfmac_f32_16x16x64_bf16 v[72:75], v[20:23], a[160:167], v9
    s_waitcnt lgkmcnt(0)
    s_barrier
    ds_read_b128 v[36:39], v17 offset:0
    ds_read_b128 v[40:43], v17 offset:1024
    v_smfmac_f32_16x16x64_bf16 v[68:71], v[24:27], a[136:143], v9
    v_smfmac_f32_16x16x64_bf16 v[72:75], v[24:27], a[168:175], v9
    s_waitcnt lgkmcnt(1)
    v_mfma_f32_16x16x32_bf16 v[44:47], v[36:39], v[84:87], 0
    s_waitcnt lgkmcnt(0)
    v_mfma_f32_16x16x32_bf16 v[44:47], v[40:43], v[84:87], v[44:47]
    v_smfmac_f32_16x16x64_bf16 v[68:71], v[28:31], a[144:151], v9
    v_smfmac_f32_16x16x64_bf16 v[72:75], v[28:31], a[176:183], v9
    s_mov_b64 exec, s[64:65]
    v_cvt_pk_bf16_f32 v48, v44, v45
    v_cvt_pk_bf16_f32 v49, v46, v47
    v_min_u32 v48, 0xfffffffe, v48
    v_min_u32 v49, 0xfffffffe, v49
    buffer_store_dwordx2 v[48:49], v10, s[8:11], s29 offen

    ds_write_b64 v18, v[48:49]
    s_mov_b64 exec, -1

    v_smfmac_f32_16x16x64_bf16 v[68:71], v[32:35], a[152:159], v9
    v_smfmac_f32_16x16x64_bf16 v[72:75], v[32:35], a[184:191], v9
    s_nop 3
    v_cvt_pk_bf16_f32 v104, v68, v69
    v_cvt_pk_bf16_f32 v105, v70, v71
    ds_write_b64 v16, v[104:105] offset:8192
    s_nop 0
    v_cvt_pk_bf16_f32 v106, v72, v73
    v_cvt_pk_bf16_f32 v107, v74, v75
    ds_write_b64 v16, v[106:107] offset:10240
    s_cmp_lg_u32 s24, 2
    s_waitcnt lgkmcnt(0)
    s_barrier
    s_cbranch_scc1 .oth_29
    buffer_load_dwordx4 v[92:95], v232, s[8:11], s29 offen sc1
    buffer_load_dwordx4 v[96:99], v233, s[8:11], s29 offen sc1
    buffer_load_dwordx4 v[100:103], v234, s[8:11], s29 offen sc1
    ds_read_b128 v[88:91], v14 offset:16384
    s_cmp_eq_u32 s28, 63
    s_cbranch_scc1 .rec_fin_6
    s_waitcnt lgkmcnt(0)
    v_mfma_f32_16x16x32_bf16 v[208:211], v[128:131], v[88:91], 0
    v_mfma_f32_16x16x32_bf16 v[212:215], v[144:147], v[88:91], 0
    v_mfma_f32_16x16x32_bf16 v[216:219], v[88:91], v[88:91], v[116:119]
    s_waitcnt vmcnt(2)
    v_max3_u32 v4, v92, v93, v94
    v_max_u32 v4, v4, v95
    v_cmp_eq_u32 vcc, -1, v4
    s_cbranch_vccnz .A_42
.W_43:
    v_mfma_f32_16x16x32_bf16 v[208:211], v[132:135], v[92:95], v[208:211]
    s_waitcnt vmcnt(1)
    v_max3_u32 v4, v96, v97, v98
    v_max_u32 v4, v4, v99
    v_mfma_f32_16x16x32_bf16 v[212:215], v[148:151], v[92:95], v[212:215]
    v_cmp_eq_u32 vcc, -1, v4
    v_mfma_f32_16x16x32_bf16 v[216:219], v[92:95], v[92:95], v[216:219]
    s_cbranch_vccnz .A_44
.W_45:
    v_mfma_f32_16x16x32_bf16 v[208:211], v[136:139], v[96:99], v[208:211]
    s_waitcnt vmcnt(0)
    v_max3_u32 v4, v100, v101, v102
    v_max_u32 v4, v4, v103
    v_mfma_f32_16x16x32_bf16 v[212:215], v[152:155], v[96:99], v[212:215]
    v_cmp_eq_u32 vcc, -1, v4
    v_mfma_f32_16x16x32_bf16 v[216:219], v[96:99], v[96:99], v[216:219]
    s_cbranch_vccnz .A_46
.W_47:
    v_mfma_f32_16x16x32_bf16 v[208:211], v[140:143], v[100:103], v[208:211]
    v_mfma_f32_16x16x32_bf16 v[212:215], v[156:159], v[100:103], v[212:215]
    v_mfma_f32_16x16x32_bf16 v[216:219], v[100:103], v[100:103], v[216:219]
.mj_41:
    s_barrier
    ds_read_b64 v[168:169], v14 offset:18432
    ds_read_b64 v[172:173], v14 offset:18440
    s_nop 0

    v_mov_b32_dpp v208, v212 row_ror:8 row_mask:0xf bank_mask:0xc
    v_mov_b32_dpp v209, v213 row_ror:8 row_mask:0xf bank_mask:0xc
    v_mov_b32_dpp v210, v214 row_ror:8 row_mask:0xf bank_mask:0xc
    v_mov_b32_dpp v211, v215 row_ror:8 row_mask:0xf bank_mask:0xc
    v_mov_b32_dpp v216, v218 row_ror:8 row_mask:0xf bank_mask:0xc
    v_mov_b32_dpp v217, v219 row_ror:8 row_mask:0xf bank_mask:0xc
    v_max3_f32 v4, v208, v209, v210
    v_max3_f32 v5, v211, v216, v217
    v_max_f32 v6, v4, v5
    v_max_f32 v4, v4, v5
    s_nop 1
    v_permlane32_swap_b32 v4, v6
    v_max_f32 v5, v4, v6
    v_max_f32 v4, v4, v6
    s_nop 1
    v_permlane16_swap_b32 v4, v5
    v_max_f32 v4, v4, v5
    s_nop 1
    v_max_f32_dpp v4, v4, v4 row_ror:8 row_mask:0xf bank_mask:0xf
    v_mul_f32 v4, s37, v4

    v_fma_f32 v104, v208, s37, -v4
    v_fma_f32 v105, v209, s37, -v4
    v_fma_f32 v106, v210, s37, -v4
    v_fma_f32 v107, v211, s37, -v4
    v_fma_f32 v108, v216, s37, -v4
    v_fma_f32 v109, v217, s37, -v4
    v_exp_f32 v104, v104
    v_exp_f32 v105, v105
    v_exp_f32 v106, v106
    v_exp_f32 v107, v107
    v_exp_f32 v108, v108
    v_exp_f32 v109, v109
    v_cvt_pk_bf16_f32 v176, v104, v105
    v_cvt_pk_bf16_f32 v177, v106, v107
    v_cvt_pk_bf16_f32 v180, v108, v109
    v_mov_b32_dpp v178, v176 row_ror:8 row_mask:0xf bank_mask:0xf
    v_mov_b32_dpp v179, v177 row_ror:8 row_mask:0xf bank_mask:0xf
    v_mov_b32_dpp v181, v180 row_ror:8 row_mask:0xf bank_mask:0xf
    s_waitcnt lgkmcnt(0)

    v_mfma_f32_16x16x32_bf16 v[208:211], v[120:123], v[176:179], 0
    v_mfma_f32_16x16x32_bf16 v[208:211], v[120:123], v[180:183], v[208:211]
    v_mfma_f32_16x16x32_bf16 v[212:215], v[160:163], v[176:179], 0
    v_mfma_f32_16x16x32_bf16 v[216:219], v[164:167], v[176:179], 0
    v_mfma_f32_16x16x32_bf16 v[212:215], v[168:171], v[180:183], v[212:215]
    v_rcp_f32 v4, v208
    v_mfma_f32_16x16x32_bf16 v[216:219], v[172:175], v[180:183], v[216:219]
    s_mov_b64 exec, s[58:59]
    s_nop 2
    v_mul_f32 v212, v4, v212
    v_mul_f32 v213, v4, v213
    v_mul_f32 v214, v4, v214
    v_mul_f32 v215, v4, v215
    v_cvt_pk_bf16_f32 v184, v212, v213
    v_cvt_pk_bf16_f32 v185, v214, v215
    v_mul_f32 v216, v4, v216
    v_mul_f32 v217, v4, v217
    v_min_u32 v184, 0xfffffffe, v184
    v_min_u32 v185, 0xfffffffe, v185
    v_mul_f32 v218, v4, v218
    v_mul_f32 v219, v4, v219
    v_cvt_pk_bf16_f32 v186, v216, v217
    v_cvt_pk_bf16_f32 v187, v218, v219
    v_min_u32 v186, 0xfffffffe, v186
    v_min_u32 v187, 0xfffffffe, v187
    buffer_store_dwordx4 v[184:187], v13, s[8:11], s29 offen
    s_mov_b64 exec, -1

.gp_31:
    s_barrier
    v_mov_b32 v5, 19968
    ds_read_b32 v4, v5
    s_mov_b32 s99, s68
    s_waitcnt vmcnt(0)
    s_cmp_eq_u32 s24, 3
    s_cbranch_scc1 .u3_48
    s_add_u32 s6, s28, 3
    s_add_u32 s7, s30, 262144
    s_waitcnt lgkmcnt(0)
    v_readfirstlane_b32 s5, v4
    s_cmp_lt_u32 s5, s6
    s_barrier
    s_cbranch_scc1 .np_50
    buffer_load_dword v226, v225, s[8:11], s7 offen

.np_50:
    s_add_u32 s4, s70, 0
    buffer_store_dwordx4 v[188:191], v238, s[8:11], s4 offen sc1
    s_add_u32 s4, s70, 262144
    buffer_store_dwordx4 v[188:191], v238, s[8:11], s4 offen sc1
    s_branch .u4_49
.u3_48:
    s_sub_u32 s4, s36, 0
    s_barrier
    s_mov_b64 exec, s[66:67]
    buffer_store_dwordx4 v[88:91], v11, s[8:11], s4 offen sc1
    s_mov_b64 exec, s[56:57]
    buffer_store_dwordx4 v[172:175], v12, s[8:11], s4 offen sc1
    s_mov_b64 exec, -1

.u4_49:
    s_barrier
    s_add_u32 s28, s28, 1
    s_add_u32 s36, s36, 196608
    s_cmp_lt_u32 s28, 63
    s_cselect_b32 s4, 262144, 0
    s_add_u32 s38, s38, s4
    s_add_u32 s39, s39, s4
    s_add_u32 s30, s30, s4
    s_mov_b32 s4, s68
    s_mov_b32 s68, s69
    s_mov_b32 s69, s70
    s_mov_b32 s70, s71
    s_mov_b32 s71, s4
    s_and_b32 s4, s28, 3
    s_lshl_b32 s5, s4, 17
    s_add_u32 s29, s5, s34
    s_xor_b32 s6, s5, 262144
    s_add_u32 s31, s6, s34
    s_add_u32 s32, s29, 20480
    s_add_u32 s33, s29, 24576
    v_mov_b32 v55, 0
    v_mov_b32 v56, 0
    v_mov_b32 v57, 0
    v_mov_b32 v58, 0
    v_mov_b32 v59, 0
    v_mov_b32 v60, 0
    v_mov_b32 v61, 0
    v_mov_b32 v62, 0
    v_mov_b32 v63, 0
    v_mov_b32 v64, 0
    v_mov_b32 v65, 0
    v_mov_b32 v66, 0
    v_mov_b32 v67, 0
    v_mov_b32 v68, 0
    v_mov_b32 v69, 0
    v_mov_b32 v70, 0
    v_mov_b32 v71, 0
    v_mov_b32 v72, 0
    v_mov_b32 v73, 0
    v_mov_b32 v74, 0
    v_mov_b32 v75, 0
    v_mov_b32 v20, -1
    v_mov_b32 v21, -1
    v_mov_b32 v22, -1
    v_mov_b32 v23, -1
    v_mov_b32 v24, -1
    v_mov_b32 v25, -1
    v_mov_b32 v26, -1
    v_mov_b32 v27, -1
    v_mov_b32 v28, -1
    v_mov_b32 v29, -1
    v_mov_b32 v30, -1
    v_mov_b32 v31, -1
    v_mov_b32 v32, -1
    v_mov_b32 v33, -1
    v_mov_b32 v34, -1
    v_mov_b32 v35, -1
    v_mov_b32 v92, -1
    v_mov_b32 v93, -1
    v_mov_b32 v94, -1
    v_mov_b32 v95, -1
    v_mov_b32 v96, -1
    v_mov_b32 v97, -1
    v_mov_b32 v98, -1
    v_mov_b32 v99, -1
    v_mov_b32 v100, -1
    v_mov_b32 v101, -1
    v_mov_b32 v102, -1
    v_mov_b32 v103, -1
    s_add_u32 s4, s99, 0
    buffer_load_dwordx4 v[192:195], v239, s[8:11], s4 offen sc1
    buffer_load_dwordx4 v[196:199], v249, s[8:11], s4 offen sc1

    ds_read_b128 v[128:131], v228 offset:0
    ds_read_b128 v[144:147], v228 offset:4096
    ds_read_b128 v[132:135], v229 offset:0
    ds_read_b128 v[148:151], v229 offset:4096
    ds_read_b128 v[136:139], v230 offset:0
    ds_read_b128 v[152:155], v230 offset:4096
    ds_read_b128 v[140:143], v231 offset:0
    ds_read_b128 v[156:159], v231 offset:4096
    ds_read_b128 v[160:163], v14 offset:28672
    ds_read_b128 v[164:167], v14 offset:29696
    ds_read_b128 v[108:111], v248
    s_waitcnt lgkmcnt(0)
    v_mfma_f32_16x16x32_bf16 v[76:79], v[108:111], v[112:115], 0
    s_add_u32 s4, s99, 262144
    buffer_load_dwordx4 v[200:203], v239, s[8:11], s4 offen sc1
    buffer_load_dwordx4 v[204:207], v249, s[8:11], s4 offen sc1

.gc_51:
    s_waitcnt vmcnt(2)

    v_max_u32 v4, v192, v196
    v_cmp_eq_u32 vcc, -1, v4
    s_cbranch_vccnz .gf_52
    v_mfma_f32_16x16x32_bf16 v[76:79], v[192:195], v[84:87], v[76:79]
    v_mfma_f32_16x16x32_bf16 v[76:79], v[196:199], v[112:115], v[76:79]
    s_mov_b64 exec, s[58:59]
    s_nop 6
    v_cvt_pk_bf16_f32 v104, v76, v77
    v_cvt_pk_bf16_f32 v105, v78, v79
    v_min_u32 v104, 0xfffffffe, v104
    v_min_u32 v105, 0xfffffffe, v105
    buffer_store_dwordx2 v[104:105], v15, s[8:11], s29 offen
    s_mov_b64 exec, -1

    s_branch .top_28
.gf_52:
    s_add_u32 s4, s99, 0
    buffer_load_dwordx4 v[192:195], v239, s[8:11], s4 offen sc1
    buffer_load_dwordx4 v[196:199], v249, s[8:11], s4 offen sc1

    s_waitcnt vmcnt(2)

    v_max_u32 v4, v200, v204
    v_cmp_eq_u32 vcc, -1, v4
    s_cbranch_vccnz .gf_53
    v_mfma_f32_16x16x32_bf16 v[76:79], v[200:203], v[84:87], v[76:79]
    v_mfma_f32_16x16x32_bf16 v[76:79], v[204:207], v[112:115], v[76:79]
    s_mov_b64 exec, s[58:59]
    s_nop 6
    v_cvt_pk_bf16_f32 v104, v76, v77
    v_cvt_pk_bf16_f32 v105, v78, v79
    v_min_u32 v104, 0xfffffffe, v104
    v_min_u32 v105, 0xfffffffe, v105
    buffer_store_dwordx2 v[104:105], v15, s[8:11], s29 offen
    s_mov_b64 exec, -1

    s_branch .top_28
.gf_53:
    s_add_u32 s4, s99, 262144
    buffer_load_dwordx4 v[200:203], v239, s[8:11], s4 offen sc1
    buffer_load_dwordx4 v[204:207], v249, s[8:11], s4 offen sc1

    s_sub_u32 s62, s62, 1
    s_cbranch_scc1 .mg_end_1
    s_branch .gc_51
.oth_29:
    s_cmp_eq_u32 s24, 3
    s_cbranch_scc1 .w3_30
    s_cmp_eq_u32 s28, 63
    s_cbranch_scc1 .rec_fin_6
    s_min_u32 s4, s14, s15
    s_max_u32 s93, s93, s4
    v_mov_b32 v4, s93
    v_mov_b32 v5, 19968
    ds_write_b32 v5, v4
    s_waitcnt vmcnt(0)
    v_mov_b32 v71, 0
    v_mov_b32 v72, 0
    v_mov_b32 v73, 0
    v_mov_b32 v74, 0
    v_mov_b32 v75, 0
    s_barrier
    s_add_u32 s6, s28, 2
    s_min_u32 s6, s6, 64
    s_cmp_lt_u32 s93, s6
    s_cbranch_scc1 .kf_54
.kb_55:
    s_mov_b32 m0, s90
    s_nop 0
    buffer_load_dwordx4 v14, s[8:11], s38 offen offset:0 lds
    buffer_load_dwordx4 v14, s[8:11], s38 offen offset:1024 lds
    buffer_load_dwordx4 v14, s[8:11], s38 offen offset:2048 lds
    buffer_load_dwordx4 v14, s[8:11], s38 offen offset:3072 lds
    s_mov_b32 m0, s91
    s_nop 0
    buffer_load_dwordx4 v14, s[8:11], s39 offen lds
    s_waitcnt lgkmcnt(0)
    s_barrier
    v_mov_b32 v20, -1
    v_mov_b32 v21, -1
    v_mov_b32 v22, -1
    v_mov_b32 v23, -1
    v_mov_b32 v24, -1
    v_mov_b32 v25, -1
    v_mov_b32 v26, -1
    v_mov_b32 v27, -1
    v_mov_b32 v28, -1
    v_mov_b32 v29, -1
    v_mov_b32 v30, -1
    v_mov_b32 v31, -1
    v_mov_b32 v32, -1
    v_mov_b32 v33, -1
    v_mov_b32 v34, -1
    v_mov_b32 v35, -1
    v_mov_b32 v55, 0
    v_mov_b32 v56, 0
    v_mov_b32 v57, 0
    v_mov_b32 v58, 0
    v_mov_b32 v59, 0
    v_mov_b32 v60, 0
    v_mov_b32 v61, 0
    v_mov_b32 v62, 0
    v_mov_b32 v63, 0
    v_mov_b32 v64, 0
    v_mov_b32 v65, 0
    v_mov_b32 v66, 0
    v_mov_b32 v67, 0
    v_mov_b32 v68, 0
    v_mov_b32 v69, 0
    v_mov_b32 v70, 0
    buffer_load_dwordx4 v[192:195], v243, s[8:11], s32 offen offset:0 sc1
    buffer_load_dwordx4 v[196:199], v243, s[8:11], s32 offen offset:1024 sc1
    v_mov_b32 v76, 0
    buffer_load_dwordx4 v[200:203], v252, s[8:11], s32 offen offset:0 sc1
    buffer_load_dwordx4 v[204:207], v252, s[8:11], s32 offen offset:1024 sc1
    v_mov_b32 v77, 0
    buffer_load_dwordx4 v[208:211], v254, s[8:11], s32 offen offset:0 sc1
    buffer_load_dwordx4 v[212:215], v254, s[8:11], s32 offen offset:1024 sc1
    v_mov_b32 v78, 0
    buffer_load_dwordx4 v[216:219], v246, s[8:11], s32 offen offset:0 sc1
    buffer_load_dwordx4 v[220:223], v246, s[8:11], s32 offen offset:1024 sc1
    s_waitcnt vmcnt(6)
    v_max3_u32 v4, v192, v193, v194
    v_max3_u32 v5, v195, v196, v197
    v_max3_u32 v4, v4, v198, v199
    v_max_u32 v4, v4, v5
    v_cmp_eq_u32 vcc, -1, v4
    s_cbranch_vccnz .A_57
.W_58:
    v_smfmac_f32_16x16x64_bf16 v[76:79], v[192:195], a[192:199], v9
    v_smfmac_f32_16x16x64_bf16 v[80:83], v[192:195], a[224:231], v9
    s_waitcnt vmcnt(4)
    v_max3_u32 v4, v200, v201, v202
    v_max3_u32 v5, v203, v204, v205
    v_max3_u32 v4, v4, v206, v207
    v_smfmac_f32_16x16x64_bf16 v[76:79], v[196:199], a[200:207], v9
    v_max_u32 v4, v4, v5
    v_cmp_eq_u32 vcc, -1, v4
    v_smfmac_f32_16x16x64_bf16 v[80:83], v[196:199], a[232:239], v9
    s_cbranch_vccnz .A_59
.W_60:
    v_smfmac_f32_16x16x64_bf16 v[76:79], v[200:203], a[208:215], v9
    v_smfmac_f32_16x16x64_bf16 v[80:83], v[200:203], a[240:247], v9
    s_waitcnt vmcnt(2)
    v_max3_u32 v4, v208, v209, v210
    v_max3_u32 v5, v211, v212, v213
    v_max3_u32 v4, v4, v214, v215
    v_smfmac_f32_16x16x64_bf16 v[76:79], v[204:207], a[216:223], v9
    v_max_u32 v4, v4, v5
    v_cmp_eq_u32 vcc, -1, v4
    v_smfmac_f32_16x16x64_bf16 v[80:83], v[204:207], a[248:255], v9
    s_cbranch_vccnz .A_61
.W_62:
    v_smfmac_f32_16x16x64_bf16 v[76:79], v[208:211], v[124:131], v9
    v_smfmac_f32_16x16x64_bf16 v[80:83], v[208:211], v[156:163], v9
    s_waitcnt vmcnt(0)
    v_max3_u32 v4, v216, v217, v218
    v_max3_u32 v5, v219, v220, v221
    v_max3_u32 v4, v4, v222, v223
    v_smfmac_f32_16x16x64_bf16 v[76:79], v[212:215], v[132:139], v9
    v_max_u32 v4, v4, v5
    v_cmp_eq_u32 vcc, -1, v4
    v_smfmac_f32_16x16x64_bf16 v[80:83], v[212:215], v[164:171], v9
    s_cbranch_vccnz .A_63
.W_64:
    v_smfmac_f32_16x16x64_bf16 v[76:79], v[216:219], v[140:147], v9
    v_smfmac_f32_16x16x64_bf16 v[80:83], v[216:219], v[172:179], v9
    v_smfmac_f32_16x16x64_bf16 v[76:79], v[220:223], v[148:155], v9
    v_smfmac_f32_16x16x64_bf16 v[80:83], v[220:223], v[180:187], v9
.mj_56:
    s_barrier
    s_nop 7
    v_permlane32_swap_b32 v76, v80
    v_permlane32_swap_b32 v77, v81
    v_permlane32_swap_b32 v78, v82
    v_permlane32_swap_b32 v79, v83
    v_add_f32 v76, v76, v80
    v_add_f32 v77, v77, v81
    v_add_f32 v78, v78, v82
    v_add_f32 v79, v79, v83
    v_cvt_pk_bf16_f32 v104, v76, v77
    v_cvt_pk_bf16_f32 v106, v76, v77
    v_cvt_pk_bf16_f32 v105, v78, v79
    v_cvt_pk_bf16_f32 v107, v78, v79
    v_permlane16_swap_b32 v104, v106
    s_nop 0
    v_permlane16_swap_b32 v105, v107
    v_min_u32 v104, 0xfffffffe, v104
    buffer_store_dwordx4 v[104:107], v237, s[8:11], s68 offen sc1

    ds_write_b128 v247, v[104:107]
    s_waitcnt lgkmcnt(0)
    s_barrier
    v_mov_b32 v79, 0
    v_mov_b32 v80, 0
    v_mov_b32 v81, 0
    v_mov_b32 v82, 0
    v_mov_b32 v83, 0
    s_waitcnt vmcnt(1)
    v_mov_b32 v192, -1
    v_mov_b32 v193, -1
    v_mov_b32 v194, -1
    v_mov_b32 v195, -1
    v_mov_b32 v196, -1
    v_mov_b32 v197, -1
    v_mov_b32 v198, -1
    v_mov_b32 v199, -1
    v_mov_b32 v200, -1
    v_mov_b32 v201, -1
    v_mov_b32 v202, -1
    v_mov_b32 v203, -1
    v_mov_b32 v204, -1
    v_mov_b32 v205, -1
    v_mov_b32 v206, -1
    v_mov_b32 v207, -1
    v_mov_b32 v208, -1
    v_mov_b32 v209, -1
    v_mov_b32 v210, -1
    v_mov_b32 v211, -1
    v_mov_b32 v212, -1
    v_mov_b32 v213, -1
    v_mov_b32 v214, -1
    v_mov_b32 v215, -1
    v_mov_b32 v216, -1
    v_mov_b32 v217, -1
    v_mov_b32 v218, -1
    v_mov_b32 v219, -1
    v_mov_b32 v220, -1
    v_mov_b32 v221, -1
    v_mov_b32 v222, -1
    v_mov_b32 v223, -1
    s_add_u32 s6, s28, 4
    s_cmp_ge_u32 s93, s6
    s_cbranch_scc1 .nl_65
    s_buffer_load_dword s14, s[8:11], s89 glc
    s_buffer_load_dword s15, s[8:11], s89 offset:8192 glc

.nl_65:
    s_add_u32 s28, s28, 1
    s_add_u32 s36, s36, 196608
    s_cmp_lt_u32 s28, 63
    s_cselect_b32 s4, 262144, 0
    s_add_u32 s38, s38, s4
    s_add_u32 s39, s39, s4
    s_add_u32 s30, s30, s4
    s_mov_b32 s4, s68
    s_mov_b32 s68, s69
    s_mov_b32 s69, s70
    s_mov_b32 s70, s71
    s_mov_b32 s71, s4
    s_and_b32 s4, s28, 3
    s_lshl_b32 s5, s4, 17
    s_add_u32 s29, s5, s34
    s_xor_b32 s6, s5, 262144
    s_add_u32 s31, s6, s34
    s_add_u32 s32, s29, 20480
    s_add_u32 s33, s29, 24576
    s_branch .top_28
.w3_30:
    ds_read_b128 v[36:39], v14 offset:8192
    ds_read_b128 v[40:43], v14 offset:9216
    ds_read_b128 v[44:47], v14 offset:10240
    ds_read_b128 v[48:51], v14 offset:11264
    ds_read_b128 v[88:91], v14 offset:16384
    s_waitcnt lgkmcnt(0)
    v_mfma_f32_16x16x32_bf16 v[104:107], v[84:87], v[36:39], 0
    v_mfma_f32_16x16x32_bf16 v[108:111], v[84:87], v[44:47], 0
    v_mfma_f32_16x16x32_bf16 v[104:107], v[84:87], v[40:43], v[104:107]
    v_mfma_f32_16x16x32_bf16 v[108:111], v[84:87], v[48:51], v[108:111]
    s_nop 7
    v_cvt_pk_bf16_f32 v168, v104, v105
    v_cvt_pk_bf16_f32 v169, v106, v107
    v_cvt_pk_bf16_f32 v170, v108, v109
    v_cvt_pk_bf16_f32 v171, v110, v111
    ds_write_b128 v14, v[168:171] offset:18432
    v_cndmask_b32 v172, v170, v168, s[60:61]
    v_cndmask_b32 v173, v171, v169, s[60:61]
    v_min_u32 v172, 0xfffffffe, v172
    v_min_u32 v173, 0xfffffffe, v173
    v_mov_b32 v174, v172
    v_mov_b32 v175, v173
    s_cmp_eq_u32 s28, 63
    s_nop 0
    v_permlane16_swap_b32 v172, v174
    v_permlane16_swap_b32 v173, v175
    ds_write_b128 v14, v[172:175] offset:17408

    s_cbranch_scc1 .sk_66
    s_waitcnt lgkmcnt(0)
    s_barrier
    buffer_store_dwordx4 v[188:191], v235, s[8:11], s31 offen
    buffer_store_dwordx4 v[188:191], v236, s[8:11], s31 offen

    s_branch .gp_31
.A_67:
    s_mov_b64 exec, vcc
    buffer_load_dwordx4 v[32:35], v8, s[8:11], s29 offen offset:3072 sc1
    s_mov_b64 exec, -1
    s_sub_u32 s62, s62, 1
    s_cbranch_scc1 .mg_end_1
    s_waitcnt vmcnt(3)
    v_max3_u32 v4, v20, v21, v22
    v_max_u32 v4, v4, v23
    v_cmp_eq_u32 vcc, -1, v4
    s_cbranch_vccz .W_34
.A_33:
    s_mov_b64 exec, vcc
    buffer_load_dwordx4 v[20:23], v8, s[8:11], s29 offen offset:0 sc1
    s_mov_b64 exec, -1
    s_waitcnt vmcnt(3)
    v_max3_u32 v4, v24, v25, v26
    v_max_u32 v4, v4, v27
    v_cmp_eq_u32 vcc, -1, v4
    s_cbranch_vccz .W_68
.A_69:
    s_mov_b64 exec, vcc
    buffer_load_dwordx4 v[24:27], v8, s[8:11], s29 offen offset:1024 sc1
    s_mov_b64 exec, -1
    s_waitcnt vmcnt(3)
    v_max3_u32 v4, v28, v29, v30
    v_max_u32 v4, v4, v31
    v_cmp_eq_u32 vcc, -1, v4
    s_cbranch_vccz .W_70
.A_71:
    s_mov_b64 exec, vcc
    buffer_load_dwordx4 v[28:31], v8, s[8:11], s29 offen offset:2048 sc1
    s_mov_b64 exec, -1
    s_waitcnt vmcnt(3)
    v_max3_u32 v4, v32, v33, v34
    v_max_u32 v4, v4, v35
    v_cmp_eq_u32 vcc, -1, v4
    s_cbranch_vccnz .A_67
.W_72:
    v_smfmac_f32_16x16x64_bf16 v[52:55], v[32:35], a[24:31], v9
    v_smfmac_f32_16x16x64_bf16 v[56:59], v[32:35], a[56:63], v9
    s_waitcnt vmcnt(2)
    v_max3_u32 v4, v20, v21, v22
    v_max_u32 v4, v4, v23
    v_smfmac_f32_16x16x64_bf16 v[60:63], v[32:35], a[88:95], v9
    v_cmp_eq_u32 vcc, -1, v4
    v_smfmac_f32_16x16x64_bf16 v[64:67], v[32:35], a[120:127], v9
    s_cbranch_vccnz .A_73
.W_74:
    v_smfmac_f32_16x16x64_bf16 v[52:55], v[20:23], a[0:7], v9
    v_smfmac_f32_16x16x64_bf16 v[56:59], v[20:23], a[32:39], v9
    s_waitcnt vmcnt(1)
    v_max3_u32 v4, v24, v25, v26
    v_max_u32 v4, v4, v27
    v_smfmac_f32_16x16x64_bf16 v[60:63], v[20:23], a[64:71], v9
    v_cmp_eq_u32 vcc, -1, v4
    v_smfmac_f32_16x16x64_bf16 v[64:67], v[20:23], a[96:103], v9
    s_cbranch_vccnz .A_75
.W_76:
    v_smfmac_f32_16x16x64_bf16 v[52:55], v[24:27], a[8:15], v9
    v_smfmac_f32_16x16x64_bf16 v[56:59], v[24:27], a[40:47], v9
    s_waitcnt vmcnt(0)
    v_max3_u32 v4, v28, v29, v30
    v_max_u32 v4, v4, v31
    v_smfmac_f32_16x16x64_bf16 v[60:63], v[24:27], a[72:79], v9
    v_cmp_eq_u32 vcc, -1, v4
    v_smfmac_f32_16x16x64_bf16 v[64:67], v[24:27], a[104:111], v9
    s_cbranch_vccnz .A_77
.W_78:
    v_smfmac_f32_16x16x64_bf16 v[52:55], v[28:31], a[16:23], v9
    v_smfmac_f32_16x16x64_bf16 v[56:59], v[28:31], a[48:55], v9
    v_smfmac_f32_16x16x64_bf16 v[60:63], v[28:31], a[80:87], v9
    v_smfmac_f32_16x16x64_bf16 v[64:67], v[28:31], a[112:119], v9
    s_branch .mj_32
.W_68:
    v_smfmac_f32_16x16x64_bf16 v[52:55], v[24:27], a[8:15], v9
    v_smfmac_f32_16x16x64_bf16 v[56:59], v[24:27], a[40:47], v9
    s_waitcnt vmcnt(2)
    v_max3_u32 v4, v28, v29, v30
    v_max_u32 v4, v4, v31
    v_smfmac_f32_16x16x64_bf16 v[60:63], v[24:27], a[72:79], v9
    v_cmp_eq_u32 vcc, -1, v4
    v_smfmac_f32_16x16x64_bf16 v[64:67], v[24:27], a[104:111], v9
    s_cbranch_vccnz .A_79
.W_80:
    v_smfmac_f32_16x16x64_bf16 v[52:55], v[28:31], a[16:23], v9
    v_smfmac_f32_16x16x64_bf16 v[56:59], v[28:31], a[48:55], v9
    s_waitcnt vmcnt(1)
    v_max3_u32 v4, v32, v33, v34
    v_max_u32 v4, v4, v35
    v_smfmac_f32_16x16x64_bf16 v[60:63], v[28:31], a[80:87], v9
    v_cmp_eq_u32 vcc, -1, v4
    v_smfmac_f32_16x16x64_bf16 v[64:67], v[28:31], a[112:119], v9
    s_cbranch_vccnz .A_81
.W_82:
    v_smfmac_f32_16x16x64_bf16 v[52:55], v[32:35], a[24:31], v9
    v_smfmac_f32_16x16x64_bf16 v[56:59], v[32:35], a[56:63], v9
    s_waitcnt vmcnt(0)
    v_max3_u32 v4, v20, v21, v22
    v_max_u32 v4, v4, v23
    v_smfmac_f32_16x16x64_bf16 v[60:63], v[32:35], a[88:95], v9
    v_cmp_eq_u32 vcc, -1, v4
    v_smfmac_f32_16x16x64_bf16 v[64:67], v[32:35], a[120:127], v9
    s_cbranch_vccnz .A_83
.W_84:
    v_smfmac_f32_16x16x64_bf16 v[52:55], v[20:23], a[0:7], v9
    v_smfmac_f32_16x16x64_bf16 v[56:59], v[20:23], a[32:39], v9
    v_smfmac_f32_16x16x64_bf16 v[60:63], v[20:23], a[64:71], v9
    v_smfmac_f32_16x16x64_bf16 v[64:67], v[20:23], a[96:103], v9
    s_branch .mj_32
.W_70:
    v_smfmac_f32_16x16x64_bf16 v[52:55], v[28:31], a[16:23], v9
    v_smfmac_f32_16x16x64_bf16 v[56:59], v[28:31], a[48:55], v9
    s_waitcnt vmcnt(2)
    v_max3_u32 v4, v32, v33, v34
    v_max_u32 v4, v4, v35
    v_smfmac_f32_16x16x64_bf16 v[60:63], v[28:31], a[80:87], v9
    v_cmp_eq_u32 vcc, -1, v4
    v_smfmac_f32_16x16x64_bf16 v[64:67], v[28:31], a[112:119], v9
    s_cbranch_vccnz .A_85
.W_86:
    v_smfmac_f32_16x16x64_bf16 v[52:55], v[32:35], a[24:31], v9
    v_smfmac_f32_16x16x64_bf16 v[56:59], v[32:35], a[56:63], v9
    s_waitcnt vmcnt(1)
    v_max3_u32 v4, v20, v21, v22
    v_max_u32 v4, v4, v23
    v_smfmac_f32_16x16x64_bf16 v[60:63], v[32:35], a[88:95], v9
    v_cmp_eq_u32 vcc, -1, v4
    v_smfmac_f32_16x16x64_bf16 v[64:67], v[32:35], a[120:127], v9
    s_cbranch_vccnz .A_87
.W_88:
    v_smfmac_f32_16x16x64_bf16 v[52:55], v[20:23], a[0:7], v9
    v_smfmac_f32_16x16x64_bf16 v[56:59], v[20:23], a[32:39], v9
    s_waitcnt vmcnt(0)
    v_max3_u32 v4, v24, v25, v26
    v_max_u32 v4, v4, v27
    v_smfmac_f32_16x16x64_bf16 v[60:63], v[20:23], a[64:71], v9
    v_cmp_eq_u32 vcc, -1, v4
    v_smfmac_f32_16x16x64_bf16 v[64:67], v[20:23], a[96:103], v9
    s_cbranch_vccnz .A_89
.W_90:
    v_smfmac_f32_16x16x64_bf16 v[52:55], v[24:27], a[8:15], v9
    v_smfmac_f32_16x16x64_bf16 v[56:59], v[24:27], a[40:47], v9
    v_smfmac_f32_16x16x64_bf16 v[60:63], v[24:27], a[72:79], v9
    v_smfmac_f32_16x16x64_bf16 v[64:67], v[24:27], a[104:111], v9
    s_branch .mj_32
.A_91:
    s_mov_b64 exec, vcc
    buffer_load_dwordx4 v[28:31], v8, s[8:11], s29 offen offset:2048 sc1
    s_mov_b64 exec, -1
    s_sub_u32 s62, s62, 1
    s_cbranch_scc1 .mg_end_1
    s_waitcnt vmcnt(2)
    v_max3_u32 v4, v20, v21, v22
    v_max_u32 v4, v4, v23
    v_cmp_eq_u32 vcc, -1, v4
    s_cbranch_vccz .W_74
.A_73:
    s_mov_b64 exec, vcc
    buffer_load_dwordx4 v[20:23], v8, s[8:11], s29 offen offset:0 sc1
    s_mov_b64 exec, -1
    s_waitcnt vmcnt(2)
    v_max3_u32 v4, v24, v25, v26
    v_max_u32 v4, v4, v27
    v_cmp_eq_u32 vcc, -1, v4
    s_cbranch_vccz .W_92
.A_93:
    s_mov_b64 exec, vcc
    buffer_load_dwordx4 v[24:27], v8, s[8:11], s29 offen offset:1024 sc1
    s_mov_b64 exec, -1
    s_waitcnt vmcnt(2)
    v_max3_u32 v4, v28, v29, v30
    v_max_u32 v4, v4, v31
    v_cmp_eq_u32 vcc, -1, v4
    s_cbranch_vccnz .A_91
.W_94:
    v_smfmac_f32_16x16x64_bf16 v[52:55], v[28:31], a[16:23], v9
    v_smfmac_f32_16x16x64_bf16 v[56:59], v[28:31], a[48:55], v9
    s_waitcnt vmcnt(1)
    v_max3_u32 v4, v20, v21, v22
    v_max_u32 v4, v4, v23
    v_smfmac_f32_16x16x64_bf16 v[60:63], v[28:31], a[80:87], v9
    v_cmp_eq_u32 vcc, -1, v4
    v_smfmac_f32_16x16x64_bf16 v[64:67], v[28:31], a[112:119], v9
    s_cbranch_vccz .W_88
    s_branch .A_87
.W_92:
    v_smfmac_f32_16x16x64_bf16 v[52:55], v[24:27], a[8:15], v9
    v_smfmac_f32_16x16x64_bf16 v[56:59], v[24:27], a[40:47], v9
    s_waitcnt vmcnt(1)
    v_max3_u32 v4, v28, v29, v30
    v_max_u32 v4, v4, v31
    v_smfmac_f32_16x16x64_bf16 v[60:63], v[24:27], a[72:79], v9
    v_cmp_eq_u32 vcc, -1, v4
    v_smfmac_f32_16x16x64_bf16 v[64:67], v[24:27], a[104:111], v9
    s_cbranch_vccnz .A_95
.W_96:
    v_smfmac_f32_16x16x64_bf16 v[52:55], v[28:31], a[16:23], v9
    v_smfmac_f32_16x16x64_bf16 v[56:59], v[28:31], a[48:55], v9
    s_waitcnt vmcnt(0)
    v_max3_u32 v4, v20, v21, v22
    v_max_u32 v4, v4, v23
    v_smfmac_f32_16x16x64_bf16 v[60:63], v[28:31], a[80:87], v9
    v_cmp_eq_u32 vcc, -1, v4
    v_smfmac_f32_16x16x64_bf16 v[64:67], v[28:31], a[112:119], v9
    s_cbranch_vccz .W_84
    s_branch .A_83
.A_97:
    s_mov_b64 exec, vcc
    buffer_load_dwordx4 v[24:27], v8, s[8:11], s29 offen offset:1024 sc1
    s_mov_b64 exec, -1
    s_sub_u32 s62, s62, 1
    s_cbranch_scc1 .mg_end_1
    s_waitcnt vmcnt(2)
    v_max3_u32 v4, v32, v33, v34
    v_max_u32 v4, v4, v35
    v_cmp_eq_u32 vcc, -1, v4
    s_cbranch_vccz .W_86
.A_85:
    s_mov_b64 exec, vcc
    buffer_load_dwordx4 v[32:35], v8, s[8:11], s29 offen offset:3072 sc1
    s_mov_b64 exec, -1
    s_waitcnt vmcnt(2)
    v_max3_u32 v4, v20, v21, v22
    v_max_u32 v4, v4, v23
    v_cmp_eq_u32 vcc, -1, v4
    s_cbranch_vccz .W_98
.A_99:
    s_mov_b64 exec, vcc
    buffer_load_dwordx4 v[20:23], v8, s[8:11], s29 offen offset:0 sc1
    s_mov_b64 exec, -1
    s_waitcnt vmcnt(2)
    v_max3_u32 v4, v24, v25, v26
    v_max_u32 v4, v4, v27
    v_cmp_eq_u32 vcc, -1, v4
    s_cbranch_vccnz .A_97
.W_100:
    v_smfmac_f32_16x16x64_bf16 v[52:55], v[24:27], a[8:15], v9
    v_smfmac_f32_16x16x64_bf16 v[56:59], v[24:27], a[40:47], v9
    s_waitcnt vmcnt(1)
    v_max3_u32 v4, v32, v33, v34
    v_max_u32 v4, v4, v35
    v_smfmac_f32_16x16x64_bf16 v[60:63], v[24:27], a[72:79], v9
    v_cmp_eq_u32 vcc, -1, v4
    v_smfmac_f32_16x16x64_bf16 v[64:67], v[24:27], a[104:111], v9
    s_cbranch_vccz .W_82
    s_branch .A_81
.W_98:
    v_smfmac_f32_16x16x64_bf16 v[52:55], v[20:23], a[0:7], v9
    v_smfmac_f32_16x16x64_bf16 v[56:59], v[20:23], a[32:39], v9
    s_waitcnt vmcnt(1)
    v_max3_u32 v4, v24, v25, v26
    v_max_u32 v4, v4, v27
    v_smfmac_f32_16x16x64_bf16 v[60:63], v[20:23], a[64:71], v9
    v_cmp_eq_u32 vcc, -1, v4
    v_smfmac_f32_16x16x64_bf16 v[64:67], v[20:23], a[96:103], v9
    s_cbranch_vccnz .A_101
.W_102:
    v_smfmac_f32_16x16x64_bf16 v[52:55], v[24:27], a[8:15], v9
    v_smfmac_f32_16x16x64_bf16 v[56:59], v[24:27], a[40:47], v9
    s_waitcnt vmcnt(0)
    v_max3_u32 v4, v32, v33, v34
    v_max_u32 v4, v4, v35
    v_smfmac_f32_16x16x64_bf16 v[60:63], v[24:27], a[72:79], v9
    v_cmp_eq_u32 vcc, -1, v4
    v_smfmac_f32_16x16x64_bf16 v[64:67], v[24:27], a[104:111], v9
    s_cbranch_vccz .W_40
    s_branch .A_39
.A_103:
    s_mov_b64 exec, vcc
    buffer_load_dwordx4 v[32:35], v8, s[8:11], s29 offen offset:3072 sc1
    s_mov_b64 exec, -1
    s_sub_u32 s62, s62, 1
    s_cbranch_scc1 .mg_end_1
    s_waitcnt vmcnt(2)
    v_max3_u32 v4, v20, v21, v22
    v_max_u32 v4, v4, v23
    v_cmp_eq_u32 vcc, -1, v4
    s_cbranch_vccz .W_104
.A_105:
    s_mov_b64 exec, vcc
    buffer_load_dwordx4 v[20:23], v8, s[8:11], s29 offen offset:0 sc1
    s_mov_b64 exec, -1
    s_waitcnt vmcnt(2)
    v_max3_u32 v4, v28, v29, v30
    v_max_u32 v4, v4, v31
    v_cmp_eq_u32 vcc, -1, v4
    s_cbranch_vccz .W_80
.A_79:
    s_mov_b64 exec, vcc
    buffer_load_dwordx4 v[28:31], v8, s[8:11], s29 offen offset:2048 sc1
    s_mov_b64 exec, -1
    s_waitcnt vmcnt(2)
    v_max3_u32 v4, v32, v33, v34
    v_max_u32 v4, v4, v35
    v_cmp_eq_u32 vcc, -1, v4
    s_cbranch_vccnz .A_103
.W_106:
    v_smfmac_f32_16x16x64_bf16 v[52:55], v[32:35], a[24:31], v9
    v_smfmac_f32_16x16x64_bf16 v[56:59], v[32:35], a[56:63], v9
    s_waitcnt vmcnt(1)
    v_max3_u32 v4, v20, v21, v22
    v_max_u32 v4, v4, v23
    v_smfmac_f32_16x16x64_bf16 v[60:63], v[32:35], a[88:95], v9
    v_cmp_eq_u32 vcc, -1, v4
    v_smfmac_f32_16x16x64_bf16 v[64:67], v[32:35], a[120:127], v9
    s_cbranch_vccnz .A_107
.W_108:
    v_smfmac_f32_16x16x64_bf16 v[52:55], v[20:23], a[0:7], v9
    v_smfmac_f32_16x16x64_bf16 v[56:59], v[20:23], a[32:39], v9
    s_waitcnt vmcnt(0)
    v_max3_u32 v4, v28, v29, v30
    v_max_u32 v4, v4, v31
    v_smfmac_f32_16x16x64_bf16 v[60:63], v[20:23], a[64:71], v9
    v_cmp_eq_u32 vcc, -1, v4
    v_smfmac_f32_16x16x64_bf16 v[64:67], v[20:23], a[96:103], v9
    s_cbranch_vccz .W_78
    s_branch .A_77
.W_104:
    v_smfmac_f32_16x16x64_bf16 v[52:55], v[20:23], a[0:7], v9
    v_smfmac_f32_16x16x64_bf16 v[56:59], v[20:23], a[32:39], v9
    s_waitcnt vmcnt(1)
    v_max3_u32 v4, v28, v29, v30
    v_max_u32 v4, v4, v31
    v_smfmac_f32_16x16x64_bf16 v[60:63], v[20:23], a[64:71], v9
    v_cmp_eq_u32 vcc, -1, v4
    v_smfmac_f32_16x16x64_bf16 v[64:67], v[20:23], a[96:103], v9
    s_cbranch_vccz .W_38
    s_branch .A_37
.A_109:
    s_mov_b64 exec, vcc
    buffer_load_dwordx4 v[32:35], v8, s[8:11], s29 offen offset:3072 sc1
    s_mov_b64 exec, -1
    s_sub_u32 s62, s62, 1
    s_cbranch_scc1 .mg_end_1
    s_waitcnt vmcnt(2)
    v_max3_u32 v4, v24, v25, v26
    v_max_u32 v4, v4, v27
    v_cmp_eq_u32 vcc, -1, v4
    s_cbranch_vccz .W_36
.A_35:
    s_mov_b64 exec, vcc
    buffer_load_dwordx4 v[24:27], v8, s[8:11], s29 offen offset:1024 sc1
    s_mov_b64 exec, -1
    s_waitcnt vmcnt(2)
    v_max3_u32 v4, v28, v29, v30
    v_max_u32 v4, v4, v31
    v_cmp_eq_u32 vcc, -1, v4
    s_cbranch_vccz .W_110
.A_111:
    s_mov_b64 exec, vcc
    buffer_load_dwordx4 v[28:31], v8, s[8:11], s29 offen offset:2048 sc1
    s_mov_b64 exec, -1
    s_waitcnt vmcnt(2)
    v_max3_u32 v4, v32, v33, v34
    v_max_u32 v4, v4, v35
    v_cmp_eq_u32 vcc, -1, v4
    s_cbranch_vccnz .A_109
.W_112:
    v_smfmac_f32_16x16x64_bf16 v[52:55], v[32:35], a[24:31], v9
    v_smfmac_f32_16x16x64_bf16 v[56:59], v[32:35], a[56:63], v9
    s_waitcnt vmcnt(1)
    v_max3_u32 v4, v24, v25, v26
    v_max_u32 v4, v4, v27
    v_smfmac_f32_16x16x64_bf16 v[60:63], v[32:35], a[88:95], v9
    v_cmp_eq_u32 vcc, -1, v4
    v_smfmac_f32_16x16x64_bf16 v[64:67], v[32:35], a[120:127], v9
    s_cbranch_vccz .W_76
    s_branch .A_75
.W_110:
    v_smfmac_f32_16x16x64_bf16 v[52:55], v[28:31], a[16:23], v9
    v_smfmac_f32_16x16x64_bf16 v[56:59], v[28:31], a[48:55], v9
    s_waitcnt vmcnt(1)
    v_max3_u32 v4, v32, v33, v34
    v_max_u32 v4, v4, v35
    v_smfmac_f32_16x16x64_bf16 v[60:63], v[28:31], a[80:87], v9
    v_cmp_eq_u32 vcc, -1, v4
    v_smfmac_f32_16x16x64_bf16 v[64:67], v[28:31], a[112:119], v9
    s_cbranch_vccnz .A_113
.W_114:
    v_smfmac_f32_16x16x64_bf16 v[52:55], v[32:35], a[24:31], v9
    v_smfmac_f32_16x16x64_bf16 v[56:59], v[32:35], a[56:63], v9
    s_waitcnt vmcnt(0)
    v_max3_u32 v4, v24, v25, v26
    v_max_u32 v4, v4, v27
    v_smfmac_f32_16x16x64_bf16 v[60:63], v[32:35], a[88:95], v9
    v_cmp_eq_u32 vcc, -1, v4
    v_smfmac_f32_16x16x64_bf16 v[64:67], v[32:35], a[120:127], v9
    s_cbranch_vccz .W_90
    s_branch .A_89
.A_115:
    s_mov_b64 exec, vcc
    buffer_load_dwordx4 v[24:27], v8, s[8:11], s29 offen offset:1024 sc1
    s_mov_b64 exec, -1
    s_sub_u32 s62, s62, 1
    s_cbranch_scc1 .mg_end_1
    s_waitcnt vmcnt(1)
    v_max3_u32 v4, v20, v21, v22
    v_max_u32 v4, v4, v23
    v_cmp_eq_u32 vcc, -1, v4
    s_cbranch_vccz .W_88
.A_87:
    s_mov_b64 exec, vcc
    buffer_load_dwordx4 v[20:23], v8, s[8:11], s29 offen offset:0 sc1
    s_mov_b64 exec, -1
    s_waitcnt vmcnt(1)
    v_max3_u32 v4, v24, v25, v26
    v_max_u32 v4, v4, v27
    v_cmp_eq_u32 vcc, -1, v4
    s_cbranch_vccnz .A_115
.W_116:
    v_smfmac_f32_16x16x64_bf16 v[52:55], v[24:27], a[8:15], v9
    v_smfmac_f32_16x16x64_bf16 v[56:59], v[24:27], a[40:47], v9
    s_waitcnt vmcnt(0)
    v_max3_u32 v4, v20, v21, v22
    v_max_u32 v4, v4, v23
    v_smfmac_f32_16x16x64_bf16 v[60:63], v[24:27], a[72:79], v9
    v_cmp_eq_u32 vcc, -1, v4
    v_smfmac_f32_16x16x64_bf16 v[64:67], v[24:27], a[104:111], v9
    s_cbranch_vccz .W_84
    s_branch .A_83
.A_95:
    s_mov_b64 exec, vcc
    buffer_load_dwordx4 v[28:31], v8, s[8:11], s29 offen offset:2048 sc1
    s_mov_b64 exec, -1
    s_sub_u32 s62, s62, 1
    s_cbranch_scc1 .mg_end_1
    s_waitcnt vmcnt(1)
    v_max3_u32 v4, v20, v21, v22
    v_max_u32 v4, v4, v23
    v_cmp_eq_u32 vcc, -1, v4
    s_cbranch_vccz .W_108
.A_107:
    s_mov_b64 exec, vcc
    buffer_load_dwordx4 v[20:23], v8, s[8:11], s29 offen offset:0 sc1
    s_mov_b64 exec, -1
    s_waitcnt vmcnt(1)
    v_max3_u32 v4, v28, v29, v30
    v_max_u32 v4, v4, v31
    v_cmp_eq_u32 vcc, -1, v4
    s_cbranch_vccnz .A_95
    s_branch .W_96
.A_117:
    s_mov_b64 exec, vcc
    buffer_load_dwordx4 v[20:23], v8, s[8:11], s29 offen offset:0 sc1
    s_mov_b64 exec, -1
    s_sub_u32 s62, s62, 1
    s_cbranch_scc1 .mg_end_1
    s_waitcnt vmcnt(1)
    v_max3_u32 v4, v32, v33, v34
    v_max_u32 v4, v4, v35
    v_cmp_eq_u32 vcc, -1, v4
    s_cbranch_vccz .W_82
.A_81:
    s_mov_b64 exec, vcc
    buffer_load_dwordx4 v[32:35], v8, s[8:11], s29 offen offset:3072 sc1
    s_mov_b64 exec, -1
    s_waitcnt vmcnt(1)
    v_max3_u32 v4, v20, v21, v22
    v_max_u32 v4, v4, v23
    v_cmp_eq_u32 vcc, -1, v4
    s_cbranch_vccnz .A_117
.W_118:
    v_smfmac_f32_16x16x64_bf16 v[52:55], v[20:23], a[0:7], v9
    v_smfmac_f32_16x16x64_bf16 v[56:59], v[20:23], a[32:39], v9
    s_waitcnt vmcnt(0)
    v_max3_u32 v4, v32, v33, v34
    v_max_u32 v4, v4, v35
    v_smfmac_f32_16x16x64_bf16 v[60:63], v[20:23], a[64:71], v9
    v_cmp_eq_u32 vcc, -1, v4
    v_smfmac_f32_16x16x64_bf16 v[64:67], v[20:23], a[96:103], v9
    s_cbranch_vccz .W_40
    s_branch .A_39
.A_119:
    s_mov_b64 exec, vcc
    buffer_load_dwordx4 v[28:31], v8, s[8:11], s29 offen offset:2048 sc1
    s_mov_b64 exec, -1
    s_sub_u32 s62, s62, 1
    s_cbranch_scc1 .mg_end_1
    s_waitcnt vmcnt(1)
    v_max3_u32 v4, v24, v25, v26
    v_max_u32 v4, v4, v27
    v_cmp_eq_u32 vcc, -1, v4
    s_cbranch_vccz .W_76
.A_75:
    s_mov_b64 exec, vcc
    buffer_load_dwordx4 v[24:27], v8, s[8:11], s29 offen offset:1024 sc1
    s_mov_b64 exec, -1
    s_waitcnt vmcnt(1)
    v_max3_u32 v4, v28, v29, v30
    v_max_u32 v4, v4, v31
    v_cmp_eq_u32 vcc, -1, v4
    s_cbranch_vccnz .A_119
.W_120:
    v_smfmac_f32_16x16x64_bf16 v[52:55], v[28:31], a[16:23], v9
    v_smfmac_f32_16x16x64_bf16 v[56:59], v[28:31], a[48:55], v9
    s_waitcnt vmcnt(0)
    v_max3_u32 v4, v24, v25, v26
    v_max_u32 v4, v4, v27
    v_smfmac_f32_16x16x64_bf16 v[60:63], v[28:31], a[80:87], v9
    v_cmp_eq_u32 vcc, -1, v4
    v_smfmac_f32_16x16x64_bf16 v[64:67], v[28:31], a[112:119], v9
    s_cbranch_vccz .W_90
    s_branch .A_89
.A_113:
    s_mov_b64 exec, vcc
    buffer_load_dwordx4 v[32:35], v8, s[8:11], s29 offen offset:3072 sc1
    s_mov_b64 exec, -1
    s_sub_u32 s62, s62, 1
    s_cbranch_scc1 .mg_end_1
    s_waitcnt vmcnt(1)
    v_max3_u32 v4, v24, v25, v26
    v_max_u32 v4, v4, v27
    v_cmp_eq_u32 vcc, -1, v4
    s_cbranch_vccz .W_102
.A_101:
    s_mov_b64 exec, vcc
    buffer_load_dwordx4 v[24:27], v8, s[8:11], s29 offen offset:1024 sc1
    s_mov_b64 exec, -1
    s_waitcnt vmcnt(1)
    v_max3_u32 v4, v32, v33, v34
    v_max_u32 v4, v4, v35
    v_cmp_eq_u32 vcc, -1, v4
    s_cbranch_vccnz .A_113
    s_branch .W_114
.A_121:
    s_mov_b64 exec, vcc
    buffer_load_dwordx4 v[32:35], v8, s[8:11], s29 offen offset:3072 sc1
    s_mov_b64 exec, -1
    s_sub_u32 s62, s62, 1
    s_cbranch_scc1 .mg_end_1
    s_waitcnt vmcnt(1)
    v_max3_u32 v4, v28, v29, v30
    v_max_u32 v4, v4, v31
    v_cmp_eq_u32 vcc, -1, v4
    s_cbranch_vccz .W_38
.A_37:
    s_mov_b64 exec, vcc
    buffer_load_dwordx4 v[28:31], v8, s[8:11], s29 offen offset:2048 sc1
    s_mov_b64 exec, -1
    s_waitcnt vmcnt(1)
    v_max3_u32 v4, v32, v33, v34
    v_max_u32 v4, v4, v35
    v_cmp_eq_u32 vcc, -1, v4
    s_cbranch_vccnz .A_121
.W_122:
    v_smfmac_f32_16x16x64_bf16 v[52:55], v[32:35], a[24:31], v9
    v_smfmac_f32_16x16x64_bf16 v[56:59], v[32:35], a[56:63], v9
    s_waitcnt vmcnt(0)
    v_max3_u32 v4, v28, v29, v30
    v_max_u32 v4, v4, v31
    v_smfmac_f32_16x16x64_bf16 v[60:63], v[32:35], a[88:95], v9
    v_cmp_eq_u32 vcc, -1, v4
    v_smfmac_f32_16x16x64_bf16 v[64:67], v[32:35], a[120:127], v9
    s_cbranch_vccz .W_78
    s_branch .A_77
.A_83:
    s_mov_b64 exec, vcc
    buffer_load_dwordx4 v[20:23], v8, s[8:11], s29 offen offset:0 sc1
    s_mov_b64 exec, -1
    s_sub_u32 s62, s62, 1
    s_cbranch_scc1 .mg_end_1
    s_waitcnt vmcnt(1)
    v_max3_u32 v4, v20, v21, v22
    v_max_u32 v4, v4, v23
    v_cmp_eq_u32 vcc, -1, v4
    s_cbranch_vccnz .A_83
    v_smfmac_f32_16x16x64_bf16 v[52:55], v[20:23], a[0:7], v9
    v_smfmac_f32_16x16x64_bf16 v[56:59], v[20:23], a[32:39], v9
    v_smfmac_f32_16x16x64_bf16 v[60:63], v[20:23], a[64:71], v9
    v_smfmac_f32_16x16x64_bf16 v[64:67], v[20:23], a[96:103], v9
    s_branch .mj_32
.A_89:
    s_mov_b64 exec, vcc
    buffer_load_dwordx4 v[24:27], v8, s[8:11], s29 offen offset:1024 sc1
    s_mov_b64 exec, -1
    s_sub_u32 s62, s62, 1
    s_cbranch_scc1 .mg_end_1
    s_waitcnt vmcnt(1)
    v_max3_u32 v4, v24, v25, v26
    v_max_u32 v4, v4, v27
    v_cmp_eq_u32 vcc, -1, v4
    s_cbranch_vccnz .A_89
    v_smfmac_f32_16x16x64_bf16 v[52:55], v[24:27], a[8:15], v9
    v_smfmac_f32_16x16x64_bf16 v[56:59], v[24:27], a[40:47], v9
    v_smfmac_f32_16x16x64_bf16 v[60:63], v[24:27], a[72:79], v9
    v_smfmac_f32_16x16x64_bf16 v[64:67], v[24:27], a[104:111], v9
    s_branch .mj_32
.A_77:
    s_mov_b64 exec, vcc
    buffer_load_dwordx4 v[28:31], v8, s[8:11], s29 offen offset:2048 sc1
    s_mov_b64 exec, -1
    s_sub_u32 s62, s62, 1
    s_cbranch_scc1 .mg_end_1
    s_waitcnt vmcnt(1)
    v_max3_u32 v4, v28, v29, v30
    v_max_u32 v4, v4, v31
    v_cmp_eq_u32 vcc, -1, v4
    s_cbranch_vccnz .A_77
    v_smfmac_f32_16x16x64_bf16 v[52:55], v[28:31], a[16:23], v9
    v_smfmac_f32_16x16x64_bf16 v[56:59], v[28:31], a[48:55], v9
    v_smfmac_f32_16x16x64_bf16 v[60:63], v[28:31], a[80:87], v9
    v_smfmac_f32_16x16x64_bf16 v[64:67], v[28:31], a[112:119], v9
    s_branch .mj_32
.A_39:
    s_mov_b64 exec, vcc
    buffer_load_dwordx4 v[32:35], v8, s[8:11], s29 offen offset:3072 sc1
    s_mov_b64 exec, -1
    s_sub_u32 s62, s62, 1
    s_cbranch_scc1 .mg_end_1
    s_waitcnt vmcnt(1)
    v_max3_u32 v4, v32, v33, v34
    v_max_u32 v4, v4, v35
    v_cmp_eq_u32 vcc, -1, v4
    s_cbranch_vccnz .A_39
    v_smfmac_f32_16x16x64_bf16 v[52:55], v[32:35], a[24:31], v9
    v_smfmac_f32_16x16x64_bf16 v[56:59], v[32:35], a[56:63], v9
    v_smfmac_f32_16x16x64_bf16 v[60:63], v[32:35], a[88:95], v9
    v_smfmac_f32_16x16x64_bf16 v[64:67], v[32:35], a[120:127], v9
    s_branch .mj_32
.A_123:
    buffer_load_dwordx4 v[100:103], v234, s[8:11], s29 offen sc1
    s_sub_u32 s62, s62, 1
    s_cbranch_scc1 .mg_end_1
    s_waitcnt vmcnt(2)
    v_max3_u32 v4, v92, v93, v94
    v_max_u32 v4, v4, v95
    v_cmp_eq_u32 vcc, -1, v4
    s_cbranch_vccz .W_43
.A_42:
    buffer_load_dwordx4 v[92:95], v232, s[8:11], s29 offen sc1
    s_waitcnt vmcnt(2)
    v_max3_u32 v4, v96, v97, v98
    v_max_u32 v4, v4, v99
    v_cmp_eq_u32 vcc, -1, v4
    s_cbranch_vccz .W_124
.A_125:
    buffer_load_dwordx4 v[96:99], v233, s[8:11], s29 offen sc1
    s_waitcnt vmcnt(2)
    v_max3_u32 v4, v100, v101, v102
    v_max_u32 v4, v4, v103
    v_cmp_eq_u32 vcc, -1, v4
    s_cbranch_vccnz .A_123
.W_126:
    v_mfma_f32_16x16x32_bf16 v[208:211], v[140:143], v[100:103], v[208:211]
    s_waitcnt vmcnt(1)
    v_max3_u32 v4, v92, v93, v94
    v_max_u32 v4, v4, v95
    v_mfma_f32_16x16x32_bf16 v[212:215], v[156:159], v[100:103], v[212:215]
    v_cmp_eq_u32 vcc, -1, v4
    v_mfma_f32_16x16x32_bf16 v[216:219], v[100:103], v[100:103], v[216:219]
    s_cbranch_vccnz .A_127
.W_128:
    v_mfma_f32_16x16x32_bf16 v[208:211], v[132:135], v[92:95], v[208:211]
    s_waitcnt vmcnt(0)
    v_max3_u32 v4, v96, v97, v98
    v_max_u32 v4, v4, v99
    v_mfma_f32_16x16x32_bf16 v[212:215], v[148:151], v[92:95], v[212:215]
    v_cmp_eq_u32 vcc, -1, v4
    v_mfma_f32_16x16x32_bf16 v[216:219], v[92:95], v[92:95], v[216:219]
    s_cbranch_vccnz .A_129
.W_130:
    v_mfma_f32_16x16x32_bf16 v[208:211], v[136:139], v[96:99], v[208:211]
    v_mfma_f32_16x16x32_bf16 v[212:215], v[152:155], v[96:99], v[212:215]
    v_mfma_f32_16x16x32_bf16 v[216:219], v[96:99], v[96:99], v[216:219]
    s_branch .mj_41
.W_124:
    v_mfma_f32_16x16x32_bf16 v[208:211], v[136:139], v[96:99], v[208:211]
    s_waitcnt vmcnt(1)
    v_max3_u32 v4, v100, v101, v102
    v_max_u32 v4, v4, v103
    v_mfma_f32_16x16x32_bf16 v[212:215], v[152:155], v[96:99], v[212:215]
    v_cmp_eq_u32 vcc, -1, v4
    v_mfma_f32_16x16x32_bf16 v[216:219], v[96:99], v[96:99], v[216:219]
    s_cbranch_vccnz .A_131
.W_132:
    v_mfma_f32_16x16x32_bf16 v[208:211], v[140:143], v[100:103], v[208:211]
    s_waitcnt vmcnt(0)
    v_max3_u32 v4, v92, v93, v94
    v_max_u32 v4, v4, v95
    v_mfma_f32_16x16x32_bf16 v[212:215], v[156:159], v[100:103], v[212:215]
    v_cmp_eq_u32 vcc, -1, v4
    v_mfma_f32_16x16x32_bf16 v[216:219], v[100:103], v[100:103], v[216:219]
    s_cbranch_vccnz .A_133
.W_134:
    v_mfma_f32_16x16x32_bf16 v[208:211], v[132:135], v[92:95], v[208:211]
    v_mfma_f32_16x16x32_bf16 v[212:215], v[148:151], v[92:95], v[212:215]
    v_mfma_f32_16x16x32_bf16 v[216:219], v[92:95], v[92:95], v[216:219]
    s_branch .mj_41
.A_135:
    buffer_load_dwordx4 v[96:99], v233, s[8:11], s29 offen sc1
    s_sub_u32 s62, s62, 1
    s_cbranch_scc1 .mg_end_1
    s_waitcnt vmcnt(1)
    v_max3_u32 v4, v92, v93, v94
    v_max_u32 v4, v4, v95
    v_cmp_eq_u32 vcc, -1, v4
    s_cbranch_vccz .W_128
.A_127:
    buffer_load_dwordx4 v[92:95], v232, s[8:11], s29 offen sc1
    s_waitcnt vmcnt(1)
    v_max3_u32 v4, v96, v97, v98
    v_max_u32 v4, v4, v99
    v_cmp_eq_u32 vcc, -1, v4
    s_cbranch_vccnz .A_135
.W_136:
    v_mfma_f32_16x16x32_bf16 v[208:211], v[136:139], v[96:99], v[208:211]
    s_waitcnt vmcnt(0)
    v_max3_u32 v4, v92, v93, v94
    v_max_u32 v4, v4, v95
    v_mfma_f32_16x16x32_bf16 v[212:215], v[152:155], v[96:99], v[212:215]
    v_cmp_eq_u32 vcc, -1, v4
    v_mfma_f32_16x16x32_bf16 v[216:219], v[96:99], v[96:99], v[216:219]
    s_cbranch_vccz .W_134
    s_branch .A_133
.A_137:
    buffer_load_dwordx4 v[92:95], v232, s[8:11], s29 offen sc1
    s_sub_u32 s62, s62, 1
    s_cbranch_scc1 .mg_end_1
    s_waitcnt vmcnt(1)
    v_max3_u32 v4, v100, v101, v102
    v_max_u32 v4, v4, v103
    v_cmp_eq_u32 vcc, -1, v4
    s_cbranch_vccz .W_132
.A_131:
    buffer_load_dwordx4 v[100:103], v234, s[8:11], s29 offen sc1
    s_waitcnt vmcnt(1)
    v_max3_u32 v4, v92, v93, v94
    v_max_u32 v4, v4, v95
    v_cmp_eq_u32 vcc, -1, v4
    s_cbranch_vccnz .A_137
.W_138:
    v_mfma_f32_16x16x32_bf16 v[208:211], v[132:135], v[92:95], v[208:211]
    s_waitcnt vmcnt(0)
    v_max3_u32 v4, v100, v101, v102
    v_max_u32 v4, v4, v103
    v_mfma_f32_16x16x32_bf16 v[212:215], v[148:151], v[92:95], v[212:215]
    v_cmp_eq_u32 vcc, -1, v4
    v_mfma_f32_16x16x32_bf16 v[216:219], v[92:95], v[92:95], v[216:219]
    s_cbranch_vccz .W_47
    s_branch .A_46
.A_139:
    buffer_load_dwordx4 v[100:103], v234, s[8:11], s29 offen sc1
    s_sub_u32 s62, s62, 1
    s_cbranch_scc1 .mg_end_1
    s_waitcnt vmcnt(1)
    v_max3_u32 v4, v96, v97, v98
    v_max_u32 v4, v4, v99
    v_cmp_eq_u32 vcc, -1, v4
    s_cbranch_vccz .W_45
.A_44:
    buffer_load_dwordx4 v[96:99], v233, s[8:11], s29 offen sc1
    s_waitcnt vmcnt(1)
    v_max3_u32 v4, v100, v101, v102
    v_max_u32 v4, v4, v103
    v_cmp_eq_u32 vcc, -1, v4
    s_cbranch_vccnz .A_139
.W_140:
    v_mfma_f32_16x16x32_bf16 v[208:211], v[140:143], v[100:103], v[208:211]
    s_waitcnt vmcnt(0)
    v_max3_u32 v4, v96, v97, v98
    v_max_u32 v4, v4, v99
    v_mfma_f32_16x16x32_bf16 v[212:215], v[156:159], v[100:103], v[212:215]
    v_cmp_eq_u32 vcc, -1, v4
    v_mfma_f32_16x16x32_bf16 v[216:219], v[100:103], v[100:103], v[216:219]
    s_cbranch_vccz .W_130
    s_branch .A_129
.A_133:
    buffer_load_dwordx4 v[92:95], v232, s[8:11], s29 offen sc1
    s_sub_u32 s62, s62, 1
    s_cbranch_scc1 .mg_end_1
    s_waitcnt vmcnt(1)
    v_max3_u32 v4, v92, v93, v94
    v_max_u32 v4, v4, v95
    v_cmp_eq_u32 vcc, -1, v4
    s_cbranch_vccnz .A_133
    v_mfma_f32_16x16x32_bf16 v[208:211], v[132:135], v[92:95], v[208:211]
    v_mfma_f32_16x16x32_bf16 v[212:215], v[148:151], v[92:95], v[212:215]
    v_mfma_f32_16x16x32_bf16 v[216:219], v[92:95], v[92:95], v[216:219]
    s_branch .mj_41
.A_129:
    buffer_load_dwordx4 v[96:99], v233, s[8:11], s29 offen sc1
    s_sub_u32 s62, s62, 1
    s_cbranch_scc1 .mg_end_1
    s_waitcnt vmcnt(1)
    v_max3_u32 v4, v96, v97, v98
    v_max_u32 v4, v4, v99
    v_cmp_eq_u32 vcc, -1, v4
    s_cbranch_vccnz .A_129
    v_mfma_f32_16x16x32_bf16 v[208:211], v[136:139], v[96:99], v[208:211]
    v_mfma_f32_16x16x32_bf16 v[212:215], v[152:155], v[96:99], v[212:215]
    v_mfma_f32_16x16x32_bf16 v[216:219], v[96:99], v[96:99], v[216:219]
    s_branch .mj_41
.A_46:
    buffer_load_dwordx4 v[100:103], v234, s[8:11], s29 offen sc1
    s_sub_u32 s62, s62, 1
    s_cbranch_scc1 .mg_end_1
    s_waitcnt vmcnt(1)
    v_max3_u32 v4, v100, v101, v102
    v_max_u32 v4, v4, v103
    v_cmp_eq_u32 vcc, -1, v4
    s_cbranch_vccnz .A_46
    v_mfma_f32_16x16x32_bf16 v[208:211], v[140:143], v[100:103], v[208:211]
    v_mfma_f32_16x16x32_bf16 v[212:215], v[156:159], v[100:103], v[212:215]
    v_mfma_f32_16x16x32_bf16 v[216:219], v[100:103], v[100:103], v[216:219]
    s_branch .mj_41
.kf_54:
    s_mov_b32 s62, 0
    s_mov_b64 exec, 3
.wf_141:
    buffer_load_dword v244, v253, s[8:11], s89 offen sc1
    s_waitcnt vmcnt(0)
    v_cmp_gt_u32 vcc, s6, v244
    s_cbranch_vccz .wfd_142
    s_sleep 2
    s_add_u32 s62, s62, 1
    s_cmp_gt_u32 s62, 0x400000
    s_cbranch_scc1 .mg_end_1
    s_branch .wf_141

.wfd_142:
    s_mov_b64 exec, -1
    v_readlane_b32 s4, v244, 0
    v_readlane_b32 s93, v244, 1
    s_min_u32 s93, s93, s4
    s_mov_b32 s62, 0x1000000
    s_branch .kb_55
.A_143:
    buffer_load_dwordx4 v[216:219], v246, s[8:11], s32 offen offset:0 sc1
    buffer_load_dwordx4 v[220:223], v246, s[8:11], s32 offen offset:1024 sc1
    s_sub_u32 s62, s62, 1
    s_cbranch_scc1 .mg_end_1
    s_waitcnt vmcnt(6)
    v_max3_u32 v4, v192, v193, v194
    v_max3_u32 v5, v195, v196, v197
    v_max3_u32 v4, v4, v198, v199
    v_max_u32 v4, v4, v5
    v_cmp_eq_u32 vcc, -1, v4
    s_cbranch_vccz .W_58
.A_57:
    buffer_load_dwordx4 v[192:195], v243, s[8:11], s32 offen offset:0 sc1
    buffer_load_dwordx4 v[196:199], v243, s[8:11], s32 offen offset:1024 sc1
    s_waitcnt vmcnt(6)
    v_max3_u32 v4, v200, v201, v202
    v_max3_u32 v5, v203, v204, v205
    v_max3_u32 v4, v4, v206, v207
    v_max_u32 v4, v4, v5
    v_cmp_eq_u32 vcc, -1, v4
    s_cbranch_vccz .W_144
.A_145:
    buffer_load_dwordx4 v[200:203], v252, s[8:11], s32 offen offset:0 sc1
    buffer_load_dwordx4 v[204:207], v252, s[8:11], s32 offen offset:1024 sc1
    s_waitcnt vmcnt(6)
    v_max3_u32 v4, v208, v209, v210
    v_max3_u32 v5, v211, v212, v213
    v_max3_u32 v4, v4, v214, v215
    v_max_u32 v4, v4, v5
    v_cmp_eq_u32 vcc, -1, v4
    s_cbranch_vccz .W_146
.A_147:
    buffer_load_dwordx4 v[208:211], v254, s[8:11], s32 offen offset:0 sc1
    buffer_load_dwordx4 v[212:215], v254, s[8:11], s32 offen offset:1024 sc1
    s_waitcnt vmcnt(6)
    v_max3_u32 v4, v216, v217, v218
    v_max3_u32 v5, v219, v220, v221
    v_max3_u32 v4, v4, v222, v223
    v_max_u32 v4, v4, v5
    v_cmp_eq_u32 vcc, -1, v4
    s_cbranch_vccnz .A_143
.W_148:
    v_smfmac_f32_16x16x64_bf16 v[76:79], v[216:219], v[140:147], v9
    v_smfmac_f32_16x16x64_bf16 v[80:83], v[216:219], v[172:179], v9
    s_waitcnt vmcnt(4)
    v_max3_u32 v4, v192, v193, v194
    v_max3_u32 v5, v195, v196, v197
    v_max3_u32 v4, v4, v198, v199
    v_smfmac_f32_16x16x64_bf16 v[76:79], v[220:223], v[148:155], v9
    v_max_u32 v4, v4, v5
    v_cmp_eq_u32 vcc, -1, v4
    v_smfmac_f32_16x16x64_bf16 v[80:83], v[220:223], v[180:187], v9
    s_cbranch_vccnz .A_149
.W_150:
    v_smfmac_f32_16x16x64_bf16 v[76:79], v[192:195], a[192:199], v9
    v_smfmac_f32_16x16x64_bf16 v[80:83], v[192:195], a[224:231], v9
    s_waitcnt vmcnt(2)
    v_max3_u32 v4, v200, v201, v202
    v_max3_u32 v5, v203, v204, v205
    v_max3_u32 v4, v4, v206, v207
    v_smfmac_f32_16x16x64_bf16 v[76:79], v[196:199], a[200:207], v9
    v_max_u32 v4, v4, v5
    v_cmp_eq_u32 vcc, -1, v4
    v_smfmac_f32_16x16x64_bf16 v[80:83], v[196:199], a[232:239], v9
    s_cbranch_vccnz .A_151
.W_152:
    v_smfmac_f32_16x16x64_bf16 v[76:79], v[200:203], a[208:215], v9
    v_smfmac_f32_16x16x64_bf16 v[80:83], v[200:203], a[240:247], v9
    s_waitcnt vmcnt(0)
    v_max3_u32 v4, v208, v209, v210
    v_max3_u32 v5, v211, v212, v213
    v_max3_u32 v4, v4, v214, v215
    v_smfmac_f32_16x16x64_bf16 v[76:79], v[204:207], a[216:223], v9
    v_max_u32 v4, v4, v5
    v_cmp_eq_u32 vcc, -1, v4
    v_smfmac_f32_16x16x64_bf16 v[80:83], v[204:207], a[248:255], v9
    s_cbranch_vccnz .A_153
.W_154:
    v_smfmac_f32_16x16x64_bf16 v[76:79], v[208:211], v[124:131], v9
    v_smfmac_f32_16x16x64_bf16 v[80:83], v[208:211], v[156:163], v9
    v_smfmac_f32_16x16x64_bf16 v[76:79], v[212:215], v[132:139], v9
    v_smfmac_f32_16x16x64_bf16 v[80:83], v[212:215], v[164:171], v9
    s_branch .mj_56
.W_144:
    v_smfmac_f32_16x16x64_bf16 v[76:79], v[200:203], a[208:215], v9
    v_smfmac_f32_16x16x64_bf16 v[80:83], v[200:203], a[240:247], v9
    s_waitcnt vmcnt(4)
    v_max3_u32 v4, v208, v209, v210
    v_max3_u32 v5, v211, v212, v213
    v_max3_u32 v4, v4, v214, v215
    v_smfmac_f32_16x16x64_bf16 v[76:79], v[204:207], a[216:223], v9
    v_max_u32 v4, v4, v5
    v_cmp_eq_u32 vcc, -1, v4
    v_smfmac_f32_16x16x64_bf16 v[80:83], v[204:207], a[248:255], v9
    s_cbranch_vccnz .A_155
.W_156:
    v_smfmac_f32_16x16x64_bf16 v[76:79], v[208:211], v[124:131], v9
    v_smfmac_f32_16x16x64_bf16 v[80:83], v[208:211], v[156:163], v9
    s_waitcnt vmcnt(2)
    v_max3_u32 v4, v216, v217, v218
    v_max3_u32 v5, v219, v220, v221
    v_max3_u32 v4, v4, v222, v223
    v_smfmac_f32_16x16x64_bf16 v[76:79], v[212:215], v[132:139], v9
    v_max_u32 v4, v4, v5
    v_cmp_eq_u32 vcc, -1, v4
    v_smfmac_f32_16x16x64_bf16 v[80:83], v[212:215], v[164:171], v9
    s_cbranch_vccnz .A_157
.W_158:
    v_smfmac_f32_16x16x64_bf16 v[76:79], v[216:219], v[140:147], v9
    v_smfmac_f32_16x16x64_bf16 v[80:83], v[216:219], v[172:179], v9
    s_waitcnt vmcnt(0)
    v_max3_u32 v4, v192, v193, v194
    v_max3_u32 v5, v195, v196, v197
    v_max3_u32 v4, v4, v198, v199
    v_smfmac_f32_16x16x64_bf16 v[76:79], v[220:223], v[148:155], v9
    v_max_u32 v4, v4, v5
    v_cmp_eq_u32 vcc, -1, v4
    v_smfmac_f32_16x16x64_bf16 v[80:83], v[220:223], v[180:187], v9
    s_cbranch_vccnz .A_159
.W_160:
    v_smfmac_f32_16x16x64_bf16 v[76:79], v[192:195], a[192:199], v9
    v_smfmac_f32_16x16x64_bf16 v[80:83], v[192:195], a[224:231], v9
    v_smfmac_f32_16x16x64_bf16 v[76:79], v[196:199], a[200:207], v9
    v_smfmac_f32_16x16x64_bf16 v[80:83], v[196:199], a[232:239], v9
    s_branch .mj_56
.W_146:
    v_smfmac_f32_16x16x64_bf16 v[76:79], v[208:211], v[124:131], v9
    v_smfmac_f32_16x16x64_bf16 v[80:83], v[208:211], v[156:163], v9
    s_waitcnt vmcnt(4)
    v_max3_u32 v4, v216, v217, v218
    v_max3_u32 v5, v219, v220, v221
    v_max3_u32 v4, v4, v222, v223
    v_smfmac_f32_16x16x64_bf16 v[76:79], v[212:215], v[132:139], v9
    v_max_u32 v4, v4, v5
    v_cmp_eq_u32 vcc, -1, v4
    v_smfmac_f32_16x16x64_bf16 v[80:83], v[212:215], v[164:171], v9
    s_cbranch_vccnz .A_161
.W_162:
    v_smfmac_f32_16x16x64_bf16 v[76:79], v[216:219], v[140:147], v9
    v_smfmac_f32_16x16x64_bf16 v[80:83], v[216:219], v[172:179], v9
    s_waitcnt vmcnt(2)
    v_max3_u32 v4, v192, v193, v194
    v_max3_u32 v5, v195, v196, v197
    v_max3_u32 v4, v4, v198, v199
    v_smfmac_f32_16x16x64_bf16 v[76:79], v[220:223], v[148:155], v9
    v_max_u32 v4, v4, v5
    v_cmp_eq_u32 vcc, -1, v4
    v_smfmac_f32_16x16x64_bf16 v[80:83], v[220:223], v[180:187], v9
    s_cbranch_vccnz .A_163
.W_164:
    v_smfmac_f32_16x16x64_bf16 v[76:79], v[192:195], a[192:199], v9
    v_smfmac_f32_16x16x64_bf16 v[80:83], v[192:195], a[224:231], v9
    s_waitcnt vmcnt(0)
    v_max3_u32 v4, v200, v201, v202
    v_max3_u32 v5, v203, v204, v205
    v_max3_u32 v4, v4, v206, v207
    v_smfmac_f32_16x16x64_bf16 v[76:79], v[196:199], a[200:207], v9
    v_max_u32 v4, v4, v5
    v_cmp_eq_u32 vcc, -1, v4
    v_smfmac_f32_16x16x64_bf16 v[80:83], v[196:199], a[232:239], v9
    s_cbranch_vccnz .A_165
.W_166:
    v_smfmac_f32_16x16x64_bf16 v[76:79], v[200:203], a[208:215], v9
    v_smfmac_f32_16x16x64_bf16 v[80:83], v[200:203], a[240:247], v9
    v_smfmac_f32_16x16x64_bf16 v[76:79], v[204:207], a[216:223], v9
    v_smfmac_f32_16x16x64_bf16 v[80:83], v[204:207], a[248:255], v9
    s_branch .mj_56
.A_167:
    buffer_load_dwordx4 v[208:211], v254, s[8:11], s32 offen offset:0 sc1
    buffer_load_dwordx4 v[212:215], v254, s[8:11], s32 offen offset:1024 sc1
    s_sub_u32 s62, s62, 1
    s_cbranch_scc1 .mg_end_1
    s_waitcnt vmcnt(4)
    v_max3_u32 v4, v192, v193, v194
    v_max3_u32 v5, v195, v196, v197
    v_max3_u32 v4, v4, v198, v199
    v_max_u32 v4, v4, v5
    v_cmp_eq_u32 vcc, -1, v4
    s_cbranch_vccz .W_150
.A_149:
    buffer_load_dwordx4 v[192:195], v243, s[8:11], s32 offen offset:0 sc1
    buffer_load_dwordx4 v[196:199], v243, s[8:11], s32 offen offset:1024 sc1
    s_waitcnt vmcnt(4)
    v_max3_u32 v4, v200, v201, v202
    v_max3_u32 v5, v203, v204, v205
    v_max3_u32 v4, v4, v206, v207
    v_max_u32 v4, v4, v5
    v_cmp_eq_u32 vcc, -1, v4
    s_cbranch_vccz .W_168
.A_169:
    buffer_load_dwordx4 v[200:203], v252, s[8:11], s32 offen offset:0 sc1
    buffer_load_dwordx4 v[204:207], v252, s[8:11], s32 offen offset:1024 sc1
    s_waitcnt vmcnt(4)
    v_max3_u32 v4, v208, v209, v210
    v_max3_u32 v5, v211, v212, v213
    v_max3_u32 v4, v4, v214, v215
    v_max_u32 v4, v4, v5
    v_cmp_eq_u32 vcc, -1, v4
    s_cbranch_vccnz .A_167
.W_170:
    v_smfmac_f32_16x16x64_bf16 v[76:79], v[208:211], v[124:131], v9
    v_smfmac_f32_16x16x64_bf16 v[80:83], v[208:211], v[156:163], v9
    s_waitcnt vmcnt(2)
    v_max3_u32 v4, v192, v193, v194
    v_max3_u32 v5, v195, v196, v197
    v_max3_u32 v4, v4, v198, v199
    v_smfmac_f32_16x16x64_bf16 v[76:79], v[212:215], v[132:139], v9
    v_max_u32 v4, v4, v5
    v_cmp_eq_u32 vcc, -1, v4
    v_smfmac_f32_16x16x64_bf16 v[80:83], v[212:215], v[164:171], v9
    s_cbranch_vccz .W_164
    s_branch .A_163
.W_168:
    v_smfmac_f32_16x16x64_bf16 v[76:79], v[200:203], a[208:215], v9
    v_smfmac_f32_16x16x64_bf16 v[80:83], v[200:203], a[240:247], v9
    s_waitcnt vmcnt(2)
    v_max3_u32 v4, v208, v209, v210
    v_max3_u32 v5, v211, v212, v213
    v_max3_u32 v4, v4, v214, v215
    v_smfmac_f32_16x16x64_bf16 v[76:79], v[204:207], a[216:223], v9
    v_max_u32 v4, v4, v5
    v_cmp_eq_u32 vcc, -1, v4
    v_smfmac_f32_16x16x64_bf16 v[80:83], v[204:207], a[248:255], v9
    s_cbranch_vccnz .A_171
.W_172:
    v_smfmac_f32_16x16x64_bf16 v[76:79], v[208:211], v[124:131], v9
    v_smfmac_f32_16x16x64_bf16 v[80:83], v[208:211], v[156:163], v9
    s_waitcnt vmcnt(0)
    v_max3_u32 v4, v192, v193, v194
    v_max3_u32 v5, v195, v196, v197
    v_max3_u32 v4, v4, v198, v199
    v_smfmac_f32_16x16x64_bf16 v[76:79], v[212:215], v[132:139], v9
    v_max_u32 v4, v4, v5
    v_cmp_eq_u32 vcc, -1, v4
    v_smfmac_f32_16x16x64_bf16 v[80:83], v[212:215], v[164:171], v9
    s_cbranch_vccz .W_160
    s_branch .A_159
.A_173:
    buffer_load_dwordx4 v[200:203], v252, s[8:11], s32 offen offset:0 sc1
    buffer_load_dwordx4 v[204:207], v252, s[8:11], s32 offen offset:1024 sc1
    s_sub_u32 s62, s62, 1
    s_cbranch_scc1 .mg_end_1
    s_waitcnt vmcnt(4)
    v_max3_u32 v4, v216, v217, v218
    v_max3_u32 v5, v219, v220, v221
    v_max3_u32 v4, v4, v222, v223
    v_max_u32 v4, v4, v5
    v_cmp_eq_u32 vcc, -1, v4
    s_cbranch_vccz .W_162
.A_161:
    buffer_load_dwordx4 v[216:219], v246, s[8:11], s32 offen offset:0 sc1
    buffer_load_dwordx4 v[220:223], v246, s[8:11], s32 offen offset:1024 sc1
    s_waitcnt vmcnt(4)
    v_max3_u32 v4, v192, v193, v194
    v_max3_u32 v5, v195, v196, v197
    v_max3_u32 v4, v4, v198, v199
    v_max_u32 v4, v4, v5
    v_cmp_eq_u32 vcc, -1, v4
    s_cbranch_vccz .W_174
.A_175:
    buffer_load_dwordx4 v[192:195], v243, s[8:11], s32 offen offset:0 sc1
    buffer_load_dwordx4 v[196:199], v243, s[8:11], s32 offen offset:1024 sc1
    s_waitcnt vmcnt(4)
    v_max3_u32 v4, v200, v201, v202
    v_max3_u32 v5, v203, v204, v205
    v_max3_u32 v4, v4, v206, v207
    v_max_u32 v4, v4, v5
    v_cmp_eq_u32 vcc, -1, v4
    s_cbranch_vccnz .A_173
.W_176:
    v_smfmac_f32_16x16x64_bf16 v[76:79], v[200:203], a[208:215], v9
    v_smfmac_f32_16x16x64_bf16 v[80:83], v[200:203], a[240:247], v9
    s_waitcnt vmcnt(2)
    v_max3_u32 v4, v216, v217, v218
    v_max3_u32 v5, v219, v220, v221
    v_max3_u32 v4, v4, v222, v223
    v_smfmac_f32_16x16x64_bf16 v[76:79], v[204:207], a[216:223], v9
    v_max_u32 v4, v4, v5
    v_cmp_eq_u32 vcc, -1, v4
    v_smfmac_f32_16x16x64_bf16 v[80:83], v[204:207], a[248:255], v9
    s_cbranch_vccz .W_158
    s_branch .A_157
.W_174:
    v_smfmac_f32_16x16x64_bf16 v[76:79], v[192:195], a[192:199], v9
    v_smfmac_f32_16x16x64_bf16 v[80:83], v[192:195], a[224:231], v9
    s_waitcnt vmcnt(2)
    v_max3_u32 v4, v200, v201, v202
    v_max3_u32 v5, v203, v204, v205
    v_max3_u32 v4, v4, v206, v207
    v_smfmac_f32_16x16x64_bf16 v[76:79], v[196:199], a[200:207], v9
    v_max_u32 v4, v4, v5
    v_cmp_eq_u32 vcc, -1, v4
    v_smfmac_f32_16x16x64_bf16 v[80:83], v[196:199], a[232:239], v9
    s_cbranch_vccnz .A_177
.W_178:
    v_smfmac_f32_16x16x64_bf16 v[76:79], v[200:203], a[208:215], v9
    v_smfmac_f32_16x16x64_bf16 v[80:83], v[200:203], a[240:247], v9
    s_waitcnt vmcnt(0)
    v_max3_u32 v4, v216, v217, v218
    v_max3_u32 v5, v219, v220, v221
    v_max3_u32 v4, v4, v222, v223
    v_smfmac_f32_16x16x64_bf16 v[76:79], v[204:207], a[216:223], v9
    v_max_u32 v4, v4, v5
    v_cmp_eq_u32 vcc, -1, v4
    v_smfmac_f32_16x16x64_bf16 v[80:83], v[204:207], a[248:255], v9
    s_cbranch_vccz .W_64
    s_branch .A_63
.A_179:
    buffer_load_dwordx4 v[216:219], v246, s[8:11], s32 offen offset:0 sc1
    buffer_load_dwordx4 v[220:223], v246, s[8:11], s32 offen offset:1024 sc1
    s_sub_u32 s62, s62, 1
    s_cbranch_scc1 .mg_end_1
    s_waitcnt vmcnt(4)
    v_max3_u32 v4, v192, v193, v194
    v_max3_u32 v5, v195, v196, v197
    v_max3_u32 v4, v4, v198, v199
    v_max_u32 v4, v4, v5
    v_cmp_eq_u32 vcc, -1, v4
    s_cbranch_vccz .W_180
.A_181:
    buffer_load_dwordx4 v[192:195], v243, s[8:11], s32 offen offset:0 sc1
    buffer_load_dwordx4 v[196:199], v243, s[8:11], s32 offen offset:1024 sc1
    s_waitcnt vmcnt(4)
    v_max3_u32 v4, v208, v209, v210
    v_max3_u32 v5, v211, v212, v213
    v_max3_u32 v4, v4, v214, v215
    v_max_u32 v4, v4, v5
    v_cmp_eq_u32 vcc, -1, v4
    s_cbranch_vccz .W_156
.A_155:
    buffer_load_dwordx4 v[208:211], v254, s[8:11], s32 offen offset:0 sc1
    buffer_load_dwordx4 v[212:215], v254, s[8:11], s32 offen offset:1024 sc1
    s_waitcnt vmcnt(4)
    v_max3_u32 v4, v216, v217, v218
    v_max3_u32 v5, v219, v220, v221
    v_max3_u32 v4, v4, v222, v223
    v_max_u32 v4, v4, v5
    v_cmp_eq_u32 vcc, -1, v4
    s_cbranch_vccnz .A_179
.W_182:
    v_smfmac_f32_16x16x64_bf16 v[76:79], v[216:219], v[140:147], v9
    v_smfmac_f32_16x16x64_bf16 v[80:83], v[216:219], v[172:179], v9
    s_waitcnt vmcnt(2)
    v_max3_u32 v4, v192, v193, v194
    v_max3_u32 v5, v195, v196, v197
    v_max3_u32 v4, v4, v198, v199
    v_smfmac_f32_16x16x64_bf16 v[76:79], v[220:223], v[148:155], v9
    v_max_u32 v4, v4, v5
    v_cmp_eq_u32 vcc, -1, v4
    v_smfmac_f32_16x16x64_bf16 v[80:83], v[220:223], v[180:187], v9
    s_cbranch_vccnz .A_183
.W_184:
    v_smfmac_f32_16x16x64_bf16 v[76:79], v[192:195], a[192:199], v9
    v_smfmac_f32_16x16x64_bf16 v[80:83], v[192:195], a[224:231], v9
    s_waitcnt vmcnt(0)
    v_max3_u32 v4, v208, v209, v210
    v_max3_u32 v5, v211, v212, v213
    v_max3_u32 v4, v4, v214, v215
    v_smfmac_f32_16x16x64_bf16 v[76:79], v[196:199], a[200:207], v9
    v_max_u32 v4, v4, v5
    v_cmp_eq_u32 vcc, -1, v4
    v_smfmac_f32_16x16x64_bf16 v[80:83], v[196:199], a[232:239], v9
    s_cbranch_vccz .W_154
    s_branch .A_153
.W_180:
    v_smfmac_f32_16x16x64_bf16 v[76:79], v[192:195], a[192:199], v9
    v_smfmac_f32_16x16x64_bf16 v[80:83], v[192:195], a[224:231], v9
    s_waitcnt vmcnt(2)
    v_max3_u32 v4, v208, v209, v210
    v_max3_u32 v5, v211, v212, v213
    v_max3_u32 v4, v4, v214, v215
    v_smfmac_f32_16x16x64_bf16 v[76:79], v[196:199], a[200:207], v9
    v_max_u32 v4, v4, v5
    v_cmp_eq_u32 vcc, -1, v4
    v_smfmac_f32_16x16x64_bf16 v[80:83], v[196:199], a[232:239], v9
    s_cbranch_vccz .W_62
    s_branch .A_61
.A_185:
    buffer_load_dwordx4 v[216:219], v246, s[8:11], s32 offen offset:0 sc1
    buffer_load_dwordx4 v[220:223], v246, s[8:11], s32 offen offset:1024 sc1
    s_sub_u32 s62, s62, 1
    s_cbranch_scc1 .mg_end_1
    s_waitcnt vmcnt(4)
    v_max3_u32 v4, v200, v201, v202
    v_max3_u32 v5, v203, v204, v205
    v_max3_u32 v4, v4, v206, v207
    v_max_u32 v4, v4, v5
    v_cmp_eq_u32 vcc, -1, v4
    s_cbranch_vccz .W_60
.A_59:
    buffer_load_dwordx4 v[200:203], v252, s[8:11], s32 offen offset:0 sc1
    buffer_load_dwordx4 v[204:207], v252, s[8:11], s32 offen offset:1024 sc1
    s_waitcnt vmcnt(4)
    v_max3_u32 v4, v208, v209, v210
    v_max3_u32 v5, v211, v212, v213
    v_max3_u32 v4, v4, v214, v215
    v_max_u32 v4, v4, v5
    v_cmp_eq_u32 vcc, -1, v4
    s_cbranch_vccz .W_186
.A_187:
    buffer_load_dwordx4 v[208:211], v254, s[8:11], s32 offen offset:0 sc1
    buffer_load_dwordx4 v[212:215], v254, s[8:11], s32 offen offset:1024 sc1
    s_waitcnt vmcnt(4)
    v_max3_u32 v4, v216, v217, v218
    v_max3_u32 v5, v219, v220, v221
    v_max3_u32 v4, v4, v222, v223
    v_max_u32 v4, v4, v5
    v_cmp_eq_u32 vcc, -1, v4
    s_cbranch_vccnz .A_185
.W_188:
    v_smfmac_f32_16x16x64_bf16 v[76:79], v[216:219], v[140:147], v9
    v_smfmac_f32_16x16x64_bf16 v[80:83], v[216:219], v[172:179], v9
    s_waitcnt vmcnt(2)
    v_max3_u32 v4, v200, v201, v202
    v_max3_u32 v5, v203, v204, v205
    v_max3_u32 v4, v4, v206, v207
    v_smfmac_f32_16x16x64_bf16 v[76:79], v[220:223], v[148:155], v9
    v_max_u32 v4, v4, v5
    v_cmp_eq_u32 vcc, -1, v4
    v_smfmac_f32_16x16x64_bf16 v[80:83], v[220:223], v[180:187], v9
    s_cbranch_vccz .W_152
    s_branch .A_151
.W_186:
    v_smfmac_f32_16x16x64_bf16 v[76:79], v[208:211], v[124:131], v9
    v_smfmac_f32_16x16x64_bf16 v[80:83], v[208:211], v[156:163], v9
    s_waitcnt vmcnt(2)
    v_max3_u32 v4, v216, v217, v218
    v_max3_u32 v5, v219, v220, v221
    v_max3_u32 v4, v4, v222, v223
    v_smfmac_f32_16x16x64_bf16 v[76:79], v[212:215], v[132:139], v9
    v_max_u32 v4, v4, v5
    v_cmp_eq_u32 vcc, -1, v4
    v_smfmac_f32_16x16x64_bf16 v[80:83], v[212:215], v[164:171], v9
    s_cbranch_vccnz .A_189
.W_190:
    v_smfmac_f32_16x16x64_bf16 v[76:79], v[216:219], v[140:147], v9
    v_smfmac_f32_16x16x64_bf16 v[80:83], v[216:219], v[172:179], v9
    s_waitcnt vmcnt(0)
    v_max3_u32 v4, v200, v201, v202
    v_max3_u32 v5, v203, v204, v205
    v_max3_u32 v4, v4, v206, v207
    v_smfmac_f32_16x16x64_bf16 v[76:79], v[220:223], v[148:155], v9
    v_max_u32 v4, v4, v5
    v_cmp_eq_u32 vcc, -1, v4
    v_smfmac_f32_16x16x64_bf16 v[80:83], v[220:223], v[180:187], v9
    s_cbranch_vccz .W_166
    s_branch .A_165
.A_191:
    buffer_load_dwordx4 v[200:203], v252, s[8:11], s32 offen offset:0 sc1
    buffer_load_dwordx4 v[204:207], v252, s[8:11], s32 offen offset:1024 sc1
    s_sub_u32 s62, s62, 1
    s_cbranch_scc1 .mg_end_1
    s_waitcnt vmcnt(2)
    v_max3_u32 v4, v192, v193, v194
    v_max3_u32 v5, v195, v196, v197
    v_max3_u32 v4, v4, v198, v199
    v_max_u32 v4, v4, v5
    v_cmp_eq_u32 vcc, -1, v4
    s_cbranch_vccz .W_164
.A_163:
    buffer_load_dwordx4 v[192:195], v243, s[8:11], s32 offen offset:0 sc1
    buffer_load_dwordx4 v[196:199], v243, s[8:11], s32 offen offset:1024 sc1
    s_waitcnt vmcnt(2)
    v_max3_u32 v4, v200, v201, v202
    v_max3_u32 v5, v203, v204, v205
    v_max3_u32 v4, v4, v206, v207
    v_max_u32 v4, v4, v5
    v_cmp_eq_u32 vcc, -1, v4
    s_cbranch_vccnz .A_191
.W_192:
    v_smfmac_f32_16x16x64_bf16 v[76:79], v[200:203], a[208:215], v9
    v_smfmac_f32_16x16x64_bf16 v[80:83], v[200:203], a[240:247], v9
    s_waitcnt vmcnt(0)
    v_max3_u32 v4, v192, v193, v194
    v_max3_u32 v5, v195, v196, v197
    v_max3_u32 v4, v4, v198, v199
    v_smfmac_f32_16x16x64_bf16 v[76:79], v[204:207], a[216:223], v9
    v_max_u32 v4, v4, v5
    v_cmp_eq_u32 vcc, -1, v4
    v_smfmac_f32_16x16x64_bf16 v[80:83], v[204:207], a[248:255], v9
    s_cbranch_vccz .W_160
    s_branch .A_159
.A_171:
    buffer_load_dwordx4 v[208:211], v254, s[8:11], s32 offen offset:0 sc1
    buffer_load_dwordx4 v[212:215], v254, s[8:11], s32 offen offset:1024 sc1
    s_sub_u32 s62, s62, 1
    s_cbranch_scc1 .mg_end_1
    s_waitcnt vmcnt(2)
    v_max3_u32 v4, v192, v193, v194
    v_max3_u32 v5, v195, v196, v197
    v_max3_u32 v4, v4, v198, v199
    v_max_u32 v4, v4, v5
    v_cmp_eq_u32 vcc, -1, v4
    s_cbranch_vccz .W_184
.A_183:
    buffer_load_dwordx4 v[192:195], v243, s[8:11], s32 offen offset:0 sc1
    buffer_load_dwordx4 v[196:199], v243, s[8:11], s32 offen offset:1024 sc1
    s_waitcnt vmcnt(2)
    v_max3_u32 v4, v208, v209, v210
    v_max3_u32 v5, v211, v212, v213
    v_max3_u32 v4, v4, v214, v215
    v_max_u32 v4, v4, v5
    v_cmp_eq_u32 vcc, -1, v4
    s_cbranch_vccnz .A_171
    s_branch .W_172
.A_193:
    buffer_load_dwordx4 v[192:195], v243, s[8:11], s32 offen offset:0 sc1
    buffer_load_dwordx4 v[196:199], v243, s[8:11], s32 offen offset:1024 sc1
    s_sub_u32 s62, s62, 1
    s_cbranch_scc1 .mg_end_1
    s_waitcnt vmcnt(2)
    v_max3_u32 v4, v216, v217, v218
    v_max3_u32 v5, v219, v220, v221
    v_max3_u32 v4, v4, v222, v223
    v_max_u32 v4, v4, v5
    v_cmp_eq_u32 vcc, -1, v4
    s_cbranch_vccz .W_158
.A_157:
    buffer_load_dwordx4 v[216:219], v246, s[8:11], s32 offen offset:0 sc1
    buffer_load_dwordx4 v[220:223], v246, s[8:11], s32 offen offset:1024 sc1
    s_waitcnt vmcnt(2)
    v_max3_u32 v4, v192, v193, v194
    v_max3_u32 v5, v195, v196, v197
    v_max3_u32 v4, v4, v198, v199
    v_max_u32 v4, v4, v5
    v_cmp_eq_u32 vcc, -1, v4
    s_cbranch_vccnz .A_193
.W_194:
    v_smfmac_f32_16x16x64_bf16 v[76:79], v[192:195], a[192:199], v9
    v_smfmac_f32_16x16x64_bf16 v[80:83], v[192:195], a[224:231], v9
    s_waitcnt vmcnt(0)
    v_max3_u32 v4, v216, v217, v218
    v_max3_u32 v5, v219, v220, v221
    v_max3_u32 v4, v4, v222, v223
    v_smfmac_f32_16x16x64_bf16 v[76:79], v[196:199], a[200:207], v9
    v_max_u32 v4, v4, v5
    v_cmp_eq_u32 vcc, -1, v4
    v_smfmac_f32_16x16x64_bf16 v[80:83], v[196:199], a[232:239], v9
    s_cbranch_vccz .W_64
    s_branch .A_63
.A_195:
    buffer_load_dwordx4 v[208:211], v254, s[8:11], s32 offen offset:0 sc1
    buffer_load_dwordx4 v[212:215], v254, s[8:11], s32 offen offset:1024 sc1
    s_sub_u32 s62, s62, 1
    s_cbranch_scc1 .mg_end_1
    s_waitcnt vmcnt(2)
    v_max3_u32 v4, v200, v201, v202
    v_max3_u32 v5, v203, v204, v205
    v_max3_u32 v4, v4, v206, v207
    v_max_u32 v4, v4, v5
    v_cmp_eq_u32 vcc, -1, v4
    s_cbranch_vccz .W_152
.A_151:
    buffer_load_dwordx4 v[200:203], v252, s[8:11], s32 offen offset:0 sc1
    buffer_load_dwordx4 v[204:207], v252, s[8:11], s32 offen offset:1024 sc1
    s_waitcnt vmcnt(2)
    v_max3_u32 v4, v208, v209, v210
    v_max3_u32 v5, v211, v212, v213
    v_max3_u32 v4, v4, v214, v215
    v_max_u32 v4, v4, v5
    v_cmp_eq_u32 vcc, -1, v4
    s_cbranch_vccnz .A_195
.W_196:
    v_smfmac_f32_16x16x64_bf16 v[76:79], v[208:211], v[124:131], v9
    v_smfmac_f32_16x16x64_bf16 v[80:83], v[208:211], v[156:163], v9
    s_waitcnt vmcnt(0)
    v_max3_u32 v4, v200, v201, v202
    v_max3_u32 v5, v203, v204, v205
    v_max3_u32 v4, v4, v206, v207
    v_smfmac_f32_16x16x64_bf16 v[76:79], v[212:215], v[132:139], v9
    v_max_u32 v4, v4, v5
    v_cmp_eq_u32 vcc, -1, v4
    v_smfmac_f32_16x16x64_bf16 v[80:83], v[212:215], v[164:171], v9
    s_cbranch_vccz .W_166
    s_branch .A_165
.A_189:
    buffer_load_dwordx4 v[216:219], v246, s[8:11], s32 offen offset:0 sc1
    buffer_load_dwordx4 v[220:223], v246, s[8:11], s32 offen offset:1024 sc1
    s_sub_u32 s62, s62, 1
    s_cbranch_scc1 .mg_end_1
    s_waitcnt vmcnt(2)
    v_max3_u32 v4, v200, v201, v202
    v_max3_u32 v5, v203, v204, v205
    v_max3_u32 v4, v4, v206, v207
    v_max_u32 v4, v4, v5
    v_cmp_eq_u32 vcc, -1, v4
    s_cbranch_vccz .W_178
.A_177:
    buffer_load_dwordx4 v[200:203], v252, s[8:11], s32 offen offset:0 sc1
    buffer_load_dwordx4 v[204:207], v252, s[8:11], s32 offen offset:1024 sc1
    s_waitcnt vmcnt(2)
    v_max3_u32 v4, v216, v217, v218
    v_max3_u32 v5, v219, v220, v221
    v_max3_u32 v4, v4, v222, v223
    v_max_u32 v4, v4, v5
    v_cmp_eq_u32 vcc, -1, v4
    s_cbranch_vccnz .A_189
    s_branch .W_190
.A_197:
    buffer_load_dwordx4 v[216:219], v246, s[8:11], s32 offen offset:0 sc1
    buffer_load_dwordx4 v[220:223], v246, s[8:11], s32 offen offset:1024 sc1
    s_sub_u32 s62, s62, 1
    s_cbranch_scc1 .mg_end_1
    s_waitcnt vmcnt(2)
    v_max3_u32 v4, v208, v209, v210
    v_max3_u32 v5, v211, v212, v213
    v_max3_u32 v4, v4, v214, v215
    v_max_u32 v4, v4, v5
    v_cmp_eq_u32 vcc, -1, v4
    s_cbranch_vccz .W_62
.A_61:
    buffer_load_dwordx4 v[208:211], v254, s[8:11], s32 offen offset:0 sc1
    buffer_load_dwordx4 v[212:215], v254, s[8:11], s32 offen offset:1024 sc1
    s_waitcnt vmcnt(2)
    v_max3_u32 v4, v216, v217, v218
    v_max3_u32 v5, v219, v220, v221
    v_max3_u32 v4, v4, v222, v223
    v_max_u32 v4, v4, v5
    v_cmp_eq_u32 vcc, -1, v4
    s_cbranch_vccnz .A_197
.W_198:
    v_smfmac_f32_16x16x64_bf16 v[76:79], v[216:219], v[140:147], v9
    v_smfmac_f32_16x16x64_bf16 v[80:83], v[216:219], v[172:179], v9
    s_waitcnt vmcnt(0)
    v_max3_u32 v4, v208, v209, v210
    v_max3_u32 v5, v211, v212, v213
    v_max3_u32 v4, v4, v214, v215
    v_smfmac_f32_16x16x64_bf16 v[76:79], v[220:223], v[148:155], v9
    v_max_u32 v4, v4, v5
    v_cmp_eq_u32 vcc, -1, v4
    v_smfmac_f32_16x16x64_bf16 v[80:83], v[220:223], v[180:187], v9
    s_cbranch_vccz .W_154
    s_branch .A_153
.A_159:
    buffer_load_dwordx4 v[192:195], v243, s[8:11], s32 offen offset:0 sc1
    buffer_load_dwordx4 v[196:199], v243, s[8:11], s32 offen offset:1024 sc1
    s_sub_u32 s62, s62, 1
    s_cbranch_scc1 .mg_end_1
    s_waitcnt vmcnt(2)
    v_max3_u32 v4, v192, v193, v194
    v_max3_u32 v5, v195, v196, v197
    v_max3_u32 v4, v4, v198, v199
    v_max_u32 v4, v4, v5
    v_cmp_eq_u32 vcc, -1, v4
    s_cbranch_vccnz .A_159
    v_smfmac_f32_16x16x64_bf16 v[76:79], v[192:195], a[192:199], v9
    v_smfmac_f32_16x16x64_bf16 v[80:83], v[192:195], a[224:231], v9
    v_smfmac_f32_16x16x64_bf16 v[76:79], v[196:199], a[200:207], v9
    v_smfmac_f32_16x16x64_bf16 v[80:83], v[196:199], a[232:239], v9
    s_branch .mj_56
.A_165:
    buffer_load_dwordx4 v[200:203], v252, s[8:11], s32 offen offset:0 sc1
    buffer_load_dwordx4 v[204:207], v252, s[8:11], s32 offen offset:1024 sc1
    s_sub_u32 s62, s62, 1
    s_cbranch_scc1 .mg_end_1
    s_waitcnt vmcnt(2)
    v_max3_u32 v4, v200, v201, v202
    v_max3_u32 v5, v203, v204, v205
    v_max3_u32 v4, v4, v206, v207
    v_max_u32 v4, v4, v5
    v_cmp_eq_u32 vcc, -1, v4
    s_cbranch_vccnz .A_165
    v_smfmac_f32_16x16x64_bf16 v[76:79], v[200:203], a[208:215], v9
    v_smfmac_f32_16x16x64_bf16 v[80:83], v[200:203], a[240:247], v9
    v_smfmac_f32_16x16x64_bf16 v[76:79], v[204:207], a[216:223], v9
    v_smfmac_f32_16x16x64_bf16 v[80:83], v[204:207], a[248:255], v9
    s_branch .mj_56
.A_153:
    buffer_load_dwordx4 v[208:211], v254, s[8:11], s32 offen offset:0 sc1
    buffer_load_dwordx4 v[212:215], v254, s[8:11], s32 offen offset:1024 sc1
    s_sub_u32 s62, s62, 1
    s_cbranch_scc1 .mg_end_1
    s_waitcnt vmcnt(2)
    v_max3_u32 v4, v208, v209, v210
    v_max3_u32 v5, v211, v212, v213
    v_max3_u32 v4, v4, v214, v215
    v_max_u32 v4, v4, v5
    v_cmp_eq_u32 vcc, -1, v4
    s_cbranch_vccnz .A_153
    v_smfmac_f32_16x16x64_bf16 v[76:79], v[208:211], v[124:131], v9
    v_smfmac_f32_16x16x64_bf16 v[80:83], v[208:211], v[156:163], v9
    v_smfmac_f32_16x16x64_bf16 v[76:79], v[212:215], v[132:139], v9
    v_smfmac_f32_16x16x64_bf16 v[80:83], v[212:215], v[164:171], v9
    s_branch .mj_56
.A_63:
    buffer_load_dwordx4 v[216:219], v246, s[8:11], s32 offen offset:0 sc1
    buffer_load_dwordx4 v[220:223], v246, s[8:11], s32 offen offset:1024 sc1
    s_sub_u32 s62, s62, 1
    s_cbranch_scc1 .mg_end_1
    s_waitcnt vmcnt(2)
    v_max3_u32 v4, v216, v217, v218
    v_max3_u32 v5, v219, v220, v221
    v_max3_u32 v4, v4, v222, v223
    v_max_u32 v4, v4, v5
    v_cmp_eq_u32 vcc, -1, v4
    s_cbranch_vccnz .A_63
    v_smfmac_f32_16x16x64_bf16 v[76:79], v[216:219], v[140:147], v9
    v_smfmac_f32_16x16x64_bf16 v[80:83], v[216:219], v[172:179], v9
    v_smfmac_f32_16x16x64_bf16 v[76:79], v[220:223], v[148:155], v9
    v_smfmac_f32_16x16x64_bf16 v[80:83], v[220:223], v[180:187], v9
    s_branch .mj_56
.sk_66:
    s_mov_b64 exec, s[66:67]
    buffer_store_dwordx4 v[88:91], v11, s[8:11], s36 offen sc1
    s_mov_b64 exec, s[56:57]
    buffer_store_dwordx4 v[172:175], v12, s[8:11], s36 offen sc1
    s_mov_b64 exec, -1

    s_branch .rec_fin_6
.p2align 6
.top_199:
    s_barrier
    buffer_load_dwordx4 v[20:23], v8, s[8:11], s29 offen offset:0 sc1
    v_mov_b32 v52, 0
    buffer_load_dwordx4 v[24:27], v8, s[8:11], s29 offen offset:1024 sc1
    v_mov_b32 v53, 0
    buffer_load_dwordx4 v[28:31], v8, s[8:11], s29 offen offset:2048 sc1
    v_mov_b32 v54, 0
    buffer_load_dwordx4 v[32:35], v8, s[8:11], s29 offen offset:3072 sc1
.ent1_26:
    s_waitcnt vmcnt(3)
    v_max3_u32 v4, v20, v21, v22
    v_max_u32 v4, v4, v23
    v_cmp_eq_u32 vcc, -1, v4
    s_cbranch_vccnz .A_204
.W_205:
    v_smfmac_f32_16x16x64_bf16 v[52:55], v[20:23], a[0:7], v9
    v_smfmac_f32_16x16x64_bf16 v[56:59], v[20:23], a[32:39], v9
    s_waitcnt vmcnt(2)
    v_max3_u32 v4, v24, v25, v26
    v_max_u32 v4, v4, v27
    v_smfmac_f32_16x16x64_bf16 v[60:63], v[20:23], a[64:71], v9
    v_cmp_eq_u32 vcc, -1, v4
    v_smfmac_f32_16x16x64_bf16 v[64:67], v[20:23], a[96:103], v9
    s_cbranch_vccnz .A_206
.W_207:
    v_smfmac_f32_16x16x64_bf16 v[52:55], v[24:27], a[8:15], v9
    v_smfmac_f32_16x16x64_bf16 v[56:59], v[24:27], a[40:47], v9
    s_waitcnt vmcnt(1)
    v_max3_u32 v4, v28, v29, v30
    v_max_u32 v4, v4, v31
    v_smfmac_f32_16x16x64_bf16 v[60:63], v[24:27], a[72:79], v9
    v_cmp_eq_u32 vcc, -1, v4
    v_smfmac_f32_16x16x64_bf16 v[64:67], v[24:27], a[104:111], v9
    s_cbranch_vccnz .A_208
.W_209:
    v_smfmac_f32_16x16x64_bf16 v[52:55], v[28:31], a[16:23], v9
    v_smfmac_f32_16x16x64_bf16 v[56:59], v[28:31], a[48:55], v9
    s_waitcnt vmcnt(0)
    v_max3_u32 v4, v32, v33, v34
    v_max_u32 v4, v4, v35
    v_smfmac_f32_16x16x64_bf16 v[60:63], v[28:31], a[80:87], v9
    v_cmp_eq_u32 vcc, -1, v4
    v_smfmac_f32_16x16x64_bf16 v[64:67], v[28:31], a[112:119], v9
    s_cbranch_vccnz .A_210
.W_211:
    v_smfmac_f32_16x16x64_bf16 v[52:55], v[32:35], a[24:31], v9
    v_smfmac_f32_16x16x64_bf16 v[56:59], v[32:35], a[56:63], v9
    v_smfmac_f32_16x16x64_bf16 v[60:63], v[32:35], a[88:95], v9
    v_smfmac_f32_16x16x64_bf16 v[64:67], v[32:35], a[120:127], v9
.mj_203:
    v_cvt_pk_bf16_f32 v104, v52, v53
    v_cvt_pk_bf16_f32 v105, v54, v55
    v_cvt_pk_bf16_f32 v106, v56, v57
    v_cvt_pk_bf16_f32 v107, v58, v59
    ds_write_b64 v16, v[104:105] offset:4096
    v_cvt_pk_bf16_f32 v108, v60, v61
    v_cvt_pk_bf16_f32 v109, v62, v63
    ds_write_b64 v16, v[106:107] offset:6144
    ds_write_b64 v16, v[108:109] offset:0
    v_cvt_pk_bf16_f32 v110, v64, v65
    v_cvt_pk_bf16_f32 v111, v66, v67
    ds_write_b64 v16, v[110:111] offset:2048
    v_smfmac_f32_16x16x64_bf16 v[68:71], v[20:23], a[128:135], v9
    v_smfmac_f32_16x16x64_bf16 v[72:75], v[20:23], a[160:167], v9
    s_waitcnt lgkmcnt(0)
    s_barrier
    ds_read_b128 v[36:39], v17 offset:0
    ds_read_b128 v[40:43], v17 offset:1024
    v_smfmac_f32_16x16x64_bf16 v[68:71], v[24:27], a[136:143], v9
    v_smfmac_f32_16x16x64_bf16 v[72:75], v[24:27], a[168:175], v9
    s_waitcnt lgkmcnt(1)
    v_mfma_f32_16x16x32_bf16 v[44:47], v[36:39], v[84:87], 0
    s_waitcnt lgkmcnt(0)
    v_mfma_f32_16x16x32_bf16 v[44:47], v[40:43], v[84:87], v[44:47]
    v_smfmac_f32_16x16x64_bf16 v[68:71], v[28:31], a[144:151], v9
    v_smfmac_f32_16x16x64_bf16 v[72:75], v[28:31], a[176:183], v9
    s_mov_b64 exec, s[64:65]
    v_cvt_pk_bf16_f32 v48, v44, v45
    v_cvt_pk_bf16_f32 v49, v46, v47
    v_min_u32 v48, 0xfffffffe, v48
    v_min_u32 v49, 0xfffffffe, v49
    buffer_store_dwordx2 v[48:49], v10, s[8:11], s29 offen sc1

    ds_write_b64 v18, v[48:49]
    s_mov_b64 exec, -1

    v_smfmac_f32_16x16x64_bf16 v[68:71], v[32:35], a[152:159], v9
    v_smfmac_f32_16x16x64_bf16 v[72:75], v[32:35], a[184:191], v9
    s_nop 3
    v_cvt_pk_bf16_f32 v104, v68, v69
    v_cvt_pk_bf16_f32 v105, v70, v71
    ds_write_b64 v16, v[104:105] offset:8192
    s_nop 0
    v_cvt_pk_bf16_f32 v106, v72, v73
    v_cvt_pk_bf16_f32 v107, v74, v75
    ds_write_b64 v16, v[106:107] offset:10240
    s_cmp_lg_u32 s24, 2
    s_waitcnt lgkmcnt(0)
    s_barrier
    s_cbranch_scc1 .oth_200
    buffer_load_dwordx4 v[92:95], v232, s[8:11], s29 offen sc1
    buffer_load_dwordx4 v[96:99], v233, s[8:11], s29 offen sc1
    buffer_load_dwordx4 v[100:103], v234, s[8:11], s29 offen sc1
    ds_read_b128 v[88:91], v14 offset:16384
    s_cmp_eq_u32 s28, 63
    s_cbranch_scc1 .rec_fin_6
    s_waitcnt lgkmcnt(0)
    v_mfma_f32_16x16x32_bf16 v[208:211], v[128:131], v[88:91], 0
    v_mfma_f32_16x16x32_bf16 v[212:215], v[144:147], v[88:91], 0
    v_mfma_f32_16x16x32_bf16 v[216:219], v[88:91], v[88:91], v[116:119]
    s_waitcnt vmcnt(2)
    v_max3_u32 v4, v92, v93, v94
    v_max_u32 v4, v4, v95
    v_cmp_eq_u32 vcc, -1, v4
    s_cbranch_vccnz .A_213
.W_214:
    v_mfma_f32_16x16x32_bf16 v[208:211], v[132:135], v[92:95], v[208:211]
    s_waitcnt vmcnt(1)
    v_max3_u32 v4, v96, v97, v98
    v_max_u32 v4, v4, v99
    v_mfma_f32_16x16x32_bf16 v[212:215], v[148:151], v[92:95], v[212:215]
    v_cmp_eq_u32 vcc, -1, v4
    v_mfma_f32_16x16x32_bf16 v[216:219], v[92:95], v[92:95], v[216:219]
    s_cbranch_vccnz .A_215
.W_216:
    v_mfma_f32_16x16x32_bf16 v[208:211], v[136:139], v[96:99], v[208:211]
    s_waitcnt vmcnt(0)
    v_max3_u32 v4, v100, v101, v102
    v_max_u32 v4, v4, v103
    v_mfma_f32_16x16x32_bf16 v[212:215], v[152:155], v[96:99], v[212:215]
    v_cmp_eq_u32 vcc, -1, v4
    v_mfma_f32_16x16x32_bf16 v[216:219], v[96:99], v[96:99], v[216:219]
    s_cbranch_vccnz .A_217
.W_218:
    v_mfma_f32_16x16x32_bf16 v[208:211], v[140:143], v[100:103], v[208:211]
    v_mfma_f32_16x16x32_bf16 v[212:215], v[156:159], v[100:103], v[212:215]
    v_mfma_f32_16x16x32_bf16 v[216:219], v[100:103], v[100:103], v[216:219]
.mj_212:
    s_barrier
    ds_read_b64 v[168:169], v14 offset:18432
    ds_read_b64 v[172:173], v14 offset:18440
    s_nop 0

    v_mov_b32_dpp v208, v212 row_ror:8 row_mask:0xf bank_mask:0xc
    v_mov_b32_dpp v209, v213 row_ror:8 row_mask:0xf bank_mask:0xc
    v_mov_b32_dpp v210, v214 row_ror:8 row_mask:0xf bank_mask:0xc
    v_mov_b32_dpp v211, v215 row_ror:8 row_mask:0xf bank_mask:0xc
    v_mov_b32_dpp v216, v218 row_ror:8 row_mask:0xf bank_mask:0xc
    v_mov_b32_dpp v217, v219 row_ror:8 row_mask:0xf bank_mask:0xc
    v_max3_f32 v4, v208, v209, v210
    v_max3_f32 v5, v211, v216, v217
    v_max_f32 v6, v4, v5
    v_max_f32 v4, v4, v5
    s_nop 1
    v_permlane32_swap_b32 v4, v6
    v_max_f32 v5, v4, v6
    v_max_f32 v4, v4, v6
    s_nop 1
    v_permlane16_swap_b32 v4, v5
    v_max_f32 v4, v4, v5
    s_nop 1
    v_max_f32_dpp v4, v4, v4 row_ror:8 row_mask:0xf bank_mask:0xf
    v_mul_f32 v4, s37, v4

    v_fma_f32 v104, v208, s37, -v4
    v_fma_f32 v105, v209, s37, -v4
    v_fma_f32 v106, v210, s37, -v4
    v_fma_f32 v107, v211, s37, -v4
    v_fma_f32 v108, v216, s37, -v4
    v_fma_f32 v109, v217, s37, -v4
    v_exp_f32 v104, v104
    v_exp_f32 v105, v105
    v_exp_f32 v106, v106
    v_exp_f32 v107, v107
    v_exp_f32 v108, v108
    v_exp_f32 v109, v109
    v_cvt_pk_bf16_f32 v176, v104, v105
    v_cvt_pk_bf16_f32 v177, v106, v107
    v_cvt_pk_bf16_f32 v180, v108, v109
    v_mov_b32_dpp v178, v176 row_ror:8 row_mask:0xf bank_mask:0xf
    v_mov_b32_dpp v179, v177 row_ror:8 row_mask:0xf bank_mask:0xf
    v_mov_b32_dpp v181, v180 row_ror:8 row_mask:0xf bank_mask:0xf
    s_waitcnt lgkmcnt(0)

    v_mfma_f32_16x16x32_bf16 v[208:211], v[120:123], v[176:179], 0
    v_mfma_f32_16x16x32_bf16 v[208:211], v[120:123], v[180:183], v[208:211]
    v_mfma_f32_16x16x32_bf16 v[212:215], v[160:163], v[176:179], 0
    v_mfma_f32_16x16x32_bf16 v[216:219], v[164:167], v[176:179], 0
    v_mfma_f32_16x16x32_bf16 v[212:215], v[168:171], v[180:183], v[212:215]
    v_rcp_f32 v4, v208
    v_mfma_f32_16x16x32_bf16 v[216:219], v[172:175], v[180:183], v[216:219]
    s_mov_b64 exec, s[58:59]
    s_nop 2
    v_mul_f32 v212, v4, v212
    v_mul_f32 v213, v4, v213
    v_mul_f32 v214, v4, v214
    v_mul_f32 v215, v4, v215
    v_cvt_pk_bf16_f32 v184, v212, v213
    v_cvt_pk_bf16_f32 v185, v214, v215
    v_mul_f32 v216, v4, v216
    v_mul_f32 v217, v4, v217
    v_min_u32 v184, 0xfffffffe, v184
    v_min_u32 v185, 0xfffffffe, v185
    v_mul_f32 v218, v4, v218
    v_mul_f32 v219, v4, v219
    v_cvt_pk_bf16_f32 v186, v216, v217
    v_cvt_pk_bf16_f32 v187, v218, v219
    v_min_u32 v186, 0xfffffffe, v186
    v_min_u32 v187, 0xfffffffe, v187
    buffer_store_dwordx4 v[184:187], v13, s[8:11], s29 offen sc1
    s_mov_b64 exec, -1

.gp_202:
    s_barrier
    v_mov_b32 v5, 19968
    ds_read_b32 v4, v5
    s_mov_b32 s99, s68
    s_waitcnt vmcnt(0)
    s_cmp_eq_u32 s24, 3
    s_cbranch_scc1 .u3_219
    s_add_u32 s6, s28, 3
    s_add_u32 s7, s30, 262144
    s_waitcnt lgkmcnt(0)
    v_readfirstlane_b32 s5, v4
    s_cmp_lt_u32 s5, s6
    s_barrier
    s_cbranch_scc1 .np_221
    buffer_load_dword v226, v225, s[8:11], s7 offen

.np_221:
    s_add_u32 s4, s70, 0
    buffer_store_dwordx4 v[188:191], v238, s[8:11], s4 offen sc1
    s_add_u32 s4, s70, 262144
    buffer_store_dwordx4 v[188:191], v238, s[8:11], s4 offen sc1
    s_branch .u4_220
.u3_219:
    s_sub_u32 s4, s36, 0
    s_barrier
    s_mov_b64 exec, s[66:67]
    buffer_store_dwordx4 v[88:91], v11, s[8:11], s4 offen sc1
    s_mov_b64 exec, s[56:57]
    buffer_store_dwordx4 v[172:175], v12, s[8:11], s4 offen sc1
    s_mov_b64 exec, -1

.u4_220:
    s_barrier
    s_add_u32 s28, s28, 1
    s_add_u32 s36, s36, 196608
    s_cmp_lt_u32 s28, 63
    s_cselect_b32 s4, 262144, 0
    s_add_u32 s38, s38, s4
    s_add_u32 s39, s39, s4
    s_add_u32 s30, s30, s4
    s_mov_b32 s4, s68
    s_mov_b32 s68, s69
    s_mov_b32 s69, s70
    s_mov_b32 s70, s71
    s_mov_b32 s71, s4
    s_and_b32 s4, s28, 3
    s_lshl_b32 s5, s4, 17
    s_add_u32 s29, s5, s34
    s_xor_b32 s6, s5, 262144
    s_add_u32 s31, s6, s34
    s_add_u32 s32, s29, 20480
    s_add_u32 s33, s29, 24576
    v_mov_b32 v55, 0
    v_mov_b32 v56, 0
    v_mov_b32 v57, 0
    v_mov_b32 v58, 0
    v_mov_b32 v59, 0
    v_mov_b32 v60, 0
    v_mov_b32 v61, 0
    v_mov_b32 v62, 0
    v_mov_b32 v63, 0
    v_mov_b32 v64, 0
    v_mov_b32 v65, 0
    v_mov_b32 v66, 0
    v_mov_b32 v67, 0
    v_mov_b32 v68, 0
    v_mov_b32 v69, 0
    v_mov_b32 v70, 0
    v_mov_b32 v71, 0
    v_mov_b32 v72, 0
    v_mov_b32 v73, 0
    v_mov_b32 v74, 0
    v_mov_b32 v75, 0
    v_mov_b32 v20, -1
    v_mov_b32 v21, -1
    v_mov_b32 v22, -1
    v_mov_b32 v23, -1
    v_mov_b32 v24, -1
    v_mov_b32 v25, -1
    v_mov_b32 v26, -1
    v_mov_b32 v27, -1
    v_mov_b32 v28, -1
    v_mov_b32 v29, -1
    v_mov_b32 v30, -1
    v_mov_b32 v31, -1
    v_mov_b32 v32, -1
    v_mov_b32 v33, -1
    v_mov_b32 v34, -1
    v_mov_b32 v35, -1
    v_mov_b32 v92, -1
    v_mov_b32 v93, -1
    v_mov_b32 v94, -1
    v_mov_b32 v95, -1
    v_mov_b32 v96, -1
    v_mov_b32 v97, -1
    v_mov_b32 v98, -1
    v_mov_b32 v99, -1
    v_mov_b32 v100, -1
    v_mov_b32 v101, -1
    v_mov_b32 v102, -1
    v_mov_b32 v103, -1
    s_add_u32 s4, s99, 0
    buffer_load_dwordx4 v[192:195], v239, s[8:11], s4 offen sc1
    buffer_load_dwordx4 v[196:199], v249, s[8:11], s4 offen sc1

    ds_read_b128 v[128:131], v228 offset:0
    ds_read_b128 v[144:147], v228 offset:4096
    ds_read_b128 v[132:135], v229 offset:0
    ds_read_b128 v[148:151], v229 offset:4096
    ds_read_b128 v[136:139], v230 offset:0
    ds_read_b128 v[152:155], v230 offset:4096
    ds_read_b128 v[140:143], v231 offset:0
    ds_read_b128 v[156:159], v231 offset:4096
    ds_read_b128 v[160:163], v14 offset:28672
    ds_read_b128 v[164:167], v14 offset:29696
    ds_read_b128 v[108:111], v248
    s_waitcnt lgkmcnt(0)
    v_mfma_f32_16x16x32_bf16 v[76:79], v[108:111], v[112:115], 0
    s_add_u32 s4, s99, 262144
    buffer_load_dwordx4 v[200:203], v239, s[8:11], s4 offen sc1
    buffer_load_dwordx4 v[204:207], v249, s[8:11], s4 offen sc1

.gc_222:
    s_waitcnt vmcnt(2)

    v_max_u32 v4, v192, v196
    v_cmp_eq_u32 vcc, -1, v4
    s_cbranch_vccnz .gf_223
    v_mfma_f32_16x16x32_bf16 v[76:79], v[192:195], v[84:87], v[76:79]
    v_mfma_f32_16x16x32_bf16 v[76:79], v[196:199], v[112:115], v[76:79]
    s_mov_b64 exec, s[58:59]
    s_nop 6
    v_cvt_pk_bf16_f32 v104, v76, v77
    v_cvt_pk_bf16_f32 v105, v78, v79
    v_min_u32 v104, 0xfffffffe, v104
    v_min_u32 v105, 0xfffffffe, v105
    buffer_store_dwordx2 v[104:105], v15, s[8:11], s29 offen sc1
    s_mov_b64 exec, -1

    s_branch .top_199
.gf_223:
    s_add_u32 s4, s99, 0
    buffer_load_dwordx4 v[192:195], v239, s[8:11], s4 offen sc1
    buffer_load_dwordx4 v[196:199], v249, s[8:11], s4 offen sc1

    s_waitcnt vmcnt(2)

    v_max_u32 v4, v200, v204
    v_cmp_eq_u32 vcc, -1, v4
    s_cbranch_vccnz .gf_224
    v_mfma_f32_16x16x32_bf16 v[76:79], v[200:203], v[84:87], v[76:79]
    v_mfma_f32_16x16x32_bf16 v[76:79], v[204:207], v[112:115], v[76:79]
    s_mov_b64 exec, s[58:59]
    s_nop 6
    v_cvt_pk_bf16_f32 v104, v76, v77
    v_cvt_pk_bf16_f32 v105, v78, v79
    v_min_u32 v104, 0xfffffffe, v104
    v_min_u32 v105, 0xfffffffe, v105
    buffer_store_dwordx2 v[104:105], v15, s[8:11], s29 offen sc1
    s_mov_b64 exec, -1

    s_branch .top_199
.gf_224:
    s_add_u32 s4, s99, 262144
    buffer_load_dwordx4 v[200:203], v239, s[8:11], s4 offen sc1
    buffer_load_dwordx4 v[204:207], v249, s[8:11], s4 offen sc1

    s_sub_u32 s62, s62, 1
    s_cbranch_scc1 .mg_end_1
    s_branch .gc_222
.oth_200:
    s_cmp_eq_u32 s24, 3
    s_cbranch_scc1 .w3_201
    s_cmp_eq_u32 s28, 63
    s_cbranch_scc1 .rec_fin_6
    s_min_u32 s4, s14, s15
    s_max_u32 s93, s93, s4
    v_mov_b32 v4, s93
    v_mov_b32 v5, 19968
    ds_write_b32 v5, v4
    s_waitcnt vmcnt(0)
    v_mov_b32 v71, 0
    v_mov_b32 v72, 0
    v_mov_b32 v73, 0
    v_mov_b32 v74, 0
    v_mov_b32 v75, 0
    s_barrier
    s_add_u32 s6, s28, 2
    s_min_u32 s6, s6, 64
    s_cmp_lt_u32 s93, s6
    s_cbranch_scc1 .kf_225
.kb_226:
    s_mov_b32 m0, s90
    s_nop 0
    buffer_load_dwordx4 v14, s[8:11], s38 offen offset:0 lds
    buffer_load_dwordx4 v14, s[8:11], s38 offen offset:1024 lds
    buffer_load_dwordx4 v14, s[8:11], s38 offen offset:2048 lds
    buffer_load_dwordx4 v14, s[8:11], s38 offen offset:3072 lds
    s_mov_b32 m0, s91
    s_nop 0
    buffer_load_dwordx4 v14, s[8:11], s39 offen lds
    s_waitcnt lgkmcnt(0)
    s_barrier
    v_mov_b32 v20, -1
    v_mov_b32 v21, -1
    v_mov_b32 v22, -1
    v_mov_b32 v23, -1
    v_mov_b32 v24, -1
    v_mov_b32 v25, -1
    v_mov_b32 v26, -1
    v_mov_b32 v27, -1
    v_mov_b32 v28, -1
    v_mov_b32 v29, -1
    v_mov_b32 v30, -1
    v_mov_b32 v31, -1
    v_mov_b32 v32, -1
    v_mov_b32 v33, -1
    v_mov_b32 v34, -1
    v_mov_b32 v35, -1
    v_mov_b32 v55, 0
    v_mov_b32 v56, 0
    v_mov_b32 v57, 0
    v_mov_b32 v58, 0
    v_mov_b32 v59, 0
    v_mov_b32 v60, 0
    v_mov_b32 v61, 0
    v_mov_b32 v62, 0
    v_mov_b32 v63, 0
    v_mov_b32 v64, 0
    v_mov_b32 v65, 0
    v_mov_b32 v66, 0
    v_mov_b32 v67, 0
    v_mov_b32 v68, 0
    v_mov_b32 v69, 0
    v_mov_b32 v70, 0
    buffer_load_dwordx4 v[192:195], v243, s[8:11], s32 offen offset:0 sc1
    buffer_load_dwordx4 v[196:199], v243, s[8:11], s32 offen offset:1024 sc1
    v_mov_b32 v76, 0
    buffer_load_dwordx4 v[200:203], v252, s[8:11], s32 offen offset:0 sc1
    buffer_load_dwordx4 v[204:207], v252, s[8:11], s32 offen offset:1024 sc1
    v_mov_b32 v77, 0
    buffer_load_dwordx4 v[208:211], v254, s[8:11], s32 offen offset:0 sc1
    buffer_load_dwordx4 v[212:215], v254, s[8:11], s32 offen offset:1024 sc1
    v_mov_b32 v78, 0
    buffer_load_dwordx4 v[216:219], v246, s[8:11], s32 offen offset:0 sc1
    buffer_load_dwordx4 v[220:223], v246, s[8:11], s32 offen offset:1024 sc1
    s_waitcnt vmcnt(6)
    v_max3_u32 v4, v192, v193, v194
    v_max3_u32 v5, v195, v196, v197
    v_max3_u32 v4, v4, v198, v199
    v_max_u32 v4, v4, v5
    v_cmp_eq_u32 vcc, -1, v4
    s_cbranch_vccnz .A_228
.W_229:
    v_smfmac_f32_16x16x64_bf16 v[76:79], v[192:195], a[192:199], v9
    v_smfmac_f32_16x16x64_bf16 v[80:83], v[192:195], a[224:231], v9
    s_waitcnt vmcnt(4)
    v_max3_u32 v4, v200, v201, v202
    v_max3_u32 v5, v203, v204, v205
    v_max3_u32 v4, v4, v206, v207
    v_smfmac_f32_16x16x64_bf16 v[76:79], v[196:199], a[200:207], v9
    v_max_u32 v4, v4, v5
    v_cmp_eq_u32 vcc, -1, v4
    v_smfmac_f32_16x16x64_bf16 v[80:83], v[196:199], a[232:239], v9
    s_cbranch_vccnz .A_230
.W_231:
    v_smfmac_f32_16x16x64_bf16 v[76:79], v[200:203], a[208:215], v9
    v_smfmac_f32_16x16x64_bf16 v[80:83], v[200:203], a[240:247], v9
    s_waitcnt vmcnt(2)
    v_max3_u32 v4, v208, v209, v210
    v_max3_u32 v5, v211, v212, v213
    v_max3_u32 v4, v4, v214, v215
    v_smfmac_f32_16x16x64_bf16 v[76:79], v[204:207], a[216:223], v9
    v_max_u32 v4, v4, v5
    v_cmp_eq_u32 vcc, -1, v4
    v_smfmac_f32_16x16x64_bf16 v[80:83], v[204:207], a[248:255], v9
    s_cbranch_vccnz .A_232
.W_233:
    v_smfmac_f32_16x16x64_bf16 v[76:79], v[208:211], v[124:131], v9
    v_smfmac_f32_16x16x64_bf16 v[80:83], v[208:211], v[156:163], v9
    s_waitcnt vmcnt(0)
    v_max3_u32 v4, v216, v217, v218
    v_max3_u32 v5, v219, v220, v221
    v_max3_u32 v4, v4, v222, v223
    v_smfmac_f32_16x16x64_bf16 v[76:79], v[212:215], v[132:139], v9
    v_max_u32 v4, v4, v5
    v_cmp_eq_u32 vcc, -1, v4
    v_smfmac_f32_16x16x64_bf16 v[80:83], v[212:215], v[164:171], v9
    s_cbranch_vccnz .A_234
.W_235:
    v_smfmac_f32_16x16x64_bf16 v[76:79], v[216:219], v[140:147], v9
    v_smfmac_f32_16x16x64_bf16 v[80:83], v[216:219], v[172:179], v9
    v_smfmac_f32_16x16x64_bf16 v[76:79], v[220:223], v[148:155], v9
    v_smfmac_f32_16x16x64_bf16 v[80:83], v[220:223], v[180:187], v9
.mj_227:
    s_barrier
    s_nop 7
    v_permlane32_swap_b32 v76, v80
    v_permlane32_swap_b32 v77, v81
    v_permlane32_swap_b32 v78, v82
    v_permlane32_swap_b32 v79, v83
    v_add_f32 v76, v76, v80
    v_add_f32 v77, v77, v81
    v_add_f32 v78, v78, v82
    v_add_f32 v79, v79, v83
    v_cvt_pk_bf16_f32 v104, v76, v77
    v_cvt_pk_bf16_f32 v106, v76, v77
    v_cvt_pk_bf16_f32 v105, v78, v79
    v_cvt_pk_bf16_f32 v107, v78, v79
    v_permlane16_swap_b32 v104, v106
    s_nop 0
    v_permlane16_swap_b32 v105, v107
    v_min_u32 v104, 0xfffffffe, v104
    buffer_store_dwordx4 v[104:107], v237, s[8:11], s68 offen sc1

    ds_write_b128 v247, v[104:107]
    s_waitcnt lgkmcnt(0)
    s_barrier
    v_mov_b32 v79, 0
    v_mov_b32 v80, 0
    v_mov_b32 v81, 0
    v_mov_b32 v82, 0
    v_mov_b32 v83, 0
    s_waitcnt vmcnt(1)
    v_mov_b32 v192, -1
    v_mov_b32 v193, -1
    v_mov_b32 v194, -1
    v_mov_b32 v195, -1
    v_mov_b32 v196, -1
    v_mov_b32 v197, -1
    v_mov_b32 v198, -1
    v_mov_b32 v199, -1
    v_mov_b32 v200, -1
    v_mov_b32 v201, -1
    v_mov_b32 v202, -1
    v_mov_b32 v203, -1
    v_mov_b32 v204, -1
    v_mov_b32 v205, -1
    v_mov_b32 v206, -1
    v_mov_b32 v207, -1
    v_mov_b32 v208, -1
    v_mov_b32 v209, -1
    v_mov_b32 v210, -1
    v_mov_b32 v211, -1
    v_mov_b32 v212, -1
    v_mov_b32 v213, -1
    v_mov_b32 v214, -1
    v_mov_b32 v215, -1
    v_mov_b32 v216, -1
    v_mov_b32 v217, -1
    v_mov_b32 v218, -1
    v_mov_b32 v219, -1
    v_mov_b32 v220, -1
    v_mov_b32 v221, -1
    v_mov_b32 v222, -1
    v_mov_b32 v223, -1
    s_add_u32 s6, s28, 4
    s_cmp_ge_u32 s93, s6
    s_cbranch_scc1 .nl_236
    s_buffer_load_dword s14, s[8:11], s89 glc
    s_buffer_load_dword s15, s[8:11], s89 offset:8192 glc

.nl_236:
    s_add_u32 s28, s28, 1
    s_add_u32 s36, s36, 196608
    s_cmp_lt_u32 s28, 63
    s_cselect_b32 s4, 262144, 0
    s_add_u32 s38, s38, s4
    s_add_u32 s39, s39, s4
    s_add_u32 s30, s30, s4
    s_mov_b32 s4, s68
    s_mov_b32 s68, s69
    s_mov_b32 s69, s70
    s_mov_b32 s70, s71
    s_mov_b32 s71, s4
    s_and_b32 s4, s28, 3
    s_lshl_b32 s5, s4, 17
    s_add_u32 s29, s5, s34
    s_xor_b32 s6, s5, 262144
    s_add_u32 s31, s6, s34
    s_add_u32 s32, s29, 20480
    s_add_u32 s33, s29, 24576
    s_branch .top_199
.w3_201:
    ds_read_b128 v[36:39], v14 offset:8192
    ds_read_b128 v[40:43], v14 offset:9216
    ds_read_b128 v[44:47], v14 offset:10240
    ds_read_b128 v[48:51], v14 offset:11264
    ds_read_b128 v[88:91], v14 offset:16384
    s_waitcnt lgkmcnt(0)
    v_mfma_f32_16x16x32_bf16 v[104:107], v[84:87], v[36:39], 0
    v_mfma_f32_16x16x32_bf16 v[108:111], v[84:87], v[44:47], 0
    v_mfma_f32_16x16x32_bf16 v[104:107], v[84:87], v[40:43], v[104:107]
    v_mfma_f32_16x16x32_bf16 v[108:111], v[84:87], v[48:51], v[108:111]
    s_nop 7
    v_cvt_pk_bf16_f32 v168, v104, v105
    v_cvt_pk_bf16_f32 v169, v106, v107
    v_cvt_pk_bf16_f32 v170, v108, v109
    v_cvt_pk_bf16_f32 v171, v110, v111
    ds_write_b128 v14, v[168:171] offset:18432
    v_cndmask_b32 v172, v170, v168, s[60:61]
    v_cndmask_b32 v173, v171, v169, s[60:61]
    v_min_u32 v172, 0xfffffffe, v172
    v_min_u32 v173, 0xfffffffe, v173
    v_mov_b32 v174, v172
    v_mov_b32 v175, v173
    s_cmp_eq_u32 s28, 63
    s_nop 0
    v_permlane16_swap_b32 v172, v174
    v_permlane16_swap_b32 v173, v175
    ds_write_b128 v14, v[172:175] offset:17408

    s_cbranch_scc1 .sk_237
    s_waitcnt lgkmcnt(0)
    s_barrier
    buffer_store_dwordx4 v[188:191], v235, s[8:11], s31 offen sc1
    buffer_store_dwordx4 v[188:191], v236, s[8:11], s31 offen sc1

    s_branch .gp_202
.A_238:
    s_mov_b64 exec, vcc
    buffer_load_dwordx4 v[32:35], v8, s[8:11], s29 offen offset:3072 sc1
    s_mov_b64 exec, -1
    s_sub_u32 s62, s62, 1
    s_cbranch_scc1 .mg_end_1
    s_waitcnt vmcnt(3)
    v_max3_u32 v4, v20, v21, v22
    v_max_u32 v4, v4, v23
    v_cmp_eq_u32 vcc, -1, v4
    s_cbranch_vccz .W_205
.A_204:
    s_mov_b64 exec, vcc
    buffer_load_dwordx4 v[20:23], v8, s[8:11], s29 offen offset:0 sc1
    s_mov_b64 exec, -1
    s_waitcnt vmcnt(3)
    v_max3_u32 v4, v24, v25, v26
    v_max_u32 v4, v4, v27
    v_cmp_eq_u32 vcc, -1, v4
    s_cbranch_vccz .W_239
.A_240:
    s_mov_b64 exec, vcc
    buffer_load_dwordx4 v[24:27], v8, s[8:11], s29 offen offset:1024 sc1
    s_mov_b64 exec, -1
    s_waitcnt vmcnt(3)
    v_max3_u32 v4, v28, v29, v30
    v_max_u32 v4, v4, v31
    v_cmp_eq_u32 vcc, -1, v4
    s_cbranch_vccz .W_241
.A_242:
    s_mov_b64 exec, vcc
    buffer_load_dwordx4 v[28:31], v8, s[8:11], s29 offen offset:2048 sc1
    s_mov_b64 exec, -1
    s_waitcnt vmcnt(3)
    v_max3_u32 v4, v32, v33, v34
    v_max_u32 v4, v4, v35
    v_cmp_eq_u32 vcc, -1, v4
    s_cbranch_vccnz .A_238
.W_243:
    v_smfmac_f32_16x16x64_bf16 v[52:55], v[32:35], a[24:31], v9
    v_smfmac_f32_16x16x64_bf16 v[56:59], v[32:35], a[56:63], v9
    s_waitcnt vmcnt(2)
    v_max3_u32 v4, v20, v21, v22
    v_max_u32 v4, v4, v23
    v_smfmac_f32_16x16x64_bf16 v[60:63], v[32:35], a[88:95], v9
    v_cmp_eq_u32 vcc, -1, v4
    v_smfmac_f32_16x16x64_bf16 v[64:67], v[32:35], a[120:127], v9
    s_cbranch_vccnz .A_244
.W_245:
    v_smfmac_f32_16x16x64_bf16 v[52:55], v[20:23], a[0:7], v9
    v_smfmac_f32_16x16x64_bf16 v[56:59], v[20:23], a[32:39], v9
    s_waitcnt vmcnt(1)
    v_max3_u32 v4, v24, v25, v26
    v_max_u32 v4, v4, v27
    v_smfmac_f32_16x16x64_bf16 v[60:63], v[20:23], a[64:71], v9
    v_cmp_eq_u32 vcc, -1, v4
    v_smfmac_f32_16x16x64_bf16 v[64:67], v[20:23], a[96:103], v9
    s_cbranch_vccnz .A_246
.W_247:
    v_smfmac_f32_16x16x64_bf16 v[52:55], v[24:27], a[8:15], v9
    v_smfmac_f32_16x16x64_bf16 v[56:59], v[24:27], a[40:47], v9
    s_waitcnt vmcnt(0)
    v_max3_u32 v4, v28, v29, v30
    v_max_u32 v4, v4, v31
    v_smfmac_f32_16x16x64_bf16 v[60:63], v[24:27], a[72:79], v9
    v_cmp_eq_u32 vcc, -1, v4
    v_smfmac_f32_16x16x64_bf16 v[64:67], v[24:27], a[104:111], v9
    s_cbranch_vccnz .A_248
.W_249:
    v_smfmac_f32_16x16x64_bf16 v[52:55], v[28:31], a[16:23], v9
    v_smfmac_f32_16x16x64_bf16 v[56:59], v[28:31], a[48:55], v9
    v_smfmac_f32_16x16x64_bf16 v[60:63], v[28:31], a[80:87], v9
    v_smfmac_f32_16x16x64_bf16 v[64:67], v[28:31], a[112:119], v9
    s_branch .mj_203
.W_239:
    v_smfmac_f32_16x16x64_bf16 v[52:55], v[24:27], a[8:15], v9
    v_smfmac_f32_16x16x64_bf16 v[56:59], v[24:27], a[40:47], v9
    s_waitcnt vmcnt(2)
    v_max3_u32 v4, v28, v29, v30
    v_max_u32 v4, v4, v31
    v_smfmac_f32_16x16x64_bf16 v[60:63], v[24:27], a[72:79], v9
    v_cmp_eq_u32 vcc, -1, v4
    v_smfmac_f32_16x16x64_bf16 v[64:67], v[24:27], a[104:111], v9
    s_cbranch_vccnz .A_250
.W_251:
    v_smfmac_f32_16x16x64_bf16 v[52:55], v[28:31], a[16:23], v9
    v_smfmac_f32_16x16x64_bf16 v[56:59], v[28:31], a[48:55], v9
    s_waitcnt vmcnt(1)
    v_max3_u32 v4, v32, v33, v34
    v_max_u32 v4, v4, v35
    v_smfmac_f32_16x16x64_bf16 v[60:63], v[28:31], a[80:87], v9
    v_cmp_eq_u32 vcc, -1, v4
    v_smfmac_f32_16x16x64_bf16 v[64:67], v[28:31], a[112:119], v9
    s_cbranch_vccnz .A_252
.W_253:
    v_smfmac_f32_16x16x64_bf16 v[52:55], v[32:35], a[24:31], v9
    v_smfmac_f32_16x16x64_bf16 v[56:59], v[32:35], a[56:63], v9
    s_waitcnt vmcnt(0)
    v_max3_u32 v4, v20, v21, v22
    v_max_u32 v4, v4, v23
    v_smfmac_f32_16x16x64_bf16 v[60:63], v[32:35], a[88:95], v9
    v_cmp_eq_u32 vcc, -1, v4
    v_smfmac_f32_16x16x64_bf16 v[64:67], v[32:35], a[120:127], v9
    s_cbranch_vccnz .A_254
.W_255:
    v_smfmac_f32_16x16x64_bf16 v[52:55], v[20:23], a[0:7], v9
    v_smfmac_f32_16x16x64_bf16 v[56:59], v[20:23], a[32:39], v9
    v_smfmac_f32_16x16x64_bf16 v[60:63], v[20:23], a[64:71], v9
    v_smfmac_f32_16x16x64_bf16 v[64:67], v[20:23], a[96:103], v9
    s_branch .mj_203
.W_241:
    v_smfmac_f32_16x16x64_bf16 v[52:55], v[28:31], a[16:23], v9
    v_smfmac_f32_16x16x64_bf16 v[56:59], v[28:31], a[48:55], v9
    s_waitcnt vmcnt(2)
    v_max3_u32 v4, v32, v33, v34
    v_max_u32 v4, v4, v35
    v_smfmac_f32_16x16x64_bf16 v[60:63], v[28:31], a[80:87], v9
    v_cmp_eq_u32 vcc, -1, v4
    v_smfmac_f32_16x16x64_bf16 v[64:67], v[28:31], a[112:119], v9
    s_cbranch_vccnz .A_256
.W_257:
    v_smfmac_f32_16x16x64_bf16 v[52:55], v[32:35], a[24:31], v9
    v_smfmac_f32_16x16x64_bf16 v[56:59], v[32:35], a[56:63], v9
    s_waitcnt vmcnt(1)
    v_max3_u32 v4, v20, v21, v22
    v_max_u32 v4, v4, v23
    v_smfmac_f32_16x16x64_bf16 v[60:63], v[32:35], a[88:95], v9
    v_cmp_eq_u32 vcc, -1, v4
    v_smfmac_f32_16x16x64_bf16 v[64:67], v[32:35], a[120:127], v9
    s_cbranch_vccnz .A_258
.W_259:
    v_smfmac_f32_16x16x64_bf16 v[52:55], v[20:23], a[0:7], v9
    v_smfmac_f32_16x16x64_bf16 v[56:59], v[20:23], a[32:39], v9
    s_waitcnt vmcnt(0)
    v_max3_u32 v4, v24, v25, v26
    v_max_u32 v4, v4, v27
    v_smfmac_f32_16x16x64_bf16 v[60:63], v[20:23], a[64:71], v9
    v_cmp_eq_u32 vcc, -1, v4
    v_smfmac_f32_16x16x64_bf16 v[64:67], v[20:23], a[96:103], v9
    s_cbranch_vccnz .A_260
.W_261:
    v_smfmac_f32_16x16x64_bf16 v[52:55], v[24:27], a[8:15], v9
    v_smfmac_f32_16x16x64_bf16 v[56:59], v[24:27], a[40:47], v9
    v_smfmac_f32_16x16x64_bf16 v[60:63], v[24:27], a[72:79], v9
    v_smfmac_f32_16x16x64_bf16 v[64:67], v[24:27], a[104:111], v9
    s_branch .mj_203
.A_262:
    s_mov_b64 exec, vcc
    buffer_load_dwordx4 v[28:31], v8, s[8:11], s29 offen offset:2048 sc1
    s_mov_b64 exec, -1
    s_sub_u32 s62, s62, 1
    s_cbranch_scc1 .mg_end_1
    s_waitcnt vmcnt(2)
    v_max3_u32 v4, v20, v21, v22
    v_max_u32 v4, v4, v23
    v_cmp_eq_u32 vcc, -1, v4
    s_cbranch_vccz .W_245
.A_244:
    s_mov_b64 exec, vcc
    buffer_load_dwordx4 v[20:23], v8, s[8:11], s29 offen offset:0 sc1
    s_mov_b64 exec, -1
    s_waitcnt vmcnt(2)
    v_max3_u32 v4, v24, v25, v26
    v_max_u32 v4, v4, v27
    v_cmp_eq_u32 vcc, -1, v4
    s_cbranch_vccz .W_263
.A_264:
    s_mov_b64 exec, vcc
    buffer_load_dwordx4 v[24:27], v8, s[8:11], s29 offen offset:1024 sc1
    s_mov_b64 exec, -1
    s_waitcnt vmcnt(2)
    v_max3_u32 v4, v28, v29, v30
    v_max_u32 v4, v4, v31
    v_cmp_eq_u32 vcc, -1, v4
    s_cbranch_vccnz .A_262
.W_265:
    v_smfmac_f32_16x16x64_bf16 v[52:55], v[28:31], a[16:23], v9
    v_smfmac_f32_16x16x64_bf16 v[56:59], v[28:31], a[48:55], v9
    s_waitcnt vmcnt(1)
    v_max3_u32 v4, v20, v21, v22
    v_max_u32 v4, v4, v23
    v_smfmac_f32_16x16x64_bf16 v[60:63], v[28:31], a[80:87], v9
    v_cmp_eq_u32 vcc, -1, v4
    v_smfmac_f32_16x16x64_bf16 v[64:67], v[28:31], a[112:119], v9
    s_cbranch_vccz .W_259
    s_branch .A_258
.W_263:
    v_smfmac_f32_16x16x64_bf16 v[52:55], v[24:27], a[8:15], v9
    v_smfmac_f32_16x16x64_bf16 v[56:59], v[24:27], a[40:47], v9
    s_waitcnt vmcnt(1)
    v_max3_u32 v4, v28, v29, v30
    v_max_u32 v4, v4, v31
    v_smfmac_f32_16x16x64_bf16 v[60:63], v[24:27], a[72:79], v9
    v_cmp_eq_u32 vcc, -1, v4
    v_smfmac_f32_16x16x64_bf16 v[64:67], v[24:27], a[104:111], v9
    s_cbranch_vccnz .A_266
.W_267:
    v_smfmac_f32_16x16x64_bf16 v[52:55], v[28:31], a[16:23], v9
    v_smfmac_f32_16x16x64_bf16 v[56:59], v[28:31], a[48:55], v9
    s_waitcnt vmcnt(0)
    v_max3_u32 v4, v20, v21, v22
    v_max_u32 v4, v4, v23
    v_smfmac_f32_16x16x64_bf16 v[60:63], v[28:31], a[80:87], v9
    v_cmp_eq_u32 vcc, -1, v4
    v_smfmac_f32_16x16x64_bf16 v[64:67], v[28:31], a[112:119], v9
    s_cbranch_vccz .W_255
    s_branch .A_254
.A_268:
    s_mov_b64 exec, vcc
    buffer_load_dwordx4 v[24:27], v8, s[8:11], s29 offen offset:1024 sc1
    s_mov_b64 exec, -1
    s_sub_u32 s62, s62, 1
    s_cbranch_scc1 .mg_end_1
    s_waitcnt vmcnt(2)
    v_max3_u32 v4, v32, v33, v34
    v_max_u32 v4, v4, v35
    v_cmp_eq_u32 vcc, -1, v4
    s_cbranch_vccz .W_257
.A_256:
    s_mov_b64 exec, vcc
    buffer_load_dwordx4 v[32:35], v8, s[8:11], s29 offen offset:3072 sc1
    s_mov_b64 exec, -1
    s_waitcnt vmcnt(2)
    v_max3_u32 v4, v20, v21, v22
    v_max_u32 v4, v4, v23
    v_cmp_eq_u32 vcc, -1, v4
    s_cbranch_vccz .W_269
.A_270:
    s_mov_b64 exec, vcc
    buffer_load_dwordx4 v[20:23], v8, s[8:11], s29 offen offset:0 sc1
    s_mov_b64 exec, -1
    s_waitcnt vmcnt(2)
    v_max3_u32 v4, v24, v25, v26
    v_max_u32 v4, v4, v27
    v_cmp_eq_u32 vcc, -1, v4
    s_cbranch_vccnz .A_268
.W_271:
    v_smfmac_f32_16x16x64_bf16 v[52:55], v[24:27], a[8:15], v9
    v_smfmac_f32_16x16x64_bf16 v[56:59], v[24:27], a[40:47], v9
    s_waitcnt vmcnt(1)
    v_max3_u32 v4, v32, v33, v34
    v_max_u32 v4, v4, v35
    v_smfmac_f32_16x16x64_bf16 v[60:63], v[24:27], a[72:79], v9
    v_cmp_eq_u32 vcc, -1, v4
    v_smfmac_f32_16x16x64_bf16 v[64:67], v[24:27], a[104:111], v9
    s_cbranch_vccz .W_253
    s_branch .A_252
.W_269:
    v_smfmac_f32_16x16x64_bf16 v[52:55], v[20:23], a[0:7], v9
    v_smfmac_f32_16x16x64_bf16 v[56:59], v[20:23], a[32:39], v9
    s_waitcnt vmcnt(1)
    v_max3_u32 v4, v24, v25, v26
    v_max_u32 v4, v4, v27
    v_smfmac_f32_16x16x64_bf16 v[60:63], v[20:23], a[64:71], v9
    v_cmp_eq_u32 vcc, -1, v4
    v_smfmac_f32_16x16x64_bf16 v[64:67], v[20:23], a[96:103], v9
    s_cbranch_vccnz .A_272
.W_273:
    v_smfmac_f32_16x16x64_bf16 v[52:55], v[24:27], a[8:15], v9
    v_smfmac_f32_16x16x64_bf16 v[56:59], v[24:27], a[40:47], v9
    s_waitcnt vmcnt(0)
    v_max3_u32 v4, v32, v33, v34
    v_max_u32 v4, v4, v35
    v_smfmac_f32_16x16x64_bf16 v[60:63], v[24:27], a[72:79], v9
    v_cmp_eq_u32 vcc, -1, v4
    v_smfmac_f32_16x16x64_bf16 v[64:67], v[24:27], a[104:111], v9
    s_cbranch_vccz .W_211
    s_branch .A_210
.A_274:
    s_mov_b64 exec, vcc
    buffer_load_dwordx4 v[32:35], v8, s[8:11], s29 offen offset:3072 sc1
    s_mov_b64 exec, -1
    s_sub_u32 s62, s62, 1
    s_cbranch_scc1 .mg_end_1
    s_waitcnt vmcnt(2)
    v_max3_u32 v4, v20, v21, v22
    v_max_u32 v4, v4, v23
    v_cmp_eq_u32 vcc, -1, v4
    s_cbranch_vccz .W_275
.A_276:
    s_mov_b64 exec, vcc
    buffer_load_dwordx4 v[20:23], v8, s[8:11], s29 offen offset:0 sc1
    s_mov_b64 exec, -1
    s_waitcnt vmcnt(2)
    v_max3_u32 v4, v28, v29, v30
    v_max_u32 v4, v4, v31
    v_cmp_eq_u32 vcc, -1, v4
    s_cbranch_vccz .W_251
.A_250:
    s_mov_b64 exec, vcc
    buffer_load_dwordx4 v[28:31], v8, s[8:11], s29 offen offset:2048 sc1
    s_mov_b64 exec, -1
    s_waitcnt vmcnt(2)
    v_max3_u32 v4, v32, v33, v34
    v_max_u32 v4, v4, v35
    v_cmp_eq_u32 vcc, -1, v4
    s_cbranch_vccnz .A_274
.W_277:
    v_smfmac_f32_16x16x64_bf16 v[52:55], v[32:35], a[24:31], v9
    v_smfmac_f32_16x16x64_bf16 v[56:59], v[32:35], a[56:63], v9
    s_waitcnt vmcnt(1)
    v_max3_u32 v4, v20, v21, v22
    v_max_u32 v4, v4, v23
    v_smfmac_f32_16x16x64_bf16 v[60:63], v[32:35], a[88:95], v9
    v_cmp_eq_u32 vcc, -1, v4
    v_smfmac_f32_16x16x64_bf16 v[64:67], v[32:35], a[120:127], v9
    s_cbranch_vccnz .A_278
.W_279:
    v_smfmac_f32_16x16x64_bf16 v[52:55], v[20:23], a[0:7], v9
    v_smfmac_f32_16x16x64_bf16 v[56:59], v[20:23], a[32:39], v9
    s_waitcnt vmcnt(0)
    v_max3_u32 v4, v28, v29, v30
    v_max_u32 v4, v4, v31
    v_smfmac_f32_16x16x64_bf16 v[60:63], v[20:23], a[64:71], v9
    v_cmp_eq_u32 vcc, -1, v4
    v_smfmac_f32_16x16x64_bf16 v[64:67], v[20:23], a[96:103], v9
    s_cbranch_vccz .W_249
    s_branch .A_248
.W_275:
    v_smfmac_f32_16x16x64_bf16 v[52:55], v[20:23], a[0:7], v9
    v_smfmac_f32_16x16x64_bf16 v[56:59], v[20:23], a[32:39], v9
    s_waitcnt vmcnt(1)
    v_max3_u32 v4, v28, v29, v30
    v_max_u32 v4, v4, v31
    v_smfmac_f32_16x16x64_bf16 v[60:63], v[20:23], a[64:71], v9
    v_cmp_eq_u32 vcc, -1, v4
    v_smfmac_f32_16x16x64_bf16 v[64:67], v[20:23], a[96:103], v9
    s_cbranch_vccz .W_209
    s_branch .A_208
.A_280:
    s_mov_b64 exec, vcc
    buffer_load_dwordx4 v[32:35], v8, s[8:11], s29 offen offset:3072 sc1
    s_mov_b64 exec, -1
    s_sub_u32 s62, s62, 1
    s_cbranch_scc1 .mg_end_1
    s_waitcnt vmcnt(2)
    v_max3_u32 v4, v24, v25, v26
    v_max_u32 v4, v4, v27
    v_cmp_eq_u32 vcc, -1, v4
    s_cbranch_vccz .W_207
.A_206:
    s_mov_b64 exec, vcc
    buffer_load_dwordx4 v[24:27], v8, s[8:11], s29 offen offset:1024 sc1
    s_mov_b64 exec, -1
    s_waitcnt vmcnt(2)
    v_max3_u32 v4, v28, v29, v30
    v_max_u32 v4, v4, v31
    v_cmp_eq_u32 vcc, -1, v4
    s_cbranch_vccz .W_281
.A_282:
    s_mov_b64 exec, vcc
    buffer_load_dwordx4 v[28:31], v8, s[8:11], s29 offen offset:2048 sc1
    s_mov_b64 exec, -1
    s_waitcnt vmcnt(2)
    v_max3_u32 v4, v32, v33, v34
    v_max_u32 v4, v4, v35
    v_cmp_eq_u32 vcc, -1, v4
    s_cbranch_vccnz .A_280
.W_283:
    v_smfmac_f32_16x16x64_bf16 v[52:55], v[32:35], a[24:31], v9
    v_smfmac_f32_16x16x64_bf16 v[56:59], v[32:35], a[56:63], v9
    s_waitcnt vmcnt(1)
    v_max3_u32 v4, v24, v25, v26
    v_max_u32 v4, v4, v27
    v_smfmac_f32_16x16x64_bf16 v[60:63], v[32:35], a[88:95], v9
    v_cmp_eq_u32 vcc, -1, v4
    v_smfmac_f32_16x16x64_bf16 v[64:67], v[32:35], a[120:127], v9
    s_cbranch_vccz .W_247
    s_branch .A_246
.W_281:
    v_smfmac_f32_16x16x64_bf16 v[52:55], v[28:31], a[16:23], v9
    v_smfmac_f32_16x16x64_bf16 v[56:59], v[28:31], a[48:55], v9
    s_waitcnt vmcnt(1)
    v_max3_u32 v4, v32, v33, v34
    v_max_u32 v4, v4, v35
    v_smfmac_f32_16x16x64_bf16 v[60:63], v[28:31], a[80:87], v9
    v_cmp_eq_u32 vcc, -1, v4
    v_smfmac_f32_16x16x64_bf16 v[64:67], v[28:31], a[112:119], v9
    s_cbranch_vccnz .A_284
.W_285:
    v_smfmac_f32_16x16x64_bf16 v[52:55], v[32:35], a[24:31], v9
    v_smfmac_f32_16x16x64_bf16 v[56:59], v[32:35], a[56:63], v9
    s_waitcnt vmcnt(0)
    v_max3_u32 v4, v24, v25, v26
    v_max_u32 v4, v4, v27
    v_smfmac_f32_16x16x64_bf16 v[60:63], v[32:35], a[88:95], v9
    v_cmp_eq_u32 vcc, -1, v4
    v_smfmac_f32_16x16x64_bf16 v[64:67], v[32:35], a[120:127], v9
    s_cbranch_vccz .W_261
    s_branch .A_260
.A_286:
    s_mov_b64 exec, vcc
    buffer_load_dwordx4 v[24:27], v8, s[8:11], s29 offen offset:1024 sc1
    s_mov_b64 exec, -1
    s_sub_u32 s62, s62, 1
    s_cbranch_scc1 .mg_end_1
    s_waitcnt vmcnt(1)
    v_max3_u32 v4, v20, v21, v22
    v_max_u32 v4, v4, v23
    v_cmp_eq_u32 vcc, -1, v4
    s_cbranch_vccz .W_259
.A_258:
    s_mov_b64 exec, vcc
    buffer_load_dwordx4 v[20:23], v8, s[8:11], s29 offen offset:0 sc1
    s_mov_b64 exec, -1
    s_waitcnt vmcnt(1)
    v_max3_u32 v4, v24, v25, v26
    v_max_u32 v4, v4, v27
    v_cmp_eq_u32 vcc, -1, v4
    s_cbranch_vccnz .A_286
.W_287:
    v_smfmac_f32_16x16x64_bf16 v[52:55], v[24:27], a[8:15], v9
    v_smfmac_f32_16x16x64_bf16 v[56:59], v[24:27], a[40:47], v9
    s_waitcnt vmcnt(0)
    v_max3_u32 v4, v20, v21, v22
    v_max_u32 v4, v4, v23
    v_smfmac_f32_16x16x64_bf16 v[60:63], v[24:27], a[72:79], v9
    v_cmp_eq_u32 vcc, -1, v4
    v_smfmac_f32_16x16x64_bf16 v[64:67], v[24:27], a[104:111], v9
    s_cbranch_vccz .W_255
    s_branch .A_254
.A_266:
    s_mov_b64 exec, vcc
    buffer_load_dwordx4 v[28:31], v8, s[8:11], s29 offen offset:2048 sc1
    s_mov_b64 exec, -1
    s_sub_u32 s62, s62, 1
    s_cbranch_scc1 .mg_end_1
    s_waitcnt vmcnt(1)
    v_max3_u32 v4, v20, v21, v22
    v_max_u32 v4, v4, v23
    v_cmp_eq_u32 vcc, -1, v4
    s_cbranch_vccz .W_279
.A_278:
    s_mov_b64 exec, vcc
    buffer_load_dwordx4 v[20:23], v8, s[8:11], s29 offen offset:0 sc1
    s_mov_b64 exec, -1
    s_waitcnt vmcnt(1)
    v_max3_u32 v4, v28, v29, v30
    v_max_u32 v4, v4, v31
    v_cmp_eq_u32 vcc, -1, v4
    s_cbranch_vccnz .A_266
    s_branch .W_267
.A_288:
    s_mov_b64 exec, vcc
    buffer_load_dwordx4 v[20:23], v8, s[8:11], s29 offen offset:0 sc1
    s_mov_b64 exec, -1
    s_sub_u32 s62, s62, 1
    s_cbranch_scc1 .mg_end_1
    s_waitcnt vmcnt(1)
    v_max3_u32 v4, v32, v33, v34
    v_max_u32 v4, v4, v35
    v_cmp_eq_u32 vcc, -1, v4
    s_cbranch_vccz .W_253
.A_252:
    s_mov_b64 exec, vcc
    buffer_load_dwordx4 v[32:35], v8, s[8:11], s29 offen offset:3072 sc1
    s_mov_b64 exec, -1
    s_waitcnt vmcnt(1)
    v_max3_u32 v4, v20, v21, v22
    v_max_u32 v4, v4, v23
    v_cmp_eq_u32 vcc, -1, v4
    s_cbranch_vccnz .A_288
.W_289:
    v_smfmac_f32_16x16x64_bf16 v[52:55], v[20:23], a[0:7], v9
    v_smfmac_f32_16x16x64_bf16 v[56:59], v[20:23], a[32:39], v9
    s_waitcnt vmcnt(0)
    v_max3_u32 v4, v32, v33, v34
    v_max_u32 v4, v4, v35
    v_smfmac_f32_16x16x64_bf16 v[60:63], v[20:23], a[64:71], v9
    v_cmp_eq_u32 vcc, -1, v4
    v_smfmac_f32_16x16x64_bf16 v[64:67], v[20:23], a[96:103], v9
    s_cbranch_vccz .W_211
    s_branch .A_210
.A_290:
    s_mov_b64 exec, vcc
    buffer_load_dwordx4 v[28:31], v8, s[8:11], s29 offen offset:2048 sc1
    s_mov_b64 exec, -1
    s_sub_u32 s62, s62, 1
    s_cbranch_scc1 .mg_end_1
    s_waitcnt vmcnt(1)
    v_max3_u32 v4, v24, v25, v26
    v_max_u32 v4, v4, v27
    v_cmp_eq_u32 vcc, -1, v4
    s_cbranch_vccz .W_247
.A_246:
    s_mov_b64 exec, vcc
    buffer_load_dwordx4 v[24:27], v8, s[8:11], s29 offen offset:1024 sc1
    s_mov_b64 exec, -1
    s_waitcnt vmcnt(1)
    v_max3_u32 v4, v28, v29, v30
    v_max_u32 v4, v4, v31
    v_cmp_eq_u32 vcc, -1, v4
    s_cbranch_vccnz .A_290
.W_291:
    v_smfmac_f32_16x16x64_bf16 v[52:55], v[28:31], a[16:23], v9
    v_smfmac_f32_16x16x64_bf16 v[56:59], v[28:31], a[48:55], v9
    s_waitcnt vmcnt(0)
    v_max3_u32 v4, v24, v25, v26
    v_max_u32 v4, v4, v27
    v_smfmac_f32_16x16x64_bf16 v[60:63], v[28:31], a[80:87], v9
    v_cmp_eq_u32 vcc, -1, v4
    v_smfmac_f32_16x16x64_bf16 v[64:67], v[28:31], a[112:119], v9
    s_cbranch_vccz .W_261
    s_branch .A_260
.A_284:
    s_mov_b64 exec, vcc
    buffer_load_dwordx4 v[32:35], v8, s[8:11], s29 offen offset:3072 sc1
    s_mov_b64 exec, -1
    s_sub_u32 s62, s62, 1
    s_cbranch_scc1 .mg_end_1
    s_waitcnt vmcnt(1)
    v_max3_u32 v4, v24, v25, v26
    v_max_u32 v4, v4, v27
    v_cmp_eq_u32 vcc, -1, v4
    s_cbranch_vccz .W_273
.A_272:
    s_mov_b64 exec, vcc
    buffer_load_dwordx4 v[24:27], v8, s[8:11], s29 offen offset:1024 sc1
    s_mov_b64 exec, -1
    s_waitcnt vmcnt(1)
    v_max3_u32 v4, v32, v33, v34
    v_max_u32 v4, v4, v35
    v_cmp_eq_u32 vcc, -1, v4
    s_cbranch_vccnz .A_284
    s_branch .W_285
.A_292:
    s_mov_b64 exec, vcc
    buffer_load_dwordx4 v[32:35], v8, s[8:11], s29 offen offset:3072 sc1
    s_mov_b64 exec, -1
    s_sub_u32 s62, s62, 1
    s_cbranch_scc1 .mg_end_1
    s_waitcnt vmcnt(1)
    v_max3_u32 v4, v28, v29, v30
    v_max_u32 v4, v4, v31
    v_cmp_eq_u32 vcc, -1, v4
    s_cbranch_vccz .W_209
.A_208:
    s_mov_b64 exec, vcc
    buffer_load_dwordx4 v[28:31], v8, s[8:11], s29 offen offset:2048 sc1
    s_mov_b64 exec, -1
    s_waitcnt vmcnt(1)
    v_max3_u32 v4, v32, v33, v34
    v_max_u32 v4, v4, v35
    v_cmp_eq_u32 vcc, -1, v4
    s_cbranch_vccnz .A_292
.W_293:
    v_smfmac_f32_16x16x64_bf16 v[52:55], v[32:35], a[24:31], v9
    v_smfmac_f32_16x16x64_bf16 v[56:59], v[32:35], a[56:63], v9
    s_waitcnt vmcnt(0)
    v_max3_u32 v4, v28, v29, v30
    v_max_u32 v4, v4, v31
    v_smfmac_f32_16x16x64_bf16 v[60:63], v[32:35], a[88:95], v9
    v_cmp_eq_u32 vcc, -1, v4
    v_smfmac_f32_16x16x64_bf16 v[64:67], v[32:35], a[120:127], v9
    s_cbranch_vccz .W_249
    s_branch .A_248
.A_254:
    s_mov_b64 exec, vcc
    buffer_load_dwordx4 v[20:23], v8, s[8:11], s29 offen offset:0 sc1
    s_mov_b64 exec, -1
    s_sub_u32 s62, s62, 1
    s_cbranch_scc1 .mg_end_1
    s_waitcnt vmcnt(1)
    v_max3_u32 v4, v20, v21, v22
    v_max_u32 v4, v4, v23
    v_cmp_eq_u32 vcc, -1, v4
    s_cbranch_vccnz .A_254
    v_smfmac_f32_16x16x64_bf16 v[52:55], v[20:23], a[0:7], v9
    v_smfmac_f32_16x16x64_bf16 v[56:59], v[20:23], a[32:39], v9
    v_smfmac_f32_16x16x64_bf16 v[60:63], v[20:23], a[64:71], v9
    v_smfmac_f32_16x16x64_bf16 v[64:67], v[20:23], a[96:103], v9
    s_branch .mj_203
.A_260:
    s_mov_b64 exec, vcc
    buffer_load_dwordx4 v[24:27], v8, s[8:11], s29 offen offset:1024 sc1
    s_mov_b64 exec, -1
    s_sub_u32 s62, s62, 1
    s_cbranch_scc1 .mg_end_1
    s_waitcnt vmcnt(1)
    v_max3_u32 v4, v24, v25, v26
    v_max_u32 v4, v4, v27
    v_cmp_eq_u32 vcc, -1, v4
    s_cbranch_vccnz .A_260
    v_smfmac_f32_16x16x64_bf16 v[52:55], v[24:27], a[8:15], v9
    v_smfmac_f32_16x16x64_bf16 v[56:59], v[24:27], a[40:47], v9
    v_smfmac_f32_16x16x64_bf16 v[60:63], v[24:27], a[72:79], v9
    v_smfmac_f32_16x16x64_bf16 v[64:67], v[24:27], a[104:111], v9
    s_branch .mj_203
.A_248:
    s_mov_b64 exec, vcc
    buffer_load_dwordx4 v[28:31], v8, s[8:11], s29 offen offset:2048 sc1
    s_mov_b64 exec, -1
    s_sub_u32 s62, s62, 1
    s_cbranch_scc1 .mg_end_1
    s_waitcnt vmcnt(1)
    v_max3_u32 v4, v28, v29, v30
    v_max_u32 v4, v4, v31
    v_cmp_eq_u32 vcc, -1, v4
    s_cbranch_vccnz .A_248
    v_smfmac_f32_16x16x64_bf16 v[52:55], v[28:31], a[16:23], v9
    v_smfmac_f32_16x16x64_bf16 v[56:59], v[28:31], a[48:55], v9
    v_smfmac_f32_16x16x64_bf16 v[60:63], v[28:31], a[80:87], v9
    v_smfmac_f32_16x16x64_bf16 v[64:67], v[28:31], a[112:119], v9
    s_branch .mj_203
.A_210:
    s_mov_b64 exec, vcc
    buffer_load_dwordx4 v[32:35], v8, s[8:11], s29 offen offset:3072 sc1
    s_mov_b64 exec, -1
    s_sub_u32 s62, s62, 1
    s_cbranch_scc1 .mg_end_1
    s_waitcnt vmcnt(1)
    v_max3_u32 v4, v32, v33, v34
    v_max_u32 v4, v4, v35
    v_cmp_eq_u32 vcc, -1, v4
    s_cbranch_vccnz .A_210
    v_smfmac_f32_16x16x64_bf16 v[52:55], v[32:35], a[24:31], v9
    v_smfmac_f32_16x16x64_bf16 v[56:59], v[32:35], a[56:63], v9
    v_smfmac_f32_16x16x64_bf16 v[60:63], v[32:35], a[88:95], v9
    v_smfmac_f32_16x16x64_bf16 v[64:67], v[32:35], a[120:127], v9
    s_branch .mj_203
.A_294:
    buffer_load_dwordx4 v[100:103], v234, s[8:11], s29 offen sc1
    s_sub_u32 s62, s62, 1
    s_cbranch_scc1 .mg_end_1
    s_waitcnt vmcnt(2)
    v_max3_u32 v4, v92, v93, v94
    v_max_u32 v4, v4, v95
    v_cmp_eq_u32 vcc, -1, v4
    s_cbranch_vccz .W_214
.A_213:
    buffer_load_dwordx4 v[92:95], v232, s[8:11], s29 offen sc1
    s_waitcnt vmcnt(2)
    v_max3_u32 v4, v96, v97, v98
    v_max_u32 v4, v4, v99
    v_cmp_eq_u32 vcc, -1, v4
    s_cbranch_vccz .W_295
.A_296:
    buffer_load_dwordx4 v[96:99], v233, s[8:11], s29 offen sc1
    s_waitcnt vmcnt(2)
    v_max3_u32 v4, v100, v101, v102
    v_max_u32 v4, v4, v103
    v_cmp_eq_u32 vcc, -1, v4
    s_cbranch_vccnz .A_294
.W_297:
    v_mfma_f32_16x16x32_bf16 v[208:211], v[140:143], v[100:103], v[208:211]
    s_waitcnt vmcnt(1)
    v_max3_u32 v4, v92, v93, v94
    v_max_u32 v4, v4, v95
    v_mfma_f32_16x16x32_bf16 v[212:215], v[156:159], v[100:103], v[212:215]
    v_cmp_eq_u32 vcc, -1, v4
    v_mfma_f32_16x16x32_bf16 v[216:219], v[100:103], v[100:103], v[216:219]
    s_cbranch_vccnz .A_298
.W_299:
    v_mfma_f32_16x16x32_bf16 v[208:211], v[132:135], v[92:95], v[208:211]
    s_waitcnt vmcnt(0)
    v_max3_u32 v4, v96, v97, v98
    v_max_u32 v4, v4, v99
    v_mfma_f32_16x16x32_bf16 v[212:215], v[148:151], v[92:95], v[212:215]
    v_cmp_eq_u32 vcc, -1, v4
    v_mfma_f32_16x16x32_bf16 v[216:219], v[92:95], v[92:95], v[216:219]
    s_cbranch_vccnz .A_300
.W_301:
    v_mfma_f32_16x16x32_bf16 v[208:211], v[136:139], v[96:99], v[208:211]
    v_mfma_f32_16x16x32_bf16 v[212:215], v[152:155], v[96:99], v[212:215]
    v_mfma_f32_16x16x32_bf16 v[216:219], v[96:99], v[96:99], v[216:219]
    s_branch .mj_212
.W_295:
    v_mfma_f32_16x16x32_bf16 v[208:211], v[136:139], v[96:99], v[208:211]
    s_waitcnt vmcnt(1)
    v_max3_u32 v4, v100, v101, v102
    v_max_u32 v4, v4, v103
    v_mfma_f32_16x16x32_bf16 v[212:215], v[152:155], v[96:99], v[212:215]
    v_cmp_eq_u32 vcc, -1, v4
    v_mfma_f32_16x16x32_bf16 v[216:219], v[96:99], v[96:99], v[216:219]
    s_cbranch_vccnz .A_302
.W_303:
    v_mfma_f32_16x16x32_bf16 v[208:211], v[140:143], v[100:103], v[208:211]
    s_waitcnt vmcnt(0)
    v_max3_u32 v4, v92, v93, v94
    v_max_u32 v4, v4, v95
    v_mfma_f32_16x16x32_bf16 v[212:215], v[156:159], v[100:103], v[212:215]
    v_cmp_eq_u32 vcc, -1, v4
    v_mfma_f32_16x16x32_bf16 v[216:219], v[100:103], v[100:103], v[216:219]
    s_cbranch_vccnz .A_304
.W_305:
    v_mfma_f32_16x16x32_bf16 v[208:211], v[132:135], v[92:95], v[208:211]
    v_mfma_f32_16x16x32_bf16 v[212:215], v[148:151], v[92:95], v[212:215]
    v_mfma_f32_16x16x32_bf16 v[216:219], v[92:95], v[92:95], v[216:219]
    s_branch .mj_212
.A_306:
    buffer_load_dwordx4 v[96:99], v233, s[8:11], s29 offen sc1
    s_sub_u32 s62, s62, 1
    s_cbranch_scc1 .mg_end_1
    s_waitcnt vmcnt(1)
    v_max3_u32 v4, v92, v93, v94
    v_max_u32 v4, v4, v95
    v_cmp_eq_u32 vcc, -1, v4
    s_cbranch_vccz .W_299
.A_298:
    buffer_load_dwordx4 v[92:95], v232, s[8:11], s29 offen sc1
    s_waitcnt vmcnt(1)
    v_max3_u32 v4, v96, v97, v98
    v_max_u32 v4, v4, v99
    v_cmp_eq_u32 vcc, -1, v4
    s_cbranch_vccnz .A_306
.W_307:
    v_mfma_f32_16x16x32_bf16 v[208:211], v[136:139], v[96:99], v[208:211]
    s_waitcnt vmcnt(0)
    v_max3_u32 v4, v92, v93, v94
    v_max_u32 v4, v4, v95
    v_mfma_f32_16x16x32_bf16 v[212:215], v[152:155], v[96:99], v[212:215]
    v_cmp_eq_u32 vcc, -1, v4
    v_mfma_f32_16x16x32_bf16 v[216:219], v[96:99], v[96:99], v[216:219]
    s_cbranch_vccz .W_305
    s_branch .A_304
.A_308:
    buffer_load_dwordx4 v[92:95], v232, s[8:11], s29 offen sc1
    s_sub_u32 s62, s62, 1
    s_cbranch_scc1 .mg_end_1
    s_waitcnt vmcnt(1)
    v_max3_u32 v4, v100, v101, v102
    v_max_u32 v4, v4, v103
    v_cmp_eq_u32 vcc, -1, v4
    s_cbranch_vccz .W_303
.A_302:
    buffer_load_dwordx4 v[100:103], v234, s[8:11], s29 offen sc1
    s_waitcnt vmcnt(1)
    v_max3_u32 v4, v92, v93, v94
    v_max_u32 v4, v4, v95
    v_cmp_eq_u32 vcc, -1, v4
    s_cbranch_vccnz .A_308
.W_309:
    v_mfma_f32_16x16x32_bf16 v[208:211], v[132:135], v[92:95], v[208:211]
    s_waitcnt vmcnt(0)
    v_max3_u32 v4, v100, v101, v102
    v_max_u32 v4, v4, v103
    v_mfma_f32_16x16x32_bf16 v[212:215], v[148:151], v[92:95], v[212:215]
    v_cmp_eq_u32 vcc, -1, v4
    v_mfma_f32_16x16x32_bf16 v[216:219], v[92:95], v[92:95], v[216:219]
    s_cbranch_vccz .W_218
    s_branch .A_217
.A_310:
    buffer_load_dwordx4 v[100:103], v234, s[8:11], s29 offen sc1
    s_sub_u32 s62, s62, 1
    s_cbranch_scc1 .mg_end_1
    s_waitcnt vmcnt(1)
    v_max3_u32 v4, v96, v97, v98
    v_max_u32 v4, v4, v99
    v_cmp_eq_u32 vcc, -1, v4
    s_cbranch_vccz .W_216
.A_215:
    buffer_load_dwordx4 v[96:99], v233, s[8:11], s29 offen sc1
    s_waitcnt vmcnt(1)
    v_max3_u32 v4, v100, v101, v102
    v_max_u32 v4, v4, v103
    v_cmp_eq_u32 vcc, -1, v4
    s_cbranch_vccnz .A_310
.W_311:
    v_mfma_f32_16x16x32_bf16 v[208:211], v[140:143], v[100:103], v[208:211]
    s_waitcnt vmcnt(0)
    v_max3_u32 v4, v96, v97, v98
    v_max_u32 v4, v4, v99
    v_mfma_f32_16x16x32_bf16 v[212:215], v[156:159], v[100:103], v[212:215]
    v_cmp_eq_u32 vcc, -1, v4
    v_mfma_f32_16x16x32_bf16 v[216:219], v[100:103], v[100:103], v[216:219]
    s_cbranch_vccz .W_301
    s_branch .A_300
.A_304:
    buffer_load_dwordx4 v[92:95], v232, s[8:11], s29 offen sc1
    s_sub_u32 s62, s62, 1
    s_cbranch_scc1 .mg_end_1
    s_waitcnt vmcnt(1)
    v_max3_u32 v4, v92, v93, v94
    v_max_u32 v4, v4, v95
    v_cmp_eq_u32 vcc, -1, v4
    s_cbranch_vccnz .A_304
    v_mfma_f32_16x16x32_bf16 v[208:211], v[132:135], v[92:95], v[208:211]
    v_mfma_f32_16x16x32_bf16 v[212:215], v[148:151], v[92:95], v[212:215]
    v_mfma_f32_16x16x32_bf16 v[216:219], v[92:95], v[92:95], v[216:219]
    s_branch .mj_212
.A_300:
    buffer_load_dwordx4 v[96:99], v233, s[8:11], s29 offen sc1
    s_sub_u32 s62, s62, 1
    s_cbranch_scc1 .mg_end_1
    s_waitcnt vmcnt(1)
    v_max3_u32 v4, v96, v97, v98
    v_max_u32 v4, v4, v99
    v_cmp_eq_u32 vcc, -1, v4
    s_cbranch_vccnz .A_300
    v_mfma_f32_16x16x32_bf16 v[208:211], v[136:139], v[96:99], v[208:211]
    v_mfma_f32_16x16x32_bf16 v[212:215], v[152:155], v[96:99], v[212:215]
    v_mfma_f32_16x16x32_bf16 v[216:219], v[96:99], v[96:99], v[216:219]
    s_branch .mj_212
.A_217:
    buffer_load_dwordx4 v[100:103], v234, s[8:11], s29 offen sc1
    s_sub_u32 s62, s62, 1
    s_cbranch_scc1 .mg_end_1
    s_waitcnt vmcnt(1)
    v_max3_u32 v4, v100, v101, v102
    v_max_u32 v4, v4, v103
    v_cmp_eq_u32 vcc, -1, v4
    s_cbranch_vccnz .A_217
    v_mfma_f32_16x16x32_bf16 v[208:211], v[140:143], v[100:103], v[208:211]
    v_mfma_f32_16x16x32_bf16 v[212:215], v[156:159], v[100:103], v[212:215]
    v_mfma_f32_16x16x32_bf16 v[216:219], v[100:103], v[100:103], v[216:219]
    s_branch .mj_212
.kf_225:
    s_mov_b32 s62, 0
    s_mov_b64 exec, 3
.wf_312:
    buffer_load_dword v244, v253, s[8:11], s89 offen sc1
    s_waitcnt vmcnt(0)
    v_cmp_gt_u32 vcc, s6, v244
    s_cbranch_vccz .wfd_313
    s_sleep 2
    s_add_u32 s62, s62, 1
    s_cmp_gt_u32 s62, 0x400000
    s_cbranch_scc1 .mg_end_1
    s_branch .wf_312

.wfd_313:
    s_mov_b64 exec, -1
    v_readlane_b32 s4, v244, 0
    v_readlane_b32 s93, v244, 1
    s_min_u32 s93, s93, s4
    s_mov_b32 s62, 0x1000000
    s_branch .kb_226
.A_314:
    buffer_load_dwordx4 v[216:219], v246, s[8:11], s32 offen offset:0 sc1
    buffer_load_dwordx4 v[220:223], v246, s[8:11], s32 offen offset:1024 sc1
    s_sub_u32 s62, s62, 1
    s_cbranch_scc1 .mg_end_1
    s_waitcnt vmcnt(6)
    v_max3_u32 v4, v192, v193, v194
    v_max3_u32 v5, v195, v196, v197
    v_max3_u32 v4, v4, v198, v199
    v_max_u32 v4, v4, v5
    v_cmp_eq_u32 vcc, -1, v4
    s_cbranch_vccz .W_229
.A_228:
    buffer_load_dwordx4 v[192:195], v243, s[8:11], s32 offen offset:0 sc1
    buffer_load_dwordx4 v[196:199], v243, s[8:11], s32 offen offset:1024 sc1
    s_waitcnt vmcnt(6)
    v_max3_u32 v4, v200, v201, v202
    v_max3_u32 v5, v203, v204, v205
    v_max3_u32 v4, v4, v206, v207
    v_max_u32 v4, v4, v5
    v_cmp_eq_u32 vcc, -1, v4
    s_cbranch_vccz .W_315
.A_316:
    buffer_load_dwordx4 v[200:203], v252, s[8:11], s32 offen offset:0 sc1
    buffer_load_dwordx4 v[204:207], v252, s[8:11], s32 offen offset:1024 sc1
    s_waitcnt vmcnt(6)
    v_max3_u32 v4, v208, v209, v210
    v_max3_u32 v5, v211, v212, v213
    v_max3_u32 v4, v4, v214, v215
    v_max_u32 v4, v4, v5
    v_cmp_eq_u32 vcc, -1, v4
    s_cbranch_vccz .W_317
.A_318:
    buffer_load_dwordx4 v[208:211], v254, s[8:11], s32 offen offset:0 sc1
    buffer_load_dwordx4 v[212:215], v254, s[8:11], s32 offen offset:1024 sc1
    s_waitcnt vmcnt(6)
    v_max3_u32 v4, v216, v217, v218
    v_max3_u32 v5, v219, v220, v221
    v_max3_u32 v4, v4, v222, v223
    v_max_u32 v4, v4, v5
    v_cmp_eq_u32 vcc, -1, v4
    s_cbranch_vccnz .A_314
.W_319:
    v_smfmac_f32_16x16x64_bf16 v[76:79], v[216:219], v[140:147], v9
    v_smfmac_f32_16x16x64_bf16 v[80:83], v[216:219], v[172:179], v9
    s_waitcnt vmcnt(4)
    v_max3_u32 v4, v192, v193, v194
    v_max3_u32 v5, v195, v196, v197
    v_max3_u32 v4, v4, v198, v199
    v_smfmac_f32_16x16x64_bf16 v[76:79], v[220:223], v[148:155], v9
    v_max_u32 v4, v4, v5
    v_cmp_eq_u32 vcc, -1, v4
    v_smfmac_f32_16x16x64_bf16 v[80:83], v[220:223], v[180:187], v9
    s_cbranch_vccnz .A_320
.W_321:
    v_smfmac_f32_16x16x64_bf16 v[76:79], v[192:195], a[192:199], v9
    v_smfmac_f32_16x16x64_bf16 v[80:83], v[192:195], a[224:231], v9
    s_waitcnt vmcnt(2)
    v_max3_u32 v4, v200, v201, v202
    v_max3_u32 v5, v203, v204, v205
    v_max3_u32 v4, v4, v206, v207
    v_smfmac_f32_16x16x64_bf16 v[76:79], v[196:199], a[200:207], v9
    v_max_u32 v4, v4, v5
    v_cmp_eq_u32 vcc, -1, v4
    v_smfmac_f32_16x16x64_bf16 v[80:83], v[196:199], a[232:239], v9
    s_cbranch_vccnz .A_322
.W_323:
    v_smfmac_f32_16x16x64_bf16 v[76:79], v[200:203], a[208:215], v9
    v_smfmac_f32_16x16x64_bf16 v[80:83], v[200:203], a[240:247], v9
    s_waitcnt vmcnt(0)
    v_max3_u32 v4, v208, v209, v210
    v_max3_u32 v5, v211, v212, v213
    v_max3_u32 v4, v4, v214, v215
    v_smfmac_f32_16x16x64_bf16 v[76:79], v[204:207], a[216:223], v9
    v_max_u32 v4, v4, v5
    v_cmp_eq_u32 vcc, -1, v4
    v_smfmac_f32_16x16x64_bf16 v[80:83], v[204:207], a[248:255], v9
    s_cbranch_vccnz .A_324
.W_325:
    v_smfmac_f32_16x16x64_bf16 v[76:79], v[208:211], v[124:131], v9
    v_smfmac_f32_16x16x64_bf16 v[80:83], v[208:211], v[156:163], v9
    v_smfmac_f32_16x16x64_bf16 v[76:79], v[212:215], v[132:139], v9
    v_smfmac_f32_16x16x64_bf16 v[80:83], v[212:215], v[164:171], v9
    s_branch .mj_227
.W_315:
    v_smfmac_f32_16x16x64_bf16 v[76:79], v[200:203], a[208:215], v9
    v_smfmac_f32_16x16x64_bf16 v[80:83], v[200:203], a[240:247], v9
    s_waitcnt vmcnt(4)
    v_max3_u32 v4, v208, v209, v210
    v_max3_u32 v5, v211, v212, v213
    v_max3_u32 v4, v4, v214, v215
    v_smfmac_f32_16x16x64_bf16 v[76:79], v[204:207], a[216:223], v9
    v_max_u32 v4, v4, v5
    v_cmp_eq_u32 vcc, -1, v4
    v_smfmac_f32_16x16x64_bf16 v[80:83], v[204:207], a[248:255], v9
    s_cbranch_vccnz .A_326
.W_327:
    v_smfmac_f32_16x16x64_bf16 v[76:79], v[208:211], v[124:131], v9
    v_smfmac_f32_16x16x64_bf16 v[80:83], v[208:211], v[156:163], v9
    s_waitcnt vmcnt(2)
    v_max3_u32 v4, v216, v217, v218
    v_max3_u32 v5, v219, v220, v221
    v_max3_u32 v4, v4, v222, v223
    v_smfmac_f32_16x16x64_bf16 v[76:79], v[212:215], v[132:139], v9
    v_max_u32 v4, v4, v5
    v_cmp_eq_u32 vcc, -1, v4
    v_smfmac_f32_16x16x64_bf16 v[80:83], v[212:215], v[164:171], v9
    s_cbranch_vccnz .A_328
.W_329:
    v_smfmac_f32_16x16x64_bf16 v[76:79], v[216:219], v[140:147], v9
    v_smfmac_f32_16x16x64_bf16 v[80:83], v[216:219], v[172:179], v9
    s_waitcnt vmcnt(0)
    v_max3_u32 v4, v192, v193, v194
    v_max3_u32 v5, v195, v196, v197
    v_max3_u32 v4, v4, v198, v199
    v_smfmac_f32_16x16x64_bf16 v[76:79], v[220:223], v[148:155], v9
    v_max_u32 v4, v4, v5
    v_cmp_eq_u32 vcc, -1, v4
    v_smfmac_f32_16x16x64_bf16 v[80:83], v[220:223], v[180:187], v9
    s_cbranch_vccnz .A_330
.W_331:
    v_smfmac_f32_16x16x64_bf16 v[76:79], v[192:195], a[192:199], v9
    v_smfmac_f32_16x16x64_bf16 v[80:83], v[192:195], a[224:231], v9
    v_smfmac_f32_16x16x64_bf16 v[76:79], v[196:199], a[200:207], v9
    v_smfmac_f32_16x16x64_bf16 v[80:83], v[196:199], a[232:239], v9
    s_branch .mj_227
.W_317:
    v_smfmac_f32_16x16x64_bf16 v[76:79], v[208:211], v[124:131], v9
    v_smfmac_f32_16x16x64_bf16 v[80:83], v[208:211], v[156:163], v9
    s_waitcnt vmcnt(4)
    v_max3_u32 v4, v216, v217, v218
    v_max3_u32 v5, v219, v220, v221
    v_max3_u32 v4, v4, v222, v223
    v_smfmac_f32_16x16x64_bf16 v[76:79], v[212:215], v[132:139], v9
    v_max_u32 v4, v4, v5
    v_cmp_eq_u32 vcc, -1, v4
    v_smfmac_f32_16x16x64_bf16 v[80:83], v[212:215], v[164:171], v9
    s_cbranch_vccnz .A_332
.W_333:
    v_smfmac_f32_16x16x64_bf16 v[76:79], v[216:219], v[140:147], v9
    v_smfmac_f32_16x16x64_bf16 v[80:83], v[216:219], v[172:179], v9
    s_waitcnt vmcnt(2)
    v_max3_u32 v4, v192, v193, v194
    v_max3_u32 v5, v195, v196, v197
    v_max3_u32 v4, v4, v198, v199
    v_smfmac_f32_16x16x64_bf16 v[76:79], v[220:223], v[148:155], v9
    v_max_u32 v4, v4, v5
    v_cmp_eq_u32 vcc, -1, v4
    v_smfmac_f32_16x16x64_bf16 v[80:83], v[220:223], v[180:187], v9
    s_cbranch_vccnz .A_334
.W_335:
    v_smfmac_f32_16x16x64_bf16 v[76:79], v[192:195], a[192:199], v9
    v_smfmac_f32_16x16x64_bf16 v[80:83], v[192:195], a[224:231], v9
    s_waitcnt vmcnt(0)
    v_max3_u32 v4, v200, v201, v202
    v_max3_u32 v5, v203, v204, v205
    v_max3_u32 v4, v4, v206, v207
    v_smfmac_f32_16x16x64_bf16 v[76:79], v[196:199], a[200:207], v9
    v_max_u32 v4, v4, v5
    v_cmp_eq_u32 vcc, -1, v4
    v_smfmac_f32_16x16x64_bf16 v[80:83], v[196:199], a[232:239], v9
    s_cbranch_vccnz .A_336
.W_337:
    v_smfmac_f32_16x16x64_bf16 v[76:79], v[200:203], a[208:215], v9
    v_smfmac_f32_16x16x64_bf16 v[80:83], v[200:203], a[240:247], v9
    v_smfmac_f32_16x16x64_bf16 v[76:79], v[204:207], a[216:223], v9
    v_smfmac_f32_16x16x64_bf16 v[80:83], v[204:207], a[248:255], v9
    s_branch .mj_227
.A_338:
    buffer_load_dwordx4 v[208:211], v254, s[8:11], s32 offen offset:0 sc1
    buffer_load_dwordx4 v[212:215], v254, s[8:11], s32 offen offset:1024 sc1
    s_sub_u32 s62, s62, 1
    s_cbranch_scc1 .mg_end_1
    s_waitcnt vmcnt(4)
    v_max3_u32 v4, v192, v193, v194
    v_max3_u32 v5, v195, v196, v197
    v_max3_u32 v4, v4, v198, v199
    v_max_u32 v4, v4, v5
    v_cmp_eq_u32 vcc, -1, v4
    s_cbranch_vccz .W_321
.A_320:
    buffer_load_dwordx4 v[192:195], v243, s[8:11], s32 offen offset:0 sc1
    buffer_load_dwordx4 v[196:199], v243, s[8:11], s32 offen offset:1024 sc1
    s_waitcnt vmcnt(4)
    v_max3_u32 v4, v200, v201, v202
    v_max3_u32 v5, v203, v204, v205
    v_max3_u32 v4, v4, v206, v207
    v_max_u32 v4, v4, v5
    v_cmp_eq_u32 vcc, -1, v4
    s_cbranch_vccz .W_339
.A_340:
    buffer_load_dwordx4 v[200:203], v252, s[8:11], s32 offen offset:0 sc1
    buffer_load_dwordx4 v[204:207], v252, s[8:11], s32 offen offset:1024 sc1
    s_waitcnt vmcnt(4)
    v_max3_u32 v4, v208, v209, v210
    v_max3_u32 v5, v211, v212, v213
    v_max3_u32 v4, v4, v214, v215
    v_max_u32 v4, v4, v5
    v_cmp_eq_u32 vcc, -1, v4
    s_cbranch_vccnz .A_338
.W_341:
    v_smfmac_f32_16x16x64_bf16 v[76:79], v[208:211], v[124:131], v9
    v_smfmac_f32_16x16x64_bf16 v[80:83], v[208:211], v[156:163], v9
    s_waitcnt vmcnt(2)
    v_max3_u32 v4, v192, v193, v194
    v_max3_u32 v5, v195, v196, v197
    v_max3_u32 v4, v4, v198, v199
    v_smfmac_f32_16x16x64_bf16 v[76:79], v[212:215], v[132:139], v9
    v_max_u32 v4, v4, v5
    v_cmp_eq_u32 vcc, -1, v4
    v_smfmac_f32_16x16x64_bf16 v[80:83], v[212:215], v[164:171], v9
    s_cbranch_vccz .W_335
    s_branch .A_334
.W_339:
    v_smfmac_f32_16x16x64_bf16 v[76:79], v[200:203], a[208:215], v9
    v_smfmac_f32_16x16x64_bf16 v[80:83], v[200:203], a[240:247], v9
    s_waitcnt vmcnt(2)
    v_max3_u32 v4, v208, v209, v210
    v_max3_u32 v5, v211, v212, v213
    v_max3_u32 v4, v4, v214, v215
    v_smfmac_f32_16x16x64_bf16 v[76:79], v[204:207], a[216:223], v9
    v_max_u32 v4, v4, v5
    v_cmp_eq_u32 vcc, -1, v4
    v_smfmac_f32_16x16x64_bf16 v[80:83], v[204:207], a[248:255], v9
    s_cbranch_vccnz .A_342
.W_343:
    v_smfmac_f32_16x16x64_bf16 v[76:79], v[208:211], v[124:131], v9
    v_smfmac_f32_16x16x64_bf16 v[80:83], v[208:211], v[156:163], v9
    s_waitcnt vmcnt(0)
    v_max3_u32 v4, v192, v193, v194
    v_max3_u32 v5, v195, v196, v197
    v_max3_u32 v4, v4, v198, v199
    v_smfmac_f32_16x16x64_bf16 v[76:79], v[212:215], v[132:139], v9
    v_max_u32 v4, v4, v5
    v_cmp_eq_u32 vcc, -1, v4
    v_smfmac_f32_16x16x64_bf16 v[80:83], v[212:215], v[164:171], v9
    s_cbranch_vccz .W_331
    s_branch .A_330
.A_344:
    buffer_load_dwordx4 v[200:203], v252, s[8:11], s32 offen offset:0 sc1
    buffer_load_dwordx4 v[204:207], v252, s[8:11], s32 offen offset:1024 sc1
    s_sub_u32 s62, s62, 1
    s_cbranch_scc1 .mg_end_1
    s_waitcnt vmcnt(4)
    v_max3_u32 v4, v216, v217, v218
    v_max3_u32 v5, v219, v220, v221
    v_max3_u32 v4, v4, v222, v223
    v_max_u32 v4, v4, v5
    v_cmp_eq_u32 vcc, -1, v4
    s_cbranch_vccz .W_333
.A_332:
    buffer_load_dwordx4 v[216:219], v246, s[8:11], s32 offen offset:0 sc1
    buffer_load_dwordx4 v[220:223], v246, s[8:11], s32 offen offset:1024 sc1
    s_waitcnt vmcnt(4)
    v_max3_u32 v4, v192, v193, v194
    v_max3_u32 v5, v195, v196, v197
    v_max3_u32 v4, v4, v198, v199
    v_max_u32 v4, v4, v5
    v_cmp_eq_u32 vcc, -1, v4
    s_cbranch_vccz .W_345
.A_346:
    buffer_load_dwordx4 v[192:195], v243, s[8:11], s32 offen offset:0 sc1
    buffer_load_dwordx4 v[196:199], v243, s[8:11], s32 offen offset:1024 sc1
    s_waitcnt vmcnt(4)
    v_max3_u32 v4, v200, v201, v202
    v_max3_u32 v5, v203, v204, v205
    v_max3_u32 v4, v4, v206, v207
    v_max_u32 v4, v4, v5
    v_cmp_eq_u32 vcc, -1, v4
    s_cbranch_vccnz .A_344
.W_347:
    v_smfmac_f32_16x16x64_bf16 v[76:79], v[200:203], a[208:215], v9
    v_smfmac_f32_16x16x64_bf16 v[80:83], v[200:203], a[240:247], v9
    s_waitcnt vmcnt(2)
    v_max3_u32 v4, v216, v217, v218
    v_max3_u32 v5, v219, v220, v221
    v_max3_u32 v4, v4, v222, v223
    v_smfmac_f32_16x16x64_bf16 v[76:79], v[204:207], a[216:223], v9
    v_max_u32 v4, v4, v5
    v_cmp_eq_u32 vcc, -1, v4
    v_smfmac_f32_16x16x64_bf16 v[80:83], v[204:207], a[248:255], v9
    s_cbranch_vccz .W_329
    s_branch .A_328
.W_345:
    v_smfmac_f32_16x16x64_bf16 v[76:79], v[192:195], a[192:199], v9
    v_smfmac_f32_16x16x64_bf16 v[80:83], v[192:195], a[224:231], v9
    s_waitcnt vmcnt(2)
    v_max3_u32 v4, v200, v201, v202
    v_max3_u32 v5, v203, v204, v205
    v_max3_u32 v4, v4, v206, v207
    v_smfmac_f32_16x16x64_bf16 v[76:79], v[196:199], a[200:207], v9
    v_max_u32 v4, v4, v5
    v_cmp_eq_u32 vcc, -1, v4
    v_smfmac_f32_16x16x64_bf16 v[80:83], v[196:199], a[232:239], v9
    s_cbranch_vccnz .A_348
.W_349:
    v_smfmac_f32_16x16x64_bf16 v[76:79], v[200:203], a[208:215], v9
    v_smfmac_f32_16x16x64_bf16 v[80:83], v[200:203], a[240:247], v9
    s_waitcnt vmcnt(0)
    v_max3_u32 v4, v216, v217, v218
    v_max3_u32 v5, v219, v220, v221
    v_max3_u32 v4, v4, v222, v223
    v_smfmac_f32_16x16x64_bf16 v[76:79], v[204:207], a[216:223], v9
    v_max_u32 v4, v4, v5
    v_cmp_eq_u32 vcc, -1, v4
    v_smfmac_f32_16x16x64_bf16 v[80:83], v[204:207], a[248:255], v9
    s_cbranch_vccz .W_235
    s_branch .A_234
.A_350:
    buffer_load_dwordx4 v[216:219], v246, s[8:11], s32 offen offset:0 sc1
    buffer_load_dwordx4 v[220:223], v246, s[8:11], s32 offen offset:1024 sc1
    s_sub_u32 s62, s62, 1
    s_cbranch_scc1 .mg_end_1
    s_waitcnt vmcnt(4)
    v_max3_u32 v4, v192, v193, v194
    v_max3_u32 v5, v195, v196, v197
    v_max3_u32 v4, v4, v198, v199
    v_max_u32 v4, v4, v5
    v_cmp_eq_u32 vcc, -1, v4
    s_cbranch_vccz .W_351
.A_352:
    buffer_load_dwordx4 v[192:195], v243, s[8:11], s32 offen offset:0 sc1
    buffer_load_dwordx4 v[196:199], v243, s[8:11], s32 offen offset:1024 sc1
    s_waitcnt vmcnt(4)
    v_max3_u32 v4, v208, v209, v210
    v_max3_u32 v5, v211, v212, v213
    v_max3_u32 v4, v4, v214, v215
    v_max_u32 v4, v4, v5
    v_cmp_eq_u32 vcc, -1, v4
    s_cbranch_vccz .W_327
.A_326:
    buffer_load_dwordx4 v[208:211], v254, s[8:11], s32 offen offset:0 sc1
    buffer_load_dwordx4 v[212:215], v254, s[8:11], s32 offen offset:1024 sc1
    s_waitcnt vmcnt(4)
    v_max3_u32 v4, v216, v217, v218
    v_max3_u32 v5, v219, v220, v221
    v_max3_u32 v4, v4, v222, v223
    v_max_u32 v4, v4, v5
    v_cmp_eq_u32 vcc, -1, v4
    s_cbranch_vccnz .A_350
.W_353:
    v_smfmac_f32_16x16x64_bf16 v[76:79], v[216:219], v[140:147], v9
    v_smfmac_f32_16x16x64_bf16 v[80:83], v[216:219], v[172:179], v9
    s_waitcnt vmcnt(2)
    v_max3_u32 v4, v192, v193, v194
    v_max3_u32 v5, v195, v196, v197
    v_max3_u32 v4, v4, v198, v199
    v_smfmac_f32_16x16x64_bf16 v[76:79], v[220:223], v[148:155], v9
    v_max_u32 v4, v4, v5
    v_cmp_eq_u32 vcc, -1, v4
    v_smfmac_f32_16x16x64_bf16 v[80:83], v[220:223], v[180:187], v9
    s_cbranch_vccnz .A_354
.W_355:
    v_smfmac_f32_16x16x64_bf16 v[76:79], v[192:195], a[192:199], v9
    v_smfmac_f32_16x16x64_bf16 v[80:83], v[192:195], a[224:231], v9
    s_waitcnt vmcnt(0)
    v_max3_u32 v4, v208, v209, v210
    v_max3_u32 v5, v211, v212, v213
    v_max3_u32 v4, v4, v214, v215
    v_smfmac_f32_16x16x64_bf16 v[76:79], v[196:199], a[200:207], v9
    v_max_u32 v4, v4, v5
    v_cmp_eq_u32 vcc, -1, v4
    v_smfmac_f32_16x16x64_bf16 v[80:83], v[196:199], a[232:239], v9
    s_cbranch_vccz .W_325
    s_branch .A_324
.W_351:
    v_smfmac_f32_16x16x64_bf16 v[76:79], v[192:195], a[192:199], v9
    v_smfmac_f32_16x16x64_bf16 v[80:83], v[192:195], a[224:231], v9
    s_waitcnt vmcnt(2)
    v_max3_u32 v4, v208, v209, v210
    v_max3_u32 v5, v211, v212, v213
    v_max3_u32 v4, v4, v214, v215
    v_smfmac_f32_16x16x64_bf16 v[76:79], v[196:199], a[200:207], v9
    v_max_u32 v4, v4, v5
    v_cmp_eq_u32 vcc, -1, v4
    v_smfmac_f32_16x16x64_bf16 v[80:83], v[196:199], a[232:239], v9
    s_cbranch_vccz .W_233
    s_branch .A_232
.A_356:
    buffer_load_dwordx4 v[216:219], v246, s[8:11], s32 offen offset:0 sc1
    buffer_load_dwordx4 v[220:223], v246, s[8:11], s32 offen offset:1024 sc1
    s_sub_u32 s62, s62, 1
    s_cbranch_scc1 .mg_end_1
    s_waitcnt vmcnt(4)
    v_max3_u32 v4, v200, v201, v202
    v_max3_u32 v5, v203, v204, v205
    v_max3_u32 v4, v4, v206, v207
    v_max_u32 v4, v4, v5
    v_cmp_eq_u32 vcc, -1, v4
    s_cbranch_vccz .W_231
.A_230:
    buffer_load_dwordx4 v[200:203], v252, s[8:11], s32 offen offset:0 sc1
    buffer_load_dwordx4 v[204:207], v252, s[8:11], s32 offen offset:1024 sc1
    s_waitcnt vmcnt(4)
    v_max3_u32 v4, v208, v209, v210
    v_max3_u32 v5, v211, v212, v213
    v_max3_u32 v4, v4, v214, v215
    v_max_u32 v4, v4, v5
    v_cmp_eq_u32 vcc, -1, v4
    s_cbranch_vccz .W_357
.A_358:
    buffer_load_dwordx4 v[208:211], v254, s[8:11], s32 offen offset:0 sc1
    buffer_load_dwordx4 v[212:215], v254, s[8:11], s32 offen offset:1024 sc1
    s_waitcnt vmcnt(4)
    v_max3_u32 v4, v216, v217, v218
    v_max3_u32 v5, v219, v220, v221
    v_max3_u32 v4, v4, v222, v223
    v_max_u32 v4, v4, v5
    v_cmp_eq_u32 vcc, -1, v4
    s_cbranch_vccnz .A_356
.W_359:
    v_smfmac_f32_16x16x64_bf16 v[76:79], v[216:219], v[140:147], v9
    v_smfmac_f32_16x16x64_bf16 v[80:83], v[216:219], v[172:179], v9
    s_waitcnt vmcnt(2)
    v_max3_u32 v4, v200, v201, v202
    v_max3_u32 v5, v203, v204, v205
    v_max3_u32 v4, v4, v206, v207
    v_smfmac_f32_16x16x64_bf16 v[76:79], v[220:223], v[148:155], v9
    v_max_u32 v4, v4, v5
    v_cmp_eq_u32 vcc, -1, v4
    v_smfmac_f32_16x16x64_bf16 v[80:83], v[220:223], v[180:187], v9
    s_cbranch_vccz .W_323
    s_branch .A_322
.W_357:
    v_smfmac_f32_16x16x64_bf16 v[76:79], v[208:211], v[124:131], v9
    v_smfmac_f32_16x16x64_bf16 v[80:83], v[208:211], v[156:163], v9
    s_waitcnt vmcnt(2)
    v_max3_u32 v4, v216, v217, v218
    v_max3_u32 v5, v219, v220, v221
    v_max3_u32 v4, v4, v222, v223
    v_smfmac_f32_16x16x64_bf16 v[76:79], v[212:215], v[132:139], v9
    v_max_u32 v4, v4, v5
    v_cmp_eq_u32 vcc, -1, v4
    v_smfmac_f32_16x16x64_bf16 v[80:83], v[212:215], v[164:171], v9
    s_cbranch_vccnz .A_360
.W_361:
    v_smfmac_f32_16x16x64_bf16 v[76:79], v[216:219], v[140:147], v9
    v_smfmac_f32_16x16x64_bf16 v[80:83], v[216:219], v[172:179], v9
    s_waitcnt vmcnt(0)
    v_max3_u32 v4, v200, v201, v202
    v_max3_u32 v5, v203, v204, v205
    v_max3_u32 v4, v4, v206, v207
    v_smfmac_f32_16x16x64_bf16 v[76:79], v[220:223], v[148:155], v9
    v_max_u32 v4, v4, v5
    v_cmp_eq_u32 vcc, -1, v4
    v_smfmac_f32_16x16x64_bf16 v[80:83], v[220:223], v[180:187], v9
    s_cbranch_vccz .W_337
    s_branch .A_336
.A_362:
    buffer_load_dwordx4 v[200:203], v252, s[8:11], s32 offen offset:0 sc1
    buffer_load_dwordx4 v[204:207], v252, s[8:11], s32 offen offset:1024 sc1
    s_sub_u32 s62, s62, 1
    s_cbranch_scc1 .mg_end_1
    s_waitcnt vmcnt(2)
    v_max3_u32 v4, v192, v193, v194
    v_max3_u32 v5, v195, v196, v197
    v_max3_u32 v4, v4, v198, v199
    v_max_u32 v4, v4, v5
    v_cmp_eq_u32 vcc, -1, v4
    s_cbranch_vccz .W_335
.A_334:
    buffer_load_dwordx4 v[192:195], v243, s[8:11], s32 offen offset:0 sc1
    buffer_load_dwordx4 v[196:199], v243, s[8:11], s32 offen offset:1024 sc1
    s_waitcnt vmcnt(2)
    v_max3_u32 v4, v200, v201, v202
    v_max3_u32 v5, v203, v204, v205
    v_max3_u32 v4, v4, v206, v207
    v_max_u32 v4, v4, v5
    v_cmp_eq_u32 vcc, -1, v4
    s_cbranch_vccnz .A_362
.W_363:
    v_smfmac_f32_16x16x64_bf16 v[76:79], v[200:203], a[208:215], v9
    v_smfmac_f32_16x16x64_bf16 v[80:83], v[200:203], a[240:247], v9
    s_waitcnt vmcnt(0)
    v_max3_u32 v4, v192, v193, v194
    v_max3_u32 v5, v195, v196, v197
    v_max3_u32 v4, v4, v198, v199
    v_smfmac_f32_16x16x64_bf16 v[76:79], v[204:207], a[216:223], v9
    v_max_u32 v4, v4, v5
    v_cmp_eq_u32 vcc, -1, v4
    v_smfmac_f32_16x16x64_bf16 v[80:83], v[204:207], a[248:255], v9
    s_cbranch_vccz .W_331
    s_branch .A_330
.A_342:
    buffer_load_dwordx4 v[208:211], v254, s[8:11], s32 offen offset:0 sc1
    buffer_load_dwordx4 v[212:215], v254, s[8:11], s32 offen offset:1024 sc1
    s_sub_u32 s62, s62, 1
    s_cbranch_scc1 .mg_end_1
    s_waitcnt vmcnt(2)
    v_max3_u32 v4, v192, v193, v194
    v_max3_u32 v5, v195, v196, v197
    v_max3_u32 v4, v4, v198, v199
    v_max_u32 v4, v4, v5
    v_cmp_eq_u32 vcc, -1, v4
    s_cbranch_vccz .W_355
.A_354:
    buffer_load_dwordx4 v[192:195], v243, s[8:11], s32 offen offset:0 sc1
    buffer_load_dwordx4 v[196:199], v243, s[8:11], s32 offen offset:1024 sc1
    s_waitcnt vmcnt(2)
    v_max3_u32 v4, v208, v209, v210
    v_max3_u32 v5, v211, v212, v213
    v_max3_u32 v4, v4, v214, v215
    v_max_u32 v4, v4, v5
    v_cmp_eq_u32 vcc, -1, v4
    s_cbranch_vccnz .A_342
    s_branch .W_343
.A_364:
    buffer_load_dwordx4 v[192:195], v243, s[8:11], s32 offen offset:0 sc1
    buffer_load_dwordx4 v[196:199], v243, s[8:11], s32 offen offset:1024 sc1
    s_sub_u32 s62, s62, 1
    s_cbranch_scc1 .mg_end_1
    s_waitcnt vmcnt(2)
    v_max3_u32 v4, v216, v217, v218
    v_max3_u32 v5, v219, v220, v221
    v_max3_u32 v4, v4, v222, v223
    v_max_u32 v4, v4, v5
    v_cmp_eq_u32 vcc, -1, v4
    s_cbranch_vccz .W_329
.A_328:
    buffer_load_dwordx4 v[216:219], v246, s[8:11], s32 offen offset:0 sc1
    buffer_load_dwordx4 v[220:223], v246, s[8:11], s32 offen offset:1024 sc1
    s_waitcnt vmcnt(2)
    v_max3_u32 v4, v192, v193, v194
    v_max3_u32 v5, v195, v196, v197
    v_max3_u32 v4, v4, v198, v199
    v_max_u32 v4, v4, v5
    v_cmp_eq_u32 vcc, -1, v4
    s_cbranch_vccnz .A_364
.W_365:
    v_smfmac_f32_16x16x64_bf16 v[76:79], v[192:195], a[192:199], v9
    v_smfmac_f32_16x16x64_bf16 v[80:83], v[192:195], a[224:231], v9
    s_waitcnt vmcnt(0)
    v_max3_u32 v4, v216, v217, v218
    v_max3_u32 v5, v219, v220, v221
    v_max3_u32 v4, v4, v222, v223
    v_smfmac_f32_16x16x64_bf16 v[76:79], v[196:199], a[200:207], v9
    v_max_u32 v4, v4, v5
    v_cmp_eq_u32 vcc, -1, v4
    v_smfmac_f32_16x16x64_bf16 v[80:83], v[196:199], a[232:239], v9
    s_cbranch_vccz .W_235
    s_branch .A_234
.A_366:
    buffer_load_dwordx4 v[208:211], v254, s[8:11], s32 offen offset:0 sc1
    buffer_load_dwordx4 v[212:215], v254, s[8:11], s32 offen offset:1024 sc1
    s_sub_u32 s62, s62, 1
    s_cbranch_scc1 .mg_end_1
    s_waitcnt vmcnt(2)
    v_max3_u32 v4, v200, v201, v202
    v_max3_u32 v5, v203, v204, v205
    v_max3_u32 v4, v4, v206, v207
    v_max_u32 v4, v4, v5
    v_cmp_eq_u32 vcc, -1, v4
    s_cbranch_vccz .W_323
.A_322:
    buffer_load_dwordx4 v[200:203], v252, s[8:11], s32 offen offset:0 sc1
    buffer_load_dwordx4 v[204:207], v252, s[8:11], s32 offen offset:1024 sc1
    s_waitcnt vmcnt(2)
    v_max3_u32 v4, v208, v209, v210
    v_max3_u32 v5, v211, v212, v213
    v_max3_u32 v4, v4, v214, v215
    v_max_u32 v4, v4, v5
    v_cmp_eq_u32 vcc, -1, v4
    s_cbranch_vccnz .A_366
.W_367:
    v_smfmac_f32_16x16x64_bf16 v[76:79], v[208:211], v[124:131], v9
    v_smfmac_f32_16x16x64_bf16 v[80:83], v[208:211], v[156:163], v9
    s_waitcnt vmcnt(0)
    v_max3_u32 v4, v200, v201, v202
    v_max3_u32 v5, v203, v204, v205
    v_max3_u32 v4, v4, v206, v207
    v_smfmac_f32_16x16x64_bf16 v[76:79], v[212:215], v[132:139], v9
    v_max_u32 v4, v4, v5
    v_cmp_eq_u32 vcc, -1, v4
    v_smfmac_f32_16x16x64_bf16 v[80:83], v[212:215], v[164:171], v9
    s_cbranch_vccz .W_337
    s_branch .A_336
.A_360:
    buffer_load_dwordx4 v[216:219], v246, s[8:11], s32 offen offset:0 sc1
    buffer_load_dwordx4 v[220:223], v246, s[8:11], s32 offen offset:1024 sc1
    s_sub_u32 s62, s62, 1
    s_cbranch_scc1 .mg_end_1
    s_waitcnt vmcnt(2)
    v_max3_u32 v4, v200, v201, v202
    v_max3_u32 v5, v203, v204, v205
    v_max3_u32 v4, v4, v206, v207
    v_max_u32 v4, v4, v5
    v_cmp_eq_u32 vcc, -1, v4
    s_cbranch_vccz .W_349
.A_348:
    buffer_load_dwordx4 v[200:203], v252, s[8:11], s32 offen offset:0 sc1
    buffer_load_dwordx4 v[204:207], v252, s[8:11], s32 offen offset:1024 sc1
    s_waitcnt vmcnt(2)
    v_max3_u32 v4, v216, v217, v218
    v_max3_u32 v5, v219, v220, v221
    v_max3_u32 v4, v4, v222, v223
    v_max_u32 v4, v4, v5
    v_cmp_eq_u32 vcc, -1, v4
    s_cbranch_vccnz .A_360
    s_branch .W_361
.A_368:
    buffer_load_dwordx4 v[216:219], v246, s[8:11], s32 offen offset:0 sc1
    buffer_load_dwordx4 v[220:223], v246, s[8:11], s32 offen offset:1024 sc1
    s_sub_u32 s62, s62, 1
    s_cbranch_scc1 .mg_end_1
    s_waitcnt vmcnt(2)
    v_max3_u32 v4, v208, v209, v210
    v_max3_u32 v5, v211, v212, v213
    v_max3_u32 v4, v4, v214, v215
    v_max_u32 v4, v4, v5
    v_cmp_eq_u32 vcc, -1, v4
    s_cbranch_vccz .W_233
.A_232:
    buffer_load_dwordx4 v[208:211], v254, s[8:11], s32 offen offset:0 sc1
    buffer_load_dwordx4 v[212:215], v254, s[8:11], s32 offen offset:1024 sc1
    s_waitcnt vmcnt(2)
    v_max3_u32 v4, v216, v217, v218
    v_max3_u32 v5, v219, v220, v221
    v_max3_u32 v4, v4, v222, v223
    v_max_u32 v4, v4, v5
    v_cmp_eq_u32 vcc, -1, v4
    s_cbranch_vccnz .A_368
.W_369:
    v_smfmac_f32_16x16x64_bf16 v[76:79], v[216:219], v[140:147], v9
    v_smfmac_f32_16x16x64_bf16 v[80:83], v[216:219], v[172:179], v9
    s_waitcnt vmcnt(0)
    v_max3_u32 v4, v208, v209, v210
    v_max3_u32 v5, v211, v212, v213
    v_max3_u32 v4, v4, v214, v215
    v_smfmac_f32_16x16x64_bf16 v[76:79], v[220:223], v[148:155], v9
    v_max_u32 v4, v4, v5
    v_cmp_eq_u32 vcc, -1, v4
    v_smfmac_f32_16x16x64_bf16 v[80:83], v[220:223], v[180:187], v9
    s_cbranch_vccz .W_325
    s_branch .A_324
.A_330:
    buffer_load_dwordx4 v[192:195], v243, s[8:11], s32 offen offset:0 sc1
    buffer_load_dwordx4 v[196:199], v243, s[8:11], s32 offen offset:1024 sc1
    s_sub_u32 s62, s62, 1
    s_cbranch_scc1 .mg_end_1
    s_waitcnt vmcnt(2)
    v_max3_u32 v4, v192, v193, v194
    v_max3_u32 v5, v195, v196, v197
    v_max3_u32 v4, v4, v198, v199
    v_max_u32 v4, v4, v5
    v_cmp_eq_u32 vcc, -1, v4
    s_cbranch_vccnz .A_330
    v_smfmac_f32_16x16x64_bf16 v[76:79], v[192:195], a[192:199], v9
    v_smfmac_f32_16x16x64_bf16 v[80:83], v[192:195], a[224:231], v9
    v_smfmac_f32_16x16x64_bf16 v[76:79], v[196:199], a[200:207], v9
    v_smfmac_f32_16x16x64_bf16 v[80:83], v[196:199], a[232:239], v9
    s_branch .mj_227
.A_336:
    buffer_load_dwordx4 v[200:203], v252, s[8:11], s32 offen offset:0 sc1
    buffer_load_dwordx4 v[204:207], v252, s[8:11], s32 offen offset:1024 sc1
    s_sub_u32 s62, s62, 1
    s_cbranch_scc1 .mg_end_1
    s_waitcnt vmcnt(2)
    v_max3_u32 v4, v200, v201, v202
    v_max3_u32 v5, v203, v204, v205
    v_max3_u32 v4, v4, v206, v207
    v_max_u32 v4, v4, v5
    v_cmp_eq_u32 vcc, -1, v4
    s_cbranch_vccnz .A_336
    v_smfmac_f32_16x16x64_bf16 v[76:79], v[200:203], a[208:215], v9
    v_smfmac_f32_16x16x64_bf16 v[80:83], v[200:203], a[240:247], v9
    v_smfmac_f32_16x16x64_bf16 v[76:79], v[204:207], a[216:223], v9
    v_smfmac_f32_16x16x64_bf16 v[80:83], v[204:207], a[248:255], v9
    s_branch .mj_227
.A_324:
    buffer_load_dwordx4 v[208:211], v254, s[8:11], s32 offen offset:0 sc1
    buffer_load_dwordx4 v[212:215], v254, s[8:11], s32 offen offset:1024 sc1
    s_sub_u32 s62, s62, 1
    s_cbranch_scc1 .mg_end_1
    s_waitcnt vmcnt(2)
    v_max3_u32 v4, v208, v209, v210
    v_max3_u32 v5, v211, v212, v213
    v_max3_u32 v4, v4, v214, v215
    v_max_u32 v4, v4, v5
    v_cmp_eq_u32 vcc, -1, v4
    s_cbranch_vccnz .A_324
    v_smfmac_f32_16x16x64_bf16 v[76:79], v[208:211], v[124:131], v9
    v_smfmac_f32_16x16x64_bf16 v[80:83], v[208:211], v[156:163], v9
    v_smfmac_f32_16x16x64_bf16 v[76:79], v[212:215], v[132:139], v9
    v_smfmac_f32_16x16x64_bf16 v[80:83], v[212:215], v[164:171], v9
    s_branch .mj_227
.A_234:
    buffer_load_dwordx4 v[216:219], v246, s[8:11], s32 offen offset:0 sc1
    buffer_load_dwordx4 v[220:223], v246, s[8:11], s32 offen offset:1024 sc1
    s_sub_u32 s62, s62, 1
    s_cbranch_scc1 .mg_end_1
    s_waitcnt vmcnt(2)
    v_max3_u32 v4, v216, v217, v218
    v_max3_u32 v5, v219, v220, v221
    v_max3_u32 v4, v4, v222, v223
    v_max_u32 v4, v4, v5
    v_cmp_eq_u32 vcc, -1, v4
    s_cbranch_vccnz .A_234
    v_smfmac_f32_16x16x64_bf16 v[76:79], v[216:219], v[140:147], v9
    v_smfmac_f32_16x16x64_bf16 v[80:83], v[216:219], v[172:179], v9
    v_smfmac_f32_16x16x64_bf16 v[76:79], v[220:223], v[148:155], v9
    v_smfmac_f32_16x16x64_bf16 v[80:83], v[220:223], v[180:187], v9
    s_branch .mj_227
.sk_237:
    s_mov_b64 exec, s[66:67]
    buffer_store_dwordx4 v[88:91], v11, s[8:11], s36 offen sc1
    s_mov_b64 exec, s[56:57]
    buffer_store_dwordx4 v[172:175], v12, s[8:11], s36 offen sc1
    s_mov_b64 exec, -1

    s_branch .rec_fin_6
.rec_fin_6:
    s_mov_b64 exec, -1
    s_endpgm
.mg_bg_2:
    s_sub_u32 s91, s25, 4
    s_lshl_b32 s90, s91, 5
    s_add_u32 s90, s90, s26
    s_cmp_ge_u32 s26, 24
    s_cbranch_scc1 .cvrole_370
    s_lshr_b32 s30, s26, 3
    s_sub_u32 s30, 2, s30
    s_and_b32 s31, s26, 7
    s_lshl_b32 s4, s91, 3
    s_add_u32 s31, s31, s4

    s_lshl_b32 s4, s30, 5
    s_add_u32 s4, s4, s31
    s_lshl_b32 s4, s4, 8
    s_add_u32 s4, s4, 92274688
    v_mov_b32 v4, 0
    s_mov_b64 exec, 1
    buffer_store_dword v4, v4, s[8:11], s4 offen sc1
    s_mov_b64 exec, -1

    s_load_dwordx2 s[40:41], s[0:1], 0
    s_load_dwordx4 s[44:47], s[0:1], 64
    s_load_dwordx2 s[42:43], s[0:1], 80

    v_and_b32 v1, 63, v0
    v_and_b32 v2, 15, v1
    v_lshrrev_b32 v3, 4, v1

    s_lshl_b32 s28, s31, 8
    s_waitcnt lgkmcnt(0)
    s_mov_b64 s[48:49], s[42:43]
    s_cmp_eq_u32 s30, 0
    s_cselect_b64 s[42:43], s[44:45], s[42:43]
    s_cmp_eq_u32 s30, 1
    s_cselect_b64 s[42:43], s[46:47], s[42:43]

    s_mov_b32 s16, s40
    s_and_b32 s17, s41, 0xffff
    s_mov_b32 s18, 0x400000
    s_mov_b32 s19, 0x00020000

    s_mov_b32 s12, s42
    s_and_b32 s13, s43, 0xffff
    s_mov_b32 s14, 0x800000
    s_mov_b32 s15, 0x00020000

    v_lshrrev_b32 v4, 1, v2
    v_xor_b32 v4, v4, v3
    v_lshlrev_b32 v4, 1, v4
    v_and_b32 v5, 1, v1
    v_or_b32 v4, v4, v5
    v_lshlrev_b32 v4, 4, v4
    v_lshlrev_b32 v5, 13, v3
    v_add_u32 v10, v4, v5
    v_xor_b32 v11, 0x80, v10
    s_lshl_b32 s4, s24, 18
    s_add_u32 s28, s28, s4
    s_lshl_b32 s29, s24, 13
    v_lshrrev_b32 v4, 2, v2
    v_and_b32 v5, 1, v3
    v_lshl_or_b32 v5, v5, 2, v4
    s_lshl_b32 s4, s24, 1
    v_xor_b32 v5, s4, v5
    v_lshlrev_b32 v5, 5, v5
    v_lshl_add_u32 v4, v3, 3, v4
    v_lshl_add_u32 v5, v4, 8, v5
    v_and_b32 v4, 3, v2
    v_lshl_add_u32 v12, v4, 3, v5
    v_xor_b32 v13, 32, v12
    v_add_u32 v14, 0x10000, v12
    v_add_u32 v15, 0x10000, v13

    s_mov_b32 s63, 0
    s_cmp_lg_u32 s30, 0
    s_cbranch_scc1 .qh_371
    s_cmp_lt_u32 s24, 2
    s_cselect_b64 s[48:49], s[46:47], s[48:49]

    s_mov_b32 s64, s48
    s_and_b32 s65, s49, 0xffff
    s_mov_b32 s66, 0x800000
    s_mov_b32 s67, 0x00020000

    v_lshlrev_b32 v4, 13, v1
    s_and_b32 s4, s24, 1
    s_lshl_b32 s4, s4, 7
    s_lshl_b32 s5, s31, 8
    s_add_u32 s4, s4, s5
    s_add_u32 s4, s4, 3145728
    s_waitcnt vmcnt(0)

    v_mov_b32 v243, s99
    v_mov_b32 v242, 0
    s_cmp_lg_u32 s24, 0
    s_cbranch_scc1 .a1_372
    v_mov_b32 v242, s26
    v_lshlrev_b32 v242, 6, v242
    v_add_u32 v242, s97, v242
    v_and_b32 v242, 255, v242
    s_mov_b64 exec, 1
    buffer_atomic_add v243, v242, s[20:23], 0 offen sc1
    s_mov_b64 exec, -1

.a1_372:
    buffer_load_dword v31, v4, s[64:67], s4 offen
    s_add_u32 s4, s4, 524288
    buffer_load_dword v31, v4, s[64:67], s4 offen
    s_add_u32 s4, s4, 524288
    buffer_load_dword v31, v4, s[64:67], s4 offen
    s_add_u32 s4, s4, 524288
    buffer_load_dword v31, v4, s[64:67], s4 offen
    s_add_u32 s4, s4, 524288
    buffer_load_dword v31, v4, s[64:67], s4 offen
    s_add_u32 s4, s4, 524288
    buffer_load_dword v31, v4, s[64:67], s4 offen
    s_add_u32 s4, s4, 524288
    buffer_load_dword v31, v4, s[64:67], s4 offen
    s_add_u32 s4, s4, 524288
    buffer_load_dword v31, v4, s[64:67], s4 offen
    s_add_u32 s4, s4, 524288
    buffer_load_dword v31, v4, s[64:67], s4 offen
    s_add_u32 s4, s4, 524288
    buffer_load_dword v31, v4, s[64:67], s4 offen
    s_add_u32 s4, s4, 524288
    s_waitcnt vmcnt(0)
    s_mov_b32 s63, 99
.qh_371:
    s_and_b32 s4, s26, 7
    s_lshl_b32 s4, s4, 1
    s_lshr_b32 s5, s24, 1
    s_add_u32 s4, s4, s5
    s_lshl_b32 s4, s4, 6
    v_add_u32 v4, s4, v1
    v_lshlrev_b32 v4, 13, v4
    s_and_b32 s4, s24, 1
    s_lshl_b32 s4, s4, 10
    s_lshl_b32 s5, s91, 11
    s_add_u32 s4, s4, s5
    buffer_load_dword v31, v4, s[12:15], s4 offen offset:384

    s_add_u32 m0, s29, 98304
    s_add_u32 s4, s28, 0
    buffer_load_dwordx4 v10, s[12:15], s4 offen lds

    s_add_u32 m0, s29, 99328
    s_add_u32 s4, s28, 32768
    buffer_load_dwordx4 v10, s[12:15], s4 offen lds

    s_add_u32 m0, s29, 100352
    s_add_u32 s4, s28, 65536
    buffer_load_dwordx4 v11, s[12:15], s4 offen lds

    s_add_u32 m0, s29, 101376
    s_add_u32 s4, s28, 98304
    buffer_load_dwordx4 v11, s[12:15], s4 offen lds

    s_add_u32 m0, s29, 102400
    s_add_u32 s4, s28, 131072
    buffer_load_dwordx4 v10, s[12:15], s4 offen lds

    s_add_u32 m0, s29, 103424
    s_add_u32 s4, s28, 163840
    buffer_load_dwordx4 v10, s[12:15], s4 offen lds

    s_add_u32 m0, s29, 104448
    s_add_u32 s4, s28, 196608
    buffer_load_dwordx4 v11, s[12:15], s4 offen lds

    s_add_u32 m0, s29, 105472
    s_add_u32 s4, s28, 229376
    buffer_load_dwordx4 v11, s[12:15], s4 offen lds

    s_waitcnt vmcnt(9)
    v_mov_b32 v243, s99
    v_mov_b32 v242, 0
    s_cmp_lg_u32 s24, s63
    s_cbranch_scc1 .a1_374
    v_mov_b32 v242, s26
    v_lshlrev_b32 v242, 6, v242
    v_add_u32 v242, s97, v242
    v_and_b32 v242, 255, v242
    s_mov_b64 exec, 1
    buffer_atomic_add v243, v242, s[20:23], 0 offen sc1
    s_mov_b64 exec, -1

.a1_374:
    v_lshrrev_b32 v4, 3, v1
    v_and_b32 v5, 7, v1
    v_xor_b32 v5, v5, v4
    v_lshlrev_b32 v5, 4, v5
    v_lshl_add_u32 v16, v4, 11, v5
    s_lshl_b32 s4, s24, 14
    v_add_u32 v16, s4, v16
    v_and_b32 v4, 7, v2
    v_xor_b32 v5, v4, v3
    v_lshlrev_b32 v5, 4, v5
    v_lshl_add_u32 v5, v4, 7, v5
    v_lshrrev_b32 v4, 3, v2
    v_lshl_add_u32 v17, v4, 13, v5
    v_xor_b32 v18, 64, v17
    v_add_u32 v19, 0x10000, v17
    v_add_u32 v20, 0x10000, v18
    v_lshlrev_b32 v21, 4, v1
    s_lshl_b32 s32, s30, 24
    s_lshl_b32 s4, s31, 13
    s_add_u32 s32, s32, s4
    s_lshr_b32 s5, s30, 1
    s_add_u32 s5, s5, 10
    s_lshl_b32 s4, s24, s5
    s_add_u32 s39, s32, s4
    s_mov_b32 s32, s39
    s_add_u32 s38, s39, 4096
    s_mul_i32 s49, s31, 6144
    s_lshl_b32 s4, s30, 11
    s_add_u32 s49, s49, s4
    s_lshl_b32 s4, s24, 9
    s_add_u32 s49, s49, s4
    s_add_u32 s49, s49, 67108864
    s_mov_b32 s48, s49
    v_mov_b32 v23, -1
    s_lshl_b32 s4, s30, 5
    s_add_u32 s4, s4, s31
    s_lshl_b32 s4, s4, 8
    s_add_u32 s33, s4, 92274688
    s_cmp_eq_u32 s24, 0
    s_cselect_b32 s36, 1, 0
    s_mov_b32 s37, 0
    v_mov_b32 v22, 0
    s_mov_b32 s34, 0
    s_mov_b32 s35, 0
    s_and_b32 s4, s26, 7
    s_lshl_b32 s4, s4, 2
    s_add_u32 s4, s4, s24
    s_lshl_b32 s4, s4, 11
    v_lshlrev_b32 v111, 5, v1
    v_add_u32 v111, s4, v111

    s_mul_i32 s47, s26, 1441792
    s_lshl_b32 s4, s24, 10
    s_add_u32 s47, s47, s4
    s_add_u32 s47, s47, 184549376
    v_mov_b32 v24, -1
    v_mov_b32 v25, -1
    v_mov_b32 v26, -1
    v_mov_b32 v27, -1

    s_xor_b32 s4, s91, 1
    s_lshl_b32 s5, s4, 14
    s_lshl_b32 s6, s91, 12
    s_add_u32 s5, s5, s6
    v_add_u32 v28, s5, v21
    s_lshl_b32 s5, s91, 14
    s_lshl_b32 s6, s4, 12
    s_add_u32 s5, s5, s6
    v_add_u32 v7, s5, v21

    s_xor_b32 s4, s91, 2
    s_lshl_b32 s5, s4, 14
    s_lshl_b32 s6, s91, 12
    s_add_u32 s5, s5, s6
    v_add_u32 v29, s5, v21
    s_lshl_b32 s5, s91, 14
    s_lshl_b32 s6, s4, 12
    s_add_u32 s5, s5, s6
    v_add_u32 v8, s5, v21

    s_xor_b32 s4, s91, 3
    s_lshl_b32 s5, s4, 14
    s_lshl_b32 s6, s91, 12
    s_add_u32 s5, s5, s6
    v_add_u32 v30, s5, v21
    s_lshl_b32 s5, s91, 14
    s_lshl_b32 s6, s4, 12
    s_add_u32 s5, s5, s6
    v_add_u32 v9, s5, v21

    s_mov_b64 s[44:45], -1
    s_mov_b32 s46, s47
    s_add_u32 s39, s39, 262144
    s_add_u32 s49, s49, 196608
    v_mov_b32 v23, 0
    v_add_u32 v113, 0x20000, v17
    v_add_u32 v114, 0x20000, v18
    s_barrier

    s_add_u32 m0, s29, 131072
    s_nop 0
    buffer_load_dwordx4 v16, s[16:19], s34 offen offset:0 lds
    s_add_u32 m0, s29, 131968
    s_nop 0
    buffer_load_dwordx4 v16, s[16:19], s34 offen offset:128 lds
    s_add_u32 m0, s29, 132864
    s_nop 0
    buffer_load_dwordx4 v16, s[16:19], s34 offen offset:256 lds
    s_add_u32 m0, s29, 133760
    s_nop 0
    buffer_load_dwordx4 v16, s[16:19], s34 offen offset:384 lds
    s_add_u32 m0, s29, 134656
    s_nop 0
    buffer_load_dwordx4 v16, s[16:19], s34 offen offset:512 lds
    s_add_u32 m0, s29, 135552
    s_nop 0
    buffer_load_dwordx4 v16, s[16:19], s34 offen offset:640 lds
    s_add_u32 m0, s29, 136448
    s_nop 0
    buffer_load_dwordx4 v16, s[16:19], s34 offen offset:768 lds
    s_add_u32 m0, s29, 137344
    s_nop 0
    buffer_load_dwordx4 v16, s[16:19], s34 offen offset:896 lds
    s_add_u32 s34, s34, 1024
    s_add_u32 m0, s29, 0
    s_add_u32 s4, s28, 1048576
    buffer_load_dwordx4 v10, s[12:15], s4 offen lds

    s_add_u32 m0, s29, 1024
    s_add_u32 s4, s28, 1081344
    buffer_load_dwordx4 v10, s[12:15], s4 offen lds

    s_add_u32 m0, s29, 2048
    s_add_u32 s4, s28, 1114112
    buffer_load_dwordx4 v11, s[12:15], s4 offen lds

    s_add_u32 m0, s29, 3072
    s_add_u32 s4, s28, 1146880
    buffer_load_dwordx4 v11, s[12:15], s4 offen lds

    s_add_u32 m0, s29, 4096
    s_add_u32 s4, s28, 1179648
    buffer_load_dwordx4 v10, s[12:15], s4 offen lds

    s_add_u32 m0, s29, 5120
    s_add_u32 s4, s28, 1212416
    buffer_load_dwordx4 v10, s[12:15], s4 offen lds

    s_add_u32 m0, s29, 6144
    s_add_u32 s4, s28, 1245184
    buffer_load_dwordx4 v11, s[12:15], s4 offen lds

    s_add_u32 m0, s29, 7168
    s_add_u32 s4, s28, 1277952
    buffer_load_dwordx4 v11, s[12:15], s4 offen lds

    s_add_u32 m0, s29, 65536
    s_add_u32 s4, s28, 2097152
    buffer_load_dwordx4 v10, s[12:15], s4 offen lds

    s_add_u32 m0, s29, 66560
    s_add_u32 s4, s28, 2129920
    buffer_load_dwordx4 v10, s[12:15], s4 offen lds

    s_add_u32 m0, s29, 67584
    s_add_u32 s4, s28, 2162688
    buffer_load_dwordx4 v11, s[12:15], s4 offen lds

    s_add_u32 m0, s29, 68608
    s_add_u32 s4, s28, 2195456
    buffer_load_dwordx4 v11, s[12:15], s4 offen lds

    s_add_u32 m0, s29, 69632
    s_add_u32 s4, s28, 2228224
    buffer_load_dwordx4 v10, s[12:15], s4 offen lds

    s_add_u32 m0, s29, 70656
    s_add_u32 s4, s28, 2260992
    buffer_load_dwordx4 v10, s[12:15], s4 offen lds

    s_add_u32 m0, s29, 71680
    s_add_u32 s4, s28, 2293760
    buffer_load_dwordx4 v11, s[12:15], s4 offen lds

    s_add_u32 m0, s29, 72704
    s_add_u32 s4, s28, 2326528
    buffer_load_dwordx4 v11, s[12:15], s4 offen lds

    s_waitcnt vmcnt(16)
    s_barrier
    ds_read_b64_tr_b16 a[0:1], v14 offset:32768
    ds_read_b64_tr_b16 a[2:3], v14 offset:33792
    ds_read_b64_tr_b16 a[4:5], v15 offset:32768
    ds_read_b64_tr_b16 a[6:7], v15 offset:33792
    ds_read_b64_tr_b16 a[8:9], v14 offset:40960
    ds_read_b64_tr_b16 a[10:11], v14 offset:41984
    ds_read_b64_tr_b16 a[12:13], v15 offset:40960
    ds_read_b64_tr_b16 a[14:15], v15 offset:41984
    ds_read_b64_tr_b16 a[16:17], v14 offset:49152
    ds_read_b64_tr_b16 a[18:19], v14 offset:50176
    ds_read_b64_tr_b16 a[20:21], v15 offset:49152
    ds_read_b64_tr_b16 a[22:23], v15 offset:50176
    ds_read_b64_tr_b16 a[24:25], v14 offset:57344
    ds_read_b64_tr_b16 a[26:27], v14 offset:58368
    ds_read_b64_tr_b16 a[28:29], v15 offset:57344
    ds_read_b64_tr_b16 a[30:31], v15 offset:58368
    ds_read_b128 v[32:35], v113 offset:0
    ds_read_b128 v[36:39], v113 offset:16384
    ds_read_b128 v[40:43], v114 offset:0
    ds_read_b128 v[44:47], v114 offset:16384
    ds_read_b128 v[48:51], v113 offset:1024
    ds_read_b128 v[52:55], v113 offset:17408
    ds_read_b128 v[56:59], v114 offset:1024
    ds_read_b128 v[60:63], v114 offset:17408
    s_waitcnt lgkmcnt(0)
    s_barrier
    s_add_u32 m0, s29, 98304
    s_add_u32 s4, s28, 3145728
    buffer_load_dwordx4 v10, s[12:15], s4 offen lds

    s_add_u32 m0, s29, 99328
    s_add_u32 s4, s28, 3178496
    buffer_load_dwordx4 v10, s[12:15], s4 offen lds

    s_add_u32 m0, s29, 100352
    s_add_u32 s4, s28, 3211264
    buffer_load_dwordx4 v11, s[12:15], s4 offen lds

    s_add_u32 m0, s29, 101376
    s_add_u32 s4, s28, 3244032
    buffer_load_dwordx4 v11, s[12:15], s4 offen lds

    s_add_u32 m0, s29, 102400
    s_add_u32 s4, s28, 3276800
    buffer_load_dwordx4 v10, s[12:15], s4 offen lds

    s_add_u32 m0, s29, 103424
    s_add_u32 s4, s28, 3309568
    buffer_load_dwordx4 v10, s[12:15], s4 offen lds

    s_add_u32 m0, s29, 104448
    s_add_u32 s4, s28, 3342336
    buffer_load_dwordx4 v11, s[12:15], s4 offen lds

    s_add_u32 m0, s29, 105472
    s_add_u32 s4, s28, 3375104
    buffer_load_dwordx4 v11, s[12:15], s4 offen lds

    s_add_u32 m0, s29, 32768
    s_nop 0
    buffer_load_dwordx4 v16, s[16:19], s34 offen offset:0 lds
    s_add_u32 m0, s29, 33664
    s_nop 0
    buffer_load_dwordx4 v16, s[16:19], s34 offen offset:128 lds
    s_add_u32 m0, s29, 34560
    s_nop 0
    buffer_load_dwordx4 v16, s[16:19], s34 offen offset:256 lds
    s_add_u32 m0, s29, 35456
    s_nop 0
    buffer_load_dwordx4 v16, s[16:19], s34 offen offset:384 lds
    s_add_u32 m0, s29, 36352
    s_nop 0
    buffer_load_dwordx4 v16, s[16:19], s34 offen offset:512 lds
    s_add_u32 m0, s29, 37248
    s_nop 0
    buffer_load_dwordx4 v16, s[16:19], s34 offen offset:640 lds
    s_add_u32 m0, s29, 38144
    s_nop 0
    buffer_load_dwordx4 v16, s[16:19], s34 offen offset:768 lds
    s_add_u32 m0, s29, 39040
    s_nop 0
    buffer_load_dwordx4 v16, s[16:19], s34 offen offset:896 lds
    s_add_u32 s34, s34, 64512
    s_min_u32 s34, s34, 4128768
    s_cmp_eq_u32 s30, 2
    s_cbranch_scc1 .s0v_378
    v_mfma_f32_16x16x32_bf16 v[64:67], a[0:3], v[32:35], 0
    v_mfma_f32_16x16x32_bf16 v[68:71], a[4:7], v[32:35], 0
    v_mfma_f32_16x16x32_bf16 v[72:75], a[0:3], v[36:39], 0
    v_mfma_f32_16x16x32_bf16 v[76:79], a[4:7], v[36:39], 0
    v_mfma_f32_16x16x32_bf16 v[64:67], a[8:11], v[40:43], v[64:67]
    v_mfma_f32_16x16x32_bf16 v[68:71], a[12:15], v[40:43], v[68:71]
    v_mfma_f32_16x16x32_bf16 v[72:75], a[8:11], v[44:47], v[72:75]
    v_mfma_f32_16x16x32_bf16 v[76:79], a[12:15], v[44:47], v[76:79]
    v_mfma_f32_16x16x32_bf16 v[64:67], a[16:19], v[48:51], v[64:67]
    v_mfma_f32_16x16x32_bf16 v[68:71], a[20:23], v[48:51], v[68:71]
    v_mfma_f32_16x16x32_bf16 v[72:75], a[16:19], v[52:55], v[72:75]
    v_mfma_f32_16x16x32_bf16 v[76:79], a[20:23], v[52:55], v[76:79]
    v_mfma_f32_16x16x32_bf16 v[64:67], a[24:27], v[56:59], v[64:67]
    v_mfma_f32_16x16x32_bf16 v[68:71], a[28:31], v[56:59], v[68:71]
    v_mfma_f32_16x16x32_bf16 v[72:75], a[24:27], v[60:63], v[72:75]
    v_mfma_f32_16x16x32_bf16 v[76:79], a[28:31], v[60:63], v[76:79]
    s_branch .s0j_379
.s0v_378:
    v_mfma_f32_16x16x32_bf16 v[64:67], v[32:35], a[0:3], 0
    v_mfma_f32_16x16x32_bf16 v[68:71], v[32:35], a[4:7], 0
    v_mfma_f32_16x16x32_bf16 v[72:75], v[36:39], a[0:3], 0
    v_mfma_f32_16x16x32_bf16 v[76:79], v[36:39], a[4:7], 0
    v_mfma_f32_16x16x32_bf16 v[64:67], v[40:43], a[8:11], v[64:67]
    v_mfma_f32_16x16x32_bf16 v[68:71], v[40:43], a[12:15], v[68:71]
    v_mfma_f32_16x16x32_bf16 v[72:75], v[44:47], a[8:11], v[72:75]
    v_mfma_f32_16x16x32_bf16 v[76:79], v[44:47], a[12:15], v[76:79]
    v_mfma_f32_16x16x32_bf16 v[64:67], v[48:51], a[16:19], v[64:67]
    v_mfma_f32_16x16x32_bf16 v[68:71], v[48:51], a[20:23], v[68:71]
    v_mfma_f32_16x16x32_bf16 v[72:75], v[52:55], a[16:19], v[72:75]
    v_mfma_f32_16x16x32_bf16 v[76:79], v[52:55], a[20:23], v[76:79]
    v_mfma_f32_16x16x32_bf16 v[64:67], v[56:59], a[24:27], v[64:67]
    v_mfma_f32_16x16x32_bf16 v[68:71], v[56:59], a[28:31], v[68:71]
    v_mfma_f32_16x16x32_bf16 v[72:75], v[60:63], a[24:27], v[72:75]
    v_mfma_f32_16x16x32_bf16 v[76:79], v[60:63], a[28:31], v[76:79]
.s0j_379:
    s_waitcnt vmcnt(24)
    s_barrier
    ds_read_b64_tr_b16 a[32:33], v12 offset:0
    ds_read_b64_tr_b16 a[34:35], v12 offset:1024
    ds_read_b64_tr_b16 a[36:37], v13 offset:0
    ds_read_b64_tr_b16 a[38:39], v13 offset:1024
    ds_read_b64_tr_b16 a[40:41], v12 offset:8192
    ds_read_b64_tr_b16 a[42:43], v12 offset:9216
    ds_read_b64_tr_b16 a[44:45], v13 offset:8192
    ds_read_b64_tr_b16 a[46:47], v13 offset:9216
    ds_read_b64_tr_b16 a[48:49], v12 offset:16384
    ds_read_b64_tr_b16 a[50:51], v12 offset:17408
    ds_read_b64_tr_b16 a[52:53], v13 offset:16384
    ds_read_b64_tr_b16 a[54:55], v13 offset:17408
    ds_read_b64_tr_b16 a[56:57], v12 offset:24576
    ds_read_b64_tr_b16 a[58:59], v12 offset:25600
    ds_read_b64_tr_b16 a[60:61], v13 offset:24576
    ds_read_b64_tr_b16 a[62:63], v13 offset:25600
    ds_read_b128 v[32:35], v113 offset:2048
    ds_read_b128 v[36:39], v113 offset:18432
    ds_read_b128 v[40:43], v114 offset:2048
    ds_read_b128 v[44:47], v114 offset:18432
    ds_read_b128 v[48:51], v113 offset:3072
    ds_read_b128 v[52:55], v113 offset:19456
    ds_read_b128 v[56:59], v114 offset:3072
    ds_read_b128 v[60:63], v114 offset:19456
    s_waitcnt lgkmcnt(0)
    s_barrier
    s_add_u32 m0, s29, 0
    s_add_u32 s4, s28, 4194304
    buffer_load_dwordx4 v10, s[12:15], s4 offen lds

    s_add_u32 m0, s29, 1024
    s_add_u32 s4, s28, 4227072
    buffer_load_dwordx4 v10, s[12:15], s4 offen lds

    s_add_u32 m0, s29, 2048
    s_add_u32 s4, s28, 4259840
    buffer_load_dwordx4 v11, s[12:15], s4 offen lds

    s_add_u32 m0, s29, 3072
    s_add_u32 s4, s28, 4292608
    buffer_load_dwordx4 v11, s[12:15], s4 offen lds

    s_add_u32 m0, s29, 4096
    s_add_u32 s4, s28, 4325376
    buffer_load_dwordx4 v10, s[12:15], s4 offen lds

    s_add_u32 m0, s29, 5120
    s_add_u32 s4, s28, 4358144
    buffer_load_dwordx4 v10, s[12:15], s4 offen lds

    s_add_u32 m0, s29, 6144
    s_add_u32 s4, s28, 4390912
    buffer_load_dwordx4 v11, s[12:15], s4 offen lds

    s_add_u32 m0, s29, 7168
    s_add_u32 s4, s28, 4423680
    buffer_load_dwordx4 v11, s[12:15], s4 offen lds

    s_cmp_eq_u32 s30, 2
    s_cbranch_scc1 .s0v_380
    v_mfma_f32_16x16x32_bf16 v[64:67], a[32:35], v[32:35], v[64:67]
    v_mfma_f32_16x16x32_bf16 v[68:71], a[36:39], v[32:35], v[68:71]
    v_mfma_f32_16x16x32_bf16 v[72:75], a[32:35], v[36:39], v[72:75]
    v_mfma_f32_16x16x32_bf16 v[76:79], a[36:39], v[36:39], v[76:79]
    v_mfma_f32_16x16x32_bf16 v[64:67], a[40:43], v[40:43], v[64:67]
    v_mfma_f32_16x16x32_bf16 v[68:71], a[44:47], v[40:43], v[68:71]
    v_mfma_f32_16x16x32_bf16 v[72:75], a[40:43], v[44:47], v[72:75]
    v_mfma_f32_16x16x32_bf16 v[76:79], a[44:47], v[44:47], v[76:79]
    v_mfma_f32_16x16x32_bf16 v[64:67], a[48:51], v[48:51], v[64:67]
    v_mfma_f32_16x16x32_bf16 v[68:71], a[52:55], v[48:51], v[68:71]
    v_mfma_f32_16x16x32_bf16 v[72:75], a[48:51], v[52:55], v[72:75]
    v_mfma_f32_16x16x32_bf16 v[76:79], a[52:55], v[52:55], v[76:79]
    v_mfma_f32_16x16x32_bf16 v[64:67], a[56:59], v[56:59], v[64:67]
    v_mfma_f32_16x16x32_bf16 v[68:71], a[60:63], v[56:59], v[68:71]
    v_mfma_f32_16x16x32_bf16 v[72:75], a[56:59], v[60:63], v[72:75]
    v_mfma_f32_16x16x32_bf16 v[76:79], a[60:63], v[60:63], v[76:79]
    s_branch .s0j_381
.s0v_380:
    v_mfma_f32_16x16x32_bf16 v[64:67], v[32:35], a[32:35], v[64:67]
    v_mfma_f32_16x16x32_bf16 v[68:71], v[32:35], a[36:39], v[68:71]
    v_mfma_f32_16x16x32_bf16 v[72:75], v[36:39], a[32:35], v[72:75]
    v_mfma_f32_16x16x32_bf16 v[76:79], v[36:39], a[36:39], v[76:79]
    v_mfma_f32_16x16x32_bf16 v[64:67], v[40:43], a[40:43], v[64:67]
    v_mfma_f32_16x16x32_bf16 v[68:71], v[40:43], a[44:47], v[68:71]
    v_mfma_f32_16x16x32_bf16 v[72:75], v[44:47], a[40:43], v[72:75]
    v_mfma_f32_16x16x32_bf16 v[76:79], v[44:47], a[44:47], v[76:79]
    v_mfma_f32_16x16x32_bf16 v[64:67], v[48:51], a[48:51], v[64:67]
    v_mfma_f32_16x16x32_bf16 v[68:71], v[48:51], a[52:55], v[68:71]
    v_mfma_f32_16x16x32_bf16 v[72:75], v[52:55], a[48:51], v[72:75]
    v_mfma_f32_16x16x32_bf16 v[76:79], v[52:55], a[52:55], v[76:79]
    v_mfma_f32_16x16x32_bf16 v[64:67], v[56:59], a[56:59], v[64:67]
    v_mfma_f32_16x16x32_bf16 v[68:71], v[56:59], a[60:63], v[68:71]
    v_mfma_f32_16x16x32_bf16 v[72:75], v[60:63], a[56:59], v[72:75]
    v_mfma_f32_16x16x32_bf16 v[76:79], v[60:63], a[60:63], v[76:79]
.s0j_381:
    s_waitcnt vmcnt(24)
    s_barrier
    ds_read_b64_tr_b16 a[64:65], v14 offset:0
    ds_read_b64_tr_b16 a[66:67], v14 offset:1024
    ds_read_b64_tr_b16 a[68:69], v15 offset:0
    ds_read_b64_tr_b16 a[70:71], v15 offset:1024
    ds_read_b64_tr_b16 a[72:73], v14 offset:8192
    ds_read_b64_tr_b16 a[74:75], v14 offset:9216
    ds_read_b64_tr_b16 a[76:77], v15 offset:8192
    ds_read_b64_tr_b16 a[78:79], v15 offset:9216
    ds_read_b64_tr_b16 a[80:81], v14 offset:16384
    ds_read_b64_tr_b16 a[82:83], v14 offset:17408
    ds_read_b64_tr_b16 a[84:85], v15 offset:16384
    ds_read_b64_tr_b16 a[86:87], v15 offset:17408
    ds_read_b64_tr_b16 a[88:89], v14 offset:24576
    ds_read_b64_tr_b16 a[90:91], v14 offset:25600
    ds_read_b64_tr_b16 a[92:93], v15 offset:24576
    ds_read_b64_tr_b16 a[94:95], v15 offset:25600
    ds_read_b128 v[32:35], v113 offset:4096
    ds_read_b128 v[36:39], v113 offset:20480
    ds_read_b128 v[40:43], v114 offset:4096
    ds_read_b128 v[44:47], v114 offset:20480
    ds_read_b128 v[48:51], v113 offset:5120
    ds_read_b128 v[52:55], v113 offset:21504
    ds_read_b128 v[56:59], v114 offset:5120
    ds_read_b128 v[60:63], v114 offset:21504
    s_waitcnt lgkmcnt(0)
    s_barrier
    s_add_u32 m0, s29, 65536
    s_add_u32 s4, s28, 5242880
    buffer_load_dwordx4 v10, s[12:15], s4 offen lds

    s_add_u32 m0, s29, 66560
    s_add_u32 s4, s28, 5275648
    buffer_load_dwordx4 v10, s[12:15], s4 offen lds

    s_add_u32 m0, s29, 67584
    s_add_u32 s4, s28, 5308416
    buffer_load_dwordx4 v11, s[12:15], s4 offen lds

    s_add_u32 m0, s29, 68608
    s_add_u32 s4, s28, 5341184
    buffer_load_dwordx4 v11, s[12:15], s4 offen lds

    s_add_u32 m0, s29, 69632
    s_add_u32 s4, s28, 5373952
    buffer_load_dwordx4 v10, s[12:15], s4 offen lds

    s_add_u32 m0, s29, 70656
    s_add_u32 s4, s28, 5406720
    buffer_load_dwordx4 v10, s[12:15], s4 offen lds

    s_add_u32 m0, s29, 71680
    s_add_u32 s4, s28, 5439488
    buffer_load_dwordx4 v11, s[12:15], s4 offen lds

    s_add_u32 m0, s29, 72704
    s_add_u32 s4, s28, 5472256
    buffer_load_dwordx4 v11, s[12:15], s4 offen lds

    s_cmp_eq_u32 s30, 2
    s_cbranch_scc1 .s0v_382
    v_mfma_f32_16x16x32_bf16 v[64:67], a[64:67], v[32:35], v[64:67]
    v_mfma_f32_16x16x32_bf16 v[68:71], a[68:71], v[32:35], v[68:71]
    v_mfma_f32_16x16x32_bf16 v[72:75], a[64:67], v[36:39], v[72:75]
    v_mfma_f32_16x16x32_bf16 v[76:79], a[68:71], v[36:39], v[76:79]
    v_mfma_f32_16x16x32_bf16 v[64:67], a[72:75], v[40:43], v[64:67]
    v_mfma_f32_16x16x32_bf16 v[68:71], a[76:79], v[40:43], v[68:71]
    v_mfma_f32_16x16x32_bf16 v[72:75], a[72:75], v[44:47], v[72:75]
    v_mfma_f32_16x16x32_bf16 v[76:79], a[76:79], v[44:47], v[76:79]
    v_mfma_f32_16x16x32_bf16 v[64:67], a[80:83], v[48:51], v[64:67]
    v_mfma_f32_16x16x32_bf16 v[68:71], a[84:87], v[48:51], v[68:71]
    v_mfma_f32_16x16x32_bf16 v[72:75], a[80:83], v[52:55], v[72:75]
    v_mfma_f32_16x16x32_bf16 v[76:79], a[84:87], v[52:55], v[76:79]
    v_mfma_f32_16x16x32_bf16 v[64:67], a[88:91], v[56:59], v[64:67]
    v_mfma_f32_16x16x32_bf16 v[68:71], a[92:95], v[56:59], v[68:71]
    v_mfma_f32_16x16x32_bf16 v[72:75], a[88:91], v[60:63], v[72:75]
    v_mfma_f32_16x16x32_bf16 v[76:79], a[92:95], v[60:63], v[76:79]
    s_branch .s0j_383
.s0v_382:
    v_mfma_f32_16x16x32_bf16 v[64:67], v[32:35], a[64:67], v[64:67]
    v_mfma_f32_16x16x32_bf16 v[68:71], v[32:35], a[68:71], v[68:71]
    v_mfma_f32_16x16x32_bf16 v[72:75], v[36:39], a[64:67], v[72:75]
    v_mfma_f32_16x16x32_bf16 v[76:79], v[36:39], a[68:71], v[76:79]
    v_mfma_f32_16x16x32_bf16 v[64:67], v[40:43], a[72:75], v[64:67]
    v_mfma_f32_16x16x32_bf16 v[68:71], v[40:43], a[76:79], v[68:71]
    v_mfma_f32_16x16x32_bf16 v[72:75], v[44:47], a[72:75], v[72:75]
    v_mfma_f32_16x16x32_bf16 v[76:79], v[44:47], a[76:79], v[76:79]
    v_mfma_f32_16x16x32_bf16 v[64:67], v[48:51], a[80:83], v[64:67]
    v_mfma_f32_16x16x32_bf16 v[68:71], v[48:51], a[84:87], v[68:71]
    v_mfma_f32_16x16x32_bf16 v[72:75], v[52:55], a[80:83], v[72:75]
    v_mfma_f32_16x16x32_bf16 v[76:79], v[52:55], a[84:87], v[76:79]
    v_mfma_f32_16x16x32_bf16 v[64:67], v[56:59], a[88:91], v[64:67]
    v_mfma_f32_16x16x32_bf16 v[68:71], v[56:59], a[92:95], v[68:71]
    v_mfma_f32_16x16x32_bf16 v[72:75], v[60:63], a[88:91], v[72:75]
    v_mfma_f32_16x16x32_bf16 v[76:79], v[60:63], a[92:95], v[76:79]
.s0j_383:
    s_waitcnt vmcnt(24)
    s_barrier
    ds_read_b64_tr_b16 a[96:97], v14 offset:32768
    ds_read_b64_tr_b16 a[98:99], v14 offset:33792
    ds_read_b64_tr_b16 a[100:101], v15 offset:32768
    ds_read_b64_tr_b16 a[102:103], v15 offset:33792
    ds_read_b64_tr_b16 a[104:105], v14 offset:40960
    ds_read_b64_tr_b16 a[106:107], v14 offset:41984
    ds_read_b64_tr_b16 a[108:109], v15 offset:40960
    ds_read_b64_tr_b16 a[110:111], v15 offset:41984
    ds_read_b64_tr_b16 a[112:113], v14 offset:49152
    ds_read_b64_tr_b16 a[114:115], v14 offset:50176
    ds_read_b64_tr_b16 a[116:117], v15 offset:49152
    ds_read_b64_tr_b16 a[118:119], v15 offset:50176
    ds_read_b64_tr_b16 a[120:121], v14 offset:57344
    ds_read_b64_tr_b16 a[122:123], v14 offset:58368
    ds_read_b64_tr_b16 a[124:125], v15 offset:57344
    ds_read_b64_tr_b16 a[126:127], v15 offset:58368
    ds_read_b128 v[32:35], v113 offset:6144
    ds_read_b128 v[36:39], v113 offset:22528
    ds_read_b128 v[40:43], v114 offset:6144
    ds_read_b128 v[44:47], v114 offset:22528
    ds_read_b128 v[48:51], v113 offset:7168
    ds_read_b128 v[52:55], v113 offset:23552
    ds_read_b128 v[56:59], v114 offset:7168
    ds_read_b128 v[60:63], v114 offset:23552
    s_waitcnt lgkmcnt(0)
    s_barrier
    s_add_u32 m0, s29, 98304
    s_add_u32 s4, s28, 6291456
    buffer_load_dwordx4 v10, s[12:15], s4 offen lds

    s_add_u32 m0, s29, 99328
    s_add_u32 s4, s28, 6324224
    buffer_load_dwordx4 v10, s[12:15], s4 offen lds

    s_add_u32 m0, s29, 100352
    s_add_u32 s4, s28, 6356992
    buffer_load_dwordx4 v11, s[12:15], s4 offen lds

    s_add_u32 m0, s29, 101376
    s_add_u32 s4, s28, 6389760
    buffer_load_dwordx4 v11, s[12:15], s4 offen lds

    s_add_u32 m0, s29, 102400
    s_add_u32 s4, s28, 6422528
    buffer_load_dwordx4 v10, s[12:15], s4 offen lds

    s_add_u32 m0, s29, 103424
    s_add_u32 s4, s28, 6455296
    buffer_load_dwordx4 v10, s[12:15], s4 offen lds

    s_add_u32 m0, s29, 104448
    s_add_u32 s4, s28, 6488064
    buffer_load_dwordx4 v11, s[12:15], s4 offen lds

    s_add_u32 m0, s29, 105472
    s_add_u32 s4, s28, 6520832
    buffer_load_dwordx4 v11, s[12:15], s4 offen lds

    v_and_b32 v241, 3, v0
    v_lshlrev_b32 v241, 2, v241

    v_and_b32 v240, 12, v0
    v_lshl_add_u32 v241, v240, 4, v241
    v_add_u32 v241, s97, v241
    v_and_b32 v241, 255, v241

    buffer_load_dword v240, v241, s[20:23], 0 offen sc1
    s_cmp_eq_u32 s30, 2
    s_cbranch_scc1 .s0v_384
    v_mfma_f32_16x16x32_bf16 v[64:67], a[96:99], v[32:35], v[64:67]
    v_mfma_f32_16x16x32_bf16 v[68:71], a[100:103], v[32:35], v[68:71]
    v_mfma_f32_16x16x32_bf16 v[72:75], a[96:99], v[36:39], v[72:75]
    v_mfma_f32_16x16x32_bf16 v[76:79], a[100:103], v[36:39], v[76:79]
    v_mfma_f32_16x16x32_bf16 v[64:67], a[104:107], v[40:43], v[64:67]
    v_mfma_f32_16x16x32_bf16 v[68:71], a[108:111], v[40:43], v[68:71]
    v_mfma_f32_16x16x32_bf16 v[72:75], a[104:107], v[44:47], v[72:75]
    v_mfma_f32_16x16x32_bf16 v[76:79], a[108:111], v[44:47], v[76:79]
    v_mfma_f32_16x16x32_bf16 v[64:67], a[112:115], v[48:51], v[64:67]
    v_mfma_f32_16x16x32_bf16 v[68:71], a[116:119], v[48:51], v[68:71]
    v_mfma_f32_16x16x32_bf16 v[72:75], a[112:115], v[52:55], v[72:75]
    v_mfma_f32_16x16x32_bf16 v[76:79], a[116:119], v[52:55], v[76:79]
    v_mfma_f32_16x16x32_bf16 v[64:67], a[120:123], v[56:59], v[64:67]
    v_mfma_f32_16x16x32_bf16 v[68:71], a[124:127], v[56:59], v[68:71]
    v_mfma_f32_16x16x32_bf16 v[72:75], a[120:123], v[60:63], v[72:75]
    v_mfma_f32_16x16x32_bf16 v[76:79], a[124:127], v[60:63], v[76:79]
    s_branch .s0j_385
.s0v_384:
    v_mfma_f32_16x16x32_bf16 v[64:67], v[32:35], a[96:99], v[64:67]
    v_mfma_f32_16x16x32_bf16 v[68:71], v[32:35], a[100:103], v[68:71]
    v_mfma_f32_16x16x32_bf16 v[72:75], v[36:39], a[96:99], v[72:75]
    v_mfma_f32_16x16x32_bf16 v[76:79], v[36:39], a[100:103], v[76:79]
    v_mfma_f32_16x16x32_bf16 v[64:67], v[40:43], a[104:107], v[64:67]
    v_mfma_f32_16x16x32_bf16 v[68:71], v[40:43], a[108:111], v[68:71]
    v_mfma_f32_16x16x32_bf16 v[72:75], v[44:47], a[104:107], v[72:75]
    v_mfma_f32_16x16x32_bf16 v[76:79], v[44:47], a[108:111], v[76:79]
    v_mfma_f32_16x16x32_bf16 v[64:67], v[48:51], a[112:115], v[64:67]
    v_mfma_f32_16x16x32_bf16 v[68:71], v[48:51], a[116:119], v[68:71]
    v_mfma_f32_16x16x32_bf16 v[72:75], v[52:55], a[112:115], v[72:75]
    v_mfma_f32_16x16x32_bf16 v[76:79], v[52:55], a[116:119], v[76:79]
    v_mfma_f32_16x16x32_bf16 v[64:67], v[56:59], a[120:123], v[64:67]
    v_mfma_f32_16x16x32_bf16 v[68:71], v[56:59], a[124:127], v[68:71]
    v_mfma_f32_16x16x32_bf16 v[72:75], v[60:63], a[120:123], v[72:75]
    v_mfma_f32_16x16x32_bf16 v[76:79], v[60:63], a[124:127], v[76:79]
.s0j_385:
    s_waitcnt vmcnt(17)
    s_barrier
    ds_read_b64_tr_b16 a[128:129], v12 offset:0
    ds_read_b64_tr_b16 a[130:131], v12 offset:1024
    ds_read_b64_tr_b16 a[132:133], v13 offset:0
    ds_read_b64_tr_b16 a[134:135], v13 offset:1024
    ds_read_b64_tr_b16 a[136:137], v12 offset:8192
    ds_read_b64_tr_b16 a[138:139], v12 offset:9216
    ds_read_b64_tr_b16 a[140:141], v13 offset:8192
    ds_read_b64_tr_b16 a[142:143], v13 offset:9216
    ds_read_b64_tr_b16 a[144:145], v12 offset:16384
    ds_read_b64_tr_b16 a[146:147], v12 offset:17408
    ds_read_b64_tr_b16 a[148:149], v13 offset:16384
    ds_read_b64_tr_b16 a[150:151], v13 offset:17408
    ds_read_b64_tr_b16 a[152:153], v12 offset:24576
    ds_read_b64_tr_b16 a[154:155], v12 offset:25600
    ds_read_b64_tr_b16 a[156:157], v13 offset:24576
    ds_read_b64_tr_b16 a[158:159], v13 offset:25600
    ds_read_b128 v[32:35], v17 offset:32768
    ds_read_b128 v[36:39], v17 offset:49152
    ds_read_b128 v[40:43], v18 offset:32768
    ds_read_b128 v[44:47], v18 offset:49152
    ds_read_b128 v[48:51], v17 offset:33792
    ds_read_b128 v[52:55], v17 offset:50176
    ds_read_b128 v[56:59], v18 offset:33792
    ds_read_b128 v[60:63], v18 offset:50176
    s_waitcnt lgkmcnt(0)
    s_barrier
    s_add_u32 m0, s29, 0
    s_add_u32 s4, s28, 7340032
    buffer_load_dwordx4 v10, s[12:15], s4 offen lds

    s_add_u32 m0, s29, 1024
    s_add_u32 s4, s28, 7372800
    buffer_load_dwordx4 v10, s[12:15], s4 offen lds

    s_add_u32 m0, s29, 2048
    s_add_u32 s4, s28, 7405568
    buffer_load_dwordx4 v11, s[12:15], s4 offen lds

    s_add_u32 m0, s29, 3072
    s_add_u32 s4, s28, 7438336
    buffer_load_dwordx4 v11, s[12:15], s4 offen lds

    s_add_u32 m0, s29, 4096
    s_add_u32 s4, s28, 7471104
    buffer_load_dwordx4 v10, s[12:15], s4 offen lds

    s_add_u32 m0, s29, 5120
    s_add_u32 s4, s28, 7503872
    buffer_load_dwordx4 v10, s[12:15], s4 offen lds

    s_add_u32 m0, s29, 6144
    s_add_u32 s4, s28, 7536640
    buffer_load_dwordx4 v11, s[12:15], s4 offen lds

    s_add_u32 m0, s29, 7168
    s_add_u32 s4, s28, 7569408
    buffer_load_dwordx4 v11, s[12:15], s4 offen lds

    s_cmp_eq_u32 s30, 2
    s_cbranch_scc1 .s0v_386
    v_mfma_f32_16x16x32_bf16 v[64:67], a[128:131], v[32:35], v[64:67]
    v_mfma_f32_16x16x32_bf16 v[68:71], a[132:135], v[32:35], v[68:71]
    v_mfma_f32_16x16x32_bf16 v[72:75], a[128:131], v[36:39], v[72:75]
    v_mfma_f32_16x16x32_bf16 v[76:79], a[132:135], v[36:39], v[76:79]
    v_mfma_f32_16x16x32_bf16 v[64:67], a[136:139], v[40:43], v[64:67]
    v_mfma_f32_16x16x32_bf16 v[68:71], a[140:143], v[40:43], v[68:71]
    v_mfma_f32_16x16x32_bf16 v[72:75], a[136:139], v[44:47], v[72:75]
    v_mfma_f32_16x16x32_bf16 v[76:79], a[140:143], v[44:47], v[76:79]
    v_mfma_f32_16x16x32_bf16 v[64:67], a[144:147], v[48:51], v[64:67]
    v_mfma_f32_16x16x32_bf16 v[68:71], a[148:151], v[48:51], v[68:71]
    v_mfma_f32_16x16x32_bf16 v[72:75], a[144:147], v[52:55], v[72:75]
    v_mfma_f32_16x16x32_bf16 v[76:79], a[148:151], v[52:55], v[76:79]
    v_mfma_f32_16x16x32_bf16 v[64:67], a[152:155], v[56:59], v[64:67]
    v_mfma_f32_16x16x32_bf16 v[68:71], a[156:159], v[56:59], v[68:71]
    v_mfma_f32_16x16x32_bf16 v[72:75], a[152:155], v[60:63], v[72:75]
    v_mfma_f32_16x16x32_bf16 v[76:79], a[156:159], v[60:63], v[76:79]
    s_branch .s0j_387
.s0v_386:
    v_mfma_f32_16x16x32_bf16 v[64:67], v[32:35], a[128:131], v[64:67]
    v_mfma_f32_16x16x32_bf16 v[68:71], v[32:35], a[132:135], v[68:71]
    v_mfma_f32_16x16x32_bf16 v[72:75], v[36:39], a[128:131], v[72:75]
    v_mfma_f32_16x16x32_bf16 v[76:79], v[36:39], a[132:135], v[76:79]
    v_mfma_f32_16x16x32_bf16 v[64:67], v[40:43], a[136:139], v[64:67]
    v_mfma_f32_16x16x32_bf16 v[68:71], v[40:43], a[140:143], v[68:71]
    v_mfma_f32_16x16x32_bf16 v[72:75], v[44:47], a[136:139], v[72:75]
    v_mfma_f32_16x16x32_bf16 v[76:79], v[44:47], a[140:143], v[76:79]
    v_mfma_f32_16x16x32_bf16 v[64:67], v[48:51], a[144:147], v[64:67]
    v_mfma_f32_16x16x32_bf16 v[68:71], v[48:51], a[148:151], v[68:71]
    v_mfma_f32_16x16x32_bf16 v[72:75], v[52:55], a[144:147], v[72:75]
    v_mfma_f32_16x16x32_bf16 v[76:79], v[52:55], a[148:151], v[76:79]
    v_mfma_f32_16x16x32_bf16 v[64:67], v[56:59], a[152:155], v[64:67]
    v_mfma_f32_16x16x32_bf16 v[68:71], v[56:59], a[156:159], v[68:71]
    v_mfma_f32_16x16x32_bf16 v[72:75], v[60:63], a[152:155], v[72:75]
    v_mfma_f32_16x16x32_bf16 v[76:79], v[60:63], a[156:159], v[76:79]
.s0j_387:
    s_waitcnt vmcnt(17)
    s_barrier
    ds_read_b64_tr_b16 a[160:161], v14 offset:0
    ds_read_b64_tr_b16 a[162:163], v14 offset:1024
    ds_read_b64_tr_b16 a[164:165], v15 offset:0
    ds_read_b64_tr_b16 a[166:167], v15 offset:1024
    ds_read_b64_tr_b16 a[168:169], v14 offset:8192
    ds_read_b64_tr_b16 a[170:171], v14 offset:9216
    ds_read_b64_tr_b16 a[172:173], v15 offset:8192
    ds_read_b64_tr_b16 a[174:175], v15 offset:9216
    ds_read_b64_tr_b16 a[176:177], v14 offset:16384
    ds_read_b64_tr_b16 a[178:179], v14 offset:17408
    ds_read_b64_tr_b16 a[180:181], v15 offset:16384
    ds_read_b64_tr_b16 a[182:183], v15 offset:17408
    ds_read_b64_tr_b16 a[184:185], v14 offset:24576
    ds_read_b64_tr_b16 a[186:187], v14 offset:25600
    ds_read_b64_tr_b16 a[188:189], v15 offset:24576
    ds_read_b64_tr_b16 a[190:191], v15 offset:25600
    ds_read_b128 v[32:35], v17 offset:34816
    ds_read_b128 v[36:39], v17 offset:51200
    ds_read_b128 v[40:43], v18 offset:34816
    ds_read_b128 v[44:47], v18 offset:51200
    ds_read_b128 v[48:51], v17 offset:35840
    ds_read_b128 v[52:55], v17 offset:52224
    ds_read_b128 v[56:59], v18 offset:35840
    ds_read_b128 v[60:63], v18 offset:52224
    s_waitcnt lgkmcnt(0)
    s_barrier
    s_add_u32 m0, s29, 65536
    s_nop 0
    buffer_load_dwordx4 v16, s[16:19], s34 offen offset:0 lds
    s_add_u32 m0, s29, 66432
    s_nop 0
    buffer_load_dwordx4 v16, s[16:19], s34 offen offset:128 lds
    s_add_u32 m0, s29, 67328
    s_nop 0
    buffer_load_dwordx4 v16, s[16:19], s34 offen offset:256 lds
    s_add_u32 m0, s29, 68224
    s_nop 0
    buffer_load_dwordx4 v16, s[16:19], s34 offen offset:384 lds
    s_add_u32 m0, s29, 69120
    s_nop 0
    buffer_load_dwordx4 v16, s[16:19], s34 offen offset:512 lds
    s_add_u32 m0, s29, 70016
    s_nop 0
    buffer_load_dwordx4 v16, s[16:19], s34 offen offset:640 lds
    s_add_u32 m0, s29, 70912
    s_nop 0
    buffer_load_dwordx4 v16, s[16:19], s34 offen offset:768 lds
    s_add_u32 m0, s29, 71808
    s_nop 0
    buffer_load_dwordx4 v16, s[16:19], s34 offen offset:896 lds
    s_add_u32 s34, s34, 1024
    s_cmp_eq_u32 s30, 2
    s_cbranch_scc1 .s0v_388
    v_mfma_f32_16x16x32_bf16 v[64:67], a[160:163], v[32:35], v[64:67]
    v_mfma_f32_16x16x32_bf16 v[68:71], a[164:167], v[32:35], v[68:71]
    v_mfma_f32_16x16x32_bf16 v[72:75], a[160:163], v[36:39], v[72:75]
    v_mfma_f32_16x16x32_bf16 v[76:79], a[164:167], v[36:39], v[76:79]
    v_mfma_f32_16x16x32_bf16 v[64:67], a[168:171], v[40:43], v[64:67]
    v_mfma_f32_16x16x32_bf16 v[68:71], a[172:175], v[40:43], v[68:71]
    v_mfma_f32_16x16x32_bf16 v[72:75], a[168:171], v[44:47], v[72:75]
    v_mfma_f32_16x16x32_bf16 v[76:79], a[172:175], v[44:47], v[76:79]
    v_mfma_f32_16x16x32_bf16 v[64:67], a[176:179], v[48:51], v[64:67]
    v_mfma_f32_16x16x32_bf16 v[68:71], a[180:183], v[48:51], v[68:71]
    v_mfma_f32_16x16x32_bf16 v[72:75], a[176:179], v[52:55], v[72:75]
    v_mfma_f32_16x16x32_bf16 v[76:79], a[180:183], v[52:55], v[76:79]
    v_mfma_f32_16x16x32_bf16 v[64:67], a[184:187], v[56:59], v[64:67]
    v_mfma_f32_16x16x32_bf16 v[68:71], a[188:191], v[56:59], v[68:71]
    v_mfma_f32_16x16x32_bf16 v[72:75], a[184:187], v[60:63], v[72:75]
    v_mfma_f32_16x16x32_bf16 v[76:79], a[188:191], v[60:63], v[76:79]
    s_branch .s0j_389
.s0v_388:
    v_mfma_f32_16x16x32_bf16 v[64:67], v[32:35], a[160:163], v[64:67]
    v_mfma_f32_16x16x32_bf16 v[68:71], v[32:35], a[164:167], v[68:71]
    v_mfma_f32_16x16x32_bf16 v[72:75], v[36:39], a[160:163], v[72:75]
    v_mfma_f32_16x16x32_bf16 v[76:79], v[36:39], a[164:167], v[76:79]
    v_mfma_f32_16x16x32_bf16 v[64:67], v[40:43], a[168:171], v[64:67]
    v_mfma_f32_16x16x32_bf16 v[68:71], v[40:43], a[172:175], v[68:71]
    v_mfma_f32_16x16x32_bf16 v[72:75], v[44:47], a[168:171], v[72:75]
    v_mfma_f32_16x16x32_bf16 v[76:79], v[44:47], a[172:175], v[76:79]
    v_mfma_f32_16x16x32_bf16 v[64:67], v[48:51], a[176:179], v[64:67]
    v_mfma_f32_16x16x32_bf16 v[68:71], v[48:51], a[180:183], v[68:71]
    v_mfma_f32_16x16x32_bf16 v[72:75], v[52:55], a[176:179], v[72:75]
    v_mfma_f32_16x16x32_bf16 v[76:79], v[52:55], a[180:183], v[76:79]
    v_mfma_f32_16x16x32_bf16 v[64:67], v[56:59], a[184:187], v[64:67]
    v_mfma_f32_16x16x32_bf16 v[68:71], v[56:59], a[188:191], v[68:71]
    v_mfma_f32_16x16x32_bf16 v[72:75], v[60:63], a[184:187], v[72:75]
    v_mfma_f32_16x16x32_bf16 v[76:79], v[60:63], a[188:191], v[76:79]
.s0j_389:
    s_waitcnt vmcnt(17)
    s_barrier
    ds_read_b64_tr_b16 a[192:193], v14 offset:32768
    ds_read_b64_tr_b16 a[194:195], v14 offset:33792
    ds_read_b64_tr_b16 a[196:197], v15 offset:32768
    ds_read_b64_tr_b16 a[198:199], v15 offset:33792
    ds_read_b64_tr_b16 a[200:201], v14 offset:40960
    ds_read_b64_tr_b16 a[202:203], v14 offset:41984
    ds_read_b64_tr_b16 a[204:205], v15 offset:40960
    ds_read_b64_tr_b16 a[206:207], v15 offset:41984
    ds_read_b64_tr_b16 a[208:209], v14 offset:49152
    ds_read_b64_tr_b16 a[210:211], v14 offset:50176
    ds_read_b64_tr_b16 a[212:213], v15 offset:49152
    ds_read_b64_tr_b16 a[214:215], v15 offset:50176
    ds_read_b64_tr_b16 a[216:217], v14 offset:57344
    ds_read_b64_tr_b16 a[218:219], v14 offset:58368
    ds_read_b64_tr_b16 a[220:221], v15 offset:57344
    ds_read_b64_tr_b16 a[222:223], v15 offset:58368
    ds_read_b128 v[32:35], v17 offset:36864
    ds_read_b128 v[36:39], v17 offset:53248
    ds_read_b128 v[40:43], v18 offset:36864
    ds_read_b128 v[44:47], v18 offset:53248
    ds_read_b128 v[48:51], v17 offset:37888
    ds_read_b128 v[52:55], v17 offset:54272
    ds_read_b128 v[56:59], v18 offset:37888
    ds_read_b128 v[60:63], v18 offset:54272
    s_waitcnt lgkmcnt(0)
    s_barrier
    s_add_u32 m0, s29, 98304
    s_nop 0
    buffer_load_dwordx4 v16, s[16:19], s34 offen offset:0 lds
    s_add_u32 m0, s29, 99200
    s_nop 0
    buffer_load_dwordx4 v16, s[16:19], s34 offen offset:128 lds
    s_add_u32 m0, s29, 100096
    s_nop 0
    buffer_load_dwordx4 v16, s[16:19], s34 offen offset:256 lds
    s_add_u32 m0, s29, 100992
    s_nop 0
    buffer_load_dwordx4 v16, s[16:19], s34 offen offset:384 lds
    s_add_u32 m0, s29, 101888
    s_nop 0
    buffer_load_dwordx4 v16, s[16:19], s34 offen offset:512 lds
    s_add_u32 m0, s29, 102784
    s_nop 0
    buffer_load_dwordx4 v16, s[16:19], s34 offen offset:640 lds
    s_add_u32 m0, s29, 103680
    s_nop 0
    buffer_load_dwordx4 v16, s[16:19], s34 offen offset:768 lds
    s_add_u32 m0, s29, 104576
    s_nop 0
    buffer_load_dwordx4 v16, s[16:19], s34 offen offset:896 lds
    s_add_u32 s34, s34, 64512
    s_min_u32 s34, s34, 4128768
    s_cmp_eq_u32 s30, 2
    s_cbranch_scc1 .s0v_390
    v_mfma_f32_16x16x32_bf16 v[64:67], a[192:195], v[32:35], v[64:67]
    v_mfma_f32_16x16x32_bf16 v[68:71], a[196:199], v[32:35], v[68:71]
    v_mfma_f32_16x16x32_bf16 v[72:75], a[192:195], v[36:39], v[72:75]
    v_mfma_f32_16x16x32_bf16 v[76:79], a[196:199], v[36:39], v[76:79]
    v_mfma_f32_16x16x32_bf16 v[64:67], a[200:203], v[40:43], v[64:67]
    v_mfma_f32_16x16x32_bf16 v[68:71], a[204:207], v[40:43], v[68:71]
    v_mfma_f32_16x16x32_bf16 v[72:75], a[200:203], v[44:47], v[72:75]
    v_mfma_f32_16x16x32_bf16 v[76:79], a[204:207], v[44:47], v[76:79]
    v_mfma_f32_16x16x32_bf16 v[64:67], a[208:211], v[48:51], v[64:67]
    v_mfma_f32_16x16x32_bf16 v[68:71], a[212:215], v[48:51], v[68:71]
    v_mfma_f32_16x16x32_bf16 v[72:75], a[208:211], v[52:55], v[72:75]
    v_mfma_f32_16x16x32_bf16 v[76:79], a[212:215], v[52:55], v[76:79]
    v_mfma_f32_16x16x32_bf16 v[64:67], a[216:219], v[56:59], v[64:67]
    v_mfma_f32_16x16x32_bf16 v[68:71], a[220:223], v[56:59], v[68:71]
    v_mfma_f32_16x16x32_bf16 v[72:75], a[216:219], v[60:63], v[72:75]
    v_mfma_f32_16x16x32_bf16 v[76:79], a[220:223], v[60:63], v[76:79]
    s_branch .s0j_391
.s0v_390:
    v_mfma_f32_16x16x32_bf16 v[64:67], v[32:35], a[192:195], v[64:67]
    v_mfma_f32_16x16x32_bf16 v[68:71], v[32:35], a[196:199], v[68:71]
    v_mfma_f32_16x16x32_bf16 v[72:75], v[36:39], a[192:195], v[72:75]
    v_mfma_f32_16x16x32_bf16 v[76:79], v[36:39], a[196:199], v[76:79]
    v_mfma_f32_16x16x32_bf16 v[64:67], v[40:43], a[200:203], v[64:67]
    v_mfma_f32_16x16x32_bf16 v[68:71], v[40:43], a[204:207], v[68:71]
    v_mfma_f32_16x16x32_bf16 v[72:75], v[44:47], a[200:203], v[72:75]
    v_mfma_f32_16x16x32_bf16 v[76:79], v[44:47], a[204:207], v[76:79]
    v_mfma_f32_16x16x32_bf16 v[64:67], v[48:51], a[208:211], v[64:67]
    v_mfma_f32_16x16x32_bf16 v[68:71], v[48:51], a[212:215], v[68:71]
    v_mfma_f32_16x16x32_bf16 v[72:75], v[52:55], a[208:211], v[72:75]
    v_mfma_f32_16x16x32_bf16 v[76:79], v[52:55], a[212:215], v[76:79]
    v_mfma_f32_16x16x32_bf16 v[64:67], v[56:59], a[216:219], v[64:67]
    v_mfma_f32_16x16x32_bf16 v[68:71], v[56:59], a[220:223], v[68:71]
    v_mfma_f32_16x16x32_bf16 v[72:75], v[60:63], a[216:219], v[72:75]
    v_mfma_f32_16x16x32_bf16 v[76:79], v[60:63], a[220:223], v[76:79]
.s0j_391:
    s_waitcnt vmcnt(16)
    s_barrier
    ds_read_b64_tr_b16 a[224:225], v12 offset:0
    ds_read_b64_tr_b16 a[226:227], v12 offset:1024
    ds_read_b64_tr_b16 a[228:229], v13 offset:0
    ds_read_b64_tr_b16 a[230:231], v13 offset:1024
    ds_read_b64_tr_b16 a[232:233], v12 offset:8192
    ds_read_b64_tr_b16 a[234:235], v12 offset:9216
    ds_read_b64_tr_b16 a[236:237], v13 offset:8192
    ds_read_b64_tr_b16 a[238:239], v13 offset:9216
    ds_read_b64_tr_b16 a[240:241], v12 offset:16384
    ds_read_b64_tr_b16 a[242:243], v12 offset:17408
    ds_read_b64_tr_b16 a[244:245], v13 offset:16384
    ds_read_b64_tr_b16 a[246:247], v13 offset:17408
    ds_read_b64_tr_b16 a[248:249], v12 offset:24576
    ds_read_b64_tr_b16 a[250:251], v12 offset:25600
    ds_read_b64_tr_b16 a[252:253], v13 offset:24576
    ds_read_b64_tr_b16 a[254:255], v13 offset:25600
    ds_read_b128 v[32:35], v17 offset:38912
    ds_read_b128 v[36:39], v17 offset:55296
    ds_read_b128 v[40:43], v18 offset:38912
    ds_read_b128 v[44:47], v18 offset:55296
    ds_read_b128 v[48:51], v17 offset:39936
    ds_read_b128 v[52:55], v17 offset:56320
    ds_read_b128 v[56:59], v18 offset:39936
    ds_read_b128 v[60:63], v18 offset:56320
    s_mov_b32 s62, 0
.vp_392:
    v_readlane_b32 s4, v240, 0
    v_readlane_b32 s7, v240, 1
    v_readlane_b32 s6, v240, 2

    v_readlane_b32 s5, v240, 4
    s_add_u32 s4, s4, s5
    v_readlane_b32 s5, v240, 8
    s_add_u32 s4, s4, s5
    v_readlane_b32 s5, v240, 12
    s_add_u32 s4, s4, s5
    s_cmp_ge_u32 s4, 256
    s_cbranch_scc1 .vd_393
    s_cmp_lg_u32 s6, 0
    s_cbranch_scc1 .vs_394
    s_add_u32 s62, s62, 1
    s_cmp_gt_u32 s62, 0x100000
    s_cbranch_scc1 .mg_end_1
    s_sleep 8
    buffer_load_dword v240, v241, s[20:23], 0 offen sc1
    s_waitcnt vmcnt(0)
    s_branch .vp_392

.vs_394:
    s_lshr_b32 s25, s2, 5
    s_and_b32 s26, s2, 31
    s_mov_b32 s27, 1
    s_mov_b32 s99, 1
    s_mov_b32 s97, 144
    s_waitcnt vmcnt(0) lgkmcnt(0)
    s_barrier
    s_branch .mg_role_3

.vd_393:
    s_waitcnt lgkmcnt(0)
    s_barrier
    s_add_u32 m0, s29, 0
    s_nop 0
    buffer_load_dwordx4 v16, s[16:19], s34 offen offset:0 lds
    s_add_u32 m0, s29, 896
    s_nop 0
    buffer_load_dwordx4 v16, s[16:19], s34 offen offset:128 lds
    s_add_u32 m0, s29, 1792
    s_nop 0
    buffer_load_dwordx4 v16, s[16:19], s34 offen offset:256 lds
    s_add_u32 m0, s29, 2688
    s_nop 0
    buffer_load_dwordx4 v16, s[16:19], s34 offen offset:384 lds
    s_add_u32 m0, s29, 3584
    s_nop 0
    buffer_load_dwordx4 v16, s[16:19], s34 offen offset:512 lds
    s_add_u32 m0, s29, 4480
    s_nop 0
    buffer_load_dwordx4 v16, s[16:19], s34 offen offset:640 lds
    s_add_u32 m0, s29, 5376
    s_nop 0
    buffer_load_dwordx4 v16, s[16:19], s34 offen offset:768 lds
    s_add_u32 m0, s29, 6272
    s_nop 0
    buffer_load_dwordx4 v16, s[16:19], s34 offen offset:896 lds
    s_add_u32 s34, s34, 1024
    s_cmp_eq_u32 s30, 2
    s_cbranch_scc1 .s0v_395
    v_mfma_f32_16x16x32_bf16 v[64:67], a[224:227], v[32:35], v[64:67]
    v_mfma_f32_16x16x32_bf16 v[68:71], a[228:231], v[32:35], v[68:71]
    v_mfma_f32_16x16x32_bf16 v[72:75], a[224:227], v[36:39], v[72:75]
    v_mfma_f32_16x16x32_bf16 v[76:79], a[228:231], v[36:39], v[76:79]
    v_mfma_f32_16x16x32_bf16 v[64:67], a[232:235], v[40:43], v[64:67]
    v_mfma_f32_16x16x32_bf16 v[68:71], a[236:239], v[40:43], v[68:71]
    v_mfma_f32_16x16x32_bf16 v[72:75], a[232:235], v[44:47], v[72:75]
    v_mfma_f32_16x16x32_bf16 v[76:79], a[236:239], v[44:47], v[76:79]
    v_mfma_f32_16x16x32_bf16 v[64:67], a[240:243], v[48:51], v[64:67]
    v_mfma_f32_16x16x32_bf16 v[68:71], a[244:247], v[48:51], v[68:71]
    v_mfma_f32_16x16x32_bf16 v[72:75], a[240:243], v[52:55], v[72:75]
    v_mfma_f32_16x16x32_bf16 v[76:79], a[244:247], v[52:55], v[76:79]
    v_mfma_f32_16x16x32_bf16 v[64:67], a[248:251], v[56:59], v[64:67]
    v_mfma_f32_16x16x32_bf16 v[68:71], a[252:255], v[56:59], v[68:71]
    v_mfma_f32_16x16x32_bf16 v[72:75], a[248:251], v[60:63], v[72:75]
    v_mfma_f32_16x16x32_bf16 v[76:79], a[252:255], v[60:63], v[76:79]
    s_branch .s0j_396
.s0v_395:
    v_mfma_f32_16x16x32_bf16 v[64:67], v[32:35], a[224:227], v[64:67]
    v_mfma_f32_16x16x32_bf16 v[68:71], v[32:35], a[228:231], v[68:71]
    v_mfma_f32_16x16x32_bf16 v[72:75], v[36:39], a[224:227], v[72:75]
    v_mfma_f32_16x16x32_bf16 v[76:79], v[36:39], a[228:231], v[76:79]
    v_mfma_f32_16x16x32_bf16 v[64:67], v[40:43], a[232:235], v[64:67]
    v_mfma_f32_16x16x32_bf16 v[68:71], v[40:43], a[236:239], v[68:71]
    v_mfma_f32_16x16x32_bf16 v[72:75], v[44:47], a[232:235], v[72:75]
    v_mfma_f32_16x16x32_bf16 v[76:79], v[44:47], a[236:239], v[76:79]
    v_mfma_f32_16x16x32_bf16 v[64:67], v[48:51], a[240:243], v[64:67]
    v_mfma_f32_16x16x32_bf16 v[68:71], v[48:51], a[244:247], v[68:71]
    v_mfma_f32_16x16x32_bf16 v[72:75], v[52:55], a[240:243], v[72:75]
    v_mfma_f32_16x16x32_bf16 v[76:79], v[52:55], a[244:247], v[76:79]
    v_mfma_f32_16x16x32_bf16 v[64:67], v[56:59], a[248:251], v[64:67]
    v_mfma_f32_16x16x32_bf16 v[68:71], v[56:59], a[252:255], v[68:71]
    v_mfma_f32_16x16x32_bf16 v[72:75], v[60:63], a[248:251], v[72:75]
    v_mfma_f32_16x16x32_bf16 v[76:79], v[60:63], a[252:255], v[76:79]
.s0j_396:
    buffer_store_dwordx4 v[24:27], v28, s[8:11], s46 offen sc1
    buffer_store_dwordx4 v[24:27], v29, s[8:11], s46 offen sc1
    s_cmp_eq_u32 s30, 2
    s_cbranch_scc1 .qv_376
    s_waitcnt vmcnt(16)
    s_barrier
    ds_read_b128 v[32:35], v19 offset:0
    ds_read_b128 v[36:39], v19 offset:16384
    ds_read_b128 v[40:43], v20 offset:0
    ds_read_b128 v[44:47], v20 offset:16384
    s_add_u32 m0, s29, 32768
    s_nop 0
    buffer_load_dwordx4 v16, s[16:19], s34 offen offset:0 lds
    ds_read_b128 v[48:51], v19 offset:1024
    ds_read_b128 v[52:55], v19 offset:17408
    s_branch .qe_398
.p2align 6
.ql_397:
    s_waitcnt lgkmcnt(4)
    v_mfma_f32_16x16x32_bf16 v[64:67], a[0:3], v[32:35], 0
    ds_read_b128 v[56:59], v18 offset:1024
    s_add_u32 m0, s29, 99200
    v_mfma_f32_16x16x32_bf16 v[68:71], a[4:7], v[32:35], 0
    buffer_load_dwordx4 v16, s[16:19], s34 offen offset:128 lds
    v_mfma_f32_16x16x32_bf16 v[72:75], a[0:3], v[36:39], 0
    ds_read_b128 v[60:63], v18 offset:17408
    v_mfma_f32_16x16x32_bf16 v[76:79], a[4:7], v[36:39], 0
    s_mov_b32 exec_hi, 0
    buffer_store_dwordx4 v[24:27], v21, s[8:11], s48 offen sc1
    s_mov_b32 exec_hi, -1

    s_waitcnt lgkmcnt(4)
    v_mfma_f32_16x16x32_bf16 v[64:67], a[8:11], v[40:43], v[64:67]
    ds_read_b128 v[32:35], v17 offset:2048
    v_mfma_f32_16x16x32_bf16 v[68:71], a[12:15], v[40:43], v[68:71]
    v_cvt_pk_bf16_f32 v96, v80, v81
    v_cvt_pk_bf16_f32 v97, v82, v83
    v_cvt_pk_bf16_f32 v98, v84, v85
    v_mfma_f32_16x16x32_bf16 v[72:75], a[8:11], v[44:47], v[72:75]
    ds_read_b128 v[36:39], v17 offset:18432
    v_mfma_f32_16x16x32_bf16 v[76:79], a[12:15], v[44:47], v[76:79]
    v_cvt_pk_bf16_f32 v99, v86, v87
    v_cvt_pk_bf16_f32 v100, v88, v89
    buffer_store_dwordx4 v[96:99], v21, s[8:11], s32 offen sc1
    s_waitcnt lgkmcnt(4)
    v_mfma_f32_16x16x32_bf16 v[64:67], a[16:19], v[48:51], v[64:67]
    ds_read_b128 v[40:43], v18 offset:2048
    s_add_u32 m0, s29, 100096
    v_mfma_f32_16x16x32_bf16 v[68:71], a[20:23], v[48:51], v[68:71]
    buffer_load_dwordx4 v16, s[16:19], s34 offen offset:256 lds
    v_mfma_f32_16x16x32_bf16 v[72:75], a[16:19], v[52:55], v[72:75]
    ds_read_b128 v[44:47], v18 offset:18432
    v_mfma_f32_16x16x32_bf16 v[76:79], a[20:23], v[52:55], v[76:79]
    v_cvt_pk_bf16_f32 v101, v90, v91
    v_cvt_pk_bf16_f32 v102, v92, v93
    v_cvt_pk_bf16_f32 v103, v94, v95
    s_waitcnt lgkmcnt(4)
    v_mfma_f32_16x16x32_bf16 v[64:67], a[24:27], v[56:59], v[64:67]
    ds_read_b128 v[48:51], v17 offset:3072
    v_mfma_f32_16x16x32_bf16 v[68:71], a[28:31], v[56:59], v[68:71]
    buffer_store_dwordx4 v[100:103], v21, s[8:11], s38 offen sc1
    v_mfma_f32_16x16x32_bf16 v[72:75], a[24:27], v[60:63], v[72:75]
    ds_read_b128 v[52:55], v17 offset:19456
    v_mfma_f32_16x16x32_bf16 v[76:79], a[28:31], v[60:63], v[76:79]
    s_waitcnt lgkmcnt(4)
    v_mfma_f32_16x16x32_bf16 v[64:67], a[32:35], v[32:35], v[64:67]
    ds_read_b128 v[56:59], v18 offset:3072
    s_add_u32 m0, s29, 100992
    v_mfma_f32_16x16x32_bf16 v[68:71], a[36:39], v[32:35], v[68:71]
    buffer_load_dwordx4 v16, s[16:19], s34 offen offset:384 lds
    v_mfma_f32_16x16x32_bf16 v[72:75], a[32:35], v[36:39], v[72:75]
    ds_read_b128 v[60:63], v18 offset:19456
    v_mfma_f32_16x16x32_bf16 v[76:79], a[36:39], v[36:39], v[76:79]
    s_waitcnt lgkmcnt(4)
    v_mfma_f32_16x16x32_bf16 v[64:67], a[40:43], v[40:43], v[64:67]
    ds_read_b128 v[32:35], v17 offset:4096
    v_mfma_f32_16x16x32_bf16 v[68:71], a[44:47], v[40:43], v[68:71]
    v_mfma_f32_16x16x32_bf16 v[72:75], a[40:43], v[44:47], v[72:75]
    ds_read_b128 v[36:39], v17 offset:20480
    v_mfma_f32_16x16x32_bf16 v[76:79], a[44:47], v[44:47], v[76:79]
    s_waitcnt lgkmcnt(4)
    v_mfma_f32_16x16x32_bf16 v[64:67], a[48:51], v[48:51], v[64:67]
    ds_read_b128 v[40:43], v18 offset:4096
    s_add_u32 m0, s29, 101888
    v_mfma_f32_16x16x32_bf16 v[68:71], a[52:55], v[48:51], v[68:71]
    buffer_load_dwordx4 v16, s[16:19], s34 offen offset:512 lds
    v_mfma_f32_16x16x32_bf16 v[72:75], a[48:51], v[52:55], v[72:75]
    ds_read_b128 v[44:47], v18 offset:20480
    v_mfma_f32_16x16x32_bf16 v[76:79], a[52:55], v[52:55], v[76:79]
    s_waitcnt lgkmcnt(4)
    v_mfma_f32_16x16x32_bf16 v[64:67], a[56:59], v[56:59], v[64:67]
    ds_read_b128 v[48:51], v17 offset:5120
    v_mfma_f32_16x16x32_bf16 v[68:71], a[60:63], v[56:59], v[68:71]
    v_mfma_f32_16x16x32_bf16 v[72:75], a[56:59], v[60:63], v[72:75]
    ds_read_b128 v[52:55], v17 offset:21504
    v_mfma_f32_16x16x32_bf16 v[76:79], a[60:63], v[60:63], v[76:79]
    s_waitcnt lgkmcnt(4)
    v_mfma_f32_16x16x32_bf16 v[64:67], a[64:67], v[32:35], v[64:67]
    ds_read_b128 v[56:59], v18 offset:5120
    s_add_u32 m0, s29, 102784
    v_mfma_f32_16x16x32_bf16 v[68:71], a[68:71], v[32:35], v[68:71]
    buffer_load_dwordx4 v16, s[16:19], s34 offen offset:640 lds
    v_mfma_f32_16x16x32_bf16 v[72:75], a[64:67], v[36:39], v[72:75]
    ds_read_b128 v[60:63], v18 offset:21504
    v_mfma_f32_16x16x32_bf16 v[76:79], a[68:71], v[36:39], v[76:79]
    s_waitcnt lgkmcnt(4)
    v_mfma_f32_16x16x32_bf16 v[64:67], a[72:75], v[40:43], v[64:67]
    ds_read_b128 v[32:35], v17 offset:6144
    v_mfma_f32_16x16x32_bf16 v[68:71], a[76:79], v[40:43], v[68:71]
    s_mov_b32 s32, s39
    s_add_u32 s38, s39, 4096
    s_add_u32 s39, s39, 262144
    s_mov_b32 s48, s49
    s_add_u32 s49, s49, 196608
    v_mfma_f32_16x16x32_bf16 v[72:75], a[72:75], v[44:47], v[72:75]
    ds_read_b128 v[36:39], v17 offset:22528
    v_mfma_f32_16x16x32_bf16 v[76:79], a[76:79], v[44:47], v[76:79]
    v_add_u32 v23, 1, v23
    s_waitcnt lgkmcnt(4)
    v_mfma_f32_16x16x32_bf16 v[64:67], a[80:83], v[48:51], v[64:67]
    ds_read_b128 v[40:43], v18 offset:6144
    s_add_u32 m0, s29, 103680
    v_mfma_f32_16x16x32_bf16 v[68:71], a[84:87], v[48:51], v[68:71]
    buffer_load_dwordx4 v16, s[16:19], s34 offen offset:768 lds
    v_mfma_f32_16x16x32_bf16 v[72:75], a[80:83], v[52:55], v[72:75]
    ds_read_b128 v[44:47], v18 offset:22528
    v_mfma_f32_16x16x32_bf16 v[76:79], a[84:87], v[52:55], v[76:79]
    s_waitcnt lgkmcnt(4)
    v_mfma_f32_16x16x32_bf16 v[64:67], a[88:91], v[56:59], v[64:67]
    ds_read_b128 v[48:51], v17 offset:7168
    v_mfma_f32_16x16x32_bf16 v[68:71], a[92:95], v[56:59], v[68:71]
    v_mfma_f32_16x16x32_bf16 v[72:75], a[88:91], v[60:63], v[72:75]
    ds_read_b128 v[52:55], v17 offset:23552
    v_mfma_f32_16x16x32_bf16 v[76:79], a[92:95], v[60:63], v[76:79]
    s_mov_b64 exec, s[44:45]
    buffer_store_dwordx4 v[24:27], v28, s[8:11], s46 offen sc1
    s_mov_b64 exec, -1
    s_waitcnt lgkmcnt(4)
    v_mfma_f32_16x16x32_bf16 v[64:67], a[96:99], v[32:35], v[64:67]
    ds_read_b128 v[56:59], v18 offset:7168
    s_add_u32 m0, s29, 104576
    v_mfma_f32_16x16x32_bf16 v[68:71], a[100:103], v[32:35], v[68:71]
    buffer_load_dwordx4 v16, s[16:19], s34 offen offset:896 lds
    v_mfma_f32_16x16x32_bf16 v[72:75], a[96:99], v[36:39], v[72:75]
    ds_read_b128 v[60:63], v18 offset:23552
    v_mfma_f32_16x16x32_bf16 v[76:79], a[100:103], v[36:39], v[76:79]
    s_waitcnt lgkmcnt(4)
    v_mfma_f32_16x16x32_bf16 v[64:67], a[104:107], v[40:43], v[64:67]
    s_add_u32 s34, s34, 64512
    s_min_u32 s34, s34, 4128768
    v_mfma_f32_16x16x32_bf16 v[68:71], a[108:111], v[40:43], v[68:71]
    v_mfma_f32_16x16x32_bf16 v[72:75], a[104:107], v[44:47], v[72:75]
    v_mfma_f32_16x16x32_bf16 v[76:79], a[108:111], v[44:47], v[76:79]
    s_waitcnt lgkmcnt(0)
    s_cmp_lt_u32 s35, 2
    s_cselect_b64 s[70:71], s[36:37], 0
    s_cbranch_scc0 .ef_399
    s_waitcnt vmcnt(5)
.ef_399:
    s_waitcnt vmcnt(19)
    s_barrier
    ds_read_b128 v[32:35], v17 offset:32768
    ds_read_b128 v[36:39], v17 offset:49152
    v_mfma_f32_16x16x32_bf16 v[64:67], a[112:115], v[48:51], v[64:67]
    ds_read_b128 v[40:43], v18 offset:32768
    s_add_u32 m0, s29, 0
    v_mfma_f32_16x16x32_bf16 v[68:71], a[116:119], v[48:51], v[68:71]
    buffer_load_dwordx4 v16, s[16:19], s34 offen offset:0 lds
    v_mfma_f32_16x16x32_bf16 v[72:75], a[112:115], v[52:55], v[72:75]
    ds_read_b128 v[44:47], v18 offset:49152
    v_mfma_f32_16x16x32_bf16 v[76:79], a[116:119], v[52:55], v[76:79]
    v_mfma_f32_16x16x32_bf16 v[64:67], a[120:123], v[56:59], v[64:67]
    ds_read_b128 v[48:51], v17 offset:33792
    v_mfma_f32_16x16x32_bf16 v[68:71], a[124:127], v[56:59], v[68:71]
    v_mfma_f32_16x16x32_bf16 v[72:75], a[120:123], v[60:63], v[72:75]
    ds_read_b128 v[52:55], v17 offset:50176
    v_mfma_f32_16x16x32_bf16 v[76:79], a[124:127], v[60:63], v[76:79]
    s_mov_b64 exec, s[70:71]
    buffer_store_dword v23, v22, s[8:11], s33 offen sc1
    s_mov_b64 exec, -1

    s_waitcnt lgkmcnt(4)
    v_mfma_f32_16x16x32_bf16 v[64:67], a[128:131], v[32:35], v[64:67]
    ds_read_b128 v[56:59], v18 offset:33792
    s_add_u32 m0, s29, 896
    v_mfma_f32_16x16x32_bf16 v[68:71], a[132:135], v[32:35], v[68:71]
    buffer_load_dwordx4 v16, s[16:19], s34 offen offset:128 lds
    v_mfma_f32_16x16x32_bf16 v[72:75], a[128:131], v[36:39], v[72:75]
    ds_read_b128 v[60:63], v18 offset:50176
    v_mfma_f32_16x16x32_bf16 v[76:79], a[132:135], v[36:39], v[76:79]
    s_waitcnt lgkmcnt(4)
    v_mfma_f32_16x16x32_bf16 v[64:67], a[136:139], v[40:43], v[64:67]
    ds_read_b128 v[32:35], v17 offset:34816
    v_mfma_f32_16x16x32_bf16 v[68:71], a[140:143], v[40:43], v[68:71]
    v_mfma_f32_16x16x32_bf16 v[72:75], a[136:139], v[44:47], v[72:75]
    ds_read_b128 v[36:39], v17 offset:51200
    v_mfma_f32_16x16x32_bf16 v[76:79], a[140:143], v[44:47], v[76:79]
    s_waitcnt lgkmcnt(4)
    v_mfma_f32_16x16x32_bf16 v[64:67], a[144:147], v[48:51], v[64:67]
    ds_read_b128 v[40:43], v18 offset:34816
    s_add_u32 m0, s29, 1792
    v_mfma_f32_16x16x32_bf16 v[68:71], a[148:151], v[48:51], v[68:71]
    buffer_load_dwordx4 v16, s[16:19], s34 offen offset:256 lds
    v_mfma_f32_16x16x32_bf16 v[72:75], a[144:147], v[52:55], v[72:75]
    ds_read_b128 v[44:47], v18 offset:51200
    v_mfma_f32_16x16x32_bf16 v[76:79], a[148:151], v[52:55], v[76:79]
    s_waitcnt lgkmcnt(4)
    v_mfma_f32_16x16x32_bf16 v[64:67], a[152:155], v[56:59], v[64:67]
    ds_read_b128 v[48:51], v17 offset:35840
    v_mfma_f32_16x16x32_bf16 v[68:71], a[156:159], v[56:59], v[68:71]
    v_mfma_f32_16x16x32_bf16 v[72:75], a[152:155], v[60:63], v[72:75]
    ds_read_b128 v[52:55], v17 offset:52224
    v_mfma_f32_16x16x32_bf16 v[76:79], a[156:159], v[60:63], v[76:79]
    s_waitcnt lgkmcnt(4)
    v_mfma_f32_16x16x32_bf16 v[64:67], a[160:163], v[32:35], v[64:67]
    ds_read_b128 v[56:59], v18 offset:35840
    s_add_u32 m0, s29, 2688
    v_mfma_f32_16x16x32_bf16 v[68:71], a[164:167], v[32:35], v[68:71]
    buffer_load_dwordx4 v16, s[16:19], s34 offen offset:384 lds
    v_mfma_f32_16x16x32_bf16 v[72:75], a[160:163], v[36:39], v[72:75]
    ds_read_b128 v[60:63], v18 offset:52224
    v_mfma_f32_16x16x32_bf16 v[76:79], a[164:167], v[36:39], v[76:79]
    s_waitcnt lgkmcnt(4)
    v_mfma_f32_16x16x32_bf16 v[64:67], a[168:171], v[40:43], v[64:67]
    ds_read_b128 v[32:35], v17 offset:36864
    v_mfma_f32_16x16x32_bf16 v[68:71], a[172:175], v[40:43], v[68:71]
    v_mfma_f32_16x16x32_bf16 v[72:75], a[168:171], v[44:47], v[72:75]
    ds_read_b128 v[36:39], v17 offset:53248
    v_mfma_f32_16x16x32_bf16 v[76:79], a[172:175], v[44:47], v[76:79]
    s_waitcnt lgkmcnt(4)
    v_mfma_f32_16x16x32_bf16 v[64:67], a[176:179], v[48:51], v[64:67]
    ds_read_b128 v[40:43], v18 offset:36864
    s_add_u32 m0, s29, 3584
    v_mfma_f32_16x16x32_bf16 v[68:71], a[180:183], v[48:51], v[68:71]
    buffer_load_dwordx4 v16, s[16:19], s34 offen offset:512 lds
    v_mfma_f32_16x16x32_bf16 v[72:75], a[176:179], v[52:55], v[72:75]
    ds_read_b128 v[44:47], v18 offset:53248
    v_mfma_f32_16x16x32_bf16 v[76:79], a[180:183], v[52:55], v[76:79]
    s_waitcnt lgkmcnt(4)
    v_mfma_f32_16x16x32_bf16 v[64:67], a[184:187], v[56:59], v[64:67]
    ds_read_b128 v[48:51], v17 offset:37888
    v_mfma_f32_16x16x32_bf16 v[68:71], a[188:191], v[56:59], v[68:71]
    v_mfma_f32_16x16x32_bf16 v[72:75], a[184:187], v[60:63], v[72:75]
    ds_read_b128 v[52:55], v17 offset:54272
    v_mfma_f32_16x16x32_bf16 v[76:79], a[188:191], v[60:63], v[76:79]
    s_waitcnt lgkmcnt(4)
    v_mfma_f32_16x16x32_bf16 v[64:67], a[192:195], v[32:35], v[64:67]
    ds_read_b128 v[56:59], v18 offset:37888
    s_add_u32 m0, s29, 4480
    v_mfma_f32_16x16x32_bf16 v[68:71], a[196:199], v[32:35], v[68:71]
    buffer_load_dwordx4 v16, s[16:19], s34 offen offset:640 lds
    v_mfma_f32_16x16x32_bf16 v[72:75], a[192:195], v[36:39], v[72:75]
    ds_read_b128 v[60:63], v18 offset:54272
    v_mfma_f32_16x16x32_bf16 v[76:79], a[196:199], v[36:39], v[76:79]
    s_waitcnt lgkmcnt(4)
    v_mfma_f32_16x16x32_bf16 v[64:67], a[200:203], v[40:43], v[64:67]
    ds_read_b128 v[32:35], v17 offset:38912
    v_mfma_f32_16x16x32_bf16 v[68:71], a[204:207], v[40:43], v[68:71]
    v_mfma_f32_16x16x32_bf16 v[72:75], a[200:203], v[44:47], v[72:75]
    ds_read_b128 v[36:39], v17 offset:55296
    v_mfma_f32_16x16x32_bf16 v[76:79], a[204:207], v[44:47], v[76:79]
    s_waitcnt lgkmcnt(4)
    v_mfma_f32_16x16x32_bf16 v[64:67], a[208:211], v[48:51], v[64:67]
    ds_read_b128 v[40:43], v18 offset:38912
    s_add_u32 m0, s29, 5376
    v_mfma_f32_16x16x32_bf16 v[68:71], a[212:215], v[48:51], v[68:71]
    buffer_load_dwordx4 v16, s[16:19], s34 offen offset:768 lds
    v_mfma_f32_16x16x32_bf16 v[72:75], a[208:211], v[52:55], v[72:75]
    ds_read_b128 v[44:47], v18 offset:55296
    v_mfma_f32_16x16x32_bf16 v[76:79], a[212:215], v[52:55], v[76:79]
    s_waitcnt lgkmcnt(4)
    v_mfma_f32_16x16x32_bf16 v[64:67], a[216:219], v[56:59], v[64:67]
    ds_read_b128 v[48:51], v17 offset:39936
    v_mfma_f32_16x16x32_bf16 v[68:71], a[220:223], v[56:59], v[68:71]
    v_mfma_f32_16x16x32_bf16 v[72:75], a[216:219], v[60:63], v[72:75]
    ds_read_b128 v[52:55], v17 offset:56320
    v_mfma_f32_16x16x32_bf16 v[76:79], a[220:223], v[60:63], v[76:79]
    s_mov_b64 exec, s[44:45]
    buffer_store_dwordx4 v[24:27], v29, s[8:11], s46 offen sc1
    s_mov_b64 exec, -1
    s_waitcnt lgkmcnt(4)
    v_mfma_f32_16x16x32_bf16 v[64:67], a[224:227], v[32:35], v[64:67]
    ds_read_b128 v[56:59], v18 offset:39936
    s_add_u32 m0, s29, 6272
    v_mfma_f32_16x16x32_bf16 v[68:71], a[228:231], v[32:35], v[68:71]
    buffer_load_dwordx4 v16, s[16:19], s34 offen offset:896 lds
    v_mfma_f32_16x16x32_bf16 v[72:75], a[224:227], v[36:39], v[72:75]
    ds_read_b128 v[60:63], v18 offset:56320
    v_mfma_f32_16x16x32_bf16 v[76:79], a[228:231], v[36:39], v[76:79]
    s_waitcnt lgkmcnt(4)
    v_mfma_f32_16x16x32_bf16 v[64:67], a[232:235], v[40:43], v[64:67]
    s_add_u32 s34, s34, 1024
    v_mfma_f32_16x16x32_bf16 v[68:71], a[236:239], v[40:43], v[68:71]
    v_mfma_f32_16x16x32_bf16 v[72:75], a[232:235], v[44:47], v[72:75]
    v_mfma_f32_16x16x32_bf16 v[76:79], a[236:239], v[44:47], v[76:79]
    s_waitcnt lgkmcnt(0)
    s_waitcnt vmcnt(13)
    s_barrier
    ds_read_b128 v[32:35], v19 offset:0
    ds_read_b128 v[36:39], v19 offset:16384
    v_mfma_f32_16x16x32_bf16 v[64:67], a[240:243], v[48:51], v[64:67]
    ds_read_b128 v[40:43], v20 offset:0
    s_add_u32 m0, s29, 32768
    v_mfma_f32_16x16x32_bf16 v[68:71], a[244:247], v[48:51], v[68:71]
    buffer_load_dwordx4 v16, s[16:19], s34 offen offset:0 lds
    v_mfma_f32_16x16x32_bf16 v[72:75], a[240:243], v[52:55], v[72:75]
    ds_read_b128 v[44:47], v20 offset:16384
    v_mfma_f32_16x16x32_bf16 v[76:79], a[244:247], v[52:55], v[76:79]
    v_mfma_f32_16x16x32_bf16 v[64:67], a[248:251], v[56:59], v[64:67]
    ds_read_b128 v[48:51], v19 offset:1024
    v_mfma_f32_16x16x32_bf16 v[68:71], a[252:255], v[56:59], v[68:71]
    v_mfma_f32_16x16x32_bf16 v[72:75], a[248:251], v[60:63], v[72:75]
    ds_read_b128 v[52:55], v19 offset:17408
    v_mfma_f32_16x16x32_bf16 v[76:79], a[252:255], v[60:63], v[76:79]
    s_mov_b64 exec, s[36:37]
    buffer_store_dword v23, v22, s[8:11], s33 offen sc1
    s_mov_b64 exec, -1

.qe_398:
    s_waitcnt lgkmcnt(4)
    v_mfma_f32_16x16x32_bf16 v[80:83], a[0:3], v[32:35], 0
    ds_read_b128 v[56:59], v20 offset:1024
    s_add_u32 m0, s29, 33664
    v_mfma_f32_16x16x32_bf16 v[84:87], a[4:7], v[32:35], 0
    buffer_load_dwordx4 v16, s[16:19], s34 offen offset:128 lds
    v_mfma_f32_16x16x32_bf16 v[88:91], a[0:3], v[36:39], 0
    ds_read_b128 v[60:63], v20 offset:17408
    v_mfma_f32_16x16x32_bf16 v[92:95], a[4:7], v[36:39], 0
    s_mov_b32 exec_hi, 0
    buffer_store_dwordx4 v[24:27], v21, s[8:11], s48 offen sc1
    s_mov_b32 exec_hi, -1

    s_waitcnt lgkmcnt(4)
    v_mfma_f32_16x16x32_bf16 v[80:83], a[8:11], v[40:43], v[80:83]
    ds_read_b128 v[32:35], v19 offset:2048
    v_mfma_f32_16x16x32_bf16 v[84:87], a[12:15], v[40:43], v[84:87]
    v_cvt_pk_bf16_f32 v96, v64, v65
    v_cvt_pk_bf16_f32 v97, v66, v67
    v_cvt_pk_bf16_f32 v98, v68, v69
    v_mfma_f32_16x16x32_bf16 v[88:91], a[8:11], v[44:47], v[88:91]
    ds_read_b128 v[36:39], v19 offset:18432
    v_mfma_f32_16x16x32_bf16 v[92:95], a[12:15], v[44:47], v[92:95]
    v_cvt_pk_bf16_f32 v99, v70, v71
    v_cvt_pk_bf16_f32 v100, v72, v73
    buffer_store_dwordx4 v[96:99], v21, s[8:11], s32 offen sc1
    s_waitcnt lgkmcnt(4)
    v_mfma_f32_16x16x32_bf16 v[80:83], a[16:19], v[48:51], v[80:83]
    ds_read_b128 v[40:43], v20 offset:2048
    s_add_u32 m0, s29, 34560
    v_mfma_f32_16x16x32_bf16 v[84:87], a[20:23], v[48:51], v[84:87]
    buffer_load_dwordx4 v16, s[16:19], s34 offen offset:256 lds
    v_mfma_f32_16x16x32_bf16 v[88:91], a[16:19], v[52:55], v[88:91]
    ds_read_b128 v[44:47], v20 offset:18432
    v_mfma_f32_16x16x32_bf16 v[92:95], a[20:23], v[52:55], v[92:95]
    v_cvt_pk_bf16_f32 v101, v74, v75
    v_cvt_pk_bf16_f32 v102, v76, v77
    v_cvt_pk_bf16_f32 v103, v78, v79
    s_waitcnt lgkmcnt(4)
    v_mfma_f32_16x16x32_bf16 v[80:83], a[24:27], v[56:59], v[80:83]
    ds_read_b128 v[48:51], v19 offset:3072
    v_mfma_f32_16x16x32_bf16 v[84:87], a[28:31], v[56:59], v[84:87]
    buffer_store_dwordx4 v[100:103], v21, s[8:11], s38 offen sc1
    v_mfma_f32_16x16x32_bf16 v[88:91], a[24:27], v[60:63], v[88:91]
    ds_read_b128 v[52:55], v19 offset:19456
    v_mfma_f32_16x16x32_bf16 v[92:95], a[28:31], v[60:63], v[92:95]
    s_waitcnt lgkmcnt(4)
    v_mfma_f32_16x16x32_bf16 v[80:83], a[32:35], v[32:35], v[80:83]
    ds_read_b128 v[56:59], v20 offset:3072
    s_add_u32 m0, s29, 35456
    v_mfma_f32_16x16x32_bf16 v[84:87], a[36:39], v[32:35], v[84:87]
    buffer_load_dwordx4 v16, s[16:19], s34 offen offset:384 lds
    v_mfma_f32_16x16x32_bf16 v[88:91], a[32:35], v[36:39], v[88:91]
    ds_read_b128 v[60:63], v20 offset:19456
    v_mfma_f32_16x16x32_bf16 v[92:95], a[36:39], v[36:39], v[92:95]
    s_waitcnt lgkmcnt(4)
    v_mfma_f32_16x16x32_bf16 v[80:83], a[40:43], v[40:43], v[80:83]
    ds_read_b128 v[32:35], v19 offset:4096
    v_mfma_f32_16x16x32_bf16 v[84:87], a[44:47], v[40:43], v[84:87]
    v_mfma_f32_16x16x32_bf16 v[88:91], a[40:43], v[44:47], v[88:91]
    ds_read_b128 v[36:39], v19 offset:20480
    v_mfma_f32_16x16x32_bf16 v[92:95], a[44:47], v[44:47], v[92:95]
    s_waitcnt lgkmcnt(4)
    v_mfma_f32_16x16x32_bf16 v[80:83], a[48:51], v[48:51], v[80:83]
    ds_read_b128 v[40:43], v20 offset:4096
    s_add_u32 m0, s29, 36352
    v_mfma_f32_16x16x32_bf16 v[84:87], a[52:55], v[48:51], v[84:87]
    buffer_load_dwordx4 v16, s[16:19], s34 offen offset:512 lds
    v_mfma_f32_16x16x32_bf16 v[88:91], a[48:51], v[52:55], v[88:91]
    ds_read_b128 v[44:47], v20 offset:20480
    v_mfma_f32_16x16x32_bf16 v[92:95], a[52:55], v[52:55], v[92:95]
    s_waitcnt lgkmcnt(4)
    v_mfma_f32_16x16x32_bf16 v[80:83], a[56:59], v[56:59], v[80:83]
    ds_read_b128 v[48:51], v19 offset:5120
    v_mfma_f32_16x16x32_bf16 v[84:87], a[60:63], v[56:59], v[84:87]
    v_mfma_f32_16x16x32_bf16 v[88:91], a[56:59], v[60:63], v[88:91]
    ds_read_b128 v[52:55], v19 offset:21504
    v_mfma_f32_16x16x32_bf16 v[92:95], a[60:63], v[60:63], v[92:95]
    s_waitcnt lgkmcnt(4)
    v_mfma_f32_16x16x32_bf16 v[80:83], a[64:67], v[32:35], v[80:83]
    ds_read_b128 v[56:59], v20 offset:5120
    s_add_u32 m0, s29, 37248
    v_mfma_f32_16x16x32_bf16 v[84:87], a[68:71], v[32:35], v[84:87]
    buffer_load_dwordx4 v16, s[16:19], s34 offen offset:640 lds
    v_mfma_f32_16x16x32_bf16 v[88:91], a[64:67], v[36:39], v[88:91]
    ds_read_b128 v[60:63], v20 offset:21504
    v_mfma_f32_16x16x32_bf16 v[92:95], a[68:71], v[36:39], v[92:95]
    s_waitcnt lgkmcnt(4)
    v_mfma_f32_16x16x32_bf16 v[80:83], a[72:75], v[40:43], v[80:83]
    ds_read_b128 v[32:35], v19 offset:6144
    v_mfma_f32_16x16x32_bf16 v[84:87], a[76:79], v[40:43], v[84:87]
    s_mov_b32 s32, s39
    s_add_u32 s38, s39, 4096
    s_add_u32 s39, s39, 262144
    s_mov_b32 s48, s49
    s_add_u32 s49, s49, 196608
    v_mfma_f32_16x16x32_bf16 v[88:91], a[72:75], v[44:47], v[88:91]
    ds_read_b128 v[36:39], v19 offset:22528
    v_mfma_f32_16x16x32_bf16 v[92:95], a[76:79], v[44:47], v[92:95]
    v_add_u32 v23, 1, v23
    s_waitcnt lgkmcnt(4)
    v_mfma_f32_16x16x32_bf16 v[80:83], a[80:83], v[48:51], v[80:83]
    ds_read_b128 v[40:43], v20 offset:6144
    s_add_u32 m0, s29, 38144
    v_mfma_f32_16x16x32_bf16 v[84:87], a[84:87], v[48:51], v[84:87]
    buffer_load_dwordx4 v16, s[16:19], s34 offen offset:768 lds
    v_mfma_f32_16x16x32_bf16 v[88:91], a[80:83], v[52:55], v[88:91]
    ds_read_b128 v[44:47], v20 offset:22528
    v_mfma_f32_16x16x32_bf16 v[92:95], a[84:87], v[52:55], v[92:95]
    s_waitcnt lgkmcnt(4)
    v_mfma_f32_16x16x32_bf16 v[80:83], a[88:91], v[56:59], v[80:83]
    ds_read_b128 v[48:51], v19 offset:7168
    v_mfma_f32_16x16x32_bf16 v[84:87], a[92:95], v[56:59], v[84:87]
    v_mfma_f32_16x16x32_bf16 v[88:91], a[88:91], v[60:63], v[88:91]
    ds_read_b128 v[52:55], v19 offset:23552
    v_mfma_f32_16x16x32_bf16 v[92:95], a[92:95], v[60:63], v[92:95]
    s_mov_b64 exec, s[44:45]
    buffer_store_dwordx4 v[24:27], v30, s[8:11], s46 offen sc1
    s_mov_b64 exec, -1
    s_waitcnt lgkmcnt(4)
    v_mfma_f32_16x16x32_bf16 v[80:83], a[96:99], v[32:35], v[80:83]
    ds_read_b128 v[56:59], v20 offset:7168
    s_add_u32 m0, s29, 39040
    v_mfma_f32_16x16x32_bf16 v[84:87], a[100:103], v[32:35], v[84:87]
    buffer_load_dwordx4 v16, s[16:19], s34 offen offset:896 lds
    v_mfma_f32_16x16x32_bf16 v[88:91], a[96:99], v[36:39], v[88:91]
    ds_read_b128 v[60:63], v20 offset:23552
    v_mfma_f32_16x16x32_bf16 v[92:95], a[100:103], v[36:39], v[92:95]
    s_waitcnt lgkmcnt(4)
    v_mfma_f32_16x16x32_bf16 v[80:83], a[104:107], v[40:43], v[80:83]
    s_add_u32 s34, s34, 64512
    s_min_u32 s34, s34, 4128768
    v_mfma_f32_16x16x32_bf16 v[84:87], a[108:111], v[40:43], v[84:87]
    v_mfma_f32_16x16x32_bf16 v[88:91], a[104:107], v[44:47], v[88:91]
    v_mfma_f32_16x16x32_bf16 v[92:95], a[108:111], v[44:47], v[92:95]
    s_waitcnt lgkmcnt(0)
    s_cmp_lt_u32 s35, 2
    s_cselect_b64 s[70:71], s[36:37], 0
    s_cbranch_scc0 .ef_400
    s_waitcnt vmcnt(5)
.ef_400:
    s_waitcnt vmcnt(19)
    s_barrier
    ds_read_b128 v[32:35], v19 offset:32768
    ds_read_b128 v[36:39], v19 offset:49152
    v_mfma_f32_16x16x32_bf16 v[80:83], a[112:115], v[48:51], v[80:83]
    ds_read_b128 v[40:43], v20 offset:32768
    s_add_u32 m0, s29, 65536
    v_mfma_f32_16x16x32_bf16 v[84:87], a[116:119], v[48:51], v[84:87]
    buffer_load_dwordx4 v16, s[16:19], s34 offen offset:0 lds
    v_mfma_f32_16x16x32_bf16 v[88:91], a[112:115], v[52:55], v[88:91]
    ds_read_b128 v[44:47], v20 offset:49152
    v_mfma_f32_16x16x32_bf16 v[92:95], a[116:119], v[52:55], v[92:95]
    v_mfma_f32_16x16x32_bf16 v[80:83], a[120:123], v[56:59], v[80:83]
    ds_read_b128 v[48:51], v19 offset:33792
    v_mfma_f32_16x16x32_bf16 v[84:87], a[124:127], v[56:59], v[84:87]
    v_mfma_f32_16x16x32_bf16 v[88:91], a[120:123], v[60:63], v[88:91]
    ds_read_b128 v[52:55], v19 offset:50176
    v_mfma_f32_16x16x32_bf16 v[92:95], a[124:127], v[60:63], v[92:95]
    s_mov_b64 exec, s[70:71]
    buffer_store_dword v23, v22, s[8:11], s33 offen sc1
    s_mov_b64 exec, -1

    s_waitcnt lgkmcnt(4)
    v_mfma_f32_16x16x32_bf16 v[80:83], a[128:131], v[32:35], v[80:83]
    ds_read_b128 v[56:59], v20 offset:33792
    s_add_u32 m0, s29, 66432
    v_mfma_f32_16x16x32_bf16 v[84:87], a[132:135], v[32:35], v[84:87]
    buffer_load_dwordx4 v16, s[16:19], s34 offen offset:128 lds
    v_mfma_f32_16x16x32_bf16 v[88:91], a[128:131], v[36:39], v[88:91]
    ds_read_b128 v[60:63], v20 offset:50176
    v_mfma_f32_16x16x32_bf16 v[92:95], a[132:135], v[36:39], v[92:95]
    s_waitcnt lgkmcnt(4)
    v_mfma_f32_16x16x32_bf16 v[80:83], a[136:139], v[40:43], v[80:83]
    ds_read_b128 v[32:35], v19 offset:34816
    v_mfma_f32_16x16x32_bf16 v[84:87], a[140:143], v[40:43], v[84:87]
    v_mfma_f32_16x16x32_bf16 v[88:91], a[136:139], v[44:47], v[88:91]
    ds_read_b128 v[36:39], v19 offset:51200
    v_mfma_f32_16x16x32_bf16 v[92:95], a[140:143], v[44:47], v[92:95]
    s_waitcnt lgkmcnt(4)
    v_mfma_f32_16x16x32_bf16 v[80:83], a[144:147], v[48:51], v[80:83]
    ds_read_b128 v[40:43], v20 offset:34816
    s_add_u32 m0, s29, 67328
    v_mfma_f32_16x16x32_bf16 v[84:87], a[148:151], v[48:51], v[84:87]
    buffer_load_dwordx4 v16, s[16:19], s34 offen offset:256 lds
    v_mfma_f32_16x16x32_bf16 v[88:91], a[144:147], v[52:55], v[88:91]
    ds_read_b128 v[44:47], v20 offset:51200
    v_mfma_f32_16x16x32_bf16 v[92:95], a[148:151], v[52:55], v[92:95]
    s_waitcnt lgkmcnt(4)
    v_mfma_f32_16x16x32_bf16 v[80:83], a[152:155], v[56:59], v[80:83]
    ds_read_b128 v[48:51], v19 offset:35840
    v_mfma_f32_16x16x32_bf16 v[84:87], a[156:159], v[56:59], v[84:87]
    v_mfma_f32_16x16x32_bf16 v[88:91], a[152:155], v[60:63], v[88:91]
    ds_read_b128 v[52:55], v19 offset:52224
    v_mfma_f32_16x16x32_bf16 v[92:95], a[156:159], v[60:63], v[92:95]
    s_waitcnt lgkmcnt(4)
    v_mfma_f32_16x16x32_bf16 v[80:83], a[160:163], v[32:35], v[80:83]
    ds_read_b128 v[56:59], v20 offset:35840
    s_add_u32 m0, s29, 68224
    v_mfma_f32_16x16x32_bf16 v[84:87], a[164:167], v[32:35], v[84:87]
    buffer_load_dwordx4 v16, s[16:19], s34 offen offset:384 lds
    v_mfma_f32_16x16x32_bf16 v[88:91], a[160:163], v[36:39], v[88:91]
    ds_read_b128 v[60:63], v20 offset:52224
    v_mfma_f32_16x16x32_bf16 v[92:95], a[164:167], v[36:39], v[92:95]
    s_waitcnt lgkmcnt(4)
    v_mfma_f32_16x16x32_bf16 v[80:83], a[168:171], v[40:43], v[80:83]
    ds_read_b128 v[32:35], v19 offset:36864
    v_mfma_f32_16x16x32_bf16 v[84:87], a[172:175], v[40:43], v[84:87]
    v_mfma_f32_16x16x32_bf16 v[88:91], a[168:171], v[44:47], v[88:91]
    ds_read_b128 v[36:39], v19 offset:53248
    v_mfma_f32_16x16x32_bf16 v[92:95], a[172:175], v[44:47], v[92:95]
    s_waitcnt lgkmcnt(4)
    v_mfma_f32_16x16x32_bf16 v[80:83], a[176:179], v[48:51], v[80:83]
    ds_read_b128 v[40:43], v20 offset:36864
    s_add_u32 m0, s29, 69120
    v_mfma_f32_16x16x32_bf16 v[84:87], a[180:183], v[48:51], v[84:87]
    buffer_load_dwordx4 v16, s[16:19], s34 offen offset:512 lds
    v_mfma_f32_16x16x32_bf16 v[88:91], a[176:179], v[52:55], v[88:91]
    ds_read_b128 v[44:47], v20 offset:53248
    v_mfma_f32_16x16x32_bf16 v[92:95], a[180:183], v[52:55], v[92:95]
    s_waitcnt lgkmcnt(4)
    v_mfma_f32_16x16x32_bf16 v[80:83], a[184:187], v[56:59], v[80:83]
    ds_read_b128 v[48:51], v19 offset:37888
    v_mfma_f32_16x16x32_bf16 v[84:87], a[188:191], v[56:59], v[84:87]
    v_mfma_f32_16x16x32_bf16 v[88:91], a[184:187], v[60:63], v[88:91]
    ds_read_b128 v[52:55], v19 offset:54272
    v_mfma_f32_16x16x32_bf16 v[92:95], a[188:191], v[60:63], v[92:95]
    s_waitcnt lgkmcnt(4)
    v_mfma_f32_16x16x32_bf16 v[80:83], a[192:195], v[32:35], v[80:83]
    ds_read_b128 v[56:59], v20 offset:37888
    s_add_u32 m0, s29, 70016
    v_mfma_f32_16x16x32_bf16 v[84:87], a[196:199], v[32:35], v[84:87]
    buffer_load_dwordx4 v16, s[16:19], s34 offen offset:640 lds
    v_mfma_f32_16x16x32_bf16 v[88:91], a[192:195], v[36:39], v[88:91]
    ds_read_b128 v[60:63], v20 offset:54272
    v_mfma_f32_16x16x32_bf16 v[92:95], a[196:199], v[36:39], v[92:95]
    s_waitcnt lgkmcnt(4)
    v_mfma_f32_16x16x32_bf16 v[80:83], a[200:203], v[40:43], v[80:83]
    ds_read_b128 v[32:35], v19 offset:38912
    v_mfma_f32_16x16x32_bf16 v[84:87], a[204:207], v[40:43], v[84:87]
    v_mfma_f32_16x16x32_bf16 v[88:91], a[200:203], v[44:47], v[88:91]
    ds_read_b128 v[36:39], v19 offset:55296
    v_mfma_f32_16x16x32_bf16 v[92:95], a[204:207], v[44:47], v[92:95]
    s_waitcnt lgkmcnt(4)
    v_mfma_f32_16x16x32_bf16 v[80:83], a[208:211], v[48:51], v[80:83]
    ds_read_b128 v[40:43], v20 offset:38912
    s_add_u32 m0, s29, 70912
    v_mfma_f32_16x16x32_bf16 v[84:87], a[212:215], v[48:51], v[84:87]
    buffer_load_dwordx4 v16, s[16:19], s34 offen offset:768 lds
    v_mfma_f32_16x16x32_bf16 v[88:91], a[208:211], v[52:55], v[88:91]
    ds_read_b128 v[44:47], v20 offset:55296
    v_mfma_f32_16x16x32_bf16 v[92:95], a[212:215], v[52:55], v[92:95]
    s_waitcnt lgkmcnt(4)
    v_mfma_f32_16x16x32_bf16 v[80:83], a[216:219], v[56:59], v[80:83]
    ds_read_b128 v[48:51], v19 offset:39936
    v_mfma_f32_16x16x32_bf16 v[84:87], a[220:223], v[56:59], v[84:87]
    s_cmp_lt_u32 s35, 21
    s_cselect_b64 s[44:45], -1, 0
    v_mfma_f32_16x16x32_bf16 v[88:91], a[216:219], v[60:63], v[88:91]
    ds_read_b128 v[52:55], v19 offset:56320
    v_mfma_f32_16x16x32_bf16 v[92:95], a[220:223], v[60:63], v[92:95]
    s_cselect_b32 s4, 0x10000, 0
    s_add_u32 s46, s46, s4
    s_waitcnt lgkmcnt(4)
    v_mfma_f32_16x16x32_bf16 v[80:83], a[224:227], v[32:35], v[80:83]
    ds_read_b128 v[56:59], v20 offset:39936
    s_add_u32 m0, s29, 71808
    v_mfma_f32_16x16x32_bf16 v[84:87], a[228:231], v[32:35], v[84:87]
    buffer_load_dwordx4 v16, s[16:19], s34 offen offset:896 lds
    v_mfma_f32_16x16x32_bf16 v[88:91], a[224:227], v[36:39], v[88:91]
    ds_read_b128 v[60:63], v20 offset:56320
    v_mfma_f32_16x16x32_bf16 v[92:95], a[228:231], v[36:39], v[92:95]
    s_waitcnt lgkmcnt(4)
    v_mfma_f32_16x16x32_bf16 v[80:83], a[232:235], v[40:43], v[80:83]
    s_add_u32 s34, s34, 1024
    v_mfma_f32_16x16x32_bf16 v[84:87], a[236:239], v[40:43], v[84:87]
    v_mfma_f32_16x16x32_bf16 v[88:91], a[232:235], v[44:47], v[88:91]
    v_mfma_f32_16x16x32_bf16 v[92:95], a[236:239], v[44:47], v[92:95]
    s_waitcnt lgkmcnt(0)
    s_waitcnt vmcnt(13)
    s_barrier
    ds_read_b128 v[32:35], v17 offset:0
    ds_read_b128 v[36:39], v17 offset:16384
    v_mfma_f32_16x16x32_bf16 v[80:83], a[240:243], v[48:51], v[80:83]
    ds_read_b128 v[40:43], v18 offset:0
    s_add_u32 m0, s29, 98304
    v_mfma_f32_16x16x32_bf16 v[84:87], a[244:247], v[48:51], v[84:87]
    buffer_load_dwordx4 v16, s[16:19], s34 offen offset:0 lds
    v_mfma_f32_16x16x32_bf16 v[88:91], a[240:243], v[52:55], v[88:91]
    ds_read_b128 v[44:47], v18 offset:16384
    v_mfma_f32_16x16x32_bf16 v[92:95], a[244:247], v[52:55], v[92:95]
    v_mfma_f32_16x16x32_bf16 v[80:83], a[248:251], v[56:59], v[80:83]
    ds_read_b128 v[48:51], v17 offset:1024
    v_mfma_f32_16x16x32_bf16 v[84:87], a[252:255], v[56:59], v[84:87]
    v_mfma_f32_16x16x32_bf16 v[88:91], a[248:251], v[60:63], v[88:91]
    ds_read_b128 v[52:55], v17 offset:17408
    v_mfma_f32_16x16x32_bf16 v[92:95], a[252:255], v[60:63], v[92:95]
    s_mov_b64 exec, s[36:37]
    buffer_store_dword v23, v22, s[8:11], s33 offen sc1
    s_mov_b64 exec, -1

    s_add_u32 s35, s35, 1
    s_cmp_lt_u32 s35, 32
    s_cbranch_scc1 .ql_397

    s_nop 7
    v_cvt_pk_bf16_f32 v96, v80, v81
    v_cvt_pk_bf16_f32 v97, v82, v83
    v_cvt_pk_bf16_f32 v98, v84, v85
    v_cvt_pk_bf16_f32 v99, v86, v87
    buffer_store_dwordx4 v[96:99], v21, s[8:11], s32 offen sc1
    v_cvt_pk_bf16_f32 v100, v88, v89
    v_cvt_pk_bf16_f32 v101, v90, v91
    v_cvt_pk_bf16_f32 v102, v92, v93
    v_cvt_pk_bf16_f32 v103, v94, v95
    buffer_store_dwordx4 v[100:103], v21, s[8:11], s38 offen sc1
    s_mov_b32 exec_hi, 0
    buffer_store_dwordx4 v[24:27], v21, s[8:11], s48 offen sc1
    s_mov_b32 exec_hi, -1

    v_mov_b32 v23, 64
    s_waitcnt vmcnt(0) lgkmcnt(0)
    s_barrier
    s_mov_b64 exec, s[36:37]
    buffer_store_dword v23, v22, s[8:11], s33 offen sc1
    s_mov_b64 exec, -1

    s_branch .qd_377
.qv_376:
    s_waitcnt vmcnt(16)
    s_barrier
    ds_read_b128 v[32:35], v19 offset:0
    ds_read_b128 v[36:39], v19 offset:16384
    ds_read_b128 v[40:43], v20 offset:0
    ds_read_b128 v[44:47], v20 offset:16384
    s_add_u32 m0, s29, 32768
    s_nop 0
    buffer_load_dwordx4 v16, s[16:19], s34 offen offset:0 lds
    ds_read_b128 v[48:51], v19 offset:1024
    ds_read_b128 v[52:55], v19 offset:17408
    s_branch .qe_402
.p2align 6
.ql_401:
    s_waitcnt lgkmcnt(4)
    v_mfma_f32_16x16x32_bf16 v[64:67], v[32:35], a[0:3], 0
    ds_read_b128 v[56:59], v18 offset:1024
    s_add_u32 m0, s29, 99200
    v_mfma_f32_16x16x32_bf16 v[68:71], v[32:35], a[4:7], 0
    buffer_load_dwordx4 v16, s[16:19], s34 offen offset:128 lds
    v_mfma_f32_16x16x32_bf16 v[72:75], v[36:39], a[0:3], 0
    ds_read_b128 v[60:63], v18 offset:17408
    v_mfma_f32_16x16x32_bf16 v[76:79], v[36:39], a[4:7], 0
    s_mov_b32 exec_hi, 0
    buffer_store_dwordx4 v[24:27], v21, s[8:11], s48 offen sc1
    s_mov_b32 exec_hi, -1

    s_waitcnt lgkmcnt(4)
    v_mfma_f32_16x16x32_bf16 v[64:67], v[40:43], a[8:11], v[64:67]
    ds_read_b128 v[32:35], v17 offset:2048
    v_mfma_f32_16x16x32_bf16 v[68:71], v[40:43], a[12:15], v[68:71]
    v_cvt_pk_bf16_f32 v96, v80, v81
    v_cvt_pk_bf16_f32 v97, v82, v83
    v_cvt_pk_bf16_f32 v98, v88, v89
    v_mfma_f32_16x16x32_bf16 v[72:75], v[44:47], a[8:11], v[72:75]
    ds_read_b128 v[36:39], v17 offset:18432
    v_mfma_f32_16x16x32_bf16 v[76:79], v[44:47], a[12:15], v[76:79]
    v_cvt_pk_bf16_f32 v99, v90, v91
    v_cvt_pk_bf16_f32 v100, v84, v85
    buffer_store_dwordx4 v[96:99], v21, s[8:11], s32 offen offset:0 sc1
    s_waitcnt lgkmcnt(4)
    v_mfma_f32_16x16x32_bf16 v[64:67], v[48:51], a[16:19], v[64:67]
    ds_read_b128 v[40:43], v18 offset:2048
    s_add_u32 m0, s29, 100096
    v_mfma_f32_16x16x32_bf16 v[68:71], v[48:51], a[20:23], v[68:71]
    buffer_load_dwordx4 v16, s[16:19], s34 offen offset:256 lds
    v_mfma_f32_16x16x32_bf16 v[72:75], v[52:55], a[16:19], v[72:75]
    ds_read_b128 v[44:47], v18 offset:18432
    v_mfma_f32_16x16x32_bf16 v[76:79], v[52:55], a[20:23], v[76:79]
    v_cvt_pk_bf16_f32 v101, v86, v87
    v_cvt_pk_bf16_f32 v102, v92, v93
    v_cvt_pk_bf16_f32 v103, v94, v95
    s_waitcnt lgkmcnt(4)
    v_mfma_f32_16x16x32_bf16 v[64:67], v[56:59], a[24:27], v[64:67]
    ds_read_b128 v[48:51], v17 offset:3072
    v_mfma_f32_16x16x32_bf16 v[68:71], v[56:59], a[28:31], v[68:71]
    buffer_store_dwordx4 v[100:103], v21, s[8:11], s32 offen offset:1024 sc1
    v_mfma_f32_16x16x32_bf16 v[72:75], v[60:63], a[24:27], v[72:75]
    ds_read_b128 v[52:55], v17 offset:19456
    v_mfma_f32_16x16x32_bf16 v[76:79], v[60:63], a[28:31], v[76:79]
    s_waitcnt lgkmcnt(4)
    v_mfma_f32_16x16x32_bf16 v[64:67], v[32:35], a[32:35], v[64:67]
    ds_read_b128 v[56:59], v18 offset:3072
    s_add_u32 m0, s29, 100992
    v_mfma_f32_16x16x32_bf16 v[68:71], v[32:35], a[36:39], v[68:71]
    buffer_load_dwordx4 v16, s[16:19], s34 offen offset:384 lds
    v_mfma_f32_16x16x32_bf16 v[72:75], v[36:39], a[32:35], v[72:75]
    ds_read_b128 v[60:63], v18 offset:19456
    v_mfma_f32_16x16x32_bf16 v[76:79], v[36:39], a[36:39], v[76:79]
    s_waitcnt lgkmcnt(4)
    v_mfma_f32_16x16x32_bf16 v[64:67], v[40:43], a[40:43], v[64:67]
    ds_read_b128 v[32:35], v17 offset:4096
    v_mfma_f32_16x16x32_bf16 v[68:71], v[40:43], a[44:47], v[68:71]
    v_mfma_f32_16x16x32_bf16 v[72:75], v[44:47], a[40:43], v[72:75]
    ds_read_b128 v[36:39], v17 offset:20480
    v_mfma_f32_16x16x32_bf16 v[76:79], v[44:47], a[44:47], v[76:79]
    s_waitcnt lgkmcnt(4)
    v_mfma_f32_16x16x32_bf16 v[64:67], v[48:51], a[48:51], v[64:67]
    ds_read_b128 v[40:43], v18 offset:4096
    s_add_u32 m0, s29, 101888
    v_mfma_f32_16x16x32_bf16 v[68:71], v[48:51], a[52:55], v[68:71]
    buffer_load_dwordx4 v16, s[16:19], s34 offen offset:512 lds
    v_mfma_f32_16x16x32_bf16 v[72:75], v[52:55], a[48:51], v[72:75]
    ds_read_b128 v[44:47], v18 offset:20480
    v_mfma_f32_16x16x32_bf16 v[76:79], v[52:55], a[52:55], v[76:79]
    s_waitcnt lgkmcnt(4)
    v_mfma_f32_16x16x32_bf16 v[64:67], v[56:59], a[56:59], v[64:67]
    ds_read_b128 v[48:51], v17 offset:5120
    v_mfma_f32_16x16x32_bf16 v[68:71], v[56:59], a[60:63], v[68:71]
    v_mfma_f32_16x16x32_bf16 v[72:75], v[60:63], a[56:59], v[72:75]
    ds_read_b128 v[52:55], v17 offset:21504
    v_mfma_f32_16x16x32_bf16 v[76:79], v[60:63], a[60:63], v[76:79]
    s_waitcnt lgkmcnt(4)
    v_mfma_f32_16x16x32_bf16 v[64:67], v[32:35], a[64:67], v[64:67]
    ds_read_b128 v[56:59], v18 offset:5120
    s_add_u32 m0, s29, 102784
    v_mfma_f32_16x16x32_bf16 v[68:71], v[32:35], a[68:71], v[68:71]
    buffer_load_dwordx4 v16, s[16:19], s34 offen offset:640 lds
    v_mfma_f32_16x16x32_bf16 v[72:75], v[36:39], a[64:67], v[72:75]
    ds_read_b128 v[60:63], v18 offset:21504
    v_mfma_f32_16x16x32_bf16 v[76:79], v[36:39], a[68:71], v[76:79]
    s_waitcnt lgkmcnt(4)
    v_mfma_f32_16x16x32_bf16 v[64:67], v[40:43], a[72:75], v[64:67]
    ds_read_b128 v[32:35], v17 offset:6144
    v_mfma_f32_16x16x32_bf16 v[68:71], v[40:43], a[76:79], v[68:71]
    s_mov_b32 s32, s39
    s_add_u32 s38, s39, 4096
    s_add_u32 s39, s39, 262144
    s_mov_b32 s48, s49
    s_add_u32 s49, s49, 196608
    v_mfma_f32_16x16x32_bf16 v[72:75], v[44:47], a[72:75], v[72:75]
    ds_read_b128 v[36:39], v17 offset:22528
    v_mfma_f32_16x16x32_bf16 v[76:79], v[44:47], a[76:79], v[76:79]
    v_add_u32 v23, 1, v23
    s_waitcnt lgkmcnt(4)
    v_mfma_f32_16x16x32_bf16 v[64:67], v[48:51], a[80:83], v[64:67]
    ds_read_b128 v[40:43], v18 offset:6144
    s_add_u32 m0, s29, 103680
    v_mfma_f32_16x16x32_bf16 v[68:71], v[48:51], a[84:87], v[68:71]
    buffer_load_dwordx4 v16, s[16:19], s34 offen offset:768 lds
    v_mfma_f32_16x16x32_bf16 v[72:75], v[52:55], a[80:83], v[72:75]
    ds_read_b128 v[44:47], v18 offset:22528
    v_mfma_f32_16x16x32_bf16 v[76:79], v[52:55], a[84:87], v[76:79]
    s_waitcnt lgkmcnt(4)
    v_mfma_f32_16x16x32_bf16 v[64:67], v[56:59], a[88:91], v[64:67]
    ds_read_b128 v[48:51], v17 offset:7168
    v_mfma_f32_16x16x32_bf16 v[68:71], v[56:59], a[92:95], v[68:71]
    v_mfma_f32_16x16x32_bf16 v[72:75], v[60:63], a[88:91], v[72:75]
    ds_read_b128 v[52:55], v17 offset:23552
    v_mfma_f32_16x16x32_bf16 v[76:79], v[60:63], a[92:95], v[76:79]
    s_mov_b64 exec, s[44:45]
    buffer_store_dwordx4 v[24:27], v28, s[8:11], s46 offen sc1
    s_mov_b64 exec, -1
    s_waitcnt lgkmcnt(4)
    v_mfma_f32_16x16x32_bf16 v[64:67], v[32:35], a[96:99], v[64:67]
    ds_read_b128 v[56:59], v18 offset:7168
    s_add_u32 m0, s29, 104576
    v_mfma_f32_16x16x32_bf16 v[68:71], v[32:35], a[100:103], v[68:71]
    buffer_load_dwordx4 v16, s[16:19], s34 offen offset:896 lds
    v_mfma_f32_16x16x32_bf16 v[72:75], v[36:39], a[96:99], v[72:75]
    ds_read_b128 v[60:63], v18 offset:23552
    v_mfma_f32_16x16x32_bf16 v[76:79], v[36:39], a[100:103], v[76:79]
    s_waitcnt lgkmcnt(4)
    v_mfma_f32_16x16x32_bf16 v[64:67], v[40:43], a[104:107], v[64:67]
    s_add_u32 s34, s34, 64512
    s_min_u32 s34, s34, 4128768
    v_mfma_f32_16x16x32_bf16 v[68:71], v[40:43], a[108:111], v[68:71]
    v_mfma_f32_16x16x32_bf16 v[72:75], v[44:47], a[104:107], v[72:75]
    v_mfma_f32_16x16x32_bf16 v[76:79], v[44:47], a[108:111], v[76:79]
    s_waitcnt lgkmcnt(0)
    s_cmp_lt_u32 s35, 2
    s_cselect_b64 s[70:71], s[36:37], 0
    s_cbranch_scc0 .ef_403
    s_waitcnt vmcnt(5)
.ef_403:
    s_waitcnt vmcnt(19)
    s_barrier
    ds_read_b128 v[32:35], v17 offset:32768
    ds_read_b128 v[36:39], v17 offset:49152
    v_mfma_f32_16x16x32_bf16 v[64:67], v[48:51], a[112:115], v[64:67]
    ds_read_b128 v[40:43], v18 offset:32768
    s_add_u32 m0, s29, 0
    v_mfma_f32_16x16x32_bf16 v[68:71], v[48:51], a[116:119], v[68:71]
    buffer_load_dwordx4 v16, s[16:19], s34 offen offset:0 lds
    v_mfma_f32_16x16x32_bf16 v[72:75], v[52:55], a[112:115], v[72:75]
    ds_read_b128 v[44:47], v18 offset:49152
    v_mfma_f32_16x16x32_bf16 v[76:79], v[52:55], a[116:119], v[76:79]
    v_mfma_f32_16x16x32_bf16 v[64:67], v[56:59], a[120:123], v[64:67]
    ds_read_b128 v[48:51], v17 offset:33792
    v_mfma_f32_16x16x32_bf16 v[68:71], v[56:59], a[124:127], v[68:71]
    v_mfma_f32_16x16x32_bf16 v[72:75], v[60:63], a[120:123], v[72:75]
    ds_read_b128 v[52:55], v17 offset:50176
    v_mfma_f32_16x16x32_bf16 v[76:79], v[60:63], a[124:127], v[76:79]
    s_mov_b64 exec, s[70:71]
    buffer_store_dword v23, v22, s[8:11], s33 offen sc1
    s_mov_b64 exec, -1

    s_waitcnt lgkmcnt(4)
    v_mfma_f32_16x16x32_bf16 v[64:67], v[32:35], a[128:131], v[64:67]
    ds_read_b128 v[56:59], v18 offset:33792
    s_add_u32 m0, s29, 896
    v_mfma_f32_16x16x32_bf16 v[68:71], v[32:35], a[132:135], v[68:71]
    buffer_load_dwordx4 v16, s[16:19], s34 offen offset:128 lds
    v_mfma_f32_16x16x32_bf16 v[72:75], v[36:39], a[128:131], v[72:75]
    ds_read_b128 v[60:63], v18 offset:50176
    v_mfma_f32_16x16x32_bf16 v[76:79], v[36:39], a[132:135], v[76:79]
    s_waitcnt lgkmcnt(4)
    v_mfma_f32_16x16x32_bf16 v[64:67], v[40:43], a[136:139], v[64:67]
    ds_read_b128 v[32:35], v17 offset:34816
    v_mfma_f32_16x16x32_bf16 v[68:71], v[40:43], a[140:143], v[68:71]
    v_mfma_f32_16x16x32_bf16 v[72:75], v[44:47], a[136:139], v[72:75]
    ds_read_b128 v[36:39], v17 offset:51200
    v_mfma_f32_16x16x32_bf16 v[76:79], v[44:47], a[140:143], v[76:79]
    s_waitcnt lgkmcnt(4)
    v_mfma_f32_16x16x32_bf16 v[64:67], v[48:51], a[144:147], v[64:67]
    ds_read_b128 v[40:43], v18 offset:34816
    s_add_u32 m0, s29, 1792
    v_mfma_f32_16x16x32_bf16 v[68:71], v[48:51], a[148:151], v[68:71]
    buffer_load_dwordx4 v16, s[16:19], s34 offen offset:256 lds
    v_mfma_f32_16x16x32_bf16 v[72:75], v[52:55], a[144:147], v[72:75]
    ds_read_b128 v[44:47], v18 offset:51200
    v_mfma_f32_16x16x32_bf16 v[76:79], v[52:55], a[148:151], v[76:79]
    s_waitcnt lgkmcnt(4)
    v_mfma_f32_16x16x32_bf16 v[64:67], v[56:59], a[152:155], v[64:67]
    ds_read_b128 v[48:51], v17 offset:35840
    v_mfma_f32_16x16x32_bf16 v[68:71], v[56:59], a[156:159], v[68:71]
    v_mfma_f32_16x16x32_bf16 v[72:75], v[60:63], a[152:155], v[72:75]
    ds_read_b128 v[52:55], v17 offset:52224
    v_mfma_f32_16x16x32_bf16 v[76:79], v[60:63], a[156:159], v[76:79]
    s_waitcnt lgkmcnt(4)
    v_mfma_f32_16x16x32_bf16 v[64:67], v[32:35], a[160:163], v[64:67]
    ds_read_b128 v[56:59], v18 offset:35840
    s_add_u32 m0, s29, 2688
    v_mfma_f32_16x16x32_bf16 v[68:71], v[32:35], a[164:167], v[68:71]
    buffer_load_dwordx4 v16, s[16:19], s34 offen offset:384 lds
    v_mfma_f32_16x16x32_bf16 v[72:75], v[36:39], a[160:163], v[72:75]
    ds_read_b128 v[60:63], v18 offset:52224
    v_mfma_f32_16x16x32_bf16 v[76:79], v[36:39], a[164:167], v[76:79]
    s_waitcnt lgkmcnt(4)
    v_mfma_f32_16x16x32_bf16 v[64:67], v[40:43], a[168:171], v[64:67]
    ds_read_b128 v[32:35], v17 offset:36864
    v_mfma_f32_16x16x32_bf16 v[68:71], v[40:43], a[172:175], v[68:71]
    v_mfma_f32_16x16x32_bf16 v[72:75], v[44:47], a[168:171], v[72:75]
    ds_read_b128 v[36:39], v17 offset:53248
    v_mfma_f32_16x16x32_bf16 v[76:79], v[44:47], a[172:175], v[76:79]
    s_waitcnt lgkmcnt(4)
    v_mfma_f32_16x16x32_bf16 v[64:67], v[48:51], a[176:179], v[64:67]
    ds_read_b128 v[40:43], v18 offset:36864
    s_add_u32 m0, s29, 3584
    v_mfma_f32_16x16x32_bf16 v[68:71], v[48:51], a[180:183], v[68:71]
    buffer_load_dwordx4 v16, s[16:19], s34 offen offset:512 lds
    v_mfma_f32_16x16x32_bf16 v[72:75], v[52:55], a[176:179], v[72:75]
    ds_read_b128 v[44:47], v18 offset:53248
    v_mfma_f32_16x16x32_bf16 v[76:79], v[52:55], a[180:183], v[76:79]
    s_waitcnt lgkmcnt(4)
    v_mfma_f32_16x16x32_bf16 v[64:67], v[56:59], a[184:187], v[64:67]
    ds_read_b128 v[48:51], v17 offset:37888
    v_mfma_f32_16x16x32_bf16 v[68:71], v[56:59], a[188:191], v[68:71]
    v_mfma_f32_16x16x32_bf16 v[72:75], v[60:63], a[184:187], v[72:75]
    ds_read_b128 v[52:55], v17 offset:54272
    v_mfma_f32_16x16x32_bf16 v[76:79], v[60:63], a[188:191], v[76:79]
    s_waitcnt lgkmcnt(4)
    v_mfma_f32_16x16x32_bf16 v[64:67], v[32:35], a[192:195], v[64:67]
    ds_read_b128 v[56:59], v18 offset:37888
    s_add_u32 m0, s29, 4480
    v_mfma_f32_16x16x32_bf16 v[68:71], v[32:35], a[196:199], v[68:71]
    buffer_load_dwordx4 v16, s[16:19], s34 offen offset:640 lds
    v_mfma_f32_16x16x32_bf16 v[72:75], v[36:39], a[192:195], v[72:75]
    ds_read_b128 v[60:63], v18 offset:54272
    v_mfma_f32_16x16x32_bf16 v[76:79], v[36:39], a[196:199], v[76:79]
    s_waitcnt lgkmcnt(4)
    v_mfma_f32_16x16x32_bf16 v[64:67], v[40:43], a[200:203], v[64:67]
    ds_read_b128 v[32:35], v17 offset:38912
    v_mfma_f32_16x16x32_bf16 v[68:71], v[40:43], a[204:207], v[68:71]
    v_mfma_f32_16x16x32_bf16 v[72:75], v[44:47], a[200:203], v[72:75]
    ds_read_b128 v[36:39], v17 offset:55296
    v_mfma_f32_16x16x32_bf16 v[76:79], v[44:47], a[204:207], v[76:79]
    s_waitcnt lgkmcnt(4)
    v_mfma_f32_16x16x32_bf16 v[64:67], v[48:51], a[208:211], v[64:67]
    ds_read_b128 v[40:43], v18 offset:38912
    s_add_u32 m0, s29, 5376
    v_mfma_f32_16x16x32_bf16 v[68:71], v[48:51], a[212:215], v[68:71]
    buffer_load_dwordx4 v16, s[16:19], s34 offen offset:768 lds
    v_mfma_f32_16x16x32_bf16 v[72:75], v[52:55], a[208:211], v[72:75]
    ds_read_b128 v[44:47], v18 offset:55296
    v_mfma_f32_16x16x32_bf16 v[76:79], v[52:55], a[212:215], v[76:79]
    s_waitcnt lgkmcnt(4)
    v_mfma_f32_16x16x32_bf16 v[64:67], v[56:59], a[216:219], v[64:67]
    ds_read_b128 v[48:51], v17 offset:39936
    v_mfma_f32_16x16x32_bf16 v[68:71], v[56:59], a[220:223], v[68:71]
    v_mfma_f32_16x16x32_bf16 v[72:75], v[60:63], a[216:219], v[72:75]
    ds_read_b128 v[52:55], v17 offset:56320
    v_mfma_f32_16x16x32_bf16 v[76:79], v[60:63], a[220:223], v[76:79]
    s_mov_b64 exec, s[44:45]
    buffer_store_dwordx4 v[24:27], v29, s[8:11], s46 offen sc1
    s_mov_b64 exec, -1
    s_waitcnt lgkmcnt(4)
    v_mfma_f32_16x16x32_bf16 v[64:67], v[32:35], a[224:227], v[64:67]
    ds_read_b128 v[56:59], v18 offset:39936
    s_add_u32 m0, s29, 6272
    v_mfma_f32_16x16x32_bf16 v[68:71], v[32:35], a[228:231], v[68:71]
    buffer_load_dwordx4 v16, s[16:19], s34 offen offset:896 lds
    v_mfma_f32_16x16x32_bf16 v[72:75], v[36:39], a[224:227], v[72:75]
    ds_read_b128 v[60:63], v18 offset:56320
    v_mfma_f32_16x16x32_bf16 v[76:79], v[36:39], a[228:231], v[76:79]
    s_waitcnt lgkmcnt(4)
    v_mfma_f32_16x16x32_bf16 v[64:67], v[40:43], a[232:235], v[64:67]
    s_add_u32 s34, s34, 1024
    v_mfma_f32_16x16x32_bf16 v[68:71], v[40:43], a[236:239], v[68:71]
    v_mfma_f32_16x16x32_bf16 v[72:75], v[44:47], a[232:235], v[72:75]
    v_mfma_f32_16x16x32_bf16 v[76:79], v[44:47], a[236:239], v[76:79]
    s_waitcnt lgkmcnt(0)
    s_waitcnt vmcnt(13)
    s_barrier
    ds_read_b128 v[32:35], v19 offset:0
    ds_read_b128 v[36:39], v19 offset:16384
    v_mfma_f32_16x16x32_bf16 v[64:67], v[48:51], a[240:243], v[64:67]
    ds_read_b128 v[40:43], v20 offset:0
    s_add_u32 m0, s29, 32768
    v_mfma_f32_16x16x32_bf16 v[68:71], v[48:51], a[244:247], v[68:71]
    buffer_load_dwordx4 v16, s[16:19], s34 offen offset:0 lds
    v_mfma_f32_16x16x32_bf16 v[72:75], v[52:55], a[240:243], v[72:75]
    ds_read_b128 v[44:47], v20 offset:16384
    v_mfma_f32_16x16x32_bf16 v[76:79], v[52:55], a[244:247], v[76:79]
    v_mfma_f32_16x16x32_bf16 v[64:67], v[56:59], a[248:251], v[64:67]
    ds_read_b128 v[48:51], v19 offset:1024
    v_mfma_f32_16x16x32_bf16 v[68:71], v[56:59], a[252:255], v[68:71]
    v_mfma_f32_16x16x32_bf16 v[72:75], v[60:63], a[248:251], v[72:75]
    ds_read_b128 v[52:55], v19 offset:17408
    v_mfma_f32_16x16x32_bf16 v[76:79], v[60:63], a[252:255], v[76:79]
    s_mov_b64 exec, s[36:37]
    buffer_store_dword v23, v22, s[8:11], s33 offen sc1
    s_mov_b64 exec, -1

.qe_402:
    s_waitcnt lgkmcnt(4)
    v_mfma_f32_16x16x32_bf16 v[80:83], v[32:35], a[0:3], 0
    ds_read_b128 v[56:59], v20 offset:1024
    s_add_u32 m0, s29, 33664
    v_mfma_f32_16x16x32_bf16 v[84:87], v[32:35], a[4:7], 0
    buffer_load_dwordx4 v16, s[16:19], s34 offen offset:128 lds
    v_mfma_f32_16x16x32_bf16 v[88:91], v[36:39], a[0:3], 0
    ds_read_b128 v[60:63], v20 offset:17408
    v_mfma_f32_16x16x32_bf16 v[92:95], v[36:39], a[4:7], 0
    s_mov_b32 exec_hi, 0
    buffer_store_dwordx4 v[24:27], v21, s[8:11], s48 offen sc1
    s_mov_b32 exec_hi, -1

    s_waitcnt lgkmcnt(4)
    v_mfma_f32_16x16x32_bf16 v[80:83], v[40:43], a[8:11], v[80:83]
    ds_read_b128 v[32:35], v19 offset:2048
    v_mfma_f32_16x16x32_bf16 v[84:87], v[40:43], a[12:15], v[84:87]
    v_cvt_pk_bf16_f32 v96, v64, v65
    v_cvt_pk_bf16_f32 v97, v66, v67
    v_cvt_pk_bf16_f32 v98, v72, v73
    v_mfma_f32_16x16x32_bf16 v[88:91], v[44:47], a[8:11], v[88:91]
    ds_read_b128 v[36:39], v19 offset:18432
    v_mfma_f32_16x16x32_bf16 v[92:95], v[44:47], a[12:15], v[92:95]
    v_cvt_pk_bf16_f32 v99, v74, v75
    v_cvt_pk_bf16_f32 v100, v68, v69
    buffer_store_dwordx4 v[96:99], v21, s[8:11], s32 offen offset:0 sc1
    s_waitcnt lgkmcnt(4)
    v_mfma_f32_16x16x32_bf16 v[80:83], v[48:51], a[16:19], v[80:83]
    ds_read_b128 v[40:43], v20 offset:2048
    s_add_u32 m0, s29, 34560
    v_mfma_f32_16x16x32_bf16 v[84:87], v[48:51], a[20:23], v[84:87]
    buffer_load_dwordx4 v16, s[16:19], s34 offen offset:256 lds
    v_mfma_f32_16x16x32_bf16 v[88:91], v[52:55], a[16:19], v[88:91]
    ds_read_b128 v[44:47], v20 offset:18432
    v_mfma_f32_16x16x32_bf16 v[92:95], v[52:55], a[20:23], v[92:95]
    v_cvt_pk_bf16_f32 v101, v70, v71
    v_cvt_pk_bf16_f32 v102, v76, v77
    v_cvt_pk_bf16_f32 v103, v78, v79
    s_waitcnt lgkmcnt(4)
    v_mfma_f32_16x16x32_bf16 v[80:83], v[56:59], a[24:27], v[80:83]
    ds_read_b128 v[48:51], v19 offset:3072
    v_mfma_f32_16x16x32_bf16 v[84:87], v[56:59], a[28:31], v[84:87]
    buffer_store_dwordx4 v[100:103], v21, s[8:11], s32 offen offset:1024 sc1
    v_mfma_f32_16x16x32_bf16 v[88:91], v[60:63], a[24:27], v[88:91]
    ds_read_b128 v[52:55], v19 offset:19456
    v_mfma_f32_16x16x32_bf16 v[92:95], v[60:63], a[28:31], v[92:95]
    s_waitcnt lgkmcnt(4)
    v_mfma_f32_16x16x32_bf16 v[80:83], v[32:35], a[32:35], v[80:83]
    ds_read_b128 v[56:59], v20 offset:3072
    s_add_u32 m0, s29, 35456
    v_mfma_f32_16x16x32_bf16 v[84:87], v[32:35], a[36:39], v[84:87]
    buffer_load_dwordx4 v16, s[16:19], s34 offen offset:384 lds
    v_mfma_f32_16x16x32_bf16 v[88:91], v[36:39], a[32:35], v[88:91]
    ds_read_b128 v[60:63], v20 offset:19456
    v_mfma_f32_16x16x32_bf16 v[92:95], v[36:39], a[36:39], v[92:95]
    s_waitcnt lgkmcnt(4)
    v_mfma_f32_16x16x32_bf16 v[80:83], v[40:43], a[40:43], v[80:83]
    ds_read_b128 v[32:35], v19 offset:4096
    v_mfma_f32_16x16x32_bf16 v[84:87], v[40:43], a[44:47], v[84:87]
    v_mfma_f32_16x16x32_bf16 v[88:91], v[44:47], a[40:43], v[88:91]
    ds_read_b128 v[36:39], v19 offset:20480
    v_mfma_f32_16x16x32_bf16 v[92:95], v[44:47], a[44:47], v[92:95]
    s_waitcnt lgkmcnt(4)
    v_mfma_f32_16x16x32_bf16 v[80:83], v[48:51], a[48:51], v[80:83]
    ds_read_b128 v[40:43], v20 offset:4096
    s_add_u32 m0, s29, 36352
    v_mfma_f32_16x16x32_bf16 v[84:87], v[48:51], a[52:55], v[84:87]
    buffer_load_dwordx4 v16, s[16:19], s34 offen offset:512 lds
    v_mfma_f32_16x16x32_bf16 v[88:91], v[52:55], a[48:51], v[88:91]
    ds_read_b128 v[44:47], v20 offset:20480
    v_mfma_f32_16x16x32_bf16 v[92:95], v[52:55], a[52:55], v[92:95]
    s_waitcnt lgkmcnt(4)
    v_mfma_f32_16x16x32_bf16 v[80:83], v[56:59], a[56:59], v[80:83]
    ds_read_b128 v[48:51], v19 offset:5120
    v_mfma_f32_16x16x32_bf16 v[84:87], v[56:59], a[60:63], v[84:87]
    v_mfma_f32_16x16x32_bf16 v[88:91], v[60:63], a[56:59], v[88:91]
    ds_read_b128 v[52:55], v19 offset:21504
    v_mfma_f32_16x16x32_bf16 v[92:95], v[60:63], a[60:63], v[92:95]
    s_waitcnt lgkmcnt(4)
    v_mfma_f32_16x16x32_bf16 v[80:83], v[32:35], a[64:67], v[80:83]
    ds_read_b128 v[56:59], v20 offset:5120
    s_add_u32 m0, s29, 37248
    v_mfma_f32_16x16x32_bf16 v[84:87], v[32:35], a[68:71], v[84:87]
    buffer_load_dwordx4 v16, s[16:19], s34 offen offset:640 lds
    v_mfma_f32_16x16x32_bf16 v[88:91], v[36:39], a[64:67], v[88:91]
    ds_read_b128 v[60:63], v20 offset:21504
    v_mfma_f32_16x16x32_bf16 v[92:95], v[36:39], a[68:71], v[92:95]
    s_waitcnt lgkmcnt(4)
    v_mfma_f32_16x16x32_bf16 v[80:83], v[40:43], a[72:75], v[80:83]
    ds_read_b128 v[32:35], v19 offset:6144
    v_mfma_f32_16x16x32_bf16 v[84:87], v[40:43], a[76:79], v[84:87]
    s_mov_b32 s32, s39
    s_add_u32 s38, s39, 4096
    s_add_u32 s39, s39, 262144
    s_mov_b32 s48, s49
    s_add_u32 s49, s49, 196608
    v_mfma_f32_16x16x32_bf16 v[88:91], v[44:47], a[72:75], v[88:91]
    ds_read_b128 v[36:39], v19 offset:22528
    v_mfma_f32_16x16x32_bf16 v[92:95], v[44:47], a[76:79], v[92:95]
    v_add_u32 v23, 1, v23
    s_waitcnt lgkmcnt(4)
    v_mfma_f32_16x16x32_bf16 v[80:83], v[48:51], a[80:83], v[80:83]
    ds_read_b128 v[40:43], v20 offset:6144
    s_add_u32 m0, s29, 38144
    v_mfma_f32_16x16x32_bf16 v[84:87], v[48:51], a[84:87], v[84:87]
    buffer_load_dwordx4 v16, s[16:19], s34 offen offset:768 lds
    v_mfma_f32_16x16x32_bf16 v[88:91], v[52:55], a[80:83], v[88:91]
    ds_read_b128 v[44:47], v20 offset:22528
    v_mfma_f32_16x16x32_bf16 v[92:95], v[52:55], a[84:87], v[92:95]
    s_waitcnt lgkmcnt(4)
    v_mfma_f32_16x16x32_bf16 v[80:83], v[56:59], a[88:91], v[80:83]
    ds_read_b128 v[48:51], v19 offset:7168
    v_mfma_f32_16x16x32_bf16 v[84:87], v[56:59], a[92:95], v[84:87]
    v_mfma_f32_16x16x32_bf16 v[88:91], v[60:63], a[88:91], v[88:91]
    ds_read_b128 v[52:55], v19 offset:23552
    v_mfma_f32_16x16x32_bf16 v[92:95], v[60:63], a[92:95], v[92:95]
    s_mov_b64 exec, s[44:45]
    buffer_store_dwordx4 v[24:27], v30, s[8:11], s46 offen sc1
    s_mov_b64 exec, -1
    s_waitcnt lgkmcnt(4)
    v_mfma_f32_16x16x32_bf16 v[80:83], v[32:35], a[96:99], v[80:83]
    ds_read_b128 v[56:59], v20 offset:7168
    s_add_u32 m0, s29, 39040
    v_mfma_f32_16x16x32_bf16 v[84:87], v[32:35], a[100:103], v[84:87]
    buffer_load_dwordx4 v16, s[16:19], s34 offen offset:896 lds
    v_mfma_f32_16x16x32_bf16 v[88:91], v[36:39], a[96:99], v[88:91]
    ds_read_b128 v[60:63], v20 offset:23552
    v_mfma_f32_16x16x32_bf16 v[92:95], v[36:39], a[100:103], v[92:95]
    s_waitcnt lgkmcnt(4)
    v_mfma_f32_16x16x32_bf16 v[80:83], v[40:43], a[104:107], v[80:83]
    s_add_u32 s34, s34, 64512
    s_min_u32 s34, s34, 4128768
    v_mfma_f32_16x16x32_bf16 v[84:87], v[40:43], a[108:111], v[84:87]
    v_mfma_f32_16x16x32_bf16 v[88:91], v[44:47], a[104:107], v[88:91]
    v_mfma_f32_16x16x32_bf16 v[92:95], v[44:47], a[108:111], v[92:95]
    s_waitcnt lgkmcnt(0)
    s_cmp_lt_u32 s35, 2
    s_cselect_b64 s[70:71], s[36:37], 0
    s_cbranch_scc0 .ef_404
    s_waitcnt vmcnt(5)
.ef_404:
    s_waitcnt vmcnt(19)
    s_barrier
    ds_read_b128 v[32:35], v19 offset:32768
    ds_read_b128 v[36:39], v19 offset:49152
    v_mfma_f32_16x16x32_bf16 v[80:83], v[48:51], a[112:115], v[80:83]
    ds_read_b128 v[40:43], v20 offset:32768
    s_add_u32 m0, s29, 65536
    v_mfma_f32_16x16x32_bf16 v[84:87], v[48:51], a[116:119], v[84:87]
    buffer_load_dwordx4 v16, s[16:19], s34 offen offset:0 lds
    v_mfma_f32_16x16x32_bf16 v[88:91], v[52:55], a[112:115], v[88:91]
    ds_read_b128 v[44:47], v20 offset:49152
    v_mfma_f32_16x16x32_bf16 v[92:95], v[52:55], a[116:119], v[92:95]
    v_mfma_f32_16x16x32_bf16 v[80:83], v[56:59], a[120:123], v[80:83]
    ds_read_b128 v[48:51], v19 offset:33792
    v_mfma_f32_16x16x32_bf16 v[84:87], v[56:59], a[124:127], v[84:87]
    v_mfma_f32_16x16x32_bf16 v[88:91], v[60:63], a[120:123], v[88:91]
    ds_read_b128 v[52:55], v19 offset:50176
    v_mfma_f32_16x16x32_bf16 v[92:95], v[60:63], a[124:127], v[92:95]
    s_mov_b64 exec, s[70:71]
    buffer_store_dword v23, v22, s[8:11], s33 offen sc1
    s_mov_b64 exec, -1

    s_waitcnt lgkmcnt(4)
    v_mfma_f32_16x16x32_bf16 v[80:83], v[32:35], a[128:131], v[80:83]
    ds_read_b128 v[56:59], v20 offset:33792
    s_add_u32 m0, s29, 66432
    v_mfma_f32_16x16x32_bf16 v[84:87], v[32:35], a[132:135], v[84:87]
    buffer_load_dwordx4 v16, s[16:19], s34 offen offset:128 lds
    v_mfma_f32_16x16x32_bf16 v[88:91], v[36:39], a[128:131], v[88:91]
    ds_read_b128 v[60:63], v20 offset:50176
    v_mfma_f32_16x16x32_bf16 v[92:95], v[36:39], a[132:135], v[92:95]
    s_waitcnt lgkmcnt(4)
    v_mfma_f32_16x16x32_bf16 v[80:83], v[40:43], a[136:139], v[80:83]
    ds_read_b128 v[32:35], v19 offset:34816
    v_mfma_f32_16x16x32_bf16 v[84:87], v[40:43], a[140:143], v[84:87]
    v_mfma_f32_16x16x32_bf16 v[88:91], v[44:47], a[136:139], v[88:91]
    ds_read_b128 v[36:39], v19 offset:51200
    v_mfma_f32_16x16x32_bf16 v[92:95], v[44:47], a[140:143], v[92:95]
    s_waitcnt lgkmcnt(4)
    v_mfma_f32_16x16x32_bf16 v[80:83], v[48:51], a[144:147], v[80:83]
    ds_read_b128 v[40:43], v20 offset:34816
    s_add_u32 m0, s29, 67328
    v_mfma_f32_16x16x32_bf16 v[84:87], v[48:51], a[148:151], v[84:87]
    buffer_load_dwordx4 v16, s[16:19], s34 offen offset:256 lds
    v_mfma_f32_16x16x32_bf16 v[88:91], v[52:55], a[144:147], v[88:91]
    ds_read_b128 v[44:47], v20 offset:51200
    v_mfma_f32_16x16x32_bf16 v[92:95], v[52:55], a[148:151], v[92:95]
    s_waitcnt lgkmcnt(4)
    v_mfma_f32_16x16x32_bf16 v[80:83], v[56:59], a[152:155], v[80:83]
    ds_read_b128 v[48:51], v19 offset:35840
    v_mfma_f32_16x16x32_bf16 v[84:87], v[56:59], a[156:159], v[84:87]
    v_mfma_f32_16x16x32_bf16 v[88:91], v[60:63], a[152:155], v[88:91]
    ds_read_b128 v[52:55], v19 offset:52224
    v_mfma_f32_16x16x32_bf16 v[92:95], v[60:63], a[156:159], v[92:95]
    s_waitcnt lgkmcnt(4)
    v_mfma_f32_16x16x32_bf16 v[80:83], v[32:35], a[160:163], v[80:83]
    ds_read_b128 v[56:59], v20 offset:35840
    s_add_u32 m0, s29, 68224
    v_mfma_f32_16x16x32_bf16 v[84:87], v[32:35], a[164:167], v[84:87]
    buffer_load_dwordx4 v16, s[16:19], s34 offen offset:384 lds
    v_mfma_f32_16x16x32_bf16 v[88:91], v[36:39], a[160:163], v[88:91]
    ds_read_b128 v[60:63], v20 offset:52224
    v_mfma_f32_16x16x32_bf16 v[92:95], v[36:39], a[164:167], v[92:95]
    s_waitcnt lgkmcnt(4)
    v_mfma_f32_16x16x32_bf16 v[80:83], v[40:43], a[168:171], v[80:83]
    ds_read_b128 v[32:35], v19 offset:36864
    v_mfma_f32_16x16x32_bf16 v[84:87], v[40:43], a[172:175], v[84:87]
    v_mfma_f32_16x16x32_bf16 v[88:91], v[44:47], a[168:171], v[88:91]
    ds_read_b128 v[36:39], v19 offset:53248
    v_mfma_f32_16x16x32_bf16 v[92:95], v[44:47], a[172:175], v[92:95]
    s_waitcnt lgkmcnt(4)
    v_mfma_f32_16x16x32_bf16 v[80:83], v[48:51], a[176:179], v[80:83]
    ds_read_b128 v[40:43], v20 offset:36864
    s_add_u32 m0, s29, 69120
    v_mfma_f32_16x16x32_bf16 v[84:87], v[48:51], a[180:183], v[84:87]
    buffer_load_dwordx4 v16, s[16:19], s34 offen offset:512 lds
    v_mfma_f32_16x16x32_bf16 v[88:91], v[52:55], a[176:179], v[88:91]
    ds_read_b128 v[44:47], v20 offset:53248
    v_mfma_f32_16x16x32_bf16 v[92:95], v[52:55], a[180:183], v[92:95]
    s_waitcnt lgkmcnt(4)
    v_mfma_f32_16x16x32_bf16 v[80:83], v[56:59], a[184:187], v[80:83]
    ds_read_b128 v[48:51], v19 offset:37888
    v_mfma_f32_16x16x32_bf16 v[84:87], v[56:59], a[188:191], v[84:87]
    v_mfma_f32_16x16x32_bf16 v[88:91], v[60:63], a[184:187], v[88:91]
    ds_read_b128 v[52:55], v19 offset:54272
    v_mfma_f32_16x16x32_bf16 v[92:95], v[60:63], a[188:191], v[92:95]
    s_waitcnt lgkmcnt(4)
    v_mfma_f32_16x16x32_bf16 v[80:83], v[32:35], a[192:195], v[80:83]
    ds_read_b128 v[56:59], v20 offset:37888
    s_add_u32 m0, s29, 70016
    v_mfma_f32_16x16x32_bf16 v[84:87], v[32:35], a[196:199], v[84:87]
    buffer_load_dwordx4 v16, s[16:19], s34 offen offset:640 lds
    v_mfma_f32_16x16x32_bf16 v[88:91], v[36:39], a[192:195], v[88:91]
    ds_read_b128 v[60:63], v20 offset:54272
    v_mfma_f32_16x16x32_bf16 v[92:95], v[36:39], a[196:199], v[92:95]
    s_waitcnt lgkmcnt(4)
    v_mfma_f32_16x16x32_bf16 v[80:83], v[40:43], a[200:203], v[80:83]
    ds_read_b128 v[32:35], v19 offset:38912
    v_mfma_f32_16x16x32_bf16 v[84:87], v[40:43], a[204:207], v[84:87]
    v_mfma_f32_16x16x32_bf16 v[88:91], v[44:47], a[200:203], v[88:91]
    ds_read_b128 v[36:39], v19 offset:55296
    v_mfma_f32_16x16x32_bf16 v[92:95], v[44:47], a[204:207], v[92:95]
    s_waitcnt lgkmcnt(4)
    v_mfma_f32_16x16x32_bf16 v[80:83], v[48:51], a[208:211], v[80:83]
    ds_read_b128 v[40:43], v20 offset:38912
    s_add_u32 m0, s29, 70912
    v_mfma_f32_16x16x32_bf16 v[84:87], v[48:51], a[212:215], v[84:87]
    buffer_load_dwordx4 v16, s[16:19], s34 offen offset:768 lds
    v_mfma_f32_16x16x32_bf16 v[88:91], v[52:55], a[208:211], v[88:91]
    ds_read_b128 v[44:47], v20 offset:55296
    v_mfma_f32_16x16x32_bf16 v[92:95], v[52:55], a[212:215], v[92:95]
    s_waitcnt lgkmcnt(4)
    v_mfma_f32_16x16x32_bf16 v[80:83], v[56:59], a[216:219], v[80:83]
    ds_read_b128 v[48:51], v19 offset:39936
    v_mfma_f32_16x16x32_bf16 v[84:87], v[56:59], a[220:223], v[84:87]
    s_cmp_lt_u32 s35, 21
    s_cselect_b64 s[44:45], -1, 0
    v_mfma_f32_16x16x32_bf16 v[88:91], v[60:63], a[216:219], v[88:91]
    ds_read_b128 v[52:55], v19 offset:56320
    v_mfma_f32_16x16x32_bf16 v[92:95], v[60:63], a[220:223], v[92:95]
    s_cselect_b32 s4, 0x10000, 0
    s_add_u32 s46, s46, s4
    s_waitcnt lgkmcnt(4)
    v_mfma_f32_16x16x32_bf16 v[80:83], v[32:35], a[224:227], v[80:83]
    ds_read_b128 v[56:59], v20 offset:39936
    s_add_u32 m0, s29, 71808
    v_mfma_f32_16x16x32_bf16 v[84:87], v[32:35], a[228:231], v[84:87]
    buffer_load_dwordx4 v16, s[16:19], s34 offen offset:896 lds
    v_mfma_f32_16x16x32_bf16 v[88:91], v[36:39], a[224:227], v[88:91]
    ds_read_b128 v[60:63], v20 offset:56320
    v_mfma_f32_16x16x32_bf16 v[92:95], v[36:39], a[228:231], v[92:95]
    s_waitcnt lgkmcnt(4)
    v_mfma_f32_16x16x32_bf16 v[80:83], v[40:43], a[232:235], v[80:83]
    s_add_u32 s34, s34, 1024
    v_mfma_f32_16x16x32_bf16 v[84:87], v[40:43], a[236:239], v[84:87]
    v_mfma_f32_16x16x32_bf16 v[88:91], v[44:47], a[232:235], v[88:91]
    v_mfma_f32_16x16x32_bf16 v[92:95], v[44:47], a[236:239], v[92:95]
    s_waitcnt lgkmcnt(0)
    s_waitcnt vmcnt(13)
    s_barrier
    ds_read_b128 v[32:35], v17 offset:0
    ds_read_b128 v[36:39], v17 offset:16384
    v_mfma_f32_16x16x32_bf16 v[80:83], v[48:51], a[240:243], v[80:83]
    ds_read_b128 v[40:43], v18 offset:0
    s_add_u32 m0, s29, 98304
    v_mfma_f32_16x16x32_bf16 v[84:87], v[48:51], a[244:247], v[84:87]
    buffer_load_dwordx4 v16, s[16:19], s34 offen offset:0 lds
    v_mfma_f32_16x16x32_bf16 v[88:91], v[52:55], a[240:243], v[88:91]
    ds_read_b128 v[44:47], v18 offset:16384
    v_mfma_f32_16x16x32_bf16 v[92:95], v[52:55], a[244:247], v[92:95]
    v_mfma_f32_16x16x32_bf16 v[80:83], v[56:59], a[248:251], v[80:83]
    ds_read_b128 v[48:51], v17 offset:1024
    v_mfma_f32_16x16x32_bf16 v[84:87], v[56:59], a[252:255], v[84:87]
    v_mfma_f32_16x16x32_bf16 v[88:91], v[60:63], a[248:251], v[88:91]
    ds_read_b128 v[52:55], v17 offset:17408
    v_mfma_f32_16x16x32_bf16 v[92:95], v[60:63], a[252:255], v[92:95]
    s_mov_b64 exec, s[36:37]
    buffer_store_dword v23, v22, s[8:11], s33 offen sc1
    s_mov_b64 exec, -1

    s_add_u32 s35, s35, 1
    s_cmp_lt_u32 s35, 32
    s_cbranch_scc1 .ql_401

    s_nop 7
    v_cvt_pk_bf16_f32 v96, v80, v81
    v_cvt_pk_bf16_f32 v97, v82, v83
    v_cvt_pk_bf16_f32 v98, v88, v89
    v_cvt_pk_bf16_f32 v99, v90, v91
    buffer_store_dwordx4 v[96:99], v21, s[8:11], s32 offen offset:0 sc1
    v_cvt_pk_bf16_f32 v100, v84, v85
    v_cvt_pk_bf16_f32 v101, v86, v87
    v_cvt_pk_bf16_f32 v102, v92, v93
    v_cvt_pk_bf16_f32 v103, v94, v95
    buffer_store_dwordx4 v[100:103], v21, s[8:11], s32 offen offset:1024 sc1
    s_mov_b32 exec_hi, 0
    buffer_store_dwordx4 v[24:27], v21, s[8:11], s48 offen sc1
    s_mov_b32 exec_hi, -1

    v_mov_b32 v23, 64
    s_waitcnt vmcnt(0) lgkmcnt(0)
    s_barrier
    s_mov_b64 exec, s[36:37]
    buffer_store_dword v23, v22, s[8:11], s33 offen sc1
    s_mov_b64 exec, -1

.qd_377:
    s_load_dwordx2 s[40:41], s[0:1], 88
    s_load_dwordx2 s[42:43], s[0:1], 112
    s_and_b32 s4, s33, 0xffffe7ff
    s_mov_b32 s57, s4
    s_mov_b32 s34, s47
    s_and_b32 s30, s26, 7
    s_lshr_b32 s31, s26, 3
    s_lshl_b32 s28, s91, 21
    s_lshl_b32 s4, s30, 8
    s_add_u32 s28, s28, s4
    s_waitcnt lgkmcnt(0)

    s_mov_b32 s12, s40
    s_and_b32 s13, s41, 0xffff
    s_mov_b32 s14, 0x800000
    s_mov_b32 s15, 0x00020000

    s_mov_b32 s44, s42
    s_and_b32 s45, s43, 0xffff
    s_mov_b32 s46, 0x400000
    s_mov_b32 s47, 0x00020000

    v_lshrrev_b32 v4, 1, v2
    v_xor_b32 v4, v4, v3
    v_lshlrev_b32 v4, 1, v4
    v_and_b32 v5, 1, v1
    v_or_b32 v4, v4, v5
    v_lshlrev_b32 v4, 4, v4
    v_lshlrev_b32 v5, 11, v3
    v_add_u32 v10, v4, v5
    v_xor_b32 v11, 0x80, v10
    s_lshl_b32 s4, s24, 16
    s_add_u32 s28, s28, s4
    s_lshl_b32 s29, s24, 13
    v_lshrrev_b32 v4, 2, v2
    v_and_b32 v5, 1, v3
    v_lshl_or_b32 v5, v5, 2, v4
    s_lshl_b32 s4, s24, 1
    v_xor_b32 v5, s4, v5
    v_lshlrev_b32 v5, 5, v5
    v_lshl_add_u32 v4, v3, 2, v4
    v_lshl_add_u32 v5, v4, 8, v5
    v_and_b32 v4, 3, v2
    v_lshl_add_u32 v12, v4, 3, v5
    v_xor_b32 v13, 32, v12
    v_add_u32 v14, 0x10000, v12
    v_add_u32 v15, 0x10000, v13

    s_and_b32 s4, s91, 1
    s_lshl_b32 s4, s4, 5
    v_xor_b32 v12, s4, v12
    v_xor_b32 v13, s4, v13
    v_xor_b32 v14, s4, v14
    v_xor_b32 v15, s4, v15

    s_and_b32 s4, s26, 7
    s_lshl_b32 s4, s4, 1
    s_lshr_b32 s5, s24, 1
    s_add_u32 s4, s4, s5
    s_lshl_b32 s4, s4, 6
    v_add_u32 v4, s4, v1
    v_lshlrev_b32 v4, 11, v4
    s_and_b32 s4, s24, 1
    s_lshl_b32 s4, s4, 10
    s_lshl_b32 s5, s91, 21
    s_add_u32 s4, s4, s5
    buffer_load_dword v31, v4, s[12:15], s4 offen offset:384

    s_add_u32 m0, s29, 0
    s_add_u32 s4, s28, 0
    buffer_load_dwordx4 v10, s[12:15], s4 offen lds

    s_add_u32 m0, s29, 1024
    s_add_u32 s4, s28, 8192
    buffer_load_dwordx4 v11, s[12:15], s4 offen lds

    s_add_u32 m0, s29, 2048
    s_add_u32 s4, s28, 16384
    buffer_load_dwordx4 v10, s[12:15], s4 offen lds

    s_add_u32 m0, s29, 3072
    s_add_u32 s4, s28, 24576
    buffer_load_dwordx4 v11, s[12:15], s4 offen lds

    s_add_u32 m0, s29, 4096
    s_add_u32 s4, s28, 32768
    buffer_load_dwordx4 v10, s[12:15], s4 offen lds

    s_add_u32 m0, s29, 5120
    s_add_u32 s4, s28, 40960
    buffer_load_dwordx4 v11, s[12:15], s4 offen lds

    s_add_u32 m0, s29, 6144
    s_add_u32 s4, s28, 49152
    buffer_load_dwordx4 v10, s[12:15], s4 offen lds

    s_add_u32 m0, s29, 7168
    s_add_u32 s4, s28, 57344
    buffer_load_dwordx4 v11, s[12:15], s4 offen lds

    s_add_u32 m0, s29, 32768
    s_add_u32 s4, s28, 262144
    buffer_load_dwordx4 v10, s[12:15], s4 offen lds

    s_add_u32 m0, s29, 33792
    s_add_u32 s4, s28, 270336
    buffer_load_dwordx4 v11, s[12:15], s4 offen lds

    s_add_u32 m0, s29, 34816
    s_add_u32 s4, s28, 278528
    buffer_load_dwordx4 v10, s[12:15], s4 offen lds

    s_add_u32 m0, s29, 35840
    s_add_u32 s4, s28, 286720
    buffer_load_dwordx4 v11, s[12:15], s4 offen lds

    s_add_u32 m0, s29, 36864
    s_add_u32 s4, s28, 294912
    buffer_load_dwordx4 v10, s[12:15], s4 offen lds

    s_add_u32 m0, s29, 37888
    s_add_u32 s4, s28, 303104
    buffer_load_dwordx4 v11, s[12:15], s4 offen lds

    s_add_u32 m0, s29, 38912
    s_add_u32 s4, s28, 311296
    buffer_load_dwordx4 v10, s[12:15], s4 offen lds

    s_add_u32 m0, s29, 39936
    s_add_u32 s4, s28, 319488
    buffer_load_dwordx4 v11, s[12:15], s4 offen lds

    s_add_u32 m0, s29, 65536
    s_add_u32 s4, s28, 524288
    buffer_load_dwordx4 v10, s[12:15], s4 offen lds

    s_add_u32 m0, s29, 66560
    s_add_u32 s4, s28, 532480
    buffer_load_dwordx4 v11, s[12:15], s4 offen lds

    s_add_u32 m0, s29, 67584
    s_add_u32 s4, s28, 540672
    buffer_load_dwordx4 v10, s[12:15], s4 offen lds

    s_add_u32 m0, s29, 68608
    s_add_u32 s4, s28, 548864
    buffer_load_dwordx4 v11, s[12:15], s4 offen lds

    s_add_u32 m0, s29, 69632
    s_add_u32 s4, s28, 557056
    buffer_load_dwordx4 v10, s[12:15], s4 offen lds

    s_add_u32 m0, s29, 70656
    s_add_u32 s4, s28, 565248
    buffer_load_dwordx4 v11, s[12:15], s4 offen lds

    s_add_u32 m0, s29, 71680
    s_add_u32 s4, s28, 573440
    buffer_load_dwordx4 v10, s[12:15], s4 offen lds

    s_add_u32 m0, s29, 72704
    s_add_u32 s4, s28, 581632
    buffer_load_dwordx4 v11, s[12:15], s4 offen lds

    s_add_u32 m0, s29, 98304
    s_add_u32 s4, s28, 786432
    buffer_load_dwordx4 v10, s[12:15], s4 offen lds

    s_add_u32 m0, s29, 99328
    s_add_u32 s4, s28, 794624
    buffer_load_dwordx4 v11, s[12:15], s4 offen lds

    s_add_u32 m0, s29, 100352
    s_add_u32 s4, s28, 802816
    buffer_load_dwordx4 v10, s[12:15], s4 offen lds

    s_add_u32 m0, s29, 101376
    s_add_u32 s4, s28, 811008
    buffer_load_dwordx4 v11, s[12:15], s4 offen lds

    s_add_u32 m0, s29, 102400
    s_add_u32 s4, s28, 819200
    buffer_load_dwordx4 v10, s[12:15], s4 offen lds

    s_add_u32 m0, s29, 103424
    s_add_u32 s4, s28, 827392
    buffer_load_dwordx4 v11, s[12:15], s4 offen lds

    s_add_u32 m0, s29, 104448
    s_add_u32 s4, s28, 835584
    buffer_load_dwordx4 v10, s[12:15], s4 offen lds

    s_add_u32 m0, s29, 105472
    s_add_u32 s4, s28, 843776
    buffer_load_dwordx4 v11, s[12:15], s4 offen lds

    s_waitcnt vmcnt(24)
    s_barrier
    ds_read_b64_tr_b16 a[0:1], v12 offset:0
    ds_read_b64_tr_b16 a[2:3], v12 offset:4096
    ds_read_b64_tr_b16 a[4:5], v13 offset:0
    ds_read_b64_tr_b16 a[6:7], v13 offset:4096
    ds_read_b64_tr_b16 a[8:9], v12 offset:8192
    ds_read_b64_tr_b16 a[10:11], v12 offset:12288
    ds_read_b64_tr_b16 a[12:13], v13 offset:8192
    ds_read_b64_tr_b16 a[14:15], v13 offset:12288
    ds_read_b64_tr_b16 a[16:17], v12 offset:16384
    ds_read_b64_tr_b16 a[18:19], v12 offset:20480
    ds_read_b64_tr_b16 a[20:21], v13 offset:16384
    ds_read_b64_tr_b16 a[22:23], v13 offset:20480
    ds_read_b64_tr_b16 a[24:25], v12 offset:24576
    ds_read_b64_tr_b16 a[26:27], v12 offset:28672
    ds_read_b64_tr_b16 a[28:29], v13 offset:24576
    ds_read_b64_tr_b16 a[30:31], v13 offset:28672
    s_waitcnt lgkmcnt(0)
    s_barrier
    s_add_u32 m0, s29, 0
    s_add_u32 s4, s28, 1048576
    buffer_load_dwordx4 v10, s[12:15], s4 offen lds

    s_add_u32 m0, s29, 1024
    s_add_u32 s4, s28, 1056768
    buffer_load_dwordx4 v11, s[12:15], s4 offen lds

    s_add_u32 m0, s29, 2048
    s_add_u32 s4, s28, 1064960
    buffer_load_dwordx4 v10, s[12:15], s4 offen lds

    s_add_u32 m0, s29, 3072
    s_add_u32 s4, s28, 1073152
    buffer_load_dwordx4 v11, s[12:15], s4 offen lds

    s_add_u32 m0, s29, 4096
    s_add_u32 s4, s28, 1081344
    buffer_load_dwordx4 v10, s[12:15], s4 offen lds

    s_add_u32 m0, s29, 5120
    s_add_u32 s4, s28, 1089536
    buffer_load_dwordx4 v11, s[12:15], s4 offen lds

    s_add_u32 m0, s29, 6144
    s_add_u32 s4, s28, 1097728
    buffer_load_dwordx4 v10, s[12:15], s4 offen lds

    s_add_u32 m0, s29, 7168
    s_add_u32 s4, s28, 1105920
    buffer_load_dwordx4 v11, s[12:15], s4 offen lds

    s_waitcnt vmcnt(24)
    s_barrier
    ds_read_b64_tr_b16 a[32:33], v12 offset:32768
    ds_read_b64_tr_b16 a[34:35], v12 offset:36864
    ds_read_b64_tr_b16 a[36:37], v13 offset:32768
    ds_read_b64_tr_b16 a[38:39], v13 offset:36864
    ds_read_b64_tr_b16 a[40:41], v12 offset:40960
    ds_read_b64_tr_b16 a[42:43], v12 offset:45056
    ds_read_b64_tr_b16 a[44:45], v13 offset:40960
    ds_read_b64_tr_b16 a[46:47], v13 offset:45056
    ds_read_b64_tr_b16 a[48:49], v12 offset:49152
    ds_read_b64_tr_b16 a[50:51], v12 offset:53248
    ds_read_b64_tr_b16 a[52:53], v13 offset:49152
    ds_read_b64_tr_b16 a[54:55], v13 offset:53248
    ds_read_b64_tr_b16 a[56:57], v12 offset:57344
    ds_read_b64_tr_b16 a[58:59], v12 offset:61440
    ds_read_b64_tr_b16 a[60:61], v13 offset:57344
    ds_read_b64_tr_b16 a[62:63], v13 offset:61440
    s_waitcnt lgkmcnt(0)
    s_barrier
    s_add_u32 m0, s29, 32768
    s_add_u32 s4, s28, 1310720
    buffer_load_dwordx4 v10, s[12:15], s4 offen lds

    s_add_u32 m0, s29, 33792
    s_add_u32 s4, s28, 1318912
    buffer_load_dwordx4 v11, s[12:15], s4 offen lds

    s_add_u32 m0, s29, 34816
    s_add_u32 s4, s28, 1327104
    buffer_load_dwordx4 v10, s[12:15], s4 offen lds

    s_add_u32 m0, s29, 35840
    s_add_u32 s4, s28, 1335296
    buffer_load_dwordx4 v11, s[12:15], s4 offen lds

    s_add_u32 m0, s29, 36864
    s_add_u32 s4, s28, 1343488
    buffer_load_dwordx4 v10, s[12:15], s4 offen lds

    s_add_u32 m0, s29, 37888
    s_add_u32 s4, s28, 1351680
    buffer_load_dwordx4 v11, s[12:15], s4 offen lds

    s_add_u32 m0, s29, 38912
    s_add_u32 s4, s28, 1359872
    buffer_load_dwordx4 v10, s[12:15], s4 offen lds

    s_add_u32 m0, s29, 39936
    s_add_u32 s4, s28, 1368064
    buffer_load_dwordx4 v11, s[12:15], s4 offen lds

    s_waitcnt vmcnt(24)
    s_barrier
    ds_read_b64_tr_b16 a[64:65], v14 offset:0
    ds_read_b64_tr_b16 a[66:67], v14 offset:4096
    ds_read_b64_tr_b16 a[68:69], v15 offset:0
    ds_read_b64_tr_b16 a[70:71], v15 offset:4096
    ds_read_b64_tr_b16 a[72:73], v14 offset:8192
    ds_read_b64_tr_b16 a[74:75], v14 offset:12288
    ds_read_b64_tr_b16 a[76:77], v15 offset:8192
    ds_read_b64_tr_b16 a[78:79], v15 offset:12288
    ds_read_b64_tr_b16 a[80:81], v14 offset:16384
    ds_read_b64_tr_b16 a[82:83], v14 offset:20480
    ds_read_b64_tr_b16 a[84:85], v15 offset:16384
    ds_read_b64_tr_b16 a[86:87], v15 offset:20480
    ds_read_b64_tr_b16 a[88:89], v14 offset:24576
    ds_read_b64_tr_b16 a[90:91], v14 offset:28672
    ds_read_b64_tr_b16 a[92:93], v15 offset:24576
    ds_read_b64_tr_b16 a[94:95], v15 offset:28672
    s_waitcnt lgkmcnt(0)
    s_barrier
    s_add_u32 m0, s29, 65536
    s_add_u32 s4, s28, 1572864
    buffer_load_dwordx4 v10, s[12:15], s4 offen lds

    s_add_u32 m0, s29, 66560
    s_add_u32 s4, s28, 1581056
    buffer_load_dwordx4 v11, s[12:15], s4 offen lds

    s_add_u32 m0, s29, 67584
    s_add_u32 s4, s28, 1589248
    buffer_load_dwordx4 v10, s[12:15], s4 offen lds

    s_add_u32 m0, s29, 68608
    s_add_u32 s4, s28, 1597440
    buffer_load_dwordx4 v11, s[12:15], s4 offen lds

    s_add_u32 m0, s29, 69632
    s_add_u32 s4, s28, 1605632
    buffer_load_dwordx4 v10, s[12:15], s4 offen lds

    s_add_u32 m0, s29, 70656
    s_add_u32 s4, s28, 1613824
    buffer_load_dwordx4 v11, s[12:15], s4 offen lds

    s_add_u32 m0, s29, 71680
    s_add_u32 s4, s28, 1622016
    buffer_load_dwordx4 v10, s[12:15], s4 offen lds

    s_add_u32 m0, s29, 72704
    s_add_u32 s4, s28, 1630208
    buffer_load_dwordx4 v11, s[12:15], s4 offen lds

    s_waitcnt vmcnt(24)
    s_barrier
    ds_read_b64_tr_b16 a[96:97], v14 offset:32768
    ds_read_b64_tr_b16 a[98:99], v14 offset:36864
    ds_read_b64_tr_b16 a[100:101], v15 offset:32768
    ds_read_b64_tr_b16 a[102:103], v15 offset:36864
    ds_read_b64_tr_b16 a[104:105], v14 offset:40960
    ds_read_b64_tr_b16 a[106:107], v14 offset:45056
    ds_read_b64_tr_b16 a[108:109], v15 offset:40960
    ds_read_b64_tr_b16 a[110:111], v15 offset:45056
    ds_read_b64_tr_b16 a[112:113], v14 offset:49152
    ds_read_b64_tr_b16 a[114:115], v14 offset:53248
    ds_read_b64_tr_b16 a[116:117], v15 offset:49152
    ds_read_b64_tr_b16 a[118:119], v15 offset:53248
    ds_read_b64_tr_b16 a[120:121], v14 offset:57344
    ds_read_b64_tr_b16 a[122:123], v14 offset:61440
    ds_read_b64_tr_b16 a[124:125], v15 offset:57344
    ds_read_b64_tr_b16 a[126:127], v15 offset:61440
    s_waitcnt lgkmcnt(0)
    s_barrier
    s_add_u32 m0, s29, 98304
    s_add_u32 s4, s28, 1835008
    buffer_load_dwordx4 v10, s[12:15], s4 offen lds

    s_add_u32 m0, s29, 99328
    s_add_u32 s4, s28, 1843200
    buffer_load_dwordx4 v11, s[12:15], s4 offen lds

    s_add_u32 m0, s29, 100352
    s_add_u32 s4, s28, 1851392
    buffer_load_dwordx4 v10, s[12:15], s4 offen lds

    s_add_u32 m0, s29, 101376
    s_add_u32 s4, s28, 1859584
    buffer_load_dwordx4 v11, s[12:15], s4 offen lds

    s_add_u32 m0, s29, 102400
    s_add_u32 s4, s28, 1867776
    buffer_load_dwordx4 v10, s[12:15], s4 offen lds

    s_add_u32 m0, s29, 103424
    s_add_u32 s4, s28, 1875968
    buffer_load_dwordx4 v11, s[12:15], s4 offen lds

    s_add_u32 m0, s29, 104448
    s_add_u32 s4, s28, 1884160
    buffer_load_dwordx4 v10, s[12:15], s4 offen lds

    s_add_u32 m0, s29, 105472
    s_add_u32 s4, s28, 1892352
    buffer_load_dwordx4 v11, s[12:15], s4 offen lds

    s_waitcnt vmcnt(24)
    s_barrier
    ds_read_b64_tr_b16 a[128:129], v12 offset:0
    ds_read_b64_tr_b16 a[130:131], v12 offset:4096
    ds_read_b64_tr_b16 a[132:133], v13 offset:0
    ds_read_b64_tr_b16 a[134:135], v13 offset:4096
    ds_read_b64_tr_b16 a[136:137], v12 offset:8192
    ds_read_b64_tr_b16 a[138:139], v12 offset:12288
    ds_read_b64_tr_b16 a[140:141], v13 offset:8192
    ds_read_b64_tr_b16 a[142:143], v13 offset:12288
    ds_read_b64_tr_b16 a[144:145], v12 offset:16384
    ds_read_b64_tr_b16 a[146:147], v12 offset:20480
    ds_read_b64_tr_b16 a[148:149], v13 offset:16384
    ds_read_b64_tr_b16 a[150:151], v13 offset:20480
    ds_read_b64_tr_b16 a[152:153], v12 offset:24576
    ds_read_b64_tr_b16 a[154:155], v12 offset:28672
    ds_read_b64_tr_b16 a[156:157], v13 offset:24576
    ds_read_b64_tr_b16 a[158:159], v13 offset:28672
    s_waitcnt lgkmcnt(0)
    s_barrier
    s_waitcnt vmcnt(16)
    s_barrier
    ds_read_b64_tr_b16 a[160:161], v12 offset:32768
    ds_read_b64_tr_b16 a[162:163], v12 offset:36864
    ds_read_b64_tr_b16 a[164:165], v13 offset:32768
    ds_read_b64_tr_b16 a[166:167], v13 offset:36864
    ds_read_b64_tr_b16 a[168:169], v12 offset:40960
    ds_read_b64_tr_b16 a[170:171], v12 offset:45056
    ds_read_b64_tr_b16 a[172:173], v13 offset:40960
    ds_read_b64_tr_b16 a[174:175], v13 offset:45056
    ds_read_b64_tr_b16 a[176:177], v12 offset:49152
    ds_read_b64_tr_b16 a[178:179], v12 offset:53248
    ds_read_b64_tr_b16 a[180:181], v13 offset:49152
    ds_read_b64_tr_b16 a[182:183], v13 offset:53248
    ds_read_b64_tr_b16 a[184:185], v12 offset:57344
    ds_read_b64_tr_b16 a[186:187], v12 offset:61440
    ds_read_b64_tr_b16 a[188:189], v13 offset:57344
    ds_read_b64_tr_b16 a[190:191], v13 offset:61440
    s_waitcnt lgkmcnt(0)
    s_barrier
    s_waitcnt vmcnt(8)
    s_barrier
    ds_read_b64_tr_b16 a[192:193], v14 offset:0
    ds_read_b64_tr_b16 a[194:195], v14 offset:4096
    ds_read_b64_tr_b16 a[196:197], v15 offset:0
    ds_read_b64_tr_b16 a[198:199], v15 offset:4096
    ds_read_b64_tr_b16 a[200:201], v14 offset:8192
    ds_read_b64_tr_b16 a[202:203], v14 offset:12288
    ds_read_b64_tr_b16 a[204:205], v15 offset:8192
    ds_read_b64_tr_b16 a[206:207], v15 offset:12288
    ds_read_b64_tr_b16 a[208:209], v14 offset:16384
    ds_read_b64_tr_b16 a[210:211], v14 offset:20480
    ds_read_b64_tr_b16 a[212:213], v15 offset:16384
    ds_read_b64_tr_b16 a[214:215], v15 offset:20480
    ds_read_b64_tr_b16 a[216:217], v14 offset:24576
    ds_read_b64_tr_b16 a[218:219], v14 offset:28672
    ds_read_b64_tr_b16 a[220:221], v15 offset:24576
    ds_read_b64_tr_b16 a[222:223], v15 offset:28672
    s_waitcnt lgkmcnt(0)
    s_barrier
    s_waitcnt vmcnt(0)
    s_barrier
    ds_read_b64_tr_b16 a[224:225], v14 offset:32768
    ds_read_b64_tr_b16 a[226:227], v14 offset:36864
    ds_read_b64_tr_b16 a[228:229], v15 offset:32768
    ds_read_b64_tr_b16 a[230:231], v15 offset:36864
    ds_read_b64_tr_b16 a[232:233], v14 offset:40960
    ds_read_b64_tr_b16 a[234:235], v14 offset:45056
    ds_read_b64_tr_b16 a[236:237], v15 offset:40960
    ds_read_b64_tr_b16 a[238:239], v15 offset:45056
    ds_read_b64_tr_b16 a[240:241], v14 offset:49152
    ds_read_b64_tr_b16 a[242:243], v14 offset:53248
    ds_read_b64_tr_b16 a[244:245], v15 offset:49152
    ds_read_b64_tr_b16 a[246:247], v15 offset:53248
    ds_read_b64_tr_b16 a[248:249], v14 offset:57344
    ds_read_b64_tr_b16 a[250:251], v14 offset:61440
    ds_read_b64_tr_b16 a[252:253], v15 offset:57344
    ds_read_b64_tr_b16 a[254:255], v15 offset:61440
    s_waitcnt lgkmcnt(0)
    s_barrier
    v_lshlrev_b32 v21, 4, v1
    s_lshr_b32 s4, s91, 1
    s_lshl_b32 s5, s4, 12
    v_add_u32 v17, s5, v21
    v_xor_b32 v18, 0x1000, v17
    s_lshl_b32 s4, s4, 4
    v_add_u32 v4, s4, v2
    s_lshl_b32 s5, s30, 5
    s_lshl_b32 s6, s24, 3
    s_add_u32 s5, s5, s6
    s_and_b32 s6, s91, 1
    s_lshl_b32 s6, s6, 2
    s_add_u32 s5, s5, s6
    v_add_u32 v5, s5, v3
    v_lshlrev_b32 v6, 3, v5
    v_lshl_add_u32 v22, v4, 11, v6
    v_lshlrev_b32 v6, 14, v5
    v_lshl_add_u32 v23, v4, 2, v6
    v_lshlrev_b32 v16, 2, v4
    v_bfe_u32 v4, v1, 2, 3
    v_lshlrev_b32 v19, 8, v4
    v_and_b32 v4, 3, v1
    v_lshl_add_u32 v19, v4, 2, v19
    s_lshl_b32 s33, s91, 11
    s_add_u32 s33, s33, 92299264
    s_lshl_b32 s35, s24, 10
    s_lshl_b32 s36, s91, 16
    s_add_u32 s36, s36, s35
    s_add_u32 s36, s36, 0
    s_mov_b32 s37, 0
    s_lshl_b32 s4, s91, 3
    s_add_u32 s4, s4, s30
    s_lshl_b32 s4, s4, 2
    s_add_u32 s4, s4, s24
    s_lshl_b32 s4, s4, 11
    s_add_u32 s4, s4, 0
    v_lshlrev_b32 v111, 5, v1
    v_add_u32 v111, s4, v111
    s_mov_b32 s52, 0
    s_mov_b32 s39, 0
    v_lshlrev_b32 v6, 11, v1

    s_mov_b32 s62, 0
    s_mov_b64 exec, 15
.wf_405:
    buffer_load_dword v4, v6, s[8:11], s57 offen sc1
    s_waitcnt vmcnt(0)
    v_cmp_gt_u32 vcc, 64, v4
    s_cbranch_vccz .wfd_406
    s_sleep 2
    s_add_u32 s62, s62, 1
    s_cmp_gt_u32 s62, 0x400000
    s_cbranch_scc1 .mg_end_1
    s_branch .wf_405

.wfd_406:
    s_mov_b64 exec, -1
    v_mov_b32 v5, 0
    s_mov_b32 s62, 0
    s_mov_b32 s5, 160
.wc_407:
    buffer_load_dword v4, v5, s[20:23], s5 offen sc1
    s_waitcnt vmcnt(0)
    v_readfirstlane_b32 s4, v4
    s_lshr_b32 s4, s4, 0
    s_and_b32 s4, s4, 0xffff
    s_cmp_ge_u32 s4, 32
    s_cbranch_scc1 .wcd_408
    s_sleep 6
    s_add_u32 s62, s62, 1
    s_cmp_gt_u32 s62, 0x400000
    s_cbranch_scc1 .mg_end_1
    s_branch .wc_407

.wcd_408:
.g2blk_409:
    s_mov_b32 s62, 0
    s_mov_b64 s[64:65], 0
    s_mov_b32 s38, 0
.g2bw_417:
    buffer_load_dword v20, v19, s[8:11], s33 offen sc1
    s_waitcnt vmcnt(0)
    s_lshr_b32 s6, s31, 2
    s_and_b32 s4, s31, 3
    v_cmp_ge_u32 vcc, s6, v20
    s_lshl_b32 s4, s4, 3
    s_lshr_b32 s5, vcc_lo, s4
    s_and_b32 s5, s5, 0xff
    s_cmp_eq_u32 s5, 0

    s_cbranch_scc1 .g2rd_418
    s_lshl_b64 exec, 0xff, s4

    s_add_u32 s62, s62, 1
    s_cmp_gt_u32 s62, 0x400000
    s_cbranch_scc1 .mg_end_1
    s_branch .g2bw_417

.g2rd_418:
    s_mov_b64 exec, -1
    s_lshl_b32 s48, s31, 18
    s_add_u32 s48, s48, s36
    s_add_u32 s49, s39, s35
    s_xor_b32 s39, s39, 0x10000

    s_add_u32 m0, s49, 0
    s_add_u32 s50, s48, 0
    buffer_load_dwordx4 v21, s[8:11], s50 offen offset:0 sc1 lds
    s_add_u32 m0, s49, 4096
    s_add_u32 s50, s48, 4096
    buffer_load_dwordx4 v21, s[8:11], s50 offen offset:0 sc1 lds
    s_add_u32 m0, s49, 8192
    s_add_u32 s50, s48, 8192
    buffer_load_dwordx4 v21, s[8:11], s50 offen offset:0 sc1 lds
    s_add_u32 m0, s49, 12288
    s_add_u32 s50, s48, 12288
    buffer_load_dwordx4 v21, s[8:11], s50 offen offset:0 sc1 lds
    s_add_u32 m0, s49, 16384
    s_add_u32 s50, s48, 16384
    buffer_load_dwordx4 v21, s[8:11], s50 offen offset:0 sc1 lds
    s_add_u32 m0, s49, 20480
    s_add_u32 s50, s48, 20480
    buffer_load_dwordx4 v21, s[8:11], s50 offen offset:0 sc1 lds
    s_add_u32 m0, s49, 24576
    s_add_u32 s50, s48, 24576
    buffer_load_dwordx4 v21, s[8:11], s50 offen offset:0 sc1 lds
    s_add_u32 m0, s49, 28672
    s_add_u32 s50, s48, 28672
    buffer_load_dwordx4 v21, s[8:11], s50 offen offset:0 sc1 lds
    s_add_u32 s53, s31, 3
    s_lshr_b32 s6, s53, 2
    s_and_b32 s4, s53, 3
    v_cmp_ge_u32 vcc, s6, v20
    s_lshl_b32 s4, s4, 3
    s_lshr_b32 s5, vcc_lo, s4
    s_and_b32 s5, s5, 0xff
    s_cmp_eq_u32 s5, 0

    s_cselect_b32 s56, 1, 0
    s_cmp_lt_u32 s53, 64
    s_cselect_b32 s56, s56, 0
    s_cmp_eq_u32 s56, 0
    s_cbranch_scc1 .g2fb_419
    s_add_u32 m0, s49, 32768
    s_add_u32 s50, s48, 32768
    buffer_load_dwordx4 v21, s[8:11], s50 offen offset:0 sc1 lds
    s_add_u32 m0, s49, 36864
    s_add_u32 s50, s48, 36864
    buffer_load_dwordx4 v21, s[8:11], s50 offen offset:0 sc1 lds
    s_add_u32 m0, s49, 40960
    s_add_u32 s50, s48, 40960
    buffer_load_dwordx4 v21, s[8:11], s50 offen offset:0 sc1 lds
    s_add_u32 m0, s49, 45056
    s_add_u32 s50, s48, 45056
    buffer_load_dwordx4 v21, s[8:11], s50 offen offset:0 sc1 lds
    s_add_u32 m0, s49, 49152
    s_add_u32 s50, s48, 49152
    buffer_load_dwordx4 v21, s[8:11], s50 offen offset:0 sc1 lds
    s_add_u32 m0, s49, 53248
    s_add_u32 s50, s48, 53248
    buffer_load_dwordx4 v21, s[8:11], s50 offen offset:0 sc1 lds
    s_add_u32 m0, s49, 57344
    s_add_u32 s50, s48, 57344
    buffer_load_dwordx4 v21, s[8:11], s50 offen offset:0 sc1 lds
    s_add_u32 m0, s49, 61440
    s_add_u32 s50, s48, 61440
    buffer_load_dwordx4 v21, s[8:11], s50 offen offset:0 sc1 lds
    s_waitcnt vmcnt(0)
.g2go_410:
    s_barrier
    ds_read_b128 v[32:35], v17 offset:0
    ds_read_b128 v[36:39], v18 offset:0
    ds_read_b128 v[40:43], v17 offset:1024
    ds_read_b128 v[44:47], v18 offset:1024
    ds_read_b128 v[48:51], v17 offset:2048
    ds_read_b128 v[52:55], v18 offset:2048
    s_add_u32 s53, s31, 3
    s_sub_u32 s54, s31, 3
    s_max_i32 s54, s54, 0
    s_sub_u32 s55, s37, 0x10000
    s_add_u32 s61, s31, 6
    s_lshr_b32 s6, s53, 2
    s_and_b32 s4, s53, 3
    v_cmp_ge_u32 vcc, s6, v20
    s_lshl_b32 s4, s4, 3
    s_lshr_b32 s5, vcc_lo, s4
    s_and_b32 s5, s5, 0xff
    s_cmp_eq_u32 s5, 0

    s_cselect_b32 s56, 1, 0
    s_cmp_lt_u32 s53, 64
    s_cselect_b32 s56, s56, 0
    s_cmp_eq_u32 s56, 0
    s_cbranch_scc1 .g2nd_413
    s_lshr_b32 s6, s61, 2
    s_and_b32 s4, s61, 3
    v_cmp_ge_u32 vcc, s6, v20
    s_lshl_b32 s4, s4, 3
    s_lshr_b32 s5, vcc_lo, s4
    s_and_b32 s5, s5, 0xff
    s_cmp_eq_u32 s5, 0

    s_cbranch_scc1 .g2nf_412
    buffer_load_dword v20, v19, s[8:11], s33 offen sc1
    s_branch .g2pd_421
.g2nf_412:
    s_lshl_b32 s4, s61, 18
    buffer_load_dword v31, v111, s[8:11], s4 offen
.g2pd_421:
    s_lshl_b32 s48, s53, 18
    s_add_u32 s48, s48, s36
    s_add_u32 s49, s39, s35
    s_xor_b32 s39, s39, 0x10000

    s_waitcnt lgkmcnt(4)
    v_mfma_f32_16x16x32_bf16 v[64:67], a[0:3], v[32:35], 0
    ds_read_b128 v[56:59], v17 offset:3072
    s_add_u32 m0, s49, 0
    s_add_u32 s50, s48, 0
    v_mfma_f32_16x16x32_bf16 v[68:71], a[4:7], v[32:35], 0
    buffer_load_dwordx4 v21, s[8:11], s50 offen offset:0 sc1 lds
    v_mfma_f32_16x16x32_bf16 v[72:75], a[0:3], v[36:39], 0
    ds_read_b128 v[60:63], v18 offset:3072
    v_mfma_f32_16x16x32_bf16 v[76:79], a[4:7], v[36:39], 0
    s_waitcnt lgkmcnt(4)
    v_mfma_f32_16x16x32_bf16 v[64:67], a[8:11], v[40:43], v[64:67]
    ds_read_b128 v[32:35], v17 offset:8192
    v_mfma_f32_16x16x32_bf16 v[68:71], a[12:15], v[40:43], v[68:71]
    v_mfma_f32_16x16x32_bf16 v[72:75], a[8:11], v[44:47], v[72:75]
    ds_read_b128 v[36:39], v18 offset:8192
    s_add_u32 m0, s49, 4096
    s_add_u32 s50, s48, 4096
    v_mfma_f32_16x16x32_bf16 v[76:79], a[12:15], v[44:47], v[76:79]
    buffer_load_dwordx4 v21, s[8:11], s50 offen offset:0 sc1 lds
    s_waitcnt lgkmcnt(4)
    v_mfma_f32_16x16x32_bf16 v[64:67], a[16:19], v[48:51], v[64:67]
    ds_read_b128 v[40:43], v17 offset:9216
    v_mfma_f32_16x16x32_bf16 v[68:71], a[20:23], v[48:51], v[68:71]
    v_mfma_f32_16x16x32_bf16 v[72:75], a[16:19], v[52:55], v[72:75]
    ds_read_b128 v[44:47], v18 offset:9216
    v_mfma_f32_16x16x32_bf16 v[76:79], a[20:23], v[52:55], v[76:79]
    s_waitcnt lgkmcnt(4)
    v_mfma_f32_16x16x32_bf16 v[64:67], a[24:27], v[56:59], v[64:67]
    ds_read_b128 v[48:51], v17 offset:10240
    s_add_u32 m0, s49, 8192
    s_add_u32 s50, s48, 8192
    v_mfma_f32_16x16x32_bf16 v[68:71], a[28:31], v[56:59], v[68:71]
    buffer_load_dwordx4 v21, s[8:11], s50 offen offset:0 sc1 lds
    v_mfma_f32_16x16x32_bf16 v[72:75], a[24:27], v[60:63], v[72:75]
    ds_read_b128 v[52:55], v18 offset:10240
    v_mfma_f32_16x16x32_bf16 v[76:79], a[28:31], v[60:63], v[76:79]
    s_waitcnt lgkmcnt(4)
    v_mfma_f32_16x16x32_bf16 v[64:67], a[32:35], v[32:35], v[64:67]
    ds_read_b128 v[56:59], v17 offset:11264
    v_mfma_f32_16x16x32_bf16 v[68:71], a[36:39], v[32:35], v[68:71]
    v_mfma_f32_16x16x32_bf16 v[72:75], a[32:35], v[36:39], v[72:75]
    ds_read_b128 v[60:63], v18 offset:11264
    s_add_u32 m0, s49, 12288
    s_add_u32 s50, s48, 12288
    v_mfma_f32_16x16x32_bf16 v[76:79], a[36:39], v[36:39], v[76:79]
    buffer_load_dwordx4 v21, s[8:11], s50 offen offset:0 sc1 lds
    s_waitcnt lgkmcnt(4)
    v_mfma_f32_16x16x32_bf16 v[64:67], a[40:43], v[40:43], v[64:67]
    s_barrier
    ds_read_b128 v[32:35], v17 offset:16384
    v_mfma_f32_16x16x32_bf16 v[68:71], a[44:47], v[40:43], v[68:71]
    v_mfma_f32_16x16x32_bf16 v[72:75], a[40:43], v[44:47], v[72:75]
    ds_read_b128 v[36:39], v18 offset:16384
    v_mfma_f32_16x16x32_bf16 v[76:79], a[44:47], v[44:47], v[76:79]
    s_waitcnt lgkmcnt(4)
    v_mfma_f32_16x16x32_bf16 v[64:67], a[48:51], v[48:51], v[64:67]
    ds_read_b128 v[40:43], v17 offset:17408
    s_add_u32 m0, s49, 16384
    s_add_u32 s50, s48, 16384
    v_mfma_f32_16x16x32_bf16 v[68:71], a[52:55], v[48:51], v[68:71]
    buffer_load_dwordx4 v21, s[8:11], s50 offen offset:0 sc1 lds
    v_mfma_f32_16x16x32_bf16 v[72:75], a[48:51], v[52:55], v[72:75]
    ds_read_b128 v[44:47], v18 offset:17408
    v_mfma_f32_16x16x32_bf16 v[76:79], a[52:55], v[52:55], v[76:79]
    s_waitcnt lgkmcnt(4)
    v_mfma_f32_16x16x32_bf16 v[64:67], a[56:59], v[56:59], v[64:67]
    ds_read_b128 v[48:51], v17 offset:18432
    v_mfma_f32_16x16x32_bf16 v[68:71], a[60:63], v[56:59], v[68:71]
    v_mfma_f32_16x16x32_bf16 v[72:75], a[56:59], v[60:63], v[72:75]
    ds_read_b128 v[52:55], v18 offset:18432
    s_add_u32 m0, s49, 20480
    s_add_u32 s50, s48, 20480
    v_mfma_f32_16x16x32_bf16 v[76:79], a[60:63], v[60:63], v[76:79]
    buffer_load_dwordx4 v21, s[8:11], s50 offen offset:0 sc1 lds
    s_waitcnt lgkmcnt(4)
    v_mfma_f32_16x16x32_bf16 v[64:67], a[64:67], v[32:35], v[64:67]
    ds_read_b128 v[56:59], v17 offset:19456
    v_mfma_f32_16x16x32_bf16 v[68:71], a[68:71], v[32:35], v[68:71]
    v_mfma_f32_16x16x32_bf16 v[72:75], a[64:67], v[36:39], v[72:75]
    ds_read_b128 v[60:63], v18 offset:19456
    v_mfma_f32_16x16x32_bf16 v[76:79], a[68:71], v[36:39], v[76:79]
    s_waitcnt lgkmcnt(4)
    v_mfma_f32_16x16x32_bf16 v[64:67], a[72:75], v[40:43], v[64:67]
    ds_read_b128 v[32:35], v17 offset:24576
    s_add_u32 m0, s49, 24576
    s_add_u32 s50, s48, 24576
    v_mfma_f32_16x16x32_bf16 v[68:71], a[76:79], v[40:43], v[68:71]
    buffer_load_dwordx4 v21, s[8:11], s50 offen offset:0 sc1 lds
    v_mfma_f32_16x16x32_bf16 v[72:75], a[72:75], v[44:47], v[72:75]
    ds_read_b128 v[36:39], v18 offset:24576
    v_mfma_f32_16x16x32_bf16 v[76:79], a[76:79], v[44:47], v[76:79]
    s_waitcnt lgkmcnt(4)
    v_mfma_f32_16x16x32_bf16 v[64:67], a[80:83], v[48:51], v[64:67]
    ds_read_b128 v[40:43], v17 offset:25600
    v_mfma_f32_16x16x32_bf16 v[68:71], a[84:87], v[48:51], v[68:71]
    s_waitcnt vmcnt(11)
    v_mfma_f32_16x16x32_bf16 v[72:75], a[80:83], v[52:55], v[72:75]
    ds_read_b128 v[44:47], v18 offset:25600
    s_add_u32 m0, s49, 28672
    s_add_u32 s50, s48, 28672
    v_mfma_f32_16x16x32_bf16 v[76:79], a[84:87], v[52:55], v[76:79]
    buffer_load_dwordx4 v21, s[8:11], s50 offen offset:0 sc1 lds
    s_mov_b32 s62, 0
.cc_422:
    v_max3_u32 v4, v84, v88, v92
    v_cmp_eq_u32 vcc, -1, v4
    s_and_b64 vcc, vcc, s[64:65]
    s_cbranch_vccnz .cf_423
    s_waitcnt lgkmcnt(4)
    v_mfma_f32_16x16x32_bf16 v[64:67], a[88:91], v[56:59], v[64:67]
    ds_read_b128 v[48:51], v17 offset:26624
    v_mfma_f32_16x16x32_bf16 v[68:71], a[92:95], v[56:59], v[68:71]
    v_add_f32 v84, v84, v88
    v_add_f32 v92, v112, v92
    v_mfma_f32_16x16x32_bf16 v[72:75], a[88:91], v[60:63], v[72:75]
    ds_read_b128 v[52:55], v18 offset:26624
    v_mfma_f32_16x16x32_bf16 v[76:79], a[92:95], v[60:63], v[76:79]
    v_add_f32 v85, v85, v89
    v_add_f32 v93, v113, v93
    s_waitcnt lgkmcnt(4)
    v_mfma_f32_16x16x32_bf16 v[64:67], a[96:99], v[32:35], v[64:67]
    ds_read_b128 v[56:59], v17 offset:27648
    s_add_u32 m0, s49, 32768
    s_add_u32 s50, s48, 32768
    v_mfma_f32_16x16x32_bf16 v[68:71], a[100:103], v[32:35], v[68:71]
    buffer_load_dwordx4 v21, s[8:11], s50 offen offset:0 sc1 lds
    v_add_f32 v86, v86, v90
    v_add_f32 v94, v114, v94
    v_mfma_f32_16x16x32_bf16 v[72:75], a[96:99], v[36:39], v[72:75]
    ds_read_b128 v[60:63], v18 offset:27648
    v_mfma_f32_16x16x32_bf16 v[76:79], a[100:103], v[36:39], v[76:79]
    v_add_f32 v87, v87, v91
    v_add_f32 v95, v115, v95
    s_waitcnt lgkmcnt(4)
    v_mfma_f32_16x16x32_bf16 v[64:67], a[104:107], v[40:43], v[64:67]
    s_barrier
    ds_read_b128 v[32:35], v17 offset:32768
    v_mfma_f32_16x16x32_bf16 v[68:71], a[108:111], v[40:43], v[68:71]
    v_add_f32 v84, v92, v84
    v_add_f32 v85, v93, v85
    v_mfma_f32_16x16x32_bf16 v[72:75], a[104:107], v[44:47], v[72:75]
    ds_read_b128 v[36:39], v18 offset:32768
    s_add_u32 m0, s49, 36864
    s_add_u32 s50, s48, 36864
    v_mfma_f32_16x16x32_bf16 v[76:79], a[108:111], v[44:47], v[76:79]
    buffer_load_dwordx4 v21, s[8:11], s50 offen offset:0 sc1 lds
    v_add_f32 v86, v94, v86
    v_add_f32 v87, v95, v87
    s_waitcnt lgkmcnt(4)
    v_mfma_f32_16x16x32_bf16 v[64:67], a[112:115], v[48:51], v[64:67]
    ds_read_b128 v[40:43], v17 offset:33792
    v_mfma_f32_16x16x32_bf16 v[68:71], a[116:119], v[48:51], v[68:71]
    v_sub_f32 v104, 1.0, v100
    v_cvt_pk_bf16_f32 v104, v104, v104
    v_mfma_f32_16x16x32_bf16 v[72:75], a[112:115], v[52:55], v[72:75]
    ds_read_b128 v[44:47], v18 offset:33792
    v_mfma_f32_16x16x32_bf16 v[76:79], a[116:119], v[52:55], v[76:79]
    v_lshlrev_b32 v104, 16, v104
    v_cvt_pk_bf16_f32 v105, v84, v85
    s_waitcnt lgkmcnt(4)
    v_mfma_f32_16x16x32_bf16 v[64:67], a[120:123], v[56:59], v[64:67]
    ds_read_b128 v[48:51], v17 offset:34816
    s_add_u32 m0, s49, 40960
    s_add_u32 s50, s48, 40960
    v_mfma_f32_16x16x32_bf16 v[68:71], a[124:127], v[56:59], v[68:71]
    buffer_load_dwordx4 v21, s[8:11], s50 offen offset:0 sc1 lds
    v_lshlrev_b32 v107, 16, v96
    v_and_b32 v108, 0xffff0000, v96
    v_mfma_f32_16x16x32_bf16 v[72:75], a[120:123], v[60:63], v[72:75]
    ds_read_b128 v[52:55], v18 offset:34816
    v_mfma_f32_16x16x32_bf16 v[76:79], a[124:127], v[60:63], v[76:79]
    v_lshlrev_b32 v109, 16, v98
    v_and_b32 v110, 0xffff0000, v98
    s_waitcnt lgkmcnt(4)
    v_mfma_f32_16x16x32_bf16 v[64:67], a[128:131], v[32:35], v[64:67]
    ds_read_b128 v[56:59], v17 offset:35840
    v_mfma_f32_16x16x32_bf16 v[68:71], a[132:135], v[32:35], v[68:71]
    v_and_b32 v106, 0xffff0000, v105
    v_lshlrev_b32 v105, 16, v105
    v_mfma_f32_16x16x32_bf16 v[72:75], a[128:131], v[36:39], v[72:75]
    ds_read_b128 v[60:63], v18 offset:35840
    s_add_u32 m0, s49, 45056
    s_add_u32 s50, s48, 45056
    v_mfma_f32_16x16x32_bf16 v[76:79], a[132:135], v[36:39], v[76:79]
    buffer_load_dwordx4 v21, s[8:11], s50 offen offset:0 sc1 lds
    v_mul_f32 v107, v107, v109
    v_mul_f32 v108, v108, v110
    s_waitcnt lgkmcnt(4)
    v_mfma_f32_16x16x32_bf16 v[64:67], a[136:139], v[40:43], v[64:67]
    ds_read_b128 v[32:35], v17 offset:40960
    v_mfma_f32_16x16x32_bf16 v[68:71], a[140:143], v[40:43], v[68:71]
    v_mul_f32 v105, v104, v105
    v_mul_f32 v106, v104, v106
    v_mfma_f32_16x16x32_bf16 v[72:75], a[136:139], v[44:47], v[72:75]
    ds_read_b128 v[36:39], v18 offset:40960
    v_mfma_f32_16x16x32_bf16 v[76:79], a[140:143], v[44:47], v[76:79]
    v_cvt_pk_bf16_f32 v107, v107, v108
    v_cvt_pk_bf16_f32 v105, v105, v106
    s_waitcnt lgkmcnt(4)
    v_mfma_f32_16x16x32_bf16 v[64:67], a[144:147], v[48:51], v[64:67]
    ds_read_b128 v[40:43], v17 offset:41984
    s_add_u32 m0, s49, 49152
    s_add_u32 s50, s48, 49152
    v_mfma_f32_16x16x32_bf16 v[68:71], a[148:151], v[48:51], v[68:71]
    buffer_load_dwordx4 v21, s[8:11], s50 offen offset:0 sc1 lds
    v_and_b32 v108, 0xffff0000, v107
    v_lshlrev_b32 v107, 16, v107
    v_mfma_f32_16x16x32_bf16 v[72:75], a[144:147], v[52:55], v[72:75]
    ds_read_b128 v[44:47], v18 offset:41984
    v_mfma_f32_16x16x32_bf16 v[76:79], a[148:151], v[52:55], v[76:79]
    v_and_b32 v106, 0xffff0000, v105
    v_lshlrev_b32 v105, 16, v105
    s_waitcnt lgkmcnt(4)
    v_mfma_f32_16x16x32_bf16 v[64:67], a[152:155], v[56:59], v[64:67]
    ds_read_b128 v[48:51], v17 offset:43008
    v_mfma_f32_16x16x32_bf16 v[68:71], a[156:159], v[56:59], v[68:71]
    v_mul_f32 v107, v100, v107
    v_mul_f32 v108, v100, v108
    v_mfma_f32_16x16x32_bf16 v[72:75], a[152:155], v[60:63], v[72:75]
    ds_read_b128 v[52:55], v18 offset:43008
    s_add_u32 m0, s49, 53248
    s_add_u32 s50, s48, 53248
    v_mfma_f32_16x16x32_bf16 v[76:79], a[156:159], v[60:63], v[76:79]
    buffer_load_dwordx4 v21, s[8:11], s50 offen offset:0 sc1 lds
    v_cvt_pk_bf16_f32 v107, v107, v108
    v_and_b32 v108, 0xffff0000, v107
    s_waitcnt lgkmcnt(4)
    v_mfma_f32_16x16x32_bf16 v[64:67], a[160:163], v[32:35], v[64:67]
    ds_read_b128 v[56:59], v17 offset:44032
    v_mfma_f32_16x16x32_bf16 v[68:71], a[164:167], v[32:35], v[68:71]
    v_lshlrev_b32 v107, 16, v107
    v_add_f32 v105, v105, v107
    v_mfma_f32_16x16x32_bf16 v[72:75], a[160:163], v[36:39], v[72:75]
    ds_read_b128 v[60:63], v18 offset:44032
    v_mfma_f32_16x16x32_bf16 v[76:79], a[164:167], v[36:39], v[76:79]
    v_add_f32 v106, v106, v108
    v_cvt_pk_bf16_f32 v102, v105, v106
    s_waitcnt lgkmcnt(4)
    v_mfma_f32_16x16x32_bf16 v[64:67], a[168:171], v[40:43], v[64:67]
    s_barrier
    ds_read_b128 v[32:35], v17 offset:49152
    s_add_u32 m0, s49, 57344
    s_add_u32 s50, s48, 57344
    v_mfma_f32_16x16x32_bf16 v[68:71], a[172:175], v[40:43], v[68:71]
    buffer_load_dwordx4 v21, s[8:11], s50 offen offset:0 sc1 lds
    v_cvt_pk_bf16_f32 v105, v86, v87
    v_lshlrev_b32 v107, 16, v97
    v_mfma_f32_16x16x32_bf16 v[72:75], a[168:171], v[44:47], v[72:75]
    ds_read_b128 v[36:39], v18 offset:49152
    v_mfma_f32_16x16x32_bf16 v[76:79], a[172:175], v[44:47], v[76:79]
    v_and_b32 v108, 0xffff0000, v97
    v_lshlrev_b32 v109, 16, v99
    s_waitcnt lgkmcnt(4)
    v_mfma_f32_16x16x32_bf16 v[64:67], a[176:179], v[48:51], v[64:67]
    ds_read_b128 v[40:43], v17 offset:50176
    v_mfma_f32_16x16x32_bf16 v[68:71], a[180:183], v[48:51], v[68:71]
    v_and_b32 v110, 0xffff0000, v99
    v_and_b32 v106, 0xffff0000, v105
    v_mfma_f32_16x16x32_bf16 v[72:75], a[176:179], v[52:55], v[72:75]
    ds_read_b128 v[44:47], v18 offset:50176
    s_add_u32 m0, s49, 61440
    s_add_u32 s50, s48, 61440
    v_mfma_f32_16x16x32_bf16 v[76:79], a[180:183], v[52:55], v[76:79]
    buffer_load_dwordx4 v21, s[8:11], s50 offen offset:0 sc1 lds
    v_lshlrev_b32 v105, 16, v105
    v_mul_f32 v107, v107, v109
    s_waitcnt lgkmcnt(4)
    v_mfma_f32_16x16x32_bf16 v[64:67], a[184:187], v[56:59], v[64:67]
    ds_read_b128 v[48:51], v17 offset:51200
    v_mfma_f32_16x16x32_bf16 v[68:71], a[188:191], v[56:59], v[68:71]
    v_mul_f32 v108, v108, v110
    v_mul_f32 v105, v104, v105
    v_mfma_f32_16x16x32_bf16 v[72:75], a[184:187], v[60:63], v[72:75]
    ds_read_b128 v[52:55], v18 offset:51200
    v_mfma_f32_16x16x32_bf16 v[76:79], a[188:191], v[60:63], v[76:79]
    v_mul_f32 v106, v104, v106
    v_cvt_pk_bf16_f32 v107, v107, v108
    s_waitcnt lgkmcnt(4)
    v_mfma_f32_16x16x32_bf16 v[64:67], a[192:195], v[32:35], v[64:67]
    ds_read_b128 v[56:59], v17 offset:52224
    v_mfma_f32_16x16x32_bf16 v[68:71], a[196:199], v[32:35], v[68:71]
    v_cvt_pk_bf16_f32 v105, v105, v106
    v_and_b32 v108, 0xffff0000, v107
    v_mfma_f32_16x16x32_bf16 v[72:75], a[192:195], v[36:39], v[72:75]
    ds_read_b128 v[60:63], v18 offset:52224
    v_mfma_f32_16x16x32_bf16 v[76:79], a[196:199], v[36:39], v[76:79]
    v_lshlrev_b32 v107, 16, v107
    v_and_b32 v106, 0xffff0000, v105
    s_waitcnt lgkmcnt(4)
    v_mfma_f32_16x16x32_bf16 v[64:67], a[200:203], v[40:43], v[64:67]
    ds_read_b128 v[32:35], v17 offset:57344
    v_mfma_f32_16x16x32_bf16 v[68:71], a[204:207], v[40:43], v[68:71]
    v_lshlrev_b32 v105, 16, v105
    v_mul_f32 v107, v100, v107
    v_mfma_f32_16x16x32_bf16 v[72:75], a[200:203], v[44:47], v[72:75]
    ds_read_b128 v[36:39], v18 offset:57344
    v_mfma_f32_16x16x32_bf16 v[76:79], a[204:207], v[44:47], v[76:79]
    v_mul_f32 v108, v100, v108
    v_cvt_pk_bf16_f32 v107, v107, v108
    s_waitcnt lgkmcnt(4)
    v_mfma_f32_16x16x32_bf16 v[64:67], a[208:211], v[48:51], v[64:67]
    ds_read_b128 v[40:43], v17 offset:58368
    v_mfma_f32_16x16x32_bf16 v[68:71], a[212:215], v[48:51], v[68:71]
    v_and_b32 v108, 0xffff0000, v107
    v_lshlrev_b32 v107, 16, v107
    v_mfma_f32_16x16x32_bf16 v[72:75], a[208:211], v[52:55], v[72:75]
    ds_read_b128 v[44:47], v18 offset:58368
    v_mfma_f32_16x16x32_bf16 v[76:79], a[212:215], v[52:55], v[76:79]
    v_add_f32 v105, v105, v107
    v_add_f32 v106, v106, v108
    s_waitcnt lgkmcnt(4)
    v_mfma_f32_16x16x32_bf16 v[64:67], a[216:219], v[56:59], v[64:67]
    ds_read_b128 v[48:51], v17 offset:59392
    v_mfma_f32_16x16x32_bf16 v[68:71], a[220:223], v[56:59], v[68:71]
    v_cvt_pk_bf16_f32 v103, v105, v106
    s_mov_b64 exec, s[64:65]
    buffer_store_dwordx2 v[102:103], v22, s[44:47], s52 offen
    s_mov_b64 exec, -1
    v_mfma_f32_16x16x32_bf16 v[72:75], a[216:219], v[60:63], v[72:75]
    ds_read_b128 v[52:55], v18 offset:59392
    v_mfma_f32_16x16x32_bf16 v[76:79], a[220:223], v[60:63], v[76:79]
    s_add_u32 s51, s34, s55
    s_lshl_b32 s52, s54, 16
    s_lshl_b32 s60, s54, 7
    s_add_u32 s58, s60, 117440512
    s_add_u32 s59, s60, 117448704
    s_add_u32 s60, s60, 121634816

    s_cmp_eq_u32 s38, 0
    s_waitcnt lgkmcnt(4)
    v_mfma_f32_16x16x32_bf16 v[64:67], a[224:227], v[32:35], v[64:67]
    ds_read_b128 v[56:59], v17 offset:60416
    v_mfma_f32_16x16x32_bf16 v[68:71], a[228:231], v[32:35], v[68:71]
    s_cbranch_scc1 .cs_424
    buffer_load_dwordx2 v[96:97], v22, s[16:19], s52 offen
.cs_424:
    v_mfma_f32_16x16x32_bf16 v[72:75], a[224:227], v[36:39], v[72:75]
    ds_read_b128 v[60:63], v18 offset:60416
    v_mfma_f32_16x16x32_bf16 v[76:79], a[228:231], v[36:39], v[76:79]
    s_cbranch_scc1 .cs_425
    buffer_load_dword v98, v23, s[8:11], s58 offen
.cs_425:
    s_waitcnt lgkmcnt(4)
    v_mfma_f32_16x16x32_bf16 v[64:67], a[232:235], v[40:43], v[64:67]
    v_mfma_f32_16x16x32_bf16 v[68:71], a[236:239], v[40:43], v[68:71]
    s_cbranch_scc1 .cs_426
    buffer_load_dword v99, v23, s[8:11], s59 offen
.cs_426:
    v_mfma_f32_16x16x32_bf16 v[72:75], a[232:235], v[44:47], v[72:75]
    v_mfma_f32_16x16x32_bf16 v[76:79], a[236:239], v[44:47], v[76:79]
    s_cbranch_scc1 .cs_427
    buffer_load_dword v100, v16, s[8:11], s60 offen
.cs_427:
    s_waitcnt lgkmcnt(2)
    v_mfma_f32_16x16x32_bf16 v[64:67], a[240:243], v[48:51], v[64:67]
    v_mfma_f32_16x16x32_bf16 v[68:71], a[244:247], v[48:51], v[68:71]
    s_cbranch_scc1 .cs_428
    buffer_load_dwordx4 v[84:87], v7, s[8:11], s51 offen sc1
.cs_428:
    v_mfma_f32_16x16x32_bf16 v[72:75], a[240:243], v[52:55], v[72:75]
    v_mfma_f32_16x16x32_bf16 v[76:79], a[244:247], v[52:55], v[76:79]
    s_cbranch_scc1 .cs_429
    buffer_load_dwordx4 v[88:91], v8, s[8:11], s51 offen sc1
.cs_429:
    s_waitcnt lgkmcnt(0)
    v_mfma_f32_16x16x32_bf16 v[64:67], a[248:251], v[56:59], v[64:67]
    v_mfma_f32_16x16x32_bf16 v[68:71], a[252:255], v[56:59], v[68:71]
    s_cbranch_scc1 .cs_430
    buffer_load_dwordx4 v[92:95], v9, s[8:11], s51 offen sc1
.cs_430:
    v_mfma_f32_16x16x32_bf16 v[72:75], a[248:251], v[60:63], v[72:75]
    v_mfma_f32_16x16x32_bf16 v[76:79], a[252:255], v[60:63], v[76:79]
    v_xor_b32 v17, 0x10000, v17
    v_xor_b32 v18, 0x10000, v18
    s_cselect_b64 s[64:65], 0, -1
    s_add_u32 s4, s34, s37

    v_mov_b32 v112, v80
    v_mov_b32 v113, v81
    v_mov_b32 v114, v82
    v_mov_b32 v115, v83
    s_branch .g2st_414
.g2nd_413:
    s_waitcnt lgkmcnt(4)
    v_mfma_f32_16x16x32_bf16 v[64:67], a[0:3], v[32:35], 0
    ds_read_b128 v[56:59], v17 offset:3072
    v_mfma_f32_16x16x32_bf16 v[68:71], a[4:7], v[32:35], 0
    v_mfma_f32_16x16x32_bf16 v[72:75], a[0:3], v[36:39], 0
    ds_read_b128 v[60:63], v18 offset:3072
    v_mfma_f32_16x16x32_bf16 v[76:79], a[4:7], v[36:39], 0
    s_waitcnt lgkmcnt(4)
    v_mfma_f32_16x16x32_bf16 v[64:67], a[8:11], v[40:43], v[64:67]
    ds_read_b128 v[32:35], v17 offset:8192
    v_mfma_f32_16x16x32_bf16 v[68:71], a[12:15], v[40:43], v[68:71]
    v_mfma_f32_16x16x32_bf16 v[72:75], a[8:11], v[44:47], v[72:75]
    ds_read_b128 v[36:39], v18 offset:8192
    v_mfma_f32_16x16x32_bf16 v[76:79], a[12:15], v[44:47], v[76:79]
    s_waitcnt lgkmcnt(4)
    v_mfma_f32_16x16x32_bf16 v[64:67], a[16:19], v[48:51], v[64:67]
    ds_read_b128 v[40:43], v17 offset:9216
    v_mfma_f32_16x16x32_bf16 v[68:71], a[20:23], v[48:51], v[68:71]
    v_mfma_f32_16x16x32_bf16 v[72:75], a[16:19], v[52:55], v[72:75]
    ds_read_b128 v[44:47], v18 offset:9216
    v_mfma_f32_16x16x32_bf16 v[76:79], a[20:23], v[52:55], v[76:79]
    s_waitcnt lgkmcnt(4)
    v_mfma_f32_16x16x32_bf16 v[64:67], a[24:27], v[56:59], v[64:67]
    ds_read_b128 v[48:51], v17 offset:10240
    v_mfma_f32_16x16x32_bf16 v[68:71], a[28:31], v[56:59], v[68:71]
    v_mfma_f32_16x16x32_bf16 v[72:75], a[24:27], v[60:63], v[72:75]
    ds_read_b128 v[52:55], v18 offset:10240
    v_mfma_f32_16x16x32_bf16 v[76:79], a[28:31], v[60:63], v[76:79]
    s_waitcnt lgkmcnt(4)
    v_mfma_f32_16x16x32_bf16 v[64:67], a[32:35], v[32:35], v[64:67]
    ds_read_b128 v[56:59], v17 offset:11264
    v_mfma_f32_16x16x32_bf16 v[68:71], a[36:39], v[32:35], v[68:71]
    v_mfma_f32_16x16x32_bf16 v[72:75], a[32:35], v[36:39], v[72:75]
    ds_read_b128 v[60:63], v18 offset:11264
    v_mfma_f32_16x16x32_bf16 v[76:79], a[36:39], v[36:39], v[76:79]
    s_waitcnt lgkmcnt(4)
    v_mfma_f32_16x16x32_bf16 v[64:67], a[40:43], v[40:43], v[64:67]
    s_barrier
    ds_read_b128 v[32:35], v17 offset:16384
    v_mfma_f32_16x16x32_bf16 v[68:71], a[44:47], v[40:43], v[68:71]
    v_mfma_f32_16x16x32_bf16 v[72:75], a[40:43], v[44:47], v[72:75]
    ds_read_b128 v[36:39], v18 offset:16384
    v_mfma_f32_16x16x32_bf16 v[76:79], a[44:47], v[44:47], v[76:79]
    s_waitcnt lgkmcnt(4)
    v_mfma_f32_16x16x32_bf16 v[64:67], a[48:51], v[48:51], v[64:67]
    ds_read_b128 v[40:43], v17 offset:17408
    v_mfma_f32_16x16x32_bf16 v[68:71], a[52:55], v[48:51], v[68:71]
    v_mfma_f32_16x16x32_bf16 v[72:75], a[48:51], v[52:55], v[72:75]
    ds_read_b128 v[44:47], v18 offset:17408
    v_mfma_f32_16x16x32_bf16 v[76:79], a[52:55], v[52:55], v[76:79]
    s_waitcnt lgkmcnt(4)
    v_mfma_f32_16x16x32_bf16 v[64:67], a[56:59], v[56:59], v[64:67]
    ds_read_b128 v[48:51], v17 offset:18432
    v_mfma_f32_16x16x32_bf16 v[68:71], a[60:63], v[56:59], v[68:71]
    v_mfma_f32_16x16x32_bf16 v[72:75], a[56:59], v[60:63], v[72:75]
    ds_read_b128 v[52:55], v18 offset:18432
    v_mfma_f32_16x16x32_bf16 v[76:79], a[60:63], v[60:63], v[76:79]
    s_waitcnt lgkmcnt(4)
    v_mfma_f32_16x16x32_bf16 v[64:67], a[64:67], v[32:35], v[64:67]
    ds_read_b128 v[56:59], v17 offset:19456
    v_mfma_f32_16x16x32_bf16 v[68:71], a[68:71], v[32:35], v[68:71]
    v_mfma_f32_16x16x32_bf16 v[72:75], a[64:67], v[36:39], v[72:75]
    ds_read_b128 v[60:63], v18 offset:19456
    v_mfma_f32_16x16x32_bf16 v[76:79], a[68:71], v[36:39], v[76:79]
    s_waitcnt lgkmcnt(4)
    v_mfma_f32_16x16x32_bf16 v[64:67], a[72:75], v[40:43], v[64:67]
    ds_read_b128 v[32:35], v17 offset:24576
    v_mfma_f32_16x16x32_bf16 v[68:71], a[76:79], v[40:43], v[68:71]
    v_mfma_f32_16x16x32_bf16 v[72:75], a[72:75], v[44:47], v[72:75]
    ds_read_b128 v[36:39], v18 offset:24576
    v_mfma_f32_16x16x32_bf16 v[76:79], a[76:79], v[44:47], v[76:79]
    s_waitcnt lgkmcnt(4)
    v_mfma_f32_16x16x32_bf16 v[64:67], a[80:83], v[48:51], v[64:67]
    ds_read_b128 v[40:43], v17 offset:25600
    v_mfma_f32_16x16x32_bf16 v[68:71], a[84:87], v[48:51], v[68:71]
    s_waitcnt vmcnt(3)
    v_mfma_f32_16x16x32_bf16 v[72:75], a[80:83], v[52:55], v[72:75]
    ds_read_b128 v[44:47], v18 offset:25600
    v_mfma_f32_16x16x32_bf16 v[76:79], a[84:87], v[52:55], v[76:79]
    s_mov_b32 s62, 0
.cc_431:
    v_max3_u32 v4, v84, v88, v92
    v_cmp_eq_u32 vcc, -1, v4
    s_and_b64 vcc, vcc, s[64:65]
    s_cbranch_vccnz .cf_432
    s_waitcnt lgkmcnt(4)
    v_mfma_f32_16x16x32_bf16 v[64:67], a[88:91], v[56:59], v[64:67]
    ds_read_b128 v[48:51], v17 offset:26624
    v_mfma_f32_16x16x32_bf16 v[68:71], a[92:95], v[56:59], v[68:71]
    v_add_f32 v84, v84, v88
    v_add_f32 v92, v112, v92
    v_mfma_f32_16x16x32_bf16 v[72:75], a[88:91], v[60:63], v[72:75]
    ds_read_b128 v[52:55], v18 offset:26624
    v_mfma_f32_16x16x32_bf16 v[76:79], a[92:95], v[60:63], v[76:79]
    v_add_f32 v85, v85, v89
    v_add_f32 v93, v113, v93
    s_waitcnt lgkmcnt(4)
    v_mfma_f32_16x16x32_bf16 v[64:67], a[96:99], v[32:35], v[64:67]
    ds_read_b128 v[56:59], v17 offset:27648
    v_mfma_f32_16x16x32_bf16 v[68:71], a[100:103], v[32:35], v[68:71]
    v_add_f32 v86, v86, v90
    v_add_f32 v94, v114, v94
    v_mfma_f32_16x16x32_bf16 v[72:75], a[96:99], v[36:39], v[72:75]
    ds_read_b128 v[60:63], v18 offset:27648
    v_mfma_f32_16x16x32_bf16 v[76:79], a[100:103], v[36:39], v[76:79]
    v_add_f32 v87, v87, v91
    v_add_f32 v95, v115, v95
    s_waitcnt lgkmcnt(4)
    v_mfma_f32_16x16x32_bf16 v[64:67], a[104:107], v[40:43], v[64:67]
    s_barrier
    ds_read_b128 v[32:35], v17 offset:32768
    v_mfma_f32_16x16x32_bf16 v[68:71], a[108:111], v[40:43], v[68:71]
    v_add_f32 v84, v92, v84
    v_add_f32 v85, v93, v85
    v_mfma_f32_16x16x32_bf16 v[72:75], a[104:107], v[44:47], v[72:75]
    ds_read_b128 v[36:39], v18 offset:32768
    v_mfma_f32_16x16x32_bf16 v[76:79], a[108:111], v[44:47], v[76:79]
    v_add_f32 v86, v94, v86
    v_add_f32 v87, v95, v87
    s_waitcnt lgkmcnt(4)
    v_mfma_f32_16x16x32_bf16 v[64:67], a[112:115], v[48:51], v[64:67]
    ds_read_b128 v[40:43], v17 offset:33792
    v_mfma_f32_16x16x32_bf16 v[68:71], a[116:119], v[48:51], v[68:71]
    v_sub_f32 v104, 1.0, v100
    v_cvt_pk_bf16_f32 v104, v104, v104
    v_mfma_f32_16x16x32_bf16 v[72:75], a[112:115], v[52:55], v[72:75]
    ds_read_b128 v[44:47], v18 offset:33792
    v_mfma_f32_16x16x32_bf16 v[76:79], a[116:119], v[52:55], v[76:79]
    v_lshlrev_b32 v104, 16, v104
    v_cvt_pk_bf16_f32 v105, v84, v85
    s_waitcnt lgkmcnt(4)
    v_mfma_f32_16x16x32_bf16 v[64:67], a[120:123], v[56:59], v[64:67]
    ds_read_b128 v[48:51], v17 offset:34816
    v_mfma_f32_16x16x32_bf16 v[68:71], a[124:127], v[56:59], v[68:71]
    v_lshlrev_b32 v107, 16, v96
    v_and_b32 v108, 0xffff0000, v96
    v_mfma_f32_16x16x32_bf16 v[72:75], a[120:123], v[60:63], v[72:75]
    ds_read_b128 v[52:55], v18 offset:34816
    v_mfma_f32_16x16x32_bf16 v[76:79], a[124:127], v[60:63], v[76:79]
    v_lshlrev_b32 v109, 16, v98
    v_and_b32 v110, 0xffff0000, v98
    s_waitcnt lgkmcnt(4)
    v_mfma_f32_16x16x32_bf16 v[64:67], a[128:131], v[32:35], v[64:67]
    ds_read_b128 v[56:59], v17 offset:35840
    v_mfma_f32_16x16x32_bf16 v[68:71], a[132:135], v[32:35], v[68:71]
    v_and_b32 v106, 0xffff0000, v105
    v_lshlrev_b32 v105, 16, v105
    v_mfma_f32_16x16x32_bf16 v[72:75], a[128:131], v[36:39], v[72:75]
    ds_read_b128 v[60:63], v18 offset:35840
    v_mfma_f32_16x16x32_bf16 v[76:79], a[132:135], v[36:39], v[76:79]
    v_mul_f32 v107, v107, v109
    v_mul_f32 v108, v108, v110
    s_waitcnt lgkmcnt(4)
    v_mfma_f32_16x16x32_bf16 v[64:67], a[136:139], v[40:43], v[64:67]
    ds_read_b128 v[32:35], v17 offset:40960
    v_mfma_f32_16x16x32_bf16 v[68:71], a[140:143], v[40:43], v[68:71]
    v_mul_f32 v105, v104, v105
    v_mul_f32 v106, v104, v106
    v_mfma_f32_16x16x32_bf16 v[72:75], a[136:139], v[44:47], v[72:75]
    ds_read_b128 v[36:39], v18 offset:40960
    v_mfma_f32_16x16x32_bf16 v[76:79], a[140:143], v[44:47], v[76:79]
    v_cvt_pk_bf16_f32 v107, v107, v108
    v_cvt_pk_bf16_f32 v105, v105, v106
    s_waitcnt lgkmcnt(4)
    v_mfma_f32_16x16x32_bf16 v[64:67], a[144:147], v[48:51], v[64:67]
    ds_read_b128 v[40:43], v17 offset:41984
    v_mfma_f32_16x16x32_bf16 v[68:71], a[148:151], v[48:51], v[68:71]
    v_and_b32 v108, 0xffff0000, v107
    v_lshlrev_b32 v107, 16, v107
    v_mfma_f32_16x16x32_bf16 v[72:75], a[144:147], v[52:55], v[72:75]
    ds_read_b128 v[44:47], v18 offset:41984
    v_mfma_f32_16x16x32_bf16 v[76:79], a[148:151], v[52:55], v[76:79]
    v_and_b32 v106, 0xffff0000, v105
    v_lshlrev_b32 v105, 16, v105
    s_waitcnt lgkmcnt(4)
    v_mfma_f32_16x16x32_bf16 v[64:67], a[152:155], v[56:59], v[64:67]
    ds_read_b128 v[48:51], v17 offset:43008
    v_mfma_f32_16x16x32_bf16 v[68:71], a[156:159], v[56:59], v[68:71]
    v_mul_f32 v107, v100, v107
    v_mul_f32 v108, v100, v108
    v_mfma_f32_16x16x32_bf16 v[72:75], a[152:155], v[60:63], v[72:75]
    ds_read_b128 v[52:55], v18 offset:43008
    v_mfma_f32_16x16x32_bf16 v[76:79], a[156:159], v[60:63], v[76:79]
    v_cvt_pk_bf16_f32 v107, v107, v108
    v_and_b32 v108, 0xffff0000, v107
    s_waitcnt lgkmcnt(4)
    v_mfma_f32_16x16x32_bf16 v[64:67], a[160:163], v[32:35], v[64:67]
    ds_read_b128 v[56:59], v17 offset:44032
    v_mfma_f32_16x16x32_bf16 v[68:71], a[164:167], v[32:35], v[68:71]
    v_lshlrev_b32 v107, 16, v107
    v_add_f32 v105, v105, v107
    v_mfma_f32_16x16x32_bf16 v[72:75], a[160:163], v[36:39], v[72:75]
    ds_read_b128 v[60:63], v18 offset:44032
    v_mfma_f32_16x16x32_bf16 v[76:79], a[164:167], v[36:39], v[76:79]
    v_add_f32 v106, v106, v108
    v_cvt_pk_bf16_f32 v102, v105, v106
    s_waitcnt lgkmcnt(4)
    v_mfma_f32_16x16x32_bf16 v[64:67], a[168:171], v[40:43], v[64:67]
    s_barrier
    ds_read_b128 v[32:35], v17 offset:49152
    v_mfma_f32_16x16x32_bf16 v[68:71], a[172:175], v[40:43], v[68:71]
    v_cvt_pk_bf16_f32 v105, v86, v87
    v_lshlrev_b32 v107, 16, v97
    v_mfma_f32_16x16x32_bf16 v[72:75], a[168:171], v[44:47], v[72:75]
    ds_read_b128 v[36:39], v18 offset:49152
    v_mfma_f32_16x16x32_bf16 v[76:79], a[172:175], v[44:47], v[76:79]
    v_and_b32 v108, 0xffff0000, v97
    v_lshlrev_b32 v109, 16, v99
    s_waitcnt lgkmcnt(4)
    v_mfma_f32_16x16x32_bf16 v[64:67], a[176:179], v[48:51], v[64:67]
    ds_read_b128 v[40:43], v17 offset:50176
    v_mfma_f32_16x16x32_bf16 v[68:71], a[180:183], v[48:51], v[68:71]
    v_and_b32 v110, 0xffff0000, v99
    v_and_b32 v106, 0xffff0000, v105
    v_mfma_f32_16x16x32_bf16 v[72:75], a[176:179], v[52:55], v[72:75]
    ds_read_b128 v[44:47], v18 offset:50176
    v_mfma_f32_16x16x32_bf16 v[76:79], a[180:183], v[52:55], v[76:79]
    v_lshlrev_b32 v105, 16, v105
    v_mul_f32 v107, v107, v109
    s_waitcnt lgkmcnt(4)
    v_mfma_f32_16x16x32_bf16 v[64:67], a[184:187], v[56:59], v[64:67]
    ds_read_b128 v[48:51], v17 offset:51200
    v_mfma_f32_16x16x32_bf16 v[68:71], a[188:191], v[56:59], v[68:71]
    v_mul_f32 v108, v108, v110
    v_mul_f32 v105, v104, v105
    v_mfma_f32_16x16x32_bf16 v[72:75], a[184:187], v[60:63], v[72:75]
    ds_read_b128 v[52:55], v18 offset:51200
    v_mfma_f32_16x16x32_bf16 v[76:79], a[188:191], v[60:63], v[76:79]
    v_mul_f32 v106, v104, v106
    v_cvt_pk_bf16_f32 v107, v107, v108
    s_waitcnt lgkmcnt(4)
    v_mfma_f32_16x16x32_bf16 v[64:67], a[192:195], v[32:35], v[64:67]
    ds_read_b128 v[56:59], v17 offset:52224
    v_mfma_f32_16x16x32_bf16 v[68:71], a[196:199], v[32:35], v[68:71]
    v_cvt_pk_bf16_f32 v105, v105, v106
    v_and_b32 v108, 0xffff0000, v107
    v_mfma_f32_16x16x32_bf16 v[72:75], a[192:195], v[36:39], v[72:75]
    ds_read_b128 v[60:63], v18 offset:52224
    v_mfma_f32_16x16x32_bf16 v[76:79], a[196:199], v[36:39], v[76:79]
    v_lshlrev_b32 v107, 16, v107
    v_and_b32 v106, 0xffff0000, v105
    s_waitcnt lgkmcnt(4)
    v_mfma_f32_16x16x32_bf16 v[64:67], a[200:203], v[40:43], v[64:67]
    ds_read_b128 v[32:35], v17 offset:57344
    v_mfma_f32_16x16x32_bf16 v[68:71], a[204:207], v[40:43], v[68:71]
    v_lshlrev_b32 v105, 16, v105
    v_mul_f32 v107, v100, v107
    v_mfma_f32_16x16x32_bf16 v[72:75], a[200:203], v[44:47], v[72:75]
    ds_read_b128 v[36:39], v18 offset:57344
    v_mfma_f32_16x16x32_bf16 v[76:79], a[204:207], v[44:47], v[76:79]
    v_mul_f32 v108, v100, v108
    v_cvt_pk_bf16_f32 v107, v107, v108
    s_waitcnt lgkmcnt(4)
    v_mfma_f32_16x16x32_bf16 v[64:67], a[208:211], v[48:51], v[64:67]
    ds_read_b128 v[40:43], v17 offset:58368
    v_mfma_f32_16x16x32_bf16 v[68:71], a[212:215], v[48:51], v[68:71]
    v_and_b32 v108, 0xffff0000, v107
    v_lshlrev_b32 v107, 16, v107
    v_mfma_f32_16x16x32_bf16 v[72:75], a[208:211], v[52:55], v[72:75]
    ds_read_b128 v[44:47], v18 offset:58368
    v_mfma_f32_16x16x32_bf16 v[76:79], a[212:215], v[52:55], v[76:79]
    v_add_f32 v105, v105, v107
    v_add_f32 v106, v106, v108
    s_waitcnt lgkmcnt(4)
    v_mfma_f32_16x16x32_bf16 v[64:67], a[216:219], v[56:59], v[64:67]
    ds_read_b128 v[48:51], v17 offset:59392
    v_mfma_f32_16x16x32_bf16 v[68:71], a[220:223], v[56:59], v[68:71]
    v_cvt_pk_bf16_f32 v103, v105, v106
    s_mov_b64 exec, s[64:65]
    buffer_store_dwordx2 v[102:103], v22, s[44:47], s52 offen
    s_mov_b64 exec, -1
    v_mfma_f32_16x16x32_bf16 v[72:75], a[216:219], v[60:63], v[72:75]
    ds_read_b128 v[52:55], v18 offset:59392
    v_mfma_f32_16x16x32_bf16 v[76:79], a[220:223], v[60:63], v[76:79]
    s_add_u32 s51, s34, s55
    s_lshl_b32 s52, s54, 16
    s_lshl_b32 s60, s54, 7
    s_add_u32 s58, s60, 117440512
    s_add_u32 s59, s60, 117448704
    s_add_u32 s60, s60, 121634816

    s_cmp_eq_u32 s38, 0
    s_waitcnt lgkmcnt(4)
    v_mfma_f32_16x16x32_bf16 v[64:67], a[224:227], v[32:35], v[64:67]
    ds_read_b128 v[56:59], v17 offset:60416
    v_mfma_f32_16x16x32_bf16 v[68:71], a[228:231], v[32:35], v[68:71]
    s_cbranch_scc1 .cs_433
    buffer_load_dwordx2 v[96:97], v22, s[16:19], s52 offen
.cs_433:
    v_mfma_f32_16x16x32_bf16 v[72:75], a[224:227], v[36:39], v[72:75]
    ds_read_b128 v[60:63], v18 offset:60416
    v_mfma_f32_16x16x32_bf16 v[76:79], a[228:231], v[36:39], v[76:79]
    s_cbranch_scc1 .cs_434
    buffer_load_dword v98, v23, s[8:11], s58 offen
.cs_434:
    s_waitcnt lgkmcnt(4)
    v_mfma_f32_16x16x32_bf16 v[64:67], a[232:235], v[40:43], v[64:67]
    v_mfma_f32_16x16x32_bf16 v[68:71], a[236:239], v[40:43], v[68:71]
    s_cbranch_scc1 .cs_435
    buffer_load_dword v99, v23, s[8:11], s59 offen
.cs_435:
    v_mfma_f32_16x16x32_bf16 v[72:75], a[232:235], v[44:47], v[72:75]
    v_mfma_f32_16x16x32_bf16 v[76:79], a[236:239], v[44:47], v[76:79]
    s_cbranch_scc1 .cs_436
    buffer_load_dword v100, v16, s[8:11], s60 offen
.cs_436:
    s_waitcnt lgkmcnt(2)
    v_mfma_f32_16x16x32_bf16 v[64:67], a[240:243], v[48:51], v[64:67]
    v_mfma_f32_16x16x32_bf16 v[68:71], a[244:247], v[48:51], v[68:71]
    s_cbranch_scc1 .cs_437
    buffer_load_dwordx4 v[84:87], v7, s[8:11], s51 offen sc1
.cs_437:
    v_mfma_f32_16x16x32_bf16 v[72:75], a[240:243], v[52:55], v[72:75]
    v_mfma_f32_16x16x32_bf16 v[76:79], a[244:247], v[52:55], v[76:79]
    s_cbranch_scc1 .cs_438
    buffer_load_dwordx4 v[88:91], v8, s[8:11], s51 offen sc1
.cs_438:
    s_waitcnt lgkmcnt(0)
    v_mfma_f32_16x16x32_bf16 v[64:67], a[248:251], v[56:59], v[64:67]
    v_mfma_f32_16x16x32_bf16 v[68:71], a[252:255], v[56:59], v[68:71]
    s_cbranch_scc1 .cs_439
    buffer_load_dwordx4 v[92:95], v9, s[8:11], s51 offen sc1
.cs_439:
    v_mfma_f32_16x16x32_bf16 v[72:75], a[248:251], v[60:63], v[72:75]
    v_mfma_f32_16x16x32_bf16 v[76:79], a[252:255], v[60:63], v[76:79]
    v_xor_b32 v17, 0x10000, v17
    v_xor_b32 v18, 0x10000, v18
    s_cselect_b64 s[64:65], 0, -1
    s_add_u32 s4, s34, s37

    v_mov_b32 v112, v80
    v_mov_b32 v113, v81
    v_mov_b32 v114, v82
    v_mov_b32 v115, v83
.g2st_414:
    v_min_u32 v68, 0xfffffffe, v68
    buffer_store_dwordx4 v[68:71], v28, s[8:11], s4 offen sc1
    v_min_u32 v72, 0xfffffffe, v72
    buffer_store_dwordx4 v[72:75], v29, s[8:11], s4 offen sc1
    v_min_u32 v76, 0xfffffffe, v76
    buffer_store_dwordx4 v[76:79], v30, s[8:11], s4 offen sc1
    v_mov_b32 v80, v64
    v_mov_b32 v81, v65
    v_mov_b32 v82, v66
    v_mov_b32 v83, v67
    s_cmp_lg_u32 s56, 0
    s_cbranch_scc1 .g2pf_440
    s_cmp_eq_u32 s38, 0
    s_cbranch_scc1 .g2nc_415
    s_waitcnt vmcnt(0)
    s_mov_b32 s62, 0
.cc_441:
    v_max3_u32 v4, v84, v88, v92
    v_cmp_eq_u32 vcc, -1, v4
    s_cbranch_vccnz .cf_442
    v_add_f32 v84, v84, v88
    v_add_f32 v92, v112, v92
    v_add_f32 v85, v85, v89
    v_add_f32 v93, v113, v93
    v_add_f32 v86, v86, v90
    v_add_f32 v94, v114, v94
    v_add_f32 v87, v87, v91
    v_add_f32 v95, v115, v95
    v_add_f32 v84, v92, v84
    v_add_f32 v85, v93, v85
    v_add_f32 v86, v94, v86
    v_add_f32 v87, v95, v87
    v_sub_f32 v104, 1.0, v100
    v_cvt_pk_bf16_f32 v104, v104, v104
    v_lshlrev_b32 v104, 16, v104
    v_cvt_pk_bf16_f32 v105, v84, v85
    v_lshlrev_b32 v107, 16, v96
    v_and_b32 v108, 0xffff0000, v96
    v_lshlrev_b32 v109, 16, v98
    v_and_b32 v110, 0xffff0000, v98
    v_and_b32 v106, 0xffff0000, v105
    v_lshlrev_b32 v105, 16, v105
    v_mul_f32 v107, v107, v109
    v_mul_f32 v108, v108, v110
    v_mul_f32 v105, v104, v105
    v_mul_f32 v106, v104, v106
    v_cvt_pk_bf16_f32 v107, v107, v108
    v_cvt_pk_bf16_f32 v105, v105, v106
    v_and_b32 v108, 0xffff0000, v107
    v_lshlrev_b32 v107, 16, v107
    v_and_b32 v106, 0xffff0000, v105
    v_lshlrev_b32 v105, 16, v105
    v_mul_f32 v107, v100, v107
    v_mul_f32 v108, v100, v108
    v_cvt_pk_bf16_f32 v107, v107, v108
    v_and_b32 v108, 0xffff0000, v107
    v_lshlrev_b32 v107, 16, v107
    v_add_f32 v105, v105, v107
    v_add_f32 v106, v106, v108
    v_cvt_pk_bf16_f32 v102, v105, v106
    v_cvt_pk_bf16_f32 v105, v86, v87
    v_lshlrev_b32 v107, 16, v97
    v_and_b32 v108, 0xffff0000, v97
    v_lshlrev_b32 v109, 16, v99
    v_and_b32 v110, 0xffff0000, v99
    v_and_b32 v106, 0xffff0000, v105
    v_lshlrev_b32 v105, 16, v105
    v_mul_f32 v107, v107, v109
    v_mul_f32 v108, v108, v110
    v_mul_f32 v105, v104, v105
    v_mul_f32 v106, v104, v106
    v_cvt_pk_bf16_f32 v107, v107, v108
    v_cvt_pk_bf16_f32 v105, v105, v106
    v_and_b32 v108, 0xffff0000, v107
    v_lshlrev_b32 v107, 16, v107
    v_and_b32 v106, 0xffff0000, v105
    v_lshlrev_b32 v105, 16, v105
    v_mul_f32 v107, v100, v107
    v_mul_f32 v108, v100, v108
    v_cvt_pk_bf16_f32 v107, v107, v108
    v_and_b32 v108, 0xffff0000, v107
    v_lshlrev_b32 v107, 16, v107
    v_add_f32 v105, v105, v107
    v_add_f32 v106, v106, v108
    v_cvt_pk_bf16_f32 v103, v105, v106
    buffer_store_dwordx2 v[102:103], v22, s[44:47], s52 offen
.g2nc_415:
    s_add_u32 s51, s34, s37
    s_lshl_b32 s52, s31, 16
    s_lshl_b32 s60, s31, 7
    s_add_u32 s58, s60, 117440512
    s_add_u32 s59, s60, 117448704
    s_add_u32 s60, s60, 121634816

    buffer_load_dwordx2 v[96:97], v22, s[16:19], s52 offen
    buffer_load_dword v98, v23, s[8:11], s58 offen
    buffer_load_dword v99, v23, s[8:11], s59 offen
    buffer_load_dword v100, v16, s[8:11], s60 offen
    buffer_load_dwordx4 v[84:87], v7, s[8:11], s51 offen sc1
    buffer_load_dwordx4 v[88:91], v8, s[8:11], s51 offen sc1
    buffer_load_dwordx4 v[92:95], v9, s[8:11], s51 offen sc1
    s_waitcnt vmcnt(0)
    s_mov_b32 s62, 0
.cc_443:
    v_max3_u32 v4, v84, v88, v92
    v_cmp_eq_u32 vcc, -1, v4
    s_cbranch_vccnz .cf_444
    v_add_f32 v84, v84, v88
    v_add_f32 v92, v80, v92
    v_add_f32 v85, v85, v89
    v_add_f32 v93, v81, v93
    v_add_f32 v86, v86, v90
    v_add_f32 v94, v82, v94
    v_add_f32 v87, v87, v91
    v_add_f32 v95, v83, v95
    v_add_f32 v84, v92, v84
    v_add_f32 v85, v93, v85
    v_add_f32 v86, v94, v86
    v_add_f32 v87, v95, v87
    v_sub_f32 v104, 1.0, v100
    v_cvt_pk_bf16_f32 v104, v104, v104
    v_lshlrev_b32 v104, 16, v104
    v_cvt_pk_bf16_f32 v105, v84, v85
    v_lshlrev_b32 v107, 16, v96
    v_and_b32 v108, 0xffff0000, v96
    v_lshlrev_b32 v109, 16, v98
    v_and_b32 v110, 0xffff0000, v98
    v_and_b32 v106, 0xffff0000, v105
    v_lshlrev_b32 v105, 16, v105
    v_mul_f32 v107, v107, v109
    v_mul_f32 v108, v108, v110
    v_mul_f32 v105, v104, v105
    v_mul_f32 v106, v104, v106
    v_cvt_pk_bf16_f32 v107, v107, v108
    v_cvt_pk_bf16_f32 v105, v105, v106
    v_and_b32 v108, 0xffff0000, v107
    v_lshlrev_b32 v107, 16, v107
    v_and_b32 v106, 0xffff0000, v105
    v_lshlrev_b32 v105, 16, v105
    v_mul_f32 v107, v100, v107
    v_mul_f32 v108, v100, v108
    v_cvt_pk_bf16_f32 v107, v107, v108
    v_and_b32 v108, 0xffff0000, v107
    v_lshlrev_b32 v107, 16, v107
    v_add_f32 v105, v105, v107
    v_add_f32 v106, v106, v108
    v_cvt_pk_bf16_f32 v102, v105, v106
    v_cvt_pk_bf16_f32 v105, v86, v87
    v_lshlrev_b32 v107, 16, v97
    v_and_b32 v108, 0xffff0000, v97
    v_lshlrev_b32 v109, 16, v99
    v_and_b32 v110, 0xffff0000, v99
    v_and_b32 v106, 0xffff0000, v105
    v_lshlrev_b32 v105, 16, v105
    v_mul_f32 v107, v107, v109
    v_mul_f32 v108, v108, v110
    v_mul_f32 v105, v104, v105
    v_mul_f32 v106, v104, v106
    v_cvt_pk_bf16_f32 v107, v107, v108
    v_cvt_pk_bf16_f32 v105, v105, v106
    v_and_b32 v108, 0xffff0000, v107
    v_lshlrev_b32 v107, 16, v107
    v_and_b32 v106, 0xffff0000, v105
    v_lshlrev_b32 v105, 16, v105
    v_mul_f32 v107, v100, v107
    v_mul_f32 v108, v100, v108
    v_cvt_pk_bf16_f32 v107, v107, v108
    v_and_b32 v108, 0xffff0000, v107
    v_lshlrev_b32 v107, 16, v107
    v_add_f32 v105, v105, v107
    v_add_f32 v106, v106, v108
    v_cvt_pk_bf16_f32 v103, v105, v106
    buffer_store_dwordx2 v[102:103], v22, s[44:47], s52 offen
.g2nx_420:
    s_mov_b32 s31, s53
    s_add_u32 s37, s37, 0x10000
    s_cmp_lt_u32 s31, 64
    s_cbranch_scc1 .g2blk_409
    s_branch .g2fin_416

.g2pf_440:
    s_mov_b32 s31, s53
    s_add_u32 s37, s37, 0x10000
    s_cmp_eq_u32 s38, 0
    s_mov_b32 s38, 1
    s_cbranch_scc1 .g2w3_411
    s_waitcnt vmcnt(10)
    s_branch .g2go_410

.g2w3_411:
    s_waitcnt vmcnt(3)
    s_branch .g2go_410
.g2fb_419:
    s_add_u32 s51, s34, s37
    s_lshl_b32 s52, s31, 16
    s_lshl_b32 s60, s31, 7
    s_add_u32 s58, s60, 117440512
    s_add_u32 s59, s60, 117448704
    s_add_u32 s60, s60, 121634816

    s_waitcnt vmcnt(4)
    s_barrier
    ds_read_b128 v[32:35], v17 offset:0
    ds_read_b128 v[36:39], v18 offset:0
    ds_read_b128 v[40:43], v17 offset:1024
    ds_read_b128 v[44:47], v18 offset:1024
    ds_read_b128 v[48:51], v17 offset:2048
    ds_read_b128 v[52:55], v18 offset:2048
    s_waitcnt lgkmcnt(4)
    v_mfma_f32_16x16x32_bf16 v[64:67], a[0:3], v[32:35], 0
    ds_read_b128 v[56:59], v17 offset:3072
    v_mfma_f32_16x16x32_bf16 v[68:71], a[4:7], v[32:35], 0
    s_add_u32 m0, s49, 32768
    s_add_u32 s50, s48, 32768
    v_mfma_f32_16x16x32_bf16 v[72:75], a[0:3], v[36:39], 0
    ds_read_b128 v[60:63], v18 offset:3072
    v_mfma_f32_16x16x32_bf16 v[76:79], a[4:7], v[36:39], 0
    buffer_load_dwordx4 v21, s[8:11], s50 offen offset:0 sc1 lds
    s_waitcnt lgkmcnt(4)
    v_mfma_f32_16x16x32_bf16 v[64:67], a[8:11], v[40:43], v[64:67]
    ds_read_b128 v[32:35], v17 offset:8192
    v_mfma_f32_16x16x32_bf16 v[68:71], a[12:15], v[40:43], v[68:71]
    s_add_u32 m0, s49, 36864
    s_add_u32 s50, s48, 36864
    v_mfma_f32_16x16x32_bf16 v[72:75], a[8:11], v[44:47], v[72:75]
    ds_read_b128 v[36:39], v18 offset:8192
    v_mfma_f32_16x16x32_bf16 v[76:79], a[12:15], v[44:47], v[76:79]
    buffer_load_dwordx4 v21, s[8:11], s50 offen offset:0 sc1 lds
    s_waitcnt lgkmcnt(4)
    v_mfma_f32_16x16x32_bf16 v[64:67], a[16:19], v[48:51], v[64:67]
    ds_read_b128 v[40:43], v17 offset:9216
    v_mfma_f32_16x16x32_bf16 v[68:71], a[20:23], v[48:51], v[68:71]
    s_add_u32 m0, s49, 40960
    s_add_u32 s50, s48, 40960
    v_mfma_f32_16x16x32_bf16 v[72:75], a[16:19], v[52:55], v[72:75]
    ds_read_b128 v[44:47], v18 offset:9216
    v_mfma_f32_16x16x32_bf16 v[76:79], a[20:23], v[52:55], v[76:79]
    buffer_load_dwordx4 v21, s[8:11], s50 offen offset:0 sc1 lds
    s_waitcnt lgkmcnt(4)
    v_mfma_f32_16x16x32_bf16 v[64:67], a[24:27], v[56:59], v[64:67]
    ds_read_b128 v[48:51], v17 offset:10240
    v_mfma_f32_16x16x32_bf16 v[68:71], a[28:31], v[56:59], v[68:71]
    s_add_u32 m0, s49, 45056
    s_add_u32 s50, s48, 45056
    v_mfma_f32_16x16x32_bf16 v[72:75], a[24:27], v[60:63], v[72:75]
    ds_read_b128 v[52:55], v18 offset:10240
    v_mfma_f32_16x16x32_bf16 v[76:79], a[28:31], v[60:63], v[76:79]
    buffer_load_dwordx4 v21, s[8:11], s50 offen offset:0 sc1 lds
    s_waitcnt lgkmcnt(4)
    v_mfma_f32_16x16x32_bf16 v[64:67], a[32:35], v[32:35], v[64:67]
    ds_read_b128 v[56:59], v17 offset:11264
    v_mfma_f32_16x16x32_bf16 v[68:71], a[36:39], v[32:35], v[68:71]
    s_add_u32 m0, s49, 49152
    s_add_u32 s50, s48, 49152
    v_mfma_f32_16x16x32_bf16 v[72:75], a[32:35], v[36:39], v[72:75]
    ds_read_b128 v[60:63], v18 offset:11264
    v_mfma_f32_16x16x32_bf16 v[76:79], a[36:39], v[36:39], v[76:79]
    buffer_load_dwordx4 v21, s[8:11], s50 offen offset:0 sc1 lds
    s_waitcnt lgkmcnt(4)
    v_mfma_f32_16x16x32_bf16 v[64:67], a[40:43], v[40:43], v[64:67]
    s_waitcnt vmcnt(5)
    s_barrier
    ds_read_b128 v[32:35], v17 offset:16384
    v_mfma_f32_16x16x32_bf16 v[68:71], a[44:47], v[40:43], v[68:71]
    s_add_u32 m0, s49, 53248
    s_add_u32 s50, s48, 53248
    v_mfma_f32_16x16x32_bf16 v[72:75], a[40:43], v[44:47], v[72:75]
    ds_read_b128 v[36:39], v18 offset:16384
    v_mfma_f32_16x16x32_bf16 v[76:79], a[44:47], v[44:47], v[76:79]
    buffer_load_dwordx4 v21, s[8:11], s50 offen offset:0 sc1 lds
    s_waitcnt lgkmcnt(4)
    v_mfma_f32_16x16x32_bf16 v[64:67], a[48:51], v[48:51], v[64:67]
    ds_read_b128 v[40:43], v17 offset:17408
    v_mfma_f32_16x16x32_bf16 v[68:71], a[52:55], v[48:51], v[68:71]
    s_add_u32 m0, s49, 57344
    s_add_u32 s50, s48, 57344
    v_mfma_f32_16x16x32_bf16 v[72:75], a[48:51], v[52:55], v[72:75]
    ds_read_b128 v[44:47], v18 offset:17408
    v_mfma_f32_16x16x32_bf16 v[76:79], a[52:55], v[52:55], v[76:79]
    buffer_load_dwordx4 v21, s[8:11], s50 offen offset:0 sc1 lds
    s_waitcnt lgkmcnt(4)
    v_mfma_f32_16x16x32_bf16 v[64:67], a[56:59], v[56:59], v[64:67]
    ds_read_b128 v[48:51], v17 offset:18432
    v_mfma_f32_16x16x32_bf16 v[68:71], a[60:63], v[56:59], v[68:71]
    s_add_u32 m0, s49, 61440
    s_add_u32 s50, s48, 61440
    v_mfma_f32_16x16x32_bf16 v[72:75], a[56:59], v[60:63], v[72:75]
    ds_read_b128 v[52:55], v18 offset:18432
    v_mfma_f32_16x16x32_bf16 v[76:79], a[60:63], v[60:63], v[76:79]
    buffer_load_dwordx4 v21, s[8:11], s50 offen offset:0 sc1 lds
    s_waitcnt lgkmcnt(4)
    v_mfma_f32_16x16x32_bf16 v[64:67], a[64:67], v[32:35], v[64:67]
    ds_read_b128 v[56:59], v17 offset:19456
    v_mfma_f32_16x16x32_bf16 v[68:71], a[68:71], v[32:35], v[68:71]
    v_mfma_f32_16x16x32_bf16 v[72:75], a[64:67], v[36:39], v[72:75]
    ds_read_b128 v[60:63], v18 offset:19456
    v_mfma_f32_16x16x32_bf16 v[76:79], a[68:71], v[36:39], v[76:79]
    buffer_load_dwordx2 v[96:97], v22, s[16:19], s52 offen
    s_waitcnt lgkmcnt(4)
    v_mfma_f32_16x16x32_bf16 v[64:67], a[72:75], v[40:43], v[64:67]
    ds_read_b128 v[32:35], v17 offset:24576
    v_mfma_f32_16x16x32_bf16 v[68:71], a[76:79], v[40:43], v[68:71]
    v_mfma_f32_16x16x32_bf16 v[72:75], a[72:75], v[44:47], v[72:75]
    ds_read_b128 v[36:39], v18 offset:24576
    v_mfma_f32_16x16x32_bf16 v[76:79], a[76:79], v[44:47], v[76:79]
    buffer_load_dword v98, v23, s[8:11], s58 offen
    s_waitcnt lgkmcnt(4)
    v_mfma_f32_16x16x32_bf16 v[64:67], a[80:83], v[48:51], v[64:67]
    ds_read_b128 v[40:43], v17 offset:25600
    v_mfma_f32_16x16x32_bf16 v[68:71], a[84:87], v[48:51], v[68:71]
    v_mfma_f32_16x16x32_bf16 v[72:75], a[80:83], v[52:55], v[72:75]
    ds_read_b128 v[44:47], v18 offset:25600
    v_mfma_f32_16x16x32_bf16 v[76:79], a[84:87], v[52:55], v[76:79]
    buffer_load_dword v99, v23, s[8:11], s59 offen
    s_waitcnt lgkmcnt(4)
    v_mfma_f32_16x16x32_bf16 v[64:67], a[88:91], v[56:59], v[64:67]
    ds_read_b128 v[48:51], v17 offset:26624
    v_mfma_f32_16x16x32_bf16 v[68:71], a[92:95], v[56:59], v[68:71]
    v_mfma_f32_16x16x32_bf16 v[72:75], a[88:91], v[60:63], v[72:75]
    ds_read_b128 v[52:55], v18 offset:26624
    v_mfma_f32_16x16x32_bf16 v[76:79], a[92:95], v[60:63], v[76:79]
    buffer_load_dword v100, v16, s[8:11], s60 offen
    s_waitcnt lgkmcnt(4)
    v_mfma_f32_16x16x32_bf16 v[64:67], a[96:99], v[32:35], v[64:67]
    ds_read_b128 v[56:59], v17 offset:27648
    v_mfma_f32_16x16x32_bf16 v[68:71], a[100:103], v[32:35], v[68:71]
    v_mfma_f32_16x16x32_bf16 v[72:75], a[96:99], v[36:39], v[72:75]
    ds_read_b128 v[60:63], v18 offset:27648
    v_mfma_f32_16x16x32_bf16 v[76:79], a[100:103], v[36:39], v[76:79]
    s_waitcnt lgkmcnt(4)
    v_mfma_f32_16x16x32_bf16 v[64:67], a[104:107], v[40:43], v[64:67]
    s_waitcnt vmcnt(8)
    s_barrier
    ds_read_b128 v[32:35], v17 offset:32768
    v_mfma_f32_16x16x32_bf16 v[68:71], a[108:111], v[40:43], v[68:71]
    v_mfma_f32_16x16x32_bf16 v[72:75], a[104:107], v[44:47], v[72:75]
    ds_read_b128 v[36:39], v18 offset:32768
    v_mfma_f32_16x16x32_bf16 v[76:79], a[108:111], v[44:47], v[76:79]
    s_waitcnt lgkmcnt(4)
    v_mfma_f32_16x16x32_bf16 v[64:67], a[112:115], v[48:51], v[64:67]
    ds_read_b128 v[40:43], v17 offset:33792
    v_mfma_f32_16x16x32_bf16 v[68:71], a[116:119], v[48:51], v[68:71]
    v_mfma_f32_16x16x32_bf16 v[72:75], a[112:115], v[52:55], v[72:75]
    ds_read_b128 v[44:47], v18 offset:33792
    v_mfma_f32_16x16x32_bf16 v[76:79], a[116:119], v[52:55], v[76:79]
    s_waitcnt lgkmcnt(4)
    v_mfma_f32_16x16x32_bf16 v[64:67], a[120:123], v[56:59], v[64:67]
    ds_read_b128 v[48:51], v17 offset:34816
    v_mfma_f32_16x16x32_bf16 v[68:71], a[124:127], v[56:59], v[68:71]
    v_mfma_f32_16x16x32_bf16 v[72:75], a[120:123], v[60:63], v[72:75]
    ds_read_b128 v[52:55], v18 offset:34816
    v_mfma_f32_16x16x32_bf16 v[76:79], a[124:127], v[60:63], v[76:79]
    s_waitcnt lgkmcnt(4)
    v_mfma_f32_16x16x32_bf16 v[64:67], a[128:131], v[32:35], v[64:67]
    ds_read_b128 v[56:59], v17 offset:35840
    v_mfma_f32_16x16x32_bf16 v[68:71], a[132:135], v[32:35], v[68:71]
    v_mfma_f32_16x16x32_bf16 v[72:75], a[128:131], v[36:39], v[72:75]
    ds_read_b128 v[60:63], v18 offset:35840
    v_mfma_f32_16x16x32_bf16 v[76:79], a[132:135], v[36:39], v[76:79]
    s_waitcnt lgkmcnt(4)
    v_mfma_f32_16x16x32_bf16 v[64:67], a[136:139], v[40:43], v[64:67]
    ds_read_b128 v[32:35], v17 offset:40960
    v_mfma_f32_16x16x32_bf16 v[68:71], a[140:143], v[40:43], v[68:71]
    v_mfma_f32_16x16x32_bf16 v[72:75], a[136:139], v[44:47], v[72:75]
    ds_read_b128 v[36:39], v18 offset:40960
    v_mfma_f32_16x16x32_bf16 v[76:79], a[140:143], v[44:47], v[76:79]
    s_waitcnt lgkmcnt(4)
    v_mfma_f32_16x16x32_bf16 v[64:67], a[144:147], v[48:51], v[64:67]
    ds_read_b128 v[40:43], v17 offset:41984
    v_mfma_f32_16x16x32_bf16 v[68:71], a[148:151], v[48:51], v[68:71]
    v_mfma_f32_16x16x32_bf16 v[72:75], a[144:147], v[52:55], v[72:75]
    ds_read_b128 v[44:47], v18 offset:41984
    v_mfma_f32_16x16x32_bf16 v[76:79], a[148:151], v[52:55], v[76:79]
    s_waitcnt lgkmcnt(4)
    v_mfma_f32_16x16x32_bf16 v[64:67], a[152:155], v[56:59], v[64:67]
    ds_read_b128 v[48:51], v17 offset:43008
    v_mfma_f32_16x16x32_bf16 v[68:71], a[156:159], v[56:59], v[68:71]
    v_mfma_f32_16x16x32_bf16 v[72:75], a[152:155], v[60:63], v[72:75]
    ds_read_b128 v[52:55], v18 offset:43008
    v_mfma_f32_16x16x32_bf16 v[76:79], a[156:159], v[60:63], v[76:79]
    s_waitcnt lgkmcnt(4)
    v_mfma_f32_16x16x32_bf16 v[64:67], a[160:163], v[32:35], v[64:67]
    ds_read_b128 v[56:59], v17 offset:44032
    v_mfma_f32_16x16x32_bf16 v[68:71], a[164:167], v[32:35], v[68:71]
    v_mfma_f32_16x16x32_bf16 v[72:75], a[160:163], v[36:39], v[72:75]
    ds_read_b128 v[60:63], v18 offset:44032
    v_mfma_f32_16x16x32_bf16 v[76:79], a[164:167], v[36:39], v[76:79]
    s_waitcnt lgkmcnt(4)
    v_mfma_f32_16x16x32_bf16 v[64:67], a[168:171], v[40:43], v[64:67]
    s_waitcnt vmcnt(4)
    s_barrier
    ds_read_b128 v[32:35], v17 offset:49152
    v_mfma_f32_16x16x32_bf16 v[68:71], a[172:175], v[40:43], v[68:71]
    v_mfma_f32_16x16x32_bf16 v[72:75], a[168:171], v[44:47], v[72:75]
    ds_read_b128 v[36:39], v18 offset:49152
    v_mfma_f32_16x16x32_bf16 v[76:79], a[172:175], v[44:47], v[76:79]
    s_waitcnt lgkmcnt(4)
    v_mfma_f32_16x16x32_bf16 v[64:67], a[176:179], v[48:51], v[64:67]
    ds_read_b128 v[40:43], v17 offset:50176
    v_mfma_f32_16x16x32_bf16 v[68:71], a[180:183], v[48:51], v[68:71]
    v_mfma_f32_16x16x32_bf16 v[72:75], a[176:179], v[52:55], v[72:75]
    ds_read_b128 v[44:47], v18 offset:50176
    v_mfma_f32_16x16x32_bf16 v[76:79], a[180:183], v[52:55], v[76:79]
    s_waitcnt lgkmcnt(4)
    v_mfma_f32_16x16x32_bf16 v[64:67], a[184:187], v[56:59], v[64:67]
    ds_read_b128 v[48:51], v17 offset:51200
    v_mfma_f32_16x16x32_bf16 v[68:71], a[188:191], v[56:59], v[68:71]
    v_mfma_f32_16x16x32_bf16 v[72:75], a[184:187], v[60:63], v[72:75]
    ds_read_b128 v[52:55], v18 offset:51200
    v_mfma_f32_16x16x32_bf16 v[76:79], a[188:191], v[60:63], v[76:79]
    s_waitcnt lgkmcnt(4)
    v_mfma_f32_16x16x32_bf16 v[64:67], a[192:195], v[32:35], v[64:67]
    ds_read_b128 v[56:59], v17 offset:52224
    v_mfma_f32_16x16x32_bf16 v[68:71], a[196:199], v[32:35], v[68:71]
    v_mfma_f32_16x16x32_bf16 v[72:75], a[192:195], v[36:39], v[72:75]
    ds_read_b128 v[60:63], v18 offset:52224
    v_mfma_f32_16x16x32_bf16 v[76:79], a[196:199], v[36:39], v[76:79]
    s_waitcnt lgkmcnt(4)
    v_mfma_f32_16x16x32_bf16 v[64:67], a[200:203], v[40:43], v[64:67]
    ds_read_b128 v[32:35], v17 offset:57344
    v_mfma_f32_16x16x32_bf16 v[68:71], a[204:207], v[40:43], v[68:71]
    v_mfma_f32_16x16x32_bf16 v[72:75], a[200:203], v[44:47], v[72:75]
    ds_read_b128 v[36:39], v18 offset:57344
    v_mfma_f32_16x16x32_bf16 v[76:79], a[204:207], v[44:47], v[76:79]
    s_waitcnt lgkmcnt(4)
    v_mfma_f32_16x16x32_bf16 v[64:67], a[208:211], v[48:51], v[64:67]
    ds_read_b128 v[40:43], v17 offset:58368
    v_mfma_f32_16x16x32_bf16 v[68:71], a[212:215], v[48:51], v[68:71]
    v_mfma_f32_16x16x32_bf16 v[72:75], a[208:211], v[52:55], v[72:75]
    ds_read_b128 v[44:47], v18 offset:58368
    v_mfma_f32_16x16x32_bf16 v[76:79], a[212:215], v[52:55], v[76:79]
    s_waitcnt lgkmcnt(4)
    v_mfma_f32_16x16x32_bf16 v[64:67], a[216:219], v[56:59], v[64:67]
    ds_read_b128 v[48:51], v17 offset:59392
    v_mfma_f32_16x16x32_bf16 v[68:71], a[220:223], v[56:59], v[68:71]
    v_mfma_f32_16x16x32_bf16 v[72:75], a[216:219], v[60:63], v[72:75]
    ds_read_b128 v[52:55], v18 offset:59392
    v_mfma_f32_16x16x32_bf16 v[76:79], a[220:223], v[60:63], v[76:79]
    s_waitcnt lgkmcnt(4)
    v_mfma_f32_16x16x32_bf16 v[64:67], a[224:227], v[32:35], v[64:67]
    ds_read_b128 v[56:59], v17 offset:60416
    v_mfma_f32_16x16x32_bf16 v[68:71], a[228:231], v[32:35], v[68:71]
    v_mfma_f32_16x16x32_bf16 v[72:75], a[224:227], v[36:39], v[72:75]
    ds_read_b128 v[60:63], v18 offset:60416
    v_mfma_f32_16x16x32_bf16 v[76:79], a[228:231], v[36:39], v[76:79]
    s_waitcnt lgkmcnt(4)
    v_mfma_f32_16x16x32_bf16 v[64:67], a[232:235], v[40:43], v[64:67]
    v_mfma_f32_16x16x32_bf16 v[68:71], a[236:239], v[40:43], v[68:71]
    v_mfma_f32_16x16x32_bf16 v[72:75], a[232:235], v[44:47], v[72:75]
    v_mfma_f32_16x16x32_bf16 v[76:79], a[236:239], v[44:47], v[76:79]
    s_waitcnt lgkmcnt(2)
    v_mfma_f32_16x16x32_bf16 v[64:67], a[240:243], v[48:51], v[64:67]
    v_mfma_f32_16x16x32_bf16 v[68:71], a[244:247], v[48:51], v[68:71]
    v_mfma_f32_16x16x32_bf16 v[72:75], a[240:243], v[52:55], v[72:75]
    v_mfma_f32_16x16x32_bf16 v[76:79], a[244:247], v[52:55], v[76:79]
    s_waitcnt lgkmcnt(0)
    v_mfma_f32_16x16x32_bf16 v[64:67], a[248:251], v[56:59], v[64:67]
    v_mfma_f32_16x16x32_bf16 v[68:71], a[252:255], v[56:59], v[68:71]
    v_mfma_f32_16x16x32_bf16 v[72:75], a[248:251], v[60:63], v[72:75]
    v_mfma_f32_16x16x32_bf16 v[76:79], a[252:255], v[60:63], v[76:79]
    v_xor_b32 v17, 0x10000, v17
    v_xor_b32 v18, 0x10000, v18
    s_nop 3
    v_min_u32 v68, 0xfffffffe, v68
    buffer_store_dwordx4 v[68:71], v28, s[8:11], s51 offen sc1
    v_min_u32 v72, 0xfffffffe, v72
    buffer_store_dwordx4 v[72:75], v29, s[8:11], s51 offen sc1
    v_min_u32 v76, 0xfffffffe, v76
    buffer_store_dwordx4 v[76:79], v30, s[8:11], s51 offen sc1
    s_waitcnt vmcnt(3)
    v_sub_f32 v104, 1.0, v100
    v_cvt_pk_bf16_f32 v104, v104, v104
    v_lshlrev_b32 v104, 16, v104
    v_lshlrev_b32 v107, 16, v96
    v_and_b32 v108, 0xffff0000, v96
    v_lshlrev_b32 v109, 16, v98
    v_and_b32 v110, 0xffff0000, v98
    v_mul_f32 v107, v107, v109
    v_mul_f32 v108, v108, v110
    v_cvt_pk_bf16_f32 v107, v107, v108
    v_and_b32 v108, 0xffff0000, v107
    v_lshlrev_b32 v107, 16, v107
    v_mul_f32 v107, v100, v107
    v_mul_f32 v108, v100, v108
    v_cvt_pk_bf16_f32 v107, v107, v108
    v_and_b32 v113, 0xffff0000, v107
    v_lshlrev_b32 v112, 16, v107
    v_lshlrev_b32 v107, 16, v97
    v_and_b32 v108, 0xffff0000, v97
    v_lshlrev_b32 v109, 16, v99
    v_and_b32 v110, 0xffff0000, v99
    v_mul_f32 v107, v107, v109
    v_mul_f32 v108, v108, v110
    v_cvt_pk_bf16_f32 v107, v107, v108
    v_and_b32 v108, 0xffff0000, v107
    v_lshlrev_b32 v107, 16, v107
    v_mul_f32 v107, v100, v107
    v_mul_f32 v108, v100, v108
    v_cvt_pk_bf16_f32 v107, v107, v108
    v_and_b32 v115, 0xffff0000, v107
    v_lshlrev_b32 v114, 16, v107
    s_waitcnt vmcnt(0)
    buffer_load_dwordx4 v[84:87], v7, s[8:11], s51 offen sc1
    buffer_load_dwordx4 v[88:91], v8, s[8:11], s51 offen sc1
    buffer_load_dwordx4 v[92:95], v9, s[8:11], s51 offen sc1
    s_waitcnt vmcnt(0)
    s_mov_b32 s62, 0
.cc_445:
    v_max3_u32 v4, v84, v88, v92
    v_cmp_eq_u32 vcc, -1, v4
    s_cbranch_vccnz .cf_446
    v_add_f32 v84, v84, v88
    v_add_f32 v92, v64, v92
    v_add_f32 v85, v85, v89
    v_add_f32 v93, v65, v93
    v_add_f32 v86, v86, v90
    v_add_f32 v94, v66, v94
    v_add_f32 v87, v87, v91
    v_add_f32 v95, v67, v95
    v_add_f32 v84, v92, v84
    v_add_f32 v85, v93, v85
    v_add_f32 v86, v94, v86
    v_add_f32 v87, v95, v87
    v_cvt_pk_bf16_f32 v105, v84, v85
    v_cvt_pk_bf16_f32 v107, v86, v87
    v_and_b32 v106, 0xffff0000, v105
    v_lshlrev_b32 v105, 16, v105
    v_and_b32 v108, 0xffff0000, v107
    v_lshlrev_b32 v107, 16, v107
    v_mul_f32 v105, v104, v105
    v_mul_f32 v106, v104, v106
    v_mul_f32 v107, v104, v107
    v_mul_f32 v108, v104, v108
    v_cvt_pk_bf16_f32 v105, v105, v106
    v_cvt_pk_bf16_f32 v107, v107, v108
    v_and_b32 v106, 0xffff0000, v105
    v_lshlrev_b32 v105, 16, v105
    v_and_b32 v108, 0xffff0000, v107
    v_lshlrev_b32 v107, 16, v107
    v_add_f32 v105, v105, v112
    v_add_f32 v106, v106, v113
    v_add_f32 v107, v107, v114
    v_add_f32 v108, v108, v115
    v_cvt_pk_bf16_f32 v102, v105, v106
    v_cvt_pk_bf16_f32 v103, v107, v108
    buffer_store_dwordx2 v[102:103], v22, s[44:47], s52 offen
    s_branch .g2nx_420
.cf_423:
    buffer_load_dwordx4 v[84:87], v7, s[8:11], s51 offen sc1
    buffer_load_dwordx4 v[88:91], v8, s[8:11], s51 offen sc1
    buffer_load_dwordx4 v[92:95], v9, s[8:11], s51 offen sc1
    s_add_u32 s62, s62, 1
    s_cmp_gt_u32 s62, 0x400000
    s_cbranch_scc1 .mg_end_1
    s_waitcnt vmcnt(0)
    s_branch .cc_422

.cf_432:
    buffer_load_dwordx4 v[84:87], v7, s[8:11], s51 offen sc1
    buffer_load_dwordx4 v[88:91], v8, s[8:11], s51 offen sc1
    buffer_load_dwordx4 v[92:95], v9, s[8:11], s51 offen sc1
    s_add_u32 s62, s62, 1
    s_cmp_gt_u32 s62, 0x400000
    s_cbranch_scc1 .mg_end_1
    s_waitcnt vmcnt(0)
    s_branch .cc_431

.cf_442:
    buffer_load_dwordx4 v[84:87], v7, s[8:11], s51 offen sc1
    buffer_load_dwordx4 v[88:91], v8, s[8:11], s51 offen sc1
    buffer_load_dwordx4 v[92:95], v9, s[8:11], s51 offen sc1
    s_add_u32 s62, s62, 1
    s_cmp_gt_u32 s62, 0x400000
    s_cbranch_scc1 .mg_end_1
    s_waitcnt vmcnt(0)
    s_branch .cc_441

.cf_444:
    buffer_load_dwordx4 v[84:87], v7, s[8:11], s51 offen sc1
    buffer_load_dwordx4 v[88:91], v8, s[8:11], s51 offen sc1
    buffer_load_dwordx4 v[92:95], v9, s[8:11], s51 offen sc1
    s_add_u32 s62, s62, 1
    s_cmp_gt_u32 s62, 0x400000
    s_cbranch_scc1 .mg_end_1
    s_waitcnt vmcnt(0)
    s_branch .cc_443

.cf_446:
    buffer_load_dwordx4 v[84:87], v7, s[8:11], s51 offen sc1
    buffer_load_dwordx4 v[88:91], v8, s[8:11], s51 offen sc1
    buffer_load_dwordx4 v[92:95], v9, s[8:11], s51 offen sc1
    s_add_u32 s62, s62, 1
    s_cmp_gt_u32 s62, 0x400000
    s_cbranch_scc1 .mg_end_1
    s_waitcnt vmcnt(0)
    s_branch .cc_445

.g2fin_416:
    s_endpgm
.cvrole_370:
    s_lshl_b32 s4, s91, 3
    s_add_u32 s4, s4, s26
    s_add_u32 s4, s4, 72
    s_lshl_b32 s4, s4, 8
    s_add_u32 s92, s4, 92274688
    s_lshl_b32 s4, s24, 2
    s_add_u32 s92, s92, s4
    v_mov_b32 v4, 0
    s_mov_b64 exec, 1
    buffer_store_dword v4, v4, s[8:11], s92 offen sc1
    s_mov_b64 exec, -1

    s_waitcnt vmcnt(0)
    s_barrier
    v_mov_b32 v243, s99
    v_mov_b32 v242, 0
    s_cmp_lg_u32 s24, 0
    s_cbranch_scc1 .a1_447
    v_mov_b32 v242, s26
    v_lshlrev_b32 v242, 6, v242
    v_add_u32 v242, s97, v242
    v_and_b32 v242, 255, v242
    s_mov_b64 exec, 1
    buffer_atomic_add v243, v242, s[20:23], 0 offen sc1
    s_mov_b64 exec, -1

.a1_447:
    s_waitcnt vmcnt(0)
    s_cmp_lg_u32 s24, 0
    s_cbranch_scc1 .pm_449
    s_lshl_b32 s93, s91, 3
    s_add_u32 s93, s93, s26
    s_sub_u32 s93, s93, 24
    s_and_b32 s94, s93, 1
    s_sub_u32 s5, 0, s100
    s_and_b32 s5, s5, 0x1fffff
    s_add_u32 s5, s5, 100663296
    s_lshl_b32 s4, s94, 21
    s_add_u32 s5, s5, s4
    s_lshl_b32 s4, s93, 8
    s_add_u32 s5, s5, s4
    s_add_u32 s6, s5, 8192
    v_and_b32 v4, 63, v0
    v_lshlrev_b32 v4, 2, v4
    v_mov_b32 v5, -1
    s_mov_b32 s82, 0x7fffffff
    s_mov_b32 s83, 0x7fffffff
    buffer_store_dword v5, v4, s[8:11], s5 offen sc1
    s_waitcnt vmcnt(0)

    s_memtime s[72:73]
    s_waitcnt lgkmcnt(0)
    buffer_store_dword v5, v4, s[8:11], s6 offen sc1
    s_waitcnt vmcnt(0)
    s_memtime s[84:85]
    s_waitcnt lgkmcnt(0)
    s_sub_u32 s84, s84, s72
    s_min_u32 s83, s83, s84

    s_memtime s[72:73]
    s_waitcnt lgkmcnt(0)
    buffer_store_dword v5, v4, s[8:11], s5 offen sc1
    s_waitcnt vmcnt(0)
    s_memtime s[84:85]
    s_waitcnt lgkmcnt(0)
    s_sub_u32 s84, s84, s72
    s_min_u32 s82, s82, s84

    s_memtime s[72:73]
    s_waitcnt lgkmcnt(0)
    buffer_store_dword v5, v4, s[8:11], s6 offen sc1
    s_waitcnt vmcnt(0)
    s_memtime s[84:85]
    s_waitcnt lgkmcnt(0)
    s_sub_u32 s84, s84, s72
    s_min_u32 s83, s83, s84

    s_memtime s[72:73]
    s_waitcnt lgkmcnt(0)
    buffer_store_dword v5, v4, s[8:11], s5 offen sc1
    s_waitcnt vmcnt(0)
    s_memtime s[84:85]
    s_waitcnt lgkmcnt(0)
    s_sub_u32 s84, s84, s72
    s_min_u32 s82, s82, s84

    s_memtime s[72:73]
    s_waitcnt lgkmcnt(0)
    buffer_store_dword v5, v4, s[8:11], s6 offen sc1
    s_waitcnt vmcnt(0)
    s_memtime s[84:85]
    s_waitcnt lgkmcnt(0)
    s_sub_u32 s84, s84, s72
    s_min_u32 s83, s83, s84

    s_memtime s[72:73]
    s_waitcnt lgkmcnt(0)
    buffer_store_dword v5, v4, s[8:11], s5 offen sc1
    s_waitcnt vmcnt(0)
    s_memtime s[84:85]
    s_waitcnt lgkmcnt(0)
    s_sub_u32 s84, s84, s72
    s_min_u32 s82, s82, s84

    s_memtime s[72:73]
    s_waitcnt lgkmcnt(0)
    buffer_store_dword v5, v4, s[8:11], s6 offen sc1
    s_waitcnt vmcnt(0)
    s_memtime s[84:85]
    s_waitcnt lgkmcnt(0)
    s_sub_u32 s84, s84, s72
    s_min_u32 s83, s83, s84

    s_memtime s[72:73]
    s_waitcnt lgkmcnt(0)
    buffer_store_dword v5, v4, s[8:11], s5 offen sc1
    s_waitcnt vmcnt(0)
    s_memtime s[84:85]
    s_waitcnt lgkmcnt(0)
    s_sub_u32 s84, s84, s72
    s_min_u32 s82, s82, s84

    s_cmp_lt_u32 s82, s83
    s_cselect_b32 s4, 1, 0
    s_mul_i32 s94, s94, 6
    s_lshl_b32 s4, s4, s94
    s_add_u32 s95, s4, 0x1000000

.pm_449:
    s_cmp_lg_u32 s24, 0
    s_cbranch_scc1 .pv_450
    s_mov_b64 exec, 1
    v_mov_b32 v4, s95
    v_mov_b32 v5, 4
    buffer_atomic_add v4, v5, s[20:23], s97 offen sc1
    s_mov_b64 exec, -1

.pv_450:
    s_barrier
    s_lshl_b32 s93, s91, 3
    s_add_u32 s93, s93, s26
    s_sub_u32 s93, s93, 24

    s_load_dwordx2 s[40:41], s[0:1], 0
    s_load_dwordx2 s[42:43], s[0:1], 104

    v_and_b32 v1, 63, v0
    v_and_b32 v2, 15, v1
    v_lshrrev_b32 v3, 4, v1

    s_waitcnt lgkmcnt(0)
    s_mov_b32 s12, s40
    s_and_b32 s13, s41, 0xffff
    s_mov_b32 s14, 0x400000
    s_mov_b32 s15, 0x00020000

    s_mov_b32 s16, s42
    s_and_b32 s17, s43, 0xffff
    s_mov_b32 s18, 0x800
    s_mov_b32 s19, 0x00020000

    s_lshl_b32 s3, s93, 6
    s_lshl_b32 s4, s24, 4
    s_add_u32 s3, s3, s4
    v_lshlrev_b32 v8, 4, v1
    buffer_load_dwordx4 v[16:19], v8, s[16:19], 0 offen
    buffer_load_dwordx4 v[20:23], v8, s[16:19], 0 offen offset:1024
    s_lshl_b32 s5, s3, 11

    buffer_load_dwordx4 v[64:67], v8, s[12:15], s5 offen
    buffer_load_dwordx4 v[68:71], v8, s[12:15], s5 offen offset:1024
    s_add_u32 s5, s5, 2048

    buffer_load_dwordx4 v[72:75], v8, s[12:15], s5 offen
    buffer_load_dwordx4 v[76:79], v8, s[12:15], s5 offen offset:1024
    s_add_u32 s5, s5, 2048

    buffer_load_dwordx4 v[80:83], v8, s[12:15], s5 offen
    buffer_load_dwordx4 v[84:87], v8, s[12:15], s5 offen offset:1024
    s_add_u32 s5, s5, 2048

    buffer_load_dwordx4 v[88:91], v8, s[12:15], s5 offen
    buffer_load_dwordx4 v[92:95], v8, s[12:15], s5 offen offset:1024
    s_add_u32 s5, s5, 2048

    buffer_load_dwordx4 v[96:99], v8, s[12:15], s5 offen
    buffer_load_dwordx4 v[100:103], v8, s[12:15], s5 offen offset:1024
    s_add_u32 s5, s5, 2048

    buffer_load_dwordx4 v[104:107], v8, s[12:15], s5 offen
    buffer_load_dwordx4 v[108:111], v8, s[12:15], s5 offen offset:1024
    s_add_u32 s5, s5, 2048

    buffer_load_dwordx4 v[112:115], v8, s[12:15], s5 offen
    buffer_load_dwordx4 v[116:119], v8, s[12:15], s5 offen offset:1024
    s_add_u32 s5, s5, 2048

    buffer_load_dwordx4 v[120:123], v8, s[12:15], s5 offen
    buffer_load_dwordx4 v[124:127], v8, s[12:15], s5 offen offset:1024
    s_add_u32 s5, s5, 2048

    buffer_load_dwordx4 v[128:131], v8, s[12:15], s5 offen
    buffer_load_dwordx4 v[132:135], v8, s[12:15], s5 offen offset:1024
    s_add_u32 s5, s5, 2048

    buffer_load_dwordx4 v[136:139], v8, s[12:15], s5 offen
    buffer_load_dwordx4 v[140:143], v8, s[12:15], s5 offen offset:1024
    s_add_u32 s5, s5, 2048

    buffer_load_dwordx4 v[144:147], v8, s[12:15], s5 offen
    buffer_load_dwordx4 v[148:151], v8, s[12:15], s5 offen offset:1024
    s_add_u32 s5, s5, 2048

    buffer_load_dwordx4 v[152:155], v8, s[12:15], s5 offen
    buffer_load_dwordx4 v[156:159], v8, s[12:15], s5 offen offset:1024
    s_add_u32 s5, s5, 2048

    buffer_load_dwordx4 v[160:163], v8, s[12:15], s5 offen
    buffer_load_dwordx4 v[164:167], v8, s[12:15], s5 offen offset:1024
    s_add_u32 s5, s5, 2048

    buffer_load_dwordx4 v[168:171], v8, s[12:15], s5 offen
    buffer_load_dwordx4 v[172:175], v8, s[12:15], s5 offen offset:1024
    s_add_u32 s5, s5, 2048

    buffer_load_dwordx4 v[176:179], v8, s[12:15], s5 offen
    buffer_load_dwordx4 v[180:183], v8, s[12:15], s5 offen offset:1024
    s_add_u32 s5, s5, 2048

    buffer_load_dwordx4 v[184:187], v8, s[12:15], s5 offen
    buffer_load_dwordx4 v[188:191], v8, s[12:15], s5 offen offset:1024
    s_add_u32 s5, s5, 2048

    v_and_b32 v241, 3, v0
    v_lshlrev_b32 v241, 2, v241

    v_and_b32 v240, 12, v0
    v_lshl_add_u32 v241, v240, 4, v241
    v_add_u32 v241, s97, v241
    v_and_b32 v241, 255, v241

    buffer_load_dword v240, v241, s[20:23], 0 offen sc1
    s_load_dwordx4 s[52:55], s[0:1], 8
    s_load_dwordx2 s[56:57], s[0:1], 32
    v_and_b32 v9, 63, v0
    v_lshlrev_b32 v9, 7, v9
    s_lshl_b32 s6, s93, 17
    s_lshl_b32 s7, s24, 15
    s_add_u32 s6, s6, s7
    s_waitcnt lgkmcnt(0)

    s_mov_b32 s80, s52
    s_and_b32 s81, s53, 0xffff
    s_mov_b32 s82, 0x400000
    s_mov_b32 s83, 0x00020000

    s_add_u32 s7, s6, 0
    buffer_load_dword v250, v9, s[80:83], s7 offen
    s_add_u32 s7, s6, 8192
    buffer_load_dword v250, v9, s[80:83], s7 offen
    s_add_u32 s7, s6, 16384
    buffer_load_dword v250, v9, s[80:83], s7 offen
    s_add_u32 s7, s6, 24576
    buffer_load_dword v250, v9, s[80:83], s7 offen
    s_mov_b32 s80, s54
    s_and_b32 s81, s55, 0xffff
    s_mov_b32 s82, 0x400000
    s_mov_b32 s83, 0x00020000

    s_add_u32 s7, s6, 0
    buffer_load_dword v250, v9, s[80:83], s7 offen
    s_add_u32 s7, s6, 8192
    buffer_load_dword v250, v9, s[80:83], s7 offen
    s_add_u32 s7, s6, 16384
    buffer_load_dword v250, v9, s[80:83], s7 offen
    s_add_u32 s7, s6, 24576
    buffer_load_dword v250, v9, s[80:83], s7 offen
    s_mov_b32 s80, s56
    s_and_b32 s81, s57, 0xffff
    s_mov_b32 s82, 0x400000
    s_mov_b32 s83, 0x00020000

    s_add_u32 s7, s6, 0
    buffer_load_dword v250, v9, s[80:83], s7 offen
    s_add_u32 s7, s6, 8192
    buffer_load_dword v250, v9, s[80:83], s7 offen
    s_add_u32 s7, s6, 16384
    buffer_load_dword v250, v9, s[80:83], s7 offen
    s_add_u32 s7, s6, 24576
    buffer_load_dword v250, v9, s[80:83], s7 offen
    s_waitcnt vmcnt(41)
    v_dot2_f32_bf16 v24, v64, v16, 0
    v_dot2_f32_bf16 v25, v72, v16, 0
    v_dot2_f32_bf16 v24, v65, v17, v24
    v_dot2_f32_bf16 v25, v73, v17, v25
    v_dot2_f32_bf16 v24, v66, v18, v24
    v_dot2_f32_bf16 v25, v74, v18, v25
    v_dot2_f32_bf16 v24, v67, v19, v24
    v_dot2_f32_bf16 v25, v75, v19, v25
    v_dot2_f32_bf16 v24, v68, v20, v24
    v_dot2_f32_bf16 v25, v76, v20, v25
    v_dot2_f32_bf16 v24, v69, v21, v24
    v_dot2_f32_bf16 v25, v77, v21, v25
    v_dot2_f32_bf16 v24, v70, v22, v24
    v_dot2_f32_bf16 v25, v78, v22, v25
    v_dot2_f32_bf16 v24, v71, v23, v24
    v_dot2_f32_bf16 v25, v79, v23, v25
    s_waitcnt vmcnt(37)
    v_dot2_f32_bf16 v26, v80, v16, 0
    v_dot2_f32_bf16 v27, v88, v16, 0
    v_dot2_f32_bf16 v26, v81, v17, v26
    v_dot2_f32_bf16 v27, v89, v17, v27
    v_dot2_f32_bf16 v26, v82, v18, v26
    v_dot2_f32_bf16 v27, v90, v18, v27
    v_dot2_f32_bf16 v26, v83, v19, v26
    v_dot2_f32_bf16 v27, v91, v19, v27
    v_dot2_f32_bf16 v26, v84, v20, v26
    v_dot2_f32_bf16 v27, v92, v20, v27
    v_dot2_f32_bf16 v26, v85, v21, v26
    v_dot2_f32_bf16 v27, v93, v21, v27
    v_dot2_f32_bf16 v26, v86, v22, v26
    v_dot2_f32_bf16 v27, v94, v22, v27
    v_dot2_f32_bf16 v26, v87, v23, v26
    v_dot2_f32_bf16 v27, v95, v23, v27
    s_waitcnt vmcnt(33)
    v_dot2_f32_bf16 v28, v96, v16, 0
    v_dot2_f32_bf16 v29, v104, v16, 0
    v_dot2_f32_bf16 v28, v97, v17, v28
    v_dot2_f32_bf16 v29, v105, v17, v29
    v_dot2_f32_bf16 v28, v98, v18, v28
    v_dot2_f32_bf16 v29, v106, v18, v29
    v_dot2_f32_bf16 v28, v99, v19, v28
    v_dot2_f32_bf16 v29, v107, v19, v29
    v_dot2_f32_bf16 v28, v100, v20, v28
    v_dot2_f32_bf16 v29, v108, v20, v29
    v_dot2_f32_bf16 v28, v101, v21, v28
    v_dot2_f32_bf16 v29, v109, v21, v29
    v_dot2_f32_bf16 v28, v102, v22, v28
    v_dot2_f32_bf16 v29, v110, v22, v29
    v_dot2_f32_bf16 v28, v103, v23, v28
    v_dot2_f32_bf16 v29, v111, v23, v29
    s_waitcnt vmcnt(29)
    v_dot2_f32_bf16 v30, v112, v16, 0
    v_dot2_f32_bf16 v31, v120, v16, 0
    v_dot2_f32_bf16 v30, v113, v17, v30
    v_dot2_f32_bf16 v31, v121, v17, v31
    v_dot2_f32_bf16 v30, v114, v18, v30
    v_dot2_f32_bf16 v31, v122, v18, v31
    v_dot2_f32_bf16 v30, v115, v19, v30
    v_dot2_f32_bf16 v31, v123, v19, v31
    v_dot2_f32_bf16 v30, v116, v20, v30
    v_dot2_f32_bf16 v31, v124, v20, v31
    v_dot2_f32_bf16 v30, v117, v21, v30
    v_dot2_f32_bf16 v31, v125, v21, v31
    v_dot2_f32_bf16 v30, v118, v22, v30
    v_dot2_f32_bf16 v31, v126, v22, v31
    v_dot2_f32_bf16 v30, v119, v23, v30
    v_dot2_f32_bf16 v31, v127, v23, v31
    s_waitcnt vmcnt(25)
    v_dot2_f32_bf16 v32, v128, v16, 0
    v_dot2_f32_bf16 v33, v136, v16, 0
    v_dot2_f32_bf16 v32, v129, v17, v32
    v_dot2_f32_bf16 v33, v137, v17, v33
    v_dot2_f32_bf16 v32, v130, v18, v32
    v_dot2_f32_bf16 v33, v138, v18, v33
    v_dot2_f32_bf16 v32, v131, v19, v32
    v_dot2_f32_bf16 v33, v139, v19, v33
    v_dot2_f32_bf16 v32, v132, v20, v32
    v_dot2_f32_bf16 v33, v140, v20, v33
    v_dot2_f32_bf16 v32, v133, v21, v32
    v_dot2_f32_bf16 v33, v141, v21, v33
    v_dot2_f32_bf16 v32, v134, v22, v32
    v_dot2_f32_bf16 v33, v142, v22, v33
    v_dot2_f32_bf16 v32, v135, v23, v32
    v_dot2_f32_bf16 v33, v143, v23, v33
    s_waitcnt vmcnt(21)
    v_dot2_f32_bf16 v34, v144, v16, 0
    v_dot2_f32_bf16 v35, v152, v16, 0
    v_dot2_f32_bf16 v34, v145, v17, v34
    v_dot2_f32_bf16 v35, v153, v17, v35
    v_dot2_f32_bf16 v34, v146, v18, v34
    v_dot2_f32_bf16 v35, v154, v18, v35
    v_dot2_f32_bf16 v34, v147, v19, v34
    v_dot2_f32_bf16 v35, v155, v19, v35
    v_dot2_f32_bf16 v34, v148, v20, v34
    v_dot2_f32_bf16 v35, v156, v20, v35
    v_dot2_f32_bf16 v34, v149, v21, v34
    v_dot2_f32_bf16 v35, v157, v21, v35
    v_dot2_f32_bf16 v34, v150, v22, v34
    v_dot2_f32_bf16 v35, v158, v22, v35
    v_dot2_f32_bf16 v34, v151, v23, v34
    v_dot2_f32_bf16 v35, v159, v23, v35
    s_waitcnt vmcnt(17)
    v_dot2_f32_bf16 v36, v160, v16, 0
    v_dot2_f32_bf16 v37, v168, v16, 0
    v_dot2_f32_bf16 v36, v161, v17, v36
    v_dot2_f32_bf16 v37, v169, v17, v37
    v_dot2_f32_bf16 v36, v162, v18, v36
    v_dot2_f32_bf16 v37, v170, v18, v37
    v_dot2_f32_bf16 v36, v163, v19, v36
    v_dot2_f32_bf16 v37, v171, v19, v37
    v_dot2_f32_bf16 v36, v164, v20, v36
    v_dot2_f32_bf16 v37, v172, v20, v37
    v_dot2_f32_bf16 v36, v165, v21, v36
    v_dot2_f32_bf16 v37, v173, v21, v37
    v_dot2_f32_bf16 v36, v166, v22, v36
    v_dot2_f32_bf16 v37, v174, v22, v37
    v_dot2_f32_bf16 v36, v167, v23, v36
    v_dot2_f32_bf16 v37, v175, v23, v37
    s_waitcnt vmcnt(13)
    v_dot2_f32_bf16 v38, v176, v16, 0
    v_dot2_f32_bf16 v39, v184, v16, 0
    v_dot2_f32_bf16 v38, v177, v17, v38
    v_dot2_f32_bf16 v39, v185, v17, v39
    v_dot2_f32_bf16 v38, v178, v18, v38
    v_dot2_f32_bf16 v39, v186, v18, v39
    v_dot2_f32_bf16 v38, v179, v19, v38
    v_dot2_f32_bf16 v39, v187, v19, v39
    v_dot2_f32_bf16 v38, v180, v20, v38
    v_dot2_f32_bf16 v39, v188, v20, v39
    v_dot2_f32_bf16 v38, v181, v21, v38
    v_dot2_f32_bf16 v39, v189, v21, v39
    v_dot2_f32_bf16 v38, v182, v22, v38
    v_dot2_f32_bf16 v39, v190, v22, v39
    v_dot2_f32_bf16 v38, v183, v23, v38
    v_dot2_f32_bf16 v39, v191, v23, v39
    s_waitcnt vmcnt(12)
    s_mov_b32 s62, 0
.vp_451:
    v_readlane_b32 s4, v240, 0
    v_readlane_b32 s7, v240, 1
    v_readlane_b32 s6, v240, 2

    v_readlane_b32 s5, v240, 4
    s_add_u32 s4, s4, s5
    v_readlane_b32 s5, v240, 8
    s_add_u32 s4, s4, s5
    v_readlane_b32 s5, v240, 12
    s_add_u32 s4, s4, s5
    s_cmp_ge_u32 s4, 256
    s_cbranch_scc1 .vd_452
    s_cmp_lg_u32 s6, 0
    s_cbranch_scc1 .vs_453
    s_add_u32 s62, s62, 1
    s_cmp_gt_u32 s62, 0x100000
    s_cbranch_scc1 .mg_end_1
    s_sleep 8
    buffer_load_dword v240, v241, s[20:23], 0 offen sc1
    s_waitcnt vmcnt(0)
    s_branch .vp_451

.vs_453:
    s_lshr_b32 s25, s2, 5
    s_and_b32 s26, s2, 31
    s_mov_b32 s27, 1
    s_mov_b32 s99, 1
    s_mov_b32 s97, 144
    s_waitcnt vmcnt(0) lgkmcnt(0)
    s_barrier
    s_branch .mg_role_3

.vd_452:
    v_permlane32_swap_b32 v24, v26
    v_permlane32_swap_b32 v25, v27
    v_permlane32_swap_b32 v28, v30
    v_permlane32_swap_b32 v29, v31
    v_permlane32_swap_b32 v32, v34
    v_permlane32_swap_b32 v33, v35
    v_permlane32_swap_b32 v36, v38
    v_permlane32_swap_b32 v37, v39
    v_add_f32 v24, v24, v26
    v_add_f32 v25, v25, v27
    v_add_f32 v28, v28, v30
    v_add_f32 v29, v29, v31
    v_add_f32 v32, v32, v34
    v_add_f32 v33, v33, v35
    v_add_f32 v36, v36, v38
    v_add_f32 v37, v37, v39
    s_nop 0
    v_permlane16_swap_b32 v24, v25
    v_permlane16_swap_b32 v28, v29
    v_permlane16_swap_b32 v32, v33
    v_permlane16_swap_b32 v36, v37
    v_add_f32 v24, v24, v25
    v_add_f32 v28, v28, v29
    v_add_f32 v32, v32, v33
    v_add_f32 v36, v36, v37
    v_add_f32_dpp v24, v24, v24 row_ror:8 row_mask:0xf bank_mask:0xf
    v_add_f32_dpp v28, v28, v28 row_ror:8 row_mask:0xf bank_mask:0xf
    v_add_f32_dpp v32, v32, v32 row_ror:8 row_mask:0xf bank_mask:0xf
    v_add_f32_dpp v36, v36, v36 row_ror:8 row_mask:0xf bank_mask:0xf
    v_add_f32_dpp v24, v24, v24 row_ror:4 row_mask:0xf bank_mask:0xf
    v_add_f32_dpp v28, v28, v28 row_ror:4 row_mask:0xf bank_mask:0xf
    v_add_f32_dpp v32, v32, v32 row_ror:4 row_mask:0xf bank_mask:0xf
    v_add_f32_dpp v36, v36, v36 row_ror:4 row_mask:0xf bank_mask:0xf
    v_add_f32_dpp v24, v24, v24 row_ror:2 row_mask:0xf bank_mask:0xf
    v_add_f32_dpp v28, v28, v28 row_ror:2 row_mask:0xf bank_mask:0xf
    v_add_f32_dpp v32, v32, v32 row_ror:2 row_mask:0xf bank_mask:0xf
    v_add_f32_dpp v36, v36, v36 row_ror:2 row_mask:0xf bank_mask:0xf
    v_add_f32_dpp v24, v24, v24 row_ror:1 row_mask:0xf bank_mask:0xf
    v_add_f32_dpp v28, v28, v28 row_ror:1 row_mask:0xf bank_mask:0xf
    v_add_f32_dpp v32, v32, v32 row_ror:1 row_mask:0xf bank_mask:0xf
    v_add_f32_dpp v36, v36, v36 row_ror:1 row_mask:0xf bank_mask:0xf
    v_cmp_eq_u32 vcc, 1, v2
    s_nop 1
    v_cndmask_b32 v24, v24, v28, vcc
    v_cmp_eq_u32 vcc, 2, v2
    s_nop 1
    v_cndmask_b32 v24, v24, v32, vcc
    v_cmp_eq_u32 vcc, 3, v2
    s_nop 1
    v_cndmask_b32 v24, v24, v36, vcc
    v_cvt_pk_bf16_f32 v24, v24, v24
    s_mov_b32 s38, 0xbfb8aa3b
    v_lshlrev_b32 v24, 16, v24
    v_mul_f32 v24, s38, v24
    v_exp_f32 v24, v24
    v_lshlrev_b32 v8, 4, v2
    v_add_f32 v24, 1.0, v24
    v_rcp_f32 v24, v24
    v_lshl_add_u32 v8, v3, 2, v8
    v_cvt_pk_bf16_f32 v24, v24, v24
    v_cmp_gt_u32 vcc, 4, v2
    s_lshl_b32 s5, s3, 2
    s_add_u32 s5, s5, 121634816
    v_lshlrev_b32 v24, 16, v24
    s_mov_b64 exec, vcc
    buffer_store_dword v24, v8, s[8:11], s5 offen sc1
    s_mov_b64 exec, -1

    s_load_dwordx4 s[52:55], s[0:1], 8
    s_load_dwordx2 s[56:57], s[0:1], 24

    v_and_b32 v1, 63, v0
    v_and_b32 v2, 15, v1
    v_lshrrev_b32 v3, 4, v1

    v_lshrrev_b32 v4, 2, v1
    v_and_b32 v5, 3, v1
    v_lshlrev_b32 v10, 11, v4
    v_lshl_add_u32 v10, v5, 4, v10
    s_lshl_b32 s4, s93, 6
    v_add_u32 v10, s4, v10
    s_lshl_b32 s70, s24, 20
    s_mul_i32 s71, s24, 33280
    v_lshrrev_b32 v4, 2, v2
    v_lshl_add_u32 v4, v3, 5, v4
    v_lshlrev_b32 v4, 6, v4
    v_lshl_add_u32 v11, v5, 3, v4
    v_add_u32 v11, s71, v11
    s_lshl_b32 s4, s93, 17
    s_lshl_b32 s5, s24, 8
    s_add_u32 s72, s4, s5
    s_add_u32 s72, s72, 125829120
    v_lshlrev_b32 v12, 12, v2
    v_lshl_add_u32 v12, v3, 4, v12
    v_lshlrev_b32 v13, 3, v2
    s_lshl_b32 s6, s93, 8
    s_waitcnt lgkmcnt(0)

    s_mov_b32 s80, s52
    s_and_b32 s81, s53, 0xffff
    s_mov_b32 s82, 0x400000
    s_mov_b32 s83, 0x00020000

    s_mov_b32 s84, s54
    s_and_b32 s85, s55, 0xffff
    s_mov_b32 s86, 0x400000
    s_mov_b32 s87, 0x00020000

    s_mov_b32 s76, s56
    s_and_b32 s77, s57, 0xffff
    s_mov_b32 s78, 0x2000
    s_mov_b32 s79, 0x00020000

    buffer_load_dwordx2 v[196:197], v13, s[76:79], s6 offen
    buffer_load_dwordx2 v[198:199], v13, s[76:79], s6 offen offset:128

    s_add_u32 s4, s70, 0
    s_add_u32 m0, s71, 0
    s_sub_u32 s5, s4, 8192
    s_max_i32 s5, s5, 0
    s_mov_b64 exec, 0xffff
    buffer_load_dwordx4 v10, s[80:83], s5 offen lds
    s_mov_b64 exec, -1

    s_add_u32 m0, s71, 256
    s_nop 0
    buffer_load_dwordx4 v10, s[80:83], s4 offen lds
    s_add_u32 m0, s71, 8448
    s_nop 0
    buffer_load_dwordx4 v10, s[84:87], s4 offen lds
    s_add_u32 m0, s71, 1280
    s_add_u32 s4, s4, 32768
    buffer_load_dwordx4 v10, s[80:83], s4 offen lds
    s_add_u32 m0, s71, 9472
    s_nop 0
    buffer_load_dwordx4 v10, s[84:87], s4 offen lds
    s_add_u32 m0, s71, 2304
    s_add_u32 s4, s4, 32768
    buffer_load_dwordx4 v10, s[80:83], s4 offen lds
    s_add_u32 m0, s71, 10496
    s_nop 0
    buffer_load_dwordx4 v10, s[84:87], s4 offen lds
    s_add_u32 m0, s71, 3328
    s_add_u32 s4, s4, 32768
    buffer_load_dwordx4 v10, s[80:83], s4 offen lds
    s_add_u32 m0, s71, 11520
    s_nop 0
    buffer_load_dwordx4 v10, s[84:87], s4 offen lds
    s_add_u32 m0, s71, 4352
    s_add_u32 s4, s4, 32768
    buffer_load_dwordx4 v10, s[80:83], s4 offen lds
    s_add_u32 m0, s71, 12544
    s_nop 0
    buffer_load_dwordx4 v10, s[84:87], s4 offen lds
    s_add_u32 m0, s71, 5376
    s_add_u32 s4, s4, 32768
    buffer_load_dwordx4 v10, s[80:83], s4 offen lds
    s_add_u32 m0, s71, 13568
    s_nop 0
    buffer_load_dwordx4 v10, s[84:87], s4 offen lds
    s_add_u32 m0, s71, 6400
    s_add_u32 s4, s4, 32768
    buffer_load_dwordx4 v10, s[80:83], s4 offen lds
    s_add_u32 m0, s71, 14592
    s_nop 0
    buffer_load_dwordx4 v10, s[84:87], s4 offen lds
    s_add_u32 m0, s71, 7424
    s_add_u32 s4, s4, 32768
    buffer_load_dwordx4 v10, s[80:83], s4 offen lds
    s_add_u32 m0, s71, 15616
    s_nop 0
    buffer_load_dwordx4 v10, s[84:87], s4 offen lds
    s_add_u32 s4, s70, 262144
    s_add_u32 m0, s71, 16640
    s_sub_u32 s5, s4, 8192
    s_max_i32 s5, s5, 0
    s_mov_b64 exec, 0xffff
    buffer_load_dwordx4 v10, s[80:83], s5 offen lds
    s_mov_b64 exec, -1

    s_add_u32 m0, s71, 16896
    s_nop 0
    buffer_load_dwordx4 v10, s[80:83], s4 offen lds
    s_add_u32 m0, s71, 25088
    s_nop 0
    buffer_load_dwordx4 v10, s[84:87], s4 offen lds
    s_add_u32 m0, s71, 17920
    s_add_u32 s4, s4, 32768
    buffer_load_dwordx4 v10, s[80:83], s4 offen lds
    s_add_u32 m0, s71, 26112
    s_nop 0
    buffer_load_dwordx4 v10, s[84:87], s4 offen lds
    s_add_u32 m0, s71, 18944
    s_add_u32 s4, s4, 32768
    buffer_load_dwordx4 v10, s[80:83], s4 offen lds
    s_add_u32 m0, s71, 27136
    s_nop 0
    buffer_load_dwordx4 v10, s[84:87], s4 offen lds
    s_add_u32 m0, s71, 19968
    s_add_u32 s4, s4, 32768
    buffer_load_dwordx4 v10, s[80:83], s4 offen lds
    s_add_u32 m0, s71, 28160
    s_nop 0
    buffer_load_dwordx4 v10, s[84:87], s4 offen lds
    s_add_u32 m0, s71, 20992
    s_add_u32 s4, s4, 32768
    buffer_load_dwordx4 v10, s[80:83], s4 offen lds
    s_add_u32 m0, s71, 29184
    s_nop 0
    buffer_load_dwordx4 v10, s[84:87], s4 offen lds
    s_add_u32 m0, s71, 22016
    s_add_u32 s4, s4, 32768
    buffer_load_dwordx4 v10, s[80:83], s4 offen lds
    s_add_u32 m0, s71, 30208
    s_nop 0
    buffer_load_dwordx4 v10, s[84:87], s4 offen lds
    s_add_u32 m0, s71, 23040
    s_add_u32 s4, s4, 32768
    buffer_load_dwordx4 v10, s[80:83], s4 offen lds
    s_add_u32 m0, s71, 31232
    s_nop 0
    buffer_load_dwordx4 v10, s[84:87], s4 offen lds
    s_add_u32 m0, s71, 24064
    s_add_u32 s4, s4, 32768
    buffer_load_dwordx4 v10, s[80:83], s4 offen lds
    s_add_u32 m0, s71, 32256
    s_nop 0
    buffer_load_dwordx4 v10, s[84:87], s4 offen lds
    s_waitcnt vmcnt(17)
    v_alignbit_b32 v196, v196, v196, 16
    v_alignbit_b32 v197, v197, v197, 16
    v_alignbit_b32 v198, v198, v198, 16
    v_alignbit_b32 v199, v199, v199, 16
    ds_read_b64_tr_b16 v[16:17], v11 offset:0
    ds_read_b64_tr_b16 v[18:19], v11 offset:256
    ds_read_b64_tr_b16 v[20:21], v11 offset:512
    ds_read_b64_tr_b16 v[22:23], v11 offset:768
    ds_read_b64_tr_b16 v[24:25], v11 offset:1024
    ds_read_b64_tr_b16 v[26:27], v11 offset:1280
    ds_read_b64_tr_b16 v[28:29], v11 offset:1536
    ds_read_b64_tr_b16 v[30:31], v11 offset:1792
    ds_read_b64_tr_b16 v[32:33], v11 offset:2048
    ds_read_b64_tr_b16 v[34:35], v11 offset:8448
    ds_read_b64_tr_b16 v[36:37], v11 offset:8704
    ds_read_b64_tr_b16 v[38:39], v11 offset:8960
    ds_read_b64_tr_b16 v[40:41], v11 offset:9216
    ds_read_b64_tr_b16 v[42:43], v11 offset:9472
    ds_read_b64_tr_b16 v[44:45], v11 offset:9728
    ds_read_b64_tr_b16 v[46:47], v11 offset:9984
    ds_read_b64_tr_b16 v[48:49], v11 offset:10240
    ds_read_b64_tr_b16 v[50:51], v11 offset:32
    ds_read_b64_tr_b16 v[52:53], v11 offset:288
    ds_read_b64_tr_b16 v[54:55], v11 offset:544
    ds_read_b64_tr_b16 v[56:57], v11 offset:800
    ds_read_b64_tr_b16 v[58:59], v11 offset:1056
    ds_read_b64_tr_b16 v[60:61], v11 offset:1312
    ds_read_b64_tr_b16 v[62:63], v11 offset:1568
    ds_read_b64_tr_b16 v[64:65], v11 offset:1824
    ds_read_b64_tr_b16 v[66:67], v11 offset:2080
    ds_read_b64_tr_b16 v[68:69], v11 offset:8480
    ds_read_b64_tr_b16 v[70:71], v11 offset:8736
    ds_read_b64_tr_b16 v[72:73], v11 offset:8992
    ds_read_b64_tr_b16 v[74:75], v11 offset:9248
    ds_read_b64_tr_b16 v[76:77], v11 offset:9504
    ds_read_b64_tr_b16 v[78:79], v11 offset:9760
    ds_read_b64_tr_b16 v[80:81], v11 offset:10016
    ds_read_b64_tr_b16 v[82:83], v11 offset:10272
    s_waitcnt lgkmcnt(0)
    s_cmp_eq_u32 s24, 0
    s_cselect_b32 exec_lo, 0xffff, 0
    s_mov_b32 exec_hi, 0
    v_mov_b32 v16, 0
    v_mov_b32 v17, 0
    v_mov_b32 v50, 0
    v_mov_b32 v51, 0
    s_mov_b64 exec, -1
    s_add_u32 s4, s70, 524288
    s_add_u32 m0, s71, 0
    s_sub_u32 s5, s4, 8192
    s_max_i32 s5, s5, 0
    s_mov_b64 exec, 0xffff
    buffer_load_dwordx4 v10, s[80:83], s5 offen lds
    s_mov_b64 exec, -1

    s_add_u32 m0, s71, 256
    s_nop 0
    buffer_load_dwordx4 v10, s[80:83], s4 offen lds
    s_add_u32 m0, s71, 8448
    s_nop 0
    buffer_load_dwordx4 v10, s[84:87], s4 offen lds
    s_add_u32 m0, s71, 1280
    s_add_u32 s4, s4, 32768
    buffer_load_dwordx4 v10, s[80:83], s4 offen lds
    s_add_u32 m0, s71, 9472
    s_nop 0
    buffer_load_dwordx4 v10, s[84:87], s4 offen lds
    s_add_u32 m0, s71, 2304
    s_add_u32 s4, s4, 32768
    buffer_load_dwordx4 v10, s[80:83], s4 offen lds
    s_add_u32 m0, s71, 10496
    s_nop 0
    buffer_load_dwordx4 v10, s[84:87], s4 offen lds
    s_add_u32 m0, s71, 3328
    s_add_u32 s4, s4, 32768
    buffer_load_dwordx4 v10, s[80:83], s4 offen lds
    s_add_u32 m0, s71, 11520
    s_nop 0
    buffer_load_dwordx4 v10, s[84:87], s4 offen lds
    s_add_u32 m0, s71, 4352
    s_add_u32 s4, s4, 32768
    buffer_load_dwordx4 v10, s[80:83], s4 offen lds
    s_add_u32 m0, s71, 12544
    s_nop 0
    buffer_load_dwordx4 v10, s[84:87], s4 offen lds
    s_add_u32 m0, s71, 5376
    s_add_u32 s4, s4, 32768
    buffer_load_dwordx4 v10, s[80:83], s4 offen lds
    s_add_u32 m0, s71, 13568
    s_nop 0
    buffer_load_dwordx4 v10, s[84:87], s4 offen lds
    s_add_u32 m0, s71, 6400
    s_add_u32 s4, s4, 32768
    buffer_load_dwordx4 v10, s[80:83], s4 offen lds
    s_add_u32 m0, s71, 14592
    s_nop 0
    buffer_load_dwordx4 v10, s[84:87], s4 offen lds
    s_add_u32 m0, s71, 7424
    s_add_u32 s4, s4, 32768
    buffer_load_dwordx4 v10, s[80:83], s4 offen lds
    s_add_u32 m0, s71, 15616
    s_nop 0
    buffer_load_dwordx4 v10, s[84:87], s4 offen lds
    v_alignbit_b32 v84, v17, v16, 16
    v_alignbit_b32 v85, v18, v17, 16
    v_alignbit_b32 v86, v19, v18, 16
    v_alignbit_b32 v87, v20, v19, 16
    v_alignbit_b32 v88, v21, v20, 16
    v_alignbit_b32 v89, v22, v21, 16
    v_alignbit_b32 v90, v23, v22, 16
    v_alignbit_b32 v91, v24, v23, 16
    v_alignbit_b32 v92, v25, v24, 16
    v_alignbit_b32 v93, v26, v25, 16
    v_alignbit_b32 v94, v27, v26, 16
    v_alignbit_b32 v95, v28, v27, 16
    v_alignbit_b32 v96, v29, v28, 16
    v_alignbit_b32 v97, v30, v29, 16
    v_alignbit_b32 v98, v31, v30, 16
    v_alignbit_b32 v99, v32, v31, 16
    v_alignbit_b32 v100, v33, v32, 16
    v_dot2_f32_bf16 v102, v84, v197, 0
    v_dot2_f32_bf16 v103, v17, v197, 0
    v_dot2_f32_bf16 v106, v85, v197, 0
    v_dot2_f32_bf16 v107, v18, v197, 0
    v_dot2_f32_bf16 v110, v86, v197, 0
    v_dot2_f32_bf16 v111, v19, v197, 0
    v_dot2_f32_bf16 v114, v87, v197, 0
    v_dot2_f32_bf16 v115, v20, v197, 0
    v_dot2_f32_bf16 v102, v85, v196, v102
    v_dot2_f32_bf16 v103, v18, v196, v103
    v_dot2_f32_bf16 v106, v86, v196, v106
    v_dot2_f32_bf16 v107, v19, v196, v107
    v_dot2_f32_bf16 v110, v87, v196, v110
    v_dot2_f32_bf16 v111, v20, v196, v111
    v_dot2_f32_bf16 v114, v88, v196, v114
    v_dot2_f32_bf16 v115, v21, v196, v115
    v_lshlrev_b32 v104, 16, v34
    v_and_b32 v105, 0xffff0000, v34
    v_lshlrev_b32 v108, 16, v35
    v_and_b32 v109, 0xffff0000, v35
    v_lshlrev_b32 v112, 16, v36
    v_and_b32 v113, 0xffff0000, v36
    v_lshlrev_b32 v116, 16, v37
    v_and_b32 v117, 0xffff0000, v37
    v_mul_f32 v102, v102, v104
    v_mul_f32 v103, v103, v105
    v_mul_f32 v106, v106, v108
    v_mul_f32 v107, v107, v109
    v_mul_f32 v110, v110, v112
    v_mul_f32 v111, v111, v113
    v_mul_f32 v114, v114, v116
    v_mul_f32 v115, v115, v117
    v_cvt_pk_bf16_f32 v137, v103, v102
    v_cvt_pk_bf16_f32 v136, v107, v106
    v_cvt_pk_bf16_f32 v135, v111, v110
    v_cvt_pk_bf16_f32 v134, v115, v114
    s_add_u32 s4, s72, 0
    buffer_store_dwordx4 v[134:137], v12, s[8:11], s4 offen offset:0
    v_dot2_f32_bf16 v118, v88, v197, 0
    v_dot2_f32_bf16 v119, v21, v197, 0
    v_dot2_f32_bf16 v122, v89, v197, 0
    v_dot2_f32_bf16 v123, v22, v197, 0
    v_dot2_f32_bf16 v126, v90, v197, 0
    v_dot2_f32_bf16 v127, v23, v197, 0
    v_dot2_f32_bf16 v130, v91, v197, 0
    v_dot2_f32_bf16 v131, v24, v197, 0
    v_dot2_f32_bf16 v118, v89, v196, v118
    v_dot2_f32_bf16 v119, v22, v196, v119
    v_dot2_f32_bf16 v122, v90, v196, v122
    v_dot2_f32_bf16 v123, v23, v196, v123
    v_dot2_f32_bf16 v126, v91, v196, v126
    v_dot2_f32_bf16 v127, v24, v196, v127
    v_dot2_f32_bf16 v130, v92, v196, v130
    v_dot2_f32_bf16 v131, v25, v196, v131
    v_lshlrev_b32 v120, 16, v38
    v_and_b32 v121, 0xffff0000, v38
    v_lshlrev_b32 v124, 16, v39
    v_and_b32 v125, 0xffff0000, v39
    v_lshlrev_b32 v128, 16, v40
    v_and_b32 v129, 0xffff0000, v40
    v_lshlrev_b32 v132, 16, v41
    v_and_b32 v133, 0xffff0000, v41
    v_mul_f32 v118, v118, v120
    v_mul_f32 v119, v119, v121
    v_mul_f32 v122, v122, v124
    v_mul_f32 v123, v123, v125
    v_mul_f32 v126, v126, v128
    v_mul_f32 v127, v127, v129
    v_mul_f32 v130, v130, v132
    v_mul_f32 v131, v131, v133
    v_cvt_pk_bf16_f32 v141, v119, v118
    v_cvt_pk_bf16_f32 v140, v123, v122
    v_cvt_pk_bf16_f32 v139, v127, v126
    v_cvt_pk_bf16_f32 v138, v131, v130
    buffer_store_dwordx4 v[138:141], v12, s[8:11], s4 offen offset:1024
    v_dot2_f32_bf16 v102, v92, v197, 0
    v_dot2_f32_bf16 v103, v25, v197, 0
    v_dot2_f32_bf16 v106, v93, v197, 0
    v_dot2_f32_bf16 v107, v26, v197, 0
    v_dot2_f32_bf16 v110, v94, v197, 0
    v_dot2_f32_bf16 v111, v27, v197, 0
    v_dot2_f32_bf16 v114, v95, v197, 0
    v_dot2_f32_bf16 v115, v28, v197, 0
    v_dot2_f32_bf16 v102, v93, v196, v102
    v_dot2_f32_bf16 v103, v26, v196, v103
    v_dot2_f32_bf16 v106, v94, v196, v106
    v_dot2_f32_bf16 v107, v27, v196, v107
    v_dot2_f32_bf16 v110, v95, v196, v110
    v_dot2_f32_bf16 v111, v28, v196, v111
    v_dot2_f32_bf16 v114, v96, v196, v114
    v_dot2_f32_bf16 v115, v29, v196, v115
    v_lshlrev_b32 v104, 16, v42
    v_and_b32 v105, 0xffff0000, v42
    v_lshlrev_b32 v108, 16, v43
    v_and_b32 v109, 0xffff0000, v43
    v_lshlrev_b32 v112, 16, v44
    v_and_b32 v113, 0xffff0000, v44
    v_lshlrev_b32 v116, 16, v45
    v_and_b32 v117, 0xffff0000, v45
    v_mul_f32 v102, v102, v104
    v_mul_f32 v103, v103, v105
    v_mul_f32 v106, v106, v108
    v_mul_f32 v107, v107, v109
    v_mul_f32 v110, v110, v112
    v_mul_f32 v111, v111, v113
    v_mul_f32 v114, v114, v116
    v_mul_f32 v115, v115, v117
    v_cvt_pk_bf16_f32 v145, v103, v102
    v_cvt_pk_bf16_f32 v144, v107, v106
    v_cvt_pk_bf16_f32 v143, v111, v110
    v_cvt_pk_bf16_f32 v142, v115, v114
    buffer_store_dwordx4 v[142:145], v12, s[8:11], s4 offen offset:2048
    v_dot2_f32_bf16 v118, v96, v197, 0
    v_dot2_f32_bf16 v119, v29, v197, 0
    v_dot2_f32_bf16 v122, v97, v197, 0
    v_dot2_f32_bf16 v123, v30, v197, 0
    v_dot2_f32_bf16 v126, v98, v197, 0
    v_dot2_f32_bf16 v127, v31, v197, 0
    v_dot2_f32_bf16 v130, v99, v197, 0
    v_dot2_f32_bf16 v131, v32, v197, 0
    v_dot2_f32_bf16 v118, v97, v196, v118
    v_dot2_f32_bf16 v119, v30, v196, v119
    v_dot2_f32_bf16 v122, v98, v196, v122
    v_dot2_f32_bf16 v123, v31, v196, v123
    v_dot2_f32_bf16 v126, v99, v196, v126
    v_dot2_f32_bf16 v127, v32, v196, v127
    v_dot2_f32_bf16 v130, v100, v196, v130
    v_dot2_f32_bf16 v131, v33, v196, v131
    v_lshlrev_b32 v120, 16, v46
    v_and_b32 v121, 0xffff0000, v46
    v_lshlrev_b32 v124, 16, v47
    v_and_b32 v125, 0xffff0000, v47
    v_lshlrev_b32 v128, 16, v48
    v_and_b32 v129, 0xffff0000, v48
    v_lshlrev_b32 v132, 16, v49
    v_and_b32 v133, 0xffff0000, v49
    v_mul_f32 v118, v118, v120
    v_mul_f32 v119, v119, v121
    v_mul_f32 v122, v122, v124
    v_mul_f32 v123, v123, v125
    v_mul_f32 v126, v126, v128
    v_mul_f32 v127, v127, v129
    v_mul_f32 v130, v130, v132
    v_mul_f32 v131, v131, v133
    v_cvt_pk_bf16_f32 v149, v119, v118
    v_cvt_pk_bf16_f32 v148, v123, v122
    v_cvt_pk_bf16_f32 v147, v127, v126
    v_cvt_pk_bf16_f32 v146, v131, v130
    buffer_store_dwordx4 v[146:149], v12, s[8:11], s4 offen offset:3072
    v_alignbit_b32 v84, v51, v50, 16
    v_alignbit_b32 v85, v52, v51, 16
    v_alignbit_b32 v86, v53, v52, 16
    v_alignbit_b32 v87, v54, v53, 16
    v_alignbit_b32 v88, v55, v54, 16
    v_alignbit_b32 v89, v56, v55, 16
    v_alignbit_b32 v90, v57, v56, 16
    v_alignbit_b32 v91, v58, v57, 16
    v_alignbit_b32 v92, v59, v58, 16
    v_alignbit_b32 v93, v60, v59, 16
    v_alignbit_b32 v94, v61, v60, 16
    v_alignbit_b32 v95, v62, v61, 16
    v_alignbit_b32 v96, v63, v62, 16
    v_alignbit_b32 v97, v64, v63, 16
    v_alignbit_b32 v98, v65, v64, 16
    v_alignbit_b32 v99, v66, v65, 16
    v_alignbit_b32 v100, v67, v66, 16
    v_dot2_f32_bf16 v102, v84, v199, 0
    v_dot2_f32_bf16 v103, v51, v199, 0
    v_dot2_f32_bf16 v106, v85, v199, 0
    v_dot2_f32_bf16 v107, v52, v199, 0
    v_dot2_f32_bf16 v110, v86, v199, 0
    v_dot2_f32_bf16 v111, v53, v199, 0
    v_dot2_f32_bf16 v114, v87, v199, 0
    v_dot2_f32_bf16 v115, v54, v199, 0
    v_dot2_f32_bf16 v102, v85, v198, v102
    v_dot2_f32_bf16 v103, v52, v198, v103
    v_dot2_f32_bf16 v106, v86, v198, v106
    v_dot2_f32_bf16 v107, v53, v198, v107
    v_dot2_f32_bf16 v110, v87, v198, v110
    v_dot2_f32_bf16 v111, v54, v198, v111
    v_dot2_f32_bf16 v114, v88, v198, v114
    v_dot2_f32_bf16 v115, v55, v198, v115
    v_lshlrev_b32 v104, 16, v68
    v_and_b32 v105, 0xffff0000, v68
    v_lshlrev_b32 v108, 16, v69
    v_and_b32 v109, 0xffff0000, v69
    v_lshlrev_b32 v112, 16, v70
    v_and_b32 v113, 0xffff0000, v70
    v_lshlrev_b32 v116, 16, v71
    v_and_b32 v117, 0xffff0000, v71
    v_mul_f32 v102, v102, v104
    v_mul_f32 v103, v103, v105
    v_mul_f32 v106, v106, v108
    v_mul_f32 v107, v107, v109
    v_mul_f32 v110, v110, v112
    v_mul_f32 v111, v111, v113
    v_mul_f32 v114, v114, v116
    v_mul_f32 v115, v115, v117
    v_cvt_pk_bf16_f32 v153, v103, v102
    v_cvt_pk_bf16_f32 v152, v107, v106
    v_cvt_pk_bf16_f32 v151, v111, v110
    v_cvt_pk_bf16_f32 v150, v115, v114
    s_add_u32 s4, s72, 65536
    buffer_store_dwordx4 v[150:153], v12, s[8:11], s4 offen offset:0
    v_dot2_f32_bf16 v118, v88, v199, 0
    v_dot2_f32_bf16 v119, v55, v199, 0
    v_dot2_f32_bf16 v122, v89, v199, 0
    v_dot2_f32_bf16 v123, v56, v199, 0
    v_dot2_f32_bf16 v126, v90, v199, 0
    v_dot2_f32_bf16 v127, v57, v199, 0
    v_dot2_f32_bf16 v130, v91, v199, 0
    v_dot2_f32_bf16 v131, v58, v199, 0
    v_dot2_f32_bf16 v118, v89, v198, v118
    v_dot2_f32_bf16 v119, v56, v198, v119
    v_dot2_f32_bf16 v122, v90, v198, v122
    v_dot2_f32_bf16 v123, v57, v198, v123
    v_dot2_f32_bf16 v126, v91, v198, v126
    v_dot2_f32_bf16 v127, v58, v198, v127
    v_dot2_f32_bf16 v130, v92, v198, v130
    v_dot2_f32_bf16 v131, v59, v198, v131
    v_lshlrev_b32 v120, 16, v72
    v_and_b32 v121, 0xffff0000, v72
    v_lshlrev_b32 v124, 16, v73
    v_and_b32 v125, 0xffff0000, v73
    v_lshlrev_b32 v128, 16, v74
    v_and_b32 v129, 0xffff0000, v74
    v_lshlrev_b32 v132, 16, v75
    v_and_b32 v133, 0xffff0000, v75
    v_mul_f32 v118, v118, v120
    v_mul_f32 v119, v119, v121
    v_mul_f32 v122, v122, v124
    v_mul_f32 v123, v123, v125
    v_mul_f32 v126, v126, v128
    v_mul_f32 v127, v127, v129
    v_mul_f32 v130, v130, v132
    v_mul_f32 v131, v131, v133
    v_cvt_pk_bf16_f32 v157, v119, v118
    v_cvt_pk_bf16_f32 v156, v123, v122
    v_cvt_pk_bf16_f32 v155, v127, v126
    v_cvt_pk_bf16_f32 v154, v131, v130
    buffer_store_dwordx4 v[154:157], v12, s[8:11], s4 offen offset:1024
    v_dot2_f32_bf16 v102, v92, v199, 0
    v_dot2_f32_bf16 v103, v59, v199, 0
    v_dot2_f32_bf16 v106, v93, v199, 0
    v_dot2_f32_bf16 v107, v60, v199, 0
    v_dot2_f32_bf16 v110, v94, v199, 0
    v_dot2_f32_bf16 v111, v61, v199, 0
    v_dot2_f32_bf16 v114, v95, v199, 0
    v_dot2_f32_bf16 v115, v62, v199, 0
    v_dot2_f32_bf16 v102, v93, v198, v102
    v_dot2_f32_bf16 v103, v60, v198, v103
    v_dot2_f32_bf16 v106, v94, v198, v106
    v_dot2_f32_bf16 v107, v61, v198, v107
    v_dot2_f32_bf16 v110, v95, v198, v110
    v_dot2_f32_bf16 v111, v62, v198, v111
    v_dot2_f32_bf16 v114, v96, v198, v114
    v_dot2_f32_bf16 v115, v63, v198, v115
    v_lshlrev_b32 v104, 16, v76
    v_and_b32 v105, 0xffff0000, v76
    v_lshlrev_b32 v108, 16, v77
    v_and_b32 v109, 0xffff0000, v77
    v_lshlrev_b32 v112, 16, v78
    v_and_b32 v113, 0xffff0000, v78
    v_lshlrev_b32 v116, 16, v79
    v_and_b32 v117, 0xffff0000, v79
    v_mul_f32 v102, v102, v104
    v_mul_f32 v103, v103, v105
    v_mul_f32 v106, v106, v108
    v_mul_f32 v107, v107, v109
    v_mul_f32 v110, v110, v112
    v_mul_f32 v111, v111, v113
    v_mul_f32 v114, v114, v116
    v_mul_f32 v115, v115, v117
    v_cvt_pk_bf16_f32 v161, v103, v102
    v_cvt_pk_bf16_f32 v160, v107, v106
    v_cvt_pk_bf16_f32 v159, v111, v110
    v_cvt_pk_bf16_f32 v158, v115, v114
    buffer_store_dwordx4 v[158:161], v12, s[8:11], s4 offen offset:2048
    v_dot2_f32_bf16 v118, v96, v199, 0
    v_dot2_f32_bf16 v119, v63, v199, 0
    v_dot2_f32_bf16 v122, v97, v199, 0
    v_dot2_f32_bf16 v123, v64, v199, 0
    v_dot2_f32_bf16 v126, v98, v199, 0
    v_dot2_f32_bf16 v127, v65, v199, 0
    v_dot2_f32_bf16 v130, v99, v199, 0
    v_dot2_f32_bf16 v131, v66, v199, 0
    v_dot2_f32_bf16 v118, v97, v198, v118
    v_dot2_f32_bf16 v119, v64, v198, v119
    v_dot2_f32_bf16 v122, v98, v198, v122
    v_dot2_f32_bf16 v123, v65, v198, v123
    v_dot2_f32_bf16 v126, v99, v198, v126
    v_dot2_f32_bf16 v127, v66, v198, v127
    v_dot2_f32_bf16 v130, v100, v198, v130
    v_dot2_f32_bf16 v131, v67, v198, v131
    v_lshlrev_b32 v120, 16, v80
    v_and_b32 v121, 0xffff0000, v80
    v_lshlrev_b32 v124, 16, v81
    v_and_b32 v125, 0xffff0000, v81
    v_lshlrev_b32 v128, 16, v82
    v_and_b32 v129, 0xffff0000, v82
    v_lshlrev_b32 v132, 16, v83
    v_and_b32 v133, 0xffff0000, v83
    v_mul_f32 v118, v118, v120
    v_mul_f32 v119, v119, v121
    v_mul_f32 v122, v122, v124
    v_mul_f32 v123, v123, v125
    v_mul_f32 v126, v126, v128
    v_mul_f32 v127, v127, v129
    v_mul_f32 v130, v130, v132
    v_mul_f32 v131, v131, v133
    v_cvt_pk_bf16_f32 v165, v119, v118
    v_cvt_pk_bf16_f32 v164, v123, v122
    v_cvt_pk_bf16_f32 v163, v127, v126
    v_cvt_pk_bf16_f32 v162, v131, v130
    buffer_store_dwordx4 v[162:165], v12, s[8:11], s4 offen offset:3072
    s_waitcnt vmcnt(25)
    ds_read_b64_tr_b16 v[16:17], v11 offset:16640
    ds_read_b64_tr_b16 v[18:19], v11 offset:16896
    ds_read_b64_tr_b16 v[20:21], v11 offset:17152
    ds_read_b64_tr_b16 v[22:23], v11 offset:17408
    ds_read_b64_tr_b16 v[24:25], v11 offset:17664
    ds_read_b64_tr_b16 v[26:27], v11 offset:17920
    ds_read_b64_tr_b16 v[28:29], v11 offset:18176
    ds_read_b64_tr_b16 v[30:31], v11 offset:18432
    ds_read_b64_tr_b16 v[32:33], v11 offset:18688
    ds_read_b64_tr_b16 v[34:35], v11 offset:25088
    ds_read_b64_tr_b16 v[36:37], v11 offset:25344
    ds_read_b64_tr_b16 v[38:39], v11 offset:25600
    ds_read_b64_tr_b16 v[40:41], v11 offset:25856
    ds_read_b64_tr_b16 v[42:43], v11 offset:26112
    ds_read_b64_tr_b16 v[44:45], v11 offset:26368
    ds_read_b64_tr_b16 v[46:47], v11 offset:26624
    ds_read_b64_tr_b16 v[48:49], v11 offset:26880
    ds_read_b64_tr_b16 v[50:51], v11 offset:16672
    ds_read_b64_tr_b16 v[52:53], v11 offset:16928
    ds_read_b64_tr_b16 v[54:55], v11 offset:17184
    ds_read_b64_tr_b16 v[56:57], v11 offset:17440
    ds_read_b64_tr_b16 v[58:59], v11 offset:17696
    ds_read_b64_tr_b16 v[60:61], v11 offset:17952
    ds_read_b64_tr_b16 v[62:63], v11 offset:18208
    ds_read_b64_tr_b16 v[64:65], v11 offset:18464
    ds_read_b64_tr_b16 v[66:67], v11 offset:18720
    ds_read_b64_tr_b16 v[68:69], v11 offset:25120
    ds_read_b64_tr_b16 v[70:71], v11 offset:25376
    ds_read_b64_tr_b16 v[72:73], v11 offset:25632
    ds_read_b64_tr_b16 v[74:75], v11 offset:25888
    ds_read_b64_tr_b16 v[76:77], v11 offset:26144
    ds_read_b64_tr_b16 v[78:79], v11 offset:26400
    ds_read_b64_tr_b16 v[80:81], v11 offset:26656
    ds_read_b64_tr_b16 v[82:83], v11 offset:26912
    s_waitcnt lgkmcnt(0)
    s_add_u32 s4, s70, 786432
    s_add_u32 m0, s71, 16640
    s_sub_u32 s5, s4, 8192
    s_max_i32 s5, s5, 0
    s_mov_b64 exec, 0xffff
    buffer_load_dwordx4 v10, s[80:83], s5 offen lds
    s_mov_b64 exec, -1

    s_add_u32 m0, s71, 16896
    s_nop 0
    buffer_load_dwordx4 v10, s[80:83], s4 offen lds
    s_add_u32 m0, s71, 25088
    s_nop 0
    buffer_load_dwordx4 v10, s[84:87], s4 offen lds
    s_add_u32 m0, s71, 17920
    s_add_u32 s4, s4, 32768
    buffer_load_dwordx4 v10, s[80:83], s4 offen lds
    s_add_u32 m0, s71, 26112
    s_nop 0
    buffer_load_dwordx4 v10, s[84:87], s4 offen lds
    s_add_u32 m0, s71, 18944
    s_add_u32 s4, s4, 32768
    buffer_load_dwordx4 v10, s[80:83], s4 offen lds
    s_add_u32 m0, s71, 27136
    s_nop 0
    buffer_load_dwordx4 v10, s[84:87], s4 offen lds
    s_add_u32 m0, s71, 19968
    s_add_u32 s4, s4, 32768
    buffer_load_dwordx4 v10, s[80:83], s4 offen lds
    s_add_u32 m0, s71, 28160
    s_nop 0
    buffer_load_dwordx4 v10, s[84:87], s4 offen lds
    s_add_u32 m0, s71, 20992
    s_add_u32 s4, s4, 32768
    buffer_load_dwordx4 v10, s[80:83], s4 offen lds
    s_add_u32 m0, s71, 29184
    s_nop 0
    buffer_load_dwordx4 v10, s[84:87], s4 offen lds
    s_add_u32 m0, s71, 22016
    s_add_u32 s4, s4, 32768
    buffer_load_dwordx4 v10, s[80:83], s4 offen lds
    s_add_u32 m0, s71, 30208
    s_nop 0
    buffer_load_dwordx4 v10, s[84:87], s4 offen lds
    s_add_u32 m0, s71, 23040
    s_add_u32 s4, s4, 32768
    buffer_load_dwordx4 v10, s[80:83], s4 offen lds
    s_add_u32 m0, s71, 31232
    s_nop 0
    buffer_load_dwordx4 v10, s[84:87], s4 offen lds
    s_add_u32 m0, s71, 24064
    s_add_u32 s4, s4, 32768
    buffer_load_dwordx4 v10, s[80:83], s4 offen lds
    s_add_u32 m0, s71, 32256
    s_nop 0
    buffer_load_dwordx4 v10, s[84:87], s4 offen lds
    v_alignbit_b32 v84, v17, v16, 16
    v_alignbit_b32 v85, v18, v17, 16
    v_alignbit_b32 v86, v19, v18, 16
    v_alignbit_b32 v87, v20, v19, 16
    v_alignbit_b32 v88, v21, v20, 16
    v_alignbit_b32 v89, v22, v21, 16
    v_alignbit_b32 v90, v23, v22, 16
    v_alignbit_b32 v91, v24, v23, 16
    v_alignbit_b32 v92, v25, v24, 16
    v_alignbit_b32 v93, v26, v25, 16
    v_alignbit_b32 v94, v27, v26, 16
    v_alignbit_b32 v95, v28, v27, 16
    v_alignbit_b32 v96, v29, v28, 16
    v_alignbit_b32 v97, v30, v29, 16
    v_alignbit_b32 v98, v31, v30, 16
    v_alignbit_b32 v99, v32, v31, 16
    v_alignbit_b32 v100, v33, v32, 16
    v_dot2_f32_bf16 v102, v84, v197, 0
    v_dot2_f32_bf16 v103, v17, v197, 0
    v_dot2_f32_bf16 v106, v85, v197, 0
    v_dot2_f32_bf16 v107, v18, v197, 0
    v_dot2_f32_bf16 v110, v86, v197, 0
    v_dot2_f32_bf16 v111, v19, v197, 0
    v_dot2_f32_bf16 v114, v87, v197, 0
    v_dot2_f32_bf16 v115, v20, v197, 0
    v_dot2_f32_bf16 v102, v85, v196, v102
    v_dot2_f32_bf16 v103, v18, v196, v103
    v_dot2_f32_bf16 v106, v86, v196, v106
    v_dot2_f32_bf16 v107, v19, v196, v107
    v_dot2_f32_bf16 v110, v87, v196, v110
    v_dot2_f32_bf16 v111, v20, v196, v111
    v_dot2_f32_bf16 v114, v88, v196, v114
    v_dot2_f32_bf16 v115, v21, v196, v115
    v_lshlrev_b32 v104, 16, v34
    v_and_b32 v105, 0xffff0000, v34
    v_lshlrev_b32 v108, 16, v35
    v_and_b32 v109, 0xffff0000, v35
    v_lshlrev_b32 v112, 16, v36
    v_and_b32 v113, 0xffff0000, v36
    v_lshlrev_b32 v116, 16, v37
    v_and_b32 v117, 0xffff0000, v37
    v_mul_f32 v102, v102, v104
    v_mul_f32 v103, v103, v105
    v_mul_f32 v106, v106, v108
    v_mul_f32 v107, v107, v109
    v_mul_f32 v110, v110, v112
    v_mul_f32 v111, v111, v113
    v_mul_f32 v114, v114, v116
    v_mul_f32 v115, v115, v117
    v_cvt_pk_bf16_f32 v137, v103, v102
    v_cvt_pk_bf16_f32 v136, v107, v106
    v_cvt_pk_bf16_f32 v135, v111, v110
    v_cvt_pk_bf16_f32 v134, v115, v114
    s_add_u32 s4, s72, 64
    buffer_store_dwordx4 v[134:137], v12, s[8:11], s4 offen offset:0
    v_dot2_f32_bf16 v118, v88, v197, 0
    v_dot2_f32_bf16 v119, v21, v197, 0
    v_dot2_f32_bf16 v122, v89, v197, 0
    v_dot2_f32_bf16 v123, v22, v197, 0
    v_dot2_f32_bf16 v126, v90, v197, 0
    v_dot2_f32_bf16 v127, v23, v197, 0
    v_dot2_f32_bf16 v130, v91, v197, 0
    v_dot2_f32_bf16 v131, v24, v197, 0
    v_dot2_f32_bf16 v118, v89, v196, v118
    v_dot2_f32_bf16 v119, v22, v196, v119
    v_dot2_f32_bf16 v122, v90, v196, v122
    v_dot2_f32_bf16 v123, v23, v196, v123
    v_dot2_f32_bf16 v126, v91, v196, v126
    v_dot2_f32_bf16 v127, v24, v196, v127
    v_dot2_f32_bf16 v130, v92, v196, v130
    v_dot2_f32_bf16 v131, v25, v196, v131
    v_lshlrev_b32 v120, 16, v38
    v_and_b32 v121, 0xffff0000, v38
    v_lshlrev_b32 v124, 16, v39
    v_and_b32 v125, 0xffff0000, v39
    v_lshlrev_b32 v128, 16, v40
    v_and_b32 v129, 0xffff0000, v40
    v_lshlrev_b32 v132, 16, v41
    v_and_b32 v133, 0xffff0000, v41
    v_mul_f32 v118, v118, v120
    v_mul_f32 v119, v119, v121
    v_mul_f32 v122, v122, v124
    v_mul_f32 v123, v123, v125
    v_mul_f32 v126, v126, v128
    v_mul_f32 v127, v127, v129
    v_mul_f32 v130, v130, v132
    v_mul_f32 v131, v131, v133
    v_cvt_pk_bf16_f32 v141, v119, v118
    v_cvt_pk_bf16_f32 v140, v123, v122
    v_cvt_pk_bf16_f32 v139, v127, v126
    v_cvt_pk_bf16_f32 v138, v131, v130
    buffer_store_dwordx4 v[138:141], v12, s[8:11], s4 offen offset:1024
    v_dot2_f32_bf16 v102, v92, v197, 0
    v_dot2_f32_bf16 v103, v25, v197, 0
    v_dot2_f32_bf16 v106, v93, v197, 0
    v_dot2_f32_bf16 v107, v26, v197, 0
    v_dot2_f32_bf16 v110, v94, v197, 0
    v_dot2_f32_bf16 v111, v27, v197, 0
    v_dot2_f32_bf16 v114, v95, v197, 0
    v_dot2_f32_bf16 v115, v28, v197, 0
    v_dot2_f32_bf16 v102, v93, v196, v102
    v_dot2_f32_bf16 v103, v26, v196, v103
    v_dot2_f32_bf16 v106, v94, v196, v106
    v_dot2_f32_bf16 v107, v27, v196, v107
    v_dot2_f32_bf16 v110, v95, v196, v110
    v_dot2_f32_bf16 v111, v28, v196, v111
    v_dot2_f32_bf16 v114, v96, v196, v114
    v_dot2_f32_bf16 v115, v29, v196, v115
    v_lshlrev_b32 v104, 16, v42
    v_and_b32 v105, 0xffff0000, v42
    v_lshlrev_b32 v108, 16, v43
    v_and_b32 v109, 0xffff0000, v43
    v_lshlrev_b32 v112, 16, v44
    v_and_b32 v113, 0xffff0000, v44
    v_lshlrev_b32 v116, 16, v45
    v_and_b32 v117, 0xffff0000, v45
    v_mul_f32 v102, v102, v104
    v_mul_f32 v103, v103, v105
    v_mul_f32 v106, v106, v108
    v_mul_f32 v107, v107, v109
    v_mul_f32 v110, v110, v112
    v_mul_f32 v111, v111, v113
    v_mul_f32 v114, v114, v116
    v_mul_f32 v115, v115, v117
    v_cvt_pk_bf16_f32 v145, v103, v102
    v_cvt_pk_bf16_f32 v144, v107, v106
    v_cvt_pk_bf16_f32 v143, v111, v110
    v_cvt_pk_bf16_f32 v142, v115, v114
    buffer_store_dwordx4 v[142:145], v12, s[8:11], s4 offen offset:2048
    v_dot2_f32_bf16 v118, v96, v197, 0
    v_dot2_f32_bf16 v119, v29, v197, 0
    v_dot2_f32_bf16 v122, v97, v197, 0
    v_dot2_f32_bf16 v123, v30, v197, 0
    v_dot2_f32_bf16 v126, v98, v197, 0
    v_dot2_f32_bf16 v127, v31, v197, 0
    v_dot2_f32_bf16 v130, v99, v197, 0
    v_dot2_f32_bf16 v131, v32, v197, 0
    v_dot2_f32_bf16 v118, v97, v196, v118
    v_dot2_f32_bf16 v119, v30, v196, v119
    v_dot2_f32_bf16 v122, v98, v196, v122
    v_dot2_f32_bf16 v123, v31, v196, v123
    v_dot2_f32_bf16 v126, v99, v196, v126
    v_dot2_f32_bf16 v127, v32, v196, v127
    v_dot2_f32_bf16 v130, v100, v196, v130
    v_dot2_f32_bf16 v131, v33, v196, v131
    v_lshlrev_b32 v120, 16, v46
    v_and_b32 v121, 0xffff0000, v46
    v_lshlrev_b32 v124, 16, v47
    v_and_b32 v125, 0xffff0000, v47
    v_lshlrev_b32 v128, 16, v48
    v_and_b32 v129, 0xffff0000, v48
    v_lshlrev_b32 v132, 16, v49
    v_and_b32 v133, 0xffff0000, v49
    v_mul_f32 v118, v118, v120
    v_mul_f32 v119, v119, v121
    v_mul_f32 v122, v122, v124
    v_mul_f32 v123, v123, v125
    v_mul_f32 v126, v126, v128
    v_mul_f32 v127, v127, v129
    v_mul_f32 v130, v130, v132
    v_mul_f32 v131, v131, v133
    v_cvt_pk_bf16_f32 v149, v119, v118
    v_cvt_pk_bf16_f32 v148, v123, v122
    v_cvt_pk_bf16_f32 v147, v127, v126
    v_cvt_pk_bf16_f32 v146, v131, v130
    buffer_store_dwordx4 v[146:149], v12, s[8:11], s4 offen offset:3072
    v_alignbit_b32 v84, v51, v50, 16
    v_alignbit_b32 v85, v52, v51, 16
    v_alignbit_b32 v86, v53, v52, 16
    v_alignbit_b32 v87, v54, v53, 16
    v_alignbit_b32 v88, v55, v54, 16
    v_alignbit_b32 v89, v56, v55, 16
    v_alignbit_b32 v90, v57, v56, 16
    v_alignbit_b32 v91, v58, v57, 16
    v_alignbit_b32 v92, v59, v58, 16
    v_alignbit_b32 v93, v60, v59, 16
    v_alignbit_b32 v94, v61, v60, 16
    v_alignbit_b32 v95, v62, v61, 16
    v_alignbit_b32 v96, v63, v62, 16
    v_alignbit_b32 v97, v64, v63, 16
    v_alignbit_b32 v98, v65, v64, 16
    v_alignbit_b32 v99, v66, v65, 16
    v_alignbit_b32 v100, v67, v66, 16
    v_dot2_f32_bf16 v102, v84, v199, 0
    v_dot2_f32_bf16 v103, v51, v199, 0
    v_dot2_f32_bf16 v106, v85, v199, 0
    v_dot2_f32_bf16 v107, v52, v199, 0
    v_dot2_f32_bf16 v110, v86, v199, 0
    v_dot2_f32_bf16 v111, v53, v199, 0
    v_dot2_f32_bf16 v114, v87, v199, 0
    v_dot2_f32_bf16 v115, v54, v199, 0
    v_dot2_f32_bf16 v102, v85, v198, v102
    v_dot2_f32_bf16 v103, v52, v198, v103
    v_dot2_f32_bf16 v106, v86, v198, v106
    v_dot2_f32_bf16 v107, v53, v198, v107
    v_dot2_f32_bf16 v110, v87, v198, v110
    v_dot2_f32_bf16 v111, v54, v198, v111
    v_dot2_f32_bf16 v114, v88, v198, v114
    v_dot2_f32_bf16 v115, v55, v198, v115
    v_lshlrev_b32 v104, 16, v68
    v_and_b32 v105, 0xffff0000, v68
    v_lshlrev_b32 v108, 16, v69
    v_and_b32 v109, 0xffff0000, v69
    v_lshlrev_b32 v112, 16, v70
    v_and_b32 v113, 0xffff0000, v70
    v_lshlrev_b32 v116, 16, v71
    v_and_b32 v117, 0xffff0000, v71
    v_mul_f32 v102, v102, v104
    v_mul_f32 v103, v103, v105
    v_mul_f32 v106, v106, v108
    v_mul_f32 v107, v107, v109
    v_mul_f32 v110, v110, v112
    v_mul_f32 v111, v111, v113
    v_mul_f32 v114, v114, v116
    v_mul_f32 v115, v115, v117
    v_cvt_pk_bf16_f32 v153, v103, v102
    v_cvt_pk_bf16_f32 v152, v107, v106
    v_cvt_pk_bf16_f32 v151, v111, v110
    v_cvt_pk_bf16_f32 v150, v115, v114
    s_add_u32 s4, s72, 65600
    buffer_store_dwordx4 v[150:153], v12, s[8:11], s4 offen offset:0
    v_dot2_f32_bf16 v118, v88, v199, 0
    v_dot2_f32_bf16 v119, v55, v199, 0
    v_dot2_f32_bf16 v122, v89, v199, 0
    v_dot2_f32_bf16 v123, v56, v199, 0
    v_dot2_f32_bf16 v126, v90, v199, 0
    v_dot2_f32_bf16 v127, v57, v199, 0
    v_dot2_f32_bf16 v130, v91, v199, 0
    v_dot2_f32_bf16 v131, v58, v199, 0
    v_dot2_f32_bf16 v118, v89, v198, v118
    v_dot2_f32_bf16 v119, v56, v198, v119
    v_dot2_f32_bf16 v122, v90, v198, v122
    v_dot2_f32_bf16 v123, v57, v198, v123
    v_dot2_f32_bf16 v126, v91, v198, v126
    v_dot2_f32_bf16 v127, v58, v198, v127
    v_dot2_f32_bf16 v130, v92, v198, v130
    v_dot2_f32_bf16 v131, v59, v198, v131
    v_lshlrev_b32 v120, 16, v72
    v_and_b32 v121, 0xffff0000, v72
    v_lshlrev_b32 v124, 16, v73
    v_and_b32 v125, 0xffff0000, v73
    v_lshlrev_b32 v128, 16, v74
    v_and_b32 v129, 0xffff0000, v74
    v_lshlrev_b32 v132, 16, v75
    v_and_b32 v133, 0xffff0000, v75
    v_mul_f32 v118, v118, v120
    v_mul_f32 v119, v119, v121
    v_mul_f32 v122, v122, v124
    v_mul_f32 v123, v123, v125
    v_mul_f32 v126, v126, v128
    v_mul_f32 v127, v127, v129
    v_mul_f32 v130, v130, v132
    v_mul_f32 v131, v131, v133
    v_cvt_pk_bf16_f32 v157, v119, v118
    v_cvt_pk_bf16_f32 v156, v123, v122
    v_cvt_pk_bf16_f32 v155, v127, v126
    v_cvt_pk_bf16_f32 v154, v131, v130
    buffer_store_dwordx4 v[154:157], v12, s[8:11], s4 offen offset:1024
    v_dot2_f32_bf16 v102, v92, v199, 0
    v_dot2_f32_bf16 v103, v59, v199, 0
    v_dot2_f32_bf16 v106, v93, v199, 0
    v_dot2_f32_bf16 v107, v60, v199, 0
    v_dot2_f32_bf16 v110, v94, v199, 0
    v_dot2_f32_bf16 v111, v61, v199, 0
    v_dot2_f32_bf16 v114, v95, v199, 0
    v_dot2_f32_bf16 v115, v62, v199, 0
    v_dot2_f32_bf16 v102, v93, v198, v102
    v_dot2_f32_bf16 v103, v60, v198, v103
    v_dot2_f32_bf16 v106, v94, v198, v106
    v_dot2_f32_bf16 v107, v61, v198, v107
    v_dot2_f32_bf16 v110, v95, v198, v110
    v_dot2_f32_bf16 v111, v62, v198, v111
    v_dot2_f32_bf16 v114, v96, v198, v114
    v_dot2_f32_bf16 v115, v63, v198, v115
    v_lshlrev_b32 v104, 16, v76
    v_and_b32 v105, 0xffff0000, v76
    v_lshlrev_b32 v108, 16, v77
    v_and_b32 v109, 0xffff0000, v77
    v_lshlrev_b32 v112, 16, v78
    v_and_b32 v113, 0xffff0000, v78
    v_lshlrev_b32 v116, 16, v79
    v_and_b32 v117, 0xffff0000, v79
    v_mul_f32 v102, v102, v104
    v_mul_f32 v103, v103, v105
    v_mul_f32 v106, v106, v108
    v_mul_f32 v107, v107, v109
    v_mul_f32 v110, v110, v112
    v_mul_f32 v111, v111, v113
    v_mul_f32 v114, v114, v116
    v_mul_f32 v115, v115, v117
    v_cvt_pk_bf16_f32 v161, v103, v102
    v_cvt_pk_bf16_f32 v160, v107, v106
    v_cvt_pk_bf16_f32 v159, v111, v110
    v_cvt_pk_bf16_f32 v158, v115, v114
    buffer_store_dwordx4 v[158:161], v12, s[8:11], s4 offen offset:2048
    v_dot2_f32_bf16 v118, v96, v199, 0
    v_dot2_f32_bf16 v119, v63, v199, 0
    v_dot2_f32_bf16 v122, v97, v199, 0
    v_dot2_f32_bf16 v123, v64, v199, 0
    v_dot2_f32_bf16 v126, v98, v199, 0
    v_dot2_f32_bf16 v127, v65, v199, 0
    v_dot2_f32_bf16 v130, v99, v199, 0
    v_dot2_f32_bf16 v131, v66, v199, 0
    v_dot2_f32_bf16 v118, v97, v198, v118
    v_dot2_f32_bf16 v119, v64, v198, v119
    v_dot2_f32_bf16 v122, v98, v198, v122
    v_dot2_f32_bf16 v123, v65, v198, v123
    v_dot2_f32_bf16 v126, v99, v198, v126
    v_dot2_f32_bf16 v127, v66, v198, v127
    v_dot2_f32_bf16 v130, v100, v198, v130
    v_dot2_f32_bf16 v131, v67, v198, v131
    v_lshlrev_b32 v120, 16, v80
    v_and_b32 v121, 0xffff0000, v80
    v_lshlrev_b32 v124, 16, v81
    v_and_b32 v125, 0xffff0000, v81
    v_lshlrev_b32 v128, 16, v82
    v_and_b32 v129, 0xffff0000, v82
    v_lshlrev_b32 v132, 16, v83
    v_and_b32 v133, 0xffff0000, v83
    v_mul_f32 v118, v118, v120
    v_mul_f32 v119, v119, v121
    v_mul_f32 v122, v122, v124
    v_mul_f32 v123, v123, v125
    v_mul_f32 v126, v126, v128
    v_mul_f32 v127, v127, v129
    v_mul_f32 v130, v130, v132
    v_mul_f32 v131, v131, v133
    v_cvt_pk_bf16_f32 v165, v119, v118
    v_cvt_pk_bf16_f32 v164, v123, v122
    v_cvt_pk_bf16_f32 v163, v127, v126
    v_cvt_pk_bf16_f32 v162, v131, v130
    buffer_store_dwordx4 v[162:165], v12, s[8:11], s4 offen offset:3072
    s_waitcnt vmcnt(25)
    ds_read_b64_tr_b16 v[16:17], v11 offset:0
    ds_read_b64_tr_b16 v[18:19], v11 offset:256
    ds_read_b64_tr_b16 v[20:21], v11 offset:512
    ds_read_b64_tr_b16 v[22:23], v11 offset:768
    ds_read_b64_tr_b16 v[24:25], v11 offset:1024
    ds_read_b64_tr_b16 v[26:27], v11 offset:1280
    ds_read_b64_tr_b16 v[28:29], v11 offset:1536
    ds_read_b64_tr_b16 v[30:31], v11 offset:1792
    ds_read_b64_tr_b16 v[32:33], v11 offset:2048
    ds_read_b64_tr_b16 v[34:35], v11 offset:8448
    ds_read_b64_tr_b16 v[36:37], v11 offset:8704
    ds_read_b64_tr_b16 v[38:39], v11 offset:8960
    ds_read_b64_tr_b16 v[40:41], v11 offset:9216
    ds_read_b64_tr_b16 v[42:43], v11 offset:9472
    ds_read_b64_tr_b16 v[44:45], v11 offset:9728
    ds_read_b64_tr_b16 v[46:47], v11 offset:9984
    ds_read_b64_tr_b16 v[48:49], v11 offset:10240
    ds_read_b64_tr_b16 v[50:51], v11 offset:32
    ds_read_b64_tr_b16 v[52:53], v11 offset:288
    ds_read_b64_tr_b16 v[54:55], v11 offset:544
    ds_read_b64_tr_b16 v[56:57], v11 offset:800
    ds_read_b64_tr_b16 v[58:59], v11 offset:1056
    ds_read_b64_tr_b16 v[60:61], v11 offset:1312
    ds_read_b64_tr_b16 v[62:63], v11 offset:1568
    ds_read_b64_tr_b16 v[64:65], v11 offset:1824
    ds_read_b64_tr_b16 v[66:67], v11 offset:2080
    ds_read_b64_tr_b16 v[68:69], v11 offset:8480
    ds_read_b64_tr_b16 v[70:71], v11 offset:8736
    ds_read_b64_tr_b16 v[72:73], v11 offset:8992
    ds_read_b64_tr_b16 v[74:75], v11 offset:9248
    ds_read_b64_tr_b16 v[76:77], v11 offset:9504
    ds_read_b64_tr_b16 v[78:79], v11 offset:9760
    ds_read_b64_tr_b16 v[80:81], v11 offset:10016
    ds_read_b64_tr_b16 v[82:83], v11 offset:10272
    s_waitcnt lgkmcnt(0)
    v_alignbit_b32 v84, v17, v16, 16
    v_alignbit_b32 v85, v18, v17, 16
    v_alignbit_b32 v86, v19, v18, 16
    v_alignbit_b32 v87, v20, v19, 16
    v_alignbit_b32 v88, v21, v20, 16
    v_alignbit_b32 v89, v22, v21, 16
    v_alignbit_b32 v90, v23, v22, 16
    v_alignbit_b32 v91, v24, v23, 16
    v_alignbit_b32 v92, v25, v24, 16
    v_alignbit_b32 v93, v26, v25, 16
    v_alignbit_b32 v94, v27, v26, 16
    v_alignbit_b32 v95, v28, v27, 16
    v_alignbit_b32 v96, v29, v28, 16
    v_alignbit_b32 v97, v30, v29, 16
    v_alignbit_b32 v98, v31, v30, 16
    v_alignbit_b32 v99, v32, v31, 16
    v_alignbit_b32 v100, v33, v32, 16
    v_dot2_f32_bf16 v102, v84, v197, 0
    v_dot2_f32_bf16 v103, v17, v197, 0
    v_dot2_f32_bf16 v106, v85, v197, 0
    v_dot2_f32_bf16 v107, v18, v197, 0
    v_dot2_f32_bf16 v110, v86, v197, 0
    v_dot2_f32_bf16 v111, v19, v197, 0
    v_dot2_f32_bf16 v114, v87, v197, 0
    v_dot2_f32_bf16 v115, v20, v197, 0
    v_dot2_f32_bf16 v102, v85, v196, v102
    v_dot2_f32_bf16 v103, v18, v196, v103
    v_dot2_f32_bf16 v106, v86, v196, v106
    v_dot2_f32_bf16 v107, v19, v196, v107
    v_dot2_f32_bf16 v110, v87, v196, v110
    v_dot2_f32_bf16 v111, v20, v196, v111
    v_dot2_f32_bf16 v114, v88, v196, v114
    v_dot2_f32_bf16 v115, v21, v196, v115
    v_lshlrev_b32 v104, 16, v34
    v_and_b32 v105, 0xffff0000, v34
    v_lshlrev_b32 v108, 16, v35
    v_and_b32 v109, 0xffff0000, v35
    v_lshlrev_b32 v112, 16, v36
    v_and_b32 v113, 0xffff0000, v36
    v_lshlrev_b32 v116, 16, v37
    v_and_b32 v117, 0xffff0000, v37
    v_mul_f32 v102, v102, v104
    v_mul_f32 v103, v103, v105
    v_mul_f32 v106, v106, v108
    v_mul_f32 v107, v107, v109
    v_mul_f32 v110, v110, v112
    v_mul_f32 v111, v111, v113
    v_mul_f32 v114, v114, v116
    v_mul_f32 v115, v115, v117
    v_cvt_pk_bf16_f32 v137, v103, v102
    v_cvt_pk_bf16_f32 v136, v107, v106
    v_cvt_pk_bf16_f32 v135, v111, v110
    v_cvt_pk_bf16_f32 v134, v115, v114
    s_add_u32 s4, s72, 128
    buffer_store_dwordx4 v[134:137], v12, s[8:11], s4 offen offset:0
    v_dot2_f32_bf16 v118, v88, v197, 0
    v_dot2_f32_bf16 v119, v21, v197, 0
    v_dot2_f32_bf16 v122, v89, v197, 0
    v_dot2_f32_bf16 v123, v22, v197, 0
    v_dot2_f32_bf16 v126, v90, v197, 0
    v_dot2_f32_bf16 v127, v23, v197, 0
    v_dot2_f32_bf16 v130, v91, v197, 0
    v_dot2_f32_bf16 v131, v24, v197, 0
    v_dot2_f32_bf16 v118, v89, v196, v118
    v_dot2_f32_bf16 v119, v22, v196, v119
    v_dot2_f32_bf16 v122, v90, v196, v122
    v_dot2_f32_bf16 v123, v23, v196, v123
    v_dot2_f32_bf16 v126, v91, v196, v126
    v_dot2_f32_bf16 v127, v24, v196, v127
    v_dot2_f32_bf16 v130, v92, v196, v130
    v_dot2_f32_bf16 v131, v25, v196, v131
    v_lshlrev_b32 v120, 16, v38
    v_and_b32 v121, 0xffff0000, v38
    v_lshlrev_b32 v124, 16, v39
    v_and_b32 v125, 0xffff0000, v39
    v_lshlrev_b32 v128, 16, v40
    v_and_b32 v129, 0xffff0000, v40
    v_lshlrev_b32 v132, 16, v41
    v_and_b32 v133, 0xffff0000, v41
    v_mul_f32 v118, v118, v120
    v_mul_f32 v119, v119, v121
    v_mul_f32 v122, v122, v124
    v_mul_f32 v123, v123, v125
    v_mul_f32 v126, v126, v128
    v_mul_f32 v127, v127, v129
    v_mul_f32 v130, v130, v132
    v_mul_f32 v131, v131, v133
    v_cvt_pk_bf16_f32 v141, v119, v118
    v_cvt_pk_bf16_f32 v140, v123, v122
    v_cvt_pk_bf16_f32 v139, v127, v126
    v_cvt_pk_bf16_f32 v138, v131, v130
    buffer_store_dwordx4 v[138:141], v12, s[8:11], s4 offen offset:1024
    v_dot2_f32_bf16 v102, v92, v197, 0
    v_dot2_f32_bf16 v103, v25, v197, 0
    v_dot2_f32_bf16 v106, v93, v197, 0
    v_dot2_f32_bf16 v107, v26, v197, 0
    v_dot2_f32_bf16 v110, v94, v197, 0
    v_dot2_f32_bf16 v111, v27, v197, 0
    v_dot2_f32_bf16 v114, v95, v197, 0
    v_dot2_f32_bf16 v115, v28, v197, 0
    v_dot2_f32_bf16 v102, v93, v196, v102
    v_dot2_f32_bf16 v103, v26, v196, v103
    v_dot2_f32_bf16 v106, v94, v196, v106
    v_dot2_f32_bf16 v107, v27, v196, v107
    v_dot2_f32_bf16 v110, v95, v196, v110
    v_dot2_f32_bf16 v111, v28, v196, v111
    v_dot2_f32_bf16 v114, v96, v196, v114
    v_dot2_f32_bf16 v115, v29, v196, v115
    v_lshlrev_b32 v104, 16, v42
    v_and_b32 v105, 0xffff0000, v42
    v_lshlrev_b32 v108, 16, v43
    v_and_b32 v109, 0xffff0000, v43
    v_lshlrev_b32 v112, 16, v44
    v_and_b32 v113, 0xffff0000, v44
    v_lshlrev_b32 v116, 16, v45
    v_and_b32 v117, 0xffff0000, v45
    v_mul_f32 v102, v102, v104
    v_mul_f32 v103, v103, v105
    v_mul_f32 v106, v106, v108
    v_mul_f32 v107, v107, v109
    v_mul_f32 v110, v110, v112
    v_mul_f32 v111, v111, v113
    v_mul_f32 v114, v114, v116
    v_mul_f32 v115, v115, v117
    v_cvt_pk_bf16_f32 v145, v103, v102
    v_cvt_pk_bf16_f32 v144, v107, v106
    v_cvt_pk_bf16_f32 v143, v111, v110
    v_cvt_pk_bf16_f32 v142, v115, v114
    buffer_store_dwordx4 v[142:145], v12, s[8:11], s4 offen offset:2048
    v_dot2_f32_bf16 v118, v96, v197, 0
    v_dot2_f32_bf16 v119, v29, v197, 0
    v_dot2_f32_bf16 v122, v97, v197, 0
    v_dot2_f32_bf16 v123, v30, v197, 0
    v_dot2_f32_bf16 v126, v98, v197, 0
    v_dot2_f32_bf16 v127, v31, v197, 0
    v_dot2_f32_bf16 v130, v99, v197, 0
    v_dot2_f32_bf16 v131, v32, v197, 0
    v_dot2_f32_bf16 v118, v97, v196, v118
    v_dot2_f32_bf16 v119, v30, v196, v119
    v_dot2_f32_bf16 v122, v98, v196, v122
    v_dot2_f32_bf16 v123, v31, v196, v123
    v_dot2_f32_bf16 v126, v99, v196, v126
    v_dot2_f32_bf16 v127, v32, v196, v127
    v_dot2_f32_bf16 v130, v100, v196, v130
    v_dot2_f32_bf16 v131, v33, v196, v131
    v_lshlrev_b32 v120, 16, v46
    v_and_b32 v121, 0xffff0000, v46
    v_lshlrev_b32 v124, 16, v47
    v_and_b32 v125, 0xffff0000, v47
    v_lshlrev_b32 v128, 16, v48
    v_and_b32 v129, 0xffff0000, v48
    v_lshlrev_b32 v132, 16, v49
    v_and_b32 v133, 0xffff0000, v49
    v_mul_f32 v118, v118, v120
    v_mul_f32 v119, v119, v121
    v_mul_f32 v122, v122, v124
    v_mul_f32 v123, v123, v125
    v_mul_f32 v126, v126, v128
    v_mul_f32 v127, v127, v129
    v_mul_f32 v130, v130, v132
    v_mul_f32 v131, v131, v133
    v_cvt_pk_bf16_f32 v149, v119, v118
    v_cvt_pk_bf16_f32 v148, v123, v122
    v_cvt_pk_bf16_f32 v147, v127, v126
    v_cvt_pk_bf16_f32 v146, v131, v130
    buffer_store_dwordx4 v[146:149], v12, s[8:11], s4 offen offset:3072
    v_alignbit_b32 v84, v51, v50, 16
    v_alignbit_b32 v85, v52, v51, 16
    v_alignbit_b32 v86, v53, v52, 16
    v_alignbit_b32 v87, v54, v53, 16
    v_alignbit_b32 v88, v55, v54, 16
    v_alignbit_b32 v89, v56, v55, 16
    v_alignbit_b32 v90, v57, v56, 16
    v_alignbit_b32 v91, v58, v57, 16
    v_alignbit_b32 v92, v59, v58, 16
    v_alignbit_b32 v93, v60, v59, 16
    v_alignbit_b32 v94, v61, v60, 16
    v_alignbit_b32 v95, v62, v61, 16
    v_alignbit_b32 v96, v63, v62, 16
    v_alignbit_b32 v97, v64, v63, 16
    v_alignbit_b32 v98, v65, v64, 16
    v_alignbit_b32 v99, v66, v65, 16
    v_alignbit_b32 v100, v67, v66, 16
    v_dot2_f32_bf16 v102, v84, v199, 0
    v_dot2_f32_bf16 v103, v51, v199, 0
    v_dot2_f32_bf16 v106, v85, v199, 0
    v_dot2_f32_bf16 v107, v52, v199, 0
    v_dot2_f32_bf16 v110, v86, v199, 0
    v_dot2_f32_bf16 v111, v53, v199, 0
    v_dot2_f32_bf16 v114, v87, v199, 0
    v_dot2_f32_bf16 v115, v54, v199, 0
    v_dot2_f32_bf16 v102, v85, v198, v102
    v_dot2_f32_bf16 v103, v52, v198, v103
    v_dot2_f32_bf16 v106, v86, v198, v106
    v_dot2_f32_bf16 v107, v53, v198, v107
    v_dot2_f32_bf16 v110, v87, v198, v110
    v_dot2_f32_bf16 v111, v54, v198, v111
    v_dot2_f32_bf16 v114, v88, v198, v114
    v_dot2_f32_bf16 v115, v55, v198, v115
    v_lshlrev_b32 v104, 16, v68
    v_and_b32 v105, 0xffff0000, v68
    v_lshlrev_b32 v108, 16, v69
    v_and_b32 v109, 0xffff0000, v69
    v_lshlrev_b32 v112, 16, v70
    v_and_b32 v113, 0xffff0000, v70
    v_lshlrev_b32 v116, 16, v71
    v_and_b32 v117, 0xffff0000, v71
    v_mul_f32 v102, v102, v104
    v_mul_f32 v103, v103, v105
    v_mul_f32 v106, v106, v108
    v_mul_f32 v107, v107, v109
    v_mul_f32 v110, v110, v112
    v_mul_f32 v111, v111, v113
    v_mul_f32 v114, v114, v116
    v_mul_f32 v115, v115, v117
    v_cvt_pk_bf16_f32 v153, v103, v102
    v_cvt_pk_bf16_f32 v152, v107, v106
    v_cvt_pk_bf16_f32 v151, v111, v110
    v_cvt_pk_bf16_f32 v150, v115, v114
    s_add_u32 s4, s72, 65664
    buffer_store_dwordx4 v[150:153], v12, s[8:11], s4 offen offset:0
    v_dot2_f32_bf16 v118, v88, v199, 0
    v_dot2_f32_bf16 v119, v55, v199, 0
    v_dot2_f32_bf16 v122, v89, v199, 0
    v_dot2_f32_bf16 v123, v56, v199, 0
    v_dot2_f32_bf16 v126, v90, v199, 0
    v_dot2_f32_bf16 v127, v57, v199, 0
    v_dot2_f32_bf16 v130, v91, v199, 0
    v_dot2_f32_bf16 v131, v58, v199, 0
    v_dot2_f32_bf16 v118, v89, v198, v118
    v_dot2_f32_bf16 v119, v56, v198, v119
    v_dot2_f32_bf16 v122, v90, v198, v122
    v_dot2_f32_bf16 v123, v57, v198, v123
    v_dot2_f32_bf16 v126, v91, v198, v126
    v_dot2_f32_bf16 v127, v58, v198, v127
    v_dot2_f32_bf16 v130, v92, v198, v130
    v_dot2_f32_bf16 v131, v59, v198, v131
    v_lshlrev_b32 v120, 16, v72
    v_and_b32 v121, 0xffff0000, v72
    v_lshlrev_b32 v124, 16, v73
    v_and_b32 v125, 0xffff0000, v73
    v_lshlrev_b32 v128, 16, v74
    v_and_b32 v129, 0xffff0000, v74
    v_lshlrev_b32 v132, 16, v75
    v_and_b32 v133, 0xffff0000, v75
    v_mul_f32 v118, v118, v120
    v_mul_f32 v119, v119, v121
    v_mul_f32 v122, v122, v124
    v_mul_f32 v123, v123, v125
    v_mul_f32 v126, v126, v128
    v_mul_f32 v127, v127, v129
    v_mul_f32 v130, v130, v132
    v_mul_f32 v131, v131, v133
    v_cvt_pk_bf16_f32 v157, v119, v118
    v_cvt_pk_bf16_f32 v156, v123, v122
    v_cvt_pk_bf16_f32 v155, v127, v126
    v_cvt_pk_bf16_f32 v154, v131, v130
    buffer_store_dwordx4 v[154:157], v12, s[8:11], s4 offen offset:1024
    v_dot2_f32_bf16 v102, v92, v199, 0
    v_dot2_f32_bf16 v103, v59, v199, 0
    v_dot2_f32_bf16 v106, v93, v199, 0
    v_dot2_f32_bf16 v107, v60, v199, 0
    v_dot2_f32_bf16 v110, v94, v199, 0
    v_dot2_f32_bf16 v111, v61, v199, 0
    v_dot2_f32_bf16 v114, v95, v199, 0
    v_dot2_f32_bf16 v115, v62, v199, 0
    v_dot2_f32_bf16 v102, v93, v198, v102
    v_dot2_f32_bf16 v103, v60, v198, v103
    v_dot2_f32_bf16 v106, v94, v198, v106
    v_dot2_f32_bf16 v107, v61, v198, v107
    v_dot2_f32_bf16 v110, v95, v198, v110
    v_dot2_f32_bf16 v111, v62, v198, v111
    v_dot2_f32_bf16 v114, v96, v198, v114
    v_dot2_f32_bf16 v115, v63, v198, v115
    v_lshlrev_b32 v104, 16, v76
    v_and_b32 v105, 0xffff0000, v76
    v_lshlrev_b32 v108, 16, v77
    v_and_b32 v109, 0xffff0000, v77
    v_lshlrev_b32 v112, 16, v78
    v_and_b32 v113, 0xffff0000, v78
    v_lshlrev_b32 v116, 16, v79
    v_and_b32 v117, 0xffff0000, v79
    v_mul_f32 v102, v102, v104
    v_mul_f32 v103, v103, v105
    v_mul_f32 v106, v106, v108
    v_mul_f32 v107, v107, v109
    v_mul_f32 v110, v110, v112
    v_mul_f32 v111, v111, v113
    v_mul_f32 v114, v114, v116
    v_mul_f32 v115, v115, v117
    v_cvt_pk_bf16_f32 v161, v103, v102
    v_cvt_pk_bf16_f32 v160, v107, v106
    v_cvt_pk_bf16_f32 v159, v111, v110
    v_cvt_pk_bf16_f32 v158, v115, v114
    buffer_store_dwordx4 v[158:161], v12, s[8:11], s4 offen offset:2048
    v_dot2_f32_bf16 v118, v96, v199, 0
    v_dot2_f32_bf16 v119, v63, v199, 0
    v_dot2_f32_bf16 v122, v97, v199, 0
    v_dot2_f32_bf16 v123, v64, v199, 0
    v_dot2_f32_bf16 v126, v98, v199, 0
    v_dot2_f32_bf16 v127, v65, v199, 0
    v_dot2_f32_bf16 v130, v99, v199, 0
    v_dot2_f32_bf16 v131, v66, v199, 0
    v_dot2_f32_bf16 v118, v97, v198, v118
    v_dot2_f32_bf16 v119, v64, v198, v119
    v_dot2_f32_bf16 v122, v98, v198, v122
    v_dot2_f32_bf16 v123, v65, v198, v123
    v_dot2_f32_bf16 v126, v99, v198, v126
    v_dot2_f32_bf16 v127, v66, v198, v127
    v_dot2_f32_bf16 v130, v100, v198, v130
    v_dot2_f32_bf16 v131, v67, v198, v131
    v_lshlrev_b32 v120, 16, v80
    v_and_b32 v121, 0xffff0000, v80
    v_lshlrev_b32 v124, 16, v81
    v_and_b32 v125, 0xffff0000, v81
    v_lshlrev_b32 v128, 16, v82
    v_and_b32 v129, 0xffff0000, v82
    v_lshlrev_b32 v132, 16, v83
    v_and_b32 v133, 0xffff0000, v83
    v_mul_f32 v118, v118, v120
    v_mul_f32 v119, v119, v121
    v_mul_f32 v122, v122, v124
    v_mul_f32 v123, v123, v125
    v_mul_f32 v126, v126, v128
    v_mul_f32 v127, v127, v129
    v_mul_f32 v130, v130, v132
    v_mul_f32 v131, v131, v133
    v_cvt_pk_bf16_f32 v165, v119, v118
    v_cvt_pk_bf16_f32 v164, v123, v122
    v_cvt_pk_bf16_f32 v163, v127, v126
    v_cvt_pk_bf16_f32 v162, v131, v130
    buffer_store_dwordx4 v[162:165], v12, s[8:11], s4 offen offset:3072
    s_waitcnt vmcnt(8)
    ds_read_b64_tr_b16 v[16:17], v11 offset:16640
    ds_read_b64_tr_b16 v[18:19], v11 offset:16896
    ds_read_b64_tr_b16 v[20:21], v11 offset:17152
    ds_read_b64_tr_b16 v[22:23], v11 offset:17408
    ds_read_b64_tr_b16 v[24:25], v11 offset:17664
    ds_read_b64_tr_b16 v[26:27], v11 offset:17920
    ds_read_b64_tr_b16 v[28:29], v11 offset:18176
    ds_read_b64_tr_b16 v[30:31], v11 offset:18432
    ds_read_b64_tr_b16 v[32:33], v11 offset:18688
    ds_read_b64_tr_b16 v[34:35], v11 offset:25088
    ds_read_b64_tr_b16 v[36:37], v11 offset:25344
    ds_read_b64_tr_b16 v[38:39], v11 offset:25600
    ds_read_b64_tr_b16 v[40:41], v11 offset:25856
    ds_read_b64_tr_b16 v[42:43], v11 offset:26112
    ds_read_b64_tr_b16 v[44:45], v11 offset:26368
    ds_read_b64_tr_b16 v[46:47], v11 offset:26624
    ds_read_b64_tr_b16 v[48:49], v11 offset:26880
    ds_read_b64_tr_b16 v[50:51], v11 offset:16672
    ds_read_b64_tr_b16 v[52:53], v11 offset:16928
    ds_read_b64_tr_b16 v[54:55], v11 offset:17184
    ds_read_b64_tr_b16 v[56:57], v11 offset:17440
    ds_read_b64_tr_b16 v[58:59], v11 offset:17696
    ds_read_b64_tr_b16 v[60:61], v11 offset:17952
    ds_read_b64_tr_b16 v[62:63], v11 offset:18208
    ds_read_b64_tr_b16 v[64:65], v11 offset:18464
    ds_read_b64_tr_b16 v[66:67], v11 offset:18720
    ds_read_b64_tr_b16 v[68:69], v11 offset:25120
    ds_read_b64_tr_b16 v[70:71], v11 offset:25376
    ds_read_b64_tr_b16 v[72:73], v11 offset:25632
    ds_read_b64_tr_b16 v[74:75], v11 offset:25888
    ds_read_b64_tr_b16 v[76:77], v11 offset:26144
    ds_read_b64_tr_b16 v[78:79], v11 offset:26400
    ds_read_b64_tr_b16 v[80:81], v11 offset:26656
    ds_read_b64_tr_b16 v[82:83], v11 offset:26912
    s_waitcnt lgkmcnt(0)
    v_alignbit_b32 v84, v17, v16, 16
    v_alignbit_b32 v85, v18, v17, 16
    v_alignbit_b32 v86, v19, v18, 16
    v_alignbit_b32 v87, v20, v19, 16
    v_alignbit_b32 v88, v21, v20, 16
    v_alignbit_b32 v89, v22, v21, 16
    v_alignbit_b32 v90, v23, v22, 16
    v_alignbit_b32 v91, v24, v23, 16
    v_alignbit_b32 v92, v25, v24, 16
    v_alignbit_b32 v93, v26, v25, 16
    v_alignbit_b32 v94, v27, v26, 16
    v_alignbit_b32 v95, v28, v27, 16
    v_alignbit_b32 v96, v29, v28, 16
    v_alignbit_b32 v97, v30, v29, 16
    v_alignbit_b32 v98, v31, v30, 16
    v_alignbit_b32 v99, v32, v31, 16
    v_alignbit_b32 v100, v33, v32, 16
    v_dot2_f32_bf16 v102, v84, v197, 0
    v_dot2_f32_bf16 v103, v17, v197, 0
    v_dot2_f32_bf16 v106, v85, v197, 0
    v_dot2_f32_bf16 v107, v18, v197, 0
    v_dot2_f32_bf16 v110, v86, v197, 0
    v_dot2_f32_bf16 v111, v19, v197, 0
    v_dot2_f32_bf16 v114, v87, v197, 0
    v_dot2_f32_bf16 v115, v20, v197, 0
    v_dot2_f32_bf16 v102, v85, v196, v102
    v_dot2_f32_bf16 v103, v18, v196, v103
    v_dot2_f32_bf16 v106, v86, v196, v106
    v_dot2_f32_bf16 v107, v19, v196, v107
    v_dot2_f32_bf16 v110, v87, v196, v110
    v_dot2_f32_bf16 v111, v20, v196, v111
    v_dot2_f32_bf16 v114, v88, v196, v114
    v_dot2_f32_bf16 v115, v21, v196, v115
    v_lshlrev_b32 v104, 16, v34
    v_and_b32 v105, 0xffff0000, v34
    v_lshlrev_b32 v108, 16, v35
    v_and_b32 v109, 0xffff0000, v35
    v_lshlrev_b32 v112, 16, v36
    v_and_b32 v113, 0xffff0000, v36
    v_lshlrev_b32 v116, 16, v37
    v_and_b32 v117, 0xffff0000, v37
    v_mul_f32 v102, v102, v104
    v_mul_f32 v103, v103, v105
    v_mul_f32 v106, v106, v108
    v_mul_f32 v107, v107, v109
    v_mul_f32 v110, v110, v112
    v_mul_f32 v111, v111, v113
    v_mul_f32 v114, v114, v116
    v_mul_f32 v115, v115, v117
    v_cvt_pk_bf16_f32 v137, v103, v102
    v_cvt_pk_bf16_f32 v136, v107, v106
    v_cvt_pk_bf16_f32 v135, v111, v110
    v_cvt_pk_bf16_f32 v134, v115, v114
    s_add_u32 s4, s72, 192
    buffer_store_dwordx4 v[134:137], v12, s[8:11], s4 offen offset:0
    v_dot2_f32_bf16 v118, v88, v197, 0
    v_dot2_f32_bf16 v119, v21, v197, 0
    v_dot2_f32_bf16 v122, v89, v197, 0
    v_dot2_f32_bf16 v123, v22, v197, 0
    v_dot2_f32_bf16 v126, v90, v197, 0
    v_dot2_f32_bf16 v127, v23, v197, 0
    v_dot2_f32_bf16 v130, v91, v197, 0
    v_dot2_f32_bf16 v131, v24, v197, 0
    v_dot2_f32_bf16 v118, v89, v196, v118
    v_dot2_f32_bf16 v119, v22, v196, v119
    v_dot2_f32_bf16 v122, v90, v196, v122
    v_dot2_f32_bf16 v123, v23, v196, v123
    v_dot2_f32_bf16 v126, v91, v196, v126
    v_dot2_f32_bf16 v127, v24, v196, v127
    v_dot2_f32_bf16 v130, v92, v196, v130
    v_dot2_f32_bf16 v131, v25, v196, v131
    v_lshlrev_b32 v120, 16, v38
    v_and_b32 v121, 0xffff0000, v38
    v_lshlrev_b32 v124, 16, v39
    v_and_b32 v125, 0xffff0000, v39
    v_lshlrev_b32 v128, 16, v40
    v_and_b32 v129, 0xffff0000, v40
    v_lshlrev_b32 v132, 16, v41
    v_and_b32 v133, 0xffff0000, v41
    v_mul_f32 v118, v118, v120
    v_mul_f32 v119, v119, v121
    v_mul_f32 v122, v122, v124
    v_mul_f32 v123, v123, v125
    v_mul_f32 v126, v126, v128
    v_mul_f32 v127, v127, v129
    v_mul_f32 v130, v130, v132
    v_mul_f32 v131, v131, v133
    v_cvt_pk_bf16_f32 v141, v119, v118
    v_cvt_pk_bf16_f32 v140, v123, v122
    v_cvt_pk_bf16_f32 v139, v127, v126
    v_cvt_pk_bf16_f32 v138, v131, v130
    buffer_store_dwordx4 v[138:141], v12, s[8:11], s4 offen offset:1024
    v_dot2_f32_bf16 v102, v92, v197, 0
    v_dot2_f32_bf16 v103, v25, v197, 0
    v_dot2_f32_bf16 v106, v93, v197, 0
    v_dot2_f32_bf16 v107, v26, v197, 0
    v_dot2_f32_bf16 v110, v94, v197, 0
    v_dot2_f32_bf16 v111, v27, v197, 0
    v_dot2_f32_bf16 v114, v95, v197, 0
    v_dot2_f32_bf16 v115, v28, v197, 0
    v_dot2_f32_bf16 v102, v93, v196, v102
    v_dot2_f32_bf16 v103, v26, v196, v103
    v_dot2_f32_bf16 v106, v94, v196, v106
    v_dot2_f32_bf16 v107, v27, v196, v107
    v_dot2_f32_bf16 v110, v95, v196, v110
    v_dot2_f32_bf16 v111, v28, v196, v111
    v_dot2_f32_bf16 v114, v96, v196, v114
    v_dot2_f32_bf16 v115, v29, v196, v115
    v_lshlrev_b32 v104, 16, v42
    v_and_b32 v105, 0xffff0000, v42
    v_lshlrev_b32 v108, 16, v43
    v_and_b32 v109, 0xffff0000, v43
    v_lshlrev_b32 v112, 16, v44
    v_and_b32 v113, 0xffff0000, v44
    v_lshlrev_b32 v116, 16, v45
    v_and_b32 v117, 0xffff0000, v45
    v_mul_f32 v102, v102, v104
    v_mul_f32 v103, v103, v105
    v_mul_f32 v106, v106, v108
    v_mul_f32 v107, v107, v109
    v_mul_f32 v110, v110, v112
    v_mul_f32 v111, v111, v113
    v_mul_f32 v114, v114, v116
    v_mul_f32 v115, v115, v117
    v_cvt_pk_bf16_f32 v145, v103, v102
    v_cvt_pk_bf16_f32 v144, v107, v106
    v_cvt_pk_bf16_f32 v143, v111, v110
    v_cvt_pk_bf16_f32 v142, v115, v114
    buffer_store_dwordx4 v[142:145], v12, s[8:11], s4 offen offset:2048
    v_dot2_f32_bf16 v118, v96, v197, 0
    v_dot2_f32_bf16 v119, v29, v197, 0
    v_dot2_f32_bf16 v122, v97, v197, 0
    v_dot2_f32_bf16 v123, v30, v197, 0
    v_dot2_f32_bf16 v126, v98, v197, 0
    v_dot2_f32_bf16 v127, v31, v197, 0
    v_dot2_f32_bf16 v130, v99, v197, 0
    v_dot2_f32_bf16 v131, v32, v197, 0
    v_dot2_f32_bf16 v118, v97, v196, v118
    v_dot2_f32_bf16 v119, v30, v196, v119
    v_dot2_f32_bf16 v122, v98, v196, v122
    v_dot2_f32_bf16 v123, v31, v196, v123
    v_dot2_f32_bf16 v126, v99, v196, v126
    v_dot2_f32_bf16 v127, v32, v196, v127
    v_dot2_f32_bf16 v130, v100, v196, v130
    v_dot2_f32_bf16 v131, v33, v196, v131
    v_lshlrev_b32 v120, 16, v46
    v_and_b32 v121, 0xffff0000, v46
    v_lshlrev_b32 v124, 16, v47
    v_and_b32 v125, 0xffff0000, v47
    v_lshlrev_b32 v128, 16, v48
    v_and_b32 v129, 0xffff0000, v48
    v_lshlrev_b32 v132, 16, v49
    v_and_b32 v133, 0xffff0000, v49
    v_mul_f32 v118, v118, v120
    v_mul_f32 v119, v119, v121
    v_mul_f32 v122, v122, v124
    v_mul_f32 v123, v123, v125
    v_mul_f32 v126, v126, v128
    v_mul_f32 v127, v127, v129
    v_mul_f32 v130, v130, v132
    v_mul_f32 v131, v131, v133
    v_cvt_pk_bf16_f32 v149, v119, v118
    v_cvt_pk_bf16_f32 v148, v123, v122
    v_cvt_pk_bf16_f32 v147, v127, v126
    v_cvt_pk_bf16_f32 v146, v131, v130
    buffer_store_dwordx4 v[146:149], v12, s[8:11], s4 offen offset:3072
    v_alignbit_b32 v84, v51, v50, 16
    v_alignbit_b32 v85, v52, v51, 16
    v_alignbit_b32 v86, v53, v52, 16
    v_alignbit_b32 v87, v54, v53, 16
    v_alignbit_b32 v88, v55, v54, 16
    v_alignbit_b32 v89, v56, v55, 16
    v_alignbit_b32 v90, v57, v56, 16
    v_alignbit_b32 v91, v58, v57, 16
    v_alignbit_b32 v92, v59, v58, 16
    v_alignbit_b32 v93, v60, v59, 16
    v_alignbit_b32 v94, v61, v60, 16
    v_alignbit_b32 v95, v62, v61, 16
    v_alignbit_b32 v96, v63, v62, 16
    v_alignbit_b32 v97, v64, v63, 16
    v_alignbit_b32 v98, v65, v64, 16
    v_alignbit_b32 v99, v66, v65, 16
    v_alignbit_b32 v100, v67, v66, 16
    v_dot2_f32_bf16 v102, v84, v199, 0
    v_dot2_f32_bf16 v103, v51, v199, 0
    v_dot2_f32_bf16 v106, v85, v199, 0
    v_dot2_f32_bf16 v107, v52, v199, 0
    v_dot2_f32_bf16 v110, v86, v199, 0
    v_dot2_f32_bf16 v111, v53, v199, 0
    v_dot2_f32_bf16 v114, v87, v199, 0
    v_dot2_f32_bf16 v115, v54, v199, 0
    v_dot2_f32_bf16 v102, v85, v198, v102
    v_dot2_f32_bf16 v103, v52, v198, v103
    v_dot2_f32_bf16 v106, v86, v198, v106
    v_dot2_f32_bf16 v107, v53, v198, v107
    v_dot2_f32_bf16 v110, v87, v198, v110
    v_dot2_f32_bf16 v111, v54, v198, v111
    v_dot2_f32_bf16 v114, v88, v198, v114
    v_dot2_f32_bf16 v115, v55, v198, v115
    v_lshlrev_b32 v104, 16, v68
    v_and_b32 v105, 0xffff0000, v68
    v_lshlrev_b32 v108, 16, v69
    v_and_b32 v109, 0xffff0000, v69
    v_lshlrev_b32 v112, 16, v70
    v_and_b32 v113, 0xffff0000, v70
    v_lshlrev_b32 v116, 16, v71
    v_and_b32 v117, 0xffff0000, v71
    v_mul_f32 v102, v102, v104
    v_mul_f32 v103, v103, v105
    v_mul_f32 v106, v106, v108
    v_mul_f32 v107, v107, v109
    v_mul_f32 v110, v110, v112
    v_mul_f32 v111, v111, v113
    v_mul_f32 v114, v114, v116
    v_mul_f32 v115, v115, v117
    v_cvt_pk_bf16_f32 v153, v103, v102
    v_cvt_pk_bf16_f32 v152, v107, v106
    v_cvt_pk_bf16_f32 v151, v111, v110
    v_cvt_pk_bf16_f32 v150, v115, v114
    s_add_u32 s4, s72, 65728
    buffer_store_dwordx4 v[150:153], v12, s[8:11], s4 offen offset:0
    v_dot2_f32_bf16 v118, v88, v199, 0
    v_dot2_f32_bf16 v119, v55, v199, 0
    v_dot2_f32_bf16 v122, v89, v199, 0
    v_dot2_f32_bf16 v123, v56, v199, 0
    v_dot2_f32_bf16 v126, v90, v199, 0
    v_dot2_f32_bf16 v127, v57, v199, 0
    v_dot2_f32_bf16 v130, v91, v199, 0
    v_dot2_f32_bf16 v131, v58, v199, 0
    v_dot2_f32_bf16 v118, v89, v198, v118
    v_dot2_f32_bf16 v119, v56, v198, v119
    v_dot2_f32_bf16 v122, v90, v198, v122
    v_dot2_f32_bf16 v123, v57, v198, v123
    v_dot2_f32_bf16 v126, v91, v198, v126
    v_dot2_f32_bf16 v127, v58, v198, v127
    v_dot2_f32_bf16 v130, v92, v198, v130
    v_dot2_f32_bf16 v131, v59, v198, v131
    v_lshlrev_b32 v120, 16, v72
    v_and_b32 v121, 0xffff0000, v72
    v_lshlrev_b32 v124, 16, v73
    v_and_b32 v125, 0xffff0000, v73
    v_lshlrev_b32 v128, 16, v74
    v_and_b32 v129, 0xffff0000, v74
    v_lshlrev_b32 v132, 16, v75
    v_and_b32 v133, 0xffff0000, v75
    v_mul_f32 v118, v118, v120
    v_mul_f32 v119, v119, v121
    v_mul_f32 v122, v122, v124
    v_mul_f32 v123, v123, v125
    v_mul_f32 v126, v126, v128
    v_mul_f32 v127, v127, v129
    v_mul_f32 v130, v130, v132
    v_mul_f32 v131, v131, v133
    v_cvt_pk_bf16_f32 v157, v119, v118
    v_cvt_pk_bf16_f32 v156, v123, v122
    v_cvt_pk_bf16_f32 v155, v127, v126
    v_cvt_pk_bf16_f32 v154, v131, v130
    buffer_store_dwordx4 v[154:157], v12, s[8:11], s4 offen offset:1024
    v_dot2_f32_bf16 v102, v92, v199, 0
    v_dot2_f32_bf16 v103, v59, v199, 0
    v_dot2_f32_bf16 v106, v93, v199, 0
    v_dot2_f32_bf16 v107, v60, v199, 0
    v_dot2_f32_bf16 v110, v94, v199, 0
    v_dot2_f32_bf16 v111, v61, v199, 0
    v_dot2_f32_bf16 v114, v95, v199, 0
    v_dot2_f32_bf16 v115, v62, v199, 0
    v_dot2_f32_bf16 v102, v93, v198, v102
    v_dot2_f32_bf16 v103, v60, v198, v103
    v_dot2_f32_bf16 v106, v94, v198, v106
    v_dot2_f32_bf16 v107, v61, v198, v107
    v_dot2_f32_bf16 v110, v95, v198, v110
    v_dot2_f32_bf16 v111, v62, v198, v111
    v_dot2_f32_bf16 v114, v96, v198, v114
    v_dot2_f32_bf16 v115, v63, v198, v115
    v_lshlrev_b32 v104, 16, v76
    v_and_b32 v105, 0xffff0000, v76
    v_lshlrev_b32 v108, 16, v77
    v_and_b32 v109, 0xffff0000, v77
    v_lshlrev_b32 v112, 16, v78
    v_and_b32 v113, 0xffff0000, v78
    v_lshlrev_b32 v116, 16, v79
    v_and_b32 v117, 0xffff0000, v79
    v_mul_f32 v102, v102, v104
    v_mul_f32 v103, v103, v105
    v_mul_f32 v106, v106, v108
    v_mul_f32 v107, v107, v109
    v_mul_f32 v110, v110, v112
    v_mul_f32 v111, v111, v113
    v_mul_f32 v114, v114, v116
    v_mul_f32 v115, v115, v117
    v_cvt_pk_bf16_f32 v161, v103, v102
    v_cvt_pk_bf16_f32 v160, v107, v106
    v_cvt_pk_bf16_f32 v159, v111, v110
    v_cvt_pk_bf16_f32 v158, v115, v114
    buffer_store_dwordx4 v[158:161], v12, s[8:11], s4 offen offset:2048
    v_dot2_f32_bf16 v118, v96, v199, 0
    v_dot2_f32_bf16 v119, v63, v199, 0
    v_dot2_f32_bf16 v122, v97, v199, 0
    v_dot2_f32_bf16 v123, v64, v199, 0
    v_dot2_f32_bf16 v126, v98, v199, 0
    v_dot2_f32_bf16 v127, v65, v199, 0
    v_dot2_f32_bf16 v130, v99, v199, 0
    v_dot2_f32_bf16 v131, v66, v199, 0
    v_dot2_f32_bf16 v118, v97, v198, v118
    v_dot2_f32_bf16 v119, v64, v198, v119
    v_dot2_f32_bf16 v122, v98, v198, v122
    v_dot2_f32_bf16 v123, v65, v198, v123
    v_dot2_f32_bf16 v126, v99, v198, v126
    v_dot2_f32_bf16 v127, v66, v198, v127
    v_dot2_f32_bf16 v130, v100, v198, v130
    v_dot2_f32_bf16 v131, v67, v198, v131
    v_lshlrev_b32 v120, 16, v80
    v_and_b32 v121, 0xffff0000, v80
    v_lshlrev_b32 v124, 16, v81
    v_and_b32 v125, 0xffff0000, v81
    v_lshlrev_b32 v128, 16, v82
    v_and_b32 v129, 0xffff0000, v82
    v_lshlrev_b32 v132, 16, v83
    v_and_b32 v133, 0xffff0000, v83
    v_mul_f32 v118, v118, v120
    v_mul_f32 v119, v119, v121
    v_mul_f32 v122, v122, v124
    v_mul_f32 v123, v123, v125
    v_mul_f32 v126, v126, v128
    v_mul_f32 v127, v127, v129
    v_mul_f32 v130, v130, v132
    v_mul_f32 v131, v131, v133
    v_cvt_pk_bf16_f32 v165, v119, v118
    v_cvt_pk_bf16_f32 v164, v123, v122
    v_cvt_pk_bf16_f32 v163, v127, v126
    v_cvt_pk_bf16_f32 v162, v131, v130
    buffer_store_dwordx4 v[162:165], v12, s[8:11], s4 offen offset:3072
    s_waitcnt vmcnt(0)
    s_barrier
    s_load_dwordx4 s[52:55], s[0:1], 32
    s_lshl_b32 s3, s93, 5
    s_lshl_b32 s4, s24, 3
    s_add_u32 s3, s3, s4
    s_lshl_b32 s4, s3, 1
    s_waitcnt lgkmcnt(0)
    s_load_dwordx4 s[64:67], s[54:55], s4

    s_mov_b32 s28, s52
    s_and_b32 s29, s53, 0xffff
    s_mov_b32 s30, 0x400000
    s_mov_b32 s31, 0x00020000

    v_and_b32 v1, 63, v0
    v_and_b32 v2, 15, v1
    v_lshrrev_b32 v3, 4, v1

    s_lshl_b32 s32, s3, 12
    s_add_u32 s33, s32, 28672
    s_mul_i32 s34, s24, 38400
    s_add_u32 s35, s34, 33536
    s_add_u32 s38, s32, 117440512
    v_lshlrev_b32 v4, 4, v1
    v_add_u32 v5, s34, v4
    v_add_u32 v5, 64, v5
    v_sub_u32 v6, 7, v2
    v_and_b32 v6, 7, v6
    v_mul_u32_u24 v6, 4160, v6
    v_lshrrev_b32 v7, 3, v2
    v_sub_u32 v7, v7, v3
    v_add_u32 v7, 4, v7
    v_lshl_add_u32 v6, v7, 4, v6
    v_add_u32 v6, s34, v6
    v_mul_u32_u24 v7, 80, v3
    v_add_u32 v7, v7, v2
    v_lshlrev_b32 v7, 4, v7
    v_add_u32 v7, s34, v7
    v_add_u32 v7, 33296, v7
    v_lshlrev_b32 v228, 7, v2
    v_lshl_add_u32 v228, v3, 4, v228
    v_subrev_u32 v229, 16, v4
    v_max_i32 v230, 0, v229
    v_sub_u32 v232, 7, v2
    v_and_b32 v232, 7, v232
    v_and_b32 v233, 1, v232
    v_lshlrev_b32 v233, 4, v233
    v_mov_b32 v234, 0xffff
    v_lshlrev_b32 v233, v233, v234
    v_lshrrev_b32 v232, 1, v232
    v_lshrrev_b32 v234, 3, v2
    v_sub_u32 v234, v3, v234
    v_lshl_add_u32 v232, v234, 1, v232
    v_and_b32 v234, 1, v234
    v_lshl_add_u32 v232, v234, 8, v232

    v_cmp_eq_u32 vcc, 0, v232
    s_nop 1
    v_cndmask_b32 v8, 0, v233, vcc
    v_cmp_eq_u32 vcc, 1, v232
    s_nop 1
    v_cndmask_b32 v9, 0, v233, vcc
    v_cmp_eq_u32 vcc, 2, v232
    s_nop 1
    v_cndmask_b32 v10, 0, v233, vcc
    v_cmp_eq_u32 vcc, 3, v232
    s_nop 1
    v_cndmask_b32 v11, 0, v233, vcc
    v_cmp_eq_u32 vcc, 4, v232
    s_nop 1
    v_cndmask_b32 v12, 0, v233, vcc
    v_cmp_eq_u32 vcc, 5, v232
    s_nop 1
    v_cndmask_b32 v13, 0, v233, vcc
    v_cmp_eq_u32 vcc, 6, v232
    s_nop 1
    v_cndmask_b32 v14, 0, v233, vcc
    v_cmp_eq_u32 vcc, 7, v232
    s_nop 1
    v_cndmask_b32 v15, 0, v233, vcc
    v_mov_b32 v208, 0
    v_mov_b32 v209, 0
    v_mov_b32 v210, 0
    v_mov_b32 v211, 0
    v_lshrrev_b32 v232, 2, v1
    v_and_b32 v232, 7, v232
    v_mul_u32_u24 v232, 4160, v232
    v_and_b32 v233, 3, v1
    v_lshl_add_u32 v232, v233, 4, v232
    v_add_u32 v232, s34, v232
    ds_write_b128 v232, v[208:211]
    v_subrev_u32 v233, 16, v7
    ds_write_b128 v233, v[208:211]

    s_add_u32 s39, s32, 125829120
    buffer_load_dwordx4 v[176:179], v230, s[28:31], s32 offen offset:0
    buffer_load_dwordx4 v[180:183], v4, s[28:31], s32 offen offset:0
    buffer_load_dwordx4 v[184:187], v4, s[28:31], s32 offen offset:1008
    buffer_load_dwordx4 v[188:191], v4, s[28:31], s32 offen offset:1024
    buffer_load_dwordx4 v[192:195], v4, s[28:31], s32 offen offset:2032
    buffer_load_dwordx4 v[196:199], v4, s[28:31], s32 offen offset:2048
    buffer_load_dwordx4 v[200:203], v4, s[28:31], s32 offen offset:3056
    buffer_load_dwordx4 v[204:207], v4, s[28:31], s32 offen offset:3072
    s_add_u32 m0, s35, 0
    s_nop 0
    buffer_load_dwordx4 v4, s[8:11], s39 offen offset:0 lds
    s_add_u32 m0, s35, 256
    s_nop 0
    buffer_load_dwordx4 v4, s[8:11], s39 offen offset:1024 lds
    s_add_u32 m0, s35, 512
    s_nop 0
    buffer_load_dwordx4 v4, s[8:11], s39 offen offset:2048 lds
    s_add_u32 m0, s35, 768
    s_nop 0
    buffer_load_dwordx4 v4, s[8:11], s39 offen offset:3072 lds
    s_waitcnt vmcnt(0) lgkmcnt(0)
    s_pack_ll_b32_b16 s40, s64, s64
    s_add_u32 s36, s32, 4096
    s_add_u32 s37, s32, 8192
    s_add_u32 s39, s36, 125829120
    s_mov_b64 exec, 1
    v_mov_b32 v176, 0
    v_mov_b32 v177, 0
    v_mov_b32 v178, 0
    v_mov_b32 v179, 0
    s_mov_b64 exec, -1
    ds_write_b128 v5, v[180:183] offset:0
    ds_write_b128 v5, v[178:181] offset:16640
    v_mov_b32 v208, v177
    v_mov_b32 v209, v178
    v_mov_b32 v210, v179
    v_mov_b32 v211, v180
    ds_write_b128 v5, v[208:211] offset:24960
    v_mov_b32 v212, v181
    v_mov_b32 v213, v182
    ds_write_b128 v5, v[210:213] offset:8320
    v_alignbit_b32 v214, v177, v176, 16
    v_alignbit_b32 v215, v178, v177, 16
    v_alignbit_b32 v216, v179, v178, 16
    v_alignbit_b32 v217, v180, v179, 16
    ds_write_b128 v5, v[214:217] offset:29120
    v_alignbit_b32 v218, v181, v180, 16
    v_alignbit_b32 v219, v182, v181, 16
    ds_write_b128 v5, v[216:219] offset:12480
    v_alignbit_b32 v220, v178, v177, 16
    v_alignbit_b32 v221, v179, v178, 16
    v_alignbit_b32 v222, v180, v179, 16
    v_alignbit_b32 v223, v181, v180, 16
    ds_write_b128 v5, v[220:223] offset:20800
    v_alignbit_b32 v224, v182, v181, 16
    v_alignbit_b32 v225, v183, v182, 16
    ds_write_b128 v5, v[222:225] offset:4160
    buffer_load_dwordx4 v[176:179], v230, s[28:31], s36 offen offset:0
    buffer_load_dwordx4 v[180:183], v4, s[28:31], s36 offen offset:0
    ds_write_b128 v5, v[188:191] offset:1024
    ds_write_b128 v5, v[186:189] offset:17664
    v_mov_b32 v208, v185
    v_mov_b32 v209, v186
    v_mov_b32 v210, v187
    v_mov_b32 v211, v188
    ds_write_b128 v5, v[208:211] offset:25984
    v_mov_b32 v212, v189
    v_mov_b32 v213, v190
    ds_write_b128 v5, v[210:213] offset:9344
    v_alignbit_b32 v214, v185, v184, 16
    v_alignbit_b32 v215, v186, v185, 16
    v_alignbit_b32 v216, v187, v186, 16
    v_alignbit_b32 v217, v188, v187, 16
    ds_write_b128 v5, v[214:217] offset:30144
    v_alignbit_b32 v218, v189, v188, 16
    v_alignbit_b32 v219, v190, v189, 16
    ds_write_b128 v5, v[216:219] offset:13504
    v_alignbit_b32 v220, v186, v185, 16
    v_alignbit_b32 v221, v187, v186, 16
    v_alignbit_b32 v222, v188, v187, 16
    v_alignbit_b32 v223, v189, v188, 16
    ds_write_b128 v5, v[220:223] offset:21824
    v_alignbit_b32 v224, v190, v189, 16
    v_alignbit_b32 v225, v191, v190, 16
    ds_write_b128 v5, v[222:225] offset:5184
    buffer_load_dwordx4 v[184:187], v4, s[28:31], s36 offen offset:1008
    buffer_load_dwordx4 v[188:191], v4, s[28:31], s36 offen offset:1024
    v_and_b32 v236, s40, v8
    v_and_b32 v237, s40, v9
    v_and_b32 v238, s40, v10
    v_and_b32 v239, s40, v11
    v_and_b32 v240, s40, v12
    v_and_b32 v241, s40, v13
    v_and_b32 v242, s40, v14
    v_and_b32 v243, s40, v15
    ds_read_b128 a[60:63], v7 offset:240
    ds_read_b128 a[124:127], v7 offset:496
    ds_read_b128 a[188:191], v7 offset:752
    ds_read_b128 a[252:255], v7 offset:1008
    ds_read_b128 v[168:171], v6 offset:0
    ds_read_b128 v[172:175], v6 offset:32
    s_waitcnt vmcnt(0) lgkmcnt(0)
    s_mov_b32 s42, 0
.cvl_454:
    s_waitcnt lgkmcnt(5)
    v_mfma_f32_16x16x32_bf16 v[16:19], v[236:239], a[60:63], 0
    v_mfma_f32_16x16x32_bf16 v[32:35], v[240:243], a[60:63], 0
    s_waitcnt lgkmcnt(4)
    v_mfma_f32_16x16x32_bf16 v[20:23], v[236:239], a[124:127], 0
    v_mfma_f32_16x16x32_bf16 v[36:39], v[240:243], a[124:127], 0
    s_waitcnt lgkmcnt(3)
    v_mfma_f32_16x16x32_bf16 v[24:27], v[236:239], a[188:191], 0
    v_mfma_f32_16x16x32_bf16 v[40:43], v[240:243], a[188:191], 0
    ds_read_b128 a[56:59], v7 offset:224
    s_waitcnt lgkmcnt(3)
    v_mfma_f32_16x16x32_bf16 v[28:31], v[236:239], a[252:255], 0
    ds_read_b128 v[112:115], v6 offset:64
    v_mfma_f32_16x16x32_bf16 v[44:47], v[240:243], a[252:255], 0
    ds_read_b128 v[116:119], v6 offset:96
    s_waitcnt lgkmcnt(4)
    v_mfma_f32_16x16x32_bf16 v[16:19], v[168:171], a[60:63], v[16:19]
    ds_read_b128 a[120:123], v7 offset:480
    s_waitcnt lgkmcnt(4)
    v_mfma_f32_16x16x32_bf16 v[32:35], v[172:175], a[60:63], v[32:35]
    s_waitcnt vmcnt(18)
    v_mfma_f32_16x16x32_bf16 v[20:23], v[168:171], a[124:127], v[20:23]
    ds_read_b128 a[184:187], v7 offset:736
    v_mfma_f32_16x16x32_bf16 v[36:39], v[172:175], a[124:127], v[36:39]
    ds_write_b128 v5, v[196:199] offset:2048
    v_mfma_f32_16x16x32_bf16 v[24:27], v[168:171], a[188:191], v[24:27]
    ds_read_b128 a[248:251], v7 offset:992
    v_mfma_f32_16x16x32_bf16 v[40:43], v[172:175], a[188:191], v[40:43]
    ds_read_b128 a[52:55], v7 offset:208
    v_mfma_f32_16x16x32_bf16 v[28:31], v[168:171], a[252:255], v[28:31]
    ds_read_b128 v[120:123], v6 offset:128
    v_mfma_f32_16x16x32_bf16 v[44:47], v[172:175], a[252:255], v[44:47]
    ds_read_b128 v[124:127], v6 offset:160
    s_waitcnt lgkmcnt(8)
    v_mfma_f32_16x16x32_bf16 v[16:19], v[112:115], a[56:59], v[16:19]
    ds_read_b128 a[116:119], v7 offset:464
    s_waitcnt lgkmcnt(8)
    v_mfma_f32_16x16x32_bf16 v[32:35], v[116:119], a[56:59], v[32:35]
    ds_write_b128 v5, v[194:197] offset:18688
    s_waitcnt lgkmcnt(8)
    v_mfma_f32_16x16x32_bf16 v[20:23], v[112:115], a[120:123], v[20:23]
    ds_read_b128 a[180:183], v7 offset:720
    v_mfma_f32_16x16x32_bf16 v[36:39], v[116:119], a[120:123], v[36:39]
    v_mov_b32 v208, v193
    v_mov_b32 v209, v194
    s_waitcnt lgkmcnt(8)
    v_mfma_f32_16x16x32_bf16 v[24:27], v[112:115], a[184:187], v[24:27]
    ds_read_b128 a[244:247], v7 offset:976
    v_mfma_f32_16x16x32_bf16 v[40:43], v[116:119], a[184:187], v[40:43]
    ds_read_b128 a[48:51], v7 offset:192
    s_waitcnt lgkmcnt(8)
    v_mfma_f32_16x16x32_bf16 v[28:31], v[112:115], a[248:251], v[28:31]
    ds_read_b128 v[128:131], v6 offset:192
    v_mfma_f32_16x16x32_bf16 v[44:47], v[116:119], a[248:251], v[44:47]
    ds_read_b128 v[132:135], v6 offset:224
    s_waitcnt lgkmcnt(8)
    v_mfma_f32_16x16x32_bf16 v[16:19], v[120:123], a[52:55], v[16:19]
    ds_read_b128 a[112:115], v7 offset:448
    s_waitcnt lgkmcnt(8)
    v_mfma_f32_16x16x32_bf16 v[32:35], v[124:127], a[52:55], v[32:35]
    v_mov_b32 v210, v195
    v_mov_b32 v211, v196
    s_waitcnt lgkmcnt(7)
    v_mfma_f32_16x16x32_bf16 v[20:23], v[120:123], a[116:119], v[20:23]
    ds_read_b128 a[176:179], v7 offset:704
    v_mfma_f32_16x16x32_bf16 v[36:39], v[124:127], a[116:119], v[36:39]
    ds_write_b128 v5, v[208:211] offset:27008
    s_waitcnt lgkmcnt(7)
    v_mfma_f32_16x16x32_bf16 v[24:27], v[120:123], a[180:183], v[24:27]
    ds_read_b128 a[240:243], v7 offset:960
    v_mfma_f32_16x16x32_bf16 v[40:43], v[124:127], a[180:183], v[40:43]
    ds_read_b128 a[44:47], v7 offset:176
    s_waitcnt lgkmcnt(8)
    v_mfma_f32_16x16x32_bf16 v[28:31], v[120:123], a[244:247], v[28:31]
    ds_read_b128 v[136:139], v6 offset:256
    v_mfma_f32_16x16x32_bf16 v[44:47], v[124:127], a[244:247], v[44:47]
    ds_read_b128 v[140:143], v6 offset:288
    s_waitcnt lgkmcnt(8)
    v_mfma_f32_16x16x32_bf16 v[16:19], v[128:131], a[48:51], v[16:19]
    ds_read_b128 a[108:111], v7 offset:432
    s_waitcnt lgkmcnt(8)
    v_mfma_f32_16x16x32_bf16 v[32:35], v[132:135], a[48:51], v[32:35]
    v_mov_b32 v212, v197
    v_mov_b32 v213, v198
    s_waitcnt lgkmcnt(7)
    v_mfma_f32_16x16x32_bf16 v[20:23], v[128:131], a[112:115], v[20:23]
    ds_read_b128 a[172:175], v7 offset:688
    v_mfma_f32_16x16x32_bf16 v[36:39], v[132:135], a[112:115], v[36:39]
    ds_write_b128 v5, v[210:213] offset:10368
    s_waitcnt lgkmcnt(8)
    v_mfma_f32_16x16x32_bf16 v[24:27], v[128:131], a[176:179], v[24:27]
    ds_read_b128 a[236:239], v7 offset:944
    v_mfma_f32_16x16x32_bf16 v[40:43], v[132:135], a[176:179], v[40:43]
    ds_read_b128 a[40:43], v7 offset:160
    s_waitcnt lgkmcnt(8)
    v_mfma_f32_16x16x32_bf16 v[28:31], v[128:131], a[240:243], v[28:31]
    ds_read_b128 v[144:147], v6 offset:320
    v_mfma_f32_16x16x32_bf16 v[44:47], v[132:135], a[240:243], v[44:47]
    ds_read_b128 v[148:151], v6 offset:352
    s_waitcnt lgkmcnt(8)
    v_mfma_f32_16x16x32_bf16 v[16:19], v[136:139], a[44:47], v[16:19]
    ds_read_b128 a[104:107], v7 offset:416
    s_waitcnt lgkmcnt(8)
    v_mfma_f32_16x16x32_bf16 v[32:35], v[140:143], a[44:47], v[32:35]
    v_alignbit_b32 v214, v193, v192, 16
    v_alignbit_b32 v215, v194, v193, 16
    s_waitcnt lgkmcnt(7)
    v_mfma_f32_16x16x32_bf16 v[20:23], v[136:139], a[108:111], v[20:23]
    ds_read_b128 a[168:171], v7 offset:672
    v_mfma_f32_16x16x32_bf16 v[36:39], v[140:143], a[108:111], v[36:39]
    v_alignbit_b32 v216, v195, v194, 16
    v_alignbit_b32 v217, v196, v195, 16
    s_waitcnt lgkmcnt(7)
    v_mfma_f32_16x16x32_bf16 v[24:27], v[136:139], a[172:175], v[24:27]
    ds_read_b128 a[232:235], v7 offset:928
    v_mfma_f32_16x16x32_bf16 v[40:43], v[140:143], a[172:175], v[40:43]
    ds_read_b128 a[36:39], v7 offset:144
    s_waitcnt lgkmcnt(7)
    v_mfma_f32_16x16x32_bf16 v[28:31], v[136:139], a[236:239], v[28:31]
    ds_read_b128 v[152:155], v6 offset:384
    v_mfma_f32_16x16x32_bf16 v[44:47], v[140:143], a[236:239], v[44:47]
    ds_read_b128 v[156:159], v6 offset:416
    s_waitcnt lgkmcnt(7)
    v_mfma_f32_16x16x32_bf16 v[16:19], v[144:147], a[40:43], v[16:19]
    ds_read_b128 a[100:103], v7 offset:400
    s_waitcnt lgkmcnt(7)
    v_mfma_f32_16x16x32_bf16 v[32:35], v[148:151], a[40:43], v[32:35]
    ds_write_b128 v5, v[214:217] offset:31168
    s_waitcnt lgkmcnt(7)
    v_mfma_f32_16x16x32_bf16 v[20:23], v[144:147], a[104:107], v[20:23]
    ds_read_b128 a[164:167], v7 offset:656
    v_mfma_f32_16x16x32_bf16 v[36:39], v[148:151], a[104:107], v[36:39]
    v_alignbit_b32 v218, v197, v196, 16
    v_alignbit_b32 v219, v198, v197, 16
    s_waitcnt lgkmcnt(7)
    v_mfma_f32_16x16x32_bf16 v[24:27], v[144:147], a[168:171], v[24:27]
    ds_read_b128 a[228:231], v7 offset:912
    v_mfma_f32_16x16x32_bf16 v[40:43], v[148:151], a[168:171], v[40:43]
    ds_read_b128 a[32:35], v7 offset:128
    s_waitcnt lgkmcnt(8)
    v_mfma_f32_16x16x32_bf16 v[28:31], v[144:147], a[232:235], v[28:31]
    ds_read_b128 v[160:163], v6 offset:448
    v_mfma_f32_16x16x32_bf16 v[44:47], v[148:151], a[232:235], v[44:47]
    ds_read_b128 v[164:167], v6 offset:480
    s_waitcnt lgkmcnt(8)
    v_mfma_f32_16x16x32_bf16 v[16:19], v[152:155], a[36:39], v[16:19]
    ds_read_b128 a[96:99], v7 offset:384
    s_waitcnt lgkmcnt(8)
    v_mfma_f32_16x16x32_bf16 v[32:35], v[156:159], a[36:39], v[32:35]
    ds_write_b128 v5, v[216:219] offset:14528
    s_waitcnt lgkmcnt(8)
    v_mfma_f32_16x16x32_bf16 v[20:23], v[152:155], a[100:103], v[20:23]
    ds_read_b128 a[160:163], v7 offset:640
    v_mfma_f32_16x16x32_bf16 v[36:39], v[156:159], a[100:103], v[36:39]
    v_alignbit_b32 v220, v194, v193, 16
    v_alignbit_b32 v221, v195, v194, 16
    s_waitcnt lgkmcnt(7)
    v_mfma_f32_16x16x32_bf16 v[24:27], v[152:155], a[164:167], v[24:27]
    ds_read_b128 a[224:227], v7 offset:896
    v_mfma_f32_16x16x32_bf16 v[40:43], v[156:159], a[164:167], v[40:43]
    ds_read_b128 a[28:31], v7 offset:112
    s_waitcnt lgkmcnt(8)
    v_mfma_f32_16x16x32_bf16 v[28:31], v[152:155], a[228:231], v[28:31]
    ds_read_b128 v[168:171], v6 offset:512
    v_mfma_f32_16x16x32_bf16 v[44:47], v[156:159], a[228:231], v[44:47]
    ds_read_b128 v[172:175], v6 offset:544
    s_waitcnt lgkmcnt(8)
    v_mfma_f32_16x16x32_bf16 v[16:19], v[160:163], a[32:35], v[16:19]
    ds_read_b128 a[92:95], v7 offset:368
    s_waitcnt lgkmcnt(8)
    v_mfma_f32_16x16x32_bf16 v[32:35], v[164:167], a[32:35], v[32:35]
    v_alignbit_b32 v222, v196, v195, 16
    v_alignbit_b32 v223, v197, v196, 16
    s_waitcnt lgkmcnt(7)
    v_mfma_f32_16x16x32_bf16 v[20:23], v[160:163], a[96:99], v[20:23]
    ds_read_b128 a[156:159], v7 offset:624
    v_mfma_f32_16x16x32_bf16 v[36:39], v[164:167], a[96:99], v[36:39]
    ds_write_b128 v5, v[220:223] offset:22848
    s_waitcnt lgkmcnt(7)
    v_mfma_f32_16x16x32_bf16 v[24:27], v[160:163], a[160:163], v[24:27]
    ds_read_b128 a[220:223], v7 offset:880
    v_mfma_f32_16x16x32_bf16 v[40:43], v[164:167], a[160:163], v[40:43]
    ds_read_b128 a[24:27], v7 offset:96
    s_waitcnt lgkmcnt(8)
    v_mfma_f32_16x16x32_bf16 v[28:31], v[160:163], a[224:227], v[28:31]
    ds_read_b128 v[112:115], v6 offset:576
    v_mfma_f32_16x16x32_bf16 v[44:47], v[164:167], a[224:227], v[44:47]
    ds_read_b128 v[116:119], v6 offset:608
    s_waitcnt lgkmcnt(8)
    v_mfma_f32_16x16x32_bf16 v[16:19], v[168:171], a[28:31], v[16:19]
    ds_read_b128 a[88:91], v7 offset:352
    s_waitcnt lgkmcnt(8)
    v_mfma_f32_16x16x32_bf16 v[32:35], v[172:175], a[28:31], v[32:35]
    v_alignbit_b32 v224, v198, v197, 16
    v_alignbit_b32 v225, v199, v198, 16
    s_waitcnt lgkmcnt(7)
    v_mfma_f32_16x16x32_bf16 v[20:23], v[168:171], a[92:95], v[20:23]
    ds_read_b128 a[152:155], v7 offset:608
    v_mfma_f32_16x16x32_bf16 v[36:39], v[172:175], a[92:95], v[36:39]
    ds_write_b128 v5, v[222:225] offset:6208
    s_waitcnt lgkmcnt(8)
    v_mfma_f32_16x16x32_bf16 v[24:27], v[168:171], a[156:159], v[24:27]
    ds_read_b128 a[216:219], v7 offset:864
    v_mfma_f32_16x16x32_bf16 v[40:43], v[172:175], a[156:159], v[40:43]
    ds_read_b128 a[20:23], v7 offset:80
    s_waitcnt lgkmcnt(8)
    v_mfma_f32_16x16x32_bf16 v[28:31], v[168:171], a[220:223], v[28:31]
    ds_read_b128 v[120:123], v6 offset:640
    v_mfma_f32_16x16x32_bf16 v[44:47], v[172:175], a[220:223], v[44:47]
    ds_read_b128 v[124:127], v6 offset:672
    s_waitcnt lgkmcnt(8)
    v_mfma_f32_16x16x32_bf16 v[16:19], v[112:115], a[24:27], v[16:19]
    ds_read_b128 a[84:87], v7 offset:336
    s_waitcnt lgkmcnt(8)
    v_mfma_f32_16x16x32_bf16 v[32:35], v[116:119], a[24:27], v[32:35]
    buffer_load_dwordx4 v[192:195], v4, s[28:31], s36 offen offset:2032
    s_waitcnt lgkmcnt(7)
    v_mfma_f32_16x16x32_bf16 v[20:23], v[112:115], a[88:91], v[20:23]
    ds_read_b128 a[148:151], v7 offset:592
    v_mfma_f32_16x16x32_bf16 v[36:39], v[116:119], a[88:91], v[36:39]
    buffer_load_dwordx4 v[196:199], v4, s[28:31], s36 offen offset:2048
    s_waitcnt lgkmcnt(7)
    v_mfma_f32_16x16x32_bf16 v[24:27], v[112:115], a[152:155], v[24:27]
    ds_read_b128 a[212:215], v7 offset:848
    v_mfma_f32_16x16x32_bf16 v[40:43], v[116:119], a[152:155], v[40:43]
    ds_read_b128 a[16:19], v7 offset:64
    s_waitcnt lgkmcnt(7)
    v_mfma_f32_16x16x32_bf16 v[28:31], v[112:115], a[216:219], v[28:31]
    ds_read_b128 v[128:131], v6 offset:704
    v_mfma_f32_16x16x32_bf16 v[44:47], v[116:119], a[216:219], v[44:47]
    ds_read_b128 v[132:135], v6 offset:736
    s_waitcnt lgkmcnt(7)
    v_mfma_f32_16x16x32_bf16 v[16:19], v[120:123], a[20:23], v[16:19]
    ds_read_b128 a[80:83], v7 offset:320
    s_waitcnt lgkmcnt(7)
    v_mfma_f32_16x16x32_bf16 v[32:35], v[124:127], a[20:23], v[32:35]
    s_waitcnt vmcnt(18)
    s_waitcnt lgkmcnt(6)
    v_mfma_f32_16x16x32_bf16 v[20:23], v[120:123], a[84:87], v[20:23]
    ds_read_b128 a[144:147], v7 offset:576
    v_mfma_f32_16x16x32_bf16 v[36:39], v[124:127], a[84:87], v[36:39]
    ds_write_b128 v5, v[204:207] offset:3072
    s_waitcnt lgkmcnt(7)
    v_mfma_f32_16x16x32_bf16 v[24:27], v[120:123], a[148:151], v[24:27]
    ds_read_b128 a[208:211], v7 offset:832
    v_mfma_f32_16x16x32_bf16 v[40:43], v[124:127], a[148:151], v[40:43]
    ds_read_b128 a[12:15], v7 offset:48
    s_waitcnt lgkmcnt(8)
    v_mfma_f32_16x16x32_bf16 v[28:31], v[120:123], a[212:215], v[28:31]
    ds_read_b128 v[136:139], v6 offset:768
    v_mfma_f32_16x16x32_bf16 v[44:47], v[124:127], a[212:215], v[44:47]
    ds_read_b128 v[140:143], v6 offset:800
    s_waitcnt lgkmcnt(8)
    v_mfma_f32_16x16x32_bf16 v[16:19], v[128:131], a[16:19], v[16:19]
    ds_read_b128 a[76:79], v7 offset:304
    s_waitcnt lgkmcnt(8)
    v_mfma_f32_16x16x32_bf16 v[32:35], v[132:135], a[16:19], v[32:35]
    ds_write_b128 v5, v[202:205] offset:19712
    s_waitcnt lgkmcnt(8)
    v_mfma_f32_16x16x32_bf16 v[20:23], v[128:131], a[80:83], v[20:23]
    ds_read_b128 a[140:143], v7 offset:560
    v_mfma_f32_16x16x32_bf16 v[36:39], v[132:135], a[80:83], v[36:39]
    v_mov_b32 v208, v201
    v_mov_b32 v209, v202
    s_waitcnt lgkmcnt(8)
    v_mfma_f32_16x16x32_bf16 v[24:27], v[128:131], a[144:147], v[24:27]
    ds_read_b128 a[204:207], v7 offset:816
    v_mfma_f32_16x16x32_bf16 v[40:43], v[132:135], a[144:147], v[40:43]
    ds_read_b128 a[8:11], v7 offset:32
    s_waitcnt lgkmcnt(8)
    v_mfma_f32_16x16x32_bf16 v[28:31], v[128:131], a[208:211], v[28:31]
    ds_read_b128 v[144:147], v6 offset:832
    v_mfma_f32_16x16x32_bf16 v[44:47], v[132:135], a[208:211], v[44:47]
    ds_read_b128 v[148:151], v6 offset:864
    s_waitcnt lgkmcnt(8)
    v_mfma_f32_16x16x32_bf16 v[16:19], v[136:139], a[12:15], v[16:19]
    ds_read_b128 a[72:75], v7 offset:288
    s_waitcnt lgkmcnt(8)
    v_mfma_f32_16x16x32_bf16 v[32:35], v[140:143], a[12:15], v[32:35]
    v_mov_b32 v210, v203
    v_mov_b32 v211, v204
    s_waitcnt lgkmcnt(7)
    v_mfma_f32_16x16x32_bf16 v[20:23], v[136:139], a[76:79], v[20:23]
    ds_read_b128 a[136:139], v7 offset:544
    v_mfma_f32_16x16x32_bf16 v[36:39], v[140:143], a[76:79], v[36:39]
    ds_write_b128 v5, v[208:211] offset:28032
    s_waitcnt lgkmcnt(7)
    v_mfma_f32_16x16x32_bf16 v[24:27], v[136:139], a[140:143], v[24:27]
    ds_read_b128 a[200:203], v7 offset:800
    v_mfma_f32_16x16x32_bf16 v[40:43], v[140:143], a[140:143], v[40:43]
    ds_read_b128 a[4:7], v7 offset:16
    s_waitcnt lgkmcnt(8)
    v_mfma_f32_16x16x32_bf16 v[28:31], v[136:139], a[204:207], v[28:31]
    ds_read_b128 v[152:155], v6 offset:896
    v_mfma_f32_16x16x32_bf16 v[44:47], v[140:143], a[204:207], v[44:47]
    ds_read_b128 v[156:159], v6 offset:928
    s_waitcnt lgkmcnt(8)
    v_mfma_f32_16x16x32_bf16 v[16:19], v[144:147], a[8:11], v[16:19]
    ds_read_b128 a[68:71], v7 offset:272
    s_waitcnt lgkmcnt(8)
    v_mfma_f32_16x16x32_bf16 v[32:35], v[148:151], a[8:11], v[32:35]
    v_mov_b32 v212, v205
    v_mov_b32 v213, v206
    s_waitcnt lgkmcnt(7)
    v_mfma_f32_16x16x32_bf16 v[20:23], v[144:147], a[72:75], v[20:23]
    ds_read_b128 a[132:135], v7 offset:528
    v_mfma_f32_16x16x32_bf16 v[36:39], v[148:151], a[72:75], v[36:39]
    ds_write_b128 v5, v[210:213] offset:11392
    s_waitcnt lgkmcnt(8)
    v_mfma_f32_16x16x32_bf16 v[24:27], v[144:147], a[136:139], v[24:27]
    ds_read_b128 a[196:199], v7 offset:784
    v_mfma_f32_16x16x32_bf16 v[40:43], v[148:151], a[136:139], v[40:43]
    ds_read_b128 a[0:3], v7 offset:0
    s_waitcnt lgkmcnt(8)
    v_mfma_f32_16x16x32_bf16 v[28:31], v[144:147], a[200:203], v[28:31]
    ds_read_b128 v[160:163], v6 offset:960
    v_mfma_f32_16x16x32_bf16 v[44:47], v[148:151], a[200:203], v[44:47]
    ds_read_b128 v[164:167], v6 offset:992
    s_waitcnt lgkmcnt(8)
    v_mfma_f32_16x16x32_bf16 v[16:19], v[152:155], a[4:7], v[16:19]
    ds_read_b128 a[64:67], v7 offset:256
    s_waitcnt lgkmcnt(8)
    v_mfma_f32_16x16x32_bf16 v[32:35], v[156:159], a[4:7], v[32:35]
    v_alignbit_b32 v214, v201, v200, 16
    v_alignbit_b32 v215, v202, v201, 16
    s_waitcnt lgkmcnt(7)
    v_mfma_f32_16x16x32_bf16 v[20:23], v[152:155], a[68:71], v[20:23]
    ds_read_b128 a[128:131], v7 offset:512
    v_mfma_f32_16x16x32_bf16 v[36:39], v[156:159], a[68:71], v[36:39]
    v_alignbit_b32 v216, v203, v202, 16
    v_alignbit_b32 v217, v204, v203, 16
    s_waitcnt lgkmcnt(7)
    v_mfma_f32_16x16x32_bf16 v[24:27], v[152:155], a[132:135], v[24:27]
    ds_read_b128 a[192:195], v7 offset:768
    v_mfma_f32_16x16x32_bf16 v[40:43], v[156:159], a[132:135], v[40:43]
    ds_write_b128 v5, v[214:217] offset:32192
    s_waitcnt lgkmcnt(7)
    v_mfma_f32_16x16x32_bf16 v[28:31], v[152:155], a[196:199], v[28:31]
    ds_read_b128 v[168:171], v6 offset:1024
    v_mfma_f32_16x16x32_bf16 v[44:47], v[156:159], a[196:199], v[44:47]
    ds_read_b128 v[172:175], v6 offset:1056
    s_waitcnt lgkmcnt(7)
    v_mfma_f32_16x16x32_bf16 v[16:19], v[160:163], a[0:3], v[16:19]
    v_alignbit_b32 v218, v205, v204, 16
    v_alignbit_b32 v219, v206, v205, 16
    s_waitcnt lgkmcnt(6)
    v_mfma_f32_16x16x32_bf16 v[32:35], v[164:167], a[0:3], v[32:35]
    ds_write_b128 v5, v[216:219] offset:15552
    s_waitcnt lgkmcnt(6)
    v_mfma_f32_16x16x32_bf16 v[20:23], v[160:163], a[64:67], v[20:23]
    v_alignbit_b32 v220, v202, v201, 16
    v_alignbit_b32 v221, v203, v202, 16
    v_mfma_f32_16x16x32_bf16 v[36:39], v[164:167], a[64:67], v[36:39]
    v_alignbit_b32 v222, v204, v203, 16
    v_alignbit_b32 v223, v205, v204, 16
    s_waitcnt lgkmcnt(5)
    v_mfma_f32_16x16x32_bf16 v[24:27], v[160:163], a[128:131], v[24:27]
    ds_read_b128 v[112:115], v6 offset:1088
    v_mfma_f32_16x16x32_bf16 v[40:43], v[164:167], a[128:131], v[40:43]
    ds_read_b128 v[116:119], v6 offset:1120
    s_waitcnt lgkmcnt(6)
    v_mfma_f32_16x16x32_bf16 v[28:31], v[160:163], a[192:195], v[28:31]
    ds_write_b128 v5, v[220:223] offset:23872
    v_mfma_f32_16x16x32_bf16 v[44:47], v[164:167], a[192:195], v[44:47]
    v_alignbit_b32 v224, v206, v205, 16
    v_alignbit_b32 v225, v207, v206, 16
    s_waitcnt lgkmcnt(5)
    v_mfma_f32_16x16x32_bf16 v[20:23], v[168:171], a[60:63], v[20:23]
    ds_write_b128 v5, v[222:225] offset:7232
    s_waitcnt lgkmcnt(5)
    v_mfma_f32_16x16x32_bf16 v[36:39], v[172:175], a[60:63], v[36:39]
    buffer_load_dwordx4 v[200:203], v4, s[28:31], s36 offen offset:3056
    v_mfma_f32_16x16x32_bf16 v[24:27], v[168:171], a[124:127], v[24:27]
    ds_read_b128 v[120:123], v6 offset:1152
    v_mfma_f32_16x16x32_bf16 v[40:43], v[172:175], a[124:127], v[40:43]
    ds_read_b128 v[124:127], v6 offset:1184
    v_mfma_f32_16x16x32_bf16 v[28:31], v[168:171], a[188:191], v[28:31]
    buffer_load_dwordx4 v[204:207], v4, s[28:31], s36 offen offset:3072
    v_mfma_f32_16x16x32_bf16 v[44:47], v[172:175], a[188:191], v[44:47]
    s_waitcnt vmcnt(18)
    s_mov_b64 exec, 1
    v_mov_b32 v176, 0
    v_mov_b32 v177, 0
    v_mov_b32 v178, 0
    v_mov_b32 v179, 0
    s_mov_b64 exec, -1
    s_waitcnt lgkmcnt(5)
    v_mfma_f32_16x16x32_bf16 v[20:23], v[112:115], a[56:59], v[20:23]
    ds_write_b128 v5, v[180:183] offset:0
    s_waitcnt lgkmcnt(5)
    v_mfma_f32_16x16x32_bf16 v[36:39], v[116:119], a[56:59], v[36:39]
    ds_write_b128 v5, v[178:181] offset:16640
    v_mfma_f32_16x16x32_bf16 v[24:27], v[112:115], a[120:123], v[24:27]
    ds_read_b128 v[128:131], v6 offset:1216
    v_mfma_f32_16x16x32_bf16 v[40:43], v[116:119], a[120:123], v[40:43]
    ds_read_b128 v[132:135], v6 offset:1248
    v_mfma_f32_16x16x32_bf16 v[28:31], v[112:115], a[184:187], v[28:31]
    v_mov_b32 v208, v177
    v_mov_b32 v209, v178
    v_mfma_f32_16x16x32_bf16 v[44:47], v[116:119], a[184:187], v[44:47]
    v_mov_b32 v210, v179
    v_mov_b32 v211, v180
    s_waitcnt lgkmcnt(5)
    v_mfma_f32_16x16x32_bf16 v[20:23], v[120:123], a[52:55], v[20:23]
    ds_write_b128 v5, v[208:211] offset:24960
    s_waitcnt lgkmcnt(5)
    v_mfma_f32_16x16x32_bf16 v[36:39], v[124:127], a[52:55], v[36:39]
    v_mov_b32 v212, v181
    v_mov_b32 v213, v182
    v_mfma_f32_16x16x32_bf16 v[24:27], v[120:123], a[116:119], v[24:27]
    ds_read_b128 v[136:139], v6 offset:1280
    v_mfma_f32_16x16x32_bf16 v[40:43], v[124:127], a[116:119], v[40:43]
    ds_read_b128 v[140:143], v6 offset:1312
    v_mfma_f32_16x16x32_bf16 v[28:31], v[120:123], a[180:183], v[28:31]
    ds_write_b128 v5, v[210:213] offset:8320
    v_mfma_f32_16x16x32_bf16 v[44:47], v[124:127], a[180:183], v[44:47]
    v_alignbit_b32 v214, v177, v176, 16
    v_alignbit_b32 v215, v178, v177, 16
    s_waitcnt lgkmcnt(5)
    v_mfma_f32_16x16x32_bf16 v[20:23], v[128:131], a[48:51], v[20:23]
    v_alignbit_b32 v216, v179, v178, 16
    v_alignbit_b32 v217, v180, v179, 16
    s_waitcnt lgkmcnt(4)
    v_mfma_f32_16x16x32_bf16 v[36:39], v[132:135], a[48:51], v[36:39]
    ds_write_b128 v5, v[214:217] offset:29120
    v_mfma_f32_16x16x32_bf16 v[24:27], v[128:131], a[112:115], v[24:27]
    ds_read_b128 v[144:147], v6 offset:1344
    v_mfma_f32_16x16x32_bf16 v[40:43], v[132:135], a[112:115], v[40:43]
    ds_read_b128 v[148:151], v6 offset:1376
    v_mfma_f32_16x16x32_bf16 v[28:31], v[128:131], a[176:179], v[28:31]
    v_alignbit_b32 v218, v181, v180, 16
    v_alignbit_b32 v219, v182, v181, 16
    v_mfma_f32_16x16x32_bf16 v[44:47], v[132:135], a[176:179], v[44:47]
    ds_write_b128 v5, v[216:219] offset:12480
    s_waitcnt lgkmcnt(6)
    v_mfma_f32_16x16x32_bf16 v[20:23], v[136:139], a[44:47], v[20:23]
    v_alignbit_b32 v220, v178, v177, 16
    v_alignbit_b32 v221, v179, v178, 16
    s_waitcnt lgkmcnt(5)
    v_mfma_f32_16x16x32_bf16 v[36:39], v[140:143], a[44:47], v[36:39]
    v_alignbit_b32 v222, v180, v179, 16
    v_alignbit_b32 v223, v181, v180, 16
    v_mfma_f32_16x16x32_bf16 v[24:27], v[136:139], a[108:111], v[24:27]
    ds_read_b128 v[152:155], v6 offset:1408
    v_mfma_f32_16x16x32_bf16 v[40:43], v[140:143], a[108:111], v[40:43]
    ds_read_b128 v[156:159], v6 offset:1440
    v_mfma_f32_16x16x32_bf16 v[28:31], v[136:139], a[172:175], v[28:31]
    ds_write_b128 v5, v[220:223] offset:20800
    v_mfma_f32_16x16x32_bf16 v[44:47], v[140:143], a[172:175], v[44:47]
    v_alignbit_b32 v224, v182, v181, 16
    v_alignbit_b32 v225, v183, v182, 16
    s_waitcnt lgkmcnt(5)
    v_mfma_f32_16x16x32_bf16 v[20:23], v[144:147], a[40:43], v[20:23]
    ds_write_b128 v5, v[222:225] offset:4160
    s_waitcnt lgkmcnt(5)
    v_mfma_f32_16x16x32_bf16 v[36:39], v[148:151], a[40:43], v[36:39]
    buffer_load_dwordx4 v[176:179], v230, s[28:31], s37 offen offset:0
    v_mfma_f32_16x16x32_bf16 v[24:27], v[144:147], a[104:107], v[24:27]
    ds_read_b128 v[160:163], v6 offset:1472
    v_mfma_f32_16x16x32_bf16 v[40:43], v[148:151], a[104:107], v[40:43]
    ds_read_b128 v[164:167], v6 offset:1504
    v_mfma_f32_16x16x32_bf16 v[28:31], v[144:147], a[168:171], v[28:31]
    buffer_load_dwordx4 v[180:183], v4, s[28:31], s37 offen offset:0
    v_mfma_f32_16x16x32_bf16 v[44:47], v[148:151], a[168:171], v[44:47]
    s_add_u32 m0, s35, 0
    s_waitcnt lgkmcnt(5)
    v_mfma_f32_16x16x32_bf16 v[20:23], v[152:155], a[36:39], v[20:23]
    buffer_load_dwordx4 v4, s[8:11], s39 offen offset:0 lds
    s_waitcnt lgkmcnt(4)
    v_mfma_f32_16x16x32_bf16 v[36:39], v[156:159], a[36:39], v[36:39]
    s_add_u32 m0, s35, 256
    v_mfma_f32_16x16x32_bf16 v[24:27], v[152:155], a[100:103], v[24:27]
    ds_read_b128 v[168:171], v6 offset:1536
    v_mfma_f32_16x16x32_bf16 v[40:43], v[156:159], a[100:103], v[40:43]
    ds_read_b128 v[172:175], v6 offset:1568
    v_mfma_f32_16x16x32_bf16 v[28:31], v[152:155], a[164:167], v[28:31]
    buffer_load_dwordx4 v4, s[8:11], s39 offen offset:1024 lds
    v_mfma_f32_16x16x32_bf16 v[44:47], v[156:159], a[164:167], v[44:47]
    s_add_u32 m0, s35, 512
    s_waitcnt lgkmcnt(3)
    v_mfma_f32_16x16x32_bf16 v[20:23], v[160:163], a[32:35], v[20:23]
    buffer_load_dwordx4 v4, s[8:11], s39 offen offset:2048 lds
    s_waitcnt lgkmcnt(2)
    v_mfma_f32_16x16x32_bf16 v[36:39], v[164:167], a[32:35], v[36:39]
    s_add_u32 m0, s35, 768
    v_mfma_f32_16x16x32_bf16 v[24:27], v[160:163], a[96:99], v[24:27]
    ds_read_b128 v[112:115], v6 offset:1600
    v_mfma_f32_16x16x32_bf16 v[40:43], v[164:167], a[96:99], v[40:43]
    ds_read_b128 v[116:119], v6 offset:1632
    v_mfma_f32_16x16x32_bf16 v[28:31], v[160:163], a[160:163], v[28:31]
    buffer_load_dwordx4 v4, s[8:11], s39 offen offset:3072 lds
    v_mfma_f32_16x16x32_bf16 v[44:47], v[164:167], a[160:163], v[44:47]
    s_waitcnt lgkmcnt(3)
    v_mfma_f32_16x16x32_bf16 v[20:23], v[168:171], a[28:31], v[20:23]
    s_waitcnt lgkmcnt(2)
    v_mfma_f32_16x16x32_bf16 v[36:39], v[172:175], a[28:31], v[36:39]
    v_mfma_f32_16x16x32_bf16 v[24:27], v[168:171], a[92:95], v[24:27]
    ds_read_b128 v[120:123], v6 offset:1664
    v_mfma_f32_16x16x32_bf16 v[40:43], v[172:175], a[92:95], v[40:43]
    ds_read_b128 v[124:127], v6 offset:1696
    v_mfma_f32_16x16x32_bf16 v[28:31], v[168:171], a[156:159], v[28:31]
    v_mfma_f32_16x16x32_bf16 v[44:47], v[172:175], a[156:159], v[44:47]
    s_waitcnt lgkmcnt(3)
    v_mfma_f32_16x16x32_bf16 v[20:23], v[112:115], a[24:27], v[20:23]
    s_waitcnt lgkmcnt(2)
    v_mfma_f32_16x16x32_bf16 v[36:39], v[116:119], a[24:27], v[36:39]
    v_mfma_f32_16x16x32_bf16 v[24:27], v[112:115], a[88:91], v[24:27]
    ds_read_b128 v[128:131], v6 offset:1728
    v_mfma_f32_16x16x32_bf16 v[40:43], v[116:119], a[88:91], v[40:43]
    ds_read_b128 v[132:135], v6 offset:1760
    v_mfma_f32_16x16x32_bf16 v[28:31], v[112:115], a[152:155], v[28:31]
    v_mfma_f32_16x16x32_bf16 v[44:47], v[116:119], a[152:155], v[44:47]
    s_waitcnt lgkmcnt(3)
    v_mfma_f32_16x16x32_bf16 v[20:23], v[120:123], a[20:23], v[20:23]
    s_waitcnt lgkmcnt(2)
    v_mfma_f32_16x16x32_bf16 v[36:39], v[124:127], a[20:23], v[36:39]
    v_mfma_f32_16x16x32_bf16 v[24:27], v[120:123], a[84:87], v[24:27]
    ds_read_b128 v[136:139], v6 offset:1792
    v_mfma_f32_16x16x32_bf16 v[40:43], v[124:127], a[84:87], v[40:43]
    ds_read_b128 v[140:143], v6 offset:1824
    v_mfma_f32_16x16x32_bf16 v[28:31], v[120:123], a[148:151], v[28:31]
    v_mfma_f32_16x16x32_bf16 v[44:47], v[124:127], a[148:151], v[44:47]
    s_waitcnt lgkmcnt(3)
    v_mfma_f32_16x16x32_bf16 v[20:23], v[128:131], a[16:19], v[20:23]
    s_waitcnt lgkmcnt(2)
    v_mfma_f32_16x16x32_bf16 v[36:39], v[132:135], a[16:19], v[36:39]
    v_mfma_f32_16x16x32_bf16 v[24:27], v[128:131], a[80:83], v[24:27]
    ds_read_b128 v[144:147], v6 offset:1856
    v_mfma_f32_16x16x32_bf16 v[40:43], v[132:135], a[80:83], v[40:43]
    ds_read_b128 v[148:151], v6 offset:1888
    v_mfma_f32_16x16x32_bf16 v[28:31], v[128:131], a[144:147], v[28:31]
    v_mfma_f32_16x16x32_bf16 v[44:47], v[132:135], a[144:147], v[44:47]
    s_waitcnt lgkmcnt(3)
    v_mfma_f32_16x16x32_bf16 v[20:23], v[136:139], a[12:15], v[20:23]
    s_waitcnt lgkmcnt(2)
    v_mfma_f32_16x16x32_bf16 v[36:39], v[140:143], a[12:15], v[36:39]
    v_mfma_f32_16x16x32_bf16 v[24:27], v[136:139], a[76:79], v[24:27]
    ds_read_b128 v[152:155], v6 offset:1920
    v_mfma_f32_16x16x32_bf16 v[40:43], v[140:143], a[76:79], v[40:43]
    ds_read_b128 v[156:159], v6 offset:1952
    v_mfma_f32_16x16x32_bf16 v[28:31], v[136:139], a[140:143], v[28:31]
    v_mfma_f32_16x16x32_bf16 v[44:47], v[140:143], a[140:143], v[44:47]
    s_waitcnt lgkmcnt(3)
    v_mfma_f32_16x16x32_bf16 v[20:23], v[144:147], a[8:11], v[20:23]
    s_waitcnt lgkmcnt(2)
    v_mfma_f32_16x16x32_bf16 v[36:39], v[148:151], a[8:11], v[36:39]
    v_mfma_f32_16x16x32_bf16 v[24:27], v[144:147], a[72:75], v[24:27]
    ds_read_b128 v[160:163], v6 offset:1984
    v_mfma_f32_16x16x32_bf16 v[40:43], v[148:151], a[72:75], v[40:43]
    ds_read_b128 v[164:167], v6 offset:2016
    v_mfma_f32_16x16x32_bf16 v[28:31], v[144:147], a[136:139], v[28:31]
    v_mfma_f32_16x16x32_bf16 v[44:47], v[148:151], a[136:139], v[44:47]
    s_waitcnt lgkmcnt(3)
    v_mfma_f32_16x16x32_bf16 v[20:23], v[152:155], a[4:7], v[20:23]
    s_waitcnt lgkmcnt(2)
    v_mfma_f32_16x16x32_bf16 v[36:39], v[156:159], a[4:7], v[36:39]
    v_mfma_f32_16x16x32_bf16 v[24:27], v[152:155], a[68:71], v[24:27]
    ds_read_b128 v[168:171], v6 offset:2048
    v_mfma_f32_16x16x32_bf16 v[40:43], v[156:159], a[68:71], v[40:43]
    ds_read_b128 v[172:175], v6 offset:2080
    v_mfma_f32_16x16x32_bf16 v[28:31], v[152:155], a[132:135], v[28:31]
    s_waitcnt vmcnt(18)
    v_mfma_f32_16x16x32_bf16 v[44:47], v[156:159], a[132:135], v[44:47]
    ds_write_b128 v5, v[188:191] offset:1024
    s_waitcnt lgkmcnt(4)
    v_mfma_f32_16x16x32_bf16 v[20:23], v[160:163], a[0:3], v[20:23]
    ds_read_b128 v[112:115], v6 offset:2112
    s_waitcnt lgkmcnt(4)
    v_mfma_f32_16x16x32_bf16 v[36:39], v[164:167], a[0:3], v[36:39]
    ds_read_b128 v[116:119], v6 offset:2144
    v_mfma_f32_16x16x32_bf16 v[24:27], v[160:163], a[64:67], v[24:27]
    ds_write_b128 v5, v[186:189] offset:17664
    v_mfma_f32_16x16x32_bf16 v[40:43], v[164:167], a[64:67], v[40:43]
    v_mov_b32 v208, v185
    v_mov_b32 v209, v186
    v_mfma_f32_16x16x32_bf16 v[28:31], v[160:163], a[128:131], v[28:31]
    ds_read_b128 v[120:123], v6 offset:2176
    v_mfma_f32_16x16x32_bf16 v[44:47], v[164:167], a[128:131], v[44:47]
    ds_read_b128 v[124:127], v6 offset:2208
    s_waitcnt lgkmcnt(7)
    v_mfma_f32_16x16x32_bf16 v[24:27], v[168:171], a[60:63], v[24:27]
    v_mov_b32 v210, v187
    v_mov_b32 v211, v188
    s_waitcnt lgkmcnt(6)
    v_mfma_f32_16x16x32_bf16 v[40:43], v[172:175], a[60:63], v[40:43]
    ds_write_b128 v5, v[208:211] offset:25984
    v_mfma_f32_16x16x32_bf16 v[28:31], v[168:171], a[124:127], v[28:31]
    ds_read_b128 v[128:131], v6 offset:2240
    v_mfma_f32_16x16x32_bf16 v[44:47], v[172:175], a[124:127], v[44:47]
    ds_read_b128 v[132:135], v6 offset:2272
    s_waitcnt lgkmcnt(7)
    v_mfma_f32_16x16x32_bf16 v[24:27], v[112:115], a[56:59], v[24:27]
    v_mov_b32 v212, v189
    v_mov_b32 v213, v190
    s_waitcnt lgkmcnt(6)
    v_mfma_f32_16x16x32_bf16 v[40:43], v[116:119], a[56:59], v[40:43]
    ds_write_b128 v5, v[210:213] offset:9344
    v_mfma_f32_16x16x32_bf16 v[28:31], v[112:115], a[120:123], v[28:31]
    ds_read_b128 v[136:139], v6 offset:2304
    v_mfma_f32_16x16x32_bf16 v[44:47], v[116:119], a[120:123], v[44:47]
    ds_read_b128 v[140:143], v6 offset:2336
    s_waitcnt lgkmcnt(7)
    v_mfma_f32_16x16x32_bf16 v[24:27], v[120:123], a[52:55], v[24:27]
    v_alignbit_b32 v214, v185, v184, 16
    v_alignbit_b32 v215, v186, v185, 16
    s_waitcnt lgkmcnt(6)
    v_mfma_f32_16x16x32_bf16 v[40:43], v[124:127], a[52:55], v[40:43]
    v_alignbit_b32 v216, v187, v186, 16
    v_alignbit_b32 v217, v188, v187, 16
    v_mfma_f32_16x16x32_bf16 v[28:31], v[120:123], a[116:119], v[28:31]
    ds_read_b128 v[144:147], v6 offset:2368
    v_mfma_f32_16x16x32_bf16 v[44:47], v[124:127], a[116:119], v[44:47]
    ds_read_b128 v[148:151], v6 offset:2400
    s_waitcnt lgkmcnt(6)
    v_mfma_f32_16x16x32_bf16 v[24:27], v[128:131], a[48:51], v[24:27]
    ds_write_b128 v5, v[214:217] offset:30144
    s_waitcnt lgkmcnt(6)
    v_mfma_f32_16x16x32_bf16 v[40:43], v[132:135], a[48:51], v[40:43]
    v_alignbit_b32 v218, v189, v188, 16
    v_alignbit_b32 v219, v190, v189, 16
    v_mfma_f32_16x16x32_bf16 v[28:31], v[128:131], a[112:115], v[28:31]
    ds_read_b128 v[152:155], v6 offset:2432
    v_mfma_f32_16x16x32_bf16 v[44:47], v[132:135], a[112:115], v[44:47]
    ds_read_b128 v[156:159], v6 offset:2464
    s_waitcnt lgkmcnt(6)
    v_mfma_f32_16x16x32_bf16 v[24:27], v[136:139], a[44:47], v[24:27]
    ds_write_b128 v5, v[216:219] offset:13504
    s_waitcnt lgkmcnt(6)
    v_mfma_f32_16x16x32_bf16 v[40:43], v[140:143], a[44:47], v[40:43]
    v_alignbit_b32 v220, v186, v185, 16
    v_alignbit_b32 v221, v187, v186, 16
    v_mfma_f32_16x16x32_bf16 v[28:31], v[136:139], a[108:111], v[28:31]
    ds_read_b128 v[160:163], v6 offset:2496
    v_mfma_f32_16x16x32_bf16 v[44:47], v[140:143], a[108:111], v[44:47]
    ds_read_b128 v[164:167], v6 offset:2528
    s_waitcnt lgkmcnt(7)
    v_mfma_f32_16x16x32_bf16 v[24:27], v[144:147], a[40:43], v[24:27]
    v_alignbit_b32 v222, v188, v187, 16
    v_alignbit_b32 v223, v189, v188, 16
    s_waitcnt lgkmcnt(6)
    v_mfma_f32_16x16x32_bf16 v[40:43], v[148:151], a[40:43], v[40:43]
    ds_write_b128 v5, v[220:223] offset:21824
    v_mfma_f32_16x16x32_bf16 v[28:31], v[144:147], a[104:107], v[28:31]
    ds_read_b128 v[168:171], v6 offset:2560
    v_mfma_f32_16x16x32_bf16 v[44:47], v[148:151], a[104:107], v[44:47]
    ds_read_b128 v[172:175], v6 offset:2592
    s_waitcnt lgkmcnt(7)
    v_mfma_f32_16x16x32_bf16 v[24:27], v[152:155], a[36:39], v[24:27]
    v_alignbit_b32 v224, v190, v189, 16
    v_alignbit_b32 v225, v191, v190, 16
    s_waitcnt lgkmcnt(6)
    v_mfma_f32_16x16x32_bf16 v[40:43], v[156:159], a[36:39], v[40:43]
    ds_write_b128 v5, v[222:225] offset:5184
    v_mfma_f32_16x16x32_bf16 v[28:31], v[152:155], a[100:103], v[28:31]
    ds_read_b128 v[112:115], v6 offset:2624
    v_mfma_f32_16x16x32_bf16 v[44:47], v[156:159], a[100:103], v[44:47]
    ds_read_b128 v[116:119], v6 offset:2656
    s_waitcnt lgkmcnt(7)
    v_mfma_f32_16x16x32_bf16 v[24:27], v[160:163], a[32:35], v[24:27]
    buffer_load_dwordx4 v[184:187], v4, s[28:31], s37 offen offset:1008
    s_waitcnt lgkmcnt(6)
    v_mfma_f32_16x16x32_bf16 v[40:43], v[164:167], a[32:35], v[40:43]
    buffer_load_dwordx4 v[188:191], v4, s[28:31], s37 offen offset:1024
    v_mfma_f32_16x16x32_bf16 v[28:31], v[160:163], a[96:99], v[28:31]
    ds_read_b128 v[120:123], v6 offset:2688
    v_mfma_f32_16x16x32_bf16 v[44:47], v[164:167], a[96:99], v[44:47]
    ds_read_b128 v[124:127], v6 offset:2720
    s_waitcnt lgkmcnt(6)
    v_mfma_f32_16x16x32_bf16 v[24:27], v[168:171], a[28:31], v[24:27]
    s_mov_b32 s36, s37
    s_add_u32 s39, s37, 125829120
    s_add_u32 s37, s37, 4096
    s_min_u32 s37, s37, s33

    s_pack_hh_b32_b16 s40, s64, s64
    v_and_b32 v236, s40, v8
    s_waitcnt lgkmcnt(5)
    v_mfma_f32_16x16x32_bf16 v[40:43], v[172:175], a[28:31], v[40:43]
    v_and_b32 v237, s40, v9
    v_and_b32 v238, s40, v10
    v_mfma_f32_16x16x32_bf16 v[28:31], v[168:171], a[92:95], v[28:31]
    ds_read_b128 v[128:131], v6 offset:2752
    v_mfma_f32_16x16x32_bf16 v[44:47], v[172:175], a[92:95], v[44:47]
    ds_read_b128 v[132:135], v6 offset:2784
    s_waitcnt lgkmcnt(5)
    v_mfma_f32_16x16x32_bf16 v[24:27], v[112:115], a[24:27], v[24:27]
    v_and_b32 v239, s40, v11
    v_and_b32 v240, s40, v12
    s_waitcnt lgkmcnt(4)
    v_mfma_f32_16x16x32_bf16 v[40:43], v[116:119], a[24:27], v[40:43]
    v_and_b32 v241, s40, v13
    v_and_b32 v242, s40, v14
    v_mfma_f32_16x16x32_bf16 v[28:31], v[112:115], a[88:91], v[28:31]
    ds_read_b128 v[136:139], v6 offset:2816
    v_mfma_f32_16x16x32_bf16 v[44:47], v[116:119], a[88:91], v[44:47]
    ds_read_b128 v[140:143], v6 offset:2848
    s_waitcnt lgkmcnt(5)
    v_mfma_f32_16x16x32_bf16 v[24:27], v[120:123], a[20:23], v[24:27]
    v_and_b32 v243, s40, v15
    s_waitcnt lgkmcnt(4)
    v_mfma_f32_16x16x32_bf16 v[40:43], v[124:127], a[20:23], v[40:43]
    v_mfma_f32_16x16x32_bf16 v[28:31], v[120:123], a[84:87], v[28:31]
    ds_read_b128 v[144:147], v6 offset:2880
    v_mfma_f32_16x16x32_bf16 v[44:47], v[124:127], a[84:87], v[44:47]
    ds_read_b128 v[148:151], v6 offset:2912
    s_waitcnt lgkmcnt(5)
    v_mfma_f32_16x16x32_bf16 v[24:27], v[128:131], a[16:19], v[24:27]
    s_waitcnt lgkmcnt(4)
    v_mfma_f32_16x16x32_bf16 v[40:43], v[132:135], a[16:19], v[40:43]
    v_mfma_f32_16x16x32_bf16 v[28:31], v[128:131], a[80:83], v[28:31]
    ds_read_b128 v[152:155], v6 offset:2944
    v_mfma_f32_16x16x32_bf16 v[44:47], v[132:135], a[80:83], v[44:47]
    ds_read_b128 v[156:159], v6 offset:2976
    s_waitcnt lgkmcnt(5)
    v_mfma_f32_16x16x32_bf16 v[24:27], v[136:139], a[12:15], v[24:27]
    s_waitcnt lgkmcnt(4)
    v_mfma_f32_16x16x32_bf16 v[40:43], v[140:143], a[12:15], v[40:43]
    v_mfma_f32_16x16x32_bf16 v[28:31], v[136:139], a[76:79], v[28:31]
    ds_read_b128 v[160:163], v6 offset:3008
    v_mfma_f32_16x16x32_bf16 v[44:47], v[140:143], a[76:79], v[44:47]
    ds_read_b128 v[164:167], v6 offset:3040
    s_waitcnt lgkmcnt(5)
    v_mfma_f32_16x16x32_bf16 v[24:27], v[144:147], a[8:11], v[24:27]
    s_waitcnt lgkmcnt(4)
    v_mfma_f32_16x16x32_bf16 v[40:43], v[148:151], a[8:11], v[40:43]
    v_mfma_f32_16x16x32_bf16 v[28:31], v[144:147], a[72:75], v[28:31]
    ds_read_b128 v[168:171], v6 offset:3072
    v_mfma_f32_16x16x32_bf16 v[44:47], v[148:151], a[72:75], v[44:47]
    ds_read_b128 v[172:175], v6 offset:3104
    s_waitcnt lgkmcnt(5)
    v_mfma_f32_16x16x32_bf16 v[24:27], v[152:155], a[4:7], v[24:27]
    ds_read_b128 v[112:115], v6 offset:3136
    s_waitcnt lgkmcnt(5)
    v_mfma_f32_16x16x32_bf16 v[40:43], v[156:159], a[4:7], v[40:43]
    ds_read_b128 v[116:119], v6 offset:3168
    v_mfma_f32_16x16x32_bf16 v[28:31], v[152:155], a[68:71], v[28:31]
    ds_read_b128 v[120:123], v6 offset:3200
    v_mfma_f32_16x16x32_bf16 v[44:47], v[156:159], a[68:71], v[44:47]
    ds_read_b128 v[124:127], v6 offset:3232
    s_waitcnt lgkmcnt(7)
    v_mfma_f32_16x16x32_bf16 v[24:27], v[160:163], a[0:3], v[24:27]
    ds_read_b128 v[128:131], v6 offset:3264
    s_waitcnt lgkmcnt(7)
    v_mfma_f32_16x16x32_bf16 v[40:43], v[164:167], a[0:3], v[40:43]
    ds_read_b128 v[132:135], v6 offset:3296
    v_mfma_f32_16x16x32_bf16 v[28:31], v[160:163], a[64:67], v[28:31]
    ds_read_b128 v[136:139], v6 offset:3328
    v_mfma_f32_16x16x32_bf16 v[44:47], v[164:167], a[64:67], v[44:47]
    ds_read_b128 v[140:143], v6 offset:3360
    s_waitcnt lgkmcnt(9)
    v_mfma_f32_16x16x32_bf16 v[28:31], v[168:171], a[60:63], v[28:31]
    ds_read_b128 v[144:147], v6 offset:3392
    s_waitcnt lgkmcnt(9)
    v_mfma_f32_16x16x32_bf16 v[44:47], v[172:175], a[60:63], v[44:47]
    ds_read_b128 v[148:151], v6 offset:3424
    s_waitcnt lgkmcnt(9)
    v_mfma_f32_16x16x32_bf16 v[28:31], v[112:115], a[56:59], v[28:31]
    ds_read_b128 v[152:155], v6 offset:3456
    s_waitcnt lgkmcnt(9)
    v_mfma_f32_16x16x32_bf16 v[44:47], v[116:119], a[56:59], v[44:47]
    ds_read_b128 v[156:159], v6 offset:3488
    s_waitcnt lgkmcnt(9)
    v_mfma_f32_16x16x32_bf16 v[28:31], v[120:123], a[52:55], v[28:31]
    ds_read_b128 v[160:163], v6 offset:3520
    s_waitcnt lgkmcnt(9)
    v_mfma_f32_16x16x32_bf16 v[44:47], v[124:127], a[52:55], v[44:47]
    ds_read_b128 v[164:167], v6 offset:3552
    s_waitcnt lgkmcnt(9)
    v_mfma_f32_16x16x32_bf16 v[28:31], v[128:131], a[48:51], v[28:31]
    ds_read_b128 v[168:171], v6 offset:3584
    s_waitcnt lgkmcnt(9)
    v_mfma_f32_16x16x32_bf16 v[44:47], v[132:135], a[48:51], v[44:47]
    ds_read_b128 v[172:175], v6 offset:3616
    s_waitcnt lgkmcnt(9)
    v_mfma_f32_16x16x32_bf16 v[28:31], v[136:139], a[44:47], v[28:31]
    ds_read_b128 v[112:115], v6 offset:3648
    s_waitcnt lgkmcnt(9)
    v_mfma_f32_16x16x32_bf16 v[44:47], v[140:143], a[44:47], v[44:47]
    ds_read_b128 v[116:119], v6 offset:3680
    s_waitcnt lgkmcnt(9)
    v_mfma_f32_16x16x32_bf16 v[28:31], v[144:147], a[40:43], v[28:31]
    ds_read_b128 v[120:123], v6 offset:3712
    s_waitcnt lgkmcnt(9)
    v_mfma_f32_16x16x32_bf16 v[44:47], v[148:151], a[40:43], v[44:47]
    ds_read_b128 v[124:127], v6 offset:3744
    s_waitcnt lgkmcnt(9)
    v_mfma_f32_16x16x32_bf16 v[28:31], v[152:155], a[36:39], v[28:31]
    ds_read_b128 v[128:131], v6 offset:3776
    s_waitcnt lgkmcnt(9)
    v_mfma_f32_16x16x32_bf16 v[44:47], v[156:159], a[36:39], v[44:47]
    ds_read_b128 v[132:135], v6 offset:3808
    s_waitcnt lgkmcnt(9)
    v_mfma_f32_16x16x32_bf16 v[28:31], v[160:163], a[32:35], v[28:31]
    ds_read_b128 v[136:139], v6 offset:3840
    s_waitcnt lgkmcnt(9)
    v_mfma_f32_16x16x32_bf16 v[44:47], v[164:167], a[32:35], v[44:47]
    ds_read_b128 v[140:143], v6 offset:3872
    s_waitcnt lgkmcnt(9)
    v_mfma_f32_16x16x32_bf16 v[28:31], v[168:171], a[28:31], v[28:31]
    ds_read_b128 v[144:147], v6 offset:3904
    s_waitcnt lgkmcnt(9)
    v_mfma_f32_16x16x32_bf16 v[44:47], v[172:175], a[28:31], v[44:47]
    ds_read_b128 v[148:151], v6 offset:3936
    s_waitcnt lgkmcnt(9)
    v_mfma_f32_16x16x32_bf16 v[28:31], v[112:115], a[24:27], v[28:31]
    ds_read_b128 v[152:155], v6 offset:3968
    s_waitcnt lgkmcnt(9)
    v_mfma_f32_16x16x32_bf16 v[44:47], v[116:119], a[24:27], v[44:47]
    ds_read_b128 v[156:159], v6 offset:4000
    s_waitcnt lgkmcnt(9)
    v_mfma_f32_16x16x32_bf16 v[28:31], v[120:123], a[20:23], v[28:31]
    ds_read_b128 v[160:163], v6 offset:4032
    s_waitcnt lgkmcnt(9)
    v_mfma_f32_16x16x32_bf16 v[44:47], v[124:127], a[20:23], v[44:47]
    ds_read_b128 v[164:167], v6 offset:4064
    s_waitcnt lgkmcnt(9)
    v_mfma_f32_16x16x32_bf16 v[28:31], v[128:131], a[16:19], v[28:31]
    s_waitcnt vmcnt(2)
    ds_read_b128 a[60:63], v7 offset:240
    s_waitcnt lgkmcnt(9)
    v_mfma_f32_16x16x32_bf16 v[44:47], v[132:135], a[16:19], v[44:47]
    s_waitcnt lgkmcnt(8)
    v_mfma_f32_16x16x32_bf16 v[28:31], v[136:139], a[12:15], v[28:31]
    ds_read_b128 a[124:127], v7 offset:496
    s_waitcnt lgkmcnt(8)
    v_mfma_f32_16x16x32_bf16 v[44:47], v[140:143], a[12:15], v[44:47]
    s_waitcnt lgkmcnt(7)
    v_mfma_f32_16x16x32_bf16 v[28:31], v[144:147], a[8:11], v[28:31]
    ds_read_b128 a[188:191], v7 offset:752
    s_waitcnt lgkmcnt(7)
    v_mfma_f32_16x16x32_bf16 v[44:47], v[148:151], a[8:11], v[44:47]
    s_waitcnt lgkmcnt(6)
    v_mfma_f32_16x16x32_bf16 v[28:31], v[152:155], a[4:7], v[28:31]
    ds_read_b128 a[252:255], v7 offset:1008
    s_waitcnt lgkmcnt(6)
    v_mfma_f32_16x16x32_bf16 v[44:47], v[156:159], a[4:7], v[44:47]
    s_waitcnt lgkmcnt(5)
    v_mfma_f32_16x16x32_bf16 v[28:31], v[160:163], a[0:3], v[28:31]
    ds_read_b128 v[168:171], v6 offset:0
    s_waitcnt lgkmcnt(5)
    v_mfma_f32_16x16x32_bf16 v[44:47], v[164:167], a[0:3], v[44:47]
    ds_read_b128 v[172:175], v6 offset:32
    s_waitcnt lgkmcnt(5)
    v_mfma_f32_16x16x32_bf16 v[48:51], v[236:239], a[60:63], 0
    v_mfma_f32_16x16x32_bf16 v[64:67], v[240:243], a[60:63], 0
    s_waitcnt lgkmcnt(4)
    v_mfma_f32_16x16x32_bf16 v[52:55], v[236:239], a[124:127], 0
    v_mfma_f32_16x16x32_bf16 v[68:71], v[240:243], a[124:127], 0
    s_waitcnt lgkmcnt(3)
    v_mfma_f32_16x16x32_bf16 v[56:59], v[236:239], a[188:191], 0
    v_mfma_f32_16x16x32_bf16 v[72:75], v[240:243], a[188:191], 0
    ds_read_b128 a[56:59], v7 offset:224
    s_waitcnt lgkmcnt(3)
    v_mfma_f32_16x16x32_bf16 v[60:63], v[236:239], a[252:255], 0
    ds_read_b128 v[112:115], v6 offset:64
    v_mfma_f32_16x16x32_bf16 v[76:79], v[240:243], a[252:255], 0
    ds_read_b128 v[116:119], v6 offset:96
    s_waitcnt lgkmcnt(4)
    v_mfma_f32_16x16x32_bf16 v[48:51], v[168:171], a[60:63], v[48:51]
    ds_read_b128 a[120:123], v7 offset:480
    s_waitcnt lgkmcnt(4)
    v_mfma_f32_16x16x32_bf16 v[64:67], v[172:175], a[60:63], v[64:67]
    s_waitcnt vmcnt(10)
    v_mfma_f32_16x16x32_bf16 v[52:55], v[168:171], a[124:127], v[52:55]
    ds_read_b128 a[184:187], v7 offset:736
    v_mfma_f32_16x16x32_bf16 v[68:71], v[172:175], a[124:127], v[68:71]
    ds_write_b128 v5, v[196:199] offset:2048
    v_mfma_f32_16x16x32_bf16 v[56:59], v[168:171], a[188:191], v[56:59]
    ds_read_b128 a[248:251], v7 offset:992
    v_mfma_f32_16x16x32_bf16 v[72:75], v[172:175], a[188:191], v[72:75]
    ds_read_b128 a[52:55], v7 offset:208
    v_mfma_f32_16x16x32_bf16 v[60:63], v[168:171], a[252:255], v[60:63]
    ds_read_b128 v[120:123], v6 offset:128
    v_mfma_f32_16x16x32_bf16 v[76:79], v[172:175], a[252:255], v[76:79]
    ds_read_b128 v[124:127], v6 offset:160
    s_waitcnt lgkmcnt(8)
    v_mfma_f32_16x16x32_bf16 v[48:51], v[112:115], a[56:59], v[48:51]
    ds_read_b128 a[116:119], v7 offset:464
    s_waitcnt lgkmcnt(8)
    v_mfma_f32_16x16x32_bf16 v[64:67], v[116:119], a[56:59], v[64:67]
    ds_write_b128 v5, v[194:197] offset:18688
    s_waitcnt lgkmcnt(8)
    v_mfma_f32_16x16x32_bf16 v[52:55], v[112:115], a[120:123], v[52:55]
    ds_read_b128 a[180:183], v7 offset:720
    v_mfma_f32_16x16x32_bf16 v[68:71], v[116:119], a[120:123], v[68:71]
    v_mov_b32 v208, v193
    v_mov_b32 v209, v194
    s_waitcnt lgkmcnt(8)
    v_mfma_f32_16x16x32_bf16 v[56:59], v[112:115], a[184:187], v[56:59]
    ds_read_b128 a[244:247], v7 offset:976
    v_mfma_f32_16x16x32_bf16 v[72:75], v[116:119], a[184:187], v[72:75]
    ds_read_b128 a[48:51], v7 offset:192
    s_waitcnt lgkmcnt(8)
    v_mfma_f32_16x16x32_bf16 v[60:63], v[112:115], a[248:251], v[60:63]
    ds_read_b128 v[128:131], v6 offset:192
    v_mfma_f32_16x16x32_bf16 v[76:79], v[116:119], a[248:251], v[76:79]
    ds_read_b128 v[132:135], v6 offset:224
    s_waitcnt lgkmcnt(8)
    v_mfma_f32_16x16x32_bf16 v[48:51], v[120:123], a[52:55], v[48:51]
    ds_read_b128 a[112:115], v7 offset:448
    s_waitcnt lgkmcnt(8)
    v_mfma_f32_16x16x32_bf16 v[64:67], v[124:127], a[52:55], v[64:67]
    v_mov_b32 v210, v195
    v_mov_b32 v211, v196
    s_waitcnt lgkmcnt(7)
    v_mfma_f32_16x16x32_bf16 v[52:55], v[120:123], a[116:119], v[52:55]
    ds_read_b128 a[176:179], v7 offset:704
    v_mfma_f32_16x16x32_bf16 v[68:71], v[124:127], a[116:119], v[68:71]
    ds_write_b128 v5, v[208:211] offset:27008
    s_waitcnt lgkmcnt(7)
    v_mfma_f32_16x16x32_bf16 v[56:59], v[120:123], a[180:183], v[56:59]
    ds_read_b128 a[240:243], v7 offset:960
    v_mfma_f32_16x16x32_bf16 v[72:75], v[124:127], a[180:183], v[72:75]
    ds_read_b128 a[44:47], v7 offset:176
    s_waitcnt lgkmcnt(8)
    v_mfma_f32_16x16x32_bf16 v[60:63], v[120:123], a[244:247], v[60:63]
    ds_read_b128 v[136:139], v6 offset:256
    v_mfma_f32_16x16x32_bf16 v[76:79], v[124:127], a[244:247], v[76:79]
    ds_read_b128 v[140:143], v6 offset:288
    s_waitcnt lgkmcnt(8)
    v_mfma_f32_16x16x32_bf16 v[48:51], v[128:131], a[48:51], v[48:51]
    ds_read_b128 a[108:111], v7 offset:432
    s_waitcnt lgkmcnt(8)
    v_mfma_f32_16x16x32_bf16 v[64:67], v[132:135], a[48:51], v[64:67]
    v_mov_b32 v212, v197
    v_mov_b32 v213, v198
    s_waitcnt lgkmcnt(7)
    v_mfma_f32_16x16x32_bf16 v[52:55], v[128:131], a[112:115], v[52:55]
    ds_read_b128 a[172:175], v7 offset:688
    v_mfma_f32_16x16x32_bf16 v[68:71], v[132:135], a[112:115], v[68:71]
    ds_write_b128 v5, v[210:213] offset:10368
    s_waitcnt lgkmcnt(8)
    v_mfma_f32_16x16x32_bf16 v[56:59], v[128:131], a[176:179], v[56:59]
    ds_read_b128 a[236:239], v7 offset:944
    v_mfma_f32_16x16x32_bf16 v[72:75], v[132:135], a[176:179], v[72:75]
    ds_read_b128 a[40:43], v7 offset:160
    s_waitcnt lgkmcnt(8)
    v_mfma_f32_16x16x32_bf16 v[60:63], v[128:131], a[240:243], v[60:63]
    ds_read_b128 v[144:147], v6 offset:320
    v_mfma_f32_16x16x32_bf16 v[76:79], v[132:135], a[240:243], v[76:79]
    ds_read_b128 v[148:151], v6 offset:352
    s_waitcnt lgkmcnt(8)
    v_mfma_f32_16x16x32_bf16 v[48:51], v[136:139], a[44:47], v[48:51]
    ds_read_b128 a[104:107], v7 offset:416
    s_waitcnt lgkmcnt(8)
    v_mfma_f32_16x16x32_bf16 v[64:67], v[140:143], a[44:47], v[64:67]
    v_alignbit_b32 v214, v193, v192, 16
    v_alignbit_b32 v215, v194, v193, 16
    s_waitcnt lgkmcnt(7)
    v_mfma_f32_16x16x32_bf16 v[52:55], v[136:139], a[108:111], v[52:55]
    ds_read_b128 a[168:171], v7 offset:672
    v_mfma_f32_16x16x32_bf16 v[68:71], v[140:143], a[108:111], v[68:71]
    v_alignbit_b32 v216, v195, v194, 16
    v_alignbit_b32 v217, v196, v195, 16
    s_waitcnt lgkmcnt(7)
    v_mfma_f32_16x16x32_bf16 v[56:59], v[136:139], a[172:175], v[56:59]
    ds_read_b128 a[232:235], v7 offset:928
    v_mfma_f32_16x16x32_bf16 v[72:75], v[140:143], a[172:175], v[72:75]
    ds_read_b128 a[36:39], v7 offset:144
    s_waitcnt lgkmcnt(7)
    v_mfma_f32_16x16x32_bf16 v[60:63], v[136:139], a[236:239], v[60:63]
    ds_read_b128 v[152:155], v6 offset:384
    v_mfma_f32_16x16x32_bf16 v[76:79], v[140:143], a[236:239], v[76:79]
    ds_read_b128 v[156:159], v6 offset:416
    s_waitcnt lgkmcnt(7)
    v_mfma_f32_16x16x32_bf16 v[48:51], v[144:147], a[40:43], v[48:51]
    ds_read_b128 a[100:103], v7 offset:400
    s_waitcnt lgkmcnt(7)
    v_mfma_f32_16x16x32_bf16 v[64:67], v[148:151], a[40:43], v[64:67]
    ds_write_b128 v5, v[214:217] offset:31168
    s_waitcnt lgkmcnt(7)
    v_mfma_f32_16x16x32_bf16 v[52:55], v[144:147], a[104:107], v[52:55]
    ds_read_b128 a[164:167], v7 offset:656
    v_mfma_f32_16x16x32_bf16 v[68:71], v[148:151], a[104:107], v[68:71]
    v_alignbit_b32 v218, v197, v196, 16
    v_alignbit_b32 v219, v198, v197, 16
    s_waitcnt lgkmcnt(7)
    v_mfma_f32_16x16x32_bf16 v[56:59], v[144:147], a[168:171], v[56:59]
    ds_read_b128 a[228:231], v7 offset:912
    v_mfma_f32_16x16x32_bf16 v[72:75], v[148:151], a[168:171], v[72:75]
    ds_read_b128 a[32:35], v7 offset:128
    s_waitcnt lgkmcnt(8)
    v_mfma_f32_16x16x32_bf16 v[60:63], v[144:147], a[232:235], v[60:63]
    ds_read_b128 v[160:163], v6 offset:448
    v_mfma_f32_16x16x32_bf16 v[76:79], v[148:151], a[232:235], v[76:79]
    ds_read_b128 v[164:167], v6 offset:480
    s_waitcnt lgkmcnt(8)
    v_mfma_f32_16x16x32_bf16 v[48:51], v[152:155], a[36:39], v[48:51]
    ds_read_b128 a[96:99], v7 offset:384
    s_waitcnt lgkmcnt(8)
    v_mfma_f32_16x16x32_bf16 v[64:67], v[156:159], a[36:39], v[64:67]
    ds_write_b128 v5, v[216:219] offset:14528
    s_waitcnt lgkmcnt(8)
    v_mfma_f32_16x16x32_bf16 v[52:55], v[152:155], a[100:103], v[52:55]
    ds_read_b128 a[160:163], v7 offset:640
    v_mfma_f32_16x16x32_bf16 v[68:71], v[156:159], a[100:103], v[68:71]
    v_alignbit_b32 v220, v194, v193, 16
    v_alignbit_b32 v221, v195, v194, 16
    s_waitcnt lgkmcnt(7)
    v_mfma_f32_16x16x32_bf16 v[56:59], v[152:155], a[164:167], v[56:59]
    ds_read_b128 a[224:227], v7 offset:896
    v_mfma_f32_16x16x32_bf16 v[72:75], v[156:159], a[164:167], v[72:75]
    ds_read_b128 a[28:31], v7 offset:112
    s_waitcnt lgkmcnt(8)
    v_mfma_f32_16x16x32_bf16 v[60:63], v[152:155], a[228:231], v[60:63]
    ds_read_b128 v[168:171], v6 offset:512
    v_mfma_f32_16x16x32_bf16 v[76:79], v[156:159], a[228:231], v[76:79]
    ds_read_b128 v[172:175], v6 offset:544
    s_waitcnt lgkmcnt(8)
    v_mfma_f32_16x16x32_bf16 v[48:51], v[160:163], a[32:35], v[48:51]
    ds_read_b128 a[92:95], v7 offset:368
    s_waitcnt lgkmcnt(8)
    v_mfma_f32_16x16x32_bf16 v[64:67], v[164:167], a[32:35], v[64:67]
    v_alignbit_b32 v222, v196, v195, 16
    v_alignbit_b32 v223, v197, v196, 16
    s_waitcnt lgkmcnt(7)
    v_mfma_f32_16x16x32_bf16 v[52:55], v[160:163], a[96:99], v[52:55]
    ds_read_b128 a[156:159], v7 offset:624
    v_mfma_f32_16x16x32_bf16 v[68:71], v[164:167], a[96:99], v[68:71]
    ds_write_b128 v5, v[220:223] offset:22848
    s_waitcnt lgkmcnt(7)
    v_mfma_f32_16x16x32_bf16 v[56:59], v[160:163], a[160:163], v[56:59]
    ds_read_b128 a[220:223], v7 offset:880
    v_mfma_f32_16x16x32_bf16 v[72:75], v[164:167], a[160:163], v[72:75]
    ds_read_b128 a[24:27], v7 offset:96
    s_waitcnt lgkmcnt(8)
    v_mfma_f32_16x16x32_bf16 v[60:63], v[160:163], a[224:227], v[60:63]
    ds_read_b128 v[112:115], v6 offset:576
    v_mfma_f32_16x16x32_bf16 v[76:79], v[164:167], a[224:227], v[76:79]
    ds_read_b128 v[116:119], v6 offset:608
    s_waitcnt lgkmcnt(8)
    v_mfma_f32_16x16x32_bf16 v[48:51], v[168:171], a[28:31], v[48:51]
    ds_read_b128 a[88:91], v7 offset:352
    s_waitcnt lgkmcnt(8)
    v_mfma_f32_16x16x32_bf16 v[64:67], v[172:175], a[28:31], v[64:67]
    v_alignbit_b32 v224, v198, v197, 16
    v_alignbit_b32 v225, v199, v198, 16
    s_waitcnt lgkmcnt(7)
    v_mfma_f32_16x16x32_bf16 v[52:55], v[168:171], a[92:95], v[52:55]
    ds_read_b128 a[152:155], v7 offset:608
    v_mfma_f32_16x16x32_bf16 v[68:71], v[172:175], a[92:95], v[68:71]
    ds_write_b128 v5, v[222:225] offset:6208
    s_waitcnt lgkmcnt(8)
    v_mfma_f32_16x16x32_bf16 v[56:59], v[168:171], a[156:159], v[56:59]
    ds_read_b128 a[216:219], v7 offset:864
    v_mfma_f32_16x16x32_bf16 v[72:75], v[172:175], a[156:159], v[72:75]
    ds_read_b128 a[20:23], v7 offset:80
    s_waitcnt lgkmcnt(8)
    v_mfma_f32_16x16x32_bf16 v[60:63], v[168:171], a[220:223], v[60:63]
    ds_read_b128 v[120:123], v6 offset:640
    v_mfma_f32_16x16x32_bf16 v[76:79], v[172:175], a[220:223], v[76:79]
    ds_read_b128 v[124:127], v6 offset:672
    s_waitcnt lgkmcnt(8)
    v_mfma_f32_16x16x32_bf16 v[48:51], v[112:115], a[24:27], v[48:51]
    ds_read_b128 a[84:87], v7 offset:336
    s_waitcnt lgkmcnt(8)
    v_mfma_f32_16x16x32_bf16 v[64:67], v[116:119], a[24:27], v[64:67]
    buffer_load_dwordx4 v[192:195], v4, s[28:31], s36 offen offset:2032
    s_waitcnt lgkmcnt(7)
    v_mfma_f32_16x16x32_bf16 v[52:55], v[112:115], a[88:91], v[52:55]
    ds_read_b128 a[148:151], v7 offset:592
    v_mfma_f32_16x16x32_bf16 v[68:71], v[116:119], a[88:91], v[68:71]
    buffer_load_dwordx4 v[196:199], v4, s[28:31], s36 offen offset:2048
    s_waitcnt lgkmcnt(7)
    v_mfma_f32_16x16x32_bf16 v[56:59], v[112:115], a[152:155], v[56:59]
    ds_read_b128 a[212:215], v7 offset:848
    v_mfma_f32_16x16x32_bf16 v[72:75], v[116:119], a[152:155], v[72:75]
    ds_read_b128 a[16:19], v7 offset:64
    s_waitcnt lgkmcnt(7)
    v_mfma_f32_16x16x32_bf16 v[60:63], v[112:115], a[216:219], v[60:63]
    ds_read_b128 v[128:131], v6 offset:704
    v_mfma_f32_16x16x32_bf16 v[76:79], v[116:119], a[216:219], v[76:79]
    ds_read_b128 v[132:135], v6 offset:736
    s_waitcnt lgkmcnt(7)
    v_mfma_f32_16x16x32_bf16 v[48:51], v[120:123], a[20:23], v[48:51]
    ds_read_b128 a[80:83], v7 offset:320
    s_waitcnt lgkmcnt(7)
    v_mfma_f32_16x16x32_bf16 v[64:67], v[124:127], a[20:23], v[64:67]
    s_waitcnt vmcnt(10)
    s_waitcnt lgkmcnt(6)
    v_mfma_f32_16x16x32_bf16 v[52:55], v[120:123], a[84:87], v[52:55]
    ds_read_b128 a[144:147], v7 offset:576
    v_mfma_f32_16x16x32_bf16 v[68:71], v[124:127], a[84:87], v[68:71]
    ds_write_b128 v5, v[204:207] offset:3072
    s_waitcnt lgkmcnt(7)
    v_mfma_f32_16x16x32_bf16 v[56:59], v[120:123], a[148:151], v[56:59]
    ds_read_b128 a[208:211], v7 offset:832
    v_mfma_f32_16x16x32_bf16 v[72:75], v[124:127], a[148:151], v[72:75]
    ds_read_b128 a[12:15], v7 offset:48
    s_waitcnt lgkmcnt(8)
    v_mfma_f32_16x16x32_bf16 v[60:63], v[120:123], a[212:215], v[60:63]
    ds_read_b128 v[136:139], v6 offset:768
    v_mfma_f32_16x16x32_bf16 v[76:79], v[124:127], a[212:215], v[76:79]
    ds_read_b128 v[140:143], v6 offset:800
    s_waitcnt lgkmcnt(8)
    v_mfma_f32_16x16x32_bf16 v[48:51], v[128:131], a[16:19], v[48:51]
    ds_read_b128 a[76:79], v7 offset:304
    s_waitcnt lgkmcnt(8)
    v_mfma_f32_16x16x32_bf16 v[64:67], v[132:135], a[16:19], v[64:67]
    ds_write_b128 v5, v[202:205] offset:19712
    s_waitcnt lgkmcnt(8)
    v_mfma_f32_16x16x32_bf16 v[52:55], v[128:131], a[80:83], v[52:55]
    ds_read_b128 a[140:143], v7 offset:560
    v_mfma_f32_16x16x32_bf16 v[68:71], v[132:135], a[80:83], v[68:71]
    v_mov_b32 v208, v201
    v_mov_b32 v209, v202
    s_waitcnt lgkmcnt(8)
    v_mfma_f32_16x16x32_bf16 v[56:59], v[128:131], a[144:147], v[56:59]
    ds_read_b128 a[204:207], v7 offset:816
    v_mfma_f32_16x16x32_bf16 v[72:75], v[132:135], a[144:147], v[72:75]
    ds_read_b128 a[8:11], v7 offset:32
    s_waitcnt lgkmcnt(8)
    v_mfma_f32_16x16x32_bf16 v[60:63], v[128:131], a[208:211], v[60:63]
    ds_read_b128 v[144:147], v6 offset:832
    v_mfma_f32_16x16x32_bf16 v[76:79], v[132:135], a[208:211], v[76:79]
    ds_read_b128 v[148:151], v6 offset:864
    s_waitcnt lgkmcnt(8)
    v_mfma_f32_16x16x32_bf16 v[48:51], v[136:139], a[12:15], v[48:51]
    ds_read_b128 a[72:75], v7 offset:288
    s_waitcnt lgkmcnt(8)
    v_mfma_f32_16x16x32_bf16 v[64:67], v[140:143], a[12:15], v[64:67]
    v_mov_b32 v210, v203
    v_mov_b32 v211, v204
    s_waitcnt lgkmcnt(7)
    v_mfma_f32_16x16x32_bf16 v[52:55], v[136:139], a[76:79], v[52:55]
    ds_read_b128 a[136:139], v7 offset:544
    v_mfma_f32_16x16x32_bf16 v[68:71], v[140:143], a[76:79], v[68:71]
    ds_write_b128 v5, v[208:211] offset:28032
    s_waitcnt lgkmcnt(7)
    v_mfma_f32_16x16x32_bf16 v[56:59], v[136:139], a[140:143], v[56:59]
    ds_read_b128 a[200:203], v7 offset:800
    v_mfma_f32_16x16x32_bf16 v[72:75], v[140:143], a[140:143], v[72:75]
    ds_read_b128 a[4:7], v7 offset:16
    s_waitcnt lgkmcnt(8)
    v_mfma_f32_16x16x32_bf16 v[60:63], v[136:139], a[204:207], v[60:63]
    ds_read_b128 v[152:155], v6 offset:896
    v_mfma_f32_16x16x32_bf16 v[76:79], v[140:143], a[204:207], v[76:79]
    ds_read_b128 v[156:159], v6 offset:928
    s_waitcnt lgkmcnt(8)
    v_mfma_f32_16x16x32_bf16 v[48:51], v[144:147], a[8:11], v[48:51]
    ds_read_b128 a[68:71], v7 offset:272
    s_waitcnt lgkmcnt(8)
    v_mfma_f32_16x16x32_bf16 v[64:67], v[148:151], a[8:11], v[64:67]
    v_mov_b32 v212, v205
    v_mov_b32 v213, v206
    s_waitcnt lgkmcnt(7)
    v_mfma_f32_16x16x32_bf16 v[52:55], v[144:147], a[72:75], v[52:55]
    ds_read_b128 a[132:135], v7 offset:528
    v_mfma_f32_16x16x32_bf16 v[68:71], v[148:151], a[72:75], v[68:71]
    ds_write_b128 v5, v[210:213] offset:11392
    s_waitcnt lgkmcnt(8)
    v_mfma_f32_16x16x32_bf16 v[56:59], v[144:147], a[136:139], v[56:59]
    ds_read_b128 a[196:199], v7 offset:784
    v_mfma_f32_16x16x32_bf16 v[72:75], v[148:151], a[136:139], v[72:75]
    ds_read_b128 a[0:3], v7 offset:0
    s_waitcnt lgkmcnt(8)
    v_mfma_f32_16x16x32_bf16 v[60:63], v[144:147], a[200:203], v[60:63]
    ds_read_b128 v[160:163], v6 offset:960
    v_mfma_f32_16x16x32_bf16 v[76:79], v[148:151], a[200:203], v[76:79]
    ds_read_b128 v[164:167], v6 offset:992
    s_waitcnt lgkmcnt(8)
    v_mfma_f32_16x16x32_bf16 v[48:51], v[152:155], a[4:7], v[48:51]
    ds_read_b128 a[64:67], v7 offset:256
    s_waitcnt lgkmcnt(8)
    v_mfma_f32_16x16x32_bf16 v[64:67], v[156:159], a[4:7], v[64:67]
    v_alignbit_b32 v214, v201, v200, 16
    v_alignbit_b32 v215, v202, v201, 16
    s_waitcnt lgkmcnt(7)
    v_mfma_f32_16x16x32_bf16 v[52:55], v[152:155], a[68:71], v[52:55]
    ds_read_b128 a[128:131], v7 offset:512
    v_mfma_f32_16x16x32_bf16 v[68:71], v[156:159], a[68:71], v[68:71]
    v_alignbit_b32 v216, v203, v202, 16
    v_alignbit_b32 v217, v204, v203, 16
    s_waitcnt lgkmcnt(7)
    v_mfma_f32_16x16x32_bf16 v[56:59], v[152:155], a[132:135], v[56:59]
    ds_read_b128 a[192:195], v7 offset:768
    v_mfma_f32_16x16x32_bf16 v[72:75], v[156:159], a[132:135], v[72:75]
    ds_write_b128 v5, v[214:217] offset:32192
    s_waitcnt lgkmcnt(7)
    v_mfma_f32_16x16x32_bf16 v[60:63], v[152:155], a[196:199], v[60:63]
    ds_read_b128 v[168:171], v6 offset:1024
    v_mfma_f32_16x16x32_bf16 v[76:79], v[156:159], a[196:199], v[76:79]
    ds_read_b128 v[172:175], v6 offset:1056
    s_waitcnt lgkmcnt(7)
    v_mfma_f32_16x16x32_bf16 v[48:51], v[160:163], a[0:3], v[48:51]
    v_alignbit_b32 v218, v205, v204, 16
    v_alignbit_b32 v219, v206, v205, 16
    s_waitcnt lgkmcnt(6)
    v_mfma_f32_16x16x32_bf16 v[64:67], v[164:167], a[0:3], v[64:67]
    ds_write_b128 v5, v[216:219] offset:15552
    s_waitcnt lgkmcnt(6)
    v_mfma_f32_16x16x32_bf16 v[52:55], v[160:163], a[64:67], v[52:55]
    v_alignbit_b32 v220, v202, v201, 16
    v_alignbit_b32 v221, v203, v202, 16
    v_mfma_f32_16x16x32_bf16 v[68:71], v[164:167], a[64:67], v[68:71]
    v_alignbit_b32 v222, v204, v203, 16
    v_alignbit_b32 v223, v205, v204, 16
    s_waitcnt lgkmcnt(5)
    v_mfma_f32_16x16x32_bf16 v[56:59], v[160:163], a[128:131], v[56:59]
    ds_read_b128 v[112:115], v6 offset:1088
    v_mfma_f32_16x16x32_bf16 v[72:75], v[164:167], a[128:131], v[72:75]
    ds_read_b128 v[116:119], v6 offset:1120
    s_waitcnt lgkmcnt(6)
    v_mfma_f32_16x16x32_bf16 v[60:63], v[160:163], a[192:195], v[60:63]
    ds_write_b128 v5, v[220:223] offset:23872
    v_mfma_f32_16x16x32_bf16 v[76:79], v[164:167], a[192:195], v[76:79]
    v_alignbit_b32 v224, v206, v205, 16
    v_alignbit_b32 v225, v207, v206, 16
    s_waitcnt lgkmcnt(5)
    v_mfma_f32_16x16x32_bf16 v[52:55], v[168:171], a[60:63], v[52:55]
    ds_write_b128 v5, v[222:225] offset:7232
    s_waitcnt lgkmcnt(5)
    v_mfma_f32_16x16x32_bf16 v[68:71], v[172:175], a[60:63], v[68:71]
    buffer_load_dwordx4 v[200:203], v4, s[28:31], s36 offen offset:3056
    v_mfma_f32_16x16x32_bf16 v[56:59], v[168:171], a[124:127], v[56:59]
    ds_read_b128 v[120:123], v6 offset:1152
    v_mfma_f32_16x16x32_bf16 v[72:75], v[172:175], a[124:127], v[72:75]
    ds_read_b128 v[124:127], v6 offset:1184
    v_mfma_f32_16x16x32_bf16 v[60:63], v[168:171], a[188:191], v[60:63]
    buffer_load_dwordx4 v[204:207], v4, s[28:31], s36 offen offset:3072
    v_mfma_f32_16x16x32_bf16 v[76:79], v[172:175], a[188:191], v[76:79]
    s_waitcnt vmcnt(10)
    s_mov_b64 exec, 1
    v_mov_b32 v176, 0
    v_mov_b32 v177, 0
    v_mov_b32 v178, 0
    v_mov_b32 v179, 0
    s_mov_b64 exec, -1
    s_waitcnt lgkmcnt(5)
    v_mfma_f32_16x16x32_bf16 v[52:55], v[112:115], a[56:59], v[52:55]
    ds_write_b128 v5, v[180:183] offset:0
    s_waitcnt lgkmcnt(5)
    v_mfma_f32_16x16x32_bf16 v[68:71], v[116:119], a[56:59], v[68:71]
    ds_write_b128 v5, v[178:181] offset:16640
    v_mfma_f32_16x16x32_bf16 v[56:59], v[112:115], a[120:123], v[56:59]
    ds_read_b128 v[128:131], v6 offset:1216
    v_mfma_f32_16x16x32_bf16 v[72:75], v[116:119], a[120:123], v[72:75]
    ds_read_b128 v[132:135], v6 offset:1248
    v_mfma_f32_16x16x32_bf16 v[60:63], v[112:115], a[184:187], v[60:63]
    v_mov_b32 v208, v177
    v_mov_b32 v209, v178
    v_mfma_f32_16x16x32_bf16 v[76:79], v[116:119], a[184:187], v[76:79]
    v_mov_b32 v210, v179
    v_mov_b32 v211, v180
    s_waitcnt lgkmcnt(5)
    v_mfma_f32_16x16x32_bf16 v[52:55], v[120:123], a[52:55], v[52:55]
    ds_write_b128 v5, v[208:211] offset:24960
    s_waitcnt lgkmcnt(5)
    v_mfma_f32_16x16x32_bf16 v[68:71], v[124:127], a[52:55], v[68:71]
    v_mov_b32 v212, v181
    v_mov_b32 v213, v182
    v_mfma_f32_16x16x32_bf16 v[56:59], v[120:123], a[116:119], v[56:59]
    ds_read_b128 v[136:139], v6 offset:1280
    v_mfma_f32_16x16x32_bf16 v[72:75], v[124:127], a[116:119], v[72:75]
    ds_read_b128 v[140:143], v6 offset:1312
    v_mfma_f32_16x16x32_bf16 v[60:63], v[120:123], a[180:183], v[60:63]
    ds_write_b128 v5, v[210:213] offset:8320
    v_mfma_f32_16x16x32_bf16 v[76:79], v[124:127], a[180:183], v[76:79]
    v_alignbit_b32 v214, v177, v176, 16
    v_alignbit_b32 v215, v178, v177, 16
    s_waitcnt lgkmcnt(5)
    v_mfma_f32_16x16x32_bf16 v[52:55], v[128:131], a[48:51], v[52:55]
    v_alignbit_b32 v216, v179, v178, 16
    v_alignbit_b32 v217, v180, v179, 16
    s_waitcnt lgkmcnt(4)
    v_mfma_f32_16x16x32_bf16 v[68:71], v[132:135], a[48:51], v[68:71]
    ds_write_b128 v5, v[214:217] offset:29120
    v_mfma_f32_16x16x32_bf16 v[56:59], v[128:131], a[112:115], v[56:59]
    ds_read_b128 v[144:147], v6 offset:1344
    v_mfma_f32_16x16x32_bf16 v[72:75], v[132:135], a[112:115], v[72:75]
    ds_read_b128 v[148:151], v6 offset:1376
    v_mfma_f32_16x16x32_bf16 v[60:63], v[128:131], a[176:179], v[60:63]
    v_alignbit_b32 v218, v181, v180, 16
    v_alignbit_b32 v219, v182, v181, 16
    v_mfma_f32_16x16x32_bf16 v[76:79], v[132:135], a[176:179], v[76:79]
    ds_write_b128 v5, v[216:219] offset:12480
    s_waitcnt lgkmcnt(6)
    v_mfma_f32_16x16x32_bf16 v[52:55], v[136:139], a[44:47], v[52:55]
    v_alignbit_b32 v220, v178, v177, 16
    v_alignbit_b32 v221, v179, v178, 16
    s_waitcnt lgkmcnt(5)
    v_mfma_f32_16x16x32_bf16 v[68:71], v[140:143], a[44:47], v[68:71]
    v_alignbit_b32 v222, v180, v179, 16
    v_alignbit_b32 v223, v181, v180, 16
    v_mfma_f32_16x16x32_bf16 v[56:59], v[136:139], a[108:111], v[56:59]
    ds_read_b128 v[152:155], v6 offset:1408
    v_mfma_f32_16x16x32_bf16 v[72:75], v[140:143], a[108:111], v[72:75]
    ds_read_b128 v[156:159], v6 offset:1440
    v_mfma_f32_16x16x32_bf16 v[60:63], v[136:139], a[172:175], v[60:63]
    ds_write_b128 v5, v[220:223] offset:20800
    v_mfma_f32_16x16x32_bf16 v[76:79], v[140:143], a[172:175], v[76:79]
    v_alignbit_b32 v224, v182, v181, 16
    v_alignbit_b32 v225, v183, v182, 16
    s_waitcnt lgkmcnt(5)
    v_mfma_f32_16x16x32_bf16 v[52:55], v[144:147], a[40:43], v[52:55]
    ds_write_b128 v5, v[222:225] offset:4160
    s_waitcnt lgkmcnt(5)
    v_mfma_f32_16x16x32_bf16 v[68:71], v[148:151], a[40:43], v[68:71]
    buffer_load_dwordx4 v[176:179], v230, s[28:31], s37 offen offset:0
    v_mfma_f32_16x16x32_bf16 v[56:59], v[144:147], a[104:107], v[56:59]
    ds_read_b128 v[160:163], v6 offset:1472
    v_mfma_f32_16x16x32_bf16 v[72:75], v[148:151], a[104:107], v[72:75]
    ds_read_b128 v[164:167], v6 offset:1504
    v_mfma_f32_16x16x32_bf16 v[60:63], v[144:147], a[168:171], v[60:63]
    buffer_load_dwordx4 v[180:183], v4, s[28:31], s37 offen offset:0
    v_mfma_f32_16x16x32_bf16 v[76:79], v[148:151], a[168:171], v[76:79]
    s_add_u32 m0, s35, 0
    s_waitcnt lgkmcnt(5)
    v_mfma_f32_16x16x32_bf16 v[52:55], v[152:155], a[36:39], v[52:55]
    buffer_load_dwordx4 v4, s[8:11], s39 offen offset:0 lds
    s_waitcnt lgkmcnt(4)
    v_mfma_f32_16x16x32_bf16 v[68:71], v[156:159], a[36:39], v[68:71]
    s_add_u32 m0, s35, 256
    v_mfma_f32_16x16x32_bf16 v[56:59], v[152:155], a[100:103], v[56:59]
    ds_read_b128 v[168:171], v6 offset:1536
    v_mfma_f32_16x16x32_bf16 v[72:75], v[156:159], a[100:103], v[72:75]
    ds_read_b128 v[172:175], v6 offset:1568
    v_mfma_f32_16x16x32_bf16 v[60:63], v[152:155], a[164:167], v[60:63]
    buffer_load_dwordx4 v4, s[8:11], s39 offen offset:1024 lds
    v_mfma_f32_16x16x32_bf16 v[76:79], v[156:159], a[164:167], v[76:79]
    s_add_u32 m0, s35, 512
    s_waitcnt lgkmcnt(3)
    v_mfma_f32_16x16x32_bf16 v[52:55], v[160:163], a[32:35], v[52:55]
    buffer_load_dwordx4 v4, s[8:11], s39 offen offset:2048 lds
    s_waitcnt lgkmcnt(2)
    v_mfma_f32_16x16x32_bf16 v[68:71], v[164:167], a[32:35], v[68:71]
    s_add_u32 m0, s35, 768
    v_mfma_f32_16x16x32_bf16 v[56:59], v[160:163], a[96:99], v[56:59]
    ds_read_b128 v[112:115], v6 offset:1600
    v_mfma_f32_16x16x32_bf16 v[72:75], v[164:167], a[96:99], v[72:75]
    ds_read_b128 v[116:119], v6 offset:1632
    v_mfma_f32_16x16x32_bf16 v[60:63], v[160:163], a[160:163], v[60:63]
    buffer_load_dwordx4 v4, s[8:11], s39 offen offset:3072 lds
    v_mfma_f32_16x16x32_bf16 v[76:79], v[164:167], a[160:163], v[76:79]
    s_waitcnt lgkmcnt(3)
    v_mfma_f32_16x16x32_bf16 v[52:55], v[168:171], a[28:31], v[52:55]
    s_waitcnt lgkmcnt(2)
    v_mfma_f32_16x16x32_bf16 v[68:71], v[172:175], a[28:31], v[68:71]
    v_mfma_f32_16x16x32_bf16 v[56:59], v[168:171], a[92:95], v[56:59]
    ds_read_b128 v[120:123], v6 offset:1664
    v_mfma_f32_16x16x32_bf16 v[72:75], v[172:175], a[92:95], v[72:75]
    ds_read_b128 v[124:127], v6 offset:1696
    v_mfma_f32_16x16x32_bf16 v[60:63], v[168:171], a[156:159], v[60:63]
    v_mfma_f32_16x16x32_bf16 v[76:79], v[172:175], a[156:159], v[76:79]
    s_waitcnt lgkmcnt(3)
    v_mfma_f32_16x16x32_bf16 v[52:55], v[112:115], a[24:27], v[52:55]
    s_waitcnt lgkmcnt(2)
    v_mfma_f32_16x16x32_bf16 v[68:71], v[116:119], a[24:27], v[68:71]
    v_mfma_f32_16x16x32_bf16 v[56:59], v[112:115], a[88:91], v[56:59]
    ds_read_b128 v[128:131], v6 offset:1728
    v_mfma_f32_16x16x32_bf16 v[72:75], v[116:119], a[88:91], v[72:75]
    ds_read_b128 v[132:135], v6 offset:1760
    v_mfma_f32_16x16x32_bf16 v[60:63], v[112:115], a[152:155], v[60:63]
    v_mfma_f32_16x16x32_bf16 v[76:79], v[116:119], a[152:155], v[76:79]
    s_waitcnt lgkmcnt(3)
    v_mfma_f32_16x16x32_bf16 v[52:55], v[120:123], a[20:23], v[52:55]
    s_waitcnt lgkmcnt(2)
    v_mfma_f32_16x16x32_bf16 v[68:71], v[124:127], a[20:23], v[68:71]
    v_mfma_f32_16x16x32_bf16 v[56:59], v[120:123], a[84:87], v[56:59]
    ds_read_b128 v[136:139], v6 offset:1792
    v_mfma_f32_16x16x32_bf16 v[72:75], v[124:127], a[84:87], v[72:75]
    ds_read_b128 v[140:143], v6 offset:1824
    v_mfma_f32_16x16x32_bf16 v[60:63], v[120:123], a[148:151], v[60:63]
    v_mfma_f32_16x16x32_bf16 v[76:79], v[124:127], a[148:151], v[76:79]
    s_waitcnt lgkmcnt(3)
    v_mfma_f32_16x16x32_bf16 v[52:55], v[128:131], a[16:19], v[52:55]
    s_waitcnt lgkmcnt(2)
    v_mfma_f32_16x16x32_bf16 v[68:71], v[132:135], a[16:19], v[68:71]
    v_mfma_f32_16x16x32_bf16 v[56:59], v[128:131], a[80:83], v[56:59]
    ds_read_b128 v[144:147], v6 offset:1856
    v_mfma_f32_16x16x32_bf16 v[72:75], v[132:135], a[80:83], v[72:75]
    ds_read_b128 v[148:151], v6 offset:1888
    v_mfma_f32_16x16x32_bf16 v[60:63], v[128:131], a[144:147], v[60:63]
    v_mfma_f32_16x16x32_bf16 v[76:79], v[132:135], a[144:147], v[76:79]
    s_waitcnt lgkmcnt(3)
    v_mfma_f32_16x16x32_bf16 v[52:55], v[136:139], a[12:15], v[52:55]
    s_waitcnt lgkmcnt(2)
    v_mfma_f32_16x16x32_bf16 v[68:71], v[140:143], a[12:15], v[68:71]
    v_mfma_f32_16x16x32_bf16 v[56:59], v[136:139], a[76:79], v[56:59]
    ds_read_b128 v[152:155], v6 offset:1920
    v_mfma_f32_16x16x32_bf16 v[72:75], v[140:143], a[76:79], v[72:75]
    ds_read_b128 v[156:159], v6 offset:1952
    v_mfma_f32_16x16x32_bf16 v[60:63], v[136:139], a[140:143], v[60:63]
    v_mfma_f32_16x16x32_bf16 v[76:79], v[140:143], a[140:143], v[76:79]
    s_waitcnt lgkmcnt(3)
    v_mfma_f32_16x16x32_bf16 v[52:55], v[144:147], a[8:11], v[52:55]
    s_waitcnt lgkmcnt(2)
    v_mfma_f32_16x16x32_bf16 v[68:71], v[148:151], a[8:11], v[68:71]
    v_mfma_f32_16x16x32_bf16 v[56:59], v[144:147], a[72:75], v[56:59]
    ds_read_b128 v[160:163], v6 offset:1984
    v_mfma_f32_16x16x32_bf16 v[72:75], v[148:151], a[72:75], v[72:75]
    ds_read_b128 v[164:167], v6 offset:2016
    v_mfma_f32_16x16x32_bf16 v[60:63], v[144:147], a[136:139], v[60:63]
    v_mfma_f32_16x16x32_bf16 v[76:79], v[148:151], a[136:139], v[76:79]
    s_waitcnt lgkmcnt(3)
    v_mfma_f32_16x16x32_bf16 v[52:55], v[152:155], a[4:7], v[52:55]
    s_waitcnt lgkmcnt(2)
    v_mfma_f32_16x16x32_bf16 v[68:71], v[156:159], a[4:7], v[68:71]
    v_mfma_f32_16x16x32_bf16 v[56:59], v[152:155], a[68:71], v[56:59]
    ds_read_b128 v[168:171], v6 offset:2048
    v_mfma_f32_16x16x32_bf16 v[72:75], v[156:159], a[68:71], v[72:75]
    ds_read_b128 v[172:175], v6 offset:2080
    v_mfma_f32_16x16x32_bf16 v[60:63], v[152:155], a[132:135], v[60:63]
    s_waitcnt vmcnt(10)
    v_mfma_f32_16x16x32_bf16 v[76:79], v[156:159], a[132:135], v[76:79]
    ds_write_b128 v5, v[188:191] offset:1024
    s_waitcnt lgkmcnt(4)
    v_mfma_f32_16x16x32_bf16 v[52:55], v[160:163], a[0:3], v[52:55]
    ds_read_b128 v[112:115], v6 offset:2112
    s_waitcnt lgkmcnt(4)
    v_mfma_f32_16x16x32_bf16 v[68:71], v[164:167], a[0:3], v[68:71]
    ds_read_b128 v[116:119], v6 offset:2144
    v_mfma_f32_16x16x32_bf16 v[56:59], v[160:163], a[64:67], v[56:59]
    ds_write_b128 v5, v[186:189] offset:17664
    v_mfma_f32_16x16x32_bf16 v[72:75], v[164:167], a[64:67], v[72:75]
    v_mov_b32 v208, v185
    v_mov_b32 v209, v186
    v_mfma_f32_16x16x32_bf16 v[60:63], v[160:163], a[128:131], v[60:63]
    ds_read_b128 v[120:123], v6 offset:2176
    v_mfma_f32_16x16x32_bf16 v[76:79], v[164:167], a[128:131], v[76:79]
    ds_read_b128 v[124:127], v6 offset:2208
    s_waitcnt lgkmcnt(7)
    v_mfma_f32_16x16x32_bf16 v[56:59], v[168:171], a[60:63], v[56:59]
    v_mov_b32 v210, v187
    v_mov_b32 v211, v188
    s_waitcnt lgkmcnt(6)
    v_mfma_f32_16x16x32_bf16 v[72:75], v[172:175], a[60:63], v[72:75]
    ds_write_b128 v5, v[208:211] offset:25984
    v_mfma_f32_16x16x32_bf16 v[60:63], v[168:171], a[124:127], v[60:63]
    ds_read_b128 v[128:131], v6 offset:2240
    v_mfma_f32_16x16x32_bf16 v[76:79], v[172:175], a[124:127], v[76:79]
    ds_read_b128 v[132:135], v6 offset:2272
    s_waitcnt lgkmcnt(7)
    v_mfma_f32_16x16x32_bf16 v[56:59], v[112:115], a[56:59], v[56:59]
    v_mov_b32 v212, v189
    v_mov_b32 v213, v190
    s_waitcnt lgkmcnt(6)
    v_mfma_f32_16x16x32_bf16 v[72:75], v[116:119], a[56:59], v[72:75]
    ds_write_b128 v5, v[210:213] offset:9344
    v_mfma_f32_16x16x32_bf16 v[60:63], v[112:115], a[120:123], v[60:63]
    ds_read_b128 v[136:139], v6 offset:2304
    v_mfma_f32_16x16x32_bf16 v[76:79], v[116:119], a[120:123], v[76:79]
    ds_read_b128 v[140:143], v6 offset:2336
    s_waitcnt lgkmcnt(7)
    v_mfma_f32_16x16x32_bf16 v[56:59], v[120:123], a[52:55], v[56:59]
    v_alignbit_b32 v214, v185, v184, 16
    v_alignbit_b32 v215, v186, v185, 16
    s_waitcnt lgkmcnt(6)
    v_mfma_f32_16x16x32_bf16 v[72:75], v[124:127], a[52:55], v[72:75]
    v_alignbit_b32 v216, v187, v186, 16
    v_alignbit_b32 v217, v188, v187, 16
    v_mfma_f32_16x16x32_bf16 v[60:63], v[120:123], a[116:119], v[60:63]
    ds_read_b128 v[144:147], v6 offset:2368
    v_mfma_f32_16x16x32_bf16 v[76:79], v[124:127], a[116:119], v[76:79]
    ds_read_b128 v[148:151], v6 offset:2400
    s_waitcnt lgkmcnt(6)
    v_mfma_f32_16x16x32_bf16 v[56:59], v[128:131], a[48:51], v[56:59]
    ds_write_b128 v5, v[214:217] offset:30144
    s_waitcnt lgkmcnt(6)
    v_mfma_f32_16x16x32_bf16 v[72:75], v[132:135], a[48:51], v[72:75]
    v_alignbit_b32 v218, v189, v188, 16
    v_alignbit_b32 v219, v190, v189, 16
    v_mfma_f32_16x16x32_bf16 v[60:63], v[128:131], a[112:115], v[60:63]
    ds_read_b128 v[152:155], v6 offset:2432
    v_mfma_f32_16x16x32_bf16 v[76:79], v[132:135], a[112:115], v[76:79]
    ds_read_b128 v[156:159], v6 offset:2464
    s_waitcnt lgkmcnt(6)
    v_mfma_f32_16x16x32_bf16 v[56:59], v[136:139], a[44:47], v[56:59]
    ds_write_b128 v5, v[216:219] offset:13504
    s_waitcnt lgkmcnt(6)
    v_mfma_f32_16x16x32_bf16 v[72:75], v[140:143], a[44:47], v[72:75]
    v_alignbit_b32 v220, v186, v185, 16
    v_alignbit_b32 v221, v187, v186, 16
    v_mfma_f32_16x16x32_bf16 v[60:63], v[136:139], a[108:111], v[60:63]
    ds_read_b128 v[160:163], v6 offset:2496
    v_mfma_f32_16x16x32_bf16 v[76:79], v[140:143], a[108:111], v[76:79]
    ds_read_b128 v[164:167], v6 offset:2528
    s_waitcnt lgkmcnt(7)
    v_mfma_f32_16x16x32_bf16 v[56:59], v[144:147], a[40:43], v[56:59]
    v_alignbit_b32 v222, v188, v187, 16
    v_alignbit_b32 v223, v189, v188, 16
    s_waitcnt lgkmcnt(6)
    v_mfma_f32_16x16x32_bf16 v[72:75], v[148:151], a[40:43], v[72:75]
    ds_write_b128 v5, v[220:223] offset:21824
    v_mfma_f32_16x16x32_bf16 v[60:63], v[144:147], a[104:107], v[60:63]
    ds_read_b128 v[168:171], v6 offset:2560
    v_mfma_f32_16x16x32_bf16 v[76:79], v[148:151], a[104:107], v[76:79]
    ds_read_b128 v[172:175], v6 offset:2592
    s_waitcnt lgkmcnt(7)
    v_mfma_f32_16x16x32_bf16 v[56:59], v[152:155], a[36:39], v[56:59]
    v_alignbit_b32 v224, v190, v189, 16
    v_alignbit_b32 v225, v191, v190, 16
    s_waitcnt lgkmcnt(6)
    v_mfma_f32_16x16x32_bf16 v[72:75], v[156:159], a[36:39], v[72:75]
    ds_write_b128 v5, v[222:225] offset:5184
    v_mfma_f32_16x16x32_bf16 v[60:63], v[152:155], a[100:103], v[60:63]
    ds_read_b128 v[112:115], v6 offset:2624
    v_mfma_f32_16x16x32_bf16 v[76:79], v[156:159], a[100:103], v[76:79]
    ds_read_b128 v[116:119], v6 offset:2656
    s_waitcnt lgkmcnt(7)
    v_mfma_f32_16x16x32_bf16 v[56:59], v[160:163], a[32:35], v[56:59]
    buffer_load_dwordx4 v[184:187], v4, s[28:31], s37 offen offset:1008
    s_waitcnt lgkmcnt(6)
    v_mfma_f32_16x16x32_bf16 v[72:75], v[164:167], a[32:35], v[72:75]
    buffer_load_dwordx4 v[188:191], v4, s[28:31], s37 offen offset:1024
    v_mfma_f32_16x16x32_bf16 v[60:63], v[160:163], a[96:99], v[60:63]
    ds_read_b128 v[120:123], v6 offset:2688
    v_mfma_f32_16x16x32_bf16 v[76:79], v[164:167], a[96:99], v[76:79]
    ds_read_b128 v[124:127], v6 offset:2720
    s_waitcnt lgkmcnt(6)
    v_mfma_f32_16x16x32_bf16 v[56:59], v[168:171], a[28:31], v[56:59]
    s_mov_b32 s36, s37
    s_add_u32 s39, s37, 125829120
    s_add_u32 s37, s37, 4096
    s_min_u32 s37, s37, s33

    s_pack_ll_b32_b16 s40, s65, s65
    s_mov_b32 s64, s65
    s_mov_b32 s65, s66
    s_mov_b32 s66, s67
    v_and_b32 v236, s40, v8
    s_waitcnt lgkmcnt(5)
    v_mfma_f32_16x16x32_bf16 v[72:75], v[172:175], a[28:31], v[72:75]
    v_and_b32 v237, s40, v9
    v_and_b32 v238, s40, v10
    v_mfma_f32_16x16x32_bf16 v[60:63], v[168:171], a[92:95], v[60:63]
    ds_read_b128 v[128:131], v6 offset:2752
    v_mfma_f32_16x16x32_bf16 v[76:79], v[172:175], a[92:95], v[76:79]
    ds_read_b128 v[132:135], v6 offset:2784
    s_waitcnt lgkmcnt(5)
    v_mfma_f32_16x16x32_bf16 v[56:59], v[112:115], a[24:27], v[56:59]
    v_and_b32 v239, s40, v11
    v_and_b32 v240, s40, v12
    s_waitcnt lgkmcnt(4)
    v_mfma_f32_16x16x32_bf16 v[72:75], v[116:119], a[24:27], v[72:75]
    v_and_b32 v241, s40, v13
    v_and_b32 v242, s40, v14
    v_mfma_f32_16x16x32_bf16 v[60:63], v[112:115], a[88:91], v[60:63]
    ds_read_b128 v[136:139], v6 offset:2816
    v_mfma_f32_16x16x32_bf16 v[76:79], v[116:119], a[88:91], v[76:79]
    ds_read_b128 v[140:143], v6 offset:2848
    s_waitcnt lgkmcnt(5)
    v_mfma_f32_16x16x32_bf16 v[56:59], v[120:123], a[20:23], v[56:59]
    v_and_b32 v243, s40, v15
    s_waitcnt lgkmcnt(4)
    v_mfma_f32_16x16x32_bf16 v[72:75], v[124:127], a[20:23], v[72:75]
    v_mfma_f32_16x16x32_bf16 v[60:63], v[120:123], a[84:87], v[60:63]
    ds_read_b128 v[144:147], v6 offset:2880
    v_mfma_f32_16x16x32_bf16 v[76:79], v[124:127], a[84:87], v[76:79]
    ds_read_b128 v[148:151], v6 offset:2912
    s_waitcnt lgkmcnt(5)
    v_mfma_f32_16x16x32_bf16 v[56:59], v[128:131], a[16:19], v[56:59]
    s_waitcnt lgkmcnt(4)
    v_mfma_f32_16x16x32_bf16 v[72:75], v[132:135], a[16:19], v[72:75]
    v_mfma_f32_16x16x32_bf16 v[60:63], v[128:131], a[80:83], v[60:63]
    ds_read_b128 v[152:155], v6 offset:2944
    v_mfma_f32_16x16x32_bf16 v[76:79], v[132:135], a[80:83], v[76:79]
    ds_read_b128 v[156:159], v6 offset:2976
    s_waitcnt lgkmcnt(5)
    v_mfma_f32_16x16x32_bf16 v[56:59], v[136:139], a[12:15], v[56:59]
    s_waitcnt lgkmcnt(4)
    v_mfma_f32_16x16x32_bf16 v[72:75], v[140:143], a[12:15], v[72:75]
    v_mfma_f32_16x16x32_bf16 v[60:63], v[136:139], a[76:79], v[60:63]
    ds_read_b128 v[160:163], v6 offset:3008
    v_mfma_f32_16x16x32_bf16 v[76:79], v[140:143], a[76:79], v[76:79]
    ds_read_b128 v[164:167], v6 offset:3040
    s_waitcnt lgkmcnt(5)
    v_mfma_f32_16x16x32_bf16 v[56:59], v[144:147], a[8:11], v[56:59]
    s_waitcnt lgkmcnt(4)
    v_mfma_f32_16x16x32_bf16 v[72:75], v[148:151], a[8:11], v[72:75]
    v_mfma_f32_16x16x32_bf16 v[60:63], v[144:147], a[72:75], v[60:63]
    ds_read_b128 v[168:171], v6 offset:3072
    v_mfma_f32_16x16x32_bf16 v[76:79], v[148:151], a[72:75], v[76:79]
    ds_read_b128 v[172:175], v6 offset:3104
    s_waitcnt lgkmcnt(5)
    v_mfma_f32_16x16x32_bf16 v[56:59], v[152:155], a[4:7], v[56:59]
    ds_read_b128 v[112:115], v6 offset:3136
    s_waitcnt lgkmcnt(5)
    v_mfma_f32_16x16x32_bf16 v[72:75], v[156:159], a[4:7], v[72:75]
    ds_read_b128 v[116:119], v6 offset:3168
    v_mfma_f32_16x16x32_bf16 v[60:63], v[152:155], a[68:71], v[60:63]
    ds_read_b128 v[120:123], v6 offset:3200
    v_mfma_f32_16x16x32_bf16 v[76:79], v[156:159], a[68:71], v[76:79]
    ds_read_b128 v[124:127], v6 offset:3232
    s_waitcnt lgkmcnt(7)
    v_mfma_f32_16x16x32_bf16 v[56:59], v[160:163], a[0:3], v[56:59]
    ds_read_b128 v[128:131], v6 offset:3264
    s_waitcnt lgkmcnt(7)
    v_mfma_f32_16x16x32_bf16 v[72:75], v[164:167], a[0:3], v[72:75]
    ds_read_b128 v[132:135], v6 offset:3296
    v_mfma_f32_16x16x32_bf16 v[60:63], v[160:163], a[64:67], v[60:63]
    ds_read_b128 v[136:139], v6 offset:3328
    v_mfma_f32_16x16x32_bf16 v[76:79], v[164:167], a[64:67], v[76:79]
    ds_read_b128 v[140:143], v6 offset:3360
    s_waitcnt lgkmcnt(9)
    v_mfma_f32_16x16x32_bf16 v[60:63], v[168:171], a[60:63], v[60:63]
    ds_read_b128 v[144:147], v6 offset:3392
    s_waitcnt lgkmcnt(9)
    v_mfma_f32_16x16x32_bf16 v[76:79], v[172:175], a[60:63], v[76:79]
    ds_read_b128 v[148:151], v6 offset:3424
    s_waitcnt lgkmcnt(9)
    v_mfma_f32_16x16x32_bf16 v[60:63], v[112:115], a[56:59], v[60:63]
    ds_read_b128 v[152:155], v6 offset:3456
    s_waitcnt lgkmcnt(9)
    v_mfma_f32_16x16x32_bf16 v[76:79], v[116:119], a[56:59], v[76:79]
    ds_read_b128 v[156:159], v6 offset:3488
    s_waitcnt lgkmcnt(9)
    v_mfma_f32_16x16x32_bf16 v[60:63], v[120:123], a[52:55], v[60:63]
    ds_read_b128 v[160:163], v6 offset:3520
    s_waitcnt lgkmcnt(9)
    v_mfma_f32_16x16x32_bf16 v[76:79], v[124:127], a[52:55], v[76:79]
    ds_read_b128 v[164:167], v6 offset:3552
    s_waitcnt lgkmcnt(9)
    v_mfma_f32_16x16x32_bf16 v[60:63], v[128:131], a[48:51], v[60:63]
    ds_read_b128 v[168:171], v6 offset:3584
    s_waitcnt lgkmcnt(9)
    v_mfma_f32_16x16x32_bf16 v[76:79], v[132:135], a[48:51], v[76:79]
    ds_read_b128 v[172:175], v6 offset:3616
    s_waitcnt lgkmcnt(9)
    v_mfma_f32_16x16x32_bf16 v[60:63], v[136:139], a[44:47], v[60:63]
    ds_read_b128 v[112:115], v6 offset:3648
    s_waitcnt lgkmcnt(9)
    v_mfma_f32_16x16x32_bf16 v[76:79], v[140:143], a[44:47], v[76:79]
    ds_read_b128 v[116:119], v6 offset:3680
    s_waitcnt lgkmcnt(9)
    v_mfma_f32_16x16x32_bf16 v[60:63], v[144:147], a[40:43], v[60:63]
    ds_read_b128 v[120:123], v6 offset:3712
    s_waitcnt lgkmcnt(9)
    v_mfma_f32_16x16x32_bf16 v[76:79], v[148:151], a[40:43], v[76:79]
    ds_read_b128 v[124:127], v6 offset:3744
    s_waitcnt lgkmcnt(9)
    v_mfma_f32_16x16x32_bf16 v[60:63], v[152:155], a[36:39], v[60:63]
    ds_read_b128 v[128:131], v6 offset:3776
    s_waitcnt lgkmcnt(9)
    v_mfma_f32_16x16x32_bf16 v[76:79], v[156:159], a[36:39], v[76:79]
    ds_read_b128 v[132:135], v6 offset:3808
    s_waitcnt lgkmcnt(9)
    v_mfma_f32_16x16x32_bf16 v[60:63], v[160:163], a[32:35], v[60:63]
    ds_read_b128 v[136:139], v6 offset:3840
    s_waitcnt lgkmcnt(9)
    v_mfma_f32_16x16x32_bf16 v[76:79], v[164:167], a[32:35], v[76:79]
    ds_read_b128 v[140:143], v6 offset:3872
    s_waitcnt lgkmcnt(9)
    v_mfma_f32_16x16x32_bf16 v[60:63], v[168:171], a[28:31], v[60:63]
    ds_read_b128 v[144:147], v6 offset:3904
    s_waitcnt lgkmcnt(9)
    v_mfma_f32_16x16x32_bf16 v[76:79], v[172:175], a[28:31], v[76:79]
    ds_read_b128 v[148:151], v6 offset:3936
    s_waitcnt lgkmcnt(9)
    v_mfma_f32_16x16x32_bf16 v[60:63], v[112:115], a[24:27], v[60:63]
    ds_read_b128 v[152:155], v6 offset:3968
    s_waitcnt lgkmcnt(9)
    v_mfma_f32_16x16x32_bf16 v[76:79], v[116:119], a[24:27], v[76:79]
    ds_read_b128 v[156:159], v6 offset:4000
    s_waitcnt lgkmcnt(9)
    v_mfma_f32_16x16x32_bf16 v[60:63], v[120:123], a[20:23], v[60:63]
    ds_read_b128 v[160:163], v6 offset:4032
    s_waitcnt lgkmcnt(9)
    v_mfma_f32_16x16x32_bf16 v[76:79], v[124:127], a[20:23], v[76:79]
    ds_read_b128 v[164:167], v6 offset:4064
    s_waitcnt lgkmcnt(9)
    v_mfma_f32_16x16x32_bf16 v[60:63], v[128:131], a[16:19], v[60:63]
    s_waitcnt vmcnt(2)
    ds_read_b128 a[60:63], v7 offset:240
    s_waitcnt lgkmcnt(9)
    v_mfma_f32_16x16x32_bf16 v[76:79], v[132:135], a[16:19], v[76:79]
    s_waitcnt lgkmcnt(8)
    v_mfma_f32_16x16x32_bf16 v[60:63], v[136:139], a[12:15], v[60:63]
    ds_read_b128 a[124:127], v7 offset:496
    s_waitcnt lgkmcnt(8)
    v_mfma_f32_16x16x32_bf16 v[76:79], v[140:143], a[12:15], v[76:79]
    s_waitcnt lgkmcnt(7)
    v_mfma_f32_16x16x32_bf16 v[60:63], v[144:147], a[8:11], v[60:63]
    ds_read_b128 a[188:191], v7 offset:752
    s_waitcnt lgkmcnt(7)
    v_mfma_f32_16x16x32_bf16 v[76:79], v[148:151], a[8:11], v[76:79]
    s_waitcnt lgkmcnt(6)
    v_mfma_f32_16x16x32_bf16 v[60:63], v[152:155], a[4:7], v[60:63]
    ds_read_b128 a[252:255], v7 offset:1008
    s_waitcnt lgkmcnt(6)
    v_mfma_f32_16x16x32_bf16 v[76:79], v[156:159], a[4:7], v[76:79]
    s_waitcnt lgkmcnt(5)
    v_mfma_f32_16x16x32_bf16 v[60:63], v[160:163], a[0:3], v[60:63]
    ds_read_b128 v[168:171], v6 offset:0
    s_waitcnt lgkmcnt(5)
    v_mfma_f32_16x16x32_bf16 v[76:79], v[164:167], a[0:3], v[76:79]
    ds_read_b128 v[172:175], v6 offset:32
    s_add_u32 s41, s38, 4096
    v_cvt_pk_bf16_f32 v80, v16, v48
    v_cvt_pk_bf16_f32 v81, v17, v49
    v_cvt_pk_bf16_f32 v82, v18, v50
    v_cvt_pk_bf16_f32 v83, v19, v51
    buffer_store_dwordx4 v[80:83], v228, s[8:11], s38 offen offset:0 sc1
    v_cvt_pk_bf16_f32 v84, v32, v64
    v_cvt_pk_bf16_f32 v85, v33, v65
    v_cvt_pk_bf16_f32 v86, v34, v66
    v_cvt_pk_bf16_f32 v87, v35, v67
    buffer_store_dwordx4 v[84:87], v228, s[8:11], s38 offen offset:64 sc1
    v_cvt_pk_bf16_f32 v88, v20, v52
    v_cvt_pk_bf16_f32 v89, v21, v53
    v_cvt_pk_bf16_f32 v90, v22, v54
    v_cvt_pk_bf16_f32 v91, v23, v55
    buffer_store_dwordx4 v[88:91], v228, s[8:11], s38 offen offset:2048 sc1
    v_cvt_pk_bf16_f32 v92, v36, v68
    v_cvt_pk_bf16_f32 v93, v37, v69
    v_cvt_pk_bf16_f32 v94, v38, v70
    v_cvt_pk_bf16_f32 v95, v39, v71
    buffer_store_dwordx4 v[92:95], v228, s[8:11], s38 offen offset:2112 sc1
    v_cvt_pk_bf16_f32 v96, v24, v56
    v_cvt_pk_bf16_f32 v97, v25, v57
    v_cvt_pk_bf16_f32 v98, v26, v58
    v_cvt_pk_bf16_f32 v99, v27, v59
    buffer_store_dwordx4 v[96:99], v228, s[8:11], s41 offen offset:0 sc1
    v_cvt_pk_bf16_f32 v100, v40, v72
    v_cvt_pk_bf16_f32 v101, v41, v73
    v_cvt_pk_bf16_f32 v102, v42, v74
    v_cvt_pk_bf16_f32 v103, v43, v75
    buffer_store_dwordx4 v[100:103], v228, s[8:11], s41 offen offset:64 sc1
    v_cvt_pk_bf16_f32 v104, v28, v60
    v_cvt_pk_bf16_f32 v105, v29, v61
    v_cvt_pk_bf16_f32 v106, v30, v62
    v_cvt_pk_bf16_f32 v107, v31, v63
    buffer_store_dwordx4 v[104:107], v228, s[8:11], s41 offen offset:2048 sc1
    v_cvt_pk_bf16_f32 v108, v44, v76
    v_cvt_pk_bf16_f32 v109, v45, v77
    v_cvt_pk_bf16_f32 v110, v46, v78
    v_cvt_pk_bf16_f32 v111, v47, v79
    buffer_store_dwordx4 v[108:111], v228, s[8:11], s41 offen offset:2112 sc1
    s_add_u32 s38, s38, 8192
    s_add_u32 s42, s42, 1
    s_cmp_lt_u32 s42, 4
    s_cbranch_scc1 .cvl_454

    s_waitcnt vmcnt(0) lgkmcnt(0)
    s_barrier
    s_mov_b32 s5, 160
    s_cmp_lg_u32 s24, 0
    s_cbranch_scc1 .sg_455
    s_mov_b64 exec, 1
    v_mov_b32 v4, 1
    v_mov_b32 v5, 0
    buffer_atomic_add v4, v5, s[20:23], s5 offen sc1
    s_mov_b64 exec, -1

.sg_455:
    v_and_b32 v1, 63, v0
    v_and_b32 v2, 15, v1
    v_lshrrev_b32 v3, 4, v1

    s_sub_u32 s4, s26, 24
    s_lshr_b32 s25, s4, 1
    s_and_b32 s4, s4, 1
    s_lshl_b32 s4, s4, 2
    s_lshl_b32 s5, s91, 3
    s_add_u32 s4, s4, s5
    s_add_u32 s26, s4, s24
    s_lshl_b32 s35, s26, 8
    s_add_u32 s35, s35, 92274688
    s_mov_b32 s37, 0x3db504f3
    s_mov_b32 s38, 0x3fb8aa3b
    v_lshlrev_b32 v8, 4, v1
    v_min_u32 v9, 2, v1
    v_lshlrev_b32 v9, 13, v9
    v_lshlrev_b32 v6, 4, v3
    v_and_b32 v5, 7, v2
    v_add_u32 v10, v6, v5
    v_lshlrev_b32 v10, 4, v10
    v_lshlrev_b32 v11, 4, v2
    v_lshlrev_b32 v5, 3, v3
    v_add_u32 v11, v11, v5
    v_cmp_gt_u32 s[60:61], 32, v1
    v_lshlrev_b32 v5, 2, v3
    v_mov_b32 v12, 0
    v_mov_b32 v13, 0
    v_mov_b32 v14, 0xff800000
    v_lshlrev_b32 v204, 9, v1
    v_add_u32 v204, 4604, v204
    s_lshl_b32 s4, s25, 5
    s_add_u32 s4, s4, s26
    s_lshl_b32 s27, s4, 13
    s_mul_i32 s33, s4, 6144
    s_add_u32 s33, s33, 67108864
    s_add_u32 s36, s25, 1

    v_add_u32 v7, 0, v5
    v_cmp_le_u32 s[40:41], v7, v2
    v_add_u32 v7, 1, v5
    v_cmp_le_u32 s[42:43], v7, v2
    v_add_u32 v7, 2, v5
    v_cmp_le_u32 s[44:45], v7, v2
    v_add_u32 v7, 3, v5
    v_cmp_le_u32 s[46:47], v7, v2
    v_mov_b32 v112, 0
    v_mov_b32 v113, 0
    v_mov_b32 v114, 0
    v_mov_b32 v115, 0
    v_mov_b32 v116, 0
    v_mov_b32 v117, 0
    v_mov_b32 v118, 0
    v_mov_b32 v119, 0
    v_mov_b32 v120, 0
    v_mov_b32 v121, 0
    v_mov_b32 v122, 0
    v_mov_b32 v123, 0
    v_mov_b32 v124, 0
    v_mov_b32 v125, 0
    v_mov_b32 v126, 0
    v_mov_b32 v127, 0
    v_mov_b32 v128, 0
    v_mov_b32 v129, 0
    v_mov_b32 v130, 0
    v_mov_b32 v131, 0
    v_mov_b32 v132, 0
    v_mov_b32 v133, 0
    v_mov_b32 v134, 0
    v_mov_b32 v135, 0
    v_mov_b32 v136, 0
    v_mov_b32 v137, 0
    v_mov_b32 v138, 0
    v_mov_b32 v139, 0
    v_mov_b32 v140, 0
    v_mov_b32 v141, 0
    v_mov_b32 v142, 0
    v_mov_b32 v143, 0
    s_bitcmp1_b32 s97, 4
    s_cselect_b32 s96, 999, 64
    v_mov_b32 v15, -1
    s_mov_b32 s62, 0
    s_mov_b64 exec, 7
.wf_456:
    buffer_load_dword v15, v9, s[8:11], s35 offen sc1
    s_waitcnt vmcnt(0)
    v_cmp_gt_u32 vcc, s36, v15
    s_cbranch_vccz .wfd_457
    s_sleep 2
    s_add_u32 s62, s62, 1
    s_cmp_gt_u32 s62, 0x400000
    s_cbranch_scc1 .mg_end_1
    s_branch .wf_456

.wfd_457:
    s_mov_b64 exec, -1
    s_add_u32 s28, s27, 4096
    s_add_u32 s29, s27, 16777216
    s_add_u32 s30, s27, 16781312
    s_add_u32 s31, s27, 33554432
    s_add_u32 s32, s27, 33558528

    buffer_load_dwordx4 a[0:3], v8, s[8:11], s27 offen offset:0
    buffer_load_dwordx4 a[16:19], v8, s[8:11], s28 offen offset:0
    buffer_load_dwordx4 a[32:35], v8, s[8:11], s29 offen offset:0
    buffer_load_dwordx4 a[48:51], v8, s[8:11], s30 offen offset:0
    buffer_load_dwordx4 a[4:7], v8, s[8:11], s27 offen offset:1024
    buffer_load_dwordx4 a[20:23], v8, s[8:11], s28 offen offset:1024
    buffer_load_dwordx4 a[36:39], v8, s[8:11], s29 offen offset:1024
    buffer_load_dwordx4 a[52:55], v8, s[8:11], s30 offen offset:1024
    buffer_load_dwordx4 a[8:11], v8, s[8:11], s27 offen offset:2048
    buffer_load_dwordx4 a[24:27], v8, s[8:11], s28 offen offset:2048
    buffer_load_dwordx4 a[40:43], v8, s[8:11], s29 offen offset:2048
    buffer_load_dwordx4 a[56:59], v8, s[8:11], s30 offen offset:2048
    buffer_load_dwordx4 a[12:15], v8, s[8:11], s27 offen offset:3072
    buffer_load_dwordx4 a[28:31], v8, s[8:11], s28 offen offset:3072
    buffer_load_dwordx4 a[44:47], v8, s[8:11], s29 offen offset:3072
    buffer_load_dwordx4 a[60:63], v8, s[8:11], s30 offen offset:3072
    buffer_load_dwordx4 a[64:67], v8, s[8:11], s31 offen offset:0
    buffer_load_dwordx4 a[68:71], v8, s[8:11], s31 offen offset:1024
    buffer_load_dwordx4 a[72:75], v8, s[8:11], s31 offen offset:2048
    buffer_load_dwordx4 a[76:79], v8, s[8:11], s31 offen offset:3072
    buffer_load_dwordx4 a[80:83], v8, s[8:11], s32 offen offset:0
    buffer_load_dwordx4 a[84:87], v8, s[8:11], s32 offen offset:1024
    buffer_load_dwordx4 a[88:91], v8, s[8:11], s32 offen offset:2048
    buffer_load_dwordx4 a[92:95], v8, s[8:11], s32 offen offset:3072
    buffer_load_dwordx4 v[80:83], v10, s[8:11], s33 offen offset:2048 sc1
    buffer_load_dwordx4 v[84:87], v10, s[8:11], s33 offen offset:2176 sc1
    buffer_load_dwordx4 v[88:91], v10, s[8:11], s33 offen offset:3072 sc1
    buffer_load_dwordx4 v[92:95], v10, s[8:11], s33 offen offset:3200 sc1
    s_add_u32 s4, s33, 4096
    s_mov_b64 exec, s[60:61]
    buffer_load_dwordx2 v[128:129], v11, s[8:11], s4 offen offset:0 sc1
    buffer_load_dwordx2 v[130:131], v11, s[8:11], s4 offen offset:256 sc1
    buffer_load_dwordx2 v[132:133], v11, s[8:11], s4 offen offset:512 sc1
    buffer_load_dwordx2 v[134:135], v11, s[8:11], s4 offen offset:768 sc1
    buffer_load_dwordx2 v[136:137], v11, s[8:11], s4 offen offset:1024 sc1
    buffer_load_dwordx2 v[138:139], v11, s[8:11], s4 offen offset:1280 sc1
    buffer_load_dwordx2 v[140:141], v11, s[8:11], s4 offen offset:1536 sc1
    buffer_load_dwordx2 v[142:143], v11, s[8:11], s4 offen offset:1792 sc1
    s_mov_b64 exec, -1
    s_waitcnt vmcnt(0)
.att_458:
    s_mov_b32 s34, s33
    s_add_u32 s50, s27, 0
    s_add_u32 s51, s27, 4096
    s_cmp_lt_u32 s25, 60
    s_cselect_b32 s4, 4, 0
    s_cselect_b32 s5, 1048576, 0
    s_cselect_b32 s6, 786432, 0
    s_add_u32 s36, s36, s4
    s_add_u32 s27, s27, s5
    s_add_u32 s33, s33, s6
    s_waitcnt vmcnt(8)

    v_cmp_gt_u32 vcc, s36, v15
    s_cbranch_vccnz .atw_459
.atb_460:
    s_add_u32 s28, s27, 4096
    s_add_u32 s29, s27, 16777216
    s_add_u32 s30, s27, 16781312
    s_add_u32 s31, s27, 33554432
    s_add_u32 s32, s27, 33558528

    buffer_load_dwordx4 a[96:99], v8, s[8:11], s27 offen offset:0
    buffer_load_dwordx4 a[112:115], v8, s[8:11], s28 offen offset:0
    buffer_load_dwordx4 a[128:131], v8, s[8:11], s29 offen offset:0
    buffer_load_dwordx4 a[144:147], v8, s[8:11], s30 offen offset:0
    buffer_load_dwordx4 a[100:103], v8, s[8:11], s27 offen offset:1024
    buffer_load_dwordx4 a[116:119], v8, s[8:11], s28 offen offset:1024
    buffer_load_dwordx4 a[132:135], v8, s[8:11], s29 offen offset:1024
    buffer_load_dwordx4 a[148:151], v8, s[8:11], s30 offen offset:1024
    buffer_load_dwordx4 a[104:107], v8, s[8:11], s27 offen offset:2048
    buffer_load_dwordx4 a[120:123], v8, s[8:11], s28 offen offset:2048
    buffer_load_dwordx4 a[136:139], v8, s[8:11], s29 offen offset:2048
    buffer_load_dwordx4 a[152:155], v8, s[8:11], s30 offen offset:2048
    buffer_load_dwordx4 a[108:111], v8, s[8:11], s27 offen offset:3072
    buffer_load_dwordx4 a[124:127], v8, s[8:11], s28 offen offset:3072
    buffer_load_dwordx4 a[140:143], v8, s[8:11], s29 offen offset:3072
    buffer_load_dwordx4 a[156:159], v8, s[8:11], s30 offen offset:3072
    buffer_load_dwordx4 a[160:163], v8, s[8:11], s31 offen offset:0
    buffer_load_dwordx4 a[164:167], v8, s[8:11], s31 offen offset:1024
    buffer_load_dwordx4 a[168:171], v8, s[8:11], s31 offen offset:2048
    buffer_load_dwordx4 a[172:175], v8, s[8:11], s31 offen offset:3072
    buffer_load_dwordx4 a[176:179], v8, s[8:11], s32 offen offset:0
    buffer_load_dwordx4 a[180:183], v8, s[8:11], s32 offen offset:1024
    buffer_load_dwordx4 a[184:187], v8, s[8:11], s32 offen offset:2048
    buffer_load_dwordx4 a[188:191], v8, s[8:11], s32 offen offset:3072
    buffer_load_dwordx4 v[96:99], v10, s[8:11], s33 offen offset:2048 sc1
    buffer_load_dwordx4 v[100:103], v10, s[8:11], s33 offen offset:2176 sc1
    buffer_load_dwordx4 v[104:107], v10, s[8:11], s33 offen offset:3072 sc1
    buffer_load_dwordx4 v[108:111], v10, s[8:11], s33 offen offset:3200 sc1
    s_add_u32 s4, s33, 4096
    s_mov_b64 exec, s[60:61]
    buffer_load_dwordx2 v[112:113], v11, s[8:11], s4 offen offset:0 sc1
    buffer_load_dwordx2 v[114:115], v11, s[8:11], s4 offen offset:256 sc1
    buffer_load_dwordx2 v[116:117], v11, s[8:11], s4 offen offset:512 sc1
    buffer_load_dwordx2 v[118:119], v11, s[8:11], s4 offen offset:768 sc1
    buffer_load_dwordx2 v[120:121], v11, s[8:11], s4 offen offset:1024 sc1
    buffer_load_dwordx2 v[122:123], v11, s[8:11], s4 offen offset:1280 sc1
    buffer_load_dwordx2 v[124:125], v11, s[8:11], s4 offen offset:1536 sc1
    buffer_load_dwordx2 v[126:127], v11, s[8:11], s4 offen offset:1792 sc1
    s_mov_b64 exec, -1
    v_mfma_f32_16x16x32_bf16 v[144:147], a[32:35], a[0:3], 0
    v_mfma_f32_16x16x32_bf16 v[156:159], a[32:35], a[16:19], 0
    v_mfma_f32_16x16x32_bf16 v[160:163], a[48:51], a[16:19], 0
    v_mfma_f32_16x16x32_bf16 v[144:147], a[36:39], a[4:7], v[144:147]
    v_mfma_f32_16x16x32_bf16 v[156:159], a[36:39], a[20:23], v[156:159]
    v_mfma_f32_16x16x32_bf16 v[160:163], a[52:55], a[20:23], v[160:163]
    v_mfma_f32_16x16x32_bf16 v[144:147], a[40:43], a[8:11], v[144:147]
    v_mfma_f32_16x16x32_bf16 v[156:159], a[40:43], a[24:27], v[156:159]
    v_mfma_f32_16x16x32_bf16 v[160:163], a[56:59], a[24:27], v[160:163]
    v_mfma_f32_16x16x32_bf16 v[144:147], a[44:47], a[12:15], v[144:147]
    v_mfma_f32_16x16x32_bf16 v[156:159], a[44:47], a[28:31], v[156:159]
    v_mfma_f32_16x16x32_bf16 v[160:163], a[60:63], a[28:31], v[160:163]
    s_nop 7
    v_cvt_pk_bf16_f32 v168, v144, v145
    v_cvt_pk_bf16_f32 v170, v146, v147
    v_and_b32 v169, 0xffff0000, v168
    v_lshlrev_b32 v168, 16, v168
    v_and_b32 v171, 0xffff0000, v170
    v_lshlrev_b32 v170, 16, v170
    v_mul_f32 v168, s37, v168
    v_mul_f32 v169, s37, v169
    v_mul_f32 v170, s37, v170
    v_mul_f32 v171, s37, v171
    v_cvt_pk_bf16_f32 v144, v168, v169
    v_cvt_pk_bf16_f32 v146, v170, v171
    v_and_b32 v145, 0xffff0000, v144
    v_lshlrev_b32 v144, 16, v144
    v_and_b32 v147, 0xffff0000, v146
    v_lshlrev_b32 v146, 16, v146
    v_cvt_pk_bf16_f32 v192, v156, v157
    v_cvt_pk_bf16_f32 v194, v158, v159
    v_cvt_pk_bf16_f32 v196, v160, v161
    v_cvt_pk_bf16_f32 v198, v162, v163
    v_and_b32 v193, 0xffff0000, v192
    v_lshlrev_b32 v192, 16, v192
    v_and_b32 v195, 0xffff0000, v194
    v_lshlrev_b32 v194, 16, v194
    v_and_b32 v197, 0xffff0000, v196
    v_lshlrev_b32 v196, 16, v196
    v_and_b32 v199, 0xffff0000, v198
    v_lshlrev_b32 v198, 16, v198
    v_mul_f32 v192, s37, v192
    v_mul_f32 v193, s37, v193
    v_mul_f32 v194, s37, v194
    v_mul_f32 v195, s37, v195
    v_mul_f32 v196, s37, v196
    v_mul_f32 v197, s37, v197
    v_mul_f32 v198, s37, v198
    v_mul_f32 v199, s37, v199
    v_cvt_pk_bf16_f32 v156, v192, v193
    v_cvt_pk_bf16_f32 v158, v194, v195
    v_cvt_pk_bf16_f32 v160, v196, v197
    v_cvt_pk_bf16_f32 v162, v198, v199
    v_and_b32 v157, 0xffff0000, v156
    v_lshlrev_b32 v156, 16, v156
    v_and_b32 v159, 0xffff0000, v158
    v_lshlrev_b32 v158, 16, v158
    v_and_b32 v161, 0xffff0000, v160
    v_lshlrev_b32 v160, 16, v160
    v_and_b32 v163, 0xffff0000, v162
    v_lshlrev_b32 v162, 16, v162
    v_cndmask_b32 v144, v14, v144, s[40:41]
    v_cndmask_b32 v145, v14, v145, s[42:43]
    v_cndmask_b32 v146, v14, v146, s[44:45]
    v_cndmask_b32 v147, v14, v147, s[46:47]
    v_cndmask_b32 v160, v14, v160, s[40:41]
    v_cndmask_b32 v161, v14, v161, s[42:43]
    v_cndmask_b32 v162, v14, v162, s[44:45]
    v_cndmask_b32 v163, v14, v163, s[46:47]
    s_mov_b32 s62, 0
.kmp_461:
    v_max3_u32 v4, v80, v81, v82
    v_max3_u32 v5, v83, v84, v85
    v_max3_u32 v4, v4, v86, v87
    v_max3_u32 v5, v5, v88, v89
    v_max3_u32 v4, v4, v90, v91
    v_max3_u32 v5, v5, v92, v93
    v_max3_u32 v4, v4, v94, v95
    v_max3_u32 v5, v5, v128, v129
    v_max3_u32 v4, v4, v130, v131
    v_max3_u32 v5, v5, v132, v133
    v_max3_u32 v4, v4, v134, v135
    v_max3_u32 v5, v5, v136, v137
    v_max3_u32 v4, v4, v138, v139
    v_max3_u32 v5, v5, v140, v141
    v_max3_u32 v4, v4, v142, v143
    v_max_u32 v4, v4, v5
    v_cmp_eq_u32 vcc, -1, v4
    s_cbranch_vccnz .kmf_462

    v_mfma_f32_16x16x32_bf16 v[152:155], v[80:83], a[0:3], 0
    v_mfma_f32_16x16x32_bf16 v[164:167], v[80:83], a[16:19], 0
    v_mfma_f32_16x16x32_bf16 v[152:155], v[84:87], a[4:7], v[152:155]
    v_mfma_f32_16x16x32_bf16 v[164:167], v[84:87], a[20:23], v[164:167]
    v_mfma_f32_16x16x32_bf16 v[152:155], v[88:91], a[8:11], v[152:155]
    v_mfma_f32_16x16x32_bf16 v[164:167], v[88:91], a[24:27], v[164:167]
    v_mfma_f32_16x16x32_bf16 v[152:155], v[92:95], a[12:15], v[152:155]
    v_mfma_f32_16x16x32_bf16 v[164:167], v[92:95], a[28:31], v[164:167]
    s_nop 5
    v_cvt_pk_bf16_f32 v176, v152, v153
    v_cvt_pk_bf16_f32 v178, v154, v155
    v_and_b32 v177, 0xffff0000, v176
    v_lshlrev_b32 v176, 16, v176
    v_and_b32 v179, 0xffff0000, v178
    v_lshlrev_b32 v178, 16, v178
    v_mul_f32 v176, s37, v176
    v_mul_f32 v177, s37, v177
    v_mul_f32 v178, s37, v178
    v_mul_f32 v179, s37, v179
    v_cvt_pk_bf16_f32 v152, v176, v177
    v_cvt_pk_bf16_f32 v154, v178, v179
    v_and_b32 v153, 0xffff0000, v152
    v_lshlrev_b32 v152, 16, v152
    v_and_b32 v155, 0xffff0000, v154
    v_lshlrev_b32 v154, 16, v154
    v_cndmask_b32 v152, v14, v152, s[60:61]
    v_cndmask_b32 v153, v14, v153, s[60:61]
    v_cndmask_b32 v154, v14, v154, s[60:61]
    v_cndmask_b32 v155, v14, v155, s[60:61]
    v_cvt_pk_bf16_f32 v200, v164, v165
    v_cvt_pk_bf16_f32 v202, v166, v167
    v_and_b32 v201, 0xffff0000, v200
    v_lshlrev_b32 v200, 16, v200
    v_and_b32 v203, 0xffff0000, v202
    v_lshlrev_b32 v202, 16, v202
    v_mul_f32 v200, s37, v200
    v_mul_f32 v201, s37, v201
    v_mul_f32 v202, s37, v202
    v_mul_f32 v203, s37, v203
    v_cvt_pk_bf16_f32 v164, v200, v201
    v_cvt_pk_bf16_f32 v166, v202, v203
    v_and_b32 v165, 0xffff0000, v164
    v_lshlrev_b32 v164, 16, v164
    v_and_b32 v167, 0xffff0000, v166
    v_lshlrev_b32 v166, 16, v166
    v_cndmask_b32 v164, v14, v164, s[60:61]
    v_cndmask_b32 v165, v14, v165, s[60:61]
    v_cndmask_b32 v166, v14, v166, s[60:61]
    v_cndmask_b32 v167, v14, v167, s[60:61]
    v_max3_f32 v4, v144, v145, v146
    v_max3_f32 v5, v147, v152, v153
    v_max3_f32 v4, v4, v154, v155
    v_max_f32 v4, v4, v5

    v_max3_f32 v6, v156, v157, v158
    v_max3_f32 v7, v159, v160, v161
    v_max3_f32 v6, v6, v162, v163
    v_max3_f32 v7, v7, v164, v165
    v_max3_f32 v6, v6, v166, v167
    v_max_f32 v6, v6, v7

    v_mov_b32 v5, v4
    v_mov_b32 v7, v6
    s_nop 0
    v_permlane32_swap_b32 v4, v5
    v_permlane32_swap_b32 v6, v7
    v_max_f32 v4, v4, v5
    v_max_f32 v6, v6, v7

    v_mov_b32 v5, v4
    v_mov_b32 v7, v6
    s_nop 0
    v_permlane16_swap_b32 v4, v5
    v_permlane16_swap_b32 v6, v7
    v_max_f32 v4, v4, v5
    v_max_f32 v6, v6, v7

    v_mul_f32 v4, s38, v4
    v_mul_f32 v6, s38, v6
    v_fma_f32 v168, v144, s38, -v4
    v_fma_f32 v169, v145, s38, -v4
    v_fma_f32 v170, v146, s38, -v4
    v_fma_f32 v171, v147, s38, -v4
    v_fma_f32 v176, v152, s38, -v4
    v_fma_f32 v177, v153, s38, -v4
    v_fma_f32 v178, v154, s38, -v4
    v_fma_f32 v179, v155, s38, -v4
    v_fma_f32 v192, v156, s38, -v6
    v_fma_f32 v193, v157, s38, -v6
    v_fma_f32 v194, v158, s38, -v6
    v_fma_f32 v195, v159, s38, -v6
    v_fma_f32 v196, v160, s38, -v6
    v_fma_f32 v197, v161, s38, -v6
    v_fma_f32 v198, v162, s38, -v6
    v_fma_f32 v199, v163, s38, -v6
    v_fma_f32 v200, v164, s38, -v6
    v_fma_f32 v201, v165, s38, -v6
    v_fma_f32 v202, v166, s38, -v6
    v_fma_f32 v203, v167, s38, -v6
    v_exp_f32 v168, v168
    v_exp_f32 v169, v169
    v_exp_f32 v170, v170
    v_exp_f32 v171, v171
    v_exp_f32 v176, v176
    v_exp_f32 v177, v177
    v_exp_f32 v178, v178
    v_exp_f32 v179, v179
    v_exp_f32 v192, v192
    v_exp_f32 v193, v193
    v_exp_f32 v194, v194
    v_exp_f32 v195, v195
    v_exp_f32 v196, v196
    v_exp_f32 v197, v197
    v_exp_f32 v198, v198
    v_exp_f32 v199, v199
    v_exp_f32 v200, v200
    v_exp_f32 v201, v201
    v_exp_f32 v202, v202
    v_exp_f32 v203, v203
    v_add_f32 v4, v168, v169
    v_add_f32 v5, v170, v171
    v_add_f32 v4, v4, v176
    v_add_f32 v5, v5, v177
    v_add_f32 v4, v4, v178
    v_add_f32 v5, v5, v179
    v_add_f32 v4, v4, v5
    v_add_f32 v6, v192, v193
    v_add_f32 v7, v194, v195
    v_add_f32 v6, v6, v196
    v_add_f32 v7, v7, v197
    v_add_f32 v6, v6, v198
    v_add_f32 v7, v7, v199
    v_add_f32 v6, v6, v200
    v_add_f32 v7, v7, v201
    v_add_f32 v6, v6, v202
    v_add_f32 v7, v7, v203
    v_add_f32 v6, v6, v7
    v_mov_b32 v5, v4
    v_mov_b32 v7, v6
    s_nop 0
    v_permlane32_swap_b32 v4, v5
    v_permlane32_swap_b32 v6, v7
    v_add_f32 v4, v4, v5
    v_add_f32 v6, v6, v7

    v_mov_b32 v5, v4
    v_mov_b32 v7, v6
    s_nop 0
    v_permlane16_swap_b32 v4, v5
    v_permlane16_swap_b32 v6, v7
    v_add_f32 v4, v4, v5
    v_add_f32 v6, v6, v7

    v_rcp_f32 v4, v4
    v_rcp_f32 v6, v6
    v_mov_b32 v182, 0
    v_mov_b32 v183, 0
    v_mul_f32 v168, v4, v168
    v_mul_f32 v169, v4, v169
    v_mul_f32 v170, v4, v170
    v_mul_f32 v171, v4, v171
    v_mul_f32 v176, v4, v176
    v_mul_f32 v177, v4, v177
    v_mul_f32 v178, v4, v178
    v_mul_f32 v179, v4, v179
    v_cvt_pk_bf16_f32 v180, v168, v169
    v_cvt_pk_bf16_f32 v181, v170, v171
    v_cvt_pk_bf16_f32 v184, v176, v177
    v_cvt_pk_bf16_f32 v185, v178, v179
    v_mul_f32 v192, v6, v192
    v_mul_f32 v193, v6, v193
    v_mul_f32 v194, v6, v194
    v_mul_f32 v195, v6, v195
    v_mul_f32 v196, v6, v196
    v_mul_f32 v197, v6, v197
    v_mul_f32 v198, v6, v198
    v_mul_f32 v199, v6, v199
    v_mul_f32 v200, v6, v200
    v_mul_f32 v201, v6, v201
    v_mul_f32 v202, v6, v202
    v_mul_f32 v203, v6, v203
    v_cvt_pk_bf16_f32 v186, v192, v193
    v_cvt_pk_bf16_f32 v187, v194, v195
    v_cvt_pk_bf16_f32 v188, v196, v197
    v_cvt_pk_bf16_f32 v189, v198, v199
    v_cvt_pk_bf16_f32 v190, v200, v201
    v_cvt_pk_bf16_f32 v191, v202, v203
    s_add_u32 s25, s25, 4

    v_mfma_f32_16x16x32_bf16 v[16:19], a[64:67], v[180:183], 0
    v_mfma_f32_16x16x32_bf16 v[20:23], a[68:71], v[180:183], 0
    v_mfma_f32_16x16x32_bf16 v[24:27], a[72:75], v[180:183], 0
    v_mfma_f32_16x16x32_bf16 v[28:31], a[76:79], v[180:183], 0
    v_mfma_f32_16x16x32_bf16 v[32:35], a[80:83], v[180:183], 0
    v_mfma_f32_16x16x32_bf16 v[36:39], a[84:87], v[180:183], 0
    v_mfma_f32_16x16x32_bf16 v[40:43], a[88:91], v[180:183], 0
    v_mfma_f32_16x16x32_bf16 v[44:47], a[92:95], v[180:183], 0
    v_mfma_f32_16x16x32_bf16 v[48:51], a[64:67], v[186:189], 0
    v_mfma_f32_16x16x32_bf16 v[52:55], a[68:71], v[186:189], 0
    v_mfma_f32_16x16x32_bf16 v[56:59], a[72:75], v[186:189], 0
    v_mfma_f32_16x16x32_bf16 v[60:63], a[76:79], v[186:189], 0
    v_mfma_f32_16x16x32_bf16 v[64:67], a[80:83], v[186:189], 0
    v_mfma_f32_16x16x32_bf16 v[68:71], a[84:87], v[186:189], 0
    v_mfma_f32_16x16x32_bf16 v[72:75], a[88:91], v[186:189], 0
    v_mfma_f32_16x16x32_bf16 v[76:79], a[92:95], v[186:189], 0
    s_waitcnt vmcnt(36)
    s_bitcmp1_b32 s97, 4
    s_mov_b64 exec, 1
    s_cbranch_scc1 .fs_463
    buffer_store_dword v12, v13, s[8:11], s92 offen
.fj_464:
    s_mov_b64 exec, -1
    s_cmp_lt_u32 s25, s96
    s_cbranch_scc1 .os_465
    v_mfma_f32_16x16x16_bf16 v[16:19], v[128:129], v[184:185], v[16:19]
    v_mfma_f32_16x16x16_bf16 v[20:23], v[130:131], v[184:185], v[20:23]
    v_add_u32 v12, 1, v12
    v_mfma_f32_16x16x16_bf16 v[24:27], v[132:133], v[184:185], v[24:27]
    v_mfma_f32_16x16x16_bf16 v[28:31], v[134:135], v[184:185], v[28:31]
    v_mfma_f32_16x16x16_bf16 v[32:35], v[136:137], v[184:185], v[32:35]
    v_mfma_f32_16x16x16_bf16 v[36:39], v[138:139], v[184:185], v[36:39]
    v_cvt_pk_bf16_f32 v208, v16, v17
    v_cvt_pk_bf16_f32 v209, v18, v19
    v_cvt_pk_bf16_f32 v210, v20, v21
    v_cvt_pk_bf16_f32 v211, v22, v23
    buffer_store_dwordx4 v[208:211], v8, s[8:11], s50 offen offset:0
    v_mfma_f32_16x16x16_bf16 v[40:43], v[140:141], v[184:185], v[40:43]
    v_mfma_f32_16x16x16_bf16 v[44:47], v[142:143], v[184:185], v[44:47]
    v_cvt_pk_bf16_f32 v212, v24, v25
    v_cvt_pk_bf16_f32 v213, v26, v27
    v_cvt_pk_bf16_f32 v214, v28, v29
    v_cvt_pk_bf16_f32 v215, v30, v31
    buffer_store_dwordx4 v[212:215], v8, s[8:11], s50 offen offset:1024
    v_mfma_f32_16x16x16_bf16 v[48:51], v[128:129], v[190:191], v[48:51]
    v_mfma_f32_16x16x16_bf16 v[52:55], v[130:131], v[190:191], v[52:55]
    v_cvt_pk_bf16_f32 v216, v32, v33
    v_cvt_pk_bf16_f32 v217, v34, v35
    v_cvt_pk_bf16_f32 v218, v36, v37
    v_cvt_pk_bf16_f32 v219, v38, v39
    buffer_store_dwordx4 v[216:219], v8, s[8:11], s50 offen offset:2048
    v_mfma_f32_16x16x16_bf16 v[56:59], v[132:133], v[190:191], v[56:59]
    v_mfma_f32_16x16x16_bf16 v[60:63], v[134:135], v[190:191], v[60:63]
    v_cvt_pk_bf16_f32 v220, v40, v41
    v_cvt_pk_bf16_f32 v221, v42, v43
    v_cvt_pk_bf16_f32 v222, v44, v45
    v_cvt_pk_bf16_f32 v223, v46, v47
    buffer_store_dwordx4 v[220:223], v8, s[8:11], s50 offen offset:3072
    v_mfma_f32_16x16x16_bf16 v[64:67], v[136:137], v[190:191], v[64:67]
    v_mfma_f32_16x16x16_bf16 v[68:71], v[138:139], v[190:191], v[68:71]
    v_cvt_pk_bf16_f32 v224, v48, v49
    v_cvt_pk_bf16_f32 v225, v50, v51
    v_cvt_pk_bf16_f32 v226, v52, v53
    v_cvt_pk_bf16_f32 v227, v54, v55
    buffer_store_dwordx4 v[224:227], v8, s[8:11], s51 offen offset:0
    v_mfma_f32_16x16x16_bf16 v[72:75], v[140:141], v[190:191], v[72:75]
    v_mfma_f32_16x16x16_bf16 v[76:79], v[142:143], v[190:191], v[76:79]
    v_cvt_pk_bf16_f32 v228, v56, v57
    v_cvt_pk_bf16_f32 v229, v58, v59
    v_cvt_pk_bf16_f32 v230, v60, v61
    v_cvt_pk_bf16_f32 v231, v62, v63
    buffer_store_dwordx4 v[228:231], v8, s[8:11], s51 offen offset:1024
    s_nop 3
    v_cvt_pk_bf16_f32 v232, v64, v65
    v_cvt_pk_bf16_f32 v233, v66, v67
    v_cvt_pk_bf16_f32 v234, v68, v69
    v_cvt_pk_bf16_f32 v235, v70, v71
    buffer_store_dwordx4 v[232:235], v8, s[8:11], s51 offen offset:2048
    v_cvt_pk_bf16_f32 v236, v72, v73
    v_cvt_pk_bf16_f32 v237, v74, v75
    v_cvt_pk_bf16_f32 v238, v76, v77
    v_cvt_pk_bf16_f32 v239, v78, v79
    buffer_store_dwordx4 v[236:239], v8, s[8:11], s51 offen offset:3072
.oj_466:
    s_mov_b32 s34, s33
    s_add_u32 s50, s27, 0
    s_add_u32 s51, s27, 4096
    s_cmp_lt_u32 s25, 60
    s_cselect_b32 s4, 4, 0
    s_cselect_b32 s5, 1048576, 0
    s_cselect_b32 s6, 786432, 0
    s_add_u32 s36, s36, s4
    s_add_u32 s27, s27, s5
    s_add_u32 s33, s33, s6
    s_waitcnt vmcnt(8)

    v_cmp_gt_u32 vcc, s36, v15
    s_cbranch_vccnz .atw_467
.atb_468:
    s_add_u32 s28, s27, 4096
    s_add_u32 s29, s27, 16777216
    s_add_u32 s30, s27, 16781312
    s_add_u32 s31, s27, 33554432
    s_add_u32 s32, s27, 33558528

    buffer_load_dwordx4 a[0:3], v8, s[8:11], s27 offen offset:0
    buffer_load_dwordx4 a[16:19], v8, s[8:11], s28 offen offset:0
    buffer_load_dwordx4 a[32:35], v8, s[8:11], s29 offen offset:0
    buffer_load_dwordx4 a[48:51], v8, s[8:11], s30 offen offset:0
    buffer_load_dwordx4 a[4:7], v8, s[8:11], s27 offen offset:1024
    buffer_load_dwordx4 a[20:23], v8, s[8:11], s28 offen offset:1024
    buffer_load_dwordx4 a[36:39], v8, s[8:11], s29 offen offset:1024
    buffer_load_dwordx4 a[52:55], v8, s[8:11], s30 offen offset:1024
    buffer_load_dwordx4 a[8:11], v8, s[8:11], s27 offen offset:2048
    buffer_load_dwordx4 a[24:27], v8, s[8:11], s28 offen offset:2048
    buffer_load_dwordx4 a[40:43], v8, s[8:11], s29 offen offset:2048
    buffer_load_dwordx4 a[56:59], v8, s[8:11], s30 offen offset:2048
    buffer_load_dwordx4 a[12:15], v8, s[8:11], s27 offen offset:3072
    buffer_load_dwordx4 a[28:31], v8, s[8:11], s28 offen offset:3072
    buffer_load_dwordx4 a[44:47], v8, s[8:11], s29 offen offset:3072
    buffer_load_dwordx4 a[60:63], v8, s[8:11], s30 offen offset:3072
    buffer_load_dwordx4 a[64:67], v8, s[8:11], s31 offen offset:0
    buffer_load_dwordx4 a[68:71], v8, s[8:11], s31 offen offset:1024
    buffer_load_dwordx4 a[72:75], v8, s[8:11], s31 offen offset:2048
    buffer_load_dwordx4 a[76:79], v8, s[8:11], s31 offen offset:3072
    buffer_load_dwordx4 a[80:83], v8, s[8:11], s32 offen offset:0
    buffer_load_dwordx4 a[84:87], v8, s[8:11], s32 offen offset:1024
    buffer_load_dwordx4 a[88:91], v8, s[8:11], s32 offen offset:2048
    buffer_load_dwordx4 a[92:95], v8, s[8:11], s32 offen offset:3072
    buffer_load_dwordx4 v[80:83], v10, s[8:11], s33 offen offset:2048 sc1
    buffer_load_dwordx4 v[84:87], v10, s[8:11], s33 offen offset:2176 sc1
    buffer_load_dwordx4 v[88:91], v10, s[8:11], s33 offen offset:3072 sc1
    buffer_load_dwordx4 v[92:95], v10, s[8:11], s33 offen offset:3200 sc1
    s_add_u32 s4, s33, 4096
    s_mov_b64 exec, s[60:61]
    buffer_load_dwordx2 v[128:129], v11, s[8:11], s4 offen offset:0 sc1
    buffer_load_dwordx2 v[130:131], v11, s[8:11], s4 offen offset:256 sc1
    buffer_load_dwordx2 v[132:133], v11, s[8:11], s4 offen offset:512 sc1
    buffer_load_dwordx2 v[134:135], v11, s[8:11], s4 offen offset:768 sc1
    buffer_load_dwordx2 v[136:137], v11, s[8:11], s4 offen offset:1024 sc1
    buffer_load_dwordx2 v[138:139], v11, s[8:11], s4 offen offset:1280 sc1
    buffer_load_dwordx2 v[140:141], v11, s[8:11], s4 offen offset:1536 sc1
    buffer_load_dwordx2 v[142:143], v11, s[8:11], s4 offen offset:1792 sc1
    s_mov_b64 exec, -1
    v_mfma_f32_16x16x32_bf16 v[144:147], a[128:131], a[96:99], 0
    v_mfma_f32_16x16x32_bf16 v[156:159], a[128:131], a[112:115], 0
    v_mfma_f32_16x16x32_bf16 v[160:163], a[144:147], a[112:115], 0
    v_mfma_f32_16x16x32_bf16 v[144:147], a[132:135], a[100:103], v[144:147]
    v_mfma_f32_16x16x32_bf16 v[156:159], a[132:135], a[116:119], v[156:159]
    v_mfma_f32_16x16x32_bf16 v[160:163], a[148:151], a[116:119], v[160:163]
    v_mfma_f32_16x16x32_bf16 v[144:147], a[136:139], a[104:107], v[144:147]
    v_mfma_f32_16x16x32_bf16 v[156:159], a[136:139], a[120:123], v[156:159]
    v_mfma_f32_16x16x32_bf16 v[160:163], a[152:155], a[120:123], v[160:163]
    v_mfma_f32_16x16x32_bf16 v[144:147], a[140:143], a[108:111], v[144:147]
    v_mfma_f32_16x16x32_bf16 v[156:159], a[140:143], a[124:127], v[156:159]
    v_mfma_f32_16x16x32_bf16 v[160:163], a[156:159], a[124:127], v[160:163]
    s_nop 7
    v_cvt_pk_bf16_f32 v168, v144, v145
    v_cvt_pk_bf16_f32 v170, v146, v147
    v_and_b32 v169, 0xffff0000, v168
    v_lshlrev_b32 v168, 16, v168
    v_and_b32 v171, 0xffff0000, v170
    v_lshlrev_b32 v170, 16, v170
    v_mul_f32 v168, s37, v168
    v_mul_f32 v169, s37, v169
    v_mul_f32 v170, s37, v170
    v_mul_f32 v171, s37, v171
    v_cvt_pk_bf16_f32 v144, v168, v169
    v_cvt_pk_bf16_f32 v146, v170, v171
    v_and_b32 v145, 0xffff0000, v144
    v_lshlrev_b32 v144, 16, v144
    v_and_b32 v147, 0xffff0000, v146
    v_lshlrev_b32 v146, 16, v146
    v_cvt_pk_bf16_f32 v192, v156, v157
    v_cvt_pk_bf16_f32 v194, v158, v159
    v_cvt_pk_bf16_f32 v196, v160, v161
    v_cvt_pk_bf16_f32 v198, v162, v163
    v_and_b32 v193, 0xffff0000, v192
    v_lshlrev_b32 v192, 16, v192
    v_and_b32 v195, 0xffff0000, v194
    v_lshlrev_b32 v194, 16, v194
    v_and_b32 v197, 0xffff0000, v196
    v_lshlrev_b32 v196, 16, v196
    v_and_b32 v199, 0xffff0000, v198
    v_lshlrev_b32 v198, 16, v198
    v_mul_f32 v192, s37, v192
    v_mul_f32 v193, s37, v193
    v_mul_f32 v194, s37, v194
    v_mul_f32 v195, s37, v195
    v_mul_f32 v196, s37, v196
    v_mul_f32 v197, s37, v197
    v_mul_f32 v198, s37, v198
    v_mul_f32 v199, s37, v199
    v_cvt_pk_bf16_f32 v156, v192, v193
    v_cvt_pk_bf16_f32 v158, v194, v195
    v_cvt_pk_bf16_f32 v160, v196, v197
    v_cvt_pk_bf16_f32 v162, v198, v199
    v_and_b32 v157, 0xffff0000, v156
    v_lshlrev_b32 v156, 16, v156
    v_and_b32 v159, 0xffff0000, v158
    v_lshlrev_b32 v158, 16, v158
    v_and_b32 v161, 0xffff0000, v160
    v_lshlrev_b32 v160, 16, v160
    v_and_b32 v163, 0xffff0000, v162
    v_lshlrev_b32 v162, 16, v162
    v_cndmask_b32 v144, v14, v144, s[40:41]
    v_cndmask_b32 v145, v14, v145, s[42:43]
    v_cndmask_b32 v146, v14, v146, s[44:45]
    v_cndmask_b32 v147, v14, v147, s[46:47]
    v_cndmask_b32 v160, v14, v160, s[40:41]
    v_cndmask_b32 v161, v14, v161, s[42:43]
    v_cndmask_b32 v162, v14, v162, s[44:45]
    v_cndmask_b32 v163, v14, v163, s[46:47]
    s_mov_b32 s62, 0
.kmp_469:
    v_max3_u32 v4, v96, v97, v98
    v_max3_u32 v5, v99, v100, v101
    v_max3_u32 v4, v4, v102, v103
    v_max3_u32 v5, v5, v104, v105
    v_max3_u32 v4, v4, v106, v107
    v_max3_u32 v5, v5, v108, v109
    v_max3_u32 v4, v4, v110, v111
    v_max3_u32 v5, v5, v112, v113
    v_max3_u32 v4, v4, v114, v115
    v_max3_u32 v5, v5, v116, v117
    v_max3_u32 v4, v4, v118, v119
    v_max3_u32 v5, v5, v120, v121
    v_max3_u32 v4, v4, v122, v123
    v_max3_u32 v5, v5, v124, v125
    v_max3_u32 v4, v4, v126, v127
    v_max_u32 v4, v4, v5
    v_cmp_eq_u32 vcc, -1, v4
    s_cbranch_vccnz .kmf_470

    v_mfma_f32_16x16x32_bf16 v[152:155], v[96:99], a[96:99], 0
    v_mfma_f32_16x16x32_bf16 v[164:167], v[96:99], a[112:115], 0
    v_mfma_f32_16x16x32_bf16 v[152:155], v[100:103], a[100:103], v[152:155]
    v_mfma_f32_16x16x32_bf16 v[164:167], v[100:103], a[116:119], v[164:167]
    v_mfma_f32_16x16x32_bf16 v[152:155], v[104:107], a[104:107], v[152:155]
    v_mfma_f32_16x16x32_bf16 v[164:167], v[104:107], a[120:123], v[164:167]
    v_mfma_f32_16x16x32_bf16 v[152:155], v[108:111], a[108:111], v[152:155]
    v_mfma_f32_16x16x32_bf16 v[164:167], v[108:111], a[124:127], v[164:167]
    s_nop 5
    v_cvt_pk_bf16_f32 v176, v152, v153
    v_cvt_pk_bf16_f32 v178, v154, v155
    v_and_b32 v177, 0xffff0000, v176
    v_lshlrev_b32 v176, 16, v176
    v_and_b32 v179, 0xffff0000, v178
    v_lshlrev_b32 v178, 16, v178
    v_mul_f32 v176, s37, v176
    v_mul_f32 v177, s37, v177
    v_mul_f32 v178, s37, v178
    v_mul_f32 v179, s37, v179
    v_cvt_pk_bf16_f32 v152, v176, v177
    v_cvt_pk_bf16_f32 v154, v178, v179
    v_and_b32 v153, 0xffff0000, v152
    v_lshlrev_b32 v152, 16, v152
    v_and_b32 v155, 0xffff0000, v154
    v_lshlrev_b32 v154, 16, v154
    v_cndmask_b32 v152, v14, v152, s[60:61]
    v_cndmask_b32 v153, v14, v153, s[60:61]
    v_cndmask_b32 v154, v14, v154, s[60:61]
    v_cndmask_b32 v155, v14, v155, s[60:61]
    v_cvt_pk_bf16_f32 v200, v164, v165
    v_cvt_pk_bf16_f32 v202, v166, v167
    v_and_b32 v201, 0xffff0000, v200
    v_lshlrev_b32 v200, 16, v200
    v_and_b32 v203, 0xffff0000, v202
    v_lshlrev_b32 v202, 16, v202
    v_mul_f32 v200, s37, v200
    v_mul_f32 v201, s37, v201
    v_mul_f32 v202, s37, v202
    v_mul_f32 v203, s37, v203
    v_cvt_pk_bf16_f32 v164, v200, v201
    v_cvt_pk_bf16_f32 v166, v202, v203
    v_and_b32 v165, 0xffff0000, v164
    v_lshlrev_b32 v164, 16, v164
    v_and_b32 v167, 0xffff0000, v166
    v_lshlrev_b32 v166, 16, v166
    v_cndmask_b32 v164, v14, v164, s[60:61]
    v_cndmask_b32 v165, v14, v165, s[60:61]
    v_cndmask_b32 v166, v14, v166, s[60:61]
    v_cndmask_b32 v167, v14, v167, s[60:61]
    v_max3_f32 v4, v144, v145, v146
    v_max3_f32 v5, v147, v152, v153
    v_max3_f32 v4, v4, v154, v155
    v_max_f32 v4, v4, v5

    v_max3_f32 v6, v156, v157, v158
    v_max3_f32 v7, v159, v160, v161
    v_max3_f32 v6, v6, v162, v163
    v_max3_f32 v7, v7, v164, v165
    v_max3_f32 v6, v6, v166, v167
    v_max_f32 v6, v6, v7

    v_mov_b32 v5, v4
    v_mov_b32 v7, v6
    s_nop 0
    v_permlane32_swap_b32 v4, v5
    v_permlane32_swap_b32 v6, v7
    v_max_f32 v4, v4, v5
    v_max_f32 v6, v6, v7

    v_mov_b32 v5, v4
    v_mov_b32 v7, v6
    s_nop 0
    v_permlane16_swap_b32 v4, v5
    v_permlane16_swap_b32 v6, v7
    v_max_f32 v4, v4, v5
    v_max_f32 v6, v6, v7

    v_mul_f32 v4, s38, v4
    v_mul_f32 v6, s38, v6
    v_fma_f32 v168, v144, s38, -v4
    v_fma_f32 v169, v145, s38, -v4
    v_fma_f32 v170, v146, s38, -v4
    v_fma_f32 v171, v147, s38, -v4
    v_fma_f32 v176, v152, s38, -v4
    v_fma_f32 v177, v153, s38, -v4
    v_fma_f32 v178, v154, s38, -v4
    v_fma_f32 v179, v155, s38, -v4
    v_fma_f32 v192, v156, s38, -v6
    v_fma_f32 v193, v157, s38, -v6
    v_fma_f32 v194, v158, s38, -v6
    v_fma_f32 v195, v159, s38, -v6
    v_fma_f32 v196, v160, s38, -v6
    v_fma_f32 v197, v161, s38, -v6
    v_fma_f32 v198, v162, s38, -v6
    v_fma_f32 v199, v163, s38, -v6
    v_fma_f32 v200, v164, s38, -v6
    v_fma_f32 v201, v165, s38, -v6
    v_fma_f32 v202, v166, s38, -v6
    v_fma_f32 v203, v167, s38, -v6
    v_exp_f32 v168, v168
    v_exp_f32 v169, v169
    v_exp_f32 v170, v170
    v_exp_f32 v171, v171
    v_exp_f32 v176, v176
    v_exp_f32 v177, v177
    v_exp_f32 v178, v178
    v_exp_f32 v179, v179
    v_exp_f32 v192, v192
    v_exp_f32 v193, v193
    v_exp_f32 v194, v194
    v_exp_f32 v195, v195
    v_exp_f32 v196, v196
    v_exp_f32 v197, v197
    v_exp_f32 v198, v198
    v_exp_f32 v199, v199
    v_exp_f32 v200, v200
    v_exp_f32 v201, v201
    v_exp_f32 v202, v202
    v_exp_f32 v203, v203
    v_add_f32 v4, v168, v169
    v_add_f32 v5, v170, v171
    v_add_f32 v4, v4, v176
    v_add_f32 v5, v5, v177
    v_add_f32 v4, v4, v178
    v_add_f32 v5, v5, v179
    v_add_f32 v4, v4, v5
    v_add_f32 v6, v192, v193
    v_add_f32 v7, v194, v195
    v_add_f32 v6, v6, v196
    v_add_f32 v7, v7, v197
    v_add_f32 v6, v6, v198
    v_add_f32 v7, v7, v199
    v_add_f32 v6, v6, v200
    v_add_f32 v7, v7, v201
    v_add_f32 v6, v6, v202
    v_add_f32 v7, v7, v203
    v_add_f32 v6, v6, v7
    v_mov_b32 v5, v4
    v_mov_b32 v7, v6
    s_nop 0
    v_permlane32_swap_b32 v4, v5
    v_permlane32_swap_b32 v6, v7
    v_add_f32 v4, v4, v5
    v_add_f32 v6, v6, v7

    v_mov_b32 v5, v4
    v_mov_b32 v7, v6
    s_nop 0
    v_permlane16_swap_b32 v4, v5
    v_permlane16_swap_b32 v6, v7
    v_add_f32 v4, v4, v5
    v_add_f32 v6, v6, v7

    v_rcp_f32 v4, v4
    v_rcp_f32 v6, v6
    v_mov_b32 v182, 0
    v_mov_b32 v183, 0
    v_mul_f32 v168, v4, v168
    v_mul_f32 v169, v4, v169
    v_mul_f32 v170, v4, v170
    v_mul_f32 v171, v4, v171
    v_mul_f32 v176, v4, v176
    v_mul_f32 v177, v4, v177
    v_mul_f32 v178, v4, v178
    v_mul_f32 v179, v4, v179
    v_cvt_pk_bf16_f32 v180, v168, v169
    v_cvt_pk_bf16_f32 v181, v170, v171
    v_cvt_pk_bf16_f32 v184, v176, v177
    v_cvt_pk_bf16_f32 v185, v178, v179
    v_mul_f32 v192, v6, v192
    v_mul_f32 v193, v6, v193
    v_mul_f32 v194, v6, v194
    v_mul_f32 v195, v6, v195
    v_mul_f32 v196, v6, v196
    v_mul_f32 v197, v6, v197
    v_mul_f32 v198, v6, v198
    v_mul_f32 v199, v6, v199
    v_mul_f32 v200, v6, v200
    v_mul_f32 v201, v6, v201
    v_mul_f32 v202, v6, v202
    v_mul_f32 v203, v6, v203
    v_cvt_pk_bf16_f32 v186, v192, v193
    v_cvt_pk_bf16_f32 v187, v194, v195
    v_cvt_pk_bf16_f32 v188, v196, v197
    v_cvt_pk_bf16_f32 v189, v198, v199
    v_cvt_pk_bf16_f32 v190, v200, v201
    v_cvt_pk_bf16_f32 v191, v202, v203
    s_add_u32 s25, s25, 4

    v_mfma_f32_16x16x32_bf16 v[16:19], a[160:163], v[180:183], 0
    v_mfma_f32_16x16x32_bf16 v[20:23], a[164:167], v[180:183], 0
    v_mfma_f32_16x16x32_bf16 v[24:27], a[168:171], v[180:183], 0
    v_mfma_f32_16x16x32_bf16 v[28:31], a[172:175], v[180:183], 0
    v_mfma_f32_16x16x32_bf16 v[32:35], a[176:179], v[180:183], 0
    v_mfma_f32_16x16x32_bf16 v[36:39], a[180:183], v[180:183], 0
    v_mfma_f32_16x16x32_bf16 v[40:43], a[184:187], v[180:183], 0
    v_mfma_f32_16x16x32_bf16 v[44:47], a[188:191], v[180:183], 0
    v_mfma_f32_16x16x32_bf16 v[48:51], a[160:163], v[186:189], 0
    v_mfma_f32_16x16x32_bf16 v[52:55], a[164:167], v[186:189], 0
    v_mfma_f32_16x16x32_bf16 v[56:59], a[168:171], v[186:189], 0
    v_mfma_f32_16x16x32_bf16 v[60:63], a[172:175], v[186:189], 0
    v_mfma_f32_16x16x32_bf16 v[64:67], a[176:179], v[186:189], 0
    v_mfma_f32_16x16x32_bf16 v[68:71], a[180:183], v[186:189], 0
    v_mfma_f32_16x16x32_bf16 v[72:75], a[184:187], v[186:189], 0
    v_mfma_f32_16x16x32_bf16 v[76:79], a[188:191], v[186:189], 0
    s_waitcnt vmcnt(36)
    s_bitcmp1_b32 s97, 4
    s_mov_b64 exec, 1
    s_cbranch_scc1 .fs_471
    buffer_store_dword v12, v13, s[8:11], s92 offen
.fj_472:
    s_mov_b64 exec, -1
    s_cmp_lt_u32 s25, s96
    s_cbranch_scc1 .os_473
    v_mfma_f32_16x16x16_bf16 v[16:19], v[112:113], v[184:185], v[16:19]
    v_mfma_f32_16x16x16_bf16 v[20:23], v[114:115], v[184:185], v[20:23]
    v_add_u32 v12, 1, v12
    v_mfma_f32_16x16x16_bf16 v[24:27], v[116:117], v[184:185], v[24:27]
    v_mfma_f32_16x16x16_bf16 v[28:31], v[118:119], v[184:185], v[28:31]
    v_mfma_f32_16x16x16_bf16 v[32:35], v[120:121], v[184:185], v[32:35]
    v_mfma_f32_16x16x16_bf16 v[36:39], v[122:123], v[184:185], v[36:39]
    v_cvt_pk_bf16_f32 v208, v16, v17
    v_cvt_pk_bf16_f32 v209, v18, v19
    v_cvt_pk_bf16_f32 v210, v20, v21
    v_cvt_pk_bf16_f32 v211, v22, v23
    buffer_store_dwordx4 v[208:211], v8, s[8:11], s50 offen offset:0
    v_mfma_f32_16x16x16_bf16 v[40:43], v[124:125], v[184:185], v[40:43]
    v_mfma_f32_16x16x16_bf16 v[44:47], v[126:127], v[184:185], v[44:47]
    v_cvt_pk_bf16_f32 v212, v24, v25
    v_cvt_pk_bf16_f32 v213, v26, v27
    v_cvt_pk_bf16_f32 v214, v28, v29
    v_cvt_pk_bf16_f32 v215, v30, v31
    buffer_store_dwordx4 v[212:215], v8, s[8:11], s50 offen offset:1024
    v_mfma_f32_16x16x16_bf16 v[48:51], v[112:113], v[190:191], v[48:51]
    v_mfma_f32_16x16x16_bf16 v[52:55], v[114:115], v[190:191], v[52:55]
    v_cvt_pk_bf16_f32 v216, v32, v33
    v_cvt_pk_bf16_f32 v217, v34, v35
    v_cvt_pk_bf16_f32 v218, v36, v37
    v_cvt_pk_bf16_f32 v219, v38, v39
    buffer_store_dwordx4 v[216:219], v8, s[8:11], s50 offen offset:2048
    v_mfma_f32_16x16x16_bf16 v[56:59], v[116:117], v[190:191], v[56:59]
    v_mfma_f32_16x16x16_bf16 v[60:63], v[118:119], v[190:191], v[60:63]
    v_cvt_pk_bf16_f32 v220, v40, v41
    v_cvt_pk_bf16_f32 v221, v42, v43
    v_cvt_pk_bf16_f32 v222, v44, v45
    v_cvt_pk_bf16_f32 v223, v46, v47
    buffer_store_dwordx4 v[220:223], v8, s[8:11], s50 offen offset:3072
    v_mfma_f32_16x16x16_bf16 v[64:67], v[120:121], v[190:191], v[64:67]
    v_mfma_f32_16x16x16_bf16 v[68:71], v[122:123], v[190:191], v[68:71]
    v_cvt_pk_bf16_f32 v224, v48, v49
    v_cvt_pk_bf16_f32 v225, v50, v51
    v_cvt_pk_bf16_f32 v226, v52, v53
    v_cvt_pk_bf16_f32 v227, v54, v55
    buffer_store_dwordx4 v[224:227], v8, s[8:11], s51 offen offset:0
    v_mfma_f32_16x16x16_bf16 v[72:75], v[124:125], v[190:191], v[72:75]
    v_mfma_f32_16x16x16_bf16 v[76:79], v[126:127], v[190:191], v[76:79]
    v_cvt_pk_bf16_f32 v228, v56, v57
    v_cvt_pk_bf16_f32 v229, v58, v59
    v_cvt_pk_bf16_f32 v230, v60, v61
    v_cvt_pk_bf16_f32 v231, v62, v63
    buffer_store_dwordx4 v[228:231], v8, s[8:11], s51 offen offset:1024
    s_nop 3
    v_cvt_pk_bf16_f32 v232, v64, v65
    v_cvt_pk_bf16_f32 v233, v66, v67
    v_cvt_pk_bf16_f32 v234, v68, v69
    v_cvt_pk_bf16_f32 v235, v70, v71
    buffer_store_dwordx4 v[232:235], v8, s[8:11], s51 offen offset:2048
    v_cvt_pk_bf16_f32 v236, v72, v73
    v_cvt_pk_bf16_f32 v237, v74, v75
    v_cvt_pk_bf16_f32 v238, v76, v77
    v_cvt_pk_bf16_f32 v239, v78, v79
    buffer_store_dwordx4 v[236:239], v8, s[8:11], s51 offen offset:3072
.oj_474:
    s_cmp_lt_u32 s25, 64
    s_cbranch_scc1 .att_458
    s_waitcnt vmcnt(0)

    s_bitcmp1_b32 s97, 4
    s_mov_b64 exec, 1
    s_cbranch_scc1 .fs_476
    buffer_store_dword v12, v13, s[8:11], s92 offen
.fj_477:
    s_mov_b64 exec, -1
    s_branch .ate_475
.atw_459:
    s_mov_b32 s62, 0
    s_mov_b64 exec, 7
.wf_478:
    buffer_load_dword v15, v9, s[8:11], s35 offen sc1
    s_waitcnt vmcnt(0)
    v_cmp_gt_u32 vcc, s36, v15
    s_cbranch_vccz .wfd_479
    s_sleep 2
    s_add_u32 s62, s62, 1
    s_cmp_gt_u32 s62, 0x400000
    s_cbranch_scc1 .mg_end_1
    s_branch .wf_478

.wfd_479:
    s_mov_b64 exec, -1
    s_branch .atb_460
.kmf_462:
    s_cmp_lg_u32 s62, 0
    s_cbranch_scc1 .kmn_480
    s_waitcnt vmcnt(36)
    s_bitcmp1_b32 s97, 4
    s_mov_b64 exec, 1
    s_cbranch_scc1 .fs_481
    buffer_store_dword v12, v13, s[8:11], s92 offen
.fj_482:
    s_mov_b64 exec, -1
    s_cmp_lt_u32 s25, 60
    s_cselect_b32 s5, 0, 196608
    s_sub_u32 s5, s34, s5
    s_mov_b64 exec, 15

.kml_483:
    s_sleep 4
    buffer_load_dword v4, v204, s[8:11], s5 offen sc1
    s_add_u32 s62, s62, 1
    s_cmp_gt_u32 s62, 0x200000
    s_cbranch_scc1 .mg_end_1
    s_waitcnt vmcnt(0)
    v_cmp_eq_u32 vcc, -1, v4
    s_cbranch_vccnz .kml_483
    s_mov_b64 exec, -1

.kmn_480:
    s_sleep 1
    buffer_load_dwordx4 v[80:83], v10, s[8:11], s34 offen offset:2048 sc1
    buffer_load_dwordx4 v[84:87], v10, s[8:11], s34 offen offset:2176 sc1
    buffer_load_dwordx4 v[88:91], v10, s[8:11], s34 offen offset:3072 sc1
    buffer_load_dwordx4 v[92:95], v10, s[8:11], s34 offen offset:3200 sc1
    s_add_u32 s4, s34, 4096
    s_mov_b64 exec, s[60:61]
    buffer_load_dwordx2 v[128:129], v11, s[8:11], s4 offen offset:0 sc1
    buffer_load_dwordx2 v[130:131], v11, s[8:11], s4 offen offset:256 sc1
    buffer_load_dwordx2 v[132:133], v11, s[8:11], s4 offen offset:512 sc1
    buffer_load_dwordx2 v[134:135], v11, s[8:11], s4 offen offset:768 sc1
    buffer_load_dwordx2 v[136:137], v11, s[8:11], s4 offen offset:1024 sc1
    buffer_load_dwordx2 v[138:139], v11, s[8:11], s4 offen offset:1280 sc1
    buffer_load_dwordx2 v[140:141], v11, s[8:11], s4 offen offset:1536 sc1
    buffer_load_dwordx2 v[142:143], v11, s[8:11], s4 offen offset:1792 sc1
    s_mov_b64 exec, -1
    s_add_u32 s62, s62, 1
    s_cmp_gt_u32 s62, 0x200000
    s_cbranch_scc1 .mg_end_1
    s_waitcnt vmcnt(0)
    s_branch .kmp_461

.fs_463:
    buffer_store_dword v12, v13, s[8:11], s92 offen sc1
    s_branch .fj_464
.os_465:
    v_mfma_f32_16x16x16_bf16 v[16:19], v[128:129], v[184:185], v[16:19]
    v_mfma_f32_16x16x16_bf16 v[20:23], v[130:131], v[184:185], v[20:23]
    v_add_u32 v12, 1, v12
    v_mfma_f32_16x16x16_bf16 v[24:27], v[132:133], v[184:185], v[24:27]
    v_mfma_f32_16x16x16_bf16 v[28:31], v[134:135], v[184:185], v[28:31]
    v_mfma_f32_16x16x16_bf16 v[32:35], v[136:137], v[184:185], v[32:35]
    v_mfma_f32_16x16x16_bf16 v[36:39], v[138:139], v[184:185], v[36:39]
    v_cvt_pk_bf16_f32 v208, v16, v17
    v_cvt_pk_bf16_f32 v209, v18, v19
    v_cvt_pk_bf16_f32 v210, v20, v21
    v_cvt_pk_bf16_f32 v211, v22, v23
    buffer_store_dwordx4 v[208:211], v8, s[8:11], s50 offen offset:0 sc1
    v_mfma_f32_16x16x16_bf16 v[40:43], v[140:141], v[184:185], v[40:43]
    v_mfma_f32_16x16x16_bf16 v[44:47], v[142:143], v[184:185], v[44:47]
    v_cvt_pk_bf16_f32 v212, v24, v25
    v_cvt_pk_bf16_f32 v213, v26, v27
    v_cvt_pk_bf16_f32 v214, v28, v29
    v_cvt_pk_bf16_f32 v215, v30, v31
    buffer_store_dwordx4 v[212:215], v8, s[8:11], s50 offen offset:1024 sc1
    v_mfma_f32_16x16x16_bf16 v[48:51], v[128:129], v[190:191], v[48:51]
    v_mfma_f32_16x16x16_bf16 v[52:55], v[130:131], v[190:191], v[52:55]
    v_cvt_pk_bf16_f32 v216, v32, v33
    v_cvt_pk_bf16_f32 v217, v34, v35
    v_cvt_pk_bf16_f32 v218, v36, v37
    v_cvt_pk_bf16_f32 v219, v38, v39
    buffer_store_dwordx4 v[216:219], v8, s[8:11], s50 offen offset:2048 sc1
    v_mfma_f32_16x16x16_bf16 v[56:59], v[132:133], v[190:191], v[56:59]
    v_mfma_f32_16x16x16_bf16 v[60:63], v[134:135], v[190:191], v[60:63]
    v_cvt_pk_bf16_f32 v220, v40, v41
    v_cvt_pk_bf16_f32 v221, v42, v43
    v_cvt_pk_bf16_f32 v222, v44, v45
    v_cvt_pk_bf16_f32 v223, v46, v47
    buffer_store_dwordx4 v[220:223], v8, s[8:11], s50 offen offset:3072 sc1
    v_mfma_f32_16x16x16_bf16 v[64:67], v[136:137], v[190:191], v[64:67]
    v_mfma_f32_16x16x16_bf16 v[68:71], v[138:139], v[190:191], v[68:71]
    v_cvt_pk_bf16_f32 v224, v48, v49
    v_cvt_pk_bf16_f32 v225, v50, v51
    v_cvt_pk_bf16_f32 v226, v52, v53
    v_cvt_pk_bf16_f32 v227, v54, v55
    buffer_store_dwordx4 v[224:227], v8, s[8:11], s51 offen offset:0 sc1
    v_mfma_f32_16x16x16_bf16 v[72:75], v[140:141], v[190:191], v[72:75]
    v_mfma_f32_16x16x16_bf16 v[76:79], v[142:143], v[190:191], v[76:79]
    v_cvt_pk_bf16_f32 v228, v56, v57
    v_cvt_pk_bf16_f32 v229, v58, v59
    v_cvt_pk_bf16_f32 v230, v60, v61
    v_cvt_pk_bf16_f32 v231, v62, v63
    buffer_store_dwordx4 v[228:231], v8, s[8:11], s51 offen offset:1024 sc1
    s_nop 3
    v_cvt_pk_bf16_f32 v232, v64, v65
    v_cvt_pk_bf16_f32 v233, v66, v67
    v_cvt_pk_bf16_f32 v234, v68, v69
    v_cvt_pk_bf16_f32 v235, v70, v71
    buffer_store_dwordx4 v[232:235], v8, s[8:11], s51 offen offset:2048 sc1
    v_cvt_pk_bf16_f32 v236, v72, v73
    v_cvt_pk_bf16_f32 v237, v74, v75
    v_cvt_pk_bf16_f32 v238, v76, v77
    v_cvt_pk_bf16_f32 v239, v78, v79
    buffer_store_dwordx4 v[236:239], v8, s[8:11], s51 offen offset:3072 sc1
    s_branch .oj_466
.atw_467:
    s_mov_b32 s62, 0
    s_mov_b64 exec, 7
.wf_484:
    buffer_load_dword v15, v9, s[8:11], s35 offen sc1
    s_waitcnt vmcnt(0)
    v_cmp_gt_u32 vcc, s36, v15
    s_cbranch_vccz .wfd_485
    s_sleep 2
    s_add_u32 s62, s62, 1
    s_cmp_gt_u32 s62, 0x400000
    s_cbranch_scc1 .mg_end_1
    s_branch .wf_484

.wfd_485:
    s_mov_b64 exec, -1
    s_branch .atb_468
.kmf_470:
    s_cmp_lg_u32 s62, 0
    s_cbranch_scc1 .kmn_486
    s_waitcnt vmcnt(36)
    s_bitcmp1_b32 s97, 4
    s_mov_b64 exec, 1
    s_cbranch_scc1 .fs_487
    buffer_store_dword v12, v13, s[8:11], s92 offen
.fj_488:
    s_mov_b64 exec, -1
    s_cmp_lt_u32 s25, 60
    s_cselect_b32 s5, 0, 196608
    s_sub_u32 s5, s34, s5
    s_mov_b64 exec, 15

.kml_489:
    s_sleep 4
    buffer_load_dword v4, v204, s[8:11], s5 offen sc1
    s_add_u32 s62, s62, 1
    s_cmp_gt_u32 s62, 0x200000
    s_cbranch_scc1 .mg_end_1
    s_waitcnt vmcnt(0)
    v_cmp_eq_u32 vcc, -1, v4
    s_cbranch_vccnz .kml_489
    s_mov_b64 exec, -1

.kmn_486:
    s_sleep 1
    buffer_load_dwordx4 v[96:99], v10, s[8:11], s34 offen offset:2048 sc1
    buffer_load_dwordx4 v[100:103], v10, s[8:11], s34 offen offset:2176 sc1
    buffer_load_dwordx4 v[104:107], v10, s[8:11], s34 offen offset:3072 sc1
    buffer_load_dwordx4 v[108:111], v10, s[8:11], s34 offen offset:3200 sc1
    s_add_u32 s4, s34, 4096
    s_mov_b64 exec, s[60:61]
    buffer_load_dwordx2 v[112:113], v11, s[8:11], s4 offen offset:0 sc1
    buffer_load_dwordx2 v[114:115], v11, s[8:11], s4 offen offset:256 sc1
    buffer_load_dwordx2 v[116:117], v11, s[8:11], s4 offen offset:512 sc1
    buffer_load_dwordx2 v[118:119], v11, s[8:11], s4 offen offset:768 sc1
    buffer_load_dwordx2 v[120:121], v11, s[8:11], s4 offen offset:1024 sc1
    buffer_load_dwordx2 v[122:123], v11, s[8:11], s4 offen offset:1280 sc1
    buffer_load_dwordx2 v[124:125], v11, s[8:11], s4 offen offset:1536 sc1
    buffer_load_dwordx2 v[126:127], v11, s[8:11], s4 offen offset:1792 sc1
    s_mov_b64 exec, -1
    s_add_u32 s62, s62, 1
    s_cmp_gt_u32 s62, 0x200000
    s_cbranch_scc1 .mg_end_1
    s_waitcnt vmcnt(0)
    s_branch .kmp_469

.fs_471:
    buffer_store_dword v12, v13, s[8:11], s92 offen sc1
    s_branch .fj_472
.os_473:
    v_mfma_f32_16x16x16_bf16 v[16:19], v[112:113], v[184:185], v[16:19]
    v_mfma_f32_16x16x16_bf16 v[20:23], v[114:115], v[184:185], v[20:23]
    v_add_u32 v12, 1, v12
    v_mfma_f32_16x16x16_bf16 v[24:27], v[116:117], v[184:185], v[24:27]
    v_mfma_f32_16x16x16_bf16 v[28:31], v[118:119], v[184:185], v[28:31]
    v_mfma_f32_16x16x16_bf16 v[32:35], v[120:121], v[184:185], v[32:35]
    v_mfma_f32_16x16x16_bf16 v[36:39], v[122:123], v[184:185], v[36:39]
    v_cvt_pk_bf16_f32 v208, v16, v17
    v_cvt_pk_bf16_f32 v209, v18, v19
    v_cvt_pk_bf16_f32 v210, v20, v21
    v_cvt_pk_bf16_f32 v211, v22, v23
    buffer_store_dwordx4 v[208:211], v8, s[8:11], s50 offen offset:0 sc1
    v_mfma_f32_16x16x16_bf16 v[40:43], v[124:125], v[184:185], v[40:43]
    v_mfma_f32_16x16x16_bf16 v[44:47], v[126:127], v[184:185], v[44:47]
    v_cvt_pk_bf16_f32 v212, v24, v25
    v_cvt_pk_bf16_f32 v213, v26, v27
    v_cvt_pk_bf16_f32 v214, v28, v29
    v_cvt_pk_bf16_f32 v215, v30, v31
    buffer_store_dwordx4 v[212:215], v8, s[8:11], s50 offen offset:1024 sc1
    v_mfma_f32_16x16x16_bf16 v[48:51], v[112:113], v[190:191], v[48:51]
    v_mfma_f32_16x16x16_bf16 v[52:55], v[114:115], v[190:191], v[52:55]
    v_cvt_pk_bf16_f32 v216, v32, v33
    v_cvt_pk_bf16_f32 v217, v34, v35
    v_cvt_pk_bf16_f32 v218, v36, v37
    v_cvt_pk_bf16_f32 v219, v38, v39
    buffer_store_dwordx4 v[216:219], v8, s[8:11], s50 offen offset:2048 sc1
    v_mfma_f32_16x16x16_bf16 v[56:59], v[116:117], v[190:191], v[56:59]
    v_mfma_f32_16x16x16_bf16 v[60:63], v[118:119], v[190:191], v[60:63]
    v_cvt_pk_bf16_f32 v220, v40, v41
    v_cvt_pk_bf16_f32 v221, v42, v43
    v_cvt_pk_bf16_f32 v222, v44, v45
    v_cvt_pk_bf16_f32 v223, v46, v47
    buffer_store_dwordx4 v[220:223], v8, s[8:11], s50 offen offset:3072 sc1
    v_mfma_f32_16x16x16_bf16 v[64:67], v[120:121], v[190:191], v[64:67]
    v_mfma_f32_16x16x16_bf16 v[68:71], v[122:123], v[190:191], v[68:71]
    v_cvt_pk_bf16_f32 v224, v48, v49
    v_cvt_pk_bf16_f32 v225, v50, v51
    v_cvt_pk_bf16_f32 v226, v52, v53
    v_cvt_pk_bf16_f32 v227, v54, v55
    buffer_store_dwordx4 v[224:227], v8, s[8:11], s51 offen offset:0 sc1
    v_mfma_f32_16x16x16_bf16 v[72:75], v[124:125], v[190:191], v[72:75]
    v_mfma_f32_16x16x16_bf16 v[76:79], v[126:127], v[190:191], v[76:79]
    v_cvt_pk_bf16_f32 v228, v56, v57
    v_cvt_pk_bf16_f32 v229, v58, v59
    v_cvt_pk_bf16_f32 v230, v60, v61
    v_cvt_pk_bf16_f32 v231, v62, v63
    buffer_store_dwordx4 v[228:231], v8, s[8:11], s51 offen offset:1024 sc1
    s_nop 3
    v_cvt_pk_bf16_f32 v232, v64, v65
    v_cvt_pk_bf16_f32 v233, v66, v67
    v_cvt_pk_bf16_f32 v234, v68, v69
    v_cvt_pk_bf16_f32 v235, v70, v71
    buffer_store_dwordx4 v[232:235], v8, s[8:11], s51 offen offset:2048 sc1
    v_cvt_pk_bf16_f32 v236, v72, v73
    v_cvt_pk_bf16_f32 v237, v74, v75
    v_cvt_pk_bf16_f32 v238, v76, v77
    v_cvt_pk_bf16_f32 v239, v78, v79
    buffer_store_dwordx4 v[236:239], v8, s[8:11], s51 offen offset:3072 sc1
    s_branch .oj_474
.fs_476:
    buffer_store_dword v12, v13, s[8:11], s92 offen sc1
    s_branch .fj_477
.fs_481:
    buffer_store_dword v12, v13, s[8:11], s92 offen sc1
    s_branch .fj_482
.fs_487:
    buffer_store_dword v12, v13, s[8:11], s92 offen sc1
    s_branch .fj_488
.ate_475:
.mg_end_1:
    s_endpgm
.section .rodata,"a"
.p2align 6
.amdhsa_kernel mega_kernel
  .amdhsa_next_free_vgpr 512
  .amdhsa_next_free_sgpr 102
  .amdhsa_accum_offset 256
  .amdhsa_group_segment_fixed_size 0
  .amdhsa_kernarg_size 136
  .amdhsa_user_sgpr_count 2
  .amdhsa_user_sgpr_kernarg_segment_ptr 1
  .amdhsa_system_sgpr_workgroup_id_x 1
.end_amdhsa_kernel
```

```asm
; @launch kernel=mega_kernel grid=(256,1,1) block=(256,1,1) lds=163840
.amdgcn_target "amdgcn-amd-amdhsa--gfx950"
.text
.globl mega_kernel
.p2align 8
.type mega_kernel,@function
mega_kernel:
    s_cmp_ge_u32 s2, 256
    s_cbranch_scc1 .mg_end_1

    s_load_dwordx4 s[52:55], s[0:1], 120
    s_load_dwordx2 s[40:41], s[0:1], 56
    s_getreg_b32 s3, hwreg(HW_REG_XCC_ID)
    v_and_b32 v1, 63, v0
    v_lshrrev_b32 v4, 6, v0
    s_and_b32 s3, s3, 7
    v_readfirstlane_b32 s24, v4
    s_waitcnt lgkmcnt(0)

    s_mov_b32 s8, s54
    s_and_b32 s9, s55, 0xffff
    s_mov_b32 s10, 0x10000000
    s_mov_b32 s11, 0x00020000

    s_mov_b32 s20, s52
    s_and_b32 s21, s53, 0xffff
    s_mov_b32 s22, 0x100
    s_mov_b32 s23, 0x00020000

    s_mov_b32 s100, s54
    s_cmp_lg_u32 s24, 0
    s_cbranch_scc1 .noat_4
    s_mov_b64 exec, 1
    v_mov_b32 v5, 1
    s_lshl_b32 s4, s3, 2
    s_lshl_b32 s4, s3, 5
    s_add_u32 s4, s4, 28
    v_mov_b32 v6, s4
    buffer_atomic_add v5, v6, s[20:23], 0 offen sc0 sc1
    v_mov_b32 v7, 163776
    s_waitcnt vmcnt(0)
    ds_write_b32 v7, v5
    v_cmp_lt_u32 vcc, 31, v5
    s_cbranch_vccz .nb_5
    v_mov_b32 v6, 136
    buffer_store_dword v7, v6, s[20:23], 0 offen sc1

.nb_5:
    s_waitcnt lgkmcnt(0)
    s_mov_b64 exec, -1

.noat_4:
    s_barrier
    v_mov_b32 v7, 163776
    ds_read_b32 v5, v7
    s_waitcnt lgkmcnt(0)
    v_readfirstlane_b32 s26, v5
    s_mov_b32 s25, s3
    s_mov_b32 s27, 0
    s_mov_b32 s97, 128
    s_cmp_lt_u32 s26, 32
    s_cselect_b32 s99, 1, 0
    s_and_b32 s26, s26, 31

.mg_role_3:
    s_cmp_ge_u32 s25, 4
    s_cbranch_scc1 .mg_bg_2

    s_load_dwordx8 s[44:51], s[0:1], 64
    s_load_dwordx2 s[40:41], s[0:1], 56
    v_and_b32 v1, 63, v0
    v_and_b32 v2, 15, v1
    v_lshrrev_b32 v3, 4, v1

    s_lshr_b32 s79, s26, 2
    s_xor_b32 s63, s26, 4
    s_and_b32 s78, s24, 1
    s_lshl_b32 s34, s25, 19
    s_add_u32 s34, s34, 83886080
    v_lshlrev_b32 v14, 4, v1
    v_lshrrev_b32 v6, 1, v3
    s_sub_u32 s101, 0, s100
    s_and_b32 s101, s101, 0x1fffff
    s_add_u32 s101, s101, 100663296

    v_mov_b32 v188, -1
    v_mov_b32 v189, -1
    v_mov_b32 v190, -1
    v_mov_b32 v191, -1
    s_lshl_b32 s5, s26, 10
    s_add_u32 s5, s5, 40960
    v_add_u32 v235, s5, v14
    s_lshr_b32 s4, s63, 3
    s_mul_i32 s4, s4, 1024
    s_lshl_b32 s5, s63, 9
    s_add_u32 s76, s4, s5
    s_lshl_b32 s5, s26, 9
    s_xor_b32 s5, s5, 1024
    s_lshr_b32 s4, s26, 4
    s_mul_i32 s4, s4, 0
    s_add_u32 s77, s4, s5
    s_add_u32 s77, s77, 20480
    s_sub_u32 s4, s77, s76
    v_and_b32 v4, 31, v1
    v_lshlrev_b32 v236, 4, v4
    v_mad_u32_u24 v236, v6, s4, v236
    v_add_u32 v236, s76, v236
    s_and_b32 s5, s63, 7
    s_lshl_b32 s4, s5, 10
    s_lshr_b32 s5, s63, 3
    s_lshl_b32 s5, s5, 14
    s_add_u32 s4, s4, s5
    s_add_u32 s35, s4, s101
    s_lshl_b32 s5, s25, 16
    v_add_u32 v238, s5, v14
    s_lshl_b32 s4, s25, 3
    s_add_u32 s7, s4, s79
    s_mul_i32 s36, s7, 6144
    s_add_u32 s36, s36, 67108864

    s_cmp_eq_u32 s78, 0
    s_cselect_b64 vcc, -1, 0
    s_lshr_b32 s6, s24, 1
    s_lshl_b32 s4, s6, 17
    s_add_u32 s4, s4, s34
    v_cndmask_b32 v4, v235, v236, vcc
    s_mul_i32 s5, s6, 1048576
    s_lshl_b32 s6, s78, 13
    buffer_store_dwordx4 v[188:191], v4, s[8:11], s4 offen sc1
    s_add_u32 s5, s5, s6
    s_add_u32 s5, s5, s35

    buffer_store_dwordx4 v[188:191], v238, s[8:11], s5 offen sc1
    s_add_u32 s5, s5, 262144
    buffer_store_dwordx4 v[188:191], v238, s[8:11], s5 offen sc1
    s_add_u32 s5, s5, 262144
    s_lshl_b32 s4, s25, 11
    s_lshl_b32 s5, s26, 6
    s_add_u32 s4, s4, s5
    s_lshl_b32 s5, s24, 21
    s_add_u32 s4, s4, s5
    v_lshrrev_b32 v4, 2, v1
    v_and_b32 v5, 3, v1
    v_lshlrev_b32 v5, 4, v5
    v_lshlrev_b32 v6, 13, v4
    v_add_u32 v6, v6, v5
    v_add_u32 v240, s4, v6
    s_lshl_b32 s4, s25, 2
    s_and_b32 s5, s24, 1
    s_lshl_b32 s5, s5, 1
    s_add_u32 s4, s4, s5
    s_lshr_b32 s5, s24, 1
    s_lshl_b32 s80, s5, 1
    s_lshl_b32 s4, s4, 19
    s_lshl_b32 s5, s63, 6
    s_add_u32 s4, s4, s5
    v_xor_b32 v224, 128, v240
    v_lshlrev_b32 v6, 11, v4
    v_add_u32 v6, v6, v5
    v_add_u32 v241, s4, v6
    s_lshl_b32 s98, s24, 15
    s_waitcnt lgkmcnt(0)

    s_add_u32 s80, s80, s79
    s_add_u32 s81, s80, 2
    s_add_u32 s80, s80, 1
    s_and_b32 s80, s80, 3
    s_and_b32 s81, s81, 3
    s_lshl_b32 s80, s80, 18
    s_lshl_b32 s81, s81, 18

    s_barrier
    s_bitcmp1_b32 s26, 0
    s_cbranch_scc1 .po_7
    s_mov_b32 s16, s44
    s_and_b32 s17, s45, 0xffff
    s_mov_b32 s18, 0x800000
    s_mov_b32 s19, 0x00020000

    s_add_u32 m0, s98, 0
    s_mov_b32 s5, 0
    buffer_load_dwordx4 v240, s[16:19], s5 offen  lds

    s_add_u32 m0, s98, 1024
    s_mov_b32 s5, 131072
    buffer_load_dwordx4 v240, s[16:19], s5 offen  lds

    s_add_u32 m0, s98, 2048
    s_mov_b32 s5, 262144
    buffer_load_dwordx4 v240, s[16:19], s5 offen  lds

    s_add_u32 m0, s98, 3072
    s_mov_b32 s5, 393216
    buffer_load_dwordx4 v240, s[16:19], s5 offen  lds

    s_add_u32 m0, s98, 4096
    s_mov_b32 s5, 524288
    buffer_load_dwordx4 v240, s[16:19], s5 offen  lds

    s_add_u32 m0, s98, 5120
    s_mov_b32 s5, 655360
    buffer_load_dwordx4 v240, s[16:19], s5 offen  lds

    s_add_u32 m0, s98, 6144
    s_mov_b32 s5, 786432
    buffer_load_dwordx4 v240, s[16:19], s5 offen  lds

    s_add_u32 m0, s98, 7168
    s_mov_b32 s5, 917504
    buffer_load_dwordx4 v240, s[16:19], s5 offen  lds

    s_branch .pj_8
.po_7:
    s_mov_b32 s16, s44
    s_and_b32 s17, s45, 0xffff
    s_mov_b32 s18, 0x800000
    s_mov_b32 s19, 0x00020000

    s_add_u32 m0, s98, 8192
    s_mov_b32 s5, 1048576
    buffer_load_dwordx4 v240, s[16:19], s5 offen  lds

    s_add_u32 m0, s98, 9216
    s_mov_b32 s5, 1179648
    buffer_load_dwordx4 v240, s[16:19], s5 offen  lds

    s_add_u32 m0, s98, 10240
    s_mov_b32 s5, 1310720
    buffer_load_dwordx4 v240, s[16:19], s5 offen  lds

    s_add_u32 m0, s98, 11264
    s_mov_b32 s5, 1441792
    buffer_load_dwordx4 v240, s[16:19], s5 offen  lds

    s_add_u32 m0, s98, 12288
    s_mov_b32 s5, 1572864
    buffer_load_dwordx4 v240, s[16:19], s5 offen  lds

    s_add_u32 m0, s98, 13312
    s_mov_b32 s5, 1703936
    buffer_load_dwordx4 v240, s[16:19], s5 offen  lds

    s_add_u32 m0, s98, 14336
    s_mov_b32 s5, 1835008
    buffer_load_dwordx4 v240, s[16:19], s5 offen  lds

    s_add_u32 m0, s98, 15360
    s_mov_b32 s5, 1966080
    buffer_load_dwordx4 v240, s[16:19], s5 offen  lds

.pj_8:
    s_waitcnt vmcnt(8)
    s_barrier
    v_mov_b32 v243, s99
    v_mov_b32 v242, 0
    s_cmp_lg_u32 s24, 3
    s_cbranch_scc1 .a1_9
    v_mov_b32 v242, s26
    v_lshlrev_b32 v242, 6, v242
    v_add_u32 v242, s97, v242
    v_and_b32 v242, 255, v242
    s_mov_b64 exec, 1
    buffer_atomic_add v243, v242, s[20:23], 0 offen sc1
    s_mov_b64 exec, -1

.a1_9:
    s_bitcmp1_b32 s26, 0
    s_cbranch_scc1 .po_11
    s_add_u32 m0, s98, 8192
    s_mov_b32 s5, 1048576
    buffer_load_dwordx4 v240, s[16:19], s5 offen  lds

    s_add_u32 m0, s98, 9216
    s_mov_b32 s5, 1179648
    buffer_load_dwordx4 v240, s[16:19], s5 offen  lds

    s_add_u32 m0, s98, 10240
    s_mov_b32 s5, 1310720
    buffer_load_dwordx4 v240, s[16:19], s5 offen  lds

    s_add_u32 m0, s98, 11264
    s_mov_b32 s5, 1441792
    buffer_load_dwordx4 v240, s[16:19], s5 offen  lds

    s_add_u32 m0, s98, 12288
    s_mov_b32 s5, 1572864
    buffer_load_dwordx4 v240, s[16:19], s5 offen  lds

    s_add_u32 m0, s98, 13312
    s_mov_b32 s5, 1703936
    buffer_load_dwordx4 v240, s[16:19], s5 offen  lds

    s_add_u32 m0, s98, 14336
    s_mov_b32 s5, 1835008
    buffer_load_dwordx4 v240, s[16:19], s5 offen  lds

    s_add_u32 m0, s98, 15360
    s_mov_b32 s5, 1966080
    buffer_load_dwordx4 v240, s[16:19], s5 offen  lds

    s_mov_b32 s16, s46
    s_and_b32 s17, s47, 0xffff
    s_mov_b32 s18, 0x800000
    s_mov_b32 s19, 0x00020000

    s_add_u32 m0, s98, 16384
    s_mov_b32 s5, 0
    buffer_load_dwordx4 v240, s[16:19], s5 offen  lds

    s_add_u32 m0, s98, 17408
    s_mov_b32 s5, 131072
    buffer_load_dwordx4 v240, s[16:19], s5 offen  lds

    s_add_u32 m0, s98, 18432
    s_mov_b32 s5, 262144
    buffer_load_dwordx4 v240, s[16:19], s5 offen  lds

    s_add_u32 m0, s98, 19456
    s_mov_b32 s5, 393216
    buffer_load_dwordx4 v240, s[16:19], s5 offen  lds

    s_add_u32 m0, s98, 20480
    s_mov_b32 s5, 524288
    buffer_load_dwordx4 v240, s[16:19], s5 offen  lds

    s_add_u32 m0, s98, 21504
    s_mov_b32 s5, 655360
    buffer_load_dwordx4 v240, s[16:19], s5 offen  lds

    s_add_u32 m0, s98, 22528
    s_mov_b32 s5, 786432
    buffer_load_dwordx4 v240, s[16:19], s5 offen  lds

    s_add_u32 m0, s98, 23552
    s_mov_b32 s5, 917504
    buffer_load_dwordx4 v240, s[16:19], s5 offen  lds

    s_add_u32 m0, s98, 24576
    s_mov_b32 s5, 1048576
    buffer_load_dwordx4 v240, s[16:19], s5 offen  lds

    s_add_u32 m0, s98, 25600
    s_mov_b32 s5, 1179648
    buffer_load_dwordx4 v240, s[16:19], s5 offen  lds

    s_add_u32 m0, s98, 26624
    s_mov_b32 s5, 1310720
    buffer_load_dwordx4 v240, s[16:19], s5 offen  lds

    s_add_u32 m0, s98, 27648
    s_mov_b32 s5, 1441792
    buffer_load_dwordx4 v240, s[16:19], s5 offen  lds

    s_add_u32 m0, s98, 28672
    s_mov_b32 s5, 1572864
    buffer_load_dwordx4 v240, s[16:19], s5 offen  lds

    s_add_u32 m0, s98, 29696
    s_mov_b32 s5, 1703936
    buffer_load_dwordx4 v240, s[16:19], s5 offen  lds

    s_add_u32 m0, s98, 30720
    s_mov_b32 s5, 1835008
    buffer_load_dwordx4 v240, s[16:19], s5 offen  lds

    s_add_u32 m0, s98, 31744
    s_mov_b32 s5, 1966080
    buffer_load_dwordx4 v240, s[16:19], s5 offen  lds

    s_branch .pj_12
.po_11:
    s_add_u32 m0, s98, 0
    s_mov_b32 s5, 0
    buffer_load_dwordx4 v240, s[16:19], s5 offen  lds

    s_add_u32 m0, s98, 1024
    s_mov_b32 s5, 131072
    buffer_load_dwordx4 v240, s[16:19], s5 offen  lds

    s_add_u32 m0, s98, 2048
    s_mov_b32 s5, 262144
    buffer_load_dwordx4 v240, s[16:19], s5 offen  lds

    s_add_u32 m0, s98, 3072
    s_mov_b32 s5, 393216
    buffer_load_dwordx4 v240, s[16:19], s5 offen  lds

    s_add_u32 m0, s98, 4096
    s_mov_b32 s5, 524288
    buffer_load_dwordx4 v240, s[16:19], s5 offen  lds

    s_add_u32 m0, s98, 5120
    s_mov_b32 s5, 655360
    buffer_load_dwordx4 v240, s[16:19], s5 offen  lds

    s_add_u32 m0, s98, 6144
    s_mov_b32 s5, 786432
    buffer_load_dwordx4 v240, s[16:19], s5 offen  lds

    s_add_u32 m0, s98, 7168
    s_mov_b32 s5, 917504
    buffer_load_dwordx4 v240, s[16:19], s5 offen  lds

    s_mov_b32 s16, s46
    s_and_b32 s17, s47, 0xffff
    s_mov_b32 s18, 0x800000
    s_mov_b32 s19, 0x00020000

    s_add_u32 m0, s98, 24576
    s_mov_b32 s5, 1048576
    buffer_load_dwordx4 v240, s[16:19], s5 offen  lds

    s_add_u32 m0, s98, 25600
    s_mov_b32 s5, 1179648
    buffer_load_dwordx4 v240, s[16:19], s5 offen  lds

    s_add_u32 m0, s98, 26624
    s_mov_b32 s5, 1310720
    buffer_load_dwordx4 v240, s[16:19], s5 offen  lds

    s_add_u32 m0, s98, 27648
    s_mov_b32 s5, 1441792
    buffer_load_dwordx4 v240, s[16:19], s5 offen  lds

    s_add_u32 m0, s98, 28672
    s_mov_b32 s5, 1572864
    buffer_load_dwordx4 v240, s[16:19], s5 offen  lds

    s_add_u32 m0, s98, 29696
    s_mov_b32 s5, 1703936
    buffer_load_dwordx4 v240, s[16:19], s5 offen  lds

    s_add_u32 m0, s98, 30720
    s_mov_b32 s5, 1835008
    buffer_load_dwordx4 v240, s[16:19], s5 offen  lds

    s_add_u32 m0, s98, 31744
    s_mov_b32 s5, 1966080
    buffer_load_dwordx4 v240, s[16:19], s5 offen  lds

    s_add_u32 m0, s98, 16384
    s_mov_b32 s5, 0
    buffer_load_dwordx4 v240, s[16:19], s5 offen  lds

    s_add_u32 m0, s98, 17408
    s_mov_b32 s5, 131072
    buffer_load_dwordx4 v240, s[16:19], s5 offen  lds

    s_add_u32 m0, s98, 18432
    s_mov_b32 s5, 262144
    buffer_load_dwordx4 v240, s[16:19], s5 offen  lds

    s_add_u32 m0, s98, 19456
    s_mov_b32 s5, 393216
    buffer_load_dwordx4 v240, s[16:19], s5 offen  lds

    s_add_u32 m0, s98, 20480
    s_mov_b32 s5, 524288
    buffer_load_dwordx4 v240, s[16:19], s5 offen  lds

    s_add_u32 m0, s98, 21504
    s_mov_b32 s5, 655360
    buffer_load_dwordx4 v240, s[16:19], s5 offen  lds

    s_add_u32 m0, s98, 22528
    s_mov_b32 s5, 786432
    buffer_load_dwordx4 v240, s[16:19], s5 offen  lds

    s_add_u32 m0, s98, 23552
    s_mov_b32 s5, 917504
    buffer_load_dwordx4 v240, s[16:19], s5 offen  lds

.pj_12:
    s_mov_b32 s12, s40
    s_and_b32 s13, s41, 0xffff
    s_mov_b32 s14, 0x4000
    s_mov_b32 s15, 0x00020000

    v_bfe_u32 v4, v2, 2, 1
    v_lshrrev_b32 v5, 3, v2
    v_lshrrev_b32 v8, 1, v3
    v_and_b32 v9, 1, v3
    v_lshl_add_u32 v6, v5, 3, v4
    v_lshl_add_u32 v6, v8, 4, v6
    v_lshl_add_u32 v6, v9, 2, v6
    v_lshl_add_u32 v7, v5, 2, v4
    v_lshl_add_u32 v7, v8, 3, v7
    v_lshl_add_u32 v7, v9, 4, v7
    v_and_b32 v5, 3, v2
    v_lshlrev_b32 v5, 3, v5
    v_lshl_add_u32 v6, v6, 6, v5
    v_lshl_add_u32 v7, v7, 6, v5
    v_add_u32 v254, s98, v6
    v_add_u32 v255, s98, v7
    v_sub_u32 v252, v254, v5
    v_and_b32 v5, 1, v2
    v_lshl_add_u32 v252, v5, 5, v252
    v_bfe_u32 v5, v2, 1, 1
    v_lshl_add_u32 v252, v5, 3, v252

    s_and_b32 s96, s26, 3
    s_lshl_b32 s4, s25, 3
    s_add_u32 s7, s4, s79
    s_mul_i32 s5, s24, 5120
    v_add_u32 v8, s5, v14
    v_and_b32 v5, 7, v2
    v_lshrrev_b32 v6, 1, v3
    v_and_b32 v7, 1, v3
    v_lshlrev_b32 v7, 3, v7
    v_lshlrev_b32 v17, 11, v5
    v_lshl_add_u32 v17, v3, 5, v17
    v_lshrrev_b32 v4, 3, v2
    v_lshl_add_u32 v17, v4, 4, v17
    s_lshl_b32 s5, s24, 9
    v_add_u32 v17, s5, v17

    buffer_load_dwordx4 v[20:23], v17, s[12:15], 0 offen offset:0
    buffer_load_dwordx4 v[24:27], v17, s[12:15], 0 offen offset:128
    buffer_load_dwordx4 v[28:31], v17, s[12:15], 0 offen offset:256
    buffer_load_dwordx4 v[32:35], v17, s[12:15], 0 offen offset:384
    v_lshlrev_b32 v4, 7, v2
    v_lshl_add_u32 v18, s26, 10, v4
    v_add_u32 v18, 40960, v18
    v_and_b32 v4, 0x180, v4
    v_add_u32 v4, s76, v4
    v_bfe_u32 v19, v2, 2, 1
    s_sub_u32 s4, s77, s76
    v_mad_u32_u24 v4, v19, s4, v4
    v_cmp_gt_u32 vcc, 8, v2
    s_lshl_b32 s4, s24, 17
    s_add_u32 s4, s4, s34
    v_cndmask_b32 v4, v4, v18, vcc

    v_add_u32 v226, s4, v4

    s_mov_b64 exec, 0xffff
    buffer_load_dword v227, v4, s[8:11], s4 offen
    s_mov_b64 exec, -1
    s_lshl_b32 s4, s79, 12
    s_add_u32 s4, s4, 40960

    s_add_u32 s5, s96, 1
    s_and_b32 s5, s5, 3
    s_lshl_b32 s5, s5, 10
    s_add_u32 s5, s5, s4
    v_add_u32 v232, s5, v14

    s_add_u32 s5, s96, 2
    s_and_b32 s5, s5, 3
    s_lshl_b32 s5, s5, 10
    s_add_u32 s5, s5, s4
    v_add_u32 v233, s5, v14

    s_add_u32 s5, s96, 3
    s_and_b32 s5, s5, 3
    s_lshl_b32 s5, s5, 10
    s_add_u32 s5, s5, s4
    v_add_u32 v234, s5, v14

    s_lshl_b32 s5, s78, 9
    v_lshlrev_b32 v10, 8, v6
    v_lshl_add_u32 v10, v2, 4, v10
    v_add_u32 v10, v10, v7
    v_add_u32 v10, s5, v10
    v_add_u32 v18, 16384, v10
    s_lshl_b32 s5, s26, 10
    s_add_u32 s5, s5, 40960
    v_add_u32 v10, s5, v10
    v_lshlrev_b32 v11, 8, v3
    v_lshl_add_u32 v11, v5, 4, v11
    s_lshr_b32 s4, s96, 1
    s_lshl_b32 s4, s4, 10
    s_and_b32 s5, s96, 1
    s_lshl_b32 s5, s5, 7
    s_add_u32 s4, s4, s5
    s_add_u32 s4, s4, 2048
    v_add_u32 v11, s4, v11
    v_lshlrev_b32 v12, 8, v6
    v_lshl_add_u32 v12, v2, 4, v12
    s_lshl_b32 s4, s96, 9
    s_xor_b32 s4, s4, 5120
    v_add_u32 v12, s4, v12
    v_lshlrev_b32 v13, 7, v3
    v_lshl_add_u32 v13, v5, 4, v13
    v_add_u32 v13, s77, v13
    v_lshlrev_b32 v15, 7, v6
    v_lshl_add_u32 v15, v5, 4, v15
    v_add_u32 v15, v15, v7
    s_lshl_b32 s5, s78, 8
    s_add_u32 s5, s5, s76
    v_add_u32 v15, s5, v15
    v_lshlrev_b32 v16, 8, v6
    v_lshl_add_u32 v16, v2, 4, v16
    v_add_u32 v16, v16, v7
    s_lshl_b32 s5, s24, 9
    v_add_u32 v16, s5, v16
    s_lshl_b32 s5, s24, 11
    v_add_u32 v17, s5, v14
    v_cmp_gt_u32 s[58:59], 8, v2
    v_cmp_gt_u32 s[60:61], 32, v1
    v_mov_b32 v4, 0x4444
    v_mov_b32 v9, 0xeeee
    v_cndmask_b32 v9, v9, v4, s[58:59]
    s_not_b64 s[66:67], s[58:59]
    s_cmp_lt_u32 s24, 2
    s_cselect_b64 s[64:65], s[66:67], s[58:59]
    s_mov_b32 s56, 0x0000ffff
    s_mov_b32 s57, 0x0000ffff
    s_cmp_eq_u32 s24, 1
    s_cselect_b64 vcc, -1, 0
    s_cselect_b64 s[66:67], s[56:57], s[66:67]
    s_lshl_b32 s5, s78, 10
    v_add_u32 v19, s5, v14
    v_cndmask_b32 v11, v11, v12, vcc
    v_cndmask_b32 v235, v235, v236, vcc
    v_mov_b32 v4, 0xff800000
    v_cndmask_b32 v116, 0, v4, s[60:61]
    v_mov_b32 v117, v116
    v_mov_b32 v118, v116
    v_mov_b32 v119, v116
    s_mul_i32 s5, s78, 8192
    v_add_u32 v246, s5, v14
    v_lshlrev_b32 v247, 9, v6
    v_lshl_add_u32 v247, v2, 4, v247
    s_lshl_b32 s5, s78, 8
    s_add_u32 s5, s5, 12288
    v_add_u32 v247, s5, v247
    v_and_b32 v4, 31, v1
    v_lshlrev_b32 v248, 4, v4
    s_lshl_b32 s5, s78, 9
    s_add_u32 s5, s5, 12288
    v_add_u32 v248, s5, v248
    s_lshl_b32 s5, s25, 16
    v_and_b32 v7, 1, v3
    v_lshlrev_b32 v237, 18, v7
    v_lshl_add_u32 v237, v6, 8, v237
    v_lshl_add_u32 v237, v2, 4, v237
    v_add_u32 v237, s5, v237
    s_lshl_b32 s6, s78, 9
    v_add_u32 v237, s6, v237
    s_lshl_b32 s6, s78, 8
    v_lshlrev_b32 v249, 9, v7
    v_lshl_add_u32 v249, v2, 4, v249
    v_add_u32 v249, s6, v249
    v_add_u32 v4, s25, v6
    v_add_u32 v4, 1, v4
    v_and_b32 v4, 3, v4
    v_lshl_add_u32 v239, v4, 16, v249
    s_add_u32 s6, s25, 3
    s_and_b32 s6, s6, 3
    s_lshl_b32 s6, s6, 16
    v_add_u32 v249, s6, v249
    v_and_b32 v4, 1, v5
    v_lshlrev_b32 v4, 4, v4
    v_mov_b32 v6, 0x3f80
    v_lshlrev_b32 v6, v4, v6
    v_lshrrev_b32 v4, 1, v5

    v_cmp_eq_u32 vcc, 0, v4
    s_nop 1
    v_cndmask_b32 v84, 0, v6, vcc
    v_cmp_eq_u32 vcc, 1, v4
    s_nop 1
    v_cndmask_b32 v85, 0, v6, vcc
    v_cmp_eq_u32 vcc, 2, v4
    s_nop 1
    v_cndmask_b32 v86, 0, v6, vcc
    v_cmp_eq_u32 vcc, 3, v4
    s_nop 1
    v_cndmask_b32 v87, 0, v6, vcc
    v_mov_b32 v120, 0x3f803f80
    v_cndmask_b32 v112, 0, v84, s[60:61]
    v_mov_b32 v121, 0x3f803f80
    v_cndmask_b32 v113, 0, v85, s[60:61]
    v_mov_b32 v122, 0x3f803f80
    v_cndmask_b32 v114, 0, v86, s[60:61]
    v_mov_b32 v123, 0x3f803f80
    v_cndmask_b32 v115, 0, v87, s[60:61]
    v_mov_b32 v170, 0
    v_mov_b32 v171, 0
    v_mov_b32 v174, 0
    v_mov_b32 v175, 0
    v_mov_b32 v182, 0
    v_mov_b32 v183, 0
    s_add_u32 s5, s96, 0
    s_and_b32 s5, s5, 3
    s_lshl_b32 s5, s5, 10
    s_add_u32 s5, s5, 20480
    v_add_u32 v228, s5, v14

    s_add_u32 s5, s96, 1
    s_and_b32 s5, s5, 3
    s_lshl_b32 s5, s5, 10
    s_add_u32 s5, s5, 20480
    v_add_u32 v229, s5, v14

    s_add_u32 s5, s96, 2
    s_and_b32 s5, s5, 3
    s_lshl_b32 s5, s5, 10
    s_add_u32 s5, s5, 20480
    v_add_u32 v230, s5, v14

    s_add_u32 s5, s96, 3
    s_and_b32 s5, s5, 3
    s_lshl_b32 s5, s5, 10
    s_add_u32 s5, s5, 20480
    v_add_u32 v231, s5, v14

    s_lshl_b32 s89, s7, 8
    s_add_u32 s89, s89, 92282880
    v_lshlrev_b32 v253, 13, v1
    s_lshl_b32 s4, s7, 13
    s_add_u32 s38, s4, 16777216
    s_lshl_b32 s5, s96, 11
    s_add_u32 s39, s4, s5
    s_add_u32 s30, s39, 17039360
    s_xor_b32 s39, s39, 4096
    s_add_u32 s39, s39, 33554432
    s_lshl_b32 s5, s78, 24
    s_add_u32 s30, s30, s5
    s_lshl_b32 s5, s78, 12
    s_add_u32 s38, s38, s5
    s_add_u32 s90, s5, 20480
    s_lshl_b32 s5, s78, 10
    s_add_u32 s39, s39, s5
    s_add_u32 s91, s5, 28672
    s_mov_b32 s37, 0x3e0293ee
    s_mov_b32 s28, 0

    v_and_b32 v4, 31, v1
    v_lshlrev_b32 v225, 6, v4
    v_lshrrev_b32 v4, 5, v1
    v_lshl_add_u32 v225, v4, 24, v225

    v_mov_b32 v52, 0
    v_mov_b32 v53, 0
    v_mov_b32 v54, 0
    v_mov_b32 v55, 0
    v_mov_b32 v56, 0
    v_mov_b32 v57, 0
    v_mov_b32 v58, 0
    v_mov_b32 v59, 0
    v_mov_b32 v60, 0
    v_mov_b32 v61, 0
    v_mov_b32 v62, 0
    v_mov_b32 v63, 0
    v_mov_b32 v64, 0
    v_mov_b32 v65, 0
    v_mov_b32 v66, 0
    v_mov_b32 v67, 0
    v_mov_b32 v68, 0
    v_mov_b32 v69, 0
    v_mov_b32 v70, 0
    v_mov_b32 v71, 0
    v_mov_b32 v72, 0
    v_mov_b32 v73, 0
    v_mov_b32 v74, 0
    v_mov_b32 v75, 0
    v_mov_b32 v76, 0
    v_mov_b32 v77, 0
    v_mov_b32 v78, 0
    v_mov_b32 v79, 0
    v_mov_b32 v80, 0
    v_mov_b32 v81, 0
    v_mov_b32 v82, 0
    v_mov_b32 v83, 0
    v_mov_b32 v92, -1
    v_mov_b32 v93, -1
    v_mov_b32 v94, -1
    v_mov_b32 v95, -1
    v_mov_b32 v96, -1
    v_mov_b32 v97, -1
    v_mov_b32 v98, -1
    v_mov_b32 v99, -1
    v_mov_b32 v100, -1
    v_mov_b32 v101, -1
    v_mov_b32 v102, -1
    v_mov_b32 v103, -1
    v_mov_b32 v192, -1
    v_mov_b32 v193, -1
    v_mov_b32 v194, -1
    v_mov_b32 v195, -1
    v_mov_b32 v196, -1
    v_mov_b32 v197, -1
    v_mov_b32 v198, -1
    v_mov_b32 v199, -1
    v_mov_b32 v200, -1
    v_mov_b32 v201, -1
    v_mov_b32 v202, -1
    v_mov_b32 v203, -1
    v_mov_b32 v204, -1
    v_mov_b32 v205, -1
    v_mov_b32 v206, -1
    v_mov_b32 v207, -1
    v_mov_b32 v208, -1
    v_mov_b32 v209, -1
    v_mov_b32 v210, -1
    v_mov_b32 v211, -1
    v_mov_b32 v212, -1
    v_mov_b32 v213, -1
    v_mov_b32 v214, -1
    v_mov_b32 v215, -1
    v_mov_b32 v216, -1
    v_mov_b32 v217, -1
    v_mov_b32 v218, -1
    v_mov_b32 v219, -1
    v_mov_b32 v220, -1
    v_mov_b32 v221, -1
    v_mov_b32 v222, -1
    v_mov_b32 v223, -1
    s_bitcmp1_b32 s26, 0
    s_cbranch_scc1 .po_13
    s_waitcnt vmcnt(29)
    ds_read_b64_tr_b16 a[0:1], v252 offset:0
    ds_read_b64_tr_b16 a[2:3], v252 offset:128
    ds_read_b64_tr_b16 a[4:5], v252 offset:2048
    ds_read_b64_tr_b16 a[6:7], v252 offset:2176
    ds_read_b64_tr_b16 a[8:9], v252 offset:4096
    ds_read_b64_tr_b16 a[10:11], v252 offset:4224
    ds_read_b64_tr_b16 a[12:13], v252 offset:6144
    ds_read_b64_tr_b16 a[14:15], v252 offset:6272
    ds_read_b64_tr_b16 a[32:33], v252 offset:16
    ds_read_b64_tr_b16 a[34:35], v252 offset:144
    ds_read_b64_tr_b16 a[36:37], v252 offset:2064
    ds_read_b64_tr_b16 a[38:39], v252 offset:2192
    ds_read_b64_tr_b16 a[40:41], v252 offset:4112
    ds_read_b64_tr_b16 a[42:43], v252 offset:4240
    ds_read_b64_tr_b16 a[44:45], v252 offset:6160
    ds_read_b64_tr_b16 a[46:47], v252 offset:6288
    s_waitcnt lgkmcnt(0)
    s_mov_b32 s16, s48
    s_and_b32 s17, s49, 0xffff
    s_mov_b32 s18, 0x800000
    s_mov_b32 s19, 0x00020000

    s_add_u32 m0, s98, 0
    s_mov_b32 s5, 0
    buffer_load_dwordx4 v224, s[16:19], s5 offen  lds

    s_add_u32 m0, s98, 1024
    s_mov_b32 s5, 131072
    buffer_load_dwordx4 v224, s[16:19], s5 offen  lds

    s_add_u32 m0, s98, 2048
    s_mov_b32 s5, 262144
    buffer_load_dwordx4 v224, s[16:19], s5 offen  lds

    s_add_u32 m0, s98, 3072
    s_mov_b32 s5, 393216
    buffer_load_dwordx4 v224, s[16:19], s5 offen  lds

    s_add_u32 m0, s98, 4096
    s_mov_b32 s5, 524288
    buffer_load_dwordx4 v224, s[16:19], s5 offen  lds

    s_add_u32 m0, s98, 5120
    s_mov_b32 s5, 655360
    buffer_load_dwordx4 v224, s[16:19], s5 offen  lds

    s_add_u32 m0, s98, 6144
    s_mov_b32 s5, 786432
    buffer_load_dwordx4 v224, s[16:19], s5 offen  lds

    s_add_u32 m0, s98, 7168
    s_mov_b32 s5, 917504
    buffer_load_dwordx4 v224, s[16:19], s5 offen  lds

    s_waitcnt vmcnt(29)
    ds_read_b64_tr_b16 a[16:17], v252 offset:8192
    ds_read_b64_tr_b16 a[18:19], v252 offset:8320
    ds_read_b64_tr_b16 a[20:21], v252 offset:10240
    ds_read_b64_tr_b16 a[22:23], v252 offset:10368
    ds_read_b64_tr_b16 a[24:25], v252 offset:12288
    ds_read_b64_tr_b16 a[26:27], v252 offset:12416
    ds_read_b64_tr_b16 a[28:29], v252 offset:14336
    ds_read_b64_tr_b16 a[30:31], v252 offset:14464
    ds_read_b64_tr_b16 a[48:49], v252 offset:8208
    ds_read_b64_tr_b16 a[50:51], v252 offset:8336
    ds_read_b64_tr_b16 a[52:53], v252 offset:10256
    ds_read_b64_tr_b16 a[54:55], v252 offset:10384
    ds_read_b64_tr_b16 a[56:57], v252 offset:12304
    ds_read_b64_tr_b16 a[58:59], v252 offset:12432
    ds_read_b64_tr_b16 a[60:61], v252 offset:14352
    ds_read_b64_tr_b16 a[62:63], v252 offset:14480
    s_waitcnt lgkmcnt(0)
    s_add_u32 m0, s98, 8192
    s_mov_b32 s5, 1048576
    buffer_load_dwordx4 v224, s[16:19], s5 offen  lds

    s_add_u32 m0, s98, 9216
    s_mov_b32 s5, 1179648
    buffer_load_dwordx4 v224, s[16:19], s5 offen  lds

    s_add_u32 m0, s98, 10240
    s_mov_b32 s5, 1310720
    buffer_load_dwordx4 v224, s[16:19], s5 offen  lds

    s_add_u32 m0, s98, 11264
    s_mov_b32 s5, 1441792
    buffer_load_dwordx4 v224, s[16:19], s5 offen  lds

    s_add_u32 m0, s98, 12288
    s_mov_b32 s5, 1572864
    buffer_load_dwordx4 v224, s[16:19], s5 offen  lds

    s_add_u32 m0, s98, 13312
    s_mov_b32 s5, 1703936
    buffer_load_dwordx4 v224, s[16:19], s5 offen  lds

    s_add_u32 m0, s98, 14336
    s_mov_b32 s5, 1835008
    buffer_load_dwordx4 v224, s[16:19], s5 offen  lds

    s_add_u32 m0, s98, 15360
    s_mov_b32 s5, 1966080
    buffer_load_dwordx4 v224, s[16:19], s5 offen  lds

    s_waitcnt vmcnt(29)
    ds_read_b64_tr_b16 a[64:65], v252 offset:16384
    ds_read_b64_tr_b16 a[66:67], v252 offset:16512
    ds_read_b64_tr_b16 a[68:69], v252 offset:18432
    ds_read_b64_tr_b16 a[70:71], v252 offset:18560
    ds_read_b64_tr_b16 a[72:73], v252 offset:20480
    ds_read_b64_tr_b16 a[74:75], v252 offset:20608
    ds_read_b64_tr_b16 a[76:77], v252 offset:22528
    ds_read_b64_tr_b16 a[78:79], v252 offset:22656
    ds_read_b64_tr_b16 a[96:97], v252 offset:16400
    ds_read_b64_tr_b16 a[98:99], v252 offset:16528
    ds_read_b64_tr_b16 a[100:101], v252 offset:18448
    ds_read_b64_tr_b16 a[102:103], v252 offset:18576
    ds_read_b64_tr_b16 a[104:105], v252 offset:20496
    ds_read_b64_tr_b16 a[106:107], v252 offset:20624
    ds_read_b64_tr_b16 a[108:109], v252 offset:22544
    ds_read_b64_tr_b16 a[110:111], v252 offset:22672
    s_waitcnt lgkmcnt(0)
    s_mov_b32 s16, s50
    s_and_b32 s17, s51, 0xffff
    s_mov_b32 s18, 0x800000
    s_mov_b32 s19, 0x00020000

    s_add_u32 m0, s98, 16384
    s_add_u32 s5, s80, 0
    buffer_load_dwordx4 v241, s[16:19], s5 offen  lds

    s_add_u32 m0, s98, 17408
    s_add_u32 s5, s80, 32768
    buffer_load_dwordx4 v241, s[16:19], s5 offen  lds

    s_add_u32 m0, s98, 18432
    s_add_u32 s5, s80, 65536
    buffer_load_dwordx4 v241, s[16:19], s5 offen  lds

    s_add_u32 m0, s98, 19456
    s_add_u32 s5, s80, 98304
    buffer_load_dwordx4 v241, s[16:19], s5 offen  lds

    s_add_u32 m0, s98, 20480
    s_add_u32 s5, s80, 131072
    buffer_load_dwordx4 v241, s[16:19], s5 offen  lds

    s_add_u32 m0, s98, 21504
    s_add_u32 s5, s80, 163840
    buffer_load_dwordx4 v241, s[16:19], s5 offen  lds

    s_add_u32 m0, s98, 22528
    s_add_u32 s5, s80, 196608
    buffer_load_dwordx4 v241, s[16:19], s5 offen  lds

    s_add_u32 m0, s98, 23552
    s_add_u32 s5, s80, 229376
    buffer_load_dwordx4 v241, s[16:19], s5 offen  lds

    s_waitcnt vmcnt(29)
    ds_read_b64_tr_b16 a[80:81], v252 offset:24576
    ds_read_b64_tr_b16 a[82:83], v252 offset:24704
    ds_read_b64_tr_b16 a[84:85], v252 offset:26624
    ds_read_b64_tr_b16 a[86:87], v252 offset:26752
    ds_read_b64_tr_b16 a[88:89], v252 offset:28672
    ds_read_b64_tr_b16 a[90:91], v252 offset:28800
    ds_read_b64_tr_b16 a[92:93], v252 offset:30720
    ds_read_b64_tr_b16 a[94:95], v252 offset:30848
    ds_read_b64_tr_b16 a[112:113], v252 offset:24592
    ds_read_b64_tr_b16 a[114:115], v252 offset:24720
    ds_read_b64_tr_b16 a[116:117], v252 offset:26640
    ds_read_b64_tr_b16 a[118:119], v252 offset:26768
    ds_read_b64_tr_b16 a[120:121], v252 offset:28688
    ds_read_b64_tr_b16 a[122:123], v252 offset:28816
    ds_read_b64_tr_b16 a[124:125], v252 offset:30736
    ds_read_b64_tr_b16 a[126:127], v252 offset:30864
    s_waitcnt lgkmcnt(0)
    s_add_u32 m0, s98, 24576
    s_add_u32 s5, s81, 0
    buffer_load_dwordx4 v241, s[16:19], s5 offen  lds

    s_add_u32 m0, s98, 25600
    s_add_u32 s5, s81, 32768
    buffer_load_dwordx4 v241, s[16:19], s5 offen  lds

    s_add_u32 m0, s98, 26624
    s_add_u32 s5, s81, 65536
    buffer_load_dwordx4 v241, s[16:19], s5 offen  lds

    s_add_u32 m0, s98, 27648
    s_add_u32 s5, s81, 98304
    buffer_load_dwordx4 v241, s[16:19], s5 offen  lds

    s_add_u32 m0, s98, 28672
    s_add_u32 s5, s81, 131072
    buffer_load_dwordx4 v241, s[16:19], s5 offen  lds

    s_add_u32 m0, s98, 29696
    s_add_u32 s5, s81, 163840
    buffer_load_dwordx4 v241, s[16:19], s5 offen  lds

    s_add_u32 m0, s98, 30720
    s_add_u32 s5, s81, 196608
    buffer_load_dwordx4 v241, s[16:19], s5 offen  lds

    s_add_u32 m0, s98, 31744
    s_add_u32 s5, s81, 229376
    buffer_load_dwordx4 v241, s[16:19], s5 offen  lds

    v_and_b32 v241, 3, v0
    v_lshlrev_b32 v241, 2, v241

    v_and_b32 v240, 12, v0
    v_lshl_add_u32 v241, v240, 4, v241
    v_add_u32 v241, s97, v241
    v_and_b32 v241, 255, v241

    buffer_load_dword v240, v241, s[20:23], 0 offen sc1
    s_waitcnt vmcnt(25)
    ds_read_b64_tr_b16 a[128:129], v254 offset:0
    ds_read_b64_tr_b16 a[130:131], v254 offset:128
    ds_read_b64_tr_b16 a[132:133], v254 offset:2048
    ds_read_b64_tr_b16 a[134:135], v254 offset:2176
    ds_read_b64_tr_b16 a[136:137], v254 offset:4096
    ds_read_b64_tr_b16 a[138:139], v254 offset:4224
    ds_read_b64_tr_b16 a[140:141], v254 offset:6144
    ds_read_b64_tr_b16 a[142:143], v254 offset:6272
    ds_read_b64_tr_b16 a[160:161], v254 offset:32
    ds_read_b64_tr_b16 a[162:163], v254 offset:160
    ds_read_b64_tr_b16 a[164:165], v254 offset:2080
    ds_read_b64_tr_b16 a[166:167], v254 offset:2208
    ds_read_b64_tr_b16 a[168:169], v254 offset:4128
    ds_read_b64_tr_b16 a[170:171], v254 offset:4256
    ds_read_b64_tr_b16 a[172:173], v254 offset:6176
    ds_read_b64_tr_b16 a[174:175], v254 offset:6304
    s_waitcnt vmcnt(17)
    ds_read_b64_tr_b16 a[144:145], v254 offset:8192
    ds_read_b64_tr_b16 a[146:147], v254 offset:8320
    ds_read_b64_tr_b16 a[148:149], v254 offset:10240
    ds_read_b64_tr_b16 a[150:151], v254 offset:10368
    ds_read_b64_tr_b16 a[152:153], v254 offset:12288
    ds_read_b64_tr_b16 a[154:155], v254 offset:12416
    ds_read_b64_tr_b16 a[156:157], v254 offset:14336
    ds_read_b64_tr_b16 a[158:159], v254 offset:14464
    ds_read_b64_tr_b16 a[176:177], v254 offset:8224
    ds_read_b64_tr_b16 a[178:179], v254 offset:8352
    ds_read_b64_tr_b16 a[180:181], v254 offset:10272
    ds_read_b64_tr_b16 a[182:183], v254 offset:10400
    ds_read_b64_tr_b16 a[184:185], v254 offset:12320
    ds_read_b64_tr_b16 a[186:187], v254 offset:12448
    ds_read_b64_tr_b16 a[188:189], v254 offset:14368
    ds_read_b64_tr_b16 a[190:191], v254 offset:14496
    s_waitcnt vmcnt(9)
    s_mov_b64 exec, 0xffff
    s_mov_b32 exec_hi, 0
    buffer_load_dword v227, v226, s[8:11], 0 offen
    s_mov_b64 exec, -1
    ds_read_b64_tr_b16 a[192:193], v255 offset:16384
    ds_read_b64_tr_b16 a[194:195], v255 offset:16512
    ds_read_b64_tr_b16 a[196:197], v255 offset:18432
    ds_read_b64_tr_b16 a[198:199], v255 offset:18560
    ds_read_b64_tr_b16 a[200:201], v255 offset:20480
    ds_read_b64_tr_b16 a[202:203], v255 offset:20608
    ds_read_b64_tr_b16 a[204:205], v255 offset:22528
    ds_read_b64_tr_b16 a[206:207], v255 offset:22656
    ds_read_b64_tr_b16 a[224:225], v255 offset:16416
    ds_read_b64_tr_b16 a[226:227], v255 offset:16544
    ds_read_b64_tr_b16 a[228:229], v255 offset:18464
    ds_read_b64_tr_b16 a[230:231], v255 offset:18592
    ds_read_b64_tr_b16 a[232:233], v255 offset:20512
    ds_read_b64_tr_b16 a[234:235], v255 offset:20640
    ds_read_b64_tr_b16 a[236:237], v255 offset:22560
    ds_read_b64_tr_b16 a[238:239], v255 offset:22688
    s_waitcnt vmcnt(2)
    ds_read_b64_tr_b16 a[208:209], v255 offset:24576
    ds_read_b64_tr_b16 a[210:211], v255 offset:24704
    ds_read_b64_tr_b16 a[212:213], v255 offset:26624
    ds_read_b64_tr_b16 a[214:215], v255 offset:26752
    ds_read_b64_tr_b16 a[216:217], v255 offset:28672
    ds_read_b64_tr_b16 a[218:219], v255 offset:28800
    ds_read_b64_tr_b16 a[220:221], v255 offset:30720
    ds_read_b64_tr_b16 a[222:223], v255 offset:30848
    ds_read_b64_tr_b16 a[240:241], v255 offset:24608
    ds_read_b64_tr_b16 a[242:243], v255 offset:24736
    ds_read_b64_tr_b16 a[244:245], v255 offset:26656
    ds_read_b64_tr_b16 a[246:247], v255 offset:26784
    ds_read_b64_tr_b16 a[248:249], v255 offset:28704
    ds_read_b64_tr_b16 a[250:251], v255 offset:28832
    ds_read_b64_tr_b16 a[252:253], v255 offset:30752
    ds_read_b64_tr_b16 a[254:255], v255 offset:30880
    s_branch .pj_14
.po_13:
    s_waitcnt vmcnt(29)
    ds_read_b64_tr_b16 a[16:17], v252 offset:8192
    ds_read_b64_tr_b16 a[18:19], v252 offset:8320
    ds_read_b64_tr_b16 a[20:21], v252 offset:10240
    ds_read_b64_tr_b16 a[22:23], v252 offset:10368
    ds_read_b64_tr_b16 a[24:25], v252 offset:12288
    ds_read_b64_tr_b16 a[26:27], v252 offset:12416
    ds_read_b64_tr_b16 a[28:29], v252 offset:14336
    ds_read_b64_tr_b16 a[30:31], v252 offset:14464
    ds_read_b64_tr_b16 a[48:49], v252 offset:8208
    ds_read_b64_tr_b16 a[50:51], v252 offset:8336
    ds_read_b64_tr_b16 a[52:53], v252 offset:10256
    ds_read_b64_tr_b16 a[54:55], v252 offset:10384
    ds_read_b64_tr_b16 a[56:57], v252 offset:12304
    ds_read_b64_tr_b16 a[58:59], v252 offset:12432
    ds_read_b64_tr_b16 a[60:61], v252 offset:14352
    ds_read_b64_tr_b16 a[62:63], v252 offset:14480
    s_waitcnt lgkmcnt(0)
    s_mov_b32 s16, s48
    s_and_b32 s17, s49, 0xffff
    s_mov_b32 s18, 0x800000
    s_mov_b32 s19, 0x00020000

    s_add_u32 m0, s98, 8192
    s_mov_b32 s5, 1048576
    buffer_load_dwordx4 v224, s[16:19], s5 offen  lds

    s_add_u32 m0, s98, 9216
    s_mov_b32 s5, 1179648
    buffer_load_dwordx4 v224, s[16:19], s5 offen  lds

    s_add_u32 m0, s98, 10240
    s_mov_b32 s5, 1310720
    buffer_load_dwordx4 v224, s[16:19], s5 offen  lds

    s_add_u32 m0, s98, 11264
    s_mov_b32 s5, 1441792
    buffer_load_dwordx4 v224, s[16:19], s5 offen  lds

    s_add_u32 m0, s98, 12288
    s_mov_b32 s5, 1572864
    buffer_load_dwordx4 v224, s[16:19], s5 offen  lds

    s_add_u32 m0, s98, 13312
    s_mov_b32 s5, 1703936
    buffer_load_dwordx4 v224, s[16:19], s5 offen  lds

    s_add_u32 m0, s98, 14336
    s_mov_b32 s5, 1835008
    buffer_load_dwordx4 v224, s[16:19], s5 offen  lds

    s_add_u32 m0, s98, 15360
    s_mov_b32 s5, 1966080
    buffer_load_dwordx4 v224, s[16:19], s5 offen  lds

    s_waitcnt vmcnt(29)
    ds_read_b64_tr_b16 a[0:1], v252 offset:0
    ds_read_b64_tr_b16 a[2:3], v252 offset:128
    ds_read_b64_tr_b16 a[4:5], v252 offset:2048
    ds_read_b64_tr_b16 a[6:7], v252 offset:2176
    ds_read_b64_tr_b16 a[8:9], v252 offset:4096
    ds_read_b64_tr_b16 a[10:11], v252 offset:4224
    ds_read_b64_tr_b16 a[12:13], v252 offset:6144
    ds_read_b64_tr_b16 a[14:15], v252 offset:6272
    ds_read_b64_tr_b16 a[32:33], v252 offset:16
    ds_read_b64_tr_b16 a[34:35], v252 offset:144
    ds_read_b64_tr_b16 a[36:37], v252 offset:2064
    ds_read_b64_tr_b16 a[38:39], v252 offset:2192
    ds_read_b64_tr_b16 a[40:41], v252 offset:4112
    ds_read_b64_tr_b16 a[42:43], v252 offset:4240
    ds_read_b64_tr_b16 a[44:45], v252 offset:6160
    ds_read_b64_tr_b16 a[46:47], v252 offset:6288
    s_waitcnt lgkmcnt(0)
    s_add_u32 m0, s98, 0
    s_mov_b32 s5, 0
    buffer_load_dwordx4 v224, s[16:19], s5 offen  lds

    s_add_u32 m0, s98, 1024
    s_mov_b32 s5, 131072
    buffer_load_dwordx4 v224, s[16:19], s5 offen  lds

    s_add_u32 m0, s98, 2048
    s_mov_b32 s5, 262144
    buffer_load_dwordx4 v224, s[16:19], s5 offen  lds

    s_add_u32 m0, s98, 3072
    s_mov_b32 s5, 393216
    buffer_load_dwordx4 v224, s[16:19], s5 offen  lds

    s_add_u32 m0, s98, 4096
    s_mov_b32 s5, 524288
    buffer_load_dwordx4 v224, s[16:19], s5 offen  lds

    s_add_u32 m0, s98, 5120
    s_mov_b32 s5, 655360
    buffer_load_dwordx4 v224, s[16:19], s5 offen  lds

    s_add_u32 m0, s98, 6144
    s_mov_b32 s5, 786432
    buffer_load_dwordx4 v224, s[16:19], s5 offen  lds

    s_add_u32 m0, s98, 7168
    s_mov_b32 s5, 917504
    buffer_load_dwordx4 v224, s[16:19], s5 offen  lds

    s_waitcnt vmcnt(29)
    ds_read_b64_tr_b16 a[80:81], v252 offset:24576
    ds_read_b64_tr_b16 a[82:83], v252 offset:24704
    ds_read_b64_tr_b16 a[84:85], v252 offset:26624
    ds_read_b64_tr_b16 a[86:87], v252 offset:26752
    ds_read_b64_tr_b16 a[88:89], v252 offset:28672
    ds_read_b64_tr_b16 a[90:91], v252 offset:28800
    ds_read_b64_tr_b16 a[92:93], v252 offset:30720
    ds_read_b64_tr_b16 a[94:95], v252 offset:30848
    ds_read_b64_tr_b16 a[112:113], v252 offset:24592
    ds_read_b64_tr_b16 a[114:115], v252 offset:24720
    ds_read_b64_tr_b16 a[116:117], v252 offset:26640
    ds_read_b64_tr_b16 a[118:119], v252 offset:26768
    ds_read_b64_tr_b16 a[120:121], v252 offset:28688
    ds_read_b64_tr_b16 a[122:123], v252 offset:28816
    ds_read_b64_tr_b16 a[124:125], v252 offset:30736
    ds_read_b64_tr_b16 a[126:127], v252 offset:30864
    s_waitcnt lgkmcnt(0)
    s_mov_b32 s16, s50
    s_and_b32 s17, s51, 0xffff
    s_mov_b32 s18, 0x800000
    s_mov_b32 s19, 0x00020000

    s_add_u32 m0, s98, 24576
    s_add_u32 s5, s81, 0
    buffer_load_dwordx4 v241, s[16:19], s5 offen  lds

    s_add_u32 m0, s98, 25600
    s_add_u32 s5, s81, 32768
    buffer_load_dwordx4 v241, s[16:19], s5 offen  lds

    s_add_u32 m0, s98, 26624
    s_add_u32 s5, s81, 65536
    buffer_load_dwordx4 v241, s[16:19], s5 offen  lds

    s_add_u32 m0, s98, 27648
    s_add_u32 s5, s81, 98304
    buffer_load_dwordx4 v241, s[16:19], s5 offen  lds

    s_add_u32 m0, s98, 28672
    s_add_u32 s5, s81, 131072
    buffer_load_dwordx4 v241, s[16:19], s5 offen  lds

    s_add_u32 m0, s98, 29696
    s_add_u32 s5, s81, 163840
    buffer_load_dwordx4 v241, s[16:19], s5 offen  lds

    s_add_u32 m0, s98, 30720
    s_add_u32 s5, s81, 196608
    buffer_load_dwordx4 v241, s[16:19], s5 offen  lds

    s_add_u32 m0, s98, 31744
    s_add_u32 s5, s81, 229376
    buffer_load_dwordx4 v241, s[16:19], s5 offen  lds

    s_waitcnt vmcnt(29)
    ds_read_b64_tr_b16 a[64:65], v252 offset:16384
    ds_read_b64_tr_b16 a[66:67], v252 offset:16512
    ds_read_b64_tr_b16 a[68:69], v252 offset:18432
    ds_read_b64_tr_b16 a[70:71], v252 offset:18560
    ds_read_b64_tr_b16 a[72:73], v252 offset:20480
    ds_read_b64_tr_b16 a[74:75], v252 offset:20608
    ds_read_b64_tr_b16 a[76:77], v252 offset:22528
    ds_read_b64_tr_b16 a[78:79], v252 offset:22656
    ds_read_b64_tr_b16 a[96:97], v252 offset:16400
    ds_read_b64_tr_b16 a[98:99], v252 offset:16528
    ds_read_b64_tr_b16 a[100:101], v252 offset:18448
    ds_read_b64_tr_b16 a[102:103], v252 offset:18576
    ds_read_b64_tr_b16 a[104:105], v252 offset:20496
    ds_read_b64_tr_b16 a[106:107], v252 offset:20624
    ds_read_b64_tr_b16 a[108:109], v252 offset:22544
    ds_read_b64_tr_b16 a[110:111], v252 offset:22672
    s_waitcnt lgkmcnt(0)
    s_add_u32 m0, s98, 16384
    s_add_u32 s5, s80, 0
    buffer_load_dwordx4 v241, s[16:19], s5 offen  lds

    s_add_u32 m0, s98, 17408
    s_add_u32 s5, s80, 32768
    buffer_load_dwordx4 v241, s[16:19], s5 offen  lds

    s_add_u32 m0, s98, 18432
    s_add_u32 s5, s80, 65536
    buffer_load_dwordx4 v241, s[16:19], s5 offen  lds

    s_add_u32 m0, s98, 19456
    s_add_u32 s5, s80, 98304
    buffer_load_dwordx4 v241, s[16:19], s5 offen  lds

    s_add_u32 m0, s98, 20480
    s_add_u32 s5, s80, 131072
    buffer_load_dwordx4 v241, s[16:19], s5 offen  lds

    s_add_u32 m0, s98, 21504
    s_add_u32 s5, s80, 163840
    buffer_load_dwordx4 v241, s[16:19], s5 offen  lds

    s_add_u32 m0, s98, 22528
    s_add_u32 s5, s80, 196608
    buffer_load_dwordx4 v241, s[16:19], s5 offen  lds

    s_add_u32 m0, s98, 23552
    s_add_u32 s5, s80, 229376
    buffer_load_dwordx4 v241, s[16:19], s5 offen  lds

    v_and_b32 v241, 3, v0
    v_lshlrev_b32 v241, 2, v241

    v_and_b32 v240, 12, v0
    v_lshl_add_u32 v241, v240, 4, v241
    v_add_u32 v241, s97, v241
    v_and_b32 v241, 255, v241

    buffer_load_dword v240, v241, s[20:23], 0 offen sc1
    s_waitcnt vmcnt(25)
    ds_read_b64_tr_b16 a[144:145], v254 offset:8192
    ds_read_b64_tr_b16 a[146:147], v254 offset:8320
    ds_read_b64_tr_b16 a[148:149], v254 offset:10240
    ds_read_b64_tr_b16 a[150:151], v254 offset:10368
    ds_read_b64_tr_b16 a[152:153], v254 offset:12288
    ds_read_b64_tr_b16 a[154:155], v254 offset:12416
    ds_read_b64_tr_b16 a[156:157], v254 offset:14336
    ds_read_b64_tr_b16 a[158:159], v254 offset:14464
    ds_read_b64_tr_b16 a[176:177], v254 offset:8224
    ds_read_b64_tr_b16 a[178:179], v254 offset:8352
    ds_read_b64_tr_b16 a[180:181], v254 offset:10272
    ds_read_b64_tr_b16 a[182:183], v254 offset:10400
    ds_read_b64_tr_b16 a[184:185], v254 offset:12320
    ds_read_b64_tr_b16 a[186:187], v254 offset:12448
    ds_read_b64_tr_b16 a[188:189], v254 offset:14368
    ds_read_b64_tr_b16 a[190:191], v254 offset:14496
    s_waitcnt vmcnt(17)
    ds_read_b64_tr_b16 a[128:129], v254 offset:0
    ds_read_b64_tr_b16 a[130:131], v254 offset:128
    ds_read_b64_tr_b16 a[132:133], v254 offset:2048
    ds_read_b64_tr_b16 a[134:135], v254 offset:2176
    ds_read_b64_tr_b16 a[136:137], v254 offset:4096
    ds_read_b64_tr_b16 a[138:139], v254 offset:4224
    ds_read_b64_tr_b16 a[140:141], v254 offset:6144
    ds_read_b64_tr_b16 a[142:143], v254 offset:6272
    ds_read_b64_tr_b16 a[160:161], v254 offset:32
    ds_read_b64_tr_b16 a[162:163], v254 offset:160
    ds_read_b64_tr_b16 a[164:165], v254 offset:2080
    ds_read_b64_tr_b16 a[166:167], v254 offset:2208
    ds_read_b64_tr_b16 a[168:169], v254 offset:4128
    ds_read_b64_tr_b16 a[170:171], v254 offset:4256
    ds_read_b64_tr_b16 a[172:173], v254 offset:6176
    ds_read_b64_tr_b16 a[174:175], v254 offset:6304
    s_waitcnt vmcnt(9)
    s_mov_b64 exec, 0xffff
    s_mov_b32 exec_hi, 0
    buffer_load_dword v227, v226, s[8:11], 0 offen
    s_mov_b64 exec, -1
    ds_read_b64_tr_b16 a[208:209], v255 offset:24576
    ds_read_b64_tr_b16 a[210:211], v255 offset:24704
    ds_read_b64_tr_b16 a[212:213], v255 offset:26624
    ds_read_b64_tr_b16 a[214:215], v255 offset:26752
    ds_read_b64_tr_b16 a[216:217], v255 offset:28672
    ds_read_b64_tr_b16 a[218:219], v255 offset:28800
    ds_read_b64_tr_b16 a[220:221], v255 offset:30720
    ds_read_b64_tr_b16 a[222:223], v255 offset:30848
    ds_read_b64_tr_b16 a[240:241], v255 offset:24608
    ds_read_b64_tr_b16 a[242:243], v255 offset:24736
    ds_read_b64_tr_b16 a[244:245], v255 offset:26656
    ds_read_b64_tr_b16 a[246:247], v255 offset:26784
    ds_read_b64_tr_b16 a[248:249], v255 offset:28704
    ds_read_b64_tr_b16 a[250:251], v255 offset:28832
    ds_read_b64_tr_b16 a[252:253], v255 offset:30752
    ds_read_b64_tr_b16 a[254:255], v255 offset:30880
    s_waitcnt vmcnt(2)
    ds_read_b64_tr_b16 a[192:193], v255 offset:16384
    ds_read_b64_tr_b16 a[194:195], v255 offset:16512
    ds_read_b64_tr_b16 a[196:197], v255 offset:18432
    ds_read_b64_tr_b16 a[198:199], v255 offset:18560
    ds_read_b64_tr_b16 a[200:201], v255 offset:20480
    ds_read_b64_tr_b16 a[202:203], v255 offset:20608
    ds_read_b64_tr_b16 a[204:205], v255 offset:22528
    ds_read_b64_tr_b16 a[206:207], v255 offset:22656
    ds_read_b64_tr_b16 a[224:225], v255 offset:16416
    ds_read_b64_tr_b16 a[226:227], v255 offset:16544
    ds_read_b64_tr_b16 a[228:229], v255 offset:18464
    ds_read_b64_tr_b16 a[230:231], v255 offset:18592
    ds_read_b64_tr_b16 a[232:233], v255 offset:20512
    ds_read_b64_tr_b16 a[234:235], v255 offset:20640
    ds_read_b64_tr_b16 a[236:237], v255 offset:22560
    ds_read_b64_tr_b16 a[238:239], v255 offset:22688
.pj_14:
    v_min_u32 v20, 0xfffffffe, v20
    v_min_u32 v21, 0xfffffffe, v21
    v_min_u32 v22, 0xfffffffe, v22
    v_min_u32 v23, 0xfffffffe, v23
    v_min_u32 v24, 0xfffffffe, v24
    v_min_u32 v25, 0xfffffffe, v25
    v_min_u32 v26, 0xfffffffe, v26
    v_min_u32 v27, 0xfffffffe, v27
    v_min_u32 v28, 0xfffffffe, v28
    v_min_u32 v29, 0xfffffffe, v29
    v_min_u32 v30, 0xfffffffe, v30
    v_min_u32 v31, 0xfffffffe, v31
    v_min_u32 v32, 0xfffffffe, v32
    v_min_u32 v33, 0xfffffffe, v33
    v_min_u32 v34, 0xfffffffe, v34
    v_min_u32 v35, 0xfffffffe, v35
    s_barrier
    s_cmp_ge_u32 s24, 2
    s_cbranch_scc1 .px_15
    v_xor_b32 v255, 0x10000, v255
    ds_read_b64_tr_b16 v[124:125], v255 offset:16384
    ds_read_b64_tr_b16 v[126:127], v255 offset:16512
    ds_read_b64_tr_b16 v[128:129], v255 offset:18432
    ds_read_b64_tr_b16 v[130:131], v255 offset:18560
    ds_read_b64_tr_b16 v[132:133], v255 offset:20480
    ds_read_b64_tr_b16 v[134:135], v255 offset:20608
    ds_read_b64_tr_b16 v[136:137], v255 offset:22528
    ds_read_b64_tr_b16 v[138:139], v255 offset:22656
    ds_read_b64_tr_b16 v[156:157], v255 offset:16416
    ds_read_b64_tr_b16 v[158:159], v255 offset:16544
    ds_read_b64_tr_b16 v[160:161], v255 offset:18464
    ds_read_b64_tr_b16 v[162:163], v255 offset:18592
    ds_read_b64_tr_b16 v[164:165], v255 offset:20512
    ds_read_b64_tr_b16 v[166:167], v255 offset:20640
    ds_read_b64_tr_b16 v[168:169], v255 offset:22560
    ds_read_b64_tr_b16 v[170:171], v255 offset:22688
    ds_read_b64_tr_b16 v[140:141], v255 offset:24576
    ds_read_b64_tr_b16 v[142:143], v255 offset:24704
    ds_read_b64_tr_b16 v[144:145], v255 offset:26624
    ds_read_b64_tr_b16 v[146:147], v255 offset:26752
    ds_read_b64_tr_b16 v[148:149], v255 offset:28672
    ds_read_b64_tr_b16 v[150:151], v255 offset:28800
    ds_read_b64_tr_b16 v[152:153], v255 offset:30720
    ds_read_b64_tr_b16 v[154:155], v255 offset:30848
    ds_read_b64_tr_b16 v[172:173], v255 offset:24608
    ds_read_b64_tr_b16 v[174:175], v255 offset:24736
    ds_read_b64_tr_b16 v[176:177], v255 offset:26656
    ds_read_b64_tr_b16 v[178:179], v255 offset:26784
    ds_read_b64_tr_b16 v[180:181], v255 offset:28704
    ds_read_b64_tr_b16 v[182:183], v255 offset:28832
    ds_read_b64_tr_b16 v[184:185], v255 offset:30752
    ds_read_b64_tr_b16 v[186:187], v255 offset:30880
.px_15:
    s_waitcnt vmcnt(0)
    s_mov_b32 s62, 0
.vp_18:
    v_readlane_b32 s4, v240, 0
    v_readlane_b32 s7, v240, 1
    v_readlane_b32 s6, v240, 2

    v_readlane_b32 s5, v240, 4
    s_add_u32 s4, s4, s5
    v_readlane_b32 s5, v240, 8
    s_add_u32 s4, s4, s5
    v_readlane_b32 s5, v240, 12
    s_add_u32 s4, s4, s5
    s_lshr_b32 s5, s7, 21
    s_min_u32 s4, s4, s5
    s_cmp_ge_u32 s4, 256
    s_cbranch_scc1 .vd_19
    s_cmp_lg_u32 s6, 0
    s_cbranch_scc1 .vs_20
    s_add_u32 s62, s62, 1
    s_cmp_gt_u32 s62, 0x100000
    s_cbranch_scc1 .mg_end_1
    s_sleep 8
    buffer_load_dword v240, v241, s[20:23], 0 offen sc1
    s_waitcnt vmcnt(0)
    s_branch .vp_18

.vs_20:
    s_lshr_b32 s25, s2, 5
    s_and_b32 s26, s2, 31
    s_mov_b32 s27, 1
    s_mov_b32 s99, 1
    s_mov_b32 s97, 144
    s_waitcnt vmcnt(0) lgkmcnt(0)
    s_barrier
    s_branch .mg_role_3

.vd_19:
    s_waitcnt lgkmcnt(0)
    s_barrier
    s_add_u32 s4, s79, 1
    s_and_b32 s4, s4, 3
    s_lshl_b32 s4, s4, 11
    v_add_u32 v243, s4, v246
    s_add_u32 s4, s79, 2
    s_and_b32 s4, s4, 3
    s_lshl_b32 s4, s4, 11
    v_add_u32 v252, s4, v246
    s_add_u32 s4, s79, 3
    s_and_b32 s4, s4, 3
    s_lshl_b32 s4, s4, 11
    v_add_u32 v254, s4, v246
    s_add_u32 s4, s79, 4
    s_and_b32 s4, s4, 3
    s_lshl_b32 s4, s4, 11
    v_add_u32 v246, s4, v246
    s_bfe_u32 s4, s7, 393216
    s_cmp_gt_u32 s4, 8
    s_cselect_b32 s4, 8192, 0
    s_add_u32 s4, s4, s35
    s_add_u32 s68, s4, 0

    s_bfe_u32 s4, s7, 393216
    s_cmp_gt_u32 s4, 8
    s_cselect_b32 s4, 8192, 0
    s_add_u32 s4, s4, s35
    s_add_u32 s69, s4, 1048576

    s_bfe_u32 s4, s7, 393222
    s_cmp_gt_u32 s4, 8
    s_cselect_b32 s4, 8192, 0
    s_add_u32 s4, s4, s35
    s_add_u32 s70, s4, 2097152

    s_bfe_u32 s4, s7, 393222
    s_cmp_gt_u32 s4, 8
    s_cselect_b32 s4, 8192, 0
    s_add_u32 s4, s4, s35
    s_add_u32 s71, s4, 3145728

    s_mov_b32 s62, 0x1000000
    s_cmp_ge_u32 s24, 2
    s_cbranch_scc1 .nd_21
    s_mov_b32 s62, 0
    s_mov_b64 exec, 3
.wf_23:
    buffer_load_dword v244, v253, s[8:11], s89 offen sc1
    s_waitcnt vmcnt(0)
    v_cmp_gt_u32 vcc, 1, v244
    s_cbranch_vccz .wfd_24
    s_sleep 2
    s_add_u32 s62, s62, 1
    s_cmp_gt_u32 s62, 0x400000
    s_cbranch_scc1 .mg_end_1
    s_branch .wf_23

.wfd_24:
    s_mov_b64 exec, -1
    v_readlane_b32 s4, v244, 0
    v_readlane_b32 s93, v244, 1
    s_min_u32 s93, s93, s4
    s_mov_b32 s62, 0x1000000
    s_mov_b32 m0, s90
    s_nop 0
    buffer_load_dwordx4 v14, s[8:11], s38 offen offset:0 lds
    buffer_load_dwordx4 v14, s[8:11], s38 offen offset:1024 lds
    buffer_load_dwordx4 v14, s[8:11], s38 offen offset:2048 lds
    buffer_load_dwordx4 v14, s[8:11], s38 offen offset:3072 lds
    s_mov_b32 m0, s91
    s_nop 0
    buffer_load_dwordx4 v14, s[8:11], s39 offen lds
    s_mov_b64 exec, 3
    buffer_load_dword v244, v253, s[8:11], s89 offen sc1
    s_mov_b64 exec, -1
    s_waitcnt vmcnt(0)
.kd_22:
    v_readlane_b32 s4, v244, 0
    v_readlane_b32 s93, v244, 1
    s_min_u32 s93, s93, s4
    v_mov_b32 v4, s93
    v_mov_b32 v5, 19968
    ds_write_b32 v5, v4
.nd_21:
    s_waitcnt vmcnt(0) lgkmcnt(0)
    s_add_u32 s38, s38, 262144
    s_add_u32 s39, s39, 262144
    s_and_b32 s4, s28, 3
    s_lshl_b32 s5, s4, 17
    s_add_u32 s29, s5, s34
    s_xor_b32 s6, s5, 262144
    s_add_u32 s31, s6, s34
    s_add_u32 s32, s29, 20480
    s_add_u32 s33, s29, 24576
    s_mov_b64 s[14:15], 0
    s_barrier
    s_cmp_lt_u32 s24, 2
    s_cbranch_scc1 .k0_27
    ds_read_b128 v[128:131], v228 offset:0
    ds_read_b128 v[144:147], v228 offset:4096
    ds_read_b128 v[132:135], v229 offset:0
    ds_read_b128 v[148:151], v229 offset:4096
    ds_read_b128 v[136:139], v230 offset:0
    ds_read_b128 v[152:155], v230 offset:4096
    ds_read_b128 v[140:143], v231 offset:0
    ds_read_b128 v[156:159], v231 offset:4096
    ds_read_b128 v[160:163], v14 offset:28672
    ds_read_b128 v[164:167], v14 offset:29696
.k0_27:
    s_cmp_lg_u32 s27, 0
    s_cbranch_scc1 .ent1_26
    s_branch .ent0_25
.p2align 6
.top_36:
    s_barrier
    buffer_load_dwordx4 v[20:23], v8, s[8:11], s29 offen offset:0 sc1
    v_mov_b32 v52, 0
    buffer_load_dwordx4 v[24:27], v8, s[8:11], s29 offen offset:1024 sc1
    v_mov_b32 v53, 0
    buffer_load_dwordx4 v[28:31], v8, s[8:11], s29 offen offset:2048 sc1
    v_mov_b32 v54, 0
    buffer_load_dwordx4 v[32:35], v8, s[8:11], s29 offen offset:3072 sc1
.ent0_25:
    s_waitcnt vmcnt(3)
    v_max3_u32 v4, v20, v21, v22
    v_max_u32 v4, v4, v23
    v_cmp_eq_u32 vcc, -1, v4
    s_cbranch_vccnz .A_41
.W_42:
    v_smfmac_f32_16x16x64_bf16 v[52:55], v[20:23], a[0:7], v9
    v_smfmac_f32_16x16x64_bf16 v[56:59], v[20:23], a[32:39], v9
    s_waitcnt vmcnt(2)
    v_max3_u32 v4, v24, v25, v26
    v_max_u32 v4, v4, v27
    v_smfmac_f32_16x16x64_bf16 v[60:63], v[20:23], a[64:71], v9
    v_cmp_eq_u32 vcc, -1, v4
    v_smfmac_f32_16x16x64_bf16 v[64:67], v[20:23], a[96:103], v9
    s_cbranch_vccnz .A_43
.W_44:
    v_smfmac_f32_16x16x64_bf16 v[52:55], v[24:27], a[8:15], v9
    v_smfmac_f32_16x16x64_bf16 v[56:59], v[24:27], a[40:47], v9
    s_waitcnt vmcnt(1)
    v_max3_u32 v4, v28, v29, v30
    v_max_u32 v4, v4, v31
    v_smfmac_f32_16x16x64_bf16 v[60:63], v[24:27], a[72:79], v9
    v_cmp_eq_u32 vcc, -1, v4
    v_smfmac_f32_16x16x64_bf16 v[64:67], v[24:27], a[104:111], v9
    s_cbranch_vccnz .A_45
.W_46:
    v_smfmac_f32_16x16x64_bf16 v[52:55], v[28:31], a[16:23], v9
    v_smfmac_f32_16x16x64_bf16 v[56:59], v[28:31], a[48:55], v9
    s_waitcnt vmcnt(0)
    v_max3_u32 v4, v32, v33, v34
    v_max_u32 v4, v4, v35
    v_smfmac_f32_16x16x64_bf16 v[60:63], v[28:31], a[80:87], v9
    v_cmp_eq_u32 vcc, -1, v4
    v_smfmac_f32_16x16x64_bf16 v[64:67], v[28:31], a[112:119], v9
    s_cbranch_vccnz .A_47
.W_48:
    v_smfmac_f32_16x16x64_bf16 v[52:55], v[32:35], a[24:31], v9
    v_smfmac_f32_16x16x64_bf16 v[56:59], v[32:35], a[56:63], v9
    v_smfmac_f32_16x16x64_bf16 v[60:63], v[32:35], a[88:95], v9
    v_smfmac_f32_16x16x64_bf16 v[64:67], v[32:35], a[120:127], v9
.mj_40:
    v_cvt_pk_bf16_f32 v104, v52, v53
    v_cvt_pk_bf16_f32 v105, v54, v55
    v_cvt_pk_bf16_f32 v106, v56, v57
    v_cvt_pk_bf16_f32 v107, v58, v59
    ds_write_b64 v16, v[104:105] offset:4096
    v_cvt_pk_bf16_f32 v108, v60, v61
    v_cvt_pk_bf16_f32 v109, v62, v63
    ds_write_b64 v16, v[106:107] offset:6144
    ds_write_b64 v16, v[108:109] offset:0
    v_cvt_pk_bf16_f32 v110, v64, v65
    v_cvt_pk_bf16_f32 v111, v66, v67
    ds_write_b64 v16, v[110:111] offset:2048
    v_smfmac_f32_16x16x64_bf16 v[68:71], v[20:23], a[128:135], v9
    v_smfmac_f32_16x16x64_bf16 v[72:75], v[20:23], a[160:167], v9
    s_waitcnt lgkmcnt(0)
    s_barrier
    ds_read_b128 v[36:39], v17 offset:0
    ds_read_b128 v[40:43], v17 offset:1024
    v_smfmac_f32_16x16x64_bf16 v[68:71], v[24:27], a[136:143], v9
    v_smfmac_f32_16x16x64_bf16 v[72:75], v[24:27], a[168:175], v9
    s_waitcnt lgkmcnt(1)
    v_mfma_f32_16x16x32_bf16 v[44:47], v[36:39], v[84:87], 0
    s_waitcnt lgkmcnt(0)
    v_mfma_f32_16x16x32_bf16 v[44:47], v[40:43], v[84:87], v[44:47]
    v_smfmac_f32_16x16x64_bf16 v[68:71], v[28:31], a[144:151], v9
    v_smfmac_f32_16x16x64_bf16 v[72:75], v[28:31], a[176:183], v9
    s_mov_b64 exec, s[64:65]
    v_cvt_pk_bf16_f32 v48, v44, v45
    v_cvt_pk_bf16_f32 v49, v46, v47
    v_min_u32 v48, 0xfffffffe, v48
    v_min_u32 v49, 0xfffffffe, v49
    buffer_store_dwordx2 v[48:49], v10, s[8:11], s29 offen

    ds_write_b64 v18, v[48:49]
    s_mov_b64 exec, -1

    v_smfmac_f32_16x16x64_bf16 v[68:71], v[32:35], a[152:159], v9
    v_smfmac_f32_16x16x64_bf16 v[72:75], v[32:35], a[184:191], v9
    s_nop 3
    v_cvt_pk_bf16_f32 v104, v68, v69
    v_cvt_pk_bf16_f32 v105, v70, v71
    ds_write_b64 v16, v[104:105] offset:8192
    s_nop 0
    v_cvt_pk_bf16_f32 v106, v72, v73
    v_cvt_pk_bf16_f32 v107, v74, v75
    ds_write_b64 v16, v[106:107] offset:10240
    s_cmp_lg_u32 s24, 2
    s_waitcnt lgkmcnt(0)
    s_barrier
    s_cbranch_scc1 .oth_37
    buffer_load_dwordx4 v[92:95], v232, s[8:11], s29 offen sc1
    buffer_load_dwordx4 v[96:99], v233, s[8:11], s29 offen sc1
    buffer_load_dwordx4 v[100:103], v234, s[8:11], s29 offen sc1
    ds_read_b128 v[88:91], v14 offset:16384
    s_cmp_eq_u32 s28, 63
    s_cbranch_scc1 .rec_fin_6
.en_32:
    s_waitcnt lgkmcnt(0)
    v_mfma_f32_16x16x32_bf16 v[208:211], v[128:131], v[88:91], 0
    v_mfma_f32_16x16x32_bf16 v[212:215], v[144:147], v[88:91], 0
    v_mfma_f32_16x16x32_bf16 v[216:219], v[88:91], v[88:91], v[116:119]
    s_waitcnt vmcnt(2)
    v_max3_u32 v4, v92, v93, v94
    v_max_u32 v4, v4, v95
    v_cmp_eq_u32 vcc, -1, v4
    s_cbranch_vccnz .A_50
.W_51:
    v_mfma_f32_16x16x32_bf16 v[208:211], v[132:135], v[92:95], v[208:211]
    s_waitcnt vmcnt(1)
    v_max3_u32 v4, v96, v97, v98
    v_max_u32 v4, v4, v99
    v_mfma_f32_16x16x32_bf16 v[212:215], v[148:151], v[92:95], v[212:215]
    v_cmp_eq_u32 vcc, -1, v4
    v_mfma_f32_16x16x32_bf16 v[216:219], v[92:95], v[92:95], v[216:219]
    s_cbranch_vccnz .A_52
.W_53:
    v_mfma_f32_16x16x32_bf16 v[208:211], v[136:139], v[96:99], v[208:211]
    s_waitcnt vmcnt(0)
    v_max3_u32 v4, v100, v101, v102
    v_max_u32 v4, v4, v103
    v_mfma_f32_16x16x32_bf16 v[212:215], v[152:155], v[96:99], v[212:215]
    v_cmp_eq_u32 vcc, -1, v4
    v_mfma_f32_16x16x32_bf16 v[216:219], v[96:99], v[96:99], v[216:219]
    s_cbranch_vccnz .A_54
.W_55:
    v_mfma_f32_16x16x32_bf16 v[208:211], v[140:143], v[100:103], v[208:211]
    v_mfma_f32_16x16x32_bf16 v[212:215], v[156:159], v[100:103], v[212:215]
    v_mfma_f32_16x16x32_bf16 v[216:219], v[100:103], v[100:103], v[216:219]
.mj_49:
    s_barrier
    ds_read_b64 v[168:169], v14 offset:18432
    ds_read_b64 v[172:173], v14 offset:18440
    s_nop 0

    v_mov_b32_dpp v208, v212 row_ror:8 row_mask:0xf bank_mask:0xc
    v_mov_b32_dpp v209, v213 row_ror:8 row_mask:0xf bank_mask:0xc
    v_mov_b32_dpp v210, v214 row_ror:8 row_mask:0xf bank_mask:0xc
    v_mov_b32_dpp v211, v215 row_ror:8 row_mask:0xf bank_mask:0xc
    v_mov_b32_dpp v216, v218 row_ror:8 row_mask:0xf bank_mask:0xc
    v_mov_b32_dpp v217, v219 row_ror:8 row_mask:0xf bank_mask:0xc
    v_max3_f32 v4, v208, v209, v210
    v_max3_f32 v5, v211, v216, v217
    v_max_f32 v6, v4, v5
    v_max_f32 v4, v4, v5
    s_nop 1
    v_permlane32_swap_b32 v4, v6
    v_max_f32 v5, v4, v6
    v_max_f32 v4, v4, v6
    s_nop 1
    v_permlane16_swap_b32 v4, v5
    v_max_f32 v4, v4, v5
    s_nop 1
    v_max_f32_dpp v4, v4, v4 row_ror:8 row_mask:0xf bank_mask:0xf
    v_mul_f32 v4, s37, v4

    v_fma_f32 v104, v208, s37, -v4
    v_fma_f32 v105, v209, s37, -v4
    v_fma_f32 v106, v210, s37, -v4
    v_fma_f32 v107, v211, s37, -v4
    v_fma_f32 v108, v216, s37, -v4
    v_fma_f32 v109, v217, s37, -v4
    v_exp_f32 v104, v104
    v_exp_f32 v105, v105
    v_exp_f32 v106, v106
    v_exp_f32 v107, v107
    v_exp_f32 v108, v108
    v_exp_f32 v109, v109
    v_cvt_pk_bf16_f32 v176, v104, v105
    v_cvt_pk_bf16_f32 v177, v106, v107
    v_cvt_pk_bf16_f32 v180, v108, v109
    v_mov_b32_dpp v178, v176 row_ror:8 row_mask:0xf bank_mask:0xf
    v_mov_b32_dpp v179, v177 row_ror:8 row_mask:0xf bank_mask:0xf
    v_mov_b32_dpp v181, v180 row_ror:8 row_mask:0xf bank_mask:0xf
    s_waitcnt lgkmcnt(0)

    v_mfma_f32_16x16x32_bf16 v[208:211], v[120:123], v[176:179], 0
    v_mfma_f32_16x16x32_bf16 v[208:211], v[120:123], v[180:183], v[208:211]
    v_mfma_f32_16x16x32_bf16 v[212:215], v[160:163], v[176:179], 0
    v_mfma_f32_16x16x32_bf16 v[216:219], v[164:167], v[176:179], 0
    v_mfma_f32_16x16x32_bf16 v[212:215], v[168:171], v[180:183], v[212:215]
    v_rcp_f32 v4, v208
    v_mfma_f32_16x16x32_bf16 v[216:219], v[172:175], v[180:183], v[216:219]
    s_mov_b64 exec, s[58:59]
    s_nop 2
    v_mul_f32 v212, v4, v212
    v_mul_f32 v213, v4, v213
    v_mul_f32 v214, v4, v214
    v_mul_f32 v215, v4, v215
    v_cvt_pk_bf16_f32 v184, v212, v213
    v_cvt_pk_bf16_f32 v185, v214, v215
    v_mul_f32 v216, v4, v216
    v_mul_f32 v217, v4, v217
    v_min_u32 v184, 0xfffffffe, v184
    v_min_u32 v185, 0xfffffffe, v185
    v_mul_f32 v218, v4, v218
    v_mul_f32 v219, v4, v219
    v_cvt_pk_bf16_f32 v186, v216, v217
    v_cvt_pk_bf16_f32 v187, v218, v219
    v_min_u32 v186, 0xfffffffe, v186
    v_min_u32 v187, 0xfffffffe, v187
    buffer_store_dwordx4 v[184:187], v13, s[8:11], s29 offen
    s_mov_b64 exec, -1

.gp_39:
    s_barrier
    v_mov_b32 v5, 19968
    ds_read_b32 v4, v5
    s_mov_b32 s99, s68
    s_waitcnt vmcnt(0)
    s_cmp_eq_u32 s24, 3
    s_cbranch_scc1 .u3_56
    s_add_u32 s6, s28, 3
    s_add_u32 s7, s30, 262144
    s_waitcnt lgkmcnt(0)
    v_readfirstlane_b32 s5, v4
    s_cmp_lt_u32 s5, s6
    s_barrier
    s_cbranch_scc1 .np_58
    buffer_load_dword v226, v225, s[8:11], s7 offen

.np_58:
    s_add_u32 s4, s70, 0
    buffer_store_dwordx4 v[188:191], v238, s[8:11], s4 offen sc1
    s_add_u32 s4, s70, 262144
    buffer_store_dwordx4 v[188:191], v238, s[8:11], s4 offen sc1
    s_branch .u4_57
.u3_56:
    s_sub_u32 s4, s36, 0
    s_barrier
    s_mov_b64 exec, s[66:67]
    buffer_store_dwordx4 v[88:91], v11, s[8:11], s4 offen sc1
    s_mov_b64 exec, s[56:57]
    buffer_store_dwordx4 v[172:175], v12, s[8:11], s4 offen sc1
    s_mov_b64 exec, -1

.u4_57:
    s_barrier
    s_add_u32 s28, s28, 1
    s_add_u32 s36, s36, 196608
    s_cmp_lt_u32 s28, 63
    s_cselect_b32 s4, 262144, 0
    s_add_u32 s38, s38, s4
    s_add_u32 s39, s39, s4
    s_add_u32 s30, s30, s4
    s_mov_b32 s4, s68
    s_mov_b32 s68, s69
    s_mov_b32 s69, s70
    s_mov_b32 s70, s71
    s_mov_b32 s71, s4
    s_and_b32 s4, s28, 3
    s_lshl_b32 s5, s4, 17
    s_add_u32 s29, s5, s34
    s_xor_b32 s6, s5, 262144
    s_add_u32 s31, s6, s34
    s_add_u32 s32, s29, 20480
    s_add_u32 s33, s29, 24576
    v_mov_b32 v55, 0
    v_mov_b32 v56, 0
    v_mov_b32 v57, 0
    v_mov_b32 v58, 0
    v_mov_b32 v59, 0
    v_mov_b32 v60, 0
    v_mov_b32 v61, 0
    v_mov_b32 v62, 0
    v_mov_b32 v63, 0
    v_mov_b32 v64, 0
    v_mov_b32 v65, 0
    v_mov_b32 v66, 0
    v_mov_b32 v67, 0
    v_mov_b32 v68, 0
    v_mov_b32 v69, 0
    v_mov_b32 v70, 0
    v_mov_b32 v71, 0
    v_mov_b32 v72, 0
    v_mov_b32 v73, 0
    v_mov_b32 v74, 0
    v_mov_b32 v75, 0
    v_mov_b32 v20, -1
    v_mov_b32 v21, -1
    v_mov_b32 v22, -1
    v_mov_b32 v23, -1
    v_mov_b32 v24, -1
    v_mov_b32 v25, -1
    v_mov_b32 v26, -1
    v_mov_b32 v27, -1
    v_mov_b32 v28, -1
    v_mov_b32 v29, -1
    v_mov_b32 v30, -1
    v_mov_b32 v31, -1
    v_mov_b32 v32, -1
    v_mov_b32 v33, -1
    v_mov_b32 v34, -1
    v_mov_b32 v35, -1
    v_mov_b32 v92, -1
    v_mov_b32 v93, -1
    v_mov_b32 v94, -1
    v_mov_b32 v95, -1
    v_mov_b32 v96, -1
    v_mov_b32 v97, -1
    v_mov_b32 v98, -1
    v_mov_b32 v99, -1
    v_mov_b32 v100, -1
    v_mov_b32 v101, -1
    v_mov_b32 v102, -1
    v_mov_b32 v103, -1
    s_add_u32 s4, s99, 0
    buffer_load_dwordx4 v[192:195], v239, s[8:11], s4 offen sc1
    buffer_load_dwordx4 v[196:199], v249, s[8:11], s4 offen sc1

    ds_read_b128 v[128:131], v228 offset:0
    ds_read_b128 v[144:147], v228 offset:4096
    ds_read_b128 v[132:135], v229 offset:0
    ds_read_b128 v[148:151], v229 offset:4096
    ds_read_b128 v[136:139], v230 offset:0
    ds_read_b128 v[152:155], v230 offset:4096
    ds_read_b128 v[140:143], v231 offset:0
    ds_read_b128 v[156:159], v231 offset:4096
    ds_read_b128 v[160:163], v14 offset:28672
    ds_read_b128 v[164:167], v14 offset:29696
    ds_read_b128 v[108:111], v248
    s_waitcnt lgkmcnt(0)
    v_mfma_f32_16x16x32_bf16 v[76:79], v[108:111], v[112:115], 0
    s_add_u32 s4, s99, 262144
    buffer_load_dwordx4 v[200:203], v239, s[8:11], s4 offen sc1
    buffer_load_dwordx4 v[204:207], v249, s[8:11], s4 offen sc1

.gc_59:
    s_waitcnt vmcnt(2)

    v_max_u32 v4, v192, v196
    v_cmp_eq_u32 vcc, -1, v4
    s_cbranch_vccnz .gf_60
    v_mfma_f32_16x16x32_bf16 v[76:79], v[192:195], v[84:87], v[76:79]
    v_mfma_f32_16x16x32_bf16 v[76:79], v[196:199], v[112:115], v[76:79]
    s_mov_b64 exec, s[58:59]
    s_nop 6
    v_cvt_pk_bf16_f32 v104, v76, v77
    v_cvt_pk_bf16_f32 v105, v78, v79
    v_min_u32 v104, 0xfffffffe, v104
    v_min_u32 v105, 0xfffffffe, v105
    buffer_store_dwordx2 v[104:105], v15, s[8:11], s29 offen
    s_mov_b64 exec, -1

    s_branch .top_36
.gf_60:
    s_add_u32 s4, s99, 0
    buffer_load_dwordx4 v[192:195], v239, s[8:11], s4 offen sc1
    buffer_load_dwordx4 v[196:199], v249, s[8:11], s4 offen sc1

    s_waitcnt vmcnt(2)

    v_max_u32 v4, v200, v204
    v_cmp_eq_u32 vcc, -1, v4
    s_cbranch_vccnz .gf_61
    v_mfma_f32_16x16x32_bf16 v[76:79], v[200:203], v[84:87], v[76:79]
    v_mfma_f32_16x16x32_bf16 v[76:79], v[204:207], v[112:115], v[76:79]
    s_mov_b64 exec, s[58:59]
    s_nop 6
    v_cvt_pk_bf16_f32 v104, v76, v77
    v_cvt_pk_bf16_f32 v105, v78, v79
    v_min_u32 v104, 0xfffffffe, v104
    v_min_u32 v105, 0xfffffffe, v105
    buffer_store_dwordx2 v[104:105], v15, s[8:11], s29 offen
    s_mov_b64 exec, -1

    s_branch .top_36
.gf_61:
    s_add_u32 s4, s99, 262144
    buffer_load_dwordx4 v[200:203], v239, s[8:11], s4 offen sc1
    buffer_load_dwordx4 v[204:207], v249, s[8:11], s4 offen sc1

    s_sub_u32 s62, s62, 1
    s_cbranch_scc1 .mg_end_1
    s_branch .gc_59
.oth_37:
    s_cmp_eq_u32 s24, 3
    s_cbranch_scc1 .w3_38
    s_cmp_eq_u32 s28, 63
    s_cbranch_scc1 .rec_fin_6
    s_min_u32 s4, s14, s15
    s_max_u32 s93, s93, s4
    v_mov_b32 v4, s93
    v_mov_b32 v5, 19968
    ds_write_b32 v5, v4
    s_waitcnt vmcnt(0)
    v_mov_b32 v71, 0
    v_mov_b32 v72, 0
    v_mov_b32 v73, 0
    v_mov_b32 v74, 0
    v_mov_b32 v75, 0
    s_barrier
.en_28:
    s_add_u32 s6, s28, 2
    s_min_u32 s6, s6, 64
    s_cmp_lt_u32 s93, s6
    s_cbranch_scc1 .kf_62
.kb_63:
    s_mov_b32 m0, s90
    s_nop 0
    buffer_load_dwordx4 v14, s[8:11], s38 offen offset:0 lds
    buffer_load_dwordx4 v14, s[8:11], s38 offen offset:1024 lds
    buffer_load_dwordx4 v14, s[8:11], s38 offen offset:2048 lds
    buffer_load_dwordx4 v14, s[8:11], s38 offen offset:3072 lds
    s_mov_b32 m0, s91
    s_nop 0
    buffer_load_dwordx4 v14, s[8:11], s39 offen lds
    s_waitcnt lgkmcnt(0)
    s_barrier
    v_mov_b32 v20, -1
    v_mov_b32 v21, -1
    v_mov_b32 v22, -1
    v_mov_b32 v23, -1
    v_mov_b32 v24, -1
    v_mov_b32 v25, -1
    v_mov_b32 v26, -1
    v_mov_b32 v27, -1
    v_mov_b32 v28, -1
    v_mov_b32 v29, -1
    v_mov_b32 v30, -1
    v_mov_b32 v31, -1
    v_mov_b32 v32, -1
    v_mov_b32 v33, -1
    v_mov_b32 v34, -1
    v_mov_b32 v35, -1
    v_mov_b32 v55, 0
    v_mov_b32 v56, 0
    v_mov_b32 v57, 0
    v_mov_b32 v58, 0
    v_mov_b32 v59, 0
    v_mov_b32 v60, 0
    v_mov_b32 v61, 0
    v_mov_b32 v62, 0
    v_mov_b32 v63, 0
    v_mov_b32 v64, 0
    v_mov_b32 v65, 0
    v_mov_b32 v66, 0
    v_mov_b32 v67, 0
    v_mov_b32 v68, 0
    v_mov_b32 v69, 0
    v_mov_b32 v70, 0
    buffer_load_dwordx4 v[192:195], v243, s[8:11], s32 offen offset:0 sc1
    buffer_load_dwordx4 v[196:199], v243, s[8:11], s32 offen offset:1024 sc1
    v_mov_b32 v76, 0
    buffer_load_dwordx4 v[200:203], v252, s[8:11], s32 offen offset:0 sc1
    buffer_load_dwordx4 v[204:207], v252, s[8:11], s32 offen offset:1024 sc1
    v_mov_b32 v77, 0
    buffer_load_dwordx4 v[208:211], v254, s[8:11], s32 offen offset:0 sc1
    buffer_load_dwordx4 v[212:215], v254, s[8:11], s32 offen offset:1024 sc1
    v_mov_b32 v78, 0
    buffer_load_dwordx4 v[216:219], v246, s[8:11], s32 offen offset:0 sc1
    buffer_load_dwordx4 v[220:223], v246, s[8:11], s32 offen offset:1024 sc1
    s_waitcnt vmcnt(6)
    v_max3_u32 v4, v192, v193, v194
    v_max3_u32 v5, v195, v196, v197
    v_max3_u32 v4, v4, v198, v199
    v_max_u32 v4, v4, v5
    v_cmp_eq_u32 vcc, -1, v4
    s_cbranch_vccnz .A_65
.W_66:
    v_smfmac_f32_16x16x64_bf16 v[76:79], v[192:195], a[192:199], v9
    v_smfmac_f32_16x16x64_bf16 v[80:83], v[192:195], a[224:231], v9
    s_waitcnt vmcnt(4)
    v_max3_u32 v4, v200, v201, v202
    v_max3_u32 v5, v203, v204, v205
    v_max3_u32 v4, v4, v206, v207
    v_smfmac_f32_16x16x64_bf16 v[76:79], v[196:199], a[200:207], v9
    v_max_u32 v4, v4, v5
    v_cmp_eq_u32 vcc, -1, v4
    v_smfmac_f32_16x16x64_bf16 v[80:83], v[196:199], a[232:239], v9
    s_cbranch_vccnz .A_67
.W_68:
    v_smfmac_f32_16x16x64_bf16 v[76:79], v[200:203], a[208:215], v9
    v_smfmac_f32_16x16x64_bf16 v[80:83], v[200:203], a[240:247], v9
    s_waitcnt vmcnt(2)
    v_max3_u32 v4, v208, v209, v210
    v_max3_u32 v5, v211, v212, v213
    v_max3_u32 v4, v4, v214, v215
    v_smfmac_f32_16x16x64_bf16 v[76:79], v[204:207], a[216:223], v9
    v_max_u32 v4, v4, v5
    v_cmp_eq_u32 vcc, -1, v4
    v_smfmac_f32_16x16x64_bf16 v[80:83], v[204:207], a[248:255], v9
    s_cbranch_vccnz .A_69
.W_70:
    v_smfmac_f32_16x16x64_bf16 v[76:79], v[208:211], v[124:131], v9
    v_smfmac_f32_16x16x64_bf16 v[80:83], v[208:211], v[156:163], v9
    s_waitcnt vmcnt(0)
    v_max3_u32 v4, v216, v217, v218
    v_max3_u32 v5, v219, v220, v221
    v_max3_u32 v4, v4, v222, v223
    v_smfmac_f32_16x16x64_bf16 v[76:79], v[212:215], v[132:139], v9
    v_max_u32 v4, v4, v5
    v_cmp_eq_u32 vcc, -1, v4
    v_smfmac_f32_16x16x64_bf16 v[80:83], v[212:215], v[164:171], v9
    s_cbranch_vccnz .A_71
.W_72:
    v_smfmac_f32_16x16x64_bf16 v[76:79], v[216:219], v[140:147], v9
    v_smfmac_f32_16x16x64_bf16 v[80:83], v[216:219], v[172:179], v9
    v_smfmac_f32_16x16x64_bf16 v[76:79], v[220:223], v[148:155], v9
    v_smfmac_f32_16x16x64_bf16 v[80:83], v[220:223], v[180:187], v9
.mj_64:
    s_barrier
    s_nop 7
    v_permlane32_swap_b32 v76, v80
    v_permlane32_swap_b32 v77, v81
    v_permlane32_swap_b32 v78, v82
    v_permlane32_swap_b32 v79, v83
    v_add_f32 v76, v76, v80
    v_add_f32 v77, v77, v81
    v_add_f32 v78, v78, v82
    v_add_f32 v79, v79, v83
    v_cvt_pk_bf16_f32 v104, v76, v77
    v_cvt_pk_bf16_f32 v106, v76, v77
    v_cvt_pk_bf16_f32 v105, v78, v79
    v_cvt_pk_bf16_f32 v107, v78, v79
    v_permlane16_swap_b32 v104, v106
    s_nop 0
    v_permlane16_swap_b32 v105, v107
    v_min_u32 v104, 0xfffffffe, v104
    buffer_store_dwordx4 v[104:107], v237, s[8:11], s68 offen sc1

    ds_write_b128 v247, v[104:107]
    s_waitcnt lgkmcnt(0)
    s_barrier
    v_mov_b32 v79, 0
    v_mov_b32 v80, 0
    v_mov_b32 v81, 0
    v_mov_b32 v82, 0
    v_mov_b32 v83, 0
    s_waitcnt vmcnt(1)
    v_mov_b32 v192, -1
    v_mov_b32 v193, -1
    v_mov_b32 v194, -1
    v_mov_b32 v195, -1
    v_mov_b32 v196, -1
    v_mov_b32 v197, -1
    v_mov_b32 v198, -1
    v_mov_b32 v199, -1
    v_mov_b32 v200, -1
    v_mov_b32 v201, -1
    v_mov_b32 v202, -1
    v_mov_b32 v203, -1
    v_mov_b32 v204, -1
    v_mov_b32 v205, -1
    v_mov_b32 v206, -1
    v_mov_b32 v207, -1
    v_mov_b32 v208, -1
    v_mov_b32 v209, -1
    v_mov_b32 v210, -1
    v_mov_b32 v211, -1
    v_mov_b32 v212, -1
    v_mov_b32 v213, -1
    v_mov_b32 v214, -1
    v_mov_b32 v215, -1
    v_mov_b32 v216, -1
    v_mov_b32 v217, -1
    v_mov_b32 v218, -1
    v_mov_b32 v219, -1
    v_mov_b32 v220, -1
    v_mov_b32 v221, -1
    v_mov_b32 v222, -1
    v_mov_b32 v223, -1
    s_add_u32 s6, s28, 4
    s_cmp_ge_u32 s93, s6
    s_cbranch_scc1 .nl_73
    s_buffer_load_dword s14, s[8:11], s89 glc
    s_buffer_load_dword s15, s[8:11], s89 offset:8192 glc

.nl_73:
    s_add_u32 s28, s28, 1
    s_add_u32 s36, s36, 196608
    s_cmp_lt_u32 s28, 63
    s_cselect_b32 s4, 262144, 0
    s_add_u32 s38, s38, s4
    s_add_u32 s39, s39, s4
    s_add_u32 s30, s30, s4
    s_mov_b32 s4, s68
    s_mov_b32 s68, s69
    s_mov_b32 s69, s70
    s_mov_b32 s70, s71
    s_mov_b32 s71, s4
    s_and_b32 s4, s28, 3
    s_lshl_b32 s5, s4, 17
    s_add_u32 s29, s5, s34
    s_xor_b32 s6, s5, 262144
    s_add_u32 s31, s6, s34
    s_add_u32 s32, s29, 20480
    s_add_u32 s33, s29, 24576
    s_branch .top_36
.w3_38:
    ds_read_b128 v[36:39], v14 offset:8192
    ds_read_b128 v[40:43], v14 offset:9216
    ds_read_b128 v[44:47], v14 offset:10240
    ds_read_b128 v[48:51], v14 offset:11264
    ds_read_b128 v[88:91], v14 offset:16384
    s_waitcnt lgkmcnt(0)
    v_mfma_f32_16x16x32_bf16 v[104:107], v[84:87], v[36:39], 0
    v_mfma_f32_16x16x32_bf16 v[108:111], v[84:87], v[44:47], 0
    v_mfma_f32_16x16x32_bf16 v[104:107], v[84:87], v[40:43], v[104:107]
    v_mfma_f32_16x16x32_bf16 v[108:111], v[84:87], v[48:51], v[108:111]
    s_nop 7
    v_cvt_pk_bf16_f32 v168, v104, v105
    v_cvt_pk_bf16_f32 v169, v106, v107
    v_cvt_pk_bf16_f32 v170, v108, v109
    v_cvt_pk_bf16_f32 v171, v110, v111
    ds_write_b128 v14, v[168:171] offset:18432
    v_cndmask_b32 v172, v170, v168, s[60:61]
    v_cndmask_b32 v173, v171, v169, s[60:61]
    v_min_u32 v172, 0xfffffffe, v172
    v_min_u32 v173, 0xfffffffe, v173
    v_mov_b32 v174, v172
    v_mov_b32 v175, v173
    s_cmp_ge_u32 s28, 62
    s_nop 0
    v_permlane16_swap_b32 v172, v174
    v_permlane16_swap_b32 v173, v175
    ds_write_b128 v14, v[172:175] offset:17408

    s_cbranch_scc1 .sk_74
.sb_75:
.en_34:
    s_waitcnt lgkmcnt(0)
    s_barrier
    buffer_store_dwordx4 v[188:191], v235, s[8:11], s31 offen
    buffer_store_dwordx4 v[188:191], v236, s[8:11], s31 offen

    s_branch .gp_39
.A_76:
    s_mov_b64 exec, vcc
    buffer_load_dwordx4 v[32:35], v8, s[8:11], s29 offen offset:3072 sc1
    s_mov_b64 exec, -1
    s_sub_u32 s62, s62, 1
    s_cbranch_scc1 .mg_end_1
    s_waitcnt vmcnt(3)
    v_max3_u32 v4, v20, v21, v22
    v_max_u32 v4, v4, v23
    v_cmp_eq_u32 vcc, -1, v4
    s_cbranch_vccz .W_42
.A_41:
    s_mov_b64 exec, vcc
    buffer_load_dwordx4 v[20:23], v8, s[8:11], s29 offen offset:0 sc1
    s_mov_b64 exec, -1
    s_waitcnt vmcnt(3)
    v_max3_u32 v4, v24, v25, v26
    v_max_u32 v4, v4, v27
    v_cmp_eq_u32 vcc, -1, v4
    s_cbranch_vccz .W_77
.A_78:
    s_mov_b64 exec, vcc
    buffer_load_dwordx4 v[24:27], v8, s[8:11], s29 offen offset:1024 sc1
    s_mov_b64 exec, -1
    s_waitcnt vmcnt(3)
    v_max3_u32 v4, v28, v29, v30
    v_max_u32 v4, v4, v31
    v_cmp_eq_u32 vcc, -1, v4
    s_cbranch_vccz .W_79
.A_80:
    s_mov_b64 exec, vcc
    buffer_load_dwordx4 v[28:31], v8, s[8:11], s29 offen offset:2048 sc1
    s_mov_b64 exec, -1
    s_waitcnt vmcnt(3)
    v_max3_u32 v4, v32, v33, v34
    v_max_u32 v4, v4, v35
    v_cmp_eq_u32 vcc, -1, v4
    s_cbranch_vccnz .A_76
.W_81:
    v_smfmac_f32_16x16x64_bf16 v[52:55], v[32:35], a[24:31], v9
    v_smfmac_f32_16x16x64_bf16 v[56:59], v[32:35], a[56:63], v9
    s_waitcnt vmcnt(2)
    v_max3_u32 v4, v20, v21, v22
    v_max_u32 v4, v4, v23
    v_smfmac_f32_16x16x64_bf16 v[60:63], v[32:35], a[88:95], v9
    v_cmp_eq_u32 vcc, -1, v4
    v_smfmac_f32_16x16x64_bf16 v[64:67], v[32:35], a[120:127], v9
    s_cbranch_vccnz .A_82
.W_83:
    v_smfmac_f32_16x16x64_bf16 v[52:55], v[20:23], a[0:7], v9
    v_smfmac_f32_16x16x64_bf16 v[56:59], v[20:23], a[32:39], v9
    s_waitcnt vmcnt(1)
    v_max3_u32 v4, v24, v25, v26
    v_max_u32 v4, v4, v27
    v_smfmac_f32_16x16x64_bf16 v[60:63], v[20:23], a[64:71], v9
    v_cmp_eq_u32 vcc, -1, v4
    v_smfmac_f32_16x16x64_bf16 v[64:67], v[20:23], a[96:103], v9
    s_cbranch_vccnz .A_84
.W_85:
    v_smfmac_f32_16x16x64_bf16 v[52:55], v[24:27], a[8:15], v9
    v_smfmac_f32_16x16x64_bf16 v[56:59], v[24:27], a[40:47], v9
    s_waitcnt vmcnt(0)
    v_max3_u32 v4, v28, v29, v30
    v_max_u32 v4, v4, v31
    v_smfmac_f32_16x16x64_bf16 v[60:63], v[24:27], a[72:79], v9
    v_cmp_eq_u32 vcc, -1, v4
    v_smfmac_f32_16x16x64_bf16 v[64:67], v[24:27], a[104:111], v9
    s_cbranch_vccnz .A_86
.W_87:
    v_smfmac_f32_16x16x64_bf16 v[52:55], v[28:31], a[16:23], v9
    v_smfmac_f32_16x16x64_bf16 v[56:59], v[28:31], a[48:55], v9
    v_smfmac_f32_16x16x64_bf16 v[60:63], v[28:31], a[80:87], v9
    v_smfmac_f32_16x16x64_bf16 v[64:67], v[28:31], a[112:119], v9
    s_branch .mj_40
.W_77:
    v_smfmac_f32_16x16x64_bf16 v[52:55], v[24:27], a[8:15], v9
    v_smfmac_f32_16x16x64_bf16 v[56:59], v[24:27], a[40:47], v9
    s_waitcnt vmcnt(2)
    v_max3_u32 v4, v28, v29, v30
    v_max_u32 v4, v4, v31
    v_smfmac_f32_16x16x64_bf16 v[60:63], v[24:27], a[72:79], v9
    v_cmp_eq_u32 vcc, -1, v4
    v_smfmac_f32_16x16x64_bf16 v[64:67], v[24:27], a[104:111], v9
    s_cbranch_vccnz .A_88
.W_89:
    v_smfmac_f32_16x16x64_bf16 v[52:55], v[28:31], a[16:23], v9
    v_smfmac_f32_16x16x64_bf16 v[56:59], v[28:31], a[48:55], v9
    s_waitcnt vmcnt(1)
    v_max3_u32 v4, v32, v33, v34
    v_max_u32 v4, v4, v35
    v_smfmac_f32_16x16x64_bf16 v[60:63], v[28:31], a[80:87], v9
    v_cmp_eq_u32 vcc, -1, v4
    v_smfmac_f32_16x16x64_bf16 v[64:67], v[28:31], a[112:119], v9
    s_cbranch_vccnz .A_90
.W_91:
    v_smfmac_f32_16x16x64_bf16 v[52:55], v[32:35], a[24:31], v9
    v_smfmac_f32_16x16x64_bf16 v[56:59], v[32:35], a[56:63], v9
    s_waitcnt vmcnt(0)
    v_max3_u32 v4, v20, v21, v22
    v_max_u32 v4, v4, v23
    v_smfmac_f32_16x16x64_bf16 v[60:63], v[32:35], a[88:95], v9
    v_cmp_eq_u32 vcc, -1, v4
    v_smfmac_f32_16x16x64_bf16 v[64:67], v[32:35], a[120:127], v9
    s_cbranch_vccnz .A_92
.W_93:
    v_smfmac_f32_16x16x64_bf16 v[52:55], v[20:23], a[0:7], v9
    v_smfmac_f32_16x16x64_bf16 v[56:59], v[20:23], a[32:39], v9
    v_smfmac_f32_16x16x64_bf16 v[60:63], v[20:23], a[64:71], v9
    v_smfmac_f32_16x16x64_bf16 v[64:67], v[20:23], a[96:103], v9
    s_branch .mj_40
.W_79:
    v_smfmac_f32_16x16x64_bf16 v[52:55], v[28:31], a[16:23], v9
    v_smfmac_f32_16x16x64_bf16 v[56:59], v[28:31], a[48:55], v9
    s_waitcnt vmcnt(2)
    v_max3_u32 v4, v32, v33, v34
    v_max_u32 v4, v4, v35
    v_smfmac_f32_16x16x64_bf16 v[60:63], v[28:31], a[80:87], v9
    v_cmp_eq_u32 vcc, -1, v4
    v_smfmac_f32_16x16x64_bf16 v[64:67], v[28:31], a[112:119], v9
    s_cbranch_vccnz .A_94
.W_95:
    v_smfmac_f32_16x16x64_bf16 v[52:55], v[32:35], a[24:31], v9
    v_smfmac_f32_16x16x64_bf16 v[56:59], v[32:35], a[56:63], v9
    s_waitcnt vmcnt(1)
    v_max3_u32 v4, v20, v21, v22
    v_max_u32 v4, v4, v23
    v_smfmac_f32_16x16x64_bf16 v[60:63], v[32:35], a[88:95], v9
    v_cmp_eq_u32 vcc, -1, v4
    v_smfmac_f32_16x16x64_bf16 v[64:67], v[32:35], a[120:127], v9
    s_cbranch_vccnz .A_96
.W_97:
    v_smfmac_f32_16x16x64_bf16 v[52:55], v[20:23], a[0:7], v9
    v_smfmac_f32_16x16x64_bf16 v[56:59], v[20:23], a[32:39], v9
    s_waitcnt vmcnt(0)
    v_max3_u32 v4, v24, v25, v26
    v_max_u32 v4, v4, v27
    v_smfmac_f32_16x16x64_bf16 v[60:63], v[20:23], a[64:71], v9
    v_cmp_eq_u32 vcc, -1, v4
    v_smfmac_f32_16x16x64_bf16 v[64:67], v[20:23], a[96:103], v9
    s_cbranch_vccnz .A_98
.W_99:
    v_smfmac_f32_16x16x64_bf16 v[52:55], v[24:27], a[8:15], v9
    v_smfmac_f32_16x16x64_bf16 v[56:59], v[24:27], a[40:47], v9
    v_smfmac_f32_16x16x64_bf16 v[60:63], v[24:27], a[72:79], v9
    v_smfmac_f32_16x16x64_bf16 v[64:67], v[24:27], a[104:111], v9
    s_branch .mj_40
.A_100:
    s_mov_b64 exec, vcc
    buffer_load_dwordx4 v[28:31], v8, s[8:11], s29 offen offset:2048 sc1
    s_mov_b64 exec, -1
    s_sub_u32 s62, s62, 1
    s_cbranch_scc1 .mg_end_1
    s_waitcnt vmcnt(2)
    v_max3_u32 v4, v20, v21, v22
    v_max_u32 v4, v4, v23
    v_cmp_eq_u32 vcc, -1, v4
    s_cbranch_vccz .W_83
.A_82:
    s_mov_b64 exec, vcc
    buffer_load_dwordx4 v[20:23], v8, s[8:11], s29 offen offset:0 sc1
    s_mov_b64 exec, -1
    s_waitcnt vmcnt(2)
    v_max3_u32 v4, v24, v25, v26
    v_max_u32 v4, v4, v27
    v_cmp_eq_u32 vcc, -1, v4
    s_cbranch_vccz .W_101
.A_102:
    s_mov_b64 exec, vcc
    buffer_load_dwordx4 v[24:27], v8, s[8:11], s29 offen offset:1024 sc1
    s_mov_b64 exec, -1
    s_waitcnt vmcnt(2)
    v_max3_u32 v4, v28, v29, v30
    v_max_u32 v4, v4, v31
    v_cmp_eq_u32 vcc, -1, v4
    s_cbranch_vccnz .A_100
.W_103:
    v_smfmac_f32_16x16x64_bf16 v[52:55], v[28:31], a[16:23], v9
    v_smfmac_f32_16x16x64_bf16 v[56:59], v[28:31], a[48:55], v9
    s_waitcnt vmcnt(1)
    v_max3_u32 v4, v20, v21, v22
    v_max_u32 v4, v4, v23
    v_smfmac_f32_16x16x64_bf16 v[60:63], v[28:31], a[80:87], v9
    v_cmp_eq_u32 vcc, -1, v4
    v_smfmac_f32_16x16x64_bf16 v[64:67], v[28:31], a[112:119], v9
    s_cbranch_vccz .W_97
    s_branch .A_96
.W_101:
    v_smfmac_f32_16x16x64_bf16 v[52:55], v[24:27], a[8:15], v9
    v_smfmac_f32_16x16x64_bf16 v[56:59], v[24:27], a[40:47], v9
    s_waitcnt vmcnt(1)
    v_max3_u32 v4, v28, v29, v30
    v_max_u32 v4, v4, v31
    v_smfmac_f32_16x16x64_bf16 v[60:63], v[24:27], a[72:79], v9
    v_cmp_eq_u32 vcc, -1, v4
    v_smfmac_f32_16x16x64_bf16 v[64:67], v[24:27], a[104:111], v9
    s_cbranch_vccnz .A_104
.W_105:
    v_smfmac_f32_16x16x64_bf16 v[52:55], v[28:31], a[16:23], v9
    v_smfmac_f32_16x16x64_bf16 v[56:59], v[28:31], a[48:55], v9
    s_waitcnt vmcnt(0)
    v_max3_u32 v4, v20, v21, v22
    v_max_u32 v4, v4, v23
    v_smfmac_f32_16x16x64_bf16 v[60:63], v[28:31], a[80:87], v9
    v_cmp_eq_u32 vcc, -1, v4
    v_smfmac_f32_16x16x64_bf16 v[64:67], v[28:31], a[112:119], v9
    s_cbranch_vccz .W_93
    s_branch .A_92
.A_106:
    s_mov_b64 exec, vcc
    buffer_load_dwordx4 v[24:27], v8, s[8:11], s29 offen offset:1024 sc1
    s_mov_b64 exec, -1
    s_sub_u32 s62, s62, 1
    s_cbranch_scc1 .mg_end_1
    s_waitcnt vmcnt(2)
    v_max3_u32 v4, v32, v33, v34
    v_max_u32 v4, v4, v35
    v_cmp_eq_u32 vcc, -1, v4
    s_cbranch_vccz .W_95
.A_94:
    s_mov_b64 exec, vcc
    buffer_load_dwordx4 v[32:35], v8, s[8:11], s29 offen offset:3072 sc1
    s_mov_b64 exec, -1
    s_waitcnt vmcnt(2)
    v_max3_u32 v4, v20, v21, v22
    v_max_u32 v4, v4, v23
    v_cmp_eq_u32 vcc, -1, v4
    s_cbranch_vccz .W_107
.A_108:
    s_mov_b64 exec, vcc
    buffer_load_dwordx4 v[20:23], v8, s[8:11], s29 offen offset:0 sc1
    s_mov_b64 exec, -1
    s_waitcnt vmcnt(2)
    v_max3_u32 v4, v24, v25, v26
    v_max_u32 v4, v4, v27
    v_cmp_eq_u32 vcc, -1, v4
    s_cbranch_vccnz .A_106
.W_109:
    v_smfmac_f32_16x16x64_bf16 v[52:55], v[24:27], a[8:15], v9
    v_smfmac_f32_16x16x64_bf16 v[56:59], v[24:27], a[40:47], v9
    s_waitcnt vmcnt(1)
    v_max3_u32 v4, v32, v33, v34
    v_max_u32 v4, v4, v35
    v_smfmac_f32_16x16x64_bf16 v[60:63], v[24:27], a[72:79], v9
    v_cmp_eq_u32 vcc, -1, v4
    v_smfmac_f32_16x16x64_bf16 v[64:67], v[24:27], a[104:111], v9
    s_cbranch_vccz .W_91
    s_branch .A_90
.W_107:
    v_smfmac_f32_16x16x64_bf16 v[52:55], v[20:23], a[0:7], v9
    v_smfmac_f32_16x16x64_bf16 v[56:59], v[20:23], a[32:39], v9
    s_waitcnt vmcnt(1)
    v_max3_u32 v4, v24, v25, v26
    v_max_u32 v4, v4, v27
    v_smfmac_f32_16x16x64_bf16 v[60:63], v[20:23], a[64:71], v9
    v_cmp_eq_u32 vcc, -1, v4
    v_smfmac_f32_16x16x64_bf16 v[64:67], v[20:23], a[96:103], v9
    s_cbranch_vccnz .A_110
.W_111:
    v_smfmac_f32_16x16x64_bf16 v[52:55], v[24:27], a[8:15], v9
    v_smfmac_f32_16x16x64_bf16 v[56:59], v[24:27], a[40:47], v9
    s_waitcnt vmcnt(0)
    v_max3_u32 v4, v32, v33, v34
    v_max_u32 v4, v4, v35
    v_smfmac_f32_16x16x64_bf16 v[60:63], v[24:27], a[72:79], v9
    v_cmp_eq_u32 vcc, -1, v4
    v_smfmac_f32_16x16x64_bf16 v[64:67], v[24:27], a[104:111], v9
    s_cbranch_vccz .W_48
    s_branch .A_47
.A_112:
    s_mov_b64 exec, vcc
    buffer_load_dwordx4 v[32:35], v8, s[8:11], s29 offen offset:3072 sc1
    s_mov_b64 exec, -1
    s_sub_u32 s62, s62, 1
    s_cbranch_scc1 .mg_end_1
    s_waitcnt vmcnt(2)
    v_max3_u32 v4, v20, v21, v22
    v_max_u32 v4, v4, v23
    v_cmp_eq_u32 vcc, -1, v4
    s_cbranch_vccz .W_113
.A_114:
    s_mov_b64 exec, vcc
    buffer_load_dwordx4 v[20:23], v8, s[8:11], s29 offen offset:0 sc1
    s_mov_b64 exec, -1
    s_waitcnt vmcnt(2)
    v_max3_u32 v4, v28, v29, v30
    v_max_u32 v4, v4, v31
    v_cmp_eq_u32 vcc, -1, v4
    s_cbranch_vccz .W_89
.A_88:
    s_mov_b64 exec, vcc
    buffer_load_dwordx4 v[28:31], v8, s[8:11], s29 offen offset:2048 sc1
    s_mov_b64 exec, -1
    s_waitcnt vmcnt(2)
    v_max3_u32 v4, v32, v33, v34
    v_max_u32 v4, v4, v35
    v_cmp_eq_u32 vcc, -1, v4
    s_cbranch_vccnz .A_112
.W_115:
    v_smfmac_f32_16x16x64_bf16 v[52:55], v[32:35], a[24:31], v9
    v_smfmac_f32_16x16x64_bf16 v[56:59], v[32:35], a[56:63], v9
    s_waitcnt vmcnt(1)
    v_max3_u32 v4, v20, v21, v22
    v_max_u32 v4, v4, v23
    v_smfmac_f32_16x16x64_bf16 v[60:63], v[32:35], a[88:95], v9
    v_cmp_eq_u32 vcc, -1, v4
    v_smfmac_f32_16x16x64_bf16 v[64:67], v[32:35], a[120:127], v9
    s_cbranch_vccnz .A_116
.W_117:
    v_smfmac_f32_16x16x64_bf16 v[52:55], v[20:23], a[0:7], v9
    v_smfmac_f32_16x16x64_bf16 v[56:59], v[20:23], a[32:39], v9
    s_waitcnt vmcnt(0)
    v_max3_u32 v4, v28, v29, v30
    v_max_u32 v4, v4, v31
    v_smfmac_f32_16x16x64_bf16 v[60:63], v[20:23], a[64:71], v9
    v_cmp_eq_u32 vcc, -1, v4
    v_smfmac_f32_16x16x64_bf16 v[64:67], v[20:23], a[96:103], v9
    s_cbranch_vccz .W_87
    s_branch .A_86
.W_113:
    v_smfmac_f32_16x16x64_bf16 v[52:55], v[20:23], a[0:7], v9
    v_smfmac_f32_16x16x64_bf16 v[56:59], v[20:23], a[32:39], v9
    s_waitcnt vmcnt(1)
    v_max3_u32 v4, v28, v29, v30
    v_max_u32 v4, v4, v31
    v_smfmac_f32_16x16x64_bf16 v[60:63], v[20:23], a[64:71], v9
    v_cmp_eq_u32 vcc, -1, v4
    v_smfmac_f32_16x16x64_bf16 v[64:67], v[20:23], a[96:103], v9
    s_cbranch_vccz .W_46
    s_branch .A_45
.A_118:
    s_mov_b64 exec, vcc
    buffer_load_dwordx4 v[32:35], v8, s[8:11], s29 offen offset:3072 sc1
    s_mov_b64 exec, -1
    s_sub_u32 s62, s62, 1
    s_cbranch_scc1 .mg_end_1
    s_waitcnt vmcnt(2)
    v_max3_u32 v4, v24, v25, v26
    v_max_u32 v4, v4, v27
    v_cmp_eq_u32 vcc, -1, v4
    s_cbranch_vccz .W_44
.A_43:
    s_mov_b64 exec, vcc
    buffer_load_dwordx4 v[24:27], v8, s[8:11], s29 offen offset:1024 sc1
    s_mov_b64 exec, -1
    s_waitcnt vmcnt(2)
    v_max3_u32 v4, v28, v29, v30
    v_max_u32 v4, v4, v31
    v_cmp_eq_u32 vcc, -1, v4
    s_cbranch_vccz .W_119
.A_120:
    s_mov_b64 exec, vcc
    buffer_load_dwordx4 v[28:31], v8, s[8:11], s29 offen offset:2048 sc1
    s_mov_b64 exec, -1
    s_waitcnt vmcnt(2)
    v_max3_u32 v4, v32, v33, v34
    v_max_u32 v4, v4, v35
    v_cmp_eq_u32 vcc, -1, v4
    s_cbranch_vccnz .A_118
.W_121:
    v_smfmac_f32_16x16x64_bf16 v[52:55], v[32:35], a[24:31], v9
    v_smfmac_f32_16x16x64_bf16 v[56:59], v[32:35], a[56:63], v9
    s_waitcnt vmcnt(1)
    v_max3_u32 v4, v24, v25, v26
    v_max_u32 v4, v4, v27
    v_smfmac_f32_16x16x64_bf16 v[60:63], v[32:35], a[88:95], v9
    v_cmp_eq_u32 vcc, -1, v4
    v_smfmac_f32_16x16x64_bf16 v[64:67], v[32:35], a[120:127], v9
    s_cbranch_vccz .W_85
    s_branch .A_84
.W_119:
    v_smfmac_f32_16x16x64_bf16 v[52:55], v[28:31], a[16:23], v9
    v_smfmac_f32_16x16x64_bf16 v[56:59], v[28:31], a[48:55], v9
    s_waitcnt vmcnt(1)
    v_max3_u32 v4, v32, v33, v34
    v_max_u32 v4, v4, v35
    v_smfmac_f32_16x16x64_bf16 v[60:63], v[28:31], a[80:87], v9
    v_cmp_eq_u32 vcc, -1, v4
    v_smfmac_f32_16x16x64_bf16 v[64:67], v[28:31], a[112:119], v9
    s_cbranch_vccnz .A_122
.W_123:
    v_smfmac_f32_16x16x64_bf16 v[52:55], v[32:35], a[24:31], v9
    v_smfmac_f32_16x16x64_bf16 v[56:59], v[32:35], a[56:63], v9
    s_waitcnt vmcnt(0)
    v_max3_u32 v4, v24, v25, v26
    v_max_u32 v4, v4, v27
    v_smfmac_f32_16x16x64_bf16 v[60:63], v[32:35], a[88:95], v9
    v_cmp_eq_u32 vcc, -1, v4
    v_smfmac_f32_16x16x64_bf16 v[64:67], v[32:35], a[120:127], v9
    s_cbranch_vccz .W_99
    s_branch .A_98
.A_124:
    s_mov_b64 exec, vcc
    buffer_load_dwordx4 v[24:27], v8, s[8:11], s29 offen offset:1024 sc1
    s_mov_b64 exec, -1
    s_sub_u32 s62, s62, 1
    s_cbranch_scc1 .mg_end_1
    s_waitcnt vmcnt(1)
    v_max3_u32 v4, v20, v21, v22
    v_max_u32 v4, v4, v23
    v_cmp_eq_u32 vcc, -1, v4
    s_cbranch_vccz .W_97
.A_96:
    s_mov_b64 exec, vcc
    buffer_load_dwordx4 v[20:23], v8, s[8:11], s29 offen offset:0 sc1
    s_mov_b64 exec, -1
    s_waitcnt vmcnt(1)
    v_max3_u32 v4, v24, v25, v26
    v_max_u32 v4, v4, v27
    v_cmp_eq_u32 vcc, -1, v4
    s_cbranch_vccnz .A_124
.W_125:
    v_smfmac_f32_16x16x64_bf16 v[52:55], v[24:27], a[8:15], v9
    v_smfmac_f32_16x16x64_bf16 v[56:59], v[24:27], a[40:47], v9
    s_waitcnt vmcnt(0)
    v_max3_u32 v4, v20, v21, v22
    v_max_u32 v4, v4, v23
    v_smfmac_f32_16x16x64_bf16 v[60:63], v[24:27], a[72:79], v9
    v_cmp_eq_u32 vcc, -1, v4
    v_smfmac_f32_16x16x64_bf16 v[64:67], v[24:27], a[104:111], v9
    s_cbranch_vccz .W_93
    s_branch .A_92
.A_104:
    s_mov_b64 exec, vcc
    buffer_load_dwordx4 v[28:31], v8, s[8:11], s29 offen offset:2048 sc1
    s_mov_b64 exec, -1
    s_sub_u32 s62, s62, 1
    s_cbranch_scc1 .mg_end_1
    s_waitcnt vmcnt(1)
    v_max3_u32 v4, v20, v21, v22
    v_max_u32 v4, v4, v23
    v_cmp_eq_u32 vcc, -1, v4
    s_cbranch_vccz .W_117
.A_116:
    s_mov_b64 exec, vcc
    buffer_load_dwordx4 v[20:23], v8, s[8:11], s29 offen offset:0 sc1
    s_mov_b64 exec, -1
    s_waitcnt vmcnt(1)
    v_max3_u32 v4, v28, v29, v30
    v_max_u32 v4, v4, v31
    v_cmp_eq_u32 vcc, -1, v4
    s_cbranch_vccnz .A_104
    s_branch .W_105
.A_126:
    s_mov_b64 exec, vcc
    buffer_load_dwordx4 v[20:23], v8, s[8:11], s29 offen offset:0 sc1
    s_mov_b64 exec, -1
    s_sub_u32 s62, s62, 1
    s_cbranch_scc1 .mg_end_1
    s_waitcnt vmcnt(1)
    v_max3_u32 v4, v32, v33, v34
    v_max_u32 v4, v4, v35
    v_cmp_eq_u32 vcc, -1, v4
    s_cbranch_vccz .W_91
.A_90:
    s_mov_b64 exec, vcc
    buffer_load_dwordx4 v[32:35], v8, s[8:11], s29 offen offset:3072 sc1
    s_mov_b64 exec, -1
    s_waitcnt vmcnt(1)
    v_max3_u32 v4, v20, v21, v22
    v_max_u32 v4, v4, v23
    v_cmp_eq_u32 vcc, -1, v4
    s_cbranch_vccnz .A_126
.W_127:
    v_smfmac_f32_16x16x64_bf16 v[52:55], v[20:23], a[0:7], v9
    v_smfmac_f32_16x16x64_bf16 v[56:59], v[20:23], a[32:39], v9
    s_waitcnt vmcnt(0)
    v_max3_u32 v4, v32, v33, v34
    v_max_u32 v4, v4, v35
    v_smfmac_f32_16x16x64_bf16 v[60:63], v[20:23], a[64:71], v9
    v_cmp_eq_u32 vcc, -1, v4
    v_smfmac_f32_16x16x64_bf16 v[64:67], v[20:23], a[96:103], v9
    s_cbranch_vccz .W_48
    s_branch .A_47
.A_128:
    s_mov_b64 exec, vcc
    buffer_load_dwordx4 v[28:31], v8, s[8:11], s29 offen offset:2048 sc1
    s_mov_b64 exec, -1
    s_sub_u32 s62, s62, 1
    s_cbranch_scc1 .mg_end_1
    s_waitcnt vmcnt(1)
    v_max3_u32 v4, v24, v25, v26
    v_max_u32 v4, v4, v27
    v_cmp_eq_u32 vcc, -1, v4
    s_cbranch_vccz .W_85
.A_84:
    s_mov_b64 exec, vcc
    buffer_load_dwordx4 v[24:27], v8, s[8:11], s29 offen offset:1024 sc1
    s_mov_b64 exec, -1
    s_waitcnt vmcnt(1)
    v_max3_u32 v4, v28, v29, v30
    v_max_u32 v4, v4, v31
    v_cmp_eq_u32 vcc, -1, v4
    s_cbranch_vccnz .A_128
.W_129:
    v_smfmac_f32_16x16x64_bf16 v[52:55], v[28:31], a[16:23], v9
    v_smfmac_f32_16x16x64_bf16 v[56:59], v[28:31], a[48:55], v9
    s_waitcnt vmcnt(0)
    v_max3_u32 v4, v24, v25, v26
    v_max_u32 v4, v4, v27
    v_smfmac_f32_16x16x64_bf16 v[60:63], v[28:31], a[80:87], v9
    v_cmp_eq_u32 vcc, -1, v4
    v_smfmac_f32_16x16x64_bf16 v[64:67], v[28:31], a[112:119], v9
    s_cbranch_vccz .W_99
    s_branch .A_98
.A_122:
    s_mov_b64 exec, vcc
    buffer_load_dwordx4 v[32:35], v8, s[8:11], s29 offen offset:3072 sc1
    s_mov_b64 exec, -1
    s_sub_u32 s62, s62, 1
    s_cbranch_scc1 .mg_end_1
    s_waitcnt vmcnt(1)
    v_max3_u32 v4, v24, v25, v26
    v_max_u32 v4, v4, v27
    v_cmp_eq_u32 vcc, -1, v4
    s_cbranch_vccz .W_111
.A_110:
    s_mov_b64 exec, vcc
    buffer_load_dwordx4 v[24:27], v8, s[8:11], s29 offen offset:1024 sc1
    s_mov_b64 exec, -1
    s_waitcnt vmcnt(1)
    v_max3_u32 v4, v32, v33, v34
    v_max_u32 v4, v4, v35
    v_cmp_eq_u32 vcc, -1, v4
    s_cbranch_vccnz .A_122
    s_branch .W_123
.A_130:
    s_mov_b64 exec, vcc
    buffer_load_dwordx4 v[32:35], v8, s[8:11], s29 offen offset:3072 sc1
    s_mov_b64 exec, -1
    s_sub_u32 s62, s62, 1
    s_cbranch_scc1 .mg_end_1
    s_waitcnt vmcnt(1)
    v_max3_u32 v4, v28, v29, v30
    v_max_u32 v4, v4, v31
    v_cmp_eq_u32 vcc, -1, v4
    s_cbranch_vccz .W_46
.A_45:
    s_mov_b64 exec, vcc
    buffer_load_dwordx4 v[28:31], v8, s[8:11], s29 offen offset:2048 sc1
    s_mov_b64 exec, -1
    s_waitcnt vmcnt(1)
    v_max3_u32 v4, v32, v33, v34
    v_max_u32 v4, v4, v35
    v_cmp_eq_u32 vcc, -1, v4
    s_cbranch_vccnz .A_130
.W_131:
    v_smfmac_f32_16x16x64_bf16 v[52:55], v[32:35], a[24:31], v9
    v_smfmac_f32_16x16x64_bf16 v[56:59], v[32:35], a[56:63], v9
    s_waitcnt vmcnt(0)
    v_max3_u32 v4, v28, v29, v30
    v_max_u32 v4, v4, v31
    v_smfmac_f32_16x16x64_bf16 v[60:63], v[32:35], a[88:95], v9
    v_cmp_eq_u32 vcc, -1, v4
    v_smfmac_f32_16x16x64_bf16 v[64:67], v[32:35], a[120:127], v9
    s_cbranch_vccz .W_87
    s_branch .A_86
.A_92:
    s_mov_b64 exec, vcc
    buffer_load_dwordx4 v[20:23], v8, s[8:11], s29 offen offset:0 sc1
    s_mov_b64 exec, -1
    s_sub_u32 s62, s62, 1
    s_cbranch_scc1 .mg_end_1
    s_waitcnt vmcnt(1)
    v_max3_u32 v4, v20, v21, v22
    v_max_u32 v4, v4, v23
    v_cmp_eq_u32 vcc, -1, v4
    s_cbranch_vccnz .A_92
    v_smfmac_f32_16x16x64_bf16 v[52:55], v[20:23], a[0:7], v9
    v_smfmac_f32_16x16x64_bf16 v[56:59], v[20:23], a[32:39], v9
    v_smfmac_f32_16x16x64_bf16 v[60:63], v[20:23], a[64:71], v9
    v_smfmac_f32_16x16x64_bf16 v[64:67], v[20:23], a[96:103], v9
    s_branch .mj_40
.A_98:
    s_mov_b64 exec, vcc
    buffer_load_dwordx4 v[24:27], v8, s[8:11], s29 offen offset:1024 sc1
    s_mov_b64 exec, -1
    s_sub_u32 s62, s62, 1
    s_cbranch_scc1 .mg_end_1
    s_waitcnt vmcnt(1)
    v_max3_u32 v4, v24, v25, v26
    v_max_u32 v4, v4, v27
    v_cmp_eq_u32 vcc, -1, v4
    s_cbranch_vccnz .A_98
    v_smfmac_f32_16x16x64_bf16 v[52:55], v[24:27], a[8:15], v9
    v_smfmac_f32_16x16x64_bf16 v[56:59], v[24:27], a[40:47], v9
    v_smfmac_f32_16x16x64_bf16 v[60:63], v[24:27], a[72:79], v9
    v_smfmac_f32_16x16x64_bf16 v[64:67], v[24:27], a[104:111], v9
    s_branch .mj_40
.A_86:
    s_mov_b64 exec, vcc
    buffer_load_dwordx4 v[28:31], v8, s[8:11], s29 offen offset:2048 sc1
    s_mov_b64 exec, -1
    s_sub_u32 s62, s62, 1
    s_cbranch_scc1 .mg_end_1
    s_waitcnt vmcnt(1)
    v_max3_u32 v4, v28, v29, v30
    v_max_u32 v4, v4, v31
    v_cmp_eq_u32 vcc, -1, v4
    s_cbranch_vccnz .A_86
    v_smfmac_f32_16x16x64_bf16 v[52:55], v[28:31], a[16:23], v9
    v_smfmac_f32_16x16x64_bf16 v[56:59], v[28:31], a[48:55], v9
    v_smfmac_f32_16x16x64_bf16 v[60:63], v[28:31], a[80:87], v9
    v_smfmac_f32_16x16x64_bf16 v[64:67], v[28:31], a[112:119], v9
    s_branch .mj_40
.A_47:
    s_mov_b64 exec, vcc
    buffer_load_dwordx4 v[32:35], v8, s[8:11], s29 offen offset:3072 sc1
    s_mov_b64 exec, -1
    s_sub_u32 s62, s62, 1
    s_cbranch_scc1 .mg_end_1
    s_waitcnt vmcnt(1)
    v_max3_u32 v4, v32, v33, v34
    v_max_u32 v4, v4, v35
    v_cmp_eq_u32 vcc, -1, v4
    s_cbranch_vccnz .A_47
    v_smfmac_f32_16x16x64_bf16 v[52:55], v[32:35], a[24:31], v9
    v_smfmac_f32_16x16x64_bf16 v[56:59], v[32:35], a[56:63], v9
    v_smfmac_f32_16x16x64_bf16 v[60:63], v[32:35], a[88:95], v9
    v_smfmac_f32_16x16x64_bf16 v[64:67], v[32:35], a[120:127], v9
    s_branch .mj_40
.A_132:
    buffer_load_dwordx4 v[100:103], v234, s[8:11], s29 offen sc1
    s_sub_u32 s62, s62, 1
    s_cbranch_scc1 .mg_end_1
    s_waitcnt vmcnt(2)
    v_max3_u32 v4, v92, v93, v94
    v_max_u32 v4, v4, v95
    v_cmp_eq_u32 vcc, -1, v4
    s_cbranch_vccz .W_51
.A_50:
    buffer_load_dwordx4 v[92:95], v232, s[8:11], s29 offen sc1
    s_waitcnt vmcnt(2)
    v_max3_u32 v4, v96, v97, v98
    v_max_u32 v4, v4, v99
    v_cmp_eq_u32 vcc, -1, v4
    s_cbranch_vccz .W_133
.A_134:
    buffer_load_dwordx4 v[96:99], v233, s[8:11], s29 offen sc1
    s_waitcnt vmcnt(2)
    v_max3_u32 v4, v100, v101, v102
    v_max_u32 v4, v4, v103
    v_cmp_eq_u32 vcc, -1, v4
    s_cbranch_vccnz .A_132
.W_135:
    v_mfma_f32_16x16x32_bf16 v[208:211], v[140:143], v[100:103], v[208:211]
    s_waitcnt vmcnt(1)
    v_max3_u32 v4, v92, v93, v94
    v_max_u32 v4, v4, v95
    v_mfma_f32_16x16x32_bf16 v[212:215], v[156:159], v[100:103], v[212:215]
    v_cmp_eq_u32 vcc, -1, v4
    v_mfma_f32_16x16x32_bf16 v[216:219], v[100:103], v[100:103], v[216:219]
    s_cbranch_vccnz .A_136
.W_137:
    v_mfma_f32_16x16x32_bf16 v[208:211], v[132:135], v[92:95], v[208:211]
    s_waitcnt vmcnt(0)
    v_max3_u32 v4, v96, v97, v98
    v_max_u32 v4, v4, v99
    v_mfma_f32_16x16x32_bf16 v[212:215], v[148:151], v[92:95], v[212:215]
    v_cmp_eq_u32 vcc, -1, v4
    v_mfma_f32_16x16x32_bf16 v[216:219], v[92:95], v[92:95], v[216:219]
    s_cbranch_vccnz .A_138
.W_139:
    v_mfma_f32_16x16x32_bf16 v[208:211], v[136:139], v[96:99], v[208:211]
    v_mfma_f32_16x16x32_bf16 v[212:215], v[152:155], v[96:99], v[212:215]
    v_mfma_f32_16x16x32_bf16 v[216:219], v[96:99], v[96:99], v[216:219]
    s_branch .mj_49
.W_133:
    v_mfma_f32_16x16x32_bf16 v[208:211], v[136:139], v[96:99], v[208:211]
    s_waitcnt vmcnt(1)
    v_max3_u32 v4, v100, v101, v102
    v_max_u32 v4, v4, v103
    v_mfma_f32_16x16x32_bf16 v[212:215], v[152:155], v[96:99], v[212:215]
    v_cmp_eq_u32 vcc, -1, v4
    v_mfma_f32_16x16x32_bf16 v[216:219], v[96:99], v[96:99], v[216:219]
    s_cbranch_vccnz .A_140
.W_141:
    v_mfma_f32_16x16x32_bf16 v[208:211], v[140:143], v[100:103], v[208:211]
    s_waitcnt vmcnt(0)
    v_max3_u32 v4, v92, v93, v94
    v_max_u32 v4, v4, v95
    v_mfma_f32_16x16x32_bf16 v[212:215], v[156:159], v[100:103], v[212:215]
    v_cmp_eq_u32 vcc, -1, v4
    v_mfma_f32_16x16x32_bf16 v[216:219], v[100:103], v[100:103], v[216:219]
    s_cbranch_vccnz .A_142
.W_143:
    v_mfma_f32_16x16x32_bf16 v[208:211], v[132:135], v[92:95], v[208:211]
    v_mfma_f32_16x16x32_bf16 v[212:215], v[148:151], v[92:95], v[212:215]
    v_mfma_f32_16x16x32_bf16 v[216:219], v[92:95], v[92:95], v[216:219]
    s_branch .mj_49
.A_144:
    buffer_load_dwordx4 v[96:99], v233, s[8:11], s29 offen sc1
    s_sub_u32 s62, s62, 1
    s_cbranch_scc1 .mg_end_1
    s_waitcnt vmcnt(1)
    v_max3_u32 v4, v92, v93, v94
    v_max_u32 v4, v4, v95
    v_cmp_eq_u32 vcc, -1, v4
    s_cbranch_vccz .W_137
.A_136:
    buffer_load_dwordx4 v[92:95], v232, s[8:11], s29 offen sc1
    s_waitcnt vmcnt(1)
    v_max3_u32 v4, v96, v97, v98
    v_max_u32 v4, v4, v99
    v_cmp_eq_u32 vcc, -1, v4
    s_cbranch_vccnz .A_144
.W_145:
    v_mfma_f32_16x16x32_bf16 v[208:211], v[136:139], v[96:99], v[208:211]
    s_waitcnt vmcnt(0)
    v_max3_u32 v4, v92, v93, v94
    v_max_u32 v4, v4, v95
    v_mfma_f32_16x16x32_bf16 v[212:215], v[152:155], v[96:99], v[212:215]
    v_cmp_eq_u32 vcc, -1, v4
    v_mfma_f32_16x16x32_bf16 v[216:219], v[96:99], v[96:99], v[216:219]
    s_cbranch_vccz .W_143
    s_branch .A_142
.A_146:
    buffer_load_dwordx4 v[92:95], v232, s[8:11], s29 offen sc1
    s_sub_u32 s62, s62, 1
    s_cbranch_scc1 .mg_end_1
    s_waitcnt vmcnt(1)
    v_max3_u32 v4, v100, v101, v102
    v_max_u32 v4, v4, v103
    v_cmp_eq_u32 vcc, -1, v4
    s_cbranch_vccz .W_141
.A_140:
    buffer_load_dwordx4 v[100:103], v234, s[8:11], s29 offen sc1
    s_waitcnt vmcnt(1)
    v_max3_u32 v4, v92, v93, v94
    v_max_u32 v4, v4, v95
    v_cmp_eq_u32 vcc, -1, v4
    s_cbranch_vccnz .A_146
.W_147:
    v_mfma_f32_16x16x32_bf16 v[208:211], v[132:135], v[92:95], v[208:211]
    s_waitcnt vmcnt(0)
    v_max3_u32 v4, v100, v101, v102
    v_max_u32 v4, v4, v103
    v_mfma_f32_16x16x32_bf16 v[212:215], v[148:151], v[92:95], v[212:215]
    v_cmp_eq_u32 vcc, -1, v4
    v_mfma_f32_16x16x32_bf16 v[216:219], v[92:95], v[92:95], v[216:219]
    s_cbranch_vccz .W_55
    s_branch .A_54
.A_148:
    buffer_load_dwordx4 v[100:103], v234, s[8:11], s29 offen sc1
    s_sub_u32 s62, s62, 1
    s_cbranch_scc1 .mg_end_1
    s_waitcnt vmcnt(1)
    v_max3_u32 v4, v96, v97, v98
    v_max_u32 v4, v4, v99
    v_cmp_eq_u32 vcc, -1, v4
    s_cbranch_vccz .W_53
.A_52:
    buffer_load_dwordx4 v[96:99], v233, s[8:11], s29 offen sc1
    s_waitcnt vmcnt(1)
    v_max3_u32 v4, v100, v101, v102
    v_max_u32 v4, v4, v103
    v_cmp_eq_u32 vcc, -1, v4
    s_cbranch_vccnz .A_148
.W_149:
    v_mfma_f32_16x16x32_bf16 v[208:211], v[140:143], v[100:103], v[208:211]
    s_waitcnt vmcnt(0)
    v_max3_u32 v4, v96, v97, v98
    v_max_u32 v4, v4, v99
    v_mfma_f32_16x16x32_bf16 v[212:215], v[156:159], v[100:103], v[212:215]
    v_cmp_eq_u32 vcc, -1, v4
    v_mfma_f32_16x16x32_bf16 v[216:219], v[100:103], v[100:103], v[216:219]
    s_cbranch_vccz .W_139
    s_branch .A_138
.A_142:
    buffer_load_dwordx4 v[92:95], v232, s[8:11], s29 offen sc1
    s_sub_u32 s62, s62, 1
    s_cbranch_scc1 .mg_end_1
    s_waitcnt vmcnt(1)
    v_max3_u32 v4, v92, v93, v94
    v_max_u32 v4, v4, v95
    v_cmp_eq_u32 vcc, -1, v4
    s_cbranch_vccnz .A_142
    v_mfma_f32_16x16x32_bf16 v[208:211], v[132:135], v[92:95], v[208:211]
    v_mfma_f32_16x16x32_bf16 v[212:215], v[148:151], v[92:95], v[212:215]
    v_mfma_f32_16x16x32_bf16 v[216:219], v[92:95], v[92:95], v[216:219]
    s_branch .mj_49
.A_138:
    buffer_load_dwordx4 v[96:99], v233, s[8:11], s29 offen sc1
    s_sub_u32 s62, s62, 1
    s_cbranch_scc1 .mg_end_1
    s_waitcnt vmcnt(1)
    v_max3_u32 v4, v96, v97, v98
    v_max_u32 v4, v4, v99
    v_cmp_eq_u32 vcc, -1, v4
    s_cbranch_vccnz .A_138
    v_mfma_f32_16x16x32_bf16 v[208:211], v[136:139], v[96:99], v[208:211]
    v_mfma_f32_16x16x32_bf16 v[212:215], v[152:155], v[96:99], v[212:215]
    v_mfma_f32_16x16x32_bf16 v[216:219], v[96:99], v[96:99], v[216:219]
    s_branch .mj_49
.A_54:
    buffer_load_dwordx4 v[100:103], v234, s[8:11], s29 offen sc1
    s_sub_u32 s62, s62, 1
    s_cbranch_scc1 .mg_end_1
    s_waitcnt vmcnt(1)
    v_max3_u32 v4, v100, v101, v102
    v_max_u32 v4, v4, v103
    v_cmp_eq_u32 vcc, -1, v4
    s_cbranch_vccnz .A_54
    v_mfma_f32_16x16x32_bf16 v[208:211], v[140:143], v[100:103], v[208:211]
    v_mfma_f32_16x16x32_bf16 v[212:215], v[156:159], v[100:103], v[212:215]
    v_mfma_f32_16x16x32_bf16 v[216:219], v[100:103], v[100:103], v[216:219]
    s_branch .mj_49
.kf_62:
    s_mov_b32 s62, 0
    s_mov_b64 exec, 3
.wf_150:
    buffer_load_dword v244, v253, s[8:11], s89 offen sc1
    s_waitcnt vmcnt(0)
    v_cmp_gt_u32 vcc, s6, v244
    s_cbranch_vccz .wfd_151
    s_sleep 2
    s_add_u32 s62, s62, 1
    s_cmp_gt_u32 s62, 0x400000
    s_cbranch_scc1 .mg_end_1
    s_branch .wf_150

.wfd_151:
    s_mov_b64 exec, -1
    v_readlane_b32 s4, v244, 0
    v_readlane_b32 s93, v244, 1
    s_min_u32 s93, s93, s4
    s_mov_b32 s62, 0x1000000
    s_branch .kb_63
.A_152:
    buffer_load_dwordx4 v[216:219], v246, s[8:11], s32 offen offset:0 sc1
    buffer_load_dwordx4 v[220:223], v246, s[8:11], s32 offen offset:1024 sc1
    s_sub_u32 s62, s62, 1
    s_cbranch_scc1 .mg_end_1
    s_waitcnt vmcnt(6)
    v_max3_u32 v4, v192, v193, v194
    v_max3_u32 v5, v195, v196, v197
    v_max3_u32 v4, v4, v198, v199
    v_max_u32 v4, v4, v5
    v_cmp_eq_u32 vcc, -1, v4
    s_cbranch_vccz .W_66
.A_65:
    buffer_load_dwordx4 v[192:195], v243, s[8:11], s32 offen offset:0 sc1
    buffer_load_dwordx4 v[196:199], v243, s[8:11], s32 offen offset:1024 sc1
    s_waitcnt vmcnt(6)
    v_max3_u32 v4, v200, v201, v202
    v_max3_u32 v5, v203, v204, v205
    v_max3_u32 v4, v4, v206, v207
    v_max_u32 v4, v4, v5
    v_cmp_eq_u32 vcc, -1, v4
    s_cbranch_vccz .W_153
.A_154:
    buffer_load_dwordx4 v[200:203], v252, s[8:11], s32 offen offset:0 sc1
    buffer_load_dwordx4 v[204:207], v252, s[8:11], s32 offen offset:1024 sc1
    s_waitcnt vmcnt(6)
    v_max3_u32 v4, v208, v209, v210
    v_max3_u32 v5, v211, v212, v213
    v_max3_u32 v4, v4, v214, v215
    v_max_u32 v4, v4, v5
    v_cmp_eq_u32 vcc, -1, v4
    s_cbranch_vccz .W_155
.A_156:
    buffer_load_dwordx4 v[208:211], v254, s[8:11], s32 offen offset:0 sc1
    buffer_load_dwordx4 v[212:215], v254, s[8:11], s32 offen offset:1024 sc1
    s_waitcnt vmcnt(6)
    v_max3_u32 v4, v216, v217, v218
    v_max3_u32 v5, v219, v220, v221
    v_max3_u32 v4, v4, v222, v223
    v_max_u32 v4, v4, v5
    v_cmp_eq_u32 vcc, -1, v4
    s_cbranch_vccnz .A_152
.W_157:
    v_smfmac_f32_16x16x64_bf16 v[76:79], v[216:219], v[140:147], v9
    v_smfmac_f32_16x16x64_bf16 v[80:83], v[216:219], v[172:179], v9
    s_waitcnt vmcnt(4)
    v_max3_u32 v4, v192, v193, v194
    v_max3_u32 v5, v195, v196, v197
    v_max3_u32 v4, v4, v198, v199
    v_smfmac_f32_16x16x64_bf16 v[76:79], v[220:223], v[148:155], v9
    v_max_u32 v4, v4, v5
    v_cmp_eq_u32 vcc, -1, v4
    v_smfmac_f32_16x16x64_bf16 v[80:83], v[220:223], v[180:187], v9
    s_cbranch_vccnz .A_158
.W_159:
    v_smfmac_f32_16x16x64_bf16 v[76:79], v[192:195], a[192:199], v9
    v_smfmac_f32_16x16x64_bf16 v[80:83], v[192:195], a[224:231], v9
    s_waitcnt vmcnt(2)
    v_max3_u32 v4, v200, v201, v202
    v_max3_u32 v5, v203, v204, v205
    v_max3_u32 v4, v4, v206, v207
    v_smfmac_f32_16x16x64_bf16 v[76:79], v[196:199], a[200:207], v9
    v_max_u32 v4, v4, v5
    v_cmp_eq_u32 vcc, -1, v4
    v_smfmac_f32_16x16x64_bf16 v[80:83], v[196:199], a[232:239], v9
    s_cbranch_vccnz .A_160
.W_161:
    v_smfmac_f32_16x16x64_bf16 v[76:79], v[200:203], a[208:215], v9
    v_smfmac_f32_16x16x64_bf16 v[80:83], v[200:203], a[240:247], v9
    s_waitcnt vmcnt(0)
    v_max3_u32 v4, v208, v209, v210
    v_max3_u32 v5, v211, v212, v213
    v_max3_u32 v4, v4, v214, v215
    v_smfmac_f32_16x16x64_bf16 v[76:79], v[204:207], a[216:223], v9
    v_max_u32 v4, v4, v5
    v_cmp_eq_u32 vcc, -1, v4
    v_smfmac_f32_16x16x64_bf16 v[80:83], v[204:207], a[248:255], v9
    s_cbranch_vccnz .A_162
.W_163:
    v_smfmac_f32_16x16x64_bf16 v[76:79], v[208:211], v[124:131], v9
    v_smfmac_f32_16x16x64_bf16 v[80:83], v[208:211], v[156:163], v9
    v_smfmac_f32_16x16x64_bf16 v[76:79], v[212:215], v[132:139], v9
    v_smfmac_f32_16x16x64_bf16 v[80:83], v[212:215], v[164:171], v9
    s_branch .mj_64
.W_153:
    v_smfmac_f32_16x16x64_bf16 v[76:79], v[200:203], a[208:215], v9
    v_smfmac_f32_16x16x64_bf16 v[80:83], v[200:203], a[240:247], v9
    s_waitcnt vmcnt(4)
    v_max3_u32 v4, v208, v209, v210
    v_max3_u32 v5, v211, v212, v213
    v_max3_u32 v4, v4, v214, v215
    v_smfmac_f32_16x16x64_bf16 v[76:79], v[204:207], a[216:223], v9
    v_max_u32 v4, v4, v5
    v_cmp_eq_u32 vcc, -1, v4
    v_smfmac_f32_16x16x64_bf16 v[80:83], v[204:207], a[248:255], v9
    s_cbranch_vccnz .A_164
.W_165:
    v_smfmac_f32_16x16x64_bf16 v[76:79], v[208:211], v[124:131], v9
    v_smfmac_f32_16x16x64_bf16 v[80:83], v[208:211], v[156:163], v9
    s_waitcnt vmcnt(2)
    v_max3_u32 v4, v216, v217, v218
    v_max3_u32 v5, v219, v220, v221
    v_max3_u32 v4, v4, v222, v223
    v_smfmac_f32_16x16x64_bf16 v[76:79], v[212:215], v[132:139], v9
    v_max_u32 v4, v4, v5
    v_cmp_eq_u32 vcc, -1, v4
    v_smfmac_f32_16x16x64_bf16 v[80:83], v[212:215], v[164:171], v9
    s_cbranch_vccnz .A_166
.W_167:
    v_smfmac_f32_16x16x64_bf16 v[76:79], v[216:219], v[140:147], v9
    v_smfmac_f32_16x16x64_bf16 v[80:83], v[216:219], v[172:179], v9
    s_waitcnt vmcnt(0)
    v_max3_u32 v4, v192, v193, v194
    v_max3_u32 v5, v195, v196, v197
    v_max3_u32 v4, v4, v198, v199
    v_smfmac_f32_16x16x64_bf16 v[76:79], v[220:223], v[148:155], v9
    v_max_u32 v4, v4, v5
    v_cmp_eq_u32 vcc, -1, v4
    v_smfmac_f32_16x16x64_bf16 v[80:83], v[220:223], v[180:187], v9
    s_cbranch_vccnz .A_168
.W_169:
    v_smfmac_f32_16x16x64_bf16 v[76:79], v[192:195], a[192:199], v9
    v_smfmac_f32_16x16x64_bf16 v[80:83], v[192:195], a[224:231], v9
    v_smfmac_f32_16x16x64_bf16 v[76:79], v[196:199], a[200:207], v9
    v_smfmac_f32_16x16x64_bf16 v[80:83], v[196:199], a[232:239], v9
    s_branch .mj_64
.W_155:
    v_smfmac_f32_16x16x64_bf16 v[76:79], v[208:211], v[124:131], v9
    v_smfmac_f32_16x16x64_bf16 v[80:83], v[208:211], v[156:163], v9
    s_waitcnt vmcnt(4)
    v_max3_u32 v4, v216, v217, v218
    v_max3_u32 v5, v219, v220, v221
    v_max3_u32 v4, v4, v222, v223
    v_smfmac_f32_16x16x64_bf16 v[76:79], v[212:215], v[132:139], v9
    v_max_u32 v4, v4, v5
    v_cmp_eq_u32 vcc, -1, v4
    v_smfmac_f32_16x16x64_bf16 v[80:83], v[212:215], v[164:171], v9
    s_cbranch_vccnz .A_170
.W_171:
    v_smfmac_f32_16x16x64_bf16 v[76:79], v[216:219], v[140:147], v9
    v_smfmac_f32_16x16x64_bf16 v[80:83], v[216:219], v[172:179], v9
    s_waitcnt vmcnt(2)
    v_max3_u32 v4, v192, v193, v194
    v_max3_u32 v5, v195, v196, v197
    v_max3_u32 v4, v4, v198, v199
    v_smfmac_f32_16x16x64_bf16 v[76:79], v[220:223], v[148:155], v9
    v_max_u32 v4, v4, v5
    v_cmp_eq_u32 vcc, -1, v4
    v_smfmac_f32_16x16x64_bf16 v[80:83], v[220:223], v[180:187], v9
    s_cbranch_vccnz .A_172
.W_173:
    v_smfmac_f32_16x16x64_bf16 v[76:79], v[192:195], a[192:199], v9
    v_smfmac_f32_16x16x64_bf16 v[80:83], v[192:195], a[224:231], v9
    s_waitcnt vmcnt(0)
    v_max3_u32 v4, v200, v201, v202
    v_max3_u32 v5, v203, v204, v205
    v_max3_u32 v4, v4, v206, v207
    v_smfmac_f32_16x16x64_bf16 v[76:79], v[196:199], a[200:207], v9
    v_max_u32 v4, v4, v5
    v_cmp_eq_u32 vcc, -1, v4
    v_smfmac_f32_16x16x64_bf16 v[80:83], v[196:199], a[232:239], v9
    s_cbranch_vccnz .A_174
.W_175:
    v_smfmac_f32_16x16x64_bf16 v[76:79], v[200:203], a[208:215], v9
    v_smfmac_f32_16x16x64_bf16 v[80:83], v[200:203], a[240:247], v9
    v_smfmac_f32_16x16x64_bf16 v[76:79], v[204:207], a[216:223], v9
    v_smfmac_f32_16x16x64_bf16 v[80:83], v[204:207], a[248:255], v9
    s_branch .mj_64
.A_176:
    buffer_load_dwordx4 v[208:211], v254, s[8:11], s32 offen offset:0 sc1
    buffer_load_dwordx4 v[212:215], v254, s[8:11], s32 offen offset:1024 sc1
    s_sub_u32 s62, s62, 1
    s_cbranch_scc1 .mg_end_1
    s_waitcnt vmcnt(4)
    v_max3_u32 v4, v192, v193, v194
    v_max3_u32 v5, v195, v196, v197
    v_max3_u32 v4, v4, v198, v199
    v_max_u32 v4, v4, v5
    v_cmp_eq_u32 vcc, -1, v4
    s_cbranch_vccz .W_159
.A_158:
    buffer_load_dwordx4 v[192:195], v243, s[8:11], s32 offen offset:0 sc1
    buffer_load_dwordx4 v[196:199], v243, s[8:11], s32 offen offset:1024 sc1
    s_waitcnt vmcnt(4)
    v_max3_u32 v4, v200, v201, v202
    v_max3_u32 v5, v203, v204, v205
    v_max3_u32 v4, v4, v206, v207
    v_max_u32 v4, v4, v5
    v_cmp_eq_u32 vcc, -1, v4
    s_cbranch_vccz .W_177
.A_178:
    buffer_load_dwordx4 v[200:203], v252, s[8:11], s32 offen offset:0 sc1
    buffer_load_dwordx4 v[204:207], v252, s[8:11], s32 offen offset:1024 sc1
    s_waitcnt vmcnt(4)
    v_max3_u32 v4, v208, v209, v210
    v_max3_u32 v5, v211, v212, v213
    v_max3_u32 v4, v4, v214, v215
    v_max_u32 v4, v4, v5
    v_cmp_eq_u32 vcc, -1, v4
    s_cbranch_vccnz .A_176
.W_179:
    v_smfmac_f32_16x16x64_bf16 v[76:79], v[208:211], v[124:131], v9
    v_smfmac_f32_16x16x64_bf16 v[80:83], v[208:211], v[156:163], v9
    s_waitcnt vmcnt(2)
    v_max3_u32 v4, v192, v193, v194
    v_max3_u32 v5, v195, v196, v197
    v_max3_u32 v4, v4, v198, v199
    v_smfmac_f32_16x16x64_bf16 v[76:79], v[212:215], v[132:139], v9
    v_max_u32 v4, v4, v5
    v_cmp_eq_u32 vcc, -1, v4
    v_smfmac_f32_16x16x64_bf16 v[80:83], v[212:215], v[164:171], v9
    s_cbranch_vccz .W_173
    s_branch .A_172
.W_177:
    v_smfmac_f32_16x16x64_bf16 v[76:79], v[200:203], a[208:215], v9
    v_smfmac_f32_16x16x64_bf16 v[80:83], v[200:203], a[240:247], v9
    s_waitcnt vmcnt(2)
    v_max3_u32 v4, v208, v209, v210
    v_max3_u32 v5, v211, v212, v213
    v_max3_u32 v4, v4, v214, v215
    v_smfmac_f32_16x16x64_bf16 v[76:79], v[204:207], a[216:223], v9
    v_max_u32 v4, v4, v5
    v_cmp_eq_u32 vcc, -1, v4
    v_smfmac_f32_16x16x64_bf16 v[80:83], v[204:207], a[248:255], v9
    s_cbranch_vccnz .A_180
.W_181:
    v_smfmac_f32_16x16x64_bf16 v[76:79], v[208:211], v[124:131], v9
    v_smfmac_f32_16x16x64_bf16 v[80:83], v[208:211], v[156:163], v9
    s_waitcnt vmcnt(0)
    v_max3_u32 v4, v192, v193, v194
    v_max3_u32 v5, v195, v196, v197
    v_max3_u32 v4, v4, v198, v199
    v_smfmac_f32_16x16x64_bf16 v[76:79], v[212:215], v[132:139], v9
    v_max_u32 v4, v4, v5
    v_cmp_eq_u32 vcc, -1, v4
    v_smfmac_f32_16x16x64_bf16 v[80:83], v[212:215], v[164:171], v9
    s_cbranch_vccz .W_169
    s_branch .A_168
.A_182:
    buffer_load_dwordx4 v[200:203], v252, s[8:11], s32 offen offset:0 sc1
    buffer_load_dwordx4 v[204:207], v252, s[8:11], s32 offen offset:1024 sc1
    s_sub_u32 s62, s62, 1
    s_cbranch_scc1 .mg_end_1
    s_waitcnt vmcnt(4)
    v_max3_u32 v4, v216, v217, v218
    v_max3_u32 v5, v219, v220, v221
    v_max3_u32 v4, v4, v222, v223
    v_max_u32 v4, v4, v5
    v_cmp_eq_u32 vcc, -1, v4
    s_cbranch_vccz .W_171
.A_170:
    buffer_load_dwordx4 v[216:219], v246, s[8:11], s32 offen offset:0 sc1
    buffer_load_dwordx4 v[220:223], v246, s[8:11], s32 offen offset:1024 sc1
    s_waitcnt vmcnt(4)
    v_max3_u32 v4, v192, v193, v194
    v_max3_u32 v5, v195, v196, v197
    v_max3_u32 v4, v4, v198, v199
    v_max_u32 v4, v4, v5
    v_cmp_eq_u32 vcc, -1, v4
    s_cbranch_vccz .W_183
.A_184:
    buffer_load_dwordx4 v[192:195], v243, s[8:11], s32 offen offset:0 sc1
    buffer_load_dwordx4 v[196:199], v243, s[8:11], s32 offen offset:1024 sc1
    s_waitcnt vmcnt(4)
    v_max3_u32 v4, v200, v201, v202
    v_max3_u32 v5, v203, v204, v205
    v_max3_u32 v4, v4, v206, v207
    v_max_u32 v4, v4, v5
    v_cmp_eq_u32 vcc, -1, v4
    s_cbranch_vccnz .A_182
.W_185:
    v_smfmac_f32_16x16x64_bf16 v[76:79], v[200:203], a[208:215], v9
    v_smfmac_f32_16x16x64_bf16 v[80:83], v[200:203], a[240:247], v9
    s_waitcnt vmcnt(2)
    v_max3_u32 v4, v216, v217, v218
    v_max3_u32 v5, v219, v220, v221
    v_max3_u32 v4, v4, v222, v223
    v_smfmac_f32_16x16x64_bf16 v[76:79], v[204:207], a[216:223], v9
    v_max_u32 v4, v4, v5
    v_cmp_eq_u32 vcc, -1, v4
    v_smfmac_f32_16x16x64_bf16 v[80:83], v[204:207], a[248:255], v9
    s_cbranch_vccz .W_167
    s_branch .A_166
.W_183:
    v_smfmac_f32_16x16x64_bf16 v[76:79], v[192:195], a[192:199], v9
    v_smfmac_f32_16x16x64_bf16 v[80:83], v[192:195], a[224:231], v9
    s_waitcnt vmcnt(2)
    v_max3_u32 v4, v200, v201, v202
    v_max3_u32 v5, v203, v204, v205
    v_max3_u32 v4, v4, v206, v207
    v_smfmac_f32_16x16x64_bf16 v[76:79], v[196:199], a[200:207], v9
    v_max_u32 v4, v4, v5
    v_cmp_eq_u32 vcc, -1, v4
    v_smfmac_f32_16x16x64_bf16 v[80:83], v[196:199], a[232:239], v9
    s_cbranch_vccnz .A_186
.W_187:
    v_smfmac_f32_16x16x64_bf16 v[76:79], v[200:203], a[208:215], v9
    v_smfmac_f32_16x16x64_bf16 v[80:83], v[200:203], a[240:247], v9
    s_waitcnt vmcnt(0)
    v_max3_u32 v4, v216, v217, v218
    v_max3_u32 v5, v219, v220, v221
    v_max3_u32 v4, v4, v222, v223
    v_smfmac_f32_16x16x64_bf16 v[76:79], v[204:207], a[216:223], v9
    v_max_u32 v4, v4, v5
    v_cmp_eq_u32 vcc, -1, v4
    v_smfmac_f32_16x16x64_bf16 v[80:83], v[204:207], a[248:255], v9
    s_cbranch_vccz .W_72
    s_branch .A_71
.A_188:
    buffer_load_dwordx4 v[216:219], v246, s[8:11], s32 offen offset:0 sc1
    buffer_load_dwordx4 v[220:223], v246, s[8:11], s32 offen offset:1024 sc1
    s_sub_u32 s62, s62, 1
    s_cbranch_scc1 .mg_end_1
    s_waitcnt vmcnt(4)
    v_max3_u32 v4, v192, v193, v194
    v_max3_u32 v5, v195, v196, v197
    v_max3_u32 v4, v4, v198, v199
    v_max_u32 v4, v4, v5
    v_cmp_eq_u32 vcc, -1, v4
    s_cbranch_vccz .W_189
.A_190:
    buffer_load_dwordx4 v[192:195], v243, s[8:11], s32 offen offset:0 sc1
    buffer_load_dwordx4 v[196:199], v243, s[8:11], s32 offen offset:1024 sc1
    s_waitcnt vmcnt(4)
    v_max3_u32 v4, v208, v209, v210
    v_max3_u32 v5, v211, v212, v213
    v_max3_u32 v4, v4, v214, v215
    v_max_u32 v4, v4, v5
    v_cmp_eq_u32 vcc, -1, v4
    s_cbranch_vccz .W_165
.A_164:
    buffer_load_dwordx4 v[208:211], v254, s[8:11], s32 offen offset:0 sc1
    buffer_load_dwordx4 v[212:215], v254, s[8:11], s32 offen offset:1024 sc1
    s_waitcnt vmcnt(4)
    v_max3_u32 v4, v216, v217, v218
    v_max3_u32 v5, v219, v220, v221
    v_max3_u32 v4, v4, v222, v223
    v_max_u32 v4, v4, v5
    v_cmp_eq_u32 vcc, -1, v4
    s_cbranch_vccnz .A_188
.W_191:
    v_smfmac_f32_16x16x64_bf16 v[76:79], v[216:219], v[140:147], v9
    v_smfmac_f32_16x16x64_bf16 v[80:83], v[216:219], v[172:179], v9
    s_waitcnt vmcnt(2)
    v_max3_u32 v4, v192, v193, v194
    v_max3_u32 v5, v195, v196, v197
    v_max3_u32 v4, v4, v198, v199
    v_smfmac_f32_16x16x64_bf16 v[76:79], v[220:223], v[148:155], v9
    v_max_u32 v4, v4, v5
    v_cmp_eq_u32 vcc, -1, v4
    v_smfmac_f32_16x16x64_bf16 v[80:83], v[220:223], v[180:187], v9
    s_cbranch_vccnz .A_192
.W_193:
    v_smfmac_f32_16x16x64_bf16 v[76:79], v[192:195], a[192:199], v9
    v_smfmac_f32_16x16x64_bf16 v[80:83], v[192:195], a[224:231], v9
    s_waitcnt vmcnt(0)
    v_max3_u32 v4, v208, v209, v210
    v_max3_u32 v5, v211, v212, v213
    v_max3_u32 v4, v4, v214, v215
    v_smfmac_f32_16x16x64_bf16 v[76:79], v[196:199], a[200:207], v9
    v_max_u32 v4, v4, v5
    v_cmp_eq_u32 vcc, -1, v4
    v_smfmac_f32_16x16x64_bf16 v[80:83], v[196:199], a[232:239], v9
    s_cbranch_vccz .W_163
    s_branch .A_162
.W_189:
    v_smfmac_f32_16x16x64_bf16 v[76:79], v[192:195], a[192:199], v9
    v_smfmac_f32_16x16x64_bf16 v[80:83], v[192:195], a[224:231], v9
    s_waitcnt vmcnt(2)
    v_max3_u32 v4, v208, v209, v210
    v_max3_u32 v5, v211, v212, v213
    v_max3_u32 v4, v4, v214, v215
    v_smfmac_f32_16x16x64_bf16 v[76:79], v[196:199], a[200:207], v9
    v_max_u32 v4, v4, v5
    v_cmp_eq_u32 vcc, -1, v4
    v_smfmac_f32_16x16x64_bf16 v[80:83], v[196:199], a[232:239], v9
    s_cbranch_vccz .W_70
    s_branch .A_69
.A_194:
    buffer_load_dwordx4 v[216:219], v246, s[8:11], s32 offen offset:0 sc1
    buffer_load_dwordx4 v[220:223], v246, s[8:11], s32 offen offset:1024 sc1
    s_sub_u32 s62, s62, 1
    s_cbranch_scc1 .mg_end_1
    s_waitcnt vmcnt(4)
    v_max3_u32 v4, v200, v201, v202
    v_max3_u32 v5, v203, v204, v205
    v_max3_u32 v4, v4, v206, v207
    v_max_u32 v4, v4, v5
    v_cmp_eq_u32 vcc, -1, v4
    s_cbranch_vccz .W_68
.A_67:
    buffer_load_dwordx4 v[200:203], v252, s[8:11], s32 offen offset:0 sc1
    buffer_load_dwordx4 v[204:207], v252, s[8:11], s32 offen offset:1024 sc1
    s_waitcnt vmcnt(4)
    v_max3_u32 v4, v208, v209, v210
    v_max3_u32 v5, v211, v212, v213
    v_max3_u32 v4, v4, v214, v215
    v_max_u32 v4, v4, v5
    v_cmp_eq_u32 vcc, -1, v4
    s_cbranch_vccz .W_195
.A_196:
    buffer_load_dwordx4 v[208:211], v254, s[8:11], s32 offen offset:0 sc1
    buffer_load_dwordx4 v[212:215], v254, s[8:11], s32 offen offset:1024 sc1
    s_waitcnt vmcnt(4)
    v_max3_u32 v4, v216, v217, v218
    v_max3_u32 v5, v219, v220, v221
    v_max3_u32 v4, v4, v222, v223
    v_max_u32 v4, v4, v5
    v_cmp_eq_u32 vcc, -1, v4
    s_cbranch_vccnz .A_194
.W_197:
    v_smfmac_f32_16x16x64_bf16 v[76:79], v[216:219], v[140:147], v9
    v_smfmac_f32_16x16x64_bf16 v[80:83], v[216:219], v[172:179], v9
    s_waitcnt vmcnt(2)
    v_max3_u32 v4, v200, v201, v202
    v_max3_u32 v5, v203, v204, v205
    v_max3_u32 v4, v4, v206, v207
    v_smfmac_f32_16x16x64_bf16 v[76:79], v[220:223], v[148:155], v9
    v_max_u32 v4, v4, v5
    v_cmp_eq_u32 vcc, -1, v4
    v_smfmac_f32_16x16x64_bf16 v[80:83], v[220:223], v[180:187], v9
    s_cbranch_vccz .W_161
    s_branch .A_160
.W_195:
    v_smfmac_f32_16x16x64_bf16 v[76:79], v[208:211], v[124:131], v9
    v_smfmac_f32_16x16x64_bf16 v[80:83], v[208:211], v[156:163], v9
    s_waitcnt vmcnt(2)
    v_max3_u32 v4, v216, v217, v218
    v_max3_u32 v5, v219, v220, v221
    v_max3_u32 v4, v4, v222, v223
    v_smfmac_f32_16x16x64_bf16 v[76:79], v[212:215], v[132:139], v9
    v_max_u32 v4, v4, v5
    v_cmp_eq_u32 vcc, -1, v4
    v_smfmac_f32_16x16x64_bf16 v[80:83], v[212:215], v[164:171], v9
    s_cbranch_vccnz .A_198
.W_199:
    v_smfmac_f32_16x16x64_bf16 v[76:79], v[216:219], v[140:147], v9
    v_smfmac_f32_16x16x64_bf16 v[80:83], v[216:219], v[172:179], v9
    s_waitcnt vmcnt(0)
    v_max3_u32 v4, v200, v201, v202
    v_max3_u32 v5, v203, v204, v205
    v_max3_u32 v4, v4, v206, v207
    v_smfmac_f32_16x16x64_bf16 v[76:79], v[220:223], v[148:155], v9
    v_max_u32 v4, v4, v5
    v_cmp_eq_u32 vcc, -1, v4
    v_smfmac_f32_16x16x64_bf16 v[80:83], v[220:223], v[180:187], v9
    s_cbranch_vccz .W_175
    s_branch .A_174
.A_200:
    buffer_load_dwordx4 v[200:203], v252, s[8:11], s32 offen offset:0 sc1
    buffer_load_dwordx4 v[204:207], v252, s[8:11], s32 offen offset:1024 sc1
    s_sub_u32 s62, s62, 1
    s_cbranch_scc1 .mg_end_1
    s_waitcnt vmcnt(2)
    v_max3_u32 v4, v192, v193, v194
    v_max3_u32 v5, v195, v196, v197
    v_max3_u32 v4, v4, v198, v199
    v_max_u32 v4, v4, v5
    v_cmp_eq_u32 vcc, -1, v4
    s_cbranch_vccz .W_173
.A_172:
    buffer_load_dwordx4 v[192:195], v243, s[8:11], s32 offen offset:0 sc1
    buffer_load_dwordx4 v[196:199], v243, s[8:11], s32 offen offset:1024 sc1
    s_waitcnt vmcnt(2)
    v_max3_u32 v4, v200, v201, v202
    v_max3_u32 v5, v203, v204, v205
    v_max3_u32 v4, v4, v206, v207
    v_max_u32 v4, v4, v5
    v_cmp_eq_u32 vcc, -1, v4
    s_cbranch_vccnz .A_200
.W_201:
    v_smfmac_f32_16x16x64_bf16 v[76:79], v[200:203], a[208:215], v9
    v_smfmac_f32_16x16x64_bf16 v[80:83], v[200:203], a[240:247], v9
    s_waitcnt vmcnt(0)
    v_max3_u32 v4, v192, v193, v194
    v_max3_u32 v5, v195, v196, v197
    v_max3_u32 v4, v4, v198, v199
    v_smfmac_f32_16x16x64_bf16 v[76:79], v[204:207], a[216:223], v9
    v_max_u32 v4, v4, v5
    v_cmp_eq_u32 vcc, -1, v4
    v_smfmac_f32_16x16x64_bf16 v[80:83], v[204:207], a[248:255], v9
    s_cbranch_vccz .W_169
    s_branch .A_168
.A_180:
    buffer_load_dwordx4 v[208:211], v254, s[8:11], s32 offen offset:0 sc1
    buffer_load_dwordx4 v[212:215], v254, s[8:11], s32 offen offset:1024 sc1
    s_sub_u32 s62, s62, 1
    s_cbranch_scc1 .mg_end_1
    s_waitcnt vmcnt(2)
    v_max3_u32 v4, v192, v193, v194
    v_max3_u32 v5, v195, v196, v197
    v_max3_u32 v4, v4, v198, v199
    v_max_u32 v4, v4, v5
    v_cmp_eq_u32 vcc, -1, v4
    s_cbranch_vccz .W_193
.A_192:
    buffer_load_dwordx4 v[192:195], v243, s[8:11], s32 offen offset:0 sc1
    buffer_load_dwordx4 v[196:199], v243, s[8:11], s32 offen offset:1024 sc1
    s_waitcnt vmcnt(2)
    v_max3_u32 v4, v208, v209, v210
    v_max3_u32 v5, v211, v212, v213
    v_max3_u32 v4, v4, v214, v215
    v_max_u32 v4, v4, v5
    v_cmp_eq_u32 vcc, -1, v4
    s_cbranch_vccnz .A_180
    s_branch .W_181
.A_202:
    buffer_load_dwordx4 v[192:195], v243, s[8:11], s32 offen offset:0 sc1
    buffer_load_dwordx4 v[196:199], v243, s[8:11], s32 offen offset:1024 sc1
    s_sub_u32 s62, s62, 1
    s_cbranch_scc1 .mg_end_1
    s_waitcnt vmcnt(2)
    v_max3_u32 v4, v216, v217, v218
    v_max3_u32 v5, v219, v220, v221
    v_max3_u32 v4, v4, v222, v223
    v_max_u32 v4, v4, v5
    v_cmp_eq_u32 vcc, -1, v4
    s_cbranch_vccz .W_167
.A_166:
    buffer_load_dwordx4 v[216:219], v246, s[8:11], s32 offen offset:0 sc1
    buffer_load_dwordx4 v[220:223], v246, s[8:11], s32 offen offset:1024 sc1
    s_waitcnt vmcnt(2)
    v_max3_u32 v4, v192, v193, v194
    v_max3_u32 v5, v195, v196, v197
    v_max3_u32 v4, v4, v198, v199
    v_max_u32 v4, v4, v5
    v_cmp_eq_u32 vcc, -1, v4
    s_cbranch_vccnz .A_202
.W_203:
    v_smfmac_f32_16x16x64_bf16 v[76:79], v[192:195], a[192:199], v9
    v_smfmac_f32_16x16x64_bf16 v[80:83], v[192:195], a[224:231], v9
    s_waitcnt vmcnt(0)
    v_max3_u32 v4, v216, v217, v218
    v_max3_u32 v5, v219, v220, v221
    v_max3_u32 v4, v4, v222, v223
    v_smfmac_f32_16x16x64_bf16 v[76:79], v[196:199], a[200:207], v9
    v_max_u32 v4, v4, v5
    v_cmp_eq_u32 vcc, -1, v4
    v_smfmac_f32_16x16x64_bf16 v[80:83], v[196:199], a[232:239], v9
    s_cbranch_vccz .W_72
    s_branch .A_71
.A_204:
    buffer_load_dwordx4 v[208:211], v254, s[8:11], s32 offen offset:0 sc1
    buffer_load_dwordx4 v[212:215], v254, s[8:11], s32 offen offset:1024 sc1
    s_sub_u32 s62, s62, 1
    s_cbranch_scc1 .mg_end_1
    s_waitcnt vmcnt(2)
    v_max3_u32 v4, v200, v201, v202
    v_max3_u32 v5, v203, v204, v205
    v_max3_u32 v4, v4, v206, v207
    v_max_u32 v4, v4, v5
    v_cmp_eq_u32 vcc, -1, v4
    s_cbranch_vccz .W_161
.A_160:
    buffer_load_dwordx4 v[200:203], v252, s[8:11], s32 offen offset:0 sc1
    buffer_load_dwordx4 v[204:207], v252, s[8:11], s32 offen offset:1024 sc1
    s_waitcnt vmcnt(2)
    v_max3_u32 v4, v208, v209, v210
    v_max3_u32 v5, v211, v212, v213
    v_max3_u32 v4, v4, v214, v215
    v_max_u32 v4, v4, v5
    v_cmp_eq_u32 vcc, -1, v4
    s_cbranch_vccnz .A_204
.W_205:
    v_smfmac_f32_16x16x64_bf16 v[76:79], v[208:211], v[124:131], v9
    v_smfmac_f32_16x16x64_bf16 v[80:83], v[208:211], v[156:163], v9
    s_waitcnt vmcnt(0)
    v_max3_u32 v4, v200, v201, v202
    v_max3_u32 v5, v203, v204, v205
    v_max3_u32 v4, v4, v206, v207
    v_smfmac_f32_16x16x64_bf16 v[76:79], v[212:215], v[132:139], v9
    v_max_u32 v4, v4, v5
    v_cmp_eq_u32 vcc, -1, v4
    v_smfmac_f32_16x16x64_bf16 v[80:83], v[212:215], v[164:171], v9
    s_cbranch_vccz .W_175
    s_branch .A_174
.A_198:
    buffer_load_dwordx4 v[216:219], v246, s[8:11], s32 offen offset:0 sc1
    buffer_load_dwordx4 v[220:223], v246, s[8:11], s32 offen offset:1024 sc1
    s_sub_u32 s62, s62, 1
    s_cbranch_scc1 .mg_end_1
    s_waitcnt vmcnt(2)
    v_max3_u32 v4, v200, v201, v202
    v_max3_u32 v5, v203, v204, v205
    v_max3_u32 v4, v4, v206, v207
    v_max_u32 v4, v4, v5
    v_cmp_eq_u32 vcc, -1, v4
    s_cbranch_vccz .W_187
.A_186:
    buffer_load_dwordx4 v[200:203], v252, s[8:11], s32 offen offset:0 sc1
    buffer_load_dwordx4 v[204:207], v252, s[8:11], s32 offen offset:1024 sc1
    s_waitcnt vmcnt(2)
    v_max3_u32 v4, v216, v217, v218
    v_max3_u32 v5, v219, v220, v221
    v_max3_u32 v4, v4, v222, v223
    v_max_u32 v4, v4, v5
    v_cmp_eq_u32 vcc, -1, v4
    s_cbranch_vccnz .A_198
    s_branch .W_199
.A_206:
    buffer_load_dwordx4 v[216:219], v246, s[8:11], s32 offen offset:0 sc1
    buffer_load_dwordx4 v[220:223], v246, s[8:11], s32 offen offset:1024 sc1
    s_sub_u32 s62, s62, 1
    s_cbranch_scc1 .mg_end_1
    s_waitcnt vmcnt(2)
    v_max3_u32 v4, v208, v209, v210
    v_max3_u32 v5, v211, v212, v213
    v_max3_u32 v4, v4, v214, v215
    v_max_u32 v4, v4, v5
    v_cmp_eq_u32 vcc, -1, v4
    s_cbranch_vccz .W_70
.A_69:
    buffer_load_dwordx4 v[208:211], v254, s[8:11], s32 offen offset:0 sc1
    buffer_load_dwordx4 v[212:215], v254, s[8:11], s32 offen offset:1024 sc1
    s_waitcnt vmcnt(2)
    v_max3_u32 v4, v216, v217, v218
    v_max3_u32 v5, v219, v220, v221
    v_max3_u32 v4, v4, v222, v223
    v_max_u32 v4, v4, v5
    v_cmp_eq_u32 vcc, -1, v4
    s_cbranch_vccnz .A_206
.W_207:
    v_smfmac_f32_16x16x64_bf16 v[76:79], v[216:219], v[140:147], v9
    v_smfmac_f32_16x16x64_bf16 v[80:83], v[216:219], v[172:179], v9
    s_waitcnt vmcnt(0)
    v_max3_u32 v4, v208, v209, v210
    v_max3_u32 v5, v211, v212, v213
    v_max3_u32 v4, v4, v214, v215
    v_smfmac_f32_16x16x64_bf16 v[76:79], v[220:223], v[148:155], v9
    v_max_u32 v4, v4, v5
    v_cmp_eq_u32 vcc, -1, v4
    v_smfmac_f32_16x16x64_bf16 v[80:83], v[220:223], v[180:187], v9
    s_cbranch_vccz .W_163
    s_branch .A_162
.A_168:
    buffer_load_dwordx4 v[192:195], v243, s[8:11], s32 offen offset:0 sc1
    buffer_load_dwordx4 v[196:199], v243, s[8:11], s32 offen offset:1024 sc1
    s_sub_u32 s62, s62, 1
    s_cbranch_scc1 .mg_end_1
    s_waitcnt vmcnt(2)
    v_max3_u32 v4, v192, v193, v194
    v_max3_u32 v5, v195, v196, v197
    v_max3_u32 v4, v4, v198, v199
    v_max_u32 v4, v4, v5
    v_cmp_eq_u32 vcc, -1, v4
    s_cbranch_vccnz .A_168
    v_smfmac_f32_16x16x64_bf16 v[76:79], v[192:195], a[192:199], v9
    v_smfmac_f32_16x16x64_bf16 v[80:83], v[192:195], a[224:231], v9
    v_smfmac_f32_16x16x64_bf16 v[76:79], v[196:199], a[200:207], v9
    v_smfmac_f32_16x16x64_bf16 v[80:83], v[196:199], a[232:239], v9
    s_branch .mj_64
.A_174:
    buffer_load_dwordx4 v[200:203], v252, s[8:11], s32 offen offset:0 sc1
    buffer_load_dwordx4 v[204:207], v252, s[8:11], s32 offen offset:1024 sc1
    s_sub_u32 s62, s62, 1
    s_cbranch_scc1 .mg_end_1
    s_waitcnt vmcnt(2)
    v_max3_u32 v4, v200, v201, v202
    v_max3_u32 v5, v203, v204, v205
    v_max3_u32 v4, v4, v206, v207
    v_max_u32 v4, v4, v5
    v_cmp_eq_u32 vcc, -1, v4
    s_cbranch_vccnz .A_174
    v_smfmac_f32_16x16x64_bf16 v[76:79], v[200:203], a[208:215], v9
    v_smfmac_f32_16x16x64_bf16 v[80:83], v[200:203], a[240:247], v9
    v_smfmac_f32_16x16x64_bf16 v[76:79], v[204:207], a[216:223], v9
    v_smfmac_f32_16x16x64_bf16 v[80:83], v[204:207], a[248:255], v9
    s_branch .mj_64
.A_162:
    buffer_load_dwordx4 v[208:211], v254, s[8:11], s32 offen offset:0 sc1
    buffer_load_dwordx4 v[212:215], v254, s[8:11], s32 offen offset:1024 sc1
    s_sub_u32 s62, s62, 1
    s_cbranch_scc1 .mg_end_1
    s_waitcnt vmcnt(2)
    v_max3_u32 v4, v208, v209, v210
    v_max3_u32 v5, v211, v212, v213
    v_max3_u32 v4, v4, v214, v215
    v_max_u32 v4, v4, v5
    v_cmp_eq_u32 vcc, -1, v4
    s_cbranch_vccnz .A_162
    v_smfmac_f32_16x16x64_bf16 v[76:79], v[208:211], v[124:131], v9
    v_smfmac_f32_16x16x64_bf16 v[80:83], v[208:211], v[156:163], v9
    v_smfmac_f32_16x16x64_bf16 v[76:79], v[212:215], v[132:139], v9
    v_smfmac_f32_16x16x64_bf16 v[80:83], v[212:215], v[164:171], v9
    s_branch .mj_64
.A_71:
    buffer_load_dwordx4 v[216:219], v246, s[8:11], s32 offen offset:0 sc1
    buffer_load_dwordx4 v[220:223], v246, s[8:11], s32 offen offset:1024 sc1
    s_sub_u32 s62, s62, 1
    s_cbranch_scc1 .mg_end_1
    s_waitcnt vmcnt(2)
    v_max3_u32 v4, v216, v217, v218
    v_max3_u32 v5, v219, v220, v221
    v_max3_u32 v4, v4, v222, v223
    v_max_u32 v4, v4, v5
    v_cmp_eq_u32 vcc, -1, v4
    s_cbranch_vccnz .A_71
    v_smfmac_f32_16x16x64_bf16 v[76:79], v[216:219], v[140:147], v9
    v_smfmac_f32_16x16x64_bf16 v[80:83], v[216:219], v[172:179], v9
    v_smfmac_f32_16x16x64_bf16 v[76:79], v[220:223], v[148:155], v9
    v_smfmac_f32_16x16x64_bf16 v[80:83], v[220:223], v[180:187], v9
    s_branch .mj_64
.sk_74:
    s_mov_b64 exec, s[66:67]
    buffer_store_dwordx4 v[88:91], v11, s[8:11], s36 offen sc1
    s_mov_b64 exec, s[56:57]
    buffer_store_dwordx4 v[172:175], v12, s[8:11], s36 offen sc1
    s_mov_b64 exec, -1

    s_cmp_lt_u32 s28, 63
    s_cbranch_scc1 .sb_75
    s_branch .rec_fin_6
.p2align 6
.top_208:
    s_barrier
    buffer_load_dwordx4 v[20:23], v8, s[8:11], s29 offen offset:0 sc1
    v_mov_b32 v52, 0
    buffer_load_dwordx4 v[24:27], v8, s[8:11], s29 offen offset:1024 sc1
    v_mov_b32 v53, 0
    buffer_load_dwordx4 v[28:31], v8, s[8:11], s29 offen offset:2048 sc1
    v_mov_b32 v54, 0
    buffer_load_dwordx4 v[32:35], v8, s[8:11], s29 offen offset:3072 sc1
.ent1_26:
    s_waitcnt vmcnt(3)
    v_max3_u32 v4, v20, v21, v22
    v_max_u32 v4, v4, v23
    v_cmp_eq_u32 vcc, -1, v4
    s_cbranch_vccnz .A_213
.W_214:
    v_smfmac_f32_16x16x64_bf16 v[52:55], v[20:23], a[0:7], v9
    v_smfmac_f32_16x16x64_bf16 v[56:59], v[20:23], a[32:39], v9
    s_waitcnt vmcnt(2)
    v_max3_u32 v4, v24, v25, v26
    v_max_u32 v4, v4, v27
    v_smfmac_f32_16x16x64_bf16 v[60:63], v[20:23], a[64:71], v9
    v_cmp_eq_u32 vcc, -1, v4
    v_smfmac_f32_16x16x64_bf16 v[64:67], v[20:23], a[96:103], v9
    s_cbranch_vccnz .A_215
.W_216:
    v_smfmac_f32_16x16x64_bf16 v[52:55], v[24:27], a[8:15], v9
    v_smfmac_f32_16x16x64_bf16 v[56:59], v[24:27], a[40:47], v9
    s_waitcnt vmcnt(1)
    v_max3_u32 v4, v28, v29, v30
    v_max_u32 v4, v4, v31
    v_smfmac_f32_16x16x64_bf16 v[60:63], v[24:27], a[72:79], v9
    v_cmp_eq_u32 vcc, -1, v4
    v_smfmac_f32_16x16x64_bf16 v[64:67], v[24:27], a[104:111], v9
    s_cbranch_vccnz .A_217
.W_218:
    v_smfmac_f32_16x16x64_bf16 v[52:55], v[28:31], a[16:23], v9
    v_smfmac_f32_16x16x64_bf16 v[56:59], v[28:31], a[48:55], v9
    s_waitcnt vmcnt(0)
    v_max3_u32 v4, v32, v33, v34
    v_max_u32 v4, v4, v35
    v_smfmac_f32_16x16x64_bf16 v[60:63], v[28:31], a[80:87], v9
    v_cmp_eq_u32 vcc, -1, v4
    v_smfmac_f32_16x16x64_bf16 v[64:67], v[28:31], a[112:119], v9
    s_cbranch_vccnz .A_219
.W_220:
    v_smfmac_f32_16x16x64_bf16 v[52:55], v[32:35], a[24:31], v9
    v_smfmac_f32_16x16x64_bf16 v[56:59], v[32:35], a[56:63], v9
    v_smfmac_f32_16x16x64_bf16 v[60:63], v[32:35], a[88:95], v9
    v_smfmac_f32_16x16x64_bf16 v[64:67], v[32:35], a[120:127], v9
.mj_212:
    v_cvt_pk_bf16_f32 v104, v52, v53
    v_cvt_pk_bf16_f32 v105, v54, v55
    v_cvt_pk_bf16_f32 v106, v56, v57
    v_cvt_pk_bf16_f32 v107, v58, v59
    ds_write_b64 v16, v[104:105] offset:4096
    v_cvt_pk_bf16_f32 v108, v60, v61
    v_cvt_pk_bf16_f32 v109, v62, v63
    ds_write_b64 v16, v[106:107] offset:6144
    ds_write_b64 v16, v[108:109] offset:0
    v_cvt_pk_bf16_f32 v110, v64, v65
    v_cvt_pk_bf16_f32 v111, v66, v67
    ds_write_b64 v16, v[110:111] offset:2048
    v_smfmac_f32_16x16x64_bf16 v[68:71], v[20:23], a[128:135], v9
    v_smfmac_f32_16x16x64_bf16 v[72:75], v[20:23], a[160:167], v9
    s_waitcnt lgkmcnt(0)
    s_barrier
    ds_read_b128 v[36:39], v17 offset:0
    ds_read_b128 v[40:43], v17 offset:1024
    v_smfmac_f32_16x16x64_bf16 v[68:71], v[24:27], a[136:143], v9
    v_smfmac_f32_16x16x64_bf16 v[72:75], v[24:27], a[168:175], v9
    s_waitcnt lgkmcnt(1)
    v_mfma_f32_16x16x32_bf16 v[44:47], v[36:39], v[84:87], 0
    s_waitcnt lgkmcnt(0)
    v_mfma_f32_16x16x32_bf16 v[44:47], v[40:43], v[84:87], v[44:47]
    v_smfmac_f32_16x16x64_bf16 v[68:71], v[28:31], a[144:151], v9
    v_smfmac_f32_16x16x64_bf16 v[72:75], v[28:31], a[176:183], v9
    s_mov_b64 exec, s[64:65]
    v_cvt_pk_bf16_f32 v48, v44, v45
    v_cvt_pk_bf16_f32 v49, v46, v47
    v_min_u32 v48, 0xfffffffe, v48
    v_min_u32 v49, 0xfffffffe, v49
    buffer_store_dwordx2 v[48:49], v10, s[8:11], s29 offen sc1

    ds_write_b64 v18, v[48:49]
    s_mov_b64 exec, -1

    v_smfmac_f32_16x16x64_bf16 v[68:71], v[32:35], a[152:159], v9
    v_smfmac_f32_16x16x64_bf16 v[72:75], v[32:35], a[184:191], v9
    s_nop 3
    v_cvt_pk_bf16_f32 v104, v68, v69
    v_cvt_pk_bf16_f32 v105, v70, v71
    ds_write_b64 v16, v[104:105] offset:8192
    s_nop 0
    v_cvt_pk_bf16_f32 v106, v72, v73
    v_cvt_pk_bf16_f32 v107, v74, v75
    ds_write_b64 v16, v[106:107] offset:10240
    s_cmp_lg_u32 s24, 2
    s_waitcnt lgkmcnt(0)
    s_barrier
    s_cbranch_scc1 .oth_209
    buffer_load_dwordx4 v[92:95], v232, s[8:11], s29 offen sc1
    buffer_load_dwordx4 v[96:99], v233, s[8:11], s29 offen sc1
    buffer_load_dwordx4 v[100:103], v234, s[8:11], s29 offen sc1
    ds_read_b128 v[88:91], v14 offset:16384
    s_cmp_eq_u32 s28, 63
    s_cbranch_scc1 .rec_fin_6
.en_33:
    s_waitcnt lgkmcnt(0)
    v_mfma_f32_16x16x32_bf16 v[208:211], v[128:131], v[88:91], 0
    v_mfma_f32_16x16x32_bf16 v[212:215], v[144:147], v[88:91], 0
    v_mfma_f32_16x16x32_bf16 v[216:219], v[88:91], v[88:91], v[116:119]
    s_waitcnt vmcnt(2)
    v_max3_u32 v4, v92, v93, v94
    v_max_u32 v4, v4, v95
    v_cmp_eq_u32 vcc, -1, v4
    s_cbranch_vccnz .A_222
.W_223:
    v_mfma_f32_16x16x32_bf16 v[208:211], v[132:135], v[92:95], v[208:211]
    s_waitcnt vmcnt(1)
    v_max3_u32 v4, v96, v97, v98
    v_max_u32 v4, v4, v99
    v_mfma_f32_16x16x32_bf16 v[212:215], v[148:151], v[92:95], v[212:215]
    v_cmp_eq_u32 vcc, -1, v4
    v_mfma_f32_16x16x32_bf16 v[216:219], v[92:95], v[92:95], v[216:219]
    s_cbranch_vccnz .A_224
.W_225:
    v_mfma_f32_16x16x32_bf16 v[208:211], v[136:139], v[96:99], v[208:211]
    s_waitcnt vmcnt(0)
    v_max3_u32 v4, v100, v101, v102
    v_max_u32 v4, v4, v103
    v_mfma_f32_16x16x32_bf16 v[212:215], v[152:155], v[96:99], v[212:215]
    v_cmp_eq_u32 vcc, -1, v4
    v_mfma_f32_16x16x32_bf16 v[216:219], v[96:99], v[96:99], v[216:219]
    s_cbranch_vccnz .A_226
.W_227:
    v_mfma_f32_16x16x32_bf16 v[208:211], v[140:143], v[100:103], v[208:211]
    v_mfma_f32_16x16x32_bf16 v[212:215], v[156:159], v[100:103], v[212:215]
    v_mfma_f32_16x16x32_bf16 v[216:219], v[100:103], v[100:103], v[216:219]
.mj_221:
    s_barrier
    ds_read_b64 v[168:169], v14 offset:18432
    ds_read_b64 v[172:173], v14 offset:18440
    s_nop 0

    v_mov_b32_dpp v208, v212 row_ror:8 row_mask:0xf bank_mask:0xc
    v_mov_b32_dpp v209, v213 row_ror:8 row_mask:0xf bank_mask:0xc
    v_mov_b32_dpp v210, v214 row_ror:8 row_mask:0xf bank_mask:0xc
    v_mov_b32_dpp v211, v215 row_ror:8 row_mask:0xf bank_mask:0xc
    v_mov_b32_dpp v216, v218 row_ror:8 row_mask:0xf bank_mask:0xc
    v_mov_b32_dpp v217, v219 row_ror:8 row_mask:0xf bank_mask:0xc
    v_max3_f32 v4, v208, v209, v210
    v_max3_f32 v5, v211, v216, v217
    v_max_f32 v6, v4, v5
    v_max_f32 v4, v4, v5
    s_nop 1
    v_permlane32_swap_b32 v4, v6
    v_max_f32 v5, v4, v6
    v_max_f32 v4, v4, v6
    s_nop 1
    v_permlane16_swap_b32 v4, v5
    v_max_f32 v4, v4, v5
    s_nop 1
    v_max_f32_dpp v4, v4, v4 row_ror:8 row_mask:0xf bank_mask:0xf
    v_mul_f32 v4, s37, v4

    v_fma_f32 v104, v208, s37, -v4
    v_fma_f32 v105, v209, s37, -v4
    v_fma_f32 v106, v210, s37, -v4
    v_fma_f32 v107, v211, s37, -v4
    v_fma_f32 v108, v216, s37, -v4
    v_fma_f32 v109, v217, s37, -v4
    v_exp_f32 v104, v104
    v_exp_f32 v105, v105
    v_exp_f32 v106, v106
    v_exp_f32 v107, v107
    v_exp_f32 v108, v108
    v_exp_f32 v109, v109
    v_cvt_pk_bf16_f32 v176, v104, v105
    v_cvt_pk_bf16_f32 v177, v106, v107
    v_cvt_pk_bf16_f32 v180, v108, v109
    v_mov_b32_dpp v178, v176 row_ror:8 row_mask:0xf bank_mask:0xf
    v_mov_b32_dpp v179, v177 row_ror:8 row_mask:0xf bank_mask:0xf
    v_mov_b32_dpp v181, v180 row_ror:8 row_mask:0xf bank_mask:0xf
    s_waitcnt lgkmcnt(0)

    v_mfma_f32_16x16x32_bf16 v[208:211], v[120:123], v[176:179], 0
    v_mfma_f32_16x16x32_bf16 v[208:211], v[120:123], v[180:183], v[208:211]
    v_mfma_f32_16x16x32_bf16 v[212:215], v[160:163], v[176:179], 0
    v_mfma_f32_16x16x32_bf16 v[216:219], v[164:167], v[176:179], 0
    v_mfma_f32_16x16x32_bf16 v[212:215], v[168:171], v[180:183], v[212:215]
    v_rcp_f32 v4, v208
    v_mfma_f32_16x16x32_bf16 v[216:219], v[172:175], v[180:183], v[216:219]
    s_mov_b64 exec, s[58:59]
    s_nop 2
    v_mul_f32 v212, v4, v212
    v_mul_f32 v213, v4, v213
    v_mul_f32 v214, v4, v214
    v_mul_f32 v215, v4, v215
    v_cvt_pk_bf16_f32 v184, v212, v213
    v_cvt_pk_bf16_f32 v185, v214, v215
    v_mul_f32 v216, v4, v216
    v_mul_f32 v217, v4, v217
    v_min_u32 v184, 0xfffffffe, v184
    v_min_u32 v185, 0xfffffffe, v185
    v_mul_f32 v218, v4, v218
    v_mul_f32 v219, v4, v219
    v_cvt_pk_bf16_f32 v186, v216, v217
    v_cvt_pk_bf16_f32 v187, v218, v219
    v_min_u32 v186, 0xfffffffe, v186
    v_min_u32 v187, 0xfffffffe, v187
    buffer_store_dwordx4 v[184:187], v13, s[8:11], s29 offen sc1
    s_mov_b64 exec, -1

.gp_211:
    s_barrier
    v_mov_b32 v5, 19968
    ds_read_b32 v4, v5
    s_mov_b32 s99, s68
    s_waitcnt vmcnt(0)
    s_cmp_eq_u32 s24, 3
    s_cbranch_scc1 .u3_228
    s_add_u32 s6, s28, 3
    s_add_u32 s7, s30, 262144
    s_waitcnt lgkmcnt(0)
    v_readfirstlane_b32 s5, v4
    s_cmp_lt_u32 s5, s6
    s_barrier
    s_cbranch_scc1 .np_230
    buffer_load_dword v226, v225, s[8:11], s7 offen

.np_230:
    s_add_u32 s4, s70, 0
    buffer_store_dwordx4 v[188:191], v238, s[8:11], s4 offen sc1
    s_add_u32 s4, s70, 262144
    buffer_store_dwordx4 v[188:191], v238, s[8:11], s4 offen sc1
    s_branch .u4_229
.u3_228:
    s_sub_u32 s4, s36, 0
    s_barrier
    s_mov_b64 exec, s[66:67]
    buffer_store_dwordx4 v[88:91], v11, s[8:11], s4 offen sc1
    s_mov_b64 exec, s[56:57]
    buffer_store_dwordx4 v[172:175], v12, s[8:11], s4 offen sc1
    s_mov_b64 exec, -1

.u4_229:
    s_barrier
    s_add_u32 s28, s28, 1
    s_add_u32 s36, s36, 196608
    s_cmp_lt_u32 s28, 63
    s_cselect_b32 s4, 262144, 0
    s_add_u32 s38, s38, s4
    s_add_u32 s39, s39, s4
    s_add_u32 s30, s30, s4
    s_mov_b32 s4, s68
    s_mov_b32 s68, s69
    s_mov_b32 s69, s70
    s_mov_b32 s70, s71
    s_mov_b32 s71, s4
    s_and_b32 s4, s28, 3
    s_lshl_b32 s5, s4, 17
    s_add_u32 s29, s5, s34
    s_xor_b32 s6, s5, 262144
    s_add_u32 s31, s6, s34
    s_add_u32 s32, s29, 20480
    s_add_u32 s33, s29, 24576
    v_mov_b32 v55, 0
    v_mov_b32 v56, 0
    v_mov_b32 v57, 0
    v_mov_b32 v58, 0
    v_mov_b32 v59, 0
    v_mov_b32 v60, 0
    v_mov_b32 v61, 0
    v_mov_b32 v62, 0
    v_mov_b32 v63, 0
    v_mov_b32 v64, 0
    v_mov_b32 v65, 0
    v_mov_b32 v66, 0
    v_mov_b32 v67, 0
    v_mov_b32 v68, 0
    v_mov_b32 v69, 0
    v_mov_b32 v70, 0
    v_mov_b32 v71, 0
    v_mov_b32 v72, 0
    v_mov_b32 v73, 0
    v_mov_b32 v74, 0
    v_mov_b32 v75, 0
    v_mov_b32 v20, -1
    v_mov_b32 v21, -1
    v_mov_b32 v22, -1
    v_mov_b32 v23, -1
    v_mov_b32 v24, -1
    v_mov_b32 v25, -1
    v_mov_b32 v26, -1
    v_mov_b32 v27, -1
    v_mov_b32 v28, -1
    v_mov_b32 v29, -1
    v_mov_b32 v30, -1
    v_mov_b32 v31, -1
    v_mov_b32 v32, -1
    v_mov_b32 v33, -1
    v_mov_b32 v34, -1
    v_mov_b32 v35, -1
    v_mov_b32 v92, -1
    v_mov_b32 v93, -1
    v_mov_b32 v94, -1
    v_mov_b32 v95, -1
    v_mov_b32 v96, -1
    v_mov_b32 v97, -1
    v_mov_b32 v98, -1
    v_mov_b32 v99, -1
    v_mov_b32 v100, -1
    v_mov_b32 v101, -1
    v_mov_b32 v102, -1
    v_mov_b32 v103, -1
    s_add_u32 s4, s99, 0
    buffer_load_dwordx4 v[192:195], v239, s[8:11], s4 offen sc1
    buffer_load_dwordx4 v[196:199], v249, s[8:11], s4 offen sc1

    ds_read_b128 v[128:131], v228 offset:0
    ds_read_b128 v[144:147], v228 offset:4096
    ds_read_b128 v[132:135], v229 offset:0
    ds_read_b128 v[148:151], v229 offset:4096
    ds_read_b128 v[136:139], v230 offset:0
    ds_read_b128 v[152:155], v230 offset:4096
    ds_read_b128 v[140:143], v231 offset:0
    ds_read_b128 v[156:159], v231 offset:4096
    ds_read_b128 v[160:163], v14 offset:28672
    ds_read_b128 v[164:167], v14 offset:29696
    ds_read_b128 v[108:111], v248
    s_waitcnt lgkmcnt(0)
    v_mfma_f32_16x16x32_bf16 v[76:79], v[108:111], v[112:115], 0
    s_add_u32 s4, s99, 262144
    buffer_load_dwordx4 v[200:203], v239, s[8:11], s4 offen sc1
    buffer_load_dwordx4 v[204:207], v249, s[8:11], s4 offen sc1

.gc_231:
    s_waitcnt vmcnt(2)

    v_max_u32 v4, v192, v196
    v_cmp_eq_u32 vcc, -1, v4
    s_cbranch_vccnz .gf_232
    v_mfma_f32_16x16x32_bf16 v[76:79], v[192:195], v[84:87], v[76:79]
    v_mfma_f32_16x16x32_bf16 v[76:79], v[196:199], v[112:115], v[76:79]
    s_mov_b64 exec, s[58:59]
    s_nop 6
    v_cvt_pk_bf16_f32 v104, v76, v77
    v_cvt_pk_bf16_f32 v105, v78, v79
    v_min_u32 v104, 0xfffffffe, v104
    v_min_u32 v105, 0xfffffffe, v105
    buffer_store_dwordx2 v[104:105], v15, s[8:11], s29 offen sc1
    s_mov_b64 exec, -1

    s_branch .top_208
.gf_232:
    s_add_u32 s4, s99, 0
    buffer_load_dwordx4 v[192:195], v239, s[8:11], s4 offen sc1
    buffer_load_dwordx4 v[196:199], v249, s[8:11], s4 offen sc1

    s_waitcnt vmcnt(2)

    v_max_u32 v4, v200, v204
    v_cmp_eq_u32 vcc, -1, v4
    s_cbranch_vccnz .gf_233
    v_mfma_f32_16x16x32_bf16 v[76:79], v[200:203], v[84:87], v[76:79]
    v_mfma_f32_16x16x32_bf16 v[76:79], v[204:207], v[112:115], v[76:79]
    s_mov_b64 exec, s[58:59]
    s_nop 6
    v_cvt_pk_bf16_f32 v104, v76, v77
    v_cvt_pk_bf16_f32 v105, v78, v79
    v_min_u32 v104, 0xfffffffe, v104
    v_min_u32 v105, 0xfffffffe, v105
    buffer_store_dwordx2 v[104:105], v15, s[8:11], s29 offen sc1
    s_mov_b64 exec, -1

    s_branch .top_208
.gf_233:
    s_add_u32 s4, s99, 262144
    buffer_load_dwordx4 v[200:203], v239, s[8:11], s4 offen sc1
    buffer_load_dwordx4 v[204:207], v249, s[8:11], s4 offen sc1

    s_sub_u32 s62, s62, 1
    s_cbranch_scc1 .mg_end_1
    s_branch .gc_231
.oth_209:
    s_cmp_eq_u32 s24, 3
    s_cbranch_scc1 .w3_210
    s_cmp_eq_u32 s28, 63
    s_cbranch_scc1 .rec_fin_6
    s_min_u32 s4, s14, s15
    s_max_u32 s93, s93, s4
    v_mov_b32 v4, s93
    v_mov_b32 v5, 19968
    ds_write_b32 v5, v4
    s_waitcnt vmcnt(0)
    v_mov_b32 v71, 0
    v_mov_b32 v72, 0
    v_mov_b32 v73, 0
    v_mov_b32 v74, 0
    v_mov_b32 v75, 0
    s_barrier
.en_29:
    s_add_u32 s6, s28, 2
    s_min_u32 s6, s6, 64
    s_cmp_lt_u32 s93, s6
    s_cbranch_scc1 .kf_234
.kb_235:
    s_mov_b32 m0, s90
    s_nop 0
    buffer_load_dwordx4 v14, s[8:11], s38 offen offset:0 lds
    buffer_load_dwordx4 v14, s[8:11], s38 offen offset:1024 lds
    buffer_load_dwordx4 v14, s[8:11], s38 offen offset:2048 lds
    buffer_load_dwordx4 v14, s[8:11], s38 offen offset:3072 lds
    s_mov_b32 m0, s91
    s_nop 0
    buffer_load_dwordx4 v14, s[8:11], s39 offen lds
    s_waitcnt lgkmcnt(0)
    s_barrier
    v_mov_b32 v20, -1
    v_mov_b32 v21, -1
    v_mov_b32 v22, -1
    v_mov_b32 v23, -1
    v_mov_b32 v24, -1
    v_mov_b32 v25, -1
    v_mov_b32 v26, -1
    v_mov_b32 v27, -1
    v_mov_b32 v28, -1
    v_mov_b32 v29, -1
    v_mov_b32 v30, -1
    v_mov_b32 v31, -1
    v_mov_b32 v32, -1
    v_mov_b32 v33, -1
    v_mov_b32 v34, -1
    v_mov_b32 v35, -1
    v_mov_b32 v55, 0
    v_mov_b32 v56, 0
    v_mov_b32 v57, 0
    v_mov_b32 v58, 0
    v_mov_b32 v59, 0
    v_mov_b32 v60, 0
    v_mov_b32 v61, 0
    v_mov_b32 v62, 0
    v_mov_b32 v63, 0
    v_mov_b32 v64, 0
    v_mov_b32 v65, 0
    v_mov_b32 v66, 0
    v_mov_b32 v67, 0
    v_mov_b32 v68, 0
    v_mov_b32 v69, 0
    v_mov_b32 v70, 0
    buffer_load_dwordx4 v[192:195], v243, s[8:11], s32 offen offset:0 sc1
    buffer_load_dwordx4 v[196:199], v243, s[8:11], s32 offen offset:1024 sc1
    v_mov_b32 v76, 0
    buffer_load_dwordx4 v[200:203], v252, s[8:11], s32 offen offset:0 sc1
    buffer_load_dwordx4 v[204:207], v252, s[8:11], s32 offen offset:1024 sc1
    v_mov_b32 v77, 0
    buffer_load_dwordx4 v[208:211], v254, s[8:11], s32 offen offset:0 sc1
    buffer_load_dwordx4 v[212:215], v254, s[8:11], s32 offen offset:1024 sc1
    v_mov_b32 v78, 0
    buffer_load_dwordx4 v[216:219], v246, s[8:11], s32 offen offset:0 sc1
    buffer_load_dwordx4 v[220:223], v246, s[8:11], s32 offen offset:1024 sc1
    s_waitcnt vmcnt(6)
    v_max3_u32 v4, v192, v193, v194
    v_max3_u32 v5, v195, v196, v197
    v_max3_u32 v4, v4, v198, v199
    v_max_u32 v4, v4, v5
    v_cmp_eq_u32 vcc, -1, v4
    s_cbranch_vccnz .A_237
.W_238:
    v_smfmac_f32_16x16x64_bf16 v[76:79], v[192:195], a[192:199], v9
    v_smfmac_f32_16x16x64_bf16 v[80:83], v[192:195], a[224:231], v9
    s_waitcnt vmcnt(4)
    v_max3_u32 v4, v200, v201, v202
    v_max3_u32 v5, v203, v204, v205
    v_max3_u32 v4, v4, v206, v207
    v_smfmac_f32_16x16x64_bf16 v[76:79], v[196:199], a[200:207], v9
    v_max_u32 v4, v4, v5
    v_cmp_eq_u32 vcc, -1, v4
    v_smfmac_f32_16x16x64_bf16 v[80:83], v[196:199], a[232:239], v9
    s_cbranch_vccnz .A_239
.W_240:
    v_smfmac_f32_16x16x64_bf16 v[76:79], v[200:203], a[208:215], v9
    v_smfmac_f32_16x16x64_bf16 v[80:83], v[200:203], a[240:247], v9
    s_waitcnt vmcnt(2)
    v_max3_u32 v4, v208, v209, v210
    v_max3_u32 v5, v211, v212, v213
    v_max3_u32 v4, v4, v214, v215
    v_smfmac_f32_16x16x64_bf16 v[76:79], v[204:207], a[216:223], v9
    v_max_u32 v4, v4, v5
    v_cmp_eq_u32 vcc, -1, v4
    v_smfmac_f32_16x16x64_bf16 v[80:83], v[204:207], a[248:255], v9
    s_cbranch_vccnz .A_241
.W_242:
    v_smfmac_f32_16x16x64_bf16 v[76:79], v[208:211], v[124:131], v9
    v_smfmac_f32_16x16x64_bf16 v[80:83], v[208:211], v[156:163], v9
    s_waitcnt vmcnt(0)
    v_max3_u32 v4, v216, v217, v218
    v_max3_u32 v5, v219, v220, v221
    v_max3_u32 v4, v4, v222, v223
    v_smfmac_f32_16x16x64_bf16 v[76:79], v[212:215], v[132:139], v9
    v_max_u32 v4, v4, v5
    v_cmp_eq_u32 vcc, -1, v4
    v_smfmac_f32_16x16x64_bf16 v[80:83], v[212:215], v[164:171], v9
    s_cbranch_vccnz .A_243
.W_244:
    v_smfmac_f32_16x16x64_bf16 v[76:79], v[216:219], v[140:147], v9
    v_smfmac_f32_16x16x64_bf16 v[80:83], v[216:219], v[172:179], v9
    v_smfmac_f32_16x16x64_bf16 v[76:79], v[220:223], v[148:155], v9
    v_smfmac_f32_16x16x64_bf16 v[80:83], v[220:223], v[180:187], v9
.mj_236:
    s_barrier
    s_nop 7
    v_permlane32_swap_b32 v76, v80
    v_permlane32_swap_b32 v77, v81
    v_permlane32_swap_b32 v78, v82
    v_permlane32_swap_b32 v79, v83
    v_add_f32 v76, v76, v80
    v_add_f32 v77, v77, v81
    v_add_f32 v78, v78, v82
    v_add_f32 v79, v79, v83
    v_cvt_pk_bf16_f32 v104, v76, v77
    v_cvt_pk_bf16_f32 v106, v76, v77
    v_cvt_pk_bf16_f32 v105, v78, v79
    v_cvt_pk_bf16_f32 v107, v78, v79
    v_permlane16_swap_b32 v104, v106
    s_nop 0
    v_permlane16_swap_b32 v105, v107
    v_min_u32 v104, 0xfffffffe, v104
    buffer_store_dwordx4 v[104:107], v237, s[8:11], s68 offen sc1

    ds_write_b128 v247, v[104:107]
    s_waitcnt lgkmcnt(0)
    s_barrier
    v_mov_b32 v79, 0
    v_mov_b32 v80, 0
    v_mov_b32 v81, 0
    v_mov_b32 v82, 0
    v_mov_b32 v83, 0
    s_waitcnt vmcnt(1)
    v_mov_b32 v192, -1
    v_mov_b32 v193, -1
    v_mov_b32 v194, -1
    v_mov_b32 v195, -1
    v_mov_b32 v196, -1
    v_mov_b32 v197, -1
    v_mov_b32 v198, -1
    v_mov_b32 v199, -1
    v_mov_b32 v200, -1
    v_mov_b32 v201, -1
    v_mov_b32 v202, -1
    v_mov_b32 v203, -1
    v_mov_b32 v204, -1
    v_mov_b32 v205, -1
    v_mov_b32 v206, -1
    v_mov_b32 v207, -1
    v_mov_b32 v208, -1
    v_mov_b32 v209, -1
    v_mov_b32 v210, -1
    v_mov_b32 v211, -1
    v_mov_b32 v212, -1
    v_mov_b32 v213, -1
    v_mov_b32 v214, -1
    v_mov_b32 v215, -1
    v_mov_b32 v216, -1
    v_mov_b32 v217, -1
    v_mov_b32 v218, -1
    v_mov_b32 v219, -1
    v_mov_b32 v220, -1
    v_mov_b32 v221, -1
    v_mov_b32 v222, -1
    v_mov_b32 v223, -1
    s_add_u32 s6, s28, 4
    s_cmp_ge_u32 s93, s6
    s_cbranch_scc1 .nl_245
    s_buffer_load_dword s14, s[8:11], s89 glc
    s_buffer_load_dword s15, s[8:11], s89 offset:8192 glc

.nl_245:
    s_add_u32 s28, s28, 1
    s_add_u32 s36, s36, 196608
    s_cmp_lt_u32 s28, 63
    s_cselect_b32 s4, 262144, 0
    s_add_u32 s38, s38, s4
    s_add_u32 s39, s39, s4
    s_add_u32 s30, s30, s4
    s_mov_b32 s4, s68
    s_mov_b32 s68, s69
    s_mov_b32 s69, s70
    s_mov_b32 s70, s71
    s_mov_b32 s71, s4
    s_and_b32 s4, s28, 3
    s_lshl_b32 s5, s4, 17
    s_add_u32 s29, s5, s34
    s_xor_b32 s6, s5, 262144
    s_add_u32 s31, s6, s34
    s_add_u32 s32, s29, 20480
    s_add_u32 s33, s29, 24576
    s_branch .top_208
.w3_210:
    ds_read_b128 v[36:39], v14 offset:8192
    ds_read_b128 v[40:43], v14 offset:9216
    ds_read_b128 v[44:47], v14 offset:10240
    ds_read_b128 v[48:51], v14 offset:11264
    ds_read_b128 v[88:91], v14 offset:16384
    s_waitcnt lgkmcnt(0)
    v_mfma_f32_16x16x32_bf16 v[104:107], v[84:87], v[36:39], 0
    v_mfma_f32_16x16x32_bf16 v[108:111], v[84:87], v[44:47], 0
    v_mfma_f32_16x16x32_bf16 v[104:107], v[84:87], v[40:43], v[104:107]
    v_mfma_f32_16x16x32_bf16 v[108:111], v[84:87], v[48:51], v[108:111]
    s_nop 7
    v_cvt_pk_bf16_f32 v168, v104, v105
    v_cvt_pk_bf16_f32 v169, v106, v107
    v_cvt_pk_bf16_f32 v170, v108, v109
    v_cvt_pk_bf16_f32 v171, v110, v111
    ds_write_b128 v14, v[168:171] offset:18432
    v_cndmask_b32 v172, v170, v168, s[60:61]
    v_cndmask_b32 v173, v171, v169, s[60:61]
    v_min_u32 v172, 0xfffffffe, v172
    v_min_u32 v173, 0xfffffffe, v173
    v_mov_b32 v174, v172
    v_mov_b32 v175, v173
    s_cmp_ge_u32 s28, 62
    s_nop 0
    v_permlane16_swap_b32 v172, v174
    v_permlane16_swap_b32 v173, v175
    ds_write_b128 v14, v[172:175] offset:17408

    s_cbranch_scc1 .sk_246
.sb_247:
.en_35:
    s_waitcnt lgkmcnt(0)
    s_barrier
    buffer_store_dwordx4 v[188:191], v235, s[8:11], s31 offen sc1
    buffer_store_dwordx4 v[188:191], v236, s[8:11], s31 offen sc1

    s_branch .gp_211
.A_248:
    s_mov_b64 exec, vcc
    buffer_load_dwordx4 v[32:35], v8, s[8:11], s29 offen offset:3072 sc1
    s_mov_b64 exec, -1
    s_sub_u32 s62, s62, 1
    s_cbranch_scc1 .mg_end_1
    s_waitcnt vmcnt(3)
    v_max3_u32 v4, v20, v21, v22
    v_max_u32 v4, v4, v23
    v_cmp_eq_u32 vcc, -1, v4
    s_cbranch_vccz .W_214
.A_213:
    s_mov_b64 exec, vcc
    buffer_load_dwordx4 v[20:23], v8, s[8:11], s29 offen offset:0 sc1
    s_mov_b64 exec, -1
    s_waitcnt vmcnt(3)
    v_max3_u32 v4, v24, v25, v26
    v_max_u32 v4, v4, v27
    v_cmp_eq_u32 vcc, -1, v4
    s_cbranch_vccz .W_249
.A_250:
    s_mov_b64 exec, vcc
    buffer_load_dwordx4 v[24:27], v8, s[8:11], s29 offen offset:1024 sc1
    s_mov_b64 exec, -1
    s_waitcnt vmcnt(3)
    v_max3_u32 v4, v28, v29, v30
    v_max_u32 v4, v4, v31
    v_cmp_eq_u32 vcc, -1, v4
    s_cbranch_vccz .W_251
.A_252:
    s_mov_b64 exec, vcc
    buffer_load_dwordx4 v[28:31], v8, s[8:11], s29 offen offset:2048 sc1
    s_mov_b64 exec, -1
    s_waitcnt vmcnt(3)
    v_max3_u32 v4, v32, v33, v34
    v_max_u32 v4, v4, v35
    v_cmp_eq_u32 vcc, -1, v4
    s_cbranch_vccnz .A_248
.W_253:
    v_smfmac_f32_16x16x64_bf16 v[52:55], v[32:35], a[24:31], v9
    v_smfmac_f32_16x16x64_bf16 v[56:59], v[32:35], a[56:63], v9
    s_waitcnt vmcnt(2)
    v_max3_u32 v4, v20, v21, v22
    v_max_u32 v4, v4, v23
    v_smfmac_f32_16x16x64_bf16 v[60:63], v[32:35], a[88:95], v9
    v_cmp_eq_u32 vcc, -1, v4
    v_smfmac_f32_16x16x64_bf16 v[64:67], v[32:35], a[120:127], v9
    s_cbranch_vccnz .A_254
.W_255:
    v_smfmac_f32_16x16x64_bf16 v[52:55], v[20:23], a[0:7], v9
    v_smfmac_f32_16x16x64_bf16 v[56:59], v[20:23], a[32:39], v9
    s_waitcnt vmcnt(1)
    v_max3_u32 v4, v24, v25, v26
    v_max_u32 v4, v4, v27
    v_smfmac_f32_16x16x64_bf16 v[60:63], v[20:23], a[64:71], v9
    v_cmp_eq_u32 vcc, -1, v4
    v_smfmac_f32_16x16x64_bf16 v[64:67], v[20:23], a[96:103], v9
    s_cbranch_vccnz .A_256
.W_257:
    v_smfmac_f32_16x16x64_bf16 v[52:55], v[24:27], a[8:15], v9
    v_smfmac_f32_16x16x64_bf16 v[56:59], v[24:27], a[40:47], v9
    s_waitcnt vmcnt(0)
    v_max3_u32 v4, v28, v29, v30
    v_max_u32 v4, v4, v31
    v_smfmac_f32_16x16x64_bf16 v[60:63], v[24:27], a[72:79], v9
    v_cmp_eq_u32 vcc, -1, v4
    v_smfmac_f32_16x16x64_bf16 v[64:67], v[24:27], a[104:111], v9
    s_cbranch_vccnz .A_258
.W_259:
    v_smfmac_f32_16x16x64_bf16 v[52:55], v[28:31], a[16:23], v9
    v_smfmac_f32_16x16x64_bf16 v[56:59], v[28:31], a[48:55], v9
    v_smfmac_f32_16x16x64_bf16 v[60:63], v[28:31], a[80:87], v9
    v_smfmac_f32_16x16x64_bf16 v[64:67], v[28:31], a[112:119], v9
    s_branch .mj_212
.W_249:
    v_smfmac_f32_16x16x64_bf16 v[52:55], v[24:27], a[8:15], v9
    v_smfmac_f32_16x16x64_bf16 v[56:59], v[24:27], a[40:47], v9
    s_waitcnt vmcnt(2)
    v_max3_u32 v4, v28, v29, v30
    v_max_u32 v4, v4, v31
    v_smfmac_f32_16x16x64_bf16 v[60:63], v[24:27], a[72:79], v9
    v_cmp_eq_u32 vcc, -1, v4
    v_smfmac_f32_16x16x64_bf16 v[64:67], v[24:27], a[104:111], v9
    s_cbranch_vccnz .A_260
.W_261:
    v_smfmac_f32_16x16x64_bf16 v[52:55], v[28:31], a[16:23], v9
    v_smfmac_f32_16x16x64_bf16 v[56:59], v[28:31], a[48:55], v9
    s_waitcnt vmcnt(1)
    v_max3_u32 v4, v32, v33, v34
    v_max_u32 v4, v4, v35
    v_smfmac_f32_16x16x64_bf16 v[60:63], v[28:31], a[80:87], v9
    v_cmp_eq_u32 vcc, -1, v4
    v_smfmac_f32_16x16x64_bf16 v[64:67], v[28:31], a[112:119], v9
    s_cbranch_vccnz .A_262
.W_263:
    v_smfmac_f32_16x16x64_bf16 v[52:55], v[32:35], a[24:31], v9
    v_smfmac_f32_16x16x64_bf16 v[56:59], v[32:35], a[56:63], v9
    s_waitcnt vmcnt(0)
    v_max3_u32 v4, v20, v21, v22
    v_max_u32 v4, v4, v23
    v_smfmac_f32_16x16x64_bf16 v[60:63], v[32:35], a[88:95], v9
    v_cmp_eq_u32 vcc, -1, v4
    v_smfmac_f32_16x16x64_bf16 v[64:67], v[32:35], a[120:127], v9
    s_cbranch_vccnz .A_264
.W_265:
    v_smfmac_f32_16x16x64_bf16 v[52:55], v[20:23], a[0:7], v9
    v_smfmac_f32_16x16x64_bf16 v[56:59], v[20:23], a[32:39], v9
    v_smfmac_f32_16x16x64_bf16 v[60:63], v[20:23], a[64:71], v9
    v_smfmac_f32_16x16x64_bf16 v[64:67], v[20:23], a[96:103], v9
    s_branch .mj_212
.W_251:
    v_smfmac_f32_16x16x64_bf16 v[52:55], v[28:31], a[16:23], v9
    v_smfmac_f32_16x16x64_bf16 v[56:59], v[28:31], a[48:55], v9
    s_waitcnt vmcnt(2)
    v_max3_u32 v4, v32, v33, v34
    v_max_u32 v4, v4, v35
    v_smfmac_f32_16x16x64_bf16 v[60:63], v[28:31], a[80:87], v9
    v_cmp_eq_u32 vcc, -1, v4
    v_smfmac_f32_16x16x64_bf16 v[64:67], v[28:31], a[112:119], v9
    s_cbranch_vccnz .A_266
.W_267:
    v_smfmac_f32_16x16x64_bf16 v[52:55], v[32:35], a[24:31], v9
    v_smfmac_f32_16x16x64_bf16 v[56:59], v[32:35], a[56:63], v9
    s_waitcnt vmcnt(1)
    v_max3_u32 v4, v20, v21, v22
    v_max_u32 v4, v4, v23
    v_smfmac_f32_16x16x64_bf16 v[60:63], v[32:35], a[88:95], v9
    v_cmp_eq_u32 vcc, -1, v4
    v_smfmac_f32_16x16x64_bf16 v[64:67], v[32:35], a[120:127], v9
    s_cbranch_vccnz .A_268
.W_269:
    v_smfmac_f32_16x16x64_bf16 v[52:55], v[20:23], a[0:7], v9
    v_smfmac_f32_16x16x64_bf16 v[56:59], v[20:23], a[32:39], v9
    s_waitcnt vmcnt(0)
    v_max3_u32 v4, v24, v25, v26
    v_max_u32 v4, v4, v27
    v_smfmac_f32_16x16x64_bf16 v[60:63], v[20:23], a[64:71], v9
    v_cmp_eq_u32 vcc, -1, v4
    v_smfmac_f32_16x16x64_bf16 v[64:67], v[20:23], a[96:103], v9
    s_cbranch_vccnz .A_270
.W_271:
    v_smfmac_f32_16x16x64_bf16 v[52:55], v[24:27], a[8:15], v9
    v_smfmac_f32_16x16x64_bf16 v[56:59], v[24:27], a[40:47], v9
    v_smfmac_f32_16x16x64_bf16 v[60:63], v[24:27], a[72:79], v9
    v_smfmac_f32_16x16x64_bf16 v[64:67], v[24:27], a[104:111], v9
    s_branch .mj_212
.A_272:
    s_mov_b64 exec, vcc
    buffer_load_dwordx4 v[28:31], v8, s[8:11], s29 offen offset:2048 sc1
    s_mov_b64 exec, -1
    s_sub_u32 s62, s62, 1
    s_cbranch_scc1 .mg_end_1
    s_waitcnt vmcnt(2)
    v_max3_u32 v4, v20, v21, v22
    v_max_u32 v4, v4, v23
    v_cmp_eq_u32 vcc, -1, v4
    s_cbranch_vccz .W_255
.A_254:
    s_mov_b64 exec, vcc
    buffer_load_dwordx4 v[20:23], v8, s[8:11], s29 offen offset:0 sc1
    s_mov_b64 exec, -1
    s_waitcnt vmcnt(2)
    v_max3_u32 v4, v24, v25, v26
    v_max_u32 v4, v4, v27
    v_cmp_eq_u32 vcc, -1, v4
    s_cbranch_vccz .W_273
.A_274:
    s_mov_b64 exec, vcc
    buffer_load_dwordx4 v[24:27], v8, s[8:11], s29 offen offset:1024 sc1
    s_mov_b64 exec, -1
    s_waitcnt vmcnt(2)
    v_max3_u32 v4, v28, v29, v30
    v_max_u32 v4, v4, v31
    v_cmp_eq_u32 vcc, -1, v4
    s_cbranch_vccnz .A_272
.W_275:
    v_smfmac_f32_16x16x64_bf16 v[52:55], v[28:31], a[16:23], v9
    v_smfmac_f32_16x16x64_bf16 v[56:59], v[28:31], a[48:55], v9
    s_waitcnt vmcnt(1)
    v_max3_u32 v4, v20, v21, v22
    v_max_u32 v4, v4, v23
    v_smfmac_f32_16x16x64_bf16 v[60:63], v[28:31], a[80:87], v9
    v_cmp_eq_u32 vcc, -1, v4
    v_smfmac_f32_16x16x64_bf16 v[64:67], v[28:31], a[112:119], v9
    s_cbranch_vccz .W_269
    s_branch .A_268
.W_273:
    v_smfmac_f32_16x16x64_bf16 v[52:55], v[24:27], a[8:15], v9
    v_smfmac_f32_16x16x64_bf16 v[56:59], v[24:27], a[40:47], v9
    s_waitcnt vmcnt(1)
    v_max3_u32 v4, v28, v29, v30
    v_max_u32 v4, v4, v31
    v_smfmac_f32_16x16x64_bf16 v[60:63], v[24:27], a[72:79], v9
    v_cmp_eq_u32 vcc, -1, v4
    v_smfmac_f32_16x16x64_bf16 v[64:67], v[24:27], a[104:111], v9
    s_cbranch_vccnz .A_276
.W_277:
    v_smfmac_f32_16x16x64_bf16 v[52:55], v[28:31], a[16:23], v9
    v_smfmac_f32_16x16x64_bf16 v[56:59], v[28:31], a[48:55], v9
    s_waitcnt vmcnt(0)
    v_max3_u32 v4, v20, v21, v22
    v_max_u32 v4, v4, v23
    v_smfmac_f32_16x16x64_bf16 v[60:63], v[28:31], a[80:87], v9
    v_cmp_eq_u32 vcc, -1, v4
    v_smfmac_f32_16x16x64_bf16 v[64:67], v[28:31], a[112:119], v9
    s_cbranch_vccz .W_265
    s_branch .A_264
.A_278:
    s_mov_b64 exec, vcc
    buffer_load_dwordx4 v[24:27], v8, s[8:11], s29 offen offset:1024 sc1
    s_mov_b64 exec, -1
    s_sub_u32 s62, s62, 1
    s_cbranch_scc1 .mg_end_1
    s_waitcnt vmcnt(2)
    v_max3_u32 v4, v32, v33, v34
    v_max_u32 v4, v4, v35
    v_cmp_eq_u32 vcc, -1, v4
    s_cbranch_vccz .W_267
.A_266:
    s_mov_b64 exec, vcc
    buffer_load_dwordx4 v[32:35], v8, s[8:11], s29 offen offset:3072 sc1
    s_mov_b64 exec, -1
    s_waitcnt vmcnt(2)
    v_max3_u32 v4, v20, v21, v22
    v_max_u32 v4, v4, v23
    v_cmp_eq_u32 vcc, -1, v4
    s_cbranch_vccz .W_279
.A_280:
    s_mov_b64 exec, vcc
    buffer_load_dwordx4 v[20:23], v8, s[8:11], s29 offen offset:0 sc1
    s_mov_b64 exec, -1
    s_waitcnt vmcnt(2)
    v_max3_u32 v4, v24, v25, v26
    v_max_u32 v4, v4, v27
    v_cmp_eq_u32 vcc, -1, v4
    s_cbranch_vccnz .A_278
.W_281:
    v_smfmac_f32_16x16x64_bf16 v[52:55], v[24:27], a[8:15], v9
    v_smfmac_f32_16x16x64_bf16 v[56:59], v[24:27], a[40:47], v9
    s_waitcnt vmcnt(1)
    v_max3_u32 v4, v32, v33, v34
    v_max_u32 v4, v4, v35
    v_smfmac_f32_16x16x64_bf16 v[60:63], v[24:27], a[72:79], v9
    v_cmp_eq_u32 vcc, -1, v4
    v_smfmac_f32_16x16x64_bf16 v[64:67], v[24:27], a[104:111], v9
    s_cbranch_vccz .W_263
    s_branch .A_262
.W_279:
    v_smfmac_f32_16x16x64_bf16 v[52:55], v[20:23], a[0:7], v9
    v_smfmac_f32_16x16x64_bf16 v[56:59], v[20:23], a[32:39], v9
    s_waitcnt vmcnt(1)
    v_max3_u32 v4, v24, v25, v26
    v_max_u32 v4, v4, v27
    v_smfmac_f32_16x16x64_bf16 v[60:63], v[20:23], a[64:71], v9
    v_cmp_eq_u32 vcc, -1, v4
    v_smfmac_f32_16x16x64_bf16 v[64:67], v[20:23], a[96:103], v9
    s_cbranch_vccnz .A_282
.W_283:
    v_smfmac_f32_16x16x64_bf16 v[52:55], v[24:27], a[8:15], v9
    v_smfmac_f32_16x16x64_bf16 v[56:59], v[24:27], a[40:47], v9
    s_waitcnt vmcnt(0)
    v_max3_u32 v4, v32, v33, v34
    v_max_u32 v4, v4, v35
    v_smfmac_f32_16x16x64_bf16 v[60:63], v[24:27], a[72:79], v9
    v_cmp_eq_u32 vcc, -1, v4
    v_smfmac_f32_16x16x64_bf16 v[64:67], v[24:27], a[104:111], v9
    s_cbranch_vccz .W_220
    s_branch .A_219
.A_284:
    s_mov_b64 exec, vcc
    buffer_load_dwordx4 v[32:35], v8, s[8:11], s29 offen offset:3072 sc1
    s_mov_b64 exec, -1
    s_sub_u32 s62, s62, 1
    s_cbranch_scc1 .mg_end_1
    s_waitcnt vmcnt(2)
    v_max3_u32 v4, v20, v21, v22
    v_max_u32 v4, v4, v23
    v_cmp_eq_u32 vcc, -1, v4
    s_cbranch_vccz .W_285
.A_286:
    s_mov_b64 exec, vcc
    buffer_load_dwordx4 v[20:23], v8, s[8:11], s29 offen offset:0 sc1
    s_mov_b64 exec, -1
    s_waitcnt vmcnt(2)
    v_max3_u32 v4, v28, v29, v30
    v_max_u32 v4, v4, v31
    v_cmp_eq_u32 vcc, -1, v4
    s_cbranch_vccz .W_261
.A_260:
    s_mov_b64 exec, vcc
    buffer_load_dwordx4 v[28:31], v8, s[8:11], s29 offen offset:2048 sc1
    s_mov_b64 exec, -1
    s_waitcnt vmcnt(2)
    v_max3_u32 v4, v32, v33, v34
    v_max_u32 v4, v4, v35
    v_cmp_eq_u32 vcc, -1, v4
    s_cbranch_vccnz .A_284
.W_287:
    v_smfmac_f32_16x16x64_bf16 v[52:55], v[32:35], a[24:31], v9
    v_smfmac_f32_16x16x64_bf16 v[56:59], v[32:35], a[56:63], v9
    s_waitcnt vmcnt(1)
    v_max3_u32 v4, v20, v21, v22
    v_max_u32 v4, v4, v23
    v_smfmac_f32_16x16x64_bf16 v[60:63], v[32:35], a[88:95], v9
    v_cmp_eq_u32 vcc, -1, v4
    v_smfmac_f32_16x16x64_bf16 v[64:67], v[32:35], a[120:127], v9
    s_cbranch_vccnz .A_288
.W_289:
    v_smfmac_f32_16x16x64_bf16 v[52:55], v[20:23], a[0:7], v9
    v_smfmac_f32_16x16x64_bf16 v[56:59], v[20:23], a[32:39], v9
    s_waitcnt vmcnt(0)
    v_max3_u32 v4, v28, v29, v30
    v_max_u32 v4, v4, v31
    v_smfmac_f32_16x16x64_bf16 v[60:63], v[20:23], a[64:71], v9
    v_cmp_eq_u32 vcc, -1, v4
    v_smfmac_f32_16x16x64_bf16 v[64:67], v[20:23], a[96:103], v9
    s_cbranch_vccz .W_259
    s_branch .A_258
.W_285:
    v_smfmac_f32_16x16x64_bf16 v[52:55], v[20:23], a[0:7], v9
    v_smfmac_f32_16x16x64_bf16 v[56:59], v[20:23], a[32:39], v9
    s_waitcnt vmcnt(1)
    v_max3_u32 v4, v28, v29, v30
    v_max_u32 v4, v4, v31
    v_smfmac_f32_16x16x64_bf16 v[60:63], v[20:23], a[64:71], v9
    v_cmp_eq_u32 vcc, -1, v4
    v_smfmac_f32_16x16x64_bf16 v[64:67], v[20:23], a[96:103], v9
    s_cbranch_vccz .W_218
    s_branch .A_217
.A_290:
    s_mov_b64 exec, vcc
    buffer_load_dwordx4 v[32:35], v8, s[8:11], s29 offen offset:3072 sc1
    s_mov_b64 exec, -1
    s_sub_u32 s62, s62, 1
    s_cbranch_scc1 .mg_end_1
    s_waitcnt vmcnt(2)
    v_max3_u32 v4, v24, v25, v26
    v_max_u32 v4, v4, v27
    v_cmp_eq_u32 vcc, -1, v4
    s_cbranch_vccz .W_216
.A_215:
    s_mov_b64 exec, vcc
    buffer_load_dwordx4 v[24:27], v8, s[8:11], s29 offen offset:1024 sc1
    s_mov_b64 exec, -1
    s_waitcnt vmcnt(2)
    v_max3_u32 v4, v28, v29, v30
    v_max_u32 v4, v4, v31
    v_cmp_eq_u32 vcc, -1, v4
    s_cbranch_vccz .W_291
.A_292:
    s_mov_b64 exec, vcc
    buffer_load_dwordx4 v[28:31], v8, s[8:11], s29 offen offset:2048 sc1
    s_mov_b64 exec, -1
    s_waitcnt vmcnt(2)
    v_max3_u32 v4, v32, v33, v34
    v_max_u32 v4, v4, v35
    v_cmp_eq_u32 vcc, -1, v4
    s_cbranch_vccnz .A_290
.W_293:
    v_smfmac_f32_16x16x64_bf16 v[52:55], v[32:35], a[24:31], v9
    v_smfmac_f32_16x16x64_bf16 v[56:59], v[32:35], a[56:63], v9
    s_waitcnt vmcnt(1)
    v_max3_u32 v4, v24, v25, v26
    v_max_u32 v4, v4, v27
    v_smfmac_f32_16x16x64_bf16 v[60:63], v[32:35], a[88:95], v9
    v_cmp_eq_u32 vcc, -1, v4
    v_smfmac_f32_16x16x64_bf16 v[64:67], v[32:35], a[120:127], v9
    s_cbranch_vccz .W_257
    s_branch .A_256
.W_291:
    v_smfmac_f32_16x16x64_bf16 v[52:55], v[28:31], a[16:23], v9
    v_smfmac_f32_16x16x64_bf16 v[56:59], v[28:31], a[48:55], v9
    s_waitcnt vmcnt(1)
    v_max3_u32 v4, v32, v33, v34
    v_max_u32 v4, v4, v35
    v_smfmac_f32_16x16x64_bf16 v[60:63], v[28:31], a[80:87], v9
    v_cmp_eq_u32 vcc, -1, v4
    v_smfmac_f32_16x16x64_bf16 v[64:67], v[28:31], a[112:119], v9
    s_cbranch_vccnz .A_294
.W_295:
    v_smfmac_f32_16x16x64_bf16 v[52:55], v[32:35], a[24:31], v9
    v_smfmac_f32_16x16x64_bf16 v[56:59], v[32:35], a[56:63], v9
    s_waitcnt vmcnt(0)
    v_max3_u32 v4, v24, v25, v26
    v_max_u32 v4, v4, v27
    v_smfmac_f32_16x16x64_bf16 v[60:63], v[32:35], a[88:95], v9
    v_cmp_eq_u32 vcc, -1, v4
    v_smfmac_f32_16x16x64_bf16 v[64:67], v[32:35], a[120:127], v9
    s_cbranch_vccz .W_271
    s_branch .A_270
.A_296:
    s_mov_b64 exec, vcc
    buffer_load_dwordx4 v[24:27], v8, s[8:11], s29 offen offset:1024 sc1
    s_mov_b64 exec, -1
    s_sub_u32 s62, s62, 1
    s_cbranch_scc1 .mg_end_1
    s_waitcnt vmcnt(1)
    v_max3_u32 v4, v20, v21, v22
    v_max_u32 v4, v4, v23
    v_cmp_eq_u32 vcc, -1, v4
    s_cbranch_vccz .W_269
.A_268:
    s_mov_b64 exec, vcc
    buffer_load_dwordx4 v[20:23], v8, s[8:11], s29 offen offset:0 sc1
    s_mov_b64 exec, -1
    s_waitcnt vmcnt(1)
    v_max3_u32 v4, v24, v25, v26
    v_max_u32 v4, v4, v27
    v_cmp_eq_u32 vcc, -1, v4
    s_cbranch_vccnz .A_296
.W_297:
    v_smfmac_f32_16x16x64_bf16 v[52:55], v[24:27], a[8:15], v9
    v_smfmac_f32_16x16x64_bf16 v[56:59], v[24:27], a[40:47], v9
    s_waitcnt vmcnt(0)
    v_max3_u32 v4, v20, v21, v22
    v_max_u32 v4, v4, v23
    v_smfmac_f32_16x16x64_bf16 v[60:63], v[24:27], a[72:79], v9
    v_cmp_eq_u32 vcc, -1, v4
    v_smfmac_f32_16x16x64_bf16 v[64:67], v[24:27], a[104:111], v9
    s_cbranch_vccz .W_265
    s_branch .A_264
.A_276:
    s_mov_b64 exec, vcc
    buffer_load_dwordx4 v[28:31], v8, s[8:11], s29 offen offset:2048 sc1
    s_mov_b64 exec, -1
    s_sub_u32 s62, s62, 1
    s_cbranch_scc1 .mg_end_1
    s_waitcnt vmcnt(1)
    v_max3_u32 v4, v20, v21, v22
    v_max_u32 v4, v4, v23
    v_cmp_eq_u32 vcc, -1, v4
    s_cbranch_vccz .W_289
.A_288:
    s_mov_b64 exec, vcc
    buffer_load_dwordx4 v[20:23], v8, s[8:11], s29 offen offset:0 sc1
    s_mov_b64 exec, -1
    s_waitcnt vmcnt(1)
    v_max3_u32 v4, v28, v29, v30
    v_max_u32 v4, v4, v31
    v_cmp_eq_u32 vcc, -1, v4
    s_cbranch_vccnz .A_276
    s_branch .W_277
.A_298:
    s_mov_b64 exec, vcc
    buffer_load_dwordx4 v[20:23], v8, s[8:11], s29 offen offset:0 sc1
    s_mov_b64 exec, -1
    s_sub_u32 s62, s62, 1
    s_cbranch_scc1 .mg_end_1
    s_waitcnt vmcnt(1)
    v_max3_u32 v4, v32, v33, v34
    v_max_u32 v4, v4, v35
    v_cmp_eq_u32 vcc, -1, v4
    s_cbranch_vccz .W_263
.A_262:
    s_mov_b64 exec, vcc
    buffer_load_dwordx4 v[32:35], v8, s[8:11], s29 offen offset:3072 sc1
    s_mov_b64 exec, -1
    s_waitcnt vmcnt(1)
    v_max3_u32 v4, v20, v21, v22
    v_max_u32 v4, v4, v23
    v_cmp_eq_u32 vcc, -1, v4
    s_cbranch_vccnz .A_298
.W_299:
    v_smfmac_f32_16x16x64_bf16 v[52:55], v[20:23], a[0:7], v9
    v_smfmac_f32_16x16x64_bf16 v[56:59], v[20:23], a[32:39], v9
    s_waitcnt vmcnt(0)
    v_max3_u32 v4, v32, v33, v34
    v_max_u32 v4, v4, v35
    v_smfmac_f32_16x16x64_bf16 v[60:63], v[20:23], a[64:71], v9
    v_cmp_eq_u32 vcc, -1, v4
    v_smfmac_f32_16x16x64_bf16 v[64:67], v[20:23], a[96:103], v9
    s_cbranch_vccz .W_220
    s_branch .A_219
.A_300:
    s_mov_b64 exec, vcc
    buffer_load_dwordx4 v[28:31], v8, s[8:11], s29 offen offset:2048 sc1
    s_mov_b64 exec, -1
    s_sub_u32 s62, s62, 1
    s_cbranch_scc1 .mg_end_1
    s_waitcnt vmcnt(1)
    v_max3_u32 v4, v24, v25, v26
    v_max_u32 v4, v4, v27
    v_cmp_eq_u32 vcc, -1, v4
    s_cbranch_vccz .W_257
.A_256:
    s_mov_b64 exec, vcc
    buffer_load_dwordx4 v[24:27], v8, s[8:11], s29 offen offset:1024 sc1
    s_mov_b64 exec, -1
    s_waitcnt vmcnt(1)
    v_max3_u32 v4, v28, v29, v30
    v_max_u32 v4, v4, v31
    v_cmp_eq_u32 vcc, -1, v4
    s_cbranch_vccnz .A_300
.W_301:
    v_smfmac_f32_16x16x64_bf16 v[52:55], v[28:31], a[16:23], v9
    v_smfmac_f32_16x16x64_bf16 v[56:59], v[28:31], a[48:55], v9
    s_waitcnt vmcnt(0)
    v_max3_u32 v4, v24, v25, v26
    v_max_u32 v4, v4, v27
    v_smfmac_f32_16x16x64_bf16 v[60:63], v[28:31], a[80:87], v9
    v_cmp_eq_u32 vcc, -1, v4
    v_smfmac_f32_16x16x64_bf16 v[64:67], v[28:31], a[112:119], v9
    s_cbranch_vccz .W_271
    s_branch .A_270
.A_294:
    s_mov_b64 exec, vcc
    buffer_load_dwordx4 v[32:35], v8, s[8:11], s29 offen offset:3072 sc1
    s_mov_b64 exec, -1
    s_sub_u32 s62, s62, 1
    s_cbranch_scc1 .mg_end_1
    s_waitcnt vmcnt(1)
    v_max3_u32 v4, v24, v25, v26
    v_max_u32 v4, v4, v27
    v_cmp_eq_u32 vcc, -1, v4
    s_cbranch_vccz .W_283
.A_282:
    s_mov_b64 exec, vcc
    buffer_load_dwordx4 v[24:27], v8, s[8:11], s29 offen offset:1024 sc1
    s_mov_b64 exec, -1
    s_waitcnt vmcnt(1)
    v_max3_u32 v4, v32, v33, v34
    v_max_u32 v4, v4, v35
    v_cmp_eq_u32 vcc, -1, v4
    s_cbranch_vccnz .A_294
    s_branch .W_295
.A_302:
    s_mov_b64 exec, vcc
    buffer_load_dwordx4 v[32:35], v8, s[8:11], s29 offen offset:3072 sc1
    s_mov_b64 exec, -1
    s_sub_u32 s62, s62, 1
    s_cbranch_scc1 .mg_end_1
    s_waitcnt vmcnt(1)
    v_max3_u32 v4, v28, v29, v30
    v_max_u32 v4, v4, v31
    v_cmp_eq_u32 vcc, -1, v4
    s_cbranch_vccz .W_218
.A_217:
    s_mov_b64 exec, vcc
    buffer_load_dwordx4 v[28:31], v8, s[8:11], s29 offen offset:2048 sc1
    s_mov_b64 exec, -1
    s_waitcnt vmcnt(1)
    v_max3_u32 v4, v32, v33, v34
    v_max_u32 v4, v4, v35
    v_cmp_eq_u32 vcc, -1, v4
    s_cbranch_vccnz .A_302
.W_303:
    v_smfmac_f32_16x16x64_bf16 v[52:55], v[32:35], a[24:31], v9
    v_smfmac_f32_16x16x64_bf16 v[56:59], v[32:35], a[56:63], v9
    s_waitcnt vmcnt(0)
    v_max3_u32 v4, v28, v29, v30
    v_max_u32 v4, v4, v31
    v_smfmac_f32_16x16x64_bf16 v[60:63], v[32:35], a[88:95], v9
    v_cmp_eq_u32 vcc, -1, v4
    v_smfmac_f32_16x16x64_bf16 v[64:67], v[32:35], a[120:127], v9
    s_cbranch_vccz .W_259
    s_branch .A_258
.A_264:
    s_mov_b64 exec, vcc
    buffer_load_dwordx4 v[20:23], v8, s[8:11], s29 offen offset:0 sc1
    s_mov_b64 exec, -1
    s_sub_u32 s62, s62, 1
    s_cbranch_scc1 .mg_end_1
    s_waitcnt vmcnt(1)
    v_max3_u32 v4, v20, v21, v22
    v_max_u32 v4, v4, v23
    v_cmp_eq_u32 vcc, -1, v4
    s_cbranch_vccnz .A_264
    v_smfmac_f32_16x16x64_bf16 v[52:55], v[20:23], a[0:7], v9
    v_smfmac_f32_16x16x64_bf16 v[56:59], v[20:23], a[32:39], v9
    v_smfmac_f32_16x16x64_bf16 v[60:63], v[20:23], a[64:71], v9
    v_smfmac_f32_16x16x64_bf16 v[64:67], v[20:23], a[96:103], v9
    s_branch .mj_212
.A_270:
    s_mov_b64 exec, vcc
    buffer_load_dwordx4 v[24:27], v8, s[8:11], s29 offen offset:1024 sc1
    s_mov_b64 exec, -1
    s_sub_u32 s62, s62, 1
    s_cbranch_scc1 .mg_end_1
    s_waitcnt vmcnt(1)
    v_max3_u32 v4, v24, v25, v26
    v_max_u32 v4, v4, v27
    v_cmp_eq_u32 vcc, -1, v4
    s_cbranch_vccnz .A_270
    v_smfmac_f32_16x16x64_bf16 v[52:55], v[24:27], a[8:15], v9
    v_smfmac_f32_16x16x64_bf16 v[56:59], v[24:27], a[40:47], v9
    v_smfmac_f32_16x16x64_bf16 v[60:63], v[24:27], a[72:79], v9
    v_smfmac_f32_16x16x64_bf16 v[64:67], v[24:27], a[104:111], v9
    s_branch .mj_212
.A_258:
    s_mov_b64 exec, vcc
    buffer_load_dwordx4 v[28:31], v8, s[8:11], s29 offen offset:2048 sc1
    s_mov_b64 exec, -1
    s_sub_u32 s62, s62, 1
    s_cbranch_scc1 .mg_end_1
    s_waitcnt vmcnt(1)
    v_max3_u32 v4, v28, v29, v30
    v_max_u32 v4, v4, v31
    v_cmp_eq_u32 vcc, -1, v4
    s_cbranch_vccnz .A_258
    v_smfmac_f32_16x16x64_bf16 v[52:55], v[28:31], a[16:23], v9
    v_smfmac_f32_16x16x64_bf16 v[56:59], v[28:31], a[48:55], v9
    v_smfmac_f32_16x16x64_bf16 v[60:63], v[28:31], a[80:87], v9
    v_smfmac_f32_16x16x64_bf16 v[64:67], v[28:31], a[112:119], v9
    s_branch .mj_212
.A_219:
    s_mov_b64 exec, vcc
    buffer_load_dwordx4 v[32:35], v8, s[8:11], s29 offen offset:3072 sc1
    s_mov_b64 exec, -1
    s_sub_u32 s62, s62, 1
    s_cbranch_scc1 .mg_end_1
    s_waitcnt vmcnt(1)
    v_max3_u32 v4, v32, v33, v34
    v_max_u32 v4, v4, v35
    v_cmp_eq_u32 vcc, -1, v4
    s_cbranch_vccnz .A_219
    v_smfmac_f32_16x16x64_bf16 v[52:55], v[32:35], a[24:31], v9
    v_smfmac_f32_16x16x64_bf16 v[56:59], v[32:35], a[56:63], v9
    v_smfmac_f32_16x16x64_bf16 v[60:63], v[32:35], a[88:95], v9
    v_smfmac_f32_16x16x64_bf16 v[64:67], v[32:35], a[120:127], v9
    s_branch .mj_212
.A_304:
    buffer_load_dwordx4 v[100:103], v234, s[8:11], s29 offen sc1
    s_sub_u32 s62, s62, 1
    s_cbranch_scc1 .mg_end_1
    s_waitcnt vmcnt(2)
    v_max3_u32 v4, v92, v93, v94
    v_max_u32 v4, v4, v95
    v_cmp_eq_u32 vcc, -1, v4
    s_cbranch_vccz .W_223
.A_222:
    buffer_load_dwordx4 v[92:95], v232, s[8:11], s29 offen sc1
    s_waitcnt vmcnt(2)
    v_max3_u32 v4, v96, v97, v98
    v_max_u32 v4, v4, v99
    v_cmp_eq_u32 vcc, -1, v4
    s_cbranch_vccz .W_305
.A_306:
    buffer_load_dwordx4 v[96:99], v233, s[8:11], s29 offen sc1
    s_waitcnt vmcnt(2)
    v_max3_u32 v4, v100, v101, v102
    v_max_u32 v4, v4, v103
    v_cmp_eq_u32 vcc, -1, v4
    s_cbranch_vccnz .A_304
.W_307:
    v_mfma_f32_16x16x32_bf16 v[208:211], v[140:143], v[100:103], v[208:211]
    s_waitcnt vmcnt(1)
    v_max3_u32 v4, v92, v93, v94
    v_max_u32 v4, v4, v95
    v_mfma_f32_16x16x32_bf16 v[212:215], v[156:159], v[100:103], v[212:215]
    v_cmp_eq_u32 vcc, -1, v4
    v_mfma_f32_16x16x32_bf16 v[216:219], v[100:103], v[100:103], v[216:219]
    s_cbranch_vccnz .A_308
.W_309:
    v_mfma_f32_16x16x32_bf16 v[208:211], v[132:135], v[92:95], v[208:211]
    s_waitcnt vmcnt(0)
    v_max3_u32 v4, v96, v97, v98
    v_max_u32 v4, v4, v99
    v_mfma_f32_16x16x32_bf16 v[212:215], v[148:151], v[92:95], v[212:215]
    v_cmp_eq_u32 vcc, -1, v4
    v_mfma_f32_16x16x32_bf16 v[216:219], v[92:95], v[92:95], v[216:219]
    s_cbranch_vccnz .A_310
.W_311:
    v_mfma_f32_16x16x32_bf16 v[208:211], v[136:139], v[96:99], v[208:211]
    v_mfma_f32_16x16x32_bf16 v[212:215], v[152:155], v[96:99], v[212:215]
    v_mfma_f32_16x16x32_bf16 v[216:219], v[96:99], v[96:99], v[216:219]
    s_branch .mj_221
.W_305:
    v_mfma_f32_16x16x32_bf16 v[208:211], v[136:139], v[96:99], v[208:211]
    s_waitcnt vmcnt(1)
    v_max3_u32 v4, v100, v101, v102
    v_max_u32 v4, v4, v103
    v_mfma_f32_16x16x32_bf16 v[212:215], v[152:155], v[96:99], v[212:215]
    v_cmp_eq_u32 vcc, -1, v4
    v_mfma_f32_16x16x32_bf16 v[216:219], v[96:99], v[96:99], v[216:219]
    s_cbranch_vccnz .A_312
.W_313:
    v_mfma_f32_16x16x32_bf16 v[208:211], v[140:143], v[100:103], v[208:211]
    s_waitcnt vmcnt(0)
    v_max3_u32 v4, v92, v93, v94
    v_max_u32 v4, v4, v95
    v_mfma_f32_16x16x32_bf16 v[212:215], v[156:159], v[100:103], v[212:215]
    v_cmp_eq_u32 vcc, -1, v4
    v_mfma_f32_16x16x32_bf16 v[216:219], v[100:103], v[100:103], v[216:219]
    s_cbranch_vccnz .A_314
.W_315:
    v_mfma_f32_16x16x32_bf16 v[208:211], v[132:135], v[92:95], v[208:211]
    v_mfma_f32_16x16x32_bf16 v[212:215], v[148:151], v[92:95], v[212:215]
    v_mfma_f32_16x16x32_bf16 v[216:219], v[92:95], v[92:95], v[216:219]
    s_branch .mj_221
.A_316:
    buffer_load_dwordx4 v[96:99], v233, s[8:11], s29 offen sc1
    s_sub_u32 s62, s62, 1
    s_cbranch_scc1 .mg_end_1
    s_waitcnt vmcnt(1)
    v_max3_u32 v4, v92, v93, v94
    v_max_u32 v4, v4, v95
    v_cmp_eq_u32 vcc, -1, v4
    s_cbranch_vccz .W_309
.A_308:
    buffer_load_dwordx4 v[92:95], v232, s[8:11], s29 offen sc1
    s_waitcnt vmcnt(1)
    v_max3_u32 v4, v96, v97, v98
    v_max_u32 v4, v4, v99
    v_cmp_eq_u32 vcc, -1, v4
    s_cbranch_vccnz .A_316
.W_317:
    v_mfma_f32_16x16x32_bf16 v[208:211], v[136:139], v[96:99], v[208:211]
    s_waitcnt vmcnt(0)
    v_max3_u32 v4, v92, v93, v94
    v_max_u32 v4, v4, v95
    v_mfma_f32_16x16x32_bf16 v[212:215], v[152:155], v[96:99], v[212:215]
    v_cmp_eq_u32 vcc, -1, v4
    v_mfma_f32_16x16x32_bf16 v[216:219], v[96:99], v[96:99], v[216:219]
    s_cbranch_vccz .W_315
    s_branch .A_314
.A_318:
    buffer_load_dwordx4 v[92:95], v232, s[8:11], s29 offen sc1
    s_sub_u32 s62, s62, 1
    s_cbranch_scc1 .mg_end_1
    s_waitcnt vmcnt(1)
    v_max3_u32 v4, v100, v101, v102
    v_max_u32 v4, v4, v103
    v_cmp_eq_u32 vcc, -1, v4
    s_cbranch_vccz .W_313
.A_312:
    buffer_load_dwordx4 v[100:103], v234, s[8:11], s29 offen sc1
    s_waitcnt vmcnt(1)
    v_max3_u32 v4, v92, v93, v94
    v_max_u32 v4, v4, v95
    v_cmp_eq_u32 vcc, -1, v4
    s_cbranch_vccnz .A_318
.W_319:
    v_mfma_f32_16x16x32_bf16 v[208:211], v[132:135], v[92:95], v[208:211]
    s_waitcnt vmcnt(0)
    v_max3_u32 v4, v100, v101, v102
    v_max_u32 v4, v4, v103
    v_mfma_f32_16x16x32_bf16 v[212:215], v[148:151], v[92:95], v[212:215]
    v_cmp_eq_u32 vcc, -1, v4
    v_mfma_f32_16x16x32_bf16 v[216:219], v[92:95], v[92:95], v[216:219]
    s_cbranch_vccz .W_227
    s_branch .A_226
.A_320:
    buffer_load_dwordx4 v[100:103], v234, s[8:11], s29 offen sc1
    s_sub_u32 s62, s62, 1
    s_cbranch_scc1 .mg_end_1
    s_waitcnt vmcnt(1)
    v_max3_u32 v4, v96, v97, v98
    v_max_u32 v4, v4, v99
    v_cmp_eq_u32 vcc, -1, v4
    s_cbranch_vccz .W_225
.A_224:
    buffer_load_dwordx4 v[96:99], v233, s[8:11], s29 offen sc1
    s_waitcnt vmcnt(1)
    v_max3_u32 v4, v100, v101, v102
    v_max_u32 v4, v4, v103
    v_cmp_eq_u32 vcc, -1, v4
    s_cbranch_vccnz .A_320
.W_321:
    v_mfma_f32_16x16x32_bf16 v[208:211], v[140:143], v[100:103], v[208:211]
    s_waitcnt vmcnt(0)
    v_max3_u32 v4, v96, v97, v98
    v_max_u32 v4, v4, v99
    v_mfma_f32_16x16x32_bf16 v[212:215], v[156:159], v[100:103], v[212:215]
    v_cmp_eq_u32 vcc, -1, v4
    v_mfma_f32_16x16x32_bf16 v[216:219], v[100:103], v[100:103], v[216:219]
    s_cbranch_vccz .W_311
    s_branch .A_310
.A_314:
    buffer_load_dwordx4 v[92:95], v232, s[8:11], s29 offen sc1
    s_sub_u32 s62, s62, 1
    s_cbranch_scc1 .mg_end_1
    s_waitcnt vmcnt(1)
    v_max3_u32 v4, v92, v93, v94
    v_max_u32 v4, v4, v95
    v_cmp_eq_u32 vcc, -1, v4
    s_cbranch_vccnz .A_314
    v_mfma_f32_16x16x32_bf16 v[208:211], v[132:135], v[92:95], v[208:211]
    v_mfma_f32_16x16x32_bf16 v[212:215], v[148:151], v[92:95], v[212:215]
    v_mfma_f32_16x16x32_bf16 v[216:219], v[92:95], v[92:95], v[216:219]
    s_branch .mj_221
.A_310:
    buffer_load_dwordx4 v[96:99], v233, s[8:11], s29 offen sc1
    s_sub_u32 s62, s62, 1
    s_cbranch_scc1 .mg_end_1
    s_waitcnt vmcnt(1)
    v_max3_u32 v4, v96, v97, v98
    v_max_u32 v4, v4, v99
    v_cmp_eq_u32 vcc, -1, v4
    s_cbranch_vccnz .A_310
    v_mfma_f32_16x16x32_bf16 v[208:211], v[136:139], v[96:99], v[208:211]
    v_mfma_f32_16x16x32_bf16 v[212:215], v[152:155], v[96:99], v[212:215]
    v_mfma_f32_16x16x32_bf16 v[216:219], v[96:99], v[96:99], v[216:219]
    s_branch .mj_221
.A_226:
    buffer_load_dwordx4 v[100:103], v234, s[8:11], s29 offen sc1
    s_sub_u32 s62, s62, 1
    s_cbranch_scc1 .mg_end_1
    s_waitcnt vmcnt(1)
    v_max3_u32 v4, v100, v101, v102
    v_max_u32 v4, v4, v103
    v_cmp_eq_u32 vcc, -1, v4
    s_cbranch_vccnz .A_226
    v_mfma_f32_16x16x32_bf16 v[208:211], v[140:143], v[100:103], v[208:211]
    v_mfma_f32_16x16x32_bf16 v[212:215], v[156:159], v[100:103], v[212:215]
    v_mfma_f32_16x16x32_bf16 v[216:219], v[100:103], v[100:103], v[216:219]
    s_branch .mj_221
.kf_234:
    s_mov_b32 s62, 0
    s_mov_b64 exec, 3
.wf_322:
    buffer_load_dword v244, v253, s[8:11], s89 offen sc1
    s_waitcnt vmcnt(0)
    v_cmp_gt_u32 vcc, s6, v244
    s_cbranch_vccz .wfd_323
    s_sleep 2
    s_add_u32 s62, s62, 1
    s_cmp_gt_u32 s62, 0x400000
    s_cbranch_scc1 .mg_end_1
    s_branch .wf_322

.wfd_323:
    s_mov_b64 exec, -1
    v_readlane_b32 s4, v244, 0
    v_readlane_b32 s93, v244, 1
    s_min_u32 s93, s93, s4
    s_mov_b32 s62, 0x1000000
    s_branch .kb_235
.A_324:
    buffer_load_dwordx4 v[216:219], v246, s[8:11], s32 offen offset:0 sc1
    buffer_load_dwordx4 v[220:223], v246, s[8:11], s32 offen offset:1024 sc1
    s_sub_u32 s62, s62, 1
    s_cbranch_scc1 .mg_end_1
    s_waitcnt vmcnt(6)
    v_max3_u32 v4, v192, v193, v194
    v_max3_u32 v5, v195, v196, v197
    v_max3_u32 v4, v4, v198, v199
    v_max_u32 v4, v4, v5
    v_cmp_eq_u32 vcc, -1, v4
    s_cbranch_vccz .W_238
.A_237:
    buffer_load_dwordx4 v[192:195], v243, s[8:11], s32 offen offset:0 sc1
    buffer_load_dwordx4 v[196:199], v243, s[8:11], s32 offen offset:1024 sc1
    s_waitcnt vmcnt(6)
    v_max3_u32 v4, v200, v201, v202
    v_max3_u32 v5, v203, v204, v205
    v_max3_u32 v4, v4, v206, v207
    v_max_u32 v4, v4, v5
    v_cmp_eq_u32 vcc, -1, v4
    s_cbranch_vccz .W_325
.A_326:
    buffer_load_dwordx4 v[200:203], v252, s[8:11], s32 offen offset:0 sc1
    buffer_load_dwordx4 v[204:207], v252, s[8:11], s32 offen offset:1024 sc1
    s_waitcnt vmcnt(6)
    v_max3_u32 v4, v208, v209, v210
    v_max3_u32 v5, v211, v212, v213
    v_max3_u32 v4, v4, v214, v215
    v_max_u32 v4, v4, v5
    v_cmp_eq_u32 vcc, -1, v4
    s_cbranch_vccz .W_327
.A_328:
    buffer_load_dwordx4 v[208:211], v254, s[8:11], s32 offen offset:0 sc1
    buffer_load_dwordx4 v[212:215], v254, s[8:11], s32 offen offset:1024 sc1
    s_waitcnt vmcnt(6)
    v_max3_u32 v4, v216, v217, v218
    v_max3_u32 v5, v219, v220, v221
    v_max3_u32 v4, v4, v222, v223
    v_max_u32 v4, v4, v5
    v_cmp_eq_u32 vcc, -1, v4
    s_cbranch_vccnz .A_324
.W_329:
    v_smfmac_f32_16x16x64_bf16 v[76:79], v[216:219], v[140:147], v9
    v_smfmac_f32_16x16x64_bf16 v[80:83], v[216:219], v[172:179], v9
    s_waitcnt vmcnt(4)
    v_max3_u32 v4, v192, v193, v194
    v_max3_u32 v5, v195, v196, v197
    v_max3_u32 v4, v4, v198, v199
    v_smfmac_f32_16x16x64_bf16 v[76:79], v[220:223], v[148:155], v9
    v_max_u32 v4, v4, v5
    v_cmp_eq_u32 vcc, -1, v4
    v_smfmac_f32_16x16x64_bf16 v[80:83], v[220:223], v[180:187], v9
    s_cbranch_vccnz .A_330
.W_331:
    v_smfmac_f32_16x16x64_bf16 v[76:79], v[192:195], a[192:199], v9
    v_smfmac_f32_16x16x64_bf16 v[80:83], v[192:195], a[224:231], v9
    s_waitcnt vmcnt(2)
    v_max3_u32 v4, v200, v201, v202
    v_max3_u32 v5, v203, v204, v205
    v_max3_u32 v4, v4, v206, v207
    v_smfmac_f32_16x16x64_bf16 v[76:79], v[196:199], a[200:207], v9
    v_max_u32 v4, v4, v5
    v_cmp_eq_u32 vcc, -1, v4
    v_smfmac_f32_16x16x64_bf16 v[80:83], v[196:199], a[232:239], v9
    s_cbranch_vccnz .A_332
.W_333:
    v_smfmac_f32_16x16x64_bf16 v[76:79], v[200:203], a[208:215], v9
    v_smfmac_f32_16x16x64_bf16 v[80:83], v[200:203], a[240:247], v9
    s_waitcnt vmcnt(0)
    v_max3_u32 v4, v208, v209, v210
    v_max3_u32 v5, v211, v212, v213
    v_max3_u32 v4, v4, v214, v215
    v_smfmac_f32_16x16x64_bf16 v[76:79], v[204:207], a[216:223], v9
    v_max_u32 v4, v4, v5
    v_cmp_eq_u32 vcc, -1, v4
    v_smfmac_f32_16x16x64_bf16 v[80:83], v[204:207], a[248:255], v9
    s_cbranch_vccnz .A_334
.W_335:
    v_smfmac_f32_16x16x64_bf16 v[76:79], v[208:211], v[124:131], v9
    v_smfmac_f32_16x16x64_bf16 v[80:83], v[208:211], v[156:163], v9
    v_smfmac_f32_16x16x64_bf16 v[76:79], v[212:215], v[132:139], v9
    v_smfmac_f32_16x16x64_bf16 v[80:83], v[212:215], v[164:171], v9
    s_branch .mj_236
.W_325:
    v_smfmac_f32_16x16x64_bf16 v[76:79], v[200:203], a[208:215], v9
    v_smfmac_f32_16x16x64_bf16 v[80:83], v[200:203], a[240:247], v9
    s_waitcnt vmcnt(4)
    v_max3_u32 v4, v208, v209, v210
    v_max3_u32 v5, v211, v212, v213
    v_max3_u32 v4, v4, v214, v215
    v_smfmac_f32_16x16x64_bf16 v[76:79], v[204:207], a[216:223], v9
    v_max_u32 v4, v4, v5
    v_cmp_eq_u32 vcc, -1, v4
    v_smfmac_f32_16x16x64_bf16 v[80:83], v[204:207], a[248:255], v9
    s_cbranch_vccnz .A_336
.W_337:
    v_smfmac_f32_16x16x64_bf16 v[76:79], v[208:211], v[124:131], v9
    v_smfmac_f32_16x16x64_bf16 v[80:83], v[208:211], v[156:163], v9
    s_waitcnt vmcnt(2)
    v_max3_u32 v4, v216, v217, v218
    v_max3_u32 v5, v219, v220, v221
    v_max3_u32 v4, v4, v222, v223
    v_smfmac_f32_16x16x64_bf16 v[76:79], v[212:215], v[132:139], v9
    v_max_u32 v4, v4, v5
    v_cmp_eq_u32 vcc, -1, v4
    v_smfmac_f32_16x16x64_bf16 v[80:83], v[212:215], v[164:171], v9
    s_cbranch_vccnz .A_338
.W_339:
    v_smfmac_f32_16x16x64_bf16 v[76:79], v[216:219], v[140:147], v9
    v_smfmac_f32_16x16x64_bf16 v[80:83], v[216:219], v[172:179], v9
    s_waitcnt vmcnt(0)
    v_max3_u32 v4, v192, v193, v194
    v_max3_u32 v5, v195, v196, v197
    v_max3_u32 v4, v4, v198, v199
    v_smfmac_f32_16x16x64_bf16 v[76:79], v[220:223], v[148:155], v9
    v_max_u32 v4, v4, v5
    v_cmp_eq_u32 vcc, -1, v4
    v_smfmac_f32_16x16x64_bf16 v[80:83], v[220:223], v[180:187], v9
    s_cbranch_vccnz .A_340
.W_341:
    v_smfmac_f32_16x16x64_bf16 v[76:79], v[192:195], a[192:199], v9
    v_smfmac_f32_16x16x64_bf16 v[80:83], v[192:195], a[224:231], v9
    v_smfmac_f32_16x16x64_bf16 v[76:79], v[196:199], a[200:207], v9
    v_smfmac_f32_16x16x64_bf16 v[80:83], v[196:199], a[232:239], v9
    s_branch .mj_236
.W_327:
    v_smfmac_f32_16x16x64_bf16 v[76:79], v[208:211], v[124:131], v9
    v_smfmac_f32_16x16x64_bf16 v[80:83], v[208:211], v[156:163], v9
    s_waitcnt vmcnt(4)
    v_max3_u32 v4, v216, v217, v218
    v_max3_u32 v5, v219, v220, v221
    v_max3_u32 v4, v4, v222, v223
    v_smfmac_f32_16x16x64_bf16 v[76:79], v[212:215], v[132:139], v9
    v_max_u32 v4, v4, v5
    v_cmp_eq_u32 vcc, -1, v4
    v_smfmac_f32_16x16x64_bf16 v[80:83], v[212:215], v[164:171], v9
    s_cbranch_vccnz .A_342
.W_343:
    v_smfmac_f32_16x16x64_bf16 v[76:79], v[216:219], v[140:147], v9
    v_smfmac_f32_16x16x64_bf16 v[80:83], v[216:219], v[172:179], v9
    s_waitcnt vmcnt(2)
    v_max3_u32 v4, v192, v193, v194
    v_max3_u32 v5, v195, v196, v197
    v_max3_u32 v4, v4, v198, v199
    v_smfmac_f32_16x16x64_bf16 v[76:79], v[220:223], v[148:155], v9
    v_max_u32 v4, v4, v5
    v_cmp_eq_u32 vcc, -1, v4
    v_smfmac_f32_16x16x64_bf16 v[80:83], v[220:223], v[180:187], v9
    s_cbranch_vccnz .A_344
.W_345:
    v_smfmac_f32_16x16x64_bf16 v[76:79], v[192:195], a[192:199], v9
    v_smfmac_f32_16x16x64_bf16 v[80:83], v[192:195], a[224:231], v9
    s_waitcnt vmcnt(0)
    v_max3_u32 v4, v200, v201, v202
    v_max3_u32 v5, v203, v204, v205
    v_max3_u32 v4, v4, v206, v207
    v_smfmac_f32_16x16x64_bf16 v[76:79], v[196:199], a[200:207], v9
    v_max_u32 v4, v4, v5
    v_cmp_eq_u32 vcc, -1, v4
    v_smfmac_f32_16x16x64_bf16 v[80:83], v[196:199], a[232:239], v9
    s_cbranch_vccnz .A_346
.W_347:
    v_smfmac_f32_16x16x64_bf16 v[76:79], v[200:203], a[208:215], v9
    v_smfmac_f32_16x16x64_bf16 v[80:83], v[200:203], a[240:247], v9
    v_smfmac_f32_16x16x64_bf16 v[76:79], v[204:207], a[216:223], v9
    v_smfmac_f32_16x16x64_bf16 v[80:83], v[204:207], a[248:255], v9
    s_branch .mj_236
.A_348:
    buffer_load_dwordx4 v[208:211], v254, s[8:11], s32 offen offset:0 sc1
    buffer_load_dwordx4 v[212:215], v254, s[8:11], s32 offen offset:1024 sc1
    s_sub_u32 s62, s62, 1
    s_cbranch_scc1 .mg_end_1
    s_waitcnt vmcnt(4)
    v_max3_u32 v4, v192, v193, v194
    v_max3_u32 v5, v195, v196, v197
    v_max3_u32 v4, v4, v198, v199
    v_max_u32 v4, v4, v5
    v_cmp_eq_u32 vcc, -1, v4
    s_cbranch_vccz .W_331
.A_330:
    buffer_load_dwordx4 v[192:195], v243, s[8:11], s32 offen offset:0 sc1
    buffer_load_dwordx4 v[196:199], v243, s[8:11], s32 offen offset:1024 sc1
    s_waitcnt vmcnt(4)
    v_max3_u32 v4, v200, v201, v202
    v_max3_u32 v5, v203, v204, v205
    v_max3_u32 v4, v4, v206, v207
    v_max_u32 v4, v4, v5
    v_cmp_eq_u32 vcc, -1, v4
    s_cbranch_vccz .W_349
.A_350:
    buffer_load_dwordx4 v[200:203], v252, s[8:11], s32 offen offset:0 sc1
    buffer_load_dwordx4 v[204:207], v252, s[8:11], s32 offen offset:1024 sc1
    s_waitcnt vmcnt(4)
    v_max3_u32 v4, v208, v209, v210
    v_max3_u32 v5, v211, v212, v213
    v_max3_u32 v4, v4, v214, v215
    v_max_u32 v4, v4, v5
    v_cmp_eq_u32 vcc, -1, v4
    s_cbranch_vccnz .A_348
.W_351:
    v_smfmac_f32_16x16x64_bf16 v[76:79], v[208:211], v[124:131], v9
    v_smfmac_f32_16x16x64_bf16 v[80:83], v[208:211], v[156:163], v9
    s_waitcnt vmcnt(2)
    v_max3_u32 v4, v192, v193, v194
    v_max3_u32 v5, v195, v196, v197
    v_max3_u32 v4, v4, v198, v199
    v_smfmac_f32_16x16x64_bf16 v[76:79], v[212:215], v[132:139], v9
    v_max_u32 v4, v4, v5
    v_cmp_eq_u32 vcc, -1, v4
    v_smfmac_f32_16x16x64_bf16 v[80:83], v[212:215], v[164:171], v9
    s_cbranch_vccz .W_345
    s_branch .A_344
.W_349:
    v_smfmac_f32_16x16x64_bf16 v[76:79], v[200:203], a[208:215], v9
    v_smfmac_f32_16x16x64_bf16 v[80:83], v[200:203], a[240:247], v9
    s_waitcnt vmcnt(2)
    v_max3_u32 v4, v208, v209, v210
    v_max3_u32 v5, v211, v212, v213
    v_max3_u32 v4, v4, v214, v215
    v_smfmac_f32_16x16x64_bf16 v[76:79], v[204:207], a[216:223], v9
    v_max_u32 v4, v4, v5
    v_cmp_eq_u32 vcc, -1, v4
    v_smfmac_f32_16x16x64_bf16 v[80:83], v[204:207], a[248:255], v9
    s_cbranch_vccnz .A_352
.W_353:
    v_smfmac_f32_16x16x64_bf16 v[76:79], v[208:211], v[124:131], v9
    v_smfmac_f32_16x16x64_bf16 v[80:83], v[208:211], v[156:163], v9
    s_waitcnt vmcnt(0)
    v_max3_u32 v4, v192, v193, v194
    v_max3_u32 v5, v195, v196, v197
    v_max3_u32 v4, v4, v198, v199
    v_smfmac_f32_16x16x64_bf16 v[76:79], v[212:215], v[132:139], v9
    v_max_u32 v4, v4, v5
    v_cmp_eq_u32 vcc, -1, v4
    v_smfmac_f32_16x16x64_bf16 v[80:83], v[212:215], v[164:171], v9
    s_cbranch_vccz .W_341
    s_branch .A_340
.A_354:
    buffer_load_dwordx4 v[200:203], v252, s[8:11], s32 offen offset:0 sc1
    buffer_load_dwordx4 v[204:207], v252, s[8:11], s32 offen offset:1024 sc1
    s_sub_u32 s62, s62, 1
    s_cbranch_scc1 .mg_end_1
    s_waitcnt vmcnt(4)
    v_max3_u32 v4, v216, v217, v218
    v_max3_u32 v5, v219, v220, v221
    v_max3_u32 v4, v4, v222, v223
    v_max_u32 v4, v4, v5
    v_cmp_eq_u32 vcc, -1, v4
    s_cbranch_vccz .W_343
.A_342:
    buffer_load_dwordx4 v[216:219], v246, s[8:11], s32 offen offset:0 sc1
    buffer_load_dwordx4 v[220:223], v246, s[8:11], s32 offen offset:1024 sc1
    s_waitcnt vmcnt(4)
    v_max3_u32 v4, v192, v193, v194
    v_max3_u32 v5, v195, v196, v197
    v_max3_u32 v4, v4, v198, v199
    v_max_u32 v4, v4, v5
    v_cmp_eq_u32 vcc, -1, v4
    s_cbranch_vccz .W_355
.A_356:
    buffer_load_dwordx4 v[192:195], v243, s[8:11], s32 offen offset:0 sc1
    buffer_load_dwordx4 v[196:199], v243, s[8:11], s32 offen offset:1024 sc1
    s_waitcnt vmcnt(4)
    v_max3_u32 v4, v200, v201, v202
    v_max3_u32 v5, v203, v204, v205
    v_max3_u32 v4, v4, v206, v207
    v_max_u32 v4, v4, v5
    v_cmp_eq_u32 vcc, -1, v4
    s_cbranch_vccnz .A_354
.W_357:
    v_smfmac_f32_16x16x64_bf16 v[76:79], v[200:203], a[208:215], v9
    v_smfmac_f32_16x16x64_bf16 v[80:83], v[200:203], a[240:247], v9
    s_waitcnt vmcnt(2)
    v_max3_u32 v4, v216, v217, v218
    v_max3_u32 v5, v219, v220, v221
    v_max3_u32 v4, v4, v222, v223
    v_smfmac_f32_16x16x64_bf16 v[76:79], v[204:207], a[216:223], v9
    v_max_u32 v4, v4, v5
    v_cmp_eq_u32 vcc, -1, v4
    v_smfmac_f32_16x16x64_bf16 v[80:83], v[204:207], a[248:255], v9
    s_cbranch_vccz .W_339
    s_branch .A_338
.W_355:
    v_smfmac_f32_16x16x64_bf16 v[76:79], v[192:195], a[192:199], v9
    v_smfmac_f32_16x16x64_bf16 v[80:83], v[192:195], a[224:231], v9
    s_waitcnt vmcnt(2)
    v_max3_u32 v4, v200, v201, v202
    v_max3_u32 v5, v203, v204, v205
    v_max3_u32 v4, v4, v206, v207
    v_smfmac_f32_16x16x64_bf16 v[76:79], v[196:199], a[200:207], v9
    v_max_u32 v4, v4, v5
    v_cmp_eq_u32 vcc, -1, v4
    v_smfmac_f32_16x16x64_bf16 v[80:83], v[196:199], a[232:239], v9
    s_cbranch_vccnz .A_358
.W_359:
    v_smfmac_f32_16x16x64_bf16 v[76:79], v[200:203], a[208:215], v9
    v_smfmac_f32_16x16x64_bf16 v[80:83], v[200:203], a[240:247], v9
    s_waitcnt vmcnt(0)
    v_max3_u32 v4, v216, v217, v218
    v_max3_u32 v5, v219, v220, v221
    v_max3_u32 v4, v4, v222, v223
    v_smfmac_f32_16x16x64_bf16 v[76:79], v[204:207], a[216:223], v9
    v_max_u32 v4, v4, v5
    v_cmp_eq_u32 vcc, -1, v4
    v_smfmac_f32_16x16x64_bf16 v[80:83], v[204:207], a[248:255], v9
    s_cbranch_vccz .W_244
    s_branch .A_243
.A_360:
    buffer_load_dwordx4 v[216:219], v246, s[8:11], s32 offen offset:0 sc1
    buffer_load_dwordx4 v[220:223], v246, s[8:11], s32 offen offset:1024 sc1
    s_sub_u32 s62, s62, 1
    s_cbranch_scc1 .mg_end_1
    s_waitcnt vmcnt(4)
    v_max3_u32 v4, v192, v193, v194
    v_max3_u32 v5, v195, v196, v197
    v_max3_u32 v4, v4, v198, v199
    v_max_u32 v4, v4, v5
    v_cmp_eq_u32 vcc, -1, v4
    s_cbranch_vccz .W_361
.A_362:
    buffer_load_dwordx4 v[192:195], v243, s[8:11], s32 offen offset:0 sc1
    buffer_load_dwordx4 v[196:199], v243, s[8:11], s32 offen offset:1024 sc1
    s_waitcnt vmcnt(4)
    v_max3_u32 v4, v208, v209, v210
    v_max3_u32 v5, v211, v212, v213
    v_max3_u32 v4, v4, v214, v215
    v_max_u32 v4, v4, v5
    v_cmp_eq_u32 vcc, -1, v4
    s_cbranch_vccz .W_337
.A_336:
    buffer_load_dwordx4 v[208:211], v254, s[8:11], s32 offen offset:0 sc1
    buffer_load_dwordx4 v[212:215], v254, s[8:11], s32 offen offset:1024 sc1
    s_waitcnt vmcnt(4)
    v_max3_u32 v4, v216, v217, v218
    v_max3_u32 v5, v219, v220, v221
    v_max3_u32 v4, v4, v222, v223
    v_max_u32 v4, v4, v5
    v_cmp_eq_u32 vcc, -1, v4
    s_cbranch_vccnz .A_360
.W_363:
    v_smfmac_f32_16x16x64_bf16 v[76:79], v[216:219], v[140:147], v9
    v_smfmac_f32_16x16x64_bf16 v[80:83], v[216:219], v[172:179], v9
    s_waitcnt vmcnt(2)
    v_max3_u32 v4, v192, v193, v194
    v_max3_u32 v5, v195, v196, v197
    v_max3_u32 v4, v4, v198, v199
    v_smfmac_f32_16x16x64_bf16 v[76:79], v[220:223], v[148:155], v9
    v_max_u32 v4, v4, v5
    v_cmp_eq_u32 vcc, -1, v4
    v_smfmac_f32_16x16x64_bf16 v[80:83], v[220:223], v[180:187], v9
    s_cbranch_vccnz .A_364
.W_365:
    v_smfmac_f32_16x16x64_bf16 v[76:79], v[192:195], a[192:199], v9
    v_smfmac_f32_16x16x64_bf16 v[80:83], v[192:195], a[224:231], v9
    s_waitcnt vmcnt(0)
    v_max3_u32 v4, v208, v209, v210
    v_max3_u32 v5, v211, v212, v213
    v_max3_u32 v4, v4, v214, v215
    v_smfmac_f32_16x16x64_bf16 v[76:79], v[196:199], a[200:207], v9
    v_max_u32 v4, v4, v5
    v_cmp_eq_u32 vcc, -1, v4
    v_smfmac_f32_16x16x64_bf16 v[80:83], v[196:199], a[232:239], v9
    s_cbranch_vccz .W_335
    s_branch .A_334
.W_361:
    v_smfmac_f32_16x16x64_bf16 v[76:79], v[192:195], a[192:199], v9
    v_smfmac_f32_16x16x64_bf16 v[80:83], v[192:195], a[224:231], v9
    s_waitcnt vmcnt(2)
    v_max3_u32 v4, v208, v209, v210
    v_max3_u32 v5, v211, v212, v213
    v_max3_u32 v4, v4, v214, v215
    v_smfmac_f32_16x16x64_bf16 v[76:79], v[196:199], a[200:207], v9
    v_max_u32 v4, v4, v5
    v_cmp_eq_u32 vcc, -1, v4
    v_smfmac_f32_16x16x64_bf16 v[80:83], v[196:199], a[232:239], v9
    s_cbranch_vccz .W_242
    s_branch .A_241
.A_366:
    buffer_load_dwordx4 v[216:219], v246, s[8:11], s32 offen offset:0 sc1
    buffer_load_dwordx4 v[220:223], v246, s[8:11], s32 offen offset:1024 sc1
    s_sub_u32 s62, s62, 1
    s_cbranch_scc1 .mg_end_1
    s_waitcnt vmcnt(4)
    v_max3_u32 v4, v200, v201, v202
    v_max3_u32 v5, v203, v204, v205
    v_max3_u32 v4, v4, v206, v207
    v_max_u32 v4, v4, v5
    v_cmp_eq_u32 vcc, -1, v4
    s_cbranch_vccz .W_240
.A_239:
    buffer_load_dwordx4 v[200:203], v252, s[8:11], s32 offen offset:0 sc1
    buffer_load_dwordx4 v[204:207], v252, s[8:11], s32 offen offset:1024 sc1
    s_waitcnt vmcnt(4)
    v_max3_u32 v4, v208, v209, v210
    v_max3_u32 v5, v211, v212, v213
    v_max3_u32 v4, v4, v214, v215
    v_max_u32 v4, v4, v5
    v_cmp_eq_u32 vcc, -1, v4
    s_cbranch_vccz .W_367
.A_368:
    buffer_load_dwordx4 v[208:211], v254, s[8:11], s32 offen offset:0 sc1
    buffer_load_dwordx4 v[212:215], v254, s[8:11], s32 offen offset:1024 sc1
    s_waitcnt vmcnt(4)
    v_max3_u32 v4, v216, v217, v218
    v_max3_u32 v5, v219, v220, v221
    v_max3_u32 v4, v4, v222, v223
    v_max_u32 v4, v4, v5
    v_cmp_eq_u32 vcc, -1, v4
    s_cbranch_vccnz .A_366
.W_369:
    v_smfmac_f32_16x16x64_bf16 v[76:79], v[216:219], v[140:147], v9
    v_smfmac_f32_16x16x64_bf16 v[80:83], v[216:219], v[172:179], v9
    s_waitcnt vmcnt(2)
    v_max3_u32 v4, v200, v201, v202
    v_max3_u32 v5, v203, v204, v205
    v_max3_u32 v4, v4, v206, v207
    v_smfmac_f32_16x16x64_bf16 v[76:79], v[220:223], v[148:155], v9
    v_max_u32 v4, v4, v5
    v_cmp_eq_u32 vcc, -1, v4
    v_smfmac_f32_16x16x64_bf16 v[80:83], v[220:223], v[180:187], v9
    s_cbranch_vccz .W_333
    s_branch .A_332
.W_367:
    v_smfmac_f32_16x16x64_bf16 v[76:79], v[208:211], v[124:131], v9
    v_smfmac_f32_16x16x64_bf16 v[80:83], v[208:211], v[156:163], v9
    s_waitcnt vmcnt(2)
    v_max3_u32 v4, v216, v217, v218
    v_max3_u32 v5, v219, v220, v221
    v_max3_u32 v4, v4, v222, v223
    v_smfmac_f32_16x16x64_bf16 v[76:79], v[212:215], v[132:139], v9
    v_max_u32 v4, v4, v5
    v_cmp_eq_u32 vcc, -1, v4
    v_smfmac_f32_16x16x64_bf16 v[80:83], v[212:215], v[164:171], v9
    s_cbranch_vccnz .A_370
.W_371:
    v_smfmac_f32_16x16x64_bf16 v[76:79], v[216:219], v[140:147], v9
    v_smfmac_f32_16x16x64_bf16 v[80:83], v[216:219], v[172:179], v9
    s_waitcnt vmcnt(0)
    v_max3_u32 v4, v200, v201, v202
    v_max3_u32 v5, v203, v204, v205
    v_max3_u32 v4, v4, v206, v207
    v_smfmac_f32_16x16x64_bf16 v[76:79], v[220:223], v[148:155], v9
    v_max_u32 v4, v4, v5
    v_cmp_eq_u32 vcc, -1, v4
    v_smfmac_f32_16x16x64_bf16 v[80:83], v[220:223], v[180:187], v9
    s_cbranch_vccz .W_347
    s_branch .A_346
.A_372:
    buffer_load_dwordx4 v[200:203], v252, s[8:11], s32 offen offset:0 sc1
    buffer_load_dwordx4 v[204:207], v252, s[8:11], s32 offen offset:1024 sc1
    s_sub_u32 s62, s62, 1
    s_cbranch_scc1 .mg_end_1
    s_waitcnt vmcnt(2)
    v_max3_u32 v4, v192, v193, v194
    v_max3_u32 v5, v195, v196, v197
    v_max3_u32 v4, v4, v198, v199
    v_max_u32 v4, v4, v5
    v_cmp_eq_u32 vcc, -1, v4
    s_cbranch_vccz .W_345
.A_344:
    buffer_load_dwordx4 v[192:195], v243, s[8:11], s32 offen offset:0 sc1
    buffer_load_dwordx4 v[196:199], v243, s[8:11], s32 offen offset:1024 sc1
    s_waitcnt vmcnt(2)
    v_max3_u32 v4, v200, v201, v202
    v_max3_u32 v5, v203, v204, v205
    v_max3_u32 v4, v4, v206, v207
    v_max_u32 v4, v4, v5
    v_cmp_eq_u32 vcc, -1, v4
    s_cbranch_vccnz .A_372
.W_373:
    v_smfmac_f32_16x16x64_bf16 v[76:79], v[200:203], a[208:215], v9
    v_smfmac_f32_16x16x64_bf16 v[80:83], v[200:203], a[240:247], v9
    s_waitcnt vmcnt(0)
    v_max3_u32 v4, v192, v193, v194
    v_max3_u32 v5, v195, v196, v197
    v_max3_u32 v4, v4, v198, v199
    v_smfmac_f32_16x16x64_bf16 v[76:79], v[204:207], a[216:223], v9
    v_max_u32 v4, v4, v5
    v_cmp_eq_u32 vcc, -1, v4
    v_smfmac_f32_16x16x64_bf16 v[80:83], v[204:207], a[248:255], v9
    s_cbranch_vccz .W_341
    s_branch .A_340
.A_352:
    buffer_load_dwordx4 v[208:211], v254, s[8:11], s32 offen offset:0 sc1
    buffer_load_dwordx4 v[212:215], v254, s[8:11], s32 offen offset:1024 sc1
    s_sub_u32 s62, s62, 1
    s_cbranch_scc1 .mg_end_1
    s_waitcnt vmcnt(2)
    v_max3_u32 v4, v192, v193, v194
    v_max3_u32 v5, v195, v196, v197
    v_max3_u32 v4, v4, v198, v199
    v_max_u32 v4, v4, v5
    v_cmp_eq_u32 vcc, -1, v4
    s_cbranch_vccz .W_365
.A_364:
    buffer_load_dwordx4 v[192:195], v243, s[8:11], s32 offen offset:0 sc1
    buffer_load_dwordx4 v[196:199], v243, s[8:11], s32 offen offset:1024 sc1
    s_waitcnt vmcnt(2)
    v_max3_u32 v4, v208, v209, v210
    v_max3_u32 v5, v211, v212, v213
    v_max3_u32 v4, v4, v214, v215
    v_max_u32 v4, v4, v5
    v_cmp_eq_u32 vcc, -1, v4
    s_cbranch_vccnz .A_352
    s_branch .W_353
.A_374:
    buffer_load_dwordx4 v[192:195], v243, s[8:11], s32 offen offset:0 sc1
    buffer_load_dwordx4 v[196:199], v243, s[8:11], s32 offen offset:1024 sc1
    s_sub_u32 s62, s62, 1
    s_cbranch_scc1 .mg_end_1
    s_waitcnt vmcnt(2)
    v_max3_u32 v4, v216, v217, v218
    v_max3_u32 v5, v219, v220, v221
    v_max3_u32 v4, v4, v222, v223
    v_max_u32 v4, v4, v5
    v_cmp_eq_u32 vcc, -1, v4
    s_cbranch_vccz .W_339
.A_338:
    buffer_load_dwordx4 v[216:219], v246, s[8:11], s32 offen offset:0 sc1
    buffer_load_dwordx4 v[220:223], v246, s[8:11], s32 offen offset:1024 sc1
    s_waitcnt vmcnt(2)
    v_max3_u32 v4, v192, v193, v194
    v_max3_u32 v5, v195, v196, v197
    v_max3_u32 v4, v4, v198, v199
    v_max_u32 v4, v4, v5
    v_cmp_eq_u32 vcc, -1, v4
    s_cbranch_vccnz .A_374
.W_375:
    v_smfmac_f32_16x16x64_bf16 v[76:79], v[192:195], a[192:199], v9
    v_smfmac_f32_16x16x64_bf16 v[80:83], v[192:195], a[224:231], v9
    s_waitcnt vmcnt(0)
    v_max3_u32 v4, v216, v217, v218
    v_max3_u32 v5, v219, v220, v221
    v_max3_u32 v4, v4, v222, v223
    v_smfmac_f32_16x16x64_bf16 v[76:79], v[196:199], a[200:207], v9
    v_max_u32 v4, v4, v5
    v_cmp_eq_u32 vcc, -1, v4
    v_smfmac_f32_16x16x64_bf16 v[80:83], v[196:199], a[232:239], v9
    s_cbranch_vccz .W_244
    s_branch .A_243
.A_376:
    buffer_load_dwordx4 v[208:211], v254, s[8:11], s32 offen offset:0 sc1
    buffer_load_dwordx4 v[212:215], v254, s[8:11], s32 offen offset:1024 sc1
    s_sub_u32 s62, s62, 1
    s_cbranch_scc1 .mg_end_1
    s_waitcnt vmcnt(2)
    v_max3_u32 v4, v200, v201, v202
    v_max3_u32 v5, v203, v204, v205
    v_max3_u32 v4, v4, v206, v207
    v_max_u32 v4, v4, v5
    v_cmp_eq_u32 vcc, -1, v4
    s_cbranch_vccz .W_333
.A_332:
    buffer_load_dwordx4 v[200:203], v252, s[8:11], s32 offen offset:0 sc1
    buffer_load_dwordx4 v[204:207], v252, s[8:11], s32 offen offset:1024 sc1
    s_waitcnt vmcnt(2)
    v_max3_u32 v4, v208, v209, v210
    v_max3_u32 v5, v211, v212, v213
    v_max3_u32 v4, v4, v214, v215
    v_max_u32 v4, v4, v5
    v_cmp_eq_u32 vcc, -1, v4
    s_cbranch_vccnz .A_376
.W_377:
    v_smfmac_f32_16x16x64_bf16 v[76:79], v[208:211], v[124:131], v9
    v_smfmac_f32_16x16x64_bf16 v[80:83], v[208:211], v[156:163], v9
    s_waitcnt vmcnt(0)
    v_max3_u32 v4, v200, v201, v202
    v_max3_u32 v5, v203, v204, v205
    v_max3_u32 v4, v4, v206, v207
    v_smfmac_f32_16x16x64_bf16 v[76:79], v[212:215], v[132:139], v9
    v_max_u32 v4, v4, v5
    v_cmp_eq_u32 vcc, -1, v4
    v_smfmac_f32_16x16x64_bf16 v[80:83], v[212:215], v[164:171], v9
    s_cbranch_vccz .W_347
    s_branch .A_346
.A_370:
    buffer_load_dwordx4 v[216:219], v246, s[8:11], s32 offen offset:0 sc1
    buffer_load_dwordx4 v[220:223], v246, s[8:11], s32 offen offset:1024 sc1
    s_sub_u32 s62, s62, 1
    s_cbranch_scc1 .mg_end_1
    s_waitcnt vmcnt(2)
    v_max3_u32 v4, v200, v201, v202
    v_max3_u32 v5, v203, v204, v205
    v_max3_u32 v4, v4, v206, v207
    v_max_u32 v4, v4, v5
    v_cmp_eq_u32 vcc, -1, v4
    s_cbranch_vccz .W_359
.A_358:
    buffer_load_dwordx4 v[200:203], v252, s[8:11], s32 offen offset:0 sc1
    buffer_load_dwordx4 v[204:207], v252, s[8:11], s32 offen offset:1024 sc1
    s_waitcnt vmcnt(2)
    v_max3_u32 v4, v216, v217, v218
    v_max3_u32 v5, v219, v220, v221
    v_max3_u32 v4, v4, v222, v223
    v_max_u32 v4, v4, v5
    v_cmp_eq_u32 vcc, -1, v4
    s_cbranch_vccnz .A_370
    s_branch .W_371
.A_378:
    buffer_load_dwordx4 v[216:219], v246, s[8:11], s32 offen offset:0 sc1
    buffer_load_dwordx4 v[220:223], v246, s[8:11], s32 offen offset:1024 sc1
    s_sub_u32 s62, s62, 1
    s_cbranch_scc1 .mg_end_1
    s_waitcnt vmcnt(2)
    v_max3_u32 v4, v208, v209, v210
    v_max3_u32 v5, v211, v212, v213
    v_max3_u32 v4, v4, v214, v215
    v_max_u32 v4, v4, v5
    v_cmp_eq_u32 vcc, -1, v4
    s_cbranch_vccz .W_242
.A_241:
    buffer_load_dwordx4 v[208:211], v254, s[8:11], s32 offen offset:0 sc1
    buffer_load_dwordx4 v[212:215], v254, s[8:11], s32 offen offset:1024 sc1
    s_waitcnt vmcnt(2)
    v_max3_u32 v4, v216, v217, v218
    v_max3_u32 v5, v219, v220, v221
    v_max3_u32 v4, v4, v222, v223
    v_max_u32 v4, v4, v5
    v_cmp_eq_u32 vcc, -1, v4
    s_cbranch_vccnz .A_378
.W_379:
    v_smfmac_f32_16x16x64_bf16 v[76:79], v[216:219], v[140:147], v9
    v_smfmac_f32_16x16x64_bf16 v[80:83], v[216:219], v[172:179], v9
    s_waitcnt vmcnt(0)
    v_max3_u32 v4, v208, v209, v210
    v_max3_u32 v5, v211, v212, v213
    v_max3_u32 v4, v4, v214, v215
    v_smfmac_f32_16x16x64_bf16 v[76:79], v[220:223], v[148:155], v9
    v_max_u32 v4, v4, v5
    v_cmp_eq_u32 vcc, -1, v4
    v_smfmac_f32_16x16x64_bf16 v[80:83], v[220:223], v[180:187], v9
    s_cbranch_vccz .W_335
    s_branch .A_334
.A_340:
    buffer_load_dwordx4 v[192:195], v243, s[8:11], s32 offen offset:0 sc1
    buffer_load_dwordx4 v[196:199], v243, s[8:11], s32 offen offset:1024 sc1
    s_sub_u32 s62, s62, 1
    s_cbranch_scc1 .mg_end_1
    s_waitcnt vmcnt(2)
    v_max3_u32 v4, v192, v193, v194
    v_max3_u32 v5, v195, v196, v197
    v_max3_u32 v4, v4, v198, v199
    v_max_u32 v4, v4, v5
    v_cmp_eq_u32 vcc, -1, v4
    s_cbranch_vccnz .A_340
    v_smfmac_f32_16x16x64_bf16 v[76:79], v[192:195], a[192:199], v9
    v_smfmac_f32_16x16x64_bf16 v[80:83], v[192:195], a[224:231], v9
    v_smfmac_f32_16x16x64_bf16 v[76:79], v[196:199], a[200:207], v9
    v_smfmac_f32_16x16x64_bf16 v[80:83], v[196:199], a[232:239], v9
    s_branch .mj_236
.A_346:
    buffer_load_dwordx4 v[200:203], v252, s[8:11], s32 offen offset:0 sc1
    buffer_load_dwordx4 v[204:207], v252, s[8:11], s32 offen offset:1024 sc1
    s_sub_u32 s62, s62, 1
    s_cbranch_scc1 .mg_end_1
    s_waitcnt vmcnt(2)
    v_max3_u32 v4, v200, v201, v202
    v_max3_u32 v5, v203, v204, v205
    v_max3_u32 v4, v4, v206, v207
    v_max_u32 v4, v4, v5
    v_cmp_eq_u32 vcc, -1, v4
    s_cbranch_vccnz .A_346
    v_smfmac_f32_16x16x64_bf16 v[76:79], v[200:203], a[208:215], v9
    v_smfmac_f32_16x16x64_bf16 v[80:83], v[200:203], a[240:247], v9
    v_smfmac_f32_16x16x64_bf16 v[76:79], v[204:207], a[216:223], v9
    v_smfmac_f32_16x16x64_bf16 v[80:83], v[204:207], a[248:255], v9
    s_branch .mj_236
.A_334:
    buffer_load_dwordx4 v[208:211], v254, s[8:11], s32 offen offset:0 sc1
    buffer_load_dwordx4 v[212:215], v254, s[8:11], s32 offen offset:1024 sc1
    s_sub_u32 s62, s62, 1
    s_cbranch_scc1 .mg_end_1
    s_waitcnt vmcnt(2)
    v_max3_u32 v4, v208, v209, v210
    v_max3_u32 v5, v211, v212, v213
    v_max3_u32 v4, v4, v214, v215
    v_max_u32 v4, v4, v5
    v_cmp_eq_u32 vcc, -1, v4
    s_cbranch_vccnz .A_334
    v_smfmac_f32_16x16x64_bf16 v[76:79], v[208:211], v[124:131], v9
    v_smfmac_f32_16x16x64_bf16 v[80:83], v[208:211], v[156:163], v9
    v_smfmac_f32_16x16x64_bf16 v[76:79], v[212:215], v[132:139], v9
    v_smfmac_f32_16x16x64_bf16 v[80:83], v[212:215], v[164:171], v9
    s_branch .mj_236
.A_243:
    buffer_load_dwordx4 v[216:219], v246, s[8:11], s32 offen offset:0 sc1
    buffer_load_dwordx4 v[220:223], v246, s[8:11], s32 offen offset:1024 sc1
    s_sub_u32 s62, s62, 1
    s_cbranch_scc1 .mg_end_1
    s_waitcnt vmcnt(2)
    v_max3_u32 v4, v216, v217, v218
    v_max3_u32 v5, v219, v220, v221
    v_max3_u32 v4, v4, v222, v223
    v_max_u32 v4, v4, v5
    v_cmp_eq_u32 vcc, -1, v4
    s_cbranch_vccnz .A_243
    v_smfmac_f32_16x16x64_bf16 v[76:79], v[216:219], v[140:147], v9
    v_smfmac_f32_16x16x64_bf16 v[80:83], v[216:219], v[172:179], v9
    v_smfmac_f32_16x16x64_bf16 v[76:79], v[220:223], v[148:155], v9
    v_smfmac_f32_16x16x64_bf16 v[80:83], v[220:223], v[180:187], v9
    s_branch .mj_236
.sk_246:
    s_mov_b64 exec, s[66:67]
    buffer_store_dwordx4 v[88:91], v11, s[8:11], s36 offen sc1
    s_mov_b64 exec, s[56:57]
    buffer_store_dwordx4 v[172:175], v12, s[8:11], s36 offen sc1
    s_mov_b64 exec, -1

    s_cmp_lt_u32 s28, 63
    s_cbranch_scc1 .sb_247
    s_branch .rec_fin_6
.rec_fin_6:
    s_mov_b64 exec, -1
    s_endpgm
.mg_bg_2:
    s_sub_u32 s91, s25, 4
    s_lshl_b32 s90, s91, 5
    s_add_u32 s90, s90, s26
    s_cmp_ge_u32 s26, 24
    s_cbranch_scc1 .cvrole_380
    s_lshr_b32 s30, s26, 3
    s_sub_u32 s30, 2, s30
    s_and_b32 s31, s26, 7
    s_lshl_b32 s4, s91, 3
    s_add_u32 s31, s31, s4

    s_lshl_b32 s4, s30, 5
    s_add_u32 s4, s4, s31
    s_lshl_b32 s4, s4, 8
    s_add_u32 s4, s4, 92274688
    v_mov_b32 v4, 0
    s_mov_b64 exec, 1
    buffer_store_dword v4, v4, s[8:11], s4 offen sc1
    s_mov_b64 exec, -1

    s_load_dwordx2 s[40:41], s[0:1], 0
    s_load_dwordx4 s[44:47], s[0:1], 64
    s_load_dwordx2 s[42:43], s[0:1], 80

    v_and_b32 v1, 63, v0
    v_and_b32 v2, 15, v1
    v_lshrrev_b32 v3, 4, v1

    s_lshl_b32 s28, s31, 8
    s_waitcnt lgkmcnt(0)
    s_mov_b64 s[48:49], s[42:43]
    s_cmp_eq_u32 s30, 0
    s_cselect_b64 s[42:43], s[44:45], s[42:43]
    s_cmp_eq_u32 s30, 1
    s_cselect_b64 s[42:43], s[46:47], s[42:43]

    s_mov_b32 s16, s40
    s_and_b32 s17, s41, 0xffff
    s_mov_b32 s18, 0x400000
    s_mov_b32 s19, 0x00020000

    s_mov_b32 s12, s42
    s_and_b32 s13, s43, 0xffff
    s_mov_b32 s14, 0x800000
    s_mov_b32 s15, 0x00020000

    v_lshrrev_b32 v4, 1, v2
    v_xor_b32 v4, v4, v3
    v_lshlrev_b32 v4, 1, v4
    v_and_b32 v5, 1, v1
    v_or_b32 v4, v4, v5
    v_lshlrev_b32 v4, 4, v4
    v_lshlrev_b32 v5, 13, v3
    v_add_u32 v10, v4, v5
    v_xor_b32 v11, 0x80, v10
    s_lshl_b32 s4, s24, 18
    s_add_u32 s28, s28, s4
    s_lshl_b32 s29, s24, 13
    v_lshrrev_b32 v4, 2, v2
    v_and_b32 v5, 1, v3
    v_lshl_or_b32 v5, v5, 2, v4
    s_lshl_b32 s4, s24, 1
    v_xor_b32 v5, s4, v5
    v_lshlrev_b32 v5, 5, v5
    v_lshl_add_u32 v4, v3, 3, v4
    v_lshl_add_u32 v5, v4, 8, v5
    v_and_b32 v4, 3, v2
    v_lshl_add_u32 v12, v4, 3, v5
    v_xor_b32 v13, 32, v12
    v_add_u32 v14, 0x10000, v12
    v_add_u32 v15, 0x10000, v13

    s_mov_b32 s63, 0
    s_cmp_lg_u32 s30, 0
    s_cbranch_scc1 .qh_381
    s_cmp_lt_u32 s24, 2
    s_cselect_b64 s[48:49], s[46:47], s[48:49]

    s_mov_b32 s64, s48
    s_and_b32 s65, s49, 0xffff
    s_mov_b32 s66, 0x800000
    s_mov_b32 s67, 0x00020000

    v_lshlrev_b32 v4, 13, v1
    s_and_b32 s4, s24, 1
    s_lshl_b32 s4, s4, 7
    s_lshl_b32 s5, s31, 8
    s_add_u32 s4, s4, s5
    s_add_u32 s4, s4, 3145728
    s_waitcnt vmcnt(0)

    v_mov_b32 v243, s99
    v_mov_b32 v242, 0
    s_cmp_lg_u32 s24, 0
    s_cbranch_scc1 .a1_382
    v_mov_b32 v242, s26
    v_lshlrev_b32 v242, 6, v242
    v_add_u32 v242, s97, v242
    v_and_b32 v242, 255, v242
    s_mov_b64 exec, 1
    buffer_atomic_add v243, v242, s[20:23], 0 offen sc1
    s_mov_b64 exec, -1

.a1_382:
    buffer_load_dword v31, v4, s[64:67], s4 offen
    s_add_u32 s4, s4, 524288
    buffer_load_dword v31, v4, s[64:67], s4 offen
    s_add_u32 s4, s4, 524288
    buffer_load_dword v31, v4, s[64:67], s4 offen
    s_add_u32 s4, s4, 524288
    buffer_load_dword v31, v4, s[64:67], s4 offen
    s_add_u32 s4, s4, 524288
    buffer_load_dword v31, v4, s[64:67], s4 offen
    s_add_u32 s4, s4, 524288
    buffer_load_dword v31, v4, s[64:67], s4 offen
    s_add_u32 s4, s4, 524288
    buffer_load_dword v31, v4, s[64:67], s4 offen
    s_add_u32 s4, s4, 524288
    buffer_load_dword v31, v4, s[64:67], s4 offen
    s_add_u32 s4, s4, 524288
    buffer_load_dword v31, v4, s[64:67], s4 offen
    s_add_u32 s4, s4, 524288
    buffer_load_dword v31, v4, s[64:67], s4 offen
    s_add_u32 s4, s4, 524288
    s_waitcnt vmcnt(0)
    s_mov_b32 s63, 99
.qh_381:
    s_and_b32 s4, s26, 7
    s_lshl_b32 s4, s4, 1
    s_lshr_b32 s5, s24, 1
    s_add_u32 s4, s4, s5
    s_lshl_b32 s4, s4, 6
    v_add_u32 v4, s4, v1
    v_lshlrev_b32 v4, 13, v4
    s_and_b32 s4, s24, 1
    s_lshl_b32 s4, s4, 10
    s_lshl_b32 s5, s91, 11
    s_add_u32 s4, s4, s5
    buffer_load_dword v31, v4, s[12:15], s4 offen offset:384

    s_add_u32 m0, s29, 98304
    s_add_u32 s4, s28, 0
    buffer_load_dwordx4 v10, s[12:15], s4 offen lds

    s_add_u32 m0, s29, 99328
    s_add_u32 s4, s28, 32768
    buffer_load_dwordx4 v10, s[12:15], s4 offen lds

    s_add_u32 m0, s29, 100352
    s_add_u32 s4, s28, 65536
    buffer_load_dwordx4 v11, s[12:15], s4 offen lds

    s_add_u32 m0, s29, 101376
    s_add_u32 s4, s28, 98304
    buffer_load_dwordx4 v11, s[12:15], s4 offen lds

    s_add_u32 m0, s29, 102400
    s_add_u32 s4, s28, 131072
    buffer_load_dwordx4 v10, s[12:15], s4 offen lds

    s_add_u32 m0, s29, 103424
    s_add_u32 s4, s28, 163840
    buffer_load_dwordx4 v10, s[12:15], s4 offen lds

    s_add_u32 m0, s29, 104448
    s_add_u32 s4, s28, 196608
    buffer_load_dwordx4 v11, s[12:15], s4 offen lds

    s_add_u32 m0, s29, 105472
    s_add_u32 s4, s28, 229376
    buffer_load_dwordx4 v11, s[12:15], s4 offen lds

    s_waitcnt vmcnt(9)
    v_mov_b32 v243, s99
    v_mov_b32 v242, 0
    s_cmp_lg_u32 s24, s63
    s_cbranch_scc1 .a1_384
    v_mov_b32 v242, s26
    v_lshlrev_b32 v242, 6, v242
    v_add_u32 v242, s97, v242
    v_and_b32 v242, 255, v242
    s_mov_b64 exec, 1
    buffer_atomic_add v243, v242, s[20:23], 0 offen sc1
    s_mov_b64 exec, -1

.a1_384:
    v_lshrrev_b32 v4, 3, v1
    v_and_b32 v5, 7, v1
    v_xor_b32 v5, v5, v4
    v_lshlrev_b32 v5, 4, v5
    v_lshl_add_u32 v16, v4, 11, v5
    s_lshl_b32 s4, s24, 14
    v_add_u32 v16, s4, v16
    v_and_b32 v4, 7, v2
    v_xor_b32 v5, v4, v3
    v_lshlrev_b32 v5, 4, v5
    v_lshl_add_u32 v5, v4, 7, v5
    v_lshrrev_b32 v4, 3, v2
    v_lshl_add_u32 v17, v4, 13, v5
    v_xor_b32 v18, 64, v17
    v_add_u32 v19, 0x10000, v17
    v_add_u32 v20, 0x10000, v18
    v_lshlrev_b32 v21, 4, v1
    s_lshl_b32 s32, s30, 24
    s_lshl_b32 s4, s31, 13
    s_add_u32 s32, s32, s4
    s_lshr_b32 s5, s30, 1
    s_add_u32 s5, s5, 10
    s_lshl_b32 s4, s24, s5
    s_add_u32 s39, s32, s4
    s_mov_b32 s32, s39
    s_add_u32 s38, s39, 4096
    s_mul_i32 s49, s31, 6144
    s_lshl_b32 s4, s30, 11
    s_add_u32 s49, s49, s4
    s_lshl_b32 s4, s24, 9
    s_add_u32 s49, s49, s4
    s_add_u32 s49, s49, 67108864
    s_mov_b32 s48, s49
    v_mov_b32 v23, -1
    s_lshl_b32 s4, s30, 5
    s_add_u32 s4, s4, s31
    s_lshl_b32 s4, s4, 8
    s_add_u32 s33, s4, 92274688
    s_cmp_eq_u32 s24, 0
    s_cselect_b32 s36, 1, 0
    s_mov_b32 s37, 0
    v_mov_b32 v22, 0
    s_mov_b32 s34, 0
    s_mov_b32 s35, 0
    s_and_b32 s4, s26, 7
    s_lshl_b32 s4, s4, 2
    s_add_u32 s4, s4, s24
    s_lshl_b32 s4, s4, 11
    v_lshlrev_b32 v111, 5, v1
    v_add_u32 v111, s4, v111

    s_mul_i32 s47, s26, 1507328
    s_lshl_b32 s4, s24, 10
    s_add_u32 s47, s47, s4
    s_add_u32 s47, s47, 184549376
    v_mov_b32 v24, -1
    v_mov_b32 v25, -1
    v_mov_b32 v26, -1
    v_mov_b32 v27, -1

    s_xor_b32 s4, s91, 1
    s_lshl_b32 s5, s4, 14
    s_lshl_b32 s6, s91, 12
    s_add_u32 s5, s5, s6
    v_add_u32 v28, s5, v21
    s_lshl_b32 s5, s91, 14
    s_lshl_b32 s6, s4, 12
    s_add_u32 s5, s5, s6
    v_add_u32 v7, s5, v21

    s_xor_b32 s4, s91, 2
    s_lshl_b32 s5, s4, 14
    s_lshl_b32 s6, s91, 12
    s_add_u32 s5, s5, s6
    v_add_u32 v29, s5, v21
    s_lshl_b32 s5, s91, 14
    s_lshl_b32 s6, s4, 12
    s_add_u32 s5, s5, s6
    v_add_u32 v8, s5, v21

    s_xor_b32 s4, s91, 3
    s_lshl_b32 s5, s4, 14
    s_lshl_b32 s6, s91, 12
    s_add_u32 s5, s5, s6
    v_add_u32 v30, s5, v21
    s_lshl_b32 s5, s91, 14
    s_lshl_b32 s6, s4, 12
    s_add_u32 s5, s5, s6
    v_add_u32 v9, s5, v21

    s_mov_b64 s[44:45], -1
    s_mov_b32 s46, s47
    s_add_u32 s39, s39, 262144
    s_add_u32 s49, s49, 196608
    v_mov_b32 v23, 0
    v_add_u32 v113, 0x20000, v17
    v_add_u32 v114, 0x20000, v18
    s_barrier

    s_add_u32 m0, s29, 131072
    s_nop 0
    buffer_load_dwordx4 v16, s[16:19], s34 offen offset:0 lds
    s_add_u32 m0, s29, 131968
    s_nop 0
    buffer_load_dwordx4 v16, s[16:19], s34 offen offset:128 lds
    s_add_u32 m0, s29, 132864
    s_nop 0
    buffer_load_dwordx4 v16, s[16:19], s34 offen offset:256 lds
    s_add_u32 m0, s29, 133760
    s_nop 0
    buffer_load_dwordx4 v16, s[16:19], s34 offen offset:384 lds
    s_add_u32 m0, s29, 134656
    s_nop 0
    buffer_load_dwordx4 v16, s[16:19], s34 offen offset:512 lds
    s_add_u32 m0, s29, 135552
    s_nop 0
    buffer_load_dwordx4 v16, s[16:19], s34 offen offset:640 lds
    s_add_u32 m0, s29, 136448
    s_nop 0
    buffer_load_dwordx4 v16, s[16:19], s34 offen offset:768 lds
    s_add_u32 m0, s29, 137344
    s_nop 0
    buffer_load_dwordx4 v16, s[16:19], s34 offen offset:896 lds
    s_add_u32 s34, s34, 1024
    s_add_u32 m0, s29, 0
    s_add_u32 s4, s28, 1048576
    buffer_load_dwordx4 v10, s[12:15], s4 offen lds

    s_add_u32 m0, s29, 1024
    s_add_u32 s4, s28, 1081344
    buffer_load_dwordx4 v10, s[12:15], s4 offen lds

    s_add_u32 m0, s29, 2048
    s_add_u32 s4, s28, 1114112
    buffer_load_dwordx4 v11, s[12:15], s4 offen lds

    s_add_u32 m0, s29, 3072
    s_add_u32 s4, s28, 1146880
    buffer_load_dwordx4 v11, s[12:15], s4 offen lds

    s_add_u32 m0, s29, 4096
    s_add_u32 s4, s28, 1179648
    buffer_load_dwordx4 v10, s[12:15], s4 offen lds

    s_add_u32 m0, s29, 5120
    s_add_u32 s4, s28, 1212416
    buffer_load_dwordx4 v10, s[12:15], s4 offen lds

    s_add_u32 m0, s29, 6144
    s_add_u32 s4, s28, 1245184
    buffer_load_dwordx4 v11, s[12:15], s4 offen lds

    s_add_u32 m0, s29, 7168
    s_add_u32 s4, s28, 1277952
    buffer_load_dwordx4 v11, s[12:15], s4 offen lds

    s_add_u32 m0, s29, 65536
    s_add_u32 s4, s28, 2097152
    buffer_load_dwordx4 v10, s[12:15], s4 offen lds

    s_add_u32 m0, s29, 66560
    s_add_u32 s4, s28, 2129920
    buffer_load_dwordx4 v10, s[12:15], s4 offen lds

    s_add_u32 m0, s29, 67584
    s_add_u32 s4, s28, 2162688
    buffer_load_dwordx4 v11, s[12:15], s4 offen lds

    s_add_u32 m0, s29, 68608
    s_add_u32 s4, s28, 2195456
    buffer_load_dwordx4 v11, s[12:15], s4 offen lds

    s_add_u32 m0, s29, 69632
    s_add_u32 s4, s28, 2228224
    buffer_load_dwordx4 v10, s[12:15], s4 offen lds

    s_add_u32 m0, s29, 70656
    s_add_u32 s4, s28, 2260992
    buffer_load_dwordx4 v10, s[12:15], s4 offen lds

    s_add_u32 m0, s29, 71680
    s_add_u32 s4, s28, 2293760
    buffer_load_dwordx4 v11, s[12:15], s4 offen lds

    s_add_u32 m0, s29, 72704
    s_add_u32 s4, s28, 2326528
    buffer_load_dwordx4 v11, s[12:15], s4 offen lds

    s_waitcnt vmcnt(16)
    s_barrier
    ds_read_b64_tr_b16 a[0:1], v14 offset:32768
    ds_read_b64_tr_b16 a[2:3], v14 offset:33792
    ds_read_b64_tr_b16 a[4:5], v15 offset:32768
    ds_read_b64_tr_b16 a[6:7], v15 offset:33792
    ds_read_b64_tr_b16 a[8:9], v14 offset:40960
    ds_read_b64_tr_b16 a[10:11], v14 offset:41984
    ds_read_b64_tr_b16 a[12:13], v15 offset:40960
    ds_read_b64_tr_b16 a[14:15], v15 offset:41984
    ds_read_b64_tr_b16 a[16:17], v14 offset:49152
    ds_read_b64_tr_b16 a[18:19], v14 offset:50176
    ds_read_b64_tr_b16 a[20:21], v15 offset:49152
    ds_read_b64_tr_b16 a[22:23], v15 offset:50176
    ds_read_b64_tr_b16 a[24:25], v14 offset:57344
    ds_read_b64_tr_b16 a[26:27], v14 offset:58368
    ds_read_b64_tr_b16 a[28:29], v15 offset:57344
    ds_read_b64_tr_b16 a[30:31], v15 offset:58368
    ds_read_b128 v[32:35], v113 offset:0
    ds_read_b128 v[36:39], v113 offset:16384
    ds_read_b128 v[40:43], v114 offset:0
    ds_read_b128 v[44:47], v114 offset:16384
    ds_read_b128 v[48:51], v113 offset:1024
    ds_read_b128 v[52:55], v113 offset:17408
    ds_read_b128 v[56:59], v114 offset:1024
    ds_read_b128 v[60:63], v114 offset:17408
    s_waitcnt lgkmcnt(0)
    s_barrier
    s_add_u32 m0, s29, 98304
    s_add_u32 s4, s28, 3145728
    buffer_load_dwordx4 v10, s[12:15], s4 offen lds

    s_add_u32 m0, s29, 99328
    s_add_u32 s4, s28, 3178496
    buffer_load_dwordx4 v10, s[12:15], s4 offen lds

    s_add_u32 m0, s29, 100352
    s_add_u32 s4, s28, 3211264
    buffer_load_dwordx4 v11, s[12:15], s4 offen lds

    s_add_u32 m0, s29, 101376
    s_add_u32 s4, s28, 3244032
    buffer_load_dwordx4 v11, s[12:15], s4 offen lds

    s_add_u32 m0, s29, 102400
    s_add_u32 s4, s28, 3276800
    buffer_load_dwordx4 v10, s[12:15], s4 offen lds

    s_add_u32 m0, s29, 103424
    s_add_u32 s4, s28, 3309568
    buffer_load_dwordx4 v10, s[12:15], s4 offen lds

    s_add_u32 m0, s29, 104448
    s_add_u32 s4, s28, 3342336
    buffer_load_dwordx4 v11, s[12:15], s4 offen lds

    s_add_u32 m0, s29, 105472
    s_add_u32 s4, s28, 3375104
    buffer_load_dwordx4 v11, s[12:15], s4 offen lds

    s_add_u32 m0, s29, 32768
    s_nop 0
    buffer_load_dwordx4 v16, s[16:19], s34 offen offset:0 lds
    s_add_u32 m0, s29, 33664
    s_nop 0
    buffer_load_dwordx4 v16, s[16:19], s34 offen offset:128 lds
    s_add_u32 m0, s29, 34560
    s_nop 0
    buffer_load_dwordx4 v16, s[16:19], s34 offen offset:256 lds
    s_add_u32 m0, s29, 35456
    s_nop 0
    buffer_load_dwordx4 v16, s[16:19], s34 offen offset:384 lds
    s_add_u32 m0, s29, 36352
    s_nop 0
    buffer_load_dwordx4 v16, s[16:19], s34 offen offset:512 lds
    s_add_u32 m0, s29, 37248
    s_nop 0
    buffer_load_dwordx4 v16, s[16:19], s34 offen offset:640 lds
    s_add_u32 m0, s29, 38144
    s_nop 0
    buffer_load_dwordx4 v16, s[16:19], s34 offen offset:768 lds
    s_add_u32 m0, s29, 39040
    s_nop 0
    buffer_load_dwordx4 v16, s[16:19], s34 offen offset:896 lds
    s_add_u32 s34, s34, 64512
    s_min_u32 s34, s34, 4128768
    s_cmp_eq_u32 s30, 2
    s_cbranch_scc1 .s0v_388
    v_mfma_f32_16x16x32_bf16 v[64:67], a[0:3], v[32:35], 0
    v_mfma_f32_16x16x32_bf16 v[68:71], a[4:7], v[32:35], 0
    v_mfma_f32_16x16x32_bf16 v[72:75], a[0:3], v[36:39], 0
    v_mfma_f32_16x16x32_bf16 v[76:79], a[4:7], v[36:39], 0
    v_mfma_f32_16x16x32_bf16 v[64:67], a[8:11], v[40:43], v[64:67]
    v_mfma_f32_16x16x32_bf16 v[68:71], a[12:15], v[40:43], v[68:71]
    v_mfma_f32_16x16x32_bf16 v[72:75], a[8:11], v[44:47], v[72:75]
    v_mfma_f32_16x16x32_bf16 v[76:79], a[12:15], v[44:47], v[76:79]
    v_mfma_f32_16x16x32_bf16 v[64:67], a[16:19], v[48:51], v[64:67]
    v_mfma_f32_16x16x32_bf16 v[68:71], a[20:23], v[48:51], v[68:71]
    v_mfma_f32_16x16x32_bf16 v[72:75], a[16:19], v[52:55], v[72:75]
    v_mfma_f32_16x16x32_bf16 v[76:79], a[20:23], v[52:55], v[76:79]
    v_mfma_f32_16x16x32_bf16 v[64:67], a[24:27], v[56:59], v[64:67]
    v_mfma_f32_16x16x32_bf16 v[68:71], a[28:31], v[56:59], v[68:71]
    v_mfma_f32_16x16x32_bf16 v[72:75], a[24:27], v[60:63], v[72:75]
    v_mfma_f32_16x16x32_bf16 v[76:79], a[28:31], v[60:63], v[76:79]
    s_branch .s0j_389
.s0v_388:
    v_mfma_f32_16x16x32_bf16 v[64:67], v[32:35], a[0:3], 0
    v_mfma_f32_16x16x32_bf16 v[68:71], v[32:35], a[4:7], 0
    v_mfma_f32_16x16x32_bf16 v[72:75], v[36:39], a[0:3], 0
    v_mfma_f32_16x16x32_bf16 v[76:79], v[36:39], a[4:7], 0
    v_mfma_f32_16x16x32_bf16 v[64:67], v[40:43], a[8:11], v[64:67]
    v_mfma_f32_16x16x32_bf16 v[68:71], v[40:43], a[12:15], v[68:71]
    v_mfma_f32_16x16x32_bf16 v[72:75], v[44:47], a[8:11], v[72:75]
    v_mfma_f32_16x16x32_bf16 v[76:79], v[44:47], a[12:15], v[76:79]
    v_mfma_f32_16x16x32_bf16 v[64:67], v[48:51], a[16:19], v[64:67]
    v_mfma_f32_16x16x32_bf16 v[68:71], v[48:51], a[20:23], v[68:71]
    v_mfma_f32_16x16x32_bf16 v[72:75], v[52:55], a[16:19], v[72:75]
    v_mfma_f32_16x16x32_bf16 v[76:79], v[52:55], a[20:23], v[76:79]
    v_mfma_f32_16x16x32_bf16 v[64:67], v[56:59], a[24:27], v[64:67]
    v_mfma_f32_16x16x32_bf16 v[68:71], v[56:59], a[28:31], v[68:71]
    v_mfma_f32_16x16x32_bf16 v[72:75], v[60:63], a[24:27], v[72:75]
    v_mfma_f32_16x16x32_bf16 v[76:79], v[60:63], a[28:31], v[76:79]
.s0j_389:
    s_waitcnt vmcnt(24)
    s_barrier
    ds_read_b64_tr_b16 a[32:33], v12 offset:0
    ds_read_b64_tr_b16 a[34:35], v12 offset:1024
    ds_read_b64_tr_b16 a[36:37], v13 offset:0
    ds_read_b64_tr_b16 a[38:39], v13 offset:1024
    ds_read_b64_tr_b16 a[40:41], v12 offset:8192
    ds_read_b64_tr_b16 a[42:43], v12 offset:9216
    ds_read_b64_tr_b16 a[44:45], v13 offset:8192
    ds_read_b64_tr_b16 a[46:47], v13 offset:9216
    ds_read_b64_tr_b16 a[48:49], v12 offset:16384
    ds_read_b64_tr_b16 a[50:51], v12 offset:17408
    ds_read_b64_tr_b16 a[52:53], v13 offset:16384
    ds_read_b64_tr_b16 a[54:55], v13 offset:17408
    ds_read_b64_tr_b16 a[56:57], v12 offset:24576
    ds_read_b64_tr_b16 a[58:59], v12 offset:25600
    ds_read_b64_tr_b16 a[60:61], v13 offset:24576
    ds_read_b64_tr_b16 a[62:63], v13 offset:25600
    ds_read_b128 v[32:35], v113 offset:2048
    ds_read_b128 v[36:39], v113 offset:18432
    ds_read_b128 v[40:43], v114 offset:2048
    ds_read_b128 v[44:47], v114 offset:18432
    ds_read_b128 v[48:51], v113 offset:3072
    ds_read_b128 v[52:55], v113 offset:19456
    ds_read_b128 v[56:59], v114 offset:3072
    ds_read_b128 v[60:63], v114 offset:19456
    s_waitcnt lgkmcnt(0)
    s_barrier
    s_add_u32 m0, s29, 0
    s_add_u32 s4, s28, 4194304
    buffer_load_dwordx4 v10, s[12:15], s4 offen lds

    s_add_u32 m0, s29, 1024
    s_add_u32 s4, s28, 4227072
    buffer_load_dwordx4 v10, s[12:15], s4 offen lds

    s_add_u32 m0, s29, 2048
    s_add_u32 s4, s28, 4259840
    buffer_load_dwordx4 v11, s[12:15], s4 offen lds

    s_add_u32 m0, s29, 3072
    s_add_u32 s4, s28, 4292608
    buffer_load_dwordx4 v11, s[12:15], s4 offen lds

    s_add_u32 m0, s29, 4096
    s_add_u32 s4, s28, 4325376
    buffer_load_dwordx4 v10, s[12:15], s4 offen lds

    s_add_u32 m0, s29, 5120
    s_add_u32 s4, s28, 4358144
    buffer_load_dwordx4 v10, s[12:15], s4 offen lds

    s_add_u32 m0, s29, 6144
    s_add_u32 s4, s28, 4390912
    buffer_load_dwordx4 v11, s[12:15], s4 offen lds

    s_add_u32 m0, s29, 7168
    s_add_u32 s4, s28, 4423680
    buffer_load_dwordx4 v11, s[12:15], s4 offen lds

    s_cmp_eq_u32 s30, 2
    s_cbranch_scc1 .s0v_390
    v_mfma_f32_16x16x32_bf16 v[64:67], a[32:35], v[32:35], v[64:67]
    v_mfma_f32_16x16x32_bf16 v[68:71], a[36:39], v[32:35], v[68:71]
    v_mfma_f32_16x16x32_bf16 v[72:75], a[32:35], v[36:39], v[72:75]
    v_mfma_f32_16x16x32_bf16 v[76:79], a[36:39], v[36:39], v[76:79]
    v_mfma_f32_16x16x32_bf16 v[64:67], a[40:43], v[40:43], v[64:67]
    v_mfma_f32_16x16x32_bf16 v[68:71], a[44:47], v[40:43], v[68:71]
    v_mfma_f32_16x16x32_bf16 v[72:75], a[40:43], v[44:47], v[72:75]
    v_mfma_f32_16x16x32_bf16 v[76:79], a[44:47], v[44:47], v[76:79]
    v_mfma_f32_16x16x32_bf16 v[64:67], a[48:51], v[48:51], v[64:67]
    v_mfma_f32_16x16x32_bf16 v[68:71], a[52:55], v[48:51], v[68:71]
    v_mfma_f32_16x16x32_bf16 v[72:75], a[48:51], v[52:55], v[72:75]
    v_mfma_f32_16x16x32_bf16 v[76:79], a[52:55], v[52:55], v[76:79]
    v_mfma_f32_16x16x32_bf16 v[64:67], a[56:59], v[56:59], v[64:67]
    v_mfma_f32_16x16x32_bf16 v[68:71], a[60:63], v[56:59], v[68:71]
    v_mfma_f32_16x16x32_bf16 v[72:75], a[56:59], v[60:63], v[72:75]
    v_mfma_f32_16x16x32_bf16 v[76:79], a[60:63], v[60:63], v[76:79]
    s_branch .s0j_391
.s0v_390:
    v_mfma_f32_16x16x32_bf16 v[64:67], v[32:35], a[32:35], v[64:67]
    v_mfma_f32_16x16x32_bf16 v[68:71], v[32:35], a[36:39], v[68:71]
    v_mfma_f32_16x16x32_bf16 v[72:75], v[36:39], a[32:35], v[72:75]
    v_mfma_f32_16x16x32_bf16 v[76:79], v[36:39], a[36:39], v[76:79]
    v_mfma_f32_16x16x32_bf16 v[64:67], v[40:43], a[40:43], v[64:67]
    v_mfma_f32_16x16x32_bf16 v[68:71], v[40:43], a[44:47], v[68:71]
    v_mfma_f32_16x16x32_bf16 v[72:75], v[44:47], a[40:43], v[72:75]
    v_mfma_f32_16x16x32_bf16 v[76:79], v[44:47], a[44:47], v[76:79]
    v_mfma_f32_16x16x32_bf16 v[64:67], v[48:51], a[48:51], v[64:67]
    v_mfma_f32_16x16x32_bf16 v[68:71], v[48:51], a[52:55], v[68:71]
    v_mfma_f32_16x16x32_bf16 v[72:75], v[52:55], a[48:51], v[72:75]
    v_mfma_f32_16x16x32_bf16 v[76:79], v[52:55], a[52:55], v[76:79]
    v_mfma_f32_16x16x32_bf16 v[64:67], v[56:59], a[56:59], v[64:67]
    v_mfma_f32_16x16x32_bf16 v[68:71], v[56:59], a[60:63], v[68:71]
    v_mfma_f32_16x16x32_bf16 v[72:75], v[60:63], a[56:59], v[72:75]
    v_mfma_f32_16x16x32_bf16 v[76:79], v[60:63], a[60:63], v[76:79]
.s0j_391:
    s_waitcnt vmcnt(24)
    s_barrier
    ds_read_b64_tr_b16 a[64:65], v14 offset:0
    ds_read_b64_tr_b16 a[66:67], v14 offset:1024
    ds_read_b64_tr_b16 a[68:69], v15 offset:0
    ds_read_b64_tr_b16 a[70:71], v15 offset:1024
    ds_read_b64_tr_b16 a[72:73], v14 offset:8192
    ds_read_b64_tr_b16 a[74:75], v14 offset:9216
    ds_read_b64_tr_b16 a[76:77], v15 offset:8192
    ds_read_b64_tr_b16 a[78:79], v15 offset:9216
    ds_read_b64_tr_b16 a[80:81], v14 offset:16384
    ds_read_b64_tr_b16 a[82:83], v14 offset:17408
    ds_read_b64_tr_b16 a[84:85], v15 offset:16384
    ds_read_b64_tr_b16 a[86:87], v15 offset:17408
    ds_read_b64_tr_b16 a[88:89], v14 offset:24576
    ds_read_b64_tr_b16 a[90:91], v14 offset:25600
    ds_read_b64_tr_b16 a[92:93], v15 offset:24576
    ds_read_b64_tr_b16 a[94:95], v15 offset:25600
    ds_read_b128 v[32:35], v113 offset:4096
    ds_read_b128 v[36:39], v113 offset:20480
    ds_read_b128 v[40:43], v114 offset:4096
    ds_read_b128 v[44:47], v114 offset:20480
    ds_read_b128 v[48:51], v113 offset:5120
    ds_read_b128 v[52:55], v113 offset:21504
    ds_read_b128 v[56:59], v114 offset:5120
    ds_read_b128 v[60:63], v114 offset:21504
    s_waitcnt lgkmcnt(0)
    s_barrier
    s_add_u32 m0, s29, 65536
    s_add_u32 s4, s28, 5242880
    buffer_load_dwordx4 v10, s[12:15], s4 offen lds

    s_add_u32 m0, s29, 66560
    s_add_u32 s4, s28, 5275648
    buffer_load_dwordx4 v10, s[12:15], s4 offen lds

    s_add_u32 m0, s29, 67584
    s_add_u32 s4, s28, 5308416
    buffer_load_dwordx4 v11, s[12:15], s4 offen lds

    s_add_u32 m0, s29, 68608
    s_add_u32 s4, s28, 5341184
    buffer_load_dwordx4 v11, s[12:15], s4 offen lds

    s_add_u32 m0, s29, 69632
    s_add_u32 s4, s28, 5373952
    buffer_load_dwordx4 v10, s[12:15], s4 offen lds

    s_add_u32 m0, s29, 70656
    s_add_u32 s4, s28, 5406720
    buffer_load_dwordx4 v10, s[12:15], s4 offen lds

    s_add_u32 m0, s29, 71680
    s_add_u32 s4, s28, 5439488
    buffer_load_dwordx4 v11, s[12:15], s4 offen lds

    s_add_u32 m0, s29, 72704
    s_add_u32 s4, s28, 5472256
    buffer_load_dwordx4 v11, s[12:15], s4 offen lds

    s_cmp_eq_u32 s30, 2
    s_cbranch_scc1 .s0v_392
    v_mfma_f32_16x16x32_bf16 v[64:67], a[64:67], v[32:35], v[64:67]
    v_mfma_f32_16x16x32_bf16 v[68:71], a[68:71], v[32:35], v[68:71]
    v_mfma_f32_16x16x32_bf16 v[72:75], a[64:67], v[36:39], v[72:75]
    v_mfma_f32_16x16x32_bf16 v[76:79], a[68:71], v[36:39], v[76:79]
    v_mfma_f32_16x16x32_bf16 v[64:67], a[72:75], v[40:43], v[64:67]
    v_mfma_f32_16x16x32_bf16 v[68:71], a[76:79], v[40:43], v[68:71]
    v_mfma_f32_16x16x32_bf16 v[72:75], a[72:75], v[44:47], v[72:75]
    v_mfma_f32_16x16x32_bf16 v[76:79], a[76:79], v[44:47], v[76:79]
    v_mfma_f32_16x16x32_bf16 v[64:67], a[80:83], v[48:51], v[64:67]
    v_mfma_f32_16x16x32_bf16 v[68:71], a[84:87], v[48:51], v[68:71]
    v_mfma_f32_16x16x32_bf16 v[72:75], a[80:83], v[52:55], v[72:75]
    v_mfma_f32_16x16x32_bf16 v[76:79], a[84:87], v[52:55], v[76:79]
    v_mfma_f32_16x16x32_bf16 v[64:67], a[88:91], v[56:59], v[64:67]
    v_mfma_f32_16x16x32_bf16 v[68:71], a[92:95], v[56:59], v[68:71]
    v_mfma_f32_16x16x32_bf16 v[72:75], a[88:91], v[60:63], v[72:75]
    v_mfma_f32_16x16x32_bf16 v[76:79], a[92:95], v[60:63], v[76:79]
    s_branch .s0j_393
.s0v_392:
    v_mfma_f32_16x16x32_bf16 v[64:67], v[32:35], a[64:67], v[64:67]
    v_mfma_f32_16x16x32_bf16 v[68:71], v[32:35], a[68:71], v[68:71]
    v_mfma_f32_16x16x32_bf16 v[72:75], v[36:39], a[64:67], v[72:75]
    v_mfma_f32_16x16x32_bf16 v[76:79], v[36:39], a[68:71], v[76:79]
    v_mfma_f32_16x16x32_bf16 v[64:67], v[40:43], a[72:75], v[64:67]
    v_mfma_f32_16x16x32_bf16 v[68:71], v[40:43], a[76:79], v[68:71]
    v_mfma_f32_16x16x32_bf16 v[72:75], v[44:47], a[72:75], v[72:75]
    v_mfma_f32_16x16x32_bf16 v[76:79], v[44:47], a[76:79], v[76:79]
    v_mfma_f32_16x16x32_bf16 v[64:67], v[48:51], a[80:83], v[64:67]
    v_mfma_f32_16x16x32_bf16 v[68:71], v[48:51], a[84:87], v[68:71]
    v_mfma_f32_16x16x32_bf16 v[72:75], v[52:55], a[80:83], v[72:75]
    v_mfma_f32_16x16x32_bf16 v[76:79], v[52:55], a[84:87], v[76:79]
    v_mfma_f32_16x16x32_bf16 v[64:67], v[56:59], a[88:91], v[64:67]
    v_mfma_f32_16x16x32_bf16 v[68:71], v[56:59], a[92:95], v[68:71]
    v_mfma_f32_16x16x32_bf16 v[72:75], v[60:63], a[88:91], v[72:75]
    v_mfma_f32_16x16x32_bf16 v[76:79], v[60:63], a[92:95], v[76:79]
.s0j_393:
    s_waitcnt vmcnt(24)
    s_barrier
    ds_read_b64_tr_b16 a[96:97], v14 offset:32768
    ds_read_b64_tr_b16 a[98:99], v14 offset:33792
    ds_read_b64_tr_b16 a[100:101], v15 offset:32768
    ds_read_b64_tr_b16 a[102:103], v15 offset:33792
    ds_read_b64_tr_b16 a[104:105], v14 offset:40960
    ds_read_b64_tr_b16 a[106:107], v14 offset:41984
    ds_read_b64_tr_b16 a[108:109], v15 offset:40960
    ds_read_b64_tr_b16 a[110:111], v15 offset:41984
    ds_read_b64_tr_b16 a[112:113], v14 offset:49152
    ds_read_b64_tr_b16 a[114:115], v14 offset:50176
    ds_read_b64_tr_b16 a[116:117], v15 offset:49152
    ds_read_b64_tr_b16 a[118:119], v15 offset:50176
    ds_read_b64_tr_b16 a[120:121], v14 offset:57344
    ds_read_b64_tr_b16 a[122:123], v14 offset:58368
    ds_read_b64_tr_b16 a[124:125], v15 offset:57344
    ds_read_b64_tr_b16 a[126:127], v15 offset:58368
    ds_read_b128 v[32:35], v113 offset:6144
    ds_read_b128 v[36:39], v113 offset:22528
    ds_read_b128 v[40:43], v114 offset:6144
    ds_read_b128 v[44:47], v114 offset:22528
    ds_read_b128 v[48:51], v113 offset:7168
    ds_read_b128 v[52:55], v113 offset:23552
    ds_read_b128 v[56:59], v114 offset:7168
    ds_read_b128 v[60:63], v114 offset:23552
    s_waitcnt lgkmcnt(0)
    s_barrier
    s_add_u32 m0, s29, 98304
    s_add_u32 s4, s28, 6291456
    buffer_load_dwordx4 v10, s[12:15], s4 offen lds

    s_add_u32 m0, s29, 99328
    s_add_u32 s4, s28, 6324224
    buffer_load_dwordx4 v10, s[12:15], s4 offen lds

    s_add_u32 m0, s29, 100352
    s_add_u32 s4, s28, 6356992
    buffer_load_dwordx4 v11, s[12:15], s4 offen lds

    s_add_u32 m0, s29, 101376
    s_add_u32 s4, s28, 6389760
    buffer_load_dwordx4 v11, s[12:15], s4 offen lds

    s_add_u32 m0, s29, 102400
    s_add_u32 s4, s28, 6422528
    buffer_load_dwordx4 v10, s[12:15], s4 offen lds

    s_add_u32 m0, s29, 103424
    s_add_u32 s4, s28, 6455296
    buffer_load_dwordx4 v10, s[12:15], s4 offen lds

    s_add_u32 m0, s29, 104448
    s_add_u32 s4, s28, 6488064
    buffer_load_dwordx4 v11, s[12:15], s4 offen lds

    s_add_u32 m0, s29, 105472
    s_add_u32 s4, s28, 6520832
    buffer_load_dwordx4 v11, s[12:15], s4 offen lds

    v_and_b32 v241, 3, v0
    v_lshlrev_b32 v241, 2, v241

    v_and_b32 v240, 12, v0
    v_lshl_add_u32 v241, v240, 4, v241
    v_add_u32 v241, s97, v241
    v_and_b32 v241, 255, v241

    buffer_load_dword v240, v241, s[20:23], 0 offen sc1
    s_cmp_eq_u32 s30, 2
    s_cbranch_scc1 .s0v_394
    v_mfma_f32_16x16x32_bf16 v[64:67], a[96:99], v[32:35], v[64:67]
    v_mfma_f32_16x16x32_bf16 v[68:71], a[100:103], v[32:35], v[68:71]
    v_mfma_f32_16x16x32_bf16 v[72:75], a[96:99], v[36:39], v[72:75]
    v_mfma_f32_16x16x32_bf16 v[76:79], a[100:103], v[36:39], v[76:79]
    v_mfma_f32_16x16x32_bf16 v[64:67], a[104:107], v[40:43], v[64:67]
    v_mfma_f32_16x16x32_bf16 v[68:71], a[108:111], v[40:43], v[68:71]
    v_mfma_f32_16x16x32_bf16 v[72:75], a[104:107], v[44:47], v[72:75]
    v_mfma_f32_16x16x32_bf16 v[76:79], a[108:111], v[44:47], v[76:79]
    v_mfma_f32_16x16x32_bf16 v[64:67], a[112:115], v[48:51], v[64:67]
    v_mfma_f32_16x16x32_bf16 v[68:71], a[116:119], v[48:51], v[68:71]
    v_mfma_f32_16x16x32_bf16 v[72:75], a[112:115], v[52:55], v[72:75]
    v_mfma_f32_16x16x32_bf16 v[76:79], a[116:119], v[52:55], v[76:79]
    v_mfma_f32_16x16x32_bf16 v[64:67], a[120:123], v[56:59], v[64:67]
    v_mfma_f32_16x16x32_bf16 v[68:71], a[124:127], v[56:59], v[68:71]
    v_mfma_f32_16x16x32_bf16 v[72:75], a[120:123], v[60:63], v[72:75]
    v_mfma_f32_16x16x32_bf16 v[76:79], a[124:127], v[60:63], v[76:79]
    s_branch .s0j_395
.s0v_394:
    v_mfma_f32_16x16x32_bf16 v[64:67], v[32:35], a[96:99], v[64:67]
    v_mfma_f32_16x16x32_bf16 v[68:71], v[32:35], a[100:103], v[68:71]
    v_mfma_f32_16x16x32_bf16 v[72:75], v[36:39], a[96:99], v[72:75]
    v_mfma_f32_16x16x32_bf16 v[76:79], v[36:39], a[100:103], v[76:79]
    v_mfma_f32_16x16x32_bf16 v[64:67], v[40:43], a[104:107], v[64:67]
    v_mfma_f32_16x16x32_bf16 v[68:71], v[40:43], a[108:111], v[68:71]
    v_mfma_f32_16x16x32_bf16 v[72:75], v[44:47], a[104:107], v[72:75]
    v_mfma_f32_16x16x32_bf16 v[76:79], v[44:47], a[108:111], v[76:79]
    v_mfma_f32_16x16x32_bf16 v[64:67], v[48:51], a[112:115], v[64:67]
    v_mfma_f32_16x16x32_bf16 v[68:71], v[48:51], a[116:119], v[68:71]
    v_mfma_f32_16x16x32_bf16 v[72:75], v[52:55], a[112:115], v[72:75]
    v_mfma_f32_16x16x32_bf16 v[76:79], v[52:55], a[116:119], v[76:79]
    v_mfma_f32_16x16x32_bf16 v[64:67], v[56:59], a[120:123], v[64:67]
    v_mfma_f32_16x16x32_bf16 v[68:71], v[56:59], a[124:127], v[68:71]
    v_mfma_f32_16x16x32_bf16 v[72:75], v[60:63], a[120:123], v[72:75]
    v_mfma_f32_16x16x32_bf16 v[76:79], v[60:63], a[124:127], v[76:79]
.s0j_395:
    s_waitcnt vmcnt(17)
    s_barrier
    ds_read_b64_tr_b16 a[128:129], v12 offset:0
    ds_read_b64_tr_b16 a[130:131], v12 offset:1024
    ds_read_b64_tr_b16 a[132:133], v13 offset:0
    ds_read_b64_tr_b16 a[134:135], v13 offset:1024
    ds_read_b64_tr_b16 a[136:137], v12 offset:8192
    ds_read_b64_tr_b16 a[138:139], v12 offset:9216
    ds_read_b64_tr_b16 a[140:141], v13 offset:8192
    ds_read_b64_tr_b16 a[142:143], v13 offset:9216
    ds_read_b64_tr_b16 a[144:145], v12 offset:16384
    ds_read_b64_tr_b16 a[146:147], v12 offset:17408
    ds_read_b64_tr_b16 a[148:149], v13 offset:16384
    ds_read_b64_tr_b16 a[150:151], v13 offset:17408
    ds_read_b64_tr_b16 a[152:153], v12 offset:24576
    ds_read_b64_tr_b16 a[154:155], v12 offset:25600
    ds_read_b64_tr_b16 a[156:157], v13 offset:24576
    ds_read_b64_tr_b16 a[158:159], v13 offset:25600
    ds_read_b128 v[32:35], v17 offset:32768
    ds_read_b128 v[36:39], v17 offset:49152
    ds_read_b128 v[40:43], v18 offset:32768
    ds_read_b128 v[44:47], v18 offset:49152
    ds_read_b128 v[48:51], v17 offset:33792
    ds_read_b128 v[52:55], v17 offset:50176
    ds_read_b128 v[56:59], v18 offset:33792
    ds_read_b128 v[60:63], v18 offset:50176
    s_waitcnt lgkmcnt(0)
    s_barrier
    s_add_u32 m0, s29, 0
    s_add_u32 s4, s28, 7340032
    buffer_load_dwordx4 v10, s[12:15], s4 offen lds

    s_add_u32 m0, s29, 1024
    s_add_u32 s4, s28, 7372800
    buffer_load_dwordx4 v10, s[12:15], s4 offen lds

    s_add_u32 m0, s29, 2048
    s_add_u32 s4, s28, 7405568
    buffer_load_dwordx4 v11, s[12:15], s4 offen lds

    s_add_u32 m0, s29, 3072
    s_add_u32 s4, s28, 7438336
    buffer_load_dwordx4 v11, s[12:15], s4 offen lds

    s_add_u32 m0, s29, 4096
    s_add_u32 s4, s28, 7471104
    buffer_load_dwordx4 v10, s[12:15], s4 offen lds

    s_add_u32 m0, s29, 5120
    s_add_u32 s4, s28, 7503872
    buffer_load_dwordx4 v10, s[12:15], s4 offen lds

    s_add_u32 m0, s29, 6144
    s_add_u32 s4, s28, 7536640
    buffer_load_dwordx4 v11, s[12:15], s4 offen lds

    s_add_u32 m0, s29, 7168
    s_add_u32 s4, s28, 7569408
    buffer_load_dwordx4 v11, s[12:15], s4 offen lds

    s_cmp_eq_u32 s30, 2
    s_cbranch_scc1 .s0v_396
    v_mfma_f32_16x16x32_bf16 v[64:67], a[128:131], v[32:35], v[64:67]
    v_mfma_f32_16x16x32_bf16 v[68:71], a[132:135], v[32:35], v[68:71]
    v_mfma_f32_16x16x32_bf16 v[72:75], a[128:131], v[36:39], v[72:75]
    v_mfma_f32_16x16x32_bf16 v[76:79], a[132:135], v[36:39], v[76:79]
    v_mfma_f32_16x16x32_bf16 v[64:67], a[136:139], v[40:43], v[64:67]
    v_mfma_f32_16x16x32_bf16 v[68:71], a[140:143], v[40:43], v[68:71]
    v_mfma_f32_16x16x32_bf16 v[72:75], a[136:139], v[44:47], v[72:75]
    v_mfma_f32_16x16x32_bf16 v[76:79], a[140:143], v[44:47], v[76:79]
    v_mfma_f32_16x16x32_bf16 v[64:67], a[144:147], v[48:51], v[64:67]
    v_mfma_f32_16x16x32_bf16 v[68:71], a[148:151], v[48:51], v[68:71]
    v_mfma_f32_16x16x32_bf16 v[72:75], a[144:147], v[52:55], v[72:75]
    v_mfma_f32_16x16x32_bf16 v[76:79], a[148:151], v[52:55], v[76:79]
    v_mfma_f32_16x16x32_bf16 v[64:67], a[152:155], v[56:59], v[64:67]
    v_mfma_f32_16x16x32_bf16 v[68:71], a[156:159], v[56:59], v[68:71]
    v_mfma_f32_16x16x32_bf16 v[72:75], a[152:155], v[60:63], v[72:75]
    v_mfma_f32_16x16x32_bf16 v[76:79], a[156:159], v[60:63], v[76:79]
    s_branch .s0j_397
.s0v_396:
    v_mfma_f32_16x16x32_bf16 v[64:67], v[32:35], a[128:131], v[64:67]
    v_mfma_f32_16x16x32_bf16 v[68:71], v[32:35], a[132:135], v[68:71]
    v_mfma_f32_16x16x32_bf16 v[72:75], v[36:39], a[128:131], v[72:75]
    v_mfma_f32_16x16x32_bf16 v[76:79], v[36:39], a[132:135], v[76:79]
    v_mfma_f32_16x16x32_bf16 v[64:67], v[40:43], a[136:139], v[64:67]
    v_mfma_f32_16x16x32_bf16 v[68:71], v[40:43], a[140:143], v[68:71]
    v_mfma_f32_16x16x32_bf16 v[72:75], v[44:47], a[136:139], v[72:75]
    v_mfma_f32_16x16x32_bf16 v[76:79], v[44:47], a[140:143], v[76:79]
    v_mfma_f32_16x16x32_bf16 v[64:67], v[48:51], a[144:147], v[64:67]
    v_mfma_f32_16x16x32_bf16 v[68:71], v[48:51], a[148:151], v[68:71]
    v_mfma_f32_16x16x32_bf16 v[72:75], v[52:55], a[144:147], v[72:75]
    v_mfma_f32_16x16x32_bf16 v[76:79], v[52:55], a[148:151], v[76:79]
    v_mfma_f32_16x16x32_bf16 v[64:67], v[56:59], a[152:155], v[64:67]
    v_mfma_f32_16x16x32_bf16 v[68:71], v[56:59], a[156:159], v[68:71]
    v_mfma_f32_16x16x32_bf16 v[72:75], v[60:63], a[152:155], v[72:75]
    v_mfma_f32_16x16x32_bf16 v[76:79], v[60:63], a[156:159], v[76:79]
.s0j_397:
    s_waitcnt vmcnt(17)
    s_barrier
    ds_read_b64_tr_b16 a[160:161], v14 offset:0
    ds_read_b64_tr_b16 a[162:163], v14 offset:1024
    ds_read_b64_tr_b16 a[164:165], v15 offset:0
    ds_read_b64_tr_b16 a[166:167], v15 offset:1024
    ds_read_b64_tr_b16 a[168:169], v14 offset:8192
    ds_read_b64_tr_b16 a[170:171], v14 offset:9216
    ds_read_b64_tr_b16 a[172:173], v15 offset:8192
    ds_read_b64_tr_b16 a[174:175], v15 offset:9216
    ds_read_b64_tr_b16 a[176:177], v14 offset:16384
    ds_read_b64_tr_b16 a[178:179], v14 offset:17408
    ds_read_b64_tr_b16 a[180:181], v15 offset:16384
    ds_read_b64_tr_b16 a[182:183], v15 offset:17408
    ds_read_b64_tr_b16 a[184:185], v14 offset:24576
    ds_read_b64_tr_b16 a[186:187], v14 offset:25600
    ds_read_b64_tr_b16 a[188:189], v15 offset:24576
    ds_read_b64_tr_b16 a[190:191], v15 offset:25600
    ds_read_b128 v[32:35], v17 offset:34816
    ds_read_b128 v[36:39], v17 offset:51200
    ds_read_b128 v[40:43], v18 offset:34816
    ds_read_b128 v[44:47], v18 offset:51200
    ds_read_b128 v[48:51], v17 offset:35840
    ds_read_b128 v[52:55], v17 offset:52224
    ds_read_b128 v[56:59], v18 offset:35840
    ds_read_b128 v[60:63], v18 offset:52224
    s_waitcnt lgkmcnt(0)
    s_barrier
    s_add_u32 m0, s29, 65536
    s_nop 0
    buffer_load_dwordx4 v16, s[16:19], s34 offen offset:0 lds
    s_add_u32 m0, s29, 66432
    s_nop 0
    buffer_load_dwordx4 v16, s[16:19], s34 offen offset:128 lds
    s_add_u32 m0, s29, 67328
    s_nop 0
    buffer_load_dwordx4 v16, s[16:19], s34 offen offset:256 lds
    s_add_u32 m0, s29, 68224
    s_nop 0
    buffer_load_dwordx4 v16, s[16:19], s34 offen offset:384 lds
    s_add_u32 m0, s29, 69120
    s_nop 0
    buffer_load_dwordx4 v16, s[16:19], s34 offen offset:512 lds
    s_add_u32 m0, s29, 70016
    s_nop 0
    buffer_load_dwordx4 v16, s[16:19], s34 offen offset:640 lds
    s_add_u32 m0, s29, 70912
    s_nop 0
    buffer_load_dwordx4 v16, s[16:19], s34 offen offset:768 lds
    s_add_u32 m0, s29, 71808
    s_nop 0
    buffer_load_dwordx4 v16, s[16:19], s34 offen offset:896 lds
    s_add_u32 s34, s34, 1024
    s_cmp_eq_u32 s30, 2
    s_cbranch_scc1 .s0v_398
    v_mfma_f32_16x16x32_bf16 v[64:67], a[160:163], v[32:35], v[64:67]
    v_mfma_f32_16x16x32_bf16 v[68:71], a[164:167], v[32:35], v[68:71]
    v_mfma_f32_16x16x32_bf16 v[72:75], a[160:163], v[36:39], v[72:75]
    v_mfma_f32_16x16x32_bf16 v[76:79], a[164:167], v[36:39], v[76:79]
    v_mfma_f32_16x16x32_bf16 v[64:67], a[168:171], v[40:43], v[64:67]
    v_mfma_f32_16x16x32_bf16 v[68:71], a[172:175], v[40:43], v[68:71]
    v_mfma_f32_16x16x32_bf16 v[72:75], a[168:171], v[44:47], v[72:75]
    v_mfma_f32_16x16x32_bf16 v[76:79], a[172:175], v[44:47], v[76:79]
    v_mfma_f32_16x16x32_bf16 v[64:67], a[176:179], v[48:51], v[64:67]
    v_mfma_f32_16x16x32_bf16 v[68:71], a[180:183], v[48:51], v[68:71]
    v_mfma_f32_16x16x32_bf16 v[72:75], a[176:179], v[52:55], v[72:75]
    v_mfma_f32_16x16x32_bf16 v[76:79], a[180:183], v[52:55], v[76:79]
    v_mfma_f32_16x16x32_bf16 v[64:67], a[184:187], v[56:59], v[64:67]
    v_mfma_f32_16x16x32_bf16 v[68:71], a[188:191], v[56:59], v[68:71]
    v_mfma_f32_16x16x32_bf16 v[72:75], a[184:187], v[60:63], v[72:75]
    v_mfma_f32_16x16x32_bf16 v[76:79], a[188:191], v[60:63], v[76:79]
    s_branch .s0j_399
.s0v_398:
    v_mfma_f32_16x16x32_bf16 v[64:67], v[32:35], a[160:163], v[64:67]
    v_mfma_f32_16x16x32_bf16 v[68:71], v[32:35], a[164:167], v[68:71]
    v_mfma_f32_16x16x32_bf16 v[72:75], v[36:39], a[160:163], v[72:75]
    v_mfma_f32_16x16x32_bf16 v[76:79], v[36:39], a[164:167], v[76:79]
    v_mfma_f32_16x16x32_bf16 v[64:67], v[40:43], a[168:171], v[64:67]
    v_mfma_f32_16x16x32_bf16 v[68:71], v[40:43], a[172:175], v[68:71]
    v_mfma_f32_16x16x32_bf16 v[72:75], v[44:47], a[168:171], v[72:75]
    v_mfma_f32_16x16x32_bf16 v[76:79], v[44:47], a[172:175], v[76:79]
    v_mfma_f32_16x16x32_bf16 v[64:67], v[48:51], a[176:179], v[64:67]
    v_mfma_f32_16x16x32_bf16 v[68:71], v[48:51], a[180:183], v[68:71]
    v_mfma_f32_16x16x32_bf16 v[72:75], v[52:55], a[176:179], v[72:75]
    v_mfma_f32_16x16x32_bf16 v[76:79], v[52:55], a[180:183], v[76:79]
    v_mfma_f32_16x16x32_bf16 v[64:67], v[56:59], a[184:187], v[64:67]
    v_mfma_f32_16x16x32_bf16 v[68:71], v[56:59], a[188:191], v[68:71]
    v_mfma_f32_16x16x32_bf16 v[72:75], v[60:63], a[184:187], v[72:75]
    v_mfma_f32_16x16x32_bf16 v[76:79], v[60:63], a[188:191], v[76:79]
.s0j_399:
    s_waitcnt vmcnt(17)
    s_barrier
    ds_read_b64_tr_b16 a[192:193], v14 offset:32768
    ds_read_b64_tr_b16 a[194:195], v14 offset:33792
    ds_read_b64_tr_b16 a[196:197], v15 offset:32768
    ds_read_b64_tr_b16 a[198:199], v15 offset:33792
    ds_read_b64_tr_b16 a[200:201], v14 offset:40960
    ds_read_b64_tr_b16 a[202:203], v14 offset:41984
    ds_read_b64_tr_b16 a[204:205], v15 offset:40960
    ds_read_b64_tr_b16 a[206:207], v15 offset:41984
    ds_read_b64_tr_b16 a[208:209], v14 offset:49152
    ds_read_b64_tr_b16 a[210:211], v14 offset:50176
    ds_read_b64_tr_b16 a[212:213], v15 offset:49152
    ds_read_b64_tr_b16 a[214:215], v15 offset:50176
    ds_read_b64_tr_b16 a[216:217], v14 offset:57344
    ds_read_b64_tr_b16 a[218:219], v14 offset:58368
    ds_read_b64_tr_b16 a[220:221], v15 offset:57344
    ds_read_b64_tr_b16 a[222:223], v15 offset:58368
    ds_read_b128 v[32:35], v17 offset:36864
    ds_read_b128 v[36:39], v17 offset:53248
    ds_read_b128 v[40:43], v18 offset:36864
    ds_read_b128 v[44:47], v18 offset:53248
    ds_read_b128 v[48:51], v17 offset:37888
    ds_read_b128 v[52:55], v17 offset:54272
    ds_read_b128 v[56:59], v18 offset:37888
    ds_read_b128 v[60:63], v18 offset:54272
    s_waitcnt lgkmcnt(0)
    s_barrier
    s_add_u32 m0, s29, 98304
    s_nop 0
    buffer_load_dwordx4 v16, s[16:19], s34 offen offset:0 lds
    s_add_u32 m0, s29, 99200
    s_nop 0
    buffer_load_dwordx4 v16, s[16:19], s34 offen offset:128 lds
    s_add_u32 m0, s29, 100096
    s_nop 0
    buffer_load_dwordx4 v16, s[16:19], s34 offen offset:256 lds
    s_add_u32 m0, s29, 100992
    s_nop 0
    buffer_load_dwordx4 v16, s[16:19], s34 offen offset:384 lds
    s_add_u32 m0, s29, 101888
    s_nop 0
    buffer_load_dwordx4 v16, s[16:19], s34 offen offset:512 lds
    s_add_u32 m0, s29, 102784
    s_nop 0
    buffer_load_dwordx4 v16, s[16:19], s34 offen offset:640 lds
    s_add_u32 m0, s29, 103680
    s_nop 0
    buffer_load_dwordx4 v16, s[16:19], s34 offen offset:768 lds
    s_add_u32 m0, s29, 104576
    s_nop 0
    buffer_load_dwordx4 v16, s[16:19], s34 offen offset:896 lds
    s_add_u32 s34, s34, 64512
    s_min_u32 s34, s34, 4128768
    s_cmp_eq_u32 s30, 2
    s_cbranch_scc1 .s0v_400
    v_mfma_f32_16x16x32_bf16 v[64:67], a[192:195], v[32:35], v[64:67]
    v_mfma_f32_16x16x32_bf16 v[68:71], a[196:199], v[32:35], v[68:71]
    v_mfma_f32_16x16x32_bf16 v[72:75], a[192:195], v[36:39], v[72:75]
    v_mfma_f32_16x16x32_bf16 v[76:79], a[196:199], v[36:39], v[76:79]
    v_mfma_f32_16x16x32_bf16 v[64:67], a[200:203], v[40:43], v[64:67]
    v_mfma_f32_16x16x32_bf16 v[68:71], a[204:207], v[40:43], v[68:71]
    v_mfma_f32_16x16x32_bf16 v[72:75], a[200:203], v[44:47], v[72:75]
    v_mfma_f32_16x16x32_bf16 v[76:79], a[204:207], v[44:47], v[76:79]
    v_mfma_f32_16x16x32_bf16 v[64:67], a[208:211], v[48:51], v[64:67]
    v_mfma_f32_16x16x32_bf16 v[68:71], a[212:215], v[48:51], v[68:71]
    v_mfma_f32_16x16x32_bf16 v[72:75], a[208:211], v[52:55], v[72:75]
    v_mfma_f32_16x16x32_bf16 v[76:79], a[212:215], v[52:55], v[76:79]
    v_mfma_f32_16x16x32_bf16 v[64:67], a[216:219], v[56:59], v[64:67]
    v_mfma_f32_16x16x32_bf16 v[68:71], a[220:223], v[56:59], v[68:71]
    v_mfma_f32_16x16x32_bf16 v[72:75], a[216:219], v[60:63], v[72:75]
    v_mfma_f32_16x16x32_bf16 v[76:79], a[220:223], v[60:63], v[76:79]
    s_branch .s0j_401
.s0v_400:
    v_mfma_f32_16x16x32_bf16 v[64:67], v[32:35], a[192:195], v[64:67]
    v_mfma_f32_16x16x32_bf16 v[68:71], v[32:35], a[196:199], v[68:71]
    v_mfma_f32_16x16x32_bf16 v[72:75], v[36:39], a[192:195], v[72:75]
    v_mfma_f32_16x16x32_bf16 v[76:79], v[36:39], a[196:199], v[76:79]
    v_mfma_f32_16x16x32_bf16 v[64:67], v[40:43], a[200:203], v[64:67]
    v_mfma_f32_16x16x32_bf16 v[68:71], v[40:43], a[204:207], v[68:71]
    v_mfma_f32_16x16x32_bf16 v[72:75], v[44:47], a[200:203], v[72:75]
    v_mfma_f32_16x16x32_bf16 v[76:79], v[44:47], a[204:207], v[76:79]
    v_mfma_f32_16x16x32_bf16 v[64:67], v[48:51], a[208:211], v[64:67]
    v_mfma_f32_16x16x32_bf16 v[68:71], v[48:51], a[212:215], v[68:71]
    v_mfma_f32_16x16x32_bf16 v[72:75], v[52:55], a[208:211], v[72:75]
    v_mfma_f32_16x16x32_bf16 v[76:79], v[52:55], a[212:215], v[76:79]
    v_mfma_f32_16x16x32_bf16 v[64:67], v[56:59], a[216:219], v[64:67]
    v_mfma_f32_16x16x32_bf16 v[68:71], v[56:59], a[220:223], v[68:71]
    v_mfma_f32_16x16x32_bf16 v[72:75], v[60:63], a[216:219], v[72:75]
    v_mfma_f32_16x16x32_bf16 v[76:79], v[60:63], a[220:223], v[76:79]
.s0j_401:
    s_waitcnt vmcnt(16)
    s_barrier
    ds_read_b64_tr_b16 a[224:225], v12 offset:0
    ds_read_b64_tr_b16 a[226:227], v12 offset:1024
    ds_read_b64_tr_b16 a[228:229], v13 offset:0
    ds_read_b64_tr_b16 a[230:231], v13 offset:1024
    ds_read_b64_tr_b16 a[232:233], v12 offset:8192
    ds_read_b64_tr_b16 a[234:235], v12 offset:9216
    ds_read_b64_tr_b16 a[236:237], v13 offset:8192
    ds_read_b64_tr_b16 a[238:239], v13 offset:9216
    ds_read_b64_tr_b16 a[240:241], v12 offset:16384
    ds_read_b64_tr_b16 a[242:243], v12 offset:17408
    ds_read_b64_tr_b16 a[244:245], v13 offset:16384
    ds_read_b64_tr_b16 a[246:247], v13 offset:17408
    ds_read_b64_tr_b16 a[248:249], v12 offset:24576
    ds_read_b64_tr_b16 a[250:251], v12 offset:25600
    ds_read_b64_tr_b16 a[252:253], v13 offset:24576
    ds_read_b64_tr_b16 a[254:255], v13 offset:25600
    ds_read_b128 v[32:35], v17 offset:38912
    ds_read_b128 v[36:39], v17 offset:55296
    ds_read_b128 v[40:43], v18 offset:38912
    ds_read_b128 v[44:47], v18 offset:55296
    ds_read_b128 v[48:51], v17 offset:39936
    ds_read_b128 v[52:55], v17 offset:56320
    ds_read_b128 v[56:59], v18 offset:39936
    ds_read_b128 v[60:63], v18 offset:56320
    s_mov_b32 s62, 0
.vp_402:
    v_readlane_b32 s4, v240, 0
    v_readlane_b32 s7, v240, 1
    v_readlane_b32 s6, v240, 2

    v_readlane_b32 s5, v240, 4
    s_add_u32 s4, s4, s5
    v_readlane_b32 s5, v240, 8
    s_add_u32 s4, s4, s5
    v_readlane_b32 s5, v240, 12
    s_add_u32 s4, s4, s5
    s_cmp_ge_u32 s4, 256
    s_cbranch_scc1 .vd_403
    s_cmp_lg_u32 s6, 0
    s_cbranch_scc1 .vs_404
    s_add_u32 s62, s62, 1
    s_cmp_gt_u32 s62, 0x100000
    s_cbranch_scc1 .mg_end_1
    s_sleep 8
    buffer_load_dword v240, v241, s[20:23], 0 offen sc1
    s_waitcnt vmcnt(0)
    s_branch .vp_402

.vs_404:
    s_lshr_b32 s25, s2, 5
    s_and_b32 s26, s2, 31
    s_mov_b32 s27, 1
    s_mov_b32 s99, 1
    s_mov_b32 s97, 144
    s_waitcnt vmcnt(0) lgkmcnt(0)
    s_barrier
    s_branch .mg_role_3

.vd_403:
    s_waitcnt lgkmcnt(0)
    s_barrier
    s_add_u32 m0, s29, 0
    s_nop 0
    buffer_load_dwordx4 v16, s[16:19], s34 offen offset:0 lds
    s_add_u32 m0, s29, 896
    s_nop 0
    buffer_load_dwordx4 v16, s[16:19], s34 offen offset:128 lds
    s_add_u32 m0, s29, 1792
    s_nop 0
    buffer_load_dwordx4 v16, s[16:19], s34 offen offset:256 lds
    s_add_u32 m0, s29, 2688
    s_nop 0
    buffer_load_dwordx4 v16, s[16:19], s34 offen offset:384 lds
    s_add_u32 m0, s29, 3584
    s_nop 0
    buffer_load_dwordx4 v16, s[16:19], s34 offen offset:512 lds
    s_add_u32 m0, s29, 4480
    s_nop 0
    buffer_load_dwordx4 v16, s[16:19], s34 offen offset:640 lds
    s_add_u32 m0, s29, 5376
    s_nop 0
    buffer_load_dwordx4 v16, s[16:19], s34 offen offset:768 lds
    s_add_u32 m0, s29, 6272
    s_nop 0
    buffer_load_dwordx4 v16, s[16:19], s34 offen offset:896 lds
    s_add_u32 s34, s34, 1024
    s_cmp_eq_u32 s30, 2
    s_cbranch_scc1 .s0v_405
    v_mfma_f32_16x16x32_bf16 v[64:67], a[224:227], v[32:35], v[64:67]
    v_mfma_f32_16x16x32_bf16 v[68:71], a[228:231], v[32:35], v[68:71]
    v_mfma_f32_16x16x32_bf16 v[72:75], a[224:227], v[36:39], v[72:75]
    v_mfma_f32_16x16x32_bf16 v[76:79], a[228:231], v[36:39], v[76:79]
    v_mfma_f32_16x16x32_bf16 v[64:67], a[232:235], v[40:43], v[64:67]
    v_mfma_f32_16x16x32_bf16 v[68:71], a[236:239], v[40:43], v[68:71]
    v_mfma_f32_16x16x32_bf16 v[72:75], a[232:235], v[44:47], v[72:75]
    v_mfma_f32_16x16x32_bf16 v[76:79], a[236:239], v[44:47], v[76:79]
    v_mfma_f32_16x16x32_bf16 v[64:67], a[240:243], v[48:51], v[64:67]
    v_mfma_f32_16x16x32_bf16 v[68:71], a[244:247], v[48:51], v[68:71]
    v_mfma_f32_16x16x32_bf16 v[72:75], a[240:243], v[52:55], v[72:75]
    v_mfma_f32_16x16x32_bf16 v[76:79], a[244:247], v[52:55], v[76:79]
    v_mfma_f32_16x16x32_bf16 v[64:67], a[248:251], v[56:59], v[64:67]
    v_mfma_f32_16x16x32_bf16 v[68:71], a[252:255], v[56:59], v[68:71]
    v_mfma_f32_16x16x32_bf16 v[72:75], a[248:251], v[60:63], v[72:75]
    v_mfma_f32_16x16x32_bf16 v[76:79], a[252:255], v[60:63], v[76:79]
    s_branch .s0j_406
.s0v_405:
    v_mfma_f32_16x16x32_bf16 v[64:67], v[32:35], a[224:227], v[64:67]
    v_mfma_f32_16x16x32_bf16 v[68:71], v[32:35], a[228:231], v[68:71]
    v_mfma_f32_16x16x32_bf16 v[72:75], v[36:39], a[224:227], v[72:75]
    v_mfma_f32_16x16x32_bf16 v[76:79], v[36:39], a[228:231], v[76:79]
    v_mfma_f32_16x16x32_bf16 v[64:67], v[40:43], a[232:235], v[64:67]
    v_mfma_f32_16x16x32_bf16 v[68:71], v[40:43], a[236:239], v[68:71]
    v_mfma_f32_16x16x32_bf16 v[72:75], v[44:47], a[232:235], v[72:75]
    v_mfma_f32_16x16x32_bf16 v[76:79], v[44:47], a[236:239], v[76:79]
    v_mfma_f32_16x16x32_bf16 v[64:67], v[48:51], a[240:243], v[64:67]
    v_mfma_f32_16x16x32_bf16 v[68:71], v[48:51], a[244:247], v[68:71]
    v_mfma_f32_16x16x32_bf16 v[72:75], v[52:55], a[240:243], v[72:75]
    v_mfma_f32_16x16x32_bf16 v[76:79], v[52:55], a[244:247], v[76:79]
    v_mfma_f32_16x16x32_bf16 v[64:67], v[56:59], a[248:251], v[64:67]
    v_mfma_f32_16x16x32_bf16 v[68:71], v[56:59], a[252:255], v[68:71]
    v_mfma_f32_16x16x32_bf16 v[72:75], v[60:63], a[248:251], v[72:75]
    v_mfma_f32_16x16x32_bf16 v[76:79], v[60:63], a[252:255], v[76:79]
.s0j_406:
    buffer_store_dwordx4 v[24:27], v28, s[8:11], s46 offen sc1
    buffer_store_dwordx4 v[24:27], v29, s[8:11], s46 offen sc1
    s_cmp_eq_u32 s30, 2
    s_cbranch_scc1 .qv_386
    s_waitcnt vmcnt(16)
    s_barrier
    ds_read_b128 v[32:35], v19 offset:0
    ds_read_b128 v[36:39], v19 offset:16384
    ds_read_b128 v[40:43], v20 offset:0
    ds_read_b128 v[44:47], v20 offset:16384
    s_add_u32 m0, s29, 32768
    s_nop 0
    buffer_load_dwordx4 v16, s[16:19], s34 offen offset:0 lds
    ds_read_b128 v[48:51], v19 offset:1024
    ds_read_b128 v[52:55], v19 offset:17408
    s_branch .qe_408
.p2align 6
.ql_407:
    s_waitcnt lgkmcnt(4)
    v_mfma_f32_16x16x32_bf16 v[64:67], a[0:3], v[32:35], 0
    ds_read_b128 v[56:59], v18 offset:1024
    s_add_u32 m0, s29, 99200
    v_mfma_f32_16x16x32_bf16 v[68:71], a[4:7], v[32:35], 0
    buffer_load_dwordx4 v16, s[16:19], s34 offen offset:128 lds
    v_mfma_f32_16x16x32_bf16 v[72:75], a[0:3], v[36:39], 0
    ds_read_b128 v[60:63], v18 offset:17408
    v_mfma_f32_16x16x32_bf16 v[76:79], a[4:7], v[36:39], 0
    s_mov_b32 exec_hi, 0
    buffer_store_dwordx4 v[24:27], v21, s[8:11], s48 offen sc1
    s_mov_b32 exec_hi, -1

    s_waitcnt lgkmcnt(4)
    v_mfma_f32_16x16x32_bf16 v[64:67], a[8:11], v[40:43], v[64:67]
    ds_read_b128 v[32:35], v17 offset:2048
    v_mfma_f32_16x16x32_bf16 v[68:71], a[12:15], v[40:43], v[68:71]
    v_cvt_pk_bf16_f32 v96, v80, v81
    v_cvt_pk_bf16_f32 v97, v82, v83
    v_cvt_pk_bf16_f32 v98, v84, v85
    v_mfma_f32_16x16x32_bf16 v[72:75], a[8:11], v[44:47], v[72:75]
    ds_read_b128 v[36:39], v17 offset:18432
    v_mfma_f32_16x16x32_bf16 v[76:79], a[12:15], v[44:47], v[76:79]
    v_cvt_pk_bf16_f32 v99, v86, v87
    v_cvt_pk_bf16_f32 v100, v88, v89
    buffer_store_dwordx4 v[96:99], v21, s[8:11], s32 offen sc1
    s_waitcnt lgkmcnt(4)
    v_mfma_f32_16x16x32_bf16 v[64:67], a[16:19], v[48:51], v[64:67]
    ds_read_b128 v[40:43], v18 offset:2048
    s_add_u32 m0, s29, 100096
    v_mfma_f32_16x16x32_bf16 v[68:71], a[20:23], v[48:51], v[68:71]
    buffer_load_dwordx4 v16, s[16:19], s34 offen offset:256 lds
    v_mfma_f32_16x16x32_bf16 v[72:75], a[16:19], v[52:55], v[72:75]
    ds_read_b128 v[44:47], v18 offset:18432
    v_mfma_f32_16x16x32_bf16 v[76:79], a[20:23], v[52:55], v[76:79]
    v_cvt_pk_bf16_f32 v101, v90, v91
    v_cvt_pk_bf16_f32 v102, v92, v93
    v_cvt_pk_bf16_f32 v103, v94, v95
    s_waitcnt lgkmcnt(4)
    v_mfma_f32_16x16x32_bf16 v[64:67], a[24:27], v[56:59], v[64:67]
    ds_read_b128 v[48:51], v17 offset:3072
    v_mfma_f32_16x16x32_bf16 v[68:71], a[28:31], v[56:59], v[68:71]
    buffer_store_dwordx4 v[100:103], v21, s[8:11], s38 offen sc1
    v_mfma_f32_16x16x32_bf16 v[72:75], a[24:27], v[60:63], v[72:75]
    ds_read_b128 v[52:55], v17 offset:19456
    v_mfma_f32_16x16x32_bf16 v[76:79], a[28:31], v[60:63], v[76:79]
    s_waitcnt lgkmcnt(4)
    v_mfma_f32_16x16x32_bf16 v[64:67], a[32:35], v[32:35], v[64:67]
    ds_read_b128 v[56:59], v18 offset:3072
    s_add_u32 m0, s29, 100992
    v_mfma_f32_16x16x32_bf16 v[68:71], a[36:39], v[32:35], v[68:71]
    buffer_load_dwordx4 v16, s[16:19], s34 offen offset:384 lds
    v_mfma_f32_16x16x32_bf16 v[72:75], a[32:35], v[36:39], v[72:75]
    ds_read_b128 v[60:63], v18 offset:19456
    v_mfma_f32_16x16x32_bf16 v[76:79], a[36:39], v[36:39], v[76:79]
    s_waitcnt lgkmcnt(4)
    v_mfma_f32_16x16x32_bf16 v[64:67], a[40:43], v[40:43], v[64:67]
    ds_read_b128 v[32:35], v17 offset:4096
    v_mfma_f32_16x16x32_bf16 v[68:71], a[44:47], v[40:43], v[68:71]
    v_mfma_f32_16x16x32_bf16 v[72:75], a[40:43], v[44:47], v[72:75]
    ds_read_b128 v[36:39], v17 offset:20480
    v_mfma_f32_16x16x32_bf16 v[76:79], a[44:47], v[44:47], v[76:79]
    s_waitcnt lgkmcnt(4)
    v_mfma_f32_16x16x32_bf16 v[64:67], a[48:51], v[48:51], v[64:67]
    ds_read_b128 v[40:43], v18 offset:4096
    s_add_u32 m0, s29, 101888
    v_mfma_f32_16x16x32_bf16 v[68:71], a[52:55], v[48:51], v[68:71]
    buffer_load_dwordx4 v16, s[16:19], s34 offen offset:512 lds
    v_mfma_f32_16x16x32_bf16 v[72:75], a[48:51], v[52:55], v[72:75]
    ds_read_b128 v[44:47], v18 offset:20480
    v_mfma_f32_16x16x32_bf16 v[76:79], a[52:55], v[52:55], v[76:79]
    s_waitcnt lgkmcnt(4)
    v_mfma_f32_16x16x32_bf16 v[64:67], a[56:59], v[56:59], v[64:67]
    ds_read_b128 v[48:51], v17 offset:5120
    v_mfma_f32_16x16x32_bf16 v[68:71], a[60:63], v[56:59], v[68:71]
    v_mfma_f32_16x16x32_bf16 v[72:75], a[56:59], v[60:63], v[72:75]
    ds_read_b128 v[52:55], v17 offset:21504
    v_mfma_f32_16x16x32_bf16 v[76:79], a[60:63], v[60:63], v[76:79]
    s_waitcnt lgkmcnt(4)
    v_mfma_f32_16x16x32_bf16 v[64:67], a[64:67], v[32:35], v[64:67]
    ds_read_b128 v[56:59], v18 offset:5120
    s_add_u32 m0, s29, 102784
    v_mfma_f32_16x16x32_bf16 v[68:71], a[68:71], v[32:35], v[68:71]
    buffer_load_dwordx4 v16, s[16:19], s34 offen offset:640 lds
    v_mfma_f32_16x16x32_bf16 v[72:75], a[64:67], v[36:39], v[72:75]
    ds_read_b128 v[60:63], v18 offset:21504
    v_mfma_f32_16x16x32_bf16 v[76:79], a[68:71], v[36:39], v[76:79]
    s_waitcnt lgkmcnt(4)
    v_mfma_f32_16x16x32_bf16 v[64:67], a[72:75], v[40:43], v[64:67]
    ds_read_b128 v[32:35], v17 offset:6144
    v_mfma_f32_16x16x32_bf16 v[68:71], a[76:79], v[40:43], v[68:71]
    s_mov_b32 s32, s39
    s_add_u32 s38, s39, 4096
    s_add_u32 s39, s39, 262144
    s_mov_b32 s48, s49
    s_add_u32 s49, s49, 196608
    v_mfma_f32_16x16x32_bf16 v[72:75], a[72:75], v[44:47], v[72:75]
    ds_read_b128 v[36:39], v17 offset:22528
    v_mfma_f32_16x16x32_bf16 v[76:79], a[76:79], v[44:47], v[76:79]
    v_add_u32 v23, 1, v23
    s_waitcnt lgkmcnt(4)
    v_mfma_f32_16x16x32_bf16 v[64:67], a[80:83], v[48:51], v[64:67]
    ds_read_b128 v[40:43], v18 offset:6144
    s_add_u32 m0, s29, 103680
    v_mfma_f32_16x16x32_bf16 v[68:71], a[84:87], v[48:51], v[68:71]
    buffer_load_dwordx4 v16, s[16:19], s34 offen offset:768 lds
    v_mfma_f32_16x16x32_bf16 v[72:75], a[80:83], v[52:55], v[72:75]
    ds_read_b128 v[44:47], v18 offset:22528
    v_mfma_f32_16x16x32_bf16 v[76:79], a[84:87], v[52:55], v[76:79]
    s_waitcnt lgkmcnt(4)
    v_mfma_f32_16x16x32_bf16 v[64:67], a[88:91], v[56:59], v[64:67]
    ds_read_b128 v[48:51], v17 offset:7168
    v_mfma_f32_16x16x32_bf16 v[68:71], a[92:95], v[56:59], v[68:71]
    v_mfma_f32_16x16x32_bf16 v[72:75], a[88:91], v[60:63], v[72:75]
    ds_read_b128 v[52:55], v17 offset:23552
    v_mfma_f32_16x16x32_bf16 v[76:79], a[92:95], v[60:63], v[76:79]
    s_mov_b64 exec, s[44:45]
    buffer_store_dwordx4 v[24:27], v28, s[8:11], s46 offen sc1
    s_mov_b64 exec, -1
    s_waitcnt lgkmcnt(4)
    v_mfma_f32_16x16x32_bf16 v[64:67], a[96:99], v[32:35], v[64:67]
    ds_read_b128 v[56:59], v18 offset:7168
    s_add_u32 m0, s29, 104576
    v_mfma_f32_16x16x32_bf16 v[68:71], a[100:103], v[32:35], v[68:71]
    buffer_load_dwordx4 v16, s[16:19], s34 offen offset:896 lds
    v_mfma_f32_16x16x32_bf16 v[72:75], a[96:99], v[36:39], v[72:75]
    ds_read_b128 v[60:63], v18 offset:23552
    v_mfma_f32_16x16x32_bf16 v[76:79], a[100:103], v[36:39], v[76:79]
    s_waitcnt lgkmcnt(4)
    v_mfma_f32_16x16x32_bf16 v[64:67], a[104:107], v[40:43], v[64:67]
    s_add_u32 s34, s34, 64512
    s_min_u32 s34, s34, 4128768
    v_mfma_f32_16x16x32_bf16 v[68:71], a[108:111], v[40:43], v[68:71]
    v_mfma_f32_16x16x32_bf16 v[72:75], a[104:107], v[44:47], v[72:75]
    v_mfma_f32_16x16x32_bf16 v[76:79], a[108:111], v[44:47], v[76:79]
    s_waitcnt lgkmcnt(0)
    s_cmp_lt_u32 s35, 2
    s_cselect_b64 s[70:71], s[36:37], 0
    s_cbranch_scc0 .ef_409
    s_waitcnt vmcnt(5)
.ef_409:
    s_waitcnt vmcnt(19)
    s_barrier
    ds_read_b128 v[32:35], v17 offset:32768
    ds_read_b128 v[36:39], v17 offset:49152
    v_mfma_f32_16x16x32_bf16 v[64:67], a[112:115], v[48:51], v[64:67]
    ds_read_b128 v[40:43], v18 offset:32768
    s_add_u32 m0, s29, 0
    v_mfma_f32_16x16x32_bf16 v[68:71], a[116:119], v[48:51], v[68:71]
    buffer_load_dwordx4 v16, s[16:19], s34 offen offset:0 lds
    v_mfma_f32_16x16x32_bf16 v[72:75], a[112:115], v[52:55], v[72:75]
    ds_read_b128 v[44:47], v18 offset:49152
    v_mfma_f32_16x16x32_bf16 v[76:79], a[116:119], v[52:55], v[76:79]
    v_mfma_f32_16x16x32_bf16 v[64:67], a[120:123], v[56:59], v[64:67]
    ds_read_b128 v[48:51], v17 offset:33792
    v_mfma_f32_16x16x32_bf16 v[68:71], a[124:127], v[56:59], v[68:71]
    v_mfma_f32_16x16x32_bf16 v[72:75], a[120:123], v[60:63], v[72:75]
    ds_read_b128 v[52:55], v17 offset:50176
    v_mfma_f32_16x16x32_bf16 v[76:79], a[124:127], v[60:63], v[76:79]
    s_mov_b64 exec, s[70:71]
    buffer_store_dword v23, v22, s[8:11], s33 offen sc1
    s_mov_b64 exec, -1

    s_waitcnt lgkmcnt(4)
    v_mfma_f32_16x16x32_bf16 v[64:67], a[128:131], v[32:35], v[64:67]
    ds_read_b128 v[56:59], v18 offset:33792
    s_add_u32 m0, s29, 896
    v_mfma_f32_16x16x32_bf16 v[68:71], a[132:135], v[32:35], v[68:71]
    buffer_load_dwordx4 v16, s[16:19], s34 offen offset:128 lds
    v_mfma_f32_16x16x32_bf16 v[72:75], a[128:131], v[36:39], v[72:75]
    ds_read_b128 v[60:63], v18 offset:50176
    v_mfma_f32_16x16x32_bf16 v[76:79], a[132:135], v[36:39], v[76:79]
    s_waitcnt lgkmcnt(4)
    v_mfma_f32_16x16x32_bf16 v[64:67], a[136:139], v[40:43], v[64:67]
    ds_read_b128 v[32:35], v17 offset:34816
    v_mfma_f32_16x16x32_bf16 v[68:71], a[140:143], v[40:43], v[68:71]
    v_mfma_f32_16x16x32_bf16 v[72:75], a[136:139], v[44:47], v[72:75]
    ds_read_b128 v[36:39], v17 offset:51200
    v_mfma_f32_16x16x32_bf16 v[76:79], a[140:143], v[44:47], v[76:79]
    s_waitcnt lgkmcnt(4)
    v_mfma_f32_16x16x32_bf16 v[64:67], a[144:147], v[48:51], v[64:67]
    ds_read_b128 v[40:43], v18 offset:34816
    s_add_u32 m0, s29, 1792
    v_mfma_f32_16x16x32_bf16 v[68:71], a[148:151], v[48:51], v[68:71]
    buffer_load_dwordx4 v16, s[16:19], s34 offen offset:256 lds
    v_mfma_f32_16x16x32_bf16 v[72:75], a[144:147], v[52:55], v[72:75]
    ds_read_b128 v[44:47], v18 offset:51200
    v_mfma_f32_16x16x32_bf16 v[76:79], a[148:151], v[52:55], v[76:79]
    s_waitcnt lgkmcnt(4)
    v_mfma_f32_16x16x32_bf16 v[64:67], a[152:155], v[56:59], v[64:67]
    ds_read_b128 v[48:51], v17 offset:35840
    v_mfma_f32_16x16x32_bf16 v[68:71], a[156:159], v[56:59], v[68:71]
    v_mfma_f32_16x16x32_bf16 v[72:75], a[152:155], v[60:63], v[72:75]
    ds_read_b128 v[52:55], v17 offset:52224
    v_mfma_f32_16x16x32_bf16 v[76:79], a[156:159], v[60:63], v[76:79]
    s_waitcnt lgkmcnt(4)
    v_mfma_f32_16x16x32_bf16 v[64:67], a[160:163], v[32:35], v[64:67]
    ds_read_b128 v[56:59], v18 offset:35840
    s_add_u32 m0, s29, 2688
    v_mfma_f32_16x16x32_bf16 v[68:71], a[164:167], v[32:35], v[68:71]
    buffer_load_dwordx4 v16, s[16:19], s34 offen offset:384 lds
    v_mfma_f32_16x16x32_bf16 v[72:75], a[160:163], v[36:39], v[72:75]
    ds_read_b128 v[60:63], v18 offset:52224
    v_mfma_f32_16x16x32_bf16 v[76:79], a[164:167], v[36:39], v[76:79]
    s_waitcnt lgkmcnt(4)
    v_mfma_f32_16x16x32_bf16 v[64:67], a[168:171], v[40:43], v[64:67]
    ds_read_b128 v[32:35], v17 offset:36864
    v_mfma_f32_16x16x32_bf16 v[68:71], a[172:175], v[40:43], v[68:71]
    v_mfma_f32_16x16x32_bf16 v[72:75], a[168:171], v[44:47], v[72:75]
    ds_read_b128 v[36:39], v17 offset:53248
    v_mfma_f32_16x16x32_bf16 v[76:79], a[172:175], v[44:47], v[76:79]
    s_waitcnt lgkmcnt(4)
    v_mfma_f32_16x16x32_bf16 v[64:67], a[176:179], v[48:51], v[64:67]
    ds_read_b128 v[40:43], v18 offset:36864
    s_add_u32 m0, s29, 3584
    v_mfma_f32_16x16x32_bf16 v[68:71], a[180:183], v[48:51], v[68:71]
    buffer_load_dwordx4 v16, s[16:19], s34 offen offset:512 lds
    v_mfma_f32_16x16x32_bf16 v[72:75], a[176:179], v[52:55], v[72:75]
    ds_read_b128 v[44:47], v18 offset:53248
    v_mfma_f32_16x16x32_bf16 v[76:79], a[180:183], v[52:55], v[76:79]
    s_waitcnt lgkmcnt(4)
    v_mfma_f32_16x16x32_bf16 v[64:67], a[184:187], v[56:59], v[64:67]
    ds_read_b128 v[48:51], v17 offset:37888
    v_mfma_f32_16x16x32_bf16 v[68:71], a[188:191], v[56:59], v[68:71]
    v_mfma_f32_16x16x32_bf16 v[72:75], a[184:187], v[60:63], v[72:75]
    ds_read_b128 v[52:55], v17 offset:54272
    v_mfma_f32_16x16x32_bf16 v[76:79], a[188:191], v[60:63], v[76:79]
    s_waitcnt lgkmcnt(4)
    v_mfma_f32_16x16x32_bf16 v[64:67], a[192:195], v[32:35], v[64:67]
    ds_read_b128 v[56:59], v18 offset:37888
    s_add_u32 m0, s29, 4480
    v_mfma_f32_16x16x32_bf16 v[68:71], a[196:199], v[32:35], v[68:71]
    buffer_load_dwordx4 v16, s[16:19], s34 offen offset:640 lds
    v_mfma_f32_16x16x32_bf16 v[72:75], a[192:195], v[36:39], v[72:75]
    ds_read_b128 v[60:63], v18 offset:54272
    v_mfma_f32_16x16x32_bf16 v[76:79], a[196:199], v[36:39], v[76:79]
    s_waitcnt lgkmcnt(4)
    v_mfma_f32_16x16x32_bf16 v[64:67], a[200:203], v[40:43], v[64:67]
    ds_read_b128 v[32:35], v17 offset:38912
    v_mfma_f32_16x16x32_bf16 v[68:71], a[204:207], v[40:43], v[68:71]
    v_mfma_f32_16x16x32_bf16 v[72:75], a[200:203], v[44:47], v[72:75]
    ds_read_b128 v[36:39], v17 offset:55296
    v_mfma_f32_16x16x32_bf16 v[76:79], a[204:207], v[44:47], v[76:79]
    s_waitcnt lgkmcnt(4)
    v_mfma_f32_16x16x32_bf16 v[64:67], a[208:211], v[48:51], v[64:67]
    ds_read_b128 v[40:43], v18 offset:38912
    s_add_u32 m0, s29, 5376
    v_mfma_f32_16x16x32_bf16 v[68:71], a[212:215], v[48:51], v[68:71]
    buffer_load_dwordx4 v16, s[16:19], s34 offen offset:768 lds
    v_mfma_f32_16x16x32_bf16 v[72:75], a[208:211], v[52:55], v[72:75]
    ds_read_b128 v[44:47], v18 offset:55296
    v_mfma_f32_16x16x32_bf16 v[76:79], a[212:215], v[52:55], v[76:79]
    s_waitcnt lgkmcnt(4)
    v_mfma_f32_16x16x32_bf16 v[64:67], a[216:219], v[56:59], v[64:67]
    ds_read_b128 v[48:51], v17 offset:39936
    v_mfma_f32_16x16x32_bf16 v[68:71], a[220:223], v[56:59], v[68:71]
    v_mfma_f32_16x16x32_bf16 v[72:75], a[216:219], v[60:63], v[72:75]
    ds_read_b128 v[52:55], v17 offset:56320
    v_mfma_f32_16x16x32_bf16 v[76:79], a[220:223], v[60:63], v[76:79]
    s_mov_b64 exec, s[44:45]
    buffer_store_dwordx4 v[24:27], v29, s[8:11], s46 offen sc1
    s_mov_b64 exec, -1
    s_waitcnt lgkmcnt(4)
    v_mfma_f32_16x16x32_bf16 v[64:67], a[224:227], v[32:35], v[64:67]
    ds_read_b128 v[56:59], v18 offset:39936
    s_add_u32 m0, s29, 6272
    v_mfma_f32_16x16x32_bf16 v[68:71], a[228:231], v[32:35], v[68:71]
    buffer_load_dwordx4 v16, s[16:19], s34 offen offset:896 lds
    v_mfma_f32_16x16x32_bf16 v[72:75], a[224:227], v[36:39], v[72:75]
    ds_read_b128 v[60:63], v18 offset:56320
    v_mfma_f32_16x16x32_bf16 v[76:79], a[228:231], v[36:39], v[76:79]
    s_waitcnt lgkmcnt(4)
    v_mfma_f32_16x16x32_bf16 v[64:67], a[232:235], v[40:43], v[64:67]
    s_add_u32 s34, s34, 1024
    v_mfma_f32_16x16x32_bf16 v[68:71], a[236:239], v[40:43], v[68:71]
    v_mfma_f32_16x16x32_bf16 v[72:75], a[232:235], v[44:47], v[72:75]
    v_mfma_f32_16x16x32_bf16 v[76:79], a[236:239], v[44:47], v[76:79]
    s_waitcnt lgkmcnt(0)
    s_waitcnt vmcnt(13)
    s_barrier
    ds_read_b128 v[32:35], v19 offset:0
    ds_read_b128 v[36:39], v19 offset:16384
    v_mfma_f32_16x16x32_bf16 v[64:67], a[240:243], v[48:51], v[64:67]
    ds_read_b128 v[40:43], v20 offset:0
    s_add_u32 m0, s29, 32768
    v_mfma_f32_16x16x32_bf16 v[68:71], a[244:247], v[48:51], v[68:71]
    buffer_load_dwordx4 v16, s[16:19], s34 offen offset:0 lds
    v_mfma_f32_16x16x32_bf16 v[72:75], a[240:243], v[52:55], v[72:75]
    ds_read_b128 v[44:47], v20 offset:16384
    v_mfma_f32_16x16x32_bf16 v[76:79], a[244:247], v[52:55], v[76:79]
    v_mfma_f32_16x16x32_bf16 v[64:67], a[248:251], v[56:59], v[64:67]
    ds_read_b128 v[48:51], v19 offset:1024
    v_mfma_f32_16x16x32_bf16 v[68:71], a[252:255], v[56:59], v[68:71]
    v_mfma_f32_16x16x32_bf16 v[72:75], a[248:251], v[60:63], v[72:75]
    ds_read_b128 v[52:55], v19 offset:17408
    v_mfma_f32_16x16x32_bf16 v[76:79], a[252:255], v[60:63], v[76:79]
    s_mov_b64 exec, s[36:37]
    buffer_store_dword v23, v22, s[8:11], s33 offen sc1
    s_mov_b64 exec, -1

.qe_408:
    s_waitcnt lgkmcnt(4)
    v_mfma_f32_16x16x32_bf16 v[80:83], a[0:3], v[32:35], 0
    ds_read_b128 v[56:59], v20 offset:1024
    s_add_u32 m0, s29, 33664
    v_mfma_f32_16x16x32_bf16 v[84:87], a[4:7], v[32:35], 0
    buffer_load_dwordx4 v16, s[16:19], s34 offen offset:128 lds
    v_mfma_f32_16x16x32_bf16 v[88:91], a[0:3], v[36:39], 0
    ds_read_b128 v[60:63], v20 offset:17408
    v_mfma_f32_16x16x32_bf16 v[92:95], a[4:7], v[36:39], 0
    s_mov_b32 exec_hi, 0
    buffer_store_dwordx4 v[24:27], v21, s[8:11], s48 offen sc1
    s_mov_b32 exec_hi, -1

    s_waitcnt lgkmcnt(4)
    v_mfma_f32_16x16x32_bf16 v[80:83], a[8:11], v[40:43], v[80:83]
    ds_read_b128 v[32:35], v19 offset:2048
    v_mfma_f32_16x16x32_bf16 v[84:87], a[12:15], v[40:43], v[84:87]
    v_cvt_pk_bf16_f32 v96, v64, v65
    v_cvt_pk_bf16_f32 v97, v66, v67
    v_cvt_pk_bf16_f32 v98, v68, v69
    v_mfma_f32_16x16x32_bf16 v[88:91], a[8:11], v[44:47], v[88:91]
    ds_read_b128 v[36:39], v19 offset:18432
    v_mfma_f32_16x16x32_bf16 v[92:95], a[12:15], v[44:47], v[92:95]
    v_cvt_pk_bf16_f32 v99, v70, v71
    v_cvt_pk_bf16_f32 v100, v72, v73
    buffer_store_dwordx4 v[96:99], v21, s[8:11], s32 offen sc1
    s_waitcnt lgkmcnt(4)
    v_mfma_f32_16x16x32_bf16 v[80:83], a[16:19], v[48:51], v[80:83]
    ds_read_b128 v[40:43], v20 offset:2048
    s_add_u32 m0, s29, 34560
    v_mfma_f32_16x16x32_bf16 v[84:87], a[20:23], v[48:51], v[84:87]
    buffer_load_dwordx4 v16, s[16:19], s34 offen offset:256 lds
    v_mfma_f32_16x16x32_bf16 v[88:91], a[16:19], v[52:55], v[88:91]
    ds_read_b128 v[44:47], v20 offset:18432
    v_mfma_f32_16x16x32_bf16 v[92:95], a[20:23], v[52:55], v[92:95]
    v_cvt_pk_bf16_f32 v101, v74, v75
    v_cvt_pk_bf16_f32 v102, v76, v77
    v_cvt_pk_bf16_f32 v103, v78, v79
    s_waitcnt lgkmcnt(4)
    v_mfma_f32_16x16x32_bf16 v[80:83], a[24:27], v[56:59], v[80:83]
    ds_read_b128 v[48:51], v19 offset:3072
    v_mfma_f32_16x16x32_bf16 v[84:87], a[28:31], v[56:59], v[84:87]
    buffer_store_dwordx4 v[100:103], v21, s[8:11], s38 offen sc1
    v_mfma_f32_16x16x32_bf16 v[88:91], a[24:27], v[60:63], v[88:91]
    ds_read_b128 v[52:55], v19 offset:19456
    v_mfma_f32_16x16x32_bf16 v[92:95], a[28:31], v[60:63], v[92:95]
    s_waitcnt lgkmcnt(4)
    v_mfma_f32_16x16x32_bf16 v[80:83], a[32:35], v[32:35], v[80:83]
    ds_read_b128 v[56:59], v20 offset:3072
    s_add_u32 m0, s29, 35456
    v_mfma_f32_16x16x32_bf16 v[84:87], a[36:39], v[32:35], v[84:87]
    buffer_load_dwordx4 v16, s[16:19], s34 offen offset:384 lds
    v_mfma_f32_16x16x32_bf16 v[88:91], a[32:35], v[36:39], v[88:91]
    ds_read_b128 v[60:63], v20 offset:19456
    v_mfma_f32_16x16x32_bf16 v[92:95], a[36:39], v[36:39], v[92:95]
    s_waitcnt lgkmcnt(4)
    v_mfma_f32_16x16x32_bf16 v[80:83], a[40:43], v[40:43], v[80:83]
    ds_read_b128 v[32:35], v19 offset:4096
    v_mfma_f32_16x16x32_bf16 v[84:87], a[44:47], v[40:43], v[84:87]
    v_mfma_f32_16x16x32_bf16 v[88:91], a[40:43], v[44:47], v[88:91]
    ds_read_b128 v[36:39], v19 offset:20480
    v_mfma_f32_16x16x32_bf16 v[92:95], a[44:47], v[44:47], v[92:95]
    s_waitcnt lgkmcnt(4)
    v_mfma_f32_16x16x32_bf16 v[80:83], a[48:51], v[48:51], v[80:83]
    ds_read_b128 v[40:43], v20 offset:4096
    s_add_u32 m0, s29, 36352
    v_mfma_f32_16x16x32_bf16 v[84:87], a[52:55], v[48:51], v[84:87]
    buffer_load_dwordx4 v16, s[16:19], s34 offen offset:512 lds
    v_mfma_f32_16x16x32_bf16 v[88:91], a[48:51], v[52:55], v[88:91]
    ds_read_b128 v[44:47], v20 offset:20480
    v_mfma_f32_16x16x32_bf16 v[92:95], a[52:55], v[52:55], v[92:95]
    s_waitcnt lgkmcnt(4)
    v_mfma_f32_16x16x32_bf16 v[80:83], a[56:59], v[56:59], v[80:83]
    ds_read_b128 v[48:51], v19 offset:5120
    v_mfma_f32_16x16x32_bf16 v[84:87], a[60:63], v[56:59], v[84:87]
    v_mfma_f32_16x16x32_bf16 v[88:91], a[56:59], v[60:63], v[88:91]
    ds_read_b128 v[52:55], v19 offset:21504
    v_mfma_f32_16x16x32_bf16 v[92:95], a[60:63], v[60:63], v[92:95]
    s_waitcnt lgkmcnt(4)
    v_mfma_f32_16x16x32_bf16 v[80:83], a[64:67], v[32:35], v[80:83]
    ds_read_b128 v[56:59], v20 offset:5120
    s_add_u32 m0, s29, 37248
    v_mfma_f32_16x16x32_bf16 v[84:87], a[68:71], v[32:35], v[84:87]
    buffer_load_dwordx4 v16, s[16:19], s34 offen offset:640 lds
    v_mfma_f32_16x16x32_bf16 v[88:91], a[64:67], v[36:39], v[88:91]
    ds_read_b128 v[60:63], v20 offset:21504
    v_mfma_f32_16x16x32_bf16 v[92:95], a[68:71], v[36:39], v[92:95]
    s_waitcnt lgkmcnt(4)
    v_mfma_f32_16x16x32_bf16 v[80:83], a[72:75], v[40:43], v[80:83]
    ds_read_b128 v[32:35], v19 offset:6144
    v_mfma_f32_16x16x32_bf16 v[84:87], a[76:79], v[40:43], v[84:87]
    s_mov_b32 s32, s39
    s_add_u32 s38, s39, 4096
    s_add_u32 s39, s39, 262144
    s_mov_b32 s48, s49
    s_add_u32 s49, s49, 196608
    v_mfma_f32_16x16x32_bf16 v[88:91], a[72:75], v[44:47], v[88:91]
    ds_read_b128 v[36:39], v19 offset:22528
    v_mfma_f32_16x16x32_bf16 v[92:95], a[76:79], v[44:47], v[92:95]
    v_add_u32 v23, 1, v23
    s_waitcnt lgkmcnt(4)
    v_mfma_f32_16x16x32_bf16 v[80:83], a[80:83], v[48:51], v[80:83]
    ds_read_b128 v[40:43], v20 offset:6144
    s_add_u32 m0, s29, 38144
    v_mfma_f32_16x16x32_bf16 v[84:87], a[84:87], v[48:51], v[84:87]
    buffer_load_dwordx4 v16, s[16:19], s34 offen offset:768 lds
    v_mfma_f32_16x16x32_bf16 v[88:91], a[80:83], v[52:55], v[88:91]
    ds_read_b128 v[44:47], v20 offset:22528
    v_mfma_f32_16x16x32_bf16 v[92:95], a[84:87], v[52:55], v[92:95]
    s_waitcnt lgkmcnt(4)
    v_mfma_f32_16x16x32_bf16 v[80:83], a[88:91], v[56:59], v[80:83]
    ds_read_b128 v[48:51], v19 offset:7168
    v_mfma_f32_16x16x32_bf16 v[84:87], a[92:95], v[56:59], v[84:87]
    v_mfma_f32_16x16x32_bf16 v[88:91], a[88:91], v[60:63], v[88:91]
    ds_read_b128 v[52:55], v19 offset:23552
    v_mfma_f32_16x16x32_bf16 v[92:95], a[92:95], v[60:63], v[92:95]
    s_mov_b64 exec, s[44:45]
    buffer_store_dwordx4 v[24:27], v30, s[8:11], s46 offen sc1
    s_mov_b64 exec, -1
    s_waitcnt lgkmcnt(4)
    v_mfma_f32_16x16x32_bf16 v[80:83], a[96:99], v[32:35], v[80:83]
    ds_read_b128 v[56:59], v20 offset:7168
    s_add_u32 m0, s29, 39040
    v_mfma_f32_16x16x32_bf16 v[84:87], a[100:103], v[32:35], v[84:87]
    buffer_load_dwordx4 v16, s[16:19], s34 offen offset:896 lds
    v_mfma_f32_16x16x32_bf16 v[88:91], a[96:99], v[36:39], v[88:91]
    ds_read_b128 v[60:63], v20 offset:23552
    v_mfma_f32_16x16x32_bf16 v[92:95], a[100:103], v[36:39], v[92:95]
    s_waitcnt lgkmcnt(4)
    v_mfma_f32_16x16x32_bf16 v[80:83], a[104:107], v[40:43], v[80:83]
    s_add_u32 s34, s34, 64512
    s_min_u32 s34, s34, 4128768
    v_mfma_f32_16x16x32_bf16 v[84:87], a[108:111], v[40:43], v[84:87]
    v_mfma_f32_16x16x32_bf16 v[88:91], a[104:107], v[44:47], v[88:91]
    v_mfma_f32_16x16x32_bf16 v[92:95], a[108:111], v[44:47], v[92:95]
    s_waitcnt lgkmcnt(0)
    s_cmp_lt_u32 s35, 2
    s_cselect_b64 s[70:71], s[36:37], 0
    s_cbranch_scc0 .ef_410
    s_waitcnt vmcnt(5)
.ef_410:
    s_waitcnt vmcnt(19)
    s_barrier
    ds_read_b128 v[32:35], v19 offset:32768
    ds_read_b128 v[36:39], v19 offset:49152
    v_mfma_f32_16x16x32_bf16 v[80:83], a[112:115], v[48:51], v[80:83]
    ds_read_b128 v[40:43], v20 offset:32768
    s_add_u32 m0, s29, 65536
    v_mfma_f32_16x16x32_bf16 v[84:87], a[116:119], v[48:51], v[84:87]
    buffer_load_dwordx4 v16, s[16:19], s34 offen offset:0 lds
    v_mfma_f32_16x16x32_bf16 v[88:91], a[112:115], v[52:55], v[88:91]
    ds_read_b128 v[44:47], v20 offset:49152
    v_mfma_f32_16x16x32_bf16 v[92:95], a[116:119], v[52:55], v[92:95]
    v_mfma_f32_16x16x32_bf16 v[80:83], a[120:123], v[56:59], v[80:83]
    ds_read_b128 v[48:51], v19 offset:33792
    v_mfma_f32_16x16x32_bf16 v[84:87], a[124:127], v[56:59], v[84:87]
    v_mfma_f32_16x16x32_bf16 v[88:91], a[120:123], v[60:63], v[88:91]
    ds_read_b128 v[52:55], v19 offset:50176
    v_mfma_f32_16x16x32_bf16 v[92:95], a[124:127], v[60:63], v[92:95]
    s_mov_b64 exec, s[70:71]
    buffer_store_dword v23, v22, s[8:11], s33 offen sc1
    s_mov_b64 exec, -1

    s_waitcnt lgkmcnt(4)
    v_mfma_f32_16x16x32_bf16 v[80:83], a[128:131], v[32:35], v[80:83]
    ds_read_b128 v[56:59], v20 offset:33792
    s_add_u32 m0, s29, 66432
    v_mfma_f32_16x16x32_bf16 v[84:87], a[132:135], v[32:35], v[84:87]
    buffer_load_dwordx4 v16, s[16:19], s34 offen offset:128 lds
    v_mfma_f32_16x16x32_bf16 v[88:91], a[128:131], v[36:39], v[88:91]
    ds_read_b128 v[60:63], v20 offset:50176
    v_mfma_f32_16x16x32_bf16 v[92:95], a[132:135], v[36:39], v[92:95]
    s_waitcnt lgkmcnt(4)
    v_mfma_f32_16x16x32_bf16 v[80:83], a[136:139], v[40:43], v[80:83]
    ds_read_b128 v[32:35], v19 offset:34816
    v_mfma_f32_16x16x32_bf16 v[84:87], a[140:143], v[40:43], v[84:87]
    v_mfma_f32_16x16x32_bf16 v[88:91], a[136:139], v[44:47], v[88:91]
    ds_read_b128 v[36:39], v19 offset:51200
    v_mfma_f32_16x16x32_bf16 v[92:95], a[140:143], v[44:47], v[92:95]
    s_waitcnt lgkmcnt(4)
    v_mfma_f32_16x16x32_bf16 v[80:83], a[144:147], v[48:51], v[80:83]
    ds_read_b128 v[40:43], v20 offset:34816
    s_add_u32 m0, s29, 67328
    v_mfma_f32_16x16x32_bf16 v[84:87], a[148:151], v[48:51], v[84:87]
    buffer_load_dwordx4 v16, s[16:19], s34 offen offset:256 lds
    v_mfma_f32_16x16x32_bf16 v[88:91], a[144:147], v[52:55], v[88:91]
    ds_read_b128 v[44:47], v20 offset:51200
    v_mfma_f32_16x16x32_bf16 v[92:95], a[148:151], v[52:55], v[92:95]
    s_waitcnt lgkmcnt(4)
    v_mfma_f32_16x16x32_bf16 v[80:83], a[152:155], v[56:59], v[80:83]
    ds_read_b128 v[48:51], v19 offset:35840
    v_mfma_f32_16x16x32_bf16 v[84:87], a[156:159], v[56:59], v[84:87]
    v_mfma_f32_16x16x32_bf16 v[88:91], a[152:155], v[60:63], v[88:91]
    ds_read_b128 v[52:55], v19 offset:52224
    v_mfma_f32_16x16x32_bf16 v[92:95], a[156:159], v[60:63], v[92:95]
    s_waitcnt lgkmcnt(4)
    v_mfma_f32_16x16x32_bf16 v[80:83], a[160:163], v[32:35], v[80:83]
    ds_read_b128 v[56:59], v20 offset:35840
    s_add_u32 m0, s29, 68224
    v_mfma_f32_16x16x32_bf16 v[84:87], a[164:167], v[32:35], v[84:87]
    buffer_load_dwordx4 v16, s[16:19], s34 offen offset:384 lds
    v_mfma_f32_16x16x32_bf16 v[88:91], a[160:163], v[36:39], v[88:91]
    ds_read_b128 v[60:63], v20 offset:52224
    v_mfma_f32_16x16x32_bf16 v[92:95], a[164:167], v[36:39], v[92:95]
    s_waitcnt lgkmcnt(4)
    v_mfma_f32_16x16x32_bf16 v[80:83], a[168:171], v[40:43], v[80:83]
    ds_read_b128 v[32:35], v19 offset:36864
    v_mfma_f32_16x16x32_bf16 v[84:87], a[172:175], v[40:43], v[84:87]
    v_mfma_f32_16x16x32_bf16 v[88:91], a[168:171], v[44:47], v[88:91]
    ds_read_b128 v[36:39], v19 offset:53248
    v_mfma_f32_16x16x32_bf16 v[92:95], a[172:175], v[44:47], v[92:95]
    s_waitcnt lgkmcnt(4)
    v_mfma_f32_16x16x32_bf16 v[80:83], a[176:179], v[48:51], v[80:83]
    ds_read_b128 v[40:43], v20 offset:36864
    s_add_u32 m0, s29, 69120
    v_mfma_f32_16x16x32_bf16 v[84:87], a[180:183], v[48:51], v[84:87]
    buffer_load_dwordx4 v16, s[16:19], s34 offen offset:512 lds
    v_mfma_f32_16x16x32_bf16 v[88:91], a[176:179], v[52:55], v[88:91]
    ds_read_b128 v[44:47], v20 offset:53248
    v_mfma_f32_16x16x32_bf16 v[92:95], a[180:183], v[52:55], v[92:95]
    s_waitcnt lgkmcnt(4)
    v_mfma_f32_16x16x32_bf16 v[80:83], a[184:187], v[56:59], v[80:83]
    ds_read_b128 v[48:51], v19 offset:37888
    v_mfma_f32_16x16x32_bf16 v[84:87], a[188:191], v[56:59], v[84:87]
    v_mfma_f32_16x16x32_bf16 v[88:91], a[184:187], v[60:63], v[88:91]
    ds_read_b128 v[52:55], v19 offset:54272
    v_mfma_f32_16x16x32_bf16 v[92:95], a[188:191], v[60:63], v[92:95]
    s_waitcnt lgkmcnt(4)
    v_mfma_f32_16x16x32_bf16 v[80:83], a[192:195], v[32:35], v[80:83]
    ds_read_b128 v[56:59], v20 offset:37888
    s_add_u32 m0, s29, 70016
    v_mfma_f32_16x16x32_bf16 v[84:87], a[196:199], v[32:35], v[84:87]
    buffer_load_dwordx4 v16, s[16:19], s34 offen offset:640 lds
    v_mfma_f32_16x16x32_bf16 v[88:91], a[192:195], v[36:39], v[88:91]
    ds_read_b128 v[60:63], v20 offset:54272
    v_mfma_f32_16x16x32_bf16 v[92:95], a[196:199], v[36:39], v[92:95]
    s_waitcnt lgkmcnt(4)
    v_mfma_f32_16x16x32_bf16 v[80:83], a[200:203], v[40:43], v[80:83]
    ds_read_b128 v[32:35], v19 offset:38912
    v_mfma_f32_16x16x32_bf16 v[84:87], a[204:207], v[40:43], v[84:87]
    v_mfma_f32_16x16x32_bf16 v[88:91], a[200:203], v[44:47], v[88:91]
    ds_read_b128 v[36:39], v19 offset:55296
    v_mfma_f32_16x16x32_bf16 v[92:95], a[204:207], v[44:47], v[92:95]
    s_waitcnt lgkmcnt(4)
    v_mfma_f32_16x16x32_bf16 v[80:83], a[208:211], v[48:51], v[80:83]
    ds_read_b128 v[40:43], v20 offset:38912
    s_add_u32 m0, s29, 70912
    v_mfma_f32_16x16x32_bf16 v[84:87], a[212:215], v[48:51], v[84:87]
    buffer_load_dwordx4 v16, s[16:19], s34 offen offset:768 lds
    v_mfma_f32_16x16x32_bf16 v[88:91], a[208:211], v[52:55], v[88:91]
    ds_read_b128 v[44:47], v20 offset:55296
    v_mfma_f32_16x16x32_bf16 v[92:95], a[212:215], v[52:55], v[92:95]
    s_waitcnt lgkmcnt(4)
    v_mfma_f32_16x16x32_bf16 v[80:83], a[216:219], v[56:59], v[80:83]
    ds_read_b128 v[48:51], v19 offset:39936
    v_mfma_f32_16x16x32_bf16 v[84:87], a[220:223], v[56:59], v[84:87]
    s_cmp_lt_u32 s35, 22
    s_cselect_b64 s[44:45], -1, 0
    v_mfma_f32_16x16x32_bf16 v[88:91], a[216:219], v[60:63], v[88:91]
    ds_read_b128 v[52:55], v19 offset:56320
    v_mfma_f32_16x16x32_bf16 v[92:95], a[220:223], v[60:63], v[92:95]
    s_cselect_b32 s4, 0x10000, 0
    s_add_u32 s46, s46, s4
    s_waitcnt lgkmcnt(4)
    v_mfma_f32_16x16x32_bf16 v[80:83], a[224:227], v[32:35], v[80:83]
    ds_read_b128 v[56:59], v20 offset:39936
    s_add_u32 m0, s29, 71808
    v_mfma_f32_16x16x32_bf16 v[84:87], a[228:231], v[32:35], v[84:87]
    buffer_load_dwordx4 v16, s[16:19], s34 offen offset:896 lds
    v_mfma_f32_16x16x32_bf16 v[88:91], a[224:227], v[36:39], v[88:91]
    ds_read_b128 v[60:63], v20 offset:56320
    v_mfma_f32_16x16x32_bf16 v[92:95], a[228:231], v[36:39], v[92:95]
    s_waitcnt lgkmcnt(4)
    v_mfma_f32_16x16x32_bf16 v[80:83], a[232:235], v[40:43], v[80:83]
    s_add_u32 s34, s34, 1024
    v_mfma_f32_16x16x32_bf16 v[84:87], a[236:239], v[40:43], v[84:87]
    v_mfma_f32_16x16x32_bf16 v[88:91], a[232:235], v[44:47], v[88:91]
    v_mfma_f32_16x16x32_bf16 v[92:95], a[236:239], v[44:47], v[92:95]
    s_waitcnt lgkmcnt(0)
    s_waitcnt vmcnt(13)
    s_barrier
    ds_read_b128 v[32:35], v17 offset:0
    ds_read_b128 v[36:39], v17 offset:16384
    v_mfma_f32_16x16x32_bf16 v[80:83], a[240:243], v[48:51], v[80:83]
    ds_read_b128 v[40:43], v18 offset:0
    s_add_u32 m0, s29, 98304
    v_mfma_f32_16x16x32_bf16 v[84:87], a[244:247], v[48:51], v[84:87]
    buffer_load_dwordx4 v16, s[16:19], s34 offen offset:0 lds
    v_mfma_f32_16x16x32_bf16 v[88:91], a[240:243], v[52:55], v[88:91]
    ds_read_b128 v[44:47], v18 offset:16384
    v_mfma_f32_16x16x32_bf16 v[92:95], a[244:247], v[52:55], v[92:95]
    v_mfma_f32_16x16x32_bf16 v[80:83], a[248:251], v[56:59], v[80:83]
    ds_read_b128 v[48:51], v17 offset:1024
    v_mfma_f32_16x16x32_bf16 v[84:87], a[252:255], v[56:59], v[84:87]
    v_mfma_f32_16x16x32_bf16 v[88:91], a[248:251], v[60:63], v[88:91]
    ds_read_b128 v[52:55], v17 offset:17408
    v_mfma_f32_16x16x32_bf16 v[92:95], a[252:255], v[60:63], v[92:95]
    s_mov_b64 exec, s[36:37]
    buffer_store_dword v23, v22, s[8:11], s33 offen sc1
    s_mov_b64 exec, -1

    s_add_u32 s35, s35, 1
    s_cmp_lt_u32 s35, 32
    s_cbranch_scc1 .ql_407

    s_nop 7
    v_cvt_pk_bf16_f32 v96, v80, v81
    v_cvt_pk_bf16_f32 v97, v82, v83
    v_cvt_pk_bf16_f32 v98, v84, v85
    v_cvt_pk_bf16_f32 v99, v86, v87
    buffer_store_dwordx4 v[96:99], v21, s[8:11], s32 offen sc1
    v_cvt_pk_bf16_f32 v100, v88, v89
    v_cvt_pk_bf16_f32 v101, v90, v91
    v_cvt_pk_bf16_f32 v102, v92, v93
    v_cvt_pk_bf16_f32 v103, v94, v95
    buffer_store_dwordx4 v[100:103], v21, s[8:11], s38 offen sc1
    s_mov_b32 exec_hi, 0
    buffer_store_dwordx4 v[24:27], v21, s[8:11], s48 offen sc1
    s_mov_b32 exec_hi, -1

    v_mov_b32 v23, 64
    s_waitcnt vmcnt(0) lgkmcnt(0)
    s_barrier
    s_mov_b64 exec, s[36:37]
    buffer_store_dword v23, v22, s[8:11], s33 offen sc1
    s_mov_b64 exec, -1

    s_branch .qd_387
.qv_386:
    s_waitcnt vmcnt(16)
    s_barrier
    ds_read_b128 v[32:35], v19 offset:0
    ds_read_b128 v[36:39], v19 offset:16384
    ds_read_b128 v[40:43], v20 offset:0
    ds_read_b128 v[44:47], v20 offset:16384
    s_add_u32 m0, s29, 32768
    s_nop 0
    buffer_load_dwordx4 v16, s[16:19], s34 offen offset:0 lds
    ds_read_b128 v[48:51], v19 offset:1024
    ds_read_b128 v[52:55], v19 offset:17408
    s_branch .qe_412
.p2align 6
.ql_411:
    s_waitcnt lgkmcnt(4)
    v_mfma_f32_16x16x32_bf16 v[64:67], v[32:35], a[0:3], 0
    ds_read_b128 v[56:59], v18 offset:1024
    s_add_u32 m0, s29, 99200
    v_mfma_f32_16x16x32_bf16 v[68:71], v[32:35], a[4:7], 0
    buffer_load_dwordx4 v16, s[16:19], s34 offen offset:128 lds
    v_mfma_f32_16x16x32_bf16 v[72:75], v[36:39], a[0:3], 0
    ds_read_b128 v[60:63], v18 offset:17408
    v_mfma_f32_16x16x32_bf16 v[76:79], v[36:39], a[4:7], 0
    s_mov_b32 exec_hi, 0
    buffer_store_dwordx4 v[24:27], v21, s[8:11], s48 offen sc1
    s_mov_b32 exec_hi, -1

    s_waitcnt lgkmcnt(4)
    v_mfma_f32_16x16x32_bf16 v[64:67], v[40:43], a[8:11], v[64:67]
    ds_read_b128 v[32:35], v17 offset:2048
    v_mfma_f32_16x16x32_bf16 v[68:71], v[40:43], a[12:15], v[68:71]
    v_cvt_pk_bf16_f32 v96, v80, v81
    v_cvt_pk_bf16_f32 v97, v82, v83
    v_cvt_pk_bf16_f32 v98, v88, v89
    v_mfma_f32_16x16x32_bf16 v[72:75], v[44:47], a[8:11], v[72:75]
    ds_read_b128 v[36:39], v17 offset:18432
    v_mfma_f32_16x16x32_bf16 v[76:79], v[44:47], a[12:15], v[76:79]
    v_cvt_pk_bf16_f32 v99, v90, v91
    v_cvt_pk_bf16_f32 v100, v84, v85
    buffer_store_dwordx4 v[96:99], v21, s[8:11], s32 offen offset:0 sc1
    s_waitcnt lgkmcnt(4)
    v_mfma_f32_16x16x32_bf16 v[64:67], v[48:51], a[16:19], v[64:67]
    ds_read_b128 v[40:43], v18 offset:2048
    s_add_u32 m0, s29, 100096
    v_mfma_f32_16x16x32_bf16 v[68:71], v[48:51], a[20:23], v[68:71]
    buffer_load_dwordx4 v16, s[16:19], s34 offen offset:256 lds
    v_mfma_f32_16x16x32_bf16 v[72:75], v[52:55], a[16:19], v[72:75]
    ds_read_b128 v[44:47], v18 offset:18432
    v_mfma_f32_16x16x32_bf16 v[76:79], v[52:55], a[20:23], v[76:79]
    v_cvt_pk_bf16_f32 v101, v86, v87
    v_cvt_pk_bf16_f32 v102, v92, v93
    v_cvt_pk_bf16_f32 v103, v94, v95
    s_waitcnt lgkmcnt(4)
    v_mfma_f32_16x16x32_bf16 v[64:67], v[56:59], a[24:27], v[64:67]
    ds_read_b128 v[48:51], v17 offset:3072
    v_mfma_f32_16x16x32_bf16 v[68:71], v[56:59], a[28:31], v[68:71]
    buffer_store_dwordx4 v[100:103], v21, s[8:11], s32 offen offset:1024 sc1
    v_mfma_f32_16x16x32_bf16 v[72:75], v[60:63], a[24:27], v[72:75]
    ds_read_b128 v[52:55], v17 offset:19456
    v_mfma_f32_16x16x32_bf16 v[76:79], v[60:63], a[28:31], v[76:79]
    s_waitcnt lgkmcnt(4)
    v_mfma_f32_16x16x32_bf16 v[64:67], v[32:35], a[32:35], v[64:67]
    ds_read_b128 v[56:59], v18 offset:3072
    s_add_u32 m0, s29, 100992
    v_mfma_f32_16x16x32_bf16 v[68:71], v[32:35], a[36:39], v[68:71]
    buffer_load_dwordx4 v16, s[16:19], s34 offen offset:384 lds
    v_mfma_f32_16x16x32_bf16 v[72:75], v[36:39], a[32:35], v[72:75]
    ds_read_b128 v[60:63], v18 offset:19456
    v_mfma_f32_16x16x32_bf16 v[76:79], v[36:39], a[36:39], v[76:79]
    s_waitcnt lgkmcnt(4)
    v_mfma_f32_16x16x32_bf16 v[64:67], v[40:43], a[40:43], v[64:67]
    ds_read_b128 v[32:35], v17 offset:4096
    v_mfma_f32_16x16x32_bf16 v[68:71], v[40:43], a[44:47], v[68:71]
    v_mfma_f32_16x16x32_bf16 v[72:75], v[44:47], a[40:43], v[72:75]
    ds_read_b128 v[36:39], v17 offset:20480
    v_mfma_f32_16x16x32_bf16 v[76:79], v[44:47], a[44:47], v[76:79]
    s_waitcnt lgkmcnt(4)
    v_mfma_f32_16x16x32_bf16 v[64:67], v[48:51], a[48:51], v[64:67]
    ds_read_b128 v[40:43], v18 offset:4096
    s_add_u32 m0, s29, 101888
    v_mfma_f32_16x16x32_bf16 v[68:71], v[48:51], a[52:55], v[68:71]
    buffer_load_dwordx4 v16, s[16:19], s34 offen offset:512 lds
    v_mfma_f32_16x16x32_bf16 v[72:75], v[52:55], a[48:51], v[72:75]
    ds_read_b128 v[44:47], v18 offset:20480
    v_mfma_f32_16x16x32_bf16 v[76:79], v[52:55], a[52:55], v[76:79]
    s_waitcnt lgkmcnt(4)
    v_mfma_f32_16x16x32_bf16 v[64:67], v[56:59], a[56:59], v[64:67]
    ds_read_b128 v[48:51], v17 offset:5120
    v_mfma_f32_16x16x32_bf16 v[68:71], v[56:59], a[60:63], v[68:71]
    v_mfma_f32_16x16x32_bf16 v[72:75], v[60:63], a[56:59], v[72:75]
    ds_read_b128 v[52:55], v17 offset:21504
    v_mfma_f32_16x16x32_bf16 v[76:79], v[60:63], a[60:63], v[76:79]
    s_waitcnt lgkmcnt(4)
    v_mfma_f32_16x16x32_bf16 v[64:67], v[32:35], a[64:67], v[64:67]
    ds_read_b128 v[56:59], v18 offset:5120
    s_add_u32 m0, s29, 102784
    v_mfma_f32_16x16x32_bf16 v[68:71], v[32:35], a[68:71], v[68:71]
    buffer_load_dwordx4 v16, s[16:19], s34 offen offset:640 lds
    v_mfma_f32_16x16x32_bf16 v[72:75], v[36:39], a[64:67], v[72:75]
    ds_read_b128 v[60:63], v18 offset:21504
    v_mfma_f32_16x16x32_bf16 v[76:79], v[36:39], a[68:71], v[76:79]
    s_waitcnt lgkmcnt(4)
    v_mfma_f32_16x16x32_bf16 v[64:67], v[40:43], a[72:75], v[64:67]
    ds_read_b128 v[32:35], v17 offset:6144
    v_mfma_f32_16x16x32_bf16 v[68:71], v[40:43], a[76:79], v[68:71]
    s_mov_b32 s32, s39
    s_add_u32 s38, s39, 4096
    s_add_u32 s39, s39, 262144
    s_mov_b32 s48, s49
    s_add_u32 s49, s49, 196608
    v_mfma_f32_16x16x32_bf16 v[72:75], v[44:47], a[72:75], v[72:75]
    ds_read_b128 v[36:39], v17 offset:22528
    v_mfma_f32_16x16x32_bf16 v[76:79], v[44:47], a[76:79], v[76:79]
    v_add_u32 v23, 1, v23
    s_waitcnt lgkmcnt(4)
    v_mfma_f32_16x16x32_bf16 v[64:67], v[48:51], a[80:83], v[64:67]
    ds_read_b128 v[40:43], v18 offset:6144
    s_add_u32 m0, s29, 103680
    v_mfma_f32_16x16x32_bf16 v[68:71], v[48:51], a[84:87], v[68:71]
    buffer_load_dwordx4 v16, s[16:19], s34 offen offset:768 lds
    v_mfma_f32_16x16x32_bf16 v[72:75], v[52:55], a[80:83], v[72:75]
    ds_read_b128 v[44:47], v18 offset:22528
    v_mfma_f32_16x16x32_bf16 v[76:79], v[52:55], a[84:87], v[76:79]
    s_waitcnt lgkmcnt(4)
    v_mfma_f32_16x16x32_bf16 v[64:67], v[56:59], a[88:91], v[64:67]
    ds_read_b128 v[48:51], v17 offset:7168
    v_mfma_f32_16x16x32_bf16 v[68:71], v[56:59], a[92:95], v[68:71]
    v_mfma_f32_16x16x32_bf16 v[72:75], v[60:63], a[88:91], v[72:75]
    ds_read_b128 v[52:55], v17 offset:23552
    v_mfma_f32_16x16x32_bf16 v[76:79], v[60:63], a[92:95], v[76:79]
    s_mov_b64 exec, s[44:45]
    buffer_store_dwordx4 v[24:27], v28, s[8:11], s46 offen sc1
    s_mov_b64 exec, -1
    s_waitcnt lgkmcnt(4)
    v_mfma_f32_16x16x32_bf16 v[64:67], v[32:35], a[96:99], v[64:67]
    ds_read_b128 v[56:59], v18 offset:7168
    s_add_u32 m0, s29, 104576
    v_mfma_f32_16x16x32_bf16 v[68:71], v[32:35], a[100:103], v[68:71]
    buffer_load_dwordx4 v16, s[16:19], s34 offen offset:896 lds
    v_mfma_f32_16x16x32_bf16 v[72:75], v[36:39], a[96:99], v[72:75]
    ds_read_b128 v[60:63], v18 offset:23552
    v_mfma_f32_16x16x32_bf16 v[76:79], v[36:39], a[100:103], v[76:79]
    s_waitcnt lgkmcnt(4)
    v_mfma_f32_16x16x32_bf16 v[64:67], v[40:43], a[104:107], v[64:67]
    s_add_u32 s34, s34, 64512
    s_min_u32 s34, s34, 4128768
    v_mfma_f32_16x16x32_bf16 v[68:71], v[40:43], a[108:111], v[68:71]
    v_mfma_f32_16x16x32_bf16 v[72:75], v[44:47], a[104:107], v[72:75]
    v_mfma_f32_16x16x32_bf16 v[76:79], v[44:47], a[108:111], v[76:79]
    s_waitcnt lgkmcnt(0)
    s_cmp_lt_u32 s35, 2
    s_cselect_b64 s[70:71], s[36:37], 0
    s_cbranch_scc0 .ef_413
    s_waitcnt vmcnt(5)
.ef_413:
    s_waitcnt vmcnt(19)
    s_barrier
    ds_read_b128 v[32:35], v17 offset:32768
    ds_read_b128 v[36:39], v17 offset:49152
    v_mfma_f32_16x16x32_bf16 v[64:67], v[48:51], a[112:115], v[64:67]
    ds_read_b128 v[40:43], v18 offset:32768
    s_add_u32 m0, s29, 0
    v_mfma_f32_16x16x32_bf16 v[68:71], v[48:51], a[116:119], v[68:71]
    buffer_load_dwordx4 v16, s[16:19], s34 offen offset:0 lds
    v_mfma_f32_16x16x32_bf16 v[72:75], v[52:55], a[112:115], v[72:75]
    ds_read_b128 v[44:47], v18 offset:49152
    v_mfma_f32_16x16x32_bf16 v[76:79], v[52:55], a[116:119], v[76:79]
    v_mfma_f32_16x16x32_bf16 v[64:67], v[56:59], a[120:123], v[64:67]
    ds_read_b128 v[48:51], v17 offset:33792
    v_mfma_f32_16x16x32_bf16 v[68:71], v[56:59], a[124:127], v[68:71]
    v_mfma_f32_16x16x32_bf16 v[72:75], v[60:63], a[120:123], v[72:75]
    ds_read_b128 v[52:55], v17 offset:50176
    v_mfma_f32_16x16x32_bf16 v[76:79], v[60:63], a[124:127], v[76:79]
    s_mov_b64 exec, s[70:71]
    buffer_store_dword v23, v22, s[8:11], s33 offen sc1
    s_mov_b64 exec, -1

    s_waitcnt lgkmcnt(4)
    v_mfma_f32_16x16x32_bf16 v[64:67], v[32:35], a[128:131], v[64:67]
    ds_read_b128 v[56:59], v18 offset:33792
    s_add_u32 m0, s29, 896
    v_mfma_f32_16x16x32_bf16 v[68:71], v[32:35], a[132:135], v[68:71]
    buffer_load_dwordx4 v16, s[16:19], s34 offen offset:128 lds
    v_mfma_f32_16x16x32_bf16 v[72:75], v[36:39], a[128:131], v[72:75]
    ds_read_b128 v[60:63], v18 offset:50176
    v_mfma_f32_16x16x32_bf16 v[76:79], v[36:39], a[132:135], v[76:79]
    s_waitcnt lgkmcnt(4)
    v_mfma_f32_16x16x32_bf16 v[64:67], v[40:43], a[136:139], v[64:67]
    ds_read_b128 v[32:35], v17 offset:34816
    v_mfma_f32_16x16x32_bf16 v[68:71], v[40:43], a[140:143], v[68:71]
    v_mfma_f32_16x16x32_bf16 v[72:75], v[44:47], a[136:139], v[72:75]
    ds_read_b128 v[36:39], v17 offset:51200
    v_mfma_f32_16x16x32_bf16 v[76:79], v[44:47], a[140:143], v[76:79]
    s_waitcnt lgkmcnt(4)
    v_mfma_f32_16x16x32_bf16 v[64:67], v[48:51], a[144:147], v[64:67]
    ds_read_b128 v[40:43], v18 offset:34816
    s_add_u32 m0, s29, 1792
    v_mfma_f32_16x16x32_bf16 v[68:71], v[48:51], a[148:151], v[68:71]
    buffer_load_dwordx4 v16, s[16:19], s34 offen offset:256 lds
    v_mfma_f32_16x16x32_bf16 v[72:75], v[52:55], a[144:147], v[72:75]
    ds_read_b128 v[44:47], v18 offset:51200
    v_mfma_f32_16x16x32_bf16 v[76:79], v[52:55], a[148:151], v[76:79]
    s_waitcnt lgkmcnt(4)
    v_mfma_f32_16x16x32_bf16 v[64:67], v[56:59], a[152:155], v[64:67]
    ds_read_b128 v[48:51], v17 offset:35840
    v_mfma_f32_16x16x32_bf16 v[68:71], v[56:59], a[156:159], v[68:71]
    v_mfma_f32_16x16x32_bf16 v[72:75], v[60:63], a[152:155], v[72:75]
    ds_read_b128 v[52:55], v17 offset:52224
    v_mfma_f32_16x16x32_bf16 v[76:79], v[60:63], a[156:159], v[76:79]
    s_waitcnt lgkmcnt(4)
    v_mfma_f32_16x16x32_bf16 v[64:67], v[32:35], a[160:163], v[64:67]
    ds_read_b128 v[56:59], v18 offset:35840
    s_add_u32 m0, s29, 2688
    v_mfma_f32_16x16x32_bf16 v[68:71], v[32:35], a[164:167], v[68:71]
    buffer_load_dwordx4 v16, s[16:19], s34 offen offset:384 lds
    v_mfma_f32_16x16x32_bf16 v[72:75], v[36:39], a[160:163], v[72:75]
    ds_read_b128 v[60:63], v18 offset:52224
    v_mfma_f32_16x16x32_bf16 v[76:79], v[36:39], a[164:167], v[76:79]
    s_waitcnt lgkmcnt(4)
    v_mfma_f32_16x16x32_bf16 v[64:67], v[40:43], a[168:171], v[64:67]
    ds_read_b128 v[32:35], v17 offset:36864
    v_mfma_f32_16x16x32_bf16 v[68:71], v[40:43], a[172:175], v[68:71]
    v_mfma_f32_16x16x32_bf16 v[72:75], v[44:47], a[168:171], v[72:75]
    ds_read_b128 v[36:39], v17 offset:53248
    v_mfma_f32_16x16x32_bf16 v[76:79], v[44:47], a[172:175], v[76:79]
    s_waitcnt lgkmcnt(4)
    v_mfma_f32_16x16x32_bf16 v[64:67], v[48:51], a[176:179], v[64:67]
    ds_read_b128 v[40:43], v18 offset:36864
    s_add_u32 m0, s29, 3584
    v_mfma_f32_16x16x32_bf16 v[68:71], v[48:51], a[180:183], v[68:71]
    buffer_load_dwordx4 v16, s[16:19], s34 offen offset:512 lds
    v_mfma_f32_16x16x32_bf16 v[72:75], v[52:55], a[176:179], v[72:75]
    ds_read_b128 v[44:47], v18 offset:53248
    v_mfma_f32_16x16x32_bf16 v[76:79], v[52:55], a[180:183], v[76:79]
    s_waitcnt lgkmcnt(4)
    v_mfma_f32_16x16x32_bf16 v[64:67], v[56:59], a[184:187], v[64:67]
    ds_read_b128 v[48:51], v17 offset:37888
    v_mfma_f32_16x16x32_bf16 v[68:71], v[56:59], a[188:191], v[68:71]
    v_mfma_f32_16x16x32_bf16 v[72:75], v[60:63], a[184:187], v[72:75]
    ds_read_b128 v[52:55], v17 offset:54272
    v_mfma_f32_16x16x32_bf16 v[76:79], v[60:63], a[188:191], v[76:79]
    s_waitcnt lgkmcnt(4)
    v_mfma_f32_16x16x32_bf16 v[64:67], v[32:35], a[192:195], v[64:67]
    ds_read_b128 v[56:59], v18 offset:37888
    s_add_u32 m0, s29, 4480
    v_mfma_f32_16x16x32_bf16 v[68:71], v[32:35], a[196:199], v[68:71]
    buffer_load_dwordx4 v16, s[16:19], s34 offen offset:640 lds
    v_mfma_f32_16x16x32_bf16 v[72:75], v[36:39], a[192:195], v[72:75]
    ds_read_b128 v[60:63], v18 offset:54272
    v_mfma_f32_16x16x32_bf16 v[76:79], v[36:39], a[196:199], v[76:79]
    s_waitcnt lgkmcnt(4)
    v_mfma_f32_16x16x32_bf16 v[64:67], v[40:43], a[200:203], v[64:67]
    ds_read_b128 v[32:35], v17 offset:38912
    v_mfma_f32_16x16x32_bf16 v[68:71], v[40:43], a[204:207], v[68:71]
    v_mfma_f32_16x16x32_bf16 v[72:75], v[44:47], a[200:203], v[72:75]
    ds_read_b128 v[36:39], v17 offset:55296
    v_mfma_f32_16x16x32_bf16 v[76:79], v[44:47], a[204:207], v[76:79]
    s_waitcnt lgkmcnt(4)
    v_mfma_f32_16x16x32_bf16 v[64:67], v[48:51], a[208:211], v[64:67]
    ds_read_b128 v[40:43], v18 offset:38912
    s_add_u32 m0, s29, 5376
    v_mfma_f32_16x16x32_bf16 v[68:71], v[48:51], a[212:215], v[68:71]
    buffer_load_dwordx4 v16, s[16:19], s34 offen offset:768 lds
    v_mfma_f32_16x16x32_bf16 v[72:75], v[52:55], a[208:211], v[72:75]
    ds_read_b128 v[44:47], v18 offset:55296
    v_mfma_f32_16x16x32_bf16 v[76:79], v[52:55], a[212:215], v[76:79]
    s_waitcnt lgkmcnt(4)
    v_mfma_f32_16x16x32_bf16 v[64:67], v[56:59], a[216:219], v[64:67]
    ds_read_b128 v[48:51], v17 offset:39936
    v_mfma_f32_16x16x32_bf16 v[68:71], v[56:59], a[220:223], v[68:71]
    v_mfma_f32_16x16x32_bf16 v[72:75], v[60:63], a[216:219], v[72:75]
    ds_read_b128 v[52:55], v17 offset:56320
    v_mfma_f32_16x16x32_bf16 v[76:79], v[60:63], a[220:223], v[76:79]
    s_mov_b64 exec, s[44:45]
    buffer_store_dwordx4 v[24:27], v29, s[8:11], s46 offen sc1
    s_mov_b64 exec, -1
    s_waitcnt lgkmcnt(4)
    v_mfma_f32_16x16x32_bf16 v[64:67], v[32:35], a[224:227], v[64:67]
    ds_read_b128 v[56:59], v18 offset:39936
    s_add_u32 m0, s29, 6272
    v_mfma_f32_16x16x32_bf16 v[68:71], v[32:35], a[228:231], v[68:71]
    buffer_load_dwordx4 v16, s[16:19], s34 offen offset:896 lds
    v_mfma_f32_16x16x32_bf16 v[72:75], v[36:39], a[224:227], v[72:75]
    ds_read_b128 v[60:63], v18 offset:56320
    v_mfma_f32_16x16x32_bf16 v[76:79], v[36:39], a[228:231], v[76:79]
    s_waitcnt lgkmcnt(4)
    v_mfma_f32_16x16x32_bf16 v[64:67], v[40:43], a[232:235], v[64:67]
    s_add_u32 s34, s34, 1024
    v_mfma_f32_16x16x32_bf16 v[68:71], v[40:43], a[236:239], v[68:71]
    v_mfma_f32_16x16x32_bf16 v[72:75], v[44:47], a[232:235], v[72:75]
    v_mfma_f32_16x16x32_bf16 v[76:79], v[44:47], a[236:239], v[76:79]
    s_waitcnt lgkmcnt(0)
    s_waitcnt vmcnt(13)
    s_barrier
    ds_read_b128 v[32:35], v19 offset:0
    ds_read_b128 v[36:39], v19 offset:16384
    v_mfma_f32_16x16x32_bf16 v[64:67], v[48:51], a[240:243], v[64:67]
    ds_read_b128 v[40:43], v20 offset:0
    s_add_u32 m0, s29, 32768
    v_mfma_f32_16x16x32_bf16 v[68:71], v[48:51], a[244:247], v[68:71]
    buffer_load_dwordx4 v16, s[16:19], s34 offen offset:0 lds
    v_mfma_f32_16x16x32_bf16 v[72:75], v[52:55], a[240:243], v[72:75]
    ds_read_b128 v[44:47], v20 offset:16384
    v_mfma_f32_16x16x32_bf16 v[76:79], v[52:55], a[244:247], v[76:79]
    v_mfma_f32_16x16x32_bf16 v[64:67], v[56:59], a[248:251], v[64:67]
    ds_read_b128 v[48:51], v19 offset:1024
    v_mfma_f32_16x16x32_bf16 v[68:71], v[56:59], a[252:255], v[68:71]
    v_mfma_f32_16x16x32_bf16 v[72:75], v[60:63], a[248:251], v[72:75]
    ds_read_b128 v[52:55], v19 offset:17408
    v_mfma_f32_16x16x32_bf16 v[76:79], v[60:63], a[252:255], v[76:79]
    s_mov_b64 exec, s[36:37]
    buffer_store_dword v23, v22, s[8:11], s33 offen sc1
    s_mov_b64 exec, -1

.qe_412:
    s_waitcnt lgkmcnt(4)
    v_mfma_f32_16x16x32_bf16 v[80:83], v[32:35], a[0:3], 0
    ds_read_b128 v[56:59], v20 offset:1024
    s_add_u32 m0, s29, 33664
    v_mfma_f32_16x16x32_bf16 v[84:87], v[32:35], a[4:7], 0
    buffer_load_dwordx4 v16, s[16:19], s34 offen offset:128 lds
    v_mfma_f32_16x16x32_bf16 v[88:91], v[36:39], a[0:3], 0
    ds_read_b128 v[60:63], v20 offset:17408
    v_mfma_f32_16x16x32_bf16 v[92:95], v[36:39], a[4:7], 0
    s_mov_b32 exec_hi, 0
    buffer_store_dwordx4 v[24:27], v21, s[8:11], s48 offen sc1
    s_mov_b32 exec_hi, -1

    s_waitcnt lgkmcnt(4)
    v_mfma_f32_16x16x32_bf16 v[80:83], v[40:43], a[8:11], v[80:83]
    ds_read_b128 v[32:35], v19 offset:2048
    v_mfma_f32_16x16x32_bf16 v[84:87], v[40:43], a[12:15], v[84:87]
    v_cvt_pk_bf16_f32 v96, v64, v65
    v_cvt_pk_bf16_f32 v97, v66, v67
    v_cvt_pk_bf16_f32 v98, v72, v73
    v_mfma_f32_16x16x32_bf16 v[88:91], v[44:47], a[8:11], v[88:91]
    ds_read_b128 v[36:39], v19 offset:18432
    v_mfma_f32_16x16x32_bf16 v[92:95], v[44:47], a[12:15], v[92:95]
    v_cvt_pk_bf16_f32 v99, v74, v75
    v_cvt_pk_bf16_f32 v100, v68, v69
    buffer_store_dwordx4 v[96:99], v21, s[8:11], s32 offen offset:0 sc1
    s_waitcnt lgkmcnt(4)
    v_mfma_f32_16x16x32_bf16 v[80:83], v[48:51], a[16:19], v[80:83]
    ds_read_b128 v[40:43], v20 offset:2048
    s_add_u32 m0, s29, 34560
    v_mfma_f32_16x16x32_bf16 v[84:87], v[48:51], a[20:23], v[84:87]
    buffer_load_dwordx4 v16, s[16:19], s34 offen offset:256 lds
    v_mfma_f32_16x16x32_bf16 v[88:91], v[52:55], a[16:19], v[88:91]
    ds_read_b128 v[44:47], v20 offset:18432
    v_mfma_f32_16x16x32_bf16 v[92:95], v[52:55], a[20:23], v[92:95]
    v_cvt_pk_bf16_f32 v101, v70, v71
    v_cvt_pk_bf16_f32 v102, v76, v77
    v_cvt_pk_bf16_f32 v103, v78, v79
    s_waitcnt lgkmcnt(4)
    v_mfma_f32_16x16x32_bf16 v[80:83], v[56:59], a[24:27], v[80:83]
    ds_read_b128 v[48:51], v19 offset:3072
    v_mfma_f32_16x16x32_bf16 v[84:87], v[56:59], a[28:31], v[84:87]
    buffer_store_dwordx4 v[100:103], v21, s[8:11], s32 offen offset:1024 sc1
    v_mfma_f32_16x16x32_bf16 v[88:91], v[60:63], a[24:27], v[88:91]
    ds_read_b128 v[52:55], v19 offset:19456
    v_mfma_f32_16x16x32_bf16 v[92:95], v[60:63], a[28:31], v[92:95]
    s_waitcnt lgkmcnt(4)
    v_mfma_f32_16x16x32_bf16 v[80:83], v[32:35], a[32:35], v[80:83]
    ds_read_b128 v[56:59], v20 offset:3072
    s_add_u32 m0, s29, 35456
    v_mfma_f32_16x16x32_bf16 v[84:87], v[32:35], a[36:39], v[84:87]
    buffer_load_dwordx4 v16, s[16:19], s34 offen offset:384 lds
    v_mfma_f32_16x16x32_bf16 v[88:91], v[36:39], a[32:35], v[88:91]
    ds_read_b128 v[60:63], v20 offset:19456
    v_mfma_f32_16x16x32_bf16 v[92:95], v[36:39], a[36:39], v[92:95]
    s_waitcnt lgkmcnt(4)
    v_mfma_f32_16x16x32_bf16 v[80:83], v[40:43], a[40:43], v[80:83]
    ds_read_b128 v[32:35], v19 offset:4096
    v_mfma_f32_16x16x32_bf16 v[84:87], v[40:43], a[44:47], v[84:87]
    v_mfma_f32_16x16x32_bf16 v[88:91], v[44:47], a[40:43], v[88:91]
    ds_read_b128 v[36:39], v19 offset:20480
    v_mfma_f32_16x16x32_bf16 v[92:95], v[44:47], a[44:47], v[92:95]
    s_waitcnt lgkmcnt(4)
    v_mfma_f32_16x16x32_bf16 v[80:83], v[48:51], a[48:51], v[80:83]
    ds_read_b128 v[40:43], v20 offset:4096
    s_add_u32 m0, s29, 36352
    v_mfma_f32_16x16x32_bf16 v[84:87], v[48:51], a[52:55], v[84:87]
    buffer_load_dwordx4 v16, s[16:19], s34 offen offset:512 lds
    v_mfma_f32_16x16x32_bf16 v[88:91], v[52:55], a[48:51], v[88:91]
    ds_read_b128 v[44:47], v20 offset:20480
    v_mfma_f32_16x16x32_bf16 v[92:95], v[52:55], a[52:55], v[92:95]
    s_waitcnt lgkmcnt(4)
    v_mfma_f32_16x16x32_bf16 v[80:83], v[56:59], a[56:59], v[80:83]
    ds_read_b128 v[48:51], v19 offset:5120
    v_mfma_f32_16x16x32_bf16 v[84:87], v[56:59], a[60:63], v[84:87]
    v_mfma_f32_16x16x32_bf16 v[88:91], v[60:63], a[56:59], v[88:91]
    ds_read_b128 v[52:55], v19 offset:21504
    v_mfma_f32_16x16x32_bf16 v[92:95], v[60:63], a[60:63], v[92:95]
    s_waitcnt lgkmcnt(4)
    v_mfma_f32_16x16x32_bf16 v[80:83], v[32:35], a[64:67], v[80:83]
    ds_read_b128 v[56:59], v20 offset:5120
    s_add_u32 m0, s29, 37248
    v_mfma_f32_16x16x32_bf16 v[84:87], v[32:35], a[68:71], v[84:87]
    buffer_load_dwordx4 v16, s[16:19], s34 offen offset:640 lds
    v_mfma_f32_16x16x32_bf16 v[88:91], v[36:39], a[64:67], v[88:91]
    ds_read_b128 v[60:63], v20 offset:21504
    v_mfma_f32_16x16x32_bf16 v[92:95], v[36:39], a[68:71], v[92:95]
    s_waitcnt lgkmcnt(4)
    v_mfma_f32_16x16x32_bf16 v[80:83], v[40:43], a[72:75], v[80:83]
    ds_read_b128 v[32:35], v19 offset:6144
    v_mfma_f32_16x16x32_bf16 v[84:87], v[40:43], a[76:79], v[84:87]
    s_mov_b32 s32, s39
    s_add_u32 s38, s39, 4096
    s_add_u32 s39, s39, 262144
    s_mov_b32 s48, s49
    s_add_u32 s49, s49, 196608
    v_mfma_f32_16x16x32_bf16 v[88:91], v[44:47], a[72:75], v[88:91]
    ds_read_b128 v[36:39], v19 offset:22528
    v_mfma_f32_16x16x32_bf16 v[92:95], v[44:47], a[76:79], v[92:95]
    v_add_u32 v23, 1, v23
    s_waitcnt lgkmcnt(4)
    v_mfma_f32_16x16x32_bf16 v[80:83], v[48:51], a[80:83], v[80:83]
    ds_read_b128 v[40:43], v20 offset:6144
    s_add_u32 m0, s29, 38144
    v_mfma_f32_16x16x32_bf16 v[84:87], v[48:51], a[84:87], v[84:87]
    buffer_load_dwordx4 v16, s[16:19], s34 offen offset:768 lds
    v_mfma_f32_16x16x32_bf16 v[88:91], v[52:55], a[80:83], v[88:91]
    ds_read_b128 v[44:47], v20 offset:22528
    v_mfma_f32_16x16x32_bf16 v[92:95], v[52:55], a[84:87], v[92:95]
    s_waitcnt lgkmcnt(4)
    v_mfma_f32_16x16x32_bf16 v[80:83], v[56:59], a[88:91], v[80:83]
    ds_read_b128 v[48:51], v19 offset:7168
    v_mfma_f32_16x16x32_bf16 v[84:87], v[56:59], a[92:95], v[84:87]
    v_mfma_f32_16x16x32_bf16 v[88:91], v[60:63], a[88:91], v[88:91]
    ds_read_b128 v[52:55], v19 offset:23552
    v_mfma_f32_16x16x32_bf16 v[92:95], v[60:63], a[92:95], v[92:95]
    s_mov_b64 exec, s[44:45]
    buffer_store_dwordx4 v[24:27], v30, s[8:11], s46 offen sc1
    s_mov_b64 exec, -1
    s_waitcnt lgkmcnt(4)
    v_mfma_f32_16x16x32_bf16 v[80:83], v[32:35], a[96:99], v[80:83]
    ds_read_b128 v[56:59], v20 offset:7168
    s_add_u32 m0, s29, 39040
    v_mfma_f32_16x16x32_bf16 v[84:87], v[32:35], a[100:103], v[84:87]
    buffer_load_dwordx4 v16, s[16:19], s34 offen offset:896 lds
    v_mfma_f32_16x16x32_bf16 v[88:91], v[36:39], a[96:99], v[88:91]
    ds_read_b128 v[60:63], v20 offset:23552
    v_mfma_f32_16x16x32_bf16 v[92:95], v[36:39], a[100:103], v[92:95]
    s_waitcnt lgkmcnt(4)
    v_mfma_f32_16x16x32_bf16 v[80:83], v[40:43], a[104:107], v[80:83]
    s_add_u32 s34, s34, 64512
    s_min_u32 s34, s34, 4128768
    v_mfma_f32_16x16x32_bf16 v[84:87], v[40:43], a[108:111], v[84:87]
    v_mfma_f32_16x16x32_bf16 v[88:91], v[44:47], a[104:107], v[88:91]
    v_mfma_f32_16x16x32_bf16 v[92:95], v[44:47], a[108:111], v[92:95]
    s_waitcnt lgkmcnt(0)
    s_cmp_lt_u32 s35, 2
    s_cselect_b64 s[70:71], s[36:37], 0
    s_cbranch_scc0 .ef_414
    s_waitcnt vmcnt(5)
.ef_414:
    s_waitcnt vmcnt(19)
    s_barrier
    ds_read_b128 v[32:35], v19 offset:32768
    ds_read_b128 v[36:39], v19 offset:49152
    v_mfma_f32_16x16x32_bf16 v[80:83], v[48:51], a[112:115], v[80:83]
    ds_read_b128 v[40:43], v20 offset:32768
    s_add_u32 m0, s29, 65536
    v_mfma_f32_16x16x32_bf16 v[84:87], v[48:51], a[116:119], v[84:87]
    buffer_load_dwordx4 v16, s[16:19], s34 offen offset:0 lds
    v_mfma_f32_16x16x32_bf16 v[88:91], v[52:55], a[112:115], v[88:91]
    ds_read_b128 v[44:47], v20 offset:49152
    v_mfma_f32_16x16x32_bf16 v[92:95], v[52:55], a[116:119], v[92:95]
    v_mfma_f32_16x16x32_bf16 v[80:83], v[56:59], a[120:123], v[80:83]
    ds_read_b128 v[48:51], v19 offset:33792
    v_mfma_f32_16x16x32_bf16 v[84:87], v[56:59], a[124:127], v[84:87]
    v_mfma_f32_16x16x32_bf16 v[88:91], v[60:63], a[120:123], v[88:91]
    ds_read_b128 v[52:55], v19 offset:50176
    v_mfma_f32_16x16x32_bf16 v[92:95], v[60:63], a[124:127], v[92:95]
    s_mov_b64 exec, s[70:71]
    buffer_store_dword v23, v22, s[8:11], s33 offen sc1
    s_mov_b64 exec, -1

    s_waitcnt lgkmcnt(4)
    v_mfma_f32_16x16x32_bf16 v[80:83], v[32:35], a[128:131], v[80:83]
    ds_read_b128 v[56:59], v20 offset:33792
    s_add_u32 m0, s29, 66432
    v_mfma_f32_16x16x32_bf16 v[84:87], v[32:35], a[132:135], v[84:87]
    buffer_load_dwordx4 v16, s[16:19], s34 offen offset:128 lds
    v_mfma_f32_16x16x32_bf16 v[88:91], v[36:39], a[128:131], v[88:91]
    ds_read_b128 v[60:63], v20 offset:50176
    v_mfma_f32_16x16x32_bf16 v[92:95], v[36:39], a[132:135], v[92:95]
    s_waitcnt lgkmcnt(4)
    v_mfma_f32_16x16x32_bf16 v[80:83], v[40:43], a[136:139], v[80:83]
    ds_read_b128 v[32:35], v19 offset:34816
    v_mfma_f32_16x16x32_bf16 v[84:87], v[40:43], a[140:143], v[84:87]
    v_mfma_f32_16x16x32_bf16 v[88:91], v[44:47], a[136:139], v[88:91]
    ds_read_b128 v[36:39], v19 offset:51200
    v_mfma_f32_16x16x32_bf16 v[92:95], v[44:47], a[140:143], v[92:95]
    s_waitcnt lgkmcnt(4)
    v_mfma_f32_16x16x32_bf16 v[80:83], v[48:51], a[144:147], v[80:83]
    ds_read_b128 v[40:43], v20 offset:34816
    s_add_u32 m0, s29, 67328
    v_mfma_f32_16x16x32_bf16 v[84:87], v[48:51], a[148:151], v[84:87]
    buffer_load_dwordx4 v16, s[16:19], s34 offen offset:256 lds
    v_mfma_f32_16x16x32_bf16 v[88:91], v[52:55], a[144:147], v[88:91]
    ds_read_b128 v[44:47], v20 offset:51200
    v_mfma_f32_16x16x32_bf16 v[92:95], v[52:55], a[148:151], v[92:95]
    s_waitcnt lgkmcnt(4)
    v_mfma_f32_16x16x32_bf16 v[80:83], v[56:59], a[152:155], v[80:83]
    ds_read_b128 v[48:51], v19 offset:35840
    v_mfma_f32_16x16x32_bf16 v[84:87], v[56:59], a[156:159], v[84:87]
    v_mfma_f32_16x16x32_bf16 v[88:91], v[60:63], a[152:155], v[88:91]
    ds_read_b128 v[52:55], v19 offset:52224
    v_mfma_f32_16x16x32_bf16 v[92:95], v[60:63], a[156:159], v[92:95]
    s_waitcnt lgkmcnt(4)
    v_mfma_f32_16x16x32_bf16 v[80:83], v[32:35], a[160:163], v[80:83]
    ds_read_b128 v[56:59], v20 offset:35840
    s_add_u32 m0, s29, 68224
    v_mfma_f32_16x16x32_bf16 v[84:87], v[32:35], a[164:167], v[84:87]
    buffer_load_dwordx4 v16, s[16:19], s34 offen offset:384 lds
    v_mfma_f32_16x16x32_bf16 v[88:91], v[36:39], a[160:163], v[88:91]
    ds_read_b128 v[60:63], v20 offset:52224
    v_mfma_f32_16x16x32_bf16 v[92:95], v[36:39], a[164:167], v[92:95]
    s_waitcnt lgkmcnt(4)
    v_mfma_f32_16x16x32_bf16 v[80:83], v[40:43], a[168:171], v[80:83]
    ds_read_b128 v[32:35], v19 offset:36864
    v_mfma_f32_16x16x32_bf16 v[84:87], v[40:43], a[172:175], v[84:87]
    v_mfma_f32_16x16x32_bf16 v[88:91], v[44:47], a[168:171], v[88:91]
    ds_read_b128 v[36:39], v19 offset:53248
    v_mfma_f32_16x16x32_bf16 v[92:95], v[44:47], a[172:175], v[92:95]
    s_waitcnt lgkmcnt(4)
    v_mfma_f32_16x16x32_bf16 v[80:83], v[48:51], a[176:179], v[80:83]
    ds_read_b128 v[40:43], v20 offset:36864
    s_add_u32 m0, s29, 69120
    v_mfma_f32_16x16x32_bf16 v[84:87], v[48:51], a[180:183], v[84:87]
    buffer_load_dwordx4 v16, s[16:19], s34 offen offset:512 lds
    v_mfma_f32_16x16x32_bf16 v[88:91], v[52:55], a[176:179], v[88:91]
    ds_read_b128 v[44:47], v20 offset:53248
    v_mfma_f32_16x16x32_bf16 v[92:95], v[52:55], a[180:183], v[92:95]
    s_waitcnt lgkmcnt(4)
    v_mfma_f32_16x16x32_bf16 v[80:83], v[56:59], a[184:187], v[80:83]
    ds_read_b128 v[48:51], v19 offset:37888
    v_mfma_f32_16x16x32_bf16 v[84:87], v[56:59], a[188:191], v[84:87]
    v_mfma_f32_16x16x32_bf16 v[88:91], v[60:63], a[184:187], v[88:91]
    ds_read_b128 v[52:55], v19 offset:54272
    v_mfma_f32_16x16x32_bf16 v[92:95], v[60:63], a[188:191], v[92:95]
    s_waitcnt lgkmcnt(4)
    v_mfma_f32_16x16x32_bf16 v[80:83], v[32:35], a[192:195], v[80:83]
    ds_read_b128 v[56:59], v20 offset:37888
    s_add_u32 m0, s29, 70016
    v_mfma_f32_16x16x32_bf16 v[84:87], v[32:35], a[196:199], v[84:87]
    buffer_load_dwordx4 v16, s[16:19], s34 offen offset:640 lds
    v_mfma_f32_16x16x32_bf16 v[88:91], v[36:39], a[192:195], v[88:91]
    ds_read_b128 v[60:63], v20 offset:54272
    v_mfma_f32_16x16x32_bf16 v[92:95], v[36:39], a[196:199], v[92:95]
    s_waitcnt lgkmcnt(4)
    v_mfma_f32_16x16x32_bf16 v[80:83], v[40:43], a[200:203], v[80:83]
    ds_read_b128 v[32:35], v19 offset:38912
    v_mfma_f32_16x16x32_bf16 v[84:87], v[40:43], a[204:207], v[84:87]
    v_mfma_f32_16x16x32_bf16 v[88:91], v[44:47], a[200:203], v[88:91]
    ds_read_b128 v[36:39], v19 offset:55296
    v_mfma_f32_16x16x32_bf16 v[92:95], v[44:47], a[204:207], v[92:95]
    s_waitcnt lgkmcnt(4)
    v_mfma_f32_16x16x32_bf16 v[80:83], v[48:51], a[208:211], v[80:83]
    ds_read_b128 v[40:43], v20 offset:38912
    s_add_u32 m0, s29, 70912
    v_mfma_f32_16x16x32_bf16 v[84:87], v[48:51], a[212:215], v[84:87]
    buffer_load_dwordx4 v16, s[16:19], s34 offen offset:768 lds
    v_mfma_f32_16x16x32_bf16 v[88:91], v[52:55], a[208:211], v[88:91]
    ds_read_b128 v[44:47], v20 offset:55296
    v_mfma_f32_16x16x32_bf16 v[92:95], v[52:55], a[212:215], v[92:95]
    s_waitcnt lgkmcnt(4)
    v_mfma_f32_16x16x32_bf16 v[80:83], v[56:59], a[216:219], v[80:83]
    ds_read_b128 v[48:51], v19 offset:39936
    v_mfma_f32_16x16x32_bf16 v[84:87], v[56:59], a[220:223], v[84:87]
    s_cmp_lt_u32 s35, 22
    s_cselect_b64 s[44:45], -1, 0
    v_mfma_f32_16x16x32_bf16 v[88:91], v[60:63], a[216:219], v[88:91]
    ds_read_b128 v[52:55], v19 offset:56320
    v_mfma_f32_16x16x32_bf16 v[92:95], v[60:63], a[220:223], v[92:95]
    s_cselect_b32 s4, 0x10000, 0
    s_add_u32 s46, s46, s4
    s_waitcnt lgkmcnt(4)
    v_mfma_f32_16x16x32_bf16 v[80:83], v[32:35], a[224:227], v[80:83]
    ds_read_b128 v[56:59], v20 offset:39936
    s_add_u32 m0, s29, 71808
    v_mfma_f32_16x16x32_bf16 v[84:87], v[32:35], a[228:231], v[84:87]
    buffer_load_dwordx4 v16, s[16:19], s34 offen offset:896 lds
    v_mfma_f32_16x16x32_bf16 v[88:91], v[36:39], a[224:227], v[88:91]
    ds_read_b128 v[60:63], v20 offset:56320
    v_mfma_f32_16x16x32_bf16 v[92:95], v[36:39], a[228:231], v[92:95]
    s_waitcnt lgkmcnt(4)
    v_mfma_f32_16x16x32_bf16 v[80:83], v[40:43], a[232:235], v[80:83]
    s_add_u32 s34, s34, 1024
    v_mfma_f32_16x16x32_bf16 v[84:87], v[40:43], a[236:239], v[84:87]
    v_mfma_f32_16x16x32_bf16 v[88:91], v[44:47], a[232:235], v[88:91]
    v_mfma_f32_16x16x32_bf16 v[92:95], v[44:47], a[236:239], v[92:95]
    s_waitcnt lgkmcnt(0)
    s_waitcnt vmcnt(13)
    s_barrier
    ds_read_b128 v[32:35], v17 offset:0
    ds_read_b128 v[36:39], v17 offset:16384
    v_mfma_f32_16x16x32_bf16 v[80:83], v[48:51], a[240:243], v[80:83]
    ds_read_b128 v[40:43], v18 offset:0
    s_add_u32 m0, s29, 98304
    v_mfma_f32_16x16x32_bf16 v[84:87], v[48:51], a[244:247], v[84:87]
    buffer_load_dwordx4 v16, s[16:19], s34 offen offset:0 lds
    v_mfma_f32_16x16x32_bf16 v[88:91], v[52:55], a[240:243], v[88:91]
    ds_read_b128 v[44:47], v18 offset:16384
    v_mfma_f32_16x16x32_bf16 v[92:95], v[52:55], a[244:247], v[92:95]
    v_mfma_f32_16x16x32_bf16 v[80:83], v[56:59], a[248:251], v[80:83]
    ds_read_b128 v[48:51], v17 offset:1024
    v_mfma_f32_16x16x32_bf16 v[84:87], v[56:59], a[252:255], v[84:87]
    v_mfma_f32_16x16x32_bf16 v[88:91], v[60:63], a[248:251], v[88:91]
    ds_read_b128 v[52:55], v17 offset:17408
    v_mfma_f32_16x16x32_bf16 v[92:95], v[60:63], a[252:255], v[92:95]
    s_mov_b64 exec, s[36:37]
    buffer_store_dword v23, v22, s[8:11], s33 offen sc1
    s_mov_b64 exec, -1

    s_add_u32 s35, s35, 1
    s_cmp_lt_u32 s35, 32
    s_cbranch_scc1 .ql_411

    s_nop 7
    v_cvt_pk_bf16_f32 v96, v80, v81
    v_cvt_pk_bf16_f32 v97, v82, v83
    v_cvt_pk_bf16_f32 v98, v88, v89
    v_cvt_pk_bf16_f32 v99, v90, v91
    buffer_store_dwordx4 v[96:99], v21, s[8:11], s32 offen offset:0 sc1
    v_cvt_pk_bf16_f32 v100, v84, v85
    v_cvt_pk_bf16_f32 v101, v86, v87
    v_cvt_pk_bf16_f32 v102, v92, v93
    v_cvt_pk_bf16_f32 v103, v94, v95
    buffer_store_dwordx4 v[100:103], v21, s[8:11], s32 offen offset:1024 sc1
    s_mov_b32 exec_hi, 0
    buffer_store_dwordx4 v[24:27], v21, s[8:11], s48 offen sc1
    s_mov_b32 exec_hi, -1

    v_mov_b32 v23, 64
    s_waitcnt vmcnt(0) lgkmcnt(0)
    s_barrier
    s_mov_b64 exec, s[36:37]
    buffer_store_dword v23, v22, s[8:11], s33 offen sc1
    s_mov_b64 exec, -1

.qd_387:
    s_load_dwordx2 s[40:41], s[0:1], 88
    s_load_dwordx2 s[42:43], s[0:1], 112
    s_and_b32 s4, s33, 0xffffe7ff
    s_mov_b32 s57, s4
    s_mov_b32 s34, s47
    s_and_b32 s30, s26, 7
    s_lshr_b32 s31, s26, 3
    s_lshl_b32 s28, s91, 21
    s_lshl_b32 s4, s30, 8
    s_add_u32 s28, s28, s4
    s_waitcnt lgkmcnt(0)

    s_mov_b32 s12, s40
    s_and_b32 s13, s41, 0xffff
    s_mov_b32 s14, 0x800000
    s_mov_b32 s15, 0x00020000

    s_mov_b32 s44, s42
    s_and_b32 s45, s43, 0xffff
    s_mov_b32 s46, 0x400000
    s_mov_b32 s47, 0x00020000

    v_lshrrev_b32 v4, 1, v2
    v_xor_b32 v4, v4, v3
    v_lshlrev_b32 v4, 1, v4
    v_and_b32 v5, 1, v1
    v_or_b32 v4, v4, v5
    v_lshlrev_b32 v4, 4, v4
    v_lshlrev_b32 v5, 11, v3
    v_add_u32 v10, v4, v5
    v_xor_b32 v11, 0x80, v10
    s_lshl_b32 s4, s24, 16
    s_add_u32 s28, s28, s4
    s_lshl_b32 s29, s24, 13
    v_lshrrev_b32 v4, 2, v2
    v_and_b32 v5, 1, v3
    v_lshl_or_b32 v5, v5, 2, v4
    s_lshl_b32 s4, s24, 1
    v_xor_b32 v5, s4, v5
    v_lshlrev_b32 v5, 5, v5
    v_lshl_add_u32 v4, v3, 2, v4
    v_lshl_add_u32 v5, v4, 8, v5
    v_and_b32 v4, 3, v2
    v_lshl_add_u32 v12, v4, 3, v5
    v_xor_b32 v13, 32, v12
    v_add_u32 v14, 0x10000, v12
    v_add_u32 v15, 0x10000, v13

    s_and_b32 s4, s91, 1
    s_lshl_b32 s4, s4, 5
    v_xor_b32 v12, s4, v12
    v_xor_b32 v13, s4, v13
    v_xor_b32 v14, s4, v14
    v_xor_b32 v15, s4, v15

    s_and_b32 s4, s26, 7
    s_lshl_b32 s4, s4, 1
    s_lshr_b32 s5, s24, 1
    s_add_u32 s4, s4, s5
    s_lshl_b32 s4, s4, 6
    v_add_u32 v4, s4, v1
    v_lshlrev_b32 v4, 11, v4
    s_and_b32 s4, s24, 1
    s_lshl_b32 s4, s4, 10
    s_lshl_b32 s5, s91, 21
    s_add_u32 s4, s4, s5
    buffer_load_dword v31, v4, s[12:15], s4 offen offset:384

    s_add_u32 m0, s29, 0
    s_add_u32 s4, s28, 0
    buffer_load_dwordx4 v10, s[12:15], s4 offen lds

    s_add_u32 m0, s29, 1024
    s_add_u32 s4, s28, 8192
    buffer_load_dwordx4 v11, s[12:15], s4 offen lds

    s_add_u32 m0, s29, 2048
    s_add_u32 s4, s28, 16384
    buffer_load_dwordx4 v10, s[12:15], s4 offen lds

    s_add_u32 m0, s29, 3072
    s_add_u32 s4, s28, 24576
    buffer_load_dwordx4 v11, s[12:15], s4 offen lds

    s_add_u32 m0, s29, 4096
    s_add_u32 s4, s28, 32768
    buffer_load_dwordx4 v10, s[12:15], s4 offen lds

    s_add_u32 m0, s29, 5120
    s_add_u32 s4, s28, 40960
    buffer_load_dwordx4 v11, s[12:15], s4 offen lds

    s_add_u32 m0, s29, 6144
    s_add_u32 s4, s28, 49152
    buffer_load_dwordx4 v10, s[12:15], s4 offen lds

    s_add_u32 m0, s29, 7168
    s_add_u32 s4, s28, 57344
    buffer_load_dwordx4 v11, s[12:15], s4 offen lds

    s_add_u32 m0, s29, 32768
    s_add_u32 s4, s28, 262144
    buffer_load_dwordx4 v10, s[12:15], s4 offen lds

    s_add_u32 m0, s29, 33792
    s_add_u32 s4, s28, 270336
    buffer_load_dwordx4 v11, s[12:15], s4 offen lds

    s_add_u32 m0, s29, 34816
    s_add_u32 s4, s28, 278528
    buffer_load_dwordx4 v10, s[12:15], s4 offen lds

    s_add_u32 m0, s29, 35840
    s_add_u32 s4, s28, 286720
    buffer_load_dwordx4 v11, s[12:15], s4 offen lds

    s_add_u32 m0, s29, 36864
    s_add_u32 s4, s28, 294912
    buffer_load_dwordx4 v10, s[12:15], s4 offen lds

    s_add_u32 m0, s29, 37888
    s_add_u32 s4, s28, 303104
    buffer_load_dwordx4 v11, s[12:15], s4 offen lds

    s_add_u32 m0, s29, 38912
    s_add_u32 s4, s28, 311296
    buffer_load_dwordx4 v10, s[12:15], s4 offen lds

    s_add_u32 m0, s29, 39936
    s_add_u32 s4, s28, 319488
    buffer_load_dwordx4 v11, s[12:15], s4 offen lds

    s_add_u32 m0, s29, 65536
    s_add_u32 s4, s28, 524288
    buffer_load_dwordx4 v10, s[12:15], s4 offen lds

    s_add_u32 m0, s29, 66560
    s_add_u32 s4, s28, 532480
    buffer_load_dwordx4 v11, s[12:15], s4 offen lds

    s_add_u32 m0, s29, 67584
    s_add_u32 s4, s28, 540672
    buffer_load_dwordx4 v10, s[12:15], s4 offen lds

    s_add_u32 m0, s29, 68608
    s_add_u32 s4, s28, 548864
    buffer_load_dwordx4 v11, s[12:15], s4 offen lds

    s_add_u32 m0, s29, 69632
    s_add_u32 s4, s28, 557056
    buffer_load_dwordx4 v10, s[12:15], s4 offen lds

    s_add_u32 m0, s29, 70656
    s_add_u32 s4, s28, 565248
    buffer_load_dwordx4 v11, s[12:15], s4 offen lds

    s_add_u32 m0, s29, 71680
    s_add_u32 s4, s28, 573440
    buffer_load_dwordx4 v10, s[12:15], s4 offen lds

    s_add_u32 m0, s29, 72704
    s_add_u32 s4, s28, 581632
    buffer_load_dwordx4 v11, s[12:15], s4 offen lds

    s_add_u32 m0, s29, 98304
    s_add_u32 s4, s28, 786432
    buffer_load_dwordx4 v10, s[12:15], s4 offen lds

    s_add_u32 m0, s29, 99328
    s_add_u32 s4, s28, 794624
    buffer_load_dwordx4 v11, s[12:15], s4 offen lds

    s_add_u32 m0, s29, 100352
    s_add_u32 s4, s28, 802816
    buffer_load_dwordx4 v10, s[12:15], s4 offen lds

    s_add_u32 m0, s29, 101376
    s_add_u32 s4, s28, 811008
    buffer_load_dwordx4 v11, s[12:15], s4 offen lds

    s_add_u32 m0, s29, 102400
    s_add_u32 s4, s28, 819200
    buffer_load_dwordx4 v10, s[12:15], s4 offen lds

    s_add_u32 m0, s29, 103424
    s_add_u32 s4, s28, 827392
    buffer_load_dwordx4 v11, s[12:15], s4 offen lds

    s_add_u32 m0, s29, 104448
    s_add_u32 s4, s28, 835584
    buffer_load_dwordx4 v10, s[12:15], s4 offen lds

    s_add_u32 m0, s29, 105472
    s_add_u32 s4, s28, 843776
    buffer_load_dwordx4 v11, s[12:15], s4 offen lds

    s_waitcnt vmcnt(24)
    s_barrier
    ds_read_b64_tr_b16 a[0:1], v12 offset:0
    ds_read_b64_tr_b16 a[2:3], v12 offset:4096
    ds_read_b64_tr_b16 a[4:5], v13 offset:0
    ds_read_b64_tr_b16 a[6:7], v13 offset:4096
    ds_read_b64_tr_b16 a[8:9], v12 offset:8192
    ds_read_b64_tr_b16 a[10:11], v12 offset:12288
    ds_read_b64_tr_b16 a[12:13], v13 offset:8192
    ds_read_b64_tr_b16 a[14:15], v13 offset:12288
    ds_read_b64_tr_b16 a[16:17], v12 offset:16384
    ds_read_b64_tr_b16 a[18:19], v12 offset:20480
    ds_read_b64_tr_b16 a[20:21], v13 offset:16384
    ds_read_b64_tr_b16 a[22:23], v13 offset:20480
    ds_read_b64_tr_b16 a[24:25], v12 offset:24576
    ds_read_b64_tr_b16 a[26:27], v12 offset:28672
    ds_read_b64_tr_b16 a[28:29], v13 offset:24576
    ds_read_b64_tr_b16 a[30:31], v13 offset:28672
    s_waitcnt lgkmcnt(0)
    s_barrier
    s_add_u32 m0, s29, 0
    s_add_u32 s4, s28, 1048576
    buffer_load_dwordx4 v10, s[12:15], s4 offen lds

    s_add_u32 m0, s29, 1024
    s_add_u32 s4, s28, 1056768
    buffer_load_dwordx4 v11, s[12:15], s4 offen lds

    s_add_u32 m0, s29, 2048
    s_add_u32 s4, s28, 1064960
    buffer_load_dwordx4 v10, s[12:15], s4 offen lds

    s_add_u32 m0, s29, 3072
    s_add_u32 s4, s28, 1073152
    buffer_load_dwordx4 v11, s[12:15], s4 offen lds

    s_add_u32 m0, s29, 4096
    s_add_u32 s4, s28, 1081344
    buffer_load_dwordx4 v10, s[12:15], s4 offen lds

    s_add_u32 m0, s29, 5120
    s_add_u32 s4, s28, 1089536
    buffer_load_dwordx4 v11, s[12:15], s4 offen lds

    s_add_u32 m0, s29, 6144
    s_add_u32 s4, s28, 1097728
    buffer_load_dwordx4 v10, s[12:15], s4 offen lds

    s_add_u32 m0, s29, 7168
    s_add_u32 s4, s28, 1105920
    buffer_load_dwordx4 v11, s[12:15], s4 offen lds

    s_waitcnt vmcnt(24)
    s_barrier
    ds_read_b64_tr_b16 a[32:33], v12 offset:32768
    ds_read_b64_tr_b16 a[34:35], v12 offset:36864
    ds_read_b64_tr_b16 a[36:37], v13 offset:32768
    ds_read_b64_tr_b16 a[38:39], v13 offset:36864
    ds_read_b64_tr_b16 a[40:41], v12 offset:40960
    ds_read_b64_tr_b16 a[42:43], v12 offset:45056
    ds_read_b64_tr_b16 a[44:45], v13 offset:40960
    ds_read_b64_tr_b16 a[46:47], v13 offset:45056
    ds_read_b64_tr_b16 a[48:49], v12 offset:49152
    ds_read_b64_tr_b16 a[50:51], v12 offset:53248
    ds_read_b64_tr_b16 a[52:53], v13 offset:49152
    ds_read_b64_tr_b16 a[54:55], v13 offset:53248
    ds_read_b64_tr_b16 a[56:57], v12 offset:57344
    ds_read_b64_tr_b16 a[58:59], v12 offset:61440
    ds_read_b64_tr_b16 a[60:61], v13 offset:57344
    ds_read_b64_tr_b16 a[62:63], v13 offset:61440
    s_waitcnt lgkmcnt(0)
    s_barrier
    s_add_u32 m0, s29, 32768
    s_add_u32 s4, s28, 1310720
    buffer_load_dwordx4 v10, s[12:15], s4 offen lds

    s_add_u32 m0, s29, 33792
    s_add_u32 s4, s28, 1318912
    buffer_load_dwordx4 v11, s[12:15], s4 offen lds

    s_add_u32 m0, s29, 34816
    s_add_u32 s4, s28, 1327104
    buffer_load_dwordx4 v10, s[12:15], s4 offen lds

    s_add_u32 m0, s29, 35840
    s_add_u32 s4, s28, 1335296
    buffer_load_dwordx4 v11, s[12:15], s4 offen lds

    s_add_u32 m0, s29, 36864
    s_add_u32 s4, s28, 1343488
    buffer_load_dwordx4 v10, s[12:15], s4 offen lds

    s_add_u32 m0, s29, 37888
    s_add_u32 s4, s28, 1351680
    buffer_load_dwordx4 v11, s[12:15], s4 offen lds

    s_add_u32 m0, s29, 38912
    s_add_u32 s4, s28, 1359872
    buffer_load_dwordx4 v10, s[12:15], s4 offen lds

    s_add_u32 m0, s29, 39936
    s_add_u32 s4, s28, 1368064
    buffer_load_dwordx4 v11, s[12:15], s4 offen lds

    s_waitcnt vmcnt(24)
    s_barrier
    ds_read_b64_tr_b16 a[64:65], v14 offset:0
    ds_read_b64_tr_b16 a[66:67], v14 offset:4096
    ds_read_b64_tr_b16 a[68:69], v15 offset:0
    ds_read_b64_tr_b16 a[70:71], v15 offset:4096
    ds_read_b64_tr_b16 a[72:73], v14 offset:8192
    ds_read_b64_tr_b16 a[74:75], v14 offset:12288
    ds_read_b64_tr_b16 a[76:77], v15 offset:8192
    ds_read_b64_tr_b16 a[78:79], v15 offset:12288
    ds_read_b64_tr_b16 a[80:81], v14 offset:16384
    ds_read_b64_tr_b16 a[82:83], v14 offset:20480
    ds_read_b64_tr_b16 a[84:85], v15 offset:16384
    ds_read_b64_tr_b16 a[86:87], v15 offset:20480
    ds_read_b64_tr_b16 a[88:89], v14 offset:24576
    ds_read_b64_tr_b16 a[90:91], v14 offset:28672
    ds_read_b64_tr_b16 a[92:93], v15 offset:24576
    ds_read_b64_tr_b16 a[94:95], v15 offset:28672
    s_waitcnt lgkmcnt(0)
    s_barrier
    s_add_u32 m0, s29, 65536
    s_add_u32 s4, s28, 1572864
    buffer_load_dwordx4 v10, s[12:15], s4 offen lds

    s_add_u32 m0, s29, 66560
    s_add_u32 s4, s28, 1581056
    buffer_load_dwordx4 v11, s[12:15], s4 offen lds

    s_add_u32 m0, s29, 67584
    s_add_u32 s4, s28, 1589248
    buffer_load_dwordx4 v10, s[12:15], s4 offen lds

    s_add_u32 m0, s29, 68608
    s_add_u32 s4, s28, 1597440
    buffer_load_dwordx4 v11, s[12:15], s4 offen lds

    s_add_u32 m0, s29, 69632
    s_add_u32 s4, s28, 1605632
    buffer_load_dwordx4 v10, s[12:15], s4 offen lds

    s_add_u32 m0, s29, 70656
    s_add_u32 s4, s28, 1613824
    buffer_load_dwordx4 v11, s[12:15], s4 offen lds

    s_add_u32 m0, s29, 71680
    s_add_u32 s4, s28, 1622016
    buffer_load_dwordx4 v10, s[12:15], s4 offen lds

    s_add_u32 m0, s29, 72704
    s_add_u32 s4, s28, 1630208
    buffer_load_dwordx4 v11, s[12:15], s4 offen lds

    s_waitcnt vmcnt(24)
    s_barrier
    ds_read_b64_tr_b16 a[96:97], v14 offset:32768
    ds_read_b64_tr_b16 a[98:99], v14 offset:36864
    ds_read_b64_tr_b16 a[100:101], v15 offset:32768
    ds_read_b64_tr_b16 a[102:103], v15 offset:36864
    ds_read_b64_tr_b16 a[104:105], v14 offset:40960
    ds_read_b64_tr_b16 a[106:107], v14 offset:45056
    ds_read_b64_tr_b16 a[108:109], v15 offset:40960
    ds_read_b64_tr_b16 a[110:111], v15 offset:45056
    ds_read_b64_tr_b16 a[112:113], v14 offset:49152
    ds_read_b64_tr_b16 a[114:115], v14 offset:53248
    ds_read_b64_tr_b16 a[116:117], v15 offset:49152
    ds_read_b64_tr_b16 a[118:119], v15 offset:53248
    ds_read_b64_tr_b16 a[120:121], v14 offset:57344
    ds_read_b64_tr_b16 a[122:123], v14 offset:61440
    ds_read_b64_tr_b16 a[124:125], v15 offset:57344
    ds_read_b64_tr_b16 a[126:127], v15 offset:61440
    s_waitcnt lgkmcnt(0)
    s_barrier
    s_add_u32 m0, s29, 98304
    s_add_u32 s4, s28, 1835008
    buffer_load_dwordx4 v10, s[12:15], s4 offen lds

    s_add_u32 m0, s29, 99328
    s_add_u32 s4, s28, 1843200
    buffer_load_dwordx4 v11, s[12:15], s4 offen lds

    s_add_u32 m0, s29, 100352
    s_add_u32 s4, s28, 1851392
    buffer_load_dwordx4 v10, s[12:15], s4 offen lds

    s_add_u32 m0, s29, 101376
    s_add_u32 s4, s28, 1859584
    buffer_load_dwordx4 v11, s[12:15], s4 offen lds

    s_add_u32 m0, s29, 102400
    s_add_u32 s4, s28, 1867776
    buffer_load_dwordx4 v10, s[12:15], s4 offen lds

    s_add_u32 m0, s29, 103424
    s_add_u32 s4, s28, 1875968
    buffer_load_dwordx4 v11, s[12:15], s4 offen lds

    s_add_u32 m0, s29, 104448
    s_add_u32 s4, s28, 1884160
    buffer_load_dwordx4 v10, s[12:15], s4 offen lds

    s_add_u32 m0, s29, 105472
    s_add_u32 s4, s28, 1892352
    buffer_load_dwordx4 v11, s[12:15], s4 offen lds

    s_waitcnt vmcnt(24)
    s_barrier
    ds_read_b64_tr_b16 a[128:129], v12 offset:0
    ds_read_b64_tr_b16 a[130:131], v12 offset:4096
    ds_read_b64_tr_b16 a[132:133], v13 offset:0
    ds_read_b64_tr_b16 a[134:135], v13 offset:4096
    ds_read_b64_tr_b16 a[136:137], v12 offset:8192
    ds_read_b64_tr_b16 a[138:139], v12 offset:12288
    ds_read_b64_tr_b16 a[140:141], v13 offset:8192
    ds_read_b64_tr_b16 a[142:143], v13 offset:12288
    ds_read_b64_tr_b16 a[144:145], v12 offset:16384
    ds_read_b64_tr_b16 a[146:147], v12 offset:20480
    ds_read_b64_tr_b16 a[148:149], v13 offset:16384
    ds_read_b64_tr_b16 a[150:151], v13 offset:20480
    ds_read_b64_tr_b16 a[152:153], v12 offset:24576
    ds_read_b64_tr_b16 a[154:155], v12 offset:28672
    ds_read_b64_tr_b16 a[156:157], v13 offset:24576
    ds_read_b64_tr_b16 a[158:159], v13 offset:28672
    s_waitcnt lgkmcnt(0)
    s_barrier
    s_waitcnt vmcnt(16)
    s_barrier
    ds_read_b64_tr_b16 a[160:161], v12 offset:32768
    ds_read_b64_tr_b16 a[162:163], v12 offset:36864
    ds_read_b64_tr_b16 a[164:165], v13 offset:32768
    ds_read_b64_tr_b16 a[166:167], v13 offset:36864
    ds_read_b64_tr_b16 a[168:169], v12 offset:40960
    ds_read_b64_tr_b16 a[170:171], v12 offset:45056
    ds_read_b64_tr_b16 a[172:173], v13 offset:40960
    ds_read_b64_tr_b16 a[174:175], v13 offset:45056
    ds_read_b64_tr_b16 a[176:177], v12 offset:49152
    ds_read_b64_tr_b16 a[178:179], v12 offset:53248
    ds_read_b64_tr_b16 a[180:181], v13 offset:49152
    ds_read_b64_tr_b16 a[182:183], v13 offset:53248
    ds_read_b64_tr_b16 a[184:185], v12 offset:57344
    ds_read_b64_tr_b16 a[186:187], v12 offset:61440
    ds_read_b64_tr_b16 a[188:189], v13 offset:57344
    ds_read_b64_tr_b16 a[190:191], v13 offset:61440
    s_waitcnt lgkmcnt(0)
    s_barrier
    s_waitcnt vmcnt(8)
    s_barrier
    ds_read_b64_tr_b16 a[192:193], v14 offset:0
    ds_read_b64_tr_b16 a[194:195], v14 offset:4096
    ds_read_b64_tr_b16 a[196:197], v15 offset:0
    ds_read_b64_tr_b16 a[198:199], v15 offset:4096
    ds_read_b64_tr_b16 a[200:201], v14 offset:8192
    ds_read_b64_tr_b16 a[202:203], v14 offset:12288
    ds_read_b64_tr_b16 a[204:205], v15 offset:8192
    ds_read_b64_tr_b16 a[206:207], v15 offset:12288
    ds_read_b64_tr_b16 a[208:209], v14 offset:16384
    ds_read_b64_tr_b16 a[210:211], v14 offset:20480
    ds_read_b64_tr_b16 a[212:213], v15 offset:16384
    ds_read_b64_tr_b16 a[214:215], v15 offset:20480
    ds_read_b64_tr_b16 a[216:217], v14 offset:24576
    ds_read_b64_tr_b16 a[218:219], v14 offset:28672
    ds_read_b64_tr_b16 a[220:221], v15 offset:24576
    ds_read_b64_tr_b16 a[222:223], v15 offset:28672
    s_waitcnt lgkmcnt(0)
    s_barrier
    s_waitcnt vmcnt(0)
    s_barrier
    ds_read_b64_tr_b16 a[224:225], v14 offset:32768
    ds_read_b64_tr_b16 a[226:227], v14 offset:36864
    ds_read_b64_tr_b16 a[228:229], v15 offset:32768
    ds_read_b64_tr_b16 a[230:231], v15 offset:36864
    ds_read_b64_tr_b16 a[232:233], v14 offset:40960
    ds_read_b64_tr_b16 a[234:235], v14 offset:45056
    ds_read_b64_tr_b16 a[236:237], v15 offset:40960
    ds_read_b64_tr_b16 a[238:239], v15 offset:45056
    ds_read_b64_tr_b16 a[240:241], v14 offset:49152
    ds_read_b64_tr_b16 a[242:243], v14 offset:53248
    ds_read_b64_tr_b16 a[244:245], v15 offset:49152
    ds_read_b64_tr_b16 a[246:247], v15 offset:53248
    ds_read_b64_tr_b16 a[248:249], v14 offset:57344
    ds_read_b64_tr_b16 a[250:251], v14 offset:61440
    ds_read_b64_tr_b16 a[252:253], v15 offset:57344
    ds_read_b64_tr_b16 a[254:255], v15 offset:61440
    s_waitcnt lgkmcnt(0)
    s_barrier
    v_lshlrev_b32 v21, 4, v1
    s_lshr_b32 s4, s91, 1
    s_lshl_b32 s5, s4, 12
    v_add_u32 v17, s5, v21
    v_xor_b32 v18, 0x1000, v17
    s_lshl_b32 s4, s4, 4
    v_add_u32 v4, s4, v2
    s_lshl_b32 s5, s30, 5
    s_lshl_b32 s6, s24, 3
    s_add_u32 s5, s5, s6
    s_and_b32 s6, s91, 1
    s_lshl_b32 s6, s6, 2
    s_add_u32 s5, s5, s6
    v_add_u32 v5, s5, v3
    v_lshlrev_b32 v6, 3, v5
    v_lshl_add_u32 v22, v4, 11, v6
    v_lshlrev_b32 v6, 14, v5
    v_lshl_add_u32 v23, v4, 2, v6
    v_lshlrev_b32 v16, 2, v4
    v_bfe_u32 v4, v1, 2, 3
    v_lshlrev_b32 v19, 8, v4
    v_and_b32 v4, 3, v1
    v_lshl_add_u32 v19, v4, 2, v19
    s_lshl_b32 s33, s91, 11
    s_add_u32 s33, s33, 92299264
    s_lshl_b32 s35, s24, 10
    s_lshl_b32 s36, s91, 16
    s_add_u32 s36, s36, s35
    s_add_u32 s36, s36, 0
    s_mov_b32 s37, 0
    s_lshl_b32 s4, s91, 3
    s_add_u32 s4, s4, s30
    s_lshl_b32 s4, s4, 2
    s_add_u32 s4, s4, s24
    s_lshl_b32 s4, s4, 11
    s_add_u32 s4, s4, 0
    v_lshlrev_b32 v111, 5, v1
    v_add_u32 v111, s4, v111
    s_mov_b32 s52, 0
    s_mov_b32 s39, 0
    v_lshlrev_b32 v6, 11, v1

    s_mov_b32 s69, 3
    s_mov_b32 s54, 0
    s_mul_i32 s4, s31, 3
    s_add_u32 s4, s4, 2
    s_sub_u32 s5, s31, s4
    s_cmp_lt_u32 s31, 2
    s_cselect_b32 s69, s5, 3
    s_cselect_b32 s4, s4, s31
    s_cmp_eq_u32 s31, 2
    s_cselect_b32 s31, 8, s4

    s_mov_b32 s62, 0
    s_mov_b64 exec, 15
.wf_415:
    buffer_load_dword v4, v6, s[8:11], s57 offen sc1
    s_waitcnt vmcnt(0)
    v_cmp_gt_u32 vcc, 64, v4
    s_cbranch_vccz .wfd_416
    s_sleep 2
    s_add_u32 s62, s62, 1
    s_cmp_gt_u32 s62, 0x400000
    s_cbranch_scc1 .mg_end_1
    s_branch .wf_415

.wfd_416:
    s_mov_b64 exec, -1
    v_mov_b32 v5, 0
    s_mov_b32 s62, 0
    s_mov_b32 s5, 160
.wc_417:
    buffer_load_dword v4, v5, s[20:23], s5 offen sc1
    s_waitcnt vmcnt(0)
    v_readfirstlane_b32 s4, v4
    s_lshr_b32 s4, s4, 0
    s_and_b32 s4, s4, 0xffff
    s_cmp_ge_u32 s4, 32
    s_cbranch_scc1 .wcd_418
    s_sleep 6
    s_add_u32 s62, s62, 1
    s_cmp_gt_u32 s62, 0x400000
    s_cbranch_scc1 .mg_end_1
    s_branch .wc_417

.wcd_418:
.g2blk_419:
    s_mov_b32 s62, 0
    s_mov_b64 s[64:65], 0
    s_mov_b32 s38, 0
    s_cmp_ge_u32 s31, 63
    s_cbranch_scc1 .g2h_428
.g2bw_427:
    buffer_load_dword v20, v19, s[8:11], s33 offen sc1
    s_waitcnt vmcnt(0)
    s_lshr_b32 s6, s31, 2
    s_and_b32 s4, s31, 3
    v_cmp_ge_u32 vcc, s6, v20
    s_lshl_b32 s4, s4, 3
    s_lshr_b32 s5, vcc_lo, s4
    s_and_b32 s5, s5, 0xff
    s_cmp_eq_u32 s5, 0

    s_cbranch_scc1 .g2rd_429
    s_lshl_b64 exec, 0xff, s4

    s_add_u32 s62, s62, 1
    s_cmp_gt_u32 s62, 0x400000
    s_cbranch_scc1 .mg_end_1
    s_branch .g2bw_427

.g2rd_429:
    s_mov_b64 exec, -1
    s_lshl_b32 s48, s31, 18
    s_add_u32 s48, s48, s36
    s_add_u32 s49, s39, s35
    s_xor_b32 s39, s39, 0x10000

    s_add_u32 m0, s49, 0
    s_add_u32 s50, s48, 0
    buffer_load_dwordx4 v21, s[8:11], s50 offen offset:0 sc1 lds
    s_add_u32 m0, s49, 4096
    s_add_u32 s50, s48, 4096
    buffer_load_dwordx4 v21, s[8:11], s50 offen offset:0 sc1 lds
    s_add_u32 m0, s49, 8192
    s_add_u32 s50, s48, 8192
    buffer_load_dwordx4 v21, s[8:11], s50 offen offset:0 sc1 lds
    s_add_u32 m0, s49, 12288
    s_add_u32 s50, s48, 12288
    buffer_load_dwordx4 v21, s[8:11], s50 offen offset:0 sc1 lds
    s_add_u32 m0, s49, 16384
    s_add_u32 s50, s48, 16384
    buffer_load_dwordx4 v21, s[8:11], s50 offen offset:0 sc1 lds
    s_add_u32 m0, s49, 20480
    s_add_u32 s50, s48, 20480
    buffer_load_dwordx4 v21, s[8:11], s50 offen offset:0 sc1 lds
    s_add_u32 m0, s49, 24576
    s_add_u32 s50, s48, 24576
    buffer_load_dwordx4 v21, s[8:11], s50 offen offset:0 sc1 lds
    s_add_u32 m0, s49, 28672
    s_add_u32 s50, s48, 28672
    buffer_load_dwordx4 v21, s[8:11], s50 offen offset:0 sc1 lds
    s_add_u32 s53, s31, s69
    s_lshr_b32 s6, s53, 2
    s_and_b32 s4, s53, 3
    v_cmp_ge_u32 vcc, s6, v20
    s_lshl_b32 s4, s4, 3
    s_lshr_b32 s5, vcc_lo, s4
    s_and_b32 s5, s5, 0xff
    s_cmp_eq_u32 s5, 0

    s_cselect_b32 s56, 1, 0
    s_cmp_lt_u32 s53, 63
    s_cselect_b32 s56, s56, 0
    s_cmp_eq_u32 s56, 0
    s_cbranch_scc1 .g2fb_430
    s_add_u32 m0, s49, 32768
    s_add_u32 s50, s48, 32768
    buffer_load_dwordx4 v21, s[8:11], s50 offen offset:0 sc1 lds
    s_add_u32 m0, s49, 36864
    s_add_u32 s50, s48, 36864
    buffer_load_dwordx4 v21, s[8:11], s50 offen offset:0 sc1 lds
    s_add_u32 m0, s49, 40960
    s_add_u32 s50, s48, 40960
    buffer_load_dwordx4 v21, s[8:11], s50 offen offset:0 sc1 lds
    s_add_u32 m0, s49, 45056
    s_add_u32 s50, s48, 45056
    buffer_load_dwordx4 v21, s[8:11], s50 offen offset:0 sc1 lds
    s_add_u32 m0, s49, 49152
    s_add_u32 s50, s48, 49152
    buffer_load_dwordx4 v21, s[8:11], s50 offen offset:0 sc1 lds
    s_add_u32 m0, s49, 53248
    s_add_u32 s50, s48, 53248
    buffer_load_dwordx4 v21, s[8:11], s50 offen offset:0 sc1 lds
    s_add_u32 m0, s49, 57344
    s_add_u32 s50, s48, 57344
    buffer_load_dwordx4 v21, s[8:11], s50 offen offset:0 sc1 lds
    s_add_u32 m0, s49, 61440
    s_add_u32 s50, s48, 61440
    buffer_load_dwordx4 v21, s[8:11], s50 offen offset:0 sc1 lds
    s_waitcnt vmcnt(0)
.g2go_420:
    s_barrier
    ds_read_b128 v[32:35], v17 offset:0
    ds_read_b128 v[36:39], v18 offset:0
    ds_read_b128 v[40:43], v17 offset:1024
    ds_read_b128 v[44:47], v18 offset:1024
    ds_read_b128 v[48:51], v17 offset:2048
    ds_read_b128 v[52:55], v18 offset:2048
    s_add_u32 s53, s31, s69
    s_sub_u32 s55, s37, 0x10000
    s_add_u32 s61, s53, 3
    s_lshr_b32 s6, s53, 2
    s_and_b32 s4, s53, 3
    v_cmp_ge_u32 vcc, s6, v20
    s_lshl_b32 s4, s4, 3
    s_lshr_b32 s5, vcc_lo, s4
    s_and_b32 s5, s5, 0xff
    s_cmp_eq_u32 s5, 0

    s_cselect_b32 s56, 1, 0
    s_cmp_lt_u32 s53, 63
    s_cselect_b32 s56, s56, 0
    s_cmp_eq_u32 s56, 0
    s_cbranch_scc1 .g2nd_423
    s_lshr_b32 s6, s61, 2
    s_and_b32 s4, s61, 3
    v_cmp_ge_u32 vcc, s6, v20
    s_lshl_b32 s4, s4, 3
    s_lshr_b32 s5, vcc_lo, s4
    s_and_b32 s5, s5, 0xff
    s_cmp_eq_u32 s5, 0

    s_cbranch_scc1 .g2nf_422
    buffer_load_dword v20, v19, s[8:11], s33 offen sc1
    s_branch .g2pd_432
.g2nf_422:
    s_lshl_b32 s4, s61, 18
    buffer_load_dword v31, v111, s[8:11], s4 offen
.g2pd_432:
    s_lshl_b32 s48, s53, 18
    s_add_u32 s48, s48, s36
    s_add_u32 s49, s39, s35
    s_xor_b32 s39, s39, 0x10000

    s_waitcnt lgkmcnt(4)
    v_mfma_f32_16x16x32_bf16 v[64:67], a[0:3], v[32:35], 0
    ds_read_b128 v[56:59], v17 offset:3072
    s_add_u32 m0, s49, 0
    s_add_u32 s50, s48, 0
    v_mfma_f32_16x16x32_bf16 v[68:71], a[4:7], v[32:35], 0
    buffer_load_dwordx4 v21, s[8:11], s50 offen offset:0 sc1 lds
    v_mfma_f32_16x16x32_bf16 v[72:75], a[0:3], v[36:39], 0
    ds_read_b128 v[60:63], v18 offset:3072
    v_mfma_f32_16x16x32_bf16 v[76:79], a[4:7], v[36:39], 0
    s_waitcnt lgkmcnt(4)
    v_mfma_f32_16x16x32_bf16 v[64:67], a[8:11], v[40:43], v[64:67]
    ds_read_b128 v[32:35], v17 offset:8192
    v_mfma_f32_16x16x32_bf16 v[68:71], a[12:15], v[40:43], v[68:71]
    v_mfma_f32_16x16x32_bf16 v[72:75], a[8:11], v[44:47], v[72:75]
    ds_read_b128 v[36:39], v18 offset:8192
    s_add_u32 m0, s49, 4096
    s_add_u32 s50, s48, 4096
    v_mfma_f32_16x16x32_bf16 v[76:79], a[12:15], v[44:47], v[76:79]
    buffer_load_dwordx4 v21, s[8:11], s50 offen offset:0 sc1 lds
    s_waitcnt lgkmcnt(4)
    v_mfma_f32_16x16x32_bf16 v[64:67], a[16:19], v[48:51], v[64:67]
    ds_read_b128 v[40:43], v17 offset:9216
    v_mfma_f32_16x16x32_bf16 v[68:71], a[20:23], v[48:51], v[68:71]
    v_mfma_f32_16x16x32_bf16 v[72:75], a[16:19], v[52:55], v[72:75]
    ds_read_b128 v[44:47], v18 offset:9216
    v_mfma_f32_16x16x32_bf16 v[76:79], a[20:23], v[52:55], v[76:79]
    s_waitcnt lgkmcnt(4)
    v_mfma_f32_16x16x32_bf16 v[64:67], a[24:27], v[56:59], v[64:67]
    ds_read_b128 v[48:51], v17 offset:10240
    s_add_u32 m0, s49, 8192
    s_add_u32 s50, s48, 8192
    v_mfma_f32_16x16x32_bf16 v[68:71], a[28:31], v[56:59], v[68:71]
    buffer_load_dwordx4 v21, s[8:11], s50 offen offset:0 sc1 lds
    v_mfma_f32_16x16x32_bf16 v[72:75], a[24:27], v[60:63], v[72:75]
    ds_read_b128 v[52:55], v18 offset:10240
    v_mfma_f32_16x16x32_bf16 v[76:79], a[28:31], v[60:63], v[76:79]
    s_waitcnt lgkmcnt(4)
    v_mfma_f32_16x16x32_bf16 v[64:67], a[32:35], v[32:35], v[64:67]
    ds_read_b128 v[56:59], v17 offset:11264
    v_mfma_f32_16x16x32_bf16 v[68:71], a[36:39], v[32:35], v[68:71]
    v_mfma_f32_16x16x32_bf16 v[72:75], a[32:35], v[36:39], v[72:75]
    ds_read_b128 v[60:63], v18 offset:11264
    s_add_u32 m0, s49, 12288
    s_add_u32 s50, s48, 12288
    v_mfma_f32_16x16x32_bf16 v[76:79], a[36:39], v[36:39], v[76:79]
    buffer_load_dwordx4 v21, s[8:11], s50 offen offset:0 sc1 lds
    s_waitcnt lgkmcnt(4)
    v_mfma_f32_16x16x32_bf16 v[64:67], a[40:43], v[40:43], v[64:67]
    s_barrier
    ds_read_b128 v[32:35], v17 offset:16384
    v_mfma_f32_16x16x32_bf16 v[68:71], a[44:47], v[40:43], v[68:71]
    v_mfma_f32_16x16x32_bf16 v[72:75], a[40:43], v[44:47], v[72:75]
    ds_read_b128 v[36:39], v18 offset:16384
    v_mfma_f32_16x16x32_bf16 v[76:79], a[44:47], v[44:47], v[76:79]
    s_waitcnt lgkmcnt(4)
    v_mfma_f32_16x16x32_bf16 v[64:67], a[48:51], v[48:51], v[64:67]
    ds_read_b128 v[40:43], v17 offset:17408
    s_add_u32 m0, s49, 16384
    s_add_u32 s50, s48, 16384
    v_mfma_f32_16x16x32_bf16 v[68:71], a[52:55], v[48:51], v[68:71]
    buffer_load_dwordx4 v21, s[8:11], s50 offen offset:0 sc1 lds
    v_mfma_f32_16x16x32_bf16 v[72:75], a[48:51], v[52:55], v[72:75]
    ds_read_b128 v[44:47], v18 offset:17408
    v_mfma_f32_16x16x32_bf16 v[76:79], a[52:55], v[52:55], v[76:79]
    s_waitcnt lgkmcnt(4)
    v_mfma_f32_16x16x32_bf16 v[64:67], a[56:59], v[56:59], v[64:67]
    ds_read_b128 v[48:51], v17 offset:18432
    v_mfma_f32_16x16x32_bf16 v[68:71], a[60:63], v[56:59], v[68:71]
    v_mfma_f32_16x16x32_bf16 v[72:75], a[56:59], v[60:63], v[72:75]
    ds_read_b128 v[52:55], v18 offset:18432
    s_add_u32 m0, s49, 20480
    s_add_u32 s50, s48, 20480
    v_mfma_f32_16x16x32_bf16 v[76:79], a[60:63], v[60:63], v[76:79]
    buffer_load_dwordx4 v21, s[8:11], s50 offen offset:0 sc1 lds
    s_waitcnt lgkmcnt(4)
    v_mfma_f32_16x16x32_bf16 v[64:67], a[64:67], v[32:35], v[64:67]
    ds_read_b128 v[56:59], v17 offset:19456
    v_mfma_f32_16x16x32_bf16 v[68:71], a[68:71], v[32:35], v[68:71]
    v_mfma_f32_16x16x32_bf16 v[72:75], a[64:67], v[36:39], v[72:75]
    ds_read_b128 v[60:63], v18 offset:19456
    v_mfma_f32_16x16x32_bf16 v[76:79], a[68:71], v[36:39], v[76:79]
    s_waitcnt lgkmcnt(4)
    v_mfma_f32_16x16x32_bf16 v[64:67], a[72:75], v[40:43], v[64:67]
    ds_read_b128 v[32:35], v17 offset:24576
    s_add_u32 m0, s49, 24576
    s_add_u32 s50, s48, 24576
    v_mfma_f32_16x16x32_bf16 v[68:71], a[76:79], v[40:43], v[68:71]
    buffer_load_dwordx4 v21, s[8:11], s50 offen offset:0 sc1 lds
    v_mfma_f32_16x16x32_bf16 v[72:75], a[72:75], v[44:47], v[72:75]
    ds_read_b128 v[36:39], v18 offset:24576
    v_mfma_f32_16x16x32_bf16 v[76:79], a[76:79], v[44:47], v[76:79]
    s_waitcnt lgkmcnt(4)
    v_mfma_f32_16x16x32_bf16 v[64:67], a[80:83], v[48:51], v[64:67]
    ds_read_b128 v[40:43], v17 offset:25600
    v_mfma_f32_16x16x32_bf16 v[68:71], a[84:87], v[48:51], v[68:71]
    s_waitcnt vmcnt(11)
    v_mfma_f32_16x16x32_bf16 v[72:75], a[80:83], v[52:55], v[72:75]
    ds_read_b128 v[44:47], v18 offset:25600
    s_add_u32 m0, s49, 28672
    s_add_u32 s50, s48, 28672
    v_mfma_f32_16x16x32_bf16 v[76:79], a[84:87], v[52:55], v[76:79]
    buffer_load_dwordx4 v21, s[8:11], s50 offen offset:0 sc1 lds
    s_mov_b32 s62, 0
.cc_433:
    v_max3_u32 v4, v84, v88, v92
    v_cmp_eq_u32 vcc, -1, v4
    s_and_b64 vcc, vcc, s[64:65]
    s_cbranch_vccnz .cf_434
    s_waitcnt lgkmcnt(4)
    v_mfma_f32_16x16x32_bf16 v[64:67], a[88:91], v[56:59], v[64:67]
    ds_read_b128 v[48:51], v17 offset:26624
    v_mfma_f32_16x16x32_bf16 v[68:71], a[92:95], v[56:59], v[68:71]
    v_add_f32 v84, v84, v88
    v_add_f32 v92, v112, v92
    v_mfma_f32_16x16x32_bf16 v[72:75], a[88:91], v[60:63], v[72:75]
    ds_read_b128 v[52:55], v18 offset:26624
    v_mfma_f32_16x16x32_bf16 v[76:79], a[92:95], v[60:63], v[76:79]
    v_add_f32 v85, v85, v89
    v_add_f32 v93, v113, v93
    s_waitcnt lgkmcnt(4)
    v_mfma_f32_16x16x32_bf16 v[64:67], a[96:99], v[32:35], v[64:67]
    ds_read_b128 v[56:59], v17 offset:27648
    s_add_u32 m0, s49, 32768
    s_add_u32 s50, s48, 32768
    v_mfma_f32_16x16x32_bf16 v[68:71], a[100:103], v[32:35], v[68:71]
    buffer_load_dwordx4 v21, s[8:11], s50 offen offset:0 sc1 lds
    v_add_f32 v86, v86, v90
    v_add_f32 v94, v114, v94
    v_mfma_f32_16x16x32_bf16 v[72:75], a[96:99], v[36:39], v[72:75]
    ds_read_b128 v[60:63], v18 offset:27648
    v_mfma_f32_16x16x32_bf16 v[76:79], a[100:103], v[36:39], v[76:79]
    v_add_f32 v87, v87, v91
    v_add_f32 v95, v115, v95
    s_waitcnt lgkmcnt(4)
    v_mfma_f32_16x16x32_bf16 v[64:67], a[104:107], v[40:43], v[64:67]
    s_barrier
    ds_read_b128 v[32:35], v17 offset:32768
    v_mfma_f32_16x16x32_bf16 v[68:71], a[108:111], v[40:43], v[68:71]
    v_add_f32 v84, v92, v84
    v_add_f32 v85, v93, v85
    v_mfma_f32_16x16x32_bf16 v[72:75], a[104:107], v[44:47], v[72:75]
    ds_read_b128 v[36:39], v18 offset:32768
    s_add_u32 m0, s49, 36864
    s_add_u32 s50, s48, 36864
    v_mfma_f32_16x16x32_bf16 v[76:79], a[108:111], v[44:47], v[76:79]
    buffer_load_dwordx4 v21, s[8:11], s50 offen offset:0 sc1 lds
    v_add_f32 v86, v94, v86
    v_add_f32 v87, v95, v87
    s_waitcnt lgkmcnt(4)
    v_mfma_f32_16x16x32_bf16 v[64:67], a[112:115], v[48:51], v[64:67]
    ds_read_b128 v[40:43], v17 offset:33792
    v_mfma_f32_16x16x32_bf16 v[68:71], a[116:119], v[48:51], v[68:71]
    v_sub_f32 v104, 1.0, v100
    v_cvt_pk_bf16_f32 v104, v104, v104
    v_mfma_f32_16x16x32_bf16 v[72:75], a[112:115], v[52:55], v[72:75]
    ds_read_b128 v[44:47], v18 offset:33792
    v_mfma_f32_16x16x32_bf16 v[76:79], a[116:119], v[52:55], v[76:79]
    v_lshlrev_b32 v104, 16, v104
    v_cvt_pk_bf16_f32 v105, v84, v85
    s_waitcnt lgkmcnt(4)
    v_mfma_f32_16x16x32_bf16 v[64:67], a[120:123], v[56:59], v[64:67]
    ds_read_b128 v[48:51], v17 offset:34816
    s_add_u32 m0, s49, 40960
    s_add_u32 s50, s48, 40960
    v_mfma_f32_16x16x32_bf16 v[68:71], a[124:127], v[56:59], v[68:71]
    buffer_load_dwordx4 v21, s[8:11], s50 offen offset:0 sc1 lds
    v_lshlrev_b32 v107, 16, v96
    v_and_b32 v108, 0xffff0000, v96
    v_mfma_f32_16x16x32_bf16 v[72:75], a[120:123], v[60:63], v[72:75]
    ds_read_b128 v[52:55], v18 offset:34816
    v_mfma_f32_16x16x32_bf16 v[76:79], a[124:127], v[60:63], v[76:79]
    v_lshlrev_b32 v109, 16, v98
    v_and_b32 v110, 0xffff0000, v98
    s_waitcnt lgkmcnt(4)
    v_mfma_f32_16x16x32_bf16 v[64:67], a[128:131], v[32:35], v[64:67]
    ds_read_b128 v[56:59], v17 offset:35840
    v_mfma_f32_16x16x32_bf16 v[68:71], a[132:135], v[32:35], v[68:71]
    v_and_b32 v106, 0xffff0000, v105
    v_lshlrev_b32 v105, 16, v105
    v_mfma_f32_16x16x32_bf16 v[72:75], a[128:131], v[36:39], v[72:75]
    ds_read_b128 v[60:63], v18 offset:35840
    s_add_u32 m0, s49, 45056
    s_add_u32 s50, s48, 45056
    v_mfma_f32_16x16x32_bf16 v[76:79], a[132:135], v[36:39], v[76:79]
    buffer_load_dwordx4 v21, s[8:11], s50 offen offset:0 sc1 lds
    v_mul_f32 v107, v107, v109
    v_mul_f32 v108, v108, v110
    s_waitcnt lgkmcnt(4)
    v_mfma_f32_16x16x32_bf16 v[64:67], a[136:139], v[40:43], v[64:67]
    ds_read_b128 v[32:35], v17 offset:40960
    v_mfma_f32_16x16x32_bf16 v[68:71], a[140:143], v[40:43], v[68:71]
    v_mul_f32 v105, v104, v105
    v_mul_f32 v106, v104, v106
    v_mfma_f32_16x16x32_bf16 v[72:75], a[136:139], v[44:47], v[72:75]
    ds_read_b128 v[36:39], v18 offset:40960
    v_mfma_f32_16x16x32_bf16 v[76:79], a[140:143], v[44:47], v[76:79]
    v_cvt_pk_bf16_f32 v107, v107, v108
    v_cvt_pk_bf16_f32 v105, v105, v106
    s_waitcnt lgkmcnt(4)
    v_mfma_f32_16x16x32_bf16 v[64:67], a[144:147], v[48:51], v[64:67]
    ds_read_b128 v[40:43], v17 offset:41984
    s_add_u32 m0, s49, 49152
    s_add_u32 s50, s48, 49152
    v_mfma_f32_16x16x32_bf16 v[68:71], a[148:151], v[48:51], v[68:71]
    buffer_load_dwordx4 v21, s[8:11], s50 offen offset:0 sc1 lds
    v_and_b32 v108, 0xffff0000, v107
    v_lshlrev_b32 v107, 16, v107
    v_mfma_f32_16x16x32_bf16 v[72:75], a[144:147], v[52:55], v[72:75]
    ds_read_b128 v[44:47], v18 offset:41984
    v_mfma_f32_16x16x32_bf16 v[76:79], a[148:151], v[52:55], v[76:79]
    v_and_b32 v106, 0xffff0000, v105
    v_lshlrev_b32 v105, 16, v105
    s_waitcnt lgkmcnt(4)
    v_mfma_f32_16x16x32_bf16 v[64:67], a[152:155], v[56:59], v[64:67]
    ds_read_b128 v[48:51], v17 offset:43008
    v_mfma_f32_16x16x32_bf16 v[68:71], a[156:159], v[56:59], v[68:71]
    v_mul_f32 v107, v100, v107
    v_mul_f32 v108, v100, v108
    v_mfma_f32_16x16x32_bf16 v[72:75], a[152:155], v[60:63], v[72:75]
    ds_read_b128 v[52:55], v18 offset:43008
    s_add_u32 m0, s49, 53248
    s_add_u32 s50, s48, 53248
    v_mfma_f32_16x16x32_bf16 v[76:79], a[156:159], v[60:63], v[76:79]
    buffer_load_dwordx4 v21, s[8:11], s50 offen offset:0 sc1 lds
    v_cvt_pk_bf16_f32 v107, v107, v108
    v_and_b32 v108, 0xffff0000, v107
    s_waitcnt lgkmcnt(4)
    v_mfma_f32_16x16x32_bf16 v[64:67], a[160:163], v[32:35], v[64:67]
    ds_read_b128 v[56:59], v17 offset:44032
    v_mfma_f32_16x16x32_bf16 v[68:71], a[164:167], v[32:35], v[68:71]
    v_lshlrev_b32 v107, 16, v107
    v_add_f32 v105, v105, v107
    v_mfma_f32_16x16x32_bf16 v[72:75], a[160:163], v[36:39], v[72:75]
    ds_read_b128 v[60:63], v18 offset:44032
    v_mfma_f32_16x16x32_bf16 v[76:79], a[164:167], v[36:39], v[76:79]
    v_add_f32 v106, v106, v108
    v_cvt_pk_bf16_f32 v102, v105, v106
    s_waitcnt lgkmcnt(4)
    v_mfma_f32_16x16x32_bf16 v[64:67], a[168:171], v[40:43], v[64:67]
    s_barrier
    ds_read_b128 v[32:35], v17 offset:49152
    s_add_u32 m0, s49, 57344
    s_add_u32 s50, s48, 57344
    v_mfma_f32_16x16x32_bf16 v[68:71], a[172:175], v[40:43], v[68:71]
    buffer_load_dwordx4 v21, s[8:11], s50 offen offset:0 sc1 lds
    v_cvt_pk_bf16_f32 v105, v86, v87
    v_lshlrev_b32 v107, 16, v97
    v_mfma_f32_16x16x32_bf16 v[72:75], a[168:171], v[44:47], v[72:75]
    ds_read_b128 v[36:39], v18 offset:49152
    v_mfma_f32_16x16x32_bf16 v[76:79], a[172:175], v[44:47], v[76:79]
    v_and_b32 v108, 0xffff0000, v97
    v_lshlrev_b32 v109, 16, v99
    s_waitcnt lgkmcnt(4)
    v_mfma_f32_16x16x32_bf16 v[64:67], a[176:179], v[48:51], v[64:67]
    ds_read_b128 v[40:43], v17 offset:50176
    v_mfma_f32_16x16x32_bf16 v[68:71], a[180:183], v[48:51], v[68:71]
    v_and_b32 v110, 0xffff0000, v99
    v_and_b32 v106, 0xffff0000, v105
    v_mfma_f32_16x16x32_bf16 v[72:75], a[176:179], v[52:55], v[72:75]
    ds_read_b128 v[44:47], v18 offset:50176
    s_add_u32 m0, s49, 61440
    s_add_u32 s50, s48, 61440
    v_mfma_f32_16x16x32_bf16 v[76:79], a[180:183], v[52:55], v[76:79]
    buffer_load_dwordx4 v21, s[8:11], s50 offen offset:0 sc1 lds
    v_lshlrev_b32 v105, 16, v105
    v_mul_f32 v107, v107, v109
    s_waitcnt lgkmcnt(4)
    v_mfma_f32_16x16x32_bf16 v[64:67], a[184:187], v[56:59], v[64:67]
    ds_read_b128 v[48:51], v17 offset:51200
    v_mfma_f32_16x16x32_bf16 v[68:71], a[188:191], v[56:59], v[68:71]
    v_mul_f32 v108, v108, v110
    v_mul_f32 v105, v104, v105
    v_mfma_f32_16x16x32_bf16 v[72:75], a[184:187], v[60:63], v[72:75]
    ds_read_b128 v[52:55], v18 offset:51200
    v_mfma_f32_16x16x32_bf16 v[76:79], a[188:191], v[60:63], v[76:79]
    v_mul_f32 v106, v104, v106
    v_cvt_pk_bf16_f32 v107, v107, v108
    s_waitcnt lgkmcnt(4)
    v_mfma_f32_16x16x32_bf16 v[64:67], a[192:195], v[32:35], v[64:67]
    ds_read_b128 v[56:59], v17 offset:52224
    v_mfma_f32_16x16x32_bf16 v[68:71], a[196:199], v[32:35], v[68:71]
    v_cvt_pk_bf16_f32 v105, v105, v106
    v_and_b32 v108, 0xffff0000, v107
    v_mfma_f32_16x16x32_bf16 v[72:75], a[192:195], v[36:39], v[72:75]
    ds_read_b128 v[60:63], v18 offset:52224
    v_mfma_f32_16x16x32_bf16 v[76:79], a[196:199], v[36:39], v[76:79]
    v_lshlrev_b32 v107, 16, v107
    v_and_b32 v106, 0xffff0000, v105
    s_waitcnt lgkmcnt(4)
    v_mfma_f32_16x16x32_bf16 v[64:67], a[200:203], v[40:43], v[64:67]
    ds_read_b128 v[32:35], v17 offset:57344
    v_mfma_f32_16x16x32_bf16 v[68:71], a[204:207], v[40:43], v[68:71]
    v_lshlrev_b32 v105, 16, v105
    v_mul_f32 v107, v100, v107
    v_mfma_f32_16x16x32_bf16 v[72:75], a[200:203], v[44:47], v[72:75]
    ds_read_b128 v[36:39], v18 offset:57344
    v_mfma_f32_16x16x32_bf16 v[76:79], a[204:207], v[44:47], v[76:79]
    v_mul_f32 v108, v100, v108
    v_cvt_pk_bf16_f32 v107, v107, v108
    s_waitcnt lgkmcnt(4)
    v_mfma_f32_16x16x32_bf16 v[64:67], a[208:211], v[48:51], v[64:67]
    ds_read_b128 v[40:43], v17 offset:58368
    v_mfma_f32_16x16x32_bf16 v[68:71], a[212:215], v[48:51], v[68:71]
    v_and_b32 v108, 0xffff0000, v107
    v_lshlrev_b32 v107, 16, v107
    v_mfma_f32_16x16x32_bf16 v[72:75], a[208:211], v[52:55], v[72:75]
    ds_read_b128 v[44:47], v18 offset:58368
    v_mfma_f32_16x16x32_bf16 v[76:79], a[212:215], v[52:55], v[76:79]
    v_add_f32 v105, v105, v107
    v_add_f32 v106, v106, v108
    s_waitcnt lgkmcnt(4)
    v_mfma_f32_16x16x32_bf16 v[64:67], a[216:219], v[56:59], v[64:67]
    ds_read_b128 v[48:51], v17 offset:59392
    v_mfma_f32_16x16x32_bf16 v[68:71], a[220:223], v[56:59], v[68:71]
    v_cvt_pk_bf16_f32 v103, v105, v106
    s_mov_b64 exec, s[64:65]
    buffer_store_dwordx2 v[102:103], v22, s[44:47], s52 offen
    s_mov_b64 exec, -1
    v_mfma_f32_16x16x32_bf16 v[72:75], a[216:219], v[60:63], v[72:75]
    ds_read_b128 v[52:55], v18 offset:59392
    v_mfma_f32_16x16x32_bf16 v[76:79], a[220:223], v[60:63], v[76:79]
    s_add_u32 s51, s34, s55
    s_lshl_b32 s52, s54, 16
    s_lshl_b32 s60, s54, 7
    s_add_u32 s58, s60, 117440512
    s_add_u32 s59, s60, 117448704
    s_add_u32 s60, s60, 121634816

    s_cmp_eq_u32 s38, 0
    s_waitcnt lgkmcnt(4)
    v_mfma_f32_16x16x32_bf16 v[64:67], a[224:227], v[32:35], v[64:67]
    ds_read_b128 v[56:59], v17 offset:60416
    v_mfma_f32_16x16x32_bf16 v[68:71], a[228:231], v[32:35], v[68:71]
    s_cbranch_scc1 .cs_435
    buffer_load_dwordx2 v[96:97], v22, s[16:19], s52 offen
.cs_435:
    v_mfma_f32_16x16x32_bf16 v[72:75], a[224:227], v[36:39], v[72:75]
    ds_read_b128 v[60:63], v18 offset:60416
    v_mfma_f32_16x16x32_bf16 v[76:79], a[228:231], v[36:39], v[76:79]
    s_cbranch_scc1 .cs_436
    buffer_load_dword v98, v23, s[8:11], s58 offen
.cs_436:
    s_waitcnt lgkmcnt(4)
    v_mfma_f32_16x16x32_bf16 v[64:67], a[232:235], v[40:43], v[64:67]
    v_mfma_f32_16x16x32_bf16 v[68:71], a[236:239], v[40:43], v[68:71]
    s_cbranch_scc1 .cs_437
    buffer_load_dword v99, v23, s[8:11], s59 offen
.cs_437:
    v_mfma_f32_16x16x32_bf16 v[72:75], a[232:235], v[44:47], v[72:75]
    v_mfma_f32_16x16x32_bf16 v[76:79], a[236:239], v[44:47], v[76:79]
    s_cbranch_scc1 .cs_438
    buffer_load_dword v100, v16, s[8:11], s60 offen
.cs_438:
    s_waitcnt lgkmcnt(2)
    v_mfma_f32_16x16x32_bf16 v[64:67], a[240:243], v[48:51], v[64:67]
    v_mfma_f32_16x16x32_bf16 v[68:71], a[244:247], v[48:51], v[68:71]
    s_cbranch_scc1 .cs_439
    buffer_load_dwordx4 v[84:87], v7, s[8:11], s51 offen sc1
.cs_439:
    v_mfma_f32_16x16x32_bf16 v[72:75], a[240:243], v[52:55], v[72:75]
    v_mfma_f32_16x16x32_bf16 v[76:79], a[244:247], v[52:55], v[76:79]
    s_cbranch_scc1 .cs_440
    buffer_load_dwordx4 v[88:91], v8, s[8:11], s51 offen sc1
.cs_440:
    s_waitcnt lgkmcnt(0)
    v_mfma_f32_16x16x32_bf16 v[64:67], a[248:251], v[56:59], v[64:67]
    v_mfma_f32_16x16x32_bf16 v[68:71], a[252:255], v[56:59], v[68:71]
    s_cbranch_scc1 .cs_441
    buffer_load_dwordx4 v[92:95], v9, s[8:11], s51 offen sc1
.cs_441:
    v_mfma_f32_16x16x32_bf16 v[72:75], a[248:251], v[60:63], v[72:75]
    v_mfma_f32_16x16x32_bf16 v[76:79], a[252:255], v[60:63], v[76:79]
    v_xor_b32 v17, 0x10000, v17
    v_xor_b32 v18, 0x10000, v18
    s_cselect_b64 s[64:65], 0, -1
    s_add_u32 s4, s34, s37

    v_mov_b32 v112, v80
    v_mov_b32 v113, v81
    v_mov_b32 v114, v82
    v_mov_b32 v115, v83
    s_branch .g2st_424
.g2nd_423:
    s_waitcnt lgkmcnt(4)
    v_mfma_f32_16x16x32_bf16 v[64:67], a[0:3], v[32:35], 0
    ds_read_b128 v[56:59], v17 offset:3072
    v_mfma_f32_16x16x32_bf16 v[68:71], a[4:7], v[32:35], 0
    v_mfma_f32_16x16x32_bf16 v[72:75], a[0:3], v[36:39], 0
    ds_read_b128 v[60:63], v18 offset:3072
    v_mfma_f32_16x16x32_bf16 v[76:79], a[4:7], v[36:39], 0
    s_waitcnt lgkmcnt(4)
    v_mfma_f32_16x16x32_bf16 v[64:67], a[8:11], v[40:43], v[64:67]
    ds_read_b128 v[32:35], v17 offset:8192
    v_mfma_f32_16x16x32_bf16 v[68:71], a[12:15], v[40:43], v[68:71]
    v_mfma_f32_16x16x32_bf16 v[72:75], a[8:11], v[44:47], v[72:75]
    ds_read_b128 v[36:39], v18 offset:8192
    v_mfma_f32_16x16x32_bf16 v[76:79], a[12:15], v[44:47], v[76:79]
    s_waitcnt lgkmcnt(4)
    v_mfma_f32_16x16x32_bf16 v[64:67], a[16:19], v[48:51], v[64:67]
    ds_read_b128 v[40:43], v17 offset:9216
    v_mfma_f32_16x16x32_bf16 v[68:71], a[20:23], v[48:51], v[68:71]
    v_mfma_f32_16x16x32_bf16 v[72:75], a[16:19], v[52:55], v[72:75]
    ds_read_b128 v[44:47], v18 offset:9216
    v_mfma_f32_16x16x32_bf16 v[76:79], a[20:23], v[52:55], v[76:79]
    s_waitcnt lgkmcnt(4)
    v_mfma_f32_16x16x32_bf16 v[64:67], a[24:27], v[56:59], v[64:67]
    ds_read_b128 v[48:51], v17 offset:10240
    v_mfma_f32_16x16x32_bf16 v[68:71], a[28:31], v[56:59], v[68:71]
    v_mfma_f32_16x16x32_bf16 v[72:75], a[24:27], v[60:63], v[72:75]
    ds_read_b128 v[52:55], v18 offset:10240
    v_mfma_f32_16x16x32_bf16 v[76:79], a[28:31], v[60:63], v[76:79]
    s_waitcnt lgkmcnt(4)
    v_mfma_f32_16x16x32_bf16 v[64:67], a[32:35], v[32:35], v[64:67]
    ds_read_b128 v[56:59], v17 offset:11264
    v_mfma_f32_16x16x32_bf16 v[68:71], a[36:39], v[32:35], v[68:71]
    v_mfma_f32_16x16x32_bf16 v[72:75], a[32:35], v[36:39], v[72:75]
    ds_read_b128 v[60:63], v18 offset:11264
    v_mfma_f32_16x16x32_bf16 v[76:79], a[36:39], v[36:39], v[76:79]
    s_waitcnt lgkmcnt(4)
    v_mfma_f32_16x16x32_bf16 v[64:67], a[40:43], v[40:43], v[64:67]
    s_barrier
    ds_read_b128 v[32:35], v17 offset:16384
    v_mfma_f32_16x16x32_bf16 v[68:71], a[44:47], v[40:43], v[68:71]
    v_mfma_f32_16x16x32_bf16 v[72:75], a[40:43], v[44:47], v[72:75]
    ds_read_b128 v[36:39], v18 offset:16384
    v_mfma_f32_16x16x32_bf16 v[76:79], a[44:47], v[44:47], v[76:79]
    s_waitcnt lgkmcnt(4)
    v_mfma_f32_16x16x32_bf16 v[64:67], a[48:51], v[48:51], v[64:67]
    ds_read_b128 v[40:43], v17 offset:17408
    v_mfma_f32_16x16x32_bf16 v[68:71], a[52:55], v[48:51], v[68:71]
    v_mfma_f32_16x16x32_bf16 v[72:75], a[48:51], v[52:55], v[72:75]
    ds_read_b128 v[44:47], v18 offset:17408
    v_mfma_f32_16x16x32_bf16 v[76:79], a[52:55], v[52:55], v[76:79]
    s_waitcnt lgkmcnt(4)
    v_mfma_f32_16x16x32_bf16 v[64:67], a[56:59], v[56:59], v[64:67]
    ds_read_b128 v[48:51], v17 offset:18432
    v_mfma_f32_16x16x32_bf16 v[68:71], a[60:63], v[56:59], v[68:71]
    v_mfma_f32_16x16x32_bf16 v[72:75], a[56:59], v[60:63], v[72:75]
    ds_read_b128 v[52:55], v18 offset:18432
    v_mfma_f32_16x16x32_bf16 v[76:79], a[60:63], v[60:63], v[76:79]
    s_waitcnt lgkmcnt(4)
    v_mfma_f32_16x16x32_bf16 v[64:67], a[64:67], v[32:35], v[64:67]
    ds_read_b128 v[56:59], v17 offset:19456
    v_mfma_f32_16x16x32_bf16 v[68:71], a[68:71], v[32:35], v[68:71]
    v_mfma_f32_16x16x32_bf16 v[72:75], a[64:67], v[36:39], v[72:75]
    ds_read_b128 v[60:63], v18 offset:19456
    v_mfma_f32_16x16x32_bf16 v[76:79], a[68:71], v[36:39], v[76:79]
    s_waitcnt lgkmcnt(4)
    v_mfma_f32_16x16x32_bf16 v[64:67], a[72:75], v[40:43], v[64:67]
    ds_read_b128 v[32:35], v17 offset:24576
    v_mfma_f32_16x16x32_bf16 v[68:71], a[76:79], v[40:43], v[68:71]
    v_mfma_f32_16x16x32_bf16 v[72:75], a[72:75], v[44:47], v[72:75]
    ds_read_b128 v[36:39], v18 offset:24576
    v_mfma_f32_16x16x32_bf16 v[76:79], a[76:79], v[44:47], v[76:79]
    s_waitcnt lgkmcnt(4)
    v_mfma_f32_16x16x32_bf16 v[64:67], a[80:83], v[48:51], v[64:67]
    ds_read_b128 v[40:43], v17 offset:25600
    v_mfma_f32_16x16x32_bf16 v[68:71], a[84:87], v[48:51], v[68:71]
    s_waitcnt vmcnt(3)
    v_mfma_f32_16x16x32_bf16 v[72:75], a[80:83], v[52:55], v[72:75]
    ds_read_b128 v[44:47], v18 offset:25600
    v_mfma_f32_16x16x32_bf16 v[76:79], a[84:87], v[52:55], v[76:79]
    s_mov_b32 s62, 0
.cc_442:
    v_max3_u32 v4, v84, v88, v92
    v_cmp_eq_u32 vcc, -1, v4
    s_and_b64 vcc, vcc, s[64:65]
    s_cbranch_vccnz .cf_443
    s_waitcnt lgkmcnt(4)
    v_mfma_f32_16x16x32_bf16 v[64:67], a[88:91], v[56:59], v[64:67]
    ds_read_b128 v[48:51], v17 offset:26624
    v_mfma_f32_16x16x32_bf16 v[68:71], a[92:95], v[56:59], v[68:71]
    v_add_f32 v84, v84, v88
    v_add_f32 v92, v112, v92
    v_mfma_f32_16x16x32_bf16 v[72:75], a[88:91], v[60:63], v[72:75]
    ds_read_b128 v[52:55], v18 offset:26624
    v_mfma_f32_16x16x32_bf16 v[76:79], a[92:95], v[60:63], v[76:79]
    v_add_f32 v85, v85, v89
    v_add_f32 v93, v113, v93
    s_waitcnt lgkmcnt(4)
    v_mfma_f32_16x16x32_bf16 v[64:67], a[96:99], v[32:35], v[64:67]
    ds_read_b128 v[56:59], v17 offset:27648
    v_mfma_f32_16x16x32_bf16 v[68:71], a[100:103], v[32:35], v[68:71]
    v_add_f32 v86, v86, v90
    v_add_f32 v94, v114, v94
    v_mfma_f32_16x16x32_bf16 v[72:75], a[96:99], v[36:39], v[72:75]
    ds_read_b128 v[60:63], v18 offset:27648
    v_mfma_f32_16x16x32_bf16 v[76:79], a[100:103], v[36:39], v[76:79]
    v_add_f32 v87, v87, v91
    v_add_f32 v95, v115, v95
    s_waitcnt lgkmcnt(4)
    v_mfma_f32_16x16x32_bf16 v[64:67], a[104:107], v[40:43], v[64:67]
    s_barrier
    ds_read_b128 v[32:35], v17 offset:32768
    v_mfma_f32_16x16x32_bf16 v[68:71], a[108:111], v[40:43], v[68:71]
    v_add_f32 v84, v92, v84
    v_add_f32 v85, v93, v85
    v_mfma_f32_16x16x32_bf16 v[72:75], a[104:107], v[44:47], v[72:75]
    ds_read_b128 v[36:39], v18 offset:32768
    v_mfma_f32_16x16x32_bf16 v[76:79], a[108:111], v[44:47], v[76:79]
    v_add_f32 v86, v94, v86
    v_add_f32 v87, v95, v87
    s_waitcnt lgkmcnt(4)
    v_mfma_f32_16x16x32_bf16 v[64:67], a[112:115], v[48:51], v[64:67]
    ds_read_b128 v[40:43], v17 offset:33792
    v_mfma_f32_16x16x32_bf16 v[68:71], a[116:119], v[48:51], v[68:71]
    v_sub_f32 v104, 1.0, v100
    v_cvt_pk_bf16_f32 v104, v104, v104
    v_mfma_f32_16x16x32_bf16 v[72:75], a[112:115], v[52:55], v[72:75]
    ds_read_b128 v[44:47], v18 offset:33792
    v_mfma_f32_16x16x32_bf16 v[76:79], a[116:119], v[52:55], v[76:79]
    v_lshlrev_b32 v104, 16, v104
    v_cvt_pk_bf16_f32 v105, v84, v85
    s_waitcnt lgkmcnt(4)
    v_mfma_f32_16x16x32_bf16 v[64:67], a[120:123], v[56:59], v[64:67]
    ds_read_b128 v[48:51], v17 offset:34816
    v_mfma_f32_16x16x32_bf16 v[68:71], a[124:127], v[56:59], v[68:71]
    v_lshlrev_b32 v107, 16, v96
    v_and_b32 v108, 0xffff0000, v96
    v_mfma_f32_16x16x32_bf16 v[72:75], a[120:123], v[60:63], v[72:75]
    ds_read_b128 v[52:55], v18 offset:34816
    v_mfma_f32_16x16x32_bf16 v[76:79], a[124:127], v[60:63], v[76:79]
    v_lshlrev_b32 v109, 16, v98
    v_and_b32 v110, 0xffff0000, v98
    s_waitcnt lgkmcnt(4)
    v_mfma_f32_16x16x32_bf16 v[64:67], a[128:131], v[32:35], v[64:67]
    ds_read_b128 v[56:59], v17 offset:35840
    v_mfma_f32_16x16x32_bf16 v[68:71], a[132:135], v[32:35], v[68:71]
    v_and_b32 v106, 0xffff0000, v105
    v_lshlrev_b32 v105, 16, v105
    v_mfma_f32_16x16x32_bf16 v[72:75], a[128:131], v[36:39], v[72:75]
    ds_read_b128 v[60:63], v18 offset:35840
    v_mfma_f32_16x16x32_bf16 v[76:79], a[132:135], v[36:39], v[76:79]
    v_mul_f32 v107, v107, v109
    v_mul_f32 v108, v108, v110
    s_waitcnt lgkmcnt(4)
    v_mfma_f32_16x16x32_bf16 v[64:67], a[136:139], v[40:43], v[64:67]
    ds_read_b128 v[32:35], v17 offset:40960
    v_mfma_f32_16x16x32_bf16 v[68:71], a[140:143], v[40:43], v[68:71]
    v_mul_f32 v105, v104, v105
    v_mul_f32 v106, v104, v106
    v_mfma_f32_16x16x32_bf16 v[72:75], a[136:139], v[44:47], v[72:75]
    ds_read_b128 v[36:39], v18 offset:40960
    v_mfma_f32_16x16x32_bf16 v[76:79], a[140:143], v[44:47], v[76:79]
    v_cvt_pk_bf16_f32 v107, v107, v108
    v_cvt_pk_bf16_f32 v105, v105, v106
    s_waitcnt lgkmcnt(4)
    v_mfma_f32_16x16x32_bf16 v[64:67], a[144:147], v[48:51], v[64:67]
    ds_read_b128 v[40:43], v17 offset:41984
    v_mfma_f32_16x16x32_bf16 v[68:71], a[148:151], v[48:51], v[68:71]
    v_and_b32 v108, 0xffff0000, v107
    v_lshlrev_b32 v107, 16, v107
    v_mfma_f32_16x16x32_bf16 v[72:75], a[144:147], v[52:55], v[72:75]
    ds_read_b128 v[44:47], v18 offset:41984
    v_mfma_f32_16x16x32_bf16 v[76:79], a[148:151], v[52:55], v[76:79]
    v_and_b32 v106, 0xffff0000, v105
    v_lshlrev_b32 v105, 16, v105
    s_waitcnt lgkmcnt(4)
    v_mfma_f32_16x16x32_bf16 v[64:67], a[152:155], v[56:59], v[64:67]
    ds_read_b128 v[48:51], v17 offset:43008
    v_mfma_f32_16x16x32_bf16 v[68:71], a[156:159], v[56:59], v[68:71]
    v_mul_f32 v107, v100, v107
    v_mul_f32 v108, v100, v108
    v_mfma_f32_16x16x32_bf16 v[72:75], a[152:155], v[60:63], v[72:75]
    ds_read_b128 v[52:55], v18 offset:43008
    v_mfma_f32_16x16x32_bf16 v[76:79], a[156:159], v[60:63], v[76:79]
    v_cvt_pk_bf16_f32 v107, v107, v108
    v_and_b32 v108, 0xffff0000, v107
    s_waitcnt lgkmcnt(4)
    v_mfma_f32_16x16x32_bf16 v[64:67], a[160:163], v[32:35], v[64:67]
    ds_read_b128 v[56:59], v17 offset:44032
    v_mfma_f32_16x16x32_bf16 v[68:71], a[164:167], v[32:35], v[68:71]
    v_lshlrev_b32 v107, 16, v107
    v_add_f32 v105, v105, v107
    v_mfma_f32_16x16x32_bf16 v[72:75], a[160:163], v[36:39], v[72:75]
    ds_read_b128 v[60:63], v18 offset:44032
    v_mfma_f32_16x16x32_bf16 v[76:79], a[164:167], v[36:39], v[76:79]
    v_add_f32 v106, v106, v108
    v_cvt_pk_bf16_f32 v102, v105, v106
    s_waitcnt lgkmcnt(4)
    v_mfma_f32_16x16x32_bf16 v[64:67], a[168:171], v[40:43], v[64:67]
    s_barrier
    ds_read_b128 v[32:35], v17 offset:49152
    v_mfma_f32_16x16x32_bf16 v[68:71], a[172:175], v[40:43], v[68:71]
    v_cvt_pk_bf16_f32 v105, v86, v87
    v_lshlrev_b32 v107, 16, v97
    v_mfma_f32_16x16x32_bf16 v[72:75], a[168:171], v[44:47], v[72:75]
    ds_read_b128 v[36:39], v18 offset:49152
    v_mfma_f32_16x16x32_bf16 v[76:79], a[172:175], v[44:47], v[76:79]
    v_and_b32 v108, 0xffff0000, v97
    v_lshlrev_b32 v109, 16, v99
    s_waitcnt lgkmcnt(4)
    v_mfma_f32_16x16x32_bf16 v[64:67], a[176:179], v[48:51], v[64:67]
    ds_read_b128 v[40:43], v17 offset:50176
    v_mfma_f32_16x16x32_bf16 v[68:71], a[180:183], v[48:51], v[68:71]
    v_and_b32 v110, 0xffff0000, v99
    v_and_b32 v106, 0xffff0000, v105
    v_mfma_f32_16x16x32_bf16 v[72:75], a[176:179], v[52:55], v[72:75]
    ds_read_b128 v[44:47], v18 offset:50176
    v_mfma_f32_16x16x32_bf16 v[76:79], a[180:183], v[52:55], v[76:79]
    v_lshlrev_b32 v105, 16, v105
    v_mul_f32 v107, v107, v109
    s_waitcnt lgkmcnt(4)
    v_mfma_f32_16x16x32_bf16 v[64:67], a[184:187], v[56:59], v[64:67]
    ds_read_b128 v[48:51], v17 offset:51200
    v_mfma_f32_16x16x32_bf16 v[68:71], a[188:191], v[56:59], v[68:71]
    v_mul_f32 v108, v108, v110
    v_mul_f32 v105, v104, v105
    v_mfma_f32_16x16x32_bf16 v[72:75], a[184:187], v[60:63], v[72:75]
    ds_read_b128 v[52:55], v18 offset:51200
    v_mfma_f32_16x16x32_bf16 v[76:79], a[188:191], v[60:63], v[76:79]
    v_mul_f32 v106, v104, v106
    v_cvt_pk_bf16_f32 v107, v107, v108
    s_waitcnt lgkmcnt(4)
    v_mfma_f32_16x16x32_bf16 v[64:67], a[192:195], v[32:35], v[64:67]
    ds_read_b128 v[56:59], v17 offset:52224
    v_mfma_f32_16x16x32_bf16 v[68:71], a[196:199], v[32:35], v[68:71]
    v_cvt_pk_bf16_f32 v105, v105, v106
    v_and_b32 v108, 0xffff0000, v107
    v_mfma_f32_16x16x32_bf16 v[72:75], a[192:195], v[36:39], v[72:75]
    ds_read_b128 v[60:63], v18 offset:52224
    v_mfma_f32_16x16x32_bf16 v[76:79], a[196:199], v[36:39], v[76:79]
    v_lshlrev_b32 v107, 16, v107
    v_and_b32 v106, 0xffff0000, v105
    s_waitcnt lgkmcnt(4)
    v_mfma_f32_16x16x32_bf16 v[64:67], a[200:203], v[40:43], v[64:67]
    ds_read_b128 v[32:35], v17 offset:57344
    v_mfma_f32_16x16x32_bf16 v[68:71], a[204:207], v[40:43], v[68:71]
    v_lshlrev_b32 v105, 16, v105
    v_mul_f32 v107, v100, v107
    v_mfma_f32_16x16x32_bf16 v[72:75], a[200:203], v[44:47], v[72:75]
    ds_read_b128 v[36:39], v18 offset:57344
    v_mfma_f32_16x16x32_bf16 v[76:79], a[204:207], v[44:47], v[76:79]
    v_mul_f32 v108, v100, v108
    v_cvt_pk_bf16_f32 v107, v107, v108
    s_waitcnt lgkmcnt(4)
    v_mfma_f32_16x16x32_bf16 v[64:67], a[208:211], v[48:51], v[64:67]
    ds_read_b128 v[40:43], v17 offset:58368
    v_mfma_f32_16x16x32_bf16 v[68:71], a[212:215], v[48:51], v[68:71]
    v_and_b32 v108, 0xffff0000, v107
    v_lshlrev_b32 v107, 16, v107
    v_mfma_f32_16x16x32_bf16 v[72:75], a[208:211], v[52:55], v[72:75]
    ds_read_b128 v[44:47], v18 offset:58368
    v_mfma_f32_16x16x32_bf16 v[76:79], a[212:215], v[52:55], v[76:79]
    v_add_f32 v105, v105, v107
    v_add_f32 v106, v106, v108
    s_waitcnt lgkmcnt(4)
    v_mfma_f32_16x16x32_bf16 v[64:67], a[216:219], v[56:59], v[64:67]
    ds_read_b128 v[48:51], v17 offset:59392
    v_mfma_f32_16x16x32_bf16 v[68:71], a[220:223], v[56:59], v[68:71]
    v_cvt_pk_bf16_f32 v103, v105, v106
    s_mov_b64 exec, s[64:65]
    buffer_store_dwordx2 v[102:103], v22, s[44:47], s52 offen
    s_mov_b64 exec, -1
    v_mfma_f32_16x16x32_bf16 v[72:75], a[216:219], v[60:63], v[72:75]
    ds_read_b128 v[52:55], v18 offset:59392
    v_mfma_f32_16x16x32_bf16 v[76:79], a[220:223], v[60:63], v[76:79]
    s_add_u32 s51, s34, s55
    s_lshl_b32 s52, s54, 16
    s_lshl_b32 s60, s54, 7
    s_add_u32 s58, s60, 117440512
    s_add_u32 s59, s60, 117448704
    s_add_u32 s60, s60, 121634816

    s_cmp_eq_u32 s38, 0
    s_waitcnt lgkmcnt(4)
    v_mfma_f32_16x16x32_bf16 v[64:67], a[224:227], v[32:35], v[64:67]
    ds_read_b128 v[56:59], v17 offset:60416
    v_mfma_f32_16x16x32_bf16 v[68:71], a[228:231], v[32:35], v[68:71]
    s_cbranch_scc1 .cs_444
    buffer_load_dwordx2 v[96:97], v22, s[16:19], s52 offen
.cs_444:
    v_mfma_f32_16x16x32_bf16 v[72:75], a[224:227], v[36:39], v[72:75]
    ds_read_b128 v[60:63], v18 offset:60416
    v_mfma_f32_16x16x32_bf16 v[76:79], a[228:231], v[36:39], v[76:79]
    s_cbranch_scc1 .cs_445
    buffer_load_dword v98, v23, s[8:11], s58 offen
.cs_445:
    s_waitcnt lgkmcnt(4)
    v_mfma_f32_16x16x32_bf16 v[64:67], a[232:235], v[40:43], v[64:67]
    v_mfma_f32_16x16x32_bf16 v[68:71], a[236:239], v[40:43], v[68:71]
    s_cbranch_scc1 .cs_446
    buffer_load_dword v99, v23, s[8:11], s59 offen
.cs_446:
    v_mfma_f32_16x16x32_bf16 v[72:75], a[232:235], v[44:47], v[72:75]
    v_mfma_f32_16x16x32_bf16 v[76:79], a[236:239], v[44:47], v[76:79]
    s_cbranch_scc1 .cs_447
    buffer_load_dword v100, v16, s[8:11], s60 offen
.cs_447:
    s_waitcnt lgkmcnt(2)
    v_mfma_f32_16x16x32_bf16 v[64:67], a[240:243], v[48:51], v[64:67]
    v_mfma_f32_16x16x32_bf16 v[68:71], a[244:247], v[48:51], v[68:71]
    s_cbranch_scc1 .cs_448
    buffer_load_dwordx4 v[84:87], v7, s[8:11], s51 offen sc1
.cs_448:
    v_mfma_f32_16x16x32_bf16 v[72:75], a[240:243], v[52:55], v[72:75]
    v_mfma_f32_16x16x32_bf16 v[76:79], a[244:247], v[52:55], v[76:79]
    s_cbranch_scc1 .cs_449
    buffer_load_dwordx4 v[88:91], v8, s[8:11], s51 offen sc1
.cs_449:
    s_waitcnt lgkmcnt(0)
    v_mfma_f32_16x16x32_bf16 v[64:67], a[248:251], v[56:59], v[64:67]
    v_mfma_f32_16x16x32_bf16 v[68:71], a[252:255], v[56:59], v[68:71]
    s_cbranch_scc1 .cs_450
    buffer_load_dwordx4 v[92:95], v9, s[8:11], s51 offen sc1
.cs_450:
    v_mfma_f32_16x16x32_bf16 v[72:75], a[248:251], v[60:63], v[72:75]
    v_mfma_f32_16x16x32_bf16 v[76:79], a[252:255], v[60:63], v[76:79]
    v_xor_b32 v17, 0x10000, v17
    v_xor_b32 v18, 0x10000, v18
    s_cselect_b64 s[64:65], 0, -1
    s_add_u32 s4, s34, s37

    v_mov_b32 v112, v80
    v_mov_b32 v113, v81
    v_mov_b32 v114, v82
    v_mov_b32 v115, v83
.g2st_424:
    v_min_u32 v68, 0xfffffffe, v68
    buffer_store_dwordx4 v[68:71], v28, s[8:11], s4 offen sc1
    v_min_u32 v72, 0xfffffffe, v72
    buffer_store_dwordx4 v[72:75], v29, s[8:11], s4 offen sc1
    v_min_u32 v76, 0xfffffffe, v76
    buffer_store_dwordx4 v[76:79], v30, s[8:11], s4 offen sc1
    v_mov_b32 v80, v64
    v_mov_b32 v81, v65
    v_mov_b32 v82, v66
    v_mov_b32 v83, v67
    s_cmp_lg_u32 s56, 0
    s_cbranch_scc1 .g2pf_451
    s_cmp_eq_u32 s38, 0
    s_cbranch_scc1 .g2nc_425
    s_waitcnt vmcnt(0)
    s_mov_b32 s62, 0
.cc_452:
    v_max3_u32 v4, v84, v88, v92
    v_cmp_eq_u32 vcc, -1, v4
    s_cbranch_vccnz .cf_453
    v_add_f32 v84, v84, v88
    v_add_f32 v92, v112, v92
    v_add_f32 v85, v85, v89
    v_add_f32 v93, v113, v93
    v_add_f32 v86, v86, v90
    v_add_f32 v94, v114, v94
    v_add_f32 v87, v87, v91
    v_add_f32 v95, v115, v95
    v_add_f32 v84, v92, v84
    v_add_f32 v85, v93, v85
    v_add_f32 v86, v94, v86
    v_add_f32 v87, v95, v87
    v_sub_f32 v104, 1.0, v100
    v_cvt_pk_bf16_f32 v104, v104, v104
    v_lshlrev_b32 v104, 16, v104
    v_cvt_pk_bf16_f32 v105, v84, v85
    v_lshlrev_b32 v107, 16, v96
    v_and_b32 v108, 0xffff0000, v96
    v_lshlrev_b32 v109, 16, v98
    v_and_b32 v110, 0xffff0000, v98
    v_and_b32 v106, 0xffff0000, v105
    v_lshlrev_b32 v105, 16, v105
    v_mul_f32 v107, v107, v109
    v_mul_f32 v108, v108, v110
    v_mul_f32 v105, v104, v105
    v_mul_f32 v106, v104, v106
    v_cvt_pk_bf16_f32 v107, v107, v108
    v_cvt_pk_bf16_f32 v105, v105, v106
    v_and_b32 v108, 0xffff0000, v107
    v_lshlrev_b32 v107, 16, v107
    v_and_b32 v106, 0xffff0000, v105
    v_lshlrev_b32 v105, 16, v105
    v_mul_f32 v107, v100, v107
    v_mul_f32 v108, v100, v108
    v_cvt_pk_bf16_f32 v107, v107, v108
    v_and_b32 v108, 0xffff0000, v107
    v_lshlrev_b32 v107, 16, v107
    v_add_f32 v105, v105, v107
    v_add_f32 v106, v106, v108
    v_cvt_pk_bf16_f32 v102, v105, v106
    v_cvt_pk_bf16_f32 v105, v86, v87
    v_lshlrev_b32 v107, 16, v97
    v_and_b32 v108, 0xffff0000, v97
    v_lshlrev_b32 v109, 16, v99
    v_and_b32 v110, 0xffff0000, v99
    v_and_b32 v106, 0xffff0000, v105
    v_lshlrev_b32 v105, 16, v105
    v_mul_f32 v107, v107, v109
    v_mul_f32 v108, v108, v110
    v_mul_f32 v105, v104, v105
    v_mul_f32 v106, v104, v106
    v_cvt_pk_bf16_f32 v107, v107, v108
    v_cvt_pk_bf16_f32 v105, v105, v106
    v_and_b32 v108, 0xffff0000, v107
    v_lshlrev_b32 v107, 16, v107
    v_and_b32 v106, 0xffff0000, v105
    v_lshlrev_b32 v105, 16, v105
    v_mul_f32 v107, v100, v107
    v_mul_f32 v108, v100, v108
    v_cvt_pk_bf16_f32 v107, v107, v108
    v_and_b32 v108, 0xffff0000, v107
    v_lshlrev_b32 v107, 16, v107
    v_add_f32 v105, v105, v107
    v_add_f32 v106, v106, v108
    v_cvt_pk_bf16_f32 v103, v105, v106
    buffer_store_dwordx2 v[102:103], v22, s[44:47], s52 offen
.g2nc_425:
    s_add_u32 s51, s34, s37
    s_lshl_b32 s52, s31, 16
    s_lshl_b32 s60, s31, 7
    s_add_u32 s58, s60, 117440512
    s_add_u32 s59, s60, 117448704
    s_add_u32 s60, s60, 121634816

    buffer_load_dwordx2 v[96:97], v22, s[16:19], s52 offen
    buffer_load_dword v98, v23, s[8:11], s58 offen
    buffer_load_dword v99, v23, s[8:11], s59 offen
    buffer_load_dword v100, v16, s[8:11], s60 offen
    buffer_load_dwordx4 v[84:87], v7, s[8:11], s51 offen sc1
    buffer_load_dwordx4 v[88:91], v8, s[8:11], s51 offen sc1
    buffer_load_dwordx4 v[92:95], v9, s[8:11], s51 offen sc1
    s_waitcnt vmcnt(0)
    s_mov_b32 s62, 0
.cc_454:
    v_max3_u32 v4, v84, v88, v92
    v_cmp_eq_u32 vcc, -1, v4
    s_cbranch_vccnz .cf_455
    v_add_f32 v84, v84, v88
    v_add_f32 v92, v80, v92
    v_add_f32 v85, v85, v89
    v_add_f32 v93, v81, v93
    v_add_f32 v86, v86, v90
    v_add_f32 v94, v82, v94
    v_add_f32 v87, v87, v91
    v_add_f32 v95, v83, v95
    v_add_f32 v84, v92, v84
    v_add_f32 v85, v93, v85
    v_add_f32 v86, v94, v86
    v_add_f32 v87, v95, v87
    v_sub_f32 v104, 1.0, v100
    v_cvt_pk_bf16_f32 v104, v104, v104
    v_lshlrev_b32 v104, 16, v104
    v_cvt_pk_bf16_f32 v105, v84, v85
    v_lshlrev_b32 v107, 16, v96
    v_and_b32 v108, 0xffff0000, v96
    v_lshlrev_b32 v109, 16, v98
    v_and_b32 v110, 0xffff0000, v98
    v_and_b32 v106, 0xffff0000, v105
    v_lshlrev_b32 v105, 16, v105
    v_mul_f32 v107, v107, v109
    v_mul_f32 v108, v108, v110
    v_mul_f32 v105, v104, v105
    v_mul_f32 v106, v104, v106
    v_cvt_pk_bf16_f32 v107, v107, v108
    v_cvt_pk_bf16_f32 v105, v105, v106
    v_and_b32 v108, 0xffff0000, v107
    v_lshlrev_b32 v107, 16, v107
    v_and_b32 v106, 0xffff0000, v105
    v_lshlrev_b32 v105, 16, v105
    v_mul_f32 v107, v100, v107
    v_mul_f32 v108, v100, v108
    v_cvt_pk_bf16_f32 v107, v107, v108
    v_and_b32 v108, 0xffff0000, v107
    v_lshlrev_b32 v107, 16, v107
    v_add_f32 v105, v105, v107
    v_add_f32 v106, v106, v108
    v_cvt_pk_bf16_f32 v102, v105, v106
    v_cvt_pk_bf16_f32 v105, v86, v87
    v_lshlrev_b32 v107, 16, v97
    v_and_b32 v108, 0xffff0000, v97
    v_lshlrev_b32 v109, 16, v99
    v_and_b32 v110, 0xffff0000, v99
    v_and_b32 v106, 0xffff0000, v105
    v_lshlrev_b32 v105, 16, v105
    v_mul_f32 v107, v107, v109
    v_mul_f32 v108, v108, v110
    v_mul_f32 v105, v104, v105
    v_mul_f32 v106, v104, v106
    v_cvt_pk_bf16_f32 v107, v107, v108
    v_cvt_pk_bf16_f32 v105, v105, v106
    v_and_b32 v108, 0xffff0000, v107
    v_lshlrev_b32 v107, 16, v107
    v_and_b32 v106, 0xffff0000, v105
    v_lshlrev_b32 v105, 16, v105
    v_mul_f32 v107, v100, v107
    v_mul_f32 v108, v100, v108
    v_cvt_pk_bf16_f32 v107, v107, v108
    v_and_b32 v108, 0xffff0000, v107
    v_lshlrev_b32 v107, 16, v107
    v_add_f32 v105, v105, v107
    v_add_f32 v106, v106, v108
    v_cvt_pk_bf16_f32 v103, v105, v106
    buffer_store_dwordx2 v[102:103], v22, s[44:47], s52 offen
.g2nx_431:
    s_mov_b32 s54, s31
    s_mov_b32 s31, s53
    s_mov_b32 s69, 3
    s_add_u32 s37, s37, 0x10000
    s_cmp_lt_u32 s31, 65
    s_cbranch_scc1 .g2blk_419
    s_branch .g2fin_426

.g2pf_451:
    s_mov_b32 s54, s31
    s_mov_b32 s31, s53
    s_mov_b32 s69, 3
    s_add_u32 s37, s37, 0x10000
    s_cmp_eq_u32 s38, 0
    s_mov_b32 s38, 1
    s_cbranch_scc1 .g2w3_421
    s_waitcnt vmcnt(10)
    s_branch .g2go_420

.g2w3_421:
    s_waitcnt vmcnt(3)
    s_branch .g2go_420
.g2h_428:
    s_mov_b32 s53, 63
    s_and_b32 s54, s31, 1
    s_lshr_b32 s4, s91, 1
    s_xor_b32 s55, s54, s4
    s_lshl_b32 s4, s55, 12
    v_xor_b32 v17, s4, v17

    s_add_u32 s51, s34, s37
    s_lshl_b32 s52, s53, 16
    s_lshl_b32 s60, s53, 7
    s_add_u32 s58, s60, 117440512
    s_add_u32 s59, s60, 117448704
    s_add_u32 s60, s60, 121634816

    s_lshl_b32 s48, s53, 18
    s_add_u32 s48, s48, s36
    s_add_u32 s49, s39, s35
    s_xor_b32 s39, s39, 0x10000

    s_lshl_b32 s4, s54, 12
    s_add_u32 s48, s48, s4
    s_add_u32 s49, s49, s4
    buffer_load_dwordx2 v[96:97], v22, s[16:19], s52 offen
    buffer_load_dword v98, v23, s[8:11], s58 offen
    buffer_load_dword v99, v23, s[8:11], s59 offen
    buffer_load_dword v100, v16, s[8:11], s60 offen
    s_waitcnt vmcnt(0)
    v_sub_f32 v104, 1.0, v100
    v_cvt_pk_bf16_f32 v104, v104, v104
    v_lshlrev_b32 v104, 16, v104
    v_lshlrev_b32 v107, 16, v96
    v_and_b32 v108, 0xffff0000, v96
    v_lshlrev_b32 v109, 16, v98
    v_and_b32 v110, 0xffff0000, v98
    v_mul_f32 v107, v107, v109
    v_mul_f32 v108, v108, v110
    v_cvt_pk_bf16_f32 v107, v107, v108
    v_and_b32 v108, 0xffff0000, v107
    v_lshlrev_b32 v107, 16, v107
    v_mul_f32 v107, v100, v107
    v_mul_f32 v108, v100, v108
    v_cvt_pk_bf16_f32 v107, v107, v108
    v_and_b32 v113, 0xffff0000, v107
    v_lshlrev_b32 v112, 16, v107
    v_lshlrev_b32 v107, 16, v97
    v_and_b32 v108, 0xffff0000, v97
    v_lshlrev_b32 v109, 16, v99
    v_and_b32 v110, 0xffff0000, v99
    v_mul_f32 v107, v107, v109
    v_mul_f32 v108, v108, v110
    v_cvt_pk_bf16_f32 v107, v107, v108
    v_and_b32 v108, 0xffff0000, v107
    v_lshlrev_b32 v107, 16, v107
    v_mul_f32 v107, v100, v107
    v_mul_f32 v108, v100, v108
    v_cvt_pk_bf16_f32 v107, v107, v108
    v_and_b32 v115, 0xffff0000, v107
    v_lshlrev_b32 v114, 16, v107
.hp_456:
    buffer_load_dword v20, v19, s[8:11], s33 offen sc1
    s_waitcnt vmcnt(0)
    s_lshr_b32 s6, s31, 2
    s_and_b32 s4, s31, 3
    v_cmp_ge_u32 vcc, s6, v20
    s_lshl_b32 s4, s4, 3
    s_lshr_b32 s5, vcc_lo, s4
    s_and_b32 s5, s5, 0xff
    s_cmp_eq_u32 s5, 0

    s_cbranch_scc1 .hr_457
    s_lshl_b64 exec, 0xff, s4
    s_add_u32 s62, s62, 1
    s_cmp_gt_u32 s62, 0x400000
    s_cbranch_scc1 .mg_end_1
    s_branch .hp_456

.hr_457:
    s_mov_b64 exec, -1
    s_add_u32 m0, s49, 0
    s_add_u32 s50, s48, 0
    buffer_load_dwordx4 v21, s[8:11], s50 offen offset:0 sc1 lds
    s_add_u32 m0, s49, 8192
    s_add_u32 s50, s48, 8192
    buffer_load_dwordx4 v21, s[8:11], s50 offen offset:0 sc1 lds
    s_add_u32 m0, s49, 16384
    s_add_u32 s50, s48, 16384
    buffer_load_dwordx4 v21, s[8:11], s50 offen offset:0 sc1 lds
    s_add_u32 m0, s49, 24576
    s_add_u32 s50, s48, 24576
    buffer_load_dwordx4 v21, s[8:11], s50 offen offset:0 sc1 lds
    s_add_u32 m0, s49, 32768
    s_add_u32 s50, s48, 32768
    buffer_load_dwordx4 v21, s[8:11], s50 offen offset:0 sc1 lds
    s_add_u32 m0, s49, 40960
    s_add_u32 s50, s48, 40960
    buffer_load_dwordx4 v21, s[8:11], s50 offen offset:0 sc1 lds
    s_add_u32 m0, s49, 49152
    s_add_u32 s50, s48, 49152
    buffer_load_dwordx4 v21, s[8:11], s50 offen offset:0 sc1 lds
    s_add_u32 m0, s49, 57344
    s_add_u32 s50, s48, 57344
    buffer_load_dwordx4 v21, s[8:11], s50 offen offset:0 sc1 lds
    s_waitcnt vmcnt(6)
    s_barrier
    ds_read_b128 v[32:35], v17 offset:0
    ds_read_b128 v[36:39], v17 offset:1024
    ds_read_b128 v[40:43], v17 offset:2048
    ds_read_b128 v[44:47], v17 offset:3072
    ds_read_b128 v[48:51], v17 offset:8192
    ds_read_b128 v[52:55], v17 offset:9216
    s_waitcnt lgkmcnt(5)
    v_mfma_f32_16x16x32_bf16 v[64:67], a[0:3], v[32:35], 0
    ds_read_b128 v[56:59], v17 offset:10240
    v_mfma_f32_16x16x32_bf16 v[68:71], a[4:7], v[32:35], 0
    s_waitcnt lgkmcnt(5)
    v_mfma_f32_16x16x32_bf16 v[72:75], a[8:11], v[36:39], 0
    ds_read_b128 v[60:63], v17 offset:11264
    v_mfma_f32_16x16x32_bf16 v[76:79], a[12:15], v[36:39], 0
    s_waitcnt lgkmcnt(5)
    v_mfma_f32_16x16x32_bf16 v[64:67], a[16:19], v[40:43], v[64:67]
    s_waitcnt vmcnt(4)
    s_barrier
    ds_read_b128 v[32:35], v17 offset:16384
    v_mfma_f32_16x16x32_bf16 v[68:71], a[20:23], v[40:43], v[68:71]
    s_waitcnt lgkmcnt(5)
    v_mfma_f32_16x16x32_bf16 v[72:75], a[24:27], v[44:47], v[72:75]
    ds_read_b128 v[36:39], v17 offset:17408
    v_mfma_f32_16x16x32_bf16 v[76:79], a[28:31], v[44:47], v[76:79]
    s_waitcnt lgkmcnt(5)
    v_mfma_f32_16x16x32_bf16 v[64:67], a[32:35], v[48:51], v[64:67]
    ds_read_b128 v[40:43], v17 offset:18432
    v_mfma_f32_16x16x32_bf16 v[68:71], a[36:39], v[48:51], v[68:71]
    s_waitcnt lgkmcnt(5)
    v_mfma_f32_16x16x32_bf16 v[72:75], a[40:43], v[52:55], v[72:75]
    ds_read_b128 v[44:47], v17 offset:19456
    v_mfma_f32_16x16x32_bf16 v[76:79], a[44:47], v[52:55], v[76:79]
    s_waitcnt lgkmcnt(5)
    v_mfma_f32_16x16x32_bf16 v[64:67], a[48:51], v[56:59], v[64:67]
    ds_read_b128 v[48:51], v17 offset:24576
    v_mfma_f32_16x16x32_bf16 v[68:71], a[52:55], v[56:59], v[68:71]
    s_waitcnt lgkmcnt(5)
    v_mfma_f32_16x16x32_bf16 v[72:75], a[56:59], v[60:63], v[72:75]
    ds_read_b128 v[52:55], v17 offset:25600
    v_mfma_f32_16x16x32_bf16 v[76:79], a[60:63], v[60:63], v[76:79]
    s_waitcnt lgkmcnt(5)
    v_mfma_f32_16x16x32_bf16 v[64:67], a[64:67], v[32:35], v[64:67]
    ds_read_b128 v[56:59], v17 offset:26624
    v_mfma_f32_16x16x32_bf16 v[68:71], a[68:71], v[32:35], v[68:71]
    s_waitcnt lgkmcnt(5)
    v_mfma_f32_16x16x32_bf16 v[72:75], a[72:75], v[36:39], v[72:75]
    ds_read_b128 v[60:63], v17 offset:27648
    v_mfma_f32_16x16x32_bf16 v[76:79], a[76:79], v[36:39], v[76:79]
    s_waitcnt lgkmcnt(5)
    v_mfma_f32_16x16x32_bf16 v[64:67], a[80:83], v[40:43], v[64:67]
    s_waitcnt vmcnt(2)
    s_barrier
    ds_read_b128 v[32:35], v17 offset:32768
    v_mfma_f32_16x16x32_bf16 v[68:71], a[84:87], v[40:43], v[68:71]
    s_waitcnt lgkmcnt(5)
    v_mfma_f32_16x16x32_bf16 v[72:75], a[88:91], v[44:47], v[72:75]
    ds_read_b128 v[36:39], v17 offset:33792
    v_mfma_f32_16x16x32_bf16 v[76:79], a[92:95], v[44:47], v[76:79]
    s_waitcnt lgkmcnt(5)
    v_mfma_f32_16x16x32_bf16 v[64:67], a[96:99], v[48:51], v[64:67]
    ds_read_b128 v[40:43], v17 offset:34816
    v_mfma_f32_16x16x32_bf16 v[68:71], a[100:103], v[48:51], v[68:71]
    s_waitcnt lgkmcnt(5)
    v_mfma_f32_16x16x32_bf16 v[72:75], a[104:107], v[52:55], v[72:75]
    ds_read_b128 v[44:47], v17 offset:35840
    v_mfma_f32_16x16x32_bf16 v[76:79], a[108:111], v[52:55], v[76:79]
    s_waitcnt lgkmcnt(5)
    v_mfma_f32_16x16x32_bf16 v[64:67], a[112:115], v[56:59], v[64:67]
    ds_read_b128 v[48:51], v17 offset:40960
    v_mfma_f32_16x16x32_bf16 v[68:71], a[116:119], v[56:59], v[68:71]
    s_waitcnt lgkmcnt(5)
    v_mfma_f32_16x16x32_bf16 v[72:75], a[120:123], v[60:63], v[72:75]
    ds_read_b128 v[52:55], v17 offset:41984
    v_mfma_f32_16x16x32_bf16 v[76:79], a[124:127], v[60:63], v[76:79]
    s_waitcnt lgkmcnt(5)
    v_mfma_f32_16x16x32_bf16 v[64:67], a[128:131], v[32:35], v[64:67]
    ds_read_b128 v[56:59], v17 offset:43008
    v_mfma_f32_16x16x32_bf16 v[68:71], a[132:135], v[32:35], v[68:71]
    s_waitcnt lgkmcnt(5)
    v_mfma_f32_16x16x32_bf16 v[72:75], a[136:139], v[36:39], v[72:75]
    ds_read_b128 v[60:63], v17 offset:44032
    v_mfma_f32_16x16x32_bf16 v[76:79], a[140:143], v[36:39], v[76:79]
    s_waitcnt lgkmcnt(5)
    v_mfma_f32_16x16x32_bf16 v[64:67], a[144:147], v[40:43], v[64:67]
    s_waitcnt vmcnt(0)
    s_barrier
    ds_read_b128 v[32:35], v17 offset:49152
    v_mfma_f32_16x16x32_bf16 v[68:71], a[148:151], v[40:43], v[68:71]
    s_waitcnt lgkmcnt(5)
    v_mfma_f32_16x16x32_bf16 v[72:75], a[152:155], v[44:47], v[72:75]
    ds_read_b128 v[36:39], v17 offset:50176
    v_mfma_f32_16x16x32_bf16 v[76:79], a[156:159], v[44:47], v[76:79]
    s_waitcnt lgkmcnt(5)
    v_mfma_f32_16x16x32_bf16 v[64:67], a[160:163], v[48:51], v[64:67]
    ds_read_b128 v[40:43], v17 offset:51200
    v_mfma_f32_16x16x32_bf16 v[68:71], a[164:167], v[48:51], v[68:71]
    s_waitcnt lgkmcnt(5)
    v_mfma_f32_16x16x32_bf16 v[72:75], a[168:171], v[52:55], v[72:75]
    ds_read_b128 v[44:47], v17 offset:52224
    v_mfma_f32_16x16x32_bf16 v[76:79], a[172:175], v[52:55], v[76:79]
    s_waitcnt lgkmcnt(5)
    v_mfma_f32_16x16x32_bf16 v[64:67], a[176:179], v[56:59], v[64:67]
    ds_read_b128 v[48:51], v17 offset:57344
    v_mfma_f32_16x16x32_bf16 v[68:71], a[180:183], v[56:59], v[68:71]
    s_waitcnt lgkmcnt(5)
    v_mfma_f32_16x16x32_bf16 v[72:75], a[184:187], v[60:63], v[72:75]
    ds_read_b128 v[52:55], v17 offset:58368
    v_mfma_f32_16x16x32_bf16 v[76:79], a[188:191], v[60:63], v[76:79]
    s_waitcnt lgkmcnt(5)
    v_mfma_f32_16x16x32_bf16 v[64:67], a[192:195], v[32:35], v[64:67]
    ds_read_b128 v[56:59], v17 offset:59392
    v_mfma_f32_16x16x32_bf16 v[68:71], a[196:199], v[32:35], v[68:71]
    s_waitcnt lgkmcnt(5)
    v_mfma_f32_16x16x32_bf16 v[72:75], a[200:203], v[36:39], v[72:75]
    ds_read_b128 v[60:63], v17 offset:60416
    v_mfma_f32_16x16x32_bf16 v[76:79], a[204:207], v[36:39], v[76:79]
    s_waitcnt lgkmcnt(5)
    v_mfma_f32_16x16x32_bf16 v[64:67], a[208:211], v[40:43], v[64:67]
    v_mfma_f32_16x16x32_bf16 v[68:71], a[212:215], v[40:43], v[68:71]
    s_waitcnt lgkmcnt(4)
    v_mfma_f32_16x16x32_bf16 v[72:75], a[216:219], v[44:47], v[72:75]
    v_mfma_f32_16x16x32_bf16 v[76:79], a[220:223], v[44:47], v[76:79]
    s_waitcnt lgkmcnt(3)
    v_mfma_f32_16x16x32_bf16 v[64:67], a[224:227], v[48:51], v[64:67]
    v_mfma_f32_16x16x32_bf16 v[68:71], a[228:231], v[48:51], v[68:71]
    s_waitcnt lgkmcnt(2)
    v_mfma_f32_16x16x32_bf16 v[72:75], a[232:235], v[52:55], v[72:75]
    v_mfma_f32_16x16x32_bf16 v[76:79], a[236:239], v[52:55], v[76:79]
    s_waitcnt lgkmcnt(1)
    v_mfma_f32_16x16x32_bf16 v[64:67], a[240:243], v[56:59], v[64:67]
    v_mfma_f32_16x16x32_bf16 v[68:71], a[244:247], v[56:59], v[68:71]
    s_waitcnt lgkmcnt(0)
    v_mfma_f32_16x16x32_bf16 v[72:75], a[248:251], v[60:63], v[72:75]
    v_mfma_f32_16x16x32_bf16 v[76:79], a[252:255], v[60:63], v[76:79]
    s_cmp_lg_u32 s55, 0
    s_nop 6
    v_pk_add_f32 v[68:69], v[68:69], v[76:77]
    v_pk_add_f32 v[70:71], v[70:71], v[78:79]
    v_pk_add_f32 v[64:65], v[64:65], v[72:73]
    v_pk_add_f32 v[66:67], v[66:67], v[74:75]
    v_min_u32 v68, 0xfffffffe, v68
    s_cbranch_scc1 .hs_458
    buffer_store_dwordx4 v[68:71], v28, s[8:11], s51 offen sc1
    s_waitcnt vmcnt(0)
    buffer_load_dwordx4 v[84:87], v7, s[8:11], s51 offen sc1
    buffer_load_dwordx4 v[88:91], v8, s[8:11], s51 offen sc1
    buffer_load_dwordx4 v[92:95], v9, s[8:11], s51 offen sc1
    s_waitcnt vmcnt(0)
    s_mov_b32 s62, 0
.cc_460:
    v_max3_u32 v4, v84, v88, v92
    v_cmp_eq_u32 vcc, -1, v4
    s_cbranch_vccnz .cf_461
    v_add_f32 v84, v84, v88
    v_add_f32 v92, v64, v92
    v_add_f32 v85, v85, v89
    v_add_f32 v93, v65, v93
    v_add_f32 v86, v86, v90
    v_add_f32 v94, v66, v94
    v_add_f32 v87, v87, v91
    v_add_f32 v95, v67, v95
    v_add_f32 v84, v92, v84
    v_add_f32 v85, v93, v85
    v_add_f32 v86, v94, v86
    v_add_f32 v87, v95, v87
    v_cvt_pk_bf16_f32 v105, v84, v85
    v_cvt_pk_bf16_f32 v107, v86, v87
    v_and_b32 v106, 0xffff0000, v105
    v_lshlrev_b32 v105, 16, v105
    v_and_b32 v108, 0xffff0000, v107
    v_lshlrev_b32 v107, 16, v107
    v_mul_f32 v105, v104, v105
    v_mul_f32 v106, v104, v106
    v_mul_f32 v107, v104, v107
    v_mul_f32 v108, v104, v108
    v_cvt_pk_bf16_f32 v105, v105, v106
    v_cvt_pk_bf16_f32 v107, v107, v108
    v_and_b32 v106, 0xffff0000, v105
    v_lshlrev_b32 v105, 16, v105
    v_and_b32 v108, 0xffff0000, v107
    v_lshlrev_b32 v107, 16, v107
    v_add_f32 v105, v105, v112
    v_add_f32 v106, v106, v113
    v_add_f32 v107, v107, v114
    v_add_f32 v108, v108, v115
    v_cvt_pk_bf16_f32 v102, v105, v106
    v_cvt_pk_bf16_f32 v103, v107, v108
    buffer_store_dwordx2 v[102:103], v22, s[44:47], s52 offen
    s_branch .g2fin_426
.hs_458:
    v_min_u32 v64, 0xfffffffe, v64
    buffer_store_dwordx4 v[68:71], v30, s[8:11], s51 offen sc1
    buffer_store_dwordx4 v[64:67], v29, s[8:11], s51 offen sc1

    s_branch .g2fin_426
.g2fb_430:
    s_add_u32 s51, s34, s37
    s_lshl_b32 s52, s31, 16
    s_lshl_b32 s60, s31, 7
    s_add_u32 s58, s60, 117440512
    s_add_u32 s59, s60, 117448704
    s_add_u32 s60, s60, 121634816

    s_waitcnt vmcnt(4)
    s_barrier
    ds_read_b128 v[32:35], v17 offset:0
    ds_read_b128 v[36:39], v18 offset:0
    ds_read_b128 v[40:43], v17 offset:1024
    ds_read_b128 v[44:47], v18 offset:1024
    ds_read_b128 v[48:51], v17 offset:2048
    ds_read_b128 v[52:55], v18 offset:2048
    s_waitcnt lgkmcnt(4)
    v_mfma_f32_16x16x32_bf16 v[64:67], a[0:3], v[32:35], 0
    ds_read_b128 v[56:59], v17 offset:3072
    v_mfma_f32_16x16x32_bf16 v[68:71], a[4:7], v[32:35], 0
    s_add_u32 m0, s49, 32768
    s_add_u32 s50, s48, 32768
    v_mfma_f32_16x16x32_bf16 v[72:75], a[0:3], v[36:39], 0
    ds_read_b128 v[60:63], v18 offset:3072
    v_mfma_f32_16x16x32_bf16 v[76:79], a[4:7], v[36:39], 0
    buffer_load_dwordx4 v21, s[8:11], s50 offen offset:0 sc1 lds
    s_waitcnt lgkmcnt(4)
    v_mfma_f32_16x16x32_bf16 v[64:67], a[8:11], v[40:43], v[64:67]
    ds_read_b128 v[32:35], v17 offset:8192
    v_mfma_f32_16x16x32_bf16 v[68:71], a[12:15], v[40:43], v[68:71]
    s_add_u32 m0, s49, 36864
    s_add_u32 s50, s48, 36864
    v_mfma_f32_16x16x32_bf16 v[72:75], a[8:11], v[44:47], v[72:75]
    ds_read_b128 v[36:39], v18 offset:8192
    v_mfma_f32_16x16x32_bf16 v[76:79], a[12:15], v[44:47], v[76:79]
    buffer_load_dwordx4 v21, s[8:11], s50 offen offset:0 sc1 lds
    s_waitcnt lgkmcnt(4)
    v_mfma_f32_16x16x32_bf16 v[64:67], a[16:19], v[48:51], v[64:67]
    ds_read_b128 v[40:43], v17 offset:9216
    v_mfma_f32_16x16x32_bf16 v[68:71], a[20:23], v[48:51], v[68:71]
    s_add_u32 m0, s49, 40960
    s_add_u32 s50, s48, 40960
    v_mfma_f32_16x16x32_bf16 v[72:75], a[16:19], v[52:55], v[72:75]
    ds_read_b128 v[44:47], v18 offset:9216
    v_mfma_f32_16x16x32_bf16 v[76:79], a[20:23], v[52:55], v[76:79]
    buffer_load_dwordx4 v21, s[8:11], s50 offen offset:0 sc1 lds
    s_waitcnt lgkmcnt(4)
    v_mfma_f32_16x16x32_bf16 v[64:67], a[24:27], v[56:59], v[64:67]
    ds_read_b128 v[48:51], v17 offset:10240
    v_mfma_f32_16x16x32_bf16 v[68:71], a[28:31], v[56:59], v[68:71]
    s_add_u32 m0, s49, 45056
    s_add_u32 s50, s48, 45056
    v_mfma_f32_16x16x32_bf16 v[72:75], a[24:27], v[60:63], v[72:75]
    ds_read_b128 v[52:55], v18 offset:10240
    v_mfma_f32_16x16x32_bf16 v[76:79], a[28:31], v[60:63], v[76:79]
    buffer_load_dwordx4 v21, s[8:11], s50 offen offset:0 sc1 lds
    s_waitcnt lgkmcnt(4)
    v_mfma_f32_16x16x32_bf16 v[64:67], a[32:35], v[32:35], v[64:67]
    ds_read_b128 v[56:59], v17 offset:11264
    v_mfma_f32_16x16x32_bf16 v[68:71], a[36:39], v[32:35], v[68:71]
    s_add_u32 m0, s49, 49152
    s_add_u32 s50, s48, 49152
    v_mfma_f32_16x16x32_bf16 v[72:75], a[32:35], v[36:39], v[72:75]
    ds_read_b128 v[60:63], v18 offset:11264
    v_mfma_f32_16x16x32_bf16 v[76:79], a[36:39], v[36:39], v[76:79]
    buffer_load_dwordx4 v21, s[8:11], s50 offen offset:0 sc1 lds
    s_waitcnt lgkmcnt(4)
    v_mfma_f32_16x16x32_bf16 v[64:67], a[40:43], v[40:43], v[64:67]
    s_waitcnt vmcnt(5)
    s_barrier
    ds_read_b128 v[32:35], v17 offset:16384
    v_mfma_f32_16x16x32_bf16 v[68:71], a[44:47], v[40:43], v[68:71]
    s_add_u32 m0, s49, 53248
    s_add_u32 s50, s48, 53248
    v_mfma_f32_16x16x32_bf16 v[72:75], a[40:43], v[44:47], v[72:75]
    ds_read_b128 v[36:39], v18 offset:16384
    v_mfma_f32_16x16x32_bf16 v[76:79], a[44:47], v[44:47], v[76:79]
    buffer_load_dwordx4 v21, s[8:11], s50 offen offset:0 sc1 lds
    s_waitcnt lgkmcnt(4)
    v_mfma_f32_16x16x32_bf16 v[64:67], a[48:51], v[48:51], v[64:67]
    ds_read_b128 v[40:43], v17 offset:17408
    v_mfma_f32_16x16x32_bf16 v[68:71], a[52:55], v[48:51], v[68:71]
    s_add_u32 m0, s49, 57344
    s_add_u32 s50, s48, 57344
    v_mfma_f32_16x16x32_bf16 v[72:75], a[48:51], v[52:55], v[72:75]
    ds_read_b128 v[44:47], v18 offset:17408
    v_mfma_f32_16x16x32_bf16 v[76:79], a[52:55], v[52:55], v[76:79]
    buffer_load_dwordx4 v21, s[8:11], s50 offen offset:0 sc1 lds
    s_waitcnt lgkmcnt(4)
    v_mfma_f32_16x16x32_bf16 v[64:67], a[56:59], v[56:59], v[64:67]
    ds_read_b128 v[48:51], v17 offset:18432
    v_mfma_f32_16x16x32_bf16 v[68:71], a[60:63], v[56:59], v[68:71]
    s_add_u32 m0, s49, 61440
    s_add_u32 s50, s48, 61440
    v_mfma_f32_16x16x32_bf16 v[72:75], a[56:59], v[60:63], v[72:75]
    ds_read_b128 v[52:55], v18 offset:18432
    v_mfma_f32_16x16x32_bf16 v[76:79], a[60:63], v[60:63], v[76:79]
    buffer_load_dwordx4 v21, s[8:11], s50 offen offset:0 sc1 lds
    s_waitcnt lgkmcnt(4)
    v_mfma_f32_16x16x32_bf16 v[64:67], a[64:67], v[32:35], v[64:67]
    ds_read_b128 v[56:59], v17 offset:19456
    v_mfma_f32_16x16x32_bf16 v[68:71], a[68:71], v[32:35], v[68:71]
    v_mfma_f32_16x16x32_bf16 v[72:75], a[64:67], v[36:39], v[72:75]
    ds_read_b128 v[60:63], v18 offset:19456
    v_mfma_f32_16x16x32_bf16 v[76:79], a[68:71], v[36:39], v[76:79]
    buffer_load_dwordx2 v[96:97], v22, s[16:19], s52 offen
    s_waitcnt lgkmcnt(4)
    v_mfma_f32_16x16x32_bf16 v[64:67], a[72:75], v[40:43], v[64:67]
    ds_read_b128 v[32:35], v17 offset:24576
    v_mfma_f32_16x16x32_bf16 v[68:71], a[76:79], v[40:43], v[68:71]
    v_mfma_f32_16x16x32_bf16 v[72:75], a[72:75], v[44:47], v[72:75]
    ds_read_b128 v[36:39], v18 offset:24576
    v_mfma_f32_16x16x32_bf16 v[76:79], a[76:79], v[44:47], v[76:79]
    buffer_load_dword v98, v23, s[8:11], s58 offen
    s_waitcnt lgkmcnt(4)
    v_mfma_f32_16x16x32_bf16 v[64:67], a[80:83], v[48:51], v[64:67]
    ds_read_b128 v[40:43], v17 offset:25600
    v_mfma_f32_16x16x32_bf16 v[68:71], a[84:87], v[48:51], v[68:71]
    v_mfma_f32_16x16x32_bf16 v[72:75], a[80:83], v[52:55], v[72:75]
    ds_read_b128 v[44:47], v18 offset:25600
    v_mfma_f32_16x16x32_bf16 v[76:79], a[84:87], v[52:55], v[76:79]
    buffer_load_dword v99, v23, s[8:11], s59 offen
    s_waitcnt lgkmcnt(4)
    v_mfma_f32_16x16x32_bf16 v[64:67], a[88:91], v[56:59], v[64:67]
    ds_read_b128 v[48:51], v17 offset:26624
    v_mfma_f32_16x16x32_bf16 v[68:71], a[92:95], v[56:59], v[68:71]
    v_mfma_f32_16x16x32_bf16 v[72:75], a[88:91], v[60:63], v[72:75]
    ds_read_b128 v[52:55], v18 offset:26624
    v_mfma_f32_16x16x32_bf16 v[76:79], a[92:95], v[60:63], v[76:79]
    buffer_load_dword v100, v16, s[8:11], s60 offen
    s_waitcnt lgkmcnt(4)
    v_mfma_f32_16x16x32_bf16 v[64:67], a[96:99], v[32:35], v[64:67]
    ds_read_b128 v[56:59], v17 offset:27648
    v_mfma_f32_16x16x32_bf16 v[68:71], a[100:103], v[32:35], v[68:71]
    v_mfma_f32_16x16x32_bf16 v[72:75], a[96:99], v[36:39], v[72:75]
    ds_read_b128 v[60:63], v18 offset:27648
    v_mfma_f32_16x16x32_bf16 v[76:79], a[100:103], v[36:39], v[76:79]
    s_waitcnt lgkmcnt(4)
    v_mfma_f32_16x16x32_bf16 v[64:67], a[104:107], v[40:43], v[64:67]
    s_waitcnt vmcnt(8)
    s_barrier
    ds_read_b128 v[32:35], v17 offset:32768
    v_mfma_f32_16x16x32_bf16 v[68:71], a[108:111], v[40:43], v[68:71]
    v_mfma_f32_16x16x32_bf16 v[72:75], a[104:107], v[44:47], v[72:75]
    ds_read_b128 v[36:39], v18 offset:32768
    v_mfma_f32_16x16x32_bf16 v[76:79], a[108:111], v[44:47], v[76:79]
    s_waitcnt lgkmcnt(4)
    v_mfma_f32_16x16x32_bf16 v[64:67], a[112:115], v[48:51], v[64:67]
    ds_read_b128 v[40:43], v17 offset:33792
    v_mfma_f32_16x16x32_bf16 v[68:71], a[116:119], v[48:51], v[68:71]
    v_mfma_f32_16x16x32_bf16 v[72:75], a[112:115], v[52:55], v[72:75]
    ds_read_b128 v[44:47], v18 offset:33792
    v_mfma_f32_16x16x32_bf16 v[76:79], a[116:119], v[52:55], v[76:79]
    s_waitcnt lgkmcnt(4)
    v_mfma_f32_16x16x32_bf16 v[64:67], a[120:123], v[56:59], v[64:67]
    ds_read_b128 v[48:51], v17 offset:34816
    v_mfma_f32_16x16x32_bf16 v[68:71], a[124:127], v[56:59], v[68:71]
    v_mfma_f32_16x16x32_bf16 v[72:75], a[120:123], v[60:63], v[72:75]
    ds_read_b128 v[52:55], v18 offset:34816
    v_mfma_f32_16x16x32_bf16 v[76:79], a[124:127], v[60:63], v[76:79]
    s_waitcnt lgkmcnt(4)
    v_mfma_f32_16x16x32_bf16 v[64:67], a[128:131], v[32:35], v[64:67]
    ds_read_b128 v[56:59], v17 offset:35840
    v_mfma_f32_16x16x32_bf16 v[68:71], a[132:135], v[32:35], v[68:71]
    v_mfma_f32_16x16x32_bf16 v[72:75], a[128:131], v[36:39], v[72:75]
    ds_read_b128 v[60:63], v18 offset:35840
    v_mfma_f32_16x16x32_bf16 v[76:79], a[132:135], v[36:39], v[76:79]
    s_waitcnt lgkmcnt(4)
    v_mfma_f32_16x16x32_bf16 v[64:67], a[136:139], v[40:43], v[64:67]
    ds_read_b128 v[32:35], v17 offset:40960
    v_mfma_f32_16x16x32_bf16 v[68:71], a[140:143], v[40:43], v[68:71]
    v_mfma_f32_16x16x32_bf16 v[72:75], a[136:139], v[44:47], v[72:75]
    ds_read_b128 v[36:39], v18 offset:40960
    v_mfma_f32_16x16x32_bf16 v[76:79], a[140:143], v[44:47], v[76:79]
    s_waitcnt lgkmcnt(4)
    v_mfma_f32_16x16x32_bf16 v[64:67], a[144:147], v[48:51], v[64:67]
    ds_read_b128 v[40:43], v17 offset:41984
    v_mfma_f32_16x16x32_bf16 v[68:71], a[148:151], v[48:51], v[68:71]
    v_mfma_f32_16x16x32_bf16 v[72:75], a[144:147], v[52:55], v[72:75]
    ds_read_b128 v[44:47], v18 offset:41984
    v_mfma_f32_16x16x32_bf16 v[76:79], a[148:151], v[52:55], v[76:79]
    s_waitcnt lgkmcnt(4)
    v_mfma_f32_16x16x32_bf16 v[64:67], a[152:155], v[56:59], v[64:67]
    ds_read_b128 v[48:51], v17 offset:43008
    v_mfma_f32_16x16x32_bf16 v[68:71], a[156:159], v[56:59], v[68:71]
    v_mfma_f32_16x16x32_bf16 v[72:75], a[152:155], v[60:63], v[72:75]
    ds_read_b128 v[52:55], v18 offset:43008
    v_mfma_f32_16x16x32_bf16 v[76:79], a[156:159], v[60:63], v[76:79]
    s_waitcnt lgkmcnt(4)
    v_mfma_f32_16x16x32_bf16 v[64:67], a[160:163], v[32:35], v[64:67]
    ds_read_b128 v[56:59], v17 offset:44032
    v_mfma_f32_16x16x32_bf16 v[68:71], a[164:167], v[32:35], v[68:71]
    v_mfma_f32_16x16x32_bf16 v[72:75], a[160:163], v[36:39], v[72:75]
    ds_read_b128 v[60:63], v18 offset:44032
    v_mfma_f32_16x16x32_bf16 v[76:79], a[164:167], v[36:39], v[76:79]
    s_waitcnt lgkmcnt(4)
    v_mfma_f32_16x16x32_bf16 v[64:67], a[168:171], v[40:43], v[64:67]
    s_waitcnt vmcnt(4)
    s_barrier
    ds_read_b128 v[32:35], v17 offset:49152
    v_mfma_f32_16x16x32_bf16 v[68:71], a[172:175], v[40:43], v[68:71]
    v_mfma_f32_16x16x32_bf16 v[72:75], a[168:171], v[44:47], v[72:75]
    ds_read_b128 v[36:39], v18 offset:49152
    v_mfma_f32_16x16x32_bf16 v[76:79], a[172:175], v[44:47], v[76:79]
    s_waitcnt lgkmcnt(4)
    v_mfma_f32_16x16x32_bf16 v[64:67], a[176:179], v[48:51], v[64:67]
    ds_read_b128 v[40:43], v17 offset:50176
    v_mfma_f32_16x16x32_bf16 v[68:71], a[180:183], v[48:51], v[68:71]
    v_mfma_f32_16x16x32_bf16 v[72:75], a[176:179], v[52:55], v[72:75]
    ds_read_b128 v[44:47], v18 offset:50176
    v_mfma_f32_16x16x32_bf16 v[76:79], a[180:183], v[52:55], v[76:79]
    s_waitcnt lgkmcnt(4)
    v_mfma_f32_16x16x32_bf16 v[64:67], a[184:187], v[56:59], v[64:67]
    ds_read_b128 v[48:51], v17 offset:51200
    v_mfma_f32_16x16x32_bf16 v[68:71], a[188:191], v[56:59], v[68:71]
    v_mfma_f32_16x16x32_bf16 v[72:75], a[184:187], v[60:63], v[72:75]
    ds_read_b128 v[52:55], v18 offset:51200
    v_mfma_f32_16x16x32_bf16 v[76:79], a[188:191], v[60:63], v[76:79]
    s_waitcnt lgkmcnt(4)
    v_mfma_f32_16x16x32_bf16 v[64:67], a[192:195], v[32:35], v[64:67]
    ds_read_b128 v[56:59], v17 offset:52224
    v_mfma_f32_16x16x32_bf16 v[68:71], a[196:199], v[32:35], v[68:71]
    v_mfma_f32_16x16x32_bf16 v[72:75], a[192:195], v[36:39], v[72:75]
    ds_read_b128 v[60:63], v18 offset:52224
    v_mfma_f32_16x16x32_bf16 v[76:79], a[196:199], v[36:39], v[76:79]
    s_waitcnt lgkmcnt(4)
    v_mfma_f32_16x16x32_bf16 v[64:67], a[200:203], v[40:43], v[64:67]
    ds_read_b128 v[32:35], v17 offset:57344
    v_mfma_f32_16x16x32_bf16 v[68:71], a[204:207], v[40:43], v[68:71]
    v_mfma_f32_16x16x32_bf16 v[72:75], a[200:203], v[44:47], v[72:75]
    ds_read_b128 v[36:39], v18 offset:57344
    v_mfma_f32_16x16x32_bf16 v[76:79], a[204:207], v[44:47], v[76:79]
    s_waitcnt lgkmcnt(4)
    v_mfma_f32_16x16x32_bf16 v[64:67], a[208:211], v[48:51], v[64:67]
    ds_read_b128 v[40:43], v17 offset:58368
    v_mfma_f32_16x16x32_bf16 v[68:71], a[212:215], v[48:51], v[68:71]
    v_mfma_f32_16x16x32_bf16 v[72:75], a[208:211], v[52:55], v[72:75]
    ds_read_b128 v[44:47], v18 offset:58368
    v_mfma_f32_16x16x32_bf16 v[76:79], a[212:215], v[52:55], v[76:79]
    s_waitcnt lgkmcnt(4)
    v_mfma_f32_16x16x32_bf16 v[64:67], a[216:219], v[56:59], v[64:67]
    ds_read_b128 v[48:51], v17 offset:59392
    v_mfma_f32_16x16x32_bf16 v[68:71], a[220:223], v[56:59], v[68:71]
    v_mfma_f32_16x16x32_bf16 v[72:75], a[216:219], v[60:63], v[72:75]
    ds_read_b128 v[52:55], v18 offset:59392
    v_mfma_f32_16x16x32_bf16 v[76:79], a[220:223], v[60:63], v[76:79]
    s_waitcnt lgkmcnt(4)
    v_mfma_f32_16x16x32_bf16 v[64:67], a[224:227], v[32:35], v[64:67]
    ds_read_b128 v[56:59], v17 offset:60416
    v_mfma_f32_16x16x32_bf16 v[68:71], a[228:231], v[32:35], v[68:71]
    v_mfma_f32_16x16x32_bf16 v[72:75], a[224:227], v[36:39], v[72:75]
    ds_read_b128 v[60:63], v18 offset:60416
    v_mfma_f32_16x16x32_bf16 v[76:79], a[228:231], v[36:39], v[76:79]
    s_waitcnt lgkmcnt(4)
    v_mfma_f32_16x16x32_bf16 v[64:67], a[232:235], v[40:43], v[64:67]
    v_mfma_f32_16x16x32_bf16 v[68:71], a[236:239], v[40:43], v[68:71]
    v_mfma_f32_16x16x32_bf16 v[72:75], a[232:235], v[44:47], v[72:75]
    v_mfma_f32_16x16x32_bf16 v[76:79], a[236:239], v[44:47], v[76:79]
    s_waitcnt lgkmcnt(2)
    v_mfma_f32_16x16x32_bf16 v[64:67], a[240:243], v[48:51], v[64:67]
    v_mfma_f32_16x16x32_bf16 v[68:71], a[244:247], v[48:51], v[68:71]
    v_mfma_f32_16x16x32_bf16 v[72:75], a[240:243], v[52:55], v[72:75]
    v_mfma_f32_16x16x32_bf16 v[76:79], a[244:247], v[52:55], v[76:79]
    s_waitcnt lgkmcnt(0)
    v_mfma_f32_16x16x32_bf16 v[64:67], a[248:251], v[56:59], v[64:67]
    v_mfma_f32_16x16x32_bf16 v[68:71], a[252:255], v[56:59], v[68:71]
    v_mfma_f32_16x16x32_bf16 v[72:75], a[248:251], v[60:63], v[72:75]
    v_mfma_f32_16x16x32_bf16 v[76:79], a[252:255], v[60:63], v[76:79]
    v_xor_b32 v17, 0x10000, v17
    v_xor_b32 v18, 0x10000, v18
    s_nop 3
    v_min_u32 v68, 0xfffffffe, v68
    buffer_store_dwordx4 v[68:71], v28, s[8:11], s51 offen sc1
    v_min_u32 v72, 0xfffffffe, v72
    buffer_store_dwordx4 v[72:75], v29, s[8:11], s51 offen sc1
    v_min_u32 v76, 0xfffffffe, v76
    buffer_store_dwordx4 v[76:79], v30, s[8:11], s51 offen sc1
    s_waitcnt vmcnt(3)
    v_sub_f32 v104, 1.0, v100
    v_cvt_pk_bf16_f32 v104, v104, v104
    v_lshlrev_b32 v104, 16, v104
    v_lshlrev_b32 v107, 16, v96
    v_and_b32 v108, 0xffff0000, v96
    v_lshlrev_b32 v109, 16, v98
    v_and_b32 v110, 0xffff0000, v98
    v_mul_f32 v107, v107, v109
    v_mul_f32 v108, v108, v110
    v_cvt_pk_bf16_f32 v107, v107, v108
    v_and_b32 v108, 0xffff0000, v107
    v_lshlrev_b32 v107, 16, v107
    v_mul_f32 v107, v100, v107
    v_mul_f32 v108, v100, v108
    v_cvt_pk_bf16_f32 v107, v107, v108
    v_and_b32 v113, 0xffff0000, v107
    v_lshlrev_b32 v112, 16, v107
    v_lshlrev_b32 v107, 16, v97
    v_and_b32 v108, 0xffff0000, v97
    v_lshlrev_b32 v109, 16, v99
    v_and_b32 v110, 0xffff0000, v99
    v_mul_f32 v107, v107, v109
    v_mul_f32 v108, v108, v110
    v_cvt_pk_bf16_f32 v107, v107, v108
    v_and_b32 v108, 0xffff0000, v107
    v_lshlrev_b32 v107, 16, v107
    v_mul_f32 v107, v100, v107
    v_mul_f32 v108, v100, v108
    v_cvt_pk_bf16_f32 v107, v107, v108
    v_and_b32 v115, 0xffff0000, v107
    v_lshlrev_b32 v114, 16, v107
    s_waitcnt vmcnt(0)
    buffer_load_dwordx4 v[84:87], v7, s[8:11], s51 offen sc1
    buffer_load_dwordx4 v[88:91], v8, s[8:11], s51 offen sc1
    buffer_load_dwordx4 v[92:95], v9, s[8:11], s51 offen sc1
    s_waitcnt vmcnt(0)
    s_mov_b32 s62, 0
.cc_462:
    v_max3_u32 v4, v84, v88, v92
    v_cmp_eq_u32 vcc, -1, v4
    s_cbranch_vccnz .cf_463
    v_add_f32 v84, v84, v88
    v_add_f32 v92, v64, v92
    v_add_f32 v85, v85, v89
    v_add_f32 v93, v65, v93
    v_add_f32 v86, v86, v90
    v_add_f32 v94, v66, v94
    v_add_f32 v87, v87, v91
    v_add_f32 v95, v67, v95
    v_add_f32 v84, v92, v84
    v_add_f32 v85, v93, v85
    v_add_f32 v86, v94, v86
    v_add_f32 v87, v95, v87
    v_cvt_pk_bf16_f32 v105, v84, v85
    v_cvt_pk_bf16_f32 v107, v86, v87
    v_and_b32 v106, 0xffff0000, v105
    v_lshlrev_b32 v105, 16, v105
    v_and_b32 v108, 0xffff0000, v107
    v_lshlrev_b32 v107, 16, v107
    v_mul_f32 v105, v104, v105
    v_mul_f32 v106, v104, v106
    v_mul_f32 v107, v104, v107
    v_mul_f32 v108, v104, v108
    v_cvt_pk_bf16_f32 v105, v105, v106
    v_cvt_pk_bf16_f32 v107, v107, v108
    v_and_b32 v106, 0xffff0000, v105
    v_lshlrev_b32 v105, 16, v105
    v_and_b32 v108, 0xffff0000, v107
    v_lshlrev_b32 v107, 16, v107
    v_add_f32 v105, v105, v112
    v_add_f32 v106, v106, v113
    v_add_f32 v107, v107, v114
    v_add_f32 v108, v108, v115
    v_cvt_pk_bf16_f32 v102, v105, v106
    v_cvt_pk_bf16_f32 v103, v107, v108
    buffer_store_dwordx2 v[102:103], v22, s[44:47], s52 offen
    s_branch .g2nx_431
.cf_434:
    buffer_load_dwordx4 v[84:87], v7, s[8:11], s51 offen sc1
    buffer_load_dwordx4 v[88:91], v8, s[8:11], s51 offen sc1
    buffer_load_dwordx4 v[92:95], v9, s[8:11], s51 offen sc1
    s_add_u32 s62, s62, 1
    s_cmp_gt_u32 s62, 0x400000
    s_cbranch_scc1 .mg_end_1
    s_waitcnt vmcnt(0)
    s_branch .cc_433

.cf_443:
    buffer_load_dwordx4 v[84:87], v7, s[8:11], s51 offen sc1
    buffer_load_dwordx4 v[88:91], v8, s[8:11], s51 offen sc1
    buffer_load_dwordx4 v[92:95], v9, s[8:11], s51 offen sc1
    s_add_u32 s62, s62, 1
    s_cmp_gt_u32 s62, 0x400000
    s_cbranch_scc1 .mg_end_1
    s_waitcnt vmcnt(0)
    s_branch .cc_442

.cf_453:
    buffer_load_dwordx4 v[84:87], v7, s[8:11], s51 offen sc1
    buffer_load_dwordx4 v[88:91], v8, s[8:11], s51 offen sc1
    buffer_load_dwordx4 v[92:95], v9, s[8:11], s51 offen sc1
    s_add_u32 s62, s62, 1
    s_cmp_gt_u32 s62, 0x400000
    s_cbranch_scc1 .mg_end_1
    s_waitcnt vmcnt(0)
    s_branch .cc_452

.cf_455:
    buffer_load_dwordx4 v[84:87], v7, s[8:11], s51 offen sc1
    buffer_load_dwordx4 v[88:91], v8, s[8:11], s51 offen sc1
    buffer_load_dwordx4 v[92:95], v9, s[8:11], s51 offen sc1
    s_add_u32 s62, s62, 1
    s_cmp_gt_u32 s62, 0x400000
    s_cbranch_scc1 .mg_end_1
    s_waitcnt vmcnt(0)
    s_branch .cc_454

.cf_461:
    buffer_load_dwordx4 v[84:87], v7, s[8:11], s51 offen sc1
    buffer_load_dwordx4 v[88:91], v8, s[8:11], s51 offen sc1
    buffer_load_dwordx4 v[92:95], v9, s[8:11], s51 offen sc1
    s_add_u32 s62, s62, 1
    s_cmp_gt_u32 s62, 0x400000
    s_cbranch_scc1 .mg_end_1
    s_waitcnt vmcnt(0)
    s_branch .cc_460

.cf_463:
    buffer_load_dwordx4 v[84:87], v7, s[8:11], s51 offen sc1
    buffer_load_dwordx4 v[88:91], v8, s[8:11], s51 offen sc1
    buffer_load_dwordx4 v[92:95], v9, s[8:11], s51 offen sc1
    s_add_u32 s62, s62, 1
    s_cmp_gt_u32 s62, 0x400000
    s_cbranch_scc1 .mg_end_1
    s_waitcnt vmcnt(0)
    s_branch .cc_462

.g2fin_426:
    s_endpgm
.cvrole_380:
    s_lshl_b32 s4, s91, 3
    s_add_u32 s4, s4, s26
    s_add_u32 s4, s4, 72
    s_lshl_b32 s4, s4, 8
    s_add_u32 s92, s4, 92274688
    s_lshl_b32 s4, s24, 2
    s_add_u32 s92, s92, s4
    v_mov_b32 v4, 0
    s_mov_b64 exec, 1
    buffer_store_dword v4, v4, s[8:11], s92 offen sc1
    s_mov_b64 exec, -1

    s_waitcnt vmcnt(0)
    s_barrier
    v_mov_b32 v243, s99
    v_mov_b32 v242, 0
    s_cmp_lg_u32 s24, 0
    s_cbranch_scc1 .a1_464
    v_mov_b32 v242, s26
    v_lshlrev_b32 v242, 6, v242
    v_add_u32 v242, s97, v242
    v_and_b32 v242, 255, v242
    s_mov_b64 exec, 1
    buffer_atomic_add v243, v242, s[20:23], 0 offen sc1
    s_mov_b64 exec, -1

.a1_464:
    s_waitcnt vmcnt(0)
    s_cmp_lg_u32 s24, 0
    s_cbranch_scc1 .pm_466
    s_lshl_b32 s93, s91, 3
    s_add_u32 s93, s93, s26
    s_sub_u32 s93, s93, 24
    s_and_b32 s94, s93, 1
    s_sub_u32 s5, 0, s100
    s_and_b32 s5, s5, 0x1fffff
    s_add_u32 s5, s5, 100663296
    s_lshl_b32 s4, s94, 21
    s_add_u32 s5, s5, s4
    s_lshl_b32 s4, s93, 8
    s_add_u32 s5, s5, s4
    s_add_u32 s6, s5, 8192
    v_and_b32 v4, 63, v0
    v_lshlrev_b32 v4, 2, v4
    v_mov_b32 v5, -1
    s_mov_b32 s82, 0x7fffffff
    s_mov_b32 s83, 0x7fffffff
    buffer_store_dword v5, v4, s[8:11], s5 offen sc1
    s_waitcnt vmcnt(0)

    s_memtime s[72:73]
    s_waitcnt lgkmcnt(0)
    buffer_store_dword v5, v4, s[8:11], s6 offen sc1
    s_waitcnt vmcnt(0)
    s_memtime s[84:85]
    s_waitcnt lgkmcnt(0)
    s_sub_u32 s84, s84, s72
    s_min_u32 s83, s83, s84

    s_memtime s[72:73]
    s_waitcnt lgkmcnt(0)
    buffer_store_dword v5, v4, s[8:11], s5 offen sc1
    s_waitcnt vmcnt(0)
    s_memtime s[84:85]
    s_waitcnt lgkmcnt(0)
    s_sub_u32 s84, s84, s72
    s_min_u32 s82, s82, s84

    s_memtime s[72:73]
    s_waitcnt lgkmcnt(0)
    buffer_store_dword v5, v4, s[8:11], s6 offen sc1
    s_waitcnt vmcnt(0)
    s_memtime s[84:85]
    s_waitcnt lgkmcnt(0)
    s_sub_u32 s84, s84, s72
    s_min_u32 s83, s83, s84

    s_memtime s[72:73]
    s_waitcnt lgkmcnt(0)
    buffer_store_dword v5, v4, s[8:11], s5 offen sc1
    s_waitcnt vmcnt(0)
    s_memtime s[84:85]
    s_waitcnt lgkmcnt(0)
    s_sub_u32 s84, s84, s72
    s_min_u32 s82, s82, s84

    s_memtime s[72:73]
    s_waitcnt lgkmcnt(0)
    buffer_store_dword v5, v4, s[8:11], s6 offen sc1
    s_waitcnt vmcnt(0)
    s_memtime s[84:85]
    s_waitcnt lgkmcnt(0)
    s_sub_u32 s84, s84, s72
    s_min_u32 s83, s83, s84

    s_memtime s[72:73]
    s_waitcnt lgkmcnt(0)
    buffer_store_dword v5, v4, s[8:11], s5 offen sc1
    s_waitcnt vmcnt(0)
    s_memtime s[84:85]
    s_waitcnt lgkmcnt(0)
    s_sub_u32 s84, s84, s72
    s_min_u32 s82, s82, s84

    s_memtime s[72:73]
    s_waitcnt lgkmcnt(0)
    buffer_store_dword v5, v4, s[8:11], s6 offen sc1
    s_waitcnt vmcnt(0)
    s_memtime s[84:85]
    s_waitcnt lgkmcnt(0)
    s_sub_u32 s84, s84, s72
    s_min_u32 s83, s83, s84

    s_memtime s[72:73]
    s_waitcnt lgkmcnt(0)
    buffer_store_dword v5, v4, s[8:11], s5 offen sc1
    s_waitcnt vmcnt(0)
    s_memtime s[84:85]
    s_waitcnt lgkmcnt(0)
    s_sub_u32 s84, s84, s72
    s_min_u32 s82, s82, s84

    s_cmp_lt_u32 s82, s83
    s_cselect_b32 s4, 1, 0
    s_mul_i32 s94, s94, 6
    s_lshl_b32 s4, s4, s94
    s_add_u32 s95, s4, 0x1000000

.pm_466:
    s_cmp_lg_u32 s24, 0
    s_cbranch_scc1 .pv_467
    s_mov_b64 exec, 1
    v_mov_b32 v4, s95
    v_mov_b32 v5, 4
    buffer_atomic_add v4, v5, s[20:23], s97 offen sc1
    s_mov_b64 exec, -1

.pv_467:
    s_barrier
    s_lshl_b32 s93, s91, 3
    s_add_u32 s93, s93, s26
    s_sub_u32 s93, s93, 24

    s_load_dwordx2 s[40:41], s[0:1], 0
    s_load_dwordx2 s[42:43], s[0:1], 104

    v_and_b32 v1, 63, v0
    v_and_b32 v2, 15, v1
    v_lshrrev_b32 v3, 4, v1

    s_waitcnt lgkmcnt(0)
    s_mov_b32 s12, s40
    s_and_b32 s13, s41, 0xffff
    s_mov_b32 s14, 0x400000
    s_mov_b32 s15, 0x00020000

    s_mov_b32 s16, s42
    s_and_b32 s17, s43, 0xffff
    s_mov_b32 s18, 0x800
    s_mov_b32 s19, 0x00020000

    s_lshl_b32 s3, s93, 6
    s_lshl_b32 s4, s24, 4
    s_add_u32 s3, s3, s4
    v_lshlrev_b32 v8, 4, v1
    buffer_load_dwordx4 v[16:19], v8, s[16:19], 0 offen
    buffer_load_dwordx4 v[20:23], v8, s[16:19], 0 offen offset:1024
    s_lshl_b32 s5, s3, 11

    buffer_load_dwordx4 v[64:67], v8, s[12:15], s5 offen
    buffer_load_dwordx4 v[68:71], v8, s[12:15], s5 offen offset:1024
    s_add_u32 s5, s5, 2048

    buffer_load_dwordx4 v[72:75], v8, s[12:15], s5 offen
    buffer_load_dwordx4 v[76:79], v8, s[12:15], s5 offen offset:1024
    s_add_u32 s5, s5, 2048

    buffer_load_dwordx4 v[80:83], v8, s[12:15], s5 offen
    buffer_load_dwordx4 v[84:87], v8, s[12:15], s5 offen offset:1024
    s_add_u32 s5, s5, 2048

    buffer_load_dwordx4 v[88:91], v8, s[12:15], s5 offen
    buffer_load_dwordx4 v[92:95], v8, s[12:15], s5 offen offset:1024
    s_add_u32 s5, s5, 2048

    buffer_load_dwordx4 v[96:99], v8, s[12:15], s5 offen
    buffer_load_dwordx4 v[100:103], v8, s[12:15], s5 offen offset:1024
    s_add_u32 s5, s5, 2048

    buffer_load_dwordx4 v[104:107], v8, s[12:15], s5 offen
    buffer_load_dwordx4 v[108:111], v8, s[12:15], s5 offen offset:1024
    s_add_u32 s5, s5, 2048

    buffer_load_dwordx4 v[112:115], v8, s[12:15], s5 offen
    buffer_load_dwordx4 v[116:119], v8, s[12:15], s5 offen offset:1024
    s_add_u32 s5, s5, 2048

    buffer_load_dwordx4 v[120:123], v8, s[12:15], s5 offen
    buffer_load_dwordx4 v[124:127], v8, s[12:15], s5 offen offset:1024
    s_add_u32 s5, s5, 2048

    buffer_load_dwordx4 v[128:131], v8, s[12:15], s5 offen
    buffer_load_dwordx4 v[132:135], v8, s[12:15], s5 offen offset:1024
    s_add_u32 s5, s5, 2048

    buffer_load_dwordx4 v[136:139], v8, s[12:15], s5 offen
    buffer_load_dwordx4 v[140:143], v8, s[12:15], s5 offen offset:1024
    s_add_u32 s5, s5, 2048

    buffer_load_dwordx4 v[144:147], v8, s[12:15], s5 offen
    buffer_load_dwordx4 v[148:151], v8, s[12:15], s5 offen offset:1024
    s_add_u32 s5, s5, 2048

    buffer_load_dwordx4 v[152:155], v8, s[12:15], s5 offen
    buffer_load_dwordx4 v[156:159], v8, s[12:15], s5 offen offset:1024
    s_add_u32 s5, s5, 2048

    buffer_load_dwordx4 v[160:163], v8, s[12:15], s5 offen
    buffer_load_dwordx4 v[164:167], v8, s[12:15], s5 offen offset:1024
    s_add_u32 s5, s5, 2048

    buffer_load_dwordx4 v[168:171], v8, s[12:15], s5 offen
    buffer_load_dwordx4 v[172:175], v8, s[12:15], s5 offen offset:1024
    s_add_u32 s5, s5, 2048

    buffer_load_dwordx4 v[176:179], v8, s[12:15], s5 offen
    buffer_load_dwordx4 v[180:183], v8, s[12:15], s5 offen offset:1024
    s_add_u32 s5, s5, 2048

    buffer_load_dwordx4 v[184:187], v8, s[12:15], s5 offen
    buffer_load_dwordx4 v[188:191], v8, s[12:15], s5 offen offset:1024
    s_add_u32 s5, s5, 2048

    v_and_b32 v241, 3, v0
    v_lshlrev_b32 v241, 2, v241

    v_and_b32 v240, 12, v0
    v_lshl_add_u32 v241, v240, 4, v241
    v_add_u32 v241, s97, v241
    v_and_b32 v241, 255, v241

    buffer_load_dword v240, v241, s[20:23], 0 offen sc1
    s_load_dwordx4 s[52:55], s[0:1], 8
    s_load_dwordx2 s[56:57], s[0:1], 32
    v_and_b32 v9, 63, v0
    v_lshlrev_b32 v9, 7, v9
    s_lshl_b32 s6, s93, 17
    s_lshl_b32 s7, s24, 15
    s_add_u32 s6, s6, s7
    s_waitcnt lgkmcnt(0)

    s_mov_b32 s80, s52
    s_and_b32 s81, s53, 0xffff
    s_mov_b32 s82, 0x400000
    s_mov_b32 s83, 0x00020000

    s_add_u32 s7, s6, 0
    buffer_load_dword v250, v9, s[80:83], s7 offen
    s_add_u32 s7, s6, 8192
    buffer_load_dword v250, v9, s[80:83], s7 offen
    s_add_u32 s7, s6, 16384
    buffer_load_dword v250, v9, s[80:83], s7 offen
    s_add_u32 s7, s6, 24576
    buffer_load_dword v250, v9, s[80:83], s7 offen
    s_mov_b32 s80, s54
    s_and_b32 s81, s55, 0xffff
    s_mov_b32 s82, 0x400000
    s_mov_b32 s83, 0x00020000

    s_add_u32 s7, s6, 0
    buffer_load_dword v250, v9, s[80:83], s7 offen
    s_add_u32 s7, s6, 8192
    buffer_load_dword v250, v9, s[80:83], s7 offen
    s_add_u32 s7, s6, 16384
    buffer_load_dword v250, v9, s[80:83], s7 offen
    s_add_u32 s7, s6, 24576
    buffer_load_dword v250, v9, s[80:83], s7 offen
    s_mov_b32 s80, s56
    s_and_b32 s81, s57, 0xffff
    s_mov_b32 s82, 0x400000
    s_mov_b32 s83, 0x00020000

    s_add_u32 s7, s6, 0
    buffer_load_dword v250, v9, s[80:83], s7 offen
    s_add_u32 s7, s6, 8192
    buffer_load_dword v250, v9, s[80:83], s7 offen
    s_add_u32 s7, s6, 16384
    buffer_load_dword v250, v9, s[80:83], s7 offen
    s_add_u32 s7, s6, 24576
    buffer_load_dword v250, v9, s[80:83], s7 offen
    s_waitcnt vmcnt(41)
    v_dot2_f32_bf16 v24, v64, v16, 0
    v_dot2_f32_bf16 v25, v72, v16, 0
    v_dot2_f32_bf16 v24, v65, v17, v24
    v_dot2_f32_bf16 v25, v73, v17, v25
    v_dot2_f32_bf16 v24, v66, v18, v24
    v_dot2_f32_bf16 v25, v74, v18, v25
    v_dot2_f32_bf16 v24, v67, v19, v24
    v_dot2_f32_bf16 v25, v75, v19, v25
    v_dot2_f32_bf16 v24, v68, v20, v24
    v_dot2_f32_bf16 v25, v76, v20, v25
    v_dot2_f32_bf16 v24, v69, v21, v24
    v_dot2_f32_bf16 v25, v77, v21, v25
    v_dot2_f32_bf16 v24, v70, v22, v24
    v_dot2_f32_bf16 v25, v78, v22, v25
    v_dot2_f32_bf16 v24, v71, v23, v24
    v_dot2_f32_bf16 v25, v79, v23, v25
    s_waitcnt vmcnt(37)
    v_dot2_f32_bf16 v26, v80, v16, 0
    v_dot2_f32_bf16 v27, v88, v16, 0
    v_dot2_f32_bf16 v26, v81, v17, v26
    v_dot2_f32_bf16 v27, v89, v17, v27
    v_dot2_f32_bf16 v26, v82, v18, v26
    v_dot2_f32_bf16 v27, v90, v18, v27
    v_dot2_f32_bf16 v26, v83, v19, v26
    v_dot2_f32_bf16 v27, v91, v19, v27
    v_dot2_f32_bf16 v26, v84, v20, v26
    v_dot2_f32_bf16 v27, v92, v20, v27
    v_dot2_f32_bf16 v26, v85, v21, v26
    v_dot2_f32_bf16 v27, v93, v21, v27
    v_dot2_f32_bf16 v26, v86, v22, v26
    v_dot2_f32_bf16 v27, v94, v22, v27
    v_dot2_f32_bf16 v26, v87, v23, v26
    v_dot2_f32_bf16 v27, v95, v23, v27
    s_waitcnt vmcnt(33)
    v_dot2_f32_bf16 v28, v96, v16, 0
    v_dot2_f32_bf16 v29, v104, v16, 0
    v_dot2_f32_bf16 v28, v97, v17, v28
    v_dot2_f32_bf16 v29, v105, v17, v29
    v_dot2_f32_bf16 v28, v98, v18, v28
    v_dot2_f32_bf16 v29, v106, v18, v29
    v_dot2_f32_bf16 v28, v99, v19, v28
    v_dot2_f32_bf16 v29, v107, v19, v29
    v_dot2_f32_bf16 v28, v100, v20, v28
    v_dot2_f32_bf16 v29, v108, v20, v29
    v_dot2_f32_bf16 v28, v101, v21, v28
    v_dot2_f32_bf16 v29, v109, v21, v29
    v_dot2_f32_bf16 v28, v102, v22, v28
    v_dot2_f32_bf16 v29, v110, v22, v29
    v_dot2_f32_bf16 v28, v103, v23, v28
    v_dot2_f32_bf16 v29, v111, v23, v29
    s_waitcnt vmcnt(29)
    v_dot2_f32_bf16 v30, v112, v16, 0
    v_dot2_f32_bf16 v31, v120, v16, 0
    v_dot2_f32_bf16 v30, v113, v17, v30
    v_dot2_f32_bf16 v31, v121, v17, v31
    v_dot2_f32_bf16 v30, v114, v18, v30
    v_dot2_f32_bf16 v31, v122, v18, v31
    v_dot2_f32_bf16 v30, v115, v19, v30
    v_dot2_f32_bf16 v31, v123, v19, v31
    v_dot2_f32_bf16 v30, v116, v20, v30
    v_dot2_f32_bf16 v31, v124, v20, v31
    v_dot2_f32_bf16 v30, v117, v21, v30
    v_dot2_f32_bf16 v31, v125, v21, v31
    v_dot2_f32_bf16 v30, v118, v22, v30
    v_dot2_f32_bf16 v31, v126, v22, v31
    v_dot2_f32_bf16 v30, v119, v23, v30
    v_dot2_f32_bf16 v31, v127, v23, v31
    s_waitcnt vmcnt(25)
    v_dot2_f32_bf16 v32, v128, v16, 0
    v_dot2_f32_bf16 v33, v136, v16, 0
    v_dot2_f32_bf16 v32, v129, v17, v32
    v_dot2_f32_bf16 v33, v137, v17, v33
    v_dot2_f32_bf16 v32, v130, v18, v32
    v_dot2_f32_bf16 v33, v138, v18, v33
    v_dot2_f32_bf16 v32, v131, v19, v32
    v_dot2_f32_bf16 v33, v139, v19, v33
    v_dot2_f32_bf16 v32, v132, v20, v32
    v_dot2_f32_bf16 v33, v140, v20, v33
    v_dot2_f32_bf16 v32, v133, v21, v32
    v_dot2_f32_bf16 v33, v141, v21, v33
    v_dot2_f32_bf16 v32, v134, v22, v32
    v_dot2_f32_bf16 v33, v142, v22, v33
    v_dot2_f32_bf16 v32, v135, v23, v32
    v_dot2_f32_bf16 v33, v143, v23, v33
    s_waitcnt vmcnt(21)
    v_dot2_f32_bf16 v34, v144, v16, 0
    v_dot2_f32_bf16 v35, v152, v16, 0
    v_dot2_f32_bf16 v34, v145, v17, v34
    v_dot2_f32_bf16 v35, v153, v17, v35
    v_dot2_f32_bf16 v34, v146, v18, v34
    v_dot2_f32_bf16 v35, v154, v18, v35
    v_dot2_f32_bf16 v34, v147, v19, v34
    v_dot2_f32_bf16 v35, v155, v19, v35
    v_dot2_f32_bf16 v34, v148, v20, v34
    v_dot2_f32_bf16 v35, v156, v20, v35
    v_dot2_f32_bf16 v34, v149, v21, v34
    v_dot2_f32_bf16 v35, v157, v21, v35
    v_dot2_f32_bf16 v34, v150, v22, v34
    v_dot2_f32_bf16 v35, v158, v22, v35
    v_dot2_f32_bf16 v34, v151, v23, v34
    v_dot2_f32_bf16 v35, v159, v23, v35
    s_waitcnt vmcnt(17)
    v_dot2_f32_bf16 v36, v160, v16, 0
    v_dot2_f32_bf16 v37, v168, v16, 0
    v_dot2_f32_bf16 v36, v161, v17, v36
    v_dot2_f32_bf16 v37, v169, v17, v37
    v_dot2_f32_bf16 v36, v162, v18, v36
    v_dot2_f32_bf16 v37, v170, v18, v37
    v_dot2_f32_bf16 v36, v163, v19, v36
    v_dot2_f32_bf16 v37, v171, v19, v37
    v_dot2_f32_bf16 v36, v164, v20, v36
    v_dot2_f32_bf16 v37, v172, v20, v37
    v_dot2_f32_bf16 v36, v165, v21, v36
    v_dot2_f32_bf16 v37, v173, v21, v37
    v_dot2_f32_bf16 v36, v166, v22, v36
    v_dot2_f32_bf16 v37, v174, v22, v37
    v_dot2_f32_bf16 v36, v167, v23, v36
    v_dot2_f32_bf16 v37, v175, v23, v37
    s_waitcnt vmcnt(13)
    v_dot2_f32_bf16 v38, v176, v16, 0
    v_dot2_f32_bf16 v39, v184, v16, 0
    v_dot2_f32_bf16 v38, v177, v17, v38
    v_dot2_f32_bf16 v39, v185, v17, v39
    v_dot2_f32_bf16 v38, v178, v18, v38
    v_dot2_f32_bf16 v39, v186, v18, v39
    v_dot2_f32_bf16 v38, v179, v19, v38
    v_dot2_f32_bf16 v39, v187, v19, v39
    v_dot2_f32_bf16 v38, v180, v20, v38
    v_dot2_f32_bf16 v39, v188, v20, v39
    v_dot2_f32_bf16 v38, v181, v21, v38
    v_dot2_f32_bf16 v39, v189, v21, v39
    v_dot2_f32_bf16 v38, v182, v22, v38
    v_dot2_f32_bf16 v39, v190, v22, v39
    v_dot2_f32_bf16 v38, v183, v23, v38
    v_dot2_f32_bf16 v39, v191, v23, v39
    s_waitcnt vmcnt(12)
    s_mov_b32 s62, 0
.vp_468:
    v_readlane_b32 s4, v240, 0
    v_readlane_b32 s7, v240, 1
    v_readlane_b32 s6, v240, 2

    v_readlane_b32 s5, v240, 4
    s_add_u32 s4, s4, s5
    v_readlane_b32 s5, v240, 8
    s_add_u32 s4, s4, s5
    v_readlane_b32 s5, v240, 12
    s_add_u32 s4, s4, s5
    s_cmp_ge_u32 s4, 256
    s_cbranch_scc1 .vd_469
    s_cmp_lg_u32 s6, 0
    s_cbranch_scc1 .vs_470
    s_add_u32 s62, s62, 1
    s_cmp_gt_u32 s62, 0x100000
    s_cbranch_scc1 .mg_end_1
    s_sleep 8
    buffer_load_dword v240, v241, s[20:23], 0 offen sc1
    s_waitcnt vmcnt(0)
    s_branch .vp_468

.vs_470:
    s_lshr_b32 s25, s2, 5
    s_and_b32 s26, s2, 31
    s_mov_b32 s27, 1
    s_mov_b32 s99, 1
    s_mov_b32 s97, 144
    s_waitcnt vmcnt(0) lgkmcnt(0)
    s_barrier
    s_branch .mg_role_3

.vd_469:
    v_permlane32_swap_b32 v24, v26
    v_permlane32_swap_b32 v25, v27
    v_permlane32_swap_b32 v28, v30
    v_permlane32_swap_b32 v29, v31
    v_permlane32_swap_b32 v32, v34
    v_permlane32_swap_b32 v33, v35
    v_permlane32_swap_b32 v36, v38
    v_permlane32_swap_b32 v37, v39
    v_add_f32 v24, v24, v26
    v_add_f32 v25, v25, v27
    v_add_f32 v28, v28, v30
    v_add_f32 v29, v29, v31
    v_add_f32 v32, v32, v34
    v_add_f32 v33, v33, v35
    v_add_f32 v36, v36, v38
    v_add_f32 v37, v37, v39
    s_nop 0
    v_permlane16_swap_b32 v24, v25
    v_permlane16_swap_b32 v28, v29
    v_permlane16_swap_b32 v32, v33
    v_permlane16_swap_b32 v36, v37
    v_add_f32 v24, v24, v25
    v_add_f32 v28, v28, v29
    v_add_f32 v32, v32, v33
    v_add_f32 v36, v36, v37
    v_add_f32_dpp v24, v24, v24 row_ror:8 row_mask:0xf bank_mask:0xf
    v_add_f32_dpp v28, v28, v28 row_ror:8 row_mask:0xf bank_mask:0xf
    v_add_f32_dpp v32, v32, v32 row_ror:8 row_mask:0xf bank_mask:0xf
    v_add_f32_dpp v36, v36, v36 row_ror:8 row_mask:0xf bank_mask:0xf
    v_add_f32_dpp v24, v24, v24 row_ror:4 row_mask:0xf bank_mask:0xf
    v_add_f32_dpp v28, v28, v28 row_ror:4 row_mask:0xf bank_mask:0xf
    v_add_f32_dpp v32, v32, v32 row_ror:4 row_mask:0xf bank_mask:0xf
    v_add_f32_dpp v36, v36, v36 row_ror:4 row_mask:0xf bank_mask:0xf
    v_add_f32_dpp v24, v24, v24 row_ror:2 row_mask:0xf bank_mask:0xf
    v_add_f32_dpp v28, v28, v28 row_ror:2 row_mask:0xf bank_mask:0xf
    v_add_f32_dpp v32, v32, v32 row_ror:2 row_mask:0xf bank_mask:0xf
    v_add_f32_dpp v36, v36, v36 row_ror:2 row_mask:0xf bank_mask:0xf
    v_add_f32_dpp v24, v24, v24 row_ror:1 row_mask:0xf bank_mask:0xf
    v_add_f32_dpp v28, v28, v28 row_ror:1 row_mask:0xf bank_mask:0xf
    v_add_f32_dpp v32, v32, v32 row_ror:1 row_mask:0xf bank_mask:0xf
    v_add_f32_dpp v36, v36, v36 row_ror:1 row_mask:0xf bank_mask:0xf
    v_cmp_eq_u32 vcc, 1, v2
    s_nop 1
    v_cndmask_b32 v24, v24, v28, vcc
    v_cmp_eq_u32 vcc, 2, v2
    s_nop 1
    v_cndmask_b32 v24, v24, v32, vcc
    v_cmp_eq_u32 vcc, 3, v2
    s_nop 1
    v_cndmask_b32 v24, v24, v36, vcc
    v_cvt_pk_bf16_f32 v24, v24, v24
    s_mov_b32 s38, 0xbfb8aa3b
    v_lshlrev_b32 v24, 16, v24
    v_mul_f32 v24, s38, v24
    v_exp_f32 v24, v24
    v_lshlrev_b32 v8, 4, v2
    v_add_f32 v24, 1.0, v24
    v_rcp_f32 v24, v24
    v_lshl_add_u32 v8, v3, 2, v8
    v_cvt_pk_bf16_f32 v24, v24, v24
    v_cmp_gt_u32 vcc, 4, v2
    s_lshl_b32 s5, s3, 2
    s_add_u32 s5, s5, 121634816
    v_lshlrev_b32 v24, 16, v24
    s_mov_b64 exec, vcc
    buffer_store_dword v24, v8, s[8:11], s5 offen sc1
    s_mov_b64 exec, -1

    s_load_dwordx4 s[52:55], s[0:1], 8
    s_load_dwordx2 s[56:57], s[0:1], 24

    v_and_b32 v1, 63, v0
    v_and_b32 v2, 15, v1
    v_lshrrev_b32 v3, 4, v1

    v_lshrrev_b32 v4, 2, v1
    v_and_b32 v5, 3, v1
    v_lshlrev_b32 v10, 11, v4
    v_lshl_add_u32 v10, v5, 4, v10
    s_lshl_b32 s4, s93, 6
    v_add_u32 v10, s4, v10
    s_lshl_b32 s70, s24, 20
    s_mul_i32 s71, s24, 33280
    v_lshrrev_b32 v4, 2, v2
    v_lshl_add_u32 v4, v3, 5, v4
    v_lshlrev_b32 v4, 6, v4
    v_lshl_add_u32 v11, v5, 3, v4
    v_add_u32 v11, s71, v11
    s_lshl_b32 s4, s93, 17
    s_lshl_b32 s5, s24, 8
    s_add_u32 s72, s4, s5
    s_add_u32 s72, s72, 125829120
    v_lshlrev_b32 v12, 12, v2
    v_lshl_add_u32 v12, v3, 4, v12
    v_lshlrev_b32 v13, 3, v2
    s_lshl_b32 s6, s93, 8
    s_waitcnt lgkmcnt(0)

    s_mov_b32 s80, s52
    s_and_b32 s81, s53, 0xffff
    s_mov_b32 s82, 0x400000
    s_mov_b32 s83, 0x00020000

    s_mov_b32 s84, s54
    s_and_b32 s85, s55, 0xffff
    s_mov_b32 s86, 0x400000
    s_mov_b32 s87, 0x00020000

    s_mov_b32 s76, s56
    s_and_b32 s77, s57, 0xffff
    s_mov_b32 s78, 0x2000
    s_mov_b32 s79, 0x00020000

    buffer_load_dwordx2 v[196:197], v13, s[76:79], s6 offen
    buffer_load_dwordx2 v[198:199], v13, s[76:79], s6 offen offset:128

    s_add_u32 s4, s70, 0
    s_add_u32 m0, s71, 0
    s_sub_u32 s5, s4, 8192
    s_max_i32 s5, s5, 0
    s_mov_b64 exec, 0xffff
    buffer_load_dwordx4 v10, s[80:83], s5 offen lds
    s_mov_b64 exec, -1

    s_add_u32 m0, s71, 256
    s_nop 0
    buffer_load_dwordx4 v10, s[80:83], s4 offen lds
    s_add_u32 m0, s71, 8448
    s_nop 0
    buffer_load_dwordx4 v10, s[84:87], s4 offen lds
    s_add_u32 m0, s71, 1280
    s_add_u32 s4, s4, 32768
    buffer_load_dwordx4 v10, s[80:83], s4 offen lds
    s_add_u32 m0, s71, 9472
    s_nop 0
    buffer_load_dwordx4 v10, s[84:87], s4 offen lds
    s_add_u32 m0, s71, 2304
    s_add_u32 s4, s4, 32768
    buffer_load_dwordx4 v10, s[80:83], s4 offen lds
    s_add_u32 m0, s71, 10496
    s_nop 0
    buffer_load_dwordx4 v10, s[84:87], s4 offen lds
    s_add_u32 m0, s71, 3328
    s_add_u32 s4, s4, 32768
    buffer_load_dwordx4 v10, s[80:83], s4 offen lds
    s_add_u32 m0, s71, 11520
    s_nop 0
    buffer_load_dwordx4 v10, s[84:87], s4 offen lds
    s_add_u32 m0, s71, 4352
    s_add_u32 s4, s4, 32768
    buffer_load_dwordx4 v10, s[80:83], s4 offen lds
    s_add_u32 m0, s71, 12544
    s_nop 0
    buffer_load_dwordx4 v10, s[84:87], s4 offen lds
    s_add_u32 m0, s71, 5376
    s_add_u32 s4, s4, 32768
    buffer_load_dwordx4 v10, s[80:83], s4 offen lds
    s_add_u32 m0, s71, 13568
    s_nop 0
    buffer_load_dwordx4 v10, s[84:87], s4 offen lds
    s_add_u32 m0, s71, 6400
    s_add_u32 s4, s4, 32768
    buffer_load_dwordx4 v10, s[80:83], s4 offen lds
    s_add_u32 m0, s71, 14592
    s_nop 0
    buffer_load_dwordx4 v10, s[84:87], s4 offen lds
    s_add_u32 m0, s71, 7424
    s_add_u32 s4, s4, 32768
    buffer_load_dwordx4 v10, s[80:83], s4 offen lds
    s_add_u32 m0, s71, 15616
    s_nop 0
    buffer_load_dwordx4 v10, s[84:87], s4 offen lds
    s_add_u32 s4, s70, 262144
    s_add_u32 m0, s71, 16640
    s_sub_u32 s5, s4, 8192
    s_max_i32 s5, s5, 0
    s_mov_b64 exec, 0xffff
    buffer_load_dwordx4 v10, s[80:83], s5 offen lds
    s_mov_b64 exec, -1

    s_add_u32 m0, s71, 16896
    s_nop 0
    buffer_load_dwordx4 v10, s[80:83], s4 offen lds
    s_add_u32 m0, s71, 25088
    s_nop 0
    buffer_load_dwordx4 v10, s[84:87], s4 offen lds
    s_add_u32 m0, s71, 17920
    s_add_u32 s4, s4, 32768
    buffer_load_dwordx4 v10, s[80:83], s4 offen lds
    s_add_u32 m0, s71, 26112
    s_nop 0
    buffer_load_dwordx4 v10, s[84:87], s4 offen lds
    s_add_u32 m0, s71, 18944
    s_add_u32 s4, s4, 32768
    buffer_load_dwordx4 v10, s[80:83], s4 offen lds
    s_add_u32 m0, s71, 27136
    s_nop 0
    buffer_load_dwordx4 v10, s[84:87], s4 offen lds
    s_add_u32 m0, s71, 19968
    s_add_u32 s4, s4, 32768
    buffer_load_dwordx4 v10, s[80:83], s4 offen lds
    s_add_u32 m0, s71, 28160
    s_nop 0
    buffer_load_dwordx4 v10, s[84:87], s4 offen lds
    s_add_u32 m0, s71, 20992
    s_add_u32 s4, s4, 32768
    buffer_load_dwordx4 v10, s[80:83], s4 offen lds
    s_add_u32 m0, s71, 29184
    s_nop 0
    buffer_load_dwordx4 v10, s[84:87], s4 offen lds
    s_add_u32 m0, s71, 22016
    s_add_u32 s4, s4, 32768
    buffer_load_dwordx4 v10, s[80:83], s4 offen lds
    s_add_u32 m0, s71, 30208
    s_nop 0
    buffer_load_dwordx4 v10, s[84:87], s4 offen lds
    s_add_u32 m0, s71, 23040
    s_add_u32 s4, s4, 32768
    buffer_load_dwordx4 v10, s[80:83], s4 offen lds
    s_add_u32 m0, s71, 31232
    s_nop 0
    buffer_load_dwordx4 v10, s[84:87], s4 offen lds
    s_add_u32 m0, s71, 24064
    s_add_u32 s4, s4, 32768
    buffer_load_dwordx4 v10, s[80:83], s4 offen lds
    s_add_u32 m0, s71, 32256
    s_nop 0
    buffer_load_dwordx4 v10, s[84:87], s4 offen lds
    s_waitcnt vmcnt(17)
    v_alignbit_b32 v196, v196, v196, 16
    v_alignbit_b32 v197, v197, v197, 16
    v_alignbit_b32 v198, v198, v198, 16
    v_alignbit_b32 v199, v199, v199, 16
    ds_read_b64_tr_b16 v[16:17], v11 offset:0
    ds_read_b64_tr_b16 v[18:19], v11 offset:256
    ds_read_b64_tr_b16 v[20:21], v11 offset:512
    ds_read_b64_tr_b16 v[22:23], v11 offset:768
    ds_read_b64_tr_b16 v[24:25], v11 offset:1024
    ds_read_b64_tr_b16 v[26:27], v11 offset:1280
    ds_read_b64_tr_b16 v[28:29], v11 offset:1536
    ds_read_b64_tr_b16 v[30:31], v11 offset:1792
    ds_read_b64_tr_b16 v[32:33], v11 offset:2048
    ds_read_b64_tr_b16 v[34:35], v11 offset:8448
    ds_read_b64_tr_b16 v[36:37], v11 offset:8704
    ds_read_b64_tr_b16 v[38:39], v11 offset:8960
    ds_read_b64_tr_b16 v[40:41], v11 offset:9216
    ds_read_b64_tr_b16 v[42:43], v11 offset:9472
    ds_read_b64_tr_b16 v[44:45], v11 offset:9728
    ds_read_b64_tr_b16 v[46:47], v11 offset:9984
    ds_read_b64_tr_b16 v[48:49], v11 offset:10240
    ds_read_b64_tr_b16 v[50:51], v11 offset:32
    ds_read_b64_tr_b16 v[52:53], v11 offset:288
    ds_read_b64_tr_b16 v[54:55], v11 offset:544
    ds_read_b64_tr_b16 v[56:57], v11 offset:800
    ds_read_b64_tr_b16 v[58:59], v11 offset:1056
    ds_read_b64_tr_b16 v[60:61], v11 offset:1312
    ds_read_b64_tr_b16 v[62:63], v11 offset:1568
    ds_read_b64_tr_b16 v[64:65], v11 offset:1824
    ds_read_b64_tr_b16 v[66:67], v11 offset:2080
    ds_read_b64_tr_b16 v[68:69], v11 offset:8480
    ds_read_b64_tr_b16 v[70:71], v11 offset:8736
    ds_read_b64_tr_b16 v[72:73], v11 offset:8992
    ds_read_b64_tr_b16 v[74:75], v11 offset:9248
    ds_read_b64_tr_b16 v[76:77], v11 offset:9504
    ds_read_b64_tr_b16 v[78:79], v11 offset:9760
    ds_read_b64_tr_b16 v[80:81], v11 offset:10016
    ds_read_b64_tr_b16 v[82:83], v11 offset:10272
    s_waitcnt lgkmcnt(0)
    s_cmp_eq_u32 s24, 0
    s_cselect_b32 exec_lo, 0xffff, 0
    s_mov_b32 exec_hi, 0
    v_mov_b32 v16, 0
    v_mov_b32 v17, 0
    v_mov_b32 v50, 0
    v_mov_b32 v51, 0
    s_mov_b64 exec, -1
    s_add_u32 s4, s70, 524288
    s_add_u32 m0, s71, 0
    s_sub_u32 s5, s4, 8192
    s_max_i32 s5, s5, 0
    s_mov_b64 exec, 0xffff
    buffer_load_dwordx4 v10, s[80:83], s5 offen lds
    s_mov_b64 exec, -1

    s_add_u32 m0, s71, 256
    s_nop 0
    buffer_load_dwordx4 v10, s[80:83], s4 offen lds
    s_add_u32 m0, s71, 8448
    s_nop 0
    buffer_load_dwordx4 v10, s[84:87], s4 offen lds
    s_add_u32 m0, s71, 1280
    s_add_u32 s4, s4, 32768
    buffer_load_dwordx4 v10, s[80:83], s4 offen lds
    s_add_u32 m0, s71, 9472
    s_nop 0
    buffer_load_dwordx4 v10, s[84:87], s4 offen lds
    s_add_u32 m0, s71, 2304
    s_add_u32 s4, s4, 32768
    buffer_load_dwordx4 v10, s[80:83], s4 offen lds
    s_add_u32 m0, s71, 10496
    s_nop 0
    buffer_load_dwordx4 v10, s[84:87], s4 offen lds
    s_add_u32 m0, s71, 3328
    s_add_u32 s4, s4, 32768
    buffer_load_dwordx4 v10, s[80:83], s4 offen lds
    s_add_u32 m0, s71, 11520
    s_nop 0
    buffer_load_dwordx4 v10, s[84:87], s4 offen lds
    s_add_u32 m0, s71, 4352
    s_add_u32 s4, s4, 32768
    buffer_load_dwordx4 v10, s[80:83], s4 offen lds
    s_add_u32 m0, s71, 12544
    s_nop 0
    buffer_load_dwordx4 v10, s[84:87], s4 offen lds
    s_add_u32 m0, s71, 5376
    s_add_u32 s4, s4, 32768
    buffer_load_dwordx4 v10, s[80:83], s4 offen lds
    s_add_u32 m0, s71, 13568
    s_nop 0
    buffer_load_dwordx4 v10, s[84:87], s4 offen lds
    s_add_u32 m0, s71, 6400
    s_add_u32 s4, s4, 32768
    buffer_load_dwordx4 v10, s[80:83], s4 offen lds
    s_add_u32 m0, s71, 14592
    s_nop 0
    buffer_load_dwordx4 v10, s[84:87], s4 offen lds
    s_add_u32 m0, s71, 7424
    s_add_u32 s4, s4, 32768
    buffer_load_dwordx4 v10, s[80:83], s4 offen lds
    s_add_u32 m0, s71, 15616
    s_nop 0
    buffer_load_dwordx4 v10, s[84:87], s4 offen lds
    v_alignbit_b32 v84, v17, v16, 16
    v_alignbit_b32 v85, v18, v17, 16
    v_alignbit_b32 v86, v19, v18, 16
    v_alignbit_b32 v87, v20, v19, 16
    v_alignbit_b32 v88, v21, v20, 16
    v_alignbit_b32 v89, v22, v21, 16
    v_alignbit_b32 v90, v23, v22, 16
    v_alignbit_b32 v91, v24, v23, 16
    v_alignbit_b32 v92, v25, v24, 16
    v_alignbit_b32 v93, v26, v25, 16
    v_alignbit_b32 v94, v27, v26, 16
    v_alignbit_b32 v95, v28, v27, 16
    v_alignbit_b32 v96, v29, v28, 16
    v_alignbit_b32 v97, v30, v29, 16
    v_alignbit_b32 v98, v31, v30, 16
    v_alignbit_b32 v99, v32, v31, 16
    v_alignbit_b32 v100, v33, v32, 16
    v_dot2_f32_bf16 v102, v84, v197, 0
    v_dot2_f32_bf16 v103, v17, v197, 0
    v_dot2_f32_bf16 v106, v85, v197, 0
    v_dot2_f32_bf16 v107, v18, v197, 0
    v_dot2_f32_bf16 v110, v86, v197, 0
    v_dot2_f32_bf16 v111, v19, v197, 0
    v_dot2_f32_bf16 v114, v87, v197, 0
    v_dot2_f32_bf16 v115, v20, v197, 0
    v_dot2_f32_bf16 v102, v85, v196, v102
    v_dot2_f32_bf16 v103, v18, v196, v103
    v_dot2_f32_bf16 v106, v86, v196, v106
    v_dot2_f32_bf16 v107, v19, v196, v107
    v_dot2_f32_bf16 v110, v87, v196, v110
    v_dot2_f32_bf16 v111, v20, v196, v111
    v_dot2_f32_bf16 v114, v88, v196, v114
    v_dot2_f32_bf16 v115, v21, v196, v115
    v_lshlrev_b32 v104, 16, v34
    v_and_b32 v105, 0xffff0000, v34
    v_lshlrev_b32 v108, 16, v35
    v_and_b32 v109, 0xffff0000, v35
    v_lshlrev_b32 v112, 16, v36
    v_and_b32 v113, 0xffff0000, v36
    v_lshlrev_b32 v116, 16, v37
    v_and_b32 v117, 0xffff0000, v37
    v_mul_f32 v102, v102, v104
    v_mul_f32 v103, v103, v105
    v_mul_f32 v106, v106, v108
    v_mul_f32 v107, v107, v109
    v_mul_f32 v110, v110, v112
    v_mul_f32 v111, v111, v113
    v_mul_f32 v114, v114, v116
    v_mul_f32 v115, v115, v117
    v_cvt_pk_bf16_f32 v137, v103, v102
    v_cvt_pk_bf16_f32 v136, v107, v106
    v_cvt_pk_bf16_f32 v135, v111, v110
    v_cvt_pk_bf16_f32 v134, v115, v114
    s_add_u32 s4, s72, 0
    buffer_store_dwordx4 v[134:137], v12, s[8:11], s4 offen offset:0
    v_dot2_f32_bf16 v118, v88, v197, 0
    v_dot2_f32_bf16 v119, v21, v197, 0
    v_dot2_f32_bf16 v122, v89, v197, 0
    v_dot2_f32_bf16 v123, v22, v197, 0
    v_dot2_f32_bf16 v126, v90, v197, 0
    v_dot2_f32_bf16 v127, v23, v197, 0
    v_dot2_f32_bf16 v130, v91, v197, 0
    v_dot2_f32_bf16 v131, v24, v197, 0
    v_dot2_f32_bf16 v118, v89, v196, v118
    v_dot2_f32_bf16 v119, v22, v196, v119
    v_dot2_f32_bf16 v122, v90, v196, v122
    v_dot2_f32_bf16 v123, v23, v196, v123
    v_dot2_f32_bf16 v126, v91, v196, v126
    v_dot2_f32_bf16 v127, v24, v196, v127
    v_dot2_f32_bf16 v130, v92, v196, v130
    v_dot2_f32_bf16 v131, v25, v196, v131
    v_lshlrev_b32 v120, 16, v38
    v_and_b32 v121, 0xffff0000, v38
    v_lshlrev_b32 v124, 16, v39
    v_and_b32 v125, 0xffff0000, v39
    v_lshlrev_b32 v128, 16, v40
    v_and_b32 v129, 0xffff0000, v40
    v_lshlrev_b32 v132, 16, v41
    v_and_b32 v133, 0xffff0000, v41
    v_mul_f32 v118, v118, v120
    v_mul_f32 v119, v119, v121
    v_mul_f32 v122, v122, v124
    v_mul_f32 v123, v123, v125
    v_mul_f32 v126, v126, v128
    v_mul_f32 v127, v127, v129
    v_mul_f32 v130, v130, v132
    v_mul_f32 v131, v131, v133
    v_cvt_pk_bf16_f32 v141, v119, v118
    v_cvt_pk_bf16_f32 v140, v123, v122
    v_cvt_pk_bf16_f32 v139, v127, v126
    v_cvt_pk_bf16_f32 v138, v131, v130
    buffer_store_dwordx4 v[138:141], v12, s[8:11], s4 offen offset:1024
    v_dot2_f32_bf16 v102, v92, v197, 0
    v_dot2_f32_bf16 v103, v25, v197, 0
    v_dot2_f32_bf16 v106, v93, v197, 0
    v_dot2_f32_bf16 v107, v26, v197, 0
    v_dot2_f32_bf16 v110, v94, v197, 0
    v_dot2_f32_bf16 v111, v27, v197, 0
    v_dot2_f32_bf16 v114, v95, v197, 0
    v_dot2_f32_bf16 v115, v28, v197, 0
    v_dot2_f32_bf16 v102, v93, v196, v102
    v_dot2_f32_bf16 v103, v26, v196, v103
    v_dot2_f32_bf16 v106, v94, v196, v106
    v_dot2_f32_bf16 v107, v27, v196, v107
    v_dot2_f32_bf16 v110, v95, v196, v110
    v_dot2_f32_bf16 v111, v28, v196, v111
    v_dot2_f32_bf16 v114, v96, v196, v114
    v_dot2_f32_bf16 v115, v29, v196, v115
    v_lshlrev_b32 v104, 16, v42
    v_and_b32 v105, 0xffff0000, v42
    v_lshlrev_b32 v108, 16, v43
    v_and_b32 v109, 0xffff0000, v43
    v_lshlrev_b32 v112, 16, v44
    v_and_b32 v113, 0xffff0000, v44
    v_lshlrev_b32 v116, 16, v45
    v_and_b32 v117, 0xffff0000, v45
    v_mul_f32 v102, v102, v104
    v_mul_f32 v103, v103, v105
    v_mul_f32 v106, v106, v108
    v_mul_f32 v107, v107, v109
    v_mul_f32 v110, v110, v112
    v_mul_f32 v111, v111, v113
    v_mul_f32 v114, v114, v116
    v_mul_f32 v115, v115, v117
    v_cvt_pk_bf16_f32 v145, v103, v102
    v_cvt_pk_bf16_f32 v144, v107, v106
    v_cvt_pk_bf16_f32 v143, v111, v110
    v_cvt_pk_bf16_f32 v142, v115, v114
    buffer_store_dwordx4 v[142:145], v12, s[8:11], s4 offen offset:2048
    v_dot2_f32_bf16 v118, v96, v197, 0
    v_dot2_f32_bf16 v119, v29, v197, 0
    v_dot2_f32_bf16 v122, v97, v197, 0
    v_dot2_f32_bf16 v123, v30, v197, 0
    v_dot2_f32_bf16 v126, v98, v197, 0
    v_dot2_f32_bf16 v127, v31, v197, 0
    v_dot2_f32_bf16 v130, v99, v197, 0
    v_dot2_f32_bf16 v131, v32, v197, 0
    v_dot2_f32_bf16 v118, v97, v196, v118
    v_dot2_f32_bf16 v119, v30, v196, v119
    v_dot2_f32_bf16 v122, v98, v196, v122
    v_dot2_f32_bf16 v123, v31, v196, v123
    v_dot2_f32_bf16 v126, v99, v196, v126
    v_dot2_f32_bf16 v127, v32, v196, v127
    v_dot2_f32_bf16 v130, v100, v196, v130
    v_dot2_f32_bf16 v131, v33, v196, v131
    v_lshlrev_b32 v120, 16, v46
    v_and_b32 v121, 0xffff0000, v46
    v_lshlrev_b32 v124, 16, v47
    v_and_b32 v125, 0xffff0000, v47
    v_lshlrev_b32 v128, 16, v48
    v_and_b32 v129, 0xffff0000, v48
    v_lshlrev_b32 v132, 16, v49
    v_and_b32 v133, 0xffff0000, v49
    v_mul_f32 v118, v118, v120
    v_mul_f32 v119, v119, v121
    v_mul_f32 v122, v122, v124
    v_mul_f32 v123, v123, v125
    v_mul_f32 v126, v126, v128
    v_mul_f32 v127, v127, v129
    v_mul_f32 v130, v130, v132
    v_mul_f32 v131, v131, v133
    v_cvt_pk_bf16_f32 v149, v119, v118
    v_cvt_pk_bf16_f32 v148, v123, v122
    v_cvt_pk_bf16_f32 v147, v127, v126
    v_cvt_pk_bf16_f32 v146, v131, v130
    buffer_store_dwordx4 v[146:149], v12, s[8:11], s4 offen offset:3072
    v_alignbit_b32 v84, v51, v50, 16
    v_alignbit_b32 v85, v52, v51, 16
    v_alignbit_b32 v86, v53, v52, 16
    v_alignbit_b32 v87, v54, v53, 16
    v_alignbit_b32 v88, v55, v54, 16
    v_alignbit_b32 v89, v56, v55, 16
    v_alignbit_b32 v90, v57, v56, 16
    v_alignbit_b32 v91, v58, v57, 16
    v_alignbit_b32 v92, v59, v58, 16
    v_alignbit_b32 v93, v60, v59, 16
    v_alignbit_b32 v94, v61, v60, 16
    v_alignbit_b32 v95, v62, v61, 16
    v_alignbit_b32 v96, v63, v62, 16
    v_alignbit_b32 v97, v64, v63, 16
    v_alignbit_b32 v98, v65, v64, 16
    v_alignbit_b32 v99, v66, v65, 16
    v_alignbit_b32 v100, v67, v66, 16
    v_dot2_f32_bf16 v102, v84, v199, 0
    v_dot2_f32_bf16 v103, v51, v199, 0
    v_dot2_f32_bf16 v106, v85, v199, 0
    v_dot2_f32_bf16 v107, v52, v199, 0
    v_dot2_f32_bf16 v110, v86, v199, 0
    v_dot2_f32_bf16 v111, v53, v199, 0
    v_dot2_f32_bf16 v114, v87, v199, 0
    v_dot2_f32_bf16 v115, v54, v199, 0
    v_dot2_f32_bf16 v102, v85, v198, v102
    v_dot2_f32_bf16 v103, v52, v198, v103
    v_dot2_f32_bf16 v106, v86, v198, v106
    v_dot2_f32_bf16 v107, v53, v198, v107
    v_dot2_f32_bf16 v110, v87, v198, v110
    v_dot2_f32_bf16 v111, v54, v198, v111
    v_dot2_f32_bf16 v114, v88, v198, v114
    v_dot2_f32_bf16 v115, v55, v198, v115
    v_lshlrev_b32 v104, 16, v68
    v_and_b32 v105, 0xffff0000, v68
    v_lshlrev_b32 v108, 16, v69
    v_and_b32 v109, 0xffff0000, v69
    v_lshlrev_b32 v112, 16, v70
    v_and_b32 v113, 0xffff0000, v70
    v_lshlrev_b32 v116, 16, v71
    v_and_b32 v117, 0xffff0000, v71
    v_mul_f32 v102, v102, v104
    v_mul_f32 v103, v103, v105
    v_mul_f32 v106, v106, v108
    v_mul_f32 v107, v107, v109
    v_mul_f32 v110, v110, v112
    v_mul_f32 v111, v111, v113
    v_mul_f32 v114, v114, v116
    v_mul_f32 v115, v115, v117
    v_cvt_pk_bf16_f32 v153, v103, v102
    v_cvt_pk_bf16_f32 v152, v107, v106
    v_cvt_pk_bf16_f32 v151, v111, v110
    v_cvt_pk_bf16_f32 v150, v115, v114
    s_add_u32 s4, s72, 65536
    buffer_store_dwordx4 v[150:153], v12, s[8:11], s4 offen offset:0
    v_dot2_f32_bf16 v118, v88, v199, 0
    v_dot2_f32_bf16 v119, v55, v199, 0
    v_dot2_f32_bf16 v122, v89, v199, 0
    v_dot2_f32_bf16 v123, v56, v199, 0
    v_dot2_f32_bf16 v126, v90, v199, 0
    v_dot2_f32_bf16 v127, v57, v199, 0
    v_dot2_f32_bf16 v130, v91, v199, 0
    v_dot2_f32_bf16 v131, v58, v199, 0
    v_dot2_f32_bf16 v118, v89, v198, v118
    v_dot2_f32_bf16 v119, v56, v198, v119
    v_dot2_f32_bf16 v122, v90, v198, v122
    v_dot2_f32_bf16 v123, v57, v198, v123
    v_dot2_f32_bf16 v126, v91, v198, v126
    v_dot2_f32_bf16 v127, v58, v198, v127
    v_dot2_f32_bf16 v130, v92, v198, v130
    v_dot2_f32_bf16 v131, v59, v198, v131
    v_lshlrev_b32 v120, 16, v72
    v_and_b32 v121, 0xffff0000, v72
    v_lshlrev_b32 v124, 16, v73
    v_and_b32 v125, 0xffff0000, v73
    v_lshlrev_b32 v128, 16, v74
    v_and_b32 v129, 0xffff0000, v74
    v_lshlrev_b32 v132, 16, v75
    v_and_b32 v133, 0xffff0000, v75
    v_mul_f32 v118, v118, v120
    v_mul_f32 v119, v119, v121
    v_mul_f32 v122, v122, v124
    v_mul_f32 v123, v123, v125
    v_mul_f32 v126, v126, v128
    v_mul_f32 v127, v127, v129
    v_mul_f32 v130, v130, v132
    v_mul_f32 v131, v131, v133
    v_cvt_pk_bf16_f32 v157, v119, v118
    v_cvt_pk_bf16_f32 v156, v123, v122
    v_cvt_pk_bf16_f32 v155, v127, v126
    v_cvt_pk_bf16_f32 v154, v131, v130
    buffer_store_dwordx4 v[154:157], v12, s[8:11], s4 offen offset:1024
    v_dot2_f32_bf16 v102, v92, v199, 0
    v_dot2_f32_bf16 v103, v59, v199, 0
    v_dot2_f32_bf16 v106, v93, v199, 0
    v_dot2_f32_bf16 v107, v60, v199, 0
    v_dot2_f32_bf16 v110, v94, v199, 0
    v_dot2_f32_bf16 v111, v61, v199, 0
    v_dot2_f32_bf16 v114, v95, v199, 0
    v_dot2_f32_bf16 v115, v62, v199, 0
    v_dot2_f32_bf16 v102, v93, v198, v102
    v_dot2_f32_bf16 v103, v60, v198, v103
    v_dot2_f32_bf16 v106, v94, v198, v106
    v_dot2_f32_bf16 v107, v61, v198, v107
    v_dot2_f32_bf16 v110, v95, v198, v110
    v_dot2_f32_bf16 v111, v62, v198, v111
    v_dot2_f32_bf16 v114, v96, v198, v114
    v_dot2_f32_bf16 v115, v63, v198, v115
    v_lshlrev_b32 v104, 16, v76
    v_and_b32 v105, 0xffff0000, v76
    v_lshlrev_b32 v108, 16, v77
    v_and_b32 v109, 0xffff0000, v77
    v_lshlrev_b32 v112, 16, v78
    v_and_b32 v113, 0xffff0000, v78
    v_lshlrev_b32 v116, 16, v79
    v_and_b32 v117, 0xffff0000, v79
    v_mul_f32 v102, v102, v104
    v_mul_f32 v103, v103, v105
    v_mul_f32 v106, v106, v108
    v_mul_f32 v107, v107, v109
    v_mul_f32 v110, v110, v112
    v_mul_f32 v111, v111, v113
    v_mul_f32 v114, v114, v116
    v_mul_f32 v115, v115, v117
    v_cvt_pk_bf16_f32 v161, v103, v102
    v_cvt_pk_bf16_f32 v160, v107, v106
    v_cvt_pk_bf16_f32 v159, v111, v110
    v_cvt_pk_bf16_f32 v158, v115, v114
    buffer_store_dwordx4 v[158:161], v12, s[8:11], s4 offen offset:2048
    v_dot2_f32_bf16 v118, v96, v199, 0
    v_dot2_f32_bf16 v119, v63, v199, 0
    v_dot2_f32_bf16 v122, v97, v199, 0
    v_dot2_f32_bf16 v123, v64, v199, 0
    v_dot2_f32_bf16 v126, v98, v199, 0
    v_dot2_f32_bf16 v127, v65, v199, 0
    v_dot2_f32_bf16 v130, v99, v199, 0
    v_dot2_f32_bf16 v131, v66, v199, 0
    v_dot2_f32_bf16 v118, v97, v198, v118
    v_dot2_f32_bf16 v119, v64, v198, v119
    v_dot2_f32_bf16 v122, v98, v198, v122
    v_dot2_f32_bf16 v123, v65, v198, v123
    v_dot2_f32_bf16 v126, v99, v198, v126
    v_dot2_f32_bf16 v127, v66, v198, v127
    v_dot2_f32_bf16 v130, v100, v198, v130
    v_dot2_f32_bf16 v131, v67, v198, v131
    v_lshlrev_b32 v120, 16, v80
    v_and_b32 v121, 0xffff0000, v80
    v_lshlrev_b32 v124, 16, v81
    v_and_b32 v125, 0xffff0000, v81
    v_lshlrev_b32 v128, 16, v82
    v_and_b32 v129, 0xffff0000, v82
    v_lshlrev_b32 v132, 16, v83
    v_and_b32 v133, 0xffff0000, v83
    v_mul_f32 v118, v118, v120
    v_mul_f32 v119, v119, v121
    v_mul_f32 v122, v122, v124
    v_mul_f32 v123, v123, v125
    v_mul_f32 v126, v126, v128
    v_mul_f32 v127, v127, v129
    v_mul_f32 v130, v130, v132
    v_mul_f32 v131, v131, v133
    v_cvt_pk_bf16_f32 v165, v119, v118
    v_cvt_pk_bf16_f32 v164, v123, v122
    v_cvt_pk_bf16_f32 v163, v127, v126
    v_cvt_pk_bf16_f32 v162, v131, v130
    buffer_store_dwordx4 v[162:165], v12, s[8:11], s4 offen offset:3072
    s_waitcnt vmcnt(25)
    ds_read_b64_tr_b16 v[16:17], v11 offset:16640
    ds_read_b64_tr_b16 v[18:19], v11 offset:16896
    ds_read_b64_tr_b16 v[20:21], v11 offset:17152
    ds_read_b64_tr_b16 v[22:23], v11 offset:17408
    ds_read_b64_tr_b16 v[24:25], v11 offset:17664
    ds_read_b64_tr_b16 v[26:27], v11 offset:17920
    ds_read_b64_tr_b16 v[28:29], v11 offset:18176
    ds_read_b64_tr_b16 v[30:31], v11 offset:18432
    ds_read_b64_tr_b16 v[32:33], v11 offset:18688
    ds_read_b64_tr_b16 v[34:35], v11 offset:25088
    ds_read_b64_tr_b16 v[36:37], v11 offset:25344
    ds_read_b64_tr_b16 v[38:39], v11 offset:25600
    ds_read_b64_tr_b16 v[40:41], v11 offset:25856
    ds_read_b64_tr_b16 v[42:43], v11 offset:26112
    ds_read_b64_tr_b16 v[44:45], v11 offset:26368
    ds_read_b64_tr_b16 v[46:47], v11 offset:26624
    ds_read_b64_tr_b16 v[48:49], v11 offset:26880
    ds_read_b64_tr_b16 v[50:51], v11 offset:16672
    ds_read_b64_tr_b16 v[52:53], v11 offset:16928
    ds_read_b64_tr_b16 v[54:55], v11 offset:17184
    ds_read_b64_tr_b16 v[56:57], v11 offset:17440
    ds_read_b64_tr_b16 v[58:59], v11 offset:17696
    ds_read_b64_tr_b16 v[60:61], v11 offset:17952
    ds_read_b64_tr_b16 v[62:63], v11 offset:18208
    ds_read_b64_tr_b16 v[64:65], v11 offset:18464
    ds_read_b64_tr_b16 v[66:67], v11 offset:18720
    ds_read_b64_tr_b16 v[68:69], v11 offset:25120
    ds_read_b64_tr_b16 v[70:71], v11 offset:25376
    ds_read_b64_tr_b16 v[72:73], v11 offset:25632
    ds_read_b64_tr_b16 v[74:75], v11 offset:25888
    ds_read_b64_tr_b16 v[76:77], v11 offset:26144
    ds_read_b64_tr_b16 v[78:79], v11 offset:26400
    ds_read_b64_tr_b16 v[80:81], v11 offset:26656
    ds_read_b64_tr_b16 v[82:83], v11 offset:26912
    s_waitcnt lgkmcnt(0)
    s_add_u32 s4, s70, 786432
    s_add_u32 m0, s71, 16640
    s_sub_u32 s5, s4, 8192
    s_max_i32 s5, s5, 0
    s_mov_b64 exec, 0xffff
    buffer_load_dwordx4 v10, s[80:83], s5 offen lds
    s_mov_b64 exec, -1

    s_add_u32 m0, s71, 16896
    s_nop 0
    buffer_load_dwordx4 v10, s[80:83], s4 offen lds
    s_add_u32 m0, s71, 25088
    s_nop 0
    buffer_load_dwordx4 v10, s[84:87], s4 offen lds
    s_add_u32 m0, s71, 17920
    s_add_u32 s4, s4, 32768
    buffer_load_dwordx4 v10, s[80:83], s4 offen lds
    s_add_u32 m0, s71, 26112
    s_nop 0
    buffer_load_dwordx4 v10, s[84:87], s4 offen lds
    s_add_u32 m0, s71, 18944
    s_add_u32 s4, s4, 32768
    buffer_load_dwordx4 v10, s[80:83], s4 offen lds
    s_add_u32 m0, s71, 27136
    s_nop 0
    buffer_load_dwordx4 v10, s[84:87], s4 offen lds
    s_add_u32 m0, s71, 19968
    s_add_u32 s4, s4, 32768
    buffer_load_dwordx4 v10, s[80:83], s4 offen lds
    s_add_u32 m0, s71, 28160
    s_nop 0
    buffer_load_dwordx4 v10, s[84:87], s4 offen lds
    s_add_u32 m0, s71, 20992
    s_add_u32 s4, s4, 32768
    buffer_load_dwordx4 v10, s[80:83], s4 offen lds
    s_add_u32 m0, s71, 29184
    s_nop 0
    buffer_load_dwordx4 v10, s[84:87], s4 offen lds
    s_add_u32 m0, s71, 22016
    s_add_u32 s4, s4, 32768
    buffer_load_dwordx4 v10, s[80:83], s4 offen lds
    s_add_u32 m0, s71, 30208
    s_nop 0
    buffer_load_dwordx4 v10, s[84:87], s4 offen lds
    s_add_u32 m0, s71, 23040
    s_add_u32 s4, s4, 32768
    buffer_load_dwordx4 v10, s[80:83], s4 offen lds
    s_add_u32 m0, s71, 31232
    s_nop 0
    buffer_load_dwordx4 v10, s[84:87], s4 offen lds
    s_add_u32 m0, s71, 24064
    s_add_u32 s4, s4, 32768
    buffer_load_dwordx4 v10, s[80:83], s4 offen lds
    s_add_u32 m0, s71, 32256
    s_nop 0
    buffer_load_dwordx4 v10, s[84:87], s4 offen lds
    v_alignbit_b32 v84, v17, v16, 16
    v_alignbit_b32 v85, v18, v17, 16
    v_alignbit_b32 v86, v19, v18, 16
    v_alignbit_b32 v87, v20, v19, 16
    v_alignbit_b32 v88, v21, v20, 16
    v_alignbit_b32 v89, v22, v21, 16
    v_alignbit_b32 v90, v23, v22, 16
    v_alignbit_b32 v91, v24, v23, 16
    v_alignbit_b32 v92, v25, v24, 16
    v_alignbit_b32 v93, v26, v25, 16
    v_alignbit_b32 v94, v27, v26, 16
    v_alignbit_b32 v95, v28, v27, 16
    v_alignbit_b32 v96, v29, v28, 16
    v_alignbit_b32 v97, v30, v29, 16
    v_alignbit_b32 v98, v31, v30, 16
    v_alignbit_b32 v99, v32, v31, 16
    v_alignbit_b32 v100, v33, v32, 16
    v_dot2_f32_bf16 v102, v84, v197, 0
    v_dot2_f32_bf16 v103, v17, v197, 0
    v_dot2_f32_bf16 v106, v85, v197, 0
    v_dot2_f32_bf16 v107, v18, v197, 0
    v_dot2_f32_bf16 v110, v86, v197, 0
    v_dot2_f32_bf16 v111, v19, v197, 0
    v_dot2_f32_bf16 v114, v87, v197, 0
    v_dot2_f32_bf16 v115, v20, v197, 0
    v_dot2_f32_bf16 v102, v85, v196, v102
    v_dot2_f32_bf16 v103, v18, v196, v103
    v_dot2_f32_bf16 v106, v86, v196, v106
    v_dot2_f32_bf16 v107, v19, v196, v107
    v_dot2_f32_bf16 v110, v87, v196, v110
    v_dot2_f32_bf16 v111, v20, v196, v111
    v_dot2_f32_bf16 v114, v88, v196, v114
    v_dot2_f32_bf16 v115, v21, v196, v115
    v_lshlrev_b32 v104, 16, v34
    v_and_b32 v105, 0xffff0000, v34
    v_lshlrev_b32 v108, 16, v35
    v_and_b32 v109, 0xffff0000, v35
    v_lshlrev_b32 v112, 16, v36
    v_and_b32 v113, 0xffff0000, v36
    v_lshlrev_b32 v116, 16, v37
    v_and_b32 v117, 0xffff0000, v37
    v_mul_f32 v102, v102, v104
    v_mul_f32 v103, v103, v105
    v_mul_f32 v106, v106, v108
    v_mul_f32 v107, v107, v109
    v_mul_f32 v110, v110, v112
    v_mul_f32 v111, v111, v113
    v_mul_f32 v114, v114, v116
    v_mul_f32 v115, v115, v117
    v_cvt_pk_bf16_f32 v137, v103, v102
    v_cvt_pk_bf16_f32 v136, v107, v106
    v_cvt_pk_bf16_f32 v135, v111, v110
    v_cvt_pk_bf16_f32 v134, v115, v114
    s_add_u32 s4, s72, 64
    buffer_store_dwordx4 v[134:137], v12, s[8:11], s4 offen offset:0
    v_dot2_f32_bf16 v118, v88, v197, 0
    v_dot2_f32_bf16 v119, v21, v197, 0
    v_dot2_f32_bf16 v122, v89, v197, 0
    v_dot2_f32_bf16 v123, v22, v197, 0
    v_dot2_f32_bf16 v126, v90, v197, 0
    v_dot2_f32_bf16 v127, v23, v197, 0
    v_dot2_f32_bf16 v130, v91, v197, 0
    v_dot2_f32_bf16 v131, v24, v197, 0
    v_dot2_f32_bf16 v118, v89, v196, v118
    v_dot2_f32_bf16 v119, v22, v196, v119
    v_dot2_f32_bf16 v122, v90, v196, v122
    v_dot2_f32_bf16 v123, v23, v196, v123
    v_dot2_f32_bf16 v126, v91, v196, v126
    v_dot2_f32_bf16 v127, v24, v196, v127
    v_dot2_f32_bf16 v130, v92, v196, v130
    v_dot2_f32_bf16 v131, v25, v196, v131
    v_lshlrev_b32 v120, 16, v38
    v_and_b32 v121, 0xffff0000, v38
    v_lshlrev_b32 v124, 16, v39
    v_and_b32 v125, 0xffff0000, v39
    v_lshlrev_b32 v128, 16, v40
    v_and_b32 v129, 0xffff0000, v40
    v_lshlrev_b32 v132, 16, v41
    v_and_b32 v133, 0xffff0000, v41
    v_mul_f32 v118, v118, v120
    v_mul_f32 v119, v119, v121
    v_mul_f32 v122, v122, v124
    v_mul_f32 v123, v123, v125
    v_mul_f32 v126, v126, v128
    v_mul_f32 v127, v127, v129
    v_mul_f32 v130, v130, v132
    v_mul_f32 v131, v131, v133
    v_cvt_pk_bf16_f32 v141, v119, v118
    v_cvt_pk_bf16_f32 v140, v123, v122
    v_cvt_pk_bf16_f32 v139, v127, v126
    v_cvt_pk_bf16_f32 v138, v131, v130
    buffer_store_dwordx4 v[138:141], v12, s[8:11], s4 offen offset:1024
    v_dot2_f32_bf16 v102, v92, v197, 0
    v_dot2_f32_bf16 v103, v25, v197, 0
    v_dot2_f32_bf16 v106, v93, v197, 0
    v_dot2_f32_bf16 v107, v26, v197, 0
    v_dot2_f32_bf16 v110, v94, v197, 0
    v_dot2_f32_bf16 v111, v27, v197, 0
    v_dot2_f32_bf16 v114, v95, v197, 0
    v_dot2_f32_bf16 v115, v28, v197, 0
    v_dot2_f32_bf16 v102, v93, v196, v102
    v_dot2_f32_bf16 v103, v26, v196, v103
    v_dot2_f32_bf16 v106, v94, v196, v106
    v_dot2_f32_bf16 v107, v27, v196, v107
    v_dot2_f32_bf16 v110, v95, v196, v110
    v_dot2_f32_bf16 v111, v28, v196, v111
    v_dot2_f32_bf16 v114, v96, v196, v114
    v_dot2_f32_bf16 v115, v29, v196, v115
    v_lshlrev_b32 v104, 16, v42
    v_and_b32 v105, 0xffff0000, v42
    v_lshlrev_b32 v108, 16, v43
    v_and_b32 v109, 0xffff0000, v43
    v_lshlrev_b32 v112, 16, v44
    v_and_b32 v113, 0xffff0000, v44
    v_lshlrev_b32 v116, 16, v45
    v_and_b32 v117, 0xffff0000, v45
    v_mul_f32 v102, v102, v104
    v_mul_f32 v103, v103, v105
    v_mul_f32 v106, v106, v108
    v_mul_f32 v107, v107, v109
    v_mul_f32 v110, v110, v112
    v_mul_f32 v111, v111, v113
    v_mul_f32 v114, v114, v116
    v_mul_f32 v115, v115, v117
    v_cvt_pk_bf16_f32 v145, v103, v102
    v_cvt_pk_bf16_f32 v144, v107, v106
    v_cvt_pk_bf16_f32 v143, v111, v110
    v_cvt_pk_bf16_f32 v142, v115, v114
    buffer_store_dwordx4 v[142:145], v12, s[8:11], s4 offen offset:2048
    v_dot2_f32_bf16 v118, v96, v197, 0
    v_dot2_f32_bf16 v119, v29, v197, 0
    v_dot2_f32_bf16 v122, v97, v197, 0
    v_dot2_f32_bf16 v123, v30, v197, 0
    v_dot2_f32_bf16 v126, v98, v197, 0
    v_dot2_f32_bf16 v127, v31, v197, 0
    v_dot2_f32_bf16 v130, v99, v197, 0
    v_dot2_f32_bf16 v131, v32, v197, 0
    v_dot2_f32_bf16 v118, v97, v196, v118
    v_dot2_f32_bf16 v119, v30, v196, v119
    v_dot2_f32_bf16 v122, v98, v196, v122
    v_dot2_f32_bf16 v123, v31, v196, v123
    v_dot2_f32_bf16 v126, v99, v196, v126
    v_dot2_f32_bf16 v127, v32, v196, v127
    v_dot2_f32_bf16 v130, v100, v196, v130
    v_dot2_f32_bf16 v131, v33, v196, v131
    v_lshlrev_b32 v120, 16, v46
    v_and_b32 v121, 0xffff0000, v46
    v_lshlrev_b32 v124, 16, v47
    v_and_b32 v125, 0xffff0000, v47
    v_lshlrev_b32 v128, 16, v48
    v_and_b32 v129, 0xffff0000, v48
    v_lshlrev_b32 v132, 16, v49
    v_and_b32 v133, 0xffff0000, v49
    v_mul_f32 v118, v118, v120
    v_mul_f32 v119, v119, v121
    v_mul_f32 v122, v122, v124
    v_mul_f32 v123, v123, v125
    v_mul_f32 v126, v126, v128
    v_mul_f32 v127, v127, v129
    v_mul_f32 v130, v130, v132
    v_mul_f32 v131, v131, v133
    v_cvt_pk_bf16_f32 v149, v119, v118
    v_cvt_pk_bf16_f32 v148, v123, v122
    v_cvt_pk_bf16_f32 v147, v127, v126
    v_cvt_pk_bf16_f32 v146, v131, v130
    buffer_store_dwordx4 v[146:149], v12, s[8:11], s4 offen offset:3072
    v_alignbit_b32 v84, v51, v50, 16
    v_alignbit_b32 v85, v52, v51, 16
    v_alignbit_b32 v86, v53, v52, 16
    v_alignbit_b32 v87, v54, v53, 16
    v_alignbit_b32 v88, v55, v54, 16
    v_alignbit_b32 v89, v56, v55, 16
    v_alignbit_b32 v90, v57, v56, 16
    v_alignbit_b32 v91, v58, v57, 16
    v_alignbit_b32 v92, v59, v58, 16
    v_alignbit_b32 v93, v60, v59, 16
    v_alignbit_b32 v94, v61, v60, 16
    v_alignbit_b32 v95, v62, v61, 16
    v_alignbit_b32 v96, v63, v62, 16
    v_alignbit_b32 v97, v64, v63, 16
    v_alignbit_b32 v98, v65, v64, 16
    v_alignbit_b32 v99, v66, v65, 16
    v_alignbit_b32 v100, v67, v66, 16
    v_dot2_f32_bf16 v102, v84, v199, 0
    v_dot2_f32_bf16 v103, v51, v199, 0
    v_dot2_f32_bf16 v106, v85, v199, 0
    v_dot2_f32_bf16 v107, v52, v199, 0
    v_dot2_f32_bf16 v110, v86, v199, 0
    v_dot2_f32_bf16 v111, v53, v199, 0
    v_dot2_f32_bf16 v114, v87, v199, 0
    v_dot2_f32_bf16 v115, v54, v199, 0
    v_dot2_f32_bf16 v102, v85, v198, v102
    v_dot2_f32_bf16 v103, v52, v198, v103
    v_dot2_f32_bf16 v106, v86, v198, v106
    v_dot2_f32_bf16 v107, v53, v198, v107
    v_dot2_f32_bf16 v110, v87, v198, v110
    v_dot2_f32_bf16 v111, v54, v198, v111
    v_dot2_f32_bf16 v114, v88, v198, v114
    v_dot2_f32_bf16 v115, v55, v198, v115
    v_lshlrev_b32 v104, 16, v68
    v_and_b32 v105, 0xffff0000, v68
    v_lshlrev_b32 v108, 16, v69
    v_and_b32 v109, 0xffff0000, v69
    v_lshlrev_b32 v112, 16, v70
    v_and_b32 v113, 0xffff0000, v70
    v_lshlrev_b32 v116, 16, v71
    v_and_b32 v117, 0xffff0000, v71
    v_mul_f32 v102, v102, v104
    v_mul_f32 v103, v103, v105
    v_mul_f32 v106, v106, v108
    v_mul_f32 v107, v107, v109
    v_mul_f32 v110, v110, v112
    v_mul_f32 v111, v111, v113
    v_mul_f32 v114, v114, v116
    v_mul_f32 v115, v115, v117
    v_cvt_pk_bf16_f32 v153, v103, v102
    v_cvt_pk_bf16_f32 v152, v107, v106
    v_cvt_pk_bf16_f32 v151, v111, v110
    v_cvt_pk_bf16_f32 v150, v115, v114
    s_add_u32 s4, s72, 65600
    buffer_store_dwordx4 v[150:153], v12, s[8:11], s4 offen offset:0
    v_dot2_f32_bf16 v118, v88, v199, 0
    v_dot2_f32_bf16 v119, v55, v199, 0
    v_dot2_f32_bf16 v122, v89, v199, 0
    v_dot2_f32_bf16 v123, v56, v199, 0
    v_dot2_f32_bf16 v126, v90, v199, 0
    v_dot2_f32_bf16 v127, v57, v199, 0
    v_dot2_f32_bf16 v130, v91, v199, 0
    v_dot2_f32_bf16 v131, v58, v199, 0
    v_dot2_f32_bf16 v118, v89, v198, v118
    v_dot2_f32_bf16 v119, v56, v198, v119
    v_dot2_f32_bf16 v122, v90, v198, v122
    v_dot2_f32_bf16 v123, v57, v198, v123
    v_dot2_f32_bf16 v126, v91, v198, v126
    v_dot2_f32_bf16 v127, v58, v198, v127
    v_dot2_f32_bf16 v130, v92, v198, v130
    v_dot2_f32_bf16 v131, v59, v198, v131
    v_lshlrev_b32 v120, 16, v72
    v_and_b32 v121, 0xffff0000, v72
    v_lshlrev_b32 v124, 16, v73
    v_and_b32 v125, 0xffff0000, v73
    v_lshlrev_b32 v128, 16, v74
    v_and_b32 v129, 0xffff0000, v74
    v_lshlrev_b32 v132, 16, v75
    v_and_b32 v133, 0xffff0000, v75
    v_mul_f32 v118, v118, v120
    v_mul_f32 v119, v119, v121
    v_mul_f32 v122, v122, v124
    v_mul_f32 v123, v123, v125
    v_mul_f32 v126, v126, v128
    v_mul_f32 v127, v127, v129
    v_mul_f32 v130, v130, v132
    v_mul_f32 v131, v131, v133
    v_cvt_pk_bf16_f32 v157, v119, v118
    v_cvt_pk_bf16_f32 v156, v123, v122
    v_cvt_pk_bf16_f32 v155, v127, v126
    v_cvt_pk_bf16_f32 v154, v131, v130
    buffer_store_dwordx4 v[154:157], v12, s[8:11], s4 offen offset:1024
    v_dot2_f32_bf16 v102, v92, v199, 0
    v_dot2_f32_bf16 v103, v59, v199, 0
    v_dot2_f32_bf16 v106, v93, v199, 0
    v_dot2_f32_bf16 v107, v60, v199, 0
    v_dot2_f32_bf16 v110, v94, v199, 0
    v_dot2_f32_bf16 v111, v61, v199, 0
    v_dot2_f32_bf16 v114, v95, v199, 0
    v_dot2_f32_bf16 v115, v62, v199, 0
    v_dot2_f32_bf16 v102, v93, v198, v102
    v_dot2_f32_bf16 v103, v60, v198, v103
    v_dot2_f32_bf16 v106, v94, v198, v106
    v_dot2_f32_bf16 v107, v61, v198, v107
    v_dot2_f32_bf16 v110, v95, v198, v110
    v_dot2_f32_bf16 v111, v62, v198, v111
    v_dot2_f32_bf16 v114, v96, v198, v114
    v_dot2_f32_bf16 v115, v63, v198, v115
    v_lshlrev_b32 v104, 16, v76
    v_and_b32 v105, 0xffff0000, v76
    v_lshlrev_b32 v108, 16, v77
    v_and_b32 v109, 0xffff0000, v77
    v_lshlrev_b32 v112, 16, v78
    v_and_b32 v113, 0xffff0000, v78
    v_lshlrev_b32 v116, 16, v79
    v_and_b32 v117, 0xffff0000, v79
    v_mul_f32 v102, v102, v104
    v_mul_f32 v103, v103, v105
    v_mul_f32 v106, v106, v108
    v_mul_f32 v107, v107, v109
    v_mul_f32 v110, v110, v112
    v_mul_f32 v111, v111, v113
    v_mul_f32 v114, v114, v116
    v_mul_f32 v115, v115, v117
    v_cvt_pk_bf16_f32 v161, v103, v102
    v_cvt_pk_bf16_f32 v160, v107, v106
    v_cvt_pk_bf16_f32 v159, v111, v110
    v_cvt_pk_bf16_f32 v158, v115, v114
    buffer_store_dwordx4 v[158:161], v12, s[8:11], s4 offen offset:2048
    v_dot2_f32_bf16 v118, v96, v199, 0
    v_dot2_f32_bf16 v119, v63, v199, 0
    v_dot2_f32_bf16 v122, v97, v199, 0
    v_dot2_f32_bf16 v123, v64, v199, 0
    v_dot2_f32_bf16 v126, v98, v199, 0
    v_dot2_f32_bf16 v127, v65, v199, 0
    v_dot2_f32_bf16 v130, v99, v199, 0
    v_dot2_f32_bf16 v131, v66, v199, 0
    v_dot2_f32_bf16 v118, v97, v198, v118
    v_dot2_f32_bf16 v119, v64, v198, v119
    v_dot2_f32_bf16 v122, v98, v198, v122
    v_dot2_f32_bf16 v123, v65, v198, v123
    v_dot2_f32_bf16 v126, v99, v198, v126
    v_dot2_f32_bf16 v127, v66, v198, v127
    v_dot2_f32_bf16 v130, v100, v198, v130
    v_dot2_f32_bf16 v131, v67, v198, v131
    v_lshlrev_b32 v120, 16, v80
    v_and_b32 v121, 0xffff0000, v80
    v_lshlrev_b32 v124, 16, v81
    v_and_b32 v125, 0xffff0000, v81
    v_lshlrev_b32 v128, 16, v82
    v_and_b32 v129, 0xffff0000, v82
    v_lshlrev_b32 v132, 16, v83
    v_and_b32 v133, 0xffff0000, v83
    v_mul_f32 v118, v118, v120
    v_mul_f32 v119, v119, v121
    v_mul_f32 v122, v122, v124
    v_mul_f32 v123, v123, v125
    v_mul_f32 v126, v126, v128
    v_mul_f32 v127, v127, v129
    v_mul_f32 v130, v130, v132
    v_mul_f32 v131, v131, v133
    v_cvt_pk_bf16_f32 v165, v119, v118
    v_cvt_pk_bf16_f32 v164, v123, v122
    v_cvt_pk_bf16_f32 v163, v127, v126
    v_cvt_pk_bf16_f32 v162, v131, v130
    buffer_store_dwordx4 v[162:165], v12, s[8:11], s4 offen offset:3072
    s_waitcnt vmcnt(25)
    ds_read_b64_tr_b16 v[16:17], v11 offset:0
    ds_read_b64_tr_b16 v[18:19], v11 offset:256
    ds_read_b64_tr_b16 v[20:21], v11 offset:512
    ds_read_b64_tr_b16 v[22:23], v11 offset:768
    ds_read_b64_tr_b16 v[24:25], v11 offset:1024
    ds_read_b64_tr_b16 v[26:27], v11 offset:1280
    ds_read_b64_tr_b16 v[28:29], v11 offset:1536
    ds_read_b64_tr_b16 v[30:31], v11 offset:1792
    ds_read_b64_tr_b16 v[32:33], v11 offset:2048
    ds_read_b64_tr_b16 v[34:35], v11 offset:8448
    ds_read_b64_tr_b16 v[36:37], v11 offset:8704
    ds_read_b64_tr_b16 v[38:39], v11 offset:8960
    ds_read_b64_tr_b16 v[40:41], v11 offset:9216
    ds_read_b64_tr_b16 v[42:43], v11 offset:9472
    ds_read_b64_tr_b16 v[44:45], v11 offset:9728
    ds_read_b64_tr_b16 v[46:47], v11 offset:9984
    ds_read_b64_tr_b16 v[48:49], v11 offset:10240
    ds_read_b64_tr_b16 v[50:51], v11 offset:32
    ds_read_b64_tr_b16 v[52:53], v11 offset:288
    ds_read_b64_tr_b16 v[54:55], v11 offset:544
    ds_read_b64_tr_b16 v[56:57], v11 offset:800
    ds_read_b64_tr_b16 v[58:59], v11 offset:1056
    ds_read_b64_tr_b16 v[60:61], v11 offset:1312
    ds_read_b64_tr_b16 v[62:63], v11 offset:1568
    ds_read_b64_tr_b16 v[64:65], v11 offset:1824
    ds_read_b64_tr_b16 v[66:67], v11 offset:2080
    ds_read_b64_tr_b16 v[68:69], v11 offset:8480
    ds_read_b64_tr_b16 v[70:71], v11 offset:8736
    ds_read_b64_tr_b16 v[72:73], v11 offset:8992
    ds_read_b64_tr_b16 v[74:75], v11 offset:9248
    ds_read_b64_tr_b16 v[76:77], v11 offset:9504
    ds_read_b64_tr_b16 v[78:79], v11 offset:9760
    ds_read_b64_tr_b16 v[80:81], v11 offset:10016
    ds_read_b64_tr_b16 v[82:83], v11 offset:10272
    s_waitcnt lgkmcnt(0)
    v_alignbit_b32 v84, v17, v16, 16
    v_alignbit_b32 v85, v18, v17, 16
    v_alignbit_b32 v86, v19, v18, 16
    v_alignbit_b32 v87, v20, v19, 16
    v_alignbit_b32 v88, v21, v20, 16
    v_alignbit_b32 v89, v22, v21, 16
    v_alignbit_b32 v90, v23, v22, 16
    v_alignbit_b32 v91, v24, v23, 16
    v_alignbit_b32 v92, v25, v24, 16
    v_alignbit_b32 v93, v26, v25, 16
    v_alignbit_b32 v94, v27, v26, 16
    v_alignbit_b32 v95, v28, v27, 16
    v_alignbit_b32 v96, v29, v28, 16
    v_alignbit_b32 v97, v30, v29, 16
    v_alignbit_b32 v98, v31, v30, 16
    v_alignbit_b32 v99, v32, v31, 16
    v_alignbit_b32 v100, v33, v32, 16
    v_dot2_f32_bf16 v102, v84, v197, 0
    v_dot2_f32_bf16 v103, v17, v197, 0
    v_dot2_f32_bf16 v106, v85, v197, 0
    v_dot2_f32_bf16 v107, v18, v197, 0
    v_dot2_f32_bf16 v110, v86, v197, 0
    v_dot2_f32_bf16 v111, v19, v197, 0
    v_dot2_f32_bf16 v114, v87, v197, 0
    v_dot2_f32_bf16 v115, v20, v197, 0
    v_dot2_f32_bf16 v102, v85, v196, v102
    v_dot2_f32_bf16 v103, v18, v196, v103
    v_dot2_f32_bf16 v106, v86, v196, v106
    v_dot2_f32_bf16 v107, v19, v196, v107
    v_dot2_f32_bf16 v110, v87, v196, v110
    v_dot2_f32_bf16 v111, v20, v196, v111
    v_dot2_f32_bf16 v114, v88, v196, v114
    v_dot2_f32_bf16 v115, v21, v196, v115
    v_lshlrev_b32 v104, 16, v34
    v_and_b32 v105, 0xffff0000, v34
    v_lshlrev_b32 v108, 16, v35
    v_and_b32 v109, 0xffff0000, v35
    v_lshlrev_b32 v112, 16, v36
    v_and_b32 v113, 0xffff0000, v36
    v_lshlrev_b32 v116, 16, v37
    v_and_b32 v117, 0xffff0000, v37
    v_mul_f32 v102, v102, v104
    v_mul_f32 v103, v103, v105
    v_mul_f32 v106, v106, v108
    v_mul_f32 v107, v107, v109
    v_mul_f32 v110, v110, v112
    v_mul_f32 v111, v111, v113
    v_mul_f32 v114, v114, v116
    v_mul_f32 v115, v115, v117
    v_cvt_pk_bf16_f32 v137, v103, v102
    v_cvt_pk_bf16_f32 v136, v107, v106
    v_cvt_pk_bf16_f32 v135, v111, v110
    v_cvt_pk_bf16_f32 v134, v115, v114
    s_add_u32 s4, s72, 128
    buffer_store_dwordx4 v[134:137], v12, s[8:11], s4 offen offset:0
    v_dot2_f32_bf16 v118, v88, v197, 0
    v_dot2_f32_bf16 v119, v21, v197, 0
    v_dot2_f32_bf16 v122, v89, v197, 0
    v_dot2_f32_bf16 v123, v22, v197, 0
    v_dot2_f32_bf16 v126, v90, v197, 0
    v_dot2_f32_bf16 v127, v23, v197, 0
    v_dot2_f32_bf16 v130, v91, v197, 0
    v_dot2_f32_bf16 v131, v24, v197, 0
    v_dot2_f32_bf16 v118, v89, v196, v118
    v_dot2_f32_bf16 v119, v22, v196, v119
    v_dot2_f32_bf16 v122, v90, v196, v122
    v_dot2_f32_bf16 v123, v23, v196, v123
    v_dot2_f32_bf16 v126, v91, v196, v126
    v_dot2_f32_bf16 v127, v24, v196, v127
    v_dot2_f32_bf16 v130, v92, v196, v130
    v_dot2_f32_bf16 v131, v25, v196, v131
    v_lshlrev_b32 v120, 16, v38
    v_and_b32 v121, 0xffff0000, v38
    v_lshlrev_b32 v124, 16, v39
    v_and_b32 v125, 0xffff0000, v39
    v_lshlrev_b32 v128, 16, v40
    v_and_b32 v129, 0xffff0000, v40
    v_lshlrev_b32 v132, 16, v41
    v_and_b32 v133, 0xffff0000, v41
    v_mul_f32 v118, v118, v120
    v_mul_f32 v119, v119, v121
    v_mul_f32 v122, v122, v124
    v_mul_f32 v123, v123, v125
    v_mul_f32 v126, v126, v128
    v_mul_f32 v127, v127, v129
    v_mul_f32 v130, v130, v132
    v_mul_f32 v131, v131, v133
    v_cvt_pk_bf16_f32 v141, v119, v118
    v_cvt_pk_bf16_f32 v140, v123, v122
    v_cvt_pk_bf16_f32 v139, v127, v126
    v_cvt_pk_bf16_f32 v138, v131, v130
    buffer_store_dwordx4 v[138:141], v12, s[8:11], s4 offen offset:1024
    v_dot2_f32_bf16 v102, v92, v197, 0
    v_dot2_f32_bf16 v103, v25, v197, 0
    v_dot2_f32_bf16 v106, v93, v197, 0
    v_dot2_f32_bf16 v107, v26, v197, 0
    v_dot2_f32_bf16 v110, v94, v197, 0
    v_dot2_f32_bf16 v111, v27, v197, 0
    v_dot2_f32_bf16 v114, v95, v197, 0
    v_dot2_f32_bf16 v115, v28, v197, 0
    v_dot2_f32_bf16 v102, v93, v196, v102
    v_dot2_f32_bf16 v103, v26, v196, v103
    v_dot2_f32_bf16 v106, v94, v196, v106
    v_dot2_f32_bf16 v107, v27, v196, v107
    v_dot2_f32_bf16 v110, v95, v196, v110
    v_dot2_f32_bf16 v111, v28, v196, v111
    v_dot2_f32_bf16 v114, v96, v196, v114
    v_dot2_f32_bf16 v115, v29, v196, v115
    v_lshlrev_b32 v104, 16, v42
    v_and_b32 v105, 0xffff0000, v42
    v_lshlrev_b32 v108, 16, v43
    v_and_b32 v109, 0xffff0000, v43
    v_lshlrev_b32 v112, 16, v44
    v_and_b32 v113, 0xffff0000, v44
    v_lshlrev_b32 v116, 16, v45
    v_and_b32 v117, 0xffff0000, v45
    v_mul_f32 v102, v102, v104
    v_mul_f32 v103, v103, v105
    v_mul_f32 v106, v106, v108
    v_mul_f32 v107, v107, v109
    v_mul_f32 v110, v110, v112
    v_mul_f32 v111, v111, v113
    v_mul_f32 v114, v114, v116
    v_mul_f32 v115, v115, v117
    v_cvt_pk_bf16_f32 v145, v103, v102
    v_cvt_pk_bf16_f32 v144, v107, v106
    v_cvt_pk_bf16_f32 v143, v111, v110
    v_cvt_pk_bf16_f32 v142, v115, v114
    buffer_store_dwordx4 v[142:145], v12, s[8:11], s4 offen offset:2048
    v_dot2_f32_bf16 v118, v96, v197, 0
    v_dot2_f32_bf16 v119, v29, v197, 0
    v_dot2_f32_bf16 v122, v97, v197, 0
    v_dot2_f32_bf16 v123, v30, v197, 0
    v_dot2_f32_bf16 v126, v98, v197, 0
    v_dot2_f32_bf16 v127, v31, v197, 0
    v_dot2_f32_bf16 v130, v99, v197, 0
    v_dot2_f32_bf16 v131, v32, v197, 0
    v_dot2_f32_bf16 v118, v97, v196, v118
    v_dot2_f32_bf16 v119, v30, v196, v119
    v_dot2_f32_bf16 v122, v98, v196, v122
    v_dot2_f32_bf16 v123, v31, v196, v123
    v_dot2_f32_bf16 v126, v99, v196, v126
    v_dot2_f32_bf16 v127, v32, v196, v127
    v_dot2_f32_bf16 v130, v100, v196, v130
    v_dot2_f32_bf16 v131, v33, v196, v131
    v_lshlrev_b32 v120, 16, v46
    v_and_b32 v121, 0xffff0000, v46
    v_lshlrev_b32 v124, 16, v47
    v_and_b32 v125, 0xffff0000, v47
    v_lshlrev_b32 v128, 16, v48
    v_and_b32 v129, 0xffff0000, v48
    v_lshlrev_b32 v132, 16, v49
    v_and_b32 v133, 0xffff0000, v49
    v_mul_f32 v118, v118, v120
    v_mul_f32 v119, v119, v121
    v_mul_f32 v122, v122, v124
    v_mul_f32 v123, v123, v125
    v_mul_f32 v126, v126, v128
    v_mul_f32 v127, v127, v129
    v_mul_f32 v130, v130, v132
    v_mul_f32 v131, v131, v133
    v_cvt_pk_bf16_f32 v149, v119, v118
    v_cvt_pk_bf16_f32 v148, v123, v122
    v_cvt_pk_bf16_f32 v147, v127, v126
    v_cvt_pk_bf16_f32 v146, v131, v130
    buffer_store_dwordx4 v[146:149], v12, s[8:11], s4 offen offset:3072
    v_alignbit_b32 v84, v51, v50, 16
    v_alignbit_b32 v85, v52, v51, 16
    v_alignbit_b32 v86, v53, v52, 16
    v_alignbit_b32 v87, v54, v53, 16
    v_alignbit_b32 v88, v55, v54, 16
    v_alignbit_b32 v89, v56, v55, 16
    v_alignbit_b32 v90, v57, v56, 16
    v_alignbit_b32 v91, v58, v57, 16
    v_alignbit_b32 v92, v59, v58, 16
    v_alignbit_b32 v93, v60, v59, 16
    v_alignbit_b32 v94, v61, v60, 16
    v_alignbit_b32 v95, v62, v61, 16
    v_alignbit_b32 v96, v63, v62, 16
    v_alignbit_b32 v97, v64, v63, 16
    v_alignbit_b32 v98, v65, v64, 16
    v_alignbit_b32 v99, v66, v65, 16
    v_alignbit_b32 v100, v67, v66, 16
    v_dot2_f32_bf16 v102, v84, v199, 0
    v_dot2_f32_bf16 v103, v51, v199, 0
    v_dot2_f32_bf16 v106, v85, v199, 0
    v_dot2_f32_bf16 v107, v52, v199, 0
    v_dot2_f32_bf16 v110, v86, v199, 0
    v_dot2_f32_bf16 v111, v53, v199, 0
    v_dot2_f32_bf16 v114, v87, v199, 0
    v_dot2_f32_bf16 v115, v54, v199, 0
    v_dot2_f32_bf16 v102, v85, v198, v102
    v_dot2_f32_bf16 v103, v52, v198, v103
    v_dot2_f32_bf16 v106, v86, v198, v106
    v_dot2_f32_bf16 v107, v53, v198, v107
    v_dot2_f32_bf16 v110, v87, v198, v110
    v_dot2_f32_bf16 v111, v54, v198, v111
    v_dot2_f32_bf16 v114, v88, v198, v114
    v_dot2_f32_bf16 v115, v55, v198, v115
    v_lshlrev_b32 v104, 16, v68
    v_and_b32 v105, 0xffff0000, v68
    v_lshlrev_b32 v108, 16, v69
    v_and_b32 v109, 0xffff0000, v69
    v_lshlrev_b32 v112, 16, v70
    v_and_b32 v113, 0xffff0000, v70
    v_lshlrev_b32 v116, 16, v71
    v_and_b32 v117, 0xffff0000, v71
    v_mul_f32 v102, v102, v104
    v_mul_f32 v103, v103, v105
    v_mul_f32 v106, v106, v108
    v_mul_f32 v107, v107, v109
    v_mul_f32 v110, v110, v112
    v_mul_f32 v111, v111, v113
    v_mul_f32 v114, v114, v116
    v_mul_f32 v115, v115, v117
    v_cvt_pk_bf16_f32 v153, v103, v102
    v_cvt_pk_bf16_f32 v152, v107, v106
    v_cvt_pk_bf16_f32 v151, v111, v110
    v_cvt_pk_bf16_f32 v150, v115, v114
    s_add_u32 s4, s72, 65664
    buffer_store_dwordx4 v[150:153], v12, s[8:11], s4 offen offset:0
    v_dot2_f32_bf16 v118, v88, v199, 0
    v_dot2_f32_bf16 v119, v55, v199, 0
    v_dot2_f32_bf16 v122, v89, v199, 0
    v_dot2_f32_bf16 v123, v56, v199, 0
    v_dot2_f32_bf16 v126, v90, v199, 0
    v_dot2_f32_bf16 v127, v57, v199, 0
    v_dot2_f32_bf16 v130, v91, v199, 0
    v_dot2_f32_bf16 v131, v58, v199, 0
    v_dot2_f32_bf16 v118, v89, v198, v118
    v_dot2_f32_bf16 v119, v56, v198, v119
    v_dot2_f32_bf16 v122, v90, v198, v122
    v_dot2_f32_bf16 v123, v57, v198, v123
    v_dot2_f32_bf16 v126, v91, v198, v126
    v_dot2_f32_bf16 v127, v58, v198, v127
    v_dot2_f32_bf16 v130, v92, v198, v130
    v_dot2_f32_bf16 v131, v59, v198, v131
    v_lshlrev_b32 v120, 16, v72
    v_and_b32 v121, 0xffff0000, v72
    v_lshlrev_b32 v124, 16, v73
    v_and_b32 v125, 0xffff0000, v73
    v_lshlrev_b32 v128, 16, v74
    v_and_b32 v129, 0xffff0000, v74
    v_lshlrev_b32 v132, 16, v75
    v_and_b32 v133, 0xffff0000, v75
    v_mul_f32 v118, v118, v120
    v_mul_f32 v119, v119, v121
    v_mul_f32 v122, v122, v124
    v_mul_f32 v123, v123, v125
    v_mul_f32 v126, v126, v128
    v_mul_f32 v127, v127, v129
    v_mul_f32 v130, v130, v132
    v_mul_f32 v131, v131, v133
    v_cvt_pk_bf16_f32 v157, v119, v118
    v_cvt_pk_bf16_f32 v156, v123, v122
    v_cvt_pk_bf16_f32 v155, v127, v126
    v_cvt_pk_bf16_f32 v154, v131, v130
    buffer_store_dwordx4 v[154:157], v12, s[8:11], s4 offen offset:1024
    v_dot2_f32_bf16 v102, v92, v199, 0
    v_dot2_f32_bf16 v103, v59, v199, 0
    v_dot2_f32_bf16 v106, v93, v199, 0
    v_dot2_f32_bf16 v107, v60, v199, 0
    v_dot2_f32_bf16 v110, v94, v199, 0
    v_dot2_f32_bf16 v111, v61, v199, 0
    v_dot2_f32_bf16 v114, v95, v199, 0
    v_dot2_f32_bf16 v115, v62, v199, 0
    v_dot2_f32_bf16 v102, v93, v198, v102
    v_dot2_f32_bf16 v103, v60, v198, v103
    v_dot2_f32_bf16 v106, v94, v198, v106
    v_dot2_f32_bf16 v107, v61, v198, v107
    v_dot2_f32_bf16 v110, v95, v198, v110
    v_dot2_f32_bf16 v111, v62, v198, v111
    v_dot2_f32_bf16 v114, v96, v198, v114
    v_dot2_f32_bf16 v115, v63, v198, v115
    v_lshlrev_b32 v104, 16, v76
    v_and_b32 v105, 0xffff0000, v76
    v_lshlrev_b32 v108, 16, v77
    v_and_b32 v109, 0xffff0000, v77
    v_lshlrev_b32 v112, 16, v78
    v_and_b32 v113, 0xffff0000, v78
    v_lshlrev_b32 v116, 16, v79
    v_and_b32 v117, 0xffff0000, v79
    v_mul_f32 v102, v102, v104
    v_mul_f32 v103, v103, v105
    v_mul_f32 v106, v106, v108
    v_mul_f32 v107, v107, v109
    v_mul_f32 v110, v110, v112
    v_mul_f32 v111, v111, v113
    v_mul_f32 v114, v114, v116
    v_mul_f32 v115, v115, v117
    v_cvt_pk_bf16_f32 v161, v103, v102
    v_cvt_pk_bf16_f32 v160, v107, v106
    v_cvt_pk_bf16_f32 v159, v111, v110
    v_cvt_pk_bf16_f32 v158, v115, v114
    buffer_store_dwordx4 v[158:161], v12, s[8:11], s4 offen offset:2048
    v_dot2_f32_bf16 v118, v96, v199, 0
    v_dot2_f32_bf16 v119, v63, v199, 0
    v_dot2_f32_bf16 v122, v97, v199, 0
    v_dot2_f32_bf16 v123, v64, v199, 0
    v_dot2_f32_bf16 v126, v98, v199, 0
    v_dot2_f32_bf16 v127, v65, v199, 0
    v_dot2_f32_bf16 v130, v99, v199, 0
    v_dot2_f32_bf16 v131, v66, v199, 0
    v_dot2_f32_bf16 v118, v97, v198, v118
    v_dot2_f32_bf16 v119, v64, v198, v119
    v_dot2_f32_bf16 v122, v98, v198, v122
    v_dot2_f32_bf16 v123, v65, v198, v123
    v_dot2_f32_bf16 v126, v99, v198, v126
    v_dot2_f32_bf16 v127, v66, v198, v127
    v_dot2_f32_bf16 v130, v100, v198, v130
    v_dot2_f32_bf16 v131, v67, v198, v131
    v_lshlrev_b32 v120, 16, v80
    v_and_b32 v121, 0xffff0000, v80
    v_lshlrev_b32 v124, 16, v81
    v_and_b32 v125, 0xffff0000, v81
    v_lshlrev_b32 v128, 16, v82
    v_and_b32 v129, 0xffff0000, v82
    v_lshlrev_b32 v132, 16, v83
    v_and_b32 v133, 0xffff0000, v83
    v_mul_f32 v118, v118, v120
    v_mul_f32 v119, v119, v121
    v_mul_f32 v122, v122, v124
    v_mul_f32 v123, v123, v125
    v_mul_f32 v126, v126, v128
    v_mul_f32 v127, v127, v129
    v_mul_f32 v130, v130, v132
    v_mul_f32 v131, v131, v133
    v_cvt_pk_bf16_f32 v165, v119, v118
    v_cvt_pk_bf16_f32 v164, v123, v122
    v_cvt_pk_bf16_f32 v163, v127, v126
    v_cvt_pk_bf16_f32 v162, v131, v130
    buffer_store_dwordx4 v[162:165], v12, s[8:11], s4 offen offset:3072
    s_waitcnt vmcnt(8)
    ds_read_b64_tr_b16 v[16:17], v11 offset:16640
    ds_read_b64_tr_b16 v[18:19], v11 offset:16896
    ds_read_b64_tr_b16 v[20:21], v11 offset:17152
    ds_read_b64_tr_b16 v[22:23], v11 offset:17408
    ds_read_b64_tr_b16 v[24:25], v11 offset:17664
    ds_read_b64_tr_b16 v[26:27], v11 offset:17920
    ds_read_b64_tr_b16 v[28:29], v11 offset:18176
    ds_read_b64_tr_b16 v[30:31], v11 offset:18432
    ds_read_b64_tr_b16 v[32:33], v11 offset:18688
    ds_read_b64_tr_b16 v[34:35], v11 offset:25088
    ds_read_b64_tr_b16 v[36:37], v11 offset:25344
    ds_read_b64_tr_b16 v[38:39], v11 offset:25600
    ds_read_b64_tr_b16 v[40:41], v11 offset:25856
    ds_read_b64_tr_b16 v[42:43], v11 offset:26112
    ds_read_b64_tr_b16 v[44:45], v11 offset:26368
    ds_read_b64_tr_b16 v[46:47], v11 offset:26624
    ds_read_b64_tr_b16 v[48:49], v11 offset:26880
    ds_read_b64_tr_b16 v[50:51], v11 offset:16672
    ds_read_b64_tr_b16 v[52:53], v11 offset:16928
    ds_read_b64_tr_b16 v[54:55], v11 offset:17184
    ds_read_b64_tr_b16 v[56:57], v11 offset:17440
    ds_read_b64_tr_b16 v[58:59], v11 offset:17696
    ds_read_b64_tr_b16 v[60:61], v11 offset:17952
    ds_read_b64_tr_b16 v[62:63], v11 offset:18208
    ds_read_b64_tr_b16 v[64:65], v11 offset:18464
    ds_read_b64_tr_b16 v[66:67], v11 offset:18720
    ds_read_b64_tr_b16 v[68:69], v11 offset:25120
    ds_read_b64_tr_b16 v[70:71], v11 offset:25376
    ds_read_b64_tr_b16 v[72:73], v11 offset:25632
    ds_read_b64_tr_b16 v[74:75], v11 offset:25888
    ds_read_b64_tr_b16 v[76:77], v11 offset:26144
    ds_read_b64_tr_b16 v[78:79], v11 offset:26400
    ds_read_b64_tr_b16 v[80:81], v11 offset:26656
    ds_read_b64_tr_b16 v[82:83], v11 offset:26912
    s_waitcnt lgkmcnt(0)
    v_alignbit_b32 v84, v17, v16, 16
    v_alignbit_b32 v85, v18, v17, 16
    v_alignbit_b32 v86, v19, v18, 16
    v_alignbit_b32 v87, v20, v19, 16
    v_alignbit_b32 v88, v21, v20, 16
    v_alignbit_b32 v89, v22, v21, 16
    v_alignbit_b32 v90, v23, v22, 16
    v_alignbit_b32 v91, v24, v23, 16
    v_alignbit_b32 v92, v25, v24, 16
    v_alignbit_b32 v93, v26, v25, 16
    v_alignbit_b32 v94, v27, v26, 16
    v_alignbit_b32 v95, v28, v27, 16
    v_alignbit_b32 v96, v29, v28, 16
    v_alignbit_b32 v97, v30, v29, 16
    v_alignbit_b32 v98, v31, v30, 16
    v_alignbit_b32 v99, v32, v31, 16
    v_alignbit_b32 v100, v33, v32, 16
    v_dot2_f32_bf16 v102, v84, v197, 0
    v_dot2_f32_bf16 v103, v17, v197, 0
    v_dot2_f32_bf16 v106, v85, v197, 0
    v_dot2_f32_bf16 v107, v18, v197, 0
    v_dot2_f32_bf16 v110, v86, v197, 0
    v_dot2_f32_bf16 v111, v19, v197, 0
    v_dot2_f32_bf16 v114, v87, v197, 0
    v_dot2_f32_bf16 v115, v20, v197, 0
    v_dot2_f32_bf16 v102, v85, v196, v102
    v_dot2_f32_bf16 v103, v18, v196, v103
    v_dot2_f32_bf16 v106, v86, v196, v106
    v_dot2_f32_bf16 v107, v19, v196, v107
    v_dot2_f32_bf16 v110, v87, v196, v110
    v_dot2_f32_bf16 v111, v20, v196, v111
    v_dot2_f32_bf16 v114, v88, v196, v114
    v_dot2_f32_bf16 v115, v21, v196, v115
    v_lshlrev_b32 v104, 16, v34
    v_and_b32 v105, 0xffff0000, v34
    v_lshlrev_b32 v108, 16, v35
    v_and_b32 v109, 0xffff0000, v35
    v_lshlrev_b32 v112, 16, v36
    v_and_b32 v113, 0xffff0000, v36
    v_lshlrev_b32 v116, 16, v37
    v_and_b32 v117, 0xffff0000, v37
    v_mul_f32 v102, v102, v104
    v_mul_f32 v103, v103, v105
    v_mul_f32 v106, v106, v108
    v_mul_f32 v107, v107, v109
    v_mul_f32 v110, v110, v112
    v_mul_f32 v111, v111, v113
    v_mul_f32 v114, v114, v116
    v_mul_f32 v115, v115, v117
    v_cvt_pk_bf16_f32 v137, v103, v102
    v_cvt_pk_bf16_f32 v136, v107, v106
    v_cvt_pk_bf16_f32 v135, v111, v110
    v_cvt_pk_bf16_f32 v134, v115, v114
    s_add_u32 s4, s72, 192
    buffer_store_dwordx4 v[134:137], v12, s[8:11], s4 offen offset:0
    v_dot2_f32_bf16 v118, v88, v197, 0
    v_dot2_f32_bf16 v119, v21, v197, 0
    v_dot2_f32_bf16 v122, v89, v197, 0
    v_dot2_f32_bf16 v123, v22, v197, 0
    v_dot2_f32_bf16 v126, v90, v197, 0
    v_dot2_f32_bf16 v127, v23, v197, 0
    v_dot2_f32_bf16 v130, v91, v197, 0
    v_dot2_f32_bf16 v131, v24, v197, 0
    v_dot2_f32_bf16 v118, v89, v196, v118
    v_dot2_f32_bf16 v119, v22, v196, v119
    v_dot2_f32_bf16 v122, v90, v196, v122
    v_dot2_f32_bf16 v123, v23, v196, v123
    v_dot2_f32_bf16 v126, v91, v196, v126
    v_dot2_f32_bf16 v127, v24, v196, v127
    v_dot2_f32_bf16 v130, v92, v196, v130
    v_dot2_f32_bf16 v131, v25, v196, v131
    v_lshlrev_b32 v120, 16, v38
    v_and_b32 v121, 0xffff0000, v38
    v_lshlrev_b32 v124, 16, v39
    v_and_b32 v125, 0xffff0000, v39
    v_lshlrev_b32 v128, 16, v40
    v_and_b32 v129, 0xffff0000, v40
    v_lshlrev_b32 v132, 16, v41
    v_and_b32 v133, 0xffff0000, v41
    v_mul_f32 v118, v118, v120
    v_mul_f32 v119, v119, v121
    v_mul_f32 v122, v122, v124
    v_mul_f32 v123, v123, v125
    v_mul_f32 v126, v126, v128
    v_mul_f32 v127, v127, v129
    v_mul_f32 v130, v130, v132
    v_mul_f32 v131, v131, v133
    v_cvt_pk_bf16_f32 v141, v119, v118
    v_cvt_pk_bf16_f32 v140, v123, v122
    v_cvt_pk_bf16_f32 v139, v127, v126
    v_cvt_pk_bf16_f32 v138, v131, v130
    buffer_store_dwordx4 v[138:141], v12, s[8:11], s4 offen offset:1024
    v_dot2_f32_bf16 v102, v92, v197, 0
    v_dot2_f32_bf16 v103, v25, v197, 0
    v_dot2_f32_bf16 v106, v93, v197, 0
    v_dot2_f32_bf16 v107, v26, v197, 0
    v_dot2_f32_bf16 v110, v94, v197, 0
    v_dot2_f32_bf16 v111, v27, v197, 0
    v_dot2_f32_bf16 v114, v95, v197, 0
    v_dot2_f32_bf16 v115, v28, v197, 0
    v_dot2_f32_bf16 v102, v93, v196, v102
    v_dot2_f32_bf16 v103, v26, v196, v103
    v_dot2_f32_bf16 v106, v94, v196, v106
    v_dot2_f32_bf16 v107, v27, v196, v107
    v_dot2_f32_bf16 v110, v95, v196, v110
    v_dot2_f32_bf16 v111, v28, v196, v111
    v_dot2_f32_bf16 v114, v96, v196, v114
    v_dot2_f32_bf16 v115, v29, v196, v115
    v_lshlrev_b32 v104, 16, v42
    v_and_b32 v105, 0xffff0000, v42
    v_lshlrev_b32 v108, 16, v43
    v_and_b32 v109, 0xffff0000, v43
    v_lshlrev_b32 v112, 16, v44
    v_and_b32 v113, 0xffff0000, v44
    v_lshlrev_b32 v116, 16, v45
    v_and_b32 v117, 0xffff0000, v45
    v_mul_f32 v102, v102, v104
    v_mul_f32 v103, v103, v105
    v_mul_f32 v106, v106, v108
    v_mul_f32 v107, v107, v109
    v_mul_f32 v110, v110, v112
    v_mul_f32 v111, v111, v113
    v_mul_f32 v114, v114, v116
    v_mul_f32 v115, v115, v117
    v_cvt_pk_bf16_f32 v145, v103, v102
    v_cvt_pk_bf16_f32 v144, v107, v106
    v_cvt_pk_bf16_f32 v143, v111, v110
    v_cvt_pk_bf16_f32 v142, v115, v114
    buffer_store_dwordx4 v[142:145], v12, s[8:11], s4 offen offset:2048
    v_dot2_f32_bf16 v118, v96, v197, 0
    v_dot2_f32_bf16 v119, v29, v197, 0
    v_dot2_f32_bf16 v122, v97, v197, 0
    v_dot2_f32_bf16 v123, v30, v197, 0
    v_dot2_f32_bf16 v126, v98, v197, 0
    v_dot2_f32_bf16 v127, v31, v197, 0
    v_dot2_f32_bf16 v130, v99, v197, 0
    v_dot2_f32_bf16 v131, v32, v197, 0
    v_dot2_f32_bf16 v118, v97, v196, v118
    v_dot2_f32_bf16 v119, v30, v196, v119
    v_dot2_f32_bf16 v122, v98, v196, v122
    v_dot2_f32_bf16 v123, v31, v196, v123
    v_dot2_f32_bf16 v126, v99, v196, v126
    v_dot2_f32_bf16 v127, v32, v196, v127
    v_dot2_f32_bf16 v130, v100, v196, v130
    v_dot2_f32_bf16 v131, v33, v196, v131
    v_lshlrev_b32 v120, 16, v46
    v_and_b32 v121, 0xffff0000, v46
    v_lshlrev_b32 v124, 16, v47
    v_and_b32 v125, 0xffff0000, v47
    v_lshlrev_b32 v128, 16, v48
    v_and_b32 v129, 0xffff0000, v48
    v_lshlrev_b32 v132, 16, v49
    v_and_b32 v133, 0xffff0000, v49
    v_mul_f32 v118, v118, v120
    v_mul_f32 v119, v119, v121
    v_mul_f32 v122, v122, v124
    v_mul_f32 v123, v123, v125
    v_mul_f32 v126, v126, v128
    v_mul_f32 v127, v127, v129
    v_mul_f32 v130, v130, v132
    v_mul_f32 v131, v131, v133
    v_cvt_pk_bf16_f32 v149, v119, v118
    v_cvt_pk_bf16_f32 v148, v123, v122
    v_cvt_pk_bf16_f32 v147, v127, v126
    v_cvt_pk_bf16_f32 v146, v131, v130
    buffer_store_dwordx4 v[146:149], v12, s[8:11], s4 offen offset:3072
    v_alignbit_b32 v84, v51, v50, 16
    v_alignbit_b32 v85, v52, v51, 16
    v_alignbit_b32 v86, v53, v52, 16
    v_alignbit_b32 v87, v54, v53, 16
    v_alignbit_b32 v88, v55, v54, 16
    v_alignbit_b32 v89, v56, v55, 16
    v_alignbit_b32 v90, v57, v56, 16
    v_alignbit_b32 v91, v58, v57, 16
    v_alignbit_b32 v92, v59, v58, 16
    v_alignbit_b32 v93, v60, v59, 16
    v_alignbit_b32 v94, v61, v60, 16
    v_alignbit_b32 v95, v62, v61, 16
    v_alignbit_b32 v96, v63, v62, 16
    v_alignbit_b32 v97, v64, v63, 16
    v_alignbit_b32 v98, v65, v64, 16
    v_alignbit_b32 v99, v66, v65, 16
    v_alignbit_b32 v100, v67, v66, 16
    v_dot2_f32_bf16 v102, v84, v199, 0
    v_dot2_f32_bf16 v103, v51, v199, 0
    v_dot2_f32_bf16 v106, v85, v199, 0
    v_dot2_f32_bf16 v107, v52, v199, 0
    v_dot2_f32_bf16 v110, v86, v199, 0
    v_dot2_f32_bf16 v111, v53, v199, 0
    v_dot2_f32_bf16 v114, v87, v199, 0
    v_dot2_f32_bf16 v115, v54, v199, 0
    v_dot2_f32_bf16 v102, v85, v198, v102
    v_dot2_f32_bf16 v103, v52, v198, v103
    v_dot2_f32_bf16 v106, v86, v198, v106
    v_dot2_f32_bf16 v107, v53, v198, v107
    v_dot2_f32_bf16 v110, v87, v198, v110
    v_dot2_f32_bf16 v111, v54, v198, v111
    v_dot2_f32_bf16 v114, v88, v198, v114
    v_dot2_f32_bf16 v115, v55, v198, v115
    v_lshlrev_b32 v104, 16, v68
    v_and_b32 v105, 0xffff0000, v68
    v_lshlrev_b32 v108, 16, v69
    v_and_b32 v109, 0xffff0000, v69
    v_lshlrev_b32 v112, 16, v70
    v_and_b32 v113, 0xffff0000, v70
    v_lshlrev_b32 v116, 16, v71
    v_and_b32 v117, 0xffff0000, v71
    v_mul_f32 v102, v102, v104
    v_mul_f32 v103, v103, v105
    v_mul_f32 v106, v106, v108
    v_mul_f32 v107, v107, v109
    v_mul_f32 v110, v110, v112
    v_mul_f32 v111, v111, v113
    v_mul_f32 v114, v114, v116
    v_mul_f32 v115, v115, v117
    v_cvt_pk_bf16_f32 v153, v103, v102
    v_cvt_pk_bf16_f32 v152, v107, v106
    v_cvt_pk_bf16_f32 v151, v111, v110
    v_cvt_pk_bf16_f32 v150, v115, v114
    s_add_u32 s4, s72, 65728
    buffer_store_dwordx4 v[150:153], v12, s[8:11], s4 offen offset:0
    v_dot2_f32_bf16 v118, v88, v199, 0
    v_dot2_f32_bf16 v119, v55, v199, 0
    v_dot2_f32_bf16 v122, v89, v199, 0
    v_dot2_f32_bf16 v123, v56, v199, 0
    v_dot2_f32_bf16 v126, v90, v199, 0
    v_dot2_f32_bf16 v127, v57, v199, 0
    v_dot2_f32_bf16 v130, v91, v199, 0
    v_dot2_f32_bf16 v131, v58, v199, 0
    v_dot2_f32_bf16 v118, v89, v198, v118
    v_dot2_f32_bf16 v119, v56, v198, v119
    v_dot2_f32_bf16 v122, v90, v198, v122
    v_dot2_f32_bf16 v123, v57, v198, v123
    v_dot2_f32_bf16 v126, v91, v198, v126
    v_dot2_f32_bf16 v127, v58, v198, v127
    v_dot2_f32_bf16 v130, v92, v198, v130
    v_dot2_f32_bf16 v131, v59, v198, v131
    v_lshlrev_b32 v120, 16, v72
    v_and_b32 v121, 0xffff0000, v72
    v_lshlrev_b32 v124, 16, v73
    v_and_b32 v125, 0xffff0000, v73
    v_lshlrev_b32 v128, 16, v74
    v_and_b32 v129, 0xffff0000, v74
    v_lshlrev_b32 v132, 16, v75
    v_and_b32 v133, 0xffff0000, v75
    v_mul_f32 v118, v118, v120
    v_mul_f32 v119, v119, v121
    v_mul_f32 v122, v122, v124
    v_mul_f32 v123, v123, v125
    v_mul_f32 v126, v126, v128
    v_mul_f32 v127, v127, v129
    v_mul_f32 v130, v130, v132
    v_mul_f32 v131, v131, v133
    v_cvt_pk_bf16_f32 v157, v119, v118
    v_cvt_pk_bf16_f32 v156, v123, v122
    v_cvt_pk_bf16_f32 v155, v127, v126
    v_cvt_pk_bf16_f32 v154, v131, v130
    buffer_store_dwordx4 v[154:157], v12, s[8:11], s4 offen offset:1024
    v_dot2_f32_bf16 v102, v92, v199, 0
    v_dot2_f32_bf16 v103, v59, v199, 0
    v_dot2_f32_bf16 v106, v93, v199, 0
    v_dot2_f32_bf16 v107, v60, v199, 0
    v_dot2_f32_bf16 v110, v94, v199, 0
    v_dot2_f32_bf16 v111, v61, v199, 0
    v_dot2_f32_bf16 v114, v95, v199, 0
    v_dot2_f32_bf16 v115, v62, v199, 0
    v_dot2_f32_bf16 v102, v93, v198, v102
    v_dot2_f32_bf16 v103, v60, v198, v103
    v_dot2_f32_bf16 v106, v94, v198, v106
    v_dot2_f32_bf16 v107, v61, v198, v107
    v_dot2_f32_bf16 v110, v95, v198, v110
    v_dot2_f32_bf16 v111, v62, v198, v111
    v_dot2_f32_bf16 v114, v96, v198, v114
    v_dot2_f32_bf16 v115, v63, v198, v115
    v_lshlrev_b32 v104, 16, v76
    v_and_b32 v105, 0xffff0000, v76
    v_lshlrev_b32 v108, 16, v77
    v_and_b32 v109, 0xffff0000, v77
    v_lshlrev_b32 v112, 16, v78
    v_and_b32 v113, 0xffff0000, v78
    v_lshlrev_b32 v116, 16, v79
    v_and_b32 v117, 0xffff0000, v79
    v_mul_f32 v102, v102, v104
    v_mul_f32 v103, v103, v105
    v_mul_f32 v106, v106, v108
    v_mul_f32 v107, v107, v109
    v_mul_f32 v110, v110, v112
    v_mul_f32 v111, v111, v113
    v_mul_f32 v114, v114, v116
    v_mul_f32 v115, v115, v117
    v_cvt_pk_bf16_f32 v161, v103, v102
    v_cvt_pk_bf16_f32 v160, v107, v106
    v_cvt_pk_bf16_f32 v159, v111, v110
    v_cvt_pk_bf16_f32 v158, v115, v114
    buffer_store_dwordx4 v[158:161], v12, s[8:11], s4 offen offset:2048
    v_dot2_f32_bf16 v118, v96, v199, 0
    v_dot2_f32_bf16 v119, v63, v199, 0
    v_dot2_f32_bf16 v122, v97, v199, 0
    v_dot2_f32_bf16 v123, v64, v199, 0
    v_dot2_f32_bf16 v126, v98, v199, 0
    v_dot2_f32_bf16 v127, v65, v199, 0
    v_dot2_f32_bf16 v130, v99, v199, 0
    v_dot2_f32_bf16 v131, v66, v199, 0
    v_dot2_f32_bf16 v118, v97, v198, v118
    v_dot2_f32_bf16 v119, v64, v198, v119
    v_dot2_f32_bf16 v122, v98, v198, v122
    v_dot2_f32_bf16 v123, v65, v198, v123
    v_dot2_f32_bf16 v126, v99, v198, v126
    v_dot2_f32_bf16 v127, v66, v198, v127
    v_dot2_f32_bf16 v130, v100, v198, v130
    v_dot2_f32_bf16 v131, v67, v198, v131
    v_lshlrev_b32 v120, 16, v80
    v_and_b32 v121, 0xffff0000, v80
    v_lshlrev_b32 v124, 16, v81
    v_and_b32 v125, 0xffff0000, v81
    v_lshlrev_b32 v128, 16, v82
    v_and_b32 v129, 0xffff0000, v82
    v_lshlrev_b32 v132, 16, v83
    v_and_b32 v133, 0xffff0000, v83
    v_mul_f32 v118, v118, v120
    v_mul_f32 v119, v119, v121
    v_mul_f32 v122, v122, v124
    v_mul_f32 v123, v123, v125
    v_mul_f32 v126, v126, v128
    v_mul_f32 v127, v127, v129
    v_mul_f32 v130, v130, v132
    v_mul_f32 v131, v131, v133
    v_cvt_pk_bf16_f32 v165, v119, v118
    v_cvt_pk_bf16_f32 v164, v123, v122
    v_cvt_pk_bf16_f32 v163, v127, v126
    v_cvt_pk_bf16_f32 v162, v131, v130
    buffer_store_dwordx4 v[162:165], v12, s[8:11], s4 offen offset:3072
    s_waitcnt vmcnt(0)
    s_barrier
    s_load_dwordx4 s[52:55], s[0:1], 32
    s_lshl_b32 s3, s93, 5
    s_lshl_b32 s4, s24, 3
    s_add_u32 s3, s3, s4
    s_lshl_b32 s4, s3, 1
    s_waitcnt lgkmcnt(0)
    s_load_dwordx4 s[64:67], s[54:55], s4

    s_mov_b32 s28, s52
    s_and_b32 s29, s53, 0xffff
    s_mov_b32 s30, 0x400000
    s_mov_b32 s31, 0x00020000

    v_and_b32 v1, 63, v0
    v_and_b32 v2, 15, v1
    v_lshrrev_b32 v3, 4, v1

    s_lshl_b32 s32, s3, 12
    s_add_u32 s33, s32, 28672
    s_mul_i32 s34, s24, 38400
    s_add_u32 s35, s34, 33536
    s_add_u32 s38, s32, 117440512
    v_lshlrev_b32 v4, 4, v1
    v_add_u32 v5, s34, v4
    v_add_u32 v5, 64, v5
    v_sub_u32 v6, 7, v2
    v_and_b32 v6, 7, v6
    v_mul_u32_u24 v6, 4160, v6
    v_lshrrev_b32 v7, 3, v2
    v_sub_u32 v7, v7, v3
    v_add_u32 v7, 4, v7
    v_lshl_add_u32 v6, v7, 4, v6
    v_add_u32 v6, s34, v6
    v_mul_u32_u24 v7, 80, v3
    v_add_u32 v7, v7, v2
    v_lshlrev_b32 v7, 4, v7
    v_add_u32 v7, s34, v7
    v_add_u32 v7, 33296, v7
    v_lshlrev_b32 v228, 7, v2
    v_lshl_add_u32 v228, v3, 4, v228
    v_subrev_u32 v229, 16, v4
    v_max_i32 v230, 0, v229
    v_sub_u32 v232, 7, v2
    v_and_b32 v232, 7, v232
    v_and_b32 v233, 1, v232
    v_lshlrev_b32 v233, 4, v233
    v_mov_b32 v234, 0xffff
    v_lshlrev_b32 v233, v233, v234
    v_lshrrev_b32 v232, 1, v232
    v_lshrrev_b32 v234, 3, v2
    v_sub_u32 v234, v3, v234
    v_lshl_add_u32 v232, v234, 1, v232
    v_and_b32 v234, 1, v234
    v_lshl_add_u32 v232, v234, 8, v232

    v_cmp_eq_u32 vcc, 0, v232
    s_nop 1
    v_cndmask_b32 v8, 0, v233, vcc
    v_cmp_eq_u32 vcc, 1, v232
    s_nop 1
    v_cndmask_b32 v9, 0, v233, vcc
    v_cmp_eq_u32 vcc, 2, v232
    s_nop 1
    v_cndmask_b32 v10, 0, v233, vcc
    v_cmp_eq_u32 vcc, 3, v232
    s_nop 1
    v_cndmask_b32 v11, 0, v233, vcc
    v_cmp_eq_u32 vcc, 4, v232
    s_nop 1
    v_cndmask_b32 v12, 0, v233, vcc
    v_cmp_eq_u32 vcc, 5, v232
    s_nop 1
    v_cndmask_b32 v13, 0, v233, vcc
    v_cmp_eq_u32 vcc, 6, v232
    s_nop 1
    v_cndmask_b32 v14, 0, v233, vcc
    v_cmp_eq_u32 vcc, 7, v232
    s_nop 1
    v_cndmask_b32 v15, 0, v233, vcc
    v_mov_b32 v208, 0
    v_mov_b32 v209, 0
    v_mov_b32 v210, 0
    v_mov_b32 v211, 0
    v_lshrrev_b32 v232, 2, v1
    v_and_b32 v232, 7, v232
    v_mul_u32_u24 v232, 4160, v232
    v_and_b32 v233, 3, v1
    v_lshl_add_u32 v232, v233, 4, v232
    v_add_u32 v232, s34, v232
    ds_write_b128 v232, v[208:211]
    v_subrev_u32 v233, 16, v7
    ds_write_b128 v233, v[208:211]

    s_add_u32 s39, s32, 125829120
    buffer_load_dwordx4 v[176:179], v230, s[28:31], s32 offen offset:0
    buffer_load_dwordx4 v[180:183], v4, s[28:31], s32 offen offset:0
    buffer_load_dwordx4 v[184:187], v4, s[28:31], s32 offen offset:1008
    buffer_load_dwordx4 v[188:191], v4, s[28:31], s32 offen offset:1024
    buffer_load_dwordx4 v[192:195], v4, s[28:31], s32 offen offset:2032
    buffer_load_dwordx4 v[196:199], v4, s[28:31], s32 offen offset:2048
    buffer_load_dwordx4 v[200:203], v4, s[28:31], s32 offen offset:3056
    buffer_load_dwordx4 v[204:207], v4, s[28:31], s32 offen offset:3072
    s_add_u32 m0, s35, 0
    s_nop 0
    buffer_load_dwordx4 v4, s[8:11], s39 offen offset:0 lds
    s_add_u32 m0, s35, 256
    s_nop 0
    buffer_load_dwordx4 v4, s[8:11], s39 offen offset:1024 lds
    s_add_u32 m0, s35, 512
    s_nop 0
    buffer_load_dwordx4 v4, s[8:11], s39 offen offset:2048 lds
    s_add_u32 m0, s35, 768
    s_nop 0
    buffer_load_dwordx4 v4, s[8:11], s39 offen offset:3072 lds
    s_waitcnt vmcnt(0) lgkmcnt(0)
    s_pack_ll_b32_b16 s40, s64, s64
    s_add_u32 s36, s32, 4096
    s_add_u32 s37, s32, 8192
    s_add_u32 s39, s36, 125829120
    s_mov_b64 exec, 1
    v_mov_b32 v176, 0
    v_mov_b32 v177, 0
    v_mov_b32 v178, 0
    v_mov_b32 v179, 0
    s_mov_b64 exec, -1
    ds_write_b128 v5, v[180:183] offset:0
    ds_write_b128 v5, v[178:181] offset:16640
    v_mov_b32 v208, v177
    v_mov_b32 v209, v178
    v_mov_b32 v210, v179
    v_mov_b32 v211, v180
    ds_write_b128 v5, v[208:211] offset:24960
    v_mov_b32 v212, v181
    v_mov_b32 v213, v182
    ds_write_b128 v5, v[210:213] offset:8320
    v_alignbit_b32 v214, v177, v176, 16
    v_alignbit_b32 v215, v178, v177, 16
    v_alignbit_b32 v216, v179, v178, 16
    v_alignbit_b32 v217, v180, v179, 16
    ds_write_b128 v5, v[214:217] offset:29120
    v_alignbit_b32 v218, v181, v180, 16
    v_alignbit_b32 v219, v182, v181, 16
    ds_write_b128 v5, v[216:219] offset:12480
    v_alignbit_b32 v220, v178, v177, 16
    v_alignbit_b32 v221, v179, v178, 16
    v_alignbit_b32 v222, v180, v179, 16
    v_alignbit_b32 v223, v181, v180, 16
    ds_write_b128 v5, v[220:223] offset:20800
    v_alignbit_b32 v224, v182, v181, 16
    v_alignbit_b32 v225, v183, v182, 16
    ds_write_b128 v5, v[222:225] offset:4160
    buffer_load_dwordx4 v[176:179], v230, s[28:31], s36 offen offset:0
    buffer_load_dwordx4 v[180:183], v4, s[28:31], s36 offen offset:0
    ds_write_b128 v5, v[188:191] offset:1024
    ds_write_b128 v5, v[186:189] offset:17664
    v_mov_b32 v208, v185
    v_mov_b32 v209, v186
    v_mov_b32 v210, v187
    v_mov_b32 v211, v188
    ds_write_b128 v5, v[208:211] offset:25984
    v_mov_b32 v212, v189
    v_mov_b32 v213, v190
    ds_write_b128 v5, v[210:213] offset:9344
    v_alignbit_b32 v214, v185, v184, 16
    v_alignbit_b32 v215, v186, v185, 16
    v_alignbit_b32 v216, v187, v186, 16
    v_alignbit_b32 v217, v188, v187, 16
    ds_write_b128 v5, v[214:217] offset:30144
    v_alignbit_b32 v218, v189, v188, 16
    v_alignbit_b32 v219, v190, v189, 16
    ds_write_b128 v5, v[216:219] offset:13504
    v_alignbit_b32 v220, v186, v185, 16
    v_alignbit_b32 v221, v187, v186, 16
    v_alignbit_b32 v222, v188, v187, 16
    v_alignbit_b32 v223, v189, v188, 16
    ds_write_b128 v5, v[220:223] offset:21824
    v_alignbit_b32 v224, v190, v189, 16
    v_alignbit_b32 v225, v191, v190, 16
    ds_write_b128 v5, v[222:225] offset:5184
    buffer_load_dwordx4 v[184:187], v4, s[28:31], s36 offen offset:1008
    buffer_load_dwordx4 v[188:191], v4, s[28:31], s36 offen offset:1024
    v_and_b32 v236, s40, v8
    v_and_b32 v237, s40, v9
    v_and_b32 v238, s40, v10
    v_and_b32 v239, s40, v11
    v_and_b32 v240, s40, v12
    v_and_b32 v241, s40, v13
    v_and_b32 v242, s40, v14
    v_and_b32 v243, s40, v15
    ds_read_b128 a[60:63], v7 offset:240
    ds_read_b128 a[124:127], v7 offset:496
    ds_read_b128 a[188:191], v7 offset:752
    ds_read_b128 a[252:255], v7 offset:1008
    ds_read_b128 v[168:171], v6 offset:0
    ds_read_b128 v[172:175], v6 offset:32
    s_waitcnt vmcnt(0) lgkmcnt(0)
    s_mov_b32 s42, 0
.cvl_471:
    s_waitcnt lgkmcnt(5)
    v_mfma_f32_16x16x32_bf16 v[16:19], v[236:239], a[60:63], 0
    v_mfma_f32_16x16x32_bf16 v[32:35], v[240:243], a[60:63], 0
    s_waitcnt lgkmcnt(4)
    v_mfma_f32_16x16x32_bf16 v[20:23], v[236:239], a[124:127], 0
    v_mfma_f32_16x16x32_bf16 v[36:39], v[240:243], a[124:127], 0
    s_waitcnt lgkmcnt(3)
    v_mfma_f32_16x16x32_bf16 v[24:27], v[236:239], a[188:191], 0
    v_mfma_f32_16x16x32_bf16 v[40:43], v[240:243], a[188:191], 0
    ds_read_b128 a[56:59], v7 offset:224
    s_waitcnt lgkmcnt(3)
    v_mfma_f32_16x16x32_bf16 v[28:31], v[236:239], a[252:255], 0
    ds_read_b128 v[112:115], v6 offset:64
    v_mfma_f32_16x16x32_bf16 v[44:47], v[240:243], a[252:255], 0
    ds_read_b128 v[116:119], v6 offset:96
    s_waitcnt lgkmcnt(4)
    v_mfma_f32_16x16x32_bf16 v[16:19], v[168:171], a[60:63], v[16:19]
    ds_read_b128 a[120:123], v7 offset:480
    s_waitcnt lgkmcnt(4)
    v_mfma_f32_16x16x32_bf16 v[32:35], v[172:175], a[60:63], v[32:35]
    s_waitcnt vmcnt(18)
    v_mfma_f32_16x16x32_bf16 v[20:23], v[168:171], a[124:127], v[20:23]
    ds_read_b128 a[184:187], v7 offset:736
    v_mfma_f32_16x16x32_bf16 v[36:39], v[172:175], a[124:127], v[36:39]
    ds_write_b128 v5, v[196:199] offset:2048
    v_mfma_f32_16x16x32_bf16 v[24:27], v[168:171], a[188:191], v[24:27]
    ds_read_b128 a[248:251], v7 offset:992
    v_mfma_f32_16x16x32_bf16 v[40:43], v[172:175], a[188:191], v[40:43]
    ds_read_b128 a[52:55], v7 offset:208
    v_mfma_f32_16x16x32_bf16 v[28:31], v[168:171], a[252:255], v[28:31]
    ds_read_b128 v[120:123], v6 offset:128
    v_mfma_f32_16x16x32_bf16 v[44:47], v[172:175], a[252:255], v[44:47]
    ds_read_b128 v[124:127], v6 offset:160
    s_waitcnt lgkmcnt(8)
    v_mfma_f32_16x16x32_bf16 v[16:19], v[112:115], a[56:59], v[16:19]
    ds_read_b128 a[116:119], v7 offset:464
    s_waitcnt lgkmcnt(8)
    v_mfma_f32_16x16x32_bf16 v[32:35], v[116:119], a[56:59], v[32:35]
    ds_write_b128 v5, v[194:197] offset:18688
    s_waitcnt lgkmcnt(8)
    v_mfma_f32_16x16x32_bf16 v[20:23], v[112:115], a[120:123], v[20:23]
    ds_read_b128 a[180:183], v7 offset:720
    v_mfma_f32_16x16x32_bf16 v[36:39], v[116:119], a[120:123], v[36:39]
    v_mov_b32 v208, v193
    v_mov_b32 v209, v194
    s_waitcnt lgkmcnt(8)
    v_mfma_f32_16x16x32_bf16 v[24:27], v[112:115], a[184:187], v[24:27]
    ds_read_b128 a[244:247], v7 offset:976
    v_mfma_f32_16x16x32_bf16 v[40:43], v[116:119], a[184:187], v[40:43]
    ds_read_b128 a[48:51], v7 offset:192
    s_waitcnt lgkmcnt(8)
    v_mfma_f32_16x16x32_bf16 v[28:31], v[112:115], a[248:251], v[28:31]
    ds_read_b128 v[128:131], v6 offset:192
    v_mfma_f32_16x16x32_bf16 v[44:47], v[116:119], a[248:251], v[44:47]
    ds_read_b128 v[132:135], v6 offset:224
    s_waitcnt lgkmcnt(8)
    v_mfma_f32_16x16x32_bf16 v[16:19], v[120:123], a[52:55], v[16:19]
    ds_read_b128 a[112:115], v7 offset:448
    s_waitcnt lgkmcnt(8)
    v_mfma_f32_16x16x32_bf16 v[32:35], v[124:127], a[52:55], v[32:35]
    v_mov_b32 v210, v195
    v_mov_b32 v211, v196
    s_waitcnt lgkmcnt(7)
    v_mfma_f32_16x16x32_bf16 v[20:23], v[120:123], a[116:119], v[20:23]
    ds_read_b128 a[176:179], v7 offset:704
    v_mfma_f32_16x16x32_bf16 v[36:39], v[124:127], a[116:119], v[36:39]
    ds_write_b128 v5, v[208:211] offset:27008
    s_waitcnt lgkmcnt(7)
    v_mfma_f32_16x16x32_bf16 v[24:27], v[120:123], a[180:183], v[24:27]
    ds_read_b128 a[240:243], v7 offset:960
    v_mfma_f32_16x16x32_bf16 v[40:43], v[124:127], a[180:183], v[40:43]
    ds_read_b128 a[44:47], v7 offset:176
    s_waitcnt lgkmcnt(8)
    v_mfma_f32_16x16x32_bf16 v[28:31], v[120:123], a[244:247], v[28:31]
    ds_read_b128 v[136:139], v6 offset:256
    v_mfma_f32_16x16x32_bf16 v[44:47], v[124:127], a[244:247], v[44:47]
    ds_read_b128 v[140:143], v6 offset:288
    s_waitcnt lgkmcnt(8)
    v_mfma_f32_16x16x32_bf16 v[16:19], v[128:131], a[48:51], v[16:19]
    ds_read_b128 a[108:111], v7 offset:432
    s_waitcnt lgkmcnt(8)
    v_mfma_f32_16x16x32_bf16 v[32:35], v[132:135], a[48:51], v[32:35]
    v_mov_b32 v212, v197
    v_mov_b32 v213, v198
    s_waitcnt lgkmcnt(7)
    v_mfma_f32_16x16x32_bf16 v[20:23], v[128:131], a[112:115], v[20:23]
    ds_read_b128 a[172:175], v7 offset:688
    v_mfma_f32_16x16x32_bf16 v[36:39], v[132:135], a[112:115], v[36:39]
    ds_write_b128 v5, v[210:213] offset:10368
    s_waitcnt lgkmcnt(8)
    v_mfma_f32_16x16x32_bf16 v[24:27], v[128:131], a[176:179], v[24:27]
    ds_read_b128 a[236:239], v7 offset:944
    v_mfma_f32_16x16x32_bf16 v[40:43], v[132:135], a[176:179], v[40:43]
    ds_read_b128 a[40:43], v7 offset:160
    s_waitcnt lgkmcnt(8)
    v_mfma_f32_16x16x32_bf16 v[28:31], v[128:131], a[240:243], v[28:31]
    ds_read_b128 v[144:147], v6 offset:320
    v_mfma_f32_16x16x32_bf16 v[44:47], v[132:135], a[240:243], v[44:47]
    ds_read_b128 v[148:151], v6 offset:352
    s_waitcnt lgkmcnt(8)
    v_mfma_f32_16x16x32_bf16 v[16:19], v[136:139], a[44:47], v[16:19]
    ds_read_b128 a[104:107], v7 offset:416
    s_waitcnt lgkmcnt(8)
    v_mfma_f32_16x16x32_bf16 v[32:35], v[140:143], a[44:47], v[32:35]
    v_alignbit_b32 v214, v193, v192, 16
    v_alignbit_b32 v215, v194, v193, 16
    s_waitcnt lgkmcnt(7)
    v_mfma_f32_16x16x32_bf16 v[20:23], v[136:139], a[108:111], v[20:23]
    ds_read_b128 a[168:171], v7 offset:672
    v_mfma_f32_16x16x32_bf16 v[36:39], v[140:143], a[108:111], v[36:39]
    v_alignbit_b32 v216, v195, v194, 16
    v_alignbit_b32 v217, v196, v195, 16
    s_waitcnt lgkmcnt(7)
    v_mfma_f32_16x16x32_bf16 v[24:27], v[136:139], a[172:175], v[24:27]
    ds_read_b128 a[232:235], v7 offset:928
    v_mfma_f32_16x16x32_bf16 v[40:43], v[140:143], a[172:175], v[40:43]
    ds_read_b128 a[36:39], v7 offset:144
    s_waitcnt lgkmcnt(7)
    v_mfma_f32_16x16x32_bf16 v[28:31], v[136:139], a[236:239], v[28:31]
    ds_read_b128 v[152:155], v6 offset:384
    v_mfma_f32_16x16x32_bf16 v[44:47], v[140:143], a[236:239], v[44:47]
    ds_read_b128 v[156:159], v6 offset:416
    s_waitcnt lgkmcnt(7)
    v_mfma_f32_16x16x32_bf16 v[16:19], v[144:147], a[40:43], v[16:19]
    ds_read_b128 a[100:103], v7 offset:400
    s_waitcnt lgkmcnt(7)
    v_mfma_f32_16x16x32_bf16 v[32:35], v[148:151], a[40:43], v[32:35]
    ds_write_b128 v5, v[214:217] offset:31168
    s_waitcnt lgkmcnt(7)
    v_mfma_f32_16x16x32_bf16 v[20:23], v[144:147], a[104:107], v[20:23]
    ds_read_b128 a[164:167], v7 offset:656
    v_mfma_f32_16x16x32_bf16 v[36:39], v[148:151], a[104:107], v[36:39]
    v_alignbit_b32 v218, v197, v196, 16
    v_alignbit_b32 v219, v198, v197, 16
    s_waitcnt lgkmcnt(7)
    v_mfma_f32_16x16x32_bf16 v[24:27], v[144:147], a[168:171], v[24:27]
    ds_read_b128 a[228:231], v7 offset:912
    v_mfma_f32_16x16x32_bf16 v[40:43], v[148:151], a[168:171], v[40:43]
    ds_read_b128 a[32:35], v7 offset:128
    s_waitcnt lgkmcnt(8)
    v_mfma_f32_16x16x32_bf16 v[28:31], v[144:147], a[232:235], v[28:31]
    ds_read_b128 v[160:163], v6 offset:448
    v_mfma_f32_16x16x32_bf16 v[44:47], v[148:151], a[232:235], v[44:47]
    ds_read_b128 v[164:167], v6 offset:480
    s_waitcnt lgkmcnt(8)
    v_mfma_f32_16x16x32_bf16 v[16:19], v[152:155], a[36:39], v[16:19]
    ds_read_b128 a[96:99], v7 offset:384
    s_waitcnt lgkmcnt(8)
    v_mfma_f32_16x16x32_bf16 v[32:35], v[156:159], a[36:39], v[32:35]
    ds_write_b128 v5, v[216:219] offset:14528
    s_waitcnt lgkmcnt(8)
    v_mfma_f32_16x16x32_bf16 v[20:23], v[152:155], a[100:103], v[20:23]
    ds_read_b128 a[160:163], v7 offset:640
    v_mfma_f32_16x16x32_bf16 v[36:39], v[156:159], a[100:103], v[36:39]
    v_alignbit_b32 v220, v194, v193, 16
    v_alignbit_b32 v221, v195, v194, 16
    s_waitcnt lgkmcnt(7)
    v_mfma_f32_16x16x32_bf16 v[24:27], v[152:155], a[164:167], v[24:27]
    ds_read_b128 a[224:227], v7 offset:896
    v_mfma_f32_16x16x32_bf16 v[40:43], v[156:159], a[164:167], v[40:43]
    ds_read_b128 a[28:31], v7 offset:112
    s_waitcnt lgkmcnt(8)
    v_mfma_f32_16x16x32_bf16 v[28:31], v[152:155], a[228:231], v[28:31]
    ds_read_b128 v[168:171], v6 offset:512
    v_mfma_f32_16x16x32_bf16 v[44:47], v[156:159], a[228:231], v[44:47]
    ds_read_b128 v[172:175], v6 offset:544
    s_waitcnt lgkmcnt(8)
    v_mfma_f32_16x16x32_bf16 v[16:19], v[160:163], a[32:35], v[16:19]
    ds_read_b128 a[92:95], v7 offset:368
    s_waitcnt lgkmcnt(8)
    v_mfma_f32_16x16x32_bf16 v[32:35], v[164:167], a[32:35], v[32:35]
    v_alignbit_b32 v222, v196, v195, 16
    v_alignbit_b32 v223, v197, v196, 16
    s_waitcnt lgkmcnt(7)
    v_mfma_f32_16x16x32_bf16 v[20:23], v[160:163], a[96:99], v[20:23]
    ds_read_b128 a[156:159], v7 offset:624
    v_mfma_f32_16x16x32_bf16 v[36:39], v[164:167], a[96:99], v[36:39]
    ds_write_b128 v5, v[220:223] offset:22848
    s_waitcnt lgkmcnt(7)
    v_mfma_f32_16x16x32_bf16 v[24:27], v[160:163], a[160:163], v[24:27]
    ds_read_b128 a[220:223], v7 offset:880
    v_mfma_f32_16x16x32_bf16 v[40:43], v[164:167], a[160:163], v[40:43]
    ds_read_b128 a[24:27], v7 offset:96
    s_waitcnt lgkmcnt(8)
    v_mfma_f32_16x16x32_bf16 v[28:31], v[160:163], a[224:227], v[28:31]
    ds_read_b128 v[112:115], v6 offset:576
    v_mfma_f32_16x16x32_bf16 v[44:47], v[164:167], a[224:227], v[44:47]
    ds_read_b128 v[116:119], v6 offset:608
    s_waitcnt lgkmcnt(8)
    v_mfma_f32_16x16x32_bf16 v[16:19], v[168:171], a[28:31], v[16:19]
    ds_read_b128 a[88:91], v7 offset:352
    s_waitcnt lgkmcnt(8)
    v_mfma_f32_16x16x32_bf16 v[32:35], v[172:175], a[28:31], v[32:35]
    v_alignbit_b32 v224, v198, v197, 16
    v_alignbit_b32 v225, v199, v198, 16
    s_waitcnt lgkmcnt(7)
    v_mfma_f32_16x16x32_bf16 v[20:23], v[168:171], a[92:95], v[20:23]
    ds_read_b128 a[152:155], v7 offset:608
    v_mfma_f32_16x16x32_bf16 v[36:39], v[172:175], a[92:95], v[36:39]
    ds_write_b128 v5, v[222:225] offset:6208
    s_waitcnt lgkmcnt(8)
    v_mfma_f32_16x16x32_bf16 v[24:27], v[168:171], a[156:159], v[24:27]
    ds_read_b128 a[216:219], v7 offset:864
    v_mfma_f32_16x16x32_bf16 v[40:43], v[172:175], a[156:159], v[40:43]
    ds_read_b128 a[20:23], v7 offset:80
    s_waitcnt lgkmcnt(8)
    v_mfma_f32_16x16x32_bf16 v[28:31], v[168:171], a[220:223], v[28:31]
    ds_read_b128 v[120:123], v6 offset:640
    v_mfma_f32_16x16x32_bf16 v[44:47], v[172:175], a[220:223], v[44:47]
    ds_read_b128 v[124:127], v6 offset:672
    s_waitcnt lgkmcnt(8)
    v_mfma_f32_16x16x32_bf16 v[16:19], v[112:115], a[24:27], v[16:19]
    ds_read_b128 a[84:87], v7 offset:336
    s_waitcnt lgkmcnt(8)
    v_mfma_f32_16x16x32_bf16 v[32:35], v[116:119], a[24:27], v[32:35]
    buffer_load_dwordx4 v[192:195], v4, s[28:31], s36 offen offset:2032
    s_waitcnt lgkmcnt(7)
    v_mfma_f32_16x16x32_bf16 v[20:23], v[112:115], a[88:91], v[20:23]
    ds_read_b128 a[148:151], v7 offset:592
    v_mfma_f32_16x16x32_bf16 v[36:39], v[116:119], a[88:91], v[36:39]
    buffer_load_dwordx4 v[196:199], v4, s[28:31], s36 offen offset:2048
    s_waitcnt lgkmcnt(7)
    v_mfma_f32_16x16x32_bf16 v[24:27], v[112:115], a[152:155], v[24:27]
    ds_read_b128 a[212:215], v7 offset:848
    v_mfma_f32_16x16x32_bf16 v[40:43], v[116:119], a[152:155], v[40:43]
    ds_read_b128 a[16:19], v7 offset:64
    s_waitcnt lgkmcnt(7)
    v_mfma_f32_16x16x32_bf16 v[28:31], v[112:115], a[216:219], v[28:31]
    ds_read_b128 v[128:131], v6 offset:704
    v_mfma_f32_16x16x32_bf16 v[44:47], v[116:119], a[216:219], v[44:47]
    ds_read_b128 v[132:135], v6 offset:736
    s_waitcnt lgkmcnt(7)
    v_mfma_f32_16x16x32_bf16 v[16:19], v[120:123], a[20:23], v[16:19]
    ds_read_b128 a[80:83], v7 offset:320
    s_waitcnt lgkmcnt(7)
    v_mfma_f32_16x16x32_bf16 v[32:35], v[124:127], a[20:23], v[32:35]
    s_waitcnt vmcnt(18)
    s_waitcnt lgkmcnt(6)
    v_mfma_f32_16x16x32_bf16 v[20:23], v[120:123], a[84:87], v[20:23]
    ds_read_b128 a[144:147], v7 offset:576
    v_mfma_f32_16x16x32_bf16 v[36:39], v[124:127], a[84:87], v[36:39]
    ds_write_b128 v5, v[204:207] offset:3072
    s_waitcnt lgkmcnt(7)
    v_mfma_f32_16x16x32_bf16 v[24:27], v[120:123], a[148:151], v[24:27]
    ds_read_b128 a[208:211], v7 offset:832
    v_mfma_f32_16x16x32_bf16 v[40:43], v[124:127], a[148:151], v[40:43]
    ds_read_b128 a[12:15], v7 offset:48
    s_waitcnt lgkmcnt(8)
    v_mfma_f32_16x16x32_bf16 v[28:31], v[120:123], a[212:215], v[28:31]
    ds_read_b128 v[136:139], v6 offset:768
    v_mfma_f32_16x16x32_bf16 v[44:47], v[124:127], a[212:215], v[44:47]
    ds_read_b128 v[140:143], v6 offset:800
    s_waitcnt lgkmcnt(8)
    v_mfma_f32_16x16x32_bf16 v[16:19], v[128:131], a[16:19], v[16:19]
    ds_read_b128 a[76:79], v7 offset:304
    s_waitcnt lgkmcnt(8)
    v_mfma_f32_16x16x32_bf16 v[32:35], v[132:135], a[16:19], v[32:35]
    ds_write_b128 v5, v[202:205] offset:19712
    s_waitcnt lgkmcnt(8)
    v_mfma_f32_16x16x32_bf16 v[20:23], v[128:131], a[80:83], v[20:23]
    ds_read_b128 a[140:143], v7 offset:560
    v_mfma_f32_16x16x32_bf16 v[36:39], v[132:135], a[80:83], v[36:39]
    v_mov_b32 v208, v201
    v_mov_b32 v209, v202
    s_waitcnt lgkmcnt(8)
    v_mfma_f32_16x16x32_bf16 v[24:27], v[128:131], a[144:147], v[24:27]
    ds_read_b128 a[204:207], v7 offset:816
    v_mfma_f32_16x16x32_bf16 v[40:43], v[132:135], a[144:147], v[40:43]
    ds_read_b128 a[8:11], v7 offset:32
    s_waitcnt lgkmcnt(8)
    v_mfma_f32_16x16x32_bf16 v[28:31], v[128:131], a[208:211], v[28:31]
    ds_read_b128 v[144:147], v6 offset:832
    v_mfma_f32_16x16x32_bf16 v[44:47], v[132:135], a[208:211], v[44:47]
    ds_read_b128 v[148:151], v6 offset:864
    s_waitcnt lgkmcnt(8)
    v_mfma_f32_16x16x32_bf16 v[16:19], v[136:139], a[12:15], v[16:19]
    ds_read_b128 a[72:75], v7 offset:288
    s_waitcnt lgkmcnt(8)
    v_mfma_f32_16x16x32_bf16 v[32:35], v[140:143], a[12:15], v[32:35]
    v_mov_b32 v210, v203
    v_mov_b32 v211, v204
    s_waitcnt lgkmcnt(7)
    v_mfma_f32_16x16x32_bf16 v[20:23], v[136:139], a[76:79], v[20:23]
    ds_read_b128 a[136:139], v7 offset:544
    v_mfma_f32_16x16x32_bf16 v[36:39], v[140:143], a[76:79], v[36:39]
    ds_write_b128 v5, v[208:211] offset:28032
    s_waitcnt lgkmcnt(7)
    v_mfma_f32_16x16x32_bf16 v[24:27], v[136:139], a[140:143], v[24:27]
    ds_read_b128 a[200:203], v7 offset:800
    v_mfma_f32_16x16x32_bf16 v[40:43], v[140:143], a[140:143], v[40:43]
    ds_read_b128 a[4:7], v7 offset:16
    s_waitcnt lgkmcnt(8)
    v_mfma_f32_16x16x32_bf16 v[28:31], v[136:139], a[204:207], v[28:31]
    ds_read_b128 v[152:155], v6 offset:896
    v_mfma_f32_16x16x32_bf16 v[44:47], v[140:143], a[204:207], v[44:47]
    ds_read_b128 v[156:159], v6 offset:928
    s_waitcnt lgkmcnt(8)
    v_mfma_f32_16x16x32_bf16 v[16:19], v[144:147], a[8:11], v[16:19]
    ds_read_b128 a[68:71], v7 offset:272
    s_waitcnt lgkmcnt(8)
    v_mfma_f32_16x16x32_bf16 v[32:35], v[148:151], a[8:11], v[32:35]
    v_mov_b32 v212, v205
    v_mov_b32 v213, v206
    s_waitcnt lgkmcnt(7)
    v_mfma_f32_16x16x32_bf16 v[20:23], v[144:147], a[72:75], v[20:23]
    ds_read_b128 a[132:135], v7 offset:528
    v_mfma_f32_16x16x32_bf16 v[36:39], v[148:151], a[72:75], v[36:39]
    ds_write_b128 v5, v[210:213] offset:11392
    s_waitcnt lgkmcnt(8)
    v_mfma_f32_16x16x32_bf16 v[24:27], v[144:147], a[136:139], v[24:27]
    ds_read_b128 a[196:199], v7 offset:784
    v_mfma_f32_16x16x32_bf16 v[40:43], v[148:151], a[136:139], v[40:43]
    ds_read_b128 a[0:3], v7 offset:0
    s_waitcnt lgkmcnt(8)
    v_mfma_f32_16x16x32_bf16 v[28:31], v[144:147], a[200:203], v[28:31]
    ds_read_b128 v[160:163], v6 offset:960
    v_mfma_f32_16x16x32_bf16 v[44:47], v[148:151], a[200:203], v[44:47]
    ds_read_b128 v[164:167], v6 offset:992
    s_waitcnt lgkmcnt(8)
    v_mfma_f32_16x16x32_bf16 v[16:19], v[152:155], a[4:7], v[16:19]
    ds_read_b128 a[64:67], v7 offset:256
    s_waitcnt lgkmcnt(8)
    v_mfma_f32_16x16x32_bf16 v[32:35], v[156:159], a[4:7], v[32:35]
    v_alignbit_b32 v214, v201, v200, 16
    v_alignbit_b32 v215, v202, v201, 16
    s_waitcnt lgkmcnt(7)
    v_mfma_f32_16x16x32_bf16 v[20:23], v[152:155], a[68:71], v[20:23]
    ds_read_b128 a[128:131], v7 offset:512
    v_mfma_f32_16x16x32_bf16 v[36:39], v[156:159], a[68:71], v[36:39]
    v_alignbit_b32 v216, v203, v202, 16
    v_alignbit_b32 v217, v204, v203, 16
    s_waitcnt lgkmcnt(7)
    v_mfma_f32_16x16x32_bf16 v[24:27], v[152:155], a[132:135], v[24:27]
    ds_read_b128 a[192:195], v7 offset:768
    v_mfma_f32_16x16x32_bf16 v[40:43], v[156:159], a[132:135], v[40:43]
    ds_write_b128 v5, v[214:217] offset:32192
    s_waitcnt lgkmcnt(7)
    v_mfma_f32_16x16x32_bf16 v[28:31], v[152:155], a[196:199], v[28:31]
    ds_read_b128 v[168:171], v6 offset:1024
    v_mfma_f32_16x16x32_bf16 v[44:47], v[156:159], a[196:199], v[44:47]
    ds_read_b128 v[172:175], v6 offset:1056
    s_waitcnt lgkmcnt(7)
    v_mfma_f32_16x16x32_bf16 v[16:19], v[160:163], a[0:3], v[16:19]
    v_alignbit_b32 v218, v205, v204, 16
    v_alignbit_b32 v219, v206, v205, 16
    s_waitcnt lgkmcnt(6)
    v_mfma_f32_16x16x32_bf16 v[32:35], v[164:167], a[0:3], v[32:35]
    ds_write_b128 v5, v[216:219] offset:15552
    s_waitcnt lgkmcnt(6)
    v_mfma_f32_16x16x32_bf16 v[20:23], v[160:163], a[64:67], v[20:23]
    v_alignbit_b32 v220, v202, v201, 16
    v_alignbit_b32 v221, v203, v202, 16
    v_mfma_f32_16x16x32_bf16 v[36:39], v[164:167], a[64:67], v[36:39]
    v_alignbit_b32 v222, v204, v203, 16
    v_alignbit_b32 v223, v205, v204, 16
    s_waitcnt lgkmcnt(5)
    v_mfma_f32_16x16x32_bf16 v[24:27], v[160:163], a[128:131], v[24:27]
    ds_read_b128 v[112:115], v6 offset:1088
    v_mfma_f32_16x16x32_bf16 v[40:43], v[164:167], a[128:131], v[40:43]
    ds_read_b128 v[116:119], v6 offset:1120
    s_waitcnt lgkmcnt(6)
    v_mfma_f32_16x16x32_bf16 v[28:31], v[160:163], a[192:195], v[28:31]
    ds_write_b128 v5, v[220:223] offset:23872
    v_mfma_f32_16x16x32_bf16 v[44:47], v[164:167], a[192:195], v[44:47]
    v_alignbit_b32 v224, v206, v205, 16
    v_alignbit_b32 v225, v207, v206, 16
    s_waitcnt lgkmcnt(5)
    v_mfma_f32_16x16x32_bf16 v[20:23], v[168:171], a[60:63], v[20:23]
    ds_write_b128 v5, v[222:225] offset:7232
    s_waitcnt lgkmcnt(5)
    v_mfma_f32_16x16x32_bf16 v[36:39], v[172:175], a[60:63], v[36:39]
    buffer_load_dwordx4 v[200:203], v4, s[28:31], s36 offen offset:3056
    v_mfma_f32_16x16x32_bf16 v[24:27], v[168:171], a[124:127], v[24:27]
    ds_read_b128 v[120:123], v6 offset:1152
    v_mfma_f32_16x16x32_bf16 v[40:43], v[172:175], a[124:127], v[40:43]
    ds_read_b128 v[124:127], v6 offset:1184
    v_mfma_f32_16x16x32_bf16 v[28:31], v[168:171], a[188:191], v[28:31]
    buffer_load_dwordx4 v[204:207], v4, s[28:31], s36 offen offset:3072
    v_mfma_f32_16x16x32_bf16 v[44:47], v[172:175], a[188:191], v[44:47]
    s_waitcnt vmcnt(18)
    s_mov_b64 exec, 1
    v_mov_b32 v176, 0
    v_mov_b32 v177, 0
    v_mov_b32 v178, 0
    v_mov_b32 v179, 0
    s_mov_b64 exec, -1
    s_waitcnt lgkmcnt(5)
    v_mfma_f32_16x16x32_bf16 v[20:23], v[112:115], a[56:59], v[20:23]
    ds_write_b128 v5, v[180:183] offset:0
    s_waitcnt lgkmcnt(5)
    v_mfma_f32_16x16x32_bf16 v[36:39], v[116:119], a[56:59], v[36:39]
    ds_write_b128 v5, v[178:181] offset:16640
    v_mfma_f32_16x16x32_bf16 v[24:27], v[112:115], a[120:123], v[24:27]
    ds_read_b128 v[128:131], v6 offset:1216
    v_mfma_f32_16x16x32_bf16 v[40:43], v[116:119], a[120:123], v[40:43]
    ds_read_b128 v[132:135], v6 offset:1248
    v_mfma_f32_16x16x32_bf16 v[28:31], v[112:115], a[184:187], v[28:31]
    v_mov_b32 v208, v177
    v_mov_b32 v209, v178
    v_mfma_f32_16x16x32_bf16 v[44:47], v[116:119], a[184:187], v[44:47]
    v_mov_b32 v210, v179
    v_mov_b32 v211, v180
    s_waitcnt lgkmcnt(5)
    v_mfma_f32_16x16x32_bf16 v[20:23], v[120:123], a[52:55], v[20:23]
    ds_write_b128 v5, v[208:211] offset:24960
    s_waitcnt lgkmcnt(5)
    v_mfma_f32_16x16x32_bf16 v[36:39], v[124:127], a[52:55], v[36:39]
    v_mov_b32 v212, v181
    v_mov_b32 v213, v182
    v_mfma_f32_16x16x32_bf16 v[24:27], v[120:123], a[116:119], v[24:27]
    ds_read_b128 v[136:139], v6 offset:1280
    v_mfma_f32_16x16x32_bf16 v[40:43], v[124:127], a[116:119], v[40:43]
    ds_read_b128 v[140:143], v6 offset:1312
    v_mfma_f32_16x16x32_bf16 v[28:31], v[120:123], a[180:183], v[28:31]
    ds_write_b128 v5, v[210:213] offset:8320
    v_mfma_f32_16x16x32_bf16 v[44:47], v[124:127], a[180:183], v[44:47]
    v_alignbit_b32 v214, v177, v176, 16
    v_alignbit_b32 v215, v178, v177, 16
    s_waitcnt lgkmcnt(5)
    v_mfma_f32_16x16x32_bf16 v[20:23], v[128:131], a[48:51], v[20:23]
    v_alignbit_b32 v216, v179, v178, 16
    v_alignbit_b32 v217, v180, v179, 16
    s_waitcnt lgkmcnt(4)
    v_mfma_f32_16x16x32_bf16 v[36:39], v[132:135], a[48:51], v[36:39]
    ds_write_b128 v5, v[214:217] offset:29120
    v_mfma_f32_16x16x32_bf16 v[24:27], v[128:131], a[112:115], v[24:27]
    ds_read_b128 v[144:147], v6 offset:1344
    v_mfma_f32_16x16x32_bf16 v[40:43], v[132:135], a[112:115], v[40:43]
    ds_read_b128 v[148:151], v6 offset:1376
    v_mfma_f32_16x16x32_bf16 v[28:31], v[128:131], a[176:179], v[28:31]
    v_alignbit_b32 v218, v181, v180, 16
    v_alignbit_b32 v219, v182, v181, 16
    v_mfma_f32_16x16x32_bf16 v[44:47], v[132:135], a[176:179], v[44:47]
    ds_write_b128 v5, v[216:219] offset:12480
    s_waitcnt lgkmcnt(6)
    v_mfma_f32_16x16x32_bf16 v[20:23], v[136:139], a[44:47], v[20:23]
    v_alignbit_b32 v220, v178, v177, 16
    v_alignbit_b32 v221, v179, v178, 16
    s_waitcnt lgkmcnt(5)
    v_mfma_f32_16x16x32_bf16 v[36:39], v[140:143], a[44:47], v[36:39]
    v_alignbit_b32 v222, v180, v179, 16
    v_alignbit_b32 v223, v181, v180, 16
    v_mfma_f32_16x16x32_bf16 v[24:27], v[136:139], a[108:111], v[24:27]
    ds_read_b128 v[152:155], v6 offset:1408
    v_mfma_f32_16x16x32_bf16 v[40:43], v[140:143], a[108:111], v[40:43]
    ds_read_b128 v[156:159], v6 offset:1440
    v_mfma_f32_16x16x32_bf16 v[28:31], v[136:139], a[172:175], v[28:31]
    ds_write_b128 v5, v[220:223] offset:20800
    v_mfma_f32_16x16x32_bf16 v[44:47], v[140:143], a[172:175], v[44:47]
    v_alignbit_b32 v224, v182, v181, 16
    v_alignbit_b32 v225, v183, v182, 16
    s_waitcnt lgkmcnt(5)
    v_mfma_f32_16x16x32_bf16 v[20:23], v[144:147], a[40:43], v[20:23]
    ds_write_b128 v5, v[222:225] offset:4160
    s_waitcnt lgkmcnt(5)
    v_mfma_f32_16x16x32_bf16 v[36:39], v[148:151], a[40:43], v[36:39]
    buffer_load_dwordx4 v[176:179], v230, s[28:31], s37 offen offset:0
    v_mfma_f32_16x16x32_bf16 v[24:27], v[144:147], a[104:107], v[24:27]
    ds_read_b128 v[160:163], v6 offset:1472
    v_mfma_f32_16x16x32_bf16 v[40:43], v[148:151], a[104:107], v[40:43]
    ds_read_b128 v[164:167], v6 offset:1504
    v_mfma_f32_16x16x32_bf16 v[28:31], v[144:147], a[168:171], v[28:31]
    buffer_load_dwordx4 v[180:183], v4, s[28:31], s37 offen offset:0
    v_mfma_f32_16x16x32_bf16 v[44:47], v[148:151], a[168:171], v[44:47]
    s_add_u32 m0, s35, 0
    s_waitcnt lgkmcnt(5)
    v_mfma_f32_16x16x32_bf16 v[20:23], v[152:155], a[36:39], v[20:23]
    buffer_load_dwordx4 v4, s[8:11], s39 offen offset:0 lds
    s_waitcnt lgkmcnt(4)
    v_mfma_f32_16x16x32_bf16 v[36:39], v[156:159], a[36:39], v[36:39]
    s_add_u32 m0, s35, 256
    v_mfma_f32_16x16x32_bf16 v[24:27], v[152:155], a[100:103], v[24:27]
    ds_read_b128 v[168:171], v6 offset:1536
    v_mfma_f32_16x16x32_bf16 v[40:43], v[156:159], a[100:103], v[40:43]
    ds_read_b128 v[172:175], v6 offset:1568
    v_mfma_f32_16x16x32_bf16 v[28:31], v[152:155], a[164:167], v[28:31]
    buffer_load_dwordx4 v4, s[8:11], s39 offen offset:1024 lds
    v_mfma_f32_16x16x32_bf16 v[44:47], v[156:159], a[164:167], v[44:47]
    s_add_u32 m0, s35, 512
    s_waitcnt lgkmcnt(3)
    v_mfma_f32_16x16x32_bf16 v[20:23], v[160:163], a[32:35], v[20:23]
    buffer_load_dwordx4 v4, s[8:11], s39 offen offset:2048 lds
    s_waitcnt lgkmcnt(2)
    v_mfma_f32_16x16x32_bf16 v[36:39], v[164:167], a[32:35], v[36:39]
    s_add_u32 m0, s35, 768
    v_mfma_f32_16x16x32_bf16 v[24:27], v[160:163], a[96:99], v[24:27]
    ds_read_b128 v[112:115], v6 offset:1600
    v_mfma_f32_16x16x32_bf16 v[40:43], v[164:167], a[96:99], v[40:43]
    ds_read_b128 v[116:119], v6 offset:1632
    v_mfma_f32_16x16x32_bf16 v[28:31], v[160:163], a[160:163], v[28:31]
    buffer_load_dwordx4 v4, s[8:11], s39 offen offset:3072 lds
    v_mfma_f32_16x16x32_bf16 v[44:47], v[164:167], a[160:163], v[44:47]
    s_waitcnt lgkmcnt(3)
    v_mfma_f32_16x16x32_bf16 v[20:23], v[168:171], a[28:31], v[20:23]
    s_waitcnt lgkmcnt(2)
    v_mfma_f32_16x16x32_bf16 v[36:39], v[172:175], a[28:31], v[36:39]
    v_mfma_f32_16x16x32_bf16 v[24:27], v[168:171], a[92:95], v[24:27]
    ds_read_b128 v[120:123], v6 offset:1664
    v_mfma_f32_16x16x32_bf16 v[40:43], v[172:175], a[92:95], v[40:43]
    ds_read_b128 v[124:127], v6 offset:1696
    v_mfma_f32_16x16x32_bf16 v[28:31], v[168:171], a[156:159], v[28:31]
    v_mfma_f32_16x16x32_bf16 v[44:47], v[172:175], a[156:159], v[44:47]
    s_waitcnt lgkmcnt(3)
    v_mfma_f32_16x16x32_bf16 v[20:23], v[112:115], a[24:27], v[20:23]
    s_waitcnt lgkmcnt(2)
    v_mfma_f32_16x16x32_bf16 v[36:39], v[116:119], a[24:27], v[36:39]
    v_mfma_f32_16x16x32_bf16 v[24:27], v[112:115], a[88:91], v[24:27]
    ds_read_b128 v[128:131], v6 offset:1728
    v_mfma_f32_16x16x32_bf16 v[40:43], v[116:119], a[88:91], v[40:43]
    ds_read_b128 v[132:135], v6 offset:1760
    v_mfma_f32_16x16x32_bf16 v[28:31], v[112:115], a[152:155], v[28:31]
    v_mfma_f32_16x16x32_bf16 v[44:47], v[116:119], a[152:155], v[44:47]
    s_waitcnt lgkmcnt(3)
    v_mfma_f32_16x16x32_bf16 v[20:23], v[120:123], a[20:23], v[20:23]
    s_waitcnt lgkmcnt(2)
    v_mfma_f32_16x16x32_bf16 v[36:39], v[124:127], a[20:23], v[36:39]
    v_mfma_f32_16x16x32_bf16 v[24:27], v[120:123], a[84:87], v[24:27]
    ds_read_b128 v[136:139], v6 offset:1792
    v_mfma_f32_16x16x32_bf16 v[40:43], v[124:127], a[84:87], v[40:43]
    ds_read_b128 v[140:143], v6 offset:1824
    v_mfma_f32_16x16x32_bf16 v[28:31], v[120:123], a[148:151], v[28:31]
    v_mfma_f32_16x16x32_bf16 v[44:47], v[124:127], a[148:151], v[44:47]
    s_waitcnt lgkmcnt(3)
    v_mfma_f32_16x16x32_bf16 v[20:23], v[128:131], a[16:19], v[20:23]
    s_waitcnt lgkmcnt(2)
    v_mfma_f32_16x16x32_bf16 v[36:39], v[132:135], a[16:19], v[36:39]
    v_mfma_f32_16x16x32_bf16 v[24:27], v[128:131], a[80:83], v[24:27]
    ds_read_b128 v[144:147], v6 offset:1856
    v_mfma_f32_16x16x32_bf16 v[40:43], v[132:135], a[80:83], v[40:43]
    ds_read_b128 v[148:151], v6 offset:1888
    v_mfma_f32_16x16x32_bf16 v[28:31], v[128:131], a[144:147], v[28:31]
    v_mfma_f32_16x16x32_bf16 v[44:47], v[132:135], a[144:147], v[44:47]
    s_waitcnt lgkmcnt(3)
    v_mfma_f32_16x16x32_bf16 v[20:23], v[136:139], a[12:15], v[20:23]
    s_waitcnt lgkmcnt(2)
    v_mfma_f32_16x16x32_bf16 v[36:39], v[140:143], a[12:15], v[36:39]
    v_mfma_f32_16x16x32_bf16 v[24:27], v[136:139], a[76:79], v[24:27]
    ds_read_b128 v[152:155], v6 offset:1920
    v_mfma_f32_16x16x32_bf16 v[40:43], v[140:143], a[76:79], v[40:43]
    ds_read_b128 v[156:159], v6 offset:1952
    v_mfma_f32_16x16x32_bf16 v[28:31], v[136:139], a[140:143], v[28:31]
    v_mfma_f32_16x16x32_bf16 v[44:47], v[140:143], a[140:143], v[44:47]
    s_waitcnt lgkmcnt(3)
    v_mfma_f32_16x16x32_bf16 v[20:23], v[144:147], a[8:11], v[20:23]
    s_waitcnt lgkmcnt(2)
    v_mfma_f32_16x16x32_bf16 v[36:39], v[148:151], a[8:11], v[36:39]
    v_mfma_f32_16x16x32_bf16 v[24:27], v[144:147], a[72:75], v[24:27]
    ds_read_b128 v[160:163], v6 offset:1984
    v_mfma_f32_16x16x32_bf16 v[40:43], v[148:151], a[72:75], v[40:43]
    ds_read_b128 v[164:167], v6 offset:2016
    v_mfma_f32_16x16x32_bf16 v[28:31], v[144:147], a[136:139], v[28:31]
    v_mfma_f32_16x16x32_bf16 v[44:47], v[148:151], a[136:139], v[44:47]
    s_waitcnt lgkmcnt(3)
    v_mfma_f32_16x16x32_bf16 v[20:23], v[152:155], a[4:7], v[20:23]
    s_waitcnt lgkmcnt(2)
    v_mfma_f32_16x16x32_bf16 v[36:39], v[156:159], a[4:7], v[36:39]
    v_mfma_f32_16x16x32_bf16 v[24:27], v[152:155], a[68:71], v[24:27]
    ds_read_b128 v[168:171], v6 offset:2048
    v_mfma_f32_16x16x32_bf16 v[40:43], v[156:159], a[68:71], v[40:43]
    ds_read_b128 v[172:175], v6 offset:2080
    v_mfma_f32_16x16x32_bf16 v[28:31], v[152:155], a[132:135], v[28:31]
    s_waitcnt vmcnt(18)
    v_mfma_f32_16x16x32_bf16 v[44:47], v[156:159], a[132:135], v[44:47]
    ds_write_b128 v5, v[188:191] offset:1024
    s_waitcnt lgkmcnt(4)
    v_mfma_f32_16x16x32_bf16 v[20:23], v[160:163], a[0:3], v[20:23]
    ds_read_b128 v[112:115], v6 offset:2112
    s_waitcnt lgkmcnt(4)
    v_mfma_f32_16x16x32_bf16 v[36:39], v[164:167], a[0:3], v[36:39]
    ds_read_b128 v[116:119], v6 offset:2144
    v_mfma_f32_16x16x32_bf16 v[24:27], v[160:163], a[64:67], v[24:27]
    ds_write_b128 v5, v[186:189] offset:17664
    v_mfma_f32_16x16x32_bf16 v[40:43], v[164:167], a[64:67], v[40:43]
    v_mov_b32 v208, v185
    v_mov_b32 v209, v186
    v_mfma_f32_16x16x32_bf16 v[28:31], v[160:163], a[128:131], v[28:31]
    ds_read_b128 v[120:123], v6 offset:2176
    v_mfma_f32_16x16x32_bf16 v[44:47], v[164:167], a[128:131], v[44:47]
    ds_read_b128 v[124:127], v6 offset:2208
    s_waitcnt lgkmcnt(7)
    v_mfma_f32_16x16x32_bf16 v[24:27], v[168:171], a[60:63], v[24:27]
    v_mov_b32 v210, v187
    v_mov_b32 v211, v188
    s_waitcnt lgkmcnt(6)
    v_mfma_f32_16x16x32_bf16 v[40:43], v[172:175], a[60:63], v[40:43]
    ds_write_b128 v5, v[208:211] offset:25984
    v_mfma_f32_16x16x32_bf16 v[28:31], v[168:171], a[124:127], v[28:31]
    ds_read_b128 v[128:131], v6 offset:2240
    v_mfma_f32_16x16x32_bf16 v[44:47], v[172:175], a[124:127], v[44:47]
    ds_read_b128 v[132:135], v6 offset:2272
    s_waitcnt lgkmcnt(7)
    v_mfma_f32_16x16x32_bf16 v[24:27], v[112:115], a[56:59], v[24:27]
    v_mov_b32 v212, v189
    v_mov_b32 v213, v190
    s_waitcnt lgkmcnt(6)
    v_mfma_f32_16x16x32_bf16 v[40:43], v[116:119], a[56:59], v[40:43]
    ds_write_b128 v5, v[210:213] offset:9344
    v_mfma_f32_16x16x32_bf16 v[28:31], v[112:115], a[120:123], v[28:31]
    ds_read_b128 v[136:139], v6 offset:2304
    v_mfma_f32_16x16x32_bf16 v[44:47], v[116:119], a[120:123], v[44:47]
    ds_read_b128 v[140:143], v6 offset:2336
    s_waitcnt lgkmcnt(7)
    v_mfma_f32_16x16x32_bf16 v[24:27], v[120:123], a[52:55], v[24:27]
    v_alignbit_b32 v214, v185, v184, 16
    v_alignbit_b32 v215, v186, v185, 16
    s_waitcnt lgkmcnt(6)
    v_mfma_f32_16x16x32_bf16 v[40:43], v[124:127], a[52:55], v[40:43]
    v_alignbit_b32 v216, v187, v186, 16
    v_alignbit_b32 v217, v188, v187, 16
    v_mfma_f32_16x16x32_bf16 v[28:31], v[120:123], a[116:119], v[28:31]
    ds_read_b128 v[144:147], v6 offset:2368
    v_mfma_f32_16x16x32_bf16 v[44:47], v[124:127], a[116:119], v[44:47]
    ds_read_b128 v[148:151], v6 offset:2400
    s_waitcnt lgkmcnt(6)
    v_mfma_f32_16x16x32_bf16 v[24:27], v[128:131], a[48:51], v[24:27]
    ds_write_b128 v5, v[214:217] offset:30144
    s_waitcnt lgkmcnt(6)
    v_mfma_f32_16x16x32_bf16 v[40:43], v[132:135], a[48:51], v[40:43]
    v_alignbit_b32 v218, v189, v188, 16
    v_alignbit_b32 v219, v190, v189, 16
    v_mfma_f32_16x16x32_bf16 v[28:31], v[128:131], a[112:115], v[28:31]
    ds_read_b128 v[152:155], v6 offset:2432
    v_mfma_f32_16x16x32_bf16 v[44:47], v[132:135], a[112:115], v[44:47]
    ds_read_b128 v[156:159], v6 offset:2464
    s_waitcnt lgkmcnt(6)
    v_mfma_f32_16x16x32_bf16 v[24:27], v[136:139], a[44:47], v[24:27]
    ds_write_b128 v5, v[216:219] offset:13504
    s_waitcnt lgkmcnt(6)
    v_mfma_f32_16x16x32_bf16 v[40:43], v[140:143], a[44:47], v[40:43]
    v_alignbit_b32 v220, v186, v185, 16
    v_alignbit_b32 v221, v187, v186, 16
    v_mfma_f32_16x16x32_bf16 v[28:31], v[136:139], a[108:111], v[28:31]
    ds_read_b128 v[160:163], v6 offset:2496
    v_mfma_f32_16x16x32_bf16 v[44:47], v[140:143], a[108:111], v[44:47]
    ds_read_b128 v[164:167], v6 offset:2528
    s_waitcnt lgkmcnt(7)
    v_mfma_f32_16x16x32_bf16 v[24:27], v[144:147], a[40:43], v[24:27]
    v_alignbit_b32 v222, v188, v187, 16
    v_alignbit_b32 v223, v189, v188, 16
    s_waitcnt lgkmcnt(6)
    v_mfma_f32_16x16x32_bf16 v[40:43], v[148:151], a[40:43], v[40:43]
    ds_write_b128 v5, v[220:223] offset:21824
    v_mfma_f32_16x16x32_bf16 v[28:31], v[144:147], a[104:107], v[28:31]
    ds_read_b128 v[168:171], v6 offset:2560
    v_mfma_f32_16x16x32_bf16 v[44:47], v[148:151], a[104:107], v[44:47]
    ds_read_b128 v[172:175], v6 offset:2592
    s_waitcnt lgkmcnt(7)
    v_mfma_f32_16x16x32_bf16 v[24:27], v[152:155], a[36:39], v[24:27]
    v_alignbit_b32 v224, v190, v189, 16
    v_alignbit_b32 v225, v191, v190, 16
    s_waitcnt lgkmcnt(6)
    v_mfma_f32_16x16x32_bf16 v[40:43], v[156:159], a[36:39], v[40:43]
    ds_write_b128 v5, v[222:225] offset:5184
    v_mfma_f32_16x16x32_bf16 v[28:31], v[152:155], a[100:103], v[28:31]
    ds_read_b128 v[112:115], v6 offset:2624
    v_mfma_f32_16x16x32_bf16 v[44:47], v[156:159], a[100:103], v[44:47]
    ds_read_b128 v[116:119], v6 offset:2656
    s_waitcnt lgkmcnt(7)
    v_mfma_f32_16x16x32_bf16 v[24:27], v[160:163], a[32:35], v[24:27]
    buffer_load_dwordx4 v[184:187], v4, s[28:31], s37 offen offset:1008
    s_waitcnt lgkmcnt(6)
    v_mfma_f32_16x16x32_bf16 v[40:43], v[164:167], a[32:35], v[40:43]
    buffer_load_dwordx4 v[188:191], v4, s[28:31], s37 offen offset:1024
    v_mfma_f32_16x16x32_bf16 v[28:31], v[160:163], a[96:99], v[28:31]
    ds_read_b128 v[120:123], v6 offset:2688
    v_mfma_f32_16x16x32_bf16 v[44:47], v[164:167], a[96:99], v[44:47]
    ds_read_b128 v[124:127], v6 offset:2720
    s_waitcnt lgkmcnt(6)
    v_mfma_f32_16x16x32_bf16 v[24:27], v[168:171], a[28:31], v[24:27]
    s_mov_b32 s36, s37
    s_add_u32 s39, s37, 125829120
    s_add_u32 s37, s37, 4096
    s_min_u32 s37, s37, s33

    s_pack_hh_b32_b16 s40, s64, s64
    v_and_b32 v236, s40, v8
    s_waitcnt lgkmcnt(5)
    v_mfma_f32_16x16x32_bf16 v[40:43], v[172:175], a[28:31], v[40:43]
    v_and_b32 v237, s40, v9
    v_and_b32 v238, s40, v10
    v_mfma_f32_16x16x32_bf16 v[28:31], v[168:171], a[92:95], v[28:31]
    ds_read_b128 v[128:131], v6 offset:2752
    v_mfma_f32_16x16x32_bf16 v[44:47], v[172:175], a[92:95], v[44:47]
    ds_read_b128 v[132:135], v6 offset:2784
    s_waitcnt lgkmcnt(5)
    v_mfma_f32_16x16x32_bf16 v[24:27], v[112:115], a[24:27], v[24:27]
    v_and_b32 v239, s40, v11
    v_and_b32 v240, s40, v12
    s_waitcnt lgkmcnt(4)
    v_mfma_f32_16x16x32_bf16 v[40:43], v[116:119], a[24:27], v[40:43]
    v_and_b32 v241, s40, v13
    v_and_b32 v242, s40, v14
    v_mfma_f32_16x16x32_bf16 v[28:31], v[112:115], a[88:91], v[28:31]
    ds_read_b128 v[136:139], v6 offset:2816
    v_mfma_f32_16x16x32_bf16 v[44:47], v[116:119], a[88:91], v[44:47]
    ds_read_b128 v[140:143], v6 offset:2848
    s_waitcnt lgkmcnt(5)
    v_mfma_f32_16x16x32_bf16 v[24:27], v[120:123], a[20:23], v[24:27]
    v_and_b32 v243, s40, v15
    s_waitcnt lgkmcnt(4)
    v_mfma_f32_16x16x32_bf16 v[40:43], v[124:127], a[20:23], v[40:43]
    v_mfma_f32_16x16x32_bf16 v[28:31], v[120:123], a[84:87], v[28:31]
    ds_read_b128 v[144:147], v6 offset:2880
    v_mfma_f32_16x16x32_bf16 v[44:47], v[124:127], a[84:87], v[44:47]
    ds_read_b128 v[148:151], v6 offset:2912
    s_waitcnt lgkmcnt(5)
    v_mfma_f32_16x16x32_bf16 v[24:27], v[128:131], a[16:19], v[24:27]
    s_waitcnt lgkmcnt(4)
    v_mfma_f32_16x16x32_bf16 v[40:43], v[132:135], a[16:19], v[40:43]
    v_mfma_f32_16x16x32_bf16 v[28:31], v[128:131], a[80:83], v[28:31]
    ds_read_b128 v[152:155], v6 offset:2944
    v_mfma_f32_16x16x32_bf16 v[44:47], v[132:135], a[80:83], v[44:47]
    ds_read_b128 v[156:159], v6 offset:2976
    s_waitcnt lgkmcnt(5)
    v_mfma_f32_16x16x32_bf16 v[24:27], v[136:139], a[12:15], v[24:27]
    s_waitcnt lgkmcnt(4)
    v_mfma_f32_16x16x32_bf16 v[40:43], v[140:143], a[12:15], v[40:43]
    v_mfma_f32_16x16x32_bf16 v[28:31], v[136:139], a[76:79], v[28:31]
    ds_read_b128 v[160:163], v6 offset:3008
    v_mfma_f32_16x16x32_bf16 v[44:47], v[140:143], a[76:79], v[44:47]
    ds_read_b128 v[164:167], v6 offset:3040
    s_waitcnt lgkmcnt(5)
    v_mfma_f32_16x16x32_bf16 v[24:27], v[144:147], a[8:11], v[24:27]
    s_waitcnt lgkmcnt(4)
    v_mfma_f32_16x16x32_bf16 v[40:43], v[148:151], a[8:11], v[40:43]
    v_mfma_f32_16x16x32_bf16 v[28:31], v[144:147], a[72:75], v[28:31]
    ds_read_b128 v[168:171], v6 offset:3072
    v_mfma_f32_16x16x32_bf16 v[44:47], v[148:151], a[72:75], v[44:47]
    ds_read_b128 v[172:175], v6 offset:3104
    s_waitcnt lgkmcnt(5)
    v_mfma_f32_16x16x32_bf16 v[24:27], v[152:155], a[4:7], v[24:27]
    ds_read_b128 v[112:115], v6 offset:3136
    s_waitcnt lgkmcnt(5)
    v_mfma_f32_16x16x32_bf16 v[40:43], v[156:159], a[4:7], v[40:43]
    ds_read_b128 v[116:119], v6 offset:3168
    v_mfma_f32_16x16x32_bf16 v[28:31], v[152:155], a[68:71], v[28:31]
    ds_read_b128 v[120:123], v6 offset:3200
    v_mfma_f32_16x16x32_bf16 v[44:47], v[156:159], a[68:71], v[44:47]
    ds_read_b128 v[124:127], v6 offset:3232
    s_waitcnt lgkmcnt(7)
    v_mfma_f32_16x16x32_bf16 v[24:27], v[160:163], a[0:3], v[24:27]
    ds_read_b128 v[128:131], v6 offset:3264
    s_waitcnt lgkmcnt(7)
    v_mfma_f32_16x16x32_bf16 v[40:43], v[164:167], a[0:3], v[40:43]
    ds_read_b128 v[132:135], v6 offset:3296
    v_mfma_f32_16x16x32_bf16 v[28:31], v[160:163], a[64:67], v[28:31]
    ds_read_b128 v[136:139], v6 offset:3328
    v_mfma_f32_16x16x32_bf16 v[44:47], v[164:167], a[64:67], v[44:47]
    ds_read_b128 v[140:143], v6 offset:3360
    s_waitcnt lgkmcnt(9)
    v_mfma_f32_16x16x32_bf16 v[28:31], v[168:171], a[60:63], v[28:31]
    ds_read_b128 v[144:147], v6 offset:3392
    s_waitcnt lgkmcnt(9)
    v_mfma_f32_16x16x32_bf16 v[44:47], v[172:175], a[60:63], v[44:47]
    ds_read_b128 v[148:151], v6 offset:3424
    s_waitcnt lgkmcnt(9)
    v_mfma_f32_16x16x32_bf16 v[28:31], v[112:115], a[56:59], v[28:31]
    ds_read_b128 v[152:155], v6 offset:3456
    s_waitcnt lgkmcnt(9)
    v_mfma_f32_16x16x32_bf16 v[44:47], v[116:119], a[56:59], v[44:47]
    ds_read_b128 v[156:159], v6 offset:3488
    s_waitcnt lgkmcnt(9)
    v_mfma_f32_16x16x32_bf16 v[28:31], v[120:123], a[52:55], v[28:31]
    ds_read_b128 v[160:163], v6 offset:3520
    s_waitcnt lgkmcnt(9)
    v_mfma_f32_16x16x32_bf16 v[44:47], v[124:127], a[52:55], v[44:47]
    ds_read_b128 v[164:167], v6 offset:3552
    s_waitcnt lgkmcnt(9)
    v_mfma_f32_16x16x32_bf16 v[28:31], v[128:131], a[48:51], v[28:31]
    ds_read_b128 v[168:171], v6 offset:3584
    s_waitcnt lgkmcnt(9)
    v_mfma_f32_16x16x32_bf16 v[44:47], v[132:135], a[48:51], v[44:47]
    ds_read_b128 v[172:175], v6 offset:3616
    s_waitcnt lgkmcnt(9)
    v_mfma_f32_16x16x32_bf16 v[28:31], v[136:139], a[44:47], v[28:31]
    ds_read_b128 v[112:115], v6 offset:3648
    s_waitcnt lgkmcnt(9)
    v_mfma_f32_16x16x32_bf16 v[44:47], v[140:143], a[44:47], v[44:47]
    ds_read_b128 v[116:119], v6 offset:3680
    s_waitcnt lgkmcnt(9)
    v_mfma_f32_16x16x32_bf16 v[28:31], v[144:147], a[40:43], v[28:31]
    ds_read_b128 v[120:123], v6 offset:3712
    s_waitcnt lgkmcnt(9)
    v_mfma_f32_16x16x32_bf16 v[44:47], v[148:151], a[40:43], v[44:47]
    ds_read_b128 v[124:127], v6 offset:3744
    s_waitcnt lgkmcnt(9)
    v_mfma_f32_16x16x32_bf16 v[28:31], v[152:155], a[36:39], v[28:31]
    ds_read_b128 v[128:131], v6 offset:3776
    s_waitcnt lgkmcnt(9)
    v_mfma_f32_16x16x32_bf16 v[44:47], v[156:159], a[36:39], v[44:47]
    ds_read_b128 v[132:135], v6 offset:3808
    s_waitcnt lgkmcnt(9)
    v_mfma_f32_16x16x32_bf16 v[28:31], v[160:163], a[32:35], v[28:31]
    ds_read_b128 v[136:139], v6 offset:3840
    s_waitcnt lgkmcnt(9)
    v_mfma_f32_16x16x32_bf16 v[44:47], v[164:167], a[32:35], v[44:47]
    ds_read_b128 v[140:143], v6 offset:3872
    s_waitcnt lgkmcnt(9)
    v_mfma_f32_16x16x32_bf16 v[28:31], v[168:171], a[28:31], v[28:31]
    ds_read_b128 v[144:147], v6 offset:3904
    s_waitcnt lgkmcnt(9)
    v_mfma_f32_16x16x32_bf16 v[44:47], v[172:175], a[28:31], v[44:47]
    ds_read_b128 v[148:151], v6 offset:3936
    s_waitcnt lgkmcnt(9)
    v_mfma_f32_16x16x32_bf16 v[28:31], v[112:115], a[24:27], v[28:31]
    ds_read_b128 v[152:155], v6 offset:3968
    s_waitcnt lgkmcnt(9)
    v_mfma_f32_16x16x32_bf16 v[44:47], v[116:119], a[24:27], v[44:47]
    ds_read_b128 v[156:159], v6 offset:4000
    s_waitcnt lgkmcnt(9)
    v_mfma_f32_16x16x32_bf16 v[28:31], v[120:123], a[20:23], v[28:31]
    ds_read_b128 v[160:163], v6 offset:4032
    s_waitcnt lgkmcnt(9)
    v_mfma_f32_16x16x32_bf16 v[44:47], v[124:127], a[20:23], v[44:47]
    ds_read_b128 v[164:167], v6 offset:4064
    s_waitcnt lgkmcnt(9)
    v_mfma_f32_16x16x32_bf16 v[28:31], v[128:131], a[16:19], v[28:31]
    s_waitcnt vmcnt(2)
    ds_read_b128 a[60:63], v7 offset:240
    s_waitcnt lgkmcnt(9)
    v_mfma_f32_16x16x32_bf16 v[44:47], v[132:135], a[16:19], v[44:47]
    s_waitcnt lgkmcnt(8)
    v_mfma_f32_16x16x32_bf16 v[28:31], v[136:139], a[12:15], v[28:31]
    ds_read_b128 a[124:127], v7 offset:496
    s_waitcnt lgkmcnt(8)
    v_mfma_f32_16x16x32_bf16 v[44:47], v[140:143], a[12:15], v[44:47]
    s_waitcnt lgkmcnt(7)
    v_mfma_f32_16x16x32_bf16 v[28:31], v[144:147], a[8:11], v[28:31]
    ds_read_b128 a[188:191], v7 offset:752
    s_waitcnt lgkmcnt(7)
    v_mfma_f32_16x16x32_bf16 v[44:47], v[148:151], a[8:11], v[44:47]
    s_waitcnt lgkmcnt(6)
    v_mfma_f32_16x16x32_bf16 v[28:31], v[152:155], a[4:7], v[28:31]
    ds_read_b128 a[252:255], v7 offset:1008
    s_waitcnt lgkmcnt(6)
    v_mfma_f32_16x16x32_bf16 v[44:47], v[156:159], a[4:7], v[44:47]
    s_waitcnt lgkmcnt(5)
    v_mfma_f32_16x16x32_bf16 v[28:31], v[160:163], a[0:3], v[28:31]
    ds_read_b128 v[168:171], v6 offset:0
    s_waitcnt lgkmcnt(5)
    v_mfma_f32_16x16x32_bf16 v[44:47], v[164:167], a[0:3], v[44:47]
    ds_read_b128 v[172:175], v6 offset:32
    s_waitcnt lgkmcnt(5)
    v_mfma_f32_16x16x32_bf16 v[48:51], v[236:239], a[60:63], 0
    v_mfma_f32_16x16x32_bf16 v[64:67], v[240:243], a[60:63], 0
    s_waitcnt lgkmcnt(4)
    v_mfma_f32_16x16x32_bf16 v[52:55], v[236:239], a[124:127], 0
    v_mfma_f32_16x16x32_bf16 v[68:71], v[240:243], a[124:127], 0
    s_waitcnt lgkmcnt(3)
    v_mfma_f32_16x16x32_bf16 v[56:59], v[236:239], a[188:191], 0
    v_mfma_f32_16x16x32_bf16 v[72:75], v[240:243], a[188:191], 0
    ds_read_b128 a[56:59], v7 offset:224
    s_waitcnt lgkmcnt(3)
    v_mfma_f32_16x16x32_bf16 v[60:63], v[236:239], a[252:255], 0
    ds_read_b128 v[112:115], v6 offset:64
    v_mfma_f32_16x16x32_bf16 v[76:79], v[240:243], a[252:255], 0
    ds_read_b128 v[116:119], v6 offset:96
    s_waitcnt lgkmcnt(4)
    v_mfma_f32_16x16x32_bf16 v[48:51], v[168:171], a[60:63], v[48:51]
    ds_read_b128 a[120:123], v7 offset:480
    s_waitcnt lgkmcnt(4)
    v_mfma_f32_16x16x32_bf16 v[64:67], v[172:175], a[60:63], v[64:67]
    s_waitcnt vmcnt(10)
    v_mfma_f32_16x16x32_bf16 v[52:55], v[168:171], a[124:127], v[52:55]
    ds_read_b128 a[184:187], v7 offset:736
    v_mfma_f32_16x16x32_bf16 v[68:71], v[172:175], a[124:127], v[68:71]
    ds_write_b128 v5, v[196:199] offset:2048
    v_mfma_f32_16x16x32_bf16 v[56:59], v[168:171], a[188:191], v[56:59]
    ds_read_b128 a[248:251], v7 offset:992
    v_mfma_f32_16x16x32_bf16 v[72:75], v[172:175], a[188:191], v[72:75]
    ds_read_b128 a[52:55], v7 offset:208
    v_mfma_f32_16x16x32_bf16 v[60:63], v[168:171], a[252:255], v[60:63]
    ds_read_b128 v[120:123], v6 offset:128
    v_mfma_f32_16x16x32_bf16 v[76:79], v[172:175], a[252:255], v[76:79]
    ds_read_b128 v[124:127], v6 offset:160
    s_waitcnt lgkmcnt(8)
    v_mfma_f32_16x16x32_bf16 v[48:51], v[112:115], a[56:59], v[48:51]
    ds_read_b128 a[116:119], v7 offset:464
    s_waitcnt lgkmcnt(8)
    v_mfma_f32_16x16x32_bf16 v[64:67], v[116:119], a[56:59], v[64:67]
    ds_write_b128 v5, v[194:197] offset:18688
    s_waitcnt lgkmcnt(8)
    v_mfma_f32_16x16x32_bf16 v[52:55], v[112:115], a[120:123], v[52:55]
    ds_read_b128 a[180:183], v7 offset:720
    v_mfma_f32_16x16x32_bf16 v[68:71], v[116:119], a[120:123], v[68:71]
    v_mov_b32 v208, v193
    v_mov_b32 v209, v194
    s_waitcnt lgkmcnt(8)
    v_mfma_f32_16x16x32_bf16 v[56:59], v[112:115], a[184:187], v[56:59]
    ds_read_b128 a[244:247], v7 offset:976
    v_mfma_f32_16x16x32_bf16 v[72:75], v[116:119], a[184:187], v[72:75]
    ds_read_b128 a[48:51], v7 offset:192
    s_waitcnt lgkmcnt(8)
    v_mfma_f32_16x16x32_bf16 v[60:63], v[112:115], a[248:251], v[60:63]
    ds_read_b128 v[128:131], v6 offset:192
    v_mfma_f32_16x16x32_bf16 v[76:79], v[116:119], a[248:251], v[76:79]
    ds_read_b128 v[132:135], v6 offset:224
    s_waitcnt lgkmcnt(8)
    v_mfma_f32_16x16x32_bf16 v[48:51], v[120:123], a[52:55], v[48:51]
    ds_read_b128 a[112:115], v7 offset:448
    s_waitcnt lgkmcnt(8)
    v_mfma_f32_16x16x32_bf16 v[64:67], v[124:127], a[52:55], v[64:67]
    v_mov_b32 v210, v195
    v_mov_b32 v211, v196
    s_waitcnt lgkmcnt(7)
    v_mfma_f32_16x16x32_bf16 v[52:55], v[120:123], a[116:119], v[52:55]
    ds_read_b128 a[176:179], v7 offset:704
    v_mfma_f32_16x16x32_bf16 v[68:71], v[124:127], a[116:119], v[68:71]
    ds_write_b128 v5, v[208:211] offset:27008
    s_waitcnt lgkmcnt(7)
    v_mfma_f32_16x16x32_bf16 v[56:59], v[120:123], a[180:183], v[56:59]
    ds_read_b128 a[240:243], v7 offset:960
    v_mfma_f32_16x16x32_bf16 v[72:75], v[124:127], a[180:183], v[72:75]
    ds_read_b128 a[44:47], v7 offset:176
    s_waitcnt lgkmcnt(8)
    v_mfma_f32_16x16x32_bf16 v[60:63], v[120:123], a[244:247], v[60:63]
    ds_read_b128 v[136:139], v6 offset:256
    v_mfma_f32_16x16x32_bf16 v[76:79], v[124:127], a[244:247], v[76:79]
    ds_read_b128 v[140:143], v6 offset:288
    s_waitcnt lgkmcnt(8)
    v_mfma_f32_16x16x32_bf16 v[48:51], v[128:131], a[48:51], v[48:51]
    ds_read_b128 a[108:111], v7 offset:432
    s_waitcnt lgkmcnt(8)
    v_mfma_f32_16x16x32_bf16 v[64:67], v[132:135], a[48:51], v[64:67]
    v_mov_b32 v212, v197
    v_mov_b32 v213, v198
    s_waitcnt lgkmcnt(7)
    v_mfma_f32_16x16x32_bf16 v[52:55], v[128:131], a[112:115], v[52:55]
    ds_read_b128 a[172:175], v7 offset:688
    v_mfma_f32_16x16x32_bf16 v[68:71], v[132:135], a[112:115], v[68:71]
    ds_write_b128 v5, v[210:213] offset:10368
    s_waitcnt lgkmcnt(8)
    v_mfma_f32_16x16x32_bf16 v[56:59], v[128:131], a[176:179], v[56:59]
    ds_read_b128 a[236:239], v7 offset:944
    v_mfma_f32_16x16x32_bf16 v[72:75], v[132:135], a[176:179], v[72:75]
    ds_read_b128 a[40:43], v7 offset:160
    s_waitcnt lgkmcnt(8)
    v_mfma_f32_16x16x32_bf16 v[60:63], v[128:131], a[240:243], v[60:63]
    ds_read_b128 v[144:147], v6 offset:320
    v_mfma_f32_16x16x32_bf16 v[76:79], v[132:135], a[240:243], v[76:79]
    ds_read_b128 v[148:151], v6 offset:352
    s_waitcnt lgkmcnt(8)
    v_mfma_f32_16x16x32_bf16 v[48:51], v[136:139], a[44:47], v[48:51]
    ds_read_b128 a[104:107], v7 offset:416
    s_waitcnt lgkmcnt(8)
    v_mfma_f32_16x16x32_bf16 v[64:67], v[140:143], a[44:47], v[64:67]
    v_alignbit_b32 v214, v193, v192, 16
    v_alignbit_b32 v215, v194, v193, 16
    s_waitcnt lgkmcnt(7)
    v_mfma_f32_16x16x32_bf16 v[52:55], v[136:139], a[108:111], v[52:55]
    ds_read_b128 a[168:171], v7 offset:672
    v_mfma_f32_16x16x32_bf16 v[68:71], v[140:143], a[108:111], v[68:71]
    v_alignbit_b32 v216, v195, v194, 16
    v_alignbit_b32 v217, v196, v195, 16
    s_waitcnt lgkmcnt(7)
    v_mfma_f32_16x16x32_bf16 v[56:59], v[136:139], a[172:175], v[56:59]
    ds_read_b128 a[232:235], v7 offset:928
    v_mfma_f32_16x16x32_bf16 v[72:75], v[140:143], a[172:175], v[72:75]
    ds_read_b128 a[36:39], v7 offset:144
    s_waitcnt lgkmcnt(7)
    v_mfma_f32_16x16x32_bf16 v[60:63], v[136:139], a[236:239], v[60:63]
    ds_read_b128 v[152:155], v6 offset:384
    v_mfma_f32_16x16x32_bf16 v[76:79], v[140:143], a[236:239], v[76:79]
    ds_read_b128 v[156:159], v6 offset:416
    s_waitcnt lgkmcnt(7)
    v_mfma_f32_16x16x32_bf16 v[48:51], v[144:147], a[40:43], v[48:51]
    ds_read_b128 a[100:103], v7 offset:400
    s_waitcnt lgkmcnt(7)
    v_mfma_f32_16x16x32_bf16 v[64:67], v[148:151], a[40:43], v[64:67]
    ds_write_b128 v5, v[214:217] offset:31168
    s_waitcnt lgkmcnt(7)
    v_mfma_f32_16x16x32_bf16 v[52:55], v[144:147], a[104:107], v[52:55]
    ds_read_b128 a[164:167], v7 offset:656
    v_mfma_f32_16x16x32_bf16 v[68:71], v[148:151], a[104:107], v[68:71]
    v_alignbit_b32 v218, v197, v196, 16
    v_alignbit_b32 v219, v198, v197, 16
    s_waitcnt lgkmcnt(7)
    v_mfma_f32_16x16x32_bf16 v[56:59], v[144:147], a[168:171], v[56:59]
    ds_read_b128 a[228:231], v7 offset:912
    v_mfma_f32_16x16x32_bf16 v[72:75], v[148:151], a[168:171], v[72:75]
    ds_read_b128 a[32:35], v7 offset:128
    s_waitcnt lgkmcnt(8)
    v_mfma_f32_16x16x32_bf16 v[60:63], v[144:147], a[232:235], v[60:63]
    ds_read_b128 v[160:163], v6 offset:448
    v_mfma_f32_16x16x32_bf16 v[76:79], v[148:151], a[232:235], v[76:79]
    ds_read_b128 v[164:167], v6 offset:480
    s_waitcnt lgkmcnt(8)
    v_mfma_f32_16x16x32_bf16 v[48:51], v[152:155], a[36:39], v[48:51]
    ds_read_b128 a[96:99], v7 offset:384
    s_waitcnt lgkmcnt(8)
    v_mfma_f32_16x16x32_bf16 v[64:67], v[156:159], a[36:39], v[64:67]
    ds_write_b128 v5, v[216:219] offset:14528
    s_waitcnt lgkmcnt(8)
    v_mfma_f32_16x16x32_bf16 v[52:55], v[152:155], a[100:103], v[52:55]
    ds_read_b128 a[160:163], v7 offset:640
    v_mfma_f32_16x16x32_bf16 v[68:71], v[156:159], a[100:103], v[68:71]
    v_alignbit_b32 v220, v194, v193, 16
    v_alignbit_b32 v221, v195, v194, 16
    s_waitcnt lgkmcnt(7)
    v_mfma_f32_16x16x32_bf16 v[56:59], v[152:155], a[164:167], v[56:59]
    ds_read_b128 a[224:227], v7 offset:896
    v_mfma_f32_16x16x32_bf16 v[72:75], v[156:159], a[164:167], v[72:75]
    ds_read_b128 a[28:31], v7 offset:112
    s_waitcnt lgkmcnt(8)
    v_mfma_f32_16x16x32_bf16 v[60:63], v[152:155], a[228:231], v[60:63]
    ds_read_b128 v[168:171], v6 offset:512
    v_mfma_f32_16x16x32_bf16 v[76:79], v[156:159], a[228:231], v[76:79]
    ds_read_b128 v[172:175], v6 offset:544
    s_waitcnt lgkmcnt(8)
    v_mfma_f32_16x16x32_bf16 v[48:51], v[160:163], a[32:35], v[48:51]
    ds_read_b128 a[92:95], v7 offset:368
    s_waitcnt lgkmcnt(8)
    v_mfma_f32_16x16x32_bf16 v[64:67], v[164:167], a[32:35], v[64:67]
    v_alignbit_b32 v222, v196, v195, 16
    v_alignbit_b32 v223, v197, v196, 16
    s_waitcnt lgkmcnt(7)
    v_mfma_f32_16x16x32_bf16 v[52:55], v[160:163], a[96:99], v[52:55]
    ds_read_b128 a[156:159], v7 offset:624
    v_mfma_f32_16x16x32_bf16 v[68:71], v[164:167], a[96:99], v[68:71]
    ds_write_b128 v5, v[220:223] offset:22848
    s_waitcnt lgkmcnt(7)
    v_mfma_f32_16x16x32_bf16 v[56:59], v[160:163], a[160:163], v[56:59]
    ds_read_b128 a[220:223], v7 offset:880
    v_mfma_f32_16x16x32_bf16 v[72:75], v[164:167], a[160:163], v[72:75]
    ds_read_b128 a[24:27], v7 offset:96
    s_waitcnt lgkmcnt(8)
    v_mfma_f32_16x16x32_bf16 v[60:63], v[160:163], a[224:227], v[60:63]
    ds_read_b128 v[112:115], v6 offset:576
    v_mfma_f32_16x16x32_bf16 v[76:79], v[164:167], a[224:227], v[76:79]
    ds_read_b128 v[116:119], v6 offset:608
    s_waitcnt lgkmcnt(8)
    v_mfma_f32_16x16x32_bf16 v[48:51], v[168:171], a[28:31], v[48:51]
    ds_read_b128 a[88:91], v7 offset:352
    s_waitcnt lgkmcnt(8)
    v_mfma_f32_16x16x32_bf16 v[64:67], v[172:175], a[28:31], v[64:67]
    v_alignbit_b32 v224, v198, v197, 16
    v_alignbit_b32 v225, v199, v198, 16
    s_waitcnt lgkmcnt(7)
    v_mfma_f32_16x16x32_bf16 v[52:55], v[168:171], a[92:95], v[52:55]
    ds_read_b128 a[152:155], v7 offset:608
    v_mfma_f32_16x16x32_bf16 v[68:71], v[172:175], a[92:95], v[68:71]
    ds_write_b128 v5, v[222:225] offset:6208
    s_waitcnt lgkmcnt(8)
    v_mfma_f32_16x16x32_bf16 v[56:59], v[168:171], a[156:159], v[56:59]
    ds_read_b128 a[216:219], v7 offset:864
    v_mfma_f32_16x16x32_bf16 v[72:75], v[172:175], a[156:159], v[72:75]
    ds_read_b128 a[20:23], v7 offset:80
    s_waitcnt lgkmcnt(8)
    v_mfma_f32_16x16x32_bf16 v[60:63], v[168:171], a[220:223], v[60:63]
    ds_read_b128 v[120:123], v6 offset:640
    v_mfma_f32_16x16x32_bf16 v[76:79], v[172:175], a[220:223], v[76:79]
    ds_read_b128 v[124:127], v6 offset:672
    s_waitcnt lgkmcnt(8)
    v_mfma_f32_16x16x32_bf16 v[48:51], v[112:115], a[24:27], v[48:51]
    ds_read_b128 a[84:87], v7 offset:336
    s_waitcnt lgkmcnt(8)
    v_mfma_f32_16x16x32_bf16 v[64:67], v[116:119], a[24:27], v[64:67]
    buffer_load_dwordx4 v[192:195], v4, s[28:31], s36 offen offset:2032
    s_waitcnt lgkmcnt(7)
    v_mfma_f32_16x16x32_bf16 v[52:55], v[112:115], a[88:91], v[52:55]
    ds_read_b128 a[148:151], v7 offset:592
    v_mfma_f32_16x16x32_bf16 v[68:71], v[116:119], a[88:91], v[68:71]
    buffer_load_dwordx4 v[196:199], v4, s[28:31], s36 offen offset:2048
    s_waitcnt lgkmcnt(7)
    v_mfma_f32_16x16x32_bf16 v[56:59], v[112:115], a[152:155], v[56:59]
    ds_read_b128 a[212:215], v7 offset:848
    v_mfma_f32_16x16x32_bf16 v[72:75], v[116:119], a[152:155], v[72:75]
    ds_read_b128 a[16:19], v7 offset:64
    s_waitcnt lgkmcnt(7)
    v_mfma_f32_16x16x32_bf16 v[60:63], v[112:115], a[216:219], v[60:63]
    ds_read_b128 v[128:131], v6 offset:704
    v_mfma_f32_16x16x32_bf16 v[76:79], v[116:119], a[216:219], v[76:79]
    ds_read_b128 v[132:135], v6 offset:736
    s_waitcnt lgkmcnt(7)
    v_mfma_f32_16x16x32_bf16 v[48:51], v[120:123], a[20:23], v[48:51]
    ds_read_b128 a[80:83], v7 offset:320
    s_waitcnt lgkmcnt(7)
    v_mfma_f32_16x16x32_bf16 v[64:67], v[124:127], a[20:23], v[64:67]
    s_waitcnt vmcnt(10)
    s_waitcnt lgkmcnt(6)
    v_mfma_f32_16x16x32_bf16 v[52:55], v[120:123], a[84:87], v[52:55]
    ds_read_b128 a[144:147], v7 offset:576
    v_mfma_f32_16x16x32_bf16 v[68:71], v[124:127], a[84:87], v[68:71]
    ds_write_b128 v5, v[204:207] offset:3072
    s_waitcnt lgkmcnt(7)
    v_mfma_f32_16x16x32_bf16 v[56:59], v[120:123], a[148:151], v[56:59]
    ds_read_b128 a[208:211], v7 offset:832
    v_mfma_f32_16x16x32_bf16 v[72:75], v[124:127], a[148:151], v[72:75]
    ds_read_b128 a[12:15], v7 offset:48
    s_waitcnt lgkmcnt(8)
    v_mfma_f32_16x16x32_bf16 v[60:63], v[120:123], a[212:215], v[60:63]
    ds_read_b128 v[136:139], v6 offset:768
    v_mfma_f32_16x16x32_bf16 v[76:79], v[124:127], a[212:215], v[76:79]
    ds_read_b128 v[140:143], v6 offset:800
    s_waitcnt lgkmcnt(8)
    v_mfma_f32_16x16x32_bf16 v[48:51], v[128:131], a[16:19], v[48:51]
    ds_read_b128 a[76:79], v7 offset:304
    s_waitcnt lgkmcnt(8)
    v_mfma_f32_16x16x32_bf16 v[64:67], v[132:135], a[16:19], v[64:67]
    ds_write_b128 v5, v[202:205] offset:19712
    s_waitcnt lgkmcnt(8)
    v_mfma_f32_16x16x32_bf16 v[52:55], v[128:131], a[80:83], v[52:55]
    ds_read_b128 a[140:143], v7 offset:560
    v_mfma_f32_16x16x32_bf16 v[68:71], v[132:135], a[80:83], v[68:71]
    v_mov_b32 v208, v201
    v_mov_b32 v209, v202
    s_waitcnt lgkmcnt(8)
    v_mfma_f32_16x16x32_bf16 v[56:59], v[128:131], a[144:147], v[56:59]
    ds_read_b128 a[204:207], v7 offset:816
    v_mfma_f32_16x16x32_bf16 v[72:75], v[132:135], a[144:147], v[72:75]
    ds_read_b128 a[8:11], v7 offset:32
    s_waitcnt lgkmcnt(8)
    v_mfma_f32_16x16x32_bf16 v[60:63], v[128:131], a[208:211], v[60:63]
    ds_read_b128 v[144:147], v6 offset:832
    v_mfma_f32_16x16x32_bf16 v[76:79], v[132:135], a[208:211], v[76:79]
    ds_read_b128 v[148:151], v6 offset:864
    s_waitcnt lgkmcnt(8)
    v_mfma_f32_16x16x32_bf16 v[48:51], v[136:139], a[12:15], v[48:51]
    ds_read_b128 a[72:75], v7 offset:288
    s_waitcnt lgkmcnt(8)
    v_mfma_f32_16x16x32_bf16 v[64:67], v[140:143], a[12:15], v[64:67]
    v_mov_b32 v210, v203
    v_mov_b32 v211, v204
    s_waitcnt lgkmcnt(7)
    v_mfma_f32_16x16x32_bf16 v[52:55], v[136:139], a[76:79], v[52:55]
    ds_read_b128 a[136:139], v7 offset:544
    v_mfma_f32_16x16x32_bf16 v[68:71], v[140:143], a[76:79], v[68:71]
    ds_write_b128 v5, v[208:211] offset:28032
    s_waitcnt lgkmcnt(7)
    v_mfma_f32_16x16x32_bf16 v[56:59], v[136:139], a[140:143], v[56:59]
    ds_read_b128 a[200:203], v7 offset:800
    v_mfma_f32_16x16x32_bf16 v[72:75], v[140:143], a[140:143], v[72:75]
    ds_read_b128 a[4:7], v7 offset:16
    s_waitcnt lgkmcnt(8)
    v_mfma_f32_16x16x32_bf16 v[60:63], v[136:139], a[204:207], v[60:63]
    ds_read_b128 v[152:155], v6 offset:896
    v_mfma_f32_16x16x32_bf16 v[76:79], v[140:143], a[204:207], v[76:79]
    ds_read_b128 v[156:159], v6 offset:928
    s_waitcnt lgkmcnt(8)
    v_mfma_f32_16x16x32_bf16 v[48:51], v[144:147], a[8:11], v[48:51]
    ds_read_b128 a[68:71], v7 offset:272
    s_waitcnt lgkmcnt(8)
    v_mfma_f32_16x16x32_bf16 v[64:67], v[148:151], a[8:11], v[64:67]
    v_mov_b32 v212, v205
    v_mov_b32 v213, v206
    s_waitcnt lgkmcnt(7)
    v_mfma_f32_16x16x32_bf16 v[52:55], v[144:147], a[72:75], v[52:55]
    ds_read_b128 a[132:135], v7 offset:528
    v_mfma_f32_16x16x32_bf16 v[68:71], v[148:151], a[72:75], v[68:71]
    ds_write_b128 v5, v[210:213] offset:11392
    s_waitcnt lgkmcnt(8)
    v_mfma_f32_16x16x32_bf16 v[56:59], v[144:147], a[136:139], v[56:59]
    ds_read_b128 a[196:199], v7 offset:784
    v_mfma_f32_16x16x32_bf16 v[72:75], v[148:151], a[136:139], v[72:75]
    ds_read_b128 a[0:3], v7 offset:0
    s_waitcnt lgkmcnt(8)
    v_mfma_f32_16x16x32_bf16 v[60:63], v[144:147], a[200:203], v[60:63]
    ds_read_b128 v[160:163], v6 offset:960
    v_mfma_f32_16x16x32_bf16 v[76:79], v[148:151], a[200:203], v[76:79]
    ds_read_b128 v[164:167], v6 offset:992
    s_waitcnt lgkmcnt(8)
    v_mfma_f32_16x16x32_bf16 v[48:51], v[152:155], a[4:7], v[48:51]
    ds_read_b128 a[64:67], v7 offset:256
    s_waitcnt lgkmcnt(8)
    v_mfma_f32_16x16x32_bf16 v[64:67], v[156:159], a[4:7], v[64:67]
    v_alignbit_b32 v214, v201, v200, 16
    v_alignbit_b32 v215, v202, v201, 16
    s_waitcnt lgkmcnt(7)
    v_mfma_f32_16x16x32_bf16 v[52:55], v[152:155], a[68:71], v[52:55]
    ds_read_b128 a[128:131], v7 offset:512
    v_mfma_f32_16x16x32_bf16 v[68:71], v[156:159], a[68:71], v[68:71]
    v_alignbit_b32 v216, v203, v202, 16
    v_alignbit_b32 v217, v204, v203, 16
    s_waitcnt lgkmcnt(7)
    v_mfma_f32_16x16x32_bf16 v[56:59], v[152:155], a[132:135], v[56:59]
    ds_read_b128 a[192:195], v7 offset:768
    v_mfma_f32_16x16x32_bf16 v[72:75], v[156:159], a[132:135], v[72:75]
    ds_write_b128 v5, v[214:217] offset:32192
    s_waitcnt lgkmcnt(7)
    v_mfma_f32_16x16x32_bf16 v[60:63], v[152:155], a[196:199], v[60:63]
    ds_read_b128 v[168:171], v6 offset:1024
    v_mfma_f32_16x16x32_bf16 v[76:79], v[156:159], a[196:199], v[76:79]
    ds_read_b128 v[172:175], v6 offset:1056
    s_waitcnt lgkmcnt(7)
    v_mfma_f32_16x16x32_bf16 v[48:51], v[160:163], a[0:3], v[48:51]
    v_alignbit_b32 v218, v205, v204, 16
    v_alignbit_b32 v219, v206, v205, 16
    s_waitcnt lgkmcnt(6)
    v_mfma_f32_16x16x32_bf16 v[64:67], v[164:167], a[0:3], v[64:67]
    ds_write_b128 v5, v[216:219] offset:15552
    s_waitcnt lgkmcnt(6)
    v_mfma_f32_16x16x32_bf16 v[52:55], v[160:163], a[64:67], v[52:55]
    v_alignbit_b32 v220, v202, v201, 16
    v_alignbit_b32 v221, v203, v202, 16
    v_mfma_f32_16x16x32_bf16 v[68:71], v[164:167], a[64:67], v[68:71]
    v_alignbit_b32 v222, v204, v203, 16
    v_alignbit_b32 v223, v205, v204, 16
    s_waitcnt lgkmcnt(5)
    v_mfma_f32_16x16x32_bf16 v[56:59], v[160:163], a[128:131], v[56:59]
    ds_read_b128 v[112:115], v6 offset:1088
    v_mfma_f32_16x16x32_bf16 v[72:75], v[164:167], a[128:131], v[72:75]
    ds_read_b128 v[116:119], v6 offset:1120
    s_waitcnt lgkmcnt(6)
    v_mfma_f32_16x16x32_bf16 v[60:63], v[160:163], a[192:195], v[60:63]
    ds_write_b128 v5, v[220:223] offset:23872
    v_mfma_f32_16x16x32_bf16 v[76:79], v[164:167], a[192:195], v[76:79]
    v_alignbit_b32 v224, v206, v205, 16
    v_alignbit_b32 v225, v207, v206, 16
    s_waitcnt lgkmcnt(5)
    v_mfma_f32_16x16x32_bf16 v[52:55], v[168:171], a[60:63], v[52:55]
    ds_write_b128 v5, v[222:225] offset:7232
    s_waitcnt lgkmcnt(5)
    v_mfma_f32_16x16x32_bf16 v[68:71], v[172:175], a[60:63], v[68:71]
    buffer_load_dwordx4 v[200:203], v4, s[28:31], s36 offen offset:3056
    v_mfma_f32_16x16x32_bf16 v[56:59], v[168:171], a[124:127], v[56:59]
    ds_read_b128 v[120:123], v6 offset:1152
    v_mfma_f32_16x16x32_bf16 v[72:75], v[172:175], a[124:127], v[72:75]
    ds_read_b128 v[124:127], v6 offset:1184
    v_mfma_f32_16x16x32_bf16 v[60:63], v[168:171], a[188:191], v[60:63]
    buffer_load_dwordx4 v[204:207], v4, s[28:31], s36 offen offset:3072
    v_mfma_f32_16x16x32_bf16 v[76:79], v[172:175], a[188:191], v[76:79]
    s_waitcnt vmcnt(10)
    s_mov_b64 exec, 1
    v_mov_b32 v176, 0
    v_mov_b32 v177, 0
    v_mov_b32 v178, 0
    v_mov_b32 v179, 0
    s_mov_b64 exec, -1
    s_waitcnt lgkmcnt(5)
    v_mfma_f32_16x16x32_bf16 v[52:55], v[112:115], a[56:59], v[52:55]
    ds_write_b128 v5, v[180:183] offset:0
    s_waitcnt lgkmcnt(5)
    v_mfma_f32_16x16x32_bf16 v[68:71], v[116:119], a[56:59], v[68:71]
    ds_write_b128 v5, v[178:181] offset:16640
    v_mfma_f32_16x16x32_bf16 v[56:59], v[112:115], a[120:123], v[56:59]
    ds_read_b128 v[128:131], v6 offset:1216
    v_mfma_f32_16x16x32_bf16 v[72:75], v[116:119], a[120:123], v[72:75]
    ds_read_b128 v[132:135], v6 offset:1248
    v_mfma_f32_16x16x32_bf16 v[60:63], v[112:115], a[184:187], v[60:63]
    v_mov_b32 v208, v177
    v_mov_b32 v209, v178
    v_mfma_f32_16x16x32_bf16 v[76:79], v[116:119], a[184:187], v[76:79]
    v_mov_b32 v210, v179
    v_mov_b32 v211, v180
    s_waitcnt lgkmcnt(5)
    v_mfma_f32_16x16x32_bf16 v[52:55], v[120:123], a[52:55], v[52:55]
    ds_write_b128 v5, v[208:211] offset:24960
    s_waitcnt lgkmcnt(5)
    v_mfma_f32_16x16x32_bf16 v[68:71], v[124:127], a[52:55], v[68:71]
    v_mov_b32 v212, v181
    v_mov_b32 v213, v182
    v_mfma_f32_16x16x32_bf16 v[56:59], v[120:123], a[116:119], v[56:59]
    ds_read_b128 v[136:139], v6 offset:1280
    v_mfma_f32_16x16x32_bf16 v[72:75], v[124:127], a[116:119], v[72:75]
    ds_read_b128 v[140:143], v6 offset:1312
    v_mfma_f32_16x16x32_bf16 v[60:63], v[120:123], a[180:183], v[60:63]
    ds_write_b128 v5, v[210:213] offset:8320
    v_mfma_f32_16x16x32_bf16 v[76:79], v[124:127], a[180:183], v[76:79]
    v_alignbit_b32 v214, v177, v176, 16
    v_alignbit_b32 v215, v178, v177, 16
    s_waitcnt lgkmcnt(5)
    v_mfma_f32_16x16x32_bf16 v[52:55], v[128:131], a[48:51], v[52:55]
    v_alignbit_b32 v216, v179, v178, 16
    v_alignbit_b32 v217, v180, v179, 16
    s_waitcnt lgkmcnt(4)
    v_mfma_f32_16x16x32_bf16 v[68:71], v[132:135], a[48:51], v[68:71]
    ds_write_b128 v5, v[214:217] offset:29120
    v_mfma_f32_16x16x32_bf16 v[56:59], v[128:131], a[112:115], v[56:59]
    ds_read_b128 v[144:147], v6 offset:1344
    v_mfma_f32_16x16x32_bf16 v[72:75], v[132:135], a[112:115], v[72:75]
    ds_read_b128 v[148:151], v6 offset:1376
    v_mfma_f32_16x16x32_bf16 v[60:63], v[128:131], a[176:179], v[60:63]
    v_alignbit_b32 v218, v181, v180, 16
    v_alignbit_b32 v219, v182, v181, 16
    v_mfma_f32_16x16x32_bf16 v[76:79], v[132:135], a[176:179], v[76:79]
    ds_write_b128 v5, v[216:219] offset:12480
    s_waitcnt lgkmcnt(6)
    v_mfma_f32_16x16x32_bf16 v[52:55], v[136:139], a[44:47], v[52:55]
    v_alignbit_b32 v220, v178, v177, 16
    v_alignbit_b32 v221, v179, v178, 16
    s_waitcnt lgkmcnt(5)
    v_mfma_f32_16x16x32_bf16 v[68:71], v[140:143], a[44:47], v[68:71]
    v_alignbit_b32 v222, v180, v179, 16
    v_alignbit_b32 v223, v181, v180, 16
    v_mfma_f32_16x16x32_bf16 v[56:59], v[136:139], a[108:111], v[56:59]
    ds_read_b128 v[152:155], v6 offset:1408
    v_mfma_f32_16x16x32_bf16 v[72:75], v[140:143], a[108:111], v[72:75]
    ds_read_b128 v[156:159], v6 offset:1440
    v_mfma_f32_16x16x32_bf16 v[60:63], v[136:139], a[172:175], v[60:63]
    ds_write_b128 v5, v[220:223] offset:20800
    v_mfma_f32_16x16x32_bf16 v[76:79], v[140:143], a[172:175], v[76:79]
    v_alignbit_b32 v224, v182, v181, 16
    v_alignbit_b32 v225, v183, v182, 16
    s_waitcnt lgkmcnt(5)
    v_mfma_f32_16x16x32_bf16 v[52:55], v[144:147], a[40:43], v[52:55]
    ds_write_b128 v5, v[222:225] offset:4160
    s_waitcnt lgkmcnt(5)
    v_mfma_f32_16x16x32_bf16 v[68:71], v[148:151], a[40:43], v[68:71]
    buffer_load_dwordx4 v[176:179], v230, s[28:31], s37 offen offset:0
    v_mfma_f32_16x16x32_bf16 v[56:59], v[144:147], a[104:107], v[56:59]
    ds_read_b128 v[160:163], v6 offset:1472
    v_mfma_f32_16x16x32_bf16 v[72:75], v[148:151], a[104:107], v[72:75]
    ds_read_b128 v[164:167], v6 offset:1504
    v_mfma_f32_16x16x32_bf16 v[60:63], v[144:147], a[168:171], v[60:63]
    buffer_load_dwordx4 v[180:183], v4, s[28:31], s37 offen offset:0
    v_mfma_f32_16x16x32_bf16 v[76:79], v[148:151], a[168:171], v[76:79]
    s_add_u32 m0, s35, 0
    s_waitcnt lgkmcnt(5)
    v_mfma_f32_16x16x32_bf16 v[52:55], v[152:155], a[36:39], v[52:55]
    buffer_load_dwordx4 v4, s[8:11], s39 offen offset:0 lds
    s_waitcnt lgkmcnt(4)
    v_mfma_f32_16x16x32_bf16 v[68:71], v[156:159], a[36:39], v[68:71]
    s_add_u32 m0, s35, 256
    v_mfma_f32_16x16x32_bf16 v[56:59], v[152:155], a[100:103], v[56:59]
    ds_read_b128 v[168:171], v6 offset:1536
    v_mfma_f32_16x16x32_bf16 v[72:75], v[156:159], a[100:103], v[72:75]
    ds_read_b128 v[172:175], v6 offset:1568
    v_mfma_f32_16x16x32_bf16 v[60:63], v[152:155], a[164:167], v[60:63]
    buffer_load_dwordx4 v4, s[8:11], s39 offen offset:1024 lds
    v_mfma_f32_16x16x32_bf16 v[76:79], v[156:159], a[164:167], v[76:79]
    s_add_u32 m0, s35, 512
    s_waitcnt lgkmcnt(3)
    v_mfma_f32_16x16x32_bf16 v[52:55], v[160:163], a[32:35], v[52:55]
    buffer_load_dwordx4 v4, s[8:11], s39 offen offset:2048 lds
    s_waitcnt lgkmcnt(2)
    v_mfma_f32_16x16x32_bf16 v[68:71], v[164:167], a[32:35], v[68:71]
    s_add_u32 m0, s35, 768
    v_mfma_f32_16x16x32_bf16 v[56:59], v[160:163], a[96:99], v[56:59]
    ds_read_b128 v[112:115], v6 offset:1600
    v_mfma_f32_16x16x32_bf16 v[72:75], v[164:167], a[96:99], v[72:75]
    ds_read_b128 v[116:119], v6 offset:1632
    v_mfma_f32_16x16x32_bf16 v[60:63], v[160:163], a[160:163], v[60:63]
    buffer_load_dwordx4 v4, s[8:11], s39 offen offset:3072 lds
    v_mfma_f32_16x16x32_bf16 v[76:79], v[164:167], a[160:163], v[76:79]
    s_waitcnt lgkmcnt(3)
    v_mfma_f32_16x16x32_bf16 v[52:55], v[168:171], a[28:31], v[52:55]
    s_waitcnt lgkmcnt(2)
    v_mfma_f32_16x16x32_bf16 v[68:71], v[172:175], a[28:31], v[68:71]
    v_mfma_f32_16x16x32_bf16 v[56:59], v[168:171], a[92:95], v[56:59]
    ds_read_b128 v[120:123], v6 offset:1664
    v_mfma_f32_16x16x32_bf16 v[72:75], v[172:175], a[92:95], v[72:75]
    ds_read_b128 v[124:127], v6 offset:1696
    v_mfma_f32_16x16x32_bf16 v[60:63], v[168:171], a[156:159], v[60:63]
    v_mfma_f32_16x16x32_bf16 v[76:79], v[172:175], a[156:159], v[76:79]
    s_waitcnt lgkmcnt(3)
    v_mfma_f32_16x16x32_bf16 v[52:55], v[112:115], a[24:27], v[52:55]
    s_waitcnt lgkmcnt(2)
    v_mfma_f32_16x16x32_bf16 v[68:71], v[116:119], a[24:27], v[68:71]
    v_mfma_f32_16x16x32_bf16 v[56:59], v[112:115], a[88:91], v[56:59]
    ds_read_b128 v[128:131], v6 offset:1728
    v_mfma_f32_16x16x32_bf16 v[72:75], v[116:119], a[88:91], v[72:75]
    ds_read_b128 v[132:135], v6 offset:1760
    v_mfma_f32_16x16x32_bf16 v[60:63], v[112:115], a[152:155], v[60:63]
    v_mfma_f32_16x16x32_bf16 v[76:79], v[116:119], a[152:155], v[76:79]
    s_waitcnt lgkmcnt(3)
    v_mfma_f32_16x16x32_bf16 v[52:55], v[120:123], a[20:23], v[52:55]
    s_waitcnt lgkmcnt(2)
    v_mfma_f32_16x16x32_bf16 v[68:71], v[124:127], a[20:23], v[68:71]
    v_mfma_f32_16x16x32_bf16 v[56:59], v[120:123], a[84:87], v[56:59]
    ds_read_b128 v[136:139], v6 offset:1792
    v_mfma_f32_16x16x32_bf16 v[72:75], v[124:127], a[84:87], v[72:75]
    ds_read_b128 v[140:143], v6 offset:1824
    v_mfma_f32_16x16x32_bf16 v[60:63], v[120:123], a[148:151], v[60:63]
    v_mfma_f32_16x16x32_bf16 v[76:79], v[124:127], a[148:151], v[76:79]
    s_waitcnt lgkmcnt(3)
    v_mfma_f32_16x16x32_bf16 v[52:55], v[128:131], a[16:19], v[52:55]
    s_waitcnt lgkmcnt(2)
    v_mfma_f32_16x16x32_bf16 v[68:71], v[132:135], a[16:19], v[68:71]
    v_mfma_f32_16x16x32_bf16 v[56:59], v[128:131], a[80:83], v[56:59]
    ds_read_b128 v[144:147], v6 offset:1856
    v_mfma_f32_16x16x32_bf16 v[72:75], v[132:135], a[80:83], v[72:75]
    ds_read_b128 v[148:151], v6 offset:1888
    v_mfma_f32_16x16x32_bf16 v[60:63], v[128:131], a[144:147], v[60:63]
    v_mfma_f32_16x16x32_bf16 v[76:79], v[132:135], a[144:147], v[76:79]
    s_waitcnt lgkmcnt(3)
    v_mfma_f32_16x16x32_bf16 v[52:55], v[136:139], a[12:15], v[52:55]
    s_waitcnt lgkmcnt(2)
    v_mfma_f32_16x16x32_bf16 v[68:71], v[140:143], a[12:15], v[68:71]
    v_mfma_f32_16x16x32_bf16 v[56:59], v[136:139], a[76:79], v[56:59]
    ds_read_b128 v[152:155], v6 offset:1920
    v_mfma_f32_16x16x32_bf16 v[72:75], v[140:143], a[76:79], v[72:75]
    ds_read_b128 v[156:159], v6 offset:1952
    v_mfma_f32_16x16x32_bf16 v[60:63], v[136:139], a[140:143], v[60:63]
    v_mfma_f32_16x16x32_bf16 v[76:79], v[140:143], a[140:143], v[76:79]
    s_waitcnt lgkmcnt(3)
    v_mfma_f32_16x16x32_bf16 v[52:55], v[144:147], a[8:11], v[52:55]
    s_waitcnt lgkmcnt(2)
    v_mfma_f32_16x16x32_bf16 v[68:71], v[148:151], a[8:11], v[68:71]
    v_mfma_f32_16x16x32_bf16 v[56:59], v[144:147], a[72:75], v[56:59]
    ds_read_b128 v[160:163], v6 offset:1984
    v_mfma_f32_16x16x32_bf16 v[72:75], v[148:151], a[72:75], v[72:75]
    ds_read_b128 v[164:167], v6 offset:2016
    v_mfma_f32_16x16x32_bf16 v[60:63], v[144:147], a[136:139], v[60:63]
    v_mfma_f32_16x16x32_bf16 v[76:79], v[148:151], a[136:139], v[76:79]
    s_waitcnt lgkmcnt(3)
    v_mfma_f32_16x16x32_bf16 v[52:55], v[152:155], a[4:7], v[52:55]
    s_waitcnt lgkmcnt(2)
    v_mfma_f32_16x16x32_bf16 v[68:71], v[156:159], a[4:7], v[68:71]
    v_mfma_f32_16x16x32_bf16 v[56:59], v[152:155], a[68:71], v[56:59]
    ds_read_b128 v[168:171], v6 offset:2048
    v_mfma_f32_16x16x32_bf16 v[72:75], v[156:159], a[68:71], v[72:75]
    ds_read_b128 v[172:175], v6 offset:2080
    v_mfma_f32_16x16x32_bf16 v[60:63], v[152:155], a[132:135], v[60:63]
    s_waitcnt vmcnt(10)
    v_mfma_f32_16x16x32_bf16 v[76:79], v[156:159], a[132:135], v[76:79]
    ds_write_b128 v5, v[188:191] offset:1024
    s_waitcnt lgkmcnt(4)
    v_mfma_f32_16x16x32_bf16 v[52:55], v[160:163], a[0:3], v[52:55]
    ds_read_b128 v[112:115], v6 offset:2112
    s_waitcnt lgkmcnt(4)
    v_mfma_f32_16x16x32_bf16 v[68:71], v[164:167], a[0:3], v[68:71]
    ds_read_b128 v[116:119], v6 offset:2144
    v_mfma_f32_16x16x32_bf16 v[56:59], v[160:163], a[64:67], v[56:59]
    ds_write_b128 v5, v[186:189] offset:17664
    v_mfma_f32_16x16x32_bf16 v[72:75], v[164:167], a[64:67], v[72:75]
    v_mov_b32 v208, v185
    v_mov_b32 v209, v186
    v_mfma_f32_16x16x32_bf16 v[60:63], v[160:163], a[128:131], v[60:63]
    ds_read_b128 v[120:123], v6 offset:2176
    v_mfma_f32_16x16x32_bf16 v[76:79], v[164:167], a[128:131], v[76:79]
    ds_read_b128 v[124:127], v6 offset:2208
    s_waitcnt lgkmcnt(7)
    v_mfma_f32_16x16x32_bf16 v[56:59], v[168:171], a[60:63], v[56:59]
    v_mov_b32 v210, v187
    v_mov_b32 v211, v188
    s_waitcnt lgkmcnt(6)
    v_mfma_f32_16x16x32_bf16 v[72:75], v[172:175], a[60:63], v[72:75]
    ds_write_b128 v5, v[208:211] offset:25984
    v_mfma_f32_16x16x32_bf16 v[60:63], v[168:171], a[124:127], v[60:63]
    ds_read_b128 v[128:131], v6 offset:2240
    v_mfma_f32_16x16x32_bf16 v[76:79], v[172:175], a[124:127], v[76:79]
    ds_read_b128 v[132:135], v6 offset:2272
    s_waitcnt lgkmcnt(7)
    v_mfma_f32_16x16x32_bf16 v[56:59], v[112:115], a[56:59], v[56:59]
    v_mov_b32 v212, v189
    v_mov_b32 v213, v190
    s_waitcnt lgkmcnt(6)
    v_mfma_f32_16x16x32_bf16 v[72:75], v[116:119], a[56:59], v[72:75]
    ds_write_b128 v5, v[210:213] offset:9344
    v_mfma_f32_16x16x32_bf16 v[60:63], v[112:115], a[120:123], v[60:63]
    ds_read_b128 v[136:139], v6 offset:2304
    v_mfma_f32_16x16x32_bf16 v[76:79], v[116:119], a[120:123], v[76:79]
    ds_read_b128 v[140:143], v6 offset:2336
    s_waitcnt lgkmcnt(7)
    v_mfma_f32_16x16x32_bf16 v[56:59], v[120:123], a[52:55], v[56:59]
    v_alignbit_b32 v214, v185, v184, 16
    v_alignbit_b32 v215, v186, v185, 16
    s_waitcnt lgkmcnt(6)
    v_mfma_f32_16x16x32_bf16 v[72:75], v[124:127], a[52:55], v[72:75]
    v_alignbit_b32 v216, v187, v186, 16
    v_alignbit_b32 v217, v188, v187, 16
    v_mfma_f32_16x16x32_bf16 v[60:63], v[120:123], a[116:119], v[60:63]
    ds_read_b128 v[144:147], v6 offset:2368
    v_mfma_f32_16x16x32_bf16 v[76:79], v[124:127], a[116:119], v[76:79]
    ds_read_b128 v[148:151], v6 offset:2400
    s_waitcnt lgkmcnt(6)
    v_mfma_f32_16x16x32_bf16 v[56:59], v[128:131], a[48:51], v[56:59]
    ds_write_b128 v5, v[214:217] offset:30144
    s_waitcnt lgkmcnt(6)
    v_mfma_f32_16x16x32_bf16 v[72:75], v[132:135], a[48:51], v[72:75]
    v_alignbit_b32 v218, v189, v188, 16
    v_alignbit_b32 v219, v190, v189, 16
    v_mfma_f32_16x16x32_bf16 v[60:63], v[128:131], a[112:115], v[60:63]
    ds_read_b128 v[152:155], v6 offset:2432
    v_mfma_f32_16x16x32_bf16 v[76:79], v[132:135], a[112:115], v[76:79]
    ds_read_b128 v[156:159], v6 offset:2464
    s_waitcnt lgkmcnt(6)
    v_mfma_f32_16x16x32_bf16 v[56:59], v[136:139], a[44:47], v[56:59]
    ds_write_b128 v5, v[216:219] offset:13504
    s_waitcnt lgkmcnt(6)
    v_mfma_f32_16x16x32_bf16 v[72:75], v[140:143], a[44:47], v[72:75]
    v_alignbit_b32 v220, v186, v185, 16
    v_alignbit_b32 v221, v187, v186, 16
    v_mfma_f32_16x16x32_bf16 v[60:63], v[136:139], a[108:111], v[60:63]
    ds_read_b128 v[160:163], v6 offset:2496
    v_mfma_f32_16x16x32_bf16 v[76:79], v[140:143], a[108:111], v[76:79]
    ds_read_b128 v[164:167], v6 offset:2528
    s_waitcnt lgkmcnt(7)
    v_mfma_f32_16x16x32_bf16 v[56:59], v[144:147], a[40:43], v[56:59]
    v_alignbit_b32 v222, v188, v187, 16
    v_alignbit_b32 v223, v189, v188, 16
    s_waitcnt lgkmcnt(6)
    v_mfma_f32_16x16x32_bf16 v[72:75], v[148:151], a[40:43], v[72:75]
    ds_write_b128 v5, v[220:223] offset:21824
    v_mfma_f32_16x16x32_bf16 v[60:63], v[144:147], a[104:107], v[60:63]
    ds_read_b128 v[168:171], v6 offset:2560
    v_mfma_f32_16x16x32_bf16 v[76:79], v[148:151], a[104:107], v[76:79]
    ds_read_b128 v[172:175], v6 offset:2592
    s_waitcnt lgkmcnt(7)
    v_mfma_f32_16x16x32_bf16 v[56:59], v[152:155], a[36:39], v[56:59]
    v_alignbit_b32 v224, v190, v189, 16
    v_alignbit_b32 v225, v191, v190, 16
    s_waitcnt lgkmcnt(6)
    v_mfma_f32_16x16x32_bf16 v[72:75], v[156:159], a[36:39], v[72:75]
    ds_write_b128 v5, v[222:225] offset:5184
    v_mfma_f32_16x16x32_bf16 v[60:63], v[152:155], a[100:103], v[60:63]
    ds_read_b128 v[112:115], v6 offset:2624
    v_mfma_f32_16x16x32_bf16 v[76:79], v[156:159], a[100:103], v[76:79]
    ds_read_b128 v[116:119], v6 offset:2656
    s_waitcnt lgkmcnt(7)
    v_mfma_f32_16x16x32_bf16 v[56:59], v[160:163], a[32:35], v[56:59]
    buffer_load_dwordx4 v[184:187], v4, s[28:31], s37 offen offset:1008
    s_waitcnt lgkmcnt(6)
    v_mfma_f32_16x16x32_bf16 v[72:75], v[164:167], a[32:35], v[72:75]
    buffer_load_dwordx4 v[188:191], v4, s[28:31], s37 offen offset:1024
    v_mfma_f32_16x16x32_bf16 v[60:63], v[160:163], a[96:99], v[60:63]
    ds_read_b128 v[120:123], v6 offset:2688
    v_mfma_f32_16x16x32_bf16 v[76:79], v[164:167], a[96:99], v[76:79]
    ds_read_b128 v[124:127], v6 offset:2720
    s_waitcnt lgkmcnt(6)
    v_mfma_f32_16x16x32_bf16 v[56:59], v[168:171], a[28:31], v[56:59]
    s_mov_b32 s36, s37
    s_add_u32 s39, s37, 125829120
    s_add_u32 s37, s37, 4096
    s_min_u32 s37, s37, s33

    s_pack_ll_b32_b16 s40, s65, s65
    s_mov_b32 s64, s65
    s_mov_b32 s65, s66
    s_mov_b32 s66, s67
    v_and_b32 v236, s40, v8
    s_waitcnt lgkmcnt(5)
    v_mfma_f32_16x16x32_bf16 v[72:75], v[172:175], a[28:31], v[72:75]
    v_and_b32 v237, s40, v9
    v_and_b32 v238, s40, v10
    v_mfma_f32_16x16x32_bf16 v[60:63], v[168:171], a[92:95], v[60:63]
    ds_read_b128 v[128:131], v6 offset:2752
    v_mfma_f32_16x16x32_bf16 v[76:79], v[172:175], a[92:95], v[76:79]
    ds_read_b128 v[132:135], v6 offset:2784
    s_waitcnt lgkmcnt(5)
    v_mfma_f32_16x16x32_bf16 v[56:59], v[112:115], a[24:27], v[56:59]
    v_and_b32 v239, s40, v11
    v_and_b32 v240, s40, v12
    s_waitcnt lgkmcnt(4)
    v_mfma_f32_16x16x32_bf16 v[72:75], v[116:119], a[24:27], v[72:75]
    v_and_b32 v241, s40, v13
    v_and_b32 v242, s40, v14
    v_mfma_f32_16x16x32_bf16 v[60:63], v[112:115], a[88:91], v[60:63]
    ds_read_b128 v[136:139], v6 offset:2816
    v_mfma_f32_16x16x32_bf16 v[76:79], v[116:119], a[88:91], v[76:79]
    ds_read_b128 v[140:143], v6 offset:2848
    s_waitcnt lgkmcnt(5)
    v_mfma_f32_16x16x32_bf16 v[56:59], v[120:123], a[20:23], v[56:59]
    v_and_b32 v243, s40, v15
    s_waitcnt lgkmcnt(4)
    v_mfma_f32_16x16x32_bf16 v[72:75], v[124:127], a[20:23], v[72:75]
    v_mfma_f32_16x16x32_bf16 v[60:63], v[120:123], a[84:87], v[60:63]
    ds_read_b128 v[144:147], v6 offset:2880
    v_mfma_f32_16x16x32_bf16 v[76:79], v[124:127], a[84:87], v[76:79]
    ds_read_b128 v[148:151], v6 offset:2912
    s_waitcnt lgkmcnt(5)
    v_mfma_f32_16x16x32_bf16 v[56:59], v[128:131], a[16:19], v[56:59]
    s_waitcnt lgkmcnt(4)
    v_mfma_f32_16x16x32_bf16 v[72:75], v[132:135], a[16:19], v[72:75]
    v_mfma_f32_16x16x32_bf16 v[60:63], v[128:131], a[80:83], v[60:63]
    ds_read_b128 v[152:155], v6 offset:2944
    v_mfma_f32_16x16x32_bf16 v[76:79], v[132:135], a[80:83], v[76:79]
    ds_read_b128 v[156:159], v6 offset:2976
    s_waitcnt lgkmcnt(5)
    v_mfma_f32_16x16x32_bf16 v[56:59], v[136:139], a[12:15], v[56:59]
    s_waitcnt lgkmcnt(4)
    v_mfma_f32_16x16x32_bf16 v[72:75], v[140:143], a[12:15], v[72:75]
    v_mfma_f32_16x16x32_bf16 v[60:63], v[136:139], a[76:79], v[60:63]
    ds_read_b128 v[160:163], v6 offset:3008
    v_mfma_f32_16x16x32_bf16 v[76:79], v[140:143], a[76:79], v[76:79]
    ds_read_b128 v[164:167], v6 offset:3040
    s_waitcnt lgkmcnt(5)
    v_mfma_f32_16x16x32_bf16 v[56:59], v[144:147], a[8:11], v[56:59]
    s_waitcnt lgkmcnt(4)
    v_mfma_f32_16x16x32_bf16 v[72:75], v[148:151], a[8:11], v[72:75]
    v_mfma_f32_16x16x32_bf16 v[60:63], v[144:147], a[72:75], v[60:63]
    ds_read_b128 v[168:171], v6 offset:3072
    v_mfma_f32_16x16x32_bf16 v[76:79], v[148:151], a[72:75], v[76:79]
    ds_read_b128 v[172:175], v6 offset:3104
    s_waitcnt lgkmcnt(5)
    v_mfma_f32_16x16x32_bf16 v[56:59], v[152:155], a[4:7], v[56:59]
    ds_read_b128 v[112:115], v6 offset:3136
    s_waitcnt lgkmcnt(5)
    v_mfma_f32_16x16x32_bf16 v[72:75], v[156:159], a[4:7], v[72:75]
    ds_read_b128 v[116:119], v6 offset:3168
    v_mfma_f32_16x16x32_bf16 v[60:63], v[152:155], a[68:71], v[60:63]
    ds_read_b128 v[120:123], v6 offset:3200
    v_mfma_f32_16x16x32_bf16 v[76:79], v[156:159], a[68:71], v[76:79]
    ds_read_b128 v[124:127], v6 offset:3232
    s_waitcnt lgkmcnt(7)
    v_mfma_f32_16x16x32_bf16 v[56:59], v[160:163], a[0:3], v[56:59]
    ds_read_b128 v[128:131], v6 offset:3264
    s_waitcnt lgkmcnt(7)
    v_mfma_f32_16x16x32_bf16 v[72:75], v[164:167], a[0:3], v[72:75]
    ds_read_b128 v[132:135], v6 offset:3296
    v_mfma_f32_16x16x32_bf16 v[60:63], v[160:163], a[64:67], v[60:63]
    ds_read_b128 v[136:139], v6 offset:3328
    v_mfma_f32_16x16x32_bf16 v[76:79], v[164:167], a[64:67], v[76:79]
    ds_read_b128 v[140:143], v6 offset:3360
    s_waitcnt lgkmcnt(9)
    v_mfma_f32_16x16x32_bf16 v[60:63], v[168:171], a[60:63], v[60:63]
    ds_read_b128 v[144:147], v6 offset:3392
    s_waitcnt lgkmcnt(9)
    v_mfma_f32_16x16x32_bf16 v[76:79], v[172:175], a[60:63], v[76:79]
    ds_read_b128 v[148:151], v6 offset:3424
    s_waitcnt lgkmcnt(9)
    v_mfma_f32_16x16x32_bf16 v[60:63], v[112:115], a[56:59], v[60:63]
    ds_read_b128 v[152:155], v6 offset:3456
    s_waitcnt lgkmcnt(9)
    v_mfma_f32_16x16x32_bf16 v[76:79], v[116:119], a[56:59], v[76:79]
    ds_read_b128 v[156:159], v6 offset:3488
    s_waitcnt lgkmcnt(9)
    v_mfma_f32_16x16x32_bf16 v[60:63], v[120:123], a[52:55], v[60:63]
    ds_read_b128 v[160:163], v6 offset:3520
    s_waitcnt lgkmcnt(9)
    v_mfma_f32_16x16x32_bf16 v[76:79], v[124:127], a[52:55], v[76:79]
    ds_read_b128 v[164:167], v6 offset:3552
    s_waitcnt lgkmcnt(9)
    v_mfma_f32_16x16x32_bf16 v[60:63], v[128:131], a[48:51], v[60:63]
    ds_read_b128 v[168:171], v6 offset:3584
    s_waitcnt lgkmcnt(9)
    v_mfma_f32_16x16x32_bf16 v[76:79], v[132:135], a[48:51], v[76:79]
    ds_read_b128 v[172:175], v6 offset:3616
    s_waitcnt lgkmcnt(9)
    v_mfma_f32_16x16x32_bf16 v[60:63], v[136:139], a[44:47], v[60:63]
    ds_read_b128 v[112:115], v6 offset:3648
    s_waitcnt lgkmcnt(9)
    v_mfma_f32_16x16x32_bf16 v[76:79], v[140:143], a[44:47], v[76:79]
    ds_read_b128 v[116:119], v6 offset:3680
    s_waitcnt lgkmcnt(9)
    v_mfma_f32_16x16x32_bf16 v[60:63], v[144:147], a[40:43], v[60:63]
    ds_read_b128 v[120:123], v6 offset:3712
    s_waitcnt lgkmcnt(9)
    v_mfma_f32_16x16x32_bf16 v[76:79], v[148:151], a[40:43], v[76:79]
    ds_read_b128 v[124:127], v6 offset:3744
    s_waitcnt lgkmcnt(9)
    v_mfma_f32_16x16x32_bf16 v[60:63], v[152:155], a[36:39], v[60:63]
    ds_read_b128 v[128:131], v6 offset:3776
    s_waitcnt lgkmcnt(9)
    v_mfma_f32_16x16x32_bf16 v[76:79], v[156:159], a[36:39], v[76:79]
    ds_read_b128 v[132:135], v6 offset:3808
    s_waitcnt lgkmcnt(9)
    v_mfma_f32_16x16x32_bf16 v[60:63], v[160:163], a[32:35], v[60:63]
    ds_read_b128 v[136:139], v6 offset:3840
    s_waitcnt lgkmcnt(9)
    v_mfma_f32_16x16x32_bf16 v[76:79], v[164:167], a[32:35], v[76:79]
    ds_read_b128 v[140:143], v6 offset:3872
    s_waitcnt lgkmcnt(9)
    v_mfma_f32_16x16x32_bf16 v[60:63], v[168:171], a[28:31], v[60:63]
    ds_read_b128 v[144:147], v6 offset:3904
    s_waitcnt lgkmcnt(9)
    v_mfma_f32_16x16x32_bf16 v[76:79], v[172:175], a[28:31], v[76:79]
    ds_read_b128 v[148:151], v6 offset:3936
    s_waitcnt lgkmcnt(9)
    v_mfma_f32_16x16x32_bf16 v[60:63], v[112:115], a[24:27], v[60:63]
    ds_read_b128 v[152:155], v6 offset:3968
    s_waitcnt lgkmcnt(9)
    v_mfma_f32_16x16x32_bf16 v[76:79], v[116:119], a[24:27], v[76:79]
    ds_read_b128 v[156:159], v6 offset:4000
    s_waitcnt lgkmcnt(9)
    v_mfma_f32_16x16x32_bf16 v[60:63], v[120:123], a[20:23], v[60:63]
    ds_read_b128 v[160:163], v6 offset:4032
    s_waitcnt lgkmcnt(9)
    v_mfma_f32_16x16x32_bf16 v[76:79], v[124:127], a[20:23], v[76:79]
    ds_read_b128 v[164:167], v6 offset:4064
    s_waitcnt lgkmcnt(9)
    v_mfma_f32_16x16x32_bf16 v[60:63], v[128:131], a[16:19], v[60:63]
    s_waitcnt vmcnt(2)
    ds_read_b128 a[60:63], v7 offset:240
    s_waitcnt lgkmcnt(9)
    v_mfma_f32_16x16x32_bf16 v[76:79], v[132:135], a[16:19], v[76:79]
    s_waitcnt lgkmcnt(8)
    v_mfma_f32_16x16x32_bf16 v[60:63], v[136:139], a[12:15], v[60:63]
    ds_read_b128 a[124:127], v7 offset:496
    s_waitcnt lgkmcnt(8)
    v_mfma_f32_16x16x32_bf16 v[76:79], v[140:143], a[12:15], v[76:79]
    s_waitcnt lgkmcnt(7)
    v_mfma_f32_16x16x32_bf16 v[60:63], v[144:147], a[8:11], v[60:63]
    ds_read_b128 a[188:191], v7 offset:752
    s_waitcnt lgkmcnt(7)
    v_mfma_f32_16x16x32_bf16 v[76:79], v[148:151], a[8:11], v[76:79]
    s_waitcnt lgkmcnt(6)
    v_mfma_f32_16x16x32_bf16 v[60:63], v[152:155], a[4:7], v[60:63]
    ds_read_b128 a[252:255], v7 offset:1008
    s_waitcnt lgkmcnt(6)
    v_mfma_f32_16x16x32_bf16 v[76:79], v[156:159], a[4:7], v[76:79]
    s_waitcnt lgkmcnt(5)
    v_mfma_f32_16x16x32_bf16 v[60:63], v[160:163], a[0:3], v[60:63]
    ds_read_b128 v[168:171], v6 offset:0
    s_waitcnt lgkmcnt(5)
    v_mfma_f32_16x16x32_bf16 v[76:79], v[164:167], a[0:3], v[76:79]
    ds_read_b128 v[172:175], v6 offset:32
    s_add_u32 s41, s38, 4096
    v_cvt_pk_bf16_f32 v80, v16, v48
    v_cvt_pk_bf16_f32 v81, v17, v49
    v_cvt_pk_bf16_f32 v82, v18, v50
    v_cvt_pk_bf16_f32 v83, v19, v51
    buffer_store_dwordx4 v[80:83], v228, s[8:11], s38 offen offset:0 sc1
    v_cvt_pk_bf16_f32 v84, v32, v64
    v_cvt_pk_bf16_f32 v85, v33, v65
    v_cvt_pk_bf16_f32 v86, v34, v66
    v_cvt_pk_bf16_f32 v87, v35, v67
    buffer_store_dwordx4 v[84:87], v228, s[8:11], s38 offen offset:64 sc1
    v_cvt_pk_bf16_f32 v88, v20, v52
    v_cvt_pk_bf16_f32 v89, v21, v53
    v_cvt_pk_bf16_f32 v90, v22, v54
    v_cvt_pk_bf16_f32 v91, v23, v55
    buffer_store_dwordx4 v[88:91], v228, s[8:11], s38 offen offset:2048 sc1
    v_cvt_pk_bf16_f32 v92, v36, v68
    v_cvt_pk_bf16_f32 v93, v37, v69
    v_cvt_pk_bf16_f32 v94, v38, v70
    v_cvt_pk_bf16_f32 v95, v39, v71
    buffer_store_dwordx4 v[92:95], v228, s[8:11], s38 offen offset:2112 sc1
    v_cvt_pk_bf16_f32 v96, v24, v56
    v_cvt_pk_bf16_f32 v97, v25, v57
    v_cvt_pk_bf16_f32 v98, v26, v58
    v_cvt_pk_bf16_f32 v99, v27, v59
    buffer_store_dwordx4 v[96:99], v228, s[8:11], s41 offen offset:0 sc1
    v_cvt_pk_bf16_f32 v100, v40, v72
    v_cvt_pk_bf16_f32 v101, v41, v73
    v_cvt_pk_bf16_f32 v102, v42, v74
    v_cvt_pk_bf16_f32 v103, v43, v75
    buffer_store_dwordx4 v[100:103], v228, s[8:11], s41 offen offset:64 sc1
    v_cvt_pk_bf16_f32 v104, v28, v60
    v_cvt_pk_bf16_f32 v105, v29, v61
    v_cvt_pk_bf16_f32 v106, v30, v62
    v_cvt_pk_bf16_f32 v107, v31, v63
    buffer_store_dwordx4 v[104:107], v228, s[8:11], s41 offen offset:2048 sc1
    v_cvt_pk_bf16_f32 v108, v44, v76
    v_cvt_pk_bf16_f32 v109, v45, v77
    v_cvt_pk_bf16_f32 v110, v46, v78
    v_cvt_pk_bf16_f32 v111, v47, v79
    buffer_store_dwordx4 v[108:111], v228, s[8:11], s41 offen offset:2112 sc1
    s_add_u32 s38, s38, 8192
    s_add_u32 s42, s42, 1
    s_cmp_lt_u32 s42, 4
    s_cbranch_scc1 .cvl_471

    s_waitcnt vmcnt(0) lgkmcnt(0)
    s_barrier
    s_mov_b32 s5, 160
    s_cmp_lg_u32 s24, 0
    s_cbranch_scc1 .sg_472
    s_mov_b64 exec, 1
    v_mov_b32 v4, 1
    v_mov_b32 v5, 0
    buffer_atomic_add v4, v5, s[20:23], s5 offen sc1
    s_mov_b64 exec, -1

.sg_472:
    v_and_b32 v1, 63, v0
    v_and_b32 v2, 15, v1
    v_lshrrev_b32 v3, 4, v1

    s_sub_u32 s4, s26, 24
    s_lshr_b32 s25, s4, 1
    s_and_b32 s4, s4, 1
    s_lshl_b32 s4, s4, 2
    s_lshl_b32 s5, s91, 3
    s_add_u32 s4, s4, s5
    s_add_u32 s26, s4, s24
    s_lshl_b32 s35, s26, 8
    s_add_u32 s35, s35, 92274688
    s_mov_b32 s37, 0x3db504f3
    s_mov_b32 s38, 0x3fb8aa3b
    v_lshlrev_b32 v8, 4, v1
    v_min_u32 v9, 2, v1
    v_lshlrev_b32 v9, 13, v9
    v_lshlrev_b32 v6, 4, v3
    v_and_b32 v5, 7, v2
    v_add_u32 v10, v6, v5
    v_lshlrev_b32 v10, 4, v10
    v_lshlrev_b32 v11, 4, v2
    v_lshlrev_b32 v5, 3, v3
    v_add_u32 v11, v11, v5
    v_cmp_gt_u32 s[60:61], 32, v1
    v_lshlrev_b32 v5, 2, v3
    v_mov_b32 v12, 0
    v_mov_b32 v13, 0
    v_mov_b32 v14, 0xff800000
    v_lshlrev_b32 v204, 9, v1
    v_add_u32 v204, 4604, v204
    s_lshl_b32 s4, s25, 5
    s_add_u32 s4, s4, s26
    s_lshl_b32 s27, s4, 13
    s_mul_i32 s33, s4, 6144
    s_add_u32 s33, s33, 67108864
    s_add_u32 s36, s25, 1

    v_add_u32 v7, 0, v5
    v_cmp_le_u32 s[40:41], v7, v2
    v_add_u32 v7, 1, v5
    v_cmp_le_u32 s[42:43], v7, v2
    v_add_u32 v7, 2, v5
    v_cmp_le_u32 s[44:45], v7, v2
    v_add_u32 v7, 3, v5
    v_cmp_le_u32 s[46:47], v7, v2
    v_mov_b32 v112, 0
    v_mov_b32 v113, 0
    v_mov_b32 v114, 0
    v_mov_b32 v115, 0
    v_mov_b32 v116, 0
    v_mov_b32 v117, 0
    v_mov_b32 v118, 0
    v_mov_b32 v119, 0
    v_mov_b32 v120, 0
    v_mov_b32 v121, 0
    v_mov_b32 v122, 0
    v_mov_b32 v123, 0
    v_mov_b32 v124, 0
    v_mov_b32 v125, 0
    v_mov_b32 v126, 0
    v_mov_b32 v127, 0
    v_mov_b32 v128, 0
    v_mov_b32 v129, 0
    v_mov_b32 v130, 0
    v_mov_b32 v131, 0
    v_mov_b32 v132, 0
    v_mov_b32 v133, 0
    v_mov_b32 v134, 0
    v_mov_b32 v135, 0
    v_mov_b32 v136, 0
    v_mov_b32 v137, 0
    v_mov_b32 v138, 0
    v_mov_b32 v139, 0
    v_mov_b32 v140, 0
    v_mov_b32 v141, 0
    v_mov_b32 v142, 0
    v_mov_b32 v143, 0
    s_bitcmp1_b32 s97, 4
    s_cselect_b32 s96, 999, 64
    v_mov_b32 v15, -1
    s_mov_b32 s62, 0
    s_mov_b64 exec, 7
.wf_473:
    buffer_load_dword v15, v9, s[8:11], s35 offen sc1
    s_waitcnt vmcnt(0)
    v_cmp_gt_u32 vcc, s36, v15
    s_cbranch_vccz .wfd_474
    s_sleep 2
    s_add_u32 s62, s62, 1
    s_cmp_gt_u32 s62, 0x400000
    s_cbranch_scc1 .mg_end_1
    s_branch .wf_473

.wfd_474:
    s_mov_b64 exec, -1
    s_add_u32 s28, s27, 4096
    s_add_u32 s29, s27, 16777216
    s_add_u32 s30, s27, 16781312
    s_add_u32 s31, s27, 33554432
    s_add_u32 s32, s27, 33558528

    buffer_load_dwordx4 a[0:3], v8, s[8:11], s27 offen offset:0
    buffer_load_dwordx4 a[16:19], v8, s[8:11], s28 offen offset:0
    buffer_load_dwordx4 a[32:35], v8, s[8:11], s29 offen offset:0
    buffer_load_dwordx4 a[48:51], v8, s[8:11], s30 offen offset:0
    buffer_load_dwordx4 a[4:7], v8, s[8:11], s27 offen offset:1024
    buffer_load_dwordx4 a[20:23], v8, s[8:11], s28 offen offset:1024
    buffer_load_dwordx4 a[36:39], v8, s[8:11], s29 offen offset:1024
    buffer_load_dwordx4 a[52:55], v8, s[8:11], s30 offen offset:1024
    buffer_load_dwordx4 a[8:11], v8, s[8:11], s27 offen offset:2048
    buffer_load_dwordx4 a[24:27], v8, s[8:11], s28 offen offset:2048
    buffer_load_dwordx4 a[40:43], v8, s[8:11], s29 offen offset:2048
    buffer_load_dwordx4 a[56:59], v8, s[8:11], s30 offen offset:2048
    buffer_load_dwordx4 a[12:15], v8, s[8:11], s27 offen offset:3072
    buffer_load_dwordx4 a[28:31], v8, s[8:11], s28 offen offset:3072
    buffer_load_dwordx4 a[44:47], v8, s[8:11], s29 offen offset:3072
    buffer_load_dwordx4 a[60:63], v8, s[8:11], s30 offen offset:3072
    buffer_load_dwordx4 a[64:67], v8, s[8:11], s31 offen offset:0
    buffer_load_dwordx4 a[68:71], v8, s[8:11], s31 offen offset:1024
    buffer_load_dwordx4 a[72:75], v8, s[8:11], s31 offen offset:2048
    buffer_load_dwordx4 a[76:79], v8, s[8:11], s31 offen offset:3072
    buffer_load_dwordx4 a[80:83], v8, s[8:11], s32 offen offset:0
    buffer_load_dwordx4 a[84:87], v8, s[8:11], s32 offen offset:1024
    buffer_load_dwordx4 a[88:91], v8, s[8:11], s32 offen offset:2048
    buffer_load_dwordx4 a[92:95], v8, s[8:11], s32 offen offset:3072
    buffer_load_dwordx4 v[80:83], v10, s[8:11], s33 offen offset:2048 sc1
    buffer_load_dwordx4 v[84:87], v10, s[8:11], s33 offen offset:2176 sc1
    buffer_load_dwordx4 v[88:91], v10, s[8:11], s33 offen offset:3072 sc1
    buffer_load_dwordx4 v[92:95], v10, s[8:11], s33 offen offset:3200 sc1
    s_add_u32 s4, s33, 4096
    s_mov_b64 exec, s[60:61]
    buffer_load_dwordx2 v[128:129], v11, s[8:11], s4 offen offset:0 sc1
    buffer_load_dwordx2 v[130:131], v11, s[8:11], s4 offen offset:256 sc1
    buffer_load_dwordx2 v[132:133], v11, s[8:11], s4 offen offset:512 sc1
    buffer_load_dwordx2 v[134:135], v11, s[8:11], s4 offen offset:768 sc1
    buffer_load_dwordx2 v[136:137], v11, s[8:11], s4 offen offset:1024 sc1
    buffer_load_dwordx2 v[138:139], v11, s[8:11], s4 offen offset:1280 sc1
    buffer_load_dwordx2 v[140:141], v11, s[8:11], s4 offen offset:1536 sc1
    buffer_load_dwordx2 v[142:143], v11, s[8:11], s4 offen offset:1792 sc1
    s_mov_b64 exec, -1
    s_waitcnt vmcnt(0)
.att_475:
    s_mov_b32 s34, s33
    s_add_u32 s50, s27, 0
    s_add_u32 s51, s27, 4096
    s_cmp_lt_u32 s25, 60
    s_cselect_b32 s4, 4, 0
    s_cselect_b32 s5, 1048576, 0
    s_cselect_b32 s6, 786432, 0

    s_add_u32 s36, s36, s4
    s_add_u32 s27, s27, s5
    s_add_u32 s33, s33, s6
    s_waitcnt vmcnt(8)

    v_cmp_gt_u32 vcc, s36, v15
    s_cbranch_vccnz .atw_479
.atb_480:
    s_add_u32 s28, s27, 4096
    s_add_u32 s29, s27, 16777216
    s_add_u32 s30, s27, 16781312
    s_add_u32 s31, s27, 33554432
    s_add_u32 s32, s27, 33558528

    buffer_load_dwordx4 a[96:99], v8, s[8:11], s27 offen offset:0
    buffer_load_dwordx4 a[112:115], v8, s[8:11], s28 offen offset:0
    buffer_load_dwordx4 a[128:131], v8, s[8:11], s29 offen offset:0
    buffer_load_dwordx4 a[144:147], v8, s[8:11], s30 offen offset:0
    buffer_load_dwordx4 a[100:103], v8, s[8:11], s27 offen offset:1024
    buffer_load_dwordx4 a[116:119], v8, s[8:11], s28 offen offset:1024
    buffer_load_dwordx4 a[132:135], v8, s[8:11], s29 offen offset:1024
    buffer_load_dwordx4 a[148:151], v8, s[8:11], s30 offen offset:1024
    buffer_load_dwordx4 a[104:107], v8, s[8:11], s27 offen offset:2048
    buffer_load_dwordx4 a[120:123], v8, s[8:11], s28 offen offset:2048
    buffer_load_dwordx4 a[136:139], v8, s[8:11], s29 offen offset:2048
    buffer_load_dwordx4 a[152:155], v8, s[8:11], s30 offen offset:2048
    buffer_load_dwordx4 a[108:111], v8, s[8:11], s27 offen offset:3072
    buffer_load_dwordx4 a[124:127], v8, s[8:11], s28 offen offset:3072
    buffer_load_dwordx4 a[140:143], v8, s[8:11], s29 offen offset:3072
    buffer_load_dwordx4 a[156:159], v8, s[8:11], s30 offen offset:3072
    buffer_load_dwordx4 a[160:163], v8, s[8:11], s31 offen offset:0
    buffer_load_dwordx4 a[164:167], v8, s[8:11], s31 offen offset:1024
    buffer_load_dwordx4 a[168:171], v8, s[8:11], s31 offen offset:2048
    buffer_load_dwordx4 a[172:175], v8, s[8:11], s31 offen offset:3072
    buffer_load_dwordx4 a[176:179], v8, s[8:11], s32 offen offset:0
    buffer_load_dwordx4 a[180:183], v8, s[8:11], s32 offen offset:1024
    buffer_load_dwordx4 a[184:187], v8, s[8:11], s32 offen offset:2048
    buffer_load_dwordx4 a[188:191], v8, s[8:11], s32 offen offset:3072
    buffer_load_dwordx4 v[96:99], v10, s[8:11], s33 offen offset:2048 sc1
    buffer_load_dwordx4 v[100:103], v10, s[8:11], s33 offen offset:2176 sc1
    buffer_load_dwordx4 v[104:107], v10, s[8:11], s33 offen offset:3072 sc1
    buffer_load_dwordx4 v[108:111], v10, s[8:11], s33 offen offset:3200 sc1
    s_add_u32 s4, s33, 4096
    s_mov_b64 exec, s[60:61]
    buffer_load_dwordx2 v[112:113], v11, s[8:11], s4 offen offset:0 sc1
    buffer_load_dwordx2 v[114:115], v11, s[8:11], s4 offen offset:256 sc1
    buffer_load_dwordx2 v[116:117], v11, s[8:11], s4 offen offset:512 sc1
    buffer_load_dwordx2 v[118:119], v11, s[8:11], s4 offen offset:768 sc1
    buffer_load_dwordx2 v[120:121], v11, s[8:11], s4 offen offset:1024 sc1
    buffer_load_dwordx2 v[122:123], v11, s[8:11], s4 offen offset:1280 sc1
    buffer_load_dwordx2 v[124:125], v11, s[8:11], s4 offen offset:1536 sc1
    buffer_load_dwordx2 v[126:127], v11, s[8:11], s4 offen offset:1792 sc1
    s_mov_b64 exec, -1
    v_mfma_f32_16x16x32_bf16 v[144:147], a[32:35], a[0:3], 0
    v_mfma_f32_16x16x32_bf16 v[156:159], a[32:35], a[16:19], 0
    v_mfma_f32_16x16x32_bf16 v[160:163], a[48:51], a[16:19], 0
    v_mfma_f32_16x16x32_bf16 v[144:147], a[36:39], a[4:7], v[144:147]
    v_mfma_f32_16x16x32_bf16 v[156:159], a[36:39], a[20:23], v[156:159]
    v_mfma_f32_16x16x32_bf16 v[160:163], a[52:55], a[20:23], v[160:163]
    v_mfma_f32_16x16x32_bf16 v[144:147], a[40:43], a[8:11], v[144:147]
    v_mfma_f32_16x16x32_bf16 v[156:159], a[40:43], a[24:27], v[156:159]
    v_mfma_f32_16x16x32_bf16 v[160:163], a[56:59], a[24:27], v[160:163]
    v_mfma_f32_16x16x32_bf16 v[144:147], a[44:47], a[12:15], v[144:147]
    v_mfma_f32_16x16x32_bf16 v[156:159], a[44:47], a[28:31], v[156:159]
    v_mfma_f32_16x16x32_bf16 v[160:163], a[60:63], a[28:31], v[160:163]
    s_nop 7
    v_cvt_pk_bf16_f32 v168, v144, v145
    v_cvt_pk_bf16_f32 v170, v146, v147
    v_and_b32 v169, 0xffff0000, v168
    v_lshlrev_b32 v168, 16, v168
    v_and_b32 v171, 0xffff0000, v170
    v_lshlrev_b32 v170, 16, v170
    v_mul_f32 v168, s37, v168
    v_mul_f32 v169, s37, v169
    v_mul_f32 v170, s37, v170
    v_mul_f32 v171, s37, v171
    v_cvt_pk_bf16_f32 v144, v168, v169
    v_cvt_pk_bf16_f32 v146, v170, v171
    v_and_b32 v145, 0xffff0000, v144
    v_lshlrev_b32 v144, 16, v144
    v_and_b32 v147, 0xffff0000, v146
    v_lshlrev_b32 v146, 16, v146
    v_cvt_pk_bf16_f32 v192, v156, v157
    v_cvt_pk_bf16_f32 v194, v158, v159
    v_cvt_pk_bf16_f32 v196, v160, v161
    v_cvt_pk_bf16_f32 v198, v162, v163
    v_and_b32 v193, 0xffff0000, v192
    v_lshlrev_b32 v192, 16, v192
    v_and_b32 v195, 0xffff0000, v194
    v_lshlrev_b32 v194, 16, v194
    v_and_b32 v197, 0xffff0000, v196
    v_lshlrev_b32 v196, 16, v196
    v_and_b32 v199, 0xffff0000, v198
    v_lshlrev_b32 v198, 16, v198
    v_mul_f32 v192, s37, v192
    v_mul_f32 v193, s37, v193
    v_mul_f32 v194, s37, v194
    v_mul_f32 v195, s37, v195
    v_mul_f32 v196, s37, v196
    v_mul_f32 v197, s37, v197
    v_mul_f32 v198, s37, v198
    v_mul_f32 v199, s37, v199
    v_cvt_pk_bf16_f32 v156, v192, v193
    v_cvt_pk_bf16_f32 v158, v194, v195
    v_cvt_pk_bf16_f32 v160, v196, v197
    v_cvt_pk_bf16_f32 v162, v198, v199
    v_and_b32 v157, 0xffff0000, v156
    v_lshlrev_b32 v156, 16, v156
    v_and_b32 v159, 0xffff0000, v158
    v_lshlrev_b32 v158, 16, v158
    v_and_b32 v161, 0xffff0000, v160
    v_lshlrev_b32 v160, 16, v160
    v_and_b32 v163, 0xffff0000, v162
    v_lshlrev_b32 v162, 16, v162
    v_cndmask_b32 v144, v14, v144, s[40:41]
    v_cndmask_b32 v145, v14, v145, s[42:43]
    v_cndmask_b32 v146, v14, v146, s[44:45]
    v_cndmask_b32 v147, v14, v147, s[46:47]
    v_cndmask_b32 v160, v14, v160, s[40:41]
    v_cndmask_b32 v161, v14, v161, s[42:43]
    v_cndmask_b32 v162, v14, v162, s[44:45]
    v_cndmask_b32 v163, v14, v163, s[46:47]
    s_mov_b32 s62, 0
.kmp_481:
    v_max3_u32 v4, v80, v81, v82
    v_max3_u32 v5, v83, v84, v85
    v_max3_u32 v4, v4, v86, v87
    v_max3_u32 v5, v5, v88, v89
    v_max3_u32 v4, v4, v90, v91
    v_max3_u32 v5, v5, v92, v93
    v_max3_u32 v4, v4, v94, v95
    v_max3_u32 v5, v5, v128, v129
    v_max3_u32 v4, v4, v130, v131
    v_max3_u32 v5, v5, v132, v133
    v_max3_u32 v4, v4, v134, v135
    v_max3_u32 v5, v5, v136, v137
    v_max3_u32 v4, v4, v138, v139
    v_max3_u32 v5, v5, v140, v141
    v_max3_u32 v4, v4, v142, v143
    v_max_u32 v4, v4, v5
    v_cmp_eq_u32 vcc, -1, v4
    s_cbranch_vccnz .kmf_482

    v_mfma_f32_16x16x32_bf16 v[152:155], v[80:83], a[0:3], 0
    v_mfma_f32_16x16x32_bf16 v[164:167], v[80:83], a[16:19], 0
    v_mfma_f32_16x16x32_bf16 v[152:155], v[84:87], a[4:7], v[152:155]
    v_mfma_f32_16x16x32_bf16 v[164:167], v[84:87], a[20:23], v[164:167]
    v_mfma_f32_16x16x32_bf16 v[152:155], v[88:91], a[8:11], v[152:155]
    v_mfma_f32_16x16x32_bf16 v[164:167], v[88:91], a[24:27], v[164:167]
    v_mfma_f32_16x16x32_bf16 v[152:155], v[92:95], a[12:15], v[152:155]
    v_mfma_f32_16x16x32_bf16 v[164:167], v[92:95], a[28:31], v[164:167]
    s_nop 5
    v_cvt_pk_bf16_f32 v176, v152, v153
    v_cvt_pk_bf16_f32 v178, v154, v155
    v_and_b32 v177, 0xffff0000, v176
    v_lshlrev_b32 v176, 16, v176
    v_and_b32 v179, 0xffff0000, v178
    v_lshlrev_b32 v178, 16, v178
    v_mul_f32 v176, s37, v176
    v_mul_f32 v177, s37, v177
    v_mul_f32 v178, s37, v178
    v_mul_f32 v179, s37, v179
    v_cvt_pk_bf16_f32 v152, v176, v177
    v_cvt_pk_bf16_f32 v154, v178, v179
    v_and_b32 v153, 0xffff0000, v152
    v_lshlrev_b32 v152, 16, v152
    v_and_b32 v155, 0xffff0000, v154
    v_lshlrev_b32 v154, 16, v154
    v_cndmask_b32 v152, v14, v152, s[60:61]
    v_cndmask_b32 v153, v14, v153, s[60:61]
    v_cndmask_b32 v154, v14, v154, s[60:61]
    v_cndmask_b32 v155, v14, v155, s[60:61]
    v_cvt_pk_bf16_f32 v200, v164, v165
    v_cvt_pk_bf16_f32 v202, v166, v167
    v_and_b32 v201, 0xffff0000, v200
    v_lshlrev_b32 v200, 16, v200
    v_and_b32 v203, 0xffff0000, v202
    v_lshlrev_b32 v202, 16, v202
    v_mul_f32 v200, s37, v200
    v_mul_f32 v201, s37, v201
    v_mul_f32 v202, s37, v202
    v_mul_f32 v203, s37, v203
    v_cvt_pk_bf16_f32 v164, v200, v201
    v_cvt_pk_bf16_f32 v166, v202, v203
    v_and_b32 v165, 0xffff0000, v164
    v_lshlrev_b32 v164, 16, v164
    v_and_b32 v167, 0xffff0000, v166
    v_lshlrev_b32 v166, 16, v166
    v_cndmask_b32 v164, v14, v164, s[60:61]
    v_cndmask_b32 v165, v14, v165, s[60:61]
    v_cndmask_b32 v166, v14, v166, s[60:61]
    v_cndmask_b32 v167, v14, v167, s[60:61]
    v_max3_f32 v4, v144, v145, v146
    v_max3_f32 v5, v147, v152, v153
    v_max3_f32 v4, v4, v154, v155
    v_max_f32 v4, v4, v5

    v_max3_f32 v6, v156, v157, v158
    v_max3_f32 v7, v159, v160, v161
    v_max3_f32 v6, v6, v162, v163
    v_max3_f32 v7, v7, v164, v165
    v_max3_f32 v6, v6, v166, v167
    v_max_f32 v6, v6, v7

    v_mov_b32 v5, v4
    v_mov_b32 v7, v6
    s_nop 0
    v_permlane32_swap_b32 v4, v5
    v_permlane32_swap_b32 v6, v7
    v_max_f32 v4, v4, v5
    v_max_f32 v6, v6, v7

    v_mov_b32 v5, v4
    v_mov_b32 v7, v6
    s_nop 0
    v_permlane16_swap_b32 v4, v5
    v_permlane16_swap_b32 v6, v7
    v_max_f32 v4, v4, v5
    v_max_f32 v6, v6, v7

    v_mul_f32 v4, s38, v4
    v_mul_f32 v6, s38, v6
    v_fma_f32 v168, v144, s38, -v4
    v_fma_f32 v169, v145, s38, -v4
    v_fma_f32 v170, v146, s38, -v4
    v_fma_f32 v171, v147, s38, -v4
    v_fma_f32 v176, v152, s38, -v4
    v_fma_f32 v177, v153, s38, -v4
    v_fma_f32 v178, v154, s38, -v4
    v_fma_f32 v179, v155, s38, -v4
    v_fma_f32 v192, v156, s38, -v6
    v_fma_f32 v193, v157, s38, -v6
    v_fma_f32 v194, v158, s38, -v6
    v_fma_f32 v195, v159, s38, -v6
    v_fma_f32 v196, v160, s38, -v6
    v_fma_f32 v197, v161, s38, -v6
    v_fma_f32 v198, v162, s38, -v6
    v_fma_f32 v199, v163, s38, -v6
    v_fma_f32 v200, v164, s38, -v6
    v_fma_f32 v201, v165, s38, -v6
    v_fma_f32 v202, v166, s38, -v6
    v_fma_f32 v203, v167, s38, -v6
    v_exp_f32 v168, v168
    v_exp_f32 v169, v169
    v_exp_f32 v170, v170
    v_exp_f32 v171, v171
    v_exp_f32 v176, v176
    v_exp_f32 v177, v177
    v_exp_f32 v178, v178
    v_exp_f32 v179, v179
    v_exp_f32 v192, v192
    v_exp_f32 v193, v193
    v_exp_f32 v194, v194
    v_exp_f32 v195, v195
    v_exp_f32 v196, v196
    v_exp_f32 v197, v197
    v_exp_f32 v198, v198
    v_exp_f32 v199, v199
    v_exp_f32 v200, v200
    v_exp_f32 v201, v201
    v_exp_f32 v202, v202
    v_exp_f32 v203, v203
    v_add_f32 v4, v168, v169
    v_add_f32 v5, v170, v171
    v_add_f32 v4, v4, v176
    v_add_f32 v5, v5, v177
    v_add_f32 v4, v4, v178
    v_add_f32 v5, v5, v179
    v_add_f32 v4, v4, v5
    v_add_f32 v6, v192, v193
    v_add_f32 v7, v194, v195
    v_add_f32 v6, v6, v196
    v_add_f32 v7, v7, v197
    v_add_f32 v6, v6, v198
    v_add_f32 v7, v7, v199
    v_add_f32 v6, v6, v200
    v_add_f32 v7, v7, v201
    v_add_f32 v6, v6, v202
    v_add_f32 v7, v7, v203
    v_add_f32 v6, v6, v7
    v_mov_b32 v5, v4
    v_mov_b32 v7, v6
    s_nop 0
    v_permlane32_swap_b32 v4, v5
    v_permlane32_swap_b32 v6, v7
    v_add_f32 v4, v4, v5
    v_add_f32 v6, v6, v7

    v_mov_b32 v5, v4
    v_mov_b32 v7, v6
    s_nop 0
    v_permlane16_swap_b32 v4, v5
    v_permlane16_swap_b32 v6, v7
    v_add_f32 v4, v4, v5
    v_add_f32 v6, v6, v7

    v_rcp_f32 v4, v4
    v_rcp_f32 v6, v6
    v_mov_b32 v182, 0
    v_mov_b32 v183, 0
    v_mul_f32 v168, v4, v168
    v_mul_f32 v169, v4, v169
    v_mul_f32 v170, v4, v170
    v_mul_f32 v171, v4, v171
    v_mul_f32 v176, v4, v176
    v_mul_f32 v177, v4, v177
    v_mul_f32 v178, v4, v178
    v_mul_f32 v179, v4, v179
    v_cvt_pk_bf16_f32 v180, v168, v169
    v_cvt_pk_bf16_f32 v181, v170, v171
    v_cvt_pk_bf16_f32 v184, v176, v177
    v_cvt_pk_bf16_f32 v185, v178, v179
    v_mul_f32 v192, v6, v192
    v_mul_f32 v193, v6, v193
    v_mul_f32 v194, v6, v194
    v_mul_f32 v195, v6, v195
    v_mul_f32 v196, v6, v196
    v_mul_f32 v197, v6, v197
    v_mul_f32 v198, v6, v198
    v_mul_f32 v199, v6, v199
    v_mul_f32 v200, v6, v200
    v_mul_f32 v201, v6, v201
    v_mul_f32 v202, v6, v202
    v_mul_f32 v203, v6, v203
    v_cvt_pk_bf16_f32 v186, v192, v193
    v_cvt_pk_bf16_f32 v187, v194, v195
    v_cvt_pk_bf16_f32 v188, v196, v197
    v_cvt_pk_bf16_f32 v189, v198, v199
    v_cvt_pk_bf16_f32 v190, v200, v201
    v_cvt_pk_bf16_f32 v191, v202, v203
    s_add_u32 s25, s25, 4

    v_mfma_f32_16x16x32_bf16 v[16:19], a[64:67], v[180:183], 0
    v_mfma_f32_16x16x32_bf16 v[20:23], a[68:71], v[180:183], 0
    v_mfma_f32_16x16x32_bf16 v[24:27], a[72:75], v[180:183], 0
    v_mfma_f32_16x16x32_bf16 v[28:31], a[76:79], v[180:183], 0
    v_mfma_f32_16x16x32_bf16 v[32:35], a[80:83], v[180:183], 0
    v_mfma_f32_16x16x32_bf16 v[36:39], a[84:87], v[180:183], 0
    v_mfma_f32_16x16x32_bf16 v[40:43], a[88:91], v[180:183], 0
    v_mfma_f32_16x16x32_bf16 v[44:47], a[92:95], v[180:183], 0
    v_mfma_f32_16x16x32_bf16 v[48:51], a[64:67], v[186:189], 0
    v_mfma_f32_16x16x32_bf16 v[52:55], a[68:71], v[186:189], 0
    v_mfma_f32_16x16x32_bf16 v[56:59], a[72:75], v[186:189], 0
    v_mfma_f32_16x16x32_bf16 v[60:63], a[76:79], v[186:189], 0
    v_mfma_f32_16x16x32_bf16 v[64:67], a[80:83], v[186:189], 0
    v_mfma_f32_16x16x32_bf16 v[68:71], a[84:87], v[186:189], 0
    v_mfma_f32_16x16x32_bf16 v[72:75], a[88:91], v[186:189], 0
    v_mfma_f32_16x16x32_bf16 v[76:79], a[92:95], v[186:189], 0
    s_waitcnt vmcnt(36)
    s_bitcmp1_b32 s97, 4
    s_mov_b64 exec, 1
    s_cbranch_scc1 .fs_483
    buffer_store_dword v12, v13, s[8:11], s92 offen
.fj_484:
    s_mov_b64 exec, -1
    s_cmp_lt_u32 s25, s96
    s_cbranch_scc1 .os_485
    v_mfma_f32_16x16x16_bf16 v[16:19], v[128:129], v[184:185], v[16:19]
    v_mfma_f32_16x16x16_bf16 v[20:23], v[130:131], v[184:185], v[20:23]
    v_add_u32 v12, 1, v12
    v_mfma_f32_16x16x16_bf16 v[24:27], v[132:133], v[184:185], v[24:27]
    v_mfma_f32_16x16x16_bf16 v[28:31], v[134:135], v[184:185], v[28:31]
    v_mfma_f32_16x16x16_bf16 v[32:35], v[136:137], v[184:185], v[32:35]
    v_mfma_f32_16x16x16_bf16 v[36:39], v[138:139], v[184:185], v[36:39]
    v_cvt_pk_bf16_f32 v208, v16, v17
    v_cvt_pk_bf16_f32 v209, v18, v19
    v_cvt_pk_bf16_f32 v210, v20, v21
    v_cvt_pk_bf16_f32 v211, v22, v23
    buffer_store_dwordx4 v[208:211], v8, s[8:11], s50 offen offset:0
    v_mfma_f32_16x16x16_bf16 v[40:43], v[140:141], v[184:185], v[40:43]
    v_mfma_f32_16x16x16_bf16 v[44:47], v[142:143], v[184:185], v[44:47]
    v_cvt_pk_bf16_f32 v212, v24, v25
    v_cvt_pk_bf16_f32 v213, v26, v27
    v_cvt_pk_bf16_f32 v214, v28, v29
    v_cvt_pk_bf16_f32 v215, v30, v31
    buffer_store_dwordx4 v[212:215], v8, s[8:11], s50 offen offset:1024
    v_mfma_f32_16x16x16_bf16 v[48:51], v[128:129], v[190:191], v[48:51]
    v_mfma_f32_16x16x16_bf16 v[52:55], v[130:131], v[190:191], v[52:55]
    v_cvt_pk_bf16_f32 v216, v32, v33
    v_cvt_pk_bf16_f32 v217, v34, v35
    v_cvt_pk_bf16_f32 v218, v36, v37
    v_cvt_pk_bf16_f32 v219, v38, v39
    buffer_store_dwordx4 v[216:219], v8, s[8:11], s50 offen offset:2048
    v_mfma_f32_16x16x16_bf16 v[56:59], v[132:133], v[190:191], v[56:59]
    v_mfma_f32_16x16x16_bf16 v[60:63], v[134:135], v[190:191], v[60:63]
    v_cvt_pk_bf16_f32 v220, v40, v41
    v_cvt_pk_bf16_f32 v221, v42, v43
    v_cvt_pk_bf16_f32 v222, v44, v45
    v_cvt_pk_bf16_f32 v223, v46, v47
    buffer_store_dwordx4 v[220:223], v8, s[8:11], s50 offen offset:3072
    v_mfma_f32_16x16x16_bf16 v[64:67], v[136:137], v[190:191], v[64:67]
    v_mfma_f32_16x16x16_bf16 v[68:71], v[138:139], v[190:191], v[68:71]
    v_cvt_pk_bf16_f32 v224, v48, v49
    v_cvt_pk_bf16_f32 v225, v50, v51
    v_cvt_pk_bf16_f32 v226, v52, v53
    v_cvt_pk_bf16_f32 v227, v54, v55
    buffer_store_dwordx4 v[224:227], v8, s[8:11], s51 offen offset:0
    v_mfma_f32_16x16x16_bf16 v[72:75], v[140:141], v[190:191], v[72:75]
    v_mfma_f32_16x16x16_bf16 v[76:79], v[142:143], v[190:191], v[76:79]
    v_cvt_pk_bf16_f32 v228, v56, v57
    v_cvt_pk_bf16_f32 v229, v58, v59
    v_cvt_pk_bf16_f32 v230, v60, v61
    v_cvt_pk_bf16_f32 v231, v62, v63
    buffer_store_dwordx4 v[228:231], v8, s[8:11], s51 offen offset:1024
    s_nop 3
    v_cvt_pk_bf16_f32 v232, v64, v65
    v_cvt_pk_bf16_f32 v233, v66, v67
    v_cvt_pk_bf16_f32 v234, v68, v69
    v_cvt_pk_bf16_f32 v235, v70, v71
    buffer_store_dwordx4 v[232:235], v8, s[8:11], s51 offen offset:2048
    v_cvt_pk_bf16_f32 v236, v72, v73
    v_cvt_pk_bf16_f32 v237, v74, v75
    v_cvt_pk_bf16_f32 v238, v76, v77
    v_cvt_pk_bf16_f32 v239, v78, v79
    buffer_store_dwordx4 v[236:239], v8, s[8:11], s51 offen offset:3072
.oj_486:
    s_cmp_eq_u32 s25, 63
    s_cbranch_scc1 .ah1_477
    s_mov_b32 s34, s33
    s_add_u32 s50, s27, 0
    s_add_u32 s51, s27, 4096
    s_cmp_lt_u32 s25, 60
    s_cselect_b32 s4, 4, 0
    s_cselect_b32 s5, 1048576, 0
    s_cselect_b32 s6, 786432, 0

    s_cmp_eq_u32 s25, 60
    s_cselect_b32 s4, 3, s4
    s_cselect_b32 s5, 786432, s5
    s_cselect_b32 s6, 589824, s6

    s_add_u32 s36, s36, s4
    s_add_u32 s27, s27, s5
    s_add_u32 s33, s33, s6
    s_waitcnt vmcnt(8)

    v_cmp_gt_u32 vcc, s36, v15
    s_cbranch_vccnz .atw_487
.atb_488:
    s_add_u32 s28, s27, 4096
    s_add_u32 s29, s27, 16777216
    s_add_u32 s30, s27, 16781312
    s_add_u32 s31, s27, 33554432
    s_add_u32 s32, s27, 33558528

    buffer_load_dwordx4 a[0:3], v8, s[8:11], s27 offen offset:0
    buffer_load_dwordx4 a[16:19], v8, s[8:11], s28 offen offset:0
    buffer_load_dwordx4 a[32:35], v8, s[8:11], s29 offen offset:0
    buffer_load_dwordx4 a[48:51], v8, s[8:11], s30 offen offset:0
    buffer_load_dwordx4 a[4:7], v8, s[8:11], s27 offen offset:1024
    buffer_load_dwordx4 a[20:23], v8, s[8:11], s28 offen offset:1024
    buffer_load_dwordx4 a[36:39], v8, s[8:11], s29 offen offset:1024
    buffer_load_dwordx4 a[52:55], v8, s[8:11], s30 offen offset:1024
    buffer_load_dwordx4 a[8:11], v8, s[8:11], s27 offen offset:2048
    buffer_load_dwordx4 a[24:27], v8, s[8:11], s28 offen offset:2048
    buffer_load_dwordx4 a[40:43], v8, s[8:11], s29 offen offset:2048
    buffer_load_dwordx4 a[56:59], v8, s[8:11], s30 offen offset:2048
    buffer_load_dwordx4 a[12:15], v8, s[8:11], s27 offen offset:3072
    buffer_load_dwordx4 a[28:31], v8, s[8:11], s28 offen offset:3072
    buffer_load_dwordx4 a[44:47], v8, s[8:11], s29 offen offset:3072
    buffer_load_dwordx4 a[60:63], v8, s[8:11], s30 offen offset:3072
    buffer_load_dwordx4 a[64:67], v8, s[8:11], s31 offen offset:0
    buffer_load_dwordx4 a[68:71], v8, s[8:11], s31 offen offset:1024
    buffer_load_dwordx4 a[72:75], v8, s[8:11], s31 offen offset:2048
    buffer_load_dwordx4 a[76:79], v8, s[8:11], s31 offen offset:3072
    buffer_load_dwordx4 a[80:83], v8, s[8:11], s32 offen offset:0
    buffer_load_dwordx4 a[84:87], v8, s[8:11], s32 offen offset:1024
    buffer_load_dwordx4 a[88:91], v8, s[8:11], s32 offen offset:2048
    buffer_load_dwordx4 a[92:95], v8, s[8:11], s32 offen offset:3072
    buffer_load_dwordx4 v[80:83], v10, s[8:11], s33 offen offset:2048 sc1
    buffer_load_dwordx4 v[84:87], v10, s[8:11], s33 offen offset:2176 sc1
    buffer_load_dwordx4 v[88:91], v10, s[8:11], s33 offen offset:3072 sc1
    buffer_load_dwordx4 v[92:95], v10, s[8:11], s33 offen offset:3200 sc1
    s_add_u32 s4, s33, 4096
    s_mov_b64 exec, s[60:61]
    buffer_load_dwordx2 v[128:129], v11, s[8:11], s4 offen offset:0 sc1
    buffer_load_dwordx2 v[130:131], v11, s[8:11], s4 offen offset:256 sc1
    buffer_load_dwordx2 v[132:133], v11, s[8:11], s4 offen offset:512 sc1
    buffer_load_dwordx2 v[134:135], v11, s[8:11], s4 offen offset:768 sc1
    buffer_load_dwordx2 v[136:137], v11, s[8:11], s4 offen offset:1024 sc1
    buffer_load_dwordx2 v[138:139], v11, s[8:11], s4 offen offset:1280 sc1
    buffer_load_dwordx2 v[140:141], v11, s[8:11], s4 offen offset:1536 sc1
    buffer_load_dwordx2 v[142:143], v11, s[8:11], s4 offen offset:1792 sc1
    s_mov_b64 exec, -1
    v_mfma_f32_16x16x32_bf16 v[144:147], a[128:131], a[96:99], 0
    v_mfma_f32_16x16x32_bf16 v[156:159], a[128:131], a[112:115], 0
    v_mfma_f32_16x16x32_bf16 v[160:163], a[144:147], a[112:115], 0
    v_mfma_f32_16x16x32_bf16 v[144:147], a[132:135], a[100:103], v[144:147]
    v_mfma_f32_16x16x32_bf16 v[156:159], a[132:135], a[116:119], v[156:159]
    v_mfma_f32_16x16x32_bf16 v[160:163], a[148:151], a[116:119], v[160:163]
    v_mfma_f32_16x16x32_bf16 v[144:147], a[136:139], a[104:107], v[144:147]
    v_mfma_f32_16x16x32_bf16 v[156:159], a[136:139], a[120:123], v[156:159]
    v_mfma_f32_16x16x32_bf16 v[160:163], a[152:155], a[120:123], v[160:163]
    v_mfma_f32_16x16x32_bf16 v[144:147], a[140:143], a[108:111], v[144:147]
    v_mfma_f32_16x16x32_bf16 v[156:159], a[140:143], a[124:127], v[156:159]
    v_mfma_f32_16x16x32_bf16 v[160:163], a[156:159], a[124:127], v[160:163]
    s_nop 7
    v_cvt_pk_bf16_f32 v168, v144, v145
    v_cvt_pk_bf16_f32 v170, v146, v147
    v_and_b32 v169, 0xffff0000, v168
    v_lshlrev_b32 v168, 16, v168
    v_and_b32 v171, 0xffff0000, v170
    v_lshlrev_b32 v170, 16, v170
    v_mul_f32 v168, s37, v168
    v_mul_f32 v169, s37, v169
    v_mul_f32 v170, s37, v170
    v_mul_f32 v171, s37, v171
    v_cvt_pk_bf16_f32 v144, v168, v169
    v_cvt_pk_bf16_f32 v146, v170, v171
    v_and_b32 v145, 0xffff0000, v144
    v_lshlrev_b32 v144, 16, v144
    v_and_b32 v147, 0xffff0000, v146
    v_lshlrev_b32 v146, 16, v146
    v_cvt_pk_bf16_f32 v192, v156, v157
    v_cvt_pk_bf16_f32 v194, v158, v159
    v_cvt_pk_bf16_f32 v196, v160, v161
    v_cvt_pk_bf16_f32 v198, v162, v163
    v_and_b32 v193, 0xffff0000, v192
    v_lshlrev_b32 v192, 16, v192
    v_and_b32 v195, 0xffff0000, v194
    v_lshlrev_b32 v194, 16, v194
    v_and_b32 v197, 0xffff0000, v196
    v_lshlrev_b32 v196, 16, v196
    v_and_b32 v199, 0xffff0000, v198
    v_lshlrev_b32 v198, 16, v198
    v_mul_f32 v192, s37, v192
    v_mul_f32 v193, s37, v193
    v_mul_f32 v194, s37, v194
    v_mul_f32 v195, s37, v195
    v_mul_f32 v196, s37, v196
    v_mul_f32 v197, s37, v197
    v_mul_f32 v198, s37, v198
    v_mul_f32 v199, s37, v199
    v_cvt_pk_bf16_f32 v156, v192, v193
    v_cvt_pk_bf16_f32 v158, v194, v195
    v_cvt_pk_bf16_f32 v160, v196, v197
    v_cvt_pk_bf16_f32 v162, v198, v199
    v_and_b32 v157, 0xffff0000, v156
    v_lshlrev_b32 v156, 16, v156
    v_and_b32 v159, 0xffff0000, v158
    v_lshlrev_b32 v158, 16, v158
    v_and_b32 v161, 0xffff0000, v160
    v_lshlrev_b32 v160, 16, v160
    v_and_b32 v163, 0xffff0000, v162
    v_lshlrev_b32 v162, 16, v162
    v_cndmask_b32 v144, v14, v144, s[40:41]
    v_cndmask_b32 v145, v14, v145, s[42:43]
    v_cndmask_b32 v146, v14, v146, s[44:45]
    v_cndmask_b32 v147, v14, v147, s[46:47]
    v_cndmask_b32 v160, v14, v160, s[40:41]
    v_cndmask_b32 v161, v14, v161, s[42:43]
    v_cndmask_b32 v162, v14, v162, s[44:45]
    v_cndmask_b32 v163, v14, v163, s[46:47]
    s_mov_b32 s62, 0
.kmp_489:
    v_max3_u32 v4, v96, v97, v98
    v_max3_u32 v5, v99, v100, v101
    v_max3_u32 v4, v4, v102, v103
    v_max3_u32 v5, v5, v104, v105
    v_max3_u32 v4, v4, v106, v107
    v_max3_u32 v5, v5, v108, v109
    v_max3_u32 v4, v4, v110, v111
    v_max3_u32 v5, v5, v112, v113
    v_max3_u32 v4, v4, v114, v115
    v_max3_u32 v5, v5, v116, v117
    v_max3_u32 v4, v4, v118, v119
    v_max3_u32 v5, v5, v120, v121
    v_max3_u32 v4, v4, v122, v123
    v_max3_u32 v5, v5, v124, v125
    v_max3_u32 v4, v4, v126, v127
    v_max_u32 v4, v4, v5
    v_cmp_eq_u32 vcc, -1, v4
    s_cbranch_vccnz .kmf_490

    v_mfma_f32_16x16x32_bf16 v[152:155], v[96:99], a[96:99], 0
    v_mfma_f32_16x16x32_bf16 v[164:167], v[96:99], a[112:115], 0
    v_mfma_f32_16x16x32_bf16 v[152:155], v[100:103], a[100:103], v[152:155]
    v_mfma_f32_16x16x32_bf16 v[164:167], v[100:103], a[116:119], v[164:167]
    v_mfma_f32_16x16x32_bf16 v[152:155], v[104:107], a[104:107], v[152:155]
    v_mfma_f32_16x16x32_bf16 v[164:167], v[104:107], a[120:123], v[164:167]
    v_mfma_f32_16x16x32_bf16 v[152:155], v[108:111], a[108:111], v[152:155]
    v_mfma_f32_16x16x32_bf16 v[164:167], v[108:111], a[124:127], v[164:167]
    s_nop 5
    v_cvt_pk_bf16_f32 v176, v152, v153
    v_cvt_pk_bf16_f32 v178, v154, v155
    v_and_b32 v177, 0xffff0000, v176
    v_lshlrev_b32 v176, 16, v176
    v_and_b32 v179, 0xffff0000, v178
    v_lshlrev_b32 v178, 16, v178
    v_mul_f32 v176, s37, v176
    v_mul_f32 v177, s37, v177
    v_mul_f32 v178, s37, v178
    v_mul_f32 v179, s37, v179
    v_cvt_pk_bf16_f32 v152, v176, v177
    v_cvt_pk_bf16_f32 v154, v178, v179
    v_and_b32 v153, 0xffff0000, v152
    v_lshlrev_b32 v152, 16, v152
    v_and_b32 v155, 0xffff0000, v154
    v_lshlrev_b32 v154, 16, v154
    v_cndmask_b32 v152, v14, v152, s[60:61]
    v_cndmask_b32 v153, v14, v153, s[60:61]
    v_cndmask_b32 v154, v14, v154, s[60:61]
    v_cndmask_b32 v155, v14, v155, s[60:61]
    v_cvt_pk_bf16_f32 v200, v164, v165
    v_cvt_pk_bf16_f32 v202, v166, v167
    v_and_b32 v201, 0xffff0000, v200
    v_lshlrev_b32 v200, 16, v200
    v_and_b32 v203, 0xffff0000, v202
    v_lshlrev_b32 v202, 16, v202
    v_mul_f32 v200, s37, v200
    v_mul_f32 v201, s37, v201
    v_mul_f32 v202, s37, v202
    v_mul_f32 v203, s37, v203
    v_cvt_pk_bf16_f32 v164, v200, v201
    v_cvt_pk_bf16_f32 v166, v202, v203
    v_and_b32 v165, 0xffff0000, v164
    v_lshlrev_b32 v164, 16, v164
    v_and_b32 v167, 0xffff0000, v166
    v_lshlrev_b32 v166, 16, v166
    v_cndmask_b32 v164, v14, v164, s[60:61]
    v_cndmask_b32 v165, v14, v165, s[60:61]
    v_cndmask_b32 v166, v14, v166, s[60:61]
    v_cndmask_b32 v167, v14, v167, s[60:61]
    v_max3_f32 v4, v144, v145, v146
    v_max3_f32 v5, v147, v152, v153
    v_max3_f32 v4, v4, v154, v155
    v_max_f32 v4, v4, v5

    v_max3_f32 v6, v156, v157, v158
    v_max3_f32 v7, v159, v160, v161
    v_max3_f32 v6, v6, v162, v163
    v_max3_f32 v7, v7, v164, v165
    v_max3_f32 v6, v6, v166, v167
    v_max_f32 v6, v6, v7

    v_mov_b32 v5, v4
    v_mov_b32 v7, v6
    s_nop 0
    v_permlane32_swap_b32 v4, v5
    v_permlane32_swap_b32 v6, v7
    v_max_f32 v4, v4, v5
    v_max_f32 v6, v6, v7

    v_mov_b32 v5, v4
    v_mov_b32 v7, v6
    s_nop 0
    v_permlane16_swap_b32 v4, v5
    v_permlane16_swap_b32 v6, v7
    v_max_f32 v4, v4, v5
    v_max_f32 v6, v6, v7

    v_mul_f32 v4, s38, v4
    v_mul_f32 v6, s38, v6
    v_fma_f32 v168, v144, s38, -v4
    v_fma_f32 v169, v145, s38, -v4
    v_fma_f32 v170, v146, s38, -v4
    v_fma_f32 v171, v147, s38, -v4
    v_fma_f32 v176, v152, s38, -v4
    v_fma_f32 v177, v153, s38, -v4
    v_fma_f32 v178, v154, s38, -v4
    v_fma_f32 v179, v155, s38, -v4
    v_fma_f32 v192, v156, s38, -v6
    v_fma_f32 v193, v157, s38, -v6
    v_fma_f32 v194, v158, s38, -v6
    v_fma_f32 v195, v159, s38, -v6
    v_fma_f32 v196, v160, s38, -v6
    v_fma_f32 v197, v161, s38, -v6
    v_fma_f32 v198, v162, s38, -v6
    v_fma_f32 v199, v163, s38, -v6
    v_fma_f32 v200, v164, s38, -v6
    v_fma_f32 v201, v165, s38, -v6
    v_fma_f32 v202, v166, s38, -v6
    v_fma_f32 v203, v167, s38, -v6
    v_exp_f32 v168, v168
    v_exp_f32 v169, v169
    v_exp_f32 v170, v170
    v_exp_f32 v171, v171
    v_exp_f32 v176, v176
    v_exp_f32 v177, v177
    v_exp_f32 v178, v178
    v_exp_f32 v179, v179
    v_exp_f32 v192, v192
    v_exp_f32 v193, v193
    v_exp_f32 v194, v194
    v_exp_f32 v195, v195
    v_exp_f32 v196, v196
    v_exp_f32 v197, v197
    v_exp_f32 v198, v198
    v_exp_f32 v199, v199
    v_exp_f32 v200, v200
    v_exp_f32 v201, v201
    v_exp_f32 v202, v202
    v_exp_f32 v203, v203
    v_add_f32 v4, v168, v169
    v_add_f32 v5, v170, v171
    v_add_f32 v4, v4, v176
    v_add_f32 v5, v5, v177
    v_add_f32 v4, v4, v178
    v_add_f32 v5, v5, v179
    v_add_f32 v4, v4, v5
    v_add_f32 v6, v192, v193
    v_add_f32 v7, v194, v195
    v_add_f32 v6, v6, v196
    v_add_f32 v7, v7, v197
    v_add_f32 v6, v6, v198
    v_add_f32 v7, v7, v199
    v_add_f32 v6, v6, v200
    v_add_f32 v7, v7, v201
    v_add_f32 v6, v6, v202
    v_add_f32 v7, v7, v203
    v_add_f32 v6, v6, v7
    v_mov_b32 v5, v4
    v_mov_b32 v7, v6
    s_nop 0
    v_permlane32_swap_b32 v4, v5
    v_permlane32_swap_b32 v6, v7
    v_add_f32 v4, v4, v5
    v_add_f32 v6, v6, v7

    v_mov_b32 v5, v4
    v_mov_b32 v7, v6
    s_nop 0
    v_permlane16_swap_b32 v4, v5
    v_permlane16_swap_b32 v6, v7
    v_add_f32 v4, v4, v5
    v_add_f32 v6, v6, v7

    v_rcp_f32 v4, v4
    v_rcp_f32 v6, v6
    v_mov_b32 v182, 0
    v_mov_b32 v183, 0
    v_mul_f32 v168, v4, v168
    v_mul_f32 v169, v4, v169
    v_mul_f32 v170, v4, v170
    v_mul_f32 v171, v4, v171
    v_mul_f32 v176, v4, v176
    v_mul_f32 v177, v4, v177
    v_mul_f32 v178, v4, v178
    v_mul_f32 v179, v4, v179
    v_cvt_pk_bf16_f32 v180, v168, v169
    v_cvt_pk_bf16_f32 v181, v170, v171
    v_cvt_pk_bf16_f32 v184, v176, v177
    v_cvt_pk_bf16_f32 v185, v178, v179
    v_mul_f32 v192, v6, v192
    v_mul_f32 v193, v6, v193
    v_mul_f32 v194, v6, v194
    v_mul_f32 v195, v6, v195
    v_mul_f32 v196, v6, v196
    v_mul_f32 v197, v6, v197
    v_mul_f32 v198, v6, v198
    v_mul_f32 v199, v6, v199
    v_mul_f32 v200, v6, v200
    v_mul_f32 v201, v6, v201
    v_mul_f32 v202, v6, v202
    v_mul_f32 v203, v6, v203
    v_cvt_pk_bf16_f32 v186, v192, v193
    v_cvt_pk_bf16_f32 v187, v194, v195
    v_cvt_pk_bf16_f32 v188, v196, v197
    v_cvt_pk_bf16_f32 v189, v198, v199
    v_cvt_pk_bf16_f32 v190, v200, v201
    v_cvt_pk_bf16_f32 v191, v202, v203
    s_add_u32 s25, s25, 4

    v_mfma_f32_16x16x32_bf16 v[16:19], a[160:163], v[180:183], 0
    v_mfma_f32_16x16x32_bf16 v[20:23], a[164:167], v[180:183], 0
    v_mfma_f32_16x16x32_bf16 v[24:27], a[168:171], v[180:183], 0
    v_mfma_f32_16x16x32_bf16 v[28:31], a[172:175], v[180:183], 0
    v_mfma_f32_16x16x32_bf16 v[32:35], a[176:179], v[180:183], 0
    v_mfma_f32_16x16x32_bf16 v[36:39], a[180:183], v[180:183], 0
    v_mfma_f32_16x16x32_bf16 v[40:43], a[184:187], v[180:183], 0
    v_mfma_f32_16x16x32_bf16 v[44:47], a[188:191], v[180:183], 0
    v_mfma_f32_16x16x32_bf16 v[48:51], a[160:163], v[186:189], 0
    v_mfma_f32_16x16x32_bf16 v[52:55], a[164:167], v[186:189], 0
    v_mfma_f32_16x16x32_bf16 v[56:59], a[168:171], v[186:189], 0
    v_mfma_f32_16x16x32_bf16 v[60:63], a[172:175], v[186:189], 0
    v_mfma_f32_16x16x32_bf16 v[64:67], a[176:179], v[186:189], 0
    v_mfma_f32_16x16x32_bf16 v[68:71], a[180:183], v[186:189], 0
    v_mfma_f32_16x16x32_bf16 v[72:75], a[184:187], v[186:189], 0
    v_mfma_f32_16x16x32_bf16 v[76:79], a[188:191], v[186:189], 0
    s_waitcnt vmcnt(36)
    s_bitcmp1_b32 s97, 4
    s_mov_b64 exec, 1
    s_cbranch_scc1 .fs_491
    buffer_store_dword v12, v13, s[8:11], s92 offen
.fj_492:
    s_mov_b64 exec, -1
    s_cmp_lt_u32 s25, s96
    s_cbranch_scc1 .os_493
    v_mfma_f32_16x16x16_bf16 v[16:19], v[112:113], v[184:185], v[16:19]
    v_mfma_f32_16x16x16_bf16 v[20:23], v[114:115], v[184:185], v[20:23]
    v_add_u32 v12, 1, v12
    v_mfma_f32_16x16x16_bf16 v[24:27], v[116:117], v[184:185], v[24:27]
    v_mfma_f32_16x16x16_bf16 v[28:31], v[118:119], v[184:185], v[28:31]
    v_mfma_f32_16x16x16_bf16 v[32:35], v[120:121], v[184:185], v[32:35]
    v_mfma_f32_16x16x16_bf16 v[36:39], v[122:123], v[184:185], v[36:39]
    v_cvt_pk_bf16_f32 v208, v16, v17
    v_cvt_pk_bf16_f32 v209, v18, v19
    v_cvt_pk_bf16_f32 v210, v20, v21
    v_cvt_pk_bf16_f32 v211, v22, v23
    buffer_store_dwordx4 v[208:211], v8, s[8:11], s50 offen offset:0
    v_mfma_f32_16x16x16_bf16 v[40:43], v[124:125], v[184:185], v[40:43]
    v_mfma_f32_16x16x16_bf16 v[44:47], v[126:127], v[184:185], v[44:47]
    v_cvt_pk_bf16_f32 v212, v24, v25
    v_cvt_pk_bf16_f32 v213, v26, v27
    v_cvt_pk_bf16_f32 v214, v28, v29
    v_cvt_pk_bf16_f32 v215, v30, v31
    buffer_store_dwordx4 v[212:215], v8, s[8:11], s50 offen offset:1024
    v_mfma_f32_16x16x16_bf16 v[48:51], v[112:113], v[190:191], v[48:51]
    v_mfma_f32_16x16x16_bf16 v[52:55], v[114:115], v[190:191], v[52:55]
    v_cvt_pk_bf16_f32 v216, v32, v33
    v_cvt_pk_bf16_f32 v217, v34, v35
    v_cvt_pk_bf16_f32 v218, v36, v37
    v_cvt_pk_bf16_f32 v219, v38, v39
    buffer_store_dwordx4 v[216:219], v8, s[8:11], s50 offen offset:2048
    v_mfma_f32_16x16x16_bf16 v[56:59], v[116:117], v[190:191], v[56:59]
    v_mfma_f32_16x16x16_bf16 v[60:63], v[118:119], v[190:191], v[60:63]
    v_cvt_pk_bf16_f32 v220, v40, v41
    v_cvt_pk_bf16_f32 v221, v42, v43
    v_cvt_pk_bf16_f32 v222, v44, v45
    v_cvt_pk_bf16_f32 v223, v46, v47
    buffer_store_dwordx4 v[220:223], v8, s[8:11], s50 offen offset:3072
    v_mfma_f32_16x16x16_bf16 v[64:67], v[120:121], v[190:191], v[64:67]
    v_mfma_f32_16x16x16_bf16 v[68:71], v[122:123], v[190:191], v[68:71]
    v_cvt_pk_bf16_f32 v224, v48, v49
    v_cvt_pk_bf16_f32 v225, v50, v51
    v_cvt_pk_bf16_f32 v226, v52, v53
    v_cvt_pk_bf16_f32 v227, v54, v55
    buffer_store_dwordx4 v[224:227], v8, s[8:11], s51 offen offset:0
    v_mfma_f32_16x16x16_bf16 v[72:75], v[124:125], v[190:191], v[72:75]
    v_mfma_f32_16x16x16_bf16 v[76:79], v[126:127], v[190:191], v[76:79]
    v_cvt_pk_bf16_f32 v228, v56, v57
    v_cvt_pk_bf16_f32 v229, v58, v59
    v_cvt_pk_bf16_f32 v230, v60, v61
    v_cvt_pk_bf16_f32 v231, v62, v63
    buffer_store_dwordx4 v[228:231], v8, s[8:11], s51 offen offset:1024
    s_nop 3
    v_cvt_pk_bf16_f32 v232, v64, v65
    v_cvt_pk_bf16_f32 v233, v66, v67
    v_cvt_pk_bf16_f32 v234, v68, v69
    v_cvt_pk_bf16_f32 v235, v70, v71
    buffer_store_dwordx4 v[232:235], v8, s[8:11], s51 offen offset:2048
    v_cvt_pk_bf16_f32 v236, v72, v73
    v_cvt_pk_bf16_f32 v237, v74, v75
    v_cvt_pk_bf16_f32 v238, v76, v77
    v_cvt_pk_bf16_f32 v239, v78, v79
    buffer_store_dwordx4 v[236:239], v8, s[8:11], s51 offen offset:3072
.oj_494:
    s_cmp_lt_u32 s25, 64
    s_cbranch_scc1 .att_475

    s_cmp_eq_u32 s25, 64
    s_cbranch_scc1 .ah0_476
.ahz_478:
    s_waitcnt vmcnt(0)
    s_bitcmp1_b32 s97, 4
    s_mov_b64 exec, 1
    s_cbranch_scc1 .fs_496
    buffer_store_dword v12, v13, s[8:11], s92 offen
.fj_497:
    s_mov_b64 exec, -1
    s_branch .ate_495
.atw_479:
    s_mov_b32 s62, 0
    s_mov_b64 exec, 7
.wf_498:
    buffer_load_dword v15, v9, s[8:11], s35 offen sc1
    s_waitcnt vmcnt(0)
    v_cmp_gt_u32 vcc, s36, v15
    s_cbranch_vccz .wfd_499
    s_sleep 2
    s_add_u32 s62, s62, 1
    s_cmp_gt_u32 s62, 0x400000
    s_cbranch_scc1 .mg_end_1
    s_branch .wf_498

.wfd_499:
    s_mov_b64 exec, -1
    s_branch .atb_480
.kmf_482:
    s_cmp_lg_u32 s62, 0
    s_cbranch_scc1 .kmn_500
    s_waitcnt vmcnt(36)
    s_bitcmp1_b32 s97, 4
    s_mov_b64 exec, 1
    s_cbranch_scc1 .fs_501
    buffer_store_dword v12, v13, s[8:11], s92 offen
.fj_502:
    s_mov_b64 exec, -1
    s_cmp_lt_u32 s25, 60
    s_cselect_b32 s5, 0, 196608
    s_sub_u32 s5, s34, s5
    s_mov_b64 exec, 15

.kml_503:
    s_sleep 4
    buffer_load_dword v4, v204, s[8:11], s5 offen sc1
    s_add_u32 s62, s62, 1
    s_cmp_gt_u32 s62, 0x200000
    s_cbranch_scc1 .mg_end_1
    s_waitcnt vmcnt(0)
    v_cmp_eq_u32 vcc, -1, v4
    s_cbranch_vccnz .kml_503
    s_mov_b64 exec, -1

.kmn_500:
    s_sleep 1
    buffer_load_dwordx4 v[80:83], v10, s[8:11], s34 offen offset:2048 sc1
    buffer_load_dwordx4 v[84:87], v10, s[8:11], s34 offen offset:2176 sc1
    buffer_load_dwordx4 v[88:91], v10, s[8:11], s34 offen offset:3072 sc1
    buffer_load_dwordx4 v[92:95], v10, s[8:11], s34 offen offset:3200 sc1
    s_add_u32 s4, s34, 4096
    s_mov_b64 exec, s[60:61]
    buffer_load_dwordx2 v[128:129], v11, s[8:11], s4 offen offset:0 sc1
    buffer_load_dwordx2 v[130:131], v11, s[8:11], s4 offen offset:256 sc1
    buffer_load_dwordx2 v[132:133], v11, s[8:11], s4 offen offset:512 sc1
    buffer_load_dwordx2 v[134:135], v11, s[8:11], s4 offen offset:768 sc1
    buffer_load_dwordx2 v[136:137], v11, s[8:11], s4 offen offset:1024 sc1
    buffer_load_dwordx2 v[138:139], v11, s[8:11], s4 offen offset:1280 sc1
    buffer_load_dwordx2 v[140:141], v11, s[8:11], s4 offen offset:1536 sc1
    buffer_load_dwordx2 v[142:143], v11, s[8:11], s4 offen offset:1792 sc1
    s_mov_b64 exec, -1
    s_add_u32 s62, s62, 1
    s_cmp_gt_u32 s62, 0x200000
    s_cbranch_scc1 .mg_end_1
    s_waitcnt vmcnt(0)
    s_branch .kmp_481

.fs_483:
    buffer_store_dword v12, v13, s[8:11], s92 offen sc1
    s_branch .fj_484
.os_485:
    v_mfma_f32_16x16x16_bf16 v[16:19], v[128:129], v[184:185], v[16:19]
    v_mfma_f32_16x16x16_bf16 v[20:23], v[130:131], v[184:185], v[20:23]
    v_add_u32 v12, 1, v12
    v_mfma_f32_16x16x16_bf16 v[24:27], v[132:133], v[184:185], v[24:27]
    v_mfma_f32_16x16x16_bf16 v[28:31], v[134:135], v[184:185], v[28:31]
    v_mfma_f32_16x16x16_bf16 v[32:35], v[136:137], v[184:185], v[32:35]
    v_mfma_f32_16x16x16_bf16 v[36:39], v[138:139], v[184:185], v[36:39]
    v_cvt_pk_bf16_f32 v208, v16, v17
    v_cvt_pk_bf16_f32 v209, v18, v19
    v_cvt_pk_bf16_f32 v210, v20, v21
    v_cvt_pk_bf16_f32 v211, v22, v23
    buffer_store_dwordx4 v[208:211], v8, s[8:11], s50 offen offset:0 sc1
    v_mfma_f32_16x16x16_bf16 v[40:43], v[140:141], v[184:185], v[40:43]
    v_mfma_f32_16x16x16_bf16 v[44:47], v[142:143], v[184:185], v[44:47]
    v_cvt_pk_bf16_f32 v212, v24, v25
    v_cvt_pk_bf16_f32 v213, v26, v27
    v_cvt_pk_bf16_f32 v214, v28, v29
    v_cvt_pk_bf16_f32 v215, v30, v31
    buffer_store_dwordx4 v[212:215], v8, s[8:11], s50 offen offset:1024 sc1
    v_mfma_f32_16x16x16_bf16 v[48:51], v[128:129], v[190:191], v[48:51]
    v_mfma_f32_16x16x16_bf16 v[52:55], v[130:131], v[190:191], v[52:55]
    v_cvt_pk_bf16_f32 v216, v32, v33
    v_cvt_pk_bf16_f32 v217, v34, v35
    v_cvt_pk_bf16_f32 v218, v36, v37
    v_cvt_pk_bf16_f32 v219, v38, v39
    buffer_store_dwordx4 v[216:219], v8, s[8:11], s50 offen offset:2048 sc1
    v_mfma_f32_16x16x16_bf16 v[56:59], v[132:133], v[190:191], v[56:59]
    v_mfma_f32_16x16x16_bf16 v[60:63], v[134:135], v[190:191], v[60:63]
    v_cvt_pk_bf16_f32 v220, v40, v41
    v_cvt_pk_bf16_f32 v221, v42, v43
    v_cvt_pk_bf16_f32 v222, v44, v45
    v_cvt_pk_bf16_f32 v223, v46, v47
    buffer_store_dwordx4 v[220:223], v8, s[8:11], s50 offen offset:3072 sc1
    v_mfma_f32_16x16x16_bf16 v[64:67], v[136:137], v[190:191], v[64:67]
    v_mfma_f32_16x16x16_bf16 v[68:71], v[138:139], v[190:191], v[68:71]
    v_cvt_pk_bf16_f32 v224, v48, v49
    v_cvt_pk_bf16_f32 v225, v50, v51
    v_cvt_pk_bf16_f32 v226, v52, v53
    v_cvt_pk_bf16_f32 v227, v54, v55
    buffer_store_dwordx4 v[224:227], v8, s[8:11], s51 offen offset:0 sc1
    v_mfma_f32_16x16x16_bf16 v[72:75], v[140:141], v[190:191], v[72:75]
    v_mfma_f32_16x16x16_bf16 v[76:79], v[142:143], v[190:191], v[76:79]
    v_cvt_pk_bf16_f32 v228, v56, v57
    v_cvt_pk_bf16_f32 v229, v58, v59
    v_cvt_pk_bf16_f32 v230, v60, v61
    v_cvt_pk_bf16_f32 v231, v62, v63
    buffer_store_dwordx4 v[228:231], v8, s[8:11], s51 offen offset:1024 sc1
    s_nop 3
    v_cvt_pk_bf16_f32 v232, v64, v65
    v_cvt_pk_bf16_f32 v233, v66, v67
    v_cvt_pk_bf16_f32 v234, v68, v69
    v_cvt_pk_bf16_f32 v235, v70, v71
    buffer_store_dwordx4 v[232:235], v8, s[8:11], s51 offen offset:2048 sc1
    v_cvt_pk_bf16_f32 v236, v72, v73
    v_cvt_pk_bf16_f32 v237, v74, v75
    v_cvt_pk_bf16_f32 v238, v76, v77
    v_cvt_pk_bf16_f32 v239, v78, v79
    buffer_store_dwordx4 v[236:239], v8, s[8:11], s51 offen offset:3072 sc1
    s_branch .oj_486
.atw_487:
    s_mov_b32 s62, 0
    s_mov_b64 exec, 7
.wf_504:
    buffer_load_dword v15, v9, s[8:11], s35 offen sc1
    s_waitcnt vmcnt(0)
    v_cmp_gt_u32 vcc, s36, v15
    s_cbranch_vccz .wfd_505
    s_sleep 2
    s_add_u32 s62, s62, 1
    s_cmp_gt_u32 s62, 0x400000
    s_cbranch_scc1 .mg_end_1
    s_branch .wf_504

.wfd_505:
    s_mov_b64 exec, -1
    s_branch .atb_488
.kmf_490:
    s_cmp_lg_u32 s62, 0
    s_cbranch_scc1 .kmn_506
    s_waitcnt vmcnt(36)
    s_bitcmp1_b32 s97, 4
    s_mov_b64 exec, 1
    s_cbranch_scc1 .fs_507
    buffer_store_dword v12, v13, s[8:11], s92 offen
.fj_508:
    s_mov_b64 exec, -1
    s_cmp_lt_u32 s25, 60
    s_cselect_b32 s5, 0, 196608
    s_sub_u32 s5, s34, s5
    s_mov_b64 exec, 15

.kml_509:
    s_sleep 4
    buffer_load_dword v4, v204, s[8:11], s5 offen sc1
    s_add_u32 s62, s62, 1
    s_cmp_gt_u32 s62, 0x200000
    s_cbranch_scc1 .mg_end_1
    s_waitcnt vmcnt(0)
    v_cmp_eq_u32 vcc, -1, v4
    s_cbranch_vccnz .kml_509
    s_mov_b64 exec, -1

.kmn_506:
    s_sleep 1
    buffer_load_dwordx4 v[96:99], v10, s[8:11], s34 offen offset:2048 sc1
    buffer_load_dwordx4 v[100:103], v10, s[8:11], s34 offen offset:2176 sc1
    buffer_load_dwordx4 v[104:107], v10, s[8:11], s34 offen offset:3072 sc1
    buffer_load_dwordx4 v[108:111], v10, s[8:11], s34 offen offset:3200 sc1
    s_add_u32 s4, s34, 4096
    s_mov_b64 exec, s[60:61]
    buffer_load_dwordx2 v[112:113], v11, s[8:11], s4 offen offset:0 sc1
    buffer_load_dwordx2 v[114:115], v11, s[8:11], s4 offen offset:256 sc1
    buffer_load_dwordx2 v[116:117], v11, s[8:11], s4 offen offset:512 sc1
    buffer_load_dwordx2 v[118:119], v11, s[8:11], s4 offen offset:768 sc1
    buffer_load_dwordx2 v[120:121], v11, s[8:11], s4 offen offset:1024 sc1
    buffer_load_dwordx2 v[122:123], v11, s[8:11], s4 offen offset:1280 sc1
    buffer_load_dwordx2 v[124:125], v11, s[8:11], s4 offen offset:1536 sc1
    buffer_load_dwordx2 v[126:127], v11, s[8:11], s4 offen offset:1792 sc1
    s_mov_b64 exec, -1
    s_add_u32 s62, s62, 1
    s_cmp_gt_u32 s62, 0x200000
    s_cbranch_scc1 .mg_end_1
    s_waitcnt vmcnt(0)
    s_branch .kmp_489

.fs_491:
    buffer_store_dword v12, v13, s[8:11], s92 offen sc1
    s_branch .fj_492
.os_493:
    v_mfma_f32_16x16x16_bf16 v[16:19], v[112:113], v[184:185], v[16:19]
    v_mfma_f32_16x16x16_bf16 v[20:23], v[114:115], v[184:185], v[20:23]
    v_add_u32 v12, 1, v12
    v_mfma_f32_16x16x16_bf16 v[24:27], v[116:117], v[184:185], v[24:27]
    v_mfma_f32_16x16x16_bf16 v[28:31], v[118:119], v[184:185], v[28:31]
    v_mfma_f32_16x16x16_bf16 v[32:35], v[120:121], v[184:185], v[32:35]
    v_mfma_f32_16x16x16_bf16 v[36:39], v[122:123], v[184:185], v[36:39]
    v_cvt_pk_bf16_f32 v208, v16, v17
    v_cvt_pk_bf16_f32 v209, v18, v19
    v_cvt_pk_bf16_f32 v210, v20, v21
    v_cvt_pk_bf16_f32 v211, v22, v23
    buffer_store_dwordx4 v[208:211], v8, s[8:11], s50 offen offset:0 sc1
    v_mfma_f32_16x16x16_bf16 v[40:43], v[124:125], v[184:185], v[40:43]
    v_mfma_f32_16x16x16_bf16 v[44:47], v[126:127], v[184:185], v[44:47]
    v_cvt_pk_bf16_f32 v212, v24, v25
    v_cvt_pk_bf16_f32 v213, v26, v27
    v_cvt_pk_bf16_f32 v214, v28, v29
    v_cvt_pk_bf16_f32 v215, v30, v31
    buffer_store_dwordx4 v[212:215], v8, s[8:11], s50 offen offset:1024 sc1
    v_mfma_f32_16x16x16_bf16 v[48:51], v[112:113], v[190:191], v[48:51]
    v_mfma_f32_16x16x16_bf16 v[52:55], v[114:115], v[190:191], v[52:55]
    v_cvt_pk_bf16_f32 v216, v32, v33
    v_cvt_pk_bf16_f32 v217, v34, v35
    v_cvt_pk_bf16_f32 v218, v36, v37
    v_cvt_pk_bf16_f32 v219, v38, v39
    buffer_store_dwordx4 v[216:219], v8, s[8:11], s50 offen offset:2048 sc1
    v_mfma_f32_16x16x16_bf16 v[56:59], v[116:117], v[190:191], v[56:59]
    v_mfma_f32_16x16x16_bf16 v[60:63], v[118:119], v[190:191], v[60:63]
    v_cvt_pk_bf16_f32 v220, v40, v41
    v_cvt_pk_bf16_f32 v221, v42, v43
    v_cvt_pk_bf16_f32 v222, v44, v45
    v_cvt_pk_bf16_f32 v223, v46, v47
    buffer_store_dwordx4 v[220:223], v8, s[8:11], s50 offen offset:3072 sc1
    v_mfma_f32_16x16x16_bf16 v[64:67], v[120:121], v[190:191], v[64:67]
    v_mfma_f32_16x16x16_bf16 v[68:71], v[122:123], v[190:191], v[68:71]
    v_cvt_pk_bf16_f32 v224, v48, v49
    v_cvt_pk_bf16_f32 v225, v50, v51
    v_cvt_pk_bf16_f32 v226, v52, v53
    v_cvt_pk_bf16_f32 v227, v54, v55
    buffer_store_dwordx4 v[224:227], v8, s[8:11], s51 offen offset:0 sc1
    v_mfma_f32_16x16x16_bf16 v[72:75], v[124:125], v[190:191], v[72:75]
    v_mfma_f32_16x16x16_bf16 v[76:79], v[126:127], v[190:191], v[76:79]
    v_cvt_pk_bf16_f32 v228, v56, v57
    v_cvt_pk_bf16_f32 v229, v58, v59
    v_cvt_pk_bf16_f32 v230, v60, v61
    v_cvt_pk_bf16_f32 v231, v62, v63
    buffer_store_dwordx4 v[228:231], v8, s[8:11], s51 offen offset:1024 sc1
    s_nop 3
    v_cvt_pk_bf16_f32 v232, v64, v65
    v_cvt_pk_bf16_f32 v233, v66, v67
    v_cvt_pk_bf16_f32 v234, v68, v69
    v_cvt_pk_bf16_f32 v235, v70, v71
    buffer_store_dwordx4 v[232:235], v8, s[8:11], s51 offen offset:2048 sc1
    v_cvt_pk_bf16_f32 v236, v72, v73
    v_cvt_pk_bf16_f32 v237, v74, v75
    v_cvt_pk_bf16_f32 v238, v76, v77
    v_cvt_pk_bf16_f32 v239, v78, v79
    buffer_store_dwordx4 v[236:239], v8, s[8:11], s51 offen offset:3072 sc1
    s_branch .oj_494
.ah0_476:
    s_mov_b32 s34, s33
    s_add_u32 s50, s27, 0
    s_mov_b32 s39, 0x3e0293ee
    v_lshlrev_b32 v5, 2, v8
    s_waitcnt vmcnt(8)
    buffer_load_dword v205, v5, s[8:11], s50 offen
    s_add_u32 s25, s25, 4

    s_mov_b32 s52, 1
    s_branch .hd_510
.hb_511:
    s_mov_b32 s52, 0
    v_mfma_f32_16x16x32_bf16 v[144:147], a[32:35], a[0:3], 0
    v_mfma_f32_16x16x32_bf16 v[144:147], a[36:39], a[4:7], v[144:147]
    v_mfma_f32_16x16x32_bf16 v[144:147], a[40:43], a[8:11], v[144:147]
    v_mfma_f32_16x16x32_bf16 v[144:147], a[44:47], a[12:15], v[144:147]
    s_nop 7
    v_cvt_pk_bf16_f32 v168, v144, v145
    v_cvt_pk_bf16_f32 v170, v146, v147
    v_and_b32 v169, 0xffff0000, v168
    v_lshlrev_b32 v168, 16, v168
    v_and_b32 v171, 0xffff0000, v170
    v_lshlrev_b32 v170, 16, v170
    v_mul_f32 v168, s37, v168
    v_mul_f32 v169, s37, v169
    v_mul_f32 v170, s37, v170
    v_mul_f32 v171, s37, v171
    v_cvt_pk_bf16_f32 v144, v168, v169
    v_cvt_pk_bf16_f32 v146, v170, v171
    v_and_b32 v145, 0xffff0000, v144
    v_lshlrev_b32 v144, 16, v144
    v_and_b32 v147, 0xffff0000, v146
    v_lshlrev_b32 v146, 16, v146
    v_cndmask_b32 v144, v14, v144, s[40:41]
    v_cndmask_b32 v145, v14, v145, s[42:43]
    v_cndmask_b32 v146, v14, v146, s[44:45]
    v_cndmask_b32 v147, v14, v147, s[46:47]
    v_max3_f32 v192, v144, v145, v146
    v_max_f32 v192, v192, v147
    v_mov_b32 v5, v192
    s_nop 1
    v_permlane32_swap_b32 v192, v5
    v_max_f32 v192, v192, v5
    v_mov_b32 v5, v192
    s_nop 1
    v_permlane16_swap_b32 v192, v5
    v_max_f32 v192, v192, v5
    v_mul_f32 v192, s38, v192
    v_mov_b32 v182, 0
    v_mov_b32 v183, 0
    v_fma_f32 v168, v144, s38, -v192
    v_fma_f32 v169, v145, s38, -v192
    v_fma_f32 v170, v146, s38, -v192
    v_fma_f32 v171, v147, s38, -v192
    v_exp_f32 v168, v168
    v_exp_f32 v169, v169
    v_exp_f32 v170, v170
    v_exp_f32 v171, v171
    s_nop 0
    v_cvt_pk_bf16_f32 v180, v168, v169
    v_cvt_pk_bf16_f32 v181, v170, v171
    v_add_f32 v193, v168, v169
    v_add_f32 v193, v193, v170
    v_add_f32 v193, v193, v171
    v_mfma_f32_16x16x32_bf16 v[16:19], a[64:67], v[180:183], 0
    v_mfma_f32_16x16x32_bf16 v[20:23], a[68:71], v[180:183], 0
    v_mfma_f32_16x16x32_bf16 v[24:27], a[72:75], v[180:183], 0
    v_mfma_f32_16x16x32_bf16 v[28:31], a[76:79], v[180:183], 0
    v_mfma_f32_16x16x32_bf16 v[32:35], a[80:83], v[180:183], 0
    v_mfma_f32_16x16x32_bf16 v[36:39], a[84:87], v[180:183], 0
    v_mfma_f32_16x16x32_bf16 v[40:43], a[88:91], v[180:183], 0
    v_mfma_f32_16x16x32_bf16 v[44:47], a[92:95], v[180:183], 0
    v_mov_b32 v5, v193
    s_nop 1
    v_permlane32_swap_b32 v193, v5
    v_add_f32 v193, v193, v5
    v_mov_b32 v5, v193
    s_nop 1
    v_permlane16_swap_b32 v193, v5
    v_add_f32 v193, v193, v5
    s_waitcnt vmcnt(0)
    s_bitcmp1_b32 s97, 4
    s_mov_b64 exec, 1
    s_cbranch_scc1 .fs_512
    buffer_store_dword v12, v13, s[8:11], s92 offen
.fj_513:
    s_mov_b64 exec, -1
    v_add_u32 v12, 1, v12
    s_mov_b32 s62, 0
.hk_514:
    v_max3_u32 v4, v80, v84, v88
    v_max3_u32 v5, v92, v128, v130
    v_max3_u32 v4, v4, v132, v134
    v_max3_u32 v5, v5, v136, v138
    v_max3_u32 v4, v4, v140, v142
    v_max_u32 v4, v4, v5
    v_cmp_eq_u32 vcc, -1, v4
    s_cbranch_vccnz .hf_515

.hd_510:
    v_mfma_f32_16x16x32_bf16 v[152:155], v[80:83], a[0:3], 0
    v_mfma_f32_16x16x32_bf16 v[152:155], v[84:87], a[4:7], v[152:155]
    v_mfma_f32_16x16x32_bf16 v[152:155], v[88:91], a[8:11], v[152:155]
    v_mfma_f32_16x16x32_bf16 v[152:155], v[92:95], a[12:15], v[152:155]
    s_nop 7
    v_cndmask_b32 v152, v14, v152, s[60:61]
    v_cndmask_b32 v153, v14, v153, s[60:61]
    v_cndmask_b32 v154, v14, v154, s[60:61]
    v_cndmask_b32 v155, v14, v155, s[60:61]
    v_max3_f32 v4, v152, v153, v154
    v_max_f32 v4, v4, v155
    v_mov_b32 v5, v4
    s_nop 1
    v_permlane32_swap_b32 v4, v5
    v_max_f32 v4, v4, v5
    v_mov_b32 v5, v4
    s_nop 1
    v_permlane16_swap_b32 v4, v5
    v_max_f32 v4, v4, v5
    v_mul_f32 v4, s39, v4
    v_max_f32 v4, v4, v192
    v_sub_f32 v6, v192, v4
    v_fma_f32 v176, v152, s39, -v4
    v_fma_f32 v177, v153, s39, -v4
    v_fma_f32 v178, v154, s39, -v4
    v_fma_f32 v179, v155, s39, -v4
    v_exp_f32 v176, v176
    v_exp_f32 v177, v177
    v_exp_f32 v178, v178
    v_exp_f32 v179, v179
    v_exp_f32 v6, v6
    v_add_f32 v4, v176, v177
    v_add_f32 v5, v178, v179
    v_add_f32 v4, v4, v5

    v_mov_b32 v5, v4
    s_nop 1
    v_permlane32_swap_b32 v4, v5
    v_add_f32 v4, v4, v5
    v_mov_b32 v5, v4
    s_nop 1
    v_permlane16_swap_b32 v4, v5
    v_add_f32 v4, v4, v5
    v_fma_f32 v4, v6, v193, v4
    v_rcp_f32 v4, v4
    s_nop 0
    v_mul_f32 v6, v6, v4
    v_pk_mul_f32 v[176:177], v[176:177], v[4:5] op_sel_hi:[1,0]
    v_pk_mul_f32 v[178:179], v[178:179], v[4:5] op_sel_hi:[1,0]

    v_cvt_pk_bf16_f32 v184, v176, v177
    v_cvt_pk_bf16_f32 v185, v178, v179
    v_pk_mul_f32 v[16:17], v[16:17], v[6:7] op_sel_hi:[1,0]
    v_pk_mul_f32 v[18:19], v[18:19], v[6:7] op_sel_hi:[1,0]
    v_pk_mul_f32 v[20:21], v[20:21], v[6:7] op_sel_hi:[1,0]
    v_pk_mul_f32 v[22:23], v[22:23], v[6:7] op_sel_hi:[1,0]
    s_cmp_lt_u32 s25, s96
    s_cbranch_scc1 .hs_518
    v_mfma_f32_16x16x16_bf16 v[16:19], v[128:129], v[184:185], v[16:19]
    v_pk_mul_f32 v[24:25], v[24:25], v[6:7] op_sel_hi:[1,0]
    v_pk_mul_f32 v[26:27], v[26:27], v[6:7] op_sel_hi:[1,0]
    v_mfma_f32_16x16x16_bf16 v[20:23], v[130:131], v[184:185], v[20:23]
    v_pk_mul_f32 v[28:29], v[28:29], v[6:7] op_sel_hi:[1,0]
    v_pk_mul_f32 v[30:31], v[30:31], v[6:7] op_sel_hi:[1,0]
    v_mfma_f32_16x16x16_bf16 v[24:27], v[132:133], v[184:185], v[24:27]
    v_pk_mul_f32 v[32:33], v[32:33], v[6:7] op_sel_hi:[1,0]
    v_pk_mul_f32 v[34:35], v[34:35], v[6:7] op_sel_hi:[1,0]
    v_mfma_f32_16x16x16_bf16 v[28:31], v[134:135], v[184:185], v[28:31]
    v_pk_mul_f32 v[36:37], v[36:37], v[6:7] op_sel_hi:[1,0]
    v_pk_mul_f32 v[38:39], v[38:39], v[6:7] op_sel_hi:[1,0]
    v_mfma_f32_16x16x16_bf16 v[32:35], v[136:137], v[184:185], v[32:35]
    v_pk_mul_f32 v[40:41], v[40:41], v[6:7] op_sel_hi:[1,0]
    v_pk_mul_f32 v[42:43], v[42:43], v[6:7] op_sel_hi:[1,0]
    v_mfma_f32_16x16x16_bf16 v[36:39], v[138:139], v[184:185], v[36:39]
    v_pk_mul_f32 v[44:45], v[44:45], v[6:7] op_sel_hi:[1,0]
    v_pk_mul_f32 v[46:47], v[46:47], v[6:7] op_sel_hi:[1,0]
    v_mfma_f32_16x16x16_bf16 v[40:43], v[140:141], v[184:185], v[40:43]
    v_cvt_pk_bf16_f32 v208, v16, v17
    v_cvt_pk_bf16_f32 v209, v18, v19
    v_cvt_pk_bf16_f32 v210, v20, v21
    v_cvt_pk_bf16_f32 v211, v22, v23
    buffer_store_dwordx4 v[208:211], v8, s[8:11], s50 offen offset:0
    v_mfma_f32_16x16x16_bf16 v[44:47], v[142:143], v[184:185], v[44:47]
    v_cvt_pk_bf16_f32 v212, v24, v25
    v_cvt_pk_bf16_f32 v213, v26, v27
    v_cvt_pk_bf16_f32 v214, v28, v29
    v_cvt_pk_bf16_f32 v215, v30, v31
    buffer_store_dwordx4 v[212:215], v8, s[8:11], s50 offen offset:1024
    v_cvt_pk_bf16_f32 v216, v32, v33
    v_cvt_pk_bf16_f32 v217, v34, v35
    v_cvt_pk_bf16_f32 v218, v36, v37
    v_cvt_pk_bf16_f32 v219, v38, v39
    buffer_store_dwordx4 v[216:219], v8, s[8:11], s50 offen offset:2048
    v_cvt_pk_bf16_f32 v220, v40, v41
    v_cvt_pk_bf16_f32 v221, v42, v43
    v_cvt_pk_bf16_f32 v222, v44, v45
    v_cvt_pk_bf16_f32 v223, v46, v47
    buffer_store_dwordx4 v[220:223], v8, s[8:11], s50 offen offset:3072
    s_cmp_lg_u32 s52, 0
    s_cbranch_scc1 .hb_511
    s_waitcnt vmcnt(0)
    s_mov_b64 exec, 1
    buffer_store_dword v12, v13, s[8:11], s92 offen
    s_mov_b64 exec, -1
    s_branch .ate_495
.ah1_477:
    s_mov_b32 s34, s33
    s_add_u32 s50, s27, 4096
    s_mov_b32 s39, 0x3e0293ee
    v_lshlrev_b32 v5, 2, v8
    s_waitcnt vmcnt(8)
    buffer_load_dword v205, v5, s[8:11], s50 offen
    s_add_u32 s25, s25, 4

    s_mov_b32 s52, 1
    s_branch .hd_519
.hb_520:
    s_mov_b32 s52, 0
    v_mfma_f32_16x16x32_bf16 v[144:147], a[128:131], a[112:115], 0
    v_mfma_f32_16x16x32_bf16 v[148:151], a[144:147], a[112:115], 0
    v_mfma_f32_16x16x32_bf16 v[144:147], a[132:135], a[116:119], v[144:147]
    v_mfma_f32_16x16x32_bf16 v[148:151], a[148:151], a[116:119], v[148:151]
    v_mfma_f32_16x16x32_bf16 v[144:147], a[136:139], a[120:123], v[144:147]
    v_mfma_f32_16x16x32_bf16 v[148:151], a[152:155], a[120:123], v[148:151]
    v_mfma_f32_16x16x32_bf16 v[144:147], a[140:143], a[124:127], v[144:147]
    v_mfma_f32_16x16x32_bf16 v[148:151], a[156:159], a[124:127], v[148:151]
    s_nop 7
    v_cvt_pk_bf16_f32 v168, v144, v145
    v_cvt_pk_bf16_f32 v170, v146, v147
    v_cvt_pk_bf16_f32 v172, v148, v149
    v_cvt_pk_bf16_f32 v174, v150, v151
    v_and_b32 v169, 0xffff0000, v168
    v_lshlrev_b32 v168, 16, v168
    v_and_b32 v171, 0xffff0000, v170
    v_lshlrev_b32 v170, 16, v170
    v_and_b32 v173, 0xffff0000, v172
    v_lshlrev_b32 v172, 16, v172
    v_and_b32 v175, 0xffff0000, v174
    v_lshlrev_b32 v174, 16, v174
    v_mul_f32 v168, s37, v168
    v_mul_f32 v169, s37, v169
    v_mul_f32 v170, s37, v170
    v_mul_f32 v171, s37, v171
    v_mul_f32 v172, s37, v172
    v_mul_f32 v173, s37, v173
    v_mul_f32 v174, s37, v174
    v_mul_f32 v175, s37, v175
    v_cvt_pk_bf16_f32 v144, v168, v169
    v_cvt_pk_bf16_f32 v146, v170, v171
    v_cvt_pk_bf16_f32 v148, v172, v173
    v_cvt_pk_bf16_f32 v150, v174, v175
    v_and_b32 v145, 0xffff0000, v144
    v_lshlrev_b32 v144, 16, v144
    v_and_b32 v147, 0xffff0000, v146
    v_lshlrev_b32 v146, 16, v146
    v_and_b32 v149, 0xffff0000, v148
    v_lshlrev_b32 v148, 16, v148
    v_and_b32 v151, 0xffff0000, v150
    v_lshlrev_b32 v150, 16, v150
    v_cndmask_b32 v148, v14, v148, s[40:41]
    v_cndmask_b32 v149, v14, v149, s[42:43]
    v_cndmask_b32 v150, v14, v150, s[44:45]
    v_cndmask_b32 v151, v14, v151, s[46:47]
    v_max3_f32 v192, v144, v145, v146
    v_max_f32 v192, v192, v147
    v_max3_f32 v192, v192, v148, v149
    v_max3_f32 v192, v192, v150, v151
    v_mov_b32 v5, v192
    s_nop 1
    v_permlane32_swap_b32 v192, v5
    v_max_f32 v192, v192, v5
    v_mov_b32 v5, v192
    s_nop 1
    v_permlane16_swap_b32 v192, v5
    v_max_f32 v192, v192, v5
    v_mul_f32 v192, s38, v192
    v_mov_b32 v182, 0
    v_mov_b32 v183, 0
    v_fma_f32 v168, v144, s38, -v192
    v_fma_f32 v169, v145, s38, -v192
    v_fma_f32 v170, v146, s38, -v192
    v_fma_f32 v171, v147, s38, -v192
    v_fma_f32 v172, v148, s38, -v192
    v_fma_f32 v173, v149, s38, -v192
    v_fma_f32 v174, v150, s38, -v192
    v_fma_f32 v175, v151, s38, -v192
    v_exp_f32 v168, v168
    v_exp_f32 v169, v169
    v_exp_f32 v170, v170
    v_exp_f32 v171, v171
    v_exp_f32 v172, v172
    v_exp_f32 v173, v173
    v_exp_f32 v174, v174
    v_exp_f32 v175, v175
    s_nop 0
    v_cvt_pk_bf16_f32 v180, v168, v169
    v_cvt_pk_bf16_f32 v181, v170, v171
    v_cvt_pk_bf16_f32 v182, v172, v173
    v_cvt_pk_bf16_f32 v183, v174, v175
    v_add_f32 v193, v168, v169
    v_add_f32 v193, v193, v170
    v_add_f32 v193, v193, v171
    v_add_f32 v193, v193, v172
    v_add_f32 v193, v193, v173
    v_add_f32 v193, v193, v174
    v_add_f32 v193, v193, v175
    v_mfma_f32_16x16x32_bf16 v[16:19], a[160:163], v[180:183], 0
    v_mfma_f32_16x16x32_bf16 v[20:23], a[164:167], v[180:183], 0
    v_mfma_f32_16x16x32_bf16 v[24:27], a[168:171], v[180:183], 0
    v_mfma_f32_16x16x32_bf16 v[28:31], a[172:175], v[180:183], 0
    v_mfma_f32_16x16x32_bf16 v[32:35], a[176:179], v[180:183], 0
    v_mfma_f32_16x16x32_bf16 v[36:39], a[180:183], v[180:183], 0
    v_mfma_f32_16x16x32_bf16 v[40:43], a[184:187], v[180:183], 0
    v_mfma_f32_16x16x32_bf16 v[44:47], a[188:191], v[180:183], 0
    v_mov_b32 v5, v193
    s_nop 1
    v_permlane32_swap_b32 v193, v5
    v_add_f32 v193, v193, v5
    v_mov_b32 v5, v193
    s_nop 1
    v_permlane16_swap_b32 v193, v5
    v_add_f32 v193, v193, v5
    s_waitcnt vmcnt(0)
    s_bitcmp1_b32 s97, 4
    s_mov_b64 exec, 1
    s_cbranch_scc1 .fs_521
    buffer_store_dword v12, v13, s[8:11], s92 offen
.fj_522:
    s_mov_b64 exec, -1
    v_add_u32 v12, 1, v12
    s_mov_b32 s62, 0
.hk_523:
    v_max3_u32 v4, v96, v100, v104
    v_max3_u32 v5, v108, v112, v114
    v_max3_u32 v4, v4, v116, v118
    v_max3_u32 v5, v5, v120, v122
    v_max3_u32 v4, v4, v124, v126
    v_max_u32 v4, v4, v5
    v_cmp_eq_u32 vcc, -1, v4
    s_cbranch_vccnz .hf_524

.hd_519:
    v_mfma_f32_16x16x32_bf16 v[152:155], v[96:99], a[112:115], 0
    v_mfma_f32_16x16x32_bf16 v[152:155], v[100:103], a[116:119], v[152:155]
    v_mfma_f32_16x16x32_bf16 v[152:155], v[104:107], a[120:123], v[152:155]
    v_mfma_f32_16x16x32_bf16 v[152:155], v[108:111], a[124:127], v[152:155]
    s_nop 7
    v_cndmask_b32 v152, v14, v152, s[60:61]
    v_cndmask_b32 v153, v14, v153, s[60:61]
    v_cndmask_b32 v154, v14, v154, s[60:61]
    v_cndmask_b32 v155, v14, v155, s[60:61]
    v_max3_f32 v4, v152, v153, v154
    v_max_f32 v4, v4, v155
    v_mov_b32 v5, v4
    s_nop 1
    v_permlane32_swap_b32 v4, v5
    v_max_f32 v4, v4, v5
    v_mov_b32 v5, v4
    s_nop 1
    v_permlane16_swap_b32 v4, v5
    v_max_f32 v4, v4, v5
    v_mul_f32 v4, s39, v4
    v_max_f32 v4, v4, v192
    v_sub_f32 v6, v192, v4
    v_fma_f32 v176, v152, s39, -v4
    v_fma_f32 v177, v153, s39, -v4
    v_fma_f32 v178, v154, s39, -v4
    v_fma_f32 v179, v155, s39, -v4
    v_exp_f32 v176, v176
    v_exp_f32 v177, v177
    v_exp_f32 v178, v178
    v_exp_f32 v179, v179
    v_exp_f32 v6, v6
    v_add_f32 v4, v176, v177
    v_add_f32 v5, v178, v179
    v_add_f32 v4, v4, v5

    v_mov_b32 v5, v4
    s_nop 1
    v_permlane32_swap_b32 v4, v5
    v_add_f32 v4, v4, v5
    v_mov_b32 v5, v4
    s_nop 1
    v_permlane16_swap_b32 v4, v5
    v_add_f32 v4, v4, v5
    v_fma_f32 v4, v6, v193, v4
    v_rcp_f32 v4, v4
    s_nop 0
    v_mul_f32 v6, v6, v4
    v_pk_mul_f32 v[176:177], v[176:177], v[4:5] op_sel_hi:[1,0]
    v_pk_mul_f32 v[178:179], v[178:179], v[4:5] op_sel_hi:[1,0]

    v_cvt_pk_bf16_f32 v184, v176, v177
    v_cvt_pk_bf16_f32 v185, v178, v179
    v_pk_mul_f32 v[16:17], v[16:17], v[6:7] op_sel_hi:[1,0]
    v_pk_mul_f32 v[18:19], v[18:19], v[6:7] op_sel_hi:[1,0]
    v_pk_mul_f32 v[20:21], v[20:21], v[6:7] op_sel_hi:[1,0]
    v_pk_mul_f32 v[22:23], v[22:23], v[6:7] op_sel_hi:[1,0]
    s_cmp_lt_u32 s25, s96
    s_cbranch_scc1 .hs_527
    v_mfma_f32_16x16x16_bf16 v[16:19], v[112:113], v[184:185], v[16:19]
    v_pk_mul_f32 v[24:25], v[24:25], v[6:7] op_sel_hi:[1,0]
    v_pk_mul_f32 v[26:27], v[26:27], v[6:7] op_sel_hi:[1,0]
    v_mfma_f32_16x16x16_bf16 v[20:23], v[114:115], v[184:185], v[20:23]
    v_pk_mul_f32 v[28:29], v[28:29], v[6:7] op_sel_hi:[1,0]
    v_pk_mul_f32 v[30:31], v[30:31], v[6:7] op_sel_hi:[1,0]
    v_mfma_f32_16x16x16_bf16 v[24:27], v[116:117], v[184:185], v[24:27]
    v_pk_mul_f32 v[32:33], v[32:33], v[6:7] op_sel_hi:[1,0]
    v_pk_mul_f32 v[34:35], v[34:35], v[6:7] op_sel_hi:[1,0]
    v_mfma_f32_16x16x16_bf16 v[28:31], v[118:119], v[184:185], v[28:31]
    v_pk_mul_f32 v[36:37], v[36:37], v[6:7] op_sel_hi:[1,0]
    v_pk_mul_f32 v[38:39], v[38:39], v[6:7] op_sel_hi:[1,0]
    v_mfma_f32_16x16x16_bf16 v[32:35], v[120:121], v[184:185], v[32:35]
    v_pk_mul_f32 v[40:41], v[40:41], v[6:7] op_sel_hi:[1,0]
    v_pk_mul_f32 v[42:43], v[42:43], v[6:7] op_sel_hi:[1,0]
    v_mfma_f32_16x16x16_bf16 v[36:39], v[122:123], v[184:185], v[36:39]
    v_pk_mul_f32 v[44:45], v[44:45], v[6:7] op_sel_hi:[1,0]
    v_pk_mul_f32 v[46:47], v[46:47], v[6:7] op_sel_hi:[1,0]
    v_mfma_f32_16x16x16_bf16 v[40:43], v[124:125], v[184:185], v[40:43]
    v_cvt_pk_bf16_f32 v208, v16, v17
    v_cvt_pk_bf16_f32 v209, v18, v19
    v_cvt_pk_bf16_f32 v210, v20, v21
    v_cvt_pk_bf16_f32 v211, v22, v23
    buffer_store_dwordx4 v[208:211], v8, s[8:11], s50 offen offset:0
    v_mfma_f32_16x16x16_bf16 v[44:47], v[126:127], v[184:185], v[44:47]
    v_cvt_pk_bf16_f32 v212, v24, v25
    v_cvt_pk_bf16_f32 v213, v26, v27
    v_cvt_pk_bf16_f32 v214, v28, v29
    v_cvt_pk_bf16_f32 v215, v30, v31
    buffer_store_dwordx4 v[212:215], v8, s[8:11], s50 offen offset:1024
    v_cvt_pk_bf16_f32 v216, v32, v33
    v_cvt_pk_bf16_f32 v217, v34, v35
    v_cvt_pk_bf16_f32 v218, v36, v37
    v_cvt_pk_bf16_f32 v219, v38, v39
    buffer_store_dwordx4 v[216:219], v8, s[8:11], s50 offen offset:2048
    v_cvt_pk_bf16_f32 v220, v40, v41
    v_cvt_pk_bf16_f32 v221, v42, v43
    v_cvt_pk_bf16_f32 v222, v44, v45
    v_cvt_pk_bf16_f32 v223, v46, v47
    buffer_store_dwordx4 v[220:223], v8, s[8:11], s50 offen offset:3072
    s_cmp_lg_u32 s52, 0
    s_cbranch_scc1 .hb_520
    s_waitcnt vmcnt(0)
    s_mov_b64 exec, 1
    buffer_store_dword v12, v13, s[8:11], s92 offen
    s_mov_b64 exec, -1
    s_branch .ate_495
.fs_496:
    buffer_store_dword v12, v13, s[8:11], s92 offen sc1
    s_branch .fj_497
.fs_501:
    buffer_store_dword v12, v13, s[8:11], s92 offen sc1
    s_branch .fj_502
.fs_507:
    buffer_store_dword v12, v13, s[8:11], s92 offen sc1
    s_branch .fj_508
.fs_512:
    buffer_store_dword v12, v13, s[8:11], s92 offen sc1
    s_branch .fj_513
.hf_515:
    s_cmp_lg_u32 s62, 0
    s_cbranch_scc1 .hn_516
    s_sub_u32 s5, s34, 196608
    s_mov_b64 exec, 15

.hq_517:
    s_sleep 4
    buffer_load_dword v4, v204, s[8:11], s5 offen sc1
    s_add_u32 s62, s62, 1
    s_cmp_gt_u32 s62, 0x200000
    s_cbranch_scc1 .mg_end_1
    s_waitcnt vmcnt(0)
    v_cmp_eq_u32 vcc, -1, v4
    s_cbranch_vccnz .hq_517
    s_mov_b64 exec, -1

.hn_516:
    s_sleep 1
    buffer_load_dwordx4 v[80:83], v10, s[8:11], s34 offen offset:2048 sc1
    buffer_load_dwordx4 v[84:87], v10, s[8:11], s34 offen offset:2176 sc1
    buffer_load_dwordx4 v[88:91], v10, s[8:11], s34 offen offset:3072 sc1
    buffer_load_dwordx4 v[92:95], v10, s[8:11], s34 offen offset:3200 sc1
    s_add_u32 s4, s34, 4096
    s_mov_b64 exec, s[60:61]
    buffer_load_dwordx2 v[128:129], v11, s[8:11], s4 offen offset:0 sc1
    buffer_load_dwordx2 v[130:131], v11, s[8:11], s4 offen offset:256 sc1
    buffer_load_dwordx2 v[132:133], v11, s[8:11], s4 offen offset:512 sc1
    buffer_load_dwordx2 v[134:135], v11, s[8:11], s4 offen offset:768 sc1
    buffer_load_dwordx2 v[136:137], v11, s[8:11], s4 offen offset:1024 sc1
    buffer_load_dwordx2 v[138:139], v11, s[8:11], s4 offen offset:1280 sc1
    buffer_load_dwordx2 v[140:141], v11, s[8:11], s4 offen offset:1536 sc1
    buffer_load_dwordx2 v[142:143], v11, s[8:11], s4 offen offset:1792 sc1
    s_mov_b64 exec, -1
    s_add_u32 s62, s62, 1
    s_cmp_gt_u32 s62, 0x200000
    s_cbranch_scc1 .mg_end_1
    s_waitcnt vmcnt(0)
    s_branch .hk_514

.hs_518:
    v_mfma_f32_16x16x16_bf16 v[16:19], v[128:129], v[184:185], v[16:19]
    v_pk_mul_f32 v[24:25], v[24:25], v[6:7] op_sel_hi:[1,0]
    v_pk_mul_f32 v[26:27], v[26:27], v[6:7] op_sel_hi:[1,0]
    v_mfma_f32_16x16x16_bf16 v[20:23], v[130:131], v[184:185], v[20:23]
    v_pk_mul_f32 v[28:29], v[28:29], v[6:7] op_sel_hi:[1,0]
    v_pk_mul_f32 v[30:31], v[30:31], v[6:7] op_sel_hi:[1,0]
    v_mfma_f32_16x16x16_bf16 v[24:27], v[132:133], v[184:185], v[24:27]
    v_pk_mul_f32 v[32:33], v[32:33], v[6:7] op_sel_hi:[1,0]
    v_pk_mul_f32 v[34:35], v[34:35], v[6:7] op_sel_hi:[1,0]
    v_mfma_f32_16x16x16_bf16 v[28:31], v[134:135], v[184:185], v[28:31]
    v_pk_mul_f32 v[36:37], v[36:37], v[6:7] op_sel_hi:[1,0]
    v_pk_mul_f32 v[38:39], v[38:39], v[6:7] op_sel_hi:[1,0]
    v_mfma_f32_16x16x16_bf16 v[32:35], v[136:137], v[184:185], v[32:35]
    v_pk_mul_f32 v[40:41], v[40:41], v[6:7] op_sel_hi:[1,0]
    v_pk_mul_f32 v[42:43], v[42:43], v[6:7] op_sel_hi:[1,0]
    v_mfma_f32_16x16x16_bf16 v[36:39], v[138:139], v[184:185], v[36:39]
    v_pk_mul_f32 v[44:45], v[44:45], v[6:7] op_sel_hi:[1,0]
    v_pk_mul_f32 v[46:47], v[46:47], v[6:7] op_sel_hi:[1,0]
    v_mfma_f32_16x16x16_bf16 v[40:43], v[140:141], v[184:185], v[40:43]
    v_cvt_pk_bf16_f32 v208, v16, v17
    v_cvt_pk_bf16_f32 v209, v18, v19
    v_cvt_pk_bf16_f32 v210, v20, v21
    v_cvt_pk_bf16_f32 v211, v22, v23
    buffer_store_dwordx4 v[208:211], v8, s[8:11], s50 offen offset:0 sc1
    v_mfma_f32_16x16x16_bf16 v[44:47], v[142:143], v[184:185], v[44:47]
    v_cvt_pk_bf16_f32 v212, v24, v25
    v_cvt_pk_bf16_f32 v213, v26, v27
    v_cvt_pk_bf16_f32 v214, v28, v29
    v_cvt_pk_bf16_f32 v215, v30, v31
    buffer_store_dwordx4 v[212:215], v8, s[8:11], s50 offen offset:1024 sc1
    v_cvt_pk_bf16_f32 v216, v32, v33
    v_cvt_pk_bf16_f32 v217, v34, v35
    v_cvt_pk_bf16_f32 v218, v36, v37
    v_cvt_pk_bf16_f32 v219, v38, v39
    buffer_store_dwordx4 v[216:219], v8, s[8:11], s50 offen offset:2048 sc1
    v_cvt_pk_bf16_f32 v220, v40, v41
    v_cvt_pk_bf16_f32 v221, v42, v43
    v_cvt_pk_bf16_f32 v222, v44, v45
    v_cvt_pk_bf16_f32 v223, v46, v47
    buffer_store_dwordx4 v[220:223], v8, s[8:11], s50 offen offset:3072 sc1
    s_cmp_lg_u32 s52, 0
    s_cbranch_scc1 .hb_511
    s_branch .ahz_478
.fs_521:
    buffer_store_dword v12, v13, s[8:11], s92 offen sc1
    s_branch .fj_522
.hf_524:
    s_cmp_lg_u32 s62, 0
    s_cbranch_scc1 .hn_525
    s_sub_u32 s5, s34, 196608
    s_mov_b64 exec, 15

.hq_526:
    s_sleep 4
    buffer_load_dword v4, v204, s[8:11], s5 offen sc1
    s_add_u32 s62, s62, 1
    s_cmp_gt_u32 s62, 0x200000
    s_cbranch_scc1 .mg_end_1
    s_waitcnt vmcnt(0)
    v_cmp_eq_u32 vcc, -1, v4
    s_cbranch_vccnz .hq_526
    s_mov_b64 exec, -1

.hn_525:
    s_sleep 1
    buffer_load_dwordx4 v[96:99], v10, s[8:11], s34 offen offset:2048 sc1
    buffer_load_dwordx4 v[100:103], v10, s[8:11], s34 offen offset:2176 sc1
    buffer_load_dwordx4 v[104:107], v10, s[8:11], s34 offen offset:3072 sc1
    buffer_load_dwordx4 v[108:111], v10, s[8:11], s34 offen offset:3200 sc1
    s_add_u32 s4, s34, 4096
    s_mov_b64 exec, s[60:61]
    buffer_load_dwordx2 v[112:113], v11, s[8:11], s4 offen offset:0 sc1
    buffer_load_dwordx2 v[114:115], v11, s[8:11], s4 offen offset:256 sc1
    buffer_load_dwordx2 v[116:117], v11, s[8:11], s4 offen offset:512 sc1
    buffer_load_dwordx2 v[118:119], v11, s[8:11], s4 offen offset:768 sc1
    buffer_load_dwordx2 v[120:121], v11, s[8:11], s4 offen offset:1024 sc1
    buffer_load_dwordx2 v[122:123], v11, s[8:11], s4 offen offset:1280 sc1
    buffer_load_dwordx2 v[124:125], v11, s[8:11], s4 offen offset:1536 sc1
    buffer_load_dwordx2 v[126:127], v11, s[8:11], s4 offen offset:1792 sc1
    s_mov_b64 exec, -1
    s_add_u32 s62, s62, 1
    s_cmp_gt_u32 s62, 0x200000
    s_cbranch_scc1 .mg_end_1
    s_waitcnt vmcnt(0)
    s_branch .hk_523

.hs_527:
    v_mfma_f32_16x16x16_bf16 v[16:19], v[112:113], v[184:185], v[16:19]
    v_pk_mul_f32 v[24:25], v[24:25], v[6:7] op_sel_hi:[1,0]
    v_pk_mul_f32 v[26:27], v[26:27], v[6:7] op_sel_hi:[1,0]
    v_mfma_f32_16x16x16_bf16 v[20:23], v[114:115], v[184:185], v[20:23]
    v_pk_mul_f32 v[28:29], v[28:29], v[6:7] op_sel_hi:[1,0]
    v_pk_mul_f32 v[30:31], v[30:31], v[6:7] op_sel_hi:[1,0]
    v_mfma_f32_16x16x16_bf16 v[24:27], v[116:117], v[184:185], v[24:27]
    v_pk_mul_f32 v[32:33], v[32:33], v[6:7] op_sel_hi:[1,0]
    v_pk_mul_f32 v[34:35], v[34:35], v[6:7] op_sel_hi:[1,0]
    v_mfma_f32_16x16x16_bf16 v[28:31], v[118:119], v[184:185], v[28:31]
    v_pk_mul_f32 v[36:37], v[36:37], v[6:7] op_sel_hi:[1,0]
    v_pk_mul_f32 v[38:39], v[38:39], v[6:7] op_sel_hi:[1,0]
    v_mfma_f32_16x16x16_bf16 v[32:35], v[120:121], v[184:185], v[32:35]
    v_pk_mul_f32 v[40:41], v[40:41], v[6:7] op_sel_hi:[1,0]
    v_pk_mul_f32 v[42:43], v[42:43], v[6:7] op_sel_hi:[1,0]
    v_mfma_f32_16x16x16_bf16 v[36:39], v[122:123], v[184:185], v[36:39]
    v_pk_mul_f32 v[44:45], v[44:45], v[6:7] op_sel_hi:[1,0]
    v_pk_mul_f32 v[46:47], v[46:47], v[6:7] op_sel_hi:[1,0]
    v_mfma_f32_16x16x16_bf16 v[40:43], v[124:125], v[184:185], v[40:43]
    v_cvt_pk_bf16_f32 v208, v16, v17
    v_cvt_pk_bf16_f32 v209, v18, v19
    v_cvt_pk_bf16_f32 v210, v20, v21
    v_cvt_pk_bf16_f32 v211, v22, v23
    buffer_store_dwordx4 v[208:211], v8, s[8:11], s50 offen offset:0 sc1
    v_mfma_f32_16x16x16_bf16 v[44:47], v[126:127], v[184:185], v[44:47]
    v_cvt_pk_bf16_f32 v212, v24, v25
    v_cvt_pk_bf16_f32 v213, v26, v27
    v_cvt_pk_bf16_f32 v214, v28, v29
    v_cvt_pk_bf16_f32 v215, v30, v31
    buffer_store_dwordx4 v[212:215], v8, s[8:11], s50 offen offset:1024 sc1
    v_cvt_pk_bf16_f32 v216, v32, v33
    v_cvt_pk_bf16_f32 v217, v34, v35
    v_cvt_pk_bf16_f32 v218, v36, v37
    v_cvt_pk_bf16_f32 v219, v38, v39
    buffer_store_dwordx4 v[216:219], v8, s[8:11], s50 offen offset:2048 sc1
    v_cvt_pk_bf16_f32 v220, v40, v41
    v_cvt_pk_bf16_f32 v221, v42, v43
    v_cvt_pk_bf16_f32 v222, v44, v45
    v_cvt_pk_bf16_f32 v223, v46, v47
    buffer_store_dwordx4 v[220:223], v8, s[8:11], s50 offen offset:3072 sc1
    s_cmp_lg_u32 s52, 0
    s_cbranch_scc1 .hb_520
    s_branch .ahz_478
.ate_495:
.mg_end_1:
    s_endpgm
.section .rodata,"a"
.p2align 6
.amdhsa_kernel mega_kernel
  .amdhsa_next_free_vgpr 512
  .amdhsa_next_free_sgpr 102
  .amdhsa_accum_offset 256
  .amdhsa_group_segment_fixed_size 0
  .amdhsa_kernarg_size 136
  .amdhsa_user_sgpr_count 2
  .amdhsa_user_sgpr_kernarg_segment_ptr 1
  .amdhsa_system_sgpr_workgroup_id_x 1
.end_amdhsa_kernel
```

```asm
; @launch kernel=mega_kernel grid=(256,1,1) block=(256,1,1) lds=163840
.amdgcn_target "amdgcn-amd-amdhsa--gfx950"
.text
.globl mega_kernel
.p2align 8
.type mega_kernel,@function
mega_kernel:
    s_cmp_ge_u32 s2, 256
    s_cbranch_scc1 .mg_end_1

    s_load_dwordx4 s[52:55], s[0:1], 120
    s_load_dwordx2 s[40:41], s[0:1], 56
    s_getreg_b32 s3, hwreg(HW_REG_XCC_ID)
    v_and_b32 v1, 63, v0
    v_lshrrev_b32 v4, 6, v0
    s_and_b32 s3, s3, 7
    v_readfirstlane_b32 s24, v4
    s_waitcnt lgkmcnt(0)

    s_mov_b32 s8, s54
    s_and_b32 s9, s55, 0xffff
    s_mov_b32 s10, 0x10000000
    s_mov_b32 s11, 0x00020000

    s_mov_b32 s20, s52
    s_and_b32 s21, s53, 0xffff
    s_mov_b32 s22, 0x100
    s_mov_b32 s23, 0x00020000

    s_mov_b32 s100, s54
    s_cmp_lg_u32 s24, 0
    s_cbranch_scc1 .noat_4
    s_mov_b64 exec, 1
    v_mov_b32 v5, 1
    s_lshl_b32 s4, s3, 2
    s_lshl_b32 s4, s3, 5
    s_add_u32 s4, s4, 28
    v_mov_b32 v6, s4
    buffer_atomic_add v5, v6, s[20:23], 0 offen sc0 sc1
    v_mov_b32 v7, 163776
    s_waitcnt vmcnt(0)
    ds_write_b32 v7, v5
    v_cmp_lt_u32 vcc, 31, v5
    s_cbranch_vccz .nb_5
    v_mov_b32 v6, 136
    buffer_store_dword v7, v6, s[20:23], 0 offen sc1

.nb_5:
    s_waitcnt lgkmcnt(0)
    s_mov_b64 exec, -1

.noat_4:
    s_barrier
    v_mov_b32 v7, 163776
    ds_read_b32 v5, v7
    s_waitcnt lgkmcnt(0)
    v_readfirstlane_b32 s26, v5
    s_mov_b32 s25, s3
    s_mov_b32 s27, 0
    s_mov_b32 s97, 128
    s_cmp_lt_u32 s26, 32
    s_cselect_b32 s99, 1, 0
    s_and_b32 s26, s26, 31

.mg_role_3:
    s_cmp_ge_u32 s25, 4
    s_cbranch_scc1 .mg_bg_2

    s_load_dwordx8 s[44:51], s[0:1], 64
    s_load_dwordx2 s[40:41], s[0:1], 56
    v_and_b32 v1, 63, v0
    v_and_b32 v2, 15, v1
    v_lshrrev_b32 v3, 4, v1

    s_lshr_b32 s79, s26, 2
    s_xor_b32 s63, s26, 4
    s_and_b32 s78, s24, 1
    s_lshl_b32 s34, s25, 19
    s_add_u32 s34, s34, 83886080
    v_lshlrev_b32 v14, 4, v1
    v_lshrrev_b32 v6, 1, v3
    s_sub_u32 s101, 0, s100
    s_and_b32 s101, s101, 0x1fffff
    s_add_u32 s101, s101, 100663296

    v_mov_b32 v188, -1
    v_mov_b32 v189, -1
    v_mov_b32 v190, -1
    v_mov_b32 v191, -1
    s_lshl_b32 s5, s26, 10
    s_add_u32 s5, s5, 40960
    v_add_u32 v235, s5, v14
    s_lshr_b32 s4, s63, 3
    s_mul_i32 s4, s4, 1024
    s_lshl_b32 s5, s63, 9
    s_add_u32 s76, s4, s5
    s_lshl_b32 s5, s26, 9
    s_xor_b32 s5, s5, 1024
    s_lshr_b32 s4, s26, 4
    s_mul_i32 s4, s4, 0
    s_add_u32 s77, s4, s5
    s_add_u32 s77, s77, 20480
    s_sub_u32 s4, s77, s76
    v_and_b32 v4, 31, v1
    v_lshlrev_b32 v236, 4, v4
    v_mad_u32_u24 v236, v6, s4, v236
    v_add_u32 v236, s76, v236
    s_and_b32 s5, s63, 7
    s_lshl_b32 s4, s5, 10
    s_lshr_b32 s5, s63, 3
    s_lshl_b32 s5, s5, 14
    s_add_u32 s4, s4, s5
    s_add_u32 s35, s4, s101
    s_lshl_b32 s5, s25, 16
    v_add_u32 v238, s5, v14
    s_lshl_b32 s4, s25, 3
    s_add_u32 s7, s4, s79
    s_mul_i32 s36, s7, 6144
    s_add_u32 s36, s36, 67108864

    s_cmp_eq_u32 s78, 0
    s_cselect_b64 vcc, -1, 0
    s_lshr_b32 s6, s24, 1
    s_lshl_b32 s4, s6, 17
    s_add_u32 s4, s4, s34
    v_cndmask_b32 v4, v235, v236, vcc
    s_mul_i32 s5, s6, 1048576
    s_lshl_b32 s6, s78, 13
    buffer_store_dwordx4 v[188:191], v4, s[8:11], s4 offen sc1
    s_add_u32 s5, s5, s6
    s_add_u32 s5, s5, s35

    buffer_store_dwordx4 v[188:191], v238, s[8:11], s5 offen sc1
    s_add_u32 s5, s5, 262144
    buffer_store_dwordx4 v[188:191], v238, s[8:11], s5 offen sc1
    s_add_u32 s5, s5, 262144
    s_lshl_b32 s4, s25, 11
    s_lshl_b32 s5, s26, 6
    s_add_u32 s4, s4, s5
    s_lshl_b32 s5, s24, 21
    s_add_u32 s4, s4, s5
    v_lshrrev_b32 v4, 2, v1
    v_and_b32 v5, 3, v1
    v_lshlrev_b32 v5, 4, v5
    v_lshlrev_b32 v6, 13, v4
    v_add_u32 v6, v6, v5
    v_add_u32 v240, s4, v6
    s_lshl_b32 s4, s25, 2
    s_and_b32 s5, s24, 1
    s_lshl_b32 s5, s5, 1
    s_add_u32 s4, s4, s5
    s_lshr_b32 s5, s24, 1
    s_lshl_b32 s80, s5, 1
    s_lshl_b32 s4, s4, 19
    s_lshl_b32 s5, s63, 6
    s_add_u32 s4, s4, s5
    v_xor_b32 v224, 128, v240
    v_lshlrev_b32 v6, 11, v4
    v_add_u32 v6, v6, v5
    v_add_u32 v241, s4, v6
    s_lshl_b32 s98, s24, 15
    s_waitcnt lgkmcnt(0)

    s_add_u32 s80, s80, s79
    s_add_u32 s81, s80, 2
    s_add_u32 s80, s80, 1
    s_and_b32 s80, s80, 3
    s_and_b32 s81, s81, 3
    s_lshl_b32 s80, s80, 18
    s_lshl_b32 s81, s81, 18

    s_barrier
    s_bitcmp1_b32 s26, 0
    s_cbranch_scc1 .po_7
    s_mov_b32 s16, s44
    s_and_b32 s17, s45, 0xffff
    s_mov_b32 s18, 0x800000
    s_mov_b32 s19, 0x00020000

    s_add_u32 m0, s98, 0
    s_mov_b32 s5, 0
    buffer_load_dwordx4 v240, s[16:19], s5 offen  lds

    s_add_u32 m0, s98, 1024
    s_mov_b32 s5, 131072
    buffer_load_dwordx4 v240, s[16:19], s5 offen  lds

    s_add_u32 m0, s98, 2048
    s_mov_b32 s5, 262144
    buffer_load_dwordx4 v240, s[16:19], s5 offen  lds

    s_add_u32 m0, s98, 3072
    s_mov_b32 s5, 393216
    buffer_load_dwordx4 v240, s[16:19], s5 offen  lds

    s_add_u32 m0, s98, 4096
    s_mov_b32 s5, 524288
    buffer_load_dwordx4 v240, s[16:19], s5 offen  lds

    s_add_u32 m0, s98, 5120
    s_mov_b32 s5, 655360
    buffer_load_dwordx4 v240, s[16:19], s5 offen  lds

    s_add_u32 m0, s98, 6144
    s_mov_b32 s5, 786432
    buffer_load_dwordx4 v240, s[16:19], s5 offen  lds

    s_add_u32 m0, s98, 7168
    s_mov_b32 s5, 917504
    buffer_load_dwordx4 v240, s[16:19], s5 offen  lds

    s_branch .pj_8
.po_7:
    s_mov_b32 s16, s44
    s_and_b32 s17, s45, 0xffff
    s_mov_b32 s18, 0x800000
    s_mov_b32 s19, 0x00020000

    s_add_u32 m0, s98, 8192
    s_mov_b32 s5, 1048576
    buffer_load_dwordx4 v240, s[16:19], s5 offen  lds

    s_add_u32 m0, s98, 9216
    s_mov_b32 s5, 1179648
    buffer_load_dwordx4 v240, s[16:19], s5 offen  lds

    s_add_u32 m0, s98, 10240
    s_mov_b32 s5, 1310720
    buffer_load_dwordx4 v240, s[16:19], s5 offen  lds

    s_add_u32 m0, s98, 11264
    s_mov_b32 s5, 1441792
    buffer_load_dwordx4 v240, s[16:19], s5 offen  lds

    s_add_u32 m0, s98, 12288
    s_mov_b32 s5, 1572864
    buffer_load_dwordx4 v240, s[16:19], s5 offen  lds

    s_add_u32 m0, s98, 13312
    s_mov_b32 s5, 1703936
    buffer_load_dwordx4 v240, s[16:19], s5 offen  lds

    s_add_u32 m0, s98, 14336
    s_mov_b32 s5, 1835008
    buffer_load_dwordx4 v240, s[16:19], s5 offen  lds

    s_add_u32 m0, s98, 15360
    s_mov_b32 s5, 1966080
    buffer_load_dwordx4 v240, s[16:19], s5 offen  lds

.pj_8:
    s_waitcnt vmcnt(8)
    s_barrier
    v_mov_b32 v243, s99
    v_mov_b32 v242, 0
    s_cmp_lg_u32 s24, 3
    s_cbranch_scc1 .a1_9
    v_mov_b32 v242, s26
    v_lshlrev_b32 v242, 6, v242
    v_add_u32 v242, s97, v242
    v_and_b32 v242, 255, v242
    s_mov_b64 exec, 1
    buffer_atomic_add v243, v242, s[20:23], 0 offen sc1
    s_mov_b64 exec, -1

.a1_9:
    s_bitcmp1_b32 s26, 0
    s_cbranch_scc1 .po_11
    s_add_u32 m0, s98, 8192
    s_mov_b32 s5, 1048576
    buffer_load_dwordx4 v240, s[16:19], s5 offen  lds

    s_add_u32 m0, s98, 9216
    s_mov_b32 s5, 1179648
    buffer_load_dwordx4 v240, s[16:19], s5 offen  lds

    s_add_u32 m0, s98, 10240
    s_mov_b32 s5, 1310720
    buffer_load_dwordx4 v240, s[16:19], s5 offen  lds

    s_add_u32 m0, s98, 11264
    s_mov_b32 s5, 1441792
    buffer_load_dwordx4 v240, s[16:19], s5 offen  lds

    s_add_u32 m0, s98, 12288
    s_mov_b32 s5, 1572864
    buffer_load_dwordx4 v240, s[16:19], s5 offen  lds

    s_add_u32 m0, s98, 13312
    s_mov_b32 s5, 1703936
    buffer_load_dwordx4 v240, s[16:19], s5 offen  lds

    s_add_u32 m0, s98, 14336
    s_mov_b32 s5, 1835008
    buffer_load_dwordx4 v240, s[16:19], s5 offen  lds

    s_add_u32 m0, s98, 15360
    s_mov_b32 s5, 1966080
    buffer_load_dwordx4 v240, s[16:19], s5 offen  lds

    s_mov_b32 s16, s46
    s_and_b32 s17, s47, 0xffff
    s_mov_b32 s18, 0x800000
    s_mov_b32 s19, 0x00020000

    s_add_u32 m0, s98, 16384
    s_mov_b32 s5, 0
    buffer_load_dwordx4 v240, s[16:19], s5 offen  lds

    s_add_u32 m0, s98, 17408
    s_mov_b32 s5, 131072
    buffer_load_dwordx4 v240, s[16:19], s5 offen  lds

    s_add_u32 m0, s98, 18432
    s_mov_b32 s5, 262144
    buffer_load_dwordx4 v240, s[16:19], s5 offen  lds

    s_add_u32 m0, s98, 19456
    s_mov_b32 s5, 393216
    buffer_load_dwordx4 v240, s[16:19], s5 offen  lds

    s_add_u32 m0, s98, 20480
    s_mov_b32 s5, 524288
    buffer_load_dwordx4 v240, s[16:19], s5 offen  lds

    s_add_u32 m0, s98, 21504
    s_mov_b32 s5, 655360
    buffer_load_dwordx4 v240, s[16:19], s5 offen  lds

    s_add_u32 m0, s98, 22528
    s_mov_b32 s5, 786432
    buffer_load_dwordx4 v240, s[16:19], s5 offen  lds

    s_add_u32 m0, s98, 23552
    s_mov_b32 s5, 917504
    buffer_load_dwordx4 v240, s[16:19], s5 offen  lds

    s_add_u32 m0, s98, 24576
    s_mov_b32 s5, 1048576
    buffer_load_dwordx4 v240, s[16:19], s5 offen  lds

    s_add_u32 m0, s98, 25600
    s_mov_b32 s5, 1179648
    buffer_load_dwordx4 v240, s[16:19], s5 offen  lds

    s_add_u32 m0, s98, 26624
    s_mov_b32 s5, 1310720
    buffer_load_dwordx4 v240, s[16:19], s5 offen  lds

    s_add_u32 m0, s98, 27648
    s_mov_b32 s5, 1441792
    buffer_load_dwordx4 v240, s[16:19], s5 offen  lds

    s_add_u32 m0, s98, 28672
    s_mov_b32 s5, 1572864
    buffer_load_dwordx4 v240, s[16:19], s5 offen  lds

    s_add_u32 m0, s98, 29696
    s_mov_b32 s5, 1703936
    buffer_load_dwordx4 v240, s[16:19], s5 offen  lds

    s_add_u32 m0, s98, 30720
    s_mov_b32 s5, 1835008
    buffer_load_dwordx4 v240, s[16:19], s5 offen  lds

    s_add_u32 m0, s98, 31744
    s_mov_b32 s5, 1966080
    buffer_load_dwordx4 v240, s[16:19], s5 offen  lds

    s_branch .pj_12
.po_11:
    s_add_u32 m0, s98, 0
    s_mov_b32 s5, 0
    buffer_load_dwordx4 v240, s[16:19], s5 offen  lds

    s_add_u32 m0, s98, 1024
    s_mov_b32 s5, 131072
    buffer_load_dwordx4 v240, s[16:19], s5 offen  lds

    s_add_u32 m0, s98, 2048
    s_mov_b32 s5, 262144
    buffer_load_dwordx4 v240, s[16:19], s5 offen  lds

    s_add_u32 m0, s98, 3072
    s_mov_b32 s5, 393216
    buffer_load_dwordx4 v240, s[16:19], s5 offen  lds

    s_add_u32 m0, s98, 4096
    s_mov_b32 s5, 524288
    buffer_load_dwordx4 v240, s[16:19], s5 offen  lds

    s_add_u32 m0, s98, 5120
    s_mov_b32 s5, 655360
    buffer_load_dwordx4 v240, s[16:19], s5 offen  lds

    s_add_u32 m0, s98, 6144
    s_mov_b32 s5, 786432
    buffer_load_dwordx4 v240, s[16:19], s5 offen  lds

    s_add_u32 m0, s98, 7168
    s_mov_b32 s5, 917504
    buffer_load_dwordx4 v240, s[16:19], s5 offen  lds

    s_mov_b32 s16, s46
    s_and_b32 s17, s47, 0xffff
    s_mov_b32 s18, 0x800000
    s_mov_b32 s19, 0x00020000

    s_add_u32 m0, s98, 24576
    s_mov_b32 s5, 1048576
    buffer_load_dwordx4 v240, s[16:19], s5 offen  lds

    s_add_u32 m0, s98, 25600
    s_mov_b32 s5, 1179648
    buffer_load_dwordx4 v240, s[16:19], s5 offen  lds

    s_add_u32 m0, s98, 26624
    s_mov_b32 s5, 1310720
    buffer_load_dwordx4 v240, s[16:19], s5 offen  lds

    s_add_u32 m0, s98, 27648
    s_mov_b32 s5, 1441792
    buffer_load_dwordx4 v240, s[16:19], s5 offen  lds

    s_add_u32 m0, s98, 28672
    s_mov_b32 s5, 1572864
    buffer_load_dwordx4 v240, s[16:19], s5 offen  lds

    s_add_u32 m0, s98, 29696
    s_mov_b32 s5, 1703936
    buffer_load_dwordx4 v240, s[16:19], s5 offen  lds

    s_add_u32 m0, s98, 30720
    s_mov_b32 s5, 1835008
    buffer_load_dwordx4 v240, s[16:19], s5 offen  lds

    s_add_u32 m0, s98, 31744
    s_mov_b32 s5, 1966080
    buffer_load_dwordx4 v240, s[16:19], s5 offen  lds

    s_add_u32 m0, s98, 16384
    s_mov_b32 s5, 0
    buffer_load_dwordx4 v240, s[16:19], s5 offen  lds

    s_add_u32 m0, s98, 17408
    s_mov_b32 s5, 131072
    buffer_load_dwordx4 v240, s[16:19], s5 offen  lds

    s_add_u32 m0, s98, 18432
    s_mov_b32 s5, 262144
    buffer_load_dwordx4 v240, s[16:19], s5 offen  lds

    s_add_u32 m0, s98, 19456
    s_mov_b32 s5, 393216
    buffer_load_dwordx4 v240, s[16:19], s5 offen  lds

    s_add_u32 m0, s98, 20480
    s_mov_b32 s5, 524288
    buffer_load_dwordx4 v240, s[16:19], s5 offen  lds

    s_add_u32 m0, s98, 21504
    s_mov_b32 s5, 655360
    buffer_load_dwordx4 v240, s[16:19], s5 offen  lds

    s_add_u32 m0, s98, 22528
    s_mov_b32 s5, 786432
    buffer_load_dwordx4 v240, s[16:19], s5 offen  lds

    s_add_u32 m0, s98, 23552
    s_mov_b32 s5, 917504
    buffer_load_dwordx4 v240, s[16:19], s5 offen  lds

.pj_12:
    s_mov_b32 s12, s40
    s_and_b32 s13, s41, 0xffff
    s_mov_b32 s14, 0x4000
    s_mov_b32 s15, 0x00020000

    v_bfe_u32 v4, v2, 2, 1
    v_lshrrev_b32 v5, 3, v2
    v_lshrrev_b32 v8, 1, v3
    v_and_b32 v9, 1, v3
    v_lshl_add_u32 v6, v5, 3, v4
    v_lshl_add_u32 v6, v8, 4, v6
    v_lshl_add_u32 v6, v9, 2, v6
    v_lshl_add_u32 v7, v5, 2, v4
    v_lshl_add_u32 v7, v8, 3, v7
    v_lshl_add_u32 v7, v9, 4, v7
    v_and_b32 v5, 3, v2
    v_lshlrev_b32 v5, 3, v5
    v_lshl_add_u32 v6, v6, 6, v5
    v_lshl_add_u32 v7, v7, 6, v5
    v_add_u32 v254, s98, v6
    v_add_u32 v255, s98, v7
    v_sub_u32 v252, v254, v5
    v_and_b32 v5, 1, v2
    v_lshl_add_u32 v252, v5, 5, v252
    v_bfe_u32 v5, v2, 1, 1
    v_lshl_add_u32 v252, v5, 3, v252

    s_and_b32 s96, s26, 3
    s_lshl_b32 s4, s25, 3
    s_add_u32 s7, s4, s79
    s_mul_i32 s5, s24, 5120
    v_add_u32 v8, s5, v14
    v_and_b32 v5, 7, v2
    v_lshrrev_b32 v6, 1, v3
    v_and_b32 v7, 1, v3
    v_lshlrev_b32 v7, 3, v7
    v_lshlrev_b32 v17, 11, v5
    v_lshl_add_u32 v17, v3, 5, v17
    v_lshrrev_b32 v4, 3, v2
    v_lshl_add_u32 v17, v4, 4, v17
    s_lshl_b32 s5, s24, 9
    v_add_u32 v17, s5, v17

    buffer_load_dwordx4 v[20:23], v17, s[12:15], 0 offen offset:0
    buffer_load_dwordx4 v[24:27], v17, s[12:15], 0 offen offset:128
    buffer_load_dwordx4 v[28:31], v17, s[12:15], 0 offen offset:256
    buffer_load_dwordx4 v[32:35], v17, s[12:15], 0 offen offset:384
    v_lshlrev_b32 v4, 7, v2
    v_lshl_add_u32 v18, s26, 10, v4
    v_add_u32 v18, 40960, v18
    v_and_b32 v4, 0x180, v4
    v_add_u32 v4, s76, v4
    v_bfe_u32 v19, v2, 2, 1
    s_sub_u32 s4, s77, s76
    v_mad_u32_u24 v4, v19, s4, v4
    v_cmp_gt_u32 vcc, 8, v2
    s_lshl_b32 s4, s24, 17
    s_add_u32 s4, s4, s34
    v_cndmask_b32 v4, v4, v18, vcc

    v_add_u32 v226, s4, v4

    s_mov_b64 exec, 0xffff
    buffer_load_dword v227, v4, s[8:11], s4 offen
    s_mov_b64 exec, -1
    s_lshl_b32 s4, s79, 12
    s_add_u32 s4, s4, 40960

    s_add_u32 s5, s96, 1
    s_and_b32 s5, s5, 3
    s_lshl_b32 s5, s5, 10
    s_add_u32 s5, s5, s4
    v_add_u32 v232, s5, v14

    s_add_u32 s5, s96, 2
    s_and_b32 s5, s5, 3
    s_lshl_b32 s5, s5, 10
    s_add_u32 s5, s5, s4
    v_add_u32 v233, s5, v14

    s_add_u32 s5, s96, 3
    s_and_b32 s5, s5, 3
    s_lshl_b32 s5, s5, 10
    s_add_u32 s5, s5, s4
    v_add_u32 v234, s5, v14

    s_lshl_b32 s5, s78, 9
    v_lshlrev_b32 v10, 8, v6
    v_lshl_add_u32 v10, v2, 4, v10
    v_add_u32 v10, v10, v7
    v_add_u32 v10, s5, v10
    v_add_u32 v18, 16384, v10
    s_lshl_b32 s5, s26, 10
    s_add_u32 s5, s5, 40960
    v_add_u32 v10, s5, v10
    v_lshlrev_b32 v11, 8, v3
    v_lshl_add_u32 v11, v5, 4, v11
    s_lshr_b32 s4, s96, 1
    s_lshl_b32 s4, s4, 10
    s_and_b32 s5, s96, 1
    s_lshl_b32 s5, s5, 7
    s_add_u32 s4, s4, s5
    s_add_u32 s4, s4, 2048
    v_add_u32 v11, s4, v11
    v_lshlrev_b32 v12, 8, v6
    v_lshl_add_u32 v12, v2, 4, v12
    s_lshl_b32 s4, s96, 9
    s_xor_b32 s4, s4, 5120
    v_add_u32 v12, s4, v12
    v_lshlrev_b32 v13, 7, v3
    v_lshl_add_u32 v13, v5, 4, v13
    v_add_u32 v13, s77, v13
    v_lshlrev_b32 v15, 7, v6
    v_lshl_add_u32 v15, v5, 4, v15
    v_add_u32 v15, v15, v7
    s_lshl_b32 s5, s78, 8
    s_add_u32 s5, s5, s76
    v_add_u32 v15, s5, v15
    v_lshlrev_b32 v16, 8, v6
    v_lshl_add_u32 v16, v2, 4, v16
    v_add_u32 v16, v16, v7
    s_lshl_b32 s5, s24, 9
    v_add_u32 v16, s5, v16
    s_lshl_b32 s5, s24, 11
    v_add_u32 v17, s5, v14
    v_cmp_gt_u32 s[58:59], 8, v2
    v_cmp_gt_u32 s[60:61], 32, v1
    v_mov_b32 v4, 0x4444
    v_mov_b32 v9, 0xeeee
    v_cndmask_b32 v9, v9, v4, s[58:59]
    s_not_b64 s[66:67], s[58:59]
    s_cmp_lt_u32 s24, 2
    s_cselect_b64 s[64:65], s[66:67], s[58:59]
    s_mov_b32 s56, 0x0000ffff
    s_mov_b32 s57, 0x0000ffff
    s_cmp_eq_u32 s24, 1
    s_cselect_b64 vcc, -1, 0
    s_cselect_b64 s[66:67], s[56:57], s[66:67]
    s_lshl_b32 s5, s78, 10
    v_add_u32 v19, s5, v14
    v_cndmask_b32 v11, v11, v12, vcc
    v_cndmask_b32 v235, v235, v236, vcc
    v_mov_b32 v4, 0xff800000
    v_cndmask_b32 v116, 0, v4, s[60:61]
    v_mov_b32 v117, v116
    v_mov_b32 v118, v116
    v_mov_b32 v119, v116
    s_mul_i32 s5, s78, 8192
    v_add_u32 v246, s5, v14
    v_lshlrev_b32 v247, 9, v6
    v_lshl_add_u32 v247, v2, 4, v247
    s_lshl_b32 s5, s78, 8
    s_add_u32 s5, s5, 12288
    v_add_u32 v247, s5, v247
    v_and_b32 v4, 31, v1
    v_lshlrev_b32 v248, 4, v4
    s_lshl_b32 s5, s78, 9
    s_add_u32 s5, s5, 12288
    v_add_u32 v248, s5, v248
    s_lshl_b32 s5, s25, 16
    v_and_b32 v7, 1, v3
    v_lshlrev_b32 v237, 18, v7
    v_lshl_add_u32 v237, v6, 8, v237
    v_lshl_add_u32 v237, v2, 4, v237
    v_add_u32 v237, s5, v237
    s_lshl_b32 s6, s78, 9
    v_add_u32 v237, s6, v237
    s_lshl_b32 s6, s78, 8
    v_lshlrev_b32 v249, 9, v7
    v_lshl_add_u32 v249, v2, 4, v249
    v_add_u32 v249, s6, v249
    v_add_u32 v4, s25, v6
    v_add_u32 v4, 1, v4
    v_and_b32 v4, 3, v4
    v_lshl_add_u32 v239, v4, 16, v249
    s_add_u32 s6, s25, 3
    s_and_b32 s6, s6, 3
    s_lshl_b32 s6, s6, 16
    v_add_u32 v249, s6, v249
    v_and_b32 v4, 1, v5
    v_lshlrev_b32 v4, 4, v4
    v_mov_b32 v6, 0x3f80
    v_lshlrev_b32 v6, v4, v6
    v_lshrrev_b32 v4, 1, v5

    v_cmp_eq_u32 vcc, 0, v4
    s_nop 1
    v_cndmask_b32 v84, 0, v6, vcc
    v_cmp_eq_u32 vcc, 1, v4
    s_nop 1
    v_cndmask_b32 v85, 0, v6, vcc
    v_cmp_eq_u32 vcc, 2, v4
    s_nop 1
    v_cndmask_b32 v86, 0, v6, vcc
    v_cmp_eq_u32 vcc, 3, v4
    s_nop 1
    v_cndmask_b32 v87, 0, v6, vcc
    v_mov_b32 v120, 0x3f803f80
    v_cndmask_b32 v112, 0, v84, s[60:61]
    v_mov_b32 v121, 0x3f803f80
    v_cndmask_b32 v113, 0, v85, s[60:61]
    v_mov_b32 v122, 0x3f803f80
    v_cndmask_b32 v114, 0, v86, s[60:61]
    v_mov_b32 v123, 0x3f803f80
    v_cndmask_b32 v115, 0, v87, s[60:61]
    v_mov_b32 v170, 0
    v_mov_b32 v171, 0
    v_mov_b32 v174, 0
    v_mov_b32 v175, 0
    v_mov_b32 v182, 0
    v_mov_b32 v183, 0
    s_add_u32 s5, s96, 0
    s_and_b32 s5, s5, 3
    s_lshl_b32 s5, s5, 10
    s_add_u32 s5, s5, 20480
    v_add_u32 v228, s5, v14

    s_add_u32 s5, s96, 1
    s_and_b32 s5, s5, 3
    s_lshl_b32 s5, s5, 10
    s_add_u32 s5, s5, 20480
    v_add_u32 v229, s5, v14

    s_add_u32 s5, s96, 2
    s_and_b32 s5, s5, 3
    s_lshl_b32 s5, s5, 10
    s_add_u32 s5, s5, 20480
    v_add_u32 v230, s5, v14

    s_add_u32 s5, s96, 3
    s_and_b32 s5, s5, 3
    s_lshl_b32 s5, s5, 10
    s_add_u32 s5, s5, 20480
    v_add_u32 v231, s5, v14

    s_lshl_b32 s89, s7, 8
    s_add_u32 s89, s89, 92282880
    v_lshlrev_b32 v253, 13, v1
    s_lshl_b32 s4, s7, 13
    s_add_u32 s38, s4, 16777216
    s_lshl_b32 s5, s96, 11
    s_add_u32 s39, s4, s5
    s_add_u32 s30, s39, 17039360
    s_xor_b32 s39, s39, 4096
    s_add_u32 s39, s39, 33554432
    s_lshl_b32 s5, s78, 24
    s_add_u32 s30, s30, s5
    s_lshl_b32 s5, s78, 12
    s_add_u32 s38, s38, s5
    s_add_u32 s90, s5, 20480
    s_lshl_b32 s5, s78, 10
    s_add_u32 s39, s39, s5
    s_add_u32 s91, s5, 28672
    s_mov_b32 s37, 0x3e0293ee
    s_mov_b32 s28, 0

    v_and_b32 v4, 31, v1
    v_lshlrev_b32 v225, 6, v4
    v_lshrrev_b32 v4, 5, v1
    v_lshl_add_u32 v225, v4, 24, v225

    v_mov_b32 v52, 0
    v_mov_b32 v53, 0
    v_mov_b32 v54, 0
    v_mov_b32 v55, 0
    v_mov_b32 v56, 0
    v_mov_b32 v57, 0
    v_mov_b32 v58, 0
    v_mov_b32 v59, 0
    v_mov_b32 v60, 0
    v_mov_b32 v61, 0
    v_mov_b32 v62, 0
    v_mov_b32 v63, 0
    v_mov_b32 v64, 0
    v_mov_b32 v65, 0
    v_mov_b32 v66, 0
    v_mov_b32 v67, 0
    v_mov_b32 v68, 0
    v_mov_b32 v69, 0
    v_mov_b32 v70, 0
    v_mov_b32 v71, 0
    v_mov_b32 v72, 0
    v_mov_b32 v73, 0
    v_mov_b32 v74, 0
    v_mov_b32 v75, 0
    v_mov_b32 v76, 0
    v_mov_b32 v77, 0
    v_mov_b32 v78, 0
    v_mov_b32 v79, 0
    v_mov_b32 v80, 0
    v_mov_b32 v81, 0
    v_mov_b32 v82, 0
    v_mov_b32 v83, 0
    v_mov_b32 v92, -1
    v_mov_b32 v93, -1
    v_mov_b32 v94, -1
    v_mov_b32 v95, -1
    v_mov_b32 v96, -1
    v_mov_b32 v97, -1
    v_mov_b32 v98, -1
    v_mov_b32 v99, -1
    v_mov_b32 v100, -1
    v_mov_b32 v101, -1
    v_mov_b32 v102, -1
    v_mov_b32 v103, -1
    v_mov_b32 v192, -1
    v_mov_b32 v193, -1
    v_mov_b32 v194, -1
    v_mov_b32 v195, -1
    v_mov_b32 v196, -1
    v_mov_b32 v197, -1
    v_mov_b32 v198, -1
    v_mov_b32 v199, -1
    v_mov_b32 v200, -1
    v_mov_b32 v201, -1
    v_mov_b32 v202, -1
    v_mov_b32 v203, -1
    v_mov_b32 v204, -1
    v_mov_b32 v205, -1
    v_mov_b32 v206, -1
    v_mov_b32 v207, -1
    v_mov_b32 v208, -1
    v_mov_b32 v209, -1
    v_mov_b32 v210, -1
    v_mov_b32 v211, -1
    v_mov_b32 v212, -1
    v_mov_b32 v213, -1
    v_mov_b32 v214, -1
    v_mov_b32 v215, -1
    v_mov_b32 v216, -1
    v_mov_b32 v217, -1
    v_mov_b32 v218, -1
    v_mov_b32 v219, -1
    v_mov_b32 v220, -1
    v_mov_b32 v221, -1
    v_mov_b32 v222, -1
    v_mov_b32 v223, -1
    s_bitcmp1_b32 s26, 0
    s_cbranch_scc1 .po_13
    s_waitcnt vmcnt(29)
    ds_read_b64_tr_b16 a[0:1], v252 offset:0
    ds_read_b64_tr_b16 a[2:3], v252 offset:128
    ds_read_b64_tr_b16 a[4:5], v252 offset:2048
    ds_read_b64_tr_b16 a[6:7], v252 offset:2176
    ds_read_b64_tr_b16 a[8:9], v252 offset:4096
    ds_read_b64_tr_b16 a[10:11], v252 offset:4224
    ds_read_b64_tr_b16 a[12:13], v252 offset:6144
    ds_read_b64_tr_b16 a[14:15], v252 offset:6272
    ds_read_b64_tr_b16 a[32:33], v252 offset:16
    ds_read_b64_tr_b16 a[34:35], v252 offset:144
    ds_read_b64_tr_b16 a[36:37], v252 offset:2064
    ds_read_b64_tr_b16 a[38:39], v252 offset:2192
    ds_read_b64_tr_b16 a[40:41], v252 offset:4112
    ds_read_b64_tr_b16 a[42:43], v252 offset:4240
    ds_read_b64_tr_b16 a[44:45], v252 offset:6160
    ds_read_b64_tr_b16 a[46:47], v252 offset:6288
    s_waitcnt lgkmcnt(0)
    s_mov_b32 s16, s48
    s_and_b32 s17, s49, 0xffff
    s_mov_b32 s18, 0x800000
    s_mov_b32 s19, 0x00020000

    s_add_u32 m0, s98, 0
    s_mov_b32 s5, 0
    buffer_load_dwordx4 v224, s[16:19], s5 offen  lds

    s_add_u32 m0, s98, 1024
    s_mov_b32 s5, 131072
    buffer_load_dwordx4 v224, s[16:19], s5 offen  lds

    s_add_u32 m0, s98, 2048
    s_mov_b32 s5, 262144
    buffer_load_dwordx4 v224, s[16:19], s5 offen  lds

    s_add_u32 m0, s98, 3072
    s_mov_b32 s5, 393216
    buffer_load_dwordx4 v224, s[16:19], s5 offen  lds

    s_add_u32 m0, s98, 4096
    s_mov_b32 s5, 524288
    buffer_load_dwordx4 v224, s[16:19], s5 offen  lds

    s_add_u32 m0, s98, 5120
    s_mov_b32 s5, 655360
    buffer_load_dwordx4 v224, s[16:19], s5 offen  lds

    s_add_u32 m0, s98, 6144
    s_mov_b32 s5, 786432
    buffer_load_dwordx4 v224, s[16:19], s5 offen  lds

    s_add_u32 m0, s98, 7168
    s_mov_b32 s5, 917504
    buffer_load_dwordx4 v224, s[16:19], s5 offen  lds

    s_waitcnt vmcnt(29)
    ds_read_b64_tr_b16 a[16:17], v252 offset:8192
    ds_read_b64_tr_b16 a[18:19], v252 offset:8320
    ds_read_b64_tr_b16 a[20:21], v252 offset:10240
    ds_read_b64_tr_b16 a[22:23], v252 offset:10368
    ds_read_b64_tr_b16 a[24:25], v252 offset:12288
    ds_read_b64_tr_b16 a[26:27], v252 offset:12416
    ds_read_b64_tr_b16 a[28:29], v252 offset:14336
    ds_read_b64_tr_b16 a[30:31], v252 offset:14464
    ds_read_b64_tr_b16 a[48:49], v252 offset:8208
    ds_read_b64_tr_b16 a[50:51], v252 offset:8336
    ds_read_b64_tr_b16 a[52:53], v252 offset:10256
    ds_read_b64_tr_b16 a[54:55], v252 offset:10384
    ds_read_b64_tr_b16 a[56:57], v252 offset:12304
    ds_read_b64_tr_b16 a[58:59], v252 offset:12432
    ds_read_b64_tr_b16 a[60:61], v252 offset:14352
    ds_read_b64_tr_b16 a[62:63], v252 offset:14480
    s_waitcnt lgkmcnt(0)
    s_add_u32 m0, s98, 8192
    s_mov_b32 s5, 1048576
    buffer_load_dwordx4 v224, s[16:19], s5 offen  lds

    s_add_u32 m0, s98, 9216
    s_mov_b32 s5, 1179648
    buffer_load_dwordx4 v224, s[16:19], s5 offen  lds

    s_add_u32 m0, s98, 10240
    s_mov_b32 s5, 1310720
    buffer_load_dwordx4 v224, s[16:19], s5 offen  lds

    s_add_u32 m0, s98, 11264
    s_mov_b32 s5, 1441792
    buffer_load_dwordx4 v224, s[16:19], s5 offen  lds

    s_add_u32 m0, s98, 12288
    s_mov_b32 s5, 1572864
    buffer_load_dwordx4 v224, s[16:19], s5 offen  lds

    s_add_u32 m0, s98, 13312
    s_mov_b32 s5, 1703936
    buffer_load_dwordx4 v224, s[16:19], s5 offen  lds

    s_add_u32 m0, s98, 14336
    s_mov_b32 s5, 1835008
    buffer_load_dwordx4 v224, s[16:19], s5 offen  lds

    s_add_u32 m0, s98, 15360
    s_mov_b32 s5, 1966080
    buffer_load_dwordx4 v224, s[16:19], s5 offen  lds

    s_waitcnt vmcnt(29)
    ds_read_b64_tr_b16 a[64:65], v252 offset:16384
    ds_read_b64_tr_b16 a[66:67], v252 offset:16512
    ds_read_b64_tr_b16 a[68:69], v252 offset:18432
    ds_read_b64_tr_b16 a[70:71], v252 offset:18560
    ds_read_b64_tr_b16 a[72:73], v252 offset:20480
    ds_read_b64_tr_b16 a[74:75], v252 offset:20608
    ds_read_b64_tr_b16 a[76:77], v252 offset:22528
    ds_read_b64_tr_b16 a[78:79], v252 offset:22656
    ds_read_b64_tr_b16 a[96:97], v252 offset:16400
    ds_read_b64_tr_b16 a[98:99], v252 offset:16528
    ds_read_b64_tr_b16 a[100:101], v252 offset:18448
    ds_read_b64_tr_b16 a[102:103], v252 offset:18576
    ds_read_b64_tr_b16 a[104:105], v252 offset:20496
    ds_read_b64_tr_b16 a[106:107], v252 offset:20624
    ds_read_b64_tr_b16 a[108:109], v252 offset:22544
    ds_read_b64_tr_b16 a[110:111], v252 offset:22672
    s_waitcnt lgkmcnt(0)
    s_mov_b32 s16, s50
    s_and_b32 s17, s51, 0xffff
    s_mov_b32 s18, 0x800000
    s_mov_b32 s19, 0x00020000

    s_add_u32 m0, s98, 16384
    s_add_u32 s5, s80, 0
    buffer_load_dwordx4 v241, s[16:19], s5 offen  lds

    s_add_u32 m0, s98, 17408
    s_add_u32 s5, s80, 32768
    buffer_load_dwordx4 v241, s[16:19], s5 offen  lds

    s_add_u32 m0, s98, 18432
    s_add_u32 s5, s80, 65536
    buffer_load_dwordx4 v241, s[16:19], s5 offen  lds

    s_add_u32 m0, s98, 19456
    s_add_u32 s5, s80, 98304
    buffer_load_dwordx4 v241, s[16:19], s5 offen  lds

    s_add_u32 m0, s98, 20480
    s_add_u32 s5, s80, 131072
    buffer_load_dwordx4 v241, s[16:19], s5 offen  lds

    s_add_u32 m0, s98, 21504
    s_add_u32 s5, s80, 163840
    buffer_load_dwordx4 v241, s[16:19], s5 offen  lds

    s_add_u32 m0, s98, 22528
    s_add_u32 s5, s80, 196608
    buffer_load_dwordx4 v241, s[16:19], s5 offen  lds

    s_add_u32 m0, s98, 23552
    s_add_u32 s5, s80, 229376
    buffer_load_dwordx4 v241, s[16:19], s5 offen  lds

    s_waitcnt vmcnt(29)
    ds_read_b64_tr_b16 a[80:81], v252 offset:24576
    ds_read_b64_tr_b16 a[82:83], v252 offset:24704
    ds_read_b64_tr_b16 a[84:85], v252 offset:26624
    ds_read_b64_tr_b16 a[86:87], v252 offset:26752
    ds_read_b64_tr_b16 a[88:89], v252 offset:28672
    ds_read_b64_tr_b16 a[90:91], v252 offset:28800
    ds_read_b64_tr_b16 a[92:93], v252 offset:30720
    ds_read_b64_tr_b16 a[94:95], v252 offset:30848
    ds_read_b64_tr_b16 a[112:113], v252 offset:24592
    ds_read_b64_tr_b16 a[114:115], v252 offset:24720
    ds_read_b64_tr_b16 a[116:117], v252 offset:26640
    ds_read_b64_tr_b16 a[118:119], v252 offset:26768
    ds_read_b64_tr_b16 a[120:121], v252 offset:28688
    ds_read_b64_tr_b16 a[122:123], v252 offset:28816
    ds_read_b64_tr_b16 a[124:125], v252 offset:30736
    ds_read_b64_tr_b16 a[126:127], v252 offset:30864
    s_waitcnt lgkmcnt(0)
    s_add_u32 m0, s98, 24576
    s_add_u32 s5, s81, 0
    buffer_load_dwordx4 v241, s[16:19], s5 offen  lds

    s_add_u32 m0, s98, 25600
    s_add_u32 s5, s81, 32768
    buffer_load_dwordx4 v241, s[16:19], s5 offen  lds

    s_add_u32 m0, s98, 26624
    s_add_u32 s5, s81, 65536
    buffer_load_dwordx4 v241, s[16:19], s5 offen  lds

    s_add_u32 m0, s98, 27648
    s_add_u32 s5, s81, 98304
    buffer_load_dwordx4 v241, s[16:19], s5 offen  lds

    s_add_u32 m0, s98, 28672
    s_add_u32 s5, s81, 131072
    buffer_load_dwordx4 v241, s[16:19], s5 offen  lds

    s_add_u32 m0, s98, 29696
    s_add_u32 s5, s81, 163840
    buffer_load_dwordx4 v241, s[16:19], s5 offen  lds

    s_add_u32 m0, s98, 30720
    s_add_u32 s5, s81, 196608
    buffer_load_dwordx4 v241, s[16:19], s5 offen  lds

    s_add_u32 m0, s98, 31744
    s_add_u32 s5, s81, 229376
    buffer_load_dwordx4 v241, s[16:19], s5 offen  lds

    v_and_b32 v241, 3, v0
    v_lshlrev_b32 v241, 2, v241

    v_and_b32 v240, 12, v0
    v_lshl_add_u32 v241, v240, 4, v241
    v_add_u32 v241, s97, v241
    v_and_b32 v241, 255, v241

    buffer_load_dword v240, v241, s[20:23], 0 offen sc1
    s_waitcnt vmcnt(25)
    ds_read_b64_tr_b16 a[128:129], v254 offset:0
    ds_read_b64_tr_b16 a[130:131], v254 offset:128
    ds_read_b64_tr_b16 a[132:133], v254 offset:2048
    ds_read_b64_tr_b16 a[134:135], v254 offset:2176
    ds_read_b64_tr_b16 a[136:137], v254 offset:4096
    ds_read_b64_tr_b16 a[138:139], v254 offset:4224
    ds_read_b64_tr_b16 a[140:141], v254 offset:6144
    ds_read_b64_tr_b16 a[142:143], v254 offset:6272
    ds_read_b64_tr_b16 a[160:161], v254 offset:32
    ds_read_b64_tr_b16 a[162:163], v254 offset:160
    ds_read_b64_tr_b16 a[164:165], v254 offset:2080
    ds_read_b64_tr_b16 a[166:167], v254 offset:2208
    ds_read_b64_tr_b16 a[168:169], v254 offset:4128
    ds_read_b64_tr_b16 a[170:171], v254 offset:4256
    ds_read_b64_tr_b16 a[172:173], v254 offset:6176
    ds_read_b64_tr_b16 a[174:175], v254 offset:6304
    s_waitcnt vmcnt(17)
    ds_read_b64_tr_b16 a[144:145], v254 offset:8192
    ds_read_b64_tr_b16 a[146:147], v254 offset:8320
    ds_read_b64_tr_b16 a[148:149], v254 offset:10240
    ds_read_b64_tr_b16 a[150:151], v254 offset:10368
    ds_read_b64_tr_b16 a[152:153], v254 offset:12288
    ds_read_b64_tr_b16 a[154:155], v254 offset:12416
    ds_read_b64_tr_b16 a[156:157], v254 offset:14336
    ds_read_b64_tr_b16 a[158:159], v254 offset:14464
    ds_read_b64_tr_b16 a[176:177], v254 offset:8224
    ds_read_b64_tr_b16 a[178:179], v254 offset:8352
    ds_read_b64_tr_b16 a[180:181], v254 offset:10272
    ds_read_b64_tr_b16 a[182:183], v254 offset:10400
    ds_read_b64_tr_b16 a[184:185], v254 offset:12320
    ds_read_b64_tr_b16 a[186:187], v254 offset:12448
    ds_read_b64_tr_b16 a[188:189], v254 offset:14368
    ds_read_b64_tr_b16 a[190:191], v254 offset:14496
    s_waitcnt vmcnt(9)
    s_mov_b64 exec, 0xffff
    s_mov_b32 exec_hi, 0
    buffer_load_dword v227, v226, s[8:11], 0 offen
    s_mov_b64 exec, -1
    ds_read_b64_tr_b16 a[192:193], v255 offset:16384
    ds_read_b64_tr_b16 a[194:195], v255 offset:16512
    ds_read_b64_tr_b16 a[196:197], v255 offset:18432
    ds_read_b64_tr_b16 a[198:199], v255 offset:18560
    ds_read_b64_tr_b16 a[200:201], v255 offset:20480
    ds_read_b64_tr_b16 a[202:203], v255 offset:20608
    ds_read_b64_tr_b16 a[204:205], v255 offset:22528
    ds_read_b64_tr_b16 a[206:207], v255 offset:22656
    ds_read_b64_tr_b16 a[224:225], v255 offset:16416
    ds_read_b64_tr_b16 a[226:227], v255 offset:16544
    ds_read_b64_tr_b16 a[228:229], v255 offset:18464
    ds_read_b64_tr_b16 a[230:231], v255 offset:18592
    ds_read_b64_tr_b16 a[232:233], v255 offset:20512
    ds_read_b64_tr_b16 a[234:235], v255 offset:20640
    ds_read_b64_tr_b16 a[236:237], v255 offset:22560
    ds_read_b64_tr_b16 a[238:239], v255 offset:22688
    s_waitcnt vmcnt(2)
    ds_read_b64_tr_b16 a[208:209], v255 offset:24576
    ds_read_b64_tr_b16 a[210:211], v255 offset:24704
    ds_read_b64_tr_b16 a[212:213], v255 offset:26624
    ds_read_b64_tr_b16 a[214:215], v255 offset:26752
    ds_read_b64_tr_b16 a[216:217], v255 offset:28672
    ds_read_b64_tr_b16 a[218:219], v255 offset:28800
    ds_read_b64_tr_b16 a[220:221], v255 offset:30720
    ds_read_b64_tr_b16 a[222:223], v255 offset:30848
    ds_read_b64_tr_b16 a[240:241], v255 offset:24608
    ds_read_b64_tr_b16 a[242:243], v255 offset:24736
    ds_read_b64_tr_b16 a[244:245], v255 offset:26656
    ds_read_b64_tr_b16 a[246:247], v255 offset:26784
    ds_read_b64_tr_b16 a[248:249], v255 offset:28704
    ds_read_b64_tr_b16 a[250:251], v255 offset:28832
    ds_read_b64_tr_b16 a[252:253], v255 offset:30752
    ds_read_b64_tr_b16 a[254:255], v255 offset:30880
    s_branch .pj_14
.po_13:
    s_waitcnt vmcnt(29)
    ds_read_b64_tr_b16 a[16:17], v252 offset:8192
    ds_read_b64_tr_b16 a[18:19], v252 offset:8320
    ds_read_b64_tr_b16 a[20:21], v252 offset:10240
    ds_read_b64_tr_b16 a[22:23], v252 offset:10368
    ds_read_b64_tr_b16 a[24:25], v252 offset:12288
    ds_read_b64_tr_b16 a[26:27], v252 offset:12416
    ds_read_b64_tr_b16 a[28:29], v252 offset:14336
    ds_read_b64_tr_b16 a[30:31], v252 offset:14464
    ds_read_b64_tr_b16 a[48:49], v252 offset:8208
    ds_read_b64_tr_b16 a[50:51], v252 offset:8336
    ds_read_b64_tr_b16 a[52:53], v252 offset:10256
    ds_read_b64_tr_b16 a[54:55], v252 offset:10384
    ds_read_b64_tr_b16 a[56:57], v252 offset:12304
    ds_read_b64_tr_b16 a[58:59], v252 offset:12432
    ds_read_b64_tr_b16 a[60:61], v252 offset:14352
    ds_read_b64_tr_b16 a[62:63], v252 offset:14480
    s_waitcnt lgkmcnt(0)
    s_mov_b32 s16, s48
    s_and_b32 s17, s49, 0xffff
    s_mov_b32 s18, 0x800000
    s_mov_b32 s19, 0x00020000

    s_add_u32 m0, s98, 8192
    s_mov_b32 s5, 1048576
    buffer_load_dwordx4 v224, s[16:19], s5 offen  lds

    s_add_u32 m0, s98, 9216
    s_mov_b32 s5, 1179648
    buffer_load_dwordx4 v224, s[16:19], s5 offen  lds

    s_add_u32 m0, s98, 10240
    s_mov_b32 s5, 1310720
    buffer_load_dwordx4 v224, s[16:19], s5 offen  lds

    s_add_u32 m0, s98, 11264
    s_mov_b32 s5, 1441792
    buffer_load_dwordx4 v224, s[16:19], s5 offen  lds

    s_add_u32 m0, s98, 12288
    s_mov_b32 s5, 1572864
    buffer_load_dwordx4 v224, s[16:19], s5 offen  lds

    s_add_u32 m0, s98, 13312
    s_mov_b32 s5, 1703936
    buffer_load_dwordx4 v224, s[16:19], s5 offen  lds

    s_add_u32 m0, s98, 14336
    s_mov_b32 s5, 1835008
    buffer_load_dwordx4 v224, s[16:19], s5 offen  lds

    s_add_u32 m0, s98, 15360
    s_mov_b32 s5, 1966080
    buffer_load_dwordx4 v224, s[16:19], s5 offen  lds

    s_waitcnt vmcnt(29)
    ds_read_b64_tr_b16 a[0:1], v252 offset:0
    ds_read_b64_tr_b16 a[2:3], v252 offset:128
    ds_read_b64_tr_b16 a[4:5], v252 offset:2048
    ds_read_b64_tr_b16 a[6:7], v252 offset:2176
    ds_read_b64_tr_b16 a[8:9], v252 offset:4096
    ds_read_b64_tr_b16 a[10:11], v252 offset:4224
    ds_read_b64_tr_b16 a[12:13], v252 offset:6144
    ds_read_b64_tr_b16 a[14:15], v252 offset:6272
    ds_read_b64_tr_b16 a[32:33], v252 offset:16
    ds_read_b64_tr_b16 a[34:35], v252 offset:144
    ds_read_b64_tr_b16 a[36:37], v252 offset:2064
    ds_read_b64_tr_b16 a[38:39], v252 offset:2192
    ds_read_b64_tr_b16 a[40:41], v252 offset:4112
    ds_read_b64_tr_b16 a[42:43], v252 offset:4240
    ds_read_b64_tr_b16 a[44:45], v252 offset:6160
    ds_read_b64_tr_b16 a[46:47], v252 offset:6288
    s_waitcnt lgkmcnt(0)
    s_add_u32 m0, s98, 0
    s_mov_b32 s5, 0
    buffer_load_dwordx4 v224, s[16:19], s5 offen  lds

    s_add_u32 m0, s98, 1024
    s_mov_b32 s5, 131072
    buffer_load_dwordx4 v224, s[16:19], s5 offen  lds

    s_add_u32 m0, s98, 2048
    s_mov_b32 s5, 262144
    buffer_load_dwordx4 v224, s[16:19], s5 offen  lds

    s_add_u32 m0, s98, 3072
    s_mov_b32 s5, 393216
    buffer_load_dwordx4 v224, s[16:19], s5 offen  lds

    s_add_u32 m0, s98, 4096
    s_mov_b32 s5, 524288
    buffer_load_dwordx4 v224, s[16:19], s5 offen  lds

    s_add_u32 m0, s98, 5120
    s_mov_b32 s5, 655360
    buffer_load_dwordx4 v224, s[16:19], s5 offen  lds

    s_add_u32 m0, s98, 6144
    s_mov_b32 s5, 786432
    buffer_load_dwordx4 v224, s[16:19], s5 offen  lds

    s_add_u32 m0, s98, 7168
    s_mov_b32 s5, 917504
    buffer_load_dwordx4 v224, s[16:19], s5 offen  lds

    s_waitcnt vmcnt(29)
    ds_read_b64_tr_b16 a[80:81], v252 offset:24576
    ds_read_b64_tr_b16 a[82:83], v252 offset:24704
    ds_read_b64_tr_b16 a[84:85], v252 offset:26624
    ds_read_b64_tr_b16 a[86:87], v252 offset:26752
    ds_read_b64_tr_b16 a[88:89], v252 offset:28672
    ds_read_b64_tr_b16 a[90:91], v252 offset:28800
    ds_read_b64_tr_b16 a[92:93], v252 offset:30720
    ds_read_b64_tr_b16 a[94:95], v252 offset:30848
    ds_read_b64_tr_b16 a[112:113], v252 offset:24592
    ds_read_b64_tr_b16 a[114:115], v252 offset:24720
    ds_read_b64_tr_b16 a[116:117], v252 offset:26640
    ds_read_b64_tr_b16 a[118:119], v252 offset:26768
    ds_read_b64_tr_b16 a[120:121], v252 offset:28688
    ds_read_b64_tr_b16 a[122:123], v252 offset:28816
    ds_read_b64_tr_b16 a[124:125], v252 offset:30736
    ds_read_b64_tr_b16 a[126:127], v252 offset:30864
    s_waitcnt lgkmcnt(0)
    s_mov_b32 s16, s50
    s_and_b32 s17, s51, 0xffff
    s_mov_b32 s18, 0x800000
    s_mov_b32 s19, 0x00020000

    s_add_u32 m0, s98, 24576
    s_add_u32 s5, s81, 0
    buffer_load_dwordx4 v241, s[16:19], s5 offen  lds

    s_add_u32 m0, s98, 25600
    s_add_u32 s5, s81, 32768
    buffer_load_dwordx4 v241, s[16:19], s5 offen  lds

    s_add_u32 m0, s98, 26624
    s_add_u32 s5, s81, 65536
    buffer_load_dwordx4 v241, s[16:19], s5 offen  lds

    s_add_u32 m0, s98, 27648
    s_add_u32 s5, s81, 98304
    buffer_load_dwordx4 v241, s[16:19], s5 offen  lds

    s_add_u32 m0, s98, 28672
    s_add_u32 s5, s81, 131072
    buffer_load_dwordx4 v241, s[16:19], s5 offen  lds

    s_add_u32 m0, s98, 29696
    s_add_u32 s5, s81, 163840
    buffer_load_dwordx4 v241, s[16:19], s5 offen  lds

    s_add_u32 m0, s98, 30720
    s_add_u32 s5, s81, 196608
    buffer_load_dwordx4 v241, s[16:19], s5 offen  lds

    s_add_u32 m0, s98, 31744
    s_add_u32 s5, s81, 229376
    buffer_load_dwordx4 v241, s[16:19], s5 offen  lds

    s_waitcnt vmcnt(29)
    ds_read_b64_tr_b16 a[64:65], v252 offset:16384
    ds_read_b64_tr_b16 a[66:67], v252 offset:16512
    ds_read_b64_tr_b16 a[68:69], v252 offset:18432
    ds_read_b64_tr_b16 a[70:71], v252 offset:18560
    ds_read_b64_tr_b16 a[72:73], v252 offset:20480
    ds_read_b64_tr_b16 a[74:75], v252 offset:20608
    ds_read_b64_tr_b16 a[76:77], v252 offset:22528
    ds_read_b64_tr_b16 a[78:79], v252 offset:22656
    ds_read_b64_tr_b16 a[96:97], v252 offset:16400
    ds_read_b64_tr_b16 a[98:99], v252 offset:16528
    ds_read_b64_tr_b16 a[100:101], v252 offset:18448
    ds_read_b64_tr_b16 a[102:103], v252 offset:18576
    ds_read_b64_tr_b16 a[104:105], v252 offset:20496
    ds_read_b64_tr_b16 a[106:107], v252 offset:20624
    ds_read_b64_tr_b16 a[108:109], v252 offset:22544
    ds_read_b64_tr_b16 a[110:111], v252 offset:22672
    s_waitcnt lgkmcnt(0)
    s_add_u32 m0, s98, 16384
    s_add_u32 s5, s80, 0
    buffer_load_dwordx4 v241, s[16:19], s5 offen  lds

    s_add_u32 m0, s98, 17408
    s_add_u32 s5, s80, 32768
    buffer_load_dwordx4 v241, s[16:19], s5 offen  lds

    s_add_u32 m0, s98, 18432
    s_add_u32 s5, s80, 65536
    buffer_load_dwordx4 v241, s[16:19], s5 offen  lds

    s_add_u32 m0, s98, 19456
    s_add_u32 s5, s80, 98304
    buffer_load_dwordx4 v241, s[16:19], s5 offen  lds

    s_add_u32 m0, s98, 20480
    s_add_u32 s5, s80, 131072
    buffer_load_dwordx4 v241, s[16:19], s5 offen  lds

    s_add_u32 m0, s98, 21504
    s_add_u32 s5, s80, 163840
    buffer_load_dwordx4 v241, s[16:19], s5 offen  lds

    s_add_u32 m0, s98, 22528
    s_add_u32 s5, s80, 196608
    buffer_load_dwordx4 v241, s[16:19], s5 offen  lds

    s_add_u32 m0, s98, 23552
    s_add_u32 s5, s80, 229376
    buffer_load_dwordx4 v241, s[16:19], s5 offen  lds

    v_and_b32 v241, 3, v0
    v_lshlrev_b32 v241, 2, v241

    v_and_b32 v240, 12, v0
    v_lshl_add_u32 v241, v240, 4, v241
    v_add_u32 v241, s97, v241
    v_and_b32 v241, 255, v241

    buffer_load_dword v240, v241, s[20:23], 0 offen sc1
    s_waitcnt vmcnt(25)
    ds_read_b64_tr_b16 a[144:145], v254 offset:8192
    ds_read_b64_tr_b16 a[146:147], v254 offset:8320
    ds_read_b64_tr_b16 a[148:149], v254 offset:10240
    ds_read_b64_tr_b16 a[150:151], v254 offset:10368
    ds_read_b64_tr_b16 a[152:153], v254 offset:12288
    ds_read_b64_tr_b16 a[154:155], v254 offset:12416
    ds_read_b64_tr_b16 a[156:157], v254 offset:14336
    ds_read_b64_tr_b16 a[158:159], v254 offset:14464
    ds_read_b64_tr_b16 a[176:177], v254 offset:8224
    ds_read_b64_tr_b16 a[178:179], v254 offset:8352
    ds_read_b64_tr_b16 a[180:181], v254 offset:10272
    ds_read_b64_tr_b16 a[182:183], v254 offset:10400
    ds_read_b64_tr_b16 a[184:185], v254 offset:12320
    ds_read_b64_tr_b16 a[186:187], v254 offset:12448
    ds_read_b64_tr_b16 a[188:189], v254 offset:14368
    ds_read_b64_tr_b16 a[190:191], v254 offset:14496
    s_waitcnt vmcnt(17)
    ds_read_b64_tr_b16 a[128:129], v254 offset:0
    ds_read_b64_tr_b16 a[130:131], v254 offset:128
    ds_read_b64_tr_b16 a[132:133], v254 offset:2048
    ds_read_b64_tr_b16 a[134:135], v254 offset:2176
    ds_read_b64_tr_b16 a[136:137], v254 offset:4096
    ds_read_b64_tr_b16 a[138:139], v254 offset:4224
    ds_read_b64_tr_b16 a[140:141], v254 offset:6144
    ds_read_b64_tr_b16 a[142:143], v254 offset:6272
    ds_read_b64_tr_b16 a[160:161], v254 offset:32
    ds_read_b64_tr_b16 a[162:163], v254 offset:160
    ds_read_b64_tr_b16 a[164:165], v254 offset:2080
    ds_read_b64_tr_b16 a[166:167], v254 offset:2208
    ds_read_b64_tr_b16 a[168:169], v254 offset:4128
    ds_read_b64_tr_b16 a[170:171], v254 offset:4256
    ds_read_b64_tr_b16 a[172:173], v254 offset:6176
    ds_read_b64_tr_b16 a[174:175], v254 offset:6304
    s_waitcnt vmcnt(9)
    s_mov_b64 exec, 0xffff
    s_mov_b32 exec_hi, 0
    buffer_load_dword v227, v226, s[8:11], 0 offen
    s_mov_b64 exec, -1
    ds_read_b64_tr_b16 a[208:209], v255 offset:24576
    ds_read_b64_tr_b16 a[210:211], v255 offset:24704
    ds_read_b64_tr_b16 a[212:213], v255 offset:26624
    ds_read_b64_tr_b16 a[214:215], v255 offset:26752
    ds_read_b64_tr_b16 a[216:217], v255 offset:28672
    ds_read_b64_tr_b16 a[218:219], v255 offset:28800
    ds_read_b64_tr_b16 a[220:221], v255 offset:30720
    ds_read_b64_tr_b16 a[222:223], v255 offset:30848
    ds_read_b64_tr_b16 a[240:241], v255 offset:24608
    ds_read_b64_tr_b16 a[242:243], v255 offset:24736
    ds_read_b64_tr_b16 a[244:245], v255 offset:26656
    ds_read_b64_tr_b16 a[246:247], v255 offset:26784
    ds_read_b64_tr_b16 a[248:249], v255 offset:28704
    ds_read_b64_tr_b16 a[250:251], v255 offset:28832
    ds_read_b64_tr_b16 a[252:253], v255 offset:30752
    ds_read_b64_tr_b16 a[254:255], v255 offset:30880
    s_waitcnt vmcnt(2)
    ds_read_b64_tr_b16 a[192:193], v255 offset:16384
    ds_read_b64_tr_b16 a[194:195], v255 offset:16512
    ds_read_b64_tr_b16 a[196:197], v255 offset:18432
    ds_read_b64_tr_b16 a[198:199], v255 offset:18560
    ds_read_b64_tr_b16 a[200:201], v255 offset:20480
    ds_read_b64_tr_b16 a[202:203], v255 offset:20608
    ds_read_b64_tr_b16 a[204:205], v255 offset:22528
    ds_read_b64_tr_b16 a[206:207], v255 offset:22656
    ds_read_b64_tr_b16 a[224:225], v255 offset:16416
    ds_read_b64_tr_b16 a[226:227], v255 offset:16544
    ds_read_b64_tr_b16 a[228:229], v255 offset:18464
    ds_read_b64_tr_b16 a[230:231], v255 offset:18592
    ds_read_b64_tr_b16 a[232:233], v255 offset:20512
    ds_read_b64_tr_b16 a[234:235], v255 offset:20640
    ds_read_b64_tr_b16 a[236:237], v255 offset:22560
    ds_read_b64_tr_b16 a[238:239], v255 offset:22688
.pj_14:
    v_min_u32 v20, 0xfffffffe, v20
    v_min_u32 v21, 0xfffffffe, v21
    v_min_u32 v22, 0xfffffffe, v22
    v_min_u32 v23, 0xfffffffe, v23
    v_min_u32 v24, 0xfffffffe, v24
    v_min_u32 v25, 0xfffffffe, v25
    v_min_u32 v26, 0xfffffffe, v26
    v_min_u32 v27, 0xfffffffe, v27
    v_min_u32 v28, 0xfffffffe, v28
    v_min_u32 v29, 0xfffffffe, v29
    v_min_u32 v30, 0xfffffffe, v30
    v_min_u32 v31, 0xfffffffe, v31
    v_min_u32 v32, 0xfffffffe, v32
    v_min_u32 v33, 0xfffffffe, v33
    v_min_u32 v34, 0xfffffffe, v34
    v_min_u32 v35, 0xfffffffe, v35
    s_barrier
    s_cmp_ge_u32 s24, 2
    s_cbranch_scc1 .px_15
    v_xor_b32 v255, 0x10000, v255
    ds_read_b64_tr_b16 v[124:125], v255 offset:16384
    ds_read_b64_tr_b16 v[126:127], v255 offset:16512
    ds_read_b64_tr_b16 v[128:129], v255 offset:18432
    ds_read_b64_tr_b16 v[130:131], v255 offset:18560
    ds_read_b64_tr_b16 v[132:133], v255 offset:20480
    ds_read_b64_tr_b16 v[134:135], v255 offset:20608
    ds_read_b64_tr_b16 v[136:137], v255 offset:22528
    ds_read_b64_tr_b16 v[138:139], v255 offset:22656
    ds_read_b64_tr_b16 v[156:157], v255 offset:16416
    ds_read_b64_tr_b16 v[158:159], v255 offset:16544
    ds_read_b64_tr_b16 v[160:161], v255 offset:18464
    ds_read_b64_tr_b16 v[162:163], v255 offset:18592
    ds_read_b64_tr_b16 v[164:165], v255 offset:20512
    ds_read_b64_tr_b16 v[166:167], v255 offset:20640
    ds_read_b64_tr_b16 v[168:169], v255 offset:22560
    ds_read_b64_tr_b16 v[170:171], v255 offset:22688
    ds_read_b64_tr_b16 v[140:141], v255 offset:24576
    ds_read_b64_tr_b16 v[142:143], v255 offset:24704
    ds_read_b64_tr_b16 v[144:145], v255 offset:26624
    ds_read_b64_tr_b16 v[146:147], v255 offset:26752
    ds_read_b64_tr_b16 v[148:149], v255 offset:28672
    ds_read_b64_tr_b16 v[150:151], v255 offset:28800
    ds_read_b64_tr_b16 v[152:153], v255 offset:30720
    ds_read_b64_tr_b16 v[154:155], v255 offset:30848
    ds_read_b64_tr_b16 v[172:173], v255 offset:24608
    ds_read_b64_tr_b16 v[174:175], v255 offset:24736
    ds_read_b64_tr_b16 v[176:177], v255 offset:26656
    ds_read_b64_tr_b16 v[178:179], v255 offset:26784
    ds_read_b64_tr_b16 v[180:181], v255 offset:28704
    ds_read_b64_tr_b16 v[182:183], v255 offset:28832
    ds_read_b64_tr_b16 v[184:185], v255 offset:30752
    ds_read_b64_tr_b16 v[186:187], v255 offset:30880
.px_15:
    s_waitcnt vmcnt(0)
    s_mov_b32 s62, 0
.vp_18:
    v_readlane_b32 s4, v240, 0
    v_readlane_b32 s7, v240, 1
    v_readlane_b32 s6, v240, 2

    v_readlane_b32 s5, v240, 4
    s_add_u32 s4, s4, s5
    v_readlane_b32 s5, v240, 8
    s_add_u32 s4, s4, s5
    v_readlane_b32 s5, v240, 12
    s_add_u32 s4, s4, s5
    s_lshr_b32 s5, s7, 21
    s_min_u32 s4, s4, s5
    s_cmp_ge_u32 s4, 256
    s_cbranch_scc1 .vd_19
    s_cmp_lg_u32 s6, 0
    s_cbranch_scc1 .vs_20
    s_add_u32 s62, s62, 1
    s_cmp_gt_u32 s62, 0x100000
    s_cbranch_scc1 .mg_end_1
    s_sleep 8
    buffer_load_dword v240, v241, s[20:23], 0 offen sc1
    s_waitcnt vmcnt(0)
    s_branch .vp_18

.vs_20:
    s_lshr_b32 s25, s2, 5
    s_and_b32 s26, s2, 31
    s_mov_b32 s27, 1
    s_mov_b32 s99, 1
    s_mov_b32 s97, 144
    s_waitcnt vmcnt(0) lgkmcnt(0)
    s_barrier
    s_branch .mg_role_3

.vd_19:
    s_waitcnt lgkmcnt(0)
    s_barrier
    s_add_u32 s4, s79, 1
    s_and_b32 s4, s4, 3
    s_lshl_b32 s4, s4, 11
    v_add_u32 v243, s4, v246
    s_add_u32 s4, s79, 2
    s_and_b32 s4, s4, 3
    s_lshl_b32 s4, s4, 11
    v_add_u32 v252, s4, v246
    s_add_u32 s4, s79, 3
    s_and_b32 s4, s4, 3
    s_lshl_b32 s4, s4, 11
    v_add_u32 v254, s4, v246
    s_add_u32 s4, s79, 4
    s_and_b32 s4, s4, 3
    s_lshl_b32 s4, s4, 11
    v_add_u32 v246, s4, v246
    s_bfe_u32 s4, s7, 393216
    s_cmp_gt_u32 s4, 8
    s_cselect_b32 s4, 8192, 0
    s_add_u32 s4, s4, s35
    s_add_u32 s68, s4, 0

    s_bfe_u32 s4, s7, 393216
    s_cmp_gt_u32 s4, 8
    s_cselect_b32 s4, 8192, 0
    s_add_u32 s4, s4, s35
    s_add_u32 s69, s4, 1048576

    s_bfe_u32 s4, s7, 393222
    s_cmp_gt_u32 s4, 8
    s_cselect_b32 s4, 8192, 0
    s_add_u32 s4, s4, s35
    s_add_u32 s70, s4, 2097152

    s_bfe_u32 s4, s7, 393222
    s_cmp_gt_u32 s4, 8
    s_cselect_b32 s4, 8192, 0
    s_add_u32 s4, s4, s35
    s_add_u32 s71, s4, 3145728

    s_mov_b32 s62, 0x1000000
    s_cmp_ge_u32 s24, 2
    s_cbranch_scc1 .nd_21
    s_mov_b32 s62, 0
    s_mov_b64 exec, 3
.wf_23:
    buffer_load_dword v244, v253, s[8:11], s89 offen sc1
    s_waitcnt vmcnt(0)
    v_cmp_gt_u32 vcc, 1, v244
    s_cbranch_vccz .wfd_24
    s_sleep 2
    s_add_u32 s62, s62, 1
    s_cmp_gt_u32 s62, 0x400000
    s_cbranch_scc1 .mg_end_1
    s_branch .wf_23

.wfd_24:
    s_mov_b64 exec, -1
    v_readlane_b32 s4, v244, 0
    v_readlane_b32 s93, v244, 1
    s_min_u32 s93, s93, s4
    s_mov_b32 s62, 0x1000000
    s_mov_b32 m0, s90
    s_nop 0
    buffer_load_dwordx4 v14, s[8:11], s38 offen offset:0 lds
    buffer_load_dwordx4 v14, s[8:11], s38 offen offset:1024 lds
    buffer_load_dwordx4 v14, s[8:11], s38 offen offset:2048 lds
    buffer_load_dwordx4 v14, s[8:11], s38 offen offset:3072 lds
    s_mov_b32 m0, s91
    s_nop 0
    buffer_load_dwordx4 v14, s[8:11], s39 offen lds
    s_mov_b64 exec, 3
    buffer_load_dword v244, v253, s[8:11], s89 offen sc1
    s_mov_b64 exec, -1
    s_waitcnt vmcnt(0)
.kd_22:
    v_readlane_b32 s4, v244, 0
    v_readlane_b32 s93, v244, 1
    s_min_u32 s93, s93, s4
    v_mov_b32 v4, s93
    v_mov_b32 v5, 19968
    ds_write_b32 v5, v4
.nd_21:
    s_waitcnt vmcnt(0) lgkmcnt(0)
    s_add_u32 s38, s38, 262144
    s_add_u32 s39, s39, 262144
    s_and_b32 s4, s28, 3
    s_lshl_b32 s5, s4, 17
    s_add_u32 s29, s5, s34
    s_xor_b32 s6, s5, 262144
    s_add_u32 s31, s6, s34
    s_add_u32 s32, s29, 20480
    s_add_u32 s33, s29, 24576
    s_mov_b64 s[14:15], 0
    s_barrier
    s_cmp_lt_u32 s24, 2
    s_cbranch_scc1 .k0_27
    ds_read_b128 v[128:131], v228 offset:0
    ds_read_b128 v[144:147], v228 offset:4096
    ds_read_b128 v[132:135], v229 offset:0
    ds_read_b128 v[148:151], v229 offset:4096
    ds_read_b128 v[136:139], v230 offset:0
    ds_read_b128 v[152:155], v230 offset:4096
    ds_read_b128 v[140:143], v231 offset:0
    ds_read_b128 v[156:159], v231 offset:4096
    ds_read_b128 v[160:163], v14 offset:28672
    ds_read_b128 v[164:167], v14 offset:29696
.k0_27:
    s_cmp_lg_u32 s27, 0
    s_cbranch_scc1 .ent1_26
    s_branch .ent0_25
.p2align 6
.top_36:
    s_barrier
.tp2_40:
    buffer_load_dwordx4 v[20:23], v8, s[8:11], s29 offen offset:0 sc1
    v_mov_b32 v52, 0
    buffer_load_dwordx4 v[24:27], v8, s[8:11], s29 offen offset:1024 sc1
    v_mov_b32 v53, 0
    buffer_load_dwordx4 v[28:31], v8, s[8:11], s29 offen offset:2048 sc1
    v_mov_b32 v54, 0
    buffer_load_dwordx4 v[32:35], v8, s[8:11], s29 offen offset:3072 sc1
.ent0_25:
    s_waitcnt vmcnt(3)
    v_max_u32 v4, v20, v22
    v_cmp_eq_u32 vcc, -1, v4
    s_cbranch_vccnz .A_42
.W_43:
    v_smfmac_f32_16x16x64_bf16 v[52:55], v[20:23], a[0:7], v9
    s_waitcnt vmcnt(2)
    v_max_u32 v4, v24, v26
    v_cmp_eq_u32 vcc, -1, v4
    v_smfmac_f32_16x16x64_bf16 v[56:59], v[20:23], a[32:39], v9
    v_smfmac_f32_16x16x64_bf16 v[60:63], v[20:23], a[64:71], v9
    v_smfmac_f32_16x16x64_bf16 v[64:67], v[20:23], a[96:103], v9
    s_cbranch_vccnz .A_44
.W_45:
    v_smfmac_f32_16x16x64_bf16 v[52:55], v[24:27], a[8:15], v9
    s_waitcnt vmcnt(1)
    v_max_u32 v4, v28, v30
    v_cmp_eq_u32 vcc, -1, v4
    v_smfmac_f32_16x16x64_bf16 v[56:59], v[24:27], a[40:47], v9
    v_smfmac_f32_16x16x64_bf16 v[60:63], v[24:27], a[72:79], v9
    v_smfmac_f32_16x16x64_bf16 v[64:67], v[24:27], a[104:111], v9
    s_cbranch_vccnz .A_46
.W_47:
    v_smfmac_f32_16x16x64_bf16 v[52:55], v[28:31], a[16:23], v9
    s_waitcnt vmcnt(0)
    v_max_u32 v4, v32, v34
    v_cmp_eq_u32 vcc, -1, v4
    v_smfmac_f32_16x16x64_bf16 v[56:59], v[28:31], a[48:55], v9
    v_smfmac_f32_16x16x64_bf16 v[60:63], v[28:31], a[80:87], v9
    v_smfmac_f32_16x16x64_bf16 v[64:67], v[28:31], a[112:119], v9
    s_cbranch_vccnz .A_48
.W_49:
    v_smfmac_f32_16x16x64_bf16 v[52:55], v[32:35], a[24:31], v9
    v_smfmac_f32_16x16x64_bf16 v[56:59], v[32:35], a[56:63], v9
    v_smfmac_f32_16x16x64_bf16 v[60:63], v[32:35], a[88:95], v9
    v_smfmac_f32_16x16x64_bf16 v[64:67], v[32:35], a[120:127], v9
.mj_41:
    v_cvt_pk_bf16_f32 v104, v52, v53
    v_cvt_pk_bf16_f32 v105, v54, v55
    v_cvt_pk_bf16_f32 v106, v56, v57
    v_cvt_pk_bf16_f32 v107, v58, v59
    ds_write_b64 v16, v[104:105] offset:4096
    v_cvt_pk_bf16_f32 v108, v60, v61
    v_cvt_pk_bf16_f32 v109, v62, v63
    ds_write_b64 v16, v[106:107] offset:6144
    ds_write_b64 v16, v[108:109] offset:0
    v_cvt_pk_bf16_f32 v110, v64, v65
    v_cvt_pk_bf16_f32 v111, v66, v67
    ds_write_b64 v16, v[110:111] offset:2048
    v_smfmac_f32_16x16x64_bf16 v[68:71], v[20:23], a[128:135], v9
    v_smfmac_f32_16x16x64_bf16 v[72:75], v[20:23], a[160:167], v9
    s_waitcnt lgkmcnt(0)
    s_barrier
    ds_read_b128 v[36:39], v17 offset:0
    ds_read_b128 v[40:43], v17 offset:1024
    v_smfmac_f32_16x16x64_bf16 v[68:71], v[24:27], a[136:143], v9
    v_smfmac_f32_16x16x64_bf16 v[72:75], v[24:27], a[168:175], v9
    s_waitcnt lgkmcnt(1)
    v_mfma_f32_16x16x32_bf16 v[44:47], v[36:39], v[84:87], 0
    s_waitcnt lgkmcnt(0)
    v_mfma_f32_16x16x32_bf16 v[44:47], v[40:43], v[84:87], v[44:47]
    v_smfmac_f32_16x16x64_bf16 v[68:71], v[28:31], a[144:151], v9
    v_smfmac_f32_16x16x64_bf16 v[72:75], v[28:31], a[176:183], v9
    s_mov_b64 exec, s[64:65]
    v_cvt_pk_bf16_f32 v48, v44, v45
    v_cvt_pk_bf16_f32 v49, v46, v47

    buffer_store_dwordx2 v[48:49], v10, s[8:11], s29 offen

    ds_write_b64 v18, v[48:49]
    s_mov_b64 exec, -1

    v_smfmac_f32_16x16x64_bf16 v[68:71], v[32:35], a[152:159], v9
    v_smfmac_f32_16x16x64_bf16 v[72:75], v[32:35], a[184:191], v9
    s_nop 3
    v_cvt_pk_bf16_f32 v104, v68, v69
    v_cvt_pk_bf16_f32 v105, v70, v71
    ds_write_b64 v16, v[104:105] offset:8192
    s_nop 0
    v_cvt_pk_bf16_f32 v106, v72, v73
    v_cvt_pk_bf16_f32 v107, v74, v75
    ds_write_b64 v16, v[106:107] offset:10240
    s_cmp_lg_u32 s24, 2
    s_waitcnt lgkmcnt(0)
    s_barrier
    s_cbranch_scc1 .oth_37
    buffer_load_dwordx4 v[92:95], v232, s[8:11], s29 offen sc1
    buffer_load_dwordx4 v[96:99], v233, s[8:11], s29 offen sc1
    buffer_load_dwordx4 v[100:103], v234, s[8:11], s29 offen sc1
    ds_read_b128 v[88:91], v14 offset:16384
    s_cmp_eq_u32 s28, 63
    s_cbranch_scc1 .rec_fin_6
.en_32:
    s_waitcnt lgkmcnt(0)
    v_mfma_f32_16x16x32_bf16 v[208:211], v[128:131], v[88:91], 0
    v_mfma_f32_16x16x32_bf16 v[212:215], v[144:147], v[88:91], 0
    v_mfma_f32_16x16x32_bf16 v[216:219], v[88:91], v[88:91], v[116:119]
    s_waitcnt vmcnt(2)
    v_max_u32 v4, v92, v94
    v_cmp_eq_u32 vcc, -1, v4
    s_cbranch_vccnz .A_51
.W_52:
    v_mfma_f32_16x16x32_bf16 v[208:211], v[132:135], v[92:95], v[208:211]
    s_waitcnt vmcnt(1)
    v_max_u32 v4, v96, v98
    v_cmp_eq_u32 vcc, -1, v4
    v_mfma_f32_16x16x32_bf16 v[212:215], v[148:151], v[92:95], v[212:215]
    v_mfma_f32_16x16x32_bf16 v[216:219], v[92:95], v[92:95], v[216:219]
    s_cbranch_vccnz .A_53
.W_54:
    v_mfma_f32_16x16x32_bf16 v[208:211], v[136:139], v[96:99], v[208:211]
    s_waitcnt vmcnt(0)
    v_max_u32 v4, v100, v102
    v_cmp_eq_u32 vcc, -1, v4
    v_mfma_f32_16x16x32_bf16 v[212:215], v[152:155], v[96:99], v[212:215]
    v_mfma_f32_16x16x32_bf16 v[216:219], v[96:99], v[96:99], v[216:219]
    s_cbranch_vccnz .A_55
.W_56:
    v_mfma_f32_16x16x32_bf16 v[208:211], v[140:143], v[100:103], v[208:211]
    s_barrier
    v_mfma_f32_16x16x32_bf16 v[212:215], v[156:159], v[100:103], v[212:215]
    v_mfma_f32_16x16x32_bf16 v[216:219], v[100:103], v[100:103], v[216:219]
.mj_50:
    s_nop 0
    ds_read_b64 v[168:169], v14 offset:18432
    ds_read_b64 v[172:173], v14 offset:18440
    s_nop 0

    v_mov_b32_dpp v208, v212 row_ror:8 row_mask:0xf bank_mask:0xc
    v_mov_b32_dpp v209, v213 row_ror:8 row_mask:0xf bank_mask:0xc
    v_mov_b32_dpp v210, v214 row_ror:8 row_mask:0xf bank_mask:0xc
    v_mov_b32_dpp v211, v215 row_ror:8 row_mask:0xf bank_mask:0xc
    v_mov_b32_dpp v216, v218 row_ror:8 row_mask:0xf bank_mask:0xc
    v_mov_b32_dpp v217, v219 row_ror:8 row_mask:0xf bank_mask:0xc
    v_max3_f32 v4, v208, v209, v210
    v_max3_f32 v5, v211, v216, v217
    v_max_f32 v6, v4, v5
    v_max_f32 v4, v4, v5
    s_nop 1
    v_permlane32_swap_b32 v4, v6
    v_max_f32 v5, v4, v6
    v_max_f32 v4, v4, v6
    s_nop 1
    v_permlane16_swap_b32 v4, v5
    v_max_f32 v4, v4, v5
    s_nop 1
    v_max_f32_dpp v4, v4, v4 row_ror:8 row_mask:0xf bank_mask:0xf
    v_mul_f32 v4, s37, v4

    v_pk_fma_f32 v[104:105], v[208:209], s[36:37], v[4:5] op_sel:[0,1,0] op_sel_hi:[1,1,0] neg_lo:[0,0,1] neg_hi:[0,0,1]
    v_pk_fma_f32 v[106:107], v[210:211], s[36:37], v[4:5] op_sel:[0,1,0] op_sel_hi:[1,1,0] neg_lo:[0,0,1] neg_hi:[0,0,1]
    v_pk_fma_f32 v[108:109], v[216:217], s[36:37], v[4:5] op_sel:[0,1,0] op_sel_hi:[1,1,0] neg_lo:[0,0,1] neg_hi:[0,0,1]
    v_exp_f32 v104, v104
    v_exp_f32 v105, v105
    v_exp_f32 v106, v106
    v_exp_f32 v107, v107
    v_exp_f32 v108, v108
    v_exp_f32 v109, v109
    v_cvt_pk_bf16_f32 v176, v104, v105
    v_cvt_pk_bf16_f32 v177, v106, v107
    v_cvt_pk_bf16_f32 v180, v108, v109
    v_mov_b32_dpp v178, v176 row_ror:8 row_mask:0xf bank_mask:0xf
    v_mov_b32_dpp v179, v177 row_ror:8 row_mask:0xf bank_mask:0xf
    v_mov_b32_dpp v181, v180 row_ror:8 row_mask:0xf bank_mask:0xf
    s_waitcnt lgkmcnt(0)

    v_mfma_f32_16x16x32_bf16 v[208:211], v[120:123], v[176:179], 0
    v_mfma_f32_16x16x32_bf16 v[208:211], v[120:123], v[180:183], v[208:211]
    v_mfma_f32_16x16x32_bf16 v[212:215], v[160:163], v[176:179], 0
    v_mfma_f32_16x16x32_bf16 v[216:219], v[164:167], v[176:179], 0
    v_mfma_f32_16x16x32_bf16 v[212:215], v[168:171], v[180:183], v[212:215]
    v_rcp_f32 v4, v208
    v_mfma_f32_16x16x32_bf16 v[216:219], v[172:175], v[180:183], v[216:219]
    s_mov_b64 exec, s[58:59]
    s_nop 2
    v_mul_f32 v212, v4, v212
    v_mul_f32 v213, v4, v213
    v_mul_f32 v214, v4, v214
    v_mul_f32 v215, v4, v215
    v_cvt_pk_bf16_f32 v184, v212, v213
    v_cvt_pk_bf16_f32 v185, v214, v215
    v_pk_mul_f32 v[216:217], v[216:217], v[4:5] op_sel_hi:[1,0]
    v_pk_mul_f32 v[218:219], v[218:219], v[4:5] op_sel_hi:[1,0]

    v_cvt_pk_bf16_f32 v186, v216, v217
    v_cvt_pk_bf16_f32 v187, v218, v219
    buffer_store_dwordx4 v[184:187], v13, s[8:11], s29 offen
    s_mov_b64 exec, -1

.gp_39:
    s_barrier
    v_mov_b32 v5, 19968
    ds_read_b32 v4, v5
    s_mov_b32 s99, s68
    s_waitcnt vmcnt(0)
    s_cmp_eq_u32 s24, 3
    s_cbranch_scc1 .u3_57
    s_add_u32 s6, s28, 3
    s_add_u32 s7, s30, 262144
    s_waitcnt lgkmcnt(0)
    v_readfirstlane_b32 s5, v4
    s_cmp_lt_u32 s5, s6
    s_barrier
    s_cbranch_scc1 .np_59
    buffer_load_dword v226, v225, s[8:11], s7 offen

.np_59:
    s_add_u32 s4, s70, 0
    buffer_store_dwordx4 v[188:191], v238, s[8:11], s4 offen sc1
    s_add_u32 s4, s70, 262144
    buffer_store_dwordx4 v[188:191], v238, s[8:11], s4 offen sc1
    s_branch .u4_58
.u3_57:
    s_sub_u32 s4, s36, 0
    s_barrier
    s_mov_b64 exec, s[66:67]
    buffer_store_dwordx4 v[88:91], v11, s[8:11], s4 offen sc1
    s_mov_b64 exec, s[56:57]
    buffer_store_dwordx4 v[172:175], v12, s[8:11], s4 offen sc1
    s_mov_b64 exec, -1

.u4_58:
    s_barrier
    s_add_u32 s28, s28, 1
    s_add_u32 s36, s36, 196608
    s_cmp_lt_u32 s28, 63
    s_cselect_b32 s4, 262144, 0
    s_add_u32 s38, s38, s4
    s_add_u32 s39, s39, s4
    s_add_u32 s30, s30, s4
    s_mov_b32 s4, s68
    s_mov_b32 s68, s69
    s_mov_b32 s69, s70
    s_mov_b32 s70, s71
    s_mov_b32 s71, s4
    s_and_b32 s4, s28, 3
    s_lshl_b32 s5, s4, 17
    s_add_u32 s29, s5, s34
    s_xor_b32 s6, s5, 262144
    s_add_u32 s31, s6, s34
    s_add_u32 s32, s29, 20480
    s_add_u32 s33, s29, 24576
    v_mov_b32 v55, 0
    v_mov_b32 v56, 0
    v_mov_b32 v57, 0
    v_mov_b32 v58, 0
    v_mov_b32 v59, 0
    v_mov_b32 v60, 0
    v_mov_b32 v61, 0
    v_mov_b32 v62, 0
    v_mov_b32 v63, 0
    v_mov_b32 v64, 0
    v_mov_b32 v65, 0
    v_mov_b32 v66, 0
    v_mov_b32 v67, 0
    v_mov_b32 v68, 0
    v_mov_b32 v69, 0
    v_mov_b32 v70, 0
    v_mov_b32 v71, 0
    v_mov_b32 v72, 0
    v_mov_b32 v73, 0
    v_mov_b32 v74, 0
    v_mov_b32 v75, 0
    v_mov_b32 v20, -1
    v_mov_b32 v21, -1
    v_mov_b32 v22, -1
    v_mov_b32 v23, -1
    v_mov_b32 v24, -1
    v_mov_b32 v25, -1
    v_mov_b32 v26, -1
    v_mov_b32 v27, -1
    v_mov_b32 v28, -1
    v_mov_b32 v29, -1
    v_mov_b32 v30, -1
    v_mov_b32 v31, -1
    v_mov_b32 v32, -1
    v_mov_b32 v33, -1
    v_mov_b32 v34, -1
    v_mov_b32 v35, -1
    v_mov_b32 v92, -1
    v_mov_b32 v93, -1
    v_mov_b32 v94, -1
    v_mov_b32 v95, -1
    v_mov_b32 v96, -1
    v_mov_b32 v97, -1
    v_mov_b32 v98, -1
    v_mov_b32 v99, -1
    v_mov_b32 v100, -1
    v_mov_b32 v101, -1
    v_mov_b32 v102, -1
    v_mov_b32 v103, -1
    s_add_u32 s4, s99, 0
    buffer_load_dwordx4 v[192:195], v239, s[8:11], s4 offen sc1
    buffer_load_dwordx4 v[196:199], v249, s[8:11], s4 offen sc1

    ds_read_b128 v[128:131], v228 offset:0
    ds_read_b128 v[144:147], v228 offset:4096
    ds_read_b128 v[132:135], v229 offset:0
    ds_read_b128 v[148:151], v229 offset:4096
    ds_read_b128 v[136:139], v230 offset:0
    ds_read_b128 v[152:155], v230 offset:4096
    ds_read_b128 v[140:143], v231 offset:0
    ds_read_b128 v[156:159], v231 offset:4096
    ds_read_b128 v[160:163], v14 offset:28672
    ds_read_b128 v[164:167], v14 offset:29696
    ds_read_b128 v[108:111], v248
    s_waitcnt lgkmcnt(0)
    v_mfma_f32_16x16x32_bf16 v[76:79], v[108:111], v[112:115], 0
    s_add_u32 s4, s99, 262144
    buffer_load_dwordx4 v[200:203], v239, s[8:11], s4 offen sc1
    buffer_load_dwordx4 v[204:207], v249, s[8:11], s4 offen sc1

.gc_60:
    s_waitcnt vmcnt(2)

    v_mfma_f32_16x16x32_bf16 v[80:83], v[192:195], v[84:87], v[76:79]
    v_max_u32 v4, v192, v196
    v_mfma_f32_16x16x32_bf16 v[80:83], v[196:199], v[112:115], v[80:83]
    v_cmp_eq_u32 vcc, -1, v4
    s_cbranch_vccnz .gf_61
    s_mov_b64 exec, s[58:59]
    s_nop 4
    v_cvt_pk_bf16_f32 v104, v80, v81
    v_cvt_pk_bf16_f32 v105, v82, v83

    buffer_store_dwordx2 v[104:105], v15, s[8:11], s29 offen
    s_mov_b64 exec, -1

    s_branch .top_36
.gf_61:
    s_add_u32 s4, s99, 0
    buffer_load_dwordx4 v[192:195], v239, s[8:11], s4 offen sc1
    buffer_load_dwordx4 v[196:199], v249, s[8:11], s4 offen sc1

    s_waitcnt vmcnt(2)

    v_mfma_f32_16x16x32_bf16 v[80:83], v[200:203], v[84:87], v[76:79]
    v_max_u32 v4, v200, v204
    v_mfma_f32_16x16x32_bf16 v[80:83], v[204:207], v[112:115], v[80:83]
    v_cmp_eq_u32 vcc, -1, v4
    s_cbranch_vccnz .gf_62
    s_mov_b64 exec, s[58:59]
    s_nop 4
    v_cvt_pk_bf16_f32 v104, v80, v81
    v_cvt_pk_bf16_f32 v105, v82, v83

    buffer_store_dwordx2 v[104:105], v15, s[8:11], s29 offen
    s_mov_b64 exec, -1

    s_branch .top_36
.gf_62:
    s_add_u32 s4, s99, 262144
    buffer_load_dwordx4 v[200:203], v239, s[8:11], s4 offen sc1
    buffer_load_dwordx4 v[204:207], v249, s[8:11], s4 offen sc1

    s_sub_u32 s62, s62, 1
    s_cbranch_scc1 .mg_end_1
    s_branch .gc_60
.oth_37:
    s_cmp_eq_u32 s24, 3
    s_cbranch_scc1 .w3_38
    s_cmp_eq_u32 s28, 63
    s_cbranch_scc1 .rec_fin_6
    s_min_u32 s4, s14, s15
    s_max_u32 s93, s93, s4
    v_mov_b32 v4, s93
    v_mov_b32 v5, 19968
    ds_write_b32 v5, v4
    s_waitcnt vmcnt(0)
    v_mov_b32 v57, 0
    v_mov_b32 v58, 0
    v_mov_b32 v59, 0
    v_mov_b32 v60, 0
    v_mov_b32 v61, 0
    v_mov_b32 v62, 0
    v_mov_b32 v63, 0
    v_mov_b32 v64, 0
    v_mov_b32 v65, 0
    v_mov_b32 v66, 0
    v_mov_b32 v67, 0
    s_barrier
.en_28:
    s_add_u32 s6, s28, 2
    s_min_u32 s6, s6, 64
    s_cmp_lt_u32 s93, s6
    s_cbranch_scc1 .kf_63
.kb_64:
    s_mov_b32 m0, s90
    s_nop 0
    buffer_load_dwordx4 v14, s[8:11], s38 offen offset:0 lds
    buffer_load_dwordx4 v14, s[8:11], s38 offen offset:1024 lds
    buffer_load_dwordx4 v14, s[8:11], s38 offen offset:2048 lds
    buffer_load_dwordx4 v14, s[8:11], s38 offen offset:3072 lds
    s_mov_b32 m0, s91
    s_nop 0
    buffer_load_dwordx4 v14, s[8:11], s39 offen lds
    s_waitcnt lgkmcnt(0)
    s_barrier
    v_mov_b32 v20, -1
    v_mov_b32 v21, -1
    v_mov_b32 v22, -1
    v_mov_b32 v23, -1
    v_mov_b32 v24, -1
    v_mov_b32 v25, -1
    v_mov_b32 v26, -1
    v_mov_b32 v27, -1
    v_mov_b32 v28, -1
    v_mov_b32 v29, -1
    v_mov_b32 v30, -1
    v_mov_b32 v31, -1
    v_mov_b32 v32, -1
    v_mov_b32 v33, -1
    v_mov_b32 v34, -1
    v_mov_b32 v35, -1
    v_mov_b32 v55, 0
    v_mov_b32 v56, 0
    buffer_load_dwordx4 v[192:195], v243, s[8:11], s32 offen offset:0 sc1
    buffer_load_dwordx4 v[196:199], v243, s[8:11], s32 offen offset:1024 sc1
    v_mov_b32 v76, 0
    buffer_load_dwordx4 v[200:203], v252, s[8:11], s32 offen offset:0 sc1
    buffer_load_dwordx4 v[204:207], v252, s[8:11], s32 offen offset:1024 sc1
    v_mov_b32 v77, 0
    buffer_load_dwordx4 v[208:211], v254, s[8:11], s32 offen offset:0 sc1
    buffer_load_dwordx4 v[212:215], v254, s[8:11], s32 offen offset:1024 sc1
    v_mov_b32 v78, 0
    buffer_load_dwordx4 v[216:219], v246, s[8:11], s32 offen offset:0 sc1
    buffer_load_dwordx4 v[220:223], v246, s[8:11], s32 offen offset:1024 sc1
    s_waitcnt vmcnt(6)
    v_max_u32 v4, v192, v196
    v_cmp_eq_u32 vcc, -1, v4
    s_cbranch_vccnz .A_66
.W_67:
    v_smfmac_f32_16x16x64_bf16 v[76:79], v[192:195], a[192:199], v9
    s_waitcnt vmcnt(4)
    v_max_u32 v4, v200, v204
    v_cmp_eq_u32 vcc, -1, v4
    v_smfmac_f32_16x16x64_bf16 v[80:83], v[192:195], a[224:231], v9
    v_smfmac_f32_16x16x64_bf16 v[76:79], v[196:199], a[200:207], v9
    v_smfmac_f32_16x16x64_bf16 v[80:83], v[196:199], a[232:239], v9
    s_cbranch_vccnz .A_68
.W_69:
    v_smfmac_f32_16x16x64_bf16 v[76:79], v[200:203], a[208:215], v9
    s_waitcnt vmcnt(2)
    v_max_u32 v4, v208, v212
    v_cmp_eq_u32 vcc, -1, v4
    v_smfmac_f32_16x16x64_bf16 v[80:83], v[200:203], a[240:247], v9
    v_smfmac_f32_16x16x64_bf16 v[76:79], v[204:207], a[216:223], v9
    v_smfmac_f32_16x16x64_bf16 v[80:83], v[204:207], a[248:255], v9
    s_cbranch_vccnz .A_70
.W_71:
    v_smfmac_f32_16x16x64_bf16 v[76:79], v[208:211], v[124:131], v9
    s_waitcnt vmcnt(0)
    v_max_u32 v4, v216, v220
    v_cmp_eq_u32 vcc, -1, v4
    v_smfmac_f32_16x16x64_bf16 v[80:83], v[208:211], v[156:163], v9
    v_smfmac_f32_16x16x64_bf16 v[76:79], v[212:215], v[132:139], v9
    v_smfmac_f32_16x16x64_bf16 v[80:83], v[212:215], v[164:171], v9
    s_cbranch_vccnz .A_72
.W_73:
    s_barrier
    v_smfmac_f32_16x16x64_bf16 v[76:79], v[216:219], v[140:147], v9
    v_smfmac_f32_16x16x64_bf16 v[80:83], v[216:219], v[172:179], v9
    v_smfmac_f32_16x16x64_bf16 v[76:79], v[220:223], v[148:155], v9
    v_smfmac_f32_16x16x64_bf16 v[80:83], v[220:223], v[180:187], v9
.mj_65:
    v_mov_b32 v68, 0
    v_mov_b32 v69, 0
    v_mov_b32 v70, 0
    v_mov_b32 v71, 0
    v_mov_b32 v72, 0
    v_mov_b32 v73, 0
    v_mov_b32 v74, 0
    v_mov_b32 v75, 0
    v_permlane32_swap_b32 v76, v80
    v_permlane32_swap_b32 v77, v81
    v_permlane32_swap_b32 v78, v82
    v_permlane32_swap_b32 v79, v83
    v_pk_add_f32 v[76:77], v[76:77], v[80:81]
    v_pk_add_f32 v[78:79], v[78:79], v[82:83]
    v_cvt_pk_bf16_f32 v104, v76, v77
    v_cvt_pk_bf16_f32 v106, v76, v77
    v_cvt_pk_bf16_f32 v105, v78, v79
    v_cvt_pk_bf16_f32 v107, v78, v79
    v_permlane16_swap_b32 v104, v106
    s_nop 0
    v_permlane16_swap_b32 v105, v107

    buffer_store_dwordx4 v[104:107], v237, s[8:11], s68 offen sc1

    ds_write_b128 v247, v[104:107]
    s_waitcnt lgkmcnt(0)
    s_barrier
    v_mov_b32 v79, 0
    v_mov_b32 v80, 0
    v_mov_b32 v81, 0
    v_mov_b32 v82, 0
    v_mov_b32 v83, 0
    s_waitcnt vmcnt(1)
    v_mov_b32 v192, -1
    v_mov_b32 v193, -1
    v_mov_b32 v194, -1
    v_mov_b32 v195, -1
    v_mov_b32 v196, -1
    v_mov_b32 v197, -1
    v_mov_b32 v198, -1
    v_mov_b32 v199, -1
    v_mov_b32 v200, -1
    v_mov_b32 v201, -1
    v_mov_b32 v202, -1
    v_mov_b32 v203, -1
    v_mov_b32 v204, -1
    v_mov_b32 v205, -1
    v_mov_b32 v206, -1
    v_mov_b32 v207, -1
    v_mov_b32 v208, -1
    v_mov_b32 v209, -1
    v_mov_b32 v210, -1
    v_mov_b32 v211, -1
    v_mov_b32 v212, -1
    v_mov_b32 v213, -1
    v_mov_b32 v214, -1
    v_mov_b32 v215, -1
    v_mov_b32 v216, -1
    v_mov_b32 v217, -1
    v_mov_b32 v218, -1
    v_mov_b32 v219, -1
    v_mov_b32 v220, -1
    v_mov_b32 v221, -1
    v_mov_b32 v222, -1
    v_mov_b32 v223, -1
    s_add_u32 s6, s28, 4
    s_cmp_ge_u32 s93, s6
    s_cbranch_scc1 .nl_74
    s_buffer_load_dword s14, s[8:11], s89 glc
    s_buffer_load_dword s15, s[8:11], s89 offset:8192 glc

.nl_74:
    s_add_u32 s28, s28, 1
    s_add_u32 s36, s36, 196608
    s_cmp_lt_u32 s28, 63
    s_cselect_b32 s4, 262144, 0
    s_add_u32 s38, s38, s4
    s_add_u32 s39, s39, s4
    s_add_u32 s30, s30, s4
    s_mov_b32 s4, s68
    s_mov_b32 s68, s69
    s_mov_b32 s69, s70
    s_mov_b32 s70, s71
    s_mov_b32 s71, s4
    s_and_b32 s4, s28, 3
    s_lshl_b32 s5, s4, 17
    s_add_u32 s29, s5, s34
    s_xor_b32 s6, s5, 262144
    s_add_u32 s31, s6, s34
    s_add_u32 s32, s29, 20480
    s_add_u32 s33, s29, 24576
    s_branch .top_36
.w3_38:
    ds_read_b128 v[36:39], v14 offset:8192
    ds_read_b128 v[40:43], v14 offset:9216
    ds_read_b128 v[44:47], v14 offset:10240
    ds_read_b128 v[48:51], v14 offset:11264
    ds_read_b128 v[88:91], v14 offset:16384
    s_waitcnt lgkmcnt(0)
    v_mfma_f32_16x16x32_bf16 v[104:107], v[84:87], v[36:39], 0
    v_mfma_f32_16x16x32_bf16 v[108:111], v[84:87], v[44:47], 0
    v_mfma_f32_16x16x32_bf16 v[104:107], v[84:87], v[40:43], v[104:107]
    v_mfma_f32_16x16x32_bf16 v[108:111], v[84:87], v[48:51], v[108:111]
    s_nop 7
    v_cvt_pk_bf16_f32 v168, v104, v105
    v_cvt_pk_bf16_f32 v169, v106, v107
    v_cvt_pk_bf16_f32 v170, v108, v109
    v_cvt_pk_bf16_f32 v171, v110, v111
    ds_write_b128 v14, v[168:171] offset:18432
    s_cmp_ge_u32 s28, 62
    s_cbranch_scc1 .sk_75
.sb_76:
.en_34:
    s_waitcnt lgkmcnt(0)
    s_barrier
    buffer_store_dwordx4 v[188:191], v235, s[8:11], s31 offen
    buffer_store_dwordx4 v[188:191], v236, s[8:11], s31 offen

    v_cndmask_b32 v172, v170, v168, s[60:61]
    v_cndmask_b32 v173, v171, v169, s[60:61]

    v_mov_b32 v174, v172
    v_mov_b32 v175, v173
    s_nop 0
    s_nop 0
    v_permlane16_swap_b32 v172, v174
    v_permlane16_swap_b32 v173, v175
    ds_write_b128 v14, v[172:175] offset:17408

    s_branch .gp_39
.A_77:
    s_mov_b64 exec, vcc
    buffer_load_dwordx4 v[32:35], v8, s[8:11], s29 offen offset:3072 sc1
    s_mov_b64 exec, -1
    s_sub_u32 s62, s62, 1
    s_cbranch_scc1 .mg_end_1
    s_waitcnt vmcnt(3)
    v_max_u32 v4, v20, v22
    v_cmp_eq_u32 vcc, -1, v4
    s_cbranch_vccz .W_43
.A_42:
    s_mov_b64 exec, vcc
    buffer_load_dwordx4 v[20:23], v8, s[8:11], s29 offen offset:0 sc1
    s_mov_b64 exec, -1
    s_waitcnt vmcnt(3)
    v_max_u32 v4, v24, v26
    v_cmp_eq_u32 vcc, -1, v4
    s_cbranch_vccz .W_78
.A_79:
    s_mov_b64 exec, vcc
    buffer_load_dwordx4 v[24:27], v8, s[8:11], s29 offen offset:1024 sc1
    s_mov_b64 exec, -1
    s_waitcnt vmcnt(3)
    v_max_u32 v4, v28, v30
    v_cmp_eq_u32 vcc, -1, v4
    s_cbranch_vccz .W_80
.A_81:
    s_mov_b64 exec, vcc
    buffer_load_dwordx4 v[28:31], v8, s[8:11], s29 offen offset:2048 sc1
    s_mov_b64 exec, -1
    s_waitcnt vmcnt(3)
    v_max_u32 v4, v32, v34
    v_cmp_eq_u32 vcc, -1, v4
    s_cbranch_vccnz .A_77
.W_82:
    v_smfmac_f32_16x16x64_bf16 v[52:55], v[32:35], a[24:31], v9
    s_waitcnt vmcnt(2)
    v_max_u32 v4, v20, v22
    v_cmp_eq_u32 vcc, -1, v4
    v_smfmac_f32_16x16x64_bf16 v[56:59], v[32:35], a[56:63], v9
    v_smfmac_f32_16x16x64_bf16 v[60:63], v[32:35], a[88:95], v9
    v_smfmac_f32_16x16x64_bf16 v[64:67], v[32:35], a[120:127], v9
    s_cbranch_vccnz .A_83
.W_84:
    v_smfmac_f32_16x16x64_bf16 v[52:55], v[20:23], a[0:7], v9
    s_waitcnt vmcnt(1)
    v_max_u32 v4, v24, v26
    v_cmp_eq_u32 vcc, -1, v4
    v_smfmac_f32_16x16x64_bf16 v[56:59], v[20:23], a[32:39], v9
    v_smfmac_f32_16x16x64_bf16 v[60:63], v[20:23], a[64:71], v9
    v_smfmac_f32_16x16x64_bf16 v[64:67], v[20:23], a[96:103], v9
    s_cbranch_vccnz .A_85
.W_86:
    v_smfmac_f32_16x16x64_bf16 v[52:55], v[24:27], a[8:15], v9
    s_waitcnt vmcnt(0)
    v_max_u32 v4, v28, v30
    v_cmp_eq_u32 vcc, -1, v4
    v_smfmac_f32_16x16x64_bf16 v[56:59], v[24:27], a[40:47], v9
    v_smfmac_f32_16x16x64_bf16 v[60:63], v[24:27], a[72:79], v9
    v_smfmac_f32_16x16x64_bf16 v[64:67], v[24:27], a[104:111], v9
    s_cbranch_vccnz .A_87
.W_88:
    v_smfmac_f32_16x16x64_bf16 v[52:55], v[28:31], a[16:23], v9
    v_smfmac_f32_16x16x64_bf16 v[56:59], v[28:31], a[48:55], v9
    v_smfmac_f32_16x16x64_bf16 v[60:63], v[28:31], a[80:87], v9
    v_smfmac_f32_16x16x64_bf16 v[64:67], v[28:31], a[112:119], v9
    s_branch .mj_41
.W_78:
    v_smfmac_f32_16x16x64_bf16 v[52:55], v[24:27], a[8:15], v9
    s_waitcnt vmcnt(2)
    v_max_u32 v4, v28, v30
    v_cmp_eq_u32 vcc, -1, v4
    v_smfmac_f32_16x16x64_bf16 v[56:59], v[24:27], a[40:47], v9
    v_smfmac_f32_16x16x64_bf16 v[60:63], v[24:27], a[72:79], v9
    v_smfmac_f32_16x16x64_bf16 v[64:67], v[24:27], a[104:111], v9
    s_cbranch_vccnz .A_89
.W_90:
    v_smfmac_f32_16x16x64_bf16 v[52:55], v[28:31], a[16:23], v9
    s_waitcnt vmcnt(1)
    v_max_u32 v4, v32, v34
    v_cmp_eq_u32 vcc, -1, v4
    v_smfmac_f32_16x16x64_bf16 v[56:59], v[28:31], a[48:55], v9
    v_smfmac_f32_16x16x64_bf16 v[60:63], v[28:31], a[80:87], v9
    v_smfmac_f32_16x16x64_bf16 v[64:67], v[28:31], a[112:119], v9
    s_cbranch_vccnz .A_91
.W_92:
    v_smfmac_f32_16x16x64_bf16 v[52:55], v[32:35], a[24:31], v9
    s_waitcnt vmcnt(0)
    v_max_u32 v4, v20, v22
    v_cmp_eq_u32 vcc, -1, v4
    v_smfmac_f32_16x16x64_bf16 v[56:59], v[32:35], a[56:63], v9
    v_smfmac_f32_16x16x64_bf16 v[60:63], v[32:35], a[88:95], v9
    v_smfmac_f32_16x16x64_bf16 v[64:67], v[32:35], a[120:127], v9
    s_cbranch_vccnz .A_93
.W_94:
    v_smfmac_f32_16x16x64_bf16 v[52:55], v[20:23], a[0:7], v9
    v_smfmac_f32_16x16x64_bf16 v[56:59], v[20:23], a[32:39], v9
    v_smfmac_f32_16x16x64_bf16 v[60:63], v[20:23], a[64:71], v9
    v_smfmac_f32_16x16x64_bf16 v[64:67], v[20:23], a[96:103], v9
    s_branch .mj_41
.W_80:
    v_smfmac_f32_16x16x64_bf16 v[52:55], v[28:31], a[16:23], v9
    s_waitcnt vmcnt(2)
    v_max_u32 v4, v32, v34
    v_cmp_eq_u32 vcc, -1, v4
    v_smfmac_f32_16x16x64_bf16 v[56:59], v[28:31], a[48:55], v9
    v_smfmac_f32_16x16x64_bf16 v[60:63], v[28:31], a[80:87], v9
    v_smfmac_f32_16x16x64_bf16 v[64:67], v[28:31], a[112:119], v9
    s_cbranch_vccnz .A_95
.W_96:
    v_smfmac_f32_16x16x64_bf16 v[52:55], v[32:35], a[24:31], v9
    s_waitcnt vmcnt(1)
    v_max_u32 v4, v20, v22
    v_cmp_eq_u32 vcc, -1, v4
    v_smfmac_f32_16x16x64_bf16 v[56:59], v[32:35], a[56:63], v9
    v_smfmac_f32_16x16x64_bf16 v[60:63], v[32:35], a[88:95], v9
    v_smfmac_f32_16x16x64_bf16 v[64:67], v[32:35], a[120:127], v9
    s_cbranch_vccnz .A_97
.W_98:
    v_smfmac_f32_16x16x64_bf16 v[52:55], v[20:23], a[0:7], v9
    s_waitcnt vmcnt(0)
    v_max_u32 v4, v24, v26
    v_cmp_eq_u32 vcc, -1, v4
    v_smfmac_f32_16x16x64_bf16 v[56:59], v[20:23], a[32:39], v9
    v_smfmac_f32_16x16x64_bf16 v[60:63], v[20:23], a[64:71], v9
    v_smfmac_f32_16x16x64_bf16 v[64:67], v[20:23], a[96:103], v9
    s_cbranch_vccnz .A_99
.W_100:
    v_smfmac_f32_16x16x64_bf16 v[52:55], v[24:27], a[8:15], v9
    v_smfmac_f32_16x16x64_bf16 v[56:59], v[24:27], a[40:47], v9
    v_smfmac_f32_16x16x64_bf16 v[60:63], v[24:27], a[72:79], v9
    v_smfmac_f32_16x16x64_bf16 v[64:67], v[24:27], a[104:111], v9
    s_branch .mj_41
.A_101:
    s_mov_b64 exec, vcc
    buffer_load_dwordx4 v[28:31], v8, s[8:11], s29 offen offset:2048 sc1
    s_mov_b64 exec, -1
    s_sub_u32 s62, s62, 1
    s_cbranch_scc1 .mg_end_1
    s_waitcnt vmcnt(2)
    v_max_u32 v4, v20, v22
    v_cmp_eq_u32 vcc, -1, v4
    s_cbranch_vccz .W_84
.A_83:
    s_mov_b64 exec, vcc
    buffer_load_dwordx4 v[20:23], v8, s[8:11], s29 offen offset:0 sc1
    s_mov_b64 exec, -1
    s_waitcnt vmcnt(2)
    v_max_u32 v4, v24, v26
    v_cmp_eq_u32 vcc, -1, v4
    s_cbranch_vccz .W_102
.A_103:
    s_mov_b64 exec, vcc
    buffer_load_dwordx4 v[24:27], v8, s[8:11], s29 offen offset:1024 sc1
    s_mov_b64 exec, -1
    s_waitcnt vmcnt(2)
    v_max_u32 v4, v28, v30
    v_cmp_eq_u32 vcc, -1, v4
    s_cbranch_vccnz .A_101
.W_104:
    v_smfmac_f32_16x16x64_bf16 v[52:55], v[28:31], a[16:23], v9
    s_waitcnt vmcnt(1)
    v_max_u32 v4, v20, v22
    v_cmp_eq_u32 vcc, -1, v4
    v_smfmac_f32_16x16x64_bf16 v[56:59], v[28:31], a[48:55], v9
    v_smfmac_f32_16x16x64_bf16 v[60:63], v[28:31], a[80:87], v9
    v_smfmac_f32_16x16x64_bf16 v[64:67], v[28:31], a[112:119], v9
    s_cbranch_vccz .W_98
    s_branch .A_97
.W_102:
    v_smfmac_f32_16x16x64_bf16 v[52:55], v[24:27], a[8:15], v9
    s_waitcnt vmcnt(1)
    v_max_u32 v4, v28, v30
    v_cmp_eq_u32 vcc, -1, v4
    v_smfmac_f32_16x16x64_bf16 v[56:59], v[24:27], a[40:47], v9
    v_smfmac_f32_16x16x64_bf16 v[60:63], v[24:27], a[72:79], v9
    v_smfmac_f32_16x16x64_bf16 v[64:67], v[24:27], a[104:111], v9
    s_cbranch_vccnz .A_105
.W_106:
    v_smfmac_f32_16x16x64_bf16 v[52:55], v[28:31], a[16:23], v9
    s_waitcnt vmcnt(0)
    v_max_u32 v4, v20, v22
    v_cmp_eq_u32 vcc, -1, v4
    v_smfmac_f32_16x16x64_bf16 v[56:59], v[28:31], a[48:55], v9
    v_smfmac_f32_16x16x64_bf16 v[60:63], v[28:31], a[80:87], v9
    v_smfmac_f32_16x16x64_bf16 v[64:67], v[28:31], a[112:119], v9
    s_cbranch_vccz .W_94
    s_branch .A_93
.A_107:
    s_mov_b64 exec, vcc
    buffer_load_dwordx4 v[24:27], v8, s[8:11], s29 offen offset:1024 sc1
    s_mov_b64 exec, -1
    s_sub_u32 s62, s62, 1
    s_cbranch_scc1 .mg_end_1
    s_waitcnt vmcnt(2)
    v_max_u32 v4, v32, v34
    v_cmp_eq_u32 vcc, -1, v4
    s_cbranch_vccz .W_96
.A_95:
    s_mov_b64 exec, vcc
    buffer_load_dwordx4 v[32:35], v8, s[8:11], s29 offen offset:3072 sc1
    s_mov_b64 exec, -1
    s_waitcnt vmcnt(2)
    v_max_u32 v4, v20, v22
    v_cmp_eq_u32 vcc, -1, v4
    s_cbranch_vccz .W_108
.A_109:
    s_mov_b64 exec, vcc
    buffer_load_dwordx4 v[20:23], v8, s[8:11], s29 offen offset:0 sc1
    s_mov_b64 exec, -1
    s_waitcnt vmcnt(2)
    v_max_u32 v4, v24, v26
    v_cmp_eq_u32 vcc, -1, v4
    s_cbranch_vccnz .A_107
.W_110:
    v_smfmac_f32_16x16x64_bf16 v[52:55], v[24:27], a[8:15], v9
    s_waitcnt vmcnt(1)
    v_max_u32 v4, v32, v34
    v_cmp_eq_u32 vcc, -1, v4
    v_smfmac_f32_16x16x64_bf16 v[56:59], v[24:27], a[40:47], v9
    v_smfmac_f32_16x16x64_bf16 v[60:63], v[24:27], a[72:79], v9
    v_smfmac_f32_16x16x64_bf16 v[64:67], v[24:27], a[104:111], v9
    s_cbranch_vccz .W_92
    s_branch .A_91
.W_108:
    v_smfmac_f32_16x16x64_bf16 v[52:55], v[20:23], a[0:7], v9
    s_waitcnt vmcnt(1)
    v_max_u32 v4, v24, v26
    v_cmp_eq_u32 vcc, -1, v4
    v_smfmac_f32_16x16x64_bf16 v[56:59], v[20:23], a[32:39], v9
    v_smfmac_f32_16x16x64_bf16 v[60:63], v[20:23], a[64:71], v9
    v_smfmac_f32_16x16x64_bf16 v[64:67], v[20:23], a[96:103], v9
    s_cbranch_vccnz .A_111
.W_112:
    v_smfmac_f32_16x16x64_bf16 v[52:55], v[24:27], a[8:15], v9
    s_waitcnt vmcnt(0)
    v_max_u32 v4, v32, v34
    v_cmp_eq_u32 vcc, -1, v4
    v_smfmac_f32_16x16x64_bf16 v[56:59], v[24:27], a[40:47], v9
    v_smfmac_f32_16x16x64_bf16 v[60:63], v[24:27], a[72:79], v9
    v_smfmac_f32_16x16x64_bf16 v[64:67], v[24:27], a[104:111], v9
    s_cbranch_vccz .W_49
    s_branch .A_48
.A_113:
    s_mov_b64 exec, vcc
    buffer_load_dwordx4 v[32:35], v8, s[8:11], s29 offen offset:3072 sc1
    s_mov_b64 exec, -1
    s_sub_u32 s62, s62, 1
    s_cbranch_scc1 .mg_end_1
    s_waitcnt vmcnt(2)
    v_max_u32 v4, v20, v22
    v_cmp_eq_u32 vcc, -1, v4
    s_cbranch_vccz .W_114
.A_115:
    s_mov_b64 exec, vcc
    buffer_load_dwordx4 v[20:23], v8, s[8:11], s29 offen offset:0 sc1
    s_mov_b64 exec, -1
    s_waitcnt vmcnt(2)
    v_max_u32 v4, v28, v30
    v_cmp_eq_u32 vcc, -1, v4
    s_cbranch_vccz .W_90
.A_89:
    s_mov_b64 exec, vcc
    buffer_load_dwordx4 v[28:31], v8, s[8:11], s29 offen offset:2048 sc1
    s_mov_b64 exec, -1
    s_waitcnt vmcnt(2)
    v_max_u32 v4, v32, v34
    v_cmp_eq_u32 vcc, -1, v4
    s_cbranch_vccnz .A_113
.W_116:
    v_smfmac_f32_16x16x64_bf16 v[52:55], v[32:35], a[24:31], v9
    s_waitcnt vmcnt(1)
    v_max_u32 v4, v20, v22
    v_cmp_eq_u32 vcc, -1, v4
    v_smfmac_f32_16x16x64_bf16 v[56:59], v[32:35], a[56:63], v9
    v_smfmac_f32_16x16x64_bf16 v[60:63], v[32:35], a[88:95], v9
    v_smfmac_f32_16x16x64_bf16 v[64:67], v[32:35], a[120:127], v9
    s_cbranch_vccnz .A_117
.W_118:
    v_smfmac_f32_16x16x64_bf16 v[52:55], v[20:23], a[0:7], v9
    s_waitcnt vmcnt(0)
    v_max_u32 v4, v28, v30
    v_cmp_eq_u32 vcc, -1, v4
    v_smfmac_f32_16x16x64_bf16 v[56:59], v[20:23], a[32:39], v9
    v_smfmac_f32_16x16x64_bf16 v[60:63], v[20:23], a[64:71], v9
    v_smfmac_f32_16x16x64_bf16 v[64:67], v[20:23], a[96:103], v9
    s_cbranch_vccz .W_88
    s_branch .A_87
.W_114:
    v_smfmac_f32_16x16x64_bf16 v[52:55], v[20:23], a[0:7], v9
    s_waitcnt vmcnt(1)
    v_max_u32 v4, v28, v30
    v_cmp_eq_u32 vcc, -1, v4
    v_smfmac_f32_16x16x64_bf16 v[56:59], v[20:23], a[32:39], v9
    v_smfmac_f32_16x16x64_bf16 v[60:63], v[20:23], a[64:71], v9
    v_smfmac_f32_16x16x64_bf16 v[64:67], v[20:23], a[96:103], v9
    s_cbranch_vccz .W_47
    s_branch .A_46
.A_119:
    s_mov_b64 exec, vcc
    buffer_load_dwordx4 v[32:35], v8, s[8:11], s29 offen offset:3072 sc1
    s_mov_b64 exec, -1
    s_sub_u32 s62, s62, 1
    s_cbranch_scc1 .mg_end_1
    s_waitcnt vmcnt(2)
    v_max_u32 v4, v24, v26
    v_cmp_eq_u32 vcc, -1, v4
    s_cbranch_vccz .W_45
.A_44:
    s_mov_b64 exec, vcc
    buffer_load_dwordx4 v[24:27], v8, s[8:11], s29 offen offset:1024 sc1
    s_mov_b64 exec, -1
    s_waitcnt vmcnt(2)
    v_max_u32 v4, v28, v30
    v_cmp_eq_u32 vcc, -1, v4
    s_cbranch_vccz .W_120
.A_121:
    s_mov_b64 exec, vcc
    buffer_load_dwordx4 v[28:31], v8, s[8:11], s29 offen offset:2048 sc1
    s_mov_b64 exec, -1
    s_waitcnt vmcnt(2)
    v_max_u32 v4, v32, v34
    v_cmp_eq_u32 vcc, -1, v4
    s_cbranch_vccnz .A_119
.W_122:
    v_smfmac_f32_16x16x64_bf16 v[52:55], v[32:35], a[24:31], v9
    s_waitcnt vmcnt(1)
    v_max_u32 v4, v24, v26
    v_cmp_eq_u32 vcc, -1, v4
    v_smfmac_f32_16x16x64_bf16 v[56:59], v[32:35], a[56:63], v9
    v_smfmac_f32_16x16x64_bf16 v[60:63], v[32:35], a[88:95], v9
    v_smfmac_f32_16x16x64_bf16 v[64:67], v[32:35], a[120:127], v9
    s_cbranch_vccz .W_86
    s_branch .A_85
.W_120:
    v_smfmac_f32_16x16x64_bf16 v[52:55], v[28:31], a[16:23], v9
    s_waitcnt vmcnt(1)
    v_max_u32 v4, v32, v34
    v_cmp_eq_u32 vcc, -1, v4
    v_smfmac_f32_16x16x64_bf16 v[56:59], v[28:31], a[48:55], v9
    v_smfmac_f32_16x16x64_bf16 v[60:63], v[28:31], a[80:87], v9
    v_smfmac_f32_16x16x64_bf16 v[64:67], v[28:31], a[112:119], v9
    s_cbranch_vccnz .A_123
.W_124:
    v_smfmac_f32_16x16x64_bf16 v[52:55], v[32:35], a[24:31], v9
    s_waitcnt vmcnt(0)
    v_max_u32 v4, v24, v26
    v_cmp_eq_u32 vcc, -1, v4
    v_smfmac_f32_16x16x64_bf16 v[56:59], v[32:35], a[56:63], v9
    v_smfmac_f32_16x16x64_bf16 v[60:63], v[32:35], a[88:95], v9
    v_smfmac_f32_16x16x64_bf16 v[64:67], v[32:35], a[120:127], v9
    s_cbranch_vccz .W_100
    s_branch .A_99
.A_125:
    s_mov_b64 exec, vcc
    buffer_load_dwordx4 v[24:27], v8, s[8:11], s29 offen offset:1024 sc1
    s_mov_b64 exec, -1
    s_sub_u32 s62, s62, 1
    s_cbranch_scc1 .mg_end_1
    s_waitcnt vmcnt(1)
    v_max_u32 v4, v20, v22
    v_cmp_eq_u32 vcc, -1, v4
    s_cbranch_vccz .W_98
.A_97:
    s_mov_b64 exec, vcc
    buffer_load_dwordx4 v[20:23], v8, s[8:11], s29 offen offset:0 sc1
    s_mov_b64 exec, -1
    s_waitcnt vmcnt(1)
    v_max_u32 v4, v24, v26
    v_cmp_eq_u32 vcc, -1, v4
    s_cbranch_vccnz .A_125
.W_126:
    v_smfmac_f32_16x16x64_bf16 v[52:55], v[24:27], a[8:15], v9
    s_waitcnt vmcnt(0)
    v_max_u32 v4, v20, v22
    v_cmp_eq_u32 vcc, -1, v4
    v_smfmac_f32_16x16x64_bf16 v[56:59], v[24:27], a[40:47], v9
    v_smfmac_f32_16x16x64_bf16 v[60:63], v[24:27], a[72:79], v9
    v_smfmac_f32_16x16x64_bf16 v[64:67], v[24:27], a[104:111], v9
    s_cbranch_vccz .W_94
    s_branch .A_93
.A_105:
    s_mov_b64 exec, vcc
    buffer_load_dwordx4 v[28:31], v8, s[8:11], s29 offen offset:2048 sc1
    s_mov_b64 exec, -1
    s_sub_u32 s62, s62, 1
    s_cbranch_scc1 .mg_end_1
    s_waitcnt vmcnt(1)
    v_max_u32 v4, v20, v22
    v_cmp_eq_u32 vcc, -1, v4
    s_cbranch_vccz .W_118
.A_117:
    s_mov_b64 exec, vcc
    buffer_load_dwordx4 v[20:23], v8, s[8:11], s29 offen offset:0 sc1
    s_mov_b64 exec, -1
    s_waitcnt vmcnt(1)
    v_max_u32 v4, v28, v30
    v_cmp_eq_u32 vcc, -1, v4
    s_cbranch_vccnz .A_105
    s_branch .W_106
.A_127:
    s_mov_b64 exec, vcc
    buffer_load_dwordx4 v[20:23], v8, s[8:11], s29 offen offset:0 sc1
    s_mov_b64 exec, -1
    s_sub_u32 s62, s62, 1
    s_cbranch_scc1 .mg_end_1
    s_waitcnt vmcnt(1)
    v_max_u32 v4, v32, v34
    v_cmp_eq_u32 vcc, -1, v4
    s_cbranch_vccz .W_92
.A_91:
    s_mov_b64 exec, vcc
    buffer_load_dwordx4 v[32:35], v8, s[8:11], s29 offen offset:3072 sc1
    s_mov_b64 exec, -1
    s_waitcnt vmcnt(1)
    v_max_u32 v4, v20, v22
    v_cmp_eq_u32 vcc, -1, v4
    s_cbranch_vccnz .A_127
.W_128:
    v_smfmac_f32_16x16x64_bf16 v[52:55], v[20:23], a[0:7], v9
    s_waitcnt vmcnt(0)
    v_max_u32 v4, v32, v34
    v_cmp_eq_u32 vcc, -1, v4
    v_smfmac_f32_16x16x64_bf16 v[56:59], v[20:23], a[32:39], v9
    v_smfmac_f32_16x16x64_bf16 v[60:63], v[20:23], a[64:71], v9
    v_smfmac_f32_16x16x64_bf16 v[64:67], v[20:23], a[96:103], v9
    s_cbranch_vccz .W_49
    s_branch .A_48
.A_129:
    s_mov_b64 exec, vcc
    buffer_load_dwordx4 v[28:31], v8, s[8:11], s29 offen offset:2048 sc1
    s_mov_b64 exec, -1
    s_sub_u32 s62, s62, 1
    s_cbranch_scc1 .mg_end_1
    s_waitcnt vmcnt(1)
    v_max_u32 v4, v24, v26
    v_cmp_eq_u32 vcc, -1, v4
    s_cbranch_vccz .W_86
.A_85:
    s_mov_b64 exec, vcc
    buffer_load_dwordx4 v[24:27], v8, s[8:11], s29 offen offset:1024 sc1
    s_mov_b64 exec, -1
    s_waitcnt vmcnt(1)
    v_max_u32 v4, v28, v30
    v_cmp_eq_u32 vcc, -1, v4
    s_cbranch_vccnz .A_129
.W_130:
    v_smfmac_f32_16x16x64_bf16 v[52:55], v[28:31], a[16:23], v9
    s_waitcnt vmcnt(0)
    v_max_u32 v4, v24, v26
    v_cmp_eq_u32 vcc, -1, v4
    v_smfmac_f32_16x16x64_bf16 v[56:59], v[28:31], a[48:55], v9
    v_smfmac_f32_16x16x64_bf16 v[60:63], v[28:31], a[80:87], v9
    v_smfmac_f32_16x16x64_bf16 v[64:67], v[28:31], a[112:119], v9
    s_cbranch_vccz .W_100
    s_branch .A_99
.A_123:
    s_mov_b64 exec, vcc
    buffer_load_dwordx4 v[32:35], v8, s[8:11], s29 offen offset:3072 sc1
    s_mov_b64 exec, -1
    s_sub_u32 s62, s62, 1
    s_cbranch_scc1 .mg_end_1
    s_waitcnt vmcnt(1)
    v_max_u32 v4, v24, v26
    v_cmp_eq_u32 vcc, -1, v4
    s_cbranch_vccz .W_112
.A_111:
    s_mov_b64 exec, vcc
    buffer_load_dwordx4 v[24:27], v8, s[8:11], s29 offen offset:1024 sc1
    s_mov_b64 exec, -1
    s_waitcnt vmcnt(1)
    v_max_u32 v4, v32, v34
    v_cmp_eq_u32 vcc, -1, v4
    s_cbranch_vccnz .A_123
    s_branch .W_124
.A_131:
    s_mov_b64 exec, vcc
    buffer_load_dwordx4 v[32:35], v8, s[8:11], s29 offen offset:3072 sc1
    s_mov_b64 exec, -1
    s_sub_u32 s62, s62, 1
    s_cbranch_scc1 .mg_end_1
    s_waitcnt vmcnt(1)
    v_max_u32 v4, v28, v30
    v_cmp_eq_u32 vcc, -1, v4
    s_cbranch_vccz .W_47
.A_46:
    s_mov_b64 exec, vcc
    buffer_load_dwordx4 v[28:31], v8, s[8:11], s29 offen offset:2048 sc1
    s_mov_b64 exec, -1
    s_waitcnt vmcnt(1)
    v_max_u32 v4, v32, v34
    v_cmp_eq_u32 vcc, -1, v4
    s_cbranch_vccnz .A_131
.W_132:
    v_smfmac_f32_16x16x64_bf16 v[52:55], v[32:35], a[24:31], v9
    s_waitcnt vmcnt(0)
    v_max_u32 v4, v28, v30
    v_cmp_eq_u32 vcc, -1, v4
    v_smfmac_f32_16x16x64_bf16 v[56:59], v[32:35], a[56:63], v9
    v_smfmac_f32_16x16x64_bf16 v[60:63], v[32:35], a[88:95], v9
    v_smfmac_f32_16x16x64_bf16 v[64:67], v[32:35], a[120:127], v9
    s_cbranch_vccz .W_88
    s_branch .A_87
.A_93:
    s_mov_b64 exec, vcc
    buffer_load_dwordx4 v[20:23], v8, s[8:11], s29 offen offset:0 sc1
    s_mov_b64 exec, -1
    s_sub_u32 s62, s62, 1
    s_cbranch_scc1 .mg_end_1
    s_waitcnt vmcnt(1)
    v_max3_u32 v4, v20, v21, v22
    v_max_u32 v4, v4, v23
    v_cmp_eq_u32 vcc, -1, v4
    s_cbranch_vccnz .A_93
    v_smfmac_f32_16x16x64_bf16 v[52:55], v[20:23], a[0:7], v9
    v_smfmac_f32_16x16x64_bf16 v[56:59], v[20:23], a[32:39], v9
    v_smfmac_f32_16x16x64_bf16 v[60:63], v[20:23], a[64:71], v9
    v_smfmac_f32_16x16x64_bf16 v[64:67], v[20:23], a[96:103], v9
    s_branch .mj_41
.A_99:
    s_mov_b64 exec, vcc
    buffer_load_dwordx4 v[24:27], v8, s[8:11], s29 offen offset:1024 sc1
    s_mov_b64 exec, -1
    s_sub_u32 s62, s62, 1
    s_cbranch_scc1 .mg_end_1
    s_waitcnt vmcnt(1)
    v_max3_u32 v4, v24, v25, v26
    v_max_u32 v4, v4, v27
    v_cmp_eq_u32 vcc, -1, v4
    s_cbranch_vccnz .A_99
    v_smfmac_f32_16x16x64_bf16 v[52:55], v[24:27], a[8:15], v9
    v_smfmac_f32_16x16x64_bf16 v[56:59], v[24:27], a[40:47], v9
    v_smfmac_f32_16x16x64_bf16 v[60:63], v[24:27], a[72:79], v9
    v_smfmac_f32_16x16x64_bf16 v[64:67], v[24:27], a[104:111], v9
    s_branch .mj_41
.A_87:
    s_mov_b64 exec, vcc
    buffer_load_dwordx4 v[28:31], v8, s[8:11], s29 offen offset:2048 sc1
    s_mov_b64 exec, -1
    s_sub_u32 s62, s62, 1
    s_cbranch_scc1 .mg_end_1
    s_waitcnt vmcnt(1)
    v_max3_u32 v4, v28, v29, v30
    v_max_u32 v4, v4, v31
    v_cmp_eq_u32 vcc, -1, v4
    s_cbranch_vccnz .A_87
    v_smfmac_f32_16x16x64_bf16 v[52:55], v[28:31], a[16:23], v9
    v_smfmac_f32_16x16x64_bf16 v[56:59], v[28:31], a[48:55], v9
    v_smfmac_f32_16x16x64_bf16 v[60:63], v[28:31], a[80:87], v9
    v_smfmac_f32_16x16x64_bf16 v[64:67], v[28:31], a[112:119], v9
    s_branch .mj_41
.A_48:
    s_mov_b64 exec, vcc
    buffer_load_dwordx4 v[32:35], v8, s[8:11], s29 offen offset:3072 sc1
    s_mov_b64 exec, -1
    s_sub_u32 s62, s62, 1
    s_cbranch_scc1 .mg_end_1
    s_waitcnt vmcnt(1)
    v_max3_u32 v4, v32, v33, v34
    v_max_u32 v4, v4, v35
    v_cmp_eq_u32 vcc, -1, v4
    s_cbranch_vccnz .A_48
    v_smfmac_f32_16x16x64_bf16 v[52:55], v[32:35], a[24:31], v9
    v_smfmac_f32_16x16x64_bf16 v[56:59], v[32:35], a[56:63], v9
    v_smfmac_f32_16x16x64_bf16 v[60:63], v[32:35], a[88:95], v9
    v_smfmac_f32_16x16x64_bf16 v[64:67], v[32:35], a[120:127], v9
    s_branch .mj_41
.A_133:
    buffer_load_dwordx4 v[100:103], v234, s[8:11], s29 offen sc1
    s_sub_u32 s62, s62, 1
    s_cbranch_scc1 .mg_end_1
    s_waitcnt vmcnt(2)
    v_max_u32 v4, v92, v94
    v_cmp_eq_u32 vcc, -1, v4
    s_cbranch_vccz .W_52
.A_51:
    buffer_load_dwordx4 v[92:95], v232, s[8:11], s29 offen sc1
    s_waitcnt vmcnt(2)
    v_max_u32 v4, v96, v98
    v_cmp_eq_u32 vcc, -1, v4
    s_cbranch_vccz .W_134
.A_135:
    buffer_load_dwordx4 v[96:99], v233, s[8:11], s29 offen sc1
    s_waitcnt vmcnt(2)
    v_max_u32 v4, v100, v102
    v_cmp_eq_u32 vcc, -1, v4
    s_cbranch_vccnz .A_133
.W_136:
    v_mfma_f32_16x16x32_bf16 v[208:211], v[140:143], v[100:103], v[208:211]
    s_waitcnt vmcnt(1)
    v_max_u32 v4, v92, v94
    v_cmp_eq_u32 vcc, -1, v4
    v_mfma_f32_16x16x32_bf16 v[212:215], v[156:159], v[100:103], v[212:215]
    v_mfma_f32_16x16x32_bf16 v[216:219], v[100:103], v[100:103], v[216:219]
    s_cbranch_vccnz .A_137
.W_138:
    v_mfma_f32_16x16x32_bf16 v[208:211], v[132:135], v[92:95], v[208:211]
    s_waitcnt vmcnt(0)
    v_max_u32 v4, v96, v98
    v_cmp_eq_u32 vcc, -1, v4
    v_mfma_f32_16x16x32_bf16 v[212:215], v[148:151], v[92:95], v[212:215]
    v_mfma_f32_16x16x32_bf16 v[216:219], v[92:95], v[92:95], v[216:219]
    s_cbranch_vccnz .A_139
.W_140:
    v_mfma_f32_16x16x32_bf16 v[208:211], v[136:139], v[96:99], v[208:211]
    s_barrier
    v_mfma_f32_16x16x32_bf16 v[212:215], v[152:155], v[96:99], v[212:215]
    v_mfma_f32_16x16x32_bf16 v[216:219], v[96:99], v[96:99], v[216:219]
    s_branch .mj_50
.W_134:
    v_mfma_f32_16x16x32_bf16 v[208:211], v[136:139], v[96:99], v[208:211]
    s_waitcnt vmcnt(1)
    v_max_u32 v4, v100, v102
    v_cmp_eq_u32 vcc, -1, v4
    v_mfma_f32_16x16x32_bf16 v[212:215], v[152:155], v[96:99], v[212:215]
    v_mfma_f32_16x16x32_bf16 v[216:219], v[96:99], v[96:99], v[216:219]
    s_cbranch_vccnz .A_141
.W_142:
    v_mfma_f32_16x16x32_bf16 v[208:211], v[140:143], v[100:103], v[208:211]
    s_waitcnt vmcnt(0)
    v_max_u32 v4, v92, v94
    v_cmp_eq_u32 vcc, -1, v4
    v_mfma_f32_16x16x32_bf16 v[212:215], v[156:159], v[100:103], v[212:215]
    v_mfma_f32_16x16x32_bf16 v[216:219], v[100:103], v[100:103], v[216:219]
    s_cbranch_vccnz .A_143
.W_144:
    v_mfma_f32_16x16x32_bf16 v[208:211], v[132:135], v[92:95], v[208:211]
    s_barrier
    v_mfma_f32_16x16x32_bf16 v[212:215], v[148:151], v[92:95], v[212:215]
    v_mfma_f32_16x16x32_bf16 v[216:219], v[92:95], v[92:95], v[216:219]
    s_branch .mj_50
.A_145:
    buffer_load_dwordx4 v[96:99], v233, s[8:11], s29 offen sc1
    s_sub_u32 s62, s62, 1
    s_cbranch_scc1 .mg_end_1
    s_waitcnt vmcnt(1)
    v_max_u32 v4, v92, v94
    v_cmp_eq_u32 vcc, -1, v4
    s_cbranch_vccz .W_138
.A_137:
    buffer_load_dwordx4 v[92:95], v232, s[8:11], s29 offen sc1
    s_waitcnt vmcnt(1)
    v_max_u32 v4, v96, v98
    v_cmp_eq_u32 vcc, -1, v4
    s_cbranch_vccnz .A_145
.W_146:
    v_mfma_f32_16x16x32_bf16 v[208:211], v[136:139], v[96:99], v[208:211]
    s_waitcnt vmcnt(0)
    v_max_u32 v4, v92, v94
    v_cmp_eq_u32 vcc, -1, v4
    v_mfma_f32_16x16x32_bf16 v[212:215], v[152:155], v[96:99], v[212:215]
    v_mfma_f32_16x16x32_bf16 v[216:219], v[96:99], v[96:99], v[216:219]
    s_cbranch_vccz .W_144
    s_branch .A_143
.A_147:
    buffer_load_dwordx4 v[92:95], v232, s[8:11], s29 offen sc1
    s_sub_u32 s62, s62, 1
    s_cbranch_scc1 .mg_end_1
    s_waitcnt vmcnt(1)
    v_max_u32 v4, v100, v102
    v_cmp_eq_u32 vcc, -1, v4
    s_cbranch_vccz .W_142
.A_141:
    buffer_load_dwordx4 v[100:103], v234, s[8:11], s29 offen sc1
    s_waitcnt vmcnt(1)
    v_max_u32 v4, v92, v94
    v_cmp_eq_u32 vcc, -1, v4
    s_cbranch_vccnz .A_147
.W_148:
    v_mfma_f32_16x16x32_bf16 v[208:211], v[132:135], v[92:95], v[208:211]
    s_waitcnt vmcnt(0)
    v_max_u32 v4, v100, v102
    v_cmp_eq_u32 vcc, -1, v4
    v_mfma_f32_16x16x32_bf16 v[212:215], v[148:151], v[92:95], v[212:215]
    v_mfma_f32_16x16x32_bf16 v[216:219], v[92:95], v[92:95], v[216:219]
    s_cbranch_vccz .W_56
    s_branch .A_55
.A_149:
    buffer_load_dwordx4 v[100:103], v234, s[8:11], s29 offen sc1
    s_sub_u32 s62, s62, 1
    s_cbranch_scc1 .mg_end_1
    s_waitcnt vmcnt(1)
    v_max_u32 v4, v96, v98
    v_cmp_eq_u32 vcc, -1, v4
    s_cbranch_vccz .W_54
.A_53:
    buffer_load_dwordx4 v[96:99], v233, s[8:11], s29 offen sc1
    s_waitcnt vmcnt(1)
    v_max_u32 v4, v100, v102
    v_cmp_eq_u32 vcc, -1, v4
    s_cbranch_vccnz .A_149
.W_150:
    v_mfma_f32_16x16x32_bf16 v[208:211], v[140:143], v[100:103], v[208:211]
    s_waitcnt vmcnt(0)
    v_max_u32 v4, v96, v98
    v_cmp_eq_u32 vcc, -1, v4
    v_mfma_f32_16x16x32_bf16 v[212:215], v[156:159], v[100:103], v[212:215]
    v_mfma_f32_16x16x32_bf16 v[216:219], v[100:103], v[100:103], v[216:219]
    s_cbranch_vccz .W_140
    s_branch .A_139
.A_143:
    buffer_load_dwordx4 v[92:95], v232, s[8:11], s29 offen sc1
    s_sub_u32 s62, s62, 1
    s_cbranch_scc1 .mg_end_1
    s_waitcnt vmcnt(1)
    v_max3_u32 v4, v92, v93, v94
    v_max_u32 v4, v4, v95
    v_cmp_eq_u32 vcc, -1, v4
    s_cbranch_vccnz .A_143
    v_mfma_f32_16x16x32_bf16 v[208:211], v[132:135], v[92:95], v[208:211]
    s_barrier
    v_mfma_f32_16x16x32_bf16 v[212:215], v[148:151], v[92:95], v[212:215]
    v_mfma_f32_16x16x32_bf16 v[216:219], v[92:95], v[92:95], v[216:219]
    s_branch .mj_50
.A_139:
    buffer_load_dwordx4 v[96:99], v233, s[8:11], s29 offen sc1
    s_sub_u32 s62, s62, 1
    s_cbranch_scc1 .mg_end_1
    s_waitcnt vmcnt(1)
    v_max3_u32 v4, v96, v97, v98
    v_max_u32 v4, v4, v99
    v_cmp_eq_u32 vcc, -1, v4
    s_cbranch_vccnz .A_139
    v_mfma_f32_16x16x32_bf16 v[208:211], v[136:139], v[96:99], v[208:211]
    s_barrier
    v_mfma_f32_16x16x32_bf16 v[212:215], v[152:155], v[96:99], v[212:215]
    v_mfma_f32_16x16x32_bf16 v[216:219], v[96:99], v[96:99], v[216:219]
    s_branch .mj_50
.A_55:
    buffer_load_dwordx4 v[100:103], v234, s[8:11], s29 offen sc1
    s_sub_u32 s62, s62, 1
    s_cbranch_scc1 .mg_end_1
    s_waitcnt vmcnt(1)
    v_max3_u32 v4, v100, v101, v102
    v_max_u32 v4, v4, v103
    v_cmp_eq_u32 vcc, -1, v4
    s_cbranch_vccnz .A_55
    v_mfma_f32_16x16x32_bf16 v[208:211], v[140:143], v[100:103], v[208:211]
    s_barrier
    v_mfma_f32_16x16x32_bf16 v[212:215], v[156:159], v[100:103], v[212:215]
    v_mfma_f32_16x16x32_bf16 v[216:219], v[100:103], v[100:103], v[216:219]
    s_branch .mj_50
.kf_63:
    s_mov_b32 s62, 0
    s_mov_b64 exec, 3
.wf_151:
    buffer_load_dword v244, v253, s[8:11], s89 offen sc1
    s_waitcnt vmcnt(0)
    v_cmp_gt_u32 vcc, s6, v244
    s_cbranch_vccz .wfd_152
    s_sleep 2
    s_add_u32 s62, s62, 1
    s_cmp_gt_u32 s62, 0x400000
    s_cbranch_scc1 .mg_end_1
    s_branch .wf_151

.wfd_152:
    s_mov_b64 exec, -1
    v_readlane_b32 s4, v244, 0
    v_readlane_b32 s93, v244, 1
    s_min_u32 s93, s93, s4
    s_mov_b32 s62, 0x1000000
    s_branch .kb_64
.A_153:
    buffer_load_dwordx4 v[216:219], v246, s[8:11], s32 offen offset:0 sc1
    buffer_load_dwordx4 v[220:223], v246, s[8:11], s32 offen offset:1024 sc1
    s_sub_u32 s62, s62, 1
    s_cbranch_scc1 .mg_end_1
    s_waitcnt vmcnt(6)
    v_max_u32 v4, v192, v196
    v_cmp_eq_u32 vcc, -1, v4
    s_cbranch_vccz .W_67
.A_66:
    buffer_load_dwordx4 v[192:195], v243, s[8:11], s32 offen offset:0 sc1
    buffer_load_dwordx4 v[196:199], v243, s[8:11], s32 offen offset:1024 sc1
    s_waitcnt vmcnt(6)
    v_max_u32 v4, v200, v204
    v_cmp_eq_u32 vcc, -1, v4
    s_cbranch_vccz .W_154
.A_155:
    buffer_load_dwordx4 v[200:203], v252, s[8:11], s32 offen offset:0 sc1
    buffer_load_dwordx4 v[204:207], v252, s[8:11], s32 offen offset:1024 sc1
    s_waitcnt vmcnt(6)
    v_max_u32 v4, v208, v212
    v_cmp_eq_u32 vcc, -1, v4
    s_cbranch_vccz .W_156
.A_157:
    buffer_load_dwordx4 v[208:211], v254, s[8:11], s32 offen offset:0 sc1
    buffer_load_dwordx4 v[212:215], v254, s[8:11], s32 offen offset:1024 sc1
    s_waitcnt vmcnt(6)
    v_max_u32 v4, v216, v220
    v_cmp_eq_u32 vcc, -1, v4
    s_cbranch_vccnz .A_153
.W_158:
    v_smfmac_f32_16x16x64_bf16 v[76:79], v[216:219], v[140:147], v9
    s_waitcnt vmcnt(4)
    v_max_u32 v4, v192, v196
    v_cmp_eq_u32 vcc, -1, v4
    v_smfmac_f32_16x16x64_bf16 v[80:83], v[216:219], v[172:179], v9
    v_smfmac_f32_16x16x64_bf16 v[76:79], v[220:223], v[148:155], v9
    v_smfmac_f32_16x16x64_bf16 v[80:83], v[220:223], v[180:187], v9
    s_cbranch_vccnz .A_159
.W_160:
    v_smfmac_f32_16x16x64_bf16 v[76:79], v[192:195], a[192:199], v9
    s_waitcnt vmcnt(2)
    v_max_u32 v4, v200, v204
    v_cmp_eq_u32 vcc, -1, v4
    v_smfmac_f32_16x16x64_bf16 v[80:83], v[192:195], a[224:231], v9
    v_smfmac_f32_16x16x64_bf16 v[76:79], v[196:199], a[200:207], v9
    v_smfmac_f32_16x16x64_bf16 v[80:83], v[196:199], a[232:239], v9
    s_cbranch_vccnz .A_161
.W_162:
    v_smfmac_f32_16x16x64_bf16 v[76:79], v[200:203], a[208:215], v9
    s_waitcnt vmcnt(0)
    v_max_u32 v4, v208, v212
    v_cmp_eq_u32 vcc, -1, v4
    v_smfmac_f32_16x16x64_bf16 v[80:83], v[200:203], a[240:247], v9
    v_smfmac_f32_16x16x64_bf16 v[76:79], v[204:207], a[216:223], v9
    v_smfmac_f32_16x16x64_bf16 v[80:83], v[204:207], a[248:255], v9
    s_cbranch_vccnz .A_163
.W_164:
    s_barrier
    v_smfmac_f32_16x16x64_bf16 v[76:79], v[208:211], v[124:131], v9
    v_smfmac_f32_16x16x64_bf16 v[80:83], v[208:211], v[156:163], v9
    v_smfmac_f32_16x16x64_bf16 v[76:79], v[212:215], v[132:139], v9
    v_smfmac_f32_16x16x64_bf16 v[80:83], v[212:215], v[164:171], v9
    s_branch .mj_65
.W_154:
    v_smfmac_f32_16x16x64_bf16 v[76:79], v[200:203], a[208:215], v9
    s_waitcnt vmcnt(4)
    v_max_u32 v4, v208, v212
    v_cmp_eq_u32 vcc, -1, v4
    v_smfmac_f32_16x16x64_bf16 v[80:83], v[200:203], a[240:247], v9
    v_smfmac_f32_16x16x64_bf16 v[76:79], v[204:207], a[216:223], v9
    v_smfmac_f32_16x16x64_bf16 v[80:83], v[204:207], a[248:255], v9
    s_cbranch_vccnz .A_165
.W_166:
    v_smfmac_f32_16x16x64_bf16 v[76:79], v[208:211], v[124:131], v9
    s_waitcnt vmcnt(2)
    v_max_u32 v4, v216, v220
    v_cmp_eq_u32 vcc, -1, v4
    v_smfmac_f32_16x16x64_bf16 v[80:83], v[208:211], v[156:163], v9
    v_smfmac_f32_16x16x64_bf16 v[76:79], v[212:215], v[132:139], v9
    v_smfmac_f32_16x16x64_bf16 v[80:83], v[212:215], v[164:171], v9
    s_cbranch_vccnz .A_167
.W_168:
    v_smfmac_f32_16x16x64_bf16 v[76:79], v[216:219], v[140:147], v9
    s_waitcnt vmcnt(0)
    v_max_u32 v4, v192, v196
    v_cmp_eq_u32 vcc, -1, v4
    v_smfmac_f32_16x16x64_bf16 v[80:83], v[216:219], v[172:179], v9
    v_smfmac_f32_16x16x64_bf16 v[76:79], v[220:223], v[148:155], v9
    v_smfmac_f32_16x16x64_bf16 v[80:83], v[220:223], v[180:187], v9
    s_cbranch_vccnz .A_169
.W_170:
    s_barrier
    v_smfmac_f32_16x16x64_bf16 v[76:79], v[192:195], a[192:199], v9
    v_smfmac_f32_16x16x64_bf16 v[80:83], v[192:195], a[224:231], v9
    v_smfmac_f32_16x16x64_bf16 v[76:79], v[196:199], a[200:207], v9
    v_smfmac_f32_16x16x64_bf16 v[80:83], v[196:199], a[232:239], v9
    s_branch .mj_65
.W_156:
    v_smfmac_f32_16x16x64_bf16 v[76:79], v[208:211], v[124:131], v9
    s_waitcnt vmcnt(4)
    v_max_u32 v4, v216, v220
    v_cmp_eq_u32 vcc, -1, v4
    v_smfmac_f32_16x16x64_bf16 v[80:83], v[208:211], v[156:163], v9
    v_smfmac_f32_16x16x64_bf16 v[76:79], v[212:215], v[132:139], v9
    v_smfmac_f32_16x16x64_bf16 v[80:83], v[212:215], v[164:171], v9
    s_cbranch_vccnz .A_171
.W_172:
    v_smfmac_f32_16x16x64_bf16 v[76:79], v[216:219], v[140:147], v9
    s_waitcnt vmcnt(2)
    v_max_u32 v4, v192, v196
    v_cmp_eq_u32 vcc, -1, v4
    v_smfmac_f32_16x16x64_bf16 v[80:83], v[216:219], v[172:179], v9
    v_smfmac_f32_16x16x64_bf16 v[76:79], v[220:223], v[148:155], v9
    v_smfmac_f32_16x16x64_bf16 v[80:83], v[220:223], v[180:187], v9
    s_cbranch_vccnz .A_173
.W_174:
    v_smfmac_f32_16x16x64_bf16 v[76:79], v[192:195], a[192:199], v9
    s_waitcnt vmcnt(0)
    v_max_u32 v4, v200, v204
    v_cmp_eq_u32 vcc, -1, v4
    v_smfmac_f32_16x16x64_bf16 v[80:83], v[192:195], a[224:231], v9
    v_smfmac_f32_16x16x64_bf16 v[76:79], v[196:199], a[200:207], v9
    v_smfmac_f32_16x16x64_bf16 v[80:83], v[196:199], a[232:239], v9
    s_cbranch_vccnz .A_175
.W_176:
    s_barrier
    v_smfmac_f32_16x16x64_bf16 v[76:79], v[200:203], a[208:215], v9
    v_smfmac_f32_16x16x64_bf16 v[80:83], v[200:203], a[240:247], v9
    v_smfmac_f32_16x16x64_bf16 v[76:79], v[204:207], a[216:223], v9
    v_smfmac_f32_16x16x64_bf16 v[80:83], v[204:207], a[248:255], v9
    s_branch .mj_65
.A_177:
    buffer_load_dwordx4 v[208:211], v254, s[8:11], s32 offen offset:0 sc1
    buffer_load_dwordx4 v[212:215], v254, s[8:11], s32 offen offset:1024 sc1
    s_sub_u32 s62, s62, 1
    s_cbranch_scc1 .mg_end_1
    s_waitcnt vmcnt(4)
    v_max_u32 v4, v192, v196
    v_cmp_eq_u32 vcc, -1, v4
    s_cbranch_vccz .W_160
.A_159:
    buffer_load_dwordx4 v[192:195], v243, s[8:11], s32 offen offset:0 sc1
    buffer_load_dwordx4 v[196:199], v243, s[8:11], s32 offen offset:1024 sc1
    s_waitcnt vmcnt(4)
    v_max_u32 v4, v200, v204
    v_cmp_eq_u32 vcc, -1, v4
    s_cbranch_vccz .W_178
.A_179:
    buffer_load_dwordx4 v[200:203], v252, s[8:11], s32 offen offset:0 sc1
    buffer_load_dwordx4 v[204:207], v252, s[8:11], s32 offen offset:1024 sc1
    s_waitcnt vmcnt(4)
    v_max_u32 v4, v208, v212
    v_cmp_eq_u32 vcc, -1, v4
    s_cbranch_vccnz .A_177
.W_180:
    v_smfmac_f32_16x16x64_bf16 v[76:79], v[208:211], v[124:131], v9
    s_waitcnt vmcnt(2)
    v_max_u32 v4, v192, v196
    v_cmp_eq_u32 vcc, -1, v4
    v_smfmac_f32_16x16x64_bf16 v[80:83], v[208:211], v[156:163], v9
    v_smfmac_f32_16x16x64_bf16 v[76:79], v[212:215], v[132:139], v9
    v_smfmac_f32_16x16x64_bf16 v[80:83], v[212:215], v[164:171], v9
    s_cbranch_vccz .W_174
    s_branch .A_173
.W_178:
    v_smfmac_f32_16x16x64_bf16 v[76:79], v[200:203], a[208:215], v9
    s_waitcnt vmcnt(2)
    v_max_u32 v4, v208, v212
    v_cmp_eq_u32 vcc, -1, v4
    v_smfmac_f32_16x16x64_bf16 v[80:83], v[200:203], a[240:247], v9
    v_smfmac_f32_16x16x64_bf16 v[76:79], v[204:207], a[216:223], v9
    v_smfmac_f32_16x16x64_bf16 v[80:83], v[204:207], a[248:255], v9
    s_cbranch_vccnz .A_181
.W_182:
    v_smfmac_f32_16x16x64_bf16 v[76:79], v[208:211], v[124:131], v9
    s_waitcnt vmcnt(0)
    v_max_u32 v4, v192, v196
    v_cmp_eq_u32 vcc, -1, v4
    v_smfmac_f32_16x16x64_bf16 v[80:83], v[208:211], v[156:163], v9
    v_smfmac_f32_16x16x64_bf16 v[76:79], v[212:215], v[132:139], v9
    v_smfmac_f32_16x16x64_bf16 v[80:83], v[212:215], v[164:171], v9
    s_cbranch_vccz .W_170
    s_branch .A_169
.A_183:
    buffer_load_dwordx4 v[200:203], v252, s[8:11], s32 offen offset:0 sc1
    buffer_load_dwordx4 v[204:207], v252, s[8:11], s32 offen offset:1024 sc1
    s_sub_u32 s62, s62, 1
    s_cbranch_scc1 .mg_end_1
    s_waitcnt vmcnt(4)
    v_max_u32 v4, v216, v220
    v_cmp_eq_u32 vcc, -1, v4
    s_cbranch_vccz .W_172
.A_171:
    buffer_load_dwordx4 v[216:219], v246, s[8:11], s32 offen offset:0 sc1
    buffer_load_dwordx4 v[220:223], v246, s[8:11], s32 offen offset:1024 sc1
    s_waitcnt vmcnt(4)
    v_max_u32 v4, v192, v196
    v_cmp_eq_u32 vcc, -1, v4
    s_cbranch_vccz .W_184
.A_185:
    buffer_load_dwordx4 v[192:195], v243, s[8:11], s32 offen offset:0 sc1
    buffer_load_dwordx4 v[196:199], v243, s[8:11], s32 offen offset:1024 sc1
    s_waitcnt vmcnt(4)
    v_max_u32 v4, v200, v204
    v_cmp_eq_u32 vcc, -1, v4
    s_cbranch_vccnz .A_183
.W_186:
    v_smfmac_f32_16x16x64_bf16 v[76:79], v[200:203], a[208:215], v9
    s_waitcnt vmcnt(2)
    v_max_u32 v4, v216, v220
    v_cmp_eq_u32 vcc, -1, v4
    v_smfmac_f32_16x16x64_bf16 v[80:83], v[200:203], a[240:247], v9
    v_smfmac_f32_16x16x64_bf16 v[76:79], v[204:207], a[216:223], v9
    v_smfmac_f32_16x16x64_bf16 v[80:83], v[204:207], a[248:255], v9
    s_cbranch_vccz .W_168
    s_branch .A_167
.W_184:
    v_smfmac_f32_16x16x64_bf16 v[76:79], v[192:195], a[192:199], v9
    s_waitcnt vmcnt(2)
    v_max_u32 v4, v200, v204
    v_cmp_eq_u32 vcc, -1, v4
    v_smfmac_f32_16x16x64_bf16 v[80:83], v[192:195], a[224:231], v9
    v_smfmac_f32_16x16x64_bf16 v[76:79], v[196:199], a[200:207], v9
    v_smfmac_f32_16x16x64_bf16 v[80:83], v[196:199], a[232:239], v9
    s_cbranch_vccnz .A_187
.W_188:
    v_smfmac_f32_16x16x64_bf16 v[76:79], v[200:203], a[208:215], v9
    s_waitcnt vmcnt(0)
    v_max_u32 v4, v216, v220
    v_cmp_eq_u32 vcc, -1, v4
    v_smfmac_f32_16x16x64_bf16 v[80:83], v[200:203], a[240:247], v9
    v_smfmac_f32_16x16x64_bf16 v[76:79], v[204:207], a[216:223], v9
    v_smfmac_f32_16x16x64_bf16 v[80:83], v[204:207], a[248:255], v9
    s_cbranch_vccz .W_73
    s_branch .A_72
.A_189:
    buffer_load_dwordx4 v[216:219], v246, s[8:11], s32 offen offset:0 sc1
    buffer_load_dwordx4 v[220:223], v246, s[8:11], s32 offen offset:1024 sc1
    s_sub_u32 s62, s62, 1
    s_cbranch_scc1 .mg_end_1
    s_waitcnt vmcnt(4)
    v_max_u32 v4, v192, v196
    v_cmp_eq_u32 vcc, -1, v4
    s_cbranch_vccz .W_190
.A_191:
    buffer_load_dwordx4 v[192:195], v243, s[8:11], s32 offen offset:0 sc1
    buffer_load_dwordx4 v[196:199], v243, s[8:11], s32 offen offset:1024 sc1
    s_waitcnt vmcnt(4)
    v_max_u32 v4, v208, v212
    v_cmp_eq_u32 vcc, -1, v4
    s_cbranch_vccz .W_166
.A_165:
    buffer_load_dwordx4 v[208:211], v254, s[8:11], s32 offen offset:0 sc1
    buffer_load_dwordx4 v[212:215], v254, s[8:11], s32 offen offset:1024 sc1
    s_waitcnt vmcnt(4)
    v_max_u32 v4, v216, v220
    v_cmp_eq_u32 vcc, -1, v4
    s_cbranch_vccnz .A_189
.W_192:
    v_smfmac_f32_16x16x64_bf16 v[76:79], v[216:219], v[140:147], v9
    s_waitcnt vmcnt(2)
    v_max_u32 v4, v192, v196
    v_cmp_eq_u32 vcc, -1, v4
    v_smfmac_f32_16x16x64_bf16 v[80:83], v[216:219], v[172:179], v9
    v_smfmac_f32_16x16x64_bf16 v[76:79], v[220:223], v[148:155], v9
    v_smfmac_f32_16x16x64_bf16 v[80:83], v[220:223], v[180:187], v9
    s_cbranch_vccnz .A_193
.W_194:
    v_smfmac_f32_16x16x64_bf16 v[76:79], v[192:195], a[192:199], v9
    s_waitcnt vmcnt(0)
    v_max_u32 v4, v208, v212
    v_cmp_eq_u32 vcc, -1, v4
    v_smfmac_f32_16x16x64_bf16 v[80:83], v[192:195], a[224:231], v9
    v_smfmac_f32_16x16x64_bf16 v[76:79], v[196:199], a[200:207], v9
    v_smfmac_f32_16x16x64_bf16 v[80:83], v[196:199], a[232:239], v9
    s_cbranch_vccz .W_164
    s_branch .A_163
.W_190:
    v_smfmac_f32_16x16x64_bf16 v[76:79], v[192:195], a[192:199], v9
    s_waitcnt vmcnt(2)
    v_max_u32 v4, v208, v212
    v_cmp_eq_u32 vcc, -1, v4
    v_smfmac_f32_16x16x64_bf16 v[80:83], v[192:195], a[224:231], v9
    v_smfmac_f32_16x16x64_bf16 v[76:79], v[196:199], a[200:207], v9
    v_smfmac_f32_16x16x64_bf16 v[80:83], v[196:199], a[232:239], v9
    s_cbranch_vccz .W_71
    s_branch .A_70
.A_195:
    buffer_load_dwordx4 v[216:219], v246, s[8:11], s32 offen offset:0 sc1
    buffer_load_dwordx4 v[220:223], v246, s[8:11], s32 offen offset:1024 sc1
    s_sub_u32 s62, s62, 1
    s_cbranch_scc1 .mg_end_1
    s_waitcnt vmcnt(4)
    v_max_u32 v4, v200, v204
    v_cmp_eq_u32 vcc, -1, v4
    s_cbranch_vccz .W_69
.A_68:
    buffer_load_dwordx4 v[200:203], v252, s[8:11], s32 offen offset:0 sc1
    buffer_load_dwordx4 v[204:207], v252, s[8:11], s32 offen offset:1024 sc1
    s_waitcnt vmcnt(4)
    v_max_u32 v4, v208, v212
    v_cmp_eq_u32 vcc, -1, v4
    s_cbranch_vccz .W_196
.A_197:
    buffer_load_dwordx4 v[208:211], v254, s[8:11], s32 offen offset:0 sc1
    buffer_load_dwordx4 v[212:215], v254, s[8:11], s32 offen offset:1024 sc1
    s_waitcnt vmcnt(4)
    v_max_u32 v4, v216, v220
    v_cmp_eq_u32 vcc, -1, v4
    s_cbranch_vccnz .A_195
.W_198:
    v_smfmac_f32_16x16x64_bf16 v[76:79], v[216:219], v[140:147], v9
    s_waitcnt vmcnt(2)
    v_max_u32 v4, v200, v204
    v_cmp_eq_u32 vcc, -1, v4
    v_smfmac_f32_16x16x64_bf16 v[80:83], v[216:219], v[172:179], v9
    v_smfmac_f32_16x16x64_bf16 v[76:79], v[220:223], v[148:155], v9
    v_smfmac_f32_16x16x64_bf16 v[80:83], v[220:223], v[180:187], v9
    s_cbranch_vccz .W_162
    s_branch .A_161
.W_196:
    v_smfmac_f32_16x16x64_bf16 v[76:79], v[208:211], v[124:131], v9
    s_waitcnt vmcnt(2)
    v_max_u32 v4, v216, v220
    v_cmp_eq_u32 vcc, -1, v4
    v_smfmac_f32_16x16x64_bf16 v[80:83], v[208:211], v[156:163], v9
    v_smfmac_f32_16x16x64_bf16 v[76:79], v[212:215], v[132:139], v9
    v_smfmac_f32_16x16x64_bf16 v[80:83], v[212:215], v[164:171], v9
    s_cbranch_vccnz .A_199
.W_200:
    v_smfmac_f32_16x16x64_bf16 v[76:79], v[216:219], v[140:147], v9
    s_waitcnt vmcnt(0)
    v_max_u32 v4, v200, v204
    v_cmp_eq_u32 vcc, -1, v4
    v_smfmac_f32_16x16x64_bf16 v[80:83], v[216:219], v[172:179], v9
    v_smfmac_f32_16x16x64_bf16 v[76:79], v[220:223], v[148:155], v9
    v_smfmac_f32_16x16x64_bf16 v[80:83], v[220:223], v[180:187], v9
    s_cbranch_vccz .W_176
    s_branch .A_175
.A_201:
    buffer_load_dwordx4 v[200:203], v252, s[8:11], s32 offen offset:0 sc1
    buffer_load_dwordx4 v[204:207], v252, s[8:11], s32 offen offset:1024 sc1
    s_sub_u32 s62, s62, 1
    s_cbranch_scc1 .mg_end_1
    s_waitcnt vmcnt(2)
    v_max_u32 v4, v192, v196
    v_cmp_eq_u32 vcc, -1, v4
    s_cbranch_vccz .W_174
.A_173:
    buffer_load_dwordx4 v[192:195], v243, s[8:11], s32 offen offset:0 sc1
    buffer_load_dwordx4 v[196:199], v243, s[8:11], s32 offen offset:1024 sc1
    s_waitcnt vmcnt(2)
    v_max_u32 v4, v200, v204
    v_cmp_eq_u32 vcc, -1, v4
    s_cbranch_vccnz .A_201
.W_202:
    v_smfmac_f32_16x16x64_bf16 v[76:79], v[200:203], a[208:215], v9
    s_waitcnt vmcnt(0)
    v_max_u32 v4, v192, v196
    v_cmp_eq_u32 vcc, -1, v4
    v_smfmac_f32_16x16x64_bf16 v[80:83], v[200:203], a[240:247], v9
    v_smfmac_f32_16x16x64_bf16 v[76:79], v[204:207], a[216:223], v9
    v_smfmac_f32_16x16x64_bf16 v[80:83], v[204:207], a[248:255], v9
    s_cbranch_vccz .W_170
    s_branch .A_169
.A_181:
    buffer_load_dwordx4 v[208:211], v254, s[8:11], s32 offen offset:0 sc1
    buffer_load_dwordx4 v[212:215], v254, s[8:11], s32 offen offset:1024 sc1
    s_sub_u32 s62, s62, 1
    s_cbranch_scc1 .mg_end_1
    s_waitcnt vmcnt(2)
    v_max_u32 v4, v192, v196
    v_cmp_eq_u32 vcc, -1, v4
    s_cbranch_vccz .W_194
.A_193:
    buffer_load_dwordx4 v[192:195], v243, s[8:11], s32 offen offset:0 sc1
    buffer_load_dwordx4 v[196:199], v243, s[8:11], s32 offen offset:1024 sc1
    s_waitcnt vmcnt(2)
    v_max_u32 v4, v208, v212
    v_cmp_eq_u32 vcc, -1, v4
    s_cbranch_vccnz .A_181
    s_branch .W_182
.A_203:
    buffer_load_dwordx4 v[192:195], v243, s[8:11], s32 offen offset:0 sc1
    buffer_load_dwordx4 v[196:199], v243, s[8:11], s32 offen offset:1024 sc1
    s_sub_u32 s62, s62, 1
    s_cbranch_scc1 .mg_end_1
    s_waitcnt vmcnt(2)
    v_max_u32 v4, v216, v220
    v_cmp_eq_u32 vcc, -1, v4
    s_cbranch_vccz .W_168
.A_167:
    buffer_load_dwordx4 v[216:219], v246, s[8:11], s32 offen offset:0 sc1
    buffer_load_dwordx4 v[220:223], v246, s[8:11], s32 offen offset:1024 sc1
    s_waitcnt vmcnt(2)
    v_max_u32 v4, v192, v196
    v_cmp_eq_u32 vcc, -1, v4
    s_cbranch_vccnz .A_203
.W_204:
    v_smfmac_f32_16x16x64_bf16 v[76:79], v[192:195], a[192:199], v9
    s_waitcnt vmcnt(0)
    v_max_u32 v4, v216, v220
    v_cmp_eq_u32 vcc, -1, v4
    v_smfmac_f32_16x16x64_bf16 v[80:83], v[192:195], a[224:231], v9
    v_smfmac_f32_16x16x64_bf16 v[76:79], v[196:199], a[200:207], v9
    v_smfmac_f32_16x16x64_bf16 v[80:83], v[196:199], a[232:239], v9
    s_cbranch_vccz .W_73
    s_branch .A_72
.A_205:
    buffer_load_dwordx4 v[208:211], v254, s[8:11], s32 offen offset:0 sc1
    buffer_load_dwordx4 v[212:215], v254, s[8:11], s32 offen offset:1024 sc1
    s_sub_u32 s62, s62, 1
    s_cbranch_scc1 .mg_end_1
    s_waitcnt vmcnt(2)
    v_max_u32 v4, v200, v204
    v_cmp_eq_u32 vcc, -1, v4
    s_cbranch_vccz .W_162
.A_161:
    buffer_load_dwordx4 v[200:203], v252, s[8:11], s32 offen offset:0 sc1
    buffer_load_dwordx4 v[204:207], v252, s[8:11], s32 offen offset:1024 sc1
    s_waitcnt vmcnt(2)
    v_max_u32 v4, v208, v212
    v_cmp_eq_u32 vcc, -1, v4
    s_cbranch_vccnz .A_205
.W_206:
    v_smfmac_f32_16x16x64_bf16 v[76:79], v[208:211], v[124:131], v9
    s_waitcnt vmcnt(0)
    v_max_u32 v4, v200, v204
    v_cmp_eq_u32 vcc, -1, v4
    v_smfmac_f32_16x16x64_bf16 v[80:83], v[208:211], v[156:163], v9
    v_smfmac_f32_16x16x64_bf16 v[76:79], v[212:215], v[132:139], v9
    v_smfmac_f32_16x16x64_bf16 v[80:83], v[212:215], v[164:171], v9
    s_cbranch_vccz .W_176
    s_branch .A_175
.A_199:
    buffer_load_dwordx4 v[216:219], v246, s[8:11], s32 offen offset:0 sc1
    buffer_load_dwordx4 v[220:223], v246, s[8:11], s32 offen offset:1024 sc1
    s_sub_u32 s62, s62, 1
    s_cbranch_scc1 .mg_end_1
    s_waitcnt vmcnt(2)
    v_max_u32 v4, v200, v204
    v_cmp_eq_u32 vcc, -1, v4
    s_cbranch_vccz .W_188
.A_187:
    buffer_load_dwordx4 v[200:203], v252, s[8:11], s32 offen offset:0 sc1
    buffer_load_dwordx4 v[204:207], v252, s[8:11], s32 offen offset:1024 sc1
    s_waitcnt vmcnt(2)
    v_max_u32 v4, v216, v220
    v_cmp_eq_u32 vcc, -1, v4
    s_cbranch_vccnz .A_199
    s_branch .W_200
.A_207:
    buffer_load_dwordx4 v[216:219], v246, s[8:11], s32 offen offset:0 sc1
    buffer_load_dwordx4 v[220:223], v246, s[8:11], s32 offen offset:1024 sc1
    s_sub_u32 s62, s62, 1
    s_cbranch_scc1 .mg_end_1
    s_waitcnt vmcnt(2)
    v_max_u32 v4, v208, v212
    v_cmp_eq_u32 vcc, -1, v4
    s_cbranch_vccz .W_71
.A_70:
    buffer_load_dwordx4 v[208:211], v254, s[8:11], s32 offen offset:0 sc1
    buffer_load_dwordx4 v[212:215], v254, s[8:11], s32 offen offset:1024 sc1
    s_waitcnt vmcnt(2)
    v_max_u32 v4, v216, v220
    v_cmp_eq_u32 vcc, -1, v4
    s_cbranch_vccnz .A_207
.W_208:
    v_smfmac_f32_16x16x64_bf16 v[76:79], v[216:219], v[140:147], v9
    s_waitcnt vmcnt(0)
    v_max_u32 v4, v208, v212
    v_cmp_eq_u32 vcc, -1, v4
    v_smfmac_f32_16x16x64_bf16 v[80:83], v[216:219], v[172:179], v9
    v_smfmac_f32_16x16x64_bf16 v[76:79], v[220:223], v[148:155], v9
    v_smfmac_f32_16x16x64_bf16 v[80:83], v[220:223], v[180:187], v9
    s_cbranch_vccz .W_164
    s_branch .A_163
.A_169:
    buffer_load_dwordx4 v[192:195], v243, s[8:11], s32 offen offset:0 sc1
    buffer_load_dwordx4 v[196:199], v243, s[8:11], s32 offen offset:1024 sc1
    s_sub_u32 s62, s62, 1
    s_cbranch_scc1 .mg_end_1
    s_waitcnt vmcnt(2)
    v_max3_u32 v4, v192, v193, v194
    v_max3_u32 v5, v195, v196, v197
    v_max3_u32 v4, v4, v198, v199
    v_max_u32 v4, v4, v5
    v_cmp_eq_u32 vcc, -1, v4
    s_cbranch_vccnz .A_169
    s_barrier
    v_smfmac_f32_16x16x64_bf16 v[76:79], v[192:195], a[192:199], v9
    v_smfmac_f32_16x16x64_bf16 v[80:83], v[192:195], a[224:231], v9
    v_smfmac_f32_16x16x64_bf16 v[76:79], v[196:199], a[200:207], v9
    v_smfmac_f32_16x16x64_bf16 v[80:83], v[196:199], a[232:239], v9
    s_branch .mj_65
.A_175:
    buffer_load_dwordx4 v[200:203], v252, s[8:11], s32 offen offset:0 sc1
    buffer_load_dwordx4 v[204:207], v252, s[8:11], s32 offen offset:1024 sc1
    s_sub_u32 s62, s62, 1
    s_cbranch_scc1 .mg_end_1
    s_waitcnt vmcnt(2)
    v_max3_u32 v4, v200, v201, v202
    v_max3_u32 v5, v203, v204, v205
    v_max3_u32 v4, v4, v206, v207
    v_max_u32 v4, v4, v5
    v_cmp_eq_u32 vcc, -1, v4
    s_cbranch_vccnz .A_175
    s_barrier
    v_smfmac_f32_16x16x64_bf16 v[76:79], v[200:203], a[208:215], v9
    v_smfmac_f32_16x16x64_bf16 v[80:83], v[200:203], a[240:247], v9
    v_smfmac_f32_16x16x64_bf16 v[76:79], v[204:207], a[216:223], v9
    v_smfmac_f32_16x16x64_bf16 v[80:83], v[204:207], a[248:255], v9
    s_branch .mj_65
.A_163:
    buffer_load_dwordx4 v[208:211], v254, s[8:11], s32 offen offset:0 sc1
    buffer_load_dwordx4 v[212:215], v254, s[8:11], s32 offen offset:1024 sc1
    s_sub_u32 s62, s62, 1
    s_cbranch_scc1 .mg_end_1
    s_waitcnt vmcnt(2)
    v_max3_u32 v4, v208, v209, v210
    v_max3_u32 v5, v211, v212, v213
    v_max3_u32 v4, v4, v214, v215
    v_max_u32 v4, v4, v5
    v_cmp_eq_u32 vcc, -1, v4
    s_cbranch_vccnz .A_163
    s_barrier
    v_smfmac_f32_16x16x64_bf16 v[76:79], v[208:211], v[124:131], v9
    v_smfmac_f32_16x16x64_bf16 v[80:83], v[208:211], v[156:163], v9
    v_smfmac_f32_16x16x64_bf16 v[76:79], v[212:215], v[132:139], v9
    v_smfmac_f32_16x16x64_bf16 v[80:83], v[212:215], v[164:171], v9
    s_branch .mj_65
.A_72:
    buffer_load_dwordx4 v[216:219], v246, s[8:11], s32 offen offset:0 sc1
    buffer_load_dwordx4 v[220:223], v246, s[8:11], s32 offen offset:1024 sc1
    s_sub_u32 s62, s62, 1
    s_cbranch_scc1 .mg_end_1
    s_waitcnt vmcnt(2)
    v_max3_u32 v4, v216, v217, v218
    v_max3_u32 v5, v219, v220, v221
    v_max3_u32 v4, v4, v222, v223
    v_max_u32 v4, v4, v5
    v_cmp_eq_u32 vcc, -1, v4
    s_cbranch_vccnz .A_72
    s_barrier
    v_smfmac_f32_16x16x64_bf16 v[76:79], v[216:219], v[140:147], v9
    v_smfmac_f32_16x16x64_bf16 v[80:83], v[216:219], v[172:179], v9
    v_smfmac_f32_16x16x64_bf16 v[76:79], v[220:223], v[148:155], v9
    v_smfmac_f32_16x16x64_bf16 v[80:83], v[220:223], v[180:187], v9
    s_branch .mj_65
.sk_75:
    v_cndmask_b32 v172, v170, v168, s[60:61]
    v_cndmask_b32 v173, v171, v169, s[60:61]

    v_mov_b32 v174, v172
    v_mov_b32 v175, v173
    s_nop 0
    s_nop 0
    v_permlane16_swap_b32 v172, v174
    v_permlane16_swap_b32 v173, v175
    ds_write_b128 v14, v[172:175] offset:17408

    s_mov_b64 exec, s[66:67]
    buffer_store_dwordx4 v[88:91], v11, s[8:11], s36 offen sc1
    s_mov_b64 exec, s[56:57]
    buffer_store_dwordx4 v[172:175], v12, s[8:11], s36 offen sc1
    s_mov_b64 exec, -1

    s_cmp_lt_u32 s28, 63
    s_cbranch_scc1 .sb_76
    s_branch .rec_fin_6
.p2align 6
.top_209:
    s_barrier
.tp2_213:
    buffer_load_dwordx4 v[20:23], v8, s[8:11], s29 offen offset:0 sc1
    v_mov_b32 v52, 0
    buffer_load_dwordx4 v[24:27], v8, s[8:11], s29 offen offset:1024 sc1
    v_mov_b32 v53, 0
    buffer_load_dwordx4 v[28:31], v8, s[8:11], s29 offen offset:2048 sc1
    v_mov_b32 v54, 0
    buffer_load_dwordx4 v[32:35], v8, s[8:11], s29 offen offset:3072 sc1
.ent1_26:
    s_waitcnt vmcnt(3)
    v_max_u32 v4, v20, v22
    v_cmp_eq_u32 vcc, -1, v4
    s_cbranch_vccnz .A_215
.W_216:
    v_smfmac_f32_16x16x64_bf16 v[52:55], v[20:23], a[0:7], v9
    s_waitcnt vmcnt(2)
    v_max_u32 v4, v24, v26
    v_cmp_eq_u32 vcc, -1, v4
    v_smfmac_f32_16x16x64_bf16 v[56:59], v[20:23], a[32:39], v9
    v_smfmac_f32_16x16x64_bf16 v[60:63], v[20:23], a[64:71], v9
    v_smfmac_f32_16x16x64_bf16 v[64:67], v[20:23], a[96:103], v9
    s_cbranch_vccnz .A_217
.W_218:
    v_smfmac_f32_16x16x64_bf16 v[52:55], v[24:27], a[8:15], v9
    s_waitcnt vmcnt(1)
    v_max_u32 v4, v28, v30
    v_cmp_eq_u32 vcc, -1, v4
    v_smfmac_f32_16x16x64_bf16 v[56:59], v[24:27], a[40:47], v9
    v_smfmac_f32_16x16x64_bf16 v[60:63], v[24:27], a[72:79], v9
    v_smfmac_f32_16x16x64_bf16 v[64:67], v[24:27], a[104:111], v9
    s_cbranch_vccnz .A_219
.W_220:
    v_smfmac_f32_16x16x64_bf16 v[52:55], v[28:31], a[16:23], v9
    s_waitcnt vmcnt(0)
    v_max_u32 v4, v32, v34
    v_cmp_eq_u32 vcc, -1, v4
    v_smfmac_f32_16x16x64_bf16 v[56:59], v[28:31], a[48:55], v9
    v_smfmac_f32_16x16x64_bf16 v[60:63], v[28:31], a[80:87], v9
    v_smfmac_f32_16x16x64_bf16 v[64:67], v[28:31], a[112:119], v9
    s_cbranch_vccnz .A_221
.W_222:
    v_smfmac_f32_16x16x64_bf16 v[52:55], v[32:35], a[24:31], v9
    v_smfmac_f32_16x16x64_bf16 v[56:59], v[32:35], a[56:63], v9
    v_smfmac_f32_16x16x64_bf16 v[60:63], v[32:35], a[88:95], v9
    v_smfmac_f32_16x16x64_bf16 v[64:67], v[32:35], a[120:127], v9
.mj_214:
    v_cvt_pk_bf16_f32 v104, v52, v53
    v_cvt_pk_bf16_f32 v105, v54, v55
    v_cvt_pk_bf16_f32 v106, v56, v57
    v_cvt_pk_bf16_f32 v107, v58, v59
    ds_write_b64 v16, v[104:105] offset:4096
    v_cvt_pk_bf16_f32 v108, v60, v61
    v_cvt_pk_bf16_f32 v109, v62, v63
    ds_write_b64 v16, v[106:107] offset:6144
    ds_write_b64 v16, v[108:109] offset:0
    v_cvt_pk_bf16_f32 v110, v64, v65
    v_cvt_pk_bf16_f32 v111, v66, v67
    ds_write_b64 v16, v[110:111] offset:2048
    v_smfmac_f32_16x16x64_bf16 v[68:71], v[20:23], a[128:135], v9
    v_smfmac_f32_16x16x64_bf16 v[72:75], v[20:23], a[160:167], v9
    s_waitcnt lgkmcnt(0)
    s_barrier
    ds_read_b128 v[36:39], v17 offset:0
    ds_read_b128 v[40:43], v17 offset:1024
    v_smfmac_f32_16x16x64_bf16 v[68:71], v[24:27], a[136:143], v9
    v_smfmac_f32_16x16x64_bf16 v[72:75], v[24:27], a[168:175], v9
    s_waitcnt lgkmcnt(1)
    v_mfma_f32_16x16x32_bf16 v[44:47], v[36:39], v[84:87], 0
    s_waitcnt lgkmcnt(0)
    v_mfma_f32_16x16x32_bf16 v[44:47], v[40:43], v[84:87], v[44:47]
    v_smfmac_f32_16x16x64_bf16 v[68:71], v[28:31], a[144:151], v9
    v_smfmac_f32_16x16x64_bf16 v[72:75], v[28:31], a[176:183], v9
    s_mov_b64 exec, s[64:65]
    v_cvt_pk_bf16_f32 v48, v44, v45
    v_cvt_pk_bf16_f32 v49, v46, v47

    buffer_store_dwordx2 v[48:49], v10, s[8:11], s29 offen sc1

    ds_write_b64 v18, v[48:49]
    s_mov_b64 exec, -1

    v_smfmac_f32_16x16x64_bf16 v[68:71], v[32:35], a[152:159], v9
    v_smfmac_f32_16x16x64_bf16 v[72:75], v[32:35], a[184:191], v9
    s_nop 3
    v_cvt_pk_bf16_f32 v104, v68, v69
    v_cvt_pk_bf16_f32 v105, v70, v71
    ds_write_b64 v16, v[104:105] offset:8192
    s_nop 0
    v_cvt_pk_bf16_f32 v106, v72, v73
    v_cvt_pk_bf16_f32 v107, v74, v75
    ds_write_b64 v16, v[106:107] offset:10240
    s_cmp_lg_u32 s24, 2
    s_waitcnt lgkmcnt(0)
    s_barrier
    s_cbranch_scc1 .oth_210
    buffer_load_dwordx4 v[92:95], v232, s[8:11], s29 offen sc1
    buffer_load_dwordx4 v[96:99], v233, s[8:11], s29 offen sc1
    buffer_load_dwordx4 v[100:103], v234, s[8:11], s29 offen sc1
    ds_read_b128 v[88:91], v14 offset:16384
    s_cmp_eq_u32 s28, 63
    s_cbranch_scc1 .rec_fin_6
.en_33:
    s_waitcnt lgkmcnt(0)
    v_mfma_f32_16x16x32_bf16 v[208:211], v[128:131], v[88:91], 0
    v_mfma_f32_16x16x32_bf16 v[212:215], v[144:147], v[88:91], 0
    v_mfma_f32_16x16x32_bf16 v[216:219], v[88:91], v[88:91], v[116:119]
    s_waitcnt vmcnt(2)
    v_max_u32 v4, v92, v94
    v_cmp_eq_u32 vcc, -1, v4
    s_cbranch_vccnz .A_224
.W_225:
    v_mfma_f32_16x16x32_bf16 v[208:211], v[132:135], v[92:95], v[208:211]
    s_waitcnt vmcnt(1)
    v_max_u32 v4, v96, v98
    v_cmp_eq_u32 vcc, -1, v4
    v_mfma_f32_16x16x32_bf16 v[212:215], v[148:151], v[92:95], v[212:215]
    v_mfma_f32_16x16x32_bf16 v[216:219], v[92:95], v[92:95], v[216:219]
    s_cbranch_vccnz .A_226
.W_227:
    v_mfma_f32_16x16x32_bf16 v[208:211], v[136:139], v[96:99], v[208:211]
    s_waitcnt vmcnt(0)
    v_max_u32 v4, v100, v102
    v_cmp_eq_u32 vcc, -1, v4
    v_mfma_f32_16x16x32_bf16 v[212:215], v[152:155], v[96:99], v[212:215]
    v_mfma_f32_16x16x32_bf16 v[216:219], v[96:99], v[96:99], v[216:219]
    s_cbranch_vccnz .A_228
.W_229:
    v_mfma_f32_16x16x32_bf16 v[208:211], v[140:143], v[100:103], v[208:211]
    s_barrier
    v_mfma_f32_16x16x32_bf16 v[212:215], v[156:159], v[100:103], v[212:215]
    v_mfma_f32_16x16x32_bf16 v[216:219], v[100:103], v[100:103], v[216:219]
.mj_223:
    s_nop 0
    ds_read_b64 v[168:169], v14 offset:18432
    ds_read_b64 v[172:173], v14 offset:18440
    s_nop 0

    v_mov_b32_dpp v208, v212 row_ror:8 row_mask:0xf bank_mask:0xc
    v_mov_b32_dpp v209, v213 row_ror:8 row_mask:0xf bank_mask:0xc
    v_mov_b32_dpp v210, v214 row_ror:8 row_mask:0xf bank_mask:0xc
    v_mov_b32_dpp v211, v215 row_ror:8 row_mask:0xf bank_mask:0xc
    v_mov_b32_dpp v216, v218 row_ror:8 row_mask:0xf bank_mask:0xc
    v_mov_b32_dpp v217, v219 row_ror:8 row_mask:0xf bank_mask:0xc
    v_max3_f32 v4, v208, v209, v210
    v_max3_f32 v5, v211, v216, v217
    v_max_f32 v6, v4, v5
    v_max_f32 v4, v4, v5
    s_nop 1
    v_permlane32_swap_b32 v4, v6
    v_max_f32 v5, v4, v6
    v_max_f32 v4, v4, v6
    s_nop 1
    v_permlane16_swap_b32 v4, v5
    v_max_f32 v4, v4, v5
    s_nop 1
    v_max_f32_dpp v4, v4, v4 row_ror:8 row_mask:0xf bank_mask:0xf
    v_mul_f32 v4, s37, v4

    v_pk_fma_f32 v[104:105], v[208:209], s[36:37], v[4:5] op_sel:[0,1,0] op_sel_hi:[1,1,0] neg_lo:[0,0,1] neg_hi:[0,0,1]
    v_pk_fma_f32 v[106:107], v[210:211], s[36:37], v[4:5] op_sel:[0,1,0] op_sel_hi:[1,1,0] neg_lo:[0,0,1] neg_hi:[0,0,1]
    v_pk_fma_f32 v[108:109], v[216:217], s[36:37], v[4:5] op_sel:[0,1,0] op_sel_hi:[1,1,0] neg_lo:[0,0,1] neg_hi:[0,0,1]
    v_exp_f32 v104, v104
    v_exp_f32 v105, v105
    v_exp_f32 v106, v106
    v_exp_f32 v107, v107
    v_exp_f32 v108, v108
    v_exp_f32 v109, v109
    v_cvt_pk_bf16_f32 v176, v104, v105
    v_cvt_pk_bf16_f32 v177, v106, v107
    v_cvt_pk_bf16_f32 v180, v108, v109
    v_mov_b32_dpp v178, v176 row_ror:8 row_mask:0xf bank_mask:0xf
    v_mov_b32_dpp v179, v177 row_ror:8 row_mask:0xf bank_mask:0xf
    v_mov_b32_dpp v181, v180 row_ror:8 row_mask:0xf bank_mask:0xf
    s_waitcnt lgkmcnt(0)

    v_mfma_f32_16x16x32_bf16 v[208:211], v[120:123], v[176:179], 0
    v_mfma_f32_16x16x32_bf16 v[208:211], v[120:123], v[180:183], v[208:211]
    v_mfma_f32_16x16x32_bf16 v[212:215], v[160:163], v[176:179], 0
    v_mfma_f32_16x16x32_bf16 v[216:219], v[164:167], v[176:179], 0
    v_mfma_f32_16x16x32_bf16 v[212:215], v[168:171], v[180:183], v[212:215]
    v_rcp_f32 v4, v208
    v_mfma_f32_16x16x32_bf16 v[216:219], v[172:175], v[180:183], v[216:219]
    s_mov_b64 exec, s[58:59]
    s_nop 2
    v_mul_f32 v212, v4, v212
    v_mul_f32 v213, v4, v213
    v_mul_f32 v214, v4, v214
    v_mul_f32 v215, v4, v215
    v_cvt_pk_bf16_f32 v184, v212, v213
    v_cvt_pk_bf16_f32 v185, v214, v215
    v_pk_mul_f32 v[216:217], v[216:217], v[4:5] op_sel_hi:[1,0]
    v_pk_mul_f32 v[218:219], v[218:219], v[4:5] op_sel_hi:[1,0]

    v_cvt_pk_bf16_f32 v186, v216, v217
    v_cvt_pk_bf16_f32 v187, v218, v219
    buffer_store_dwordx4 v[184:187], v13, s[8:11], s29 offen sc1
    s_mov_b64 exec, -1

.gp_212:
    s_barrier
    v_mov_b32 v5, 19968
    ds_read_b32 v4, v5
    s_mov_b32 s99, s68
    s_waitcnt vmcnt(0)
    s_cmp_eq_u32 s24, 3
    s_cbranch_scc1 .u3_230
    s_add_u32 s6, s28, 3
    s_add_u32 s7, s30, 262144
    s_waitcnt lgkmcnt(0)
    v_readfirstlane_b32 s5, v4
    s_cmp_lt_u32 s5, s6
    s_barrier
    s_cbranch_scc1 .np_232
    buffer_load_dword v226, v225, s[8:11], s7 offen

.np_232:
    s_add_u32 s4, s70, 0
    buffer_store_dwordx4 v[188:191], v238, s[8:11], s4 offen sc1
    s_add_u32 s4, s70, 262144
    buffer_store_dwordx4 v[188:191], v238, s[8:11], s4 offen sc1
    s_branch .u4_231
.u3_230:
    s_sub_u32 s4, s36, 0
    s_barrier
    s_mov_b64 exec, s[66:67]
    buffer_store_dwordx4 v[88:91], v11, s[8:11], s4 offen sc1
    s_mov_b64 exec, s[56:57]
    buffer_store_dwordx4 v[172:175], v12, s[8:11], s4 offen sc1
    s_mov_b64 exec, -1

.u4_231:
    s_barrier
    s_add_u32 s28, s28, 1
    s_add_u32 s36, s36, 196608
    s_cmp_lt_u32 s28, 63
    s_cselect_b32 s4, 262144, 0
    s_add_u32 s38, s38, s4
    s_add_u32 s39, s39, s4
    s_add_u32 s30, s30, s4
    s_mov_b32 s4, s68
    s_mov_b32 s68, s69
    s_mov_b32 s69, s70
    s_mov_b32 s70, s71
    s_mov_b32 s71, s4
    s_and_b32 s4, s28, 3
    s_lshl_b32 s5, s4, 17
    s_add_u32 s29, s5, s34
    s_xor_b32 s6, s5, 262144
    s_add_u32 s31, s6, s34
    s_add_u32 s32, s29, 20480
    s_add_u32 s33, s29, 24576
    v_mov_b32 v55, 0
    v_mov_b32 v56, 0
    v_mov_b32 v57, 0
    v_mov_b32 v58, 0
    v_mov_b32 v59, 0
    v_mov_b32 v60, 0
    v_mov_b32 v61, 0
    v_mov_b32 v62, 0
    v_mov_b32 v63, 0
    v_mov_b32 v64, 0
    v_mov_b32 v65, 0
    v_mov_b32 v66, 0
    v_mov_b32 v67, 0
    v_mov_b32 v68, 0
    v_mov_b32 v69, 0
    v_mov_b32 v70, 0
    v_mov_b32 v71, 0
    v_mov_b32 v72, 0
    v_mov_b32 v73, 0
    v_mov_b32 v74, 0
    v_mov_b32 v75, 0
    v_mov_b32 v20, -1
    v_mov_b32 v21, -1
    v_mov_b32 v22, -1
    v_mov_b32 v23, -1
    v_mov_b32 v24, -1
    v_mov_b32 v25, -1
    v_mov_b32 v26, -1
    v_mov_b32 v27, -1
    v_mov_b32 v28, -1
    v_mov_b32 v29, -1
    v_mov_b32 v30, -1
    v_mov_b32 v31, -1
    v_mov_b32 v32, -1
    v_mov_b32 v33, -1
    v_mov_b32 v34, -1
    v_mov_b32 v35, -1
    v_mov_b32 v92, -1
    v_mov_b32 v93, -1
    v_mov_b32 v94, -1
    v_mov_b32 v95, -1
    v_mov_b32 v96, -1
    v_mov_b32 v97, -1
    v_mov_b32 v98, -1
    v_mov_b32 v99, -1
    v_mov_b32 v100, -1
    v_mov_b32 v101, -1
    v_mov_b32 v102, -1
    v_mov_b32 v103, -1
    s_add_u32 s4, s99, 0
    buffer_load_dwordx4 v[192:195], v239, s[8:11], s4 offen sc1
    buffer_load_dwordx4 v[196:199], v249, s[8:11], s4 offen sc1

    ds_read_b128 v[128:131], v228 offset:0
    ds_read_b128 v[144:147], v228 offset:4096
    ds_read_b128 v[132:135], v229 offset:0
    ds_read_b128 v[148:151], v229 offset:4096
    ds_read_b128 v[136:139], v230 offset:0
    ds_read_b128 v[152:155], v230 offset:4096
    ds_read_b128 v[140:143], v231 offset:0
    ds_read_b128 v[156:159], v231 offset:4096
    ds_read_b128 v[160:163], v14 offset:28672
    ds_read_b128 v[164:167], v14 offset:29696
    ds_read_b128 v[108:111], v248
    s_waitcnt lgkmcnt(0)
    v_mfma_f32_16x16x32_bf16 v[76:79], v[108:111], v[112:115], 0
    s_add_u32 s4, s99, 262144
    buffer_load_dwordx4 v[200:203], v239, s[8:11], s4 offen sc1
    buffer_load_dwordx4 v[204:207], v249, s[8:11], s4 offen sc1

.gc_233:
    s_waitcnt vmcnt(2)

    v_mfma_f32_16x16x32_bf16 v[80:83], v[192:195], v[84:87], v[76:79]
    v_max_u32 v4, v192, v196
    v_mfma_f32_16x16x32_bf16 v[80:83], v[196:199], v[112:115], v[80:83]
    v_cmp_eq_u32 vcc, -1, v4
    s_cbranch_vccnz .gf_234
    s_mov_b64 exec, s[58:59]
    s_nop 4
    v_cvt_pk_bf16_f32 v104, v80, v81
    v_cvt_pk_bf16_f32 v105, v82, v83

    buffer_store_dwordx2 v[104:105], v15, s[8:11], s29 offen sc1
    s_mov_b64 exec, -1

    s_branch .top_209
.gf_234:
    s_add_u32 s4, s99, 0
    buffer_load_dwordx4 v[192:195], v239, s[8:11], s4 offen sc1
    buffer_load_dwordx4 v[196:199], v249, s[8:11], s4 offen sc1

    s_waitcnt vmcnt(2)

    v_mfma_f32_16x16x32_bf16 v[80:83], v[200:203], v[84:87], v[76:79]
    v_max_u32 v4, v200, v204
    v_mfma_f32_16x16x32_bf16 v[80:83], v[204:207], v[112:115], v[80:83]
    v_cmp_eq_u32 vcc, -1, v4
    s_cbranch_vccnz .gf_235
    s_mov_b64 exec, s[58:59]
    s_nop 4
    v_cvt_pk_bf16_f32 v104, v80, v81
    v_cvt_pk_bf16_f32 v105, v82, v83

    buffer_store_dwordx2 v[104:105], v15, s[8:11], s29 offen sc1
    s_mov_b64 exec, -1

    s_branch .top_209
.gf_235:
    s_add_u32 s4, s99, 262144
    buffer_load_dwordx4 v[200:203], v239, s[8:11], s4 offen sc1
    buffer_load_dwordx4 v[204:207], v249, s[8:11], s4 offen sc1

    s_sub_u32 s62, s62, 1
    s_cbranch_scc1 .mg_end_1
    s_branch .gc_233
.oth_210:
    s_cmp_eq_u32 s24, 3
    s_cbranch_scc1 .w3_211
    s_cmp_eq_u32 s28, 63
    s_cbranch_scc1 .rec_fin_6
    s_min_u32 s4, s14, s15
    s_max_u32 s93, s93, s4
    v_mov_b32 v4, s93
    v_mov_b32 v5, 19968
    ds_write_b32 v5, v4
    s_waitcnt vmcnt(0)
    v_mov_b32 v57, 0
    v_mov_b32 v58, 0
    v_mov_b32 v59, 0
    v_mov_b32 v60, 0
    v_mov_b32 v61, 0
    v_mov_b32 v62, 0
    v_mov_b32 v63, 0
    v_mov_b32 v64, 0
    v_mov_b32 v65, 0
    v_mov_b32 v66, 0
    v_mov_b32 v67, 0
    s_barrier
.en_29:
    s_add_u32 s6, s28, 2
    s_min_u32 s6, s6, 64
    s_cmp_lt_u32 s93, s6
    s_cbranch_scc1 .kf_236
.kb_237:
    s_mov_b32 m0, s90
    s_nop 0
    buffer_load_dwordx4 v14, s[8:11], s38 offen offset:0 lds
    buffer_load_dwordx4 v14, s[8:11], s38 offen offset:1024 lds
    buffer_load_dwordx4 v14, s[8:11], s38 offen offset:2048 lds
    buffer_load_dwordx4 v14, s[8:11], s38 offen offset:3072 lds
    s_mov_b32 m0, s91
    s_nop 0
    buffer_load_dwordx4 v14, s[8:11], s39 offen lds
    s_waitcnt lgkmcnt(0)
    s_barrier
    v_mov_b32 v20, -1
    v_mov_b32 v21, -1
    v_mov_b32 v22, -1
    v_mov_b32 v23, -1
    v_mov_b32 v24, -1
    v_mov_b32 v25, -1
    v_mov_b32 v26, -1
    v_mov_b32 v27, -1
    v_mov_b32 v28, -1
    v_mov_b32 v29, -1
    v_mov_b32 v30, -1
    v_mov_b32 v31, -1
    v_mov_b32 v32, -1
    v_mov_b32 v33, -1
    v_mov_b32 v34, -1
    v_mov_b32 v35, -1
    v_mov_b32 v55, 0
    v_mov_b32 v56, 0
    buffer_load_dwordx4 v[192:195], v243, s[8:11], s32 offen offset:0 sc1
    buffer_load_dwordx4 v[196:199], v243, s[8:11], s32 offen offset:1024 sc1
    v_mov_b32 v76, 0
    buffer_load_dwordx4 v[200:203], v252, s[8:11], s32 offen offset:0 sc1
    buffer_load_dwordx4 v[204:207], v252, s[8:11], s32 offen offset:1024 sc1
    v_mov_b32 v77, 0
    buffer_load_dwordx4 v[208:211], v254, s[8:11], s32 offen offset:0 sc1
    buffer_load_dwordx4 v[212:215], v254, s[8:11], s32 offen offset:1024 sc1
    v_mov_b32 v78, 0
    buffer_load_dwordx4 v[216:219], v246, s[8:11], s32 offen offset:0 sc1
    buffer_load_dwordx4 v[220:223], v246, s[8:11], s32 offen offset:1024 sc1
    s_waitcnt vmcnt(6)
    v_max_u32 v4, v192, v196
    v_cmp_eq_u32 vcc, -1, v4
    s_cbranch_vccnz .A_239
.W_240:
    v_smfmac_f32_16x16x64_bf16 v[76:79], v[192:195], a[192:199], v9
    s_waitcnt vmcnt(4)
    v_max_u32 v4, v200, v204
    v_cmp_eq_u32 vcc, -1, v4
    v_smfmac_f32_16x16x64_bf16 v[80:83], v[192:195], a[224:231], v9
    v_smfmac_f32_16x16x64_bf16 v[76:79], v[196:199], a[200:207], v9
    v_smfmac_f32_16x16x64_bf16 v[80:83], v[196:199], a[232:239], v9
    s_cbranch_vccnz .A_241
.W_242:
    v_smfmac_f32_16x16x64_bf16 v[76:79], v[200:203], a[208:215], v9
    s_waitcnt vmcnt(2)
    v_max_u32 v4, v208, v212
    v_cmp_eq_u32 vcc, -1, v4
    v_smfmac_f32_16x16x64_bf16 v[80:83], v[200:203], a[240:247], v9
    v_smfmac_f32_16x16x64_bf16 v[76:79], v[204:207], a[216:223], v9
    v_smfmac_f32_16x16x64_bf16 v[80:83], v[204:207], a[248:255], v9
    s_cbranch_vccnz .A_243
.W_244:
    v_smfmac_f32_16x16x64_bf16 v[76:79], v[208:211], v[124:131], v9
    s_waitcnt vmcnt(0)
    v_max_u32 v4, v216, v220
    v_cmp_eq_u32 vcc, -1, v4
    v_smfmac_f32_16x16x64_bf16 v[80:83], v[208:211], v[156:163], v9
    v_smfmac_f32_16x16x64_bf16 v[76:79], v[212:215], v[132:139], v9
    v_smfmac_f32_16x16x64_bf16 v[80:83], v[212:215], v[164:171], v9
    s_cbranch_vccnz .A_245
.W_246:
    s_barrier
    v_smfmac_f32_16x16x64_bf16 v[76:79], v[216:219], v[140:147], v9
    v_smfmac_f32_16x16x64_bf16 v[80:83], v[216:219], v[172:179], v9
    v_smfmac_f32_16x16x64_bf16 v[76:79], v[220:223], v[148:155], v9
    v_smfmac_f32_16x16x64_bf16 v[80:83], v[220:223], v[180:187], v9
.mj_238:
    v_mov_b32 v68, 0
    v_mov_b32 v69, 0
    v_mov_b32 v70, 0
    v_mov_b32 v71, 0
    v_mov_b32 v72, 0
    v_mov_b32 v73, 0
    v_mov_b32 v74, 0
    v_mov_b32 v75, 0
    v_permlane32_swap_b32 v76, v80
    v_permlane32_swap_b32 v77, v81
    v_permlane32_swap_b32 v78, v82
    v_permlane32_swap_b32 v79, v83
    v_pk_add_f32 v[76:77], v[76:77], v[80:81]
    v_pk_add_f32 v[78:79], v[78:79], v[82:83]
    v_cvt_pk_bf16_f32 v104, v76, v77
    v_cvt_pk_bf16_f32 v106, v76, v77
    v_cvt_pk_bf16_f32 v105, v78, v79
    v_cvt_pk_bf16_f32 v107, v78, v79
    v_permlane16_swap_b32 v104, v106
    s_nop 0
    v_permlane16_swap_b32 v105, v107

    buffer_store_dwordx4 v[104:107], v237, s[8:11], s68 offen sc1

    ds_write_b128 v247, v[104:107]
    s_waitcnt lgkmcnt(0)
    s_barrier
    v_mov_b32 v79, 0
    v_mov_b32 v80, 0
    v_mov_b32 v81, 0
    v_mov_b32 v82, 0
    v_mov_b32 v83, 0
    s_waitcnt vmcnt(1)
    v_mov_b32 v192, -1
    v_mov_b32 v193, -1
    v_mov_b32 v194, -1
    v_mov_b32 v195, -1
    v_mov_b32 v196, -1
    v_mov_b32 v197, -1
    v_mov_b32 v198, -1
    v_mov_b32 v199, -1
    v_mov_b32 v200, -1
    v_mov_b32 v201, -1
    v_mov_b32 v202, -1
    v_mov_b32 v203, -1
    v_mov_b32 v204, -1
    v_mov_b32 v205, -1
    v_mov_b32 v206, -1
    v_mov_b32 v207, -1
    v_mov_b32 v208, -1
    v_mov_b32 v209, -1
    v_mov_b32 v210, -1
    v_mov_b32 v211, -1
    v_mov_b32 v212, -1
    v_mov_b32 v213, -1
    v_mov_b32 v214, -1
    v_mov_b32 v215, -1
    v_mov_b32 v216, -1
    v_mov_b32 v217, -1
    v_mov_b32 v218, -1
    v_mov_b32 v219, -1
    v_mov_b32 v220, -1
    v_mov_b32 v221, -1
    v_mov_b32 v222, -1
    v_mov_b32 v223, -1
    s_add_u32 s6, s28, 4
    s_cmp_ge_u32 s93, s6
    s_cbranch_scc1 .nl_247
    s_buffer_load_dword s14, s[8:11], s89 glc
    s_buffer_load_dword s15, s[8:11], s89 offset:8192 glc

.nl_247:
    s_add_u32 s28, s28, 1
    s_add_u32 s36, s36, 196608
    s_cmp_lt_u32 s28, 63
    s_cselect_b32 s4, 262144, 0
    s_add_u32 s38, s38, s4
    s_add_u32 s39, s39, s4
    s_add_u32 s30, s30, s4
    s_mov_b32 s4, s68
    s_mov_b32 s68, s69
    s_mov_b32 s69, s70
    s_mov_b32 s70, s71
    s_mov_b32 s71, s4
    s_and_b32 s4, s28, 3
    s_lshl_b32 s5, s4, 17
    s_add_u32 s29, s5, s34
    s_xor_b32 s6, s5, 262144
    s_add_u32 s31, s6, s34
    s_add_u32 s32, s29, 20480
    s_add_u32 s33, s29, 24576
    s_branch .top_209
.w3_211:
    ds_read_b128 v[36:39], v14 offset:8192
    ds_read_b128 v[40:43], v14 offset:9216
    ds_read_b128 v[44:47], v14 offset:10240
    ds_read_b128 v[48:51], v14 offset:11264
    ds_read_b128 v[88:91], v14 offset:16384
    s_waitcnt lgkmcnt(0)
    v_mfma_f32_16x16x32_bf16 v[104:107], v[84:87], v[36:39], 0
    v_mfma_f32_16x16x32_bf16 v[108:111], v[84:87], v[44:47], 0
    v_mfma_f32_16x16x32_bf16 v[104:107], v[84:87], v[40:43], v[104:107]
    v_mfma_f32_16x16x32_bf16 v[108:111], v[84:87], v[48:51], v[108:111]
    s_nop 7
    v_cvt_pk_bf16_f32 v168, v104, v105
    v_cvt_pk_bf16_f32 v169, v106, v107
    v_cvt_pk_bf16_f32 v170, v108, v109
    v_cvt_pk_bf16_f32 v171, v110, v111
    ds_write_b128 v14, v[168:171] offset:18432
    s_cmp_ge_u32 s28, 62
    s_cbranch_scc1 .sk_248
.sb_249:
.en_35:
    s_waitcnt lgkmcnt(0)
    s_barrier
    buffer_store_dwordx4 v[188:191], v235, s[8:11], s31 offen sc1
    buffer_store_dwordx4 v[188:191], v236, s[8:11], s31 offen sc1

    v_cndmask_b32 v172, v170, v168, s[60:61]
    v_cndmask_b32 v173, v171, v169, s[60:61]

    v_mov_b32 v174, v172
    v_mov_b32 v175, v173
    s_nop 0
    s_nop 0
    v_permlane16_swap_b32 v172, v174
    v_permlane16_swap_b32 v173, v175
    ds_write_b128 v14, v[172:175] offset:17408

    s_branch .gp_212
.A_250:
    s_mov_b64 exec, vcc
    buffer_load_dwordx4 v[32:35], v8, s[8:11], s29 offen offset:3072 sc1
    s_mov_b64 exec, -1
    s_sub_u32 s62, s62, 1
    s_cbranch_scc1 .mg_end_1
    s_waitcnt vmcnt(3)
    v_max_u32 v4, v20, v22
    v_cmp_eq_u32 vcc, -1, v4
    s_cbranch_vccz .W_216
.A_215:
    s_mov_b64 exec, vcc
    buffer_load_dwordx4 v[20:23], v8, s[8:11], s29 offen offset:0 sc1
    s_mov_b64 exec, -1
    s_waitcnt vmcnt(3)
    v_max_u32 v4, v24, v26
    v_cmp_eq_u32 vcc, -1, v4
    s_cbranch_vccz .W_251
.A_252:
    s_mov_b64 exec, vcc
    buffer_load_dwordx4 v[24:27], v8, s[8:11], s29 offen offset:1024 sc1
    s_mov_b64 exec, -1
    s_waitcnt vmcnt(3)
    v_max_u32 v4, v28, v30
    v_cmp_eq_u32 vcc, -1, v4
    s_cbranch_vccz .W_253
.A_254:
    s_mov_b64 exec, vcc
    buffer_load_dwordx4 v[28:31], v8, s[8:11], s29 offen offset:2048 sc1
    s_mov_b64 exec, -1
    s_waitcnt vmcnt(3)
    v_max_u32 v4, v32, v34
    v_cmp_eq_u32 vcc, -1, v4
    s_cbranch_vccnz .A_250
.W_255:
    v_smfmac_f32_16x16x64_bf16 v[52:55], v[32:35], a[24:31], v9
    s_waitcnt vmcnt(2)
    v_max_u32 v4, v20, v22
    v_cmp_eq_u32 vcc, -1, v4
    v_smfmac_f32_16x16x64_bf16 v[56:59], v[32:35], a[56:63], v9
    v_smfmac_f32_16x16x64_bf16 v[60:63], v[32:35], a[88:95], v9
    v_smfmac_f32_16x16x64_bf16 v[64:67], v[32:35], a[120:127], v9
    s_cbranch_vccnz .A_256
.W_257:
    v_smfmac_f32_16x16x64_bf16 v[52:55], v[20:23], a[0:7], v9
    s_waitcnt vmcnt(1)
    v_max_u32 v4, v24, v26
    v_cmp_eq_u32 vcc, -1, v4
    v_smfmac_f32_16x16x64_bf16 v[56:59], v[20:23], a[32:39], v9
    v_smfmac_f32_16x16x64_bf16 v[60:63], v[20:23], a[64:71], v9
    v_smfmac_f32_16x16x64_bf16 v[64:67], v[20:23], a[96:103], v9
    s_cbranch_vccnz .A_258
.W_259:
    v_smfmac_f32_16x16x64_bf16 v[52:55], v[24:27], a[8:15], v9
    s_waitcnt vmcnt(0)
    v_max_u32 v4, v28, v30
    v_cmp_eq_u32 vcc, -1, v4
    v_smfmac_f32_16x16x64_bf16 v[56:59], v[24:27], a[40:47], v9
    v_smfmac_f32_16x16x64_bf16 v[60:63], v[24:27], a[72:79], v9
    v_smfmac_f32_16x16x64_bf16 v[64:67], v[24:27], a[104:111], v9
    s_cbranch_vccnz .A_260
.W_261:
    v_smfmac_f32_16x16x64_bf16 v[52:55], v[28:31], a[16:23], v9
    v_smfmac_f32_16x16x64_bf16 v[56:59], v[28:31], a[48:55], v9
    v_smfmac_f32_16x16x64_bf16 v[60:63], v[28:31], a[80:87], v9
    v_smfmac_f32_16x16x64_bf16 v[64:67], v[28:31], a[112:119], v9
    s_branch .mj_214
.W_251:
    v_smfmac_f32_16x16x64_bf16 v[52:55], v[24:27], a[8:15], v9
    s_waitcnt vmcnt(2)
    v_max_u32 v4, v28, v30
    v_cmp_eq_u32 vcc, -1, v4
    v_smfmac_f32_16x16x64_bf16 v[56:59], v[24:27], a[40:47], v9
    v_smfmac_f32_16x16x64_bf16 v[60:63], v[24:27], a[72:79], v9
    v_smfmac_f32_16x16x64_bf16 v[64:67], v[24:27], a[104:111], v9
    s_cbranch_vccnz .A_262
.W_263:
    v_smfmac_f32_16x16x64_bf16 v[52:55], v[28:31], a[16:23], v9
    s_waitcnt vmcnt(1)
    v_max_u32 v4, v32, v34
    v_cmp_eq_u32 vcc, -1, v4
    v_smfmac_f32_16x16x64_bf16 v[56:59], v[28:31], a[48:55], v9
    v_smfmac_f32_16x16x64_bf16 v[60:63], v[28:31], a[80:87], v9
    v_smfmac_f32_16x16x64_bf16 v[64:67], v[28:31], a[112:119], v9
    s_cbranch_vccnz .A_264
.W_265:
    v_smfmac_f32_16x16x64_bf16 v[52:55], v[32:35], a[24:31], v9
    s_waitcnt vmcnt(0)
    v_max_u32 v4, v20, v22
    v_cmp_eq_u32 vcc, -1, v4
    v_smfmac_f32_16x16x64_bf16 v[56:59], v[32:35], a[56:63], v9
    v_smfmac_f32_16x16x64_bf16 v[60:63], v[32:35], a[88:95], v9
    v_smfmac_f32_16x16x64_bf16 v[64:67], v[32:35], a[120:127], v9
    s_cbranch_vccnz .A_266
.W_267:
    v_smfmac_f32_16x16x64_bf16 v[52:55], v[20:23], a[0:7], v9
    v_smfmac_f32_16x16x64_bf16 v[56:59], v[20:23], a[32:39], v9
    v_smfmac_f32_16x16x64_bf16 v[60:63], v[20:23], a[64:71], v9
    v_smfmac_f32_16x16x64_bf16 v[64:67], v[20:23], a[96:103], v9
    s_branch .mj_214
.W_253:
    v_smfmac_f32_16x16x64_bf16 v[52:55], v[28:31], a[16:23], v9
    s_waitcnt vmcnt(2)
    v_max_u32 v4, v32, v34
    v_cmp_eq_u32 vcc, -1, v4
    v_smfmac_f32_16x16x64_bf16 v[56:59], v[28:31], a[48:55], v9
    v_smfmac_f32_16x16x64_bf16 v[60:63], v[28:31], a[80:87], v9
    v_smfmac_f32_16x16x64_bf16 v[64:67], v[28:31], a[112:119], v9
    s_cbranch_vccnz .A_268
.W_269:
    v_smfmac_f32_16x16x64_bf16 v[52:55], v[32:35], a[24:31], v9
    s_waitcnt vmcnt(1)
    v_max_u32 v4, v20, v22
    v_cmp_eq_u32 vcc, -1, v4
    v_smfmac_f32_16x16x64_bf16 v[56:59], v[32:35], a[56:63], v9
    v_smfmac_f32_16x16x64_bf16 v[60:63], v[32:35], a[88:95], v9
    v_smfmac_f32_16x16x64_bf16 v[64:67], v[32:35], a[120:127], v9
    s_cbranch_vccnz .A_270
.W_271:
    v_smfmac_f32_16x16x64_bf16 v[52:55], v[20:23], a[0:7], v9
    s_waitcnt vmcnt(0)
    v_max_u32 v4, v24, v26
    v_cmp_eq_u32 vcc, -1, v4
    v_smfmac_f32_16x16x64_bf16 v[56:59], v[20:23], a[32:39], v9
    v_smfmac_f32_16x16x64_bf16 v[60:63], v[20:23], a[64:71], v9
    v_smfmac_f32_16x16x64_bf16 v[64:67], v[20:23], a[96:103], v9
    s_cbranch_vccnz .A_272
.W_273:
    v_smfmac_f32_16x16x64_bf16 v[52:55], v[24:27], a[8:15], v9
    v_smfmac_f32_16x16x64_bf16 v[56:59], v[24:27], a[40:47], v9
    v_smfmac_f32_16x16x64_bf16 v[60:63], v[24:27], a[72:79], v9
    v_smfmac_f32_16x16x64_bf16 v[64:67], v[24:27], a[104:111], v9
    s_branch .mj_214
.A_274:
    s_mov_b64 exec, vcc
    buffer_load_dwordx4 v[28:31], v8, s[8:11], s29 offen offset:2048 sc1
    s_mov_b64 exec, -1
    s_sub_u32 s62, s62, 1
    s_cbranch_scc1 .mg_end_1
    s_waitcnt vmcnt(2)
    v_max_u32 v4, v20, v22
    v_cmp_eq_u32 vcc, -1, v4
    s_cbranch_vccz .W_257
.A_256:
    s_mov_b64 exec, vcc
    buffer_load_dwordx4 v[20:23], v8, s[8:11], s29 offen offset:0 sc1
    s_mov_b64 exec, -1
    s_waitcnt vmcnt(2)
    v_max_u32 v4, v24, v26
    v_cmp_eq_u32 vcc, -1, v4
    s_cbranch_vccz .W_275
.A_276:
    s_mov_b64 exec, vcc
    buffer_load_dwordx4 v[24:27], v8, s[8:11], s29 offen offset:1024 sc1
    s_mov_b64 exec, -1
    s_waitcnt vmcnt(2)
    v_max_u32 v4, v28, v30
    v_cmp_eq_u32 vcc, -1, v4
    s_cbranch_vccnz .A_274
.W_277:
    v_smfmac_f32_16x16x64_bf16 v[52:55], v[28:31], a[16:23], v9
    s_waitcnt vmcnt(1)
    v_max_u32 v4, v20, v22
    v_cmp_eq_u32 vcc, -1, v4
    v_smfmac_f32_16x16x64_bf16 v[56:59], v[28:31], a[48:55], v9
    v_smfmac_f32_16x16x64_bf16 v[60:63], v[28:31], a[80:87], v9
    v_smfmac_f32_16x16x64_bf16 v[64:67], v[28:31], a[112:119], v9
    s_cbranch_vccz .W_271
    s_branch .A_270
.W_275:
    v_smfmac_f32_16x16x64_bf16 v[52:55], v[24:27], a[8:15], v9
    s_waitcnt vmcnt(1)
    v_max_u32 v4, v28, v30
    v_cmp_eq_u32 vcc, -1, v4
    v_smfmac_f32_16x16x64_bf16 v[56:59], v[24:27], a[40:47], v9
    v_smfmac_f32_16x16x64_bf16 v[60:63], v[24:27], a[72:79], v9
    v_smfmac_f32_16x16x64_bf16 v[64:67], v[24:27], a[104:111], v9
    s_cbranch_vccnz .A_278
.W_279:
    v_smfmac_f32_16x16x64_bf16 v[52:55], v[28:31], a[16:23], v9
    s_waitcnt vmcnt(0)
    v_max_u32 v4, v20, v22
    v_cmp_eq_u32 vcc, -1, v4
    v_smfmac_f32_16x16x64_bf16 v[56:59], v[28:31], a[48:55], v9
    v_smfmac_f32_16x16x64_bf16 v[60:63], v[28:31], a[80:87], v9
    v_smfmac_f32_16x16x64_bf16 v[64:67], v[28:31], a[112:119], v9
    s_cbranch_vccz .W_267
    s_branch .A_266
.A_280:
    s_mov_b64 exec, vcc
    buffer_load_dwordx4 v[24:27], v8, s[8:11], s29 offen offset:1024 sc1
    s_mov_b64 exec, -1
    s_sub_u32 s62, s62, 1
    s_cbranch_scc1 .mg_end_1
    s_waitcnt vmcnt(2)
    v_max_u32 v4, v32, v34
    v_cmp_eq_u32 vcc, -1, v4
    s_cbranch_vccz .W_269
.A_268:
    s_mov_b64 exec, vcc
    buffer_load_dwordx4 v[32:35], v8, s[8:11], s29 offen offset:3072 sc1
    s_mov_b64 exec, -1
    s_waitcnt vmcnt(2)
    v_max_u32 v4, v20, v22
    v_cmp_eq_u32 vcc, -1, v4
    s_cbranch_vccz .W_281
.A_282:
    s_mov_b64 exec, vcc
    buffer_load_dwordx4 v[20:23], v8, s[8:11], s29 offen offset:0 sc1
    s_mov_b64 exec, -1
    s_waitcnt vmcnt(2)
    v_max_u32 v4, v24, v26
    v_cmp_eq_u32 vcc, -1, v4
    s_cbranch_vccnz .A_280
.W_283:
    v_smfmac_f32_16x16x64_bf16 v[52:55], v[24:27], a[8:15], v9
    s_waitcnt vmcnt(1)
    v_max_u32 v4, v32, v34
    v_cmp_eq_u32 vcc, -1, v4
    v_smfmac_f32_16x16x64_bf16 v[56:59], v[24:27], a[40:47], v9
    v_smfmac_f32_16x16x64_bf16 v[60:63], v[24:27], a[72:79], v9
    v_smfmac_f32_16x16x64_bf16 v[64:67], v[24:27], a[104:111], v9
    s_cbranch_vccz .W_265
    s_branch .A_264
.W_281:
    v_smfmac_f32_16x16x64_bf16 v[52:55], v[20:23], a[0:7], v9
    s_waitcnt vmcnt(1)
    v_max_u32 v4, v24, v26
    v_cmp_eq_u32 vcc, -1, v4
    v_smfmac_f32_16x16x64_bf16 v[56:59], v[20:23], a[32:39], v9
    v_smfmac_f32_16x16x64_bf16 v[60:63], v[20:23], a[64:71], v9
    v_smfmac_f32_16x16x64_bf16 v[64:67], v[20:23], a[96:103], v9
    s_cbranch_vccnz .A_284
.W_285:
    v_smfmac_f32_16x16x64_bf16 v[52:55], v[24:27], a[8:15], v9
    s_waitcnt vmcnt(0)
    v_max_u32 v4, v32, v34
    v_cmp_eq_u32 vcc, -1, v4
    v_smfmac_f32_16x16x64_bf16 v[56:59], v[24:27], a[40:47], v9
    v_smfmac_f32_16x16x64_bf16 v[60:63], v[24:27], a[72:79], v9
    v_smfmac_f32_16x16x64_bf16 v[64:67], v[24:27], a[104:111], v9
    s_cbranch_vccz .W_222
    s_branch .A_221
.A_286:
    s_mov_b64 exec, vcc
    buffer_load_dwordx4 v[32:35], v8, s[8:11], s29 offen offset:3072 sc1
    s_mov_b64 exec, -1
    s_sub_u32 s62, s62, 1
    s_cbranch_scc1 .mg_end_1
    s_waitcnt vmcnt(2)
    v_max_u32 v4, v20, v22
    v_cmp_eq_u32 vcc, -1, v4
    s_cbranch_vccz .W_287
.A_288:
    s_mov_b64 exec, vcc
    buffer_load_dwordx4 v[20:23], v8, s[8:11], s29 offen offset:0 sc1
    s_mov_b64 exec, -1
    s_waitcnt vmcnt(2)
    v_max_u32 v4, v28, v30
    v_cmp_eq_u32 vcc, -1, v4
    s_cbranch_vccz .W_263
.A_262:
    s_mov_b64 exec, vcc
    buffer_load_dwordx4 v[28:31], v8, s[8:11], s29 offen offset:2048 sc1
    s_mov_b64 exec, -1
    s_waitcnt vmcnt(2)
    v_max_u32 v4, v32, v34
    v_cmp_eq_u32 vcc, -1, v4
    s_cbranch_vccnz .A_286
.W_289:
    v_smfmac_f32_16x16x64_bf16 v[52:55], v[32:35], a[24:31], v9
    s_waitcnt vmcnt(1)
    v_max_u32 v4, v20, v22
    v_cmp_eq_u32 vcc, -1, v4
    v_smfmac_f32_16x16x64_bf16 v[56:59], v[32:35], a[56:63], v9
    v_smfmac_f32_16x16x64_bf16 v[60:63], v[32:35], a[88:95], v9
    v_smfmac_f32_16x16x64_bf16 v[64:67], v[32:35], a[120:127], v9
    s_cbranch_vccnz .A_290
.W_291:
    v_smfmac_f32_16x16x64_bf16 v[52:55], v[20:23], a[0:7], v9
    s_waitcnt vmcnt(0)
    v_max_u32 v4, v28, v30
    v_cmp_eq_u32 vcc, -1, v4
    v_smfmac_f32_16x16x64_bf16 v[56:59], v[20:23], a[32:39], v9
    v_smfmac_f32_16x16x64_bf16 v[60:63], v[20:23], a[64:71], v9
    v_smfmac_f32_16x16x64_bf16 v[64:67], v[20:23], a[96:103], v9
    s_cbranch_vccz .W_261
    s_branch .A_260
.W_287:
    v_smfmac_f32_16x16x64_bf16 v[52:55], v[20:23], a[0:7], v9
    s_waitcnt vmcnt(1)
    v_max_u32 v4, v28, v30
    v_cmp_eq_u32 vcc, -1, v4
    v_smfmac_f32_16x16x64_bf16 v[56:59], v[20:23], a[32:39], v9
    v_smfmac_f32_16x16x64_bf16 v[60:63], v[20:23], a[64:71], v9
    v_smfmac_f32_16x16x64_bf16 v[64:67], v[20:23], a[96:103], v9
    s_cbranch_vccz .W_220
    s_branch .A_219
.A_292:
    s_mov_b64 exec, vcc
    buffer_load_dwordx4 v[32:35], v8, s[8:11], s29 offen offset:3072 sc1
    s_mov_b64 exec, -1
    s_sub_u32 s62, s62, 1
    s_cbranch_scc1 .mg_end_1
    s_waitcnt vmcnt(2)
    v_max_u32 v4, v24, v26
    v_cmp_eq_u32 vcc, -1, v4
    s_cbranch_vccz .W_218
.A_217:
    s_mov_b64 exec, vcc
    buffer_load_dwordx4 v[24:27], v8, s[8:11], s29 offen offset:1024 sc1
    s_mov_b64 exec, -1
    s_waitcnt vmcnt(2)
    v_max_u32 v4, v28, v30
    v_cmp_eq_u32 vcc, -1, v4
    s_cbranch_vccz .W_293
.A_294:
    s_mov_b64 exec, vcc
    buffer_load_dwordx4 v[28:31], v8, s[8:11], s29 offen offset:2048 sc1
    s_mov_b64 exec, -1
    s_waitcnt vmcnt(2)
    v_max_u32 v4, v32, v34
    v_cmp_eq_u32 vcc, -1, v4
    s_cbranch_vccnz .A_292
.W_295:
    v_smfmac_f32_16x16x64_bf16 v[52:55], v[32:35], a[24:31], v9
    s_waitcnt vmcnt(1)
    v_max_u32 v4, v24, v26
    v_cmp_eq_u32 vcc, -1, v4
    v_smfmac_f32_16x16x64_bf16 v[56:59], v[32:35], a[56:63], v9
    v_smfmac_f32_16x16x64_bf16 v[60:63], v[32:35], a[88:95], v9
    v_smfmac_f32_16x16x64_bf16 v[64:67], v[32:35], a[120:127], v9
    s_cbranch_vccz .W_259
    s_branch .A_258
.W_293:
    v_smfmac_f32_16x16x64_bf16 v[52:55], v[28:31], a[16:23], v9
    s_waitcnt vmcnt(1)
    v_max_u32 v4, v32, v34
    v_cmp_eq_u32 vcc, -1, v4
    v_smfmac_f32_16x16x64_bf16 v[56:59], v[28:31], a[48:55], v9
    v_smfmac_f32_16x16x64_bf16 v[60:63], v[28:31], a[80:87], v9
    v_smfmac_f32_16x16x64_bf16 v[64:67], v[28:31], a[112:119], v9
    s_cbranch_vccnz .A_296
.W_297:
    v_smfmac_f32_16x16x64_bf16 v[52:55], v[32:35], a[24:31], v9
    s_waitcnt vmcnt(0)
    v_max_u32 v4, v24, v26
    v_cmp_eq_u32 vcc, -1, v4
    v_smfmac_f32_16x16x64_bf16 v[56:59], v[32:35], a[56:63], v9
    v_smfmac_f32_16x16x64_bf16 v[60:63], v[32:35], a[88:95], v9
    v_smfmac_f32_16x16x64_bf16 v[64:67], v[32:35], a[120:127], v9
    s_cbranch_vccz .W_273
    s_branch .A_272
.A_298:
    s_mov_b64 exec, vcc
    buffer_load_dwordx4 v[24:27], v8, s[8:11], s29 offen offset:1024 sc1
    s_mov_b64 exec, -1
    s_sub_u32 s62, s62, 1
    s_cbranch_scc1 .mg_end_1
    s_waitcnt vmcnt(1)
    v_max_u32 v4, v20, v22
    v_cmp_eq_u32 vcc, -1, v4
    s_cbranch_vccz .W_271
.A_270:
    s_mov_b64 exec, vcc
    buffer_load_dwordx4 v[20:23], v8, s[8:11], s29 offen offset:0 sc1
    s_mov_b64 exec, -1
    s_waitcnt vmcnt(1)
    v_max_u32 v4, v24, v26
    v_cmp_eq_u32 vcc, -1, v4
    s_cbranch_vccnz .A_298
.W_299:
    v_smfmac_f32_16x16x64_bf16 v[52:55], v[24:27], a[8:15], v9
    s_waitcnt vmcnt(0)
    v_max_u32 v4, v20, v22
    v_cmp_eq_u32 vcc, -1, v4
    v_smfmac_f32_16x16x64_bf16 v[56:59], v[24:27], a[40:47], v9
    v_smfmac_f32_16x16x64_bf16 v[60:63], v[24:27], a[72:79], v9
    v_smfmac_f32_16x16x64_bf16 v[64:67], v[24:27], a[104:111], v9
    s_cbranch_vccz .W_267
    s_branch .A_266
.A_278:
    s_mov_b64 exec, vcc
    buffer_load_dwordx4 v[28:31], v8, s[8:11], s29 offen offset:2048 sc1
    s_mov_b64 exec, -1
    s_sub_u32 s62, s62, 1
    s_cbranch_scc1 .mg_end_1
    s_waitcnt vmcnt(1)
    v_max_u32 v4, v20, v22
    v_cmp_eq_u32 vcc, -1, v4
    s_cbranch_vccz .W_291
.A_290:
    s_mov_b64 exec, vcc
    buffer_load_dwordx4 v[20:23], v8, s[8:11], s29 offen offset:0 sc1
    s_mov_b64 exec, -1
    s_waitcnt vmcnt(1)
    v_max_u32 v4, v28, v30
    v_cmp_eq_u32 vcc, -1, v4
    s_cbranch_vccnz .A_278
    s_branch .W_279
.A_300:
    s_mov_b64 exec, vcc
    buffer_load_dwordx4 v[20:23], v8, s[8:11], s29 offen offset:0 sc1
    s_mov_b64 exec, -1
    s_sub_u32 s62, s62, 1
    s_cbranch_scc1 .mg_end_1
    s_waitcnt vmcnt(1)
    v_max_u32 v4, v32, v34
    v_cmp_eq_u32 vcc, -1, v4
    s_cbranch_vccz .W_265
.A_264:
    s_mov_b64 exec, vcc
    buffer_load_dwordx4 v[32:35], v8, s[8:11], s29 offen offset:3072 sc1
    s_mov_b64 exec, -1
    s_waitcnt vmcnt(1)
    v_max_u32 v4, v20, v22
    v_cmp_eq_u32 vcc, -1, v4
    s_cbranch_vccnz .A_300
.W_301:
    v_smfmac_f32_16x16x64_bf16 v[52:55], v[20:23], a[0:7], v9
    s_waitcnt vmcnt(0)
    v_max_u32 v4, v32, v34
    v_cmp_eq_u32 vcc, -1, v4
    v_smfmac_f32_16x16x64_bf16 v[56:59], v[20:23], a[32:39], v9
    v_smfmac_f32_16x16x64_bf16 v[60:63], v[20:23], a[64:71], v9
    v_smfmac_f32_16x16x64_bf16 v[64:67], v[20:23], a[96:103], v9
    s_cbranch_vccz .W_222
    s_branch .A_221
.A_302:
    s_mov_b64 exec, vcc
    buffer_load_dwordx4 v[28:31], v8, s[8:11], s29 offen offset:2048 sc1
    s_mov_b64 exec, -1
    s_sub_u32 s62, s62, 1
    s_cbranch_scc1 .mg_end_1
    s_waitcnt vmcnt(1)
    v_max_u32 v4, v24, v26
    v_cmp_eq_u32 vcc, -1, v4
    s_cbranch_vccz .W_259
.A_258:
    s_mov_b64 exec, vcc
    buffer_load_dwordx4 v[24:27], v8, s[8:11], s29 offen offset:1024 sc1
    s_mov_b64 exec, -1
    s_waitcnt vmcnt(1)
    v_max_u32 v4, v28, v30
    v_cmp_eq_u32 vcc, -1, v4
    s_cbranch_vccnz .A_302
.W_303:
    v_smfmac_f32_16x16x64_bf16 v[52:55], v[28:31], a[16:23], v9
    s_waitcnt vmcnt(0)
    v_max_u32 v4, v24, v26
    v_cmp_eq_u32 vcc, -1, v4
    v_smfmac_f32_16x16x64_bf16 v[56:59], v[28:31], a[48:55], v9
    v_smfmac_f32_16x16x64_bf16 v[60:63], v[28:31], a[80:87], v9
    v_smfmac_f32_16x16x64_bf16 v[64:67], v[28:31], a[112:119], v9
    s_cbranch_vccz .W_273
    s_branch .A_272
.A_296:
    s_mov_b64 exec, vcc
    buffer_load_dwordx4 v[32:35], v8, s[8:11], s29 offen offset:3072 sc1
    s_mov_b64 exec, -1
    s_sub_u32 s62, s62, 1
    s_cbranch_scc1 .mg_end_1
    s_waitcnt vmcnt(1)
    v_max_u32 v4, v24, v26
    v_cmp_eq_u32 vcc, -1, v4
    s_cbranch_vccz .W_285
.A_284:
    s_mov_b64 exec, vcc
    buffer_load_dwordx4 v[24:27], v8, s[8:11], s29 offen offset:1024 sc1
    s_mov_b64 exec, -1
    s_waitcnt vmcnt(1)
    v_max_u32 v4, v32, v34
    v_cmp_eq_u32 vcc, -1, v4
    s_cbranch_vccnz .A_296
    s_branch .W_297
.A_304:
    s_mov_b64 exec, vcc
    buffer_load_dwordx4 v[32:35], v8, s[8:11], s29 offen offset:3072 sc1
    s_mov_b64 exec, -1
    s_sub_u32 s62, s62, 1
    s_cbranch_scc1 .mg_end_1
    s_waitcnt vmcnt(1)
    v_max_u32 v4, v28, v30
    v_cmp_eq_u32 vcc, -1, v4
    s_cbranch_vccz .W_220
.A_219:
    s_mov_b64 exec, vcc
    buffer_load_dwordx4 v[28:31], v8, s[8:11], s29 offen offset:2048 sc1
    s_mov_b64 exec, -1
    s_waitcnt vmcnt(1)
    v_max_u32 v4, v32, v34
    v_cmp_eq_u32 vcc, -1, v4
    s_cbranch_vccnz .A_304
.W_305:
    v_smfmac_f32_16x16x64_bf16 v[52:55], v[32:35], a[24:31], v9
    s_waitcnt vmcnt(0)
    v_max_u32 v4, v28, v30
    v_cmp_eq_u32 vcc, -1, v4
    v_smfmac_f32_16x16x64_bf16 v[56:59], v[32:35], a[56:63], v9
    v_smfmac_f32_16x16x64_bf16 v[60:63], v[32:35], a[88:95], v9
    v_smfmac_f32_16x16x64_bf16 v[64:67], v[32:35], a[120:127], v9
    s_cbranch_vccz .W_261
    s_branch .A_260
.A_266:
    s_mov_b64 exec, vcc
    buffer_load_dwordx4 v[20:23], v8, s[8:11], s29 offen offset:0 sc1
    s_mov_b64 exec, -1
    s_sub_u32 s62, s62, 1
    s_cbranch_scc1 .mg_end_1
    s_waitcnt vmcnt(1)
    v_max3_u32 v4, v20, v21, v22
    v_max_u32 v4, v4, v23
    v_cmp_eq_u32 vcc, -1, v4
    s_cbranch_vccnz .A_266
    v_smfmac_f32_16x16x64_bf16 v[52:55], v[20:23], a[0:7], v9
    v_smfmac_f32_16x16x64_bf16 v[56:59], v[20:23], a[32:39], v9
    v_smfmac_f32_16x16x64_bf16 v[60:63], v[20:23], a[64:71], v9
    v_smfmac_f32_16x16x64_bf16 v[64:67], v[20:23], a[96:103], v9
    s_branch .mj_214
.A_272:
    s_mov_b64 exec, vcc
    buffer_load_dwordx4 v[24:27], v8, s[8:11], s29 offen offset:1024 sc1
    s_mov_b64 exec, -1
    s_sub_u32 s62, s62, 1
    s_cbranch_scc1 .mg_end_1
    s_waitcnt vmcnt(1)
    v_max3_u32 v4, v24, v25, v26
    v_max_u32 v4, v4, v27
    v_cmp_eq_u32 vcc, -1, v4
    s_cbranch_vccnz .A_272
    v_smfmac_f32_16x16x64_bf16 v[52:55], v[24:27], a[8:15], v9
    v_smfmac_f32_16x16x64_bf16 v[56:59], v[24:27], a[40:47], v9
    v_smfmac_f32_16x16x64_bf16 v[60:63], v[24:27], a[72:79], v9
    v_smfmac_f32_16x16x64_bf16 v[64:67], v[24:27], a[104:111], v9
    s_branch .mj_214
.A_260:
    s_mov_b64 exec, vcc
    buffer_load_dwordx4 v[28:31], v8, s[8:11], s29 offen offset:2048 sc1
    s_mov_b64 exec, -1
    s_sub_u32 s62, s62, 1
    s_cbranch_scc1 .mg_end_1
    s_waitcnt vmcnt(1)
    v_max3_u32 v4, v28, v29, v30
    v_max_u32 v4, v4, v31
    v_cmp_eq_u32 vcc, -1, v4
    s_cbranch_vccnz .A_260
    v_smfmac_f32_16x16x64_bf16 v[52:55], v[28:31], a[16:23], v9
    v_smfmac_f32_16x16x64_bf16 v[56:59], v[28:31], a[48:55], v9
    v_smfmac_f32_16x16x64_bf16 v[60:63], v[28:31], a[80:87], v9
    v_smfmac_f32_16x16x64_bf16 v[64:67], v[28:31], a[112:119], v9
    s_branch .mj_214
.A_221:
    s_mov_b64 exec, vcc
    buffer_load_dwordx4 v[32:35], v8, s[8:11], s29 offen offset:3072 sc1
    s_mov_b64 exec, -1
    s_sub_u32 s62, s62, 1
    s_cbranch_scc1 .mg_end_1
    s_waitcnt vmcnt(1)
    v_max3_u32 v4, v32, v33, v34
    v_max_u32 v4, v4, v35
    v_cmp_eq_u32 vcc, -1, v4
    s_cbranch_vccnz .A_221
    v_smfmac_f32_16x16x64_bf16 v[52:55], v[32:35], a[24:31], v9
    v_smfmac_f32_16x16x64_bf16 v[56:59], v[32:35], a[56:63], v9
    v_smfmac_f32_16x16x64_bf16 v[60:63], v[32:35], a[88:95], v9
    v_smfmac_f32_16x16x64_bf16 v[64:67], v[32:35], a[120:127], v9
    s_branch .mj_214
.A_306:
    buffer_load_dwordx4 v[100:103], v234, s[8:11], s29 offen sc1
    s_sub_u32 s62, s62, 1
    s_cbranch_scc1 .mg_end_1
    s_waitcnt vmcnt(2)
    v_max_u32 v4, v92, v94
    v_cmp_eq_u32 vcc, -1, v4
    s_cbranch_vccz .W_225
.A_224:
    buffer_load_dwordx4 v[92:95], v232, s[8:11], s29 offen sc1
    s_waitcnt vmcnt(2)
    v_max_u32 v4, v96, v98
    v_cmp_eq_u32 vcc, -1, v4
    s_cbranch_vccz .W_307
.A_308:
    buffer_load_dwordx4 v[96:99], v233, s[8:11], s29 offen sc1
    s_waitcnt vmcnt(2)
    v_max_u32 v4, v100, v102
    v_cmp_eq_u32 vcc, -1, v4
    s_cbranch_vccnz .A_306
.W_309:
    v_mfma_f32_16x16x32_bf16 v[208:211], v[140:143], v[100:103], v[208:211]
    s_waitcnt vmcnt(1)
    v_max_u32 v4, v92, v94
    v_cmp_eq_u32 vcc, -1, v4
    v_mfma_f32_16x16x32_bf16 v[212:215], v[156:159], v[100:103], v[212:215]
    v_mfma_f32_16x16x32_bf16 v[216:219], v[100:103], v[100:103], v[216:219]
    s_cbranch_vccnz .A_310
.W_311:
    v_mfma_f32_16x16x32_bf16 v[208:211], v[132:135], v[92:95], v[208:211]
    s_waitcnt vmcnt(0)
    v_max_u32 v4, v96, v98
    v_cmp_eq_u32 vcc, -1, v4
    v_mfma_f32_16x16x32_bf16 v[212:215], v[148:151], v[92:95], v[212:215]
    v_mfma_f32_16x16x32_bf16 v[216:219], v[92:95], v[92:95], v[216:219]
    s_cbranch_vccnz .A_312
.W_313:
    v_mfma_f32_16x16x32_bf16 v[208:211], v[136:139], v[96:99], v[208:211]
    s_barrier
    v_mfma_f32_16x16x32_bf16 v[212:215], v[152:155], v[96:99], v[212:215]
    v_mfma_f32_16x16x32_bf16 v[216:219], v[96:99], v[96:99], v[216:219]
    s_branch .mj_223
.W_307:
    v_mfma_f32_16x16x32_bf16 v[208:211], v[136:139], v[96:99], v[208:211]
    s_waitcnt vmcnt(1)
    v_max_u32 v4, v100, v102
    v_cmp_eq_u32 vcc, -1, v4
    v_mfma_f32_16x16x32_bf16 v[212:215], v[152:155], v[96:99], v[212:215]
    v_mfma_f32_16x16x32_bf16 v[216:219], v[96:99], v[96:99], v[216:219]
    s_cbranch_vccnz .A_314
.W_315:
    v_mfma_f32_16x16x32_bf16 v[208:211], v[140:143], v[100:103], v[208:211]
    s_waitcnt vmcnt(0)
    v_max_u32 v4, v92, v94
    v_cmp_eq_u32 vcc, -1, v4
    v_mfma_f32_16x16x32_bf16 v[212:215], v[156:159], v[100:103], v[212:215]
    v_mfma_f32_16x16x32_bf16 v[216:219], v[100:103], v[100:103], v[216:219]
    s_cbranch_vccnz .A_316
.W_317:
    v_mfma_f32_16x16x32_bf16 v[208:211], v[132:135], v[92:95], v[208:211]
    s_barrier
    v_mfma_f32_16x16x32_bf16 v[212:215], v[148:151], v[92:95], v[212:215]
    v_mfma_f32_16x16x32_bf16 v[216:219], v[92:95], v[92:95], v[216:219]
    s_branch .mj_223
.A_318:
    buffer_load_dwordx4 v[96:99], v233, s[8:11], s29 offen sc1
    s_sub_u32 s62, s62, 1
    s_cbranch_scc1 .mg_end_1
    s_waitcnt vmcnt(1)
    v_max_u32 v4, v92, v94
    v_cmp_eq_u32 vcc, -1, v4
    s_cbranch_vccz .W_311
.A_310:
    buffer_load_dwordx4 v[92:95], v232, s[8:11], s29 offen sc1
    s_waitcnt vmcnt(1)
    v_max_u32 v4, v96, v98
    v_cmp_eq_u32 vcc, -1, v4
    s_cbranch_vccnz .A_318
.W_319:
    v_mfma_f32_16x16x32_bf16 v[208:211], v[136:139], v[96:99], v[208:211]
    s_waitcnt vmcnt(0)
    v_max_u32 v4, v92, v94
    v_cmp_eq_u32 vcc, -1, v4
    v_mfma_f32_16x16x32_bf16 v[212:215], v[152:155], v[96:99], v[212:215]
    v_mfma_f32_16x16x32_bf16 v[216:219], v[96:99], v[96:99], v[216:219]
    s_cbranch_vccz .W_317
    s_branch .A_316
.A_320:
    buffer_load_dwordx4 v[92:95], v232, s[8:11], s29 offen sc1
    s_sub_u32 s62, s62, 1
    s_cbranch_scc1 .mg_end_1
    s_waitcnt vmcnt(1)
    v_max_u32 v4, v100, v102
    v_cmp_eq_u32 vcc, -1, v4
    s_cbranch_vccz .W_315
.A_314:
    buffer_load_dwordx4 v[100:103], v234, s[8:11], s29 offen sc1
    s_waitcnt vmcnt(1)
    v_max_u32 v4, v92, v94
    v_cmp_eq_u32 vcc, -1, v4
    s_cbranch_vccnz .A_320
.W_321:
    v_mfma_f32_16x16x32_bf16 v[208:211], v[132:135], v[92:95], v[208:211]
    s_waitcnt vmcnt(0)
    v_max_u32 v4, v100, v102
    v_cmp_eq_u32 vcc, -1, v4
    v_mfma_f32_16x16x32_bf16 v[212:215], v[148:151], v[92:95], v[212:215]
    v_mfma_f32_16x16x32_bf16 v[216:219], v[92:95], v[92:95], v[216:219]
    s_cbranch_vccz .W_229
    s_branch .A_228
.A_322:
    buffer_load_dwordx4 v[100:103], v234, s[8:11], s29 offen sc1
    s_sub_u32 s62, s62, 1
    s_cbranch_scc1 .mg_end_1
    s_waitcnt vmcnt(1)
    v_max_u32 v4, v96, v98
    v_cmp_eq_u32 vcc, -1, v4
    s_cbranch_vccz .W_227
.A_226:
    buffer_load_dwordx4 v[96:99], v233, s[8:11], s29 offen sc1
    s_waitcnt vmcnt(1)
    v_max_u32 v4, v100, v102
    v_cmp_eq_u32 vcc, -1, v4
    s_cbranch_vccnz .A_322
.W_323:
    v_mfma_f32_16x16x32_bf16 v[208:211], v[140:143], v[100:103], v[208:211]
    s_waitcnt vmcnt(0)
    v_max_u32 v4, v96, v98
    v_cmp_eq_u32 vcc, -1, v4
    v_mfma_f32_16x16x32_bf16 v[212:215], v[156:159], v[100:103], v[212:215]
    v_mfma_f32_16x16x32_bf16 v[216:219], v[100:103], v[100:103], v[216:219]
    s_cbranch_vccz .W_313
    s_branch .A_312
.A_316:
    buffer_load_dwordx4 v[92:95], v232, s[8:11], s29 offen sc1
    s_sub_u32 s62, s62, 1
    s_cbranch_scc1 .mg_end_1
    s_waitcnt vmcnt(1)
    v_max3_u32 v4, v92, v93, v94
    v_max_u32 v4, v4, v95
    v_cmp_eq_u32 vcc, -1, v4
    s_cbranch_vccnz .A_316
    v_mfma_f32_16x16x32_bf16 v[208:211], v[132:135], v[92:95], v[208:211]
    s_barrier
    v_mfma_f32_16x16x32_bf16 v[212:215], v[148:151], v[92:95], v[212:215]
    v_mfma_f32_16x16x32_bf16 v[216:219], v[92:95], v[92:95], v[216:219]
    s_branch .mj_223
.A_312:
    buffer_load_dwordx4 v[96:99], v233, s[8:11], s29 offen sc1
    s_sub_u32 s62, s62, 1
    s_cbranch_scc1 .mg_end_1
    s_waitcnt vmcnt(1)
    v_max3_u32 v4, v96, v97, v98
    v_max_u32 v4, v4, v99
    v_cmp_eq_u32 vcc, -1, v4
    s_cbranch_vccnz .A_312
    v_mfma_f32_16x16x32_bf16 v[208:211], v[136:139], v[96:99], v[208:211]
    s_barrier
    v_mfma_f32_16x16x32_bf16 v[212:215], v[152:155], v[96:99], v[212:215]
    v_mfma_f32_16x16x32_bf16 v[216:219], v[96:99], v[96:99], v[216:219]
    s_branch .mj_223
.A_228:
    buffer_load_dwordx4 v[100:103], v234, s[8:11], s29 offen sc1
    s_sub_u32 s62, s62, 1
    s_cbranch_scc1 .mg_end_1
    s_waitcnt vmcnt(1)
    v_max3_u32 v4, v100, v101, v102
    v_max_u32 v4, v4, v103
    v_cmp_eq_u32 vcc, -1, v4
    s_cbranch_vccnz .A_228
    v_mfma_f32_16x16x32_bf16 v[208:211], v[140:143], v[100:103], v[208:211]
    s_barrier
    v_mfma_f32_16x16x32_bf16 v[212:215], v[156:159], v[100:103], v[212:215]
    v_mfma_f32_16x16x32_bf16 v[216:219], v[100:103], v[100:103], v[216:219]
    s_branch .mj_223
.kf_236:
    s_mov_b32 s62, 0
    s_mov_b64 exec, 3
.wf_324:
    buffer_load_dword v244, v253, s[8:11], s89 offen sc1
    s_waitcnt vmcnt(0)
    v_cmp_gt_u32 vcc, s6, v244
    s_cbranch_vccz .wfd_325
    s_sleep 2
    s_add_u32 s62, s62, 1
    s_cmp_gt_u32 s62, 0x400000
    s_cbranch_scc1 .mg_end_1
    s_branch .wf_324

.wfd_325:
    s_mov_b64 exec, -1
    v_readlane_b32 s4, v244, 0
    v_readlane_b32 s93, v244, 1
    s_min_u32 s93, s93, s4
    s_mov_b32 s62, 0x1000000
    s_branch .kb_237
.A_326:
    buffer_load_dwordx4 v[216:219], v246, s[8:11], s32 offen offset:0 sc1
    buffer_load_dwordx4 v[220:223], v246, s[8:11], s32 offen offset:1024 sc1
    s_sub_u32 s62, s62, 1
    s_cbranch_scc1 .mg_end_1
    s_waitcnt vmcnt(6)
    v_max_u32 v4, v192, v196
    v_cmp_eq_u32 vcc, -1, v4
    s_cbranch_vccz .W_240
.A_239:
    buffer_load_dwordx4 v[192:195], v243, s[8:11], s32 offen offset:0 sc1
    buffer_load_dwordx4 v[196:199], v243, s[8:11], s32 offen offset:1024 sc1
    s_waitcnt vmcnt(6)
    v_max_u32 v4, v200, v204
    v_cmp_eq_u32 vcc, -1, v4
    s_cbranch_vccz .W_327
.A_328:
    buffer_load_dwordx4 v[200:203], v252, s[8:11], s32 offen offset:0 sc1
    buffer_load_dwordx4 v[204:207], v252, s[8:11], s32 offen offset:1024 sc1
    s_waitcnt vmcnt(6)
    v_max_u32 v4, v208, v212
    v_cmp_eq_u32 vcc, -1, v4
    s_cbranch_vccz .W_329
.A_330:
    buffer_load_dwordx4 v[208:211], v254, s[8:11], s32 offen offset:0 sc1
    buffer_load_dwordx4 v[212:215], v254, s[8:11], s32 offen offset:1024 sc1
    s_waitcnt vmcnt(6)
    v_max_u32 v4, v216, v220
    v_cmp_eq_u32 vcc, -1, v4
    s_cbranch_vccnz .A_326
.W_331:
    v_smfmac_f32_16x16x64_bf16 v[76:79], v[216:219], v[140:147], v9
    s_waitcnt vmcnt(4)
    v_max_u32 v4, v192, v196
    v_cmp_eq_u32 vcc, -1, v4
    v_smfmac_f32_16x16x64_bf16 v[80:83], v[216:219], v[172:179], v9
    v_smfmac_f32_16x16x64_bf16 v[76:79], v[220:223], v[148:155], v9
    v_smfmac_f32_16x16x64_bf16 v[80:83], v[220:223], v[180:187], v9
    s_cbranch_vccnz .A_332
.W_333:
    v_smfmac_f32_16x16x64_bf16 v[76:79], v[192:195], a[192:199], v9
    s_waitcnt vmcnt(2)
    v_max_u32 v4, v200, v204
    v_cmp_eq_u32 vcc, -1, v4
    v_smfmac_f32_16x16x64_bf16 v[80:83], v[192:195], a[224:231], v9
    v_smfmac_f32_16x16x64_bf16 v[76:79], v[196:199], a[200:207], v9
    v_smfmac_f32_16x16x64_bf16 v[80:83], v[196:199], a[232:239], v9
    s_cbranch_vccnz .A_334
.W_335:
    v_smfmac_f32_16x16x64_bf16 v[76:79], v[200:203], a[208:215], v9
    s_waitcnt vmcnt(0)
    v_max_u32 v4, v208, v212
    v_cmp_eq_u32 vcc, -1, v4
    v_smfmac_f32_16x16x64_bf16 v[80:83], v[200:203], a[240:247], v9
    v_smfmac_f32_16x16x64_bf16 v[76:79], v[204:207], a[216:223], v9
    v_smfmac_f32_16x16x64_bf16 v[80:83], v[204:207], a[248:255], v9
    s_cbranch_vccnz .A_336
.W_337:
    s_barrier
    v_smfmac_f32_16x16x64_bf16 v[76:79], v[208:211], v[124:131], v9
    v_smfmac_f32_16x16x64_bf16 v[80:83], v[208:211], v[156:163], v9
    v_smfmac_f32_16x16x64_bf16 v[76:79], v[212:215], v[132:139], v9
    v_smfmac_f32_16x16x64_bf16 v[80:83], v[212:215], v[164:171], v9
    s_branch .mj_238
.W_327:
    v_smfmac_f32_16x16x64_bf16 v[76:79], v[200:203], a[208:215], v9
    s_waitcnt vmcnt(4)
    v_max_u32 v4, v208, v212
    v_cmp_eq_u32 vcc, -1, v4
    v_smfmac_f32_16x16x64_bf16 v[80:83], v[200:203], a[240:247], v9
    v_smfmac_f32_16x16x64_bf16 v[76:79], v[204:207], a[216:223], v9
    v_smfmac_f32_16x16x64_bf16 v[80:83], v[204:207], a[248:255], v9
    s_cbranch_vccnz .A_338
.W_339:
    v_smfmac_f32_16x16x64_bf16 v[76:79], v[208:211], v[124:131], v9
    s_waitcnt vmcnt(2)
    v_max_u32 v4, v216, v220
    v_cmp_eq_u32 vcc, -1, v4
    v_smfmac_f32_16x16x64_bf16 v[80:83], v[208:211], v[156:163], v9
    v_smfmac_f32_16x16x64_bf16 v[76:79], v[212:215], v[132:139], v9
    v_smfmac_f32_16x16x64_bf16 v[80:83], v[212:215], v[164:171], v9
    s_cbranch_vccnz .A_340
.W_341:
    v_smfmac_f32_16x16x64_bf16 v[76:79], v[216:219], v[140:147], v9
    s_waitcnt vmcnt(0)
    v_max_u32 v4, v192, v196
    v_cmp_eq_u32 vcc, -1, v4
    v_smfmac_f32_16x16x64_bf16 v[80:83], v[216:219], v[172:179], v9
    v_smfmac_f32_16x16x64_bf16 v[76:79], v[220:223], v[148:155], v9
    v_smfmac_f32_16x16x64_bf16 v[80:83], v[220:223], v[180:187], v9
    s_cbranch_vccnz .A_342
.W_343:
    s_barrier
    v_smfmac_f32_16x16x64_bf16 v[76:79], v[192:195], a[192:199], v9
    v_smfmac_f32_16x16x64_bf16 v[80:83], v[192:195], a[224:231], v9
    v_smfmac_f32_16x16x64_bf16 v[76:79], v[196:199], a[200:207], v9
    v_smfmac_f32_16x16x64_bf16 v[80:83], v[196:199], a[232:239], v9
    s_branch .mj_238
.W_329:
    v_smfmac_f32_16x16x64_bf16 v[76:79], v[208:211], v[124:131], v9
    s_waitcnt vmcnt(4)
    v_max_u32 v4, v216, v220
    v_cmp_eq_u32 vcc, -1, v4
    v_smfmac_f32_16x16x64_bf16 v[80:83], v[208:211], v[156:163], v9
    v_smfmac_f32_16x16x64_bf16 v[76:79], v[212:215], v[132:139], v9
    v_smfmac_f32_16x16x64_bf16 v[80:83], v[212:215], v[164:171], v9
    s_cbranch_vccnz .A_344
.W_345:
    v_smfmac_f32_16x16x64_bf16 v[76:79], v[216:219], v[140:147], v9
    s_waitcnt vmcnt(2)
    v_max_u32 v4, v192, v196
    v_cmp_eq_u32 vcc, -1, v4
    v_smfmac_f32_16x16x64_bf16 v[80:83], v[216:219], v[172:179], v9
    v_smfmac_f32_16x16x64_bf16 v[76:79], v[220:223], v[148:155], v9
    v_smfmac_f32_16x16x64_bf16 v[80:83], v[220:223], v[180:187], v9
    s_cbranch_vccnz .A_346
.W_347:
    v_smfmac_f32_16x16x64_bf16 v[76:79], v[192:195], a[192:199], v9
    s_waitcnt vmcnt(0)
    v_max_u32 v4, v200, v204
    v_cmp_eq_u32 vcc, -1, v4
    v_smfmac_f32_16x16x64_bf16 v[80:83], v[192:195], a[224:231], v9
    v_smfmac_f32_16x16x64_bf16 v[76:79], v[196:199], a[200:207], v9
    v_smfmac_f32_16x16x64_bf16 v[80:83], v[196:199], a[232:239], v9
    s_cbranch_vccnz .A_348
.W_349:
    s_barrier
    v_smfmac_f32_16x16x64_bf16 v[76:79], v[200:203], a[208:215], v9
    v_smfmac_f32_16x16x64_bf16 v[80:83], v[200:203], a[240:247], v9
    v_smfmac_f32_16x16x64_bf16 v[76:79], v[204:207], a[216:223], v9
    v_smfmac_f32_16x16x64_bf16 v[80:83], v[204:207], a[248:255], v9
    s_branch .mj_238
.A_350:
    buffer_load_dwordx4 v[208:211], v254, s[8:11], s32 offen offset:0 sc1
    buffer_load_dwordx4 v[212:215], v254, s[8:11], s32 offen offset:1024 sc1
    s_sub_u32 s62, s62, 1
    s_cbranch_scc1 .mg_end_1
    s_waitcnt vmcnt(4)
    v_max_u32 v4, v192, v196
    v_cmp_eq_u32 vcc, -1, v4
    s_cbranch_vccz .W_333
.A_332:
    buffer_load_dwordx4 v[192:195], v243, s[8:11], s32 offen offset:0 sc1
    buffer_load_dwordx4 v[196:199], v243, s[8:11], s32 offen offset:1024 sc1
    s_waitcnt vmcnt(4)
    v_max_u32 v4, v200, v204
    v_cmp_eq_u32 vcc, -1, v4
    s_cbranch_vccz .W_351
.A_352:
    buffer_load_dwordx4 v[200:203], v252, s[8:11], s32 offen offset:0 sc1
    buffer_load_dwordx4 v[204:207], v252, s[8:11], s32 offen offset:1024 sc1
    s_waitcnt vmcnt(4)
    v_max_u32 v4, v208, v212
    v_cmp_eq_u32 vcc, -1, v4
    s_cbranch_vccnz .A_350
.W_353:
    v_smfmac_f32_16x16x64_bf16 v[76:79], v[208:211], v[124:131], v9
    s_waitcnt vmcnt(2)
    v_max_u32 v4, v192, v196
    v_cmp_eq_u32 vcc, -1, v4
    v_smfmac_f32_16x16x64_bf16 v[80:83], v[208:211], v[156:163], v9
    v_smfmac_f32_16x16x64_bf16 v[76:79], v[212:215], v[132:139], v9
    v_smfmac_f32_16x16x64_bf16 v[80:83], v[212:215], v[164:171], v9
    s_cbranch_vccz .W_347
    s_branch .A_346
.W_351:
    v_smfmac_f32_16x16x64_bf16 v[76:79], v[200:203], a[208:215], v9
    s_waitcnt vmcnt(2)
    v_max_u32 v4, v208, v212
    v_cmp_eq_u32 vcc, -1, v4
    v_smfmac_f32_16x16x64_bf16 v[80:83], v[200:203], a[240:247], v9
    v_smfmac_f32_16x16x64_bf16 v[76:79], v[204:207], a[216:223], v9
    v_smfmac_f32_16x16x64_bf16 v[80:83], v[204:207], a[248:255], v9
    s_cbranch_vccnz .A_354
.W_355:
    v_smfmac_f32_16x16x64_bf16 v[76:79], v[208:211], v[124:131], v9
    s_waitcnt vmcnt(0)
    v_max_u32 v4, v192, v196
    v_cmp_eq_u32 vcc, -1, v4
    v_smfmac_f32_16x16x64_bf16 v[80:83], v[208:211], v[156:163], v9
    v_smfmac_f32_16x16x64_bf16 v[76:79], v[212:215], v[132:139], v9
    v_smfmac_f32_16x16x64_bf16 v[80:83], v[212:215], v[164:171], v9
    s_cbranch_vccz .W_343
    s_branch .A_342
.A_356:
    buffer_load_dwordx4 v[200:203], v252, s[8:11], s32 offen offset:0 sc1
    buffer_load_dwordx4 v[204:207], v252, s[8:11], s32 offen offset:1024 sc1
    s_sub_u32 s62, s62, 1
    s_cbranch_scc1 .mg_end_1
    s_waitcnt vmcnt(4)
    v_max_u32 v4, v216, v220
    v_cmp_eq_u32 vcc, -1, v4
    s_cbranch_vccz .W_345
.A_344:
    buffer_load_dwordx4 v[216:219], v246, s[8:11], s32 offen offset:0 sc1
    buffer_load_dwordx4 v[220:223], v246, s[8:11], s32 offen offset:1024 sc1
    s_waitcnt vmcnt(4)
    v_max_u32 v4, v192, v196
    v_cmp_eq_u32 vcc, -1, v4
    s_cbranch_vccz .W_357
.A_358:
    buffer_load_dwordx4 v[192:195], v243, s[8:11], s32 offen offset:0 sc1
    buffer_load_dwordx4 v[196:199], v243, s[8:11], s32 offen offset:1024 sc1
    s_waitcnt vmcnt(4)
    v_max_u32 v4, v200, v204
    v_cmp_eq_u32 vcc, -1, v4
    s_cbranch_vccnz .A_356
.W_359:
    v_smfmac_f32_16x16x64_bf16 v[76:79], v[200:203], a[208:215], v9
    s_waitcnt vmcnt(2)
    v_max_u32 v4, v216, v220
    v_cmp_eq_u32 vcc, -1, v4
    v_smfmac_f32_16x16x64_bf16 v[80:83], v[200:203], a[240:247], v9
    v_smfmac_f32_16x16x64_bf16 v[76:79], v[204:207], a[216:223], v9
    v_smfmac_f32_16x16x64_bf16 v[80:83], v[204:207], a[248:255], v9
    s_cbranch_vccz .W_341
    s_branch .A_340
.W_357:
    v_smfmac_f32_16x16x64_bf16 v[76:79], v[192:195], a[192:199], v9
    s_waitcnt vmcnt(2)
    v_max_u32 v4, v200, v204
    v_cmp_eq_u32 vcc, -1, v4
    v_smfmac_f32_16x16x64_bf16 v[80:83], v[192:195], a[224:231], v9
    v_smfmac_f32_16x16x64_bf16 v[76:79], v[196:199], a[200:207], v9
    v_smfmac_f32_16x16x64_bf16 v[80:83], v[196:199], a[232:239], v9
    s_cbranch_vccnz .A_360
.W_361:
    v_smfmac_f32_16x16x64_bf16 v[76:79], v[200:203], a[208:215], v9
    s_waitcnt vmcnt(0)
    v_max_u32 v4, v216, v220
    v_cmp_eq_u32 vcc, -1, v4
    v_smfmac_f32_16x16x64_bf16 v[80:83], v[200:203], a[240:247], v9
    v_smfmac_f32_16x16x64_bf16 v[76:79], v[204:207], a[216:223], v9
    v_smfmac_f32_16x16x64_bf16 v[80:83], v[204:207], a[248:255], v9
    s_cbranch_vccz .W_246
    s_branch .A_245
.A_362:
    buffer_load_dwordx4 v[216:219], v246, s[8:11], s32 offen offset:0 sc1
    buffer_load_dwordx4 v[220:223], v246, s[8:11], s32 offen offset:1024 sc1
    s_sub_u32 s62, s62, 1
    s_cbranch_scc1 .mg_end_1
    s_waitcnt vmcnt(4)
    v_max_u32 v4, v192, v196
    v_cmp_eq_u32 vcc, -1, v4
    s_cbranch_vccz .W_363
.A_364:
    buffer_load_dwordx4 v[192:195], v243, s[8:11], s32 offen offset:0 sc1
    buffer_load_dwordx4 v[196:199], v243, s[8:11], s32 offen offset:1024 sc1
    s_waitcnt vmcnt(4)
    v_max_u32 v4, v208, v212
    v_cmp_eq_u32 vcc, -1, v4
    s_cbranch_vccz .W_339
.A_338:
    buffer_load_dwordx4 v[208:211], v254, s[8:11], s32 offen offset:0 sc1
    buffer_load_dwordx4 v[212:215], v254, s[8:11], s32 offen offset:1024 sc1
    s_waitcnt vmcnt(4)
    v_max_u32 v4, v216, v220
    v_cmp_eq_u32 vcc, -1, v4
    s_cbranch_vccnz .A_362
.W_365:
    v_smfmac_f32_16x16x64_bf16 v[76:79], v[216:219], v[140:147], v9
    s_waitcnt vmcnt(2)
    v_max_u32 v4, v192, v196
    v_cmp_eq_u32 vcc, -1, v4
    v_smfmac_f32_16x16x64_bf16 v[80:83], v[216:219], v[172:179], v9
    v_smfmac_f32_16x16x64_bf16 v[76:79], v[220:223], v[148:155], v9
    v_smfmac_f32_16x16x64_bf16 v[80:83], v[220:223], v[180:187], v9
    s_cbranch_vccnz .A_366
.W_367:
    v_smfmac_f32_16x16x64_bf16 v[76:79], v[192:195], a[192:199], v9
    s_waitcnt vmcnt(0)
    v_max_u32 v4, v208, v212
    v_cmp_eq_u32 vcc, -1, v4
    v_smfmac_f32_16x16x64_bf16 v[80:83], v[192:195], a[224:231], v9
    v_smfmac_f32_16x16x64_bf16 v[76:79], v[196:199], a[200:207], v9
    v_smfmac_f32_16x16x64_bf16 v[80:83], v[196:199], a[232:239], v9
    s_cbranch_vccz .W_337
    s_branch .A_336
.W_363:
    v_smfmac_f32_16x16x64_bf16 v[76:79], v[192:195], a[192:199], v9
    s_waitcnt vmcnt(2)
    v_max_u32 v4, v208, v212
    v_cmp_eq_u32 vcc, -1, v4
    v_smfmac_f32_16x16x64_bf16 v[80:83], v[192:195], a[224:231], v9
    v_smfmac_f32_16x16x64_bf16 v[76:79], v[196:199], a[200:207], v9
    v_smfmac_f32_16x16x64_bf16 v[80:83], v[196:199], a[232:239], v9
    s_cbranch_vccz .W_244
    s_branch .A_243
.A_368:
    buffer_load_dwordx4 v[216:219], v246, s[8:11], s32 offen offset:0 sc1
    buffer_load_dwordx4 v[220:223], v246, s[8:11], s32 offen offset:1024 sc1
    s_sub_u32 s62, s62, 1
    s_cbranch_scc1 .mg_end_1
    s_waitcnt vmcnt(4)
    v_max_u32 v4, v200, v204
    v_cmp_eq_u32 vcc, -1, v4
    s_cbranch_vccz .W_242
.A_241:
    buffer_load_dwordx4 v[200:203], v252, s[8:11], s32 offen offset:0 sc1
    buffer_load_dwordx4 v[204:207], v252, s[8:11], s32 offen offset:1024 sc1
    s_waitcnt vmcnt(4)
    v_max_u32 v4, v208, v212
    v_cmp_eq_u32 vcc, -1, v4
    s_cbranch_vccz .W_369
.A_370:
    buffer_load_dwordx4 v[208:211], v254, s[8:11], s32 offen offset:0 sc1
    buffer_load_dwordx4 v[212:215], v254, s[8:11], s32 offen offset:1024 sc1
    s_waitcnt vmcnt(4)
    v_max_u32 v4, v216, v220
    v_cmp_eq_u32 vcc, -1, v4
    s_cbranch_vccnz .A_368
.W_371:
    v_smfmac_f32_16x16x64_bf16 v[76:79], v[216:219], v[140:147], v9
    s_waitcnt vmcnt(2)
    v_max_u32 v4, v200, v204
    v_cmp_eq_u32 vcc, -1, v4
    v_smfmac_f32_16x16x64_bf16 v[80:83], v[216:219], v[172:179], v9
    v_smfmac_f32_16x16x64_bf16 v[76:79], v[220:223], v[148:155], v9
    v_smfmac_f32_16x16x64_bf16 v[80:83], v[220:223], v[180:187], v9
    s_cbranch_vccz .W_335
    s_branch .A_334
.W_369:
    v_smfmac_f32_16x16x64_bf16 v[76:79], v[208:211], v[124:131], v9
    s_waitcnt vmcnt(2)
    v_max_u32 v4, v216, v220
    v_cmp_eq_u32 vcc, -1, v4
    v_smfmac_f32_16x16x64_bf16 v[80:83], v[208:211], v[156:163], v9
    v_smfmac_f32_16x16x64_bf16 v[76:79], v[212:215], v[132:139], v9
    v_smfmac_f32_16x16x64_bf16 v[80:83], v[212:215], v[164:171], v9
    s_cbranch_vccnz .A_372
.W_373:
    v_smfmac_f32_16x16x64_bf16 v[76:79], v[216:219], v[140:147], v9
    s_waitcnt vmcnt(0)
    v_max_u32 v4, v200, v204
    v_cmp_eq_u32 vcc, -1, v4
    v_smfmac_f32_16x16x64_bf16 v[80:83], v[216:219], v[172:179], v9
    v_smfmac_f32_16x16x64_bf16 v[76:79], v[220:223], v[148:155], v9
    v_smfmac_f32_16x16x64_bf16 v[80:83], v[220:223], v[180:187], v9
    s_cbranch_vccz .W_349
    s_branch .A_348
.A_374:
    buffer_load_dwordx4 v[200:203], v252, s[8:11], s32 offen offset:0 sc1
    buffer_load_dwordx4 v[204:207], v252, s[8:11], s32 offen offset:1024 sc1
    s_sub_u32 s62, s62, 1
    s_cbranch_scc1 .mg_end_1
    s_waitcnt vmcnt(2)
    v_max_u32 v4, v192, v196
    v_cmp_eq_u32 vcc, -1, v4
    s_cbranch_vccz .W_347
.A_346:
    buffer_load_dwordx4 v[192:195], v243, s[8:11], s32 offen offset:0 sc1
    buffer_load_dwordx4 v[196:199], v243, s[8:11], s32 offen offset:1024 sc1
    s_waitcnt vmcnt(2)
    v_max_u32 v4, v200, v204
    v_cmp_eq_u32 vcc, -1, v4
    s_cbranch_vccnz .A_374
.W_375:
    v_smfmac_f32_16x16x64_bf16 v[76:79], v[200:203], a[208:215], v9
    s_waitcnt vmcnt(0)
    v_max_u32 v4, v192, v196
    v_cmp_eq_u32 vcc, -1, v4
    v_smfmac_f32_16x16x64_bf16 v[80:83], v[200:203], a[240:247], v9
    v_smfmac_f32_16x16x64_bf16 v[76:79], v[204:207], a[216:223], v9
    v_smfmac_f32_16x16x64_bf16 v[80:83], v[204:207], a[248:255], v9
    s_cbranch_vccz .W_343
    s_branch .A_342
.A_354:
    buffer_load_dwordx4 v[208:211], v254, s[8:11], s32 offen offset:0 sc1
    buffer_load_dwordx4 v[212:215], v254, s[8:11], s32 offen offset:1024 sc1
    s_sub_u32 s62, s62, 1
    s_cbranch_scc1 .mg_end_1
    s_waitcnt vmcnt(2)
    v_max_u32 v4, v192, v196
    v_cmp_eq_u32 vcc, -1, v4
    s_cbranch_vccz .W_367
.A_366:
    buffer_load_dwordx4 v[192:195], v243, s[8:11], s32 offen offset:0 sc1
    buffer_load_dwordx4 v[196:199], v243, s[8:11], s32 offen offset:1024 sc1
    s_waitcnt vmcnt(2)
    v_max_u32 v4, v208, v212
    v_cmp_eq_u32 vcc, -1, v4
    s_cbranch_vccnz .A_354
    s_branch .W_355
.A_376:
    buffer_load_dwordx4 v[192:195], v243, s[8:11], s32 offen offset:0 sc1
    buffer_load_dwordx4 v[196:199], v243, s[8:11], s32 offen offset:1024 sc1
    s_sub_u32 s62, s62, 1
    s_cbranch_scc1 .mg_end_1
    s_waitcnt vmcnt(2)
    v_max_u32 v4, v216, v220
    v_cmp_eq_u32 vcc, -1, v4
    s_cbranch_vccz .W_341
.A_340:
    buffer_load_dwordx4 v[216:219], v246, s[8:11], s32 offen offset:0 sc1
    buffer_load_dwordx4 v[220:223], v246, s[8:11], s32 offen offset:1024 sc1
    s_waitcnt vmcnt(2)
    v_max_u32 v4, v192, v196
    v_cmp_eq_u32 vcc, -1, v4
    s_cbranch_vccnz .A_376
.W_377:
    v_smfmac_f32_16x16x64_bf16 v[76:79], v[192:195], a[192:199], v9
    s_waitcnt vmcnt(0)
    v_max_u32 v4, v216, v220
    v_cmp_eq_u32 vcc, -1, v4
    v_smfmac_f32_16x16x64_bf16 v[80:83], v[192:195], a[224:231], v9
    v_smfmac_f32_16x16x64_bf16 v[76:79], v[196:199], a[200:207], v9
    v_smfmac_f32_16x16x64_bf16 v[80:83], v[196:199], a[232:239], v9
    s_cbranch_vccz .W_246
    s_branch .A_245
.A_378:
    buffer_load_dwordx4 v[208:211], v254, s[8:11], s32 offen offset:0 sc1
    buffer_load_dwordx4 v[212:215], v254, s[8:11], s32 offen offset:1024 sc1
    s_sub_u32 s62, s62, 1
    s_cbranch_scc1 .mg_end_1
    s_waitcnt vmcnt(2)
    v_max_u32 v4, v200, v204
    v_cmp_eq_u32 vcc, -1, v4
    s_cbranch_vccz .W_335
.A_334:
    buffer_load_dwordx4 v[200:203], v252, s[8:11], s32 offen offset:0 sc1
    buffer_load_dwordx4 v[204:207], v252, s[8:11], s32 offen offset:1024 sc1
    s_waitcnt vmcnt(2)
    v_max_u32 v4, v208, v212
    v_cmp_eq_u32 vcc, -1, v4
    s_cbranch_vccnz .A_378
.W_379:
    v_smfmac_f32_16x16x64_bf16 v[76:79], v[208:211], v[124:131], v9
    s_waitcnt vmcnt(0)
    v_max_u32 v4, v200, v204
    v_cmp_eq_u32 vcc, -1, v4
    v_smfmac_f32_16x16x64_bf16 v[80:83], v[208:211], v[156:163], v9
    v_smfmac_f32_16x16x64_bf16 v[76:79], v[212:215], v[132:139], v9
    v_smfmac_f32_16x16x64_bf16 v[80:83], v[212:215], v[164:171], v9
    s_cbranch_vccz .W_349
    s_branch .A_348
.A_372:
    buffer_load_dwordx4 v[216:219], v246, s[8:11], s32 offen offset:0 sc1
    buffer_load_dwordx4 v[220:223], v246, s[8:11], s32 offen offset:1024 sc1
    s_sub_u32 s62, s62, 1
    s_cbranch_scc1 .mg_end_1
    s_waitcnt vmcnt(2)
    v_max_u32 v4, v200, v204
    v_cmp_eq_u32 vcc, -1, v4
    s_cbranch_vccz .W_361
.A_360:
    buffer_load_dwordx4 v[200:203], v252, s[8:11], s32 offen offset:0 sc1
    buffer_load_dwordx4 v[204:207], v252, s[8:11], s32 offen offset:1024 sc1
    s_waitcnt vmcnt(2)
    v_max_u32 v4, v216, v220
    v_cmp_eq_u32 vcc, -1, v4
    s_cbranch_vccnz .A_372
    s_branch .W_373
.A_380:
    buffer_load_dwordx4 v[216:219], v246, s[8:11], s32 offen offset:0 sc1
    buffer_load_dwordx4 v[220:223], v246, s[8:11], s32 offen offset:1024 sc1
    s_sub_u32 s62, s62, 1
    s_cbranch_scc1 .mg_end_1
    s_waitcnt vmcnt(2)
    v_max_u32 v4, v208, v212
    v_cmp_eq_u32 vcc, -1, v4
    s_cbranch_vccz .W_244
.A_243:
    buffer_load_dwordx4 v[208:211], v254, s[8:11], s32 offen offset:0 sc1
    buffer_load_dwordx4 v[212:215], v254, s[8:11], s32 offen offset:1024 sc1
    s_waitcnt vmcnt(2)
    v_max_u32 v4, v216, v220
    v_cmp_eq_u32 vcc, -1, v4
    s_cbranch_vccnz .A_380
.W_381:
    v_smfmac_f32_16x16x64_bf16 v[76:79], v[216:219], v[140:147], v9
    s_waitcnt vmcnt(0)
    v_max_u32 v4, v208, v212
    v_cmp_eq_u32 vcc, -1, v4
    v_smfmac_f32_16x16x64_bf16 v[80:83], v[216:219], v[172:179], v9
    v_smfmac_f32_16x16x64_bf16 v[76:79], v[220:223], v[148:155], v9
    v_smfmac_f32_16x16x64_bf16 v[80:83], v[220:223], v[180:187], v9
    s_cbranch_vccz .W_337
    s_branch .A_336
.A_342:
    buffer_load_dwordx4 v[192:195], v243, s[8:11], s32 offen offset:0 sc1
    buffer_load_dwordx4 v[196:199], v243, s[8:11], s32 offen offset:1024 sc1
    s_sub_u32 s62, s62, 1
    s_cbranch_scc1 .mg_end_1
    s_waitcnt vmcnt(2)
    v_max3_u32 v4, v192, v193, v194
    v_max3_u32 v5, v195, v196, v197
    v_max3_u32 v4, v4, v198, v199
    v_max_u32 v4, v4, v5
    v_cmp_eq_u32 vcc, -1, v4
    s_cbranch_vccnz .A_342
    s_barrier
    v_smfmac_f32_16x16x64_bf16 v[76:79], v[192:195], a[192:199], v9
    v_smfmac_f32_16x16x64_bf16 v[80:83], v[192:195], a[224:231], v9
    v_smfmac_f32_16x16x64_bf16 v[76:79], v[196:199], a[200:207], v9
    v_smfmac_f32_16x16x64_bf16 v[80:83], v[196:199], a[232:239], v9
    s_branch .mj_238
.A_348:
    buffer_load_dwordx4 v[200:203], v252, s[8:11], s32 offen offset:0 sc1
    buffer_load_dwordx4 v[204:207], v252, s[8:11], s32 offen offset:1024 sc1
    s_sub_u32 s62, s62, 1
    s_cbranch_scc1 .mg_end_1
    s_waitcnt vmcnt(2)
    v_max3_u32 v4, v200, v201, v202
    v_max3_u32 v5, v203, v204, v205
    v_max3_u32 v4, v4, v206, v207
    v_max_u32 v4, v4, v5
    v_cmp_eq_u32 vcc, -1, v4
    s_cbranch_vccnz .A_348
    s_barrier
    v_smfmac_f32_16x16x64_bf16 v[76:79], v[200:203], a[208:215], v9
    v_smfmac_f32_16x16x64_bf16 v[80:83], v[200:203], a[240:247], v9
    v_smfmac_f32_16x16x64_bf16 v[76:79], v[204:207], a[216:223], v9
    v_smfmac_f32_16x16x64_bf16 v[80:83], v[204:207], a[248:255], v9
    s_branch .mj_238
.A_336:
    buffer_load_dwordx4 v[208:211], v254, s[8:11], s32 offen offset:0 sc1
    buffer_load_dwordx4 v[212:215], v254, s[8:11], s32 offen offset:1024 sc1
    s_sub_u32 s62, s62, 1
    s_cbranch_scc1 .mg_end_1
    s_waitcnt vmcnt(2)
    v_max3_u32 v4, v208, v209, v210
    v_max3_u32 v5, v211, v212, v213
    v_max3_u32 v4, v4, v214, v215
    v_max_u32 v4, v4, v5
    v_cmp_eq_u32 vcc, -1, v4
    s_cbranch_vccnz .A_336
    s_barrier
    v_smfmac_f32_16x16x64_bf16 v[76:79], v[208:211], v[124:131], v9
    v_smfmac_f32_16x16x64_bf16 v[80:83], v[208:211], v[156:163], v9
    v_smfmac_f32_16x16x64_bf16 v[76:79], v[212:215], v[132:139], v9
    v_smfmac_f32_16x16x64_bf16 v[80:83], v[212:215], v[164:171], v9
    s_branch .mj_238
.A_245:
    buffer_load_dwordx4 v[216:219], v246, s[8:11], s32 offen offset:0 sc1
    buffer_load_dwordx4 v[220:223], v246, s[8:11], s32 offen offset:1024 sc1
    s_sub_u32 s62, s62, 1
    s_cbranch_scc1 .mg_end_1
    s_waitcnt vmcnt(2)
    v_max3_u32 v4, v216, v217, v218
    v_max3_u32 v5, v219, v220, v221
    v_max3_u32 v4, v4, v222, v223
    v_max_u32 v4, v4, v5
    v_cmp_eq_u32 vcc, -1, v4
    s_cbranch_vccnz .A_245
    s_barrier
    v_smfmac_f32_16x16x64_bf16 v[76:79], v[216:219], v[140:147], v9
    v_smfmac_f32_16x16x64_bf16 v[80:83], v[216:219], v[172:179], v9
    v_smfmac_f32_16x16x64_bf16 v[76:79], v[220:223], v[148:155], v9
    v_smfmac_f32_16x16x64_bf16 v[80:83], v[220:223], v[180:187], v9
    s_branch .mj_238
.sk_248:
    v_cndmask_b32 v172, v170, v168, s[60:61]
    v_cndmask_b32 v173, v171, v169, s[60:61]

    v_mov_b32 v174, v172
    v_mov_b32 v175, v173
    s_nop 0
    s_nop 0
    v_permlane16_swap_b32 v172, v174
    v_permlane16_swap_b32 v173, v175
    ds_write_b128 v14, v[172:175] offset:17408

    s_mov_b64 exec, s[66:67]
    buffer_store_dwordx4 v[88:91], v11, s[8:11], s36 offen sc1
    s_mov_b64 exec, s[56:57]
    buffer_store_dwordx4 v[172:175], v12, s[8:11], s36 offen sc1
    s_mov_b64 exec, -1

    s_cmp_lt_u32 s28, 63
    s_cbranch_scc1 .sb_249
    s_branch .rec_fin_6
.rec_fin_6:
    s_mov_b64 exec, -1
    s_endpgm
.mg_bg_2:
    s_sub_u32 s91, s25, 4
    s_lshl_b32 s90, s91, 5
    s_add_u32 s90, s90, s26
    s_cmp_ge_u32 s26, 24
    s_cbranch_scc1 .cvrole_382
    s_lshr_b32 s30, s26, 3
    s_sub_u32 s30, 2, s30
    s_and_b32 s31, s26, 7
    s_lshl_b32 s4, s91, 3
    s_add_u32 s31, s31, s4

    s_lshl_b32 s4, s30, 5
    s_add_u32 s4, s4, s31
    s_lshl_b32 s4, s4, 8
    s_add_u32 s4, s4, 92274688
    v_mov_b32 v4, 0
    s_mov_b64 exec, 1
    buffer_store_dword v4, v4, s[8:11], s4 offen sc1
    s_mov_b64 exec, -1

    s_load_dwordx2 s[40:41], s[0:1], 0
    s_load_dwordx4 s[44:47], s[0:1], 64
    s_load_dwordx2 s[42:43], s[0:1], 80

    v_and_b32 v1, 63, v0
    v_and_b32 v2, 15, v1
    v_lshrrev_b32 v3, 4, v1

    s_lshl_b32 s28, s31, 8
    s_waitcnt lgkmcnt(0)
    s_mov_b64 s[48:49], s[42:43]
    s_cmp_eq_u32 s30, 0
    s_cselect_b64 s[42:43], s[44:45], s[42:43]
    s_cmp_eq_u32 s30, 1
    s_cselect_b64 s[42:43], s[46:47], s[42:43]

    s_mov_b32 s16, s40
    s_and_b32 s17, s41, 0xffff
    s_mov_b32 s18, 0x400000
    s_mov_b32 s19, 0x00020000

    s_mov_b32 s12, s42
    s_and_b32 s13, s43, 0xffff
    s_mov_b32 s14, 0x800000
    s_mov_b32 s15, 0x00020000

    v_lshrrev_b32 v4, 1, v2
    v_xor_b32 v4, v4, v3
    v_lshlrev_b32 v4, 1, v4
    v_and_b32 v5, 1, v1
    v_or_b32 v4, v4, v5
    v_lshlrev_b32 v4, 4, v4
    v_lshlrev_b32 v5, 13, v3
    v_add_u32 v10, v4, v5
    v_xor_b32 v11, 0x80, v10
    s_lshl_b32 s4, s24, 18
    s_add_u32 s28, s28, s4
    s_lshl_b32 s29, s24, 13
    v_lshrrev_b32 v4, 2, v2
    v_and_b32 v5, 1, v3
    v_lshl_or_b32 v5, v5, 2, v4
    s_lshl_b32 s4, s24, 1
    v_xor_b32 v5, s4, v5
    v_lshlrev_b32 v5, 5, v5
    v_lshl_add_u32 v4, v3, 3, v4
    v_lshl_add_u32 v5, v4, 8, v5
    v_and_b32 v4, 3, v2
    v_lshl_add_u32 v12, v4, 3, v5
    v_xor_b32 v13, 32, v12
    v_add_u32 v14, 0x10000, v12
    v_add_u32 v15, 0x10000, v13

    s_mov_b32 s63, 0
    s_cmp_lg_u32 s30, 0
    s_cbranch_scc1 .qh_383
    s_cmp_lt_u32 s24, 2
    s_cselect_b64 s[48:49], s[46:47], s[48:49]

    s_mov_b32 s64, s48
    s_and_b32 s65, s49, 0xffff
    s_mov_b32 s66, 0x800000
    s_mov_b32 s67, 0x00020000

    v_lshlrev_b32 v4, 13, v1
    s_and_b32 s4, s24, 1
    s_lshl_b32 s4, s4, 7
    s_lshl_b32 s5, s31, 8
    s_add_u32 s4, s4, s5
    s_add_u32 s4, s4, 3145728
    s_waitcnt vmcnt(0)

    v_mov_b32 v243, s99
    v_mov_b32 v242, 0
    s_cmp_lg_u32 s24, 0
    s_cbranch_scc1 .a1_384
    v_mov_b32 v242, s26
    v_lshlrev_b32 v242, 6, v242
    v_add_u32 v242, s97, v242
    v_and_b32 v242, 255, v242
    s_mov_b64 exec, 1
    buffer_atomic_add v243, v242, s[20:23], 0 offen sc1
    s_mov_b64 exec, -1

.a1_384:
    buffer_load_dword v31, v4, s[64:67], s4 offen
    s_add_u32 s4, s4, 524288
    buffer_load_dword v31, v4, s[64:67], s4 offen
    s_add_u32 s4, s4, 524288
    buffer_load_dword v31, v4, s[64:67], s4 offen
    s_add_u32 s4, s4, 524288
    buffer_load_dword v31, v4, s[64:67], s4 offen
    s_add_u32 s4, s4, 524288
    buffer_load_dword v31, v4, s[64:67], s4 offen
    s_add_u32 s4, s4, 524288
    buffer_load_dword v31, v4, s[64:67], s4 offen
    s_add_u32 s4, s4, 524288
    buffer_load_dword v31, v4, s[64:67], s4 offen
    s_add_u32 s4, s4, 524288
    buffer_load_dword v31, v4, s[64:67], s4 offen
    s_add_u32 s4, s4, 524288
    buffer_load_dword v31, v4, s[64:67], s4 offen
    s_add_u32 s4, s4, 524288
    buffer_load_dword v31, v4, s[64:67], s4 offen
    s_add_u32 s4, s4, 524288
    s_waitcnt vmcnt(0)
    s_mov_b32 s63, 99
.qh_383:
    s_and_b32 s4, s26, 7
    s_lshl_b32 s4, s4, 1
    s_lshr_b32 s5, s24, 1
    s_add_u32 s4, s4, s5
    s_lshl_b32 s4, s4, 6
    v_add_u32 v4, s4, v1
    v_lshlrev_b32 v4, 13, v4
    s_and_b32 s4, s24, 1
    s_lshl_b32 s4, s4, 10
    s_lshl_b32 s5, s91, 11
    s_add_u32 s4, s4, s5
    buffer_load_dword v31, v4, s[12:15], s4 offen offset:384

    s_add_u32 m0, s29, 98304
    s_add_u32 s4, s28, 0
    buffer_load_dwordx4 v10, s[12:15], s4 offen lds

    s_add_u32 m0, s29, 99328
    s_add_u32 s4, s28, 32768
    buffer_load_dwordx4 v10, s[12:15], s4 offen lds

    s_add_u32 m0, s29, 100352
    s_add_u32 s4, s28, 65536
    buffer_load_dwordx4 v11, s[12:15], s4 offen lds

    s_add_u32 m0, s29, 101376
    s_add_u32 s4, s28, 98304
    buffer_load_dwordx4 v11, s[12:15], s4 offen lds

    s_add_u32 m0, s29, 102400
    s_add_u32 s4, s28, 131072
    buffer_load_dwordx4 v10, s[12:15], s4 offen lds

    s_add_u32 m0, s29, 103424
    s_add_u32 s4, s28, 163840
    buffer_load_dwordx4 v10, s[12:15], s4 offen lds

    s_add_u32 m0, s29, 104448
    s_add_u32 s4, s28, 196608
    buffer_load_dwordx4 v11, s[12:15], s4 offen lds

    s_add_u32 m0, s29, 105472
    s_add_u32 s4, s28, 229376
    buffer_load_dwordx4 v11, s[12:15], s4 offen lds

    s_waitcnt vmcnt(9)
    v_mov_b32 v243, s99
    v_mov_b32 v242, 0
    s_cmp_lg_u32 s24, s63
    s_cbranch_scc1 .a1_386
    v_mov_b32 v242, s26
    v_lshlrev_b32 v242, 6, v242
    v_add_u32 v242, s97, v242
    v_and_b32 v242, 255, v242
    s_mov_b64 exec, 1
    buffer_atomic_add v243, v242, s[20:23], 0 offen sc1
    s_mov_b64 exec, -1

.a1_386:
    v_lshrrev_b32 v4, 3, v1
    v_and_b32 v5, 7, v1
    v_xor_b32 v5, v5, v4
    v_lshlrev_b32 v5, 4, v5
    v_lshl_add_u32 v16, v4, 11, v5
    s_lshl_b32 s4, s24, 14
    v_add_u32 v16, s4, v16
    v_and_b32 v4, 7, v2
    v_xor_b32 v5, v4, v3
    v_lshlrev_b32 v5, 4, v5
    v_lshl_add_u32 v5, v4, 7, v5
    v_lshrrev_b32 v4, 3, v2
    v_lshl_add_u32 v17, v4, 13, v5
    v_xor_b32 v18, 64, v17
    v_add_u32 v19, 0x10000, v17
    v_add_u32 v20, 0x10000, v18
    v_lshlrev_b32 v21, 4, v1
    s_lshl_b32 s32, s30, 24
    s_lshl_b32 s4, s31, 13
    s_add_u32 s32, s32, s4
    s_lshr_b32 s5, s30, 1
    s_add_u32 s5, s5, 10
    s_lshl_b32 s4, s24, s5
    s_add_u32 s39, s32, s4
    s_mov_b32 s32, s39
    s_add_u32 s38, s39, 4096
    s_mul_i32 s49, s31, 6144
    s_lshl_b32 s4, s30, 11
    s_add_u32 s49, s49, s4
    s_lshl_b32 s4, s24, 9
    s_add_u32 s49, s49, s4
    s_add_u32 s49, s49, 67108864
    s_mov_b32 s48, s49
    v_mov_b32 v23, -1
    s_lshl_b32 s4, s30, 5
    s_add_u32 s4, s4, s31
    s_lshl_b32 s4, s4, 8
    s_add_u32 s33, s4, 92274688
    s_cmp_eq_u32 s24, 0
    s_cselect_b32 s36, 1, 0
    s_mov_b32 s37, 0
    v_mov_b32 v22, 0
    s_mov_b32 s34, 0
    s_mov_b32 s35, 0
    s_and_b32 s4, s26, 7
    s_lshl_b32 s4, s4, 2
    s_add_u32 s4, s4, s24
    s_lshl_b32 s4, s4, 11
    v_lshlrev_b32 v111, 5, v1
    v_add_u32 v111, s4, v111

    s_mul_i32 s47, s26, 1507328
    s_lshl_b32 s4, s24, 10
    s_add_u32 s47, s47, s4
    s_add_u32 s47, s47, 184549376
    v_mov_b32 v24, -1
    v_mov_b32 v25, -1
    v_mov_b32 v26, -1
    v_mov_b32 v27, -1

    s_xor_b32 s4, s91, 1
    s_lshl_b32 s5, s4, 14
    s_lshl_b32 s6, s91, 12
    s_add_u32 s5, s5, s6
    v_add_u32 v28, s5, v21
    s_lshl_b32 s5, s91, 14
    s_lshl_b32 s6, s4, 12
    s_add_u32 s5, s5, s6
    v_add_u32 v7, s5, v21

    s_xor_b32 s4, s91, 2
    s_lshl_b32 s5, s4, 14
    s_lshl_b32 s6, s91, 12
    s_add_u32 s5, s5, s6
    v_add_u32 v29, s5, v21
    s_lshl_b32 s5, s91, 14
    s_lshl_b32 s6, s4, 12
    s_add_u32 s5, s5, s6
    v_add_u32 v8, s5, v21

    s_xor_b32 s4, s91, 3
    s_lshl_b32 s5, s4, 14
    s_lshl_b32 s6, s91, 12
    s_add_u32 s5, s5, s6
    v_add_u32 v30, s5, v21
    s_lshl_b32 s5, s91, 14
    s_lshl_b32 s6, s4, 12
    s_add_u32 s5, s5, s6
    v_add_u32 v9, s5, v21

    s_mov_b64 s[44:45], -1
    s_mov_b32 s46, s47
    s_add_u32 s39, s39, 262144
    s_add_u32 s49, s49, 196608
    v_mov_b32 v23, 0
    v_add_u32 v113, 0x20000, v17
    v_add_u32 v114, 0x20000, v18
    s_barrier

    s_add_u32 m0, s29, 131072
    s_nop 0
    buffer_load_dwordx4 v16, s[16:19], s34 offen offset:0 lds
    s_add_u32 m0, s29, 131968
    s_nop 0
    buffer_load_dwordx4 v16, s[16:19], s34 offen offset:128 lds
    s_add_u32 m0, s29, 132864
    s_nop 0
    buffer_load_dwordx4 v16, s[16:19], s34 offen offset:256 lds
    s_add_u32 m0, s29, 133760
    s_nop 0
    buffer_load_dwordx4 v16, s[16:19], s34 offen offset:384 lds
    s_add_u32 m0, s29, 134656
    s_nop 0
    buffer_load_dwordx4 v16, s[16:19], s34 offen offset:512 lds
    s_add_u32 m0, s29, 135552
    s_nop 0
    buffer_load_dwordx4 v16, s[16:19], s34 offen offset:640 lds
    s_add_u32 m0, s29, 136448
    s_nop 0
    buffer_load_dwordx4 v16, s[16:19], s34 offen offset:768 lds
    s_add_u32 m0, s29, 137344
    s_nop 0
    buffer_load_dwordx4 v16, s[16:19], s34 offen offset:896 lds
    s_add_u32 s34, s34, 1024
    s_add_u32 m0, s29, 0
    s_add_u32 s4, s28, 1048576
    buffer_load_dwordx4 v10, s[12:15], s4 offen lds

    s_add_u32 m0, s29, 1024
    s_add_u32 s4, s28, 1081344
    buffer_load_dwordx4 v10, s[12:15], s4 offen lds

    s_add_u32 m0, s29, 2048
    s_add_u32 s4, s28, 1114112
    buffer_load_dwordx4 v11, s[12:15], s4 offen lds

    s_add_u32 m0, s29, 3072
    s_add_u32 s4, s28, 1146880
    buffer_load_dwordx4 v11, s[12:15], s4 offen lds

    s_add_u32 m0, s29, 4096
    s_add_u32 s4, s28, 1179648
    buffer_load_dwordx4 v10, s[12:15], s4 offen lds

    s_add_u32 m0, s29, 5120
    s_add_u32 s4, s28, 1212416
    buffer_load_dwordx4 v10, s[12:15], s4 offen lds

    s_add_u32 m0, s29, 6144
    s_add_u32 s4, s28, 1245184
    buffer_load_dwordx4 v11, s[12:15], s4 offen lds

    s_add_u32 m0, s29, 7168
    s_add_u32 s4, s28, 1277952
    buffer_load_dwordx4 v11, s[12:15], s4 offen lds

    s_add_u32 m0, s29, 65536
    s_add_u32 s4, s28, 2097152
    buffer_load_dwordx4 v10, s[12:15], s4 offen lds

    s_add_u32 m0, s29, 66560
    s_add_u32 s4, s28, 2129920
    buffer_load_dwordx4 v10, s[12:15], s4 offen lds

    s_add_u32 m0, s29, 67584
    s_add_u32 s4, s28, 2162688
    buffer_load_dwordx4 v11, s[12:15], s4 offen lds

    s_add_u32 m0, s29, 68608
    s_add_u32 s4, s28, 2195456
    buffer_load_dwordx4 v11, s[12:15], s4 offen lds

    s_add_u32 m0, s29, 69632
    s_add_u32 s4, s28, 2228224
    buffer_load_dwordx4 v10, s[12:15], s4 offen lds

    s_add_u32 m0, s29, 70656
    s_add_u32 s4, s28, 2260992
    buffer_load_dwordx4 v10, s[12:15], s4 offen lds

    s_add_u32 m0, s29, 71680
    s_add_u32 s4, s28, 2293760
    buffer_load_dwordx4 v11, s[12:15], s4 offen lds

    s_add_u32 m0, s29, 72704
    s_add_u32 s4, s28, 2326528
    buffer_load_dwordx4 v11, s[12:15], s4 offen lds

    s_waitcnt vmcnt(16)
    s_barrier
    ds_read_b64_tr_b16 a[0:1], v14 offset:32768
    ds_read_b64_tr_b16 a[2:3], v14 offset:33792
    ds_read_b64_tr_b16 a[4:5], v15 offset:32768
    ds_read_b64_tr_b16 a[6:7], v15 offset:33792
    ds_read_b64_tr_b16 a[8:9], v14 offset:40960
    ds_read_b64_tr_b16 a[10:11], v14 offset:41984
    ds_read_b64_tr_b16 a[12:13], v15 offset:40960
    ds_read_b64_tr_b16 a[14:15], v15 offset:41984
    ds_read_b64_tr_b16 a[16:17], v14 offset:49152
    ds_read_b64_tr_b16 a[18:19], v14 offset:50176
    ds_read_b64_tr_b16 a[20:21], v15 offset:49152
    ds_read_b64_tr_b16 a[22:23], v15 offset:50176
    ds_read_b64_tr_b16 a[24:25], v14 offset:57344
    ds_read_b64_tr_b16 a[26:27], v14 offset:58368
    ds_read_b64_tr_b16 a[28:29], v15 offset:57344
    ds_read_b64_tr_b16 a[30:31], v15 offset:58368
    ds_read_b128 v[32:35], v113 offset:0
    ds_read_b128 v[36:39], v113 offset:16384
    ds_read_b128 v[40:43], v114 offset:0
    ds_read_b128 v[44:47], v114 offset:16384
    ds_read_b128 v[48:51], v113 offset:1024
    ds_read_b128 v[52:55], v113 offset:17408
    ds_read_b128 v[56:59], v114 offset:1024
    ds_read_b128 v[60:63], v114 offset:17408
    s_waitcnt lgkmcnt(0)
    s_barrier
    s_add_u32 m0, s29, 98304
    s_add_u32 s4, s28, 3145728
    buffer_load_dwordx4 v10, s[12:15], s4 offen lds

    s_add_u32 m0, s29, 99328
    s_add_u32 s4, s28, 3178496
    buffer_load_dwordx4 v10, s[12:15], s4 offen lds

    s_add_u32 m0, s29, 100352
    s_add_u32 s4, s28, 3211264
    buffer_load_dwordx4 v11, s[12:15], s4 offen lds

    s_add_u32 m0, s29, 101376
    s_add_u32 s4, s28, 3244032
    buffer_load_dwordx4 v11, s[12:15], s4 offen lds

    s_add_u32 m0, s29, 102400
    s_add_u32 s4, s28, 3276800
    buffer_load_dwordx4 v10, s[12:15], s4 offen lds

    s_add_u32 m0, s29, 103424
    s_add_u32 s4, s28, 3309568
    buffer_load_dwordx4 v10, s[12:15], s4 offen lds

    s_add_u32 m0, s29, 104448
    s_add_u32 s4, s28, 3342336
    buffer_load_dwordx4 v11, s[12:15], s4 offen lds

    s_add_u32 m0, s29, 105472
    s_add_u32 s4, s28, 3375104
    buffer_load_dwordx4 v11, s[12:15], s4 offen lds

    s_add_u32 m0, s29, 32768
    s_nop 0
    buffer_load_dwordx4 v16, s[16:19], s34 offen offset:0 lds
    s_add_u32 m0, s29, 33664
    s_nop 0
    buffer_load_dwordx4 v16, s[16:19], s34 offen offset:128 lds
    s_add_u32 m0, s29, 34560
    s_nop 0
    buffer_load_dwordx4 v16, s[16:19], s34 offen offset:256 lds
    s_add_u32 m0, s29, 35456
    s_nop 0
    buffer_load_dwordx4 v16, s[16:19], s34 offen offset:384 lds
    s_add_u32 m0, s29, 36352
    s_nop 0
    buffer_load_dwordx4 v16, s[16:19], s34 offen offset:512 lds
    s_add_u32 m0, s29, 37248
    s_nop 0
    buffer_load_dwordx4 v16, s[16:19], s34 offen offset:640 lds
    s_add_u32 m0, s29, 38144
    s_nop 0
    buffer_load_dwordx4 v16, s[16:19], s34 offen offset:768 lds
    s_add_u32 m0, s29, 39040
    s_nop 0
    buffer_load_dwordx4 v16, s[16:19], s34 offen offset:896 lds
    s_add_u32 s34, s34, 64512
    s_min_u32 s34, s34, 4128768
    s_cmp_eq_u32 s30, 2
    s_cbranch_scc1 .s0v_390
    v_mfma_f32_16x16x32_bf16 v[64:67], a[0:3], v[32:35], 0
    v_mfma_f32_16x16x32_bf16 v[68:71], a[4:7], v[32:35], 0
    v_mfma_f32_16x16x32_bf16 v[72:75], a[0:3], v[36:39], 0
    v_mfma_f32_16x16x32_bf16 v[76:79], a[4:7], v[36:39], 0
    v_mfma_f32_16x16x32_bf16 v[64:67], a[8:11], v[40:43], v[64:67]
    v_mfma_f32_16x16x32_bf16 v[68:71], a[12:15], v[40:43], v[68:71]
    v_mfma_f32_16x16x32_bf16 v[72:75], a[8:11], v[44:47], v[72:75]
    v_mfma_f32_16x16x32_bf16 v[76:79], a[12:15], v[44:47], v[76:79]
    v_mfma_f32_16x16x32_bf16 v[64:67], a[16:19], v[48:51], v[64:67]
    v_mfma_f32_16x16x32_bf16 v[68:71], a[20:23], v[48:51], v[68:71]
    v_mfma_f32_16x16x32_bf16 v[72:75], a[16:19], v[52:55], v[72:75]
    v_mfma_f32_16x16x32_bf16 v[76:79], a[20:23], v[52:55], v[76:79]
    v_mfma_f32_16x16x32_bf16 v[64:67], a[24:27], v[56:59], v[64:67]
    v_mfma_f32_16x16x32_bf16 v[68:71], a[28:31], v[56:59], v[68:71]
    v_mfma_f32_16x16x32_bf16 v[72:75], a[24:27], v[60:63], v[72:75]
    v_mfma_f32_16x16x32_bf16 v[76:79], a[28:31], v[60:63], v[76:79]
    s_branch .s0j_391
.s0v_390:
    v_mfma_f32_16x16x32_bf16 v[64:67], v[32:35], a[0:3], 0
    v_mfma_f32_16x16x32_bf16 v[68:71], v[32:35], a[4:7], 0
    v_mfma_f32_16x16x32_bf16 v[72:75], v[36:39], a[0:3], 0
    v_mfma_f32_16x16x32_bf16 v[76:79], v[36:39], a[4:7], 0
    v_mfma_f32_16x16x32_bf16 v[64:67], v[40:43], a[8:11], v[64:67]
    v_mfma_f32_16x16x32_bf16 v[68:71], v[40:43], a[12:15], v[68:71]
    v_mfma_f32_16x16x32_bf16 v[72:75], v[44:47], a[8:11], v[72:75]
    v_mfma_f32_16x16x32_bf16 v[76:79], v[44:47], a[12:15], v[76:79]
    v_mfma_f32_16x16x32_bf16 v[64:67], v[48:51], a[16:19], v[64:67]
    v_mfma_f32_16x16x32_bf16 v[68:71], v[48:51], a[20:23], v[68:71]
    v_mfma_f32_16x16x32_bf16 v[72:75], v[52:55], a[16:19], v[72:75]
    v_mfma_f32_16x16x32_bf16 v[76:79], v[52:55], a[20:23], v[76:79]
    v_mfma_f32_16x16x32_bf16 v[64:67], v[56:59], a[24:27], v[64:67]
    v_mfma_f32_16x16x32_bf16 v[68:71], v[56:59], a[28:31], v[68:71]
    v_mfma_f32_16x16x32_bf16 v[72:75], v[60:63], a[24:27], v[72:75]
    v_mfma_f32_16x16x32_bf16 v[76:79], v[60:63], a[28:31], v[76:79]
.s0j_391:
    s_waitcnt vmcnt(24)
    s_barrier
    ds_read_b64_tr_b16 a[32:33], v12 offset:0
    ds_read_b64_tr_b16 a[34:35], v12 offset:1024
    ds_read_b64_tr_b16 a[36:37], v13 offset:0
    ds_read_b64_tr_b16 a[38:39], v13 offset:1024
    ds_read_b64_tr_b16 a[40:41], v12 offset:8192
    ds_read_b64_tr_b16 a[42:43], v12 offset:9216
    ds_read_b64_tr_b16 a[44:45], v13 offset:8192
    ds_read_b64_tr_b16 a[46:47], v13 offset:9216
    ds_read_b64_tr_b16 a[48:49], v12 offset:16384
    ds_read_b64_tr_b16 a[50:51], v12 offset:17408
    ds_read_b64_tr_b16 a[52:53], v13 offset:16384
    ds_read_b64_tr_b16 a[54:55], v13 offset:17408
    ds_read_b64_tr_b16 a[56:57], v12 offset:24576
    ds_read_b64_tr_b16 a[58:59], v12 offset:25600
    ds_read_b64_tr_b16 a[60:61], v13 offset:24576
    ds_read_b64_tr_b16 a[62:63], v13 offset:25600
    ds_read_b128 v[32:35], v113 offset:2048
    ds_read_b128 v[36:39], v113 offset:18432
    ds_read_b128 v[40:43], v114 offset:2048
    ds_read_b128 v[44:47], v114 offset:18432
    ds_read_b128 v[48:51], v113 offset:3072
    ds_read_b128 v[52:55], v113 offset:19456
    ds_read_b128 v[56:59], v114 offset:3072
    ds_read_b128 v[60:63], v114 offset:19456
    s_waitcnt lgkmcnt(0)
    s_barrier
    s_add_u32 m0, s29, 0
    s_add_u32 s4, s28, 4194304
    buffer_load_dwordx4 v10, s[12:15], s4 offen lds

    s_add_u32 m0, s29, 1024
    s_add_u32 s4, s28, 4227072
    buffer_load_dwordx4 v10, s[12:15], s4 offen lds

    s_add_u32 m0, s29, 2048
    s_add_u32 s4, s28, 4259840
    buffer_load_dwordx4 v11, s[12:15], s4 offen lds

    s_add_u32 m0, s29, 3072
    s_add_u32 s4, s28, 4292608
    buffer_load_dwordx4 v11, s[12:15], s4 offen lds

    s_add_u32 m0, s29, 4096
    s_add_u32 s4, s28, 4325376
    buffer_load_dwordx4 v10, s[12:15], s4 offen lds

    s_add_u32 m0, s29, 5120
    s_add_u32 s4, s28, 4358144
    buffer_load_dwordx4 v10, s[12:15], s4 offen lds

    s_add_u32 m0, s29, 6144
    s_add_u32 s4, s28, 4390912
    buffer_load_dwordx4 v11, s[12:15], s4 offen lds

    s_add_u32 m0, s29, 7168
    s_add_u32 s4, s28, 4423680
    buffer_load_dwordx4 v11, s[12:15], s4 offen lds

    s_cmp_eq_u32 s30, 2
    s_cbranch_scc1 .s0v_392
    v_mfma_f32_16x16x32_bf16 v[64:67], a[32:35], v[32:35], v[64:67]
    v_mfma_f32_16x16x32_bf16 v[68:71], a[36:39], v[32:35], v[68:71]
    v_mfma_f32_16x16x32_bf16 v[72:75], a[32:35], v[36:39], v[72:75]
    v_mfma_f32_16x16x32_bf16 v[76:79], a[36:39], v[36:39], v[76:79]
    v_mfma_f32_16x16x32_bf16 v[64:67], a[40:43], v[40:43], v[64:67]
    v_mfma_f32_16x16x32_bf16 v[68:71], a[44:47], v[40:43], v[68:71]
    v_mfma_f32_16x16x32_bf16 v[72:75], a[40:43], v[44:47], v[72:75]
    v_mfma_f32_16x16x32_bf16 v[76:79], a[44:47], v[44:47], v[76:79]
    v_mfma_f32_16x16x32_bf16 v[64:67], a[48:51], v[48:51], v[64:67]
    v_mfma_f32_16x16x32_bf16 v[68:71], a[52:55], v[48:51], v[68:71]
    v_mfma_f32_16x16x32_bf16 v[72:75], a[48:51], v[52:55], v[72:75]
    v_mfma_f32_16x16x32_bf16 v[76:79], a[52:55], v[52:55], v[76:79]
    v_mfma_f32_16x16x32_bf16 v[64:67], a[56:59], v[56:59], v[64:67]
    v_mfma_f32_16x16x32_bf16 v[68:71], a[60:63], v[56:59], v[68:71]
    v_mfma_f32_16x16x32_bf16 v[72:75], a[56:59], v[60:63], v[72:75]
    v_mfma_f32_16x16x32_bf16 v[76:79], a[60:63], v[60:63], v[76:79]
    s_branch .s0j_393
.s0v_392:
    v_mfma_f32_16x16x32_bf16 v[64:67], v[32:35], a[32:35], v[64:67]
    v_mfma_f32_16x16x32_bf16 v[68:71], v[32:35], a[36:39], v[68:71]
    v_mfma_f32_16x16x32_bf16 v[72:75], v[36:39], a[32:35], v[72:75]
    v_mfma_f32_16x16x32_bf16 v[76:79], v[36:39], a[36:39], v[76:79]
    v_mfma_f32_16x16x32_bf16 v[64:67], v[40:43], a[40:43], v[64:67]
    v_mfma_f32_16x16x32_bf16 v[68:71], v[40:43], a[44:47], v[68:71]
    v_mfma_f32_16x16x32_bf16 v[72:75], v[44:47], a[40:43], v[72:75]
    v_mfma_f32_16x16x32_bf16 v[76:79], v[44:47], a[44:47], v[76:79]
    v_mfma_f32_16x16x32_bf16 v[64:67], v[48:51], a[48:51], v[64:67]
    v_mfma_f32_16x16x32_bf16 v[68:71], v[48:51], a[52:55], v[68:71]
    v_mfma_f32_16x16x32_bf16 v[72:75], v[52:55], a[48:51], v[72:75]
    v_mfma_f32_16x16x32_bf16 v[76:79], v[52:55], a[52:55], v[76:79]
    v_mfma_f32_16x16x32_bf16 v[64:67], v[56:59], a[56:59], v[64:67]
    v_mfma_f32_16x16x32_bf16 v[68:71], v[56:59], a[60:63], v[68:71]
    v_mfma_f32_16x16x32_bf16 v[72:75], v[60:63], a[56:59], v[72:75]
    v_mfma_f32_16x16x32_bf16 v[76:79], v[60:63], a[60:63], v[76:79]
.s0j_393:
    s_waitcnt vmcnt(24)
    s_barrier
    ds_read_b64_tr_b16 a[64:65], v14 offset:0
    ds_read_b64_tr_b16 a[66:67], v14 offset:1024
    ds_read_b64_tr_b16 a[68:69], v15 offset:0
    ds_read_b64_tr_b16 a[70:71], v15 offset:1024
    ds_read_b64_tr_b16 a[72:73], v14 offset:8192
    ds_read_b64_tr_b16 a[74:75], v14 offset:9216
    ds_read_b64_tr_b16 a[76:77], v15 offset:8192
    ds_read_b64_tr_b16 a[78:79], v15 offset:9216
    ds_read_b64_tr_b16 a[80:81], v14 offset:16384
    ds_read_b64_tr_b16 a[82:83], v14 offset:17408
    ds_read_b64_tr_b16 a[84:85], v15 offset:16384
    ds_read_b64_tr_b16 a[86:87], v15 offset:17408
    ds_read_b64_tr_b16 a[88:89], v14 offset:24576
    ds_read_b64_tr_b16 a[90:91], v14 offset:25600
    ds_read_b64_tr_b16 a[92:93], v15 offset:24576
    ds_read_b64_tr_b16 a[94:95], v15 offset:25600
    ds_read_b128 v[32:35], v113 offset:4096
    ds_read_b128 v[36:39], v113 offset:20480
    ds_read_b128 v[40:43], v114 offset:4096
    ds_read_b128 v[44:47], v114 offset:20480
    ds_read_b128 v[48:51], v113 offset:5120
    ds_read_b128 v[52:55], v113 offset:21504
    ds_read_b128 v[56:59], v114 offset:5120
    ds_read_b128 v[60:63], v114 offset:21504
    s_waitcnt lgkmcnt(0)
    s_barrier
    s_add_u32 m0, s29, 65536
    s_add_u32 s4, s28, 5242880
    buffer_load_dwordx4 v10, s[12:15], s4 offen lds

    s_add_u32 m0, s29, 66560
    s_add_u32 s4, s28, 5275648
    buffer_load_dwordx4 v10, s[12:15], s4 offen lds

    s_add_u32 m0, s29, 67584
    s_add_u32 s4, s28, 5308416
    buffer_load_dwordx4 v11, s[12:15], s4 offen lds

    s_add_u32 m0, s29, 68608
    s_add_u32 s4, s28, 5341184
    buffer_load_dwordx4 v11, s[12:15], s4 offen lds

    s_add_u32 m0, s29, 69632
    s_add_u32 s4, s28, 5373952
    buffer_load_dwordx4 v10, s[12:15], s4 offen lds

    s_add_u32 m0, s29, 70656
    s_add_u32 s4, s28, 5406720
    buffer_load_dwordx4 v10, s[12:15], s4 offen lds

    s_add_u32 m0, s29, 71680
    s_add_u32 s4, s28, 5439488
    buffer_load_dwordx4 v11, s[12:15], s4 offen lds

    s_add_u32 m0, s29, 72704
    s_add_u32 s4, s28, 5472256
    buffer_load_dwordx4 v11, s[12:15], s4 offen lds

    s_cmp_eq_u32 s30, 2
    s_cbranch_scc1 .s0v_394
    v_mfma_f32_16x16x32_bf16 v[64:67], a[64:67], v[32:35], v[64:67]
    v_mfma_f32_16x16x32_bf16 v[68:71], a[68:71], v[32:35], v[68:71]
    v_mfma_f32_16x16x32_bf16 v[72:75], a[64:67], v[36:39], v[72:75]
    v_mfma_f32_16x16x32_bf16 v[76:79], a[68:71], v[36:39], v[76:79]
    v_mfma_f32_16x16x32_bf16 v[64:67], a[72:75], v[40:43], v[64:67]
    v_mfma_f32_16x16x32_bf16 v[68:71], a[76:79], v[40:43], v[68:71]
    v_mfma_f32_16x16x32_bf16 v[72:75], a[72:75], v[44:47], v[72:75]
    v_mfma_f32_16x16x32_bf16 v[76:79], a[76:79], v[44:47], v[76:79]
    v_mfma_f32_16x16x32_bf16 v[64:67], a[80:83], v[48:51], v[64:67]
    v_mfma_f32_16x16x32_bf16 v[68:71], a[84:87], v[48:51], v[68:71]
    v_mfma_f32_16x16x32_bf16 v[72:75], a[80:83], v[52:55], v[72:75]
    v_mfma_f32_16x16x32_bf16 v[76:79], a[84:87], v[52:55], v[76:79]
    v_mfma_f32_16x16x32_bf16 v[64:67], a[88:91], v[56:59], v[64:67]
    v_mfma_f32_16x16x32_bf16 v[68:71], a[92:95], v[56:59], v[68:71]
    v_mfma_f32_16x16x32_bf16 v[72:75], a[88:91], v[60:63], v[72:75]
    v_mfma_f32_16x16x32_bf16 v[76:79], a[92:95], v[60:63], v[76:79]
    s_branch .s0j_395
.s0v_394:
    v_mfma_f32_16x16x32_bf16 v[64:67], v[32:35], a[64:67], v[64:67]
    v_mfma_f32_16x16x32_bf16 v[68:71], v[32:35], a[68:71], v[68:71]
    v_mfma_f32_16x16x32_bf16 v[72:75], v[36:39], a[64:67], v[72:75]
    v_mfma_f32_16x16x32_bf16 v[76:79], v[36:39], a[68:71], v[76:79]
    v_mfma_f32_16x16x32_bf16 v[64:67], v[40:43], a[72:75], v[64:67]
    v_mfma_f32_16x16x32_bf16 v[68:71], v[40:43], a[76:79], v[68:71]
    v_mfma_f32_16x16x32_bf16 v[72:75], v[44:47], a[72:75], v[72:75]
    v_mfma_f32_16x16x32_bf16 v[76:79], v[44:47], a[76:79], v[76:79]
    v_mfma_f32_16x16x32_bf16 v[64:67], v[48:51], a[80:83], v[64:67]
    v_mfma_f32_16x16x32_bf16 v[68:71], v[48:51], a[84:87], v[68:71]
    v_mfma_f32_16x16x32_bf16 v[72:75], v[52:55], a[80:83], v[72:75]
    v_mfma_f32_16x16x32_bf16 v[76:79], v[52:55], a[84:87], v[76:79]
    v_mfma_f32_16x16x32_bf16 v[64:67], v[56:59], a[88:91], v[64:67]
    v_mfma_f32_16x16x32_bf16 v[68:71], v[56:59], a[92:95], v[68:71]
    v_mfma_f32_16x16x32_bf16 v[72:75], v[60:63], a[88:91], v[72:75]
    v_mfma_f32_16x16x32_bf16 v[76:79], v[60:63], a[92:95], v[76:79]
.s0j_395:
    s_waitcnt vmcnt(24)
    s_barrier
    ds_read_b64_tr_b16 a[96:97], v14 offset:32768
    ds_read_b64_tr_b16 a[98:99], v14 offset:33792
    ds_read_b64_tr_b16 a[100:101], v15 offset:32768
    ds_read_b64_tr_b16 a[102:103], v15 offset:33792
    ds_read_b64_tr_b16 a[104:105], v14 offset:40960
    ds_read_b64_tr_b16 a[106:107], v14 offset:41984
    ds_read_b64_tr_b16 a[108:109], v15 offset:40960
    ds_read_b64_tr_b16 a[110:111], v15 offset:41984
    ds_read_b64_tr_b16 a[112:113], v14 offset:49152
    ds_read_b64_tr_b16 a[114:115], v14 offset:50176
    ds_read_b64_tr_b16 a[116:117], v15 offset:49152
    ds_read_b64_tr_b16 a[118:119], v15 offset:50176
    ds_read_b64_tr_b16 a[120:121], v14 offset:57344
    ds_read_b64_tr_b16 a[122:123], v14 offset:58368
    ds_read_b64_tr_b16 a[124:125], v15 offset:57344
    ds_read_b64_tr_b16 a[126:127], v15 offset:58368
    ds_read_b128 v[32:35], v113 offset:6144
    ds_read_b128 v[36:39], v113 offset:22528
    ds_read_b128 v[40:43], v114 offset:6144
    ds_read_b128 v[44:47], v114 offset:22528
    ds_read_b128 v[48:51], v113 offset:7168
    ds_read_b128 v[52:55], v113 offset:23552
    ds_read_b128 v[56:59], v114 offset:7168
    ds_read_b128 v[60:63], v114 offset:23552
    s_waitcnt lgkmcnt(0)
    s_barrier
    s_add_u32 m0, s29, 98304
    s_add_u32 s4, s28, 6291456
    buffer_load_dwordx4 v10, s[12:15], s4 offen lds

    s_add_u32 m0, s29, 99328
    s_add_u32 s4, s28, 6324224
    buffer_load_dwordx4 v10, s[12:15], s4 offen lds

    s_add_u32 m0, s29, 100352
    s_add_u32 s4, s28, 6356992
    buffer_load_dwordx4 v11, s[12:15], s4 offen lds

    s_add_u32 m0, s29, 101376
    s_add_u32 s4, s28, 6389760
    buffer_load_dwordx4 v11, s[12:15], s4 offen lds

    s_add_u32 m0, s29, 102400
    s_add_u32 s4, s28, 6422528
    buffer_load_dwordx4 v10, s[12:15], s4 offen lds

    s_add_u32 m0, s29, 103424
    s_add_u32 s4, s28, 6455296
    buffer_load_dwordx4 v10, s[12:15], s4 offen lds

    s_add_u32 m0, s29, 104448
    s_add_u32 s4, s28, 6488064
    buffer_load_dwordx4 v11, s[12:15], s4 offen lds

    s_add_u32 m0, s29, 105472
    s_add_u32 s4, s28, 6520832
    buffer_load_dwordx4 v11, s[12:15], s4 offen lds

    v_and_b32 v241, 3, v0
    v_lshlrev_b32 v241, 2, v241

    v_and_b32 v240, 12, v0
    v_lshl_add_u32 v241, v240, 4, v241
    v_add_u32 v241, s97, v241
    v_and_b32 v241, 255, v241

    buffer_load_dword v240, v241, s[20:23], 0 offen sc1
    s_cmp_eq_u32 s30, 2
    s_cbranch_scc1 .s0v_396
    v_mfma_f32_16x16x32_bf16 v[64:67], a[96:99], v[32:35], v[64:67]
    v_mfma_f32_16x16x32_bf16 v[68:71], a[100:103], v[32:35], v[68:71]
    v_mfma_f32_16x16x32_bf16 v[72:75], a[96:99], v[36:39], v[72:75]
    v_mfma_f32_16x16x32_bf16 v[76:79], a[100:103], v[36:39], v[76:79]
    v_mfma_f32_16x16x32_bf16 v[64:67], a[104:107], v[40:43], v[64:67]
    v_mfma_f32_16x16x32_bf16 v[68:71], a[108:111], v[40:43], v[68:71]
    v_mfma_f32_16x16x32_bf16 v[72:75], a[104:107], v[44:47], v[72:75]
    v_mfma_f32_16x16x32_bf16 v[76:79], a[108:111], v[44:47], v[76:79]
    v_mfma_f32_16x16x32_bf16 v[64:67], a[112:115], v[48:51], v[64:67]
    v_mfma_f32_16x16x32_bf16 v[68:71], a[116:119], v[48:51], v[68:71]
    v_mfma_f32_16x16x32_bf16 v[72:75], a[112:115], v[52:55], v[72:75]
    v_mfma_f32_16x16x32_bf16 v[76:79], a[116:119], v[52:55], v[76:79]
    v_mfma_f32_16x16x32_bf16 v[64:67], a[120:123], v[56:59], v[64:67]
    v_mfma_f32_16x16x32_bf16 v[68:71], a[124:127], v[56:59], v[68:71]
    v_mfma_f32_16x16x32_bf16 v[72:75], a[120:123], v[60:63], v[72:75]
    v_mfma_f32_16x16x32_bf16 v[76:79], a[124:127], v[60:63], v[76:79]
    s_branch .s0j_397
.s0v_396:
    v_mfma_f32_16x16x32_bf16 v[64:67], v[32:35], a[96:99], v[64:67]
    v_mfma_f32_16x16x32_bf16 v[68:71], v[32:35], a[100:103], v[68:71]
    v_mfma_f32_16x16x32_bf16 v[72:75], v[36:39], a[96:99], v[72:75]
    v_mfma_f32_16x16x32_bf16 v[76:79], v[36:39], a[100:103], v[76:79]
    v_mfma_f32_16x16x32_bf16 v[64:67], v[40:43], a[104:107], v[64:67]
    v_mfma_f32_16x16x32_bf16 v[68:71], v[40:43], a[108:111], v[68:71]
    v_mfma_f32_16x16x32_bf16 v[72:75], v[44:47], a[104:107], v[72:75]
    v_mfma_f32_16x16x32_bf16 v[76:79], v[44:47], a[108:111], v[76:79]
    v_mfma_f32_16x16x32_bf16 v[64:67], v[48:51], a[112:115], v[64:67]
    v_mfma_f32_16x16x32_bf16 v[68:71], v[48:51], a[116:119], v[68:71]
    v_mfma_f32_16x16x32_bf16 v[72:75], v[52:55], a[112:115], v[72:75]
    v_mfma_f32_16x16x32_bf16 v[76:79], v[52:55], a[116:119], v[76:79]
    v_mfma_f32_16x16x32_bf16 v[64:67], v[56:59], a[120:123], v[64:67]
    v_mfma_f32_16x16x32_bf16 v[68:71], v[56:59], a[124:127], v[68:71]
    v_mfma_f32_16x16x32_bf16 v[72:75], v[60:63], a[120:123], v[72:75]
    v_mfma_f32_16x16x32_bf16 v[76:79], v[60:63], a[124:127], v[76:79]
.s0j_397:
    s_waitcnt vmcnt(17)
    s_barrier
    ds_read_b64_tr_b16 a[128:129], v12 offset:0
    ds_read_b64_tr_b16 a[130:131], v12 offset:1024
    ds_read_b64_tr_b16 a[132:133], v13 offset:0
    ds_read_b64_tr_b16 a[134:135], v13 offset:1024
    ds_read_b64_tr_b16 a[136:137], v12 offset:8192
    ds_read_b64_tr_b16 a[138:139], v12 offset:9216
    ds_read_b64_tr_b16 a[140:141], v13 offset:8192
    ds_read_b64_tr_b16 a[142:143], v13 offset:9216
    ds_read_b64_tr_b16 a[144:145], v12 offset:16384
    ds_read_b64_tr_b16 a[146:147], v12 offset:17408
    ds_read_b64_tr_b16 a[148:149], v13 offset:16384
    ds_read_b64_tr_b16 a[150:151], v13 offset:17408
    ds_read_b64_tr_b16 a[152:153], v12 offset:24576
    ds_read_b64_tr_b16 a[154:155], v12 offset:25600
    ds_read_b64_tr_b16 a[156:157], v13 offset:24576
    ds_read_b64_tr_b16 a[158:159], v13 offset:25600
    ds_read_b128 v[32:35], v17 offset:32768
    ds_read_b128 v[36:39], v17 offset:49152
    ds_read_b128 v[40:43], v18 offset:32768
    ds_read_b128 v[44:47], v18 offset:49152
    ds_read_b128 v[48:51], v17 offset:33792
    ds_read_b128 v[52:55], v17 offset:50176
    ds_read_b128 v[56:59], v18 offset:33792
    ds_read_b128 v[60:63], v18 offset:50176
    s_waitcnt lgkmcnt(0)
    s_barrier
    s_add_u32 m0, s29, 0
    s_add_u32 s4, s28, 7340032
    buffer_load_dwordx4 v10, s[12:15], s4 offen lds

    s_add_u32 m0, s29, 1024
    s_add_u32 s4, s28, 7372800
    buffer_load_dwordx4 v10, s[12:15], s4 offen lds

    s_add_u32 m0, s29, 2048
    s_add_u32 s4, s28, 7405568
    buffer_load_dwordx4 v11, s[12:15], s4 offen lds

    s_add_u32 m0, s29, 3072
    s_add_u32 s4, s28, 7438336
    buffer_load_dwordx4 v11, s[12:15], s4 offen lds

    s_add_u32 m0, s29, 4096
    s_add_u32 s4, s28, 7471104
    buffer_load_dwordx4 v10, s[12:15], s4 offen lds

    s_add_u32 m0, s29, 5120
    s_add_u32 s4, s28, 7503872
    buffer_load_dwordx4 v10, s[12:15], s4 offen lds

    s_add_u32 m0, s29, 6144
    s_add_u32 s4, s28, 7536640
    buffer_load_dwordx4 v11, s[12:15], s4 offen lds

    s_add_u32 m0, s29, 7168
    s_add_u32 s4, s28, 7569408
    buffer_load_dwordx4 v11, s[12:15], s4 offen lds

    s_cmp_eq_u32 s30, 2
    s_cbranch_scc1 .s0v_398
    v_mfma_f32_16x16x32_bf16 v[64:67], a[128:131], v[32:35], v[64:67]
    v_mfma_f32_16x16x32_bf16 v[68:71], a[132:135], v[32:35], v[68:71]
    v_mfma_f32_16x16x32_bf16 v[72:75], a[128:131], v[36:39], v[72:75]
    v_mfma_f32_16x16x32_bf16 v[76:79], a[132:135], v[36:39], v[76:79]
    v_mfma_f32_16x16x32_bf16 v[64:67], a[136:139], v[40:43], v[64:67]
    v_mfma_f32_16x16x32_bf16 v[68:71], a[140:143], v[40:43], v[68:71]
    v_mfma_f32_16x16x32_bf16 v[72:75], a[136:139], v[44:47], v[72:75]
    v_mfma_f32_16x16x32_bf16 v[76:79], a[140:143], v[44:47], v[76:79]
    v_mfma_f32_16x16x32_bf16 v[64:67], a[144:147], v[48:51], v[64:67]
    v_mfma_f32_16x16x32_bf16 v[68:71], a[148:151], v[48:51], v[68:71]
    v_mfma_f32_16x16x32_bf16 v[72:75], a[144:147], v[52:55], v[72:75]
    v_mfma_f32_16x16x32_bf16 v[76:79], a[148:151], v[52:55], v[76:79]
    v_mfma_f32_16x16x32_bf16 v[64:67], a[152:155], v[56:59], v[64:67]
    v_mfma_f32_16x16x32_bf16 v[68:71], a[156:159], v[56:59], v[68:71]
    v_mfma_f32_16x16x32_bf16 v[72:75], a[152:155], v[60:63], v[72:75]
    v_mfma_f32_16x16x32_bf16 v[76:79], a[156:159], v[60:63], v[76:79]
    s_branch .s0j_399
.s0v_398:
    v_mfma_f32_16x16x32_bf16 v[64:67], v[32:35], a[128:131], v[64:67]
    v_mfma_f32_16x16x32_bf16 v[68:71], v[32:35], a[132:135], v[68:71]
    v_mfma_f32_16x16x32_bf16 v[72:75], v[36:39], a[128:131], v[72:75]
    v_mfma_f32_16x16x32_bf16 v[76:79], v[36:39], a[132:135], v[76:79]
    v_mfma_f32_16x16x32_bf16 v[64:67], v[40:43], a[136:139], v[64:67]
    v_mfma_f32_16x16x32_bf16 v[68:71], v[40:43], a[140:143], v[68:71]
    v_mfma_f32_16x16x32_bf16 v[72:75], v[44:47], a[136:139], v[72:75]
    v_mfma_f32_16x16x32_bf16 v[76:79], v[44:47], a[140:143], v[76:79]
    v_mfma_f32_16x16x32_bf16 v[64:67], v[48:51], a[144:147], v[64:67]
    v_mfma_f32_16x16x32_bf16 v[68:71], v[48:51], a[148:151], v[68:71]
    v_mfma_f32_16x16x32_bf16 v[72:75], v[52:55], a[144:147], v[72:75]
    v_mfma_f32_16x16x32_bf16 v[76:79], v[52:55], a[148:151], v[76:79]
    v_mfma_f32_16x16x32_bf16 v[64:67], v[56:59], a[152:155], v[64:67]
    v_mfma_f32_16x16x32_bf16 v[68:71], v[56:59], a[156:159], v[68:71]
    v_mfma_f32_16x16x32_bf16 v[72:75], v[60:63], a[152:155], v[72:75]
    v_mfma_f32_16x16x32_bf16 v[76:79], v[60:63], a[156:159], v[76:79]
.s0j_399:
    s_waitcnt vmcnt(17)
    s_barrier
    ds_read_b64_tr_b16 a[160:161], v14 offset:0
    ds_read_b64_tr_b16 a[162:163], v14 offset:1024
    ds_read_b64_tr_b16 a[164:165], v15 offset:0
    ds_read_b64_tr_b16 a[166:167], v15 offset:1024
    ds_read_b64_tr_b16 a[168:169], v14 offset:8192
    ds_read_b64_tr_b16 a[170:171], v14 offset:9216
    ds_read_b64_tr_b16 a[172:173], v15 offset:8192
    ds_read_b64_tr_b16 a[174:175], v15 offset:9216
    ds_read_b64_tr_b16 a[176:177], v14 offset:16384
    ds_read_b64_tr_b16 a[178:179], v14 offset:17408
    ds_read_b64_tr_b16 a[180:181], v15 offset:16384
    ds_read_b64_tr_b16 a[182:183], v15 offset:17408
    ds_read_b64_tr_b16 a[184:185], v14 offset:24576
    ds_read_b64_tr_b16 a[186:187], v14 offset:25600
    ds_read_b64_tr_b16 a[188:189], v15 offset:24576
    ds_read_b64_tr_b16 a[190:191], v15 offset:25600
    ds_read_b128 v[32:35], v17 offset:34816
    ds_read_b128 v[36:39], v17 offset:51200
    ds_read_b128 v[40:43], v18 offset:34816
    ds_read_b128 v[44:47], v18 offset:51200
    ds_read_b128 v[48:51], v17 offset:35840
    ds_read_b128 v[52:55], v17 offset:52224
    ds_read_b128 v[56:59], v18 offset:35840
    ds_read_b128 v[60:63], v18 offset:52224
    s_waitcnt lgkmcnt(0)
    s_barrier
    s_add_u32 m0, s29, 65536
    s_nop 0
    buffer_load_dwordx4 v16, s[16:19], s34 offen offset:0 lds
    s_add_u32 m0, s29, 66432
    s_nop 0
    buffer_load_dwordx4 v16, s[16:19], s34 offen offset:128 lds
    s_add_u32 m0, s29, 67328
    s_nop 0
    buffer_load_dwordx4 v16, s[16:19], s34 offen offset:256 lds
    s_add_u32 m0, s29, 68224
    s_nop 0
    buffer_load_dwordx4 v16, s[16:19], s34 offen offset:384 lds
    s_add_u32 m0, s29, 69120
    s_nop 0
    buffer_load_dwordx4 v16, s[16:19], s34 offen offset:512 lds
    s_add_u32 m0, s29, 70016
    s_nop 0
    buffer_load_dwordx4 v16, s[16:19], s34 offen offset:640 lds
    s_add_u32 m0, s29, 70912
    s_nop 0
    buffer_load_dwordx4 v16, s[16:19], s34 offen offset:768 lds
    s_add_u32 m0, s29, 71808
    s_nop 0
    buffer_load_dwordx4 v16, s[16:19], s34 offen offset:896 lds
    s_add_u32 s34, s34, 1024
    s_cmp_eq_u32 s30, 2
    s_cbranch_scc1 .s0v_400
    v_mfma_f32_16x16x32_bf16 v[64:67], a[160:163], v[32:35], v[64:67]
    v_mfma_f32_16x16x32_bf16 v[68:71], a[164:167], v[32:35], v[68:71]
    v_mfma_f32_16x16x32_bf16 v[72:75], a[160:163], v[36:39], v[72:75]
    v_mfma_f32_16x16x32_bf16 v[76:79], a[164:167], v[36:39], v[76:79]
    v_mfma_f32_16x16x32_bf16 v[64:67], a[168:171], v[40:43], v[64:67]
    v_mfma_f32_16x16x32_bf16 v[68:71], a[172:175], v[40:43], v[68:71]
    v_mfma_f32_16x16x32_bf16 v[72:75], a[168:171], v[44:47], v[72:75]
    v_mfma_f32_16x16x32_bf16 v[76:79], a[172:175], v[44:47], v[76:79]
    v_mfma_f32_16x16x32_bf16 v[64:67], a[176:179], v[48:51], v[64:67]
    v_mfma_f32_16x16x32_bf16 v[68:71], a[180:183], v[48:51], v[68:71]
    v_mfma_f32_16x16x32_bf16 v[72:75], a[176:179], v[52:55], v[72:75]
    v_mfma_f32_16x16x32_bf16 v[76:79], a[180:183], v[52:55], v[76:79]
    v_mfma_f32_16x16x32_bf16 v[64:67], a[184:187], v[56:59], v[64:67]
    v_mfma_f32_16x16x32_bf16 v[68:71], a[188:191], v[56:59], v[68:71]
    v_mfma_f32_16x16x32_bf16 v[72:75], a[184:187], v[60:63], v[72:75]
    v_mfma_f32_16x16x32_bf16 v[76:79], a[188:191], v[60:63], v[76:79]
    s_branch .s0j_401
.s0v_400:
    v_mfma_f32_16x16x32_bf16 v[64:67], v[32:35], a[160:163], v[64:67]
    v_mfma_f32_16x16x32_bf16 v[68:71], v[32:35], a[164:167], v[68:71]
    v_mfma_f32_16x16x32_bf16 v[72:75], v[36:39], a[160:163], v[72:75]
    v_mfma_f32_16x16x32_bf16 v[76:79], v[36:39], a[164:167], v[76:79]
    v_mfma_f32_16x16x32_bf16 v[64:67], v[40:43], a[168:171], v[64:67]
    v_mfma_f32_16x16x32_bf16 v[68:71], v[40:43], a[172:175], v[68:71]
    v_mfma_f32_16x16x32_bf16 v[72:75], v[44:47], a[168:171], v[72:75]
    v_mfma_f32_16x16x32_bf16 v[76:79], v[44:47], a[172:175], v[76:79]
    v_mfma_f32_16x16x32_bf16 v[64:67], v[48:51], a[176:179], v[64:67]
    v_mfma_f32_16x16x32_bf16 v[68:71], v[48:51], a[180:183], v[68:71]
    v_mfma_f32_16x16x32_bf16 v[72:75], v[52:55], a[176:179], v[72:75]
    v_mfma_f32_16x16x32_bf16 v[76:79], v[52:55], a[180:183], v[76:79]
    v_mfma_f32_16x16x32_bf16 v[64:67], v[56:59], a[184:187], v[64:67]
    v_mfma_f32_16x16x32_bf16 v[68:71], v[56:59], a[188:191], v[68:71]
    v_mfma_f32_16x16x32_bf16 v[72:75], v[60:63], a[184:187], v[72:75]
    v_mfma_f32_16x16x32_bf16 v[76:79], v[60:63], a[188:191], v[76:79]
.s0j_401:
    s_waitcnt vmcnt(17)
    s_barrier
    ds_read_b64_tr_b16 a[192:193], v14 offset:32768
    ds_read_b64_tr_b16 a[194:195], v14 offset:33792
    ds_read_b64_tr_b16 a[196:197], v15 offset:32768
    ds_read_b64_tr_b16 a[198:199], v15 offset:33792
    ds_read_b64_tr_b16 a[200:201], v14 offset:40960
    ds_read_b64_tr_b16 a[202:203], v14 offset:41984
    ds_read_b64_tr_b16 a[204:205], v15 offset:40960
    ds_read_b64_tr_b16 a[206:207], v15 offset:41984
    ds_read_b64_tr_b16 a[208:209], v14 offset:49152
    ds_read_b64_tr_b16 a[210:211], v14 offset:50176
    ds_read_b64_tr_b16 a[212:213], v15 offset:49152
    ds_read_b64_tr_b16 a[214:215], v15 offset:50176
    ds_read_b64_tr_b16 a[216:217], v14 offset:57344
    ds_read_b64_tr_b16 a[218:219], v14 offset:58368
    ds_read_b64_tr_b16 a[220:221], v15 offset:57344
    ds_read_b64_tr_b16 a[222:223], v15 offset:58368
    ds_read_b128 v[32:35], v17 offset:36864
    ds_read_b128 v[36:39], v17 offset:53248
    ds_read_b128 v[40:43], v18 offset:36864
    ds_read_b128 v[44:47], v18 offset:53248
    ds_read_b128 v[48:51], v17 offset:37888
    ds_read_b128 v[52:55], v17 offset:54272
    ds_read_b128 v[56:59], v18 offset:37888
    ds_read_b128 v[60:63], v18 offset:54272
    s_waitcnt lgkmcnt(0)
    s_barrier
    s_add_u32 m0, s29, 98304
    s_nop 0
    buffer_load_dwordx4 v16, s[16:19], s34 offen offset:0 lds
    s_add_u32 m0, s29, 99200
    s_nop 0
    buffer_load_dwordx4 v16, s[16:19], s34 offen offset:128 lds
    s_add_u32 m0, s29, 100096
    s_nop 0
    buffer_load_dwordx4 v16, s[16:19], s34 offen offset:256 lds
    s_add_u32 m0, s29, 100992
    s_nop 0
    buffer_load_dwordx4 v16, s[16:19], s34 offen offset:384 lds
    s_add_u32 m0, s29, 101888
    s_nop 0
    buffer_load_dwordx4 v16, s[16:19], s34 offen offset:512 lds
    s_add_u32 m0, s29, 102784
    s_nop 0
    buffer_load_dwordx4 v16, s[16:19], s34 offen offset:640 lds
    s_add_u32 m0, s29, 103680
    s_nop 0
    buffer_load_dwordx4 v16, s[16:19], s34 offen offset:768 lds
    s_add_u32 m0, s29, 104576
    s_nop 0
    buffer_load_dwordx4 v16, s[16:19], s34 offen offset:896 lds
    s_add_u32 s34, s34, 64512
    s_min_u32 s34, s34, 4128768
    s_cmp_eq_u32 s30, 2
    s_cbranch_scc1 .s0v_402
    v_mfma_f32_16x16x32_bf16 v[64:67], a[192:195], v[32:35], v[64:67]
    v_mfma_f32_16x16x32_bf16 v[68:71], a[196:199], v[32:35], v[68:71]
    v_mfma_f32_16x16x32_bf16 v[72:75], a[192:195], v[36:39], v[72:75]
    v_mfma_f32_16x16x32_bf16 v[76:79], a[196:199], v[36:39], v[76:79]
    v_mfma_f32_16x16x32_bf16 v[64:67], a[200:203], v[40:43], v[64:67]
    v_mfma_f32_16x16x32_bf16 v[68:71], a[204:207], v[40:43], v[68:71]
    v_mfma_f32_16x16x32_bf16 v[72:75], a[200:203], v[44:47], v[72:75]
    v_mfma_f32_16x16x32_bf16 v[76:79], a[204:207], v[44:47], v[76:79]
    v_mfma_f32_16x16x32_bf16 v[64:67], a[208:211], v[48:51], v[64:67]
    v_mfma_f32_16x16x32_bf16 v[68:71], a[212:215], v[48:51], v[68:71]
    v_mfma_f32_16x16x32_bf16 v[72:75], a[208:211], v[52:55], v[72:75]
    v_mfma_f32_16x16x32_bf16 v[76:79], a[212:215], v[52:55], v[76:79]
    v_mfma_f32_16x16x32_bf16 v[64:67], a[216:219], v[56:59], v[64:67]
    v_mfma_f32_16x16x32_bf16 v[68:71], a[220:223], v[56:59], v[68:71]
    v_mfma_f32_16x16x32_bf16 v[72:75], a[216:219], v[60:63], v[72:75]
    v_mfma_f32_16x16x32_bf16 v[76:79], a[220:223], v[60:63], v[76:79]
    s_branch .s0j_403
.s0v_402:
    v_mfma_f32_16x16x32_bf16 v[64:67], v[32:35], a[192:195], v[64:67]
    v_mfma_f32_16x16x32_bf16 v[68:71], v[32:35], a[196:199], v[68:71]
    v_mfma_f32_16x16x32_bf16 v[72:75], v[36:39], a[192:195], v[72:75]
    v_mfma_f32_16x16x32_bf16 v[76:79], v[36:39], a[196:199], v[76:79]
    v_mfma_f32_16x16x32_bf16 v[64:67], v[40:43], a[200:203], v[64:67]
    v_mfma_f32_16x16x32_bf16 v[68:71], v[40:43], a[204:207], v[68:71]
    v_mfma_f32_16x16x32_bf16 v[72:75], v[44:47], a[200:203], v[72:75]
    v_mfma_f32_16x16x32_bf16 v[76:79], v[44:47], a[204:207], v[76:79]
    v_mfma_f32_16x16x32_bf16 v[64:67], v[48:51], a[208:211], v[64:67]
    v_mfma_f32_16x16x32_bf16 v[68:71], v[48:51], a[212:215], v[68:71]
    v_mfma_f32_16x16x32_bf16 v[72:75], v[52:55], a[208:211], v[72:75]
    v_mfma_f32_16x16x32_bf16 v[76:79], v[52:55], a[212:215], v[76:79]
    v_mfma_f32_16x16x32_bf16 v[64:67], v[56:59], a[216:219], v[64:67]
    v_mfma_f32_16x16x32_bf16 v[68:71], v[56:59], a[220:223], v[68:71]
    v_mfma_f32_16x16x32_bf16 v[72:75], v[60:63], a[216:219], v[72:75]
    v_mfma_f32_16x16x32_bf16 v[76:79], v[60:63], a[220:223], v[76:79]
.s0j_403:
    s_waitcnt vmcnt(16)
    s_barrier
    ds_read_b64_tr_b16 a[224:225], v12 offset:0
    ds_read_b64_tr_b16 a[226:227], v12 offset:1024
    ds_read_b64_tr_b16 a[228:229], v13 offset:0
    ds_read_b64_tr_b16 a[230:231], v13 offset:1024
    ds_read_b64_tr_b16 a[232:233], v12 offset:8192
    ds_read_b64_tr_b16 a[234:235], v12 offset:9216
    ds_read_b64_tr_b16 a[236:237], v13 offset:8192
    ds_read_b64_tr_b16 a[238:239], v13 offset:9216
    ds_read_b64_tr_b16 a[240:241], v12 offset:16384
    ds_read_b64_tr_b16 a[242:243], v12 offset:17408
    ds_read_b64_tr_b16 a[244:245], v13 offset:16384
    ds_read_b64_tr_b16 a[246:247], v13 offset:17408
    ds_read_b64_tr_b16 a[248:249], v12 offset:24576
    ds_read_b64_tr_b16 a[250:251], v12 offset:25600
    ds_read_b64_tr_b16 a[252:253], v13 offset:24576
    ds_read_b64_tr_b16 a[254:255], v13 offset:25600
    ds_read_b128 v[32:35], v17 offset:38912
    ds_read_b128 v[36:39], v17 offset:55296
    ds_read_b128 v[40:43], v18 offset:38912
    ds_read_b128 v[44:47], v18 offset:55296
    ds_read_b128 v[48:51], v17 offset:39936
    ds_read_b128 v[52:55], v17 offset:56320
    ds_read_b128 v[56:59], v18 offset:39936
    ds_read_b128 v[60:63], v18 offset:56320
    s_mov_b32 s62, 0
.vp_404:
    v_readlane_b32 s4, v240, 0
    v_readlane_b32 s7, v240, 1
    v_readlane_b32 s6, v240, 2

    v_readlane_b32 s5, v240, 4
    s_add_u32 s4, s4, s5
    v_readlane_b32 s5, v240, 8
    s_add_u32 s4, s4, s5
    v_readlane_b32 s5, v240, 12
    s_add_u32 s4, s4, s5
    s_cmp_ge_u32 s4, 256
    s_cbranch_scc1 .vd_405
    s_cmp_lg_u32 s6, 0
    s_cbranch_scc1 .vs_406
    s_add_u32 s62, s62, 1
    s_cmp_gt_u32 s62, 0x100000
    s_cbranch_scc1 .mg_end_1
    s_sleep 8
    buffer_load_dword v240, v241, s[20:23], 0 offen sc1
    s_waitcnt vmcnt(0)
    s_branch .vp_404

.vs_406:
    s_lshr_b32 s25, s2, 5
    s_and_b32 s26, s2, 31
    s_mov_b32 s27, 1
    s_mov_b32 s99, 1
    s_mov_b32 s97, 144
    s_waitcnt vmcnt(0) lgkmcnt(0)
    s_barrier
    s_branch .mg_role_3

.vd_405:
    s_waitcnt lgkmcnt(0)
    s_barrier
    s_add_u32 m0, s29, 0
    s_nop 0
    buffer_load_dwordx4 v16, s[16:19], s34 offen offset:0 lds
    s_add_u32 m0, s29, 896
    s_nop 0
    buffer_load_dwordx4 v16, s[16:19], s34 offen offset:128 lds
    s_add_u32 m0, s29, 1792
    s_nop 0
    buffer_load_dwordx4 v16, s[16:19], s34 offen offset:256 lds
    s_add_u32 m0, s29, 2688
    s_nop 0
    buffer_load_dwordx4 v16, s[16:19], s34 offen offset:384 lds
    s_add_u32 m0, s29, 3584
    s_nop 0
    buffer_load_dwordx4 v16, s[16:19], s34 offen offset:512 lds
    s_add_u32 m0, s29, 4480
    s_nop 0
    buffer_load_dwordx4 v16, s[16:19], s34 offen offset:640 lds
    s_add_u32 m0, s29, 5376
    s_nop 0
    buffer_load_dwordx4 v16, s[16:19], s34 offen offset:768 lds
    s_add_u32 m0, s29, 6272
    s_nop 0
    buffer_load_dwordx4 v16, s[16:19], s34 offen offset:896 lds
    s_add_u32 s34, s34, 1024
    s_cmp_eq_u32 s30, 2
    s_cbranch_scc1 .s0v_407
    v_mfma_f32_16x16x32_bf16 v[64:67], a[224:227], v[32:35], v[64:67]
    v_mfma_f32_16x16x32_bf16 v[68:71], a[228:231], v[32:35], v[68:71]
    v_mfma_f32_16x16x32_bf16 v[72:75], a[224:227], v[36:39], v[72:75]
    v_mfma_f32_16x16x32_bf16 v[76:79], a[228:231], v[36:39], v[76:79]
    v_mfma_f32_16x16x32_bf16 v[64:67], a[232:235], v[40:43], v[64:67]
    v_mfma_f32_16x16x32_bf16 v[68:71], a[236:239], v[40:43], v[68:71]
    v_mfma_f32_16x16x32_bf16 v[72:75], a[232:235], v[44:47], v[72:75]
    v_mfma_f32_16x16x32_bf16 v[76:79], a[236:239], v[44:47], v[76:79]
    v_mfma_f32_16x16x32_bf16 v[64:67], a[240:243], v[48:51], v[64:67]
    v_mfma_f32_16x16x32_bf16 v[68:71], a[244:247], v[48:51], v[68:71]
    v_mfma_f32_16x16x32_bf16 v[72:75], a[240:243], v[52:55], v[72:75]
    v_mfma_f32_16x16x32_bf16 v[76:79], a[244:247], v[52:55], v[76:79]
    v_mfma_f32_16x16x32_bf16 v[64:67], a[248:251], v[56:59], v[64:67]
    v_mfma_f32_16x16x32_bf16 v[68:71], a[252:255], v[56:59], v[68:71]
    v_mfma_f32_16x16x32_bf16 v[72:75], a[248:251], v[60:63], v[72:75]
    v_mfma_f32_16x16x32_bf16 v[76:79], a[252:255], v[60:63], v[76:79]
    s_branch .s0j_408
.s0v_407:
    v_mfma_f32_16x16x32_bf16 v[64:67], v[32:35], a[224:227], v[64:67]
    v_mfma_f32_16x16x32_bf16 v[68:71], v[32:35], a[228:231], v[68:71]
    v_mfma_f32_16x16x32_bf16 v[72:75], v[36:39], a[224:227], v[72:75]
    v_mfma_f32_16x16x32_bf16 v[76:79], v[36:39], a[228:231], v[76:79]
    v_mfma_f32_16x16x32_bf16 v[64:67], v[40:43], a[232:235], v[64:67]
    v_mfma_f32_16x16x32_bf16 v[68:71], v[40:43], a[236:239], v[68:71]
    v_mfma_f32_16x16x32_bf16 v[72:75], v[44:47], a[232:235], v[72:75]
    v_mfma_f32_16x16x32_bf16 v[76:79], v[44:47], a[236:239], v[76:79]
    v_mfma_f32_16x16x32_bf16 v[64:67], v[48:51], a[240:243], v[64:67]
    v_mfma_f32_16x16x32_bf16 v[68:71], v[48:51], a[244:247], v[68:71]
    v_mfma_f32_16x16x32_bf16 v[72:75], v[52:55], a[240:243], v[72:75]
    v_mfma_f32_16x16x32_bf16 v[76:79], v[52:55], a[244:247], v[76:79]
    v_mfma_f32_16x16x32_bf16 v[64:67], v[56:59], a[248:251], v[64:67]
    v_mfma_f32_16x16x32_bf16 v[68:71], v[56:59], a[252:255], v[68:71]
    v_mfma_f32_16x16x32_bf16 v[72:75], v[60:63], a[248:251], v[72:75]
    v_mfma_f32_16x16x32_bf16 v[76:79], v[60:63], a[252:255], v[76:79]
.s0j_408:
    buffer_store_dwordx4 v[24:27], v28, s[8:11], s46 offen sc1
    buffer_store_dwordx4 v[24:27], v29, s[8:11], s46 offen sc1
    s_cmp_eq_u32 s30, 2
    s_cbranch_scc1 .qv_388
    s_waitcnt vmcnt(16)
    s_barrier
    ds_read_b128 v[32:35], v19 offset:0
    ds_read_b128 v[36:39], v19 offset:16384
    ds_read_b128 v[40:43], v20 offset:0
    ds_read_b128 v[44:47], v20 offset:16384
    s_add_u32 m0, s29, 32768
    s_nop 0
    buffer_load_dwordx4 v16, s[16:19], s34 offen offset:0 lds
    ds_read_b128 v[48:51], v19 offset:1024
    ds_read_b128 v[52:55], v19 offset:17408
    s_branch .qe_410
.p2align 6
.ql_409:
    s_waitcnt lgkmcnt(4)
    v_mfma_f32_16x16x32_bf16 v[64:67], a[0:3], v[32:35], 0
    ds_read_b128 v[56:59], v18 offset:1024
    s_add_u32 m0, s29, 99200
    v_mfma_f32_16x16x32_bf16 v[68:71], a[4:7], v[32:35], 0
    buffer_load_dwordx4 v16, s[16:19], s34 offen offset:128 lds
    v_mfma_f32_16x16x32_bf16 v[72:75], a[0:3], v[36:39], 0
    ds_read_b128 v[60:63], v18 offset:17408
    v_mfma_f32_16x16x32_bf16 v[76:79], a[4:7], v[36:39], 0
    s_mov_b32 exec_hi, 0
    buffer_store_dwordx4 v[24:27], v21, s[8:11], s48 offen sc1
    s_mov_b32 exec_hi, -1

    s_waitcnt lgkmcnt(4)
    v_mfma_f32_16x16x32_bf16 v[64:67], a[8:11], v[40:43], v[64:67]
    ds_read_b128 v[32:35], v17 offset:2048
    v_mfma_f32_16x16x32_bf16 v[68:71], a[12:15], v[40:43], v[68:71]
    v_cvt_pk_bf16_f32 v96, v80, v81
    v_cvt_pk_bf16_f32 v97, v82, v83
    v_cvt_pk_bf16_f32 v98, v84, v85
    v_mfma_f32_16x16x32_bf16 v[72:75], a[8:11], v[44:47], v[72:75]
    ds_read_b128 v[36:39], v17 offset:18432
    v_mfma_f32_16x16x32_bf16 v[76:79], a[12:15], v[44:47], v[76:79]
    v_cvt_pk_bf16_f32 v99, v86, v87
    v_cvt_pk_bf16_f32 v100, v88, v89
    buffer_store_dwordx4 v[96:99], v21, s[8:11], s32 offen sc1
    s_waitcnt lgkmcnt(4)
    v_mfma_f32_16x16x32_bf16 v[64:67], a[16:19], v[48:51], v[64:67]
    ds_read_b128 v[40:43], v18 offset:2048
    s_add_u32 m0, s29, 100096
    v_mfma_f32_16x16x32_bf16 v[68:71], a[20:23], v[48:51], v[68:71]
    buffer_load_dwordx4 v16, s[16:19], s34 offen offset:256 lds
    v_mfma_f32_16x16x32_bf16 v[72:75], a[16:19], v[52:55], v[72:75]
    ds_read_b128 v[44:47], v18 offset:18432
    v_mfma_f32_16x16x32_bf16 v[76:79], a[20:23], v[52:55], v[76:79]
    v_cvt_pk_bf16_f32 v101, v90, v91
    v_cvt_pk_bf16_f32 v102, v92, v93
    v_cvt_pk_bf16_f32 v103, v94, v95
    s_waitcnt lgkmcnt(4)
    v_mfma_f32_16x16x32_bf16 v[64:67], a[24:27], v[56:59], v[64:67]
    ds_read_b128 v[48:51], v17 offset:3072
    v_mfma_f32_16x16x32_bf16 v[68:71], a[28:31], v[56:59], v[68:71]
    buffer_store_dwordx4 v[100:103], v21, s[8:11], s38 offen sc1
    v_mfma_f32_16x16x32_bf16 v[72:75], a[24:27], v[60:63], v[72:75]
    ds_read_b128 v[52:55], v17 offset:19456
    v_mfma_f32_16x16x32_bf16 v[76:79], a[28:31], v[60:63], v[76:79]
    s_waitcnt lgkmcnt(4)
    v_mfma_f32_16x16x32_bf16 v[64:67], a[32:35], v[32:35], v[64:67]
    ds_read_b128 v[56:59], v18 offset:3072
    s_add_u32 m0, s29, 100992
    v_mfma_f32_16x16x32_bf16 v[68:71], a[36:39], v[32:35], v[68:71]
    buffer_load_dwordx4 v16, s[16:19], s34 offen offset:384 lds
    v_mfma_f32_16x16x32_bf16 v[72:75], a[32:35], v[36:39], v[72:75]
    ds_read_b128 v[60:63], v18 offset:19456
    v_mfma_f32_16x16x32_bf16 v[76:79], a[36:39], v[36:39], v[76:79]
    s_waitcnt lgkmcnt(4)
    v_mfma_f32_16x16x32_bf16 v[64:67], a[40:43], v[40:43], v[64:67]
    ds_read_b128 v[32:35], v17 offset:4096
    v_mfma_f32_16x16x32_bf16 v[68:71], a[44:47], v[40:43], v[68:71]
    v_mfma_f32_16x16x32_bf16 v[72:75], a[40:43], v[44:47], v[72:75]
    ds_read_b128 v[36:39], v17 offset:20480
    v_mfma_f32_16x16x32_bf16 v[76:79], a[44:47], v[44:47], v[76:79]
    s_waitcnt lgkmcnt(4)
    v_mfma_f32_16x16x32_bf16 v[64:67], a[48:51], v[48:51], v[64:67]
    ds_read_b128 v[40:43], v18 offset:4096
    s_add_u32 m0, s29, 101888
    v_mfma_f32_16x16x32_bf16 v[68:71], a[52:55], v[48:51], v[68:71]
    buffer_load_dwordx4 v16, s[16:19], s34 offen offset:512 lds
    v_mfma_f32_16x16x32_bf16 v[72:75], a[48:51], v[52:55], v[72:75]
    ds_read_b128 v[44:47], v18 offset:20480
    v_mfma_f32_16x16x32_bf16 v[76:79], a[52:55], v[52:55], v[76:79]
    s_waitcnt lgkmcnt(4)
    v_mfma_f32_16x16x32_bf16 v[64:67], a[56:59], v[56:59], v[64:67]
    ds_read_b128 v[48:51], v17 offset:5120
    v_mfma_f32_16x16x32_bf16 v[68:71], a[60:63], v[56:59], v[68:71]
    v_mfma_f32_16x16x32_bf16 v[72:75], a[56:59], v[60:63], v[72:75]
    ds_read_b128 v[52:55], v17 offset:21504
    v_mfma_f32_16x16x32_bf16 v[76:79], a[60:63], v[60:63], v[76:79]
    s_waitcnt lgkmcnt(4)
    v_mfma_f32_16x16x32_bf16 v[64:67], a[64:67], v[32:35], v[64:67]
    ds_read_b128 v[56:59], v18 offset:5120
    s_add_u32 m0, s29, 102784
    v_mfma_f32_16x16x32_bf16 v[68:71], a[68:71], v[32:35], v[68:71]
    buffer_load_dwordx4 v16, s[16:19], s34 offen offset:640 lds
    v_mfma_f32_16x16x32_bf16 v[72:75], a[64:67], v[36:39], v[72:75]
    ds_read_b128 v[60:63], v18 offset:21504
    v_mfma_f32_16x16x32_bf16 v[76:79], a[68:71], v[36:39], v[76:79]
    s_waitcnt lgkmcnt(4)
    v_mfma_f32_16x16x32_bf16 v[64:67], a[72:75], v[40:43], v[64:67]
    ds_read_b128 v[32:35], v17 offset:6144
    v_mfma_f32_16x16x32_bf16 v[68:71], a[76:79], v[40:43], v[68:71]
    s_mov_b32 s32, s39
    s_add_u32 s38, s39, 4096
    s_add_u32 s39, s39, 262144
    s_mov_b32 s48, s49
    s_add_u32 s49, s49, 196608
    v_mfma_f32_16x16x32_bf16 v[72:75], a[72:75], v[44:47], v[72:75]
    ds_read_b128 v[36:39], v17 offset:22528
    v_mfma_f32_16x16x32_bf16 v[76:79], a[76:79], v[44:47], v[76:79]
    v_add_u32 v23, 1, v23
    s_waitcnt lgkmcnt(4)
    v_mfma_f32_16x16x32_bf16 v[64:67], a[80:83], v[48:51], v[64:67]
    ds_read_b128 v[40:43], v18 offset:6144
    s_add_u32 m0, s29, 103680
    v_mfma_f32_16x16x32_bf16 v[68:71], a[84:87], v[48:51], v[68:71]
    buffer_load_dwordx4 v16, s[16:19], s34 offen offset:768 lds
    v_mfma_f32_16x16x32_bf16 v[72:75], a[80:83], v[52:55], v[72:75]
    ds_read_b128 v[44:47], v18 offset:22528
    v_mfma_f32_16x16x32_bf16 v[76:79], a[84:87], v[52:55], v[76:79]
    s_waitcnt lgkmcnt(4)
    v_mfma_f32_16x16x32_bf16 v[64:67], a[88:91], v[56:59], v[64:67]
    ds_read_b128 v[48:51], v17 offset:7168
    v_mfma_f32_16x16x32_bf16 v[68:71], a[92:95], v[56:59], v[68:71]
    v_mfma_f32_16x16x32_bf16 v[72:75], a[88:91], v[60:63], v[72:75]
    ds_read_b128 v[52:55], v17 offset:23552
    v_mfma_f32_16x16x32_bf16 v[76:79], a[92:95], v[60:63], v[76:79]
    s_mov_b64 exec, s[44:45]
    buffer_store_dwordx4 v[24:27], v28, s[8:11], s46 offen sc1
    s_mov_b64 exec, -1
    s_waitcnt lgkmcnt(4)
    v_mfma_f32_16x16x32_bf16 v[64:67], a[96:99], v[32:35], v[64:67]
    ds_read_b128 v[56:59], v18 offset:7168
    s_add_u32 m0, s29, 104576
    v_mfma_f32_16x16x32_bf16 v[68:71], a[100:103], v[32:35], v[68:71]
    buffer_load_dwordx4 v16, s[16:19], s34 offen offset:896 lds
    v_mfma_f32_16x16x32_bf16 v[72:75], a[96:99], v[36:39], v[72:75]
    ds_read_b128 v[60:63], v18 offset:23552
    v_mfma_f32_16x16x32_bf16 v[76:79], a[100:103], v[36:39], v[76:79]
    s_waitcnt lgkmcnt(4)
    v_mfma_f32_16x16x32_bf16 v[64:67], a[104:107], v[40:43], v[64:67]
    s_add_u32 s34, s34, 64512
    s_min_u32 s34, s34, 4128768
    v_mfma_f32_16x16x32_bf16 v[68:71], a[108:111], v[40:43], v[68:71]
    v_mfma_f32_16x16x32_bf16 v[72:75], a[104:107], v[44:47], v[72:75]
    v_mfma_f32_16x16x32_bf16 v[76:79], a[108:111], v[44:47], v[76:79]
    s_waitcnt lgkmcnt(0)
    s_cmp_lt_u32 s35, 2
    s_cselect_b64 s[70:71], s[36:37], 0
    s_cbranch_scc0 .ef_411
    s_waitcnt vmcnt(5)
.ef_411:
    s_waitcnt vmcnt(19)
    s_barrier
    ds_read_b128 v[32:35], v17 offset:32768
    ds_read_b128 v[36:39], v17 offset:49152
    v_mfma_f32_16x16x32_bf16 v[64:67], a[112:115], v[48:51], v[64:67]
    ds_read_b128 v[40:43], v18 offset:32768
    s_add_u32 m0, s29, 0
    v_mfma_f32_16x16x32_bf16 v[68:71], a[116:119], v[48:51], v[68:71]
    buffer_load_dwordx4 v16, s[16:19], s34 offen offset:0 lds
    v_mfma_f32_16x16x32_bf16 v[72:75], a[112:115], v[52:55], v[72:75]
    ds_read_b128 v[44:47], v18 offset:49152
    v_mfma_f32_16x16x32_bf16 v[76:79], a[116:119], v[52:55], v[76:79]
    v_mfma_f32_16x16x32_bf16 v[64:67], a[120:123], v[56:59], v[64:67]
    ds_read_b128 v[48:51], v17 offset:33792
    v_mfma_f32_16x16x32_bf16 v[68:71], a[124:127], v[56:59], v[68:71]
    v_mfma_f32_16x16x32_bf16 v[72:75], a[120:123], v[60:63], v[72:75]
    ds_read_b128 v[52:55], v17 offset:50176
    v_mfma_f32_16x16x32_bf16 v[76:79], a[124:127], v[60:63], v[76:79]
    s_mov_b64 exec, s[70:71]
    buffer_store_dword v23, v22, s[8:11], s33 offen sc1
    s_mov_b64 exec, -1

    s_waitcnt lgkmcnt(4)
    v_mfma_f32_16x16x32_bf16 v[64:67], a[128:131], v[32:35], v[64:67]
    ds_read_b128 v[56:59], v18 offset:33792
    s_add_u32 m0, s29, 896
    v_mfma_f32_16x16x32_bf16 v[68:71], a[132:135], v[32:35], v[68:71]
    buffer_load_dwordx4 v16, s[16:19], s34 offen offset:128 lds
    v_mfma_f32_16x16x32_bf16 v[72:75], a[128:131], v[36:39], v[72:75]
    ds_read_b128 v[60:63], v18 offset:50176
    v_mfma_f32_16x16x32_bf16 v[76:79], a[132:135], v[36:39], v[76:79]
    s_waitcnt lgkmcnt(4)
    v_mfma_f32_16x16x32_bf16 v[64:67], a[136:139], v[40:43], v[64:67]
    ds_read_b128 v[32:35], v17 offset:34816
    v_mfma_f32_16x16x32_bf16 v[68:71], a[140:143], v[40:43], v[68:71]
    v_mfma_f32_16x16x32_bf16 v[72:75], a[136:139], v[44:47], v[72:75]
    ds_read_b128 v[36:39], v17 offset:51200
    v_mfma_f32_16x16x32_bf16 v[76:79], a[140:143], v[44:47], v[76:79]
    s_waitcnt lgkmcnt(4)
    v_mfma_f32_16x16x32_bf16 v[64:67], a[144:147], v[48:51], v[64:67]
    ds_read_b128 v[40:43], v18 offset:34816
    s_add_u32 m0, s29, 1792
    v_mfma_f32_16x16x32_bf16 v[68:71], a[148:151], v[48:51], v[68:71]
    buffer_load_dwordx4 v16, s[16:19], s34 offen offset:256 lds
    v_mfma_f32_16x16x32_bf16 v[72:75], a[144:147], v[52:55], v[72:75]
    ds_read_b128 v[44:47], v18 offset:51200
    v_mfma_f32_16x16x32_bf16 v[76:79], a[148:151], v[52:55], v[76:79]
    s_waitcnt lgkmcnt(4)
    v_mfma_f32_16x16x32_bf16 v[64:67], a[152:155], v[56:59], v[64:67]
    ds_read_b128 v[48:51], v17 offset:35840
    v_mfma_f32_16x16x32_bf16 v[68:71], a[156:159], v[56:59], v[68:71]
    v_mfma_f32_16x16x32_bf16 v[72:75], a[152:155], v[60:63], v[72:75]
    ds_read_b128 v[52:55], v17 offset:52224
    v_mfma_f32_16x16x32_bf16 v[76:79], a[156:159], v[60:63], v[76:79]
    s_waitcnt lgkmcnt(4)
    v_mfma_f32_16x16x32_bf16 v[64:67], a[160:163], v[32:35], v[64:67]
    ds_read_b128 v[56:59], v18 offset:35840
    s_add_u32 m0, s29, 2688
    v_mfma_f32_16x16x32_bf16 v[68:71], a[164:167], v[32:35], v[68:71]
    buffer_load_dwordx4 v16, s[16:19], s34 offen offset:384 lds
    v_mfma_f32_16x16x32_bf16 v[72:75], a[160:163], v[36:39], v[72:75]
    ds_read_b128 v[60:63], v18 offset:52224
    v_mfma_f32_16x16x32_bf16 v[76:79], a[164:167], v[36:39], v[76:79]
    s_waitcnt lgkmcnt(4)
    v_mfma_f32_16x16x32_bf16 v[64:67], a[168:171], v[40:43], v[64:67]
    ds_read_b128 v[32:35], v17 offset:36864
    v_mfma_f32_16x16x32_bf16 v[68:71], a[172:175], v[40:43], v[68:71]
    v_mfma_f32_16x16x32_bf16 v[72:75], a[168:171], v[44:47], v[72:75]
    ds_read_b128 v[36:39], v17 offset:53248
    v_mfma_f32_16x16x32_bf16 v[76:79], a[172:175], v[44:47], v[76:79]
    s_waitcnt lgkmcnt(4)
    v_mfma_f32_16x16x32_bf16 v[64:67], a[176:179], v[48:51], v[64:67]
    ds_read_b128 v[40:43], v18 offset:36864
    s_add_u32 m0, s29, 3584
    v_mfma_f32_16x16x32_bf16 v[68:71], a[180:183], v[48:51], v[68:71]
    buffer_load_dwordx4 v16, s[16:19], s34 offen offset:512 lds
    v_mfma_f32_16x16x32_bf16 v[72:75], a[176:179], v[52:55], v[72:75]
    ds_read_b128 v[44:47], v18 offset:53248
    v_mfma_f32_16x16x32_bf16 v[76:79], a[180:183], v[52:55], v[76:79]
    s_waitcnt lgkmcnt(4)
    v_mfma_f32_16x16x32_bf16 v[64:67], a[184:187], v[56:59], v[64:67]
    ds_read_b128 v[48:51], v17 offset:37888
    v_mfma_f32_16x16x32_bf16 v[68:71], a[188:191], v[56:59], v[68:71]
    v_mfma_f32_16x16x32_bf16 v[72:75], a[184:187], v[60:63], v[72:75]
    ds_read_b128 v[52:55], v17 offset:54272
    v_mfma_f32_16x16x32_bf16 v[76:79], a[188:191], v[60:63], v[76:79]
    s_waitcnt lgkmcnt(4)
    v_mfma_f32_16x16x32_bf16 v[64:67], a[192:195], v[32:35], v[64:67]
    ds_read_b128 v[56:59], v18 offset:37888
    s_add_u32 m0, s29, 4480
    v_mfma_f32_16x16x32_bf16 v[68:71], a[196:199], v[32:35], v[68:71]
    buffer_load_dwordx4 v16, s[16:19], s34 offen offset:640 lds
    v_mfma_f32_16x16x32_bf16 v[72:75], a[192:195], v[36:39], v[72:75]
    ds_read_b128 v[60:63], v18 offset:54272
    v_mfma_f32_16x16x32_bf16 v[76:79], a[196:199], v[36:39], v[76:79]
    s_waitcnt lgkmcnt(4)
    v_mfma_f32_16x16x32_bf16 v[64:67], a[200:203], v[40:43], v[64:67]
    ds_read_b128 v[32:35], v17 offset:38912
    v_mfma_f32_16x16x32_bf16 v[68:71], a[204:207], v[40:43], v[68:71]
    v_mfma_f32_16x16x32_bf16 v[72:75], a[200:203], v[44:47], v[72:75]
    ds_read_b128 v[36:39], v17 offset:55296
    v_mfma_f32_16x16x32_bf16 v[76:79], a[204:207], v[44:47], v[76:79]
    s_waitcnt lgkmcnt(4)
    v_mfma_f32_16x16x32_bf16 v[64:67], a[208:211], v[48:51], v[64:67]
    ds_read_b128 v[40:43], v18 offset:38912
    s_add_u32 m0, s29, 5376
    v_mfma_f32_16x16x32_bf16 v[68:71], a[212:215], v[48:51], v[68:71]
    buffer_load_dwordx4 v16, s[16:19], s34 offen offset:768 lds
    v_mfma_f32_16x16x32_bf16 v[72:75], a[208:211], v[52:55], v[72:75]
    ds_read_b128 v[44:47], v18 offset:55296
    v_mfma_f32_16x16x32_bf16 v[76:79], a[212:215], v[52:55], v[76:79]
    s_waitcnt lgkmcnt(4)
    v_mfma_f32_16x16x32_bf16 v[64:67], a[216:219], v[56:59], v[64:67]
    ds_read_b128 v[48:51], v17 offset:39936
    v_mfma_f32_16x16x32_bf16 v[68:71], a[220:223], v[56:59], v[68:71]
    v_mfma_f32_16x16x32_bf16 v[72:75], a[216:219], v[60:63], v[72:75]
    ds_read_b128 v[52:55], v17 offset:56320
    v_mfma_f32_16x16x32_bf16 v[76:79], a[220:223], v[60:63], v[76:79]
    s_mov_b64 exec, s[44:45]
    buffer_store_dwordx4 v[24:27], v29, s[8:11], s46 offen sc1
    s_mov_b64 exec, -1
    s_waitcnt lgkmcnt(4)
    v_mfma_f32_16x16x32_bf16 v[64:67], a[224:227], v[32:35], v[64:67]
    ds_read_b128 v[56:59], v18 offset:39936
    s_add_u32 m0, s29, 6272
    v_mfma_f32_16x16x32_bf16 v[68:71], a[228:231], v[32:35], v[68:71]
    buffer_load_dwordx4 v16, s[16:19], s34 offen offset:896 lds
    v_mfma_f32_16x16x32_bf16 v[72:75], a[224:227], v[36:39], v[72:75]
    ds_read_b128 v[60:63], v18 offset:56320
    v_mfma_f32_16x16x32_bf16 v[76:79], a[228:231], v[36:39], v[76:79]
    s_waitcnt lgkmcnt(4)
    v_mfma_f32_16x16x32_bf16 v[64:67], a[232:235], v[40:43], v[64:67]
    s_add_u32 s34, s34, 1024
    v_mfma_f32_16x16x32_bf16 v[68:71], a[236:239], v[40:43], v[68:71]
    v_mfma_f32_16x16x32_bf16 v[72:75], a[232:235], v[44:47], v[72:75]
    v_mfma_f32_16x16x32_bf16 v[76:79], a[236:239], v[44:47], v[76:79]
    s_waitcnt lgkmcnt(0)
    s_waitcnt vmcnt(13)
    s_barrier
    ds_read_b128 v[32:35], v19 offset:0
    ds_read_b128 v[36:39], v19 offset:16384
    v_mfma_f32_16x16x32_bf16 v[64:67], a[240:243], v[48:51], v[64:67]
    ds_read_b128 v[40:43], v20 offset:0
    s_add_u32 m0, s29, 32768
    v_mfma_f32_16x16x32_bf16 v[68:71], a[244:247], v[48:51], v[68:71]
    buffer_load_dwordx4 v16, s[16:19], s34 offen offset:0 lds
    v_mfma_f32_16x16x32_bf16 v[72:75], a[240:243], v[52:55], v[72:75]
    ds_read_b128 v[44:47], v20 offset:16384
    v_mfma_f32_16x16x32_bf16 v[76:79], a[244:247], v[52:55], v[76:79]
    v_mfma_f32_16x16x32_bf16 v[64:67], a[248:251], v[56:59], v[64:67]
    ds_read_b128 v[48:51], v19 offset:1024
    v_mfma_f32_16x16x32_bf16 v[68:71], a[252:255], v[56:59], v[68:71]
    v_mfma_f32_16x16x32_bf16 v[72:75], a[248:251], v[60:63], v[72:75]
    ds_read_b128 v[52:55], v19 offset:17408
    v_mfma_f32_16x16x32_bf16 v[76:79], a[252:255], v[60:63], v[76:79]
    s_mov_b64 exec, s[36:37]
    buffer_store_dword v23, v22, s[8:11], s33 offen sc1
    s_mov_b64 exec, -1

.qe_410:
    s_waitcnt lgkmcnt(4)
    v_mfma_f32_16x16x32_bf16 v[80:83], a[0:3], v[32:35], 0
    ds_read_b128 v[56:59], v20 offset:1024
    s_add_u32 m0, s29, 33664
    v_mfma_f32_16x16x32_bf16 v[84:87], a[4:7], v[32:35], 0
    buffer_load_dwordx4 v16, s[16:19], s34 offen offset:128 lds
    v_mfma_f32_16x16x32_bf16 v[88:91], a[0:3], v[36:39], 0
    ds_read_b128 v[60:63], v20 offset:17408
    v_mfma_f32_16x16x32_bf16 v[92:95], a[4:7], v[36:39], 0
    s_mov_b32 exec_hi, 0
    buffer_store_dwordx4 v[24:27], v21, s[8:11], s48 offen sc1
    s_mov_b32 exec_hi, -1

    s_waitcnt lgkmcnt(4)
    v_mfma_f32_16x16x32_bf16 v[80:83], a[8:11], v[40:43], v[80:83]
    ds_read_b128 v[32:35], v19 offset:2048
    v_mfma_f32_16x16x32_bf16 v[84:87], a[12:15], v[40:43], v[84:87]
    v_cvt_pk_bf16_f32 v96, v64, v65
    v_cvt_pk_bf16_f32 v97, v66, v67
    v_cvt_pk_bf16_f32 v98, v68, v69
    v_mfma_f32_16x16x32_bf16 v[88:91], a[8:11], v[44:47], v[88:91]
    ds_read_b128 v[36:39], v19 offset:18432
    v_mfma_f32_16x16x32_bf16 v[92:95], a[12:15], v[44:47], v[92:95]
    v_cvt_pk_bf16_f32 v99, v70, v71
    v_cvt_pk_bf16_f32 v100, v72, v73
    buffer_store_dwordx4 v[96:99], v21, s[8:11], s32 offen sc1
    s_waitcnt lgkmcnt(4)
    v_mfma_f32_16x16x32_bf16 v[80:83], a[16:19], v[48:51], v[80:83]
    ds_read_b128 v[40:43], v20 offset:2048
    s_add_u32 m0, s29, 34560
    v_mfma_f32_16x16x32_bf16 v[84:87], a[20:23], v[48:51], v[84:87]
    buffer_load_dwordx4 v16, s[16:19], s34 offen offset:256 lds
    v_mfma_f32_16x16x32_bf16 v[88:91], a[16:19], v[52:55], v[88:91]
    ds_read_b128 v[44:47], v20 offset:18432
    v_mfma_f32_16x16x32_bf16 v[92:95], a[20:23], v[52:55], v[92:95]
    v_cvt_pk_bf16_f32 v101, v74, v75
    v_cvt_pk_bf16_f32 v102, v76, v77
    v_cvt_pk_bf16_f32 v103, v78, v79
    s_waitcnt lgkmcnt(4)
    v_mfma_f32_16x16x32_bf16 v[80:83], a[24:27], v[56:59], v[80:83]
    ds_read_b128 v[48:51], v19 offset:3072
    v_mfma_f32_16x16x32_bf16 v[84:87], a[28:31], v[56:59], v[84:87]
    buffer_store_dwordx4 v[100:103], v21, s[8:11], s38 offen sc1
    v_mfma_f32_16x16x32_bf16 v[88:91], a[24:27], v[60:63], v[88:91]
    ds_read_b128 v[52:55], v19 offset:19456
    v_mfma_f32_16x16x32_bf16 v[92:95], a[28:31], v[60:63], v[92:95]
    s_waitcnt lgkmcnt(4)
    v_mfma_f32_16x16x32_bf16 v[80:83], a[32:35], v[32:35], v[80:83]
    ds_read_b128 v[56:59], v20 offset:3072
    s_add_u32 m0, s29, 35456
    v_mfma_f32_16x16x32_bf16 v[84:87], a[36:39], v[32:35], v[84:87]
    buffer_load_dwordx4 v16, s[16:19], s34 offen offset:384 lds
    v_mfma_f32_16x16x32_bf16 v[88:91], a[32:35], v[36:39], v[88:91]
    ds_read_b128 v[60:63], v20 offset:19456
    v_mfma_f32_16x16x32_bf16 v[92:95], a[36:39], v[36:39], v[92:95]
    s_waitcnt lgkmcnt(4)
    v_mfma_f32_16x16x32_bf16 v[80:83], a[40:43], v[40:43], v[80:83]
    ds_read_b128 v[32:35], v19 offset:4096
    v_mfma_f32_16x16x32_bf16 v[84:87], a[44:47], v[40:43], v[84:87]
    v_mfma_f32_16x16x32_bf16 v[88:91], a[40:43], v[44:47], v[88:91]
    ds_read_b128 v[36:39], v19 offset:20480
    v_mfma_f32_16x16x32_bf16 v[92:95], a[44:47], v[44:47], v[92:95]
    s_waitcnt lgkmcnt(4)
    v_mfma_f32_16x16x32_bf16 v[80:83], a[48:51], v[48:51], v[80:83]
    ds_read_b128 v[40:43], v20 offset:4096
    s_add_u32 m0, s29, 36352
    v_mfma_f32_16x16x32_bf16 v[84:87], a[52:55], v[48:51], v[84:87]
    buffer_load_dwordx4 v16, s[16:19], s34 offen offset:512 lds
    v_mfma_f32_16x16x32_bf16 v[88:91], a[48:51], v[52:55], v[88:91]
    ds_read_b128 v[44:47], v20 offset:20480
    v_mfma_f32_16x16x32_bf16 v[92:95], a[52:55], v[52:55], v[92:95]
    s_waitcnt lgkmcnt(4)
    v_mfma_f32_16x16x32_bf16 v[80:83], a[56:59], v[56:59], v[80:83]
    ds_read_b128 v[48:51], v19 offset:5120
    v_mfma_f32_16x16x32_bf16 v[84:87], a[60:63], v[56:59], v[84:87]
    v_mfma_f32_16x16x32_bf16 v[88:91], a[56:59], v[60:63], v[88:91]
    ds_read_b128 v[52:55], v19 offset:21504
    v_mfma_f32_16x16x32_bf16 v[92:95], a[60:63], v[60:63], v[92:95]
    s_waitcnt lgkmcnt(4)
    v_mfma_f32_16x16x32_bf16 v[80:83], a[64:67], v[32:35], v[80:83]
    ds_read_b128 v[56:59], v20 offset:5120
    s_add_u32 m0, s29, 37248
    v_mfma_f32_16x16x32_bf16 v[84:87], a[68:71], v[32:35], v[84:87]
    buffer_load_dwordx4 v16, s[16:19], s34 offen offset:640 lds
    v_mfma_f32_16x16x32_bf16 v[88:91], a[64:67], v[36:39], v[88:91]
    ds_read_b128 v[60:63], v20 offset:21504
    v_mfma_f32_16x16x32_bf16 v[92:95], a[68:71], v[36:39], v[92:95]
    s_waitcnt lgkmcnt(4)
    v_mfma_f32_16x16x32_bf16 v[80:83], a[72:75], v[40:43], v[80:83]
    ds_read_b128 v[32:35], v19 offset:6144
    v_mfma_f32_16x16x32_bf16 v[84:87], a[76:79], v[40:43], v[84:87]
    s_mov_b32 s32, s39
    s_add_u32 s38, s39, 4096
    s_add_u32 s39, s39, 262144
    s_mov_b32 s48, s49
    s_add_u32 s49, s49, 196608
    v_mfma_f32_16x16x32_bf16 v[88:91], a[72:75], v[44:47], v[88:91]
    ds_read_b128 v[36:39], v19 offset:22528
    v_mfma_f32_16x16x32_bf16 v[92:95], a[76:79], v[44:47], v[92:95]
    v_add_u32 v23, 1, v23
    s_waitcnt lgkmcnt(4)
    v_mfma_f32_16x16x32_bf16 v[80:83], a[80:83], v[48:51], v[80:83]
    ds_read_b128 v[40:43], v20 offset:6144
    s_add_u32 m0, s29, 38144
    v_mfma_f32_16x16x32_bf16 v[84:87], a[84:87], v[48:51], v[84:87]
    buffer_load_dwordx4 v16, s[16:19], s34 offen offset:768 lds
    v_mfma_f32_16x16x32_bf16 v[88:91], a[80:83], v[52:55], v[88:91]
    ds_read_b128 v[44:47], v20 offset:22528
    v_mfma_f32_16x16x32_bf16 v[92:95], a[84:87], v[52:55], v[92:95]
    s_waitcnt lgkmcnt(4)
    v_mfma_f32_16x16x32_bf16 v[80:83], a[88:91], v[56:59], v[80:83]
    ds_read_b128 v[48:51], v19 offset:7168
    v_mfma_f32_16x16x32_bf16 v[84:87], a[92:95], v[56:59], v[84:87]
    v_mfma_f32_16x16x32_bf16 v[88:91], a[88:91], v[60:63], v[88:91]
    ds_read_b128 v[52:55], v19 offset:23552
    v_mfma_f32_16x16x32_bf16 v[92:95], a[92:95], v[60:63], v[92:95]
    s_mov_b64 exec, s[44:45]
    buffer_store_dwordx4 v[24:27], v30, s[8:11], s46 offen sc1
    s_mov_b64 exec, -1
    s_waitcnt lgkmcnt(4)
    v_mfma_f32_16x16x32_bf16 v[80:83], a[96:99], v[32:35], v[80:83]
    ds_read_b128 v[56:59], v20 offset:7168
    s_add_u32 m0, s29, 39040
    v_mfma_f32_16x16x32_bf16 v[84:87], a[100:103], v[32:35], v[84:87]
    buffer_load_dwordx4 v16, s[16:19], s34 offen offset:896 lds
    v_mfma_f32_16x16x32_bf16 v[88:91], a[96:99], v[36:39], v[88:91]
    ds_read_b128 v[60:63], v20 offset:23552
    v_mfma_f32_16x16x32_bf16 v[92:95], a[100:103], v[36:39], v[92:95]
    s_waitcnt lgkmcnt(4)
    v_mfma_f32_16x16x32_bf16 v[80:83], a[104:107], v[40:43], v[80:83]
    s_add_u32 s34, s34, 64512
    s_min_u32 s34, s34, 4128768
    v_mfma_f32_16x16x32_bf16 v[84:87], a[108:111], v[40:43], v[84:87]
    v_mfma_f32_16x16x32_bf16 v[88:91], a[104:107], v[44:47], v[88:91]
    v_mfma_f32_16x16x32_bf16 v[92:95], a[108:111], v[44:47], v[92:95]
    s_waitcnt lgkmcnt(0)
    s_cmp_lt_u32 s35, 2
    s_cselect_b64 s[70:71], s[36:37], 0
    s_cbranch_scc0 .ef_412
    s_waitcnt vmcnt(5)
.ef_412:
    s_waitcnt vmcnt(19)
    s_barrier
    ds_read_b128 v[32:35], v19 offset:32768
    ds_read_b128 v[36:39], v19 offset:49152
    v_mfma_f32_16x16x32_bf16 v[80:83], a[112:115], v[48:51], v[80:83]
    ds_read_b128 v[40:43], v20 offset:32768
    s_add_u32 m0, s29, 65536
    v_mfma_f32_16x16x32_bf16 v[84:87], a[116:119], v[48:51], v[84:87]
    buffer_load_dwordx4 v16, s[16:19], s34 offen offset:0 lds
    v_mfma_f32_16x16x32_bf16 v[88:91], a[112:115], v[52:55], v[88:91]
    ds_read_b128 v[44:47], v20 offset:49152
    v_mfma_f32_16x16x32_bf16 v[92:95], a[116:119], v[52:55], v[92:95]
    v_mfma_f32_16x16x32_bf16 v[80:83], a[120:123], v[56:59], v[80:83]
    ds_read_b128 v[48:51], v19 offset:33792
    v_mfma_f32_16x16x32_bf16 v[84:87], a[124:127], v[56:59], v[84:87]
    v_mfma_f32_16x16x32_bf16 v[88:91], a[120:123], v[60:63], v[88:91]
    ds_read_b128 v[52:55], v19 offset:50176
    v_mfma_f32_16x16x32_bf16 v[92:95], a[124:127], v[60:63], v[92:95]
    s_mov_b64 exec, s[70:71]
    buffer_store_dword v23, v22, s[8:11], s33 offen sc1
    s_mov_b64 exec, -1

    s_waitcnt lgkmcnt(4)
    v_mfma_f32_16x16x32_bf16 v[80:83], a[128:131], v[32:35], v[80:83]
    ds_read_b128 v[56:59], v20 offset:33792
    s_add_u32 m0, s29, 66432
    v_mfma_f32_16x16x32_bf16 v[84:87], a[132:135], v[32:35], v[84:87]
    buffer_load_dwordx4 v16, s[16:19], s34 offen offset:128 lds
    v_mfma_f32_16x16x32_bf16 v[88:91], a[128:131], v[36:39], v[88:91]
    ds_read_b128 v[60:63], v20 offset:50176
    v_mfma_f32_16x16x32_bf16 v[92:95], a[132:135], v[36:39], v[92:95]
    s_waitcnt lgkmcnt(4)
    v_mfma_f32_16x16x32_bf16 v[80:83], a[136:139], v[40:43], v[80:83]
    ds_read_b128 v[32:35], v19 offset:34816
    v_mfma_f32_16x16x32_bf16 v[84:87], a[140:143], v[40:43], v[84:87]
    v_mfma_f32_16x16x32_bf16 v[88:91], a[136:139], v[44:47], v[88:91]
    ds_read_b128 v[36:39], v19 offset:51200
    v_mfma_f32_16x16x32_bf16 v[92:95], a[140:143], v[44:47], v[92:95]
    s_waitcnt lgkmcnt(4)
    v_mfma_f32_16x16x32_bf16 v[80:83], a[144:147], v[48:51], v[80:83]
    ds_read_b128 v[40:43], v20 offset:34816
    s_add_u32 m0, s29, 67328
    v_mfma_f32_16x16x32_bf16 v[84:87], a[148:151], v[48:51], v[84:87]
    buffer_load_dwordx4 v16, s[16:19], s34 offen offset:256 lds
    v_mfma_f32_16x16x32_bf16 v[88:91], a[144:147], v[52:55], v[88:91]
    ds_read_b128 v[44:47], v20 offset:51200
    v_mfma_f32_16x16x32_bf16 v[92:95], a[148:151], v[52:55], v[92:95]
    s_waitcnt lgkmcnt(4)
    v_mfma_f32_16x16x32_bf16 v[80:83], a[152:155], v[56:59], v[80:83]
    ds_read_b128 v[48:51], v19 offset:35840
    v_mfma_f32_16x16x32_bf16 v[84:87], a[156:159], v[56:59], v[84:87]
    v_mfma_f32_16x16x32_bf16 v[88:91], a[152:155], v[60:63], v[88:91]
    ds_read_b128 v[52:55], v19 offset:52224
    v_mfma_f32_16x16x32_bf16 v[92:95], a[156:159], v[60:63], v[92:95]
    s_waitcnt lgkmcnt(4)
    v_mfma_f32_16x16x32_bf16 v[80:83], a[160:163], v[32:35], v[80:83]
    ds_read_b128 v[56:59], v20 offset:35840
    s_add_u32 m0, s29, 68224
    v_mfma_f32_16x16x32_bf16 v[84:87], a[164:167], v[32:35], v[84:87]
    buffer_load_dwordx4 v16, s[16:19], s34 offen offset:384 lds
    v_mfma_f32_16x16x32_bf16 v[88:91], a[160:163], v[36:39], v[88:91]
    ds_read_b128 v[60:63], v20 offset:52224
    v_mfma_f32_16x16x32_bf16 v[92:95], a[164:167], v[36:39], v[92:95]
    s_waitcnt lgkmcnt(4)
    v_mfma_f32_16x16x32_bf16 v[80:83], a[168:171], v[40:43], v[80:83]
    ds_read_b128 v[32:35], v19 offset:36864
    v_mfma_f32_16x16x32_bf16 v[84:87], a[172:175], v[40:43], v[84:87]
    v_mfma_f32_16x16x32_bf16 v[88:91], a[168:171], v[44:47], v[88:91]
    ds_read_b128 v[36:39], v19 offset:53248
    v_mfma_f32_16x16x32_bf16 v[92:95], a[172:175], v[44:47], v[92:95]
    s_waitcnt lgkmcnt(4)
    v_mfma_f32_16x16x32_bf16 v[80:83], a[176:179], v[48:51], v[80:83]
    ds_read_b128 v[40:43], v20 offset:36864
    s_add_u32 m0, s29, 69120
    v_mfma_f32_16x16x32_bf16 v[84:87], a[180:183], v[48:51], v[84:87]
    buffer_load_dwordx4 v16, s[16:19], s34 offen offset:512 lds
    v_mfma_f32_16x16x32_bf16 v[88:91], a[176:179], v[52:55], v[88:91]
    ds_read_b128 v[44:47], v20 offset:53248
    v_mfma_f32_16x16x32_bf16 v[92:95], a[180:183], v[52:55], v[92:95]
    s_waitcnt lgkmcnt(4)
    v_mfma_f32_16x16x32_bf16 v[80:83], a[184:187], v[56:59], v[80:83]
    ds_read_b128 v[48:51], v19 offset:37888
    v_mfma_f32_16x16x32_bf16 v[84:87], a[188:191], v[56:59], v[84:87]
    v_mfma_f32_16x16x32_bf16 v[88:91], a[184:187], v[60:63], v[88:91]
    ds_read_b128 v[52:55], v19 offset:54272
    v_mfma_f32_16x16x32_bf16 v[92:95], a[188:191], v[60:63], v[92:95]
    s_waitcnt lgkmcnt(4)
    v_mfma_f32_16x16x32_bf16 v[80:83], a[192:195], v[32:35], v[80:83]
    ds_read_b128 v[56:59], v20 offset:37888
    s_add_u32 m0, s29, 70016
    v_mfma_f32_16x16x32_bf16 v[84:87], a[196:199], v[32:35], v[84:87]
    buffer_load_dwordx4 v16, s[16:19], s34 offen offset:640 lds
    v_mfma_f32_16x16x32_bf16 v[88:91], a[192:195], v[36:39], v[88:91]
    ds_read_b128 v[60:63], v20 offset:54272
    v_mfma_f32_16x16x32_bf16 v[92:95], a[196:199], v[36:39], v[92:95]
    s_waitcnt lgkmcnt(4)
    v_mfma_f32_16x16x32_bf16 v[80:83], a[200:203], v[40:43], v[80:83]
    ds_read_b128 v[32:35], v19 offset:38912
    v_mfma_f32_16x16x32_bf16 v[84:87], a[204:207], v[40:43], v[84:87]
    v_mfma_f32_16x16x32_bf16 v[88:91], a[200:203], v[44:47], v[88:91]
    ds_read_b128 v[36:39], v19 offset:55296
    v_mfma_f32_16x16x32_bf16 v[92:95], a[204:207], v[44:47], v[92:95]
    s_waitcnt lgkmcnt(4)
    v_mfma_f32_16x16x32_bf16 v[80:83], a[208:211], v[48:51], v[80:83]
    ds_read_b128 v[40:43], v20 offset:38912
    s_add_u32 m0, s29, 70912
    v_mfma_f32_16x16x32_bf16 v[84:87], a[212:215], v[48:51], v[84:87]
    buffer_load_dwordx4 v16, s[16:19], s34 offen offset:768 lds
    v_mfma_f32_16x16x32_bf16 v[88:91], a[208:211], v[52:55], v[88:91]
    ds_read_b128 v[44:47], v20 offset:55296
    v_mfma_f32_16x16x32_bf16 v[92:95], a[212:215], v[52:55], v[92:95]
    s_waitcnt lgkmcnt(4)
    v_mfma_f32_16x16x32_bf16 v[80:83], a[216:219], v[56:59], v[80:83]
    ds_read_b128 v[48:51], v19 offset:39936
    v_mfma_f32_16x16x32_bf16 v[84:87], a[220:223], v[56:59], v[84:87]
    s_cmp_lt_u32 s35, 22
    s_cselect_b64 s[44:45], -1, 0
    v_mfma_f32_16x16x32_bf16 v[88:91], a[216:219], v[60:63], v[88:91]
    ds_read_b128 v[52:55], v19 offset:56320
    v_mfma_f32_16x16x32_bf16 v[92:95], a[220:223], v[60:63], v[92:95]
    s_cselect_b32 s4, 0x10000, 0
    s_add_u32 s46, s46, s4
    s_waitcnt lgkmcnt(4)
    v_mfma_f32_16x16x32_bf16 v[80:83], a[224:227], v[32:35], v[80:83]
    ds_read_b128 v[56:59], v20 offset:39936
    s_add_u32 m0, s29, 71808
    v_mfma_f32_16x16x32_bf16 v[84:87], a[228:231], v[32:35], v[84:87]
    buffer_load_dwordx4 v16, s[16:19], s34 offen offset:896 lds
    v_mfma_f32_16x16x32_bf16 v[88:91], a[224:227], v[36:39], v[88:91]
    ds_read_b128 v[60:63], v20 offset:56320
    v_mfma_f32_16x16x32_bf16 v[92:95], a[228:231], v[36:39], v[92:95]
    s_waitcnt lgkmcnt(4)
    v_mfma_f32_16x16x32_bf16 v[80:83], a[232:235], v[40:43], v[80:83]
    s_add_u32 s34, s34, 1024
    v_mfma_f32_16x16x32_bf16 v[84:87], a[236:239], v[40:43], v[84:87]
    v_mfma_f32_16x16x32_bf16 v[88:91], a[232:235], v[44:47], v[88:91]
    v_mfma_f32_16x16x32_bf16 v[92:95], a[236:239], v[44:47], v[92:95]
    s_waitcnt lgkmcnt(0)
    s_waitcnt vmcnt(13)
    s_barrier
    ds_read_b128 v[32:35], v17 offset:0
    ds_read_b128 v[36:39], v17 offset:16384
    v_mfma_f32_16x16x32_bf16 v[80:83], a[240:243], v[48:51], v[80:83]
    ds_read_b128 v[40:43], v18 offset:0
    s_add_u32 m0, s29, 98304
    v_mfma_f32_16x16x32_bf16 v[84:87], a[244:247], v[48:51], v[84:87]
    buffer_load_dwordx4 v16, s[16:19], s34 offen offset:0 lds
    v_mfma_f32_16x16x32_bf16 v[88:91], a[240:243], v[52:55], v[88:91]
    ds_read_b128 v[44:47], v18 offset:16384
    v_mfma_f32_16x16x32_bf16 v[92:95], a[244:247], v[52:55], v[92:95]
    v_mfma_f32_16x16x32_bf16 v[80:83], a[248:251], v[56:59], v[80:83]
    ds_read_b128 v[48:51], v17 offset:1024
    v_mfma_f32_16x16x32_bf16 v[84:87], a[252:255], v[56:59], v[84:87]
    v_mfma_f32_16x16x32_bf16 v[88:91], a[248:251], v[60:63], v[88:91]
    ds_read_b128 v[52:55], v17 offset:17408
    v_mfma_f32_16x16x32_bf16 v[92:95], a[252:255], v[60:63], v[92:95]
    s_mov_b64 exec, s[36:37]
    buffer_store_dword v23, v22, s[8:11], s33 offen sc1
    s_mov_b64 exec, -1

    s_add_u32 s35, s35, 1
    s_cmp_lt_u32 s35, 32
    s_cbranch_scc1 .ql_409

    s_nop 7
    v_cvt_pk_bf16_f32 v96, v80, v81
    v_cvt_pk_bf16_f32 v97, v82, v83
    v_cvt_pk_bf16_f32 v98, v84, v85
    v_cvt_pk_bf16_f32 v99, v86, v87
    buffer_store_dwordx4 v[96:99], v21, s[8:11], s32 offen sc1
    v_cvt_pk_bf16_f32 v100, v88, v89
    v_cvt_pk_bf16_f32 v101, v90, v91
    v_cvt_pk_bf16_f32 v102, v92, v93
    v_cvt_pk_bf16_f32 v103, v94, v95
    buffer_store_dwordx4 v[100:103], v21, s[8:11], s38 offen sc1
    s_mov_b32 exec_hi, 0
    buffer_store_dwordx4 v[24:27], v21, s[8:11], s48 offen sc1
    s_mov_b32 exec_hi, -1

    v_mov_b32 v23, 64
    s_waitcnt vmcnt(0) lgkmcnt(0)
    s_barrier
    s_mov_b64 exec, s[36:37]
    buffer_store_dword v23, v22, s[8:11], s33 offen sc1
    s_mov_b64 exec, -1

    s_branch .qd_389
.qv_388:
    s_waitcnt vmcnt(16)
    s_barrier
    ds_read_b128 v[32:35], v19 offset:0
    ds_read_b128 v[36:39], v19 offset:16384
    ds_read_b128 v[40:43], v20 offset:0
    ds_read_b128 v[44:47], v20 offset:16384
    s_add_u32 m0, s29, 32768
    s_nop 0
    buffer_load_dwordx4 v16, s[16:19], s34 offen offset:0 lds
    ds_read_b128 v[48:51], v19 offset:1024
    ds_read_b128 v[52:55], v19 offset:17408
    s_branch .qe_414
.p2align 6
.ql_413:
    s_waitcnt lgkmcnt(4)
    v_mfma_f32_16x16x32_bf16 v[64:67], v[32:35], a[0:3], 0
    ds_read_b128 v[56:59], v18 offset:1024
    s_add_u32 m0, s29, 99200
    v_mfma_f32_16x16x32_bf16 v[68:71], v[32:35], a[4:7], 0
    buffer_load_dwordx4 v16, s[16:19], s34 offen offset:128 lds
    v_mfma_f32_16x16x32_bf16 v[72:75], v[36:39], a[0:3], 0
    ds_read_b128 v[60:63], v18 offset:17408
    v_mfma_f32_16x16x32_bf16 v[76:79], v[36:39], a[4:7], 0
    s_mov_b32 exec_hi, 0
    buffer_store_dwordx4 v[24:27], v21, s[8:11], s48 offen sc1
    s_mov_b32 exec_hi, -1

    s_waitcnt lgkmcnt(4)
    v_mfma_f32_16x16x32_bf16 v[64:67], v[40:43], a[8:11], v[64:67]
    ds_read_b128 v[32:35], v17 offset:2048
    v_mfma_f32_16x16x32_bf16 v[68:71], v[40:43], a[12:15], v[68:71]
    v_cvt_pk_bf16_f32 v96, v80, v81
    v_cvt_pk_bf16_f32 v97, v82, v83
    v_cvt_pk_bf16_f32 v98, v88, v89
    v_mfma_f32_16x16x32_bf16 v[72:75], v[44:47], a[8:11], v[72:75]
    ds_read_b128 v[36:39], v17 offset:18432
    v_mfma_f32_16x16x32_bf16 v[76:79], v[44:47], a[12:15], v[76:79]
    v_cvt_pk_bf16_f32 v99, v90, v91
    v_cvt_pk_bf16_f32 v100, v84, v85
    buffer_store_dwordx4 v[96:99], v21, s[8:11], s32 offen offset:0 sc1
    s_waitcnt lgkmcnt(4)
    v_mfma_f32_16x16x32_bf16 v[64:67], v[48:51], a[16:19], v[64:67]
    ds_read_b128 v[40:43], v18 offset:2048
    s_add_u32 m0, s29, 100096
    v_mfma_f32_16x16x32_bf16 v[68:71], v[48:51], a[20:23], v[68:71]
    buffer_load_dwordx4 v16, s[16:19], s34 offen offset:256 lds
    v_mfma_f32_16x16x32_bf16 v[72:75], v[52:55], a[16:19], v[72:75]
    ds_read_b128 v[44:47], v18 offset:18432
    v_mfma_f32_16x16x32_bf16 v[76:79], v[52:55], a[20:23], v[76:79]
    v_cvt_pk_bf16_f32 v101, v86, v87
    v_cvt_pk_bf16_f32 v102, v92, v93
    v_cvt_pk_bf16_f32 v103, v94, v95
    s_waitcnt lgkmcnt(4)
    v_mfma_f32_16x16x32_bf16 v[64:67], v[56:59], a[24:27], v[64:67]
    ds_read_b128 v[48:51], v17 offset:3072
    v_mfma_f32_16x16x32_bf16 v[68:71], v[56:59], a[28:31], v[68:71]
    buffer_store_dwordx4 v[100:103], v21, s[8:11], s32 offen offset:1024 sc1
    v_mfma_f32_16x16x32_bf16 v[72:75], v[60:63], a[24:27], v[72:75]
    ds_read_b128 v[52:55], v17 offset:19456
    v_mfma_f32_16x16x32_bf16 v[76:79], v[60:63], a[28:31], v[76:79]
    s_waitcnt lgkmcnt(4)
    v_mfma_f32_16x16x32_bf16 v[64:67], v[32:35], a[32:35], v[64:67]
    ds_read_b128 v[56:59], v18 offset:3072
    s_add_u32 m0, s29, 100992
    v_mfma_f32_16x16x32_bf16 v[68:71], v[32:35], a[36:39], v[68:71]
    buffer_load_dwordx4 v16, s[16:19], s34 offen offset:384 lds
    v_mfma_f32_16x16x32_bf16 v[72:75], v[36:39], a[32:35], v[72:75]
    ds_read_b128 v[60:63], v18 offset:19456
    v_mfma_f32_16x16x32_bf16 v[76:79], v[36:39], a[36:39], v[76:79]
    s_waitcnt lgkmcnt(4)
    v_mfma_f32_16x16x32_bf16 v[64:67], v[40:43], a[40:43], v[64:67]
    ds_read_b128 v[32:35], v17 offset:4096
    v_mfma_f32_16x16x32_bf16 v[68:71], v[40:43], a[44:47], v[68:71]
    v_mfma_f32_16x16x32_bf16 v[72:75], v[44:47], a[40:43], v[72:75]
    ds_read_b128 v[36:39], v17 offset:20480
    v_mfma_f32_16x16x32_bf16 v[76:79], v[44:47], a[44:47], v[76:79]
    s_waitcnt lgkmcnt(4)
    v_mfma_f32_16x16x32_bf16 v[64:67], v[48:51], a[48:51], v[64:67]
    ds_read_b128 v[40:43], v18 offset:4096
    s_add_u32 m0, s29, 101888
    v_mfma_f32_16x16x32_bf16 v[68:71], v[48:51], a[52:55], v[68:71]
    buffer_load_dwordx4 v16, s[16:19], s34 offen offset:512 lds
    v_mfma_f32_16x16x32_bf16 v[72:75], v[52:55], a[48:51], v[72:75]
    ds_read_b128 v[44:47], v18 offset:20480
    v_mfma_f32_16x16x32_bf16 v[76:79], v[52:55], a[52:55], v[76:79]
    s_waitcnt lgkmcnt(4)
    v_mfma_f32_16x16x32_bf16 v[64:67], v[56:59], a[56:59], v[64:67]
    ds_read_b128 v[48:51], v17 offset:5120
    v_mfma_f32_16x16x32_bf16 v[68:71], v[56:59], a[60:63], v[68:71]
    v_mfma_f32_16x16x32_bf16 v[72:75], v[60:63], a[56:59], v[72:75]
    ds_read_b128 v[52:55], v17 offset:21504
    v_mfma_f32_16x16x32_bf16 v[76:79], v[60:63], a[60:63], v[76:79]
    s_waitcnt lgkmcnt(4)
    v_mfma_f32_16x16x32_bf16 v[64:67], v[32:35], a[64:67], v[64:67]
    ds_read_b128 v[56:59], v18 offset:5120
    s_add_u32 m0, s29, 102784
    v_mfma_f32_16x16x32_bf16 v[68:71], v[32:35], a[68:71], v[68:71]
    buffer_load_dwordx4 v16, s[16:19], s34 offen offset:640 lds
    v_mfma_f32_16x16x32_bf16 v[72:75], v[36:39], a[64:67], v[72:75]
    ds_read_b128 v[60:63], v18 offset:21504
    v_mfma_f32_16x16x32_bf16 v[76:79], v[36:39], a[68:71], v[76:79]
    s_waitcnt lgkmcnt(4)
    v_mfma_f32_16x16x32_bf16 v[64:67], v[40:43], a[72:75], v[64:67]
    ds_read_b128 v[32:35], v17 offset:6144
    v_mfma_f32_16x16x32_bf16 v[68:71], v[40:43], a[76:79], v[68:71]
    s_mov_b32 s32, s39
    s_add_u32 s38, s39, 4096
    s_add_u32 s39, s39, 262144
    s_mov_b32 s48, s49
    s_add_u32 s49, s49, 196608
    v_mfma_f32_16x16x32_bf16 v[72:75], v[44:47], a[72:75], v[72:75]
    ds_read_b128 v[36:39], v17 offset:22528
    v_mfma_f32_16x16x32_bf16 v[76:79], v[44:47], a[76:79], v[76:79]
    v_add_u32 v23, 1, v23
    s_waitcnt lgkmcnt(4)
    v_mfma_f32_16x16x32_bf16 v[64:67], v[48:51], a[80:83], v[64:67]
    ds_read_b128 v[40:43], v18 offset:6144
    s_add_u32 m0, s29, 103680
    v_mfma_f32_16x16x32_bf16 v[68:71], v[48:51], a[84:87], v[68:71]
    buffer_load_dwordx4 v16, s[16:19], s34 offen offset:768 lds
    v_mfma_f32_16x16x32_bf16 v[72:75], v[52:55], a[80:83], v[72:75]
    ds_read_b128 v[44:47], v18 offset:22528
    v_mfma_f32_16x16x32_bf16 v[76:79], v[52:55], a[84:87], v[76:79]
    s_waitcnt lgkmcnt(4)
    v_mfma_f32_16x16x32_bf16 v[64:67], v[56:59], a[88:91], v[64:67]
    ds_read_b128 v[48:51], v17 offset:7168
    v_mfma_f32_16x16x32_bf16 v[68:71], v[56:59], a[92:95], v[68:71]
    v_mfma_f32_16x16x32_bf16 v[72:75], v[60:63], a[88:91], v[72:75]
    ds_read_b128 v[52:55], v17 offset:23552
    v_mfma_f32_16x16x32_bf16 v[76:79], v[60:63], a[92:95], v[76:79]
    s_mov_b64 exec, s[44:45]
    buffer_store_dwordx4 v[24:27], v28, s[8:11], s46 offen sc1
    s_mov_b64 exec, -1
    s_waitcnt lgkmcnt(4)
    v_mfma_f32_16x16x32_bf16 v[64:67], v[32:35], a[96:99], v[64:67]
    ds_read_b128 v[56:59], v18 offset:7168
    s_add_u32 m0, s29, 104576
    v_mfma_f32_16x16x32_bf16 v[68:71], v[32:35], a[100:103], v[68:71]
    buffer_load_dwordx4 v16, s[16:19], s34 offen offset:896 lds
    v_mfma_f32_16x16x32_bf16 v[72:75], v[36:39], a[96:99], v[72:75]
    ds_read_b128 v[60:63], v18 offset:23552
    v_mfma_f32_16x16x32_bf16 v[76:79], v[36:39], a[100:103], v[76:79]
    s_waitcnt lgkmcnt(4)
    v_mfma_f32_16x16x32_bf16 v[64:67], v[40:43], a[104:107], v[64:67]
    s_add_u32 s34, s34, 64512
    s_min_u32 s34, s34, 4128768
    v_mfma_f32_16x16x32_bf16 v[68:71], v[40:43], a[108:111], v[68:71]
    v_mfma_f32_16x16x32_bf16 v[72:75], v[44:47], a[104:107], v[72:75]
    v_mfma_f32_16x16x32_bf16 v[76:79], v[44:47], a[108:111], v[76:79]
    s_waitcnt lgkmcnt(0)
    s_cmp_lt_u32 s35, 2
    s_cselect_b64 s[70:71], s[36:37], 0
    s_cbranch_scc0 .ef_415
    s_waitcnt vmcnt(5)
.ef_415:
    s_waitcnt vmcnt(19)
    s_barrier
    ds_read_b128 v[32:35], v17 offset:32768
    ds_read_b128 v[36:39], v17 offset:49152
    v_mfma_f32_16x16x32_bf16 v[64:67], v[48:51], a[112:115], v[64:67]
    ds_read_b128 v[40:43], v18 offset:32768
    s_add_u32 m0, s29, 0
    v_mfma_f32_16x16x32_bf16 v[68:71], v[48:51], a[116:119], v[68:71]
    buffer_load_dwordx4 v16, s[16:19], s34 offen offset:0 lds
    v_mfma_f32_16x16x32_bf16 v[72:75], v[52:55], a[112:115], v[72:75]
    ds_read_b128 v[44:47], v18 offset:49152
    v_mfma_f32_16x16x32_bf16 v[76:79], v[52:55], a[116:119], v[76:79]
    v_mfma_f32_16x16x32_bf16 v[64:67], v[56:59], a[120:123], v[64:67]
    ds_read_b128 v[48:51], v17 offset:33792
    v_mfma_f32_16x16x32_bf16 v[68:71], v[56:59], a[124:127], v[68:71]
    v_mfma_f32_16x16x32_bf16 v[72:75], v[60:63], a[120:123], v[72:75]
    ds_read_b128 v[52:55], v17 offset:50176
    v_mfma_f32_16x16x32_bf16 v[76:79], v[60:63], a[124:127], v[76:79]
    s_mov_b64 exec, s[70:71]
    buffer_store_dword v23, v22, s[8:11], s33 offen sc1
    s_mov_b64 exec, -1

    s_waitcnt lgkmcnt(4)
    v_mfma_f32_16x16x32_bf16 v[64:67], v[32:35], a[128:131], v[64:67]
    ds_read_b128 v[56:59], v18 offset:33792
    s_add_u32 m0, s29, 896
    v_mfma_f32_16x16x32_bf16 v[68:71], v[32:35], a[132:135], v[68:71]
    buffer_load_dwordx4 v16, s[16:19], s34 offen offset:128 lds
    v_mfma_f32_16x16x32_bf16 v[72:75], v[36:39], a[128:131], v[72:75]
    ds_read_b128 v[60:63], v18 offset:50176
    v_mfma_f32_16x16x32_bf16 v[76:79], v[36:39], a[132:135], v[76:79]
    s_waitcnt lgkmcnt(4)
    v_mfma_f32_16x16x32_bf16 v[64:67], v[40:43], a[136:139], v[64:67]
    ds_read_b128 v[32:35], v17 offset:34816
    v_mfma_f32_16x16x32_bf16 v[68:71], v[40:43], a[140:143], v[68:71]
    v_mfma_f32_16x16x32_bf16 v[72:75], v[44:47], a[136:139], v[72:75]
    ds_read_b128 v[36:39], v17 offset:51200
    v_mfma_f32_16x16x32_bf16 v[76:79], v[44:47], a[140:143], v[76:79]
    s_waitcnt lgkmcnt(4)
    v_mfma_f32_16x16x32_bf16 v[64:67], v[48:51], a[144:147], v[64:67]
    ds_read_b128 v[40:43], v18 offset:34816
    s_add_u32 m0, s29, 1792
    v_mfma_f32_16x16x32_bf16 v[68:71], v[48:51], a[148:151], v[68:71]
    buffer_load_dwordx4 v16, s[16:19], s34 offen offset:256 lds
    v_mfma_f32_16x16x32_bf16 v[72:75], v[52:55], a[144:147], v[72:75]
    ds_read_b128 v[44:47], v18 offset:51200
    v_mfma_f32_16x16x32_bf16 v[76:79], v[52:55], a[148:151], v[76:79]
    s_waitcnt lgkmcnt(4)
    v_mfma_f32_16x16x32_bf16 v[64:67], v[56:59], a[152:155], v[64:67]
    ds_read_b128 v[48:51], v17 offset:35840
    v_mfma_f32_16x16x32_bf16 v[68:71], v[56:59], a[156:159], v[68:71]
    v_mfma_f32_16x16x32_bf16 v[72:75], v[60:63], a[152:155], v[72:75]
    ds_read_b128 v[52:55], v17 offset:52224
    v_mfma_f32_16x16x32_bf16 v[76:79], v[60:63], a[156:159], v[76:79]
    s_waitcnt lgkmcnt(4)
    v_mfma_f32_16x16x32_bf16 v[64:67], v[32:35], a[160:163], v[64:67]
    ds_read_b128 v[56:59], v18 offset:35840
    s_add_u32 m0, s29, 2688
    v_mfma_f32_16x16x32_bf16 v[68:71], v[32:35], a[164:167], v[68:71]
    buffer_load_dwordx4 v16, s[16:19], s34 offen offset:384 lds
    v_mfma_f32_16x16x32_bf16 v[72:75], v[36:39], a[160:163], v[72:75]
    ds_read_b128 v[60:63], v18 offset:52224
    v_mfma_f32_16x16x32_bf16 v[76:79], v[36:39], a[164:167], v[76:79]
    s_waitcnt lgkmcnt(4)
    v_mfma_f32_16x16x32_bf16 v[64:67], v[40:43], a[168:171], v[64:67]
    ds_read_b128 v[32:35], v17 offset:36864
    v_mfma_f32_16x16x32_bf16 v[68:71], v[40:43], a[172:175], v[68:71]
    v_mfma_f32_16x16x32_bf16 v[72:75], v[44:47], a[168:171], v[72:75]
    ds_read_b128 v[36:39], v17 offset:53248
    v_mfma_f32_16x16x32_bf16 v[76:79], v[44:47], a[172:175], v[76:79]
    s_waitcnt lgkmcnt(4)
    v_mfma_f32_16x16x32_bf16 v[64:67], v[48:51], a[176:179], v[64:67]
    ds_read_b128 v[40:43], v18 offset:36864
    s_add_u32 m0, s29, 3584
    v_mfma_f32_16x16x32_bf16 v[68:71], v[48:51], a[180:183], v[68:71]
    buffer_load_dwordx4 v16, s[16:19], s34 offen offset:512 lds
    v_mfma_f32_16x16x32_bf16 v[72:75], v[52:55], a[176:179], v[72:75]
    ds_read_b128 v[44:47], v18 offset:53248
    v_mfma_f32_16x16x32_bf16 v[76:79], v[52:55], a[180:183], v[76:79]
    s_waitcnt lgkmcnt(4)
    v_mfma_f32_16x16x32_bf16 v[64:67], v[56:59], a[184:187], v[64:67]
    ds_read_b128 v[48:51], v17 offset:37888
    v_mfma_f32_16x16x32_bf16 v[68:71], v[56:59], a[188:191], v[68:71]
    v_mfma_f32_16x16x32_bf16 v[72:75], v[60:63], a[184:187], v[72:75]
    ds_read_b128 v[52:55], v17 offset:54272
    v_mfma_f32_16x16x32_bf16 v[76:79], v[60:63], a[188:191], v[76:79]
    s_waitcnt lgkmcnt(4)
    v_mfma_f32_16x16x32_bf16 v[64:67], v[32:35], a[192:195], v[64:67]
    ds_read_b128 v[56:59], v18 offset:37888
    s_add_u32 m0, s29, 4480
    v_mfma_f32_16x16x32_bf16 v[68:71], v[32:35], a[196:199], v[68:71]
    buffer_load_dwordx4 v16, s[16:19], s34 offen offset:640 lds
    v_mfma_f32_16x16x32_bf16 v[72:75], v[36:39], a[192:195], v[72:75]
    ds_read_b128 v[60:63], v18 offset:54272
    v_mfma_f32_16x16x32_bf16 v[76:79], v[36:39], a[196:199], v[76:79]
    s_waitcnt lgkmcnt(4)
    v_mfma_f32_16x16x32_bf16 v[64:67], v[40:43], a[200:203], v[64:67]
    ds_read_b128 v[32:35], v17 offset:38912
    v_mfma_f32_16x16x32_bf16 v[68:71], v[40:43], a[204:207], v[68:71]
    v_mfma_f32_16x16x32_bf16 v[72:75], v[44:47], a[200:203], v[72:75]
    ds_read_b128 v[36:39], v17 offset:55296
    v_mfma_f32_16x16x32_bf16 v[76:79], v[44:47], a[204:207], v[76:79]
    s_waitcnt lgkmcnt(4)
    v_mfma_f32_16x16x32_bf16 v[64:67], v[48:51], a[208:211], v[64:67]
    ds_read_b128 v[40:43], v18 offset:38912
    s_add_u32 m0, s29, 5376
    v_mfma_f32_16x16x32_bf16 v[68:71], v[48:51], a[212:215], v[68:71]
    buffer_load_dwordx4 v16, s[16:19], s34 offen offset:768 lds
    v_mfma_f32_16x16x32_bf16 v[72:75], v[52:55], a[208:211], v[72:75]
    ds_read_b128 v[44:47], v18 offset:55296
    v_mfma_f32_16x16x32_bf16 v[76:79], v[52:55], a[212:215], v[76:79]
    s_waitcnt lgkmcnt(4)
    v_mfma_f32_16x16x32_bf16 v[64:67], v[56:59], a[216:219], v[64:67]
    ds_read_b128 v[48:51], v17 offset:39936
    v_mfma_f32_16x16x32_bf16 v[68:71], v[56:59], a[220:223], v[68:71]
    v_mfma_f32_16x16x32_bf16 v[72:75], v[60:63], a[216:219], v[72:75]
    ds_read_b128 v[52:55], v17 offset:56320
    v_mfma_f32_16x16x32_bf16 v[76:79], v[60:63], a[220:223], v[76:79]
    s_mov_b64 exec, s[44:45]
    buffer_store_dwordx4 v[24:27], v29, s[8:11], s46 offen sc1
    s_mov_b64 exec, -1
    s_waitcnt lgkmcnt(4)
    v_mfma_f32_16x16x32_bf16 v[64:67], v[32:35], a[224:227], v[64:67]
    ds_read_b128 v[56:59], v18 offset:39936
    s_add_u32 m0, s29, 6272
    v_mfma_f32_16x16x32_bf16 v[68:71], v[32:35], a[228:231], v[68:71]
    buffer_load_dwordx4 v16, s[16:19], s34 offen offset:896 lds
    v_mfma_f32_16x16x32_bf16 v[72:75], v[36:39], a[224:227], v[72:75]
    ds_read_b128 v[60:63], v18 offset:56320
    v_mfma_f32_16x16x32_bf16 v[76:79], v[36:39], a[228:231], v[76:79]
    s_waitcnt lgkmcnt(4)
    v_mfma_f32_16x16x32_bf16 v[64:67], v[40:43], a[232:235], v[64:67]
    s_add_u32 s34, s34, 1024
    v_mfma_f32_16x16x32_bf16 v[68:71], v[40:43], a[236:239], v[68:71]
    v_mfma_f32_16x16x32_bf16 v[72:75], v[44:47], a[232:235], v[72:75]
    v_mfma_f32_16x16x32_bf16 v[76:79], v[44:47], a[236:239], v[76:79]
    s_waitcnt lgkmcnt(0)
    s_waitcnt vmcnt(13)
    s_barrier
    ds_read_b128 v[32:35], v19 offset:0
    ds_read_b128 v[36:39], v19 offset:16384
    v_mfma_f32_16x16x32_bf16 v[64:67], v[48:51], a[240:243], v[64:67]
    ds_read_b128 v[40:43], v20 offset:0
    s_add_u32 m0, s29, 32768
    v_mfma_f32_16x16x32_bf16 v[68:71], v[48:51], a[244:247], v[68:71]
    buffer_load_dwordx4 v16, s[16:19], s34 offen offset:0 lds
    v_mfma_f32_16x16x32_bf16 v[72:75], v[52:55], a[240:243], v[72:75]
    ds_read_b128 v[44:47], v20 offset:16384
    v_mfma_f32_16x16x32_bf16 v[76:79], v[52:55], a[244:247], v[76:79]
    v_mfma_f32_16x16x32_bf16 v[64:67], v[56:59], a[248:251], v[64:67]
    ds_read_b128 v[48:51], v19 offset:1024
    v_mfma_f32_16x16x32_bf16 v[68:71], v[56:59], a[252:255], v[68:71]
    v_mfma_f32_16x16x32_bf16 v[72:75], v[60:63], a[248:251], v[72:75]
    ds_read_b128 v[52:55], v19 offset:17408
    v_mfma_f32_16x16x32_bf16 v[76:79], v[60:63], a[252:255], v[76:79]
    s_mov_b64 exec, s[36:37]
    buffer_store_dword v23, v22, s[8:11], s33 offen sc1
    s_mov_b64 exec, -1

.qe_414:
    s_waitcnt lgkmcnt(4)
    v_mfma_f32_16x16x32_bf16 v[80:83], v[32:35], a[0:3], 0
    ds_read_b128 v[56:59], v20 offset:1024
    s_add_u32 m0, s29, 33664
    v_mfma_f32_16x16x32_bf16 v[84:87], v[32:35], a[4:7], 0
    buffer_load_dwordx4 v16, s[16:19], s34 offen offset:128 lds
    v_mfma_f32_16x16x32_bf16 v[88:91], v[36:39], a[0:3], 0
    ds_read_b128 v[60:63], v20 offset:17408
    v_mfma_f32_16x16x32_bf16 v[92:95], v[36:39], a[4:7], 0
    s_mov_b32 exec_hi, 0
    buffer_store_dwordx4 v[24:27], v21, s[8:11], s48 offen sc1
    s_mov_b32 exec_hi, -1

    s_waitcnt lgkmcnt(4)
    v_mfma_f32_16x16x32_bf16 v[80:83], v[40:43], a[8:11], v[80:83]
    ds_read_b128 v[32:35], v19 offset:2048
    v_mfma_f32_16x16x32_bf16 v[84:87], v[40:43], a[12:15], v[84:87]
    v_cvt_pk_bf16_f32 v96, v64, v65
    v_cvt_pk_bf16_f32 v97, v66, v67
    v_cvt_pk_bf16_f32 v98, v72, v73
    v_mfma_f32_16x16x32_bf16 v[88:91], v[44:47], a[8:11], v[88:91]
    ds_read_b128 v[36:39], v19 offset:18432
    v_mfma_f32_16x16x32_bf16 v[92:95], v[44:47], a[12:15], v[92:95]
    v_cvt_pk_bf16_f32 v99, v74, v75
    v_cvt_pk_bf16_f32 v100, v68, v69
    buffer_store_dwordx4 v[96:99], v21, s[8:11], s32 offen offset:0 sc1
    s_waitcnt lgkmcnt(4)
    v_mfma_f32_16x16x32_bf16 v[80:83], v[48:51], a[16:19], v[80:83]
    ds_read_b128 v[40:43], v20 offset:2048
    s_add_u32 m0, s29, 34560
    v_mfma_f32_16x16x32_bf16 v[84:87], v[48:51], a[20:23], v[84:87]
    buffer_load_dwordx4 v16, s[16:19], s34 offen offset:256 lds
    v_mfma_f32_16x16x32_bf16 v[88:91], v[52:55], a[16:19], v[88:91]
    ds_read_b128 v[44:47], v20 offset:18432
    v_mfma_f32_16x16x32_bf16 v[92:95], v[52:55], a[20:23], v[92:95]
    v_cvt_pk_bf16_f32 v101, v70, v71
    v_cvt_pk_bf16_f32 v102, v76, v77
    v_cvt_pk_bf16_f32 v103, v78, v79
    s_waitcnt lgkmcnt(4)
    v_mfma_f32_16x16x32_bf16 v[80:83], v[56:59], a[24:27], v[80:83]
    ds_read_b128 v[48:51], v19 offset:3072
    v_mfma_f32_16x16x32_bf16 v[84:87], v[56:59], a[28:31], v[84:87]
    buffer_store_dwordx4 v[100:103], v21, s[8:11], s32 offen offset:1024 sc1
    v_mfma_f32_16x16x32_bf16 v[88:91], v[60:63], a[24:27], v[88:91]
    ds_read_b128 v[52:55], v19 offset:19456
    v_mfma_f32_16x16x32_bf16 v[92:95], v[60:63], a[28:31], v[92:95]
    s_waitcnt lgkmcnt(4)
    v_mfma_f32_16x16x32_bf16 v[80:83], v[32:35], a[32:35], v[80:83]
    ds_read_b128 v[56:59], v20 offset:3072
    s_add_u32 m0, s29, 35456
    v_mfma_f32_16x16x32_bf16 v[84:87], v[32:35], a[36:39], v[84:87]
    buffer_load_dwordx4 v16, s[16:19], s34 offen offset:384 lds
    v_mfma_f32_16x16x32_bf16 v[88:91], v[36:39], a[32:35], v[88:91]
    ds_read_b128 v[60:63], v20 offset:19456
    v_mfma_f32_16x16x32_bf16 v[92:95], v[36:39], a[36:39], v[92:95]
    s_waitcnt lgkmcnt(4)
    v_mfma_f32_16x16x32_bf16 v[80:83], v[40:43], a[40:43], v[80:83]
    ds_read_b128 v[32:35], v19 offset:4096
    v_mfma_f32_16x16x32_bf16 v[84:87], v[40:43], a[44:47], v[84:87]
    v_mfma_f32_16x16x32_bf16 v[88:91], v[44:47], a[40:43], v[88:91]
    ds_read_b128 v[36:39], v19 offset:20480
    v_mfma_f32_16x16x32_bf16 v[92:95], v[44:47], a[44:47], v[92:95]
    s_waitcnt lgkmcnt(4)
    v_mfma_f32_16x16x32_bf16 v[80:83], v[48:51], a[48:51], v[80:83]
    ds_read_b128 v[40:43], v20 offset:4096
    s_add_u32 m0, s29, 36352
    v_mfma_f32_16x16x32_bf16 v[84:87], v[48:51], a[52:55], v[84:87]
    buffer_load_dwordx4 v16, s[16:19], s34 offen offset:512 lds
    v_mfma_f32_16x16x32_bf16 v[88:91], v[52:55], a[48:51], v[88:91]
    ds_read_b128 v[44:47], v20 offset:20480
    v_mfma_f32_16x16x32_bf16 v[92:95], v[52:55], a[52:55], v[92:95]
    s_waitcnt lgkmcnt(4)
    v_mfma_f32_16x16x32_bf16 v[80:83], v[56:59], a[56:59], v[80:83]
    ds_read_b128 v[48:51], v19 offset:5120
    v_mfma_f32_16x16x32_bf16 v[84:87], v[56:59], a[60:63], v[84:87]
    v_mfma_f32_16x16x32_bf16 v[88:91], v[60:63], a[56:59], v[88:91]
    ds_read_b128 v[52:55], v19 offset:21504
    v_mfma_f32_16x16x32_bf16 v[92:95], v[60:63], a[60:63], v[92:95]
    s_waitcnt lgkmcnt(4)
    v_mfma_f32_16x16x32_bf16 v[80:83], v[32:35], a[64:67], v[80:83]
    ds_read_b128 v[56:59], v20 offset:5120
    s_add_u32 m0, s29, 37248
    v_mfma_f32_16x16x32_bf16 v[84:87], v[32:35], a[68:71], v[84:87]
    buffer_load_dwordx4 v16, s[16:19], s34 offen offset:640 lds
    v_mfma_f32_16x16x32_bf16 v[88:91], v[36:39], a[64:67], v[88:91]
    ds_read_b128 v[60:63], v20 offset:21504
    v_mfma_f32_16x16x32_bf16 v[92:95], v[36:39], a[68:71], v[92:95]
    s_waitcnt lgkmcnt(4)
    v_mfma_f32_16x16x32_bf16 v[80:83], v[40:43], a[72:75], v[80:83]
    ds_read_b128 v[32:35], v19 offset:6144
    v_mfma_f32_16x16x32_bf16 v[84:87], v[40:43], a[76:79], v[84:87]
    s_mov_b32 s32, s39
    s_add_u32 s38, s39, 4096
    s_add_u32 s39, s39, 262144
    s_mov_b32 s48, s49
    s_add_u32 s49, s49, 196608
    v_mfma_f32_16x16x32_bf16 v[88:91], v[44:47], a[72:75], v[88:91]
    ds_read_b128 v[36:39], v19 offset:22528
    v_mfma_f32_16x16x32_bf16 v[92:95], v[44:47], a[76:79], v[92:95]
    v_add_u32 v23, 1, v23
    s_waitcnt lgkmcnt(4)
    v_mfma_f32_16x16x32_bf16 v[80:83], v[48:51], a[80:83], v[80:83]
    ds_read_b128 v[40:43], v20 offset:6144
    s_add_u32 m0, s29, 38144
    v_mfma_f32_16x16x32_bf16 v[84:87], v[48:51], a[84:87], v[84:87]
    buffer_load_dwordx4 v16, s[16:19], s34 offen offset:768 lds
    v_mfma_f32_16x16x32_bf16 v[88:91], v[52:55], a[80:83], v[88:91]
    ds_read_b128 v[44:47], v20 offset:22528
    v_mfma_f32_16x16x32_bf16 v[92:95], v[52:55], a[84:87], v[92:95]
    s_waitcnt lgkmcnt(4)
    v_mfma_f32_16x16x32_bf16 v[80:83], v[56:59], a[88:91], v[80:83]
    ds_read_b128 v[48:51], v19 offset:7168
    v_mfma_f32_16x16x32_bf16 v[84:87], v[56:59], a[92:95], v[84:87]
    v_mfma_f32_16x16x32_bf16 v[88:91], v[60:63], a[88:91], v[88:91]
    ds_read_b128 v[52:55], v19 offset:23552
    v_mfma_f32_16x16x32_bf16 v[92:95], v[60:63], a[92:95], v[92:95]
    s_mov_b64 exec, s[44:45]
    buffer_store_dwordx4 v[24:27], v30, s[8:11], s46 offen sc1
    s_mov_b64 exec, -1
    s_waitcnt lgkmcnt(4)
    v_mfma_f32_16x16x32_bf16 v[80:83], v[32:35], a[96:99], v[80:83]
    ds_read_b128 v[56:59], v20 offset:7168
    s_add_u32 m0, s29, 39040
    v_mfma_f32_16x16x32_bf16 v[84:87], v[32:35], a[100:103], v[84:87]
    buffer_load_dwordx4 v16, s[16:19], s34 offen offset:896 lds
    v_mfma_f32_16x16x32_bf16 v[88:91], v[36:39], a[96:99], v[88:91]
    ds_read_b128 v[60:63], v20 offset:23552
    v_mfma_f32_16x16x32_bf16 v[92:95], v[36:39], a[100:103], v[92:95]
    s_waitcnt lgkmcnt(4)
    v_mfma_f32_16x16x32_bf16 v[80:83], v[40:43], a[104:107], v[80:83]
    s_add_u32 s34, s34, 64512
    s_min_u32 s34, s34, 4128768
    v_mfma_f32_16x16x32_bf16 v[84:87], v[40:43], a[108:111], v[84:87]
    v_mfma_f32_16x16x32_bf16 v[88:91], v[44:47], a[104:107], v[88:91]
    v_mfma_f32_16x16x32_bf16 v[92:95], v[44:47], a[108:111], v[92:95]
    s_waitcnt lgkmcnt(0)
    s_cmp_lt_u32 s35, 2
    s_cselect_b64 s[70:71], s[36:37], 0
    s_cbranch_scc0 .ef_416
    s_waitcnt vmcnt(5)
.ef_416:
    s_waitcnt vmcnt(19)
    s_barrier
    ds_read_b128 v[32:35], v19 offset:32768
    ds_read_b128 v[36:39], v19 offset:49152
    v_mfma_f32_16x16x32_bf16 v[80:83], v[48:51], a[112:115], v[80:83]
    ds_read_b128 v[40:43], v20 offset:32768
    s_add_u32 m0, s29, 65536
    v_mfma_f32_16x16x32_bf16 v[84:87], v[48:51], a[116:119], v[84:87]
    buffer_load_dwordx4 v16, s[16:19], s34 offen offset:0 lds
    v_mfma_f32_16x16x32_bf16 v[88:91], v[52:55], a[112:115], v[88:91]
    ds_read_b128 v[44:47], v20 offset:49152
    v_mfma_f32_16x16x32_bf16 v[92:95], v[52:55], a[116:119], v[92:95]
    v_mfma_f32_16x16x32_bf16 v[80:83], v[56:59], a[120:123], v[80:83]
    ds_read_b128 v[48:51], v19 offset:33792
    v_mfma_f32_16x16x32_bf16 v[84:87], v[56:59], a[124:127], v[84:87]
    v_mfma_f32_16x16x32_bf16 v[88:91], v[60:63], a[120:123], v[88:91]
    ds_read_b128 v[52:55], v19 offset:50176
    v_mfma_f32_16x16x32_bf16 v[92:95], v[60:63], a[124:127], v[92:95]
    s_mov_b64 exec, s[70:71]
    buffer_store_dword v23, v22, s[8:11], s33 offen sc1
    s_mov_b64 exec, -1

    s_waitcnt lgkmcnt(4)
    v_mfma_f32_16x16x32_bf16 v[80:83], v[32:35], a[128:131], v[80:83]
    ds_read_b128 v[56:59], v20 offset:33792
    s_add_u32 m0, s29, 66432
    v_mfma_f32_16x16x32_bf16 v[84:87], v[32:35], a[132:135], v[84:87]
    buffer_load_dwordx4 v16, s[16:19], s34 offen offset:128 lds
    v_mfma_f32_16x16x32_bf16 v[88:91], v[36:39], a[128:131], v[88:91]
    ds_read_b128 v[60:63], v20 offset:50176
    v_mfma_f32_16x16x32_bf16 v[92:95], v[36:39], a[132:135], v[92:95]
    s_waitcnt lgkmcnt(4)
    v_mfma_f32_16x16x32_bf16 v[80:83], v[40:43], a[136:139], v[80:83]
    ds_read_b128 v[32:35], v19 offset:34816
    v_mfma_f32_16x16x32_bf16 v[84:87], v[40:43], a[140:143], v[84:87]
    v_mfma_f32_16x16x32_bf16 v[88:91], v[44:47], a[136:139], v[88:91]
    ds_read_b128 v[36:39], v19 offset:51200
    v_mfma_f32_16x16x32_bf16 v[92:95], v[44:47], a[140:143], v[92:95]
    s_waitcnt lgkmcnt(4)
    v_mfma_f32_16x16x32_bf16 v[80:83], v[48:51], a[144:147], v[80:83]
    ds_read_b128 v[40:43], v20 offset:34816
    s_add_u32 m0, s29, 67328
    v_mfma_f32_16x16x32_bf16 v[84:87], v[48:51], a[148:151], v[84:87]
    buffer_load_dwordx4 v16, s[16:19], s34 offen offset:256 lds
    v_mfma_f32_16x16x32_bf16 v[88:91], v[52:55], a[144:147], v[88:91]
    ds_read_b128 v[44:47], v20 offset:51200
    v_mfma_f32_16x16x32_bf16 v[92:95], v[52:55], a[148:151], v[92:95]
    s_waitcnt lgkmcnt(4)
    v_mfma_f32_16x16x32_bf16 v[80:83], v[56:59], a[152:155], v[80:83]
    ds_read_b128 v[48:51], v19 offset:35840
    v_mfma_f32_16x16x32_bf16 v[84:87], v[56:59], a[156:159], v[84:87]
    v_mfma_f32_16x16x32_bf16 v[88:91], v[60:63], a[152:155], v[88:91]
    ds_read_b128 v[52:55], v19 offset:52224
    v_mfma_f32_16x16x32_bf16 v[92:95], v[60:63], a[156:159], v[92:95]
    s_waitcnt lgkmcnt(4)
    v_mfma_f32_16x16x32_bf16 v[80:83], v[32:35], a[160:163], v[80:83]
    ds_read_b128 v[56:59], v20 offset:35840
    s_add_u32 m0, s29, 68224
    v_mfma_f32_16x16x32_bf16 v[84:87], v[32:35], a[164:167], v[84:87]
    buffer_load_dwordx4 v16, s[16:19], s34 offen offset:384 lds
    v_mfma_f32_16x16x32_bf16 v[88:91], v[36:39], a[160:163], v[88:91]
    ds_read_b128 v[60:63], v20 offset:52224
    v_mfma_f32_16x16x32_bf16 v[92:95], v[36:39], a[164:167], v[92:95]
    s_waitcnt lgkmcnt(4)
    v_mfma_f32_16x16x32_bf16 v[80:83], v[40:43], a[168:171], v[80:83]
    ds_read_b128 v[32:35], v19 offset:36864
    v_mfma_f32_16x16x32_bf16 v[84:87], v[40:43], a[172:175], v[84:87]
    v_mfma_f32_16x16x32_bf16 v[88:91], v[44:47], a[168:171], v[88:91]
    ds_read_b128 v[36:39], v19 offset:53248
    v_mfma_f32_16x16x32_bf16 v[92:95], v[44:47], a[172:175], v[92:95]
    s_waitcnt lgkmcnt(4)
    v_mfma_f32_16x16x32_bf16 v[80:83], v[48:51], a[176:179], v[80:83]
    ds_read_b128 v[40:43], v20 offset:36864
    s_add_u32 m0, s29, 69120
    v_mfma_f32_16x16x32_bf16 v[84:87], v[48:51], a[180:183], v[84:87]
    buffer_load_dwordx4 v16, s[16:19], s34 offen offset:512 lds
    v_mfma_f32_16x16x32_bf16 v[88:91], v[52:55], a[176:179], v[88:91]
    ds_read_b128 v[44:47], v20 offset:53248
    v_mfma_f32_16x16x32_bf16 v[92:95], v[52:55], a[180:183], v[92:95]
    s_waitcnt lgkmcnt(4)
    v_mfma_f32_16x16x32_bf16 v[80:83], v[56:59], a[184:187], v[80:83]
    ds_read_b128 v[48:51], v19 offset:37888
    v_mfma_f32_16x16x32_bf16 v[84:87], v[56:59], a[188:191], v[84:87]
    v_mfma_f32_16x16x32_bf16 v[88:91], v[60:63], a[184:187], v[88:91]
    ds_read_b128 v[52:55], v19 offset:54272
    v_mfma_f32_16x16x32_bf16 v[92:95], v[60:63], a[188:191], v[92:95]
    s_waitcnt lgkmcnt(4)
    v_mfma_f32_16x16x32_bf16 v[80:83], v[32:35], a[192:195], v[80:83]
    ds_read_b128 v[56:59], v20 offset:37888
    s_add_u32 m0, s29, 70016
    v_mfma_f32_16x16x32_bf16 v[84:87], v[32:35], a[196:199], v[84:87]
    buffer_load_dwordx4 v16, s[16:19], s34 offen offset:640 lds
    v_mfma_f32_16x16x32_bf16 v[88:91], v[36:39], a[192:195], v[88:91]
    ds_read_b128 v[60:63], v20 offset:54272
    v_mfma_f32_16x16x32_bf16 v[92:95], v[36:39], a[196:199], v[92:95]
    s_waitcnt lgkmcnt(4)
    v_mfma_f32_16x16x32_bf16 v[80:83], v[40:43], a[200:203], v[80:83]
    ds_read_b128 v[32:35], v19 offset:38912
    v_mfma_f32_16x16x32_bf16 v[84:87], v[40:43], a[204:207], v[84:87]
    v_mfma_f32_16x16x32_bf16 v[88:91], v[44:47], a[200:203], v[88:91]
    ds_read_b128 v[36:39], v19 offset:55296
    v_mfma_f32_16x16x32_bf16 v[92:95], v[44:47], a[204:207], v[92:95]
    s_waitcnt lgkmcnt(4)
    v_mfma_f32_16x16x32_bf16 v[80:83], v[48:51], a[208:211], v[80:83]
    ds_read_b128 v[40:43], v20 offset:38912
    s_add_u32 m0, s29, 70912
    v_mfma_f32_16x16x32_bf16 v[84:87], v[48:51], a[212:215], v[84:87]
    buffer_load_dwordx4 v16, s[16:19], s34 offen offset:768 lds
    v_mfma_f32_16x16x32_bf16 v[88:91], v[52:55], a[208:211], v[88:91]
    ds_read_b128 v[44:47], v20 offset:55296
    v_mfma_f32_16x16x32_bf16 v[92:95], v[52:55], a[212:215], v[92:95]
    s_waitcnt lgkmcnt(4)
    v_mfma_f32_16x16x32_bf16 v[80:83], v[56:59], a[216:219], v[80:83]
    ds_read_b128 v[48:51], v19 offset:39936
    v_mfma_f32_16x16x32_bf16 v[84:87], v[56:59], a[220:223], v[84:87]
    s_cmp_lt_u32 s35, 22
    s_cselect_b64 s[44:45], -1, 0
    v_mfma_f32_16x16x32_bf16 v[88:91], v[60:63], a[216:219], v[88:91]
    ds_read_b128 v[52:55], v19 offset:56320
    v_mfma_f32_16x16x32_bf16 v[92:95], v[60:63], a[220:223], v[92:95]
    s_cselect_b32 s4, 0x10000, 0
    s_add_u32 s46, s46, s4
    s_waitcnt lgkmcnt(4)
    v_mfma_f32_16x16x32_bf16 v[80:83], v[32:35], a[224:227], v[80:83]
    ds_read_b128 v[56:59], v20 offset:39936
    s_add_u32 m0, s29, 71808
    v_mfma_f32_16x16x32_bf16 v[84:87], v[32:35], a[228:231], v[84:87]
    buffer_load_dwordx4 v16, s[16:19], s34 offen offset:896 lds
    v_mfma_f32_16x16x32_bf16 v[88:91], v[36:39], a[224:227], v[88:91]
    ds_read_b128 v[60:63], v20 offset:56320
    v_mfma_f32_16x16x32_bf16 v[92:95], v[36:39], a[228:231], v[92:95]
    s_waitcnt lgkmcnt(4)
    v_mfma_f32_16x16x32_bf16 v[80:83], v[40:43], a[232:235], v[80:83]
    s_add_u32 s34, s34, 1024
    v_mfma_f32_16x16x32_bf16 v[84:87], v[40:43], a[236:239], v[84:87]
    v_mfma_f32_16x16x32_bf16 v[88:91], v[44:47], a[232:235], v[88:91]
    v_mfma_f32_16x16x32_bf16 v[92:95], v[44:47], a[236:239], v[92:95]
    s_waitcnt lgkmcnt(0)
    s_waitcnt vmcnt(13)
    s_barrier
    ds_read_b128 v[32:35], v17 offset:0
    ds_read_b128 v[36:39], v17 offset:16384
    v_mfma_f32_16x16x32_bf16 v[80:83], v[48:51], a[240:243], v[80:83]
    ds_read_b128 v[40:43], v18 offset:0
    s_add_u32 m0, s29, 98304
    v_mfma_f32_16x16x32_bf16 v[84:87], v[48:51], a[244:247], v[84:87]
    buffer_load_dwordx4 v16, s[16:19], s34 offen offset:0 lds
    v_mfma_f32_16x16x32_bf16 v[88:91], v[52:55], a[240:243], v[88:91]
    ds_read_b128 v[44:47], v18 offset:16384
    v_mfma_f32_16x16x32_bf16 v[92:95], v[52:55], a[244:247], v[92:95]
    v_mfma_f32_16x16x32_bf16 v[80:83], v[56:59], a[248:251], v[80:83]
    ds_read_b128 v[48:51], v17 offset:1024
    v_mfma_f32_16x16x32_bf16 v[84:87], v[56:59], a[252:255], v[84:87]
    v_mfma_f32_16x16x32_bf16 v[88:91], v[60:63], a[248:251], v[88:91]
    ds_read_b128 v[52:55], v17 offset:17408
    v_mfma_f32_16x16x32_bf16 v[92:95], v[60:63], a[252:255], v[92:95]
    s_mov_b64 exec, s[36:37]
    buffer_store_dword v23, v22, s[8:11], s33 offen sc1
    s_mov_b64 exec, -1

    s_add_u32 s35, s35, 1
    s_cmp_lt_u32 s35, 32
    s_cbranch_scc1 .ql_413

    s_nop 7
    v_cvt_pk_bf16_f32 v96, v80, v81
    v_cvt_pk_bf16_f32 v97, v82, v83
    v_cvt_pk_bf16_f32 v98, v88, v89
    v_cvt_pk_bf16_f32 v99, v90, v91
    buffer_store_dwordx4 v[96:99], v21, s[8:11], s32 offen offset:0 sc1
    v_cvt_pk_bf16_f32 v100, v84, v85
    v_cvt_pk_bf16_f32 v101, v86, v87
    v_cvt_pk_bf16_f32 v102, v92, v93
    v_cvt_pk_bf16_f32 v103, v94, v95
    buffer_store_dwordx4 v[100:103], v21, s[8:11], s32 offen offset:1024 sc1
    s_mov_b32 exec_hi, 0
    buffer_store_dwordx4 v[24:27], v21, s[8:11], s48 offen sc1
    s_mov_b32 exec_hi, -1

    v_mov_b32 v23, 64
    s_waitcnt vmcnt(0) lgkmcnt(0)
    s_barrier
    s_mov_b64 exec, s[36:37]
    buffer_store_dword v23, v22, s[8:11], s33 offen sc1
    s_mov_b64 exec, -1

.qd_389:
    s_load_dwordx2 s[40:41], s[0:1], 88
    s_load_dwordx2 s[42:43], s[0:1], 112
    s_and_b32 s4, s33, 0xffffe7ff
    s_mov_b32 s57, s4
    s_mov_b32 s34, s47
    s_and_b32 s30, s26, 7
    s_lshr_b32 s31, s26, 3
    s_lshl_b32 s28, s91, 21
    s_lshl_b32 s4, s30, 8
    s_add_u32 s28, s28, s4
    s_waitcnt lgkmcnt(0)

    s_mov_b32 s12, s40
    s_and_b32 s13, s41, 0xffff
    s_mov_b32 s14, 0x800000
    s_mov_b32 s15, 0x00020000

    s_mov_b32 s44, s42
    s_and_b32 s45, s43, 0xffff
    s_mov_b32 s46, 0x400000
    s_mov_b32 s47, 0x00020000

    v_lshrrev_b32 v4, 1, v2
    v_xor_b32 v4, v4, v3
    v_lshlrev_b32 v4, 1, v4
    v_and_b32 v5, 1, v1
    v_or_b32 v4, v4, v5
    v_lshlrev_b32 v4, 4, v4
    v_lshlrev_b32 v5, 11, v3
    v_add_u32 v10, v4, v5
    v_xor_b32 v11, 0x80, v10
    s_lshl_b32 s4, s24, 16
    s_add_u32 s28, s28, s4
    s_lshl_b32 s29, s24, 13
    v_lshrrev_b32 v4, 2, v2
    v_and_b32 v5, 1, v3
    v_lshl_or_b32 v5, v5, 2, v4
    s_lshl_b32 s4, s24, 1
    v_xor_b32 v5, s4, v5
    v_lshlrev_b32 v5, 5, v5
    v_lshl_add_u32 v4, v3, 2, v4
    v_lshl_add_u32 v5, v4, 8, v5
    v_and_b32 v4, 3, v2
    v_lshl_add_u32 v12, v4, 3, v5
    v_xor_b32 v13, 32, v12
    v_add_u32 v14, 0x10000, v12
    v_add_u32 v15, 0x10000, v13

    s_and_b32 s4, s91, 1
    s_lshl_b32 s4, s4, 5
    v_xor_b32 v12, s4, v12
    v_xor_b32 v13, s4, v13
    v_xor_b32 v14, s4, v14
    v_xor_b32 v15, s4, v15

    s_and_b32 s4, s26, 7
    s_lshl_b32 s4, s4, 1
    s_lshr_b32 s5, s24, 1
    s_add_u32 s4, s4, s5
    s_lshl_b32 s4, s4, 6
    v_add_u32 v4, s4, v1
    v_lshlrev_b32 v4, 11, v4
    s_and_b32 s4, s24, 1
    s_lshl_b32 s4, s4, 10
    s_lshl_b32 s5, s91, 21
    s_add_u32 s4, s4, s5
    buffer_load_dword v31, v4, s[12:15], s4 offen offset:384

    s_add_u32 m0, s29, 0
    s_add_u32 s4, s28, 0
    buffer_load_dwordx4 v10, s[12:15], s4 offen lds

    s_add_u32 m0, s29, 1024
    s_add_u32 s4, s28, 8192
    buffer_load_dwordx4 v11, s[12:15], s4 offen lds

    s_add_u32 m0, s29, 2048
    s_add_u32 s4, s28, 16384
    buffer_load_dwordx4 v10, s[12:15], s4 offen lds

    s_add_u32 m0, s29, 3072
    s_add_u32 s4, s28, 24576
    buffer_load_dwordx4 v11, s[12:15], s4 offen lds

    s_add_u32 m0, s29, 4096
    s_add_u32 s4, s28, 32768
    buffer_load_dwordx4 v10, s[12:15], s4 offen lds

    s_add_u32 m0, s29, 5120
    s_add_u32 s4, s28, 40960
    buffer_load_dwordx4 v11, s[12:15], s4 offen lds

    s_add_u32 m0, s29, 6144
    s_add_u32 s4, s28, 49152
    buffer_load_dwordx4 v10, s[12:15], s4 offen lds

    s_add_u32 m0, s29, 7168
    s_add_u32 s4, s28, 57344
    buffer_load_dwordx4 v11, s[12:15], s4 offen lds

    s_add_u32 m0, s29, 32768
    s_add_u32 s4, s28, 262144
    buffer_load_dwordx4 v10, s[12:15], s4 offen lds

    s_add_u32 m0, s29, 33792
    s_add_u32 s4, s28, 270336
    buffer_load_dwordx4 v11, s[12:15], s4 offen lds

    s_add_u32 m0, s29, 34816
    s_add_u32 s4, s28, 278528
    buffer_load_dwordx4 v10, s[12:15], s4 offen lds

    s_add_u32 m0, s29, 35840
    s_add_u32 s4, s28, 286720
    buffer_load_dwordx4 v11, s[12:15], s4 offen lds

    s_add_u32 m0, s29, 36864
    s_add_u32 s4, s28, 294912
    buffer_load_dwordx4 v10, s[12:15], s4 offen lds

    s_add_u32 m0, s29, 37888
    s_add_u32 s4, s28, 303104
    buffer_load_dwordx4 v11, s[12:15], s4 offen lds

    s_add_u32 m0, s29, 38912
    s_add_u32 s4, s28, 311296
    buffer_load_dwordx4 v10, s[12:15], s4 offen lds

    s_add_u32 m0, s29, 39936
    s_add_u32 s4, s28, 319488
    buffer_load_dwordx4 v11, s[12:15], s4 offen lds

    s_add_u32 m0, s29, 65536
    s_add_u32 s4, s28, 524288
    buffer_load_dwordx4 v10, s[12:15], s4 offen lds

    s_add_u32 m0, s29, 66560
    s_add_u32 s4, s28, 532480
    buffer_load_dwordx4 v11, s[12:15], s4 offen lds

    s_add_u32 m0, s29, 67584
    s_add_u32 s4, s28, 540672
    buffer_load_dwordx4 v10, s[12:15], s4 offen lds

    s_add_u32 m0, s29, 68608
    s_add_u32 s4, s28, 548864
    buffer_load_dwordx4 v11, s[12:15], s4 offen lds

    s_add_u32 m0, s29, 69632
    s_add_u32 s4, s28, 557056
    buffer_load_dwordx4 v10, s[12:15], s4 offen lds

    s_add_u32 m0, s29, 70656
    s_add_u32 s4, s28, 565248
    buffer_load_dwordx4 v11, s[12:15], s4 offen lds

    s_add_u32 m0, s29, 71680
    s_add_u32 s4, s28, 573440
    buffer_load_dwordx4 v10, s[12:15], s4 offen lds

    s_add_u32 m0, s29, 72704
    s_add_u32 s4, s28, 581632
    buffer_load_dwordx4 v11, s[12:15], s4 offen lds

    s_add_u32 m0, s29, 98304
    s_add_u32 s4, s28, 786432
    buffer_load_dwordx4 v10, s[12:15], s4 offen lds

    s_add_u32 m0, s29, 99328
    s_add_u32 s4, s28, 794624
    buffer_load_dwordx4 v11, s[12:15], s4 offen lds

    s_add_u32 m0, s29, 100352
    s_add_u32 s4, s28, 802816
    buffer_load_dwordx4 v10, s[12:15], s4 offen lds

    s_add_u32 m0, s29, 101376
    s_add_u32 s4, s28, 811008
    buffer_load_dwordx4 v11, s[12:15], s4 offen lds

    s_add_u32 m0, s29, 102400
    s_add_u32 s4, s28, 819200
    buffer_load_dwordx4 v10, s[12:15], s4 offen lds

    s_add_u32 m0, s29, 103424
    s_add_u32 s4, s28, 827392
    buffer_load_dwordx4 v11, s[12:15], s4 offen lds

    s_add_u32 m0, s29, 104448
    s_add_u32 s4, s28, 835584
    buffer_load_dwordx4 v10, s[12:15], s4 offen lds

    s_add_u32 m0, s29, 105472
    s_add_u32 s4, s28, 843776
    buffer_load_dwordx4 v11, s[12:15], s4 offen lds

    s_waitcnt vmcnt(24)
    s_barrier
    ds_read_b64_tr_b16 a[0:1], v12 offset:0
    ds_read_b64_tr_b16 a[2:3], v12 offset:4096
    ds_read_b64_tr_b16 a[4:5], v13 offset:0
    ds_read_b64_tr_b16 a[6:7], v13 offset:4096
    ds_read_b64_tr_b16 a[8:9], v12 offset:8192
    ds_read_b64_tr_b16 a[10:11], v12 offset:12288
    ds_read_b64_tr_b16 a[12:13], v13 offset:8192
    ds_read_b64_tr_b16 a[14:15], v13 offset:12288
    ds_read_b64_tr_b16 a[16:17], v12 offset:16384
    ds_read_b64_tr_b16 a[18:19], v12 offset:20480
    ds_read_b64_tr_b16 a[20:21], v13 offset:16384
    ds_read_b64_tr_b16 a[22:23], v13 offset:20480
    ds_read_b64_tr_b16 a[24:25], v12 offset:24576
    ds_read_b64_tr_b16 a[26:27], v12 offset:28672
    ds_read_b64_tr_b16 a[28:29], v13 offset:24576
    ds_read_b64_tr_b16 a[30:31], v13 offset:28672
    s_waitcnt lgkmcnt(0)
    s_barrier
    s_add_u32 m0, s29, 0
    s_add_u32 s4, s28, 1048576
    buffer_load_dwordx4 v10, s[12:15], s4 offen lds

    s_add_u32 m0, s29, 1024
    s_add_u32 s4, s28, 1056768
    buffer_load_dwordx4 v11, s[12:15], s4 offen lds

    s_add_u32 m0, s29, 2048
    s_add_u32 s4, s28, 1064960
    buffer_load_dwordx4 v10, s[12:15], s4 offen lds

    s_add_u32 m0, s29, 3072
    s_add_u32 s4, s28, 1073152
    buffer_load_dwordx4 v11, s[12:15], s4 offen lds

    s_add_u32 m0, s29, 4096
    s_add_u32 s4, s28, 1081344
    buffer_load_dwordx4 v10, s[12:15], s4 offen lds

    s_add_u32 m0, s29, 5120
    s_add_u32 s4, s28, 1089536
    buffer_load_dwordx4 v11, s[12:15], s4 offen lds

    s_add_u32 m0, s29, 6144
    s_add_u32 s4, s28, 1097728
    buffer_load_dwordx4 v10, s[12:15], s4 offen lds

    s_add_u32 m0, s29, 7168
    s_add_u32 s4, s28, 1105920
    buffer_load_dwordx4 v11, s[12:15], s4 offen lds

    s_waitcnt vmcnt(24)
    s_barrier
    ds_read_b64_tr_b16 a[32:33], v12 offset:32768
    ds_read_b64_tr_b16 a[34:35], v12 offset:36864
    ds_read_b64_tr_b16 a[36:37], v13 offset:32768
    ds_read_b64_tr_b16 a[38:39], v13 offset:36864
    ds_read_b64_tr_b16 a[40:41], v12 offset:40960
    ds_read_b64_tr_b16 a[42:43], v12 offset:45056
    ds_read_b64_tr_b16 a[44:45], v13 offset:40960
    ds_read_b64_tr_b16 a[46:47], v13 offset:45056
    ds_read_b64_tr_b16 a[48:49], v12 offset:49152
    ds_read_b64_tr_b16 a[50:51], v12 offset:53248
    ds_read_b64_tr_b16 a[52:53], v13 offset:49152
    ds_read_b64_tr_b16 a[54:55], v13 offset:53248
    ds_read_b64_tr_b16 a[56:57], v12 offset:57344
    ds_read_b64_tr_b16 a[58:59], v12 offset:61440
    ds_read_b64_tr_b16 a[60:61], v13 offset:57344
    ds_read_b64_tr_b16 a[62:63], v13 offset:61440
    s_waitcnt lgkmcnt(0)
    s_barrier
    s_add_u32 m0, s29, 32768
    s_add_u32 s4, s28, 1310720
    buffer_load_dwordx4 v10, s[12:15], s4 offen lds

    s_add_u32 m0, s29, 33792
    s_add_u32 s4, s28, 1318912
    buffer_load_dwordx4 v11, s[12:15], s4 offen lds

    s_add_u32 m0, s29, 34816
    s_add_u32 s4, s28, 1327104
    buffer_load_dwordx4 v10, s[12:15], s4 offen lds

    s_add_u32 m0, s29, 35840
    s_add_u32 s4, s28, 1335296
    buffer_load_dwordx4 v11, s[12:15], s4 offen lds

    s_add_u32 m0, s29, 36864
    s_add_u32 s4, s28, 1343488
    buffer_load_dwordx4 v10, s[12:15], s4 offen lds

    s_add_u32 m0, s29, 37888
    s_add_u32 s4, s28, 1351680
    buffer_load_dwordx4 v11, s[12:15], s4 offen lds

    s_add_u32 m0, s29, 38912
    s_add_u32 s4, s28, 1359872
    buffer_load_dwordx4 v10, s[12:15], s4 offen lds

    s_add_u32 m0, s29, 39936
    s_add_u32 s4, s28, 1368064
    buffer_load_dwordx4 v11, s[12:15], s4 offen lds

    s_waitcnt vmcnt(24)
    s_barrier
    ds_read_b64_tr_b16 a[64:65], v14 offset:0
    ds_read_b64_tr_b16 a[66:67], v14 offset:4096
    ds_read_b64_tr_b16 a[68:69], v15 offset:0
    ds_read_b64_tr_b16 a[70:71], v15 offset:4096
    ds_read_b64_tr_b16 a[72:73], v14 offset:8192
    ds_read_b64_tr_b16 a[74:75], v14 offset:12288
    ds_read_b64_tr_b16 a[76:77], v15 offset:8192
    ds_read_b64_tr_b16 a[78:79], v15 offset:12288
    ds_read_b64_tr_b16 a[80:81], v14 offset:16384
    ds_read_b64_tr_b16 a[82:83], v14 offset:20480
    ds_read_b64_tr_b16 a[84:85], v15 offset:16384
    ds_read_b64_tr_b16 a[86:87], v15 offset:20480
    ds_read_b64_tr_b16 a[88:89], v14 offset:24576
    ds_read_b64_tr_b16 a[90:91], v14 offset:28672
    ds_read_b64_tr_b16 a[92:93], v15 offset:24576
    ds_read_b64_tr_b16 a[94:95], v15 offset:28672
    s_waitcnt lgkmcnt(0)
    s_barrier
    s_add_u32 m0, s29, 65536
    s_add_u32 s4, s28, 1572864
    buffer_load_dwordx4 v10, s[12:15], s4 offen lds

    s_add_u32 m0, s29, 66560
    s_add_u32 s4, s28, 1581056
    buffer_load_dwordx4 v11, s[12:15], s4 offen lds

    s_add_u32 m0, s29, 67584
    s_add_u32 s4, s28, 1589248
    buffer_load_dwordx4 v10, s[12:15], s4 offen lds

    s_add_u32 m0, s29, 68608
    s_add_u32 s4, s28, 1597440
    buffer_load_dwordx4 v11, s[12:15], s4 offen lds

    s_add_u32 m0, s29, 69632
    s_add_u32 s4, s28, 1605632
    buffer_load_dwordx4 v10, s[12:15], s4 offen lds

    s_add_u32 m0, s29, 70656
    s_add_u32 s4, s28, 1613824
    buffer_load_dwordx4 v11, s[12:15], s4 offen lds

    s_add_u32 m0, s29, 71680
    s_add_u32 s4, s28, 1622016
    buffer_load_dwordx4 v10, s[12:15], s4 offen lds

    s_add_u32 m0, s29, 72704
    s_add_u32 s4, s28, 1630208
    buffer_load_dwordx4 v11, s[12:15], s4 offen lds

    s_waitcnt vmcnt(24)
    s_barrier
    ds_read_b64_tr_b16 a[96:97], v14 offset:32768
    ds_read_b64_tr_b16 a[98:99], v14 offset:36864
    ds_read_b64_tr_b16 a[100:101], v15 offset:32768
    ds_read_b64_tr_b16 a[102:103], v15 offset:36864
    ds_read_b64_tr_b16 a[104:105], v14 offset:40960
    ds_read_b64_tr_b16 a[106:107], v14 offset:45056
    ds_read_b64_tr_b16 a[108:109], v15 offset:40960
    ds_read_b64_tr_b16 a[110:111], v15 offset:45056
    ds_read_b64_tr_b16 a[112:113], v14 offset:49152
    ds_read_b64_tr_b16 a[114:115], v14 offset:53248
    ds_read_b64_tr_b16 a[116:117], v15 offset:49152
    ds_read_b64_tr_b16 a[118:119], v15 offset:53248
    ds_read_b64_tr_b16 a[120:121], v14 offset:57344
    ds_read_b64_tr_b16 a[122:123], v14 offset:61440
    ds_read_b64_tr_b16 a[124:125], v15 offset:57344
    ds_read_b64_tr_b16 a[126:127], v15 offset:61440
    s_waitcnt lgkmcnt(0)
    s_barrier
    s_add_u32 m0, s29, 98304
    s_add_u32 s4, s28, 1835008
    buffer_load_dwordx4 v10, s[12:15], s4 offen lds

    s_add_u32 m0, s29, 99328
    s_add_u32 s4, s28, 1843200
    buffer_load_dwordx4 v11, s[12:15], s4 offen lds

    s_add_u32 m0, s29, 100352
    s_add_u32 s4, s28, 1851392
    buffer_load_dwordx4 v10, s[12:15], s4 offen lds

    s_add_u32 m0, s29, 101376
    s_add_u32 s4, s28, 1859584
    buffer_load_dwordx4 v11, s[12:15], s4 offen lds

    s_add_u32 m0, s29, 102400
    s_add_u32 s4, s28, 1867776
    buffer_load_dwordx4 v10, s[12:15], s4 offen lds

    s_add_u32 m0, s29, 103424
    s_add_u32 s4, s28, 1875968
    buffer_load_dwordx4 v11, s[12:15], s4 offen lds

    s_add_u32 m0, s29, 104448
    s_add_u32 s4, s28, 1884160
    buffer_load_dwordx4 v10, s[12:15], s4 offen lds

    s_add_u32 m0, s29, 105472
    s_add_u32 s4, s28, 1892352
    buffer_load_dwordx4 v11, s[12:15], s4 offen lds

    s_waitcnt vmcnt(24)
    s_barrier
    ds_read_b64_tr_b16 a[128:129], v12 offset:0
    ds_read_b64_tr_b16 a[130:131], v12 offset:4096
    ds_read_b64_tr_b16 a[132:133], v13 offset:0
    ds_read_b64_tr_b16 a[134:135], v13 offset:4096
    ds_read_b64_tr_b16 a[136:137], v12 offset:8192
    ds_read_b64_tr_b16 a[138:139], v12 offset:12288
    ds_read_b64_tr_b16 a[140:141], v13 offset:8192
    ds_read_b64_tr_b16 a[142:143], v13 offset:12288
    ds_read_b64_tr_b16 a[144:145], v12 offset:16384
    ds_read_b64_tr_b16 a[146:147], v12 offset:20480
    ds_read_b64_tr_b16 a[148:149], v13 offset:16384
    ds_read_b64_tr_b16 a[150:151], v13 offset:20480
    ds_read_b64_tr_b16 a[152:153], v12 offset:24576
    ds_read_b64_tr_b16 a[154:155], v12 offset:28672
    ds_read_b64_tr_b16 a[156:157], v13 offset:24576
    ds_read_b64_tr_b16 a[158:159], v13 offset:28672
    s_waitcnt lgkmcnt(0)
    s_barrier
    s_waitcnt vmcnt(16)
    s_barrier
    ds_read_b64_tr_b16 a[160:161], v12 offset:32768
    ds_read_b64_tr_b16 a[162:163], v12 offset:36864
    ds_read_b64_tr_b16 a[164:165], v13 offset:32768
    ds_read_b64_tr_b16 a[166:167], v13 offset:36864
    ds_read_b64_tr_b16 a[168:169], v12 offset:40960
    ds_read_b64_tr_b16 a[170:171], v12 offset:45056
    ds_read_b64_tr_b16 a[172:173], v13 offset:40960
    ds_read_b64_tr_b16 a[174:175], v13 offset:45056
    ds_read_b64_tr_b16 a[176:177], v12 offset:49152
    ds_read_b64_tr_b16 a[178:179], v12 offset:53248
    ds_read_b64_tr_b16 a[180:181], v13 offset:49152
    ds_read_b64_tr_b16 a[182:183], v13 offset:53248
    ds_read_b64_tr_b16 a[184:185], v12 offset:57344
    ds_read_b64_tr_b16 a[186:187], v12 offset:61440
    ds_read_b64_tr_b16 a[188:189], v13 offset:57344
    ds_read_b64_tr_b16 a[190:191], v13 offset:61440
    s_waitcnt lgkmcnt(0)
    s_barrier
    s_waitcnt vmcnt(8)
    s_barrier
    ds_read_b64_tr_b16 a[192:193], v14 offset:0
    ds_read_b64_tr_b16 a[194:195], v14 offset:4096
    ds_read_b64_tr_b16 a[196:197], v15 offset:0
    ds_read_b64_tr_b16 a[198:199], v15 offset:4096
    ds_read_b64_tr_b16 a[200:201], v14 offset:8192
    ds_read_b64_tr_b16 a[202:203], v14 offset:12288
    ds_read_b64_tr_b16 a[204:205], v15 offset:8192
    ds_read_b64_tr_b16 a[206:207], v15 offset:12288
    ds_read_b64_tr_b16 a[208:209], v14 offset:16384
    ds_read_b64_tr_b16 a[210:211], v14 offset:20480
    ds_read_b64_tr_b16 a[212:213], v15 offset:16384
    ds_read_b64_tr_b16 a[214:215], v15 offset:20480
    ds_read_b64_tr_b16 a[216:217], v14 offset:24576
    ds_read_b64_tr_b16 a[218:219], v14 offset:28672
    ds_read_b64_tr_b16 a[220:221], v15 offset:24576
    ds_read_b64_tr_b16 a[222:223], v15 offset:28672
    s_waitcnt lgkmcnt(0)
    s_barrier
    s_waitcnt vmcnt(0)
    s_barrier
    ds_read_b64_tr_b16 a[224:225], v14 offset:32768
    ds_read_b64_tr_b16 a[226:227], v14 offset:36864
    ds_read_b64_tr_b16 a[228:229], v15 offset:32768
    ds_read_b64_tr_b16 a[230:231], v15 offset:36864
    ds_read_b64_tr_b16 a[232:233], v14 offset:40960
    ds_read_b64_tr_b16 a[234:235], v14 offset:45056
    ds_read_b64_tr_b16 a[236:237], v15 offset:40960
    ds_read_b64_tr_b16 a[238:239], v15 offset:45056
    ds_read_b64_tr_b16 a[240:241], v14 offset:49152
    ds_read_b64_tr_b16 a[242:243], v14 offset:53248
    ds_read_b64_tr_b16 a[244:245], v15 offset:49152
    ds_read_b64_tr_b16 a[246:247], v15 offset:53248
    ds_read_b64_tr_b16 a[248:249], v14 offset:57344
    ds_read_b64_tr_b16 a[250:251], v14 offset:61440
    ds_read_b64_tr_b16 a[252:253], v15 offset:57344
    ds_read_b64_tr_b16 a[254:255], v15 offset:61440
    s_waitcnt lgkmcnt(0)
    s_barrier
    v_lshlrev_b32 v21, 4, v1
    s_lshr_b32 s4, s91, 1
    s_lshl_b32 s5, s4, 12
    v_add_u32 v17, s5, v21
    v_xor_b32 v18, 0x1000, v17
    s_lshl_b32 s4, s4, 4
    v_add_u32 v4, s4, v2
    s_lshl_b32 s5, s30, 5
    s_lshl_b32 s6, s24, 3
    s_add_u32 s5, s5, s6
    s_and_b32 s6, s91, 1
    s_lshl_b32 s6, s6, 2
    s_add_u32 s5, s5, s6
    v_add_u32 v5, s5, v3
    v_lshlrev_b32 v6, 3, v5
    v_lshl_add_u32 v22, v4, 11, v6
    v_lshlrev_b32 v6, 14, v5
    v_lshl_add_u32 v23, v4, 2, v6
    v_lshlrev_b32 v16, 2, v4
    v_bfe_u32 v4, v1, 2, 3
    v_lshlrev_b32 v19, 8, v4
    v_and_b32 v4, 3, v1
    v_lshl_add_u32 v19, v4, 2, v19
    s_lshl_b32 s33, s91, 11
    s_add_u32 s33, s33, 92299264
    s_lshl_b32 s35, s24, 10
    s_lshl_b32 s36, s91, 16
    s_add_u32 s36, s36, s35
    s_add_u32 s36, s36, 0
    s_mov_b32 s37, 0
    s_lshl_b32 s4, s91, 3
    s_add_u32 s4, s4, s30
    s_lshl_b32 s4, s4, 2
    s_add_u32 s4, s4, s24
    s_lshl_b32 s4, s4, 11
    s_add_u32 s4, s4, 0
    v_lshlrev_b32 v111, 5, v1
    v_add_u32 v111, s4, v111
    s_mov_b32 s52, 0
    s_mov_b32 s39, 0
    v_lshlrev_b32 v6, 11, v1

    s_mov_b32 s69, 3
    s_mov_b32 s54, 0
    s_mul_i32 s4, s31, 3
    s_add_u32 s4, s4, 2
    s_sub_u32 s5, s31, s4
    s_cmp_lt_u32 s31, 2
    s_cselect_b32 s69, s5, 3
    s_cselect_b32 s4, s4, s31
    s_cmp_eq_u32 s31, 2
    s_cselect_b32 s31, 8, s4

    s_mov_b32 s62, 0
    s_mov_b64 exec, 15
.wf_417:
    buffer_load_dword v4, v6, s[8:11], s57 offen sc1
    s_waitcnt vmcnt(0)
    v_cmp_gt_u32 vcc, 64, v4
    s_cbranch_vccz .wfd_418
    s_sleep 2
    s_add_u32 s62, s62, 1
    s_cmp_gt_u32 s62, 0x400000
    s_cbranch_scc1 .mg_end_1
    s_branch .wf_417

.wfd_418:
    s_mov_b64 exec, -1
    v_mov_b32 v5, 0
    s_mov_b32 s62, 0
    s_mov_b32 s5, 160
.wc_419:
    buffer_load_dword v4, v5, s[20:23], s5 offen sc1
    s_waitcnt vmcnt(0)
    v_readfirstlane_b32 s4, v4
    s_lshr_b32 s4, s4, 0
    s_and_b32 s4, s4, 0xffff
    s_cmp_ge_u32 s4, 32
    s_cbranch_scc1 .wcd_420
    s_sleep 6
    s_add_u32 s62, s62, 1
    s_cmp_gt_u32 s62, 0x400000
    s_cbranch_scc1 .mg_end_1
    s_branch .wc_419

.wcd_420:
.g2blk_421:
    s_mov_b32 s62, 0
    s_mov_b64 s[64:65], 0
    s_mov_b32 s38, 0
    s_cmp_ge_u32 s31, 63
    s_cbranch_scc1 .g2h_430
.g2bw_429:
    buffer_load_dword v20, v19, s[8:11], s33 offen sc1
    s_waitcnt vmcnt(0)
    s_lshr_b32 s6, s31, 2
    s_and_b32 s4, s31, 3
    v_cmp_ge_u32 vcc, s6, v20
    s_lshl_b32 s4, s4, 3
    s_lshr_b32 s5, vcc_lo, s4
    s_and_b32 s5, s5, 0xff
    s_cmp_eq_u32 s5, 0

    s_cbranch_scc1 .g2rd_431
    s_lshl_b64 exec, 0xff, s4

    s_add_u32 s62, s62, 1
    s_cmp_gt_u32 s62, 0x400000
    s_cbranch_scc1 .mg_end_1
    s_branch .g2bw_429

.g2rd_431:
    s_mov_b64 exec, -1
    s_lshl_b32 s48, s31, 18
    s_add_u32 s48, s48, s36
    s_add_u32 s49, s39, s35
    s_xor_b32 s39, s39, 0x10000

    s_add_u32 m0, s49, 0
    s_add_u32 s50, s48, 0
    buffer_load_dwordx4 v21, s[8:11], s50 offen offset:0 sc1 lds
    s_add_u32 m0, s49, 4096
    s_add_u32 s50, s48, 4096
    buffer_load_dwordx4 v21, s[8:11], s50 offen offset:0 sc1 lds
    s_add_u32 m0, s49, 8192
    s_add_u32 s50, s48, 8192
    buffer_load_dwordx4 v21, s[8:11], s50 offen offset:0 sc1 lds
    s_add_u32 m0, s49, 12288
    s_add_u32 s50, s48, 12288
    buffer_load_dwordx4 v21, s[8:11], s50 offen offset:0 sc1 lds
    s_add_u32 m0, s49, 16384
    s_add_u32 s50, s48, 16384
    buffer_load_dwordx4 v21, s[8:11], s50 offen offset:0 sc1 lds
    s_add_u32 m0, s49, 20480
    s_add_u32 s50, s48, 20480
    buffer_load_dwordx4 v21, s[8:11], s50 offen offset:0 sc1 lds
    s_add_u32 m0, s49, 24576
    s_add_u32 s50, s48, 24576
    buffer_load_dwordx4 v21, s[8:11], s50 offen offset:0 sc1 lds
    s_add_u32 m0, s49, 28672
    s_add_u32 s50, s48, 28672
    buffer_load_dwordx4 v21, s[8:11], s50 offen offset:0 sc1 lds
    s_add_u32 s53, s31, s69
    s_lshr_b32 s6, s53, 2
    s_and_b32 s4, s53, 3
    v_cmp_ge_u32 vcc, s6, v20
    s_lshl_b32 s4, s4, 3
    s_lshr_b32 s5, vcc_lo, s4
    s_and_b32 s5, s5, 0xff
    s_cmp_eq_u32 s5, 0

    s_cselect_b32 s56, 1, 0
    s_cmp_lt_u32 s53, 63
    s_cselect_b32 s56, s56, 0
    s_cmp_eq_u32 s56, 0
    s_cbranch_scc1 .g2fb_432
    s_add_u32 m0, s49, 32768
    s_add_u32 s50, s48, 32768
    buffer_load_dwordx4 v21, s[8:11], s50 offen offset:0 sc1 lds
    s_add_u32 m0, s49, 36864
    s_add_u32 s50, s48, 36864
    buffer_load_dwordx4 v21, s[8:11], s50 offen offset:0 sc1 lds
    s_add_u32 m0, s49, 40960
    s_add_u32 s50, s48, 40960
    buffer_load_dwordx4 v21, s[8:11], s50 offen offset:0 sc1 lds
    s_add_u32 m0, s49, 45056
    s_add_u32 s50, s48, 45056
    buffer_load_dwordx4 v21, s[8:11], s50 offen offset:0 sc1 lds
    s_add_u32 m0, s49, 49152
    s_add_u32 s50, s48, 49152
    buffer_load_dwordx4 v21, s[8:11], s50 offen offset:0 sc1 lds
    s_add_u32 m0, s49, 53248
    s_add_u32 s50, s48, 53248
    buffer_load_dwordx4 v21, s[8:11], s50 offen offset:0 sc1 lds
    s_add_u32 m0, s49, 57344
    s_add_u32 s50, s48, 57344
    buffer_load_dwordx4 v21, s[8:11], s50 offen offset:0 sc1 lds
    s_add_u32 m0, s49, 61440
    s_add_u32 s50, s48, 61440
    buffer_load_dwordx4 v21, s[8:11], s50 offen offset:0 sc1 lds
    s_waitcnt vmcnt(0)
.g2go_422:
    s_barrier
    ds_read_b128 v[32:35], v17 offset:0
    ds_read_b128 v[36:39], v18 offset:0
    ds_read_b128 v[40:43], v17 offset:1024
    ds_read_b128 v[44:47], v18 offset:1024
    ds_read_b128 v[48:51], v17 offset:2048
    ds_read_b128 v[52:55], v18 offset:2048
    s_add_u32 s53, s31, s69
    s_sub_u32 s55, s37, 0x10000
    s_add_u32 s61, s53, 3
    s_lshr_b32 s6, s53, 2
    s_and_b32 s4, s53, 3
    v_cmp_ge_u32 vcc, s6, v20
    s_lshl_b32 s4, s4, 3
    s_lshr_b32 s5, vcc_lo, s4
    s_and_b32 s5, s5, 0xff
    s_cmp_eq_u32 s5, 0

    s_cselect_b32 s56, 1, 0
    s_cmp_lt_u32 s53, 63
    s_cselect_b32 s56, s56, 0
    s_cmp_eq_u32 s56, 0
    s_cbranch_scc1 .g2nd_425
    s_lshr_b32 s6, s61, 2
    s_and_b32 s4, s61, 3
    v_cmp_ge_u32 vcc, s6, v20
    s_lshl_b32 s4, s4, 3
    s_lshr_b32 s5, vcc_lo, s4
    s_and_b32 s5, s5, 0xff
    s_cmp_eq_u32 s5, 0

    s_cbranch_scc1 .g2nf_424
    buffer_load_dword v20, v19, s[8:11], s33 offen sc1
    s_branch .g2pd_434
.g2nf_424:
    s_lshl_b32 s4, s61, 18
    buffer_load_dword v31, v111, s[8:11], s4 offen
.g2pd_434:
    s_lshl_b32 s48, s53, 18
    s_add_u32 s48, s48, s36
    s_add_u32 s49, s39, s35
    s_xor_b32 s39, s39, 0x10000

    s_waitcnt lgkmcnt(4)
    v_mfma_f32_16x16x32_bf16 v[64:67], a[0:3], v[32:35], 0
    ds_read_b128 v[56:59], v17 offset:3072
    s_add_u32 m0, s49, 0
    s_add_u32 s50, s48, 0
    v_mfma_f32_16x16x32_bf16 v[68:71], a[4:7], v[32:35], 0
    buffer_load_dwordx4 v21, s[8:11], s50 offen offset:0 sc1 lds
    v_mfma_f32_16x16x32_bf16 v[72:75], a[0:3], v[36:39], 0
    ds_read_b128 v[60:63], v18 offset:3072
    v_mfma_f32_16x16x32_bf16 v[76:79], a[4:7], v[36:39], 0
    s_waitcnt lgkmcnt(4)
    v_mfma_f32_16x16x32_bf16 v[64:67], a[8:11], v[40:43], v[64:67]
    ds_read_b128 v[32:35], v17 offset:8192
    v_mfma_f32_16x16x32_bf16 v[68:71], a[12:15], v[40:43], v[68:71]
    v_mfma_f32_16x16x32_bf16 v[72:75], a[8:11], v[44:47], v[72:75]
    ds_read_b128 v[36:39], v18 offset:8192
    s_add_u32 m0, s49, 4096
    s_add_u32 s50, s48, 4096
    v_mfma_f32_16x16x32_bf16 v[76:79], a[12:15], v[44:47], v[76:79]
    buffer_load_dwordx4 v21, s[8:11], s50 offen offset:0 sc1 lds
    s_waitcnt lgkmcnt(4)
    v_mfma_f32_16x16x32_bf16 v[64:67], a[16:19], v[48:51], v[64:67]
    ds_read_b128 v[40:43], v17 offset:9216
    v_mfma_f32_16x16x32_bf16 v[68:71], a[20:23], v[48:51], v[68:71]
    v_mfma_f32_16x16x32_bf16 v[72:75], a[16:19], v[52:55], v[72:75]
    ds_read_b128 v[44:47], v18 offset:9216
    v_mfma_f32_16x16x32_bf16 v[76:79], a[20:23], v[52:55], v[76:79]
    s_waitcnt lgkmcnt(4)
    v_mfma_f32_16x16x32_bf16 v[64:67], a[24:27], v[56:59], v[64:67]
    ds_read_b128 v[48:51], v17 offset:10240
    s_add_u32 m0, s49, 8192
    s_add_u32 s50, s48, 8192
    v_mfma_f32_16x16x32_bf16 v[68:71], a[28:31], v[56:59], v[68:71]
    buffer_load_dwordx4 v21, s[8:11], s50 offen offset:0 sc1 lds
    v_mfma_f32_16x16x32_bf16 v[72:75], a[24:27], v[60:63], v[72:75]
    ds_read_b128 v[52:55], v18 offset:10240
    v_mfma_f32_16x16x32_bf16 v[76:79], a[28:31], v[60:63], v[76:79]
    s_waitcnt lgkmcnt(4)
    v_mfma_f32_16x16x32_bf16 v[64:67], a[32:35], v[32:35], v[64:67]
    ds_read_b128 v[56:59], v17 offset:11264
    v_mfma_f32_16x16x32_bf16 v[68:71], a[36:39], v[32:35], v[68:71]
    v_mfma_f32_16x16x32_bf16 v[72:75], a[32:35], v[36:39], v[72:75]
    ds_read_b128 v[60:63], v18 offset:11264
    s_add_u32 m0, s49, 12288
    s_add_u32 s50, s48, 12288
    v_mfma_f32_16x16x32_bf16 v[76:79], a[36:39], v[36:39], v[76:79]
    buffer_load_dwordx4 v21, s[8:11], s50 offen offset:0 sc1 lds
    s_waitcnt lgkmcnt(4)
    v_mfma_f32_16x16x32_bf16 v[64:67], a[40:43], v[40:43], v[64:67]
    s_barrier
    ds_read_b128 v[32:35], v17 offset:16384
    v_mfma_f32_16x16x32_bf16 v[68:71], a[44:47], v[40:43], v[68:71]
    v_mfma_f32_16x16x32_bf16 v[72:75], a[40:43], v[44:47], v[72:75]
    ds_read_b128 v[36:39], v18 offset:16384
    v_mfma_f32_16x16x32_bf16 v[76:79], a[44:47], v[44:47], v[76:79]
    s_waitcnt lgkmcnt(4)
    v_mfma_f32_16x16x32_bf16 v[64:67], a[48:51], v[48:51], v[64:67]
    ds_read_b128 v[40:43], v17 offset:17408
    s_add_u32 m0, s49, 16384
    s_add_u32 s50, s48, 16384
    v_mfma_f32_16x16x32_bf16 v[68:71], a[52:55], v[48:51], v[68:71]
    buffer_load_dwordx4 v21, s[8:11], s50 offen offset:0 sc1 lds
    v_mfma_f32_16x16x32_bf16 v[72:75], a[48:51], v[52:55], v[72:75]
    ds_read_b128 v[44:47], v18 offset:17408
    v_mfma_f32_16x16x32_bf16 v[76:79], a[52:55], v[52:55], v[76:79]
    s_waitcnt lgkmcnt(4)
    v_mfma_f32_16x16x32_bf16 v[64:67], a[56:59], v[56:59], v[64:67]
    ds_read_b128 v[48:51], v17 offset:18432
    v_mfma_f32_16x16x32_bf16 v[68:71], a[60:63], v[56:59], v[68:71]
    v_mfma_f32_16x16x32_bf16 v[72:75], a[56:59], v[60:63], v[72:75]
    ds_read_b128 v[52:55], v18 offset:18432
    s_add_u32 m0, s49, 20480
    s_add_u32 s50, s48, 20480
    v_mfma_f32_16x16x32_bf16 v[76:79], a[60:63], v[60:63], v[76:79]
    buffer_load_dwordx4 v21, s[8:11], s50 offen offset:0 sc1 lds
    s_waitcnt lgkmcnt(4)
    v_mfma_f32_16x16x32_bf16 v[64:67], a[64:67], v[32:35], v[64:67]
    ds_read_b128 v[56:59], v17 offset:19456
    v_mfma_f32_16x16x32_bf16 v[68:71], a[68:71], v[32:35], v[68:71]
    v_mfma_f32_16x16x32_bf16 v[72:75], a[64:67], v[36:39], v[72:75]
    ds_read_b128 v[60:63], v18 offset:19456
    v_mfma_f32_16x16x32_bf16 v[76:79], a[68:71], v[36:39], v[76:79]
    s_waitcnt lgkmcnt(4)
    v_mfma_f32_16x16x32_bf16 v[64:67], a[72:75], v[40:43], v[64:67]
    ds_read_b128 v[32:35], v17 offset:24576
    s_add_u32 m0, s49, 24576
    s_add_u32 s50, s48, 24576
    v_mfma_f32_16x16x32_bf16 v[68:71], a[76:79], v[40:43], v[68:71]
    buffer_load_dwordx4 v21, s[8:11], s50 offen offset:0 sc1 lds
    v_mfma_f32_16x16x32_bf16 v[72:75], a[72:75], v[44:47], v[72:75]
    ds_read_b128 v[36:39], v18 offset:24576
    v_mfma_f32_16x16x32_bf16 v[76:79], a[76:79], v[44:47], v[76:79]
    s_waitcnt lgkmcnt(4)
    v_mfma_f32_16x16x32_bf16 v[64:67], a[80:83], v[48:51], v[64:67]
    ds_read_b128 v[40:43], v17 offset:25600
    v_mfma_f32_16x16x32_bf16 v[68:71], a[84:87], v[48:51], v[68:71]
    s_waitcnt vmcnt(11)
    v_mfma_f32_16x16x32_bf16 v[72:75], a[80:83], v[52:55], v[72:75]
    ds_read_b128 v[44:47], v18 offset:25600
    s_add_u32 m0, s49, 28672
    s_add_u32 s50, s48, 28672
    v_mfma_f32_16x16x32_bf16 v[76:79], a[84:87], v[52:55], v[76:79]
    buffer_load_dwordx4 v21, s[8:11], s50 offen offset:0 sc1 lds
    s_mov_b32 s62, 0
.cc_435:
    v_max3_u32 v4, v84, v88, v92
    v_cmp_eq_u32 vcc, -1, v4
    s_and_b64 vcc, vcc, s[64:65]
    s_cbranch_vccnz .cf_436
    s_waitcnt lgkmcnt(4)
    v_mfma_f32_16x16x32_bf16 v[64:67], a[88:91], v[56:59], v[64:67]
    ds_read_b128 v[48:51], v17 offset:26624
    v_mfma_f32_16x16x32_bf16 v[68:71], a[92:95], v[56:59], v[68:71]
    v_add_f32 v84, v84, v88
    v_add_f32 v92, v112, v92
    v_mfma_f32_16x16x32_bf16 v[72:75], a[88:91], v[60:63], v[72:75]
    ds_read_b128 v[52:55], v18 offset:26624
    v_mfma_f32_16x16x32_bf16 v[76:79], a[92:95], v[60:63], v[76:79]
    v_add_f32 v85, v85, v89
    v_add_f32 v93, v113, v93
    s_waitcnt lgkmcnt(4)
    v_mfma_f32_16x16x32_bf16 v[64:67], a[96:99], v[32:35], v[64:67]
    ds_read_b128 v[56:59], v17 offset:27648
    s_add_u32 m0, s49, 32768
    s_add_u32 s50, s48, 32768
    v_mfma_f32_16x16x32_bf16 v[68:71], a[100:103], v[32:35], v[68:71]
    buffer_load_dwordx4 v21, s[8:11], s50 offen offset:0 sc1 lds
    v_add_f32 v86, v86, v90
    v_add_f32 v94, v114, v94
    v_mfma_f32_16x16x32_bf16 v[72:75], a[96:99], v[36:39], v[72:75]
    ds_read_b128 v[60:63], v18 offset:27648
    v_mfma_f32_16x16x32_bf16 v[76:79], a[100:103], v[36:39], v[76:79]
    v_add_f32 v87, v87, v91
    v_add_f32 v95, v115, v95
    s_waitcnt lgkmcnt(4)
    v_mfma_f32_16x16x32_bf16 v[64:67], a[104:107], v[40:43], v[64:67]
    s_barrier
    ds_read_b128 v[32:35], v17 offset:32768
    v_mfma_f32_16x16x32_bf16 v[68:71], a[108:111], v[40:43], v[68:71]
    v_add_f32 v84, v92, v84
    v_add_f32 v85, v93, v85
    v_mfma_f32_16x16x32_bf16 v[72:75], a[104:107], v[44:47], v[72:75]
    ds_read_b128 v[36:39], v18 offset:32768
    s_add_u32 m0, s49, 36864
    s_add_u32 s50, s48, 36864
    v_mfma_f32_16x16x32_bf16 v[76:79], a[108:111], v[44:47], v[76:79]
    buffer_load_dwordx4 v21, s[8:11], s50 offen offset:0 sc1 lds
    v_add_f32 v86, v94, v86
    v_add_f32 v87, v95, v87
    s_waitcnt lgkmcnt(4)
    v_mfma_f32_16x16x32_bf16 v[64:67], a[112:115], v[48:51], v[64:67]
    ds_read_b128 v[40:43], v17 offset:33792
    v_mfma_f32_16x16x32_bf16 v[68:71], a[116:119], v[48:51], v[68:71]
    v_sub_f32 v104, 1.0, v100
    v_cvt_pk_bf16_f32 v104, v104, v104
    v_mfma_f32_16x16x32_bf16 v[72:75], a[112:115], v[52:55], v[72:75]
    ds_read_b128 v[44:47], v18 offset:33792
    v_mfma_f32_16x16x32_bf16 v[76:79], a[116:119], v[52:55], v[76:79]
    v_lshlrev_b32 v104, 16, v104
    v_cvt_pk_bf16_f32 v105, v84, v85
    s_waitcnt lgkmcnt(4)
    v_mfma_f32_16x16x32_bf16 v[64:67], a[120:123], v[56:59], v[64:67]
    ds_read_b128 v[48:51], v17 offset:34816
    s_add_u32 m0, s49, 40960
    s_add_u32 s50, s48, 40960
    v_mfma_f32_16x16x32_bf16 v[68:71], a[124:127], v[56:59], v[68:71]
    buffer_load_dwordx4 v21, s[8:11], s50 offen offset:0 sc1 lds
    v_lshlrev_b32 v107, 16, v96
    v_and_b32 v108, 0xffff0000, v96
    v_mfma_f32_16x16x32_bf16 v[72:75], a[120:123], v[60:63], v[72:75]
    ds_read_b128 v[52:55], v18 offset:34816
    v_mfma_f32_16x16x32_bf16 v[76:79], a[124:127], v[60:63], v[76:79]
    v_lshlrev_b32 v109, 16, v98
    v_and_b32 v110, 0xffff0000, v98
    s_waitcnt lgkmcnt(4)
    v_mfma_f32_16x16x32_bf16 v[64:67], a[128:131], v[32:35], v[64:67]
    ds_read_b128 v[56:59], v17 offset:35840
    v_mfma_f32_16x16x32_bf16 v[68:71], a[132:135], v[32:35], v[68:71]
    v_and_b32 v106, 0xffff0000, v105
    v_lshlrev_b32 v105, 16, v105
    v_mfma_f32_16x16x32_bf16 v[72:75], a[128:131], v[36:39], v[72:75]
    ds_read_b128 v[60:63], v18 offset:35840
    s_add_u32 m0, s49, 45056
    s_add_u32 s50, s48, 45056
    v_mfma_f32_16x16x32_bf16 v[76:79], a[132:135], v[36:39], v[76:79]
    buffer_load_dwordx4 v21, s[8:11], s50 offen offset:0 sc1 lds
    v_mul_f32 v107, v107, v109
    v_mul_f32 v108, v108, v110
    s_waitcnt lgkmcnt(4)
    v_mfma_f32_16x16x32_bf16 v[64:67], a[136:139], v[40:43], v[64:67]
    ds_read_b128 v[32:35], v17 offset:40960
    v_mfma_f32_16x16x32_bf16 v[68:71], a[140:143], v[40:43], v[68:71]
    v_mul_f32 v105, v104, v105
    v_mul_f32 v106, v104, v106
    v_mfma_f32_16x16x32_bf16 v[72:75], a[136:139], v[44:47], v[72:75]
    ds_read_b128 v[36:39], v18 offset:40960
    v_mfma_f32_16x16x32_bf16 v[76:79], a[140:143], v[44:47], v[76:79]
    v_cvt_pk_bf16_f32 v107, v107, v108
    v_cvt_pk_bf16_f32 v105, v105, v106
    s_waitcnt lgkmcnt(4)
    v_mfma_f32_16x16x32_bf16 v[64:67], a[144:147], v[48:51], v[64:67]
    ds_read_b128 v[40:43], v17 offset:41984
    s_add_u32 m0, s49, 49152
    s_add_u32 s50, s48, 49152
    v_mfma_f32_16x16x32_bf16 v[68:71], a[148:151], v[48:51], v[68:71]
    buffer_load_dwordx4 v21, s[8:11], s50 offen offset:0 sc1 lds
    v_and_b32 v108, 0xffff0000, v107
    v_lshlrev_b32 v107, 16, v107
    v_mfma_f32_16x16x32_bf16 v[72:75], a[144:147], v[52:55], v[72:75]
    ds_read_b128 v[44:47], v18 offset:41984
    v_mfma_f32_16x16x32_bf16 v[76:79], a[148:151], v[52:55], v[76:79]
    v_and_b32 v106, 0xffff0000, v105
    v_lshlrev_b32 v105, 16, v105
    s_waitcnt lgkmcnt(4)
    v_mfma_f32_16x16x32_bf16 v[64:67], a[152:155], v[56:59], v[64:67]
    ds_read_b128 v[48:51], v17 offset:43008
    v_mfma_f32_16x16x32_bf16 v[68:71], a[156:159], v[56:59], v[68:71]
    v_mul_f32 v107, v100, v107
    v_mul_f32 v108, v100, v108
    v_mfma_f32_16x16x32_bf16 v[72:75], a[152:155], v[60:63], v[72:75]
    ds_read_b128 v[52:55], v18 offset:43008
    s_add_u32 m0, s49, 53248
    s_add_u32 s50, s48, 53248
    v_mfma_f32_16x16x32_bf16 v[76:79], a[156:159], v[60:63], v[76:79]
    buffer_load_dwordx4 v21, s[8:11], s50 offen offset:0 sc1 lds
    v_cvt_pk_bf16_f32 v107, v107, v108
    v_and_b32 v108, 0xffff0000, v107
    s_waitcnt lgkmcnt(4)
    v_mfma_f32_16x16x32_bf16 v[64:67], a[160:163], v[32:35], v[64:67]
    ds_read_b128 v[56:59], v17 offset:44032
    v_mfma_f32_16x16x32_bf16 v[68:71], a[164:167], v[32:35], v[68:71]
    v_lshlrev_b32 v107, 16, v107
    v_add_f32 v105, v105, v107
    v_mfma_f32_16x16x32_bf16 v[72:75], a[160:163], v[36:39], v[72:75]
    ds_read_b128 v[60:63], v18 offset:44032
    v_mfma_f32_16x16x32_bf16 v[76:79], a[164:167], v[36:39], v[76:79]
    v_add_f32 v106, v106, v108
    v_cvt_pk_bf16_f32 v102, v105, v106
    s_waitcnt lgkmcnt(4)
    v_mfma_f32_16x16x32_bf16 v[64:67], a[168:171], v[40:43], v[64:67]
    s_barrier
    ds_read_b128 v[32:35], v17 offset:49152
    s_add_u32 m0, s49, 57344
    s_add_u32 s50, s48, 57344
    v_mfma_f32_16x16x32_bf16 v[68:71], a[172:175], v[40:43], v[68:71]
    buffer_load_dwordx4 v21, s[8:11], s50 offen offset:0 sc1 lds
    v_cvt_pk_bf16_f32 v105, v86, v87
    v_lshlrev_b32 v107, 16, v97
    v_mfma_f32_16x16x32_bf16 v[72:75], a[168:171], v[44:47], v[72:75]
    ds_read_b128 v[36:39], v18 offset:49152
    v_mfma_f32_16x16x32_bf16 v[76:79], a[172:175], v[44:47], v[76:79]
    v_and_b32 v108, 0xffff0000, v97
    v_lshlrev_b32 v109, 16, v99
    s_waitcnt lgkmcnt(4)
    v_mfma_f32_16x16x32_bf16 v[64:67], a[176:179], v[48:51], v[64:67]
    ds_read_b128 v[40:43], v17 offset:50176
    v_mfma_f32_16x16x32_bf16 v[68:71], a[180:183], v[48:51], v[68:71]
    v_and_b32 v110, 0xffff0000, v99
    v_and_b32 v106, 0xffff0000, v105
    v_mfma_f32_16x16x32_bf16 v[72:75], a[176:179], v[52:55], v[72:75]
    ds_read_b128 v[44:47], v18 offset:50176
    s_add_u32 m0, s49, 61440
    s_add_u32 s50, s48, 61440
    v_mfma_f32_16x16x32_bf16 v[76:79], a[180:183], v[52:55], v[76:79]
    buffer_load_dwordx4 v21, s[8:11], s50 offen offset:0 sc1 lds
    v_lshlrev_b32 v105, 16, v105
    v_mul_f32 v107, v107, v109
    s_waitcnt lgkmcnt(4)
    v_mfma_f32_16x16x32_bf16 v[64:67], a[184:187], v[56:59], v[64:67]
    ds_read_b128 v[48:51], v17 offset:51200
    v_mfma_f32_16x16x32_bf16 v[68:71], a[188:191], v[56:59], v[68:71]
    v_mul_f32 v108, v108, v110
    v_mul_f32 v105, v104, v105
    v_mfma_f32_16x16x32_bf16 v[72:75], a[184:187], v[60:63], v[72:75]
    ds_read_b128 v[52:55], v18 offset:51200
    v_mfma_f32_16x16x32_bf16 v[76:79], a[188:191], v[60:63], v[76:79]
    v_mul_f32 v106, v104, v106
    v_cvt_pk_bf16_f32 v107, v107, v108
    s_waitcnt lgkmcnt(4)
    v_mfma_f32_16x16x32_bf16 v[64:67], a[192:195], v[32:35], v[64:67]
    ds_read_b128 v[56:59], v17 offset:52224
    v_mfma_f32_16x16x32_bf16 v[68:71], a[196:199], v[32:35], v[68:71]
    v_cvt_pk_bf16_f32 v105, v105, v106
    v_and_b32 v108, 0xffff0000, v107
    v_mfma_f32_16x16x32_bf16 v[72:75], a[192:195], v[36:39], v[72:75]
    ds_read_b128 v[60:63], v18 offset:52224
    v_mfma_f32_16x16x32_bf16 v[76:79], a[196:199], v[36:39], v[76:79]
    v_lshlrev_b32 v107, 16, v107
    v_and_b32 v106, 0xffff0000, v105
    s_waitcnt lgkmcnt(4)
    v_mfma_f32_16x16x32_bf16 v[64:67], a[200:203], v[40:43], v[64:67]
    ds_read_b128 v[32:35], v17 offset:57344
    v_mfma_f32_16x16x32_bf16 v[68:71], a[204:207], v[40:43], v[68:71]
    v_lshlrev_b32 v105, 16, v105
    v_mul_f32 v107, v100, v107
    v_mfma_f32_16x16x32_bf16 v[72:75], a[200:203], v[44:47], v[72:75]
    ds_read_b128 v[36:39], v18 offset:57344
    v_mfma_f32_16x16x32_bf16 v[76:79], a[204:207], v[44:47], v[76:79]
    v_mul_f32 v108, v100, v108
    v_cvt_pk_bf16_f32 v107, v107, v108
    s_waitcnt lgkmcnt(4)
    v_mfma_f32_16x16x32_bf16 v[64:67], a[208:211], v[48:51], v[64:67]
    ds_read_b128 v[40:43], v17 offset:58368
    v_mfma_f32_16x16x32_bf16 v[68:71], a[212:215], v[48:51], v[68:71]
    v_and_b32 v108, 0xffff0000, v107
    v_lshlrev_b32 v107, 16, v107
    v_mfma_f32_16x16x32_bf16 v[72:75], a[208:211], v[52:55], v[72:75]
    ds_read_b128 v[44:47], v18 offset:58368
    v_mfma_f32_16x16x32_bf16 v[76:79], a[212:215], v[52:55], v[76:79]
    v_add_f32 v105, v105, v107
    v_add_f32 v106, v106, v108
    s_waitcnt lgkmcnt(4)
    v_mfma_f32_16x16x32_bf16 v[64:67], a[216:219], v[56:59], v[64:67]
    ds_read_b128 v[48:51], v17 offset:59392
    v_mfma_f32_16x16x32_bf16 v[68:71], a[220:223], v[56:59], v[68:71]
    v_cvt_pk_bf16_f32 v103, v105, v106
    s_mov_b64 exec, s[64:65]
    buffer_store_dwordx2 v[102:103], v22, s[44:47], s52 offen
    s_mov_b64 exec, -1
    v_mfma_f32_16x16x32_bf16 v[72:75], a[216:219], v[60:63], v[72:75]
    ds_read_b128 v[52:55], v18 offset:59392
    v_mfma_f32_16x16x32_bf16 v[76:79], a[220:223], v[60:63], v[76:79]
    s_add_u32 s51, s34, s55
    s_lshl_b32 s52, s54, 16
    s_lshl_b32 s60, s54, 7
    s_add_u32 s58, s60, 117440512
    s_add_u32 s59, s60, 117448704
    s_add_u32 s60, s60, 121634816

    s_cmp_eq_u32 s38, 0
    s_waitcnt lgkmcnt(4)
    v_mfma_f32_16x16x32_bf16 v[64:67], a[224:227], v[32:35], v[64:67]
    ds_read_b128 v[56:59], v17 offset:60416
    v_mfma_f32_16x16x32_bf16 v[68:71], a[228:231], v[32:35], v[68:71]
    s_cbranch_scc1 .cs_437
    buffer_load_dwordx2 v[96:97], v22, s[16:19], s52 offen
.cs_437:
    v_mfma_f32_16x16x32_bf16 v[72:75], a[224:227], v[36:39], v[72:75]
    ds_read_b128 v[60:63], v18 offset:60416
    v_mfma_f32_16x16x32_bf16 v[76:79], a[228:231], v[36:39], v[76:79]
    s_cbranch_scc1 .cs_438
    buffer_load_dword v98, v23, s[8:11], s58 offen
.cs_438:
    s_waitcnt lgkmcnt(4)
    v_mfma_f32_16x16x32_bf16 v[64:67], a[232:235], v[40:43], v[64:67]
    v_mfma_f32_16x16x32_bf16 v[68:71], a[236:239], v[40:43], v[68:71]
    s_cbranch_scc1 .cs_439
    buffer_load_dword v99, v23, s[8:11], s59 offen
.cs_439:
    v_mfma_f32_16x16x32_bf16 v[72:75], a[232:235], v[44:47], v[72:75]
    v_mfma_f32_16x16x32_bf16 v[76:79], a[236:239], v[44:47], v[76:79]
    s_cbranch_scc1 .cs_440
    buffer_load_dword v100, v16, s[8:11], s60 offen
.cs_440:
    s_waitcnt lgkmcnt(2)
    v_mfma_f32_16x16x32_bf16 v[64:67], a[240:243], v[48:51], v[64:67]
    v_mfma_f32_16x16x32_bf16 v[68:71], a[244:247], v[48:51], v[68:71]
    s_cbranch_scc1 .cs_441
    buffer_load_dwordx4 v[84:87], v7, s[8:11], s51 offen sc1
.cs_441:
    v_mfma_f32_16x16x32_bf16 v[72:75], a[240:243], v[52:55], v[72:75]
    v_mfma_f32_16x16x32_bf16 v[76:79], a[244:247], v[52:55], v[76:79]
    s_cbranch_scc1 .cs_442
    buffer_load_dwordx4 v[88:91], v8, s[8:11], s51 offen sc1
.cs_442:
    s_waitcnt lgkmcnt(0)
    v_mfma_f32_16x16x32_bf16 v[64:67], a[248:251], v[56:59], v[64:67]
    v_mfma_f32_16x16x32_bf16 v[68:71], a[252:255], v[56:59], v[68:71]
    s_cbranch_scc1 .cs_443
    buffer_load_dwordx4 v[92:95], v9, s[8:11], s51 offen sc1
.cs_443:
    v_mfma_f32_16x16x32_bf16 v[72:75], a[248:251], v[60:63], v[72:75]
    v_mfma_f32_16x16x32_bf16 v[76:79], a[252:255], v[60:63], v[76:79]
    v_xor_b32 v17, 0x10000, v17
    v_xor_b32 v18, 0x10000, v18
    s_cselect_b64 s[64:65], 0, -1
    s_add_u32 s4, s34, s37

    v_mov_b32 v112, v80
    v_mov_b32 v113, v81
    v_mov_b32 v114, v82
    v_mov_b32 v115, v83
    s_branch .g2st_426
.g2nd_425:
    s_waitcnt lgkmcnt(4)
    v_mfma_f32_16x16x32_bf16 v[64:67], a[0:3], v[32:35], 0
    ds_read_b128 v[56:59], v17 offset:3072
    v_mfma_f32_16x16x32_bf16 v[68:71], a[4:7], v[32:35], 0
    v_mfma_f32_16x16x32_bf16 v[72:75], a[0:3], v[36:39], 0
    ds_read_b128 v[60:63], v18 offset:3072
    v_mfma_f32_16x16x32_bf16 v[76:79], a[4:7], v[36:39], 0
    s_waitcnt lgkmcnt(4)
    v_mfma_f32_16x16x32_bf16 v[64:67], a[8:11], v[40:43], v[64:67]
    ds_read_b128 v[32:35], v17 offset:8192
    v_mfma_f32_16x16x32_bf16 v[68:71], a[12:15], v[40:43], v[68:71]
    v_mfma_f32_16x16x32_bf16 v[72:75], a[8:11], v[44:47], v[72:75]
    ds_read_b128 v[36:39], v18 offset:8192
    v_mfma_f32_16x16x32_bf16 v[76:79], a[12:15], v[44:47], v[76:79]
    s_waitcnt lgkmcnt(4)
    v_mfma_f32_16x16x32_bf16 v[64:67], a[16:19], v[48:51], v[64:67]
    ds_read_b128 v[40:43], v17 offset:9216
    v_mfma_f32_16x16x32_bf16 v[68:71], a[20:23], v[48:51], v[68:71]
    v_mfma_f32_16x16x32_bf16 v[72:75], a[16:19], v[52:55], v[72:75]
    ds_read_b128 v[44:47], v18 offset:9216
    v_mfma_f32_16x16x32_bf16 v[76:79], a[20:23], v[52:55], v[76:79]
    s_waitcnt lgkmcnt(4)
    v_mfma_f32_16x16x32_bf16 v[64:67], a[24:27], v[56:59], v[64:67]
    ds_read_b128 v[48:51], v17 offset:10240
    v_mfma_f32_16x16x32_bf16 v[68:71], a[28:31], v[56:59], v[68:71]
    v_mfma_f32_16x16x32_bf16 v[72:75], a[24:27], v[60:63], v[72:75]
    ds_read_b128 v[52:55], v18 offset:10240
    v_mfma_f32_16x16x32_bf16 v[76:79], a[28:31], v[60:63], v[76:79]
    s_waitcnt lgkmcnt(4)
    v_mfma_f32_16x16x32_bf16 v[64:67], a[32:35], v[32:35], v[64:67]
    ds_read_b128 v[56:59], v17 offset:11264
    v_mfma_f32_16x16x32_bf16 v[68:71], a[36:39], v[32:35], v[68:71]
    v_mfma_f32_16x16x32_bf16 v[72:75], a[32:35], v[36:39], v[72:75]
    ds_read_b128 v[60:63], v18 offset:11264
    v_mfma_f32_16x16x32_bf16 v[76:79], a[36:39], v[36:39], v[76:79]
    s_waitcnt lgkmcnt(4)
    v_mfma_f32_16x16x32_bf16 v[64:67], a[40:43], v[40:43], v[64:67]
    s_barrier
    ds_read_b128 v[32:35], v17 offset:16384
    v_mfma_f32_16x16x32_bf16 v[68:71], a[44:47], v[40:43], v[68:71]
    v_mfma_f32_16x16x32_bf16 v[72:75], a[40:43], v[44:47], v[72:75]
    ds_read_b128 v[36:39], v18 offset:16384
    v_mfma_f32_16x16x32_bf16 v[76:79], a[44:47], v[44:47], v[76:79]
    s_waitcnt lgkmcnt(4)
    v_mfma_f32_16x16x32_bf16 v[64:67], a[48:51], v[48:51], v[64:67]
    ds_read_b128 v[40:43], v17 offset:17408
    v_mfma_f32_16x16x32_bf16 v[68:71], a[52:55], v[48:51], v[68:71]
    v_mfma_f32_16x16x32_bf16 v[72:75], a[48:51], v[52:55], v[72:75]
    ds_read_b128 v[44:47], v18 offset:17408
    v_mfma_f32_16x16x32_bf16 v[76:79], a[52:55], v[52:55], v[76:79]
    s_waitcnt lgkmcnt(4)
    v_mfma_f32_16x16x32_bf16 v[64:67], a[56:59], v[56:59], v[64:67]
    ds_read_b128 v[48:51], v17 offset:18432
    v_mfma_f32_16x16x32_bf16 v[68:71], a[60:63], v[56:59], v[68:71]
    v_mfma_f32_16x16x32_bf16 v[72:75], a[56:59], v[60:63], v[72:75]
    ds_read_b128 v[52:55], v18 offset:18432
    v_mfma_f32_16x16x32_bf16 v[76:79], a[60:63], v[60:63], v[76:79]
    s_waitcnt lgkmcnt(4)
    v_mfma_f32_16x16x32_bf16 v[64:67], a[64:67], v[32:35], v[64:67]
    ds_read_b128 v[56:59], v17 offset:19456
    v_mfma_f32_16x16x32_bf16 v[68:71], a[68:71], v[32:35], v[68:71]
    v_mfma_f32_16x16x32_bf16 v[72:75], a[64:67], v[36:39], v[72:75]
    ds_read_b128 v[60:63], v18 offset:19456
    v_mfma_f32_16x16x32_bf16 v[76:79], a[68:71], v[36:39], v[76:79]
    s_waitcnt lgkmcnt(4)
    v_mfma_f32_16x16x32_bf16 v[64:67], a[72:75], v[40:43], v[64:67]
    ds_read_b128 v[32:35], v17 offset:24576
    v_mfma_f32_16x16x32_bf16 v[68:71], a[76:79], v[40:43], v[68:71]
    v_mfma_f32_16x16x32_bf16 v[72:75], a[72:75], v[44:47], v[72:75]
    ds_read_b128 v[36:39], v18 offset:24576
    v_mfma_f32_16x16x32_bf16 v[76:79], a[76:79], v[44:47], v[76:79]
    s_waitcnt lgkmcnt(4)
    v_mfma_f32_16x16x32_bf16 v[64:67], a[80:83], v[48:51], v[64:67]
    ds_read_b128 v[40:43], v17 offset:25600
    v_mfma_f32_16x16x32_bf16 v[68:71], a[84:87], v[48:51], v[68:71]
    s_waitcnt vmcnt(3)
    v_mfma_f32_16x16x32_bf16 v[72:75], a[80:83], v[52:55], v[72:75]
    ds_read_b128 v[44:47], v18 offset:25600
    v_mfma_f32_16x16x32_bf16 v[76:79], a[84:87], v[52:55], v[76:79]
    s_mov_b32 s62, 0
.cc_444:
    v_max3_u32 v4, v84, v88, v92
    v_cmp_eq_u32 vcc, -1, v4
    s_and_b64 vcc, vcc, s[64:65]
    s_cbranch_vccnz .cf_445
    s_waitcnt lgkmcnt(4)
    v_mfma_f32_16x16x32_bf16 v[64:67], a[88:91], v[56:59], v[64:67]
    ds_read_b128 v[48:51], v17 offset:26624
    v_mfma_f32_16x16x32_bf16 v[68:71], a[92:95], v[56:59], v[68:71]
    v_add_f32 v84, v84, v88
    v_add_f32 v92, v112, v92
    v_mfma_f32_16x16x32_bf16 v[72:75], a[88:91], v[60:63], v[72:75]
    ds_read_b128 v[52:55], v18 offset:26624
    v_mfma_f32_16x16x32_bf16 v[76:79], a[92:95], v[60:63], v[76:79]
    v_add_f32 v85, v85, v89
    v_add_f32 v93, v113, v93
    s_waitcnt lgkmcnt(4)
    v_mfma_f32_16x16x32_bf16 v[64:67], a[96:99], v[32:35], v[64:67]
    ds_read_b128 v[56:59], v17 offset:27648
    v_mfma_f32_16x16x32_bf16 v[68:71], a[100:103], v[32:35], v[68:71]
    v_add_f32 v86, v86, v90
    v_add_f32 v94, v114, v94
    v_mfma_f32_16x16x32_bf16 v[72:75], a[96:99], v[36:39], v[72:75]
    ds_read_b128 v[60:63], v18 offset:27648
    v_mfma_f32_16x16x32_bf16 v[76:79], a[100:103], v[36:39], v[76:79]
    v_add_f32 v87, v87, v91
    v_add_f32 v95, v115, v95
    s_waitcnt lgkmcnt(4)
    v_mfma_f32_16x16x32_bf16 v[64:67], a[104:107], v[40:43], v[64:67]
    s_barrier
    ds_read_b128 v[32:35], v17 offset:32768
    v_mfma_f32_16x16x32_bf16 v[68:71], a[108:111], v[40:43], v[68:71]
    v_add_f32 v84, v92, v84
    v_add_f32 v85, v93, v85
    v_mfma_f32_16x16x32_bf16 v[72:75], a[104:107], v[44:47], v[72:75]
    ds_read_b128 v[36:39], v18 offset:32768
    v_mfma_f32_16x16x32_bf16 v[76:79], a[108:111], v[44:47], v[76:79]
    v_add_f32 v86, v94, v86
    v_add_f32 v87, v95, v87
    s_waitcnt lgkmcnt(4)
    v_mfma_f32_16x16x32_bf16 v[64:67], a[112:115], v[48:51], v[64:67]
    ds_read_b128 v[40:43], v17 offset:33792
    v_mfma_f32_16x16x32_bf16 v[68:71], a[116:119], v[48:51], v[68:71]
    v_sub_f32 v104, 1.0, v100
    v_cvt_pk_bf16_f32 v104, v104, v104
    v_mfma_f32_16x16x32_bf16 v[72:75], a[112:115], v[52:55], v[72:75]
    ds_read_b128 v[44:47], v18 offset:33792
    v_mfma_f32_16x16x32_bf16 v[76:79], a[116:119], v[52:55], v[76:79]
    v_lshlrev_b32 v104, 16, v104
    v_cvt_pk_bf16_f32 v105, v84, v85
    s_waitcnt lgkmcnt(4)
    v_mfma_f32_16x16x32_bf16 v[64:67], a[120:123], v[56:59], v[64:67]
    ds_read_b128 v[48:51], v17 offset:34816
    v_mfma_f32_16x16x32_bf16 v[68:71], a[124:127], v[56:59], v[68:71]
    v_lshlrev_b32 v107, 16, v96
    v_and_b32 v108, 0xffff0000, v96
    v_mfma_f32_16x16x32_bf16 v[72:75], a[120:123], v[60:63], v[72:75]
    ds_read_b128 v[52:55], v18 offset:34816
    v_mfma_f32_16x16x32_bf16 v[76:79], a[124:127], v[60:63], v[76:79]
    v_lshlrev_b32 v109, 16, v98
    v_and_b32 v110, 0xffff0000, v98
    s_waitcnt lgkmcnt(4)
    v_mfma_f32_16x16x32_bf16 v[64:67], a[128:131], v[32:35], v[64:67]
    ds_read_b128 v[56:59], v17 offset:35840
    v_mfma_f32_16x16x32_bf16 v[68:71], a[132:135], v[32:35], v[68:71]
    v_and_b32 v106, 0xffff0000, v105
    v_lshlrev_b32 v105, 16, v105
    v_mfma_f32_16x16x32_bf16 v[72:75], a[128:131], v[36:39], v[72:75]
    ds_read_b128 v[60:63], v18 offset:35840
    v_mfma_f32_16x16x32_bf16 v[76:79], a[132:135], v[36:39], v[76:79]
    v_mul_f32 v107, v107, v109
    v_mul_f32 v108, v108, v110
    s_waitcnt lgkmcnt(4)
    v_mfma_f32_16x16x32_bf16 v[64:67], a[136:139], v[40:43], v[64:67]
    ds_read_b128 v[32:35], v17 offset:40960
    v_mfma_f32_16x16x32_bf16 v[68:71], a[140:143], v[40:43], v[68:71]
    v_mul_f32 v105, v104, v105
    v_mul_f32 v106, v104, v106
    v_mfma_f32_16x16x32_bf16 v[72:75], a[136:139], v[44:47], v[72:75]
    ds_read_b128 v[36:39], v18 offset:40960
    v_mfma_f32_16x16x32_bf16 v[76:79], a[140:143], v[44:47], v[76:79]
    v_cvt_pk_bf16_f32 v107, v107, v108
    v_cvt_pk_bf16_f32 v105, v105, v106
    s_waitcnt lgkmcnt(4)
    v_mfma_f32_16x16x32_bf16 v[64:67], a[144:147], v[48:51], v[64:67]
    ds_read_b128 v[40:43], v17 offset:41984
    v_mfma_f32_16x16x32_bf16 v[68:71], a[148:151], v[48:51], v[68:71]
    v_and_b32 v108, 0xffff0000, v107
    v_lshlrev_b32 v107, 16, v107
    v_mfma_f32_16x16x32_bf16 v[72:75], a[144:147], v[52:55], v[72:75]
    ds_read_b128 v[44:47], v18 offset:41984
    v_mfma_f32_16x16x32_bf16 v[76:79], a[148:151], v[52:55], v[76:79]
    v_and_b32 v106, 0xffff0000, v105
    v_lshlrev_b32 v105, 16, v105
    s_waitcnt lgkmcnt(4)
    v_mfma_f32_16x16x32_bf16 v[64:67], a[152:155], v[56:59], v[64:67]
    ds_read_b128 v[48:51], v17 offset:43008
    v_mfma_f32_16x16x32_bf16 v[68:71], a[156:159], v[56:59], v[68:71]
    v_mul_f32 v107, v100, v107
    v_mul_f32 v108, v100, v108
    v_mfma_f32_16x16x32_bf16 v[72:75], a[152:155], v[60:63], v[72:75]
    ds_read_b128 v[52:55], v18 offset:43008
    v_mfma_f32_16x16x32_bf16 v[76:79], a[156:159], v[60:63], v[76:79]
    v_cvt_pk_bf16_f32 v107, v107, v108
    v_and_b32 v108, 0xffff0000, v107
    s_waitcnt lgkmcnt(4)
    v_mfma_f32_16x16x32_bf16 v[64:67], a[160:163], v[32:35], v[64:67]
    ds_read_b128 v[56:59], v17 offset:44032
    v_mfma_f32_16x16x32_bf16 v[68:71], a[164:167], v[32:35], v[68:71]
    v_lshlrev_b32 v107, 16, v107
    v_add_f32 v105, v105, v107
    v_mfma_f32_16x16x32_bf16 v[72:75], a[160:163], v[36:39], v[72:75]
    ds_read_b128 v[60:63], v18 offset:44032
    v_mfma_f32_16x16x32_bf16 v[76:79], a[164:167], v[36:39], v[76:79]
    v_add_f32 v106, v106, v108
    v_cvt_pk_bf16_f32 v102, v105, v106
    s_waitcnt lgkmcnt(4)
    v_mfma_f32_16x16x32_bf16 v[64:67], a[168:171], v[40:43], v[64:67]
    s_barrier
    ds_read_b128 v[32:35], v17 offset:49152
    v_mfma_f32_16x16x32_bf16 v[68:71], a[172:175], v[40:43], v[68:71]
    v_cvt_pk_bf16_f32 v105, v86, v87
    v_lshlrev_b32 v107, 16, v97
    v_mfma_f32_16x16x32_bf16 v[72:75], a[168:171], v[44:47], v[72:75]
    ds_read_b128 v[36:39], v18 offset:49152
    v_mfma_f32_16x16x32_bf16 v[76:79], a[172:175], v[44:47], v[76:79]
    v_and_b32 v108, 0xffff0000, v97
    v_lshlrev_b32 v109, 16, v99
    s_waitcnt lgkmcnt(4)
    v_mfma_f32_16x16x32_bf16 v[64:67], a[176:179], v[48:51], v[64:67]
    ds_read_b128 v[40:43], v17 offset:50176
    v_mfma_f32_16x16x32_bf16 v[68:71], a[180:183], v[48:51], v[68:71]
    v_and_b32 v110, 0xffff0000, v99
    v_and_b32 v106, 0xffff0000, v105
    v_mfma_f32_16x16x32_bf16 v[72:75], a[176:179], v[52:55], v[72:75]
    ds_read_b128 v[44:47], v18 offset:50176
    v_mfma_f32_16x16x32_bf16 v[76:79], a[180:183], v[52:55], v[76:79]
    v_lshlrev_b32 v105, 16, v105
    v_mul_f32 v107, v107, v109
    s_waitcnt lgkmcnt(4)
    v_mfma_f32_16x16x32_bf16 v[64:67], a[184:187], v[56:59], v[64:67]
    ds_read_b128 v[48:51], v17 offset:51200
    v_mfma_f32_16x16x32_bf16 v[68:71], a[188:191], v[56:59], v[68:71]
    v_mul_f32 v108, v108, v110
    v_mul_f32 v105, v104, v105
    v_mfma_f32_16x16x32_bf16 v[72:75], a[184:187], v[60:63], v[72:75]
    ds_read_b128 v[52:55], v18 offset:51200
    v_mfma_f32_16x16x32_bf16 v[76:79], a[188:191], v[60:63], v[76:79]
    v_mul_f32 v106, v104, v106
    v_cvt_pk_bf16_f32 v107, v107, v108
    s_waitcnt lgkmcnt(4)
    v_mfma_f32_16x16x32_bf16 v[64:67], a[192:195], v[32:35], v[64:67]
    ds_read_b128 v[56:59], v17 offset:52224
    v_mfma_f32_16x16x32_bf16 v[68:71], a[196:199], v[32:35], v[68:71]
    v_cvt_pk_bf16_f32 v105, v105, v106
    v_and_b32 v108, 0xffff0000, v107
    v_mfma_f32_16x16x32_bf16 v[72:75], a[192:195], v[36:39], v[72:75]
    ds_read_b128 v[60:63], v18 offset:52224
    v_mfma_f32_16x16x32_bf16 v[76:79], a[196:199], v[36:39], v[76:79]
    v_lshlrev_b32 v107, 16, v107
    v_and_b32 v106, 0xffff0000, v105
    s_waitcnt lgkmcnt(4)
    v_mfma_f32_16x16x32_bf16 v[64:67], a[200:203], v[40:43], v[64:67]
    ds_read_b128 v[32:35], v17 offset:57344
    v_mfma_f32_16x16x32_bf16 v[68:71], a[204:207], v[40:43], v[68:71]
    v_lshlrev_b32 v105, 16, v105
    v_mul_f32 v107, v100, v107
    v_mfma_f32_16x16x32_bf16 v[72:75], a[200:203], v[44:47], v[72:75]
    ds_read_b128 v[36:39], v18 offset:57344
    v_mfma_f32_16x16x32_bf16 v[76:79], a[204:207], v[44:47], v[76:79]
    v_mul_f32 v108, v100, v108
    v_cvt_pk_bf16_f32 v107, v107, v108
    s_waitcnt lgkmcnt(4)
    v_mfma_f32_16x16x32_bf16 v[64:67], a[208:211], v[48:51], v[64:67]
    ds_read_b128 v[40:43], v17 offset:58368
    v_mfma_f32_16x16x32_bf16 v[68:71], a[212:215], v[48:51], v[68:71]
    v_and_b32 v108, 0xffff0000, v107
    v_lshlrev_b32 v107, 16, v107
    v_mfma_f32_16x16x32_bf16 v[72:75], a[208:211], v[52:55], v[72:75]
    ds_read_b128 v[44:47], v18 offset:58368
    v_mfma_f32_16x16x32_bf16 v[76:79], a[212:215], v[52:55], v[76:79]
    v_add_f32 v105, v105, v107
    v_add_f32 v106, v106, v108
    s_waitcnt lgkmcnt(4)
    v_mfma_f32_16x16x32_bf16 v[64:67], a[216:219], v[56:59], v[64:67]
    ds_read_b128 v[48:51], v17 offset:59392
    v_mfma_f32_16x16x32_bf16 v[68:71], a[220:223], v[56:59], v[68:71]
    v_cvt_pk_bf16_f32 v103, v105, v106
    s_mov_b64 exec, s[64:65]
    buffer_store_dwordx2 v[102:103], v22, s[44:47], s52 offen
    s_mov_b64 exec, -1
    v_mfma_f32_16x16x32_bf16 v[72:75], a[216:219], v[60:63], v[72:75]
    ds_read_b128 v[52:55], v18 offset:59392
    v_mfma_f32_16x16x32_bf16 v[76:79], a[220:223], v[60:63], v[76:79]
    s_add_u32 s51, s34, s55
    s_lshl_b32 s52, s54, 16
    s_lshl_b32 s60, s54, 7
    s_add_u32 s58, s60, 117440512
    s_add_u32 s59, s60, 117448704
    s_add_u32 s60, s60, 121634816

    s_cmp_eq_u32 s38, 0
    s_waitcnt lgkmcnt(4)
    v_mfma_f32_16x16x32_bf16 v[64:67], a[224:227], v[32:35], v[64:67]
    ds_read_b128 v[56:59], v17 offset:60416
    v_mfma_f32_16x16x32_bf16 v[68:71], a[228:231], v[32:35], v[68:71]
    s_cbranch_scc1 .cs_446
    buffer_load_dwordx2 v[96:97], v22, s[16:19], s52 offen
.cs_446:
    v_mfma_f32_16x16x32_bf16 v[72:75], a[224:227], v[36:39], v[72:75]
    ds_read_b128 v[60:63], v18 offset:60416
    v_mfma_f32_16x16x32_bf16 v[76:79], a[228:231], v[36:39], v[76:79]
    s_cbranch_scc1 .cs_447
    buffer_load_dword v98, v23, s[8:11], s58 offen
.cs_447:
    s_waitcnt lgkmcnt(4)
    v_mfma_f32_16x16x32_bf16 v[64:67], a[232:235], v[40:43], v[64:67]
    v_mfma_f32_16x16x32_bf16 v[68:71], a[236:239], v[40:43], v[68:71]
    s_cbranch_scc1 .cs_448
    buffer_load_dword v99, v23, s[8:11], s59 offen
.cs_448:
    v_mfma_f32_16x16x32_bf16 v[72:75], a[232:235], v[44:47], v[72:75]
    v_mfma_f32_16x16x32_bf16 v[76:79], a[236:239], v[44:47], v[76:79]
    s_cbranch_scc1 .cs_449
    buffer_load_dword v100, v16, s[8:11], s60 offen
.cs_449:
    s_waitcnt lgkmcnt(2)
    v_mfma_f32_16x16x32_bf16 v[64:67], a[240:243], v[48:51], v[64:67]
    v_mfma_f32_16x16x32_bf16 v[68:71], a[244:247], v[48:51], v[68:71]
    s_cbranch_scc1 .cs_450
    buffer_load_dwordx4 v[84:87], v7, s[8:11], s51 offen sc1
.cs_450:
    v_mfma_f32_16x16x32_bf16 v[72:75], a[240:243], v[52:55], v[72:75]
    v_mfma_f32_16x16x32_bf16 v[76:79], a[244:247], v[52:55], v[76:79]
    s_cbranch_scc1 .cs_451
    buffer_load_dwordx4 v[88:91], v8, s[8:11], s51 offen sc1
.cs_451:
    s_waitcnt lgkmcnt(0)
    v_mfma_f32_16x16x32_bf16 v[64:67], a[248:251], v[56:59], v[64:67]
    v_mfma_f32_16x16x32_bf16 v[68:71], a[252:255], v[56:59], v[68:71]
    s_cbranch_scc1 .cs_452
    buffer_load_dwordx4 v[92:95], v9, s[8:11], s51 offen sc1
.cs_452:
    v_mfma_f32_16x16x32_bf16 v[72:75], a[248:251], v[60:63], v[72:75]
    v_mfma_f32_16x16x32_bf16 v[76:79], a[252:255], v[60:63], v[76:79]
    v_xor_b32 v17, 0x10000, v17
    v_xor_b32 v18, 0x10000, v18
    s_cselect_b64 s[64:65], 0, -1
    s_add_u32 s4, s34, s37

    v_mov_b32 v112, v80
    v_mov_b32 v113, v81
    v_mov_b32 v114, v82
    v_mov_b32 v115, v83
.g2st_426:
    v_min_u32 v68, 0xfffffffe, v68
    buffer_store_dwordx4 v[68:71], v28, s[8:11], s4 offen sc1
    v_min_u32 v72, 0xfffffffe, v72
    buffer_store_dwordx4 v[72:75], v29, s[8:11], s4 offen sc1
    v_min_u32 v76, 0xfffffffe, v76
    buffer_store_dwordx4 v[76:79], v30, s[8:11], s4 offen sc1
    v_mov_b32 v80, v64
    v_mov_b32 v81, v65
    v_mov_b32 v82, v66
    v_mov_b32 v83, v67
    s_cmp_lg_u32 s56, 0
    s_cbranch_scc1 .g2pf_453
    s_cmp_eq_u32 s38, 0
    s_cbranch_scc1 .g2nc_427
    s_waitcnt vmcnt(0)
    s_mov_b32 s62, 0
.cc_454:
    v_max3_u32 v4, v84, v88, v92
    v_cmp_eq_u32 vcc, -1, v4
    s_cbranch_vccnz .cf_455
    v_add_f32 v84, v84, v88
    v_add_f32 v92, v112, v92
    v_add_f32 v85, v85, v89
    v_add_f32 v93, v113, v93
    v_add_f32 v86, v86, v90
    v_add_f32 v94, v114, v94
    v_add_f32 v87, v87, v91
    v_add_f32 v95, v115, v95
    v_add_f32 v84, v92, v84
    v_add_f32 v85, v93, v85
    v_add_f32 v86, v94, v86
    v_add_f32 v87, v95, v87
    v_sub_f32 v104, 1.0, v100
    v_cvt_pk_bf16_f32 v104, v104, v104
    v_lshlrev_b32 v104, 16, v104
    v_cvt_pk_bf16_f32 v105, v84, v85
    v_lshlrev_b32 v107, 16, v96
    v_and_b32 v108, 0xffff0000, v96
    v_lshlrev_b32 v109, 16, v98
    v_and_b32 v110, 0xffff0000, v98
    v_and_b32 v106, 0xffff0000, v105
    v_lshlrev_b32 v105, 16, v105
    v_mul_f32 v107, v107, v109
    v_mul_f32 v108, v108, v110
    v_mul_f32 v105, v104, v105
    v_mul_f32 v106, v104, v106
    v_cvt_pk_bf16_f32 v107, v107, v108
    v_cvt_pk_bf16_f32 v105, v105, v106
    v_and_b32 v108, 0xffff0000, v107
    v_lshlrev_b32 v107, 16, v107
    v_and_b32 v106, 0xffff0000, v105
    v_lshlrev_b32 v105, 16, v105
    v_mul_f32 v107, v100, v107
    v_mul_f32 v108, v100, v108
    v_cvt_pk_bf16_f32 v107, v107, v108
    v_and_b32 v108, 0xffff0000, v107
    v_lshlrev_b32 v107, 16, v107
    v_add_f32 v105, v105, v107
    v_add_f32 v106, v106, v108
    v_cvt_pk_bf16_f32 v102, v105, v106
    v_cvt_pk_bf16_f32 v105, v86, v87
    v_lshlrev_b32 v107, 16, v97
    v_and_b32 v108, 0xffff0000, v97
    v_lshlrev_b32 v109, 16, v99
    v_and_b32 v110, 0xffff0000, v99
    v_and_b32 v106, 0xffff0000, v105
    v_lshlrev_b32 v105, 16, v105
    v_mul_f32 v107, v107, v109
    v_mul_f32 v108, v108, v110
    v_mul_f32 v105, v104, v105
    v_mul_f32 v106, v104, v106
    v_cvt_pk_bf16_f32 v107, v107, v108
    v_cvt_pk_bf16_f32 v105, v105, v106
    v_and_b32 v108, 0xffff0000, v107
    v_lshlrev_b32 v107, 16, v107
    v_and_b32 v106, 0xffff0000, v105
    v_lshlrev_b32 v105, 16, v105
    v_mul_f32 v107, v100, v107
    v_mul_f32 v108, v100, v108
    v_cvt_pk_bf16_f32 v107, v107, v108
    v_and_b32 v108, 0xffff0000, v107
    v_lshlrev_b32 v107, 16, v107
    v_add_f32 v105, v105, v107
    v_add_f32 v106, v106, v108
    v_cvt_pk_bf16_f32 v103, v105, v106
    buffer_store_dwordx2 v[102:103], v22, s[44:47], s52 offen
.g2nc_427:
    s_add_u32 s51, s34, s37
    s_lshl_b32 s52, s31, 16
    s_lshl_b32 s60, s31, 7
    s_add_u32 s58, s60, 117440512
    s_add_u32 s59, s60, 117448704
    s_add_u32 s60, s60, 121634816

    buffer_load_dwordx2 v[96:97], v22, s[16:19], s52 offen
    buffer_load_dword v98, v23, s[8:11], s58 offen
    buffer_load_dword v99, v23, s[8:11], s59 offen
    buffer_load_dword v100, v16, s[8:11], s60 offen
    buffer_load_dwordx4 v[84:87], v7, s[8:11], s51 offen sc1
    buffer_load_dwordx4 v[88:91], v8, s[8:11], s51 offen sc1
    buffer_load_dwordx4 v[92:95], v9, s[8:11], s51 offen sc1
    s_waitcnt vmcnt(0)
    s_mov_b32 s62, 0
.cc_456:
    v_max3_u32 v4, v84, v88, v92
    v_cmp_eq_u32 vcc, -1, v4
    s_cbranch_vccnz .cf_457
    v_add_f32 v84, v84, v88
    v_add_f32 v92, v80, v92
    v_add_f32 v85, v85, v89
    v_add_f32 v93, v81, v93
    v_add_f32 v86, v86, v90
    v_add_f32 v94, v82, v94
    v_add_f32 v87, v87, v91
    v_add_f32 v95, v83, v95
    v_add_f32 v84, v92, v84
    v_add_f32 v85, v93, v85
    v_add_f32 v86, v94, v86
    v_add_f32 v87, v95, v87
    v_sub_f32 v104, 1.0, v100
    v_cvt_pk_bf16_f32 v104, v104, v104
    v_lshlrev_b32 v104, 16, v104
    v_cvt_pk_bf16_f32 v105, v84, v85
    v_lshlrev_b32 v107, 16, v96
    v_and_b32 v108, 0xffff0000, v96
    v_lshlrev_b32 v109, 16, v98
    v_and_b32 v110, 0xffff0000, v98
    v_and_b32 v106, 0xffff0000, v105
    v_lshlrev_b32 v105, 16, v105
    v_mul_f32 v107, v107, v109
    v_mul_f32 v108, v108, v110
    v_mul_f32 v105, v104, v105
    v_mul_f32 v106, v104, v106
    v_cvt_pk_bf16_f32 v107, v107, v108
    v_cvt_pk_bf16_f32 v105, v105, v106
    v_and_b32 v108, 0xffff0000, v107
    v_lshlrev_b32 v107, 16, v107
    v_and_b32 v106, 0xffff0000, v105
    v_lshlrev_b32 v105, 16, v105
    v_mul_f32 v107, v100, v107
    v_mul_f32 v108, v100, v108
    v_cvt_pk_bf16_f32 v107, v107, v108
    v_and_b32 v108, 0xffff0000, v107
    v_lshlrev_b32 v107, 16, v107
    v_add_f32 v105, v105, v107
    v_add_f32 v106, v106, v108
    v_cvt_pk_bf16_f32 v102, v105, v106
    v_cvt_pk_bf16_f32 v105, v86, v87
    v_lshlrev_b32 v107, 16, v97
    v_and_b32 v108, 0xffff0000, v97
    v_lshlrev_b32 v109, 16, v99
    v_and_b32 v110, 0xffff0000, v99
    v_and_b32 v106, 0xffff0000, v105
    v_lshlrev_b32 v105, 16, v105
    v_mul_f32 v107, v107, v109
    v_mul_f32 v108, v108, v110
    v_mul_f32 v105, v104, v105
    v_mul_f32 v106, v104, v106
    v_cvt_pk_bf16_f32 v107, v107, v108
    v_cvt_pk_bf16_f32 v105, v105, v106
    v_and_b32 v108, 0xffff0000, v107
    v_lshlrev_b32 v107, 16, v107
    v_and_b32 v106, 0xffff0000, v105
    v_lshlrev_b32 v105, 16, v105
    v_mul_f32 v107, v100, v107
    v_mul_f32 v108, v100, v108
    v_cvt_pk_bf16_f32 v107, v107, v108
    v_and_b32 v108, 0xffff0000, v107
    v_lshlrev_b32 v107, 16, v107
    v_add_f32 v105, v105, v107
    v_add_f32 v106, v106, v108
    v_cvt_pk_bf16_f32 v103, v105, v106
    buffer_store_dwordx2 v[102:103], v22, s[44:47], s52 offen
.g2nx_433:
    s_mov_b32 s54, s31
    s_mov_b32 s31, s53
    s_mov_b32 s69, 3
    s_add_u32 s37, s37, 0x10000
    s_cmp_lt_u32 s31, 65
    s_cbranch_scc1 .g2blk_421
    s_branch .g2fin_428

.g2pf_453:
    s_mov_b32 s54, s31
    s_mov_b32 s31, s53
    s_mov_b32 s69, 3
    s_add_u32 s37, s37, 0x10000
    s_cmp_eq_u32 s38, 0
    s_mov_b32 s38, 1
    s_cbranch_scc1 .g2w3_423
    s_waitcnt vmcnt(10)
    s_branch .g2go_422

.g2w3_423:
    s_waitcnt vmcnt(3)
    s_branch .g2go_422
.g2h_430:
    s_mov_b32 s53, 63
    s_and_b32 s54, s31, 1
    s_lshr_b32 s4, s91, 1
    s_xor_b32 s55, s54, s4
    s_lshl_b32 s4, s55, 12
    v_xor_b32 v17, s4, v17

    s_add_u32 s51, s34, s37
    s_lshl_b32 s52, s53, 16
    s_lshl_b32 s60, s53, 7
    s_add_u32 s58, s60, 117440512
    s_add_u32 s59, s60, 117448704
    s_add_u32 s60, s60, 121634816

    s_lshl_b32 s48, s53, 18
    s_add_u32 s48, s48, s36
    s_add_u32 s49, s39, s35
    s_xor_b32 s39, s39, 0x10000

    s_lshl_b32 s4, s54, 12
    s_add_u32 s48, s48, s4
    s_add_u32 s49, s49, s4
    buffer_load_dwordx2 v[96:97], v22, s[16:19], s52 offen
    buffer_load_dword v98, v23, s[8:11], s58 offen
    buffer_load_dword v99, v23, s[8:11], s59 offen
    buffer_load_dword v100, v16, s[8:11], s60 offen
    s_waitcnt vmcnt(0)
    v_sub_f32 v104, 1.0, v100
    v_cvt_pk_bf16_f32 v104, v104, v104
    v_lshlrev_b32 v104, 16, v104
    v_lshlrev_b32 v107, 16, v96
    v_and_b32 v108, 0xffff0000, v96
    v_lshlrev_b32 v109, 16, v98
    v_and_b32 v110, 0xffff0000, v98
    v_mul_f32 v107, v107, v109
    v_mul_f32 v108, v108, v110
    v_cvt_pk_bf16_f32 v107, v107, v108
    v_and_b32 v108, 0xffff0000, v107
    v_lshlrev_b32 v107, 16, v107
    v_mul_f32 v107, v100, v107
    v_mul_f32 v108, v100, v108
    v_cvt_pk_bf16_f32 v107, v107, v108
    v_and_b32 v113, 0xffff0000, v107
    v_lshlrev_b32 v112, 16, v107
    v_lshlrev_b32 v107, 16, v97
    v_and_b32 v108, 0xffff0000, v97
    v_lshlrev_b32 v109, 16, v99
    v_and_b32 v110, 0xffff0000, v99
    v_mul_f32 v107, v107, v109
    v_mul_f32 v108, v108, v110
    v_cvt_pk_bf16_f32 v107, v107, v108
    v_and_b32 v108, 0xffff0000, v107
    v_lshlrev_b32 v107, 16, v107
    v_mul_f32 v107, v100, v107
    v_mul_f32 v108, v100, v108
    v_cvt_pk_bf16_f32 v107, v107, v108
    v_and_b32 v115, 0xffff0000, v107
    v_lshlrev_b32 v114, 16, v107
.hp_458:
    buffer_load_dword v20, v19, s[8:11], s33 offen sc1
    s_waitcnt vmcnt(0)
    s_lshr_b32 s6, s31, 2
    s_and_b32 s4, s31, 3
    v_cmp_ge_u32 vcc, s6, v20
    s_lshl_b32 s4, s4, 3
    s_lshr_b32 s5, vcc_lo, s4
    s_and_b32 s5, s5, 0xff
    s_cmp_eq_u32 s5, 0

    s_cbranch_scc1 .hr_459
    s_lshl_b64 exec, 0xff, s4
    s_add_u32 s62, s62, 1
    s_cmp_gt_u32 s62, 0x400000
    s_cbranch_scc1 .mg_end_1
    s_branch .hp_458

.hr_459:
    s_mov_b64 exec, -1
    s_add_u32 m0, s49, 0
    s_add_u32 s50, s48, 0
    buffer_load_dwordx4 v21, s[8:11], s50 offen offset:0 sc1 lds
    s_add_u32 m0, s49, 8192
    s_add_u32 s50, s48, 8192
    buffer_load_dwordx4 v21, s[8:11], s50 offen offset:0 sc1 lds
    s_add_u32 m0, s49, 16384
    s_add_u32 s50, s48, 16384
    buffer_load_dwordx4 v21, s[8:11], s50 offen offset:0 sc1 lds
    s_add_u32 m0, s49, 24576
    s_add_u32 s50, s48, 24576
    buffer_load_dwordx4 v21, s[8:11], s50 offen offset:0 sc1 lds
    s_add_u32 m0, s49, 32768
    s_add_u32 s50, s48, 32768
    buffer_load_dwordx4 v21, s[8:11], s50 offen offset:0 sc1 lds
    s_add_u32 m0, s49, 40960
    s_add_u32 s50, s48, 40960
    buffer_load_dwordx4 v21, s[8:11], s50 offen offset:0 sc1 lds
    s_add_u32 m0, s49, 49152
    s_add_u32 s50, s48, 49152
    buffer_load_dwordx4 v21, s[8:11], s50 offen offset:0 sc1 lds
    s_add_u32 m0, s49, 57344
    s_add_u32 s50, s48, 57344
    buffer_load_dwordx4 v21, s[8:11], s50 offen offset:0 sc1 lds
    s_waitcnt vmcnt(6)
    s_barrier
    ds_read_b128 v[32:35], v17 offset:0
    ds_read_b128 v[36:39], v17 offset:1024
    ds_read_b128 v[40:43], v17 offset:2048
    ds_read_b128 v[44:47], v17 offset:3072
    ds_read_b128 v[48:51], v17 offset:8192
    ds_read_b128 v[52:55], v17 offset:9216
    s_waitcnt lgkmcnt(5)
    v_mfma_f32_16x16x32_bf16 v[64:67], a[0:3], v[32:35], 0
    ds_read_b128 v[56:59], v17 offset:10240
    v_mfma_f32_16x16x32_bf16 v[68:71], a[4:7], v[32:35], 0
    s_waitcnt lgkmcnt(5)
    v_mfma_f32_16x16x32_bf16 v[72:75], a[8:11], v[36:39], 0
    ds_read_b128 v[60:63], v17 offset:11264
    v_mfma_f32_16x16x32_bf16 v[76:79], a[12:15], v[36:39], 0
    s_waitcnt lgkmcnt(5)
    v_mfma_f32_16x16x32_bf16 v[64:67], a[16:19], v[40:43], v[64:67]
    s_waitcnt vmcnt(4)
    s_barrier
    ds_read_b128 v[32:35], v17 offset:16384
    v_mfma_f32_16x16x32_bf16 v[68:71], a[20:23], v[40:43], v[68:71]
    s_waitcnt lgkmcnt(5)
    v_mfma_f32_16x16x32_bf16 v[72:75], a[24:27], v[44:47], v[72:75]
    ds_read_b128 v[36:39], v17 offset:17408
    v_mfma_f32_16x16x32_bf16 v[76:79], a[28:31], v[44:47], v[76:79]
    s_waitcnt lgkmcnt(5)
    v_mfma_f32_16x16x32_bf16 v[64:67], a[32:35], v[48:51], v[64:67]
    ds_read_b128 v[40:43], v17 offset:18432
    v_mfma_f32_16x16x32_bf16 v[68:71], a[36:39], v[48:51], v[68:71]
    s_waitcnt lgkmcnt(5)
    v_mfma_f32_16x16x32_bf16 v[72:75], a[40:43], v[52:55], v[72:75]
    ds_read_b128 v[44:47], v17 offset:19456
    v_mfma_f32_16x16x32_bf16 v[76:79], a[44:47], v[52:55], v[76:79]
    s_waitcnt lgkmcnt(5)
    v_mfma_f32_16x16x32_bf16 v[64:67], a[48:51], v[56:59], v[64:67]
    ds_read_b128 v[48:51], v17 offset:24576
    v_mfma_f32_16x16x32_bf16 v[68:71], a[52:55], v[56:59], v[68:71]
    s_waitcnt lgkmcnt(5)
    v_mfma_f32_16x16x32_bf16 v[72:75], a[56:59], v[60:63], v[72:75]
    ds_read_b128 v[52:55], v17 offset:25600
    v_mfma_f32_16x16x32_bf16 v[76:79], a[60:63], v[60:63], v[76:79]
    s_waitcnt lgkmcnt(5)
    v_mfma_f32_16x16x32_bf16 v[64:67], a[64:67], v[32:35], v[64:67]
    ds_read_b128 v[56:59], v17 offset:26624
    v_mfma_f32_16x16x32_bf16 v[68:71], a[68:71], v[32:35], v[68:71]
    s_waitcnt lgkmcnt(5)
    v_mfma_f32_16x16x32_bf16 v[72:75], a[72:75], v[36:39], v[72:75]
    ds_read_b128 v[60:63], v17 offset:27648
    v_mfma_f32_16x16x32_bf16 v[76:79], a[76:79], v[36:39], v[76:79]
    s_waitcnt lgkmcnt(5)
    v_mfma_f32_16x16x32_bf16 v[64:67], a[80:83], v[40:43], v[64:67]
    s_waitcnt vmcnt(2)
    s_barrier
    ds_read_b128 v[32:35], v17 offset:32768
    v_mfma_f32_16x16x32_bf16 v[68:71], a[84:87], v[40:43], v[68:71]
    s_waitcnt lgkmcnt(5)
    v_mfma_f32_16x16x32_bf16 v[72:75], a[88:91], v[44:47], v[72:75]
    ds_read_b128 v[36:39], v17 offset:33792
    v_mfma_f32_16x16x32_bf16 v[76:79], a[92:95], v[44:47], v[76:79]
    s_waitcnt lgkmcnt(5)
    v_mfma_f32_16x16x32_bf16 v[64:67], a[96:99], v[48:51], v[64:67]
    ds_read_b128 v[40:43], v17 offset:34816
    v_mfma_f32_16x16x32_bf16 v[68:71], a[100:103], v[48:51], v[68:71]
    s_waitcnt lgkmcnt(5)
    v_mfma_f32_16x16x32_bf16 v[72:75], a[104:107], v[52:55], v[72:75]
    ds_read_b128 v[44:47], v17 offset:35840
    v_mfma_f32_16x16x32_bf16 v[76:79], a[108:111], v[52:55], v[76:79]
    s_waitcnt lgkmcnt(5)
    v_mfma_f32_16x16x32_bf16 v[64:67], a[112:115], v[56:59], v[64:67]
    ds_read_b128 v[48:51], v17 offset:40960
    v_mfma_f32_16x16x32_bf16 v[68:71], a[116:119], v[56:59], v[68:71]
    s_waitcnt lgkmcnt(5)
    v_mfma_f32_16x16x32_bf16 v[72:75], a[120:123], v[60:63], v[72:75]
    ds_read_b128 v[52:55], v17 offset:41984
    v_mfma_f32_16x16x32_bf16 v[76:79], a[124:127], v[60:63], v[76:79]
    s_waitcnt lgkmcnt(5)
    v_mfma_f32_16x16x32_bf16 v[64:67], a[128:131], v[32:35], v[64:67]
    ds_read_b128 v[56:59], v17 offset:43008
    v_mfma_f32_16x16x32_bf16 v[68:71], a[132:135], v[32:35], v[68:71]
    s_waitcnt lgkmcnt(5)
    v_mfma_f32_16x16x32_bf16 v[72:75], a[136:139], v[36:39], v[72:75]
    ds_read_b128 v[60:63], v17 offset:44032
    v_mfma_f32_16x16x32_bf16 v[76:79], a[140:143], v[36:39], v[76:79]
    s_waitcnt lgkmcnt(5)
    v_mfma_f32_16x16x32_bf16 v[64:67], a[144:147], v[40:43], v[64:67]
    s_waitcnt vmcnt(0)
    s_barrier
    ds_read_b128 v[32:35], v17 offset:49152
    v_mfma_f32_16x16x32_bf16 v[68:71], a[148:151], v[40:43], v[68:71]
    s_waitcnt lgkmcnt(5)
    v_mfma_f32_16x16x32_bf16 v[72:75], a[152:155], v[44:47], v[72:75]
    ds_read_b128 v[36:39], v17 offset:50176
    v_mfma_f32_16x16x32_bf16 v[76:79], a[156:159], v[44:47], v[76:79]
    s_waitcnt lgkmcnt(5)
    v_mfma_f32_16x16x32_bf16 v[64:67], a[160:163], v[48:51], v[64:67]
    ds_read_b128 v[40:43], v17 offset:51200
    v_mfma_f32_16x16x32_bf16 v[68:71], a[164:167], v[48:51], v[68:71]
    s_waitcnt lgkmcnt(5)
    v_mfma_f32_16x16x32_bf16 v[72:75], a[168:171], v[52:55], v[72:75]
    ds_read_b128 v[44:47], v17 offset:52224
    v_mfma_f32_16x16x32_bf16 v[76:79], a[172:175], v[52:55], v[76:79]
    s_waitcnt lgkmcnt(5)
    v_mfma_f32_16x16x32_bf16 v[64:67], a[176:179], v[56:59], v[64:67]
    ds_read_b128 v[48:51], v17 offset:57344
    v_mfma_f32_16x16x32_bf16 v[68:71], a[180:183], v[56:59], v[68:71]
    s_waitcnt lgkmcnt(5)
    v_mfma_f32_16x16x32_bf16 v[72:75], a[184:187], v[60:63], v[72:75]
    ds_read_b128 v[52:55], v17 offset:58368
    v_mfma_f32_16x16x32_bf16 v[76:79], a[188:191], v[60:63], v[76:79]
    s_waitcnt lgkmcnt(5)
    v_mfma_f32_16x16x32_bf16 v[64:67], a[192:195], v[32:35], v[64:67]
    ds_read_b128 v[56:59], v17 offset:59392
    v_mfma_f32_16x16x32_bf16 v[68:71], a[196:199], v[32:35], v[68:71]
    s_waitcnt lgkmcnt(5)
    v_mfma_f32_16x16x32_bf16 v[72:75], a[200:203], v[36:39], v[72:75]
    ds_read_b128 v[60:63], v17 offset:60416
    v_mfma_f32_16x16x32_bf16 v[76:79], a[204:207], v[36:39], v[76:79]
    s_waitcnt lgkmcnt(5)
    v_mfma_f32_16x16x32_bf16 v[64:67], a[208:211], v[40:43], v[64:67]
    v_mfma_f32_16x16x32_bf16 v[68:71], a[212:215], v[40:43], v[68:71]
    s_waitcnt lgkmcnt(4)
    v_mfma_f32_16x16x32_bf16 v[72:75], a[216:219], v[44:47], v[72:75]
    v_mfma_f32_16x16x32_bf16 v[76:79], a[220:223], v[44:47], v[76:79]
    s_waitcnt lgkmcnt(3)
    v_mfma_f32_16x16x32_bf16 v[64:67], a[224:227], v[48:51], v[64:67]
    v_mfma_f32_16x16x32_bf16 v[68:71], a[228:231], v[48:51], v[68:71]
    s_waitcnt lgkmcnt(2)
    v_mfma_f32_16x16x32_bf16 v[72:75], a[232:235], v[52:55], v[72:75]
    v_mfma_f32_16x16x32_bf16 v[76:79], a[236:239], v[52:55], v[76:79]
    s_waitcnt lgkmcnt(1)
    v_mfma_f32_16x16x32_bf16 v[64:67], a[240:243], v[56:59], v[64:67]
    v_mfma_f32_16x16x32_bf16 v[68:71], a[244:247], v[56:59], v[68:71]
    s_waitcnt lgkmcnt(0)
    v_mfma_f32_16x16x32_bf16 v[72:75], a[248:251], v[60:63], v[72:75]
    v_mfma_f32_16x16x32_bf16 v[76:79], a[252:255], v[60:63], v[76:79]
    s_cmp_lg_u32 s55, 0
    s_nop 6
    v_pk_add_f32 v[68:69], v[68:69], v[76:77]
    v_pk_add_f32 v[70:71], v[70:71], v[78:79]
    v_pk_add_f32 v[64:65], v[64:65], v[72:73]
    v_pk_add_f32 v[66:67], v[66:67], v[74:75]
    v_min_u32 v68, 0xfffffffe, v68
    s_cbranch_scc1 .hs_460
    buffer_store_dwordx4 v[68:71], v28, s[8:11], s51 offen sc1
    s_waitcnt vmcnt(0)
    buffer_load_dwordx4 v[84:87], v7, s[8:11], s51 offen sc1
    buffer_load_dwordx4 v[88:91], v8, s[8:11], s51 offen sc1
    buffer_load_dwordx4 v[92:95], v9, s[8:11], s51 offen sc1
    s_waitcnt vmcnt(0)
    s_mov_b32 s62, 0
.cc_462:
    v_max3_u32 v4, v84, v88, v92
    v_cmp_eq_u32 vcc, -1, v4
    s_cbranch_vccnz .cf_463
    v_add_f32 v84, v84, v88
    v_add_f32 v92, v64, v92
    v_add_f32 v85, v85, v89
    v_add_f32 v93, v65, v93
    v_add_f32 v86, v86, v90
    v_add_f32 v94, v66, v94
    v_add_f32 v87, v87, v91
    v_add_f32 v95, v67, v95
    v_add_f32 v84, v92, v84
    v_add_f32 v85, v93, v85
    v_add_f32 v86, v94, v86
    v_add_f32 v87, v95, v87
    v_cvt_pk_bf16_f32 v105, v84, v85
    v_cvt_pk_bf16_f32 v107, v86, v87
    v_and_b32 v106, 0xffff0000, v105
    v_lshlrev_b32 v105, 16, v105
    v_and_b32 v108, 0xffff0000, v107
    v_lshlrev_b32 v107, 16, v107
    v_mul_f32 v105, v104, v105
    v_mul_f32 v106, v104, v106
    v_mul_f32 v107, v104, v107
    v_mul_f32 v108, v104, v108
    v_cvt_pk_bf16_f32 v105, v105, v106
    v_cvt_pk_bf16_f32 v107, v107, v108
    v_and_b32 v106, 0xffff0000, v105
    v_lshlrev_b32 v105, 16, v105
    v_and_b32 v108, 0xffff0000, v107
    v_lshlrev_b32 v107, 16, v107
    v_add_f32 v105, v105, v112
    v_add_f32 v106, v106, v113
    v_add_f32 v107, v107, v114
    v_add_f32 v108, v108, v115
    v_cvt_pk_bf16_f32 v102, v105, v106
    v_cvt_pk_bf16_f32 v103, v107, v108
    buffer_store_dwordx2 v[102:103], v22, s[44:47], s52 offen
    s_branch .g2fin_428
.hs_460:
    v_min_u32 v64, 0xfffffffe, v64
    buffer_store_dwordx4 v[68:71], v30, s[8:11], s51 offen sc1
    buffer_store_dwordx4 v[64:67], v29, s[8:11], s51 offen sc1

    s_branch .g2fin_428
.g2fb_432:
    s_add_u32 s51, s34, s37
    s_lshl_b32 s52, s31, 16
    s_lshl_b32 s60, s31, 7
    s_add_u32 s58, s60, 117440512
    s_add_u32 s59, s60, 117448704
    s_add_u32 s60, s60, 121634816

    s_waitcnt vmcnt(4)
    s_barrier
    ds_read_b128 v[32:35], v17 offset:0
    ds_read_b128 v[36:39], v18 offset:0
    ds_read_b128 v[40:43], v17 offset:1024
    ds_read_b128 v[44:47], v18 offset:1024
    ds_read_b128 v[48:51], v17 offset:2048
    ds_read_b128 v[52:55], v18 offset:2048
    s_waitcnt lgkmcnt(4)
    v_mfma_f32_16x16x32_bf16 v[64:67], a[0:3], v[32:35], 0
    ds_read_b128 v[56:59], v17 offset:3072
    v_mfma_f32_16x16x32_bf16 v[68:71], a[4:7], v[32:35], 0
    s_add_u32 m0, s49, 32768
    s_add_u32 s50, s48, 32768
    v_mfma_f32_16x16x32_bf16 v[72:75], a[0:3], v[36:39], 0
    ds_read_b128 v[60:63], v18 offset:3072
    v_mfma_f32_16x16x32_bf16 v[76:79], a[4:7], v[36:39], 0
    buffer_load_dwordx4 v21, s[8:11], s50 offen offset:0 sc1 lds
    s_waitcnt lgkmcnt(4)
    v_mfma_f32_16x16x32_bf16 v[64:67], a[8:11], v[40:43], v[64:67]
    ds_read_b128 v[32:35], v17 offset:8192
    v_mfma_f32_16x16x32_bf16 v[68:71], a[12:15], v[40:43], v[68:71]
    s_add_u32 m0, s49, 36864
    s_add_u32 s50, s48, 36864
    v_mfma_f32_16x16x32_bf16 v[72:75], a[8:11], v[44:47], v[72:75]
    ds_read_b128 v[36:39], v18 offset:8192
    v_mfma_f32_16x16x32_bf16 v[76:79], a[12:15], v[44:47], v[76:79]
    buffer_load_dwordx4 v21, s[8:11], s50 offen offset:0 sc1 lds
    s_waitcnt lgkmcnt(4)
    v_mfma_f32_16x16x32_bf16 v[64:67], a[16:19], v[48:51], v[64:67]
    ds_read_b128 v[40:43], v17 offset:9216
    v_mfma_f32_16x16x32_bf16 v[68:71], a[20:23], v[48:51], v[68:71]
    s_add_u32 m0, s49, 40960
    s_add_u32 s50, s48, 40960
    v_mfma_f32_16x16x32_bf16 v[72:75], a[16:19], v[52:55], v[72:75]
    ds_read_b128 v[44:47], v18 offset:9216
    v_mfma_f32_16x16x32_bf16 v[76:79], a[20:23], v[52:55], v[76:79]
    buffer_load_dwordx4 v21, s[8:11], s50 offen offset:0 sc1 lds
    s_waitcnt lgkmcnt(4)
    v_mfma_f32_16x16x32_bf16 v[64:67], a[24:27], v[56:59], v[64:67]
    ds_read_b128 v[48:51], v17 offset:10240
    v_mfma_f32_16x16x32_bf16 v[68:71], a[28:31], v[56:59], v[68:71]
    s_add_u32 m0, s49, 45056
    s_add_u32 s50, s48, 45056
    v_mfma_f32_16x16x32_bf16 v[72:75], a[24:27], v[60:63], v[72:75]
    ds_read_b128 v[52:55], v18 offset:10240
    v_mfma_f32_16x16x32_bf16 v[76:79], a[28:31], v[60:63], v[76:79]
    buffer_load_dwordx4 v21, s[8:11], s50 offen offset:0 sc1 lds
    s_waitcnt lgkmcnt(4)
    v_mfma_f32_16x16x32_bf16 v[64:67], a[32:35], v[32:35], v[64:67]
    ds_read_b128 v[56:59], v17 offset:11264
    v_mfma_f32_16x16x32_bf16 v[68:71], a[36:39], v[32:35], v[68:71]
    s_add_u32 m0, s49, 49152
    s_add_u32 s50, s48, 49152
    v_mfma_f32_16x16x32_bf16 v[72:75], a[32:35], v[36:39], v[72:75]
    ds_read_b128 v[60:63], v18 offset:11264
    v_mfma_f32_16x16x32_bf16 v[76:79], a[36:39], v[36:39], v[76:79]
    buffer_load_dwordx4 v21, s[8:11], s50 offen offset:0 sc1 lds
    s_waitcnt lgkmcnt(4)
    v_mfma_f32_16x16x32_bf16 v[64:67], a[40:43], v[40:43], v[64:67]
    s_waitcnt vmcnt(5)
    s_barrier
    ds_read_b128 v[32:35], v17 offset:16384
    v_mfma_f32_16x16x32_bf16 v[68:71], a[44:47], v[40:43], v[68:71]
    s_add_u32 m0, s49, 53248
    s_add_u32 s50, s48, 53248
    v_mfma_f32_16x16x32_bf16 v[72:75], a[40:43], v[44:47], v[72:75]
    ds_read_b128 v[36:39], v18 offset:16384
    v_mfma_f32_16x16x32_bf16 v[76:79], a[44:47], v[44:47], v[76:79]
    buffer_load_dwordx4 v21, s[8:11], s50 offen offset:0 sc1 lds
    s_waitcnt lgkmcnt(4)
    v_mfma_f32_16x16x32_bf16 v[64:67], a[48:51], v[48:51], v[64:67]
    ds_read_b128 v[40:43], v17 offset:17408
    v_mfma_f32_16x16x32_bf16 v[68:71], a[52:55], v[48:51], v[68:71]
    s_add_u32 m0, s49, 57344
    s_add_u32 s50, s48, 57344
    v_mfma_f32_16x16x32_bf16 v[72:75], a[48:51], v[52:55], v[72:75]
    ds_read_b128 v[44:47], v18 offset:17408
    v_mfma_f32_16x16x32_bf16 v[76:79], a[52:55], v[52:55], v[76:79]
    buffer_load_dwordx4 v21, s[8:11], s50 offen offset:0 sc1 lds
    s_waitcnt lgkmcnt(4)
    v_mfma_f32_16x16x32_bf16 v[64:67], a[56:59], v[56:59], v[64:67]
    ds_read_b128 v[48:51], v17 offset:18432
    v_mfma_f32_16x16x32_bf16 v[68:71], a[60:63], v[56:59], v[68:71]
    s_add_u32 m0, s49, 61440
    s_add_u32 s50, s48, 61440
    v_mfma_f32_16x16x32_bf16 v[72:75], a[56:59], v[60:63], v[72:75]
    ds_read_b128 v[52:55], v18 offset:18432
    v_mfma_f32_16x16x32_bf16 v[76:79], a[60:63], v[60:63], v[76:79]
    buffer_load_dwordx4 v21, s[8:11], s50 offen offset:0 sc1 lds
    s_waitcnt lgkmcnt(4)
    v_mfma_f32_16x16x32_bf16 v[64:67], a[64:67], v[32:35], v[64:67]
    ds_read_b128 v[56:59], v17 offset:19456
    v_mfma_f32_16x16x32_bf16 v[68:71], a[68:71], v[32:35], v[68:71]
    v_mfma_f32_16x16x32_bf16 v[72:75], a[64:67], v[36:39], v[72:75]
    ds_read_b128 v[60:63], v18 offset:19456
    v_mfma_f32_16x16x32_bf16 v[76:79], a[68:71], v[36:39], v[76:79]
    buffer_load_dwordx2 v[96:97], v22, s[16:19], s52 offen
    s_waitcnt lgkmcnt(4)
    v_mfma_f32_16x16x32_bf16 v[64:67], a[72:75], v[40:43], v[64:67]
    ds_read_b128 v[32:35], v17 offset:24576
    v_mfma_f32_16x16x32_bf16 v[68:71], a[76:79], v[40:43], v[68:71]
    v_mfma_f32_16x16x32_bf16 v[72:75], a[72:75], v[44:47], v[72:75]
    ds_read_b128 v[36:39], v18 offset:24576
    v_mfma_f32_16x16x32_bf16 v[76:79], a[76:79], v[44:47], v[76:79]
    buffer_load_dword v98, v23, s[8:11], s58 offen
    s_waitcnt lgkmcnt(4)
    v_mfma_f32_16x16x32_bf16 v[64:67], a[80:83], v[48:51], v[64:67]
    ds_read_b128 v[40:43], v17 offset:25600
    v_mfma_f32_16x16x32_bf16 v[68:71], a[84:87], v[48:51], v[68:71]
    v_mfma_f32_16x16x32_bf16 v[72:75], a[80:83], v[52:55], v[72:75]
    ds_read_b128 v[44:47], v18 offset:25600
    v_mfma_f32_16x16x32_bf16 v[76:79], a[84:87], v[52:55], v[76:79]
    buffer_load_dword v99, v23, s[8:11], s59 offen
    s_waitcnt lgkmcnt(4)
    v_mfma_f32_16x16x32_bf16 v[64:67], a[88:91], v[56:59], v[64:67]
    ds_read_b128 v[48:51], v17 offset:26624
    v_mfma_f32_16x16x32_bf16 v[68:71], a[92:95], v[56:59], v[68:71]
    v_mfma_f32_16x16x32_bf16 v[72:75], a[88:91], v[60:63], v[72:75]
    ds_read_b128 v[52:55], v18 offset:26624
    v_mfma_f32_16x16x32_bf16 v[76:79], a[92:95], v[60:63], v[76:79]
    buffer_load_dword v100, v16, s[8:11], s60 offen
    s_waitcnt lgkmcnt(4)
    v_mfma_f32_16x16x32_bf16 v[64:67], a[96:99], v[32:35], v[64:67]
    ds_read_b128 v[56:59], v17 offset:27648
    v_mfma_f32_16x16x32_bf16 v[68:71], a[100:103], v[32:35], v[68:71]
    v_mfma_f32_16x16x32_bf16 v[72:75], a[96:99], v[36:39], v[72:75]
    ds_read_b128 v[60:63], v18 offset:27648
    v_mfma_f32_16x16x32_bf16 v[76:79], a[100:103], v[36:39], v[76:79]
    s_waitcnt lgkmcnt(4)
    v_mfma_f32_16x16x32_bf16 v[64:67], a[104:107], v[40:43], v[64:67]
    s_waitcnt vmcnt(8)
    s_barrier
    ds_read_b128 v[32:35], v17 offset:32768
    v_mfma_f32_16x16x32_bf16 v[68:71], a[108:111], v[40:43], v[68:71]
    v_mfma_f32_16x16x32_bf16 v[72:75], a[104:107], v[44:47], v[72:75]
    ds_read_b128 v[36:39], v18 offset:32768
    v_mfma_f32_16x16x32_bf16 v[76:79], a[108:111], v[44:47], v[76:79]
    s_waitcnt lgkmcnt(4)
    v_mfma_f32_16x16x32_bf16 v[64:67], a[112:115], v[48:51], v[64:67]
    ds_read_b128 v[40:43], v17 offset:33792
    v_mfma_f32_16x16x32_bf16 v[68:71], a[116:119], v[48:51], v[68:71]
    v_mfma_f32_16x16x32_bf16 v[72:75], a[112:115], v[52:55], v[72:75]
    ds_read_b128 v[44:47], v18 offset:33792
    v_mfma_f32_16x16x32_bf16 v[76:79], a[116:119], v[52:55], v[76:79]
    s_waitcnt lgkmcnt(4)
    v_mfma_f32_16x16x32_bf16 v[64:67], a[120:123], v[56:59], v[64:67]
    ds_read_b128 v[48:51], v17 offset:34816
    v_mfma_f32_16x16x32_bf16 v[68:71], a[124:127], v[56:59], v[68:71]
    v_mfma_f32_16x16x32_bf16 v[72:75], a[120:123], v[60:63], v[72:75]
    ds_read_b128 v[52:55], v18 offset:34816
    v_mfma_f32_16x16x32_bf16 v[76:79], a[124:127], v[60:63], v[76:79]
    s_waitcnt lgkmcnt(4)
    v_mfma_f32_16x16x32_bf16 v[64:67], a[128:131], v[32:35], v[64:67]
    ds_read_b128 v[56:59], v17 offset:35840
    v_mfma_f32_16x16x32_bf16 v[68:71], a[132:135], v[32:35], v[68:71]
    v_mfma_f32_16x16x32_bf16 v[72:75], a[128:131], v[36:39], v[72:75]
    ds_read_b128 v[60:63], v18 offset:35840
    v_mfma_f32_16x16x32_bf16 v[76:79], a[132:135], v[36:39], v[76:79]
    s_waitcnt lgkmcnt(4)
    v_mfma_f32_16x16x32_bf16 v[64:67], a[136:139], v[40:43], v[64:67]
    ds_read_b128 v[32:35], v17 offset:40960
    v_mfma_f32_16x16x32_bf16 v[68:71], a[140:143], v[40:43], v[68:71]
    v_mfma_f32_16x16x32_bf16 v[72:75], a[136:139], v[44:47], v[72:75]
    ds_read_b128 v[36:39], v18 offset:40960
    v_mfma_f32_16x16x32_bf16 v[76:79], a[140:143], v[44:47], v[76:79]
    s_waitcnt lgkmcnt(4)
    v_mfma_f32_16x16x32_bf16 v[64:67], a[144:147], v[48:51], v[64:67]
    ds_read_b128 v[40:43], v17 offset:41984
    v_mfma_f32_16x16x32_bf16 v[68:71], a[148:151], v[48:51], v[68:71]
    v_mfma_f32_16x16x32_bf16 v[72:75], a[144:147], v[52:55], v[72:75]
    ds_read_b128 v[44:47], v18 offset:41984
    v_mfma_f32_16x16x32_bf16 v[76:79], a[148:151], v[52:55], v[76:79]
    s_waitcnt lgkmcnt(4)
    v_mfma_f32_16x16x32_bf16 v[64:67], a[152:155], v[56:59], v[64:67]
    ds_read_b128 v[48:51], v17 offset:43008
    v_mfma_f32_16x16x32_bf16 v[68:71], a[156:159], v[56:59], v[68:71]
    v_mfma_f32_16x16x32_bf16 v[72:75], a[152:155], v[60:63], v[72:75]
    ds_read_b128 v[52:55], v18 offset:43008
    v_mfma_f32_16x16x32_bf16 v[76:79], a[156:159], v[60:63], v[76:79]
    s_waitcnt lgkmcnt(4)
    v_mfma_f32_16x16x32_bf16 v[64:67], a[160:163], v[32:35], v[64:67]
    ds_read_b128 v[56:59], v17 offset:44032
    v_mfma_f32_16x16x32_bf16 v[68:71], a[164:167], v[32:35], v[68:71]
    v_mfma_f32_16x16x32_bf16 v[72:75], a[160:163], v[36:39], v[72:75]
    ds_read_b128 v[60:63], v18 offset:44032
    v_mfma_f32_16x16x32_bf16 v[76:79], a[164:167], v[36:39], v[76:79]
    s_waitcnt lgkmcnt(4)
    v_mfma_f32_16x16x32_bf16 v[64:67], a[168:171], v[40:43], v[64:67]
    s_waitcnt vmcnt(4)
    s_barrier
    ds_read_b128 v[32:35], v17 offset:49152
    v_mfma_f32_16x16x32_bf16 v[68:71], a[172:175], v[40:43], v[68:71]
    v_mfma_f32_16x16x32_bf16 v[72:75], a[168:171], v[44:47], v[72:75]
    ds_read_b128 v[36:39], v18 offset:49152
    v_mfma_f32_16x16x32_bf16 v[76:79], a[172:175], v[44:47], v[76:79]
    s_waitcnt lgkmcnt(4)
    v_mfma_f32_16x16x32_bf16 v[64:67], a[176:179], v[48:51], v[64:67]
    ds_read_b128 v[40:43], v17 offset:50176
    v_mfma_f32_16x16x32_bf16 v[68:71], a[180:183], v[48:51], v[68:71]
    v_mfma_f32_16x16x32_bf16 v[72:75], a[176:179], v[52:55], v[72:75]
    ds_read_b128 v[44:47], v18 offset:50176
    v_mfma_f32_16x16x32_bf16 v[76:79], a[180:183], v[52:55], v[76:79]
    s_waitcnt lgkmcnt(4)
    v_mfma_f32_16x16x32_bf16 v[64:67], a[184:187], v[56:59], v[64:67]
    ds_read_b128 v[48:51], v17 offset:51200
    v_mfma_f32_16x16x32_bf16 v[68:71], a[188:191], v[56:59], v[68:71]
    v_mfma_f32_16x16x32_bf16 v[72:75], a[184:187], v[60:63], v[72:75]
    ds_read_b128 v[52:55], v18 offset:51200
    v_mfma_f32_16x16x32_bf16 v[76:79], a[188:191], v[60:63], v[76:79]
    s_waitcnt lgkmcnt(4)
    v_mfma_f32_16x16x32_bf16 v[64:67], a[192:195], v[32:35], v[64:67]
    ds_read_b128 v[56:59], v17 offset:52224
    v_mfma_f32_16x16x32_bf16 v[68:71], a[196:199], v[32:35], v[68:71]
    v_mfma_f32_16x16x32_bf16 v[72:75], a[192:195], v[36:39], v[72:75]
    ds_read_b128 v[60:63], v18 offset:52224
    v_mfma_f32_16x16x32_bf16 v[76:79], a[196:199], v[36:39], v[76:79]
    s_waitcnt lgkmcnt(4)
    v_mfma_f32_16x16x32_bf16 v[64:67], a[200:203], v[40:43], v[64:67]
    ds_read_b128 v[32:35], v17 offset:57344
    v_mfma_f32_16x16x32_bf16 v[68:71], a[204:207], v[40:43], v[68:71]
    v_mfma_f32_16x16x32_bf16 v[72:75], a[200:203], v[44:47], v[72:75]
    ds_read_b128 v[36:39], v18 offset:57344
    v_mfma_f32_16x16x32_bf16 v[76:79], a[204:207], v[44:47], v[76:79]
    s_waitcnt lgkmcnt(4)
    v_mfma_f32_16x16x32_bf16 v[64:67], a[208:211], v[48:51], v[64:67]
    ds_read_b128 v[40:43], v17 offset:58368
    v_mfma_f32_16x16x32_bf16 v[68:71], a[212:215], v[48:51], v[68:71]
    v_mfma_f32_16x16x32_bf16 v[72:75], a[208:211], v[52:55], v[72:75]
    ds_read_b128 v[44:47], v18 offset:58368
    v_mfma_f32_16x16x32_bf16 v[76:79], a[212:215], v[52:55], v[76:79]
    s_waitcnt lgkmcnt(4)
    v_mfma_f32_16x16x32_bf16 v[64:67], a[216:219], v[56:59], v[64:67]
    ds_read_b128 v[48:51], v17 offset:59392
    v_mfma_f32_16x16x32_bf16 v[68:71], a[220:223], v[56:59], v[68:71]
    v_mfma_f32_16x16x32_bf16 v[72:75], a[216:219], v[60:63], v[72:75]
    ds_read_b128 v[52:55], v18 offset:59392
    v_mfma_f32_16x16x32_bf16 v[76:79], a[220:223], v[60:63], v[76:79]
    s_waitcnt lgkmcnt(4)
    v_mfma_f32_16x16x32_bf16 v[64:67], a[224:227], v[32:35], v[64:67]
    ds_read_b128 v[56:59], v17 offset:60416
    v_mfma_f32_16x16x32_bf16 v[68:71], a[228:231], v[32:35], v[68:71]
    v_mfma_f32_16x16x32_bf16 v[72:75], a[224:227], v[36:39], v[72:75]
    ds_read_b128 v[60:63], v18 offset:60416
    v_mfma_f32_16x16x32_bf16 v[76:79], a[228:231], v[36:39], v[76:79]
    s_waitcnt lgkmcnt(4)
    v_mfma_f32_16x16x32_bf16 v[64:67], a[232:235], v[40:43], v[64:67]
    v_mfma_f32_16x16x32_bf16 v[68:71], a[236:239], v[40:43], v[68:71]
    v_mfma_f32_16x16x32_bf16 v[72:75], a[232:235], v[44:47], v[72:75]
    v_mfma_f32_16x16x32_bf16 v[76:79], a[236:239], v[44:47], v[76:79]
    s_waitcnt lgkmcnt(2)
    v_mfma_f32_16x16x32_bf16 v[64:67], a[240:243], v[48:51], v[64:67]
    v_mfma_f32_16x16x32_bf16 v[68:71], a[244:247], v[48:51], v[68:71]
    v_mfma_f32_16x16x32_bf16 v[72:75], a[240:243], v[52:55], v[72:75]
    v_mfma_f32_16x16x32_bf16 v[76:79], a[244:247], v[52:55], v[76:79]
    s_waitcnt lgkmcnt(0)
    v_mfma_f32_16x16x32_bf16 v[64:67], a[248:251], v[56:59], v[64:67]
    v_mfma_f32_16x16x32_bf16 v[68:71], a[252:255], v[56:59], v[68:71]
    v_mfma_f32_16x16x32_bf16 v[72:75], a[248:251], v[60:63], v[72:75]
    v_mfma_f32_16x16x32_bf16 v[76:79], a[252:255], v[60:63], v[76:79]
    v_xor_b32 v17, 0x10000, v17
    v_xor_b32 v18, 0x10000, v18
    s_nop 3
    v_min_u32 v68, 0xfffffffe, v68
    buffer_store_dwordx4 v[68:71], v28, s[8:11], s51 offen sc1
    v_min_u32 v72, 0xfffffffe, v72
    buffer_store_dwordx4 v[72:75], v29, s[8:11], s51 offen sc1
    v_min_u32 v76, 0xfffffffe, v76
    buffer_store_dwordx4 v[76:79], v30, s[8:11], s51 offen sc1
    s_waitcnt vmcnt(3)
    v_sub_f32 v104, 1.0, v100
    v_cvt_pk_bf16_f32 v104, v104, v104
    v_lshlrev_b32 v104, 16, v104
    v_lshlrev_b32 v107, 16, v96
    v_and_b32 v108, 0xffff0000, v96
    v_lshlrev_b32 v109, 16, v98
    v_and_b32 v110, 0xffff0000, v98
    v_mul_f32 v107, v107, v109
    v_mul_f32 v108, v108, v110
    v_cvt_pk_bf16_f32 v107, v107, v108
    v_and_b32 v108, 0xffff0000, v107
    v_lshlrev_b32 v107, 16, v107
    v_mul_f32 v107, v100, v107
    v_mul_f32 v108, v100, v108
    v_cvt_pk_bf16_f32 v107, v107, v108
    v_and_b32 v113, 0xffff0000, v107
    v_lshlrev_b32 v112, 16, v107
    v_lshlrev_b32 v107, 16, v97
    v_and_b32 v108, 0xffff0000, v97
    v_lshlrev_b32 v109, 16, v99
    v_and_b32 v110, 0xffff0000, v99
    v_mul_f32 v107, v107, v109
    v_mul_f32 v108, v108, v110
    v_cvt_pk_bf16_f32 v107, v107, v108
    v_and_b32 v108, 0xffff0000, v107
    v_lshlrev_b32 v107, 16, v107
    v_mul_f32 v107, v100, v107
    v_mul_f32 v108, v100, v108
    v_cvt_pk_bf16_f32 v107, v107, v108
    v_and_b32 v115, 0xffff0000, v107
    v_lshlrev_b32 v114, 16, v107
    s_waitcnt vmcnt(0)
    buffer_load_dwordx4 v[84:87], v7, s[8:11], s51 offen sc1
    buffer_load_dwordx4 v[88:91], v8, s[8:11], s51 offen sc1
    buffer_load_dwordx4 v[92:95], v9, s[8:11], s51 offen sc1
    s_waitcnt vmcnt(0)
    s_mov_b32 s62, 0
.cc_464:
    v_max3_u32 v4, v84, v88, v92
    v_cmp_eq_u32 vcc, -1, v4
    s_cbranch_vccnz .cf_465
    v_add_f32 v84, v84, v88
    v_add_f32 v92, v64, v92
    v_add_f32 v85, v85, v89
    v_add_f32 v93, v65, v93
    v_add_f32 v86, v86, v90
    v_add_f32 v94, v66, v94
    v_add_f32 v87, v87, v91
    v_add_f32 v95, v67, v95
    v_add_f32 v84, v92, v84
    v_add_f32 v85, v93, v85
    v_add_f32 v86, v94, v86
    v_add_f32 v87, v95, v87
    v_cvt_pk_bf16_f32 v105, v84, v85
    v_cvt_pk_bf16_f32 v107, v86, v87
    v_and_b32 v106, 0xffff0000, v105
    v_lshlrev_b32 v105, 16, v105
    v_and_b32 v108, 0xffff0000, v107
    v_lshlrev_b32 v107, 16, v107
    v_mul_f32 v105, v104, v105
    v_mul_f32 v106, v104, v106
    v_mul_f32 v107, v104, v107
    v_mul_f32 v108, v104, v108
    v_cvt_pk_bf16_f32 v105, v105, v106
    v_cvt_pk_bf16_f32 v107, v107, v108
    v_and_b32 v106, 0xffff0000, v105
    v_lshlrev_b32 v105, 16, v105
    v_and_b32 v108, 0xffff0000, v107
    v_lshlrev_b32 v107, 16, v107
    v_add_f32 v105, v105, v112
    v_add_f32 v106, v106, v113
    v_add_f32 v107, v107, v114
    v_add_f32 v108, v108, v115
    v_cvt_pk_bf16_f32 v102, v105, v106
    v_cvt_pk_bf16_f32 v103, v107, v108
    buffer_store_dwordx2 v[102:103], v22, s[44:47], s52 offen
    s_branch .g2nx_433
.cf_436:
    buffer_load_dwordx4 v[84:87], v7, s[8:11], s51 offen sc1
    buffer_load_dwordx4 v[88:91], v8, s[8:11], s51 offen sc1
    buffer_load_dwordx4 v[92:95], v9, s[8:11], s51 offen sc1
    s_add_u32 s62, s62, 1
    s_cmp_gt_u32 s62, 0x400000
    s_cbranch_scc1 .mg_end_1
    s_waitcnt vmcnt(0)
    s_branch .cc_435

.cf_445:
    buffer_load_dwordx4 v[84:87], v7, s[8:11], s51 offen sc1
    buffer_load_dwordx4 v[88:91], v8, s[8:11], s51 offen sc1
    buffer_load_dwordx4 v[92:95], v9, s[8:11], s51 offen sc1
    s_add_u32 s62, s62, 1
    s_cmp_gt_u32 s62, 0x400000
    s_cbranch_scc1 .mg_end_1
    s_waitcnt vmcnt(0)
    s_branch .cc_444

.cf_455:
    buffer_load_dwordx4 v[84:87], v7, s[8:11], s51 offen sc1
    buffer_load_dwordx4 v[88:91], v8, s[8:11], s51 offen sc1
    buffer_load_dwordx4 v[92:95], v9, s[8:11], s51 offen sc1
    s_add_u32 s62, s62, 1
    s_cmp_gt_u32 s62, 0x400000
    s_cbranch_scc1 .mg_end_1
    s_waitcnt vmcnt(0)
    s_branch .cc_454

.cf_457:
    buffer_load_dwordx4 v[84:87], v7, s[8:11], s51 offen sc1
    buffer_load_dwordx4 v[88:91], v8, s[8:11], s51 offen sc1
    buffer_load_dwordx4 v[92:95], v9, s[8:11], s51 offen sc1
    s_add_u32 s62, s62, 1
    s_cmp_gt_u32 s62, 0x400000
    s_cbranch_scc1 .mg_end_1
    s_waitcnt vmcnt(0)
    s_branch .cc_456

.cf_463:
    buffer_load_dwordx4 v[84:87], v7, s[8:11], s51 offen sc1
    buffer_load_dwordx4 v[88:91], v8, s[8:11], s51 offen sc1
    buffer_load_dwordx4 v[92:95], v9, s[8:11], s51 offen sc1
    s_add_u32 s62, s62, 1
    s_cmp_gt_u32 s62, 0x400000
    s_cbranch_scc1 .mg_end_1
    s_waitcnt vmcnt(0)
    s_branch .cc_462

.cf_465:
    buffer_load_dwordx4 v[84:87], v7, s[8:11], s51 offen sc1
    buffer_load_dwordx4 v[88:91], v8, s[8:11], s51 offen sc1
    buffer_load_dwordx4 v[92:95], v9, s[8:11], s51 offen sc1
    s_add_u32 s62, s62, 1
    s_cmp_gt_u32 s62, 0x400000
    s_cbranch_scc1 .mg_end_1
    s_waitcnt vmcnt(0)
    s_branch .cc_464

.g2fin_428:
    s_endpgm
.cvrole_382:
    s_lshl_b32 s4, s91, 3
    s_add_u32 s4, s4, s26
    s_add_u32 s4, s4, 72
    s_lshl_b32 s4, s4, 8
    s_add_u32 s92, s4, 92274688
    s_lshl_b32 s4, s24, 2
    s_add_u32 s92, s92, s4
    v_mov_b32 v4, 0
    s_mov_b64 exec, 1
    buffer_store_dword v4, v4, s[8:11], s92 offen sc1
    s_mov_b64 exec, -1

    s_waitcnt vmcnt(0)
    s_barrier
    v_mov_b32 v243, s99
    v_mov_b32 v242, 0
    s_cmp_lg_u32 s24, 0
    s_cbranch_scc1 .a1_466
    v_mov_b32 v242, s26
    v_lshlrev_b32 v242, 6, v242
    v_add_u32 v242, s97, v242
    v_and_b32 v242, 255, v242
    s_mov_b64 exec, 1
    buffer_atomic_add v243, v242, s[20:23], 0 offen sc1
    s_mov_b64 exec, -1

.a1_466:
    s_waitcnt vmcnt(0)
    s_cmp_lg_u32 s24, 0
    s_cbranch_scc1 .pm_468
    s_lshl_b32 s93, s91, 3
    s_add_u32 s93, s93, s26
    s_sub_u32 s93, s93, 24
    s_and_b32 s94, s93, 1
    s_sub_u32 s5, 0, s100
    s_and_b32 s5, s5, 0x1fffff
    s_add_u32 s5, s5, 100663296
    s_lshl_b32 s4, s94, 21
    s_add_u32 s5, s5, s4
    s_lshl_b32 s4, s93, 8
    s_add_u32 s5, s5, s4
    s_add_u32 s6, s5, 8192
    v_and_b32 v4, 63, v0
    v_lshlrev_b32 v4, 2, v4
    v_mov_b32 v5, -1
    s_mov_b32 s82, 0x7fffffff
    s_mov_b32 s83, 0x7fffffff
    buffer_store_dword v5, v4, s[8:11], s5 offen sc1
    s_waitcnt vmcnt(0)

    s_memtime s[72:73]
    s_waitcnt lgkmcnt(0)
    buffer_store_dword v5, v4, s[8:11], s6 offen sc1
    s_waitcnt vmcnt(0)
    s_memtime s[84:85]
    s_waitcnt lgkmcnt(0)
    s_sub_u32 s84, s84, s72
    s_min_u32 s83, s83, s84

    s_memtime s[72:73]
    s_waitcnt lgkmcnt(0)
    buffer_store_dword v5, v4, s[8:11], s5 offen sc1
    s_waitcnt vmcnt(0)
    s_memtime s[84:85]
    s_waitcnt lgkmcnt(0)
    s_sub_u32 s84, s84, s72
    s_min_u32 s82, s82, s84

    s_memtime s[72:73]
    s_waitcnt lgkmcnt(0)
    buffer_store_dword v5, v4, s[8:11], s6 offen sc1
    s_waitcnt vmcnt(0)
    s_memtime s[84:85]
    s_waitcnt lgkmcnt(0)
    s_sub_u32 s84, s84, s72
    s_min_u32 s83, s83, s84

    s_memtime s[72:73]
    s_waitcnt lgkmcnt(0)
    buffer_store_dword v5, v4, s[8:11], s5 offen sc1
    s_waitcnt vmcnt(0)
    s_memtime s[84:85]
    s_waitcnt lgkmcnt(0)
    s_sub_u32 s84, s84, s72
    s_min_u32 s82, s82, s84

    s_memtime s[72:73]
    s_waitcnt lgkmcnt(0)
    buffer_store_dword v5, v4, s[8:11], s6 offen sc1
    s_waitcnt vmcnt(0)
    s_memtime s[84:85]
    s_waitcnt lgkmcnt(0)
    s_sub_u32 s84, s84, s72
    s_min_u32 s83, s83, s84

    s_memtime s[72:73]
    s_waitcnt lgkmcnt(0)
    buffer_store_dword v5, v4, s[8:11], s5 offen sc1
    s_waitcnt vmcnt(0)
    s_memtime s[84:85]
    s_waitcnt lgkmcnt(0)
    s_sub_u32 s84, s84, s72
    s_min_u32 s82, s82, s84

    s_memtime s[72:73]
    s_waitcnt lgkmcnt(0)
    buffer_store_dword v5, v4, s[8:11], s6 offen sc1
    s_waitcnt vmcnt(0)
    s_memtime s[84:85]
    s_waitcnt lgkmcnt(0)
    s_sub_u32 s84, s84, s72
    s_min_u32 s83, s83, s84

    s_memtime s[72:73]
    s_waitcnt lgkmcnt(0)
    buffer_store_dword v5, v4, s[8:11], s5 offen sc1
    s_waitcnt vmcnt(0)
    s_memtime s[84:85]
    s_waitcnt lgkmcnt(0)
    s_sub_u32 s84, s84, s72
    s_min_u32 s82, s82, s84

    s_cmp_lt_u32 s82, s83
    s_cselect_b32 s4, 1, 0
    s_mul_i32 s94, s94, 6
    s_lshl_b32 s4, s4, s94
    s_add_u32 s95, s4, 0x1000000

.pm_468:
    s_cmp_lg_u32 s24, 0
    s_cbranch_scc1 .pv_469
    s_mov_b64 exec, 1
    v_mov_b32 v4, s95
    v_mov_b32 v5, 4
    buffer_atomic_add v4, v5, s[20:23], s97 offen sc1
    s_mov_b64 exec, -1

.pv_469:
    s_barrier
    s_lshl_b32 s93, s91, 3
    s_add_u32 s93, s93, s26
    s_sub_u32 s93, s93, 24

    s_load_dwordx2 s[40:41], s[0:1], 0
    s_load_dwordx2 s[42:43], s[0:1], 104

    v_and_b32 v1, 63, v0
    v_and_b32 v2, 15, v1
    v_lshrrev_b32 v3, 4, v1

    s_waitcnt lgkmcnt(0)
    s_mov_b32 s12, s40
    s_and_b32 s13, s41, 0xffff
    s_mov_b32 s14, 0x400000
    s_mov_b32 s15, 0x00020000

    s_mov_b32 s16, s42
    s_and_b32 s17, s43, 0xffff
    s_mov_b32 s18, 0x800
    s_mov_b32 s19, 0x00020000

    s_lshl_b32 s3, s93, 6
    s_lshl_b32 s4, s24, 4
    s_add_u32 s3, s3, s4
    v_lshlrev_b32 v8, 4, v1
    buffer_load_dwordx4 v[16:19], v8, s[16:19], 0 offen
    buffer_load_dwordx4 v[20:23], v8, s[16:19], 0 offen offset:1024
    s_lshl_b32 s5, s3, 11

    buffer_load_dwordx4 v[64:67], v8, s[12:15], s5 offen
    buffer_load_dwordx4 v[68:71], v8, s[12:15], s5 offen offset:1024
    s_add_u32 s5, s5, 2048

    buffer_load_dwordx4 v[72:75], v8, s[12:15], s5 offen
    buffer_load_dwordx4 v[76:79], v8, s[12:15], s5 offen offset:1024
    s_add_u32 s5, s5, 2048

    buffer_load_dwordx4 v[80:83], v8, s[12:15], s5 offen
    buffer_load_dwordx4 v[84:87], v8, s[12:15], s5 offen offset:1024
    s_add_u32 s5, s5, 2048

    buffer_load_dwordx4 v[88:91], v8, s[12:15], s5 offen
    buffer_load_dwordx4 v[92:95], v8, s[12:15], s5 offen offset:1024
    s_add_u32 s5, s5, 2048

    buffer_load_dwordx4 v[96:99], v8, s[12:15], s5 offen
    buffer_load_dwordx4 v[100:103], v8, s[12:15], s5 offen offset:1024
    s_add_u32 s5, s5, 2048

    buffer_load_dwordx4 v[104:107], v8, s[12:15], s5 offen
    buffer_load_dwordx4 v[108:111], v8, s[12:15], s5 offen offset:1024
    s_add_u32 s5, s5, 2048

    buffer_load_dwordx4 v[112:115], v8, s[12:15], s5 offen
    buffer_load_dwordx4 v[116:119], v8, s[12:15], s5 offen offset:1024
    s_add_u32 s5, s5, 2048

    buffer_load_dwordx4 v[120:123], v8, s[12:15], s5 offen
    buffer_load_dwordx4 v[124:127], v8, s[12:15], s5 offen offset:1024
    s_add_u32 s5, s5, 2048

    buffer_load_dwordx4 v[128:131], v8, s[12:15], s5 offen
    buffer_load_dwordx4 v[132:135], v8, s[12:15], s5 offen offset:1024
    s_add_u32 s5, s5, 2048

    buffer_load_dwordx4 v[136:139], v8, s[12:15], s5 offen
    buffer_load_dwordx4 v[140:143], v8, s[12:15], s5 offen offset:1024
    s_add_u32 s5, s5, 2048

    buffer_load_dwordx4 v[144:147], v8, s[12:15], s5 offen
    buffer_load_dwordx4 v[148:151], v8, s[12:15], s5 offen offset:1024
    s_add_u32 s5, s5, 2048

    buffer_load_dwordx4 v[152:155], v8, s[12:15], s5 offen
    buffer_load_dwordx4 v[156:159], v8, s[12:15], s5 offen offset:1024
    s_add_u32 s5, s5, 2048

    buffer_load_dwordx4 v[160:163], v8, s[12:15], s5 offen
    buffer_load_dwordx4 v[164:167], v8, s[12:15], s5 offen offset:1024
    s_add_u32 s5, s5, 2048

    buffer_load_dwordx4 v[168:171], v8, s[12:15], s5 offen
    buffer_load_dwordx4 v[172:175], v8, s[12:15], s5 offen offset:1024
    s_add_u32 s5, s5, 2048

    buffer_load_dwordx4 v[176:179], v8, s[12:15], s5 offen
    buffer_load_dwordx4 v[180:183], v8, s[12:15], s5 offen offset:1024
    s_add_u32 s5, s5, 2048

    buffer_load_dwordx4 v[184:187], v8, s[12:15], s5 offen
    buffer_load_dwordx4 v[188:191], v8, s[12:15], s5 offen offset:1024
    s_add_u32 s5, s5, 2048

    v_and_b32 v241, 3, v0
    v_lshlrev_b32 v241, 2, v241

    v_and_b32 v240, 12, v0
    v_lshl_add_u32 v241, v240, 4, v241
    v_add_u32 v241, s97, v241
    v_and_b32 v241, 255, v241

    buffer_load_dword v240, v241, s[20:23], 0 offen sc1
    s_load_dwordx4 s[52:55], s[0:1], 8
    s_load_dwordx2 s[56:57], s[0:1], 32
    v_and_b32 v9, 63, v0
    v_lshlrev_b32 v9, 7, v9
    s_lshl_b32 s6, s93, 17
    s_lshl_b32 s7, s24, 15
    s_add_u32 s6, s6, s7
    s_waitcnt lgkmcnt(0)

    s_mov_b32 s80, s52
    s_and_b32 s81, s53, 0xffff
    s_mov_b32 s82, 0x400000
    s_mov_b32 s83, 0x00020000

    s_add_u32 s7, s6, 0
    buffer_load_dword v250, v9, s[80:83], s7 offen
    s_add_u32 s7, s6, 8192
    buffer_load_dword v250, v9, s[80:83], s7 offen
    s_add_u32 s7, s6, 16384
    buffer_load_dword v250, v9, s[80:83], s7 offen
    s_add_u32 s7, s6, 24576
    buffer_load_dword v250, v9, s[80:83], s7 offen
    s_mov_b32 s80, s54
    s_and_b32 s81, s55, 0xffff
    s_mov_b32 s82, 0x400000
    s_mov_b32 s83, 0x00020000

    s_add_u32 s7, s6, 0
    buffer_load_dword v250, v9, s[80:83], s7 offen
    s_add_u32 s7, s6, 8192
    buffer_load_dword v250, v9, s[80:83], s7 offen
    s_add_u32 s7, s6, 16384
    buffer_load_dword v250, v9, s[80:83], s7 offen
    s_add_u32 s7, s6, 24576
    buffer_load_dword v250, v9, s[80:83], s7 offen
    s_mov_b32 s80, s56
    s_and_b32 s81, s57, 0xffff
    s_mov_b32 s82, 0x400000
    s_mov_b32 s83, 0x00020000

    s_add_u32 s7, s6, 0
    buffer_load_dword v250, v9, s[80:83], s7 offen
    s_add_u32 s7, s6, 8192
    buffer_load_dword v250, v9, s[80:83], s7 offen
    s_add_u32 s7, s6, 16384
    buffer_load_dword v250, v9, s[80:83], s7 offen
    s_add_u32 s7, s6, 24576
    buffer_load_dword v250, v9, s[80:83], s7 offen
    s_waitcnt vmcnt(41)
    v_dot2_f32_bf16 v24, v64, v16, 0
    v_dot2_f32_bf16 v25, v72, v16, 0
    v_dot2_f32_bf16 v24, v65, v17, v24
    v_dot2_f32_bf16 v25, v73, v17, v25
    v_dot2_f32_bf16 v24, v66, v18, v24
    v_dot2_f32_bf16 v25, v74, v18, v25
    v_dot2_f32_bf16 v24, v67, v19, v24
    v_dot2_f32_bf16 v25, v75, v19, v25
    v_dot2_f32_bf16 v24, v68, v20, v24
    v_dot2_f32_bf16 v25, v76, v20, v25
    v_dot2_f32_bf16 v24, v69, v21, v24
    v_dot2_f32_bf16 v25, v77, v21, v25
    v_dot2_f32_bf16 v24, v70, v22, v24
    v_dot2_f32_bf16 v25, v78, v22, v25
    v_dot2_f32_bf16 v24, v71, v23, v24
    v_dot2_f32_bf16 v25, v79, v23, v25
    s_waitcnt vmcnt(37)
    v_dot2_f32_bf16 v26, v80, v16, 0
    v_dot2_f32_bf16 v27, v88, v16, 0
    v_dot2_f32_bf16 v26, v81, v17, v26
    v_dot2_f32_bf16 v27, v89, v17, v27
    v_dot2_f32_bf16 v26, v82, v18, v26
    v_dot2_f32_bf16 v27, v90, v18, v27
    v_dot2_f32_bf16 v26, v83, v19, v26
    v_dot2_f32_bf16 v27, v91, v19, v27
    v_dot2_f32_bf16 v26, v84, v20, v26
    v_dot2_f32_bf16 v27, v92, v20, v27
    v_dot2_f32_bf16 v26, v85, v21, v26
    v_dot2_f32_bf16 v27, v93, v21, v27
    v_dot2_f32_bf16 v26, v86, v22, v26
    v_dot2_f32_bf16 v27, v94, v22, v27
    v_dot2_f32_bf16 v26, v87, v23, v26
    v_dot2_f32_bf16 v27, v95, v23, v27
    s_waitcnt vmcnt(33)
    v_dot2_f32_bf16 v28, v96, v16, 0
    v_dot2_f32_bf16 v29, v104, v16, 0
    v_dot2_f32_bf16 v28, v97, v17, v28
    v_dot2_f32_bf16 v29, v105, v17, v29
    v_dot2_f32_bf16 v28, v98, v18, v28
    v_dot2_f32_bf16 v29, v106, v18, v29
    v_dot2_f32_bf16 v28, v99, v19, v28
    v_dot2_f32_bf16 v29, v107, v19, v29
    v_dot2_f32_bf16 v28, v100, v20, v28
    v_dot2_f32_bf16 v29, v108, v20, v29
    v_dot2_f32_bf16 v28, v101, v21, v28
    v_dot2_f32_bf16 v29, v109, v21, v29
    v_dot2_f32_bf16 v28, v102, v22, v28
    v_dot2_f32_bf16 v29, v110, v22, v29
    v_dot2_f32_bf16 v28, v103, v23, v28
    v_dot2_f32_bf16 v29, v111, v23, v29
    s_waitcnt vmcnt(29)
    v_dot2_f32_bf16 v30, v112, v16, 0
    v_dot2_f32_bf16 v31, v120, v16, 0
    v_dot2_f32_bf16 v30, v113, v17, v30
    v_dot2_f32_bf16 v31, v121, v17, v31
    v_dot2_f32_bf16 v30, v114, v18, v30
    v_dot2_f32_bf16 v31, v122, v18, v31
    v_dot2_f32_bf16 v30, v115, v19, v30
    v_dot2_f32_bf16 v31, v123, v19, v31
    v_dot2_f32_bf16 v30, v116, v20, v30
    v_dot2_f32_bf16 v31, v124, v20, v31
    v_dot2_f32_bf16 v30, v117, v21, v30
    v_dot2_f32_bf16 v31, v125, v21, v31
    v_dot2_f32_bf16 v30, v118, v22, v30
    v_dot2_f32_bf16 v31, v126, v22, v31
    v_dot2_f32_bf16 v30, v119, v23, v30
    v_dot2_f32_bf16 v31, v127, v23, v31
    s_waitcnt vmcnt(25)
    v_dot2_f32_bf16 v32, v128, v16, 0
    v_dot2_f32_bf16 v33, v136, v16, 0
    v_dot2_f32_bf16 v32, v129, v17, v32
    v_dot2_f32_bf16 v33, v137, v17, v33
    v_dot2_f32_bf16 v32, v130, v18, v32
    v_dot2_f32_bf16 v33, v138, v18, v33
    v_dot2_f32_bf16 v32, v131, v19, v32
    v_dot2_f32_bf16 v33, v139, v19, v33
    v_dot2_f32_bf16 v32, v132, v20, v32
    v_dot2_f32_bf16 v33, v140, v20, v33
    v_dot2_f32_bf16 v32, v133, v21, v32
    v_dot2_f32_bf16 v33, v141, v21, v33
    v_dot2_f32_bf16 v32, v134, v22, v32
    v_dot2_f32_bf16 v33, v142, v22, v33
    v_dot2_f32_bf16 v32, v135, v23, v32
    v_dot2_f32_bf16 v33, v143, v23, v33
    s_waitcnt vmcnt(21)
    v_dot2_f32_bf16 v34, v144, v16, 0
    v_dot2_f32_bf16 v35, v152, v16, 0
    v_dot2_f32_bf16 v34, v145, v17, v34
    v_dot2_f32_bf16 v35, v153, v17, v35
    v_dot2_f32_bf16 v34, v146, v18, v34
    v_dot2_f32_bf16 v35, v154, v18, v35
    v_dot2_f32_bf16 v34, v147, v19, v34
    v_dot2_f32_bf16 v35, v155, v19, v35
    v_dot2_f32_bf16 v34, v148, v20, v34
    v_dot2_f32_bf16 v35, v156, v20, v35
    v_dot2_f32_bf16 v34, v149, v21, v34
    v_dot2_f32_bf16 v35, v157, v21, v35
    v_dot2_f32_bf16 v34, v150, v22, v34
    v_dot2_f32_bf16 v35, v158, v22, v35
    v_dot2_f32_bf16 v34, v151, v23, v34
    v_dot2_f32_bf16 v35, v159, v23, v35
    s_waitcnt vmcnt(17)
    v_dot2_f32_bf16 v36, v160, v16, 0
    v_dot2_f32_bf16 v37, v168, v16, 0
    v_dot2_f32_bf16 v36, v161, v17, v36
    v_dot2_f32_bf16 v37, v169, v17, v37
    v_dot2_f32_bf16 v36, v162, v18, v36
    v_dot2_f32_bf16 v37, v170, v18, v37
    v_dot2_f32_bf16 v36, v163, v19, v36
    v_dot2_f32_bf16 v37, v171, v19, v37
    v_dot2_f32_bf16 v36, v164, v20, v36
    v_dot2_f32_bf16 v37, v172, v20, v37
    v_dot2_f32_bf16 v36, v165, v21, v36
    v_dot2_f32_bf16 v37, v173, v21, v37
    v_dot2_f32_bf16 v36, v166, v22, v36
    v_dot2_f32_bf16 v37, v174, v22, v37
    v_dot2_f32_bf16 v36, v167, v23, v36
    v_dot2_f32_bf16 v37, v175, v23, v37
    s_waitcnt vmcnt(13)
    v_dot2_f32_bf16 v38, v176, v16, 0
    v_dot2_f32_bf16 v39, v184, v16, 0
    v_dot2_f32_bf16 v38, v177, v17, v38
    v_dot2_f32_bf16 v39, v185, v17, v39
    v_dot2_f32_bf16 v38, v178, v18, v38
    v_dot2_f32_bf16 v39, v186, v18, v39
    v_dot2_f32_bf16 v38, v179, v19, v38
    v_dot2_f32_bf16 v39, v187, v19, v39
    v_dot2_f32_bf16 v38, v180, v20, v38
    v_dot2_f32_bf16 v39, v188, v20, v39
    v_dot2_f32_bf16 v38, v181, v21, v38
    v_dot2_f32_bf16 v39, v189, v21, v39
    v_dot2_f32_bf16 v38, v182, v22, v38
    v_dot2_f32_bf16 v39, v190, v22, v39
    v_dot2_f32_bf16 v38, v183, v23, v38
    v_dot2_f32_bf16 v39, v191, v23, v39
    s_waitcnt vmcnt(12)
    s_mov_b32 s62, 0
.vp_470:
    v_readlane_b32 s4, v240, 0
    v_readlane_b32 s7, v240, 1
    v_readlane_b32 s6, v240, 2

    v_readlane_b32 s5, v240, 4
    s_add_u32 s4, s4, s5
    v_readlane_b32 s5, v240, 8
    s_add_u32 s4, s4, s5
    v_readlane_b32 s5, v240, 12
    s_add_u32 s4, s4, s5
    s_cmp_ge_u32 s4, 256
    s_cbranch_scc1 .vd_471
    s_cmp_lg_u32 s6, 0
    s_cbranch_scc1 .vs_472
    s_add_u32 s62, s62, 1
    s_cmp_gt_u32 s62, 0x100000
    s_cbranch_scc1 .mg_end_1
    s_sleep 8
    buffer_load_dword v240, v241, s[20:23], 0 offen sc1
    s_waitcnt vmcnt(0)
    s_branch .vp_470

.vs_472:
    s_lshr_b32 s25, s2, 5
    s_and_b32 s26, s2, 31
    s_mov_b32 s27, 1
    s_mov_b32 s99, 1
    s_mov_b32 s97, 144
    s_waitcnt vmcnt(0) lgkmcnt(0)
    s_barrier
    s_branch .mg_role_3

.vd_471:
    v_permlane32_swap_b32 v24, v26
    v_permlane32_swap_b32 v25, v27
    v_permlane32_swap_b32 v28, v30
    v_permlane32_swap_b32 v29, v31
    v_permlane32_swap_b32 v32, v34
    v_permlane32_swap_b32 v33, v35
    v_permlane32_swap_b32 v36, v38
    v_permlane32_swap_b32 v37, v39
    v_add_f32 v24, v24, v26
    v_add_f32 v25, v25, v27
    v_add_f32 v28, v28, v30
    v_add_f32 v29, v29, v31
    v_add_f32 v32, v32, v34
    v_add_f32 v33, v33, v35
    v_add_f32 v36, v36, v38
    v_add_f32 v37, v37, v39
    s_nop 0
    v_permlane16_swap_b32 v24, v25
    v_permlane16_swap_b32 v28, v29
    v_permlane16_swap_b32 v32, v33
    v_permlane16_swap_b32 v36, v37
    v_add_f32 v24, v24, v25
    v_add_f32 v28, v28, v29
    v_add_f32 v32, v32, v33
    v_add_f32 v36, v36, v37
    v_add_f32_dpp v24, v24, v24 row_ror:8 row_mask:0xf bank_mask:0xf
    v_add_f32_dpp v28, v28, v28 row_ror:8 row_mask:0xf bank_mask:0xf
    v_add_f32_dpp v32, v32, v32 row_ror:8 row_mask:0xf bank_mask:0xf
    v_add_f32_dpp v36, v36, v36 row_ror:8 row_mask:0xf bank_mask:0xf
    v_add_f32_dpp v24, v24, v24 row_ror:4 row_mask:0xf bank_mask:0xf
    v_add_f32_dpp v28, v28, v28 row_ror:4 row_mask:0xf bank_mask:0xf
    v_add_f32_dpp v32, v32, v32 row_ror:4 row_mask:0xf bank_mask:0xf
    v_add_f32_dpp v36, v36, v36 row_ror:4 row_mask:0xf bank_mask:0xf
    v_add_f32_dpp v24, v24, v24 row_ror:2 row_mask:0xf bank_mask:0xf
    v_add_f32_dpp v28, v28, v28 row_ror:2 row_mask:0xf bank_mask:0xf
    v_add_f32_dpp v32, v32, v32 row_ror:2 row_mask:0xf bank_mask:0xf
    v_add_f32_dpp v36, v36, v36 row_ror:2 row_mask:0xf bank_mask:0xf
    v_add_f32_dpp v24, v24, v24 row_ror:1 row_mask:0xf bank_mask:0xf
    v_add_f32_dpp v28, v28, v28 row_ror:1 row_mask:0xf bank_mask:0xf
    v_add_f32_dpp v32, v32, v32 row_ror:1 row_mask:0xf bank_mask:0xf
    v_add_f32_dpp v36, v36, v36 row_ror:1 row_mask:0xf bank_mask:0xf
    v_cmp_eq_u32 vcc, 1, v2
    s_nop 1
    v_cndmask_b32 v24, v24, v28, vcc
    v_cmp_eq_u32 vcc, 2, v2
    s_nop 1
    v_cndmask_b32 v24, v24, v32, vcc
    v_cmp_eq_u32 vcc, 3, v2
    s_nop 1
    v_cndmask_b32 v24, v24, v36, vcc
    v_cvt_pk_bf16_f32 v24, v24, v24
    s_mov_b32 s38, 0xbfb8aa3b
    v_lshlrev_b32 v24, 16, v24
    v_mul_f32 v24, s38, v24
    v_exp_f32 v24, v24
    v_lshlrev_b32 v8, 4, v2
    v_add_f32 v24, 1.0, v24
    v_rcp_f32 v24, v24
    v_lshl_add_u32 v8, v3, 2, v8
    v_cvt_pk_bf16_f32 v24, v24, v24
    v_cmp_gt_u32 vcc, 4, v2
    s_lshl_b32 s5, s3, 2
    s_add_u32 s5, s5, 121634816
    v_lshlrev_b32 v24, 16, v24
    s_mov_b64 exec, vcc
    buffer_store_dword v24, v8, s[8:11], s5 offen sc1
    s_mov_b64 exec, -1

    s_load_dwordx4 s[52:55], s[0:1], 8
    s_load_dwordx2 s[56:57], s[0:1], 24

    v_and_b32 v1, 63, v0
    v_and_b32 v2, 15, v1
    v_lshrrev_b32 v3, 4, v1

    v_lshrrev_b32 v4, 2, v1
    v_and_b32 v5, 3, v1
    v_lshlrev_b32 v10, 11, v4
    v_lshl_add_u32 v10, v5, 4, v10
    s_lshl_b32 s4, s93, 6
    v_add_u32 v10, s4, v10
    s_lshl_b32 s70, s24, 20
    s_mul_i32 s71, s24, 33280
    v_lshrrev_b32 v4, 2, v2
    v_lshl_add_u32 v4, v3, 5, v4
    v_lshlrev_b32 v4, 6, v4
    v_lshl_add_u32 v11, v5, 3, v4
    v_add_u32 v11, s71, v11
    s_lshl_b32 s4, s93, 17
    s_lshl_b32 s5, s24, 8
    s_add_u32 s72, s4, s5
    s_add_u32 s72, s72, 125829120
    v_lshlrev_b32 v12, 12, v2
    v_lshl_add_u32 v12, v3, 4, v12
    v_lshlrev_b32 v13, 3, v2
    s_lshl_b32 s6, s93, 8
    s_waitcnt lgkmcnt(0)

    s_mov_b32 s80, s52
    s_and_b32 s81, s53, 0xffff
    s_mov_b32 s82, 0x400000
    s_mov_b32 s83, 0x00020000

    s_mov_b32 s84, s54
    s_and_b32 s85, s55, 0xffff
    s_mov_b32 s86, 0x400000
    s_mov_b32 s87, 0x00020000

    s_mov_b32 s76, s56
    s_and_b32 s77, s57, 0xffff
    s_mov_b32 s78, 0x2000
    s_mov_b32 s79, 0x00020000

    buffer_load_dwordx2 v[196:197], v13, s[76:79], s6 offen
    buffer_load_dwordx2 v[198:199], v13, s[76:79], s6 offen offset:128

    s_add_u32 s4, s70, 0
    s_add_u32 m0, s71, 0
    s_sub_u32 s5, s4, 8192
    s_max_i32 s5, s5, 0
    s_mov_b64 exec, 0xffff
    buffer_load_dwordx4 v10, s[80:83], s5 offen lds
    s_mov_b64 exec, -1

    s_add_u32 m0, s71, 256
    s_nop 0
    buffer_load_dwordx4 v10, s[80:83], s4 offen lds
    s_add_u32 m0, s71, 8448
    s_nop 0
    buffer_load_dwordx4 v10, s[84:87], s4 offen lds
    s_add_u32 m0, s71, 1280
    s_add_u32 s4, s4, 32768
    buffer_load_dwordx4 v10, s[80:83], s4 offen lds
    s_add_u32 m0, s71, 9472
    s_nop 0
    buffer_load_dwordx4 v10, s[84:87], s4 offen lds
    s_add_u32 m0, s71, 2304
    s_add_u32 s4, s4, 32768
    buffer_load_dwordx4 v10, s[80:83], s4 offen lds
    s_add_u32 m0, s71, 10496
    s_nop 0
    buffer_load_dwordx4 v10, s[84:87], s4 offen lds
    s_add_u32 m0, s71, 3328
    s_add_u32 s4, s4, 32768
    buffer_load_dwordx4 v10, s[80:83], s4 offen lds
    s_add_u32 m0, s71, 11520
    s_nop 0
    buffer_load_dwordx4 v10, s[84:87], s4 offen lds
    s_add_u32 m0, s71, 4352
    s_add_u32 s4, s4, 32768
    buffer_load_dwordx4 v10, s[80:83], s4 offen lds
    s_add_u32 m0, s71, 12544
    s_nop 0
    buffer_load_dwordx4 v10, s[84:87], s4 offen lds
    s_add_u32 m0, s71, 5376
    s_add_u32 s4, s4, 32768
    buffer_load_dwordx4 v10, s[80:83], s4 offen lds
    s_add_u32 m0, s71, 13568
    s_nop 0
    buffer_load_dwordx4 v10, s[84:87], s4 offen lds
    s_add_u32 m0, s71, 6400
    s_add_u32 s4, s4, 32768
    buffer_load_dwordx4 v10, s[80:83], s4 offen lds
    s_add_u32 m0, s71, 14592
    s_nop 0
    buffer_load_dwordx4 v10, s[84:87], s4 offen lds
    s_add_u32 m0, s71, 7424
    s_add_u32 s4, s4, 32768
    buffer_load_dwordx4 v10, s[80:83], s4 offen lds
    s_add_u32 m0, s71, 15616
    s_nop 0
    buffer_load_dwordx4 v10, s[84:87], s4 offen lds
    s_add_u32 s4, s70, 262144
    s_add_u32 m0, s71, 16640
    s_sub_u32 s5, s4, 8192
    s_max_i32 s5, s5, 0
    s_mov_b64 exec, 0xffff
    buffer_load_dwordx4 v10, s[80:83], s5 offen lds
    s_mov_b64 exec, -1

    s_add_u32 m0, s71, 16896
    s_nop 0
    buffer_load_dwordx4 v10, s[80:83], s4 offen lds
    s_add_u32 m0, s71, 25088
    s_nop 0
    buffer_load_dwordx4 v10, s[84:87], s4 offen lds
    s_add_u32 m0, s71, 17920
    s_add_u32 s4, s4, 32768
    buffer_load_dwordx4 v10, s[80:83], s4 offen lds
    s_add_u32 m0, s71, 26112
    s_nop 0
    buffer_load_dwordx4 v10, s[84:87], s4 offen lds
    s_add_u32 m0, s71, 18944
    s_add_u32 s4, s4, 32768
    buffer_load_dwordx4 v10, s[80:83], s4 offen lds
    s_add_u32 m0, s71, 27136
    s_nop 0
    buffer_load_dwordx4 v10, s[84:87], s4 offen lds
    s_add_u32 m0, s71, 19968
    s_add_u32 s4, s4, 32768
    buffer_load_dwordx4 v10, s[80:83], s4 offen lds
    s_add_u32 m0, s71, 28160
    s_nop 0
    buffer_load_dwordx4 v10, s[84:87], s4 offen lds
    s_add_u32 m0, s71, 20992
    s_add_u32 s4, s4, 32768
    buffer_load_dwordx4 v10, s[80:83], s4 offen lds
    s_add_u32 m0, s71, 29184
    s_nop 0
    buffer_load_dwordx4 v10, s[84:87], s4 offen lds
    s_add_u32 m0, s71, 22016
    s_add_u32 s4, s4, 32768
    buffer_load_dwordx4 v10, s[80:83], s4 offen lds
    s_add_u32 m0, s71, 30208
    s_nop 0
    buffer_load_dwordx4 v10, s[84:87], s4 offen lds
    s_add_u32 m0, s71, 23040
    s_add_u32 s4, s4, 32768
    buffer_load_dwordx4 v10, s[80:83], s4 offen lds
    s_add_u32 m0, s71, 31232
    s_nop 0
    buffer_load_dwordx4 v10, s[84:87], s4 offen lds
    s_add_u32 m0, s71, 24064
    s_add_u32 s4, s4, 32768
    buffer_load_dwordx4 v10, s[80:83], s4 offen lds
    s_add_u32 m0, s71, 32256
    s_nop 0
    buffer_load_dwordx4 v10, s[84:87], s4 offen lds
    s_waitcnt vmcnt(17)
    v_alignbit_b32 v196, v196, v196, 16
    v_alignbit_b32 v197, v197, v197, 16
    v_alignbit_b32 v198, v198, v198, 16
    v_alignbit_b32 v199, v199, v199, 16
    ds_read_b64_tr_b16 v[16:17], v11 offset:0
    ds_read_b64_tr_b16 v[18:19], v11 offset:256
    ds_read_b64_tr_b16 v[20:21], v11 offset:512
    ds_read_b64_tr_b16 v[22:23], v11 offset:768
    ds_read_b64_tr_b16 v[24:25], v11 offset:1024
    ds_read_b64_tr_b16 v[26:27], v11 offset:1280
    ds_read_b64_tr_b16 v[28:29], v11 offset:1536
    ds_read_b64_tr_b16 v[30:31], v11 offset:1792
    ds_read_b64_tr_b16 v[32:33], v11 offset:2048
    ds_read_b64_tr_b16 v[34:35], v11 offset:8448
    ds_read_b64_tr_b16 v[36:37], v11 offset:8704
    ds_read_b64_tr_b16 v[38:39], v11 offset:8960
    ds_read_b64_tr_b16 v[40:41], v11 offset:9216
    ds_read_b64_tr_b16 v[42:43], v11 offset:9472
    ds_read_b64_tr_b16 v[44:45], v11 offset:9728
    ds_read_b64_tr_b16 v[46:47], v11 offset:9984
    ds_read_b64_tr_b16 v[48:49], v11 offset:10240
    ds_read_b64_tr_b16 v[50:51], v11 offset:32
    ds_read_b64_tr_b16 v[52:53], v11 offset:288
    ds_read_b64_tr_b16 v[54:55], v11 offset:544
    ds_read_b64_tr_b16 v[56:57], v11 offset:800
    ds_read_b64_tr_b16 v[58:59], v11 offset:1056
    ds_read_b64_tr_b16 v[60:61], v11 offset:1312
    ds_read_b64_tr_b16 v[62:63], v11 offset:1568
    ds_read_b64_tr_b16 v[64:65], v11 offset:1824
    ds_read_b64_tr_b16 v[66:67], v11 offset:2080
    ds_read_b64_tr_b16 v[68:69], v11 offset:8480
    ds_read_b64_tr_b16 v[70:71], v11 offset:8736
    ds_read_b64_tr_b16 v[72:73], v11 offset:8992
    ds_read_b64_tr_b16 v[74:75], v11 offset:9248
    ds_read_b64_tr_b16 v[76:77], v11 offset:9504
    ds_read_b64_tr_b16 v[78:79], v11 offset:9760
    ds_read_b64_tr_b16 v[80:81], v11 offset:10016
    ds_read_b64_tr_b16 v[82:83], v11 offset:10272
    s_waitcnt lgkmcnt(0)
    s_cmp_eq_u32 s24, 0
    s_cselect_b32 exec_lo, 0xffff, 0
    s_mov_b32 exec_hi, 0
    v_mov_b32 v16, 0
    v_mov_b32 v17, 0
    v_mov_b32 v50, 0
    v_mov_b32 v51, 0
    s_mov_b64 exec, -1
    s_add_u32 s4, s70, 524288
    s_add_u32 m0, s71, 0
    s_sub_u32 s5, s4, 8192
    s_max_i32 s5, s5, 0
    s_mov_b64 exec, 0xffff
    buffer_load_dwordx4 v10, s[80:83], s5 offen lds
    s_mov_b64 exec, -1

    s_add_u32 m0, s71, 256
    s_nop 0
    buffer_load_dwordx4 v10, s[80:83], s4 offen lds
    s_add_u32 m0, s71, 8448
    s_nop 0
    buffer_load_dwordx4 v10, s[84:87], s4 offen lds
    s_add_u32 m0, s71, 1280
    s_add_u32 s4, s4, 32768
    buffer_load_dwordx4 v10, s[80:83], s4 offen lds
    s_add_u32 m0, s71, 9472
    s_nop 0
    buffer_load_dwordx4 v10, s[84:87], s4 offen lds
    s_add_u32 m0, s71, 2304
    s_add_u32 s4, s4, 32768
    buffer_load_dwordx4 v10, s[80:83], s4 offen lds
    s_add_u32 m0, s71, 10496
    s_nop 0
    buffer_load_dwordx4 v10, s[84:87], s4 offen lds
    s_add_u32 m0, s71, 3328
    s_add_u32 s4, s4, 32768
    buffer_load_dwordx4 v10, s[80:83], s4 offen lds
    s_add_u32 m0, s71, 11520
    s_nop 0
    buffer_load_dwordx4 v10, s[84:87], s4 offen lds
    s_add_u32 m0, s71, 4352
    s_add_u32 s4, s4, 32768
    buffer_load_dwordx4 v10, s[80:83], s4 offen lds
    s_add_u32 m0, s71, 12544
    s_nop 0
    buffer_load_dwordx4 v10, s[84:87], s4 offen lds
    s_add_u32 m0, s71, 5376
    s_add_u32 s4, s4, 32768
    buffer_load_dwordx4 v10, s[80:83], s4 offen lds
    s_add_u32 m0, s71, 13568
    s_nop 0
    buffer_load_dwordx4 v10, s[84:87], s4 offen lds
    s_add_u32 m0, s71, 6400
    s_add_u32 s4, s4, 32768
    buffer_load_dwordx4 v10, s[80:83], s4 offen lds
    s_add_u32 m0, s71, 14592
    s_nop 0
    buffer_load_dwordx4 v10, s[84:87], s4 offen lds
    s_add_u32 m0, s71, 7424
    s_add_u32 s4, s4, 32768
    buffer_load_dwordx4 v10, s[80:83], s4 offen lds
    s_add_u32 m0, s71, 15616
    s_nop 0
    buffer_load_dwordx4 v10, s[84:87], s4 offen lds
    v_alignbit_b32 v84, v17, v16, 16
    v_alignbit_b32 v85, v18, v17, 16
    v_alignbit_b32 v86, v19, v18, 16
    v_alignbit_b32 v87, v20, v19, 16
    v_alignbit_b32 v88, v21, v20, 16
    v_alignbit_b32 v89, v22, v21, 16
    v_alignbit_b32 v90, v23, v22, 16
    v_alignbit_b32 v91, v24, v23, 16
    v_alignbit_b32 v92, v25, v24, 16
    v_alignbit_b32 v93, v26, v25, 16
    v_alignbit_b32 v94, v27, v26, 16
    v_alignbit_b32 v95, v28, v27, 16
    v_alignbit_b32 v96, v29, v28, 16
    v_alignbit_b32 v97, v30, v29, 16
    v_alignbit_b32 v98, v31, v30, 16
    v_alignbit_b32 v99, v32, v31, 16
    v_alignbit_b32 v100, v33, v32, 16
    v_dot2_f32_bf16 v102, v84, v197, 0
    v_dot2_f32_bf16 v103, v17, v197, 0
    v_dot2_f32_bf16 v106, v85, v197, 0
    v_dot2_f32_bf16 v107, v18, v197, 0
    v_dot2_f32_bf16 v110, v86, v197, 0
    v_dot2_f32_bf16 v111, v19, v197, 0
    v_dot2_f32_bf16 v114, v87, v197, 0
    v_dot2_f32_bf16 v115, v20, v197, 0
    v_dot2_f32_bf16 v102, v85, v196, v102
    v_dot2_f32_bf16 v103, v18, v196, v103
    v_dot2_f32_bf16 v106, v86, v196, v106
    v_dot2_f32_bf16 v107, v19, v196, v107
    v_dot2_f32_bf16 v110, v87, v196, v110
    v_dot2_f32_bf16 v111, v20, v196, v111
    v_dot2_f32_bf16 v114, v88, v196, v114
    v_dot2_f32_bf16 v115, v21, v196, v115
    v_lshlrev_b32 v104, 16, v34
    v_and_b32 v105, 0xffff0000, v34
    v_lshlrev_b32 v108, 16, v35
    v_and_b32 v109, 0xffff0000, v35
    v_lshlrev_b32 v112, 16, v36
    v_and_b32 v113, 0xffff0000, v36
    v_lshlrev_b32 v116, 16, v37
    v_and_b32 v117, 0xffff0000, v37
    v_mul_f32 v102, v102, v104
    v_mul_f32 v103, v103, v105
    v_mul_f32 v106, v106, v108
    v_mul_f32 v107, v107, v109
    v_mul_f32 v110, v110, v112
    v_mul_f32 v111, v111, v113
    v_mul_f32 v114, v114, v116
    v_mul_f32 v115, v115, v117
    v_cvt_pk_bf16_f32 v137, v103, v102
    v_cvt_pk_bf16_f32 v136, v107, v106
    v_cvt_pk_bf16_f32 v135, v111, v110
    v_cvt_pk_bf16_f32 v134, v115, v114
    s_add_u32 s4, s72, 0
    buffer_store_dwordx4 v[134:137], v12, s[8:11], s4 offen offset:0
    v_dot2_f32_bf16 v118, v88, v197, 0
    v_dot2_f32_bf16 v119, v21, v197, 0
    v_dot2_f32_bf16 v122, v89, v197, 0
    v_dot2_f32_bf16 v123, v22, v197, 0
    v_dot2_f32_bf16 v126, v90, v197, 0
    v_dot2_f32_bf16 v127, v23, v197, 0
    v_dot2_f32_bf16 v130, v91, v197, 0
    v_dot2_f32_bf16 v131, v24, v197, 0
    v_dot2_f32_bf16 v118, v89, v196, v118
    v_dot2_f32_bf16 v119, v22, v196, v119
    v_dot2_f32_bf16 v122, v90, v196, v122
    v_dot2_f32_bf16 v123, v23, v196, v123
    v_dot2_f32_bf16 v126, v91, v196, v126
    v_dot2_f32_bf16 v127, v24, v196, v127
    v_dot2_f32_bf16 v130, v92, v196, v130
    v_dot2_f32_bf16 v131, v25, v196, v131
    v_lshlrev_b32 v120, 16, v38
    v_and_b32 v121, 0xffff0000, v38
    v_lshlrev_b32 v124, 16, v39
    v_and_b32 v125, 0xffff0000, v39
    v_lshlrev_b32 v128, 16, v40
    v_and_b32 v129, 0xffff0000, v40
    v_lshlrev_b32 v132, 16, v41
    v_and_b32 v133, 0xffff0000, v41
    v_mul_f32 v118, v118, v120
    v_mul_f32 v119, v119, v121
    v_mul_f32 v122, v122, v124
    v_mul_f32 v123, v123, v125
    v_mul_f32 v126, v126, v128
    v_mul_f32 v127, v127, v129
    v_mul_f32 v130, v130, v132
    v_mul_f32 v131, v131, v133
    v_cvt_pk_bf16_f32 v141, v119, v118
    v_cvt_pk_bf16_f32 v140, v123, v122
    v_cvt_pk_bf16_f32 v139, v127, v126
    v_cvt_pk_bf16_f32 v138, v131, v130
    buffer_store_dwordx4 v[138:141], v12, s[8:11], s4 offen offset:1024
    v_dot2_f32_bf16 v102, v92, v197, 0
    v_dot2_f32_bf16 v103, v25, v197, 0
    v_dot2_f32_bf16 v106, v93, v197, 0
    v_dot2_f32_bf16 v107, v26, v197, 0
    v_dot2_f32_bf16 v110, v94, v197, 0
    v_dot2_f32_bf16 v111, v27, v197, 0
    v_dot2_f32_bf16 v114, v95, v197, 0
    v_dot2_f32_bf16 v115, v28, v197, 0
    v_dot2_f32_bf16 v102, v93, v196, v102
    v_dot2_f32_bf16 v103, v26, v196, v103
    v_dot2_f32_bf16 v106, v94, v196, v106
    v_dot2_f32_bf16 v107, v27, v196, v107
    v_dot2_f32_bf16 v110, v95, v196, v110
    v_dot2_f32_bf16 v111, v28, v196, v111
    v_dot2_f32_bf16 v114, v96, v196, v114
    v_dot2_f32_bf16 v115, v29, v196, v115
    v_lshlrev_b32 v104, 16, v42
    v_and_b32 v105, 0xffff0000, v42
    v_lshlrev_b32 v108, 16, v43
    v_and_b32 v109, 0xffff0000, v43
    v_lshlrev_b32 v112, 16, v44
    v_and_b32 v113, 0xffff0000, v44
    v_lshlrev_b32 v116, 16, v45
    v_and_b32 v117, 0xffff0000, v45
    v_mul_f32 v102, v102, v104
    v_mul_f32 v103, v103, v105
    v_mul_f32 v106, v106, v108
    v_mul_f32 v107, v107, v109
    v_mul_f32 v110, v110, v112
    v_mul_f32 v111, v111, v113
    v_mul_f32 v114, v114, v116
    v_mul_f32 v115, v115, v117
    v_cvt_pk_bf16_f32 v145, v103, v102
    v_cvt_pk_bf16_f32 v144, v107, v106
    v_cvt_pk_bf16_f32 v143, v111, v110
    v_cvt_pk_bf16_f32 v142, v115, v114
    buffer_store_dwordx4 v[142:145], v12, s[8:11], s4 offen offset:2048
    v_dot2_f32_bf16 v118, v96, v197, 0
    v_dot2_f32_bf16 v119, v29, v197, 0
    v_dot2_f32_bf16 v122, v97, v197, 0
    v_dot2_f32_bf16 v123, v30, v197, 0
    v_dot2_f32_bf16 v126, v98, v197, 0
    v_dot2_f32_bf16 v127, v31, v197, 0
    v_dot2_f32_bf16 v130, v99, v197, 0
    v_dot2_f32_bf16 v131, v32, v197, 0
    v_dot2_f32_bf16 v118, v97, v196, v118
    v_dot2_f32_bf16 v119, v30, v196, v119
    v_dot2_f32_bf16 v122, v98, v196, v122
    v_dot2_f32_bf16 v123, v31, v196, v123
    v_dot2_f32_bf16 v126, v99, v196, v126
    v_dot2_f32_bf16 v127, v32, v196, v127
    v_dot2_f32_bf16 v130, v100, v196, v130
    v_dot2_f32_bf16 v131, v33, v196, v131
    v_lshlrev_b32 v120, 16, v46
    v_and_b32 v121, 0xffff0000, v46
    v_lshlrev_b32 v124, 16, v47
    v_and_b32 v125, 0xffff0000, v47
    v_lshlrev_b32 v128, 16, v48
    v_and_b32 v129, 0xffff0000, v48
    v_lshlrev_b32 v132, 16, v49
    v_and_b32 v133, 0xffff0000, v49
    v_mul_f32 v118, v118, v120
    v_mul_f32 v119, v119, v121
    v_mul_f32 v122, v122, v124
    v_mul_f32 v123, v123, v125
    v_mul_f32 v126, v126, v128
    v_mul_f32 v127, v127, v129
    v_mul_f32 v130, v130, v132
    v_mul_f32 v131, v131, v133
    v_cvt_pk_bf16_f32 v149, v119, v118
    v_cvt_pk_bf16_f32 v148, v123, v122
    v_cvt_pk_bf16_f32 v147, v127, v126
    v_cvt_pk_bf16_f32 v146, v131, v130
    buffer_store_dwordx4 v[146:149], v12, s[8:11], s4 offen offset:3072
    v_alignbit_b32 v84, v51, v50, 16
    v_alignbit_b32 v85, v52, v51, 16
    v_alignbit_b32 v86, v53, v52, 16
    v_alignbit_b32 v87, v54, v53, 16
    v_alignbit_b32 v88, v55, v54, 16
    v_alignbit_b32 v89, v56, v55, 16
    v_alignbit_b32 v90, v57, v56, 16
    v_alignbit_b32 v91, v58, v57, 16
    v_alignbit_b32 v92, v59, v58, 16
    v_alignbit_b32 v93, v60, v59, 16
    v_alignbit_b32 v94, v61, v60, 16
    v_alignbit_b32 v95, v62, v61, 16
    v_alignbit_b32 v96, v63, v62, 16
    v_alignbit_b32 v97, v64, v63, 16
    v_alignbit_b32 v98, v65, v64, 16
    v_alignbit_b32 v99, v66, v65, 16
    v_alignbit_b32 v100, v67, v66, 16
    v_dot2_f32_bf16 v102, v84, v199, 0
    v_dot2_f32_bf16 v103, v51, v199, 0
    v_dot2_f32_bf16 v106, v85, v199, 0
    v_dot2_f32_bf16 v107, v52, v199, 0
    v_dot2_f32_bf16 v110, v86, v199, 0
    v_dot2_f32_bf16 v111, v53, v199, 0
    v_dot2_f32_bf16 v114, v87, v199, 0
    v_dot2_f32_bf16 v115, v54, v199, 0
    v_dot2_f32_bf16 v102, v85, v198, v102
    v_dot2_f32_bf16 v103, v52, v198, v103
    v_dot2_f32_bf16 v106, v86, v198, v106
    v_dot2_f32_bf16 v107, v53, v198, v107
    v_dot2_f32_bf16 v110, v87, v198, v110
    v_dot2_f32_bf16 v111, v54, v198, v111
    v_dot2_f32_bf16 v114, v88, v198, v114
    v_dot2_f32_bf16 v115, v55, v198, v115
    v_lshlrev_b32 v104, 16, v68
    v_and_b32 v105, 0xffff0000, v68
    v_lshlrev_b32 v108, 16, v69
    v_and_b32 v109, 0xffff0000, v69
    v_lshlrev_b32 v112, 16, v70
    v_and_b32 v113, 0xffff0000, v70
    v_lshlrev_b32 v116, 16, v71
    v_and_b32 v117, 0xffff0000, v71
    v_mul_f32 v102, v102, v104
    v_mul_f32 v103, v103, v105
    v_mul_f32 v106, v106, v108
    v_mul_f32 v107, v107, v109
    v_mul_f32 v110, v110, v112
    v_mul_f32 v111, v111, v113
    v_mul_f32 v114, v114, v116
    v_mul_f32 v115, v115, v117
    v_cvt_pk_bf16_f32 v153, v103, v102
    v_cvt_pk_bf16_f32 v152, v107, v106
    v_cvt_pk_bf16_f32 v151, v111, v110
    v_cvt_pk_bf16_f32 v150, v115, v114
    s_add_u32 s4, s72, 65536
    buffer_store_dwordx4 v[150:153], v12, s[8:11], s4 offen offset:0
    v_dot2_f32_bf16 v118, v88, v199, 0
    v_dot2_f32_bf16 v119, v55, v199, 0
    v_dot2_f32_bf16 v122, v89, v199, 0
    v_dot2_f32_bf16 v123, v56, v199, 0
    v_dot2_f32_bf16 v126, v90, v199, 0
    v_dot2_f32_bf16 v127, v57, v199, 0
    v_dot2_f32_bf16 v130, v91, v199, 0
    v_dot2_f32_bf16 v131, v58, v199, 0
    v_dot2_f32_bf16 v118, v89, v198, v118
    v_dot2_f32_bf16 v119, v56, v198, v119
    v_dot2_f32_bf16 v122, v90, v198, v122
    v_dot2_f32_bf16 v123, v57, v198, v123
    v_dot2_f32_bf16 v126, v91, v198, v126
    v_dot2_f32_bf16 v127, v58, v198, v127
    v_dot2_f32_bf16 v130, v92, v198, v130
    v_dot2_f32_bf16 v131, v59, v198, v131
    v_lshlrev_b32 v120, 16, v72
    v_and_b32 v121, 0xffff0000, v72
    v_lshlrev_b32 v124, 16, v73
    v_and_b32 v125, 0xffff0000, v73
    v_lshlrev_b32 v128, 16, v74
    v_and_b32 v129, 0xffff0000, v74
    v_lshlrev_b32 v132, 16, v75
    v_and_b32 v133, 0xffff0000, v75
    v_mul_f32 v118, v118, v120
    v_mul_f32 v119, v119, v121
    v_mul_f32 v122, v122, v124
    v_mul_f32 v123, v123, v125
    v_mul_f32 v126, v126, v128
    v_mul_f32 v127, v127, v129
    v_mul_f32 v130, v130, v132
    v_mul_f32 v131, v131, v133
    v_cvt_pk_bf16_f32 v157, v119, v118
    v_cvt_pk_bf16_f32 v156, v123, v122
    v_cvt_pk_bf16_f32 v155, v127, v126
    v_cvt_pk_bf16_f32 v154, v131, v130
    buffer_store_dwordx4 v[154:157], v12, s[8:11], s4 offen offset:1024
    v_dot2_f32_bf16 v102, v92, v199, 0
    v_dot2_f32_bf16 v103, v59, v199, 0
    v_dot2_f32_bf16 v106, v93, v199, 0
    v_dot2_f32_bf16 v107, v60, v199, 0
    v_dot2_f32_bf16 v110, v94, v199, 0
    v_dot2_f32_bf16 v111, v61, v199, 0
    v_dot2_f32_bf16 v114, v95, v199, 0
    v_dot2_f32_bf16 v115, v62, v199, 0
    v_dot2_f32_bf16 v102, v93, v198, v102
    v_dot2_f32_bf16 v103, v60, v198, v103
    v_dot2_f32_bf16 v106, v94, v198, v106
    v_dot2_f32_bf16 v107, v61, v198, v107
    v_dot2_f32_bf16 v110, v95, v198, v110
    v_dot2_f32_bf16 v111, v62, v198, v111
    v_dot2_f32_bf16 v114, v96, v198, v114
    v_dot2_f32_bf16 v115, v63, v198, v115
    v_lshlrev_b32 v104, 16, v76
    v_and_b32 v105, 0xffff0000, v76
    v_lshlrev_b32 v108, 16, v77
    v_and_b32 v109, 0xffff0000, v77
    v_lshlrev_b32 v112, 16, v78
    v_and_b32 v113, 0xffff0000, v78
    v_lshlrev_b32 v116, 16, v79
    v_and_b32 v117, 0xffff0000, v79
    v_mul_f32 v102, v102, v104
    v_mul_f32 v103, v103, v105
    v_mul_f32 v106, v106, v108
    v_mul_f32 v107, v107, v109
    v_mul_f32 v110, v110, v112
    v_mul_f32 v111, v111, v113
    v_mul_f32 v114, v114, v116
    v_mul_f32 v115, v115, v117
    v_cvt_pk_bf16_f32 v161, v103, v102
    v_cvt_pk_bf16_f32 v160, v107, v106
    v_cvt_pk_bf16_f32 v159, v111, v110
    v_cvt_pk_bf16_f32 v158, v115, v114
    buffer_store_dwordx4 v[158:161], v12, s[8:11], s4 offen offset:2048
    v_dot2_f32_bf16 v118, v96, v199, 0
    v_dot2_f32_bf16 v119, v63, v199, 0
    v_dot2_f32_bf16 v122, v97, v199, 0
    v_dot2_f32_bf16 v123, v64, v199, 0
    v_dot2_f32_bf16 v126, v98, v199, 0
    v_dot2_f32_bf16 v127, v65, v199, 0
    v_dot2_f32_bf16 v130, v99, v199, 0
    v_dot2_f32_bf16 v131, v66, v199, 0
    v_dot2_f32_bf16 v118, v97, v198, v118
    v_dot2_f32_bf16 v119, v64, v198, v119
    v_dot2_f32_bf16 v122, v98, v198, v122
    v_dot2_f32_bf16 v123, v65, v198, v123
    v_dot2_f32_bf16 v126, v99, v198, v126
    v_dot2_f32_bf16 v127, v66, v198, v127
    v_dot2_f32_bf16 v130, v100, v198, v130
    v_dot2_f32_bf16 v131, v67, v198, v131
    v_lshlrev_b32 v120, 16, v80
    v_and_b32 v121, 0xffff0000, v80
    v_lshlrev_b32 v124, 16, v81
    v_and_b32 v125, 0xffff0000, v81
    v_lshlrev_b32 v128, 16, v82
    v_and_b32 v129, 0xffff0000, v82
    v_lshlrev_b32 v132, 16, v83
    v_and_b32 v133, 0xffff0000, v83
    v_mul_f32 v118, v118, v120
    v_mul_f32 v119, v119, v121
    v_mul_f32 v122, v122, v124
    v_mul_f32 v123, v123, v125
    v_mul_f32 v126, v126, v128
    v_mul_f32 v127, v127, v129
    v_mul_f32 v130, v130, v132
    v_mul_f32 v131, v131, v133
    v_cvt_pk_bf16_f32 v165, v119, v118
    v_cvt_pk_bf16_f32 v164, v123, v122
    v_cvt_pk_bf16_f32 v163, v127, v126
    v_cvt_pk_bf16_f32 v162, v131, v130
    buffer_store_dwordx4 v[162:165], v12, s[8:11], s4 offen offset:3072
    s_waitcnt vmcnt(25)
    ds_read_b64_tr_b16 v[16:17], v11 offset:16640
    ds_read_b64_tr_b16 v[18:19], v11 offset:16896
    ds_read_b64_tr_b16 v[20:21], v11 offset:17152
    ds_read_b64_tr_b16 v[22:23], v11 offset:17408
    ds_read_b64_tr_b16 v[24:25], v11 offset:17664
    ds_read_b64_tr_b16 v[26:27], v11 offset:17920
    ds_read_b64_tr_b16 v[28:29], v11 offset:18176
    ds_read_b64_tr_b16 v[30:31], v11 offset:18432
    ds_read_b64_tr_b16 v[32:33], v11 offset:18688
    ds_read_b64_tr_b16 v[34:35], v11 offset:25088
    ds_read_b64_tr_b16 v[36:37], v11 offset:25344
    ds_read_b64_tr_b16 v[38:39], v11 offset:25600
    ds_read_b64_tr_b16 v[40:41], v11 offset:25856
    ds_read_b64_tr_b16 v[42:43], v11 offset:26112
    ds_read_b64_tr_b16 v[44:45], v11 offset:26368
    ds_read_b64_tr_b16 v[46:47], v11 offset:26624
    ds_read_b64_tr_b16 v[48:49], v11 offset:26880
    ds_read_b64_tr_b16 v[50:51], v11 offset:16672
    ds_read_b64_tr_b16 v[52:53], v11 offset:16928
    ds_read_b64_tr_b16 v[54:55], v11 offset:17184
    ds_read_b64_tr_b16 v[56:57], v11 offset:17440
    ds_read_b64_tr_b16 v[58:59], v11 offset:17696
    ds_read_b64_tr_b16 v[60:61], v11 offset:17952
    ds_read_b64_tr_b16 v[62:63], v11 offset:18208
    ds_read_b64_tr_b16 v[64:65], v11 offset:18464
    ds_read_b64_tr_b16 v[66:67], v11 offset:18720
    ds_read_b64_tr_b16 v[68:69], v11 offset:25120
    ds_read_b64_tr_b16 v[70:71], v11 offset:25376
    ds_read_b64_tr_b16 v[72:73], v11 offset:25632
    ds_read_b64_tr_b16 v[74:75], v11 offset:25888
    ds_read_b64_tr_b16 v[76:77], v11 offset:26144
    ds_read_b64_tr_b16 v[78:79], v11 offset:26400
    ds_read_b64_tr_b16 v[80:81], v11 offset:26656
    ds_read_b64_tr_b16 v[82:83], v11 offset:26912
    s_waitcnt lgkmcnt(0)
    s_add_u32 s4, s70, 786432
    s_add_u32 m0, s71, 16640
    s_sub_u32 s5, s4, 8192
    s_max_i32 s5, s5, 0
    s_mov_b64 exec, 0xffff
    buffer_load_dwordx4 v10, s[80:83], s5 offen lds
    s_mov_b64 exec, -1

    s_add_u32 m0, s71, 16896
    s_nop 0
    buffer_load_dwordx4 v10, s[80:83], s4 offen lds
    s_add_u32 m0, s71, 25088
    s_nop 0
    buffer_load_dwordx4 v10, s[84:87], s4 offen lds
    s_add_u32 m0, s71, 17920
    s_add_u32 s4, s4, 32768
    buffer_load_dwordx4 v10, s[80:83], s4 offen lds
    s_add_u32 m0, s71, 26112
    s_nop 0
    buffer_load_dwordx4 v10, s[84:87], s4 offen lds
    s_add_u32 m0, s71, 18944
    s_add_u32 s4, s4, 32768
    buffer_load_dwordx4 v10, s[80:83], s4 offen lds
    s_add_u32 m0, s71, 27136
    s_nop 0
    buffer_load_dwordx4 v10, s[84:87], s4 offen lds
    s_add_u32 m0, s71, 19968
    s_add_u32 s4, s4, 32768
    buffer_load_dwordx4 v10, s[80:83], s4 offen lds
    s_add_u32 m0, s71, 28160
    s_nop 0
    buffer_load_dwordx4 v10, s[84:87], s4 offen lds
    s_add_u32 m0, s71, 20992
    s_add_u32 s4, s4, 32768
    buffer_load_dwordx4 v10, s[80:83], s4 offen lds
    s_add_u32 m0, s71, 29184
    s_nop 0
    buffer_load_dwordx4 v10, s[84:87], s4 offen lds
    s_add_u32 m0, s71, 22016
    s_add_u32 s4, s4, 32768
    buffer_load_dwordx4 v10, s[80:83], s4 offen lds
    s_add_u32 m0, s71, 30208
    s_nop 0
    buffer_load_dwordx4 v10, s[84:87], s4 offen lds
    s_add_u32 m0, s71, 23040
    s_add_u32 s4, s4, 32768
    buffer_load_dwordx4 v10, s[80:83], s4 offen lds
    s_add_u32 m0, s71, 31232
    s_nop 0
    buffer_load_dwordx4 v10, s[84:87], s4 offen lds
    s_add_u32 m0, s71, 24064
    s_add_u32 s4, s4, 32768
    buffer_load_dwordx4 v10, s[80:83], s4 offen lds
    s_add_u32 m0, s71, 32256
    s_nop 0
    buffer_load_dwordx4 v10, s[84:87], s4 offen lds
    v_alignbit_b32 v84, v17, v16, 16
    v_alignbit_b32 v85, v18, v17, 16
    v_alignbit_b32 v86, v19, v18, 16
    v_alignbit_b32 v87, v20, v19, 16
    v_alignbit_b32 v88, v21, v20, 16
    v_alignbit_b32 v89, v22, v21, 16
    v_alignbit_b32 v90, v23, v22, 16
    v_alignbit_b32 v91, v24, v23, 16
    v_alignbit_b32 v92, v25, v24, 16
    v_alignbit_b32 v93, v26, v25, 16
    v_alignbit_b32 v94, v27, v26, 16
    v_alignbit_b32 v95, v28, v27, 16
    v_alignbit_b32 v96, v29, v28, 16
    v_alignbit_b32 v97, v30, v29, 16
    v_alignbit_b32 v98, v31, v30, 16
    v_alignbit_b32 v99, v32, v31, 16
    v_alignbit_b32 v100, v33, v32, 16
    v_dot2_f32_bf16 v102, v84, v197, 0
    v_dot2_f32_bf16 v103, v17, v197, 0
    v_dot2_f32_bf16 v106, v85, v197, 0
    v_dot2_f32_bf16 v107, v18, v197, 0
    v_dot2_f32_bf16 v110, v86, v197, 0
    v_dot2_f32_bf16 v111, v19, v197, 0
    v_dot2_f32_bf16 v114, v87, v197, 0
    v_dot2_f32_bf16 v115, v20, v197, 0
    v_dot2_f32_bf16 v102, v85, v196, v102
    v_dot2_f32_bf16 v103, v18, v196, v103
    v_dot2_f32_bf16 v106, v86, v196, v106
    v_dot2_f32_bf16 v107, v19, v196, v107
    v_dot2_f32_bf16 v110, v87, v196, v110
    v_dot2_f32_bf16 v111, v20, v196, v111
    v_dot2_f32_bf16 v114, v88, v196, v114
    v_dot2_f32_bf16 v115, v21, v196, v115
    v_lshlrev_b32 v104, 16, v34
    v_and_b32 v105, 0xffff0000, v34
    v_lshlrev_b32 v108, 16, v35
    v_and_b32 v109, 0xffff0000, v35
    v_lshlrev_b32 v112, 16, v36
    v_and_b32 v113, 0xffff0000, v36
    v_lshlrev_b32 v116, 16, v37
    v_and_b32 v117, 0xffff0000, v37
    v_mul_f32 v102, v102, v104
    v_mul_f32 v103, v103, v105
    v_mul_f32 v106, v106, v108
    v_mul_f32 v107, v107, v109
    v_mul_f32 v110, v110, v112
    v_mul_f32 v111, v111, v113
    v_mul_f32 v114, v114, v116
    v_mul_f32 v115, v115, v117
    v_cvt_pk_bf16_f32 v137, v103, v102
    v_cvt_pk_bf16_f32 v136, v107, v106
    v_cvt_pk_bf16_f32 v135, v111, v110
    v_cvt_pk_bf16_f32 v134, v115, v114
    s_add_u32 s4, s72, 64
    buffer_store_dwordx4 v[134:137], v12, s[8:11], s4 offen offset:0
    v_dot2_f32_bf16 v118, v88, v197, 0
    v_dot2_f32_bf16 v119, v21, v197, 0
    v_dot2_f32_bf16 v122, v89, v197, 0
    v_dot2_f32_bf16 v123, v22, v197, 0
    v_dot2_f32_bf16 v126, v90, v197, 0
    v_dot2_f32_bf16 v127, v23, v197, 0
    v_dot2_f32_bf16 v130, v91, v197, 0
    v_dot2_f32_bf16 v131, v24, v197, 0
    v_dot2_f32_bf16 v118, v89, v196, v118
    v_dot2_f32_bf16 v119, v22, v196, v119
    v_dot2_f32_bf16 v122, v90, v196, v122
    v_dot2_f32_bf16 v123, v23, v196, v123
    v_dot2_f32_bf16 v126, v91, v196, v126
    v_dot2_f32_bf16 v127, v24, v196, v127
    v_dot2_f32_bf16 v130, v92, v196, v130
    v_dot2_f32_bf16 v131, v25, v196, v131
    v_lshlrev_b32 v120, 16, v38
    v_and_b32 v121, 0xffff0000, v38
    v_lshlrev_b32 v124, 16, v39
    v_and_b32 v125, 0xffff0000, v39
    v_lshlrev_b32 v128, 16, v40
    v_and_b32 v129, 0xffff0000, v40
    v_lshlrev_b32 v132, 16, v41
    v_and_b32 v133, 0xffff0000, v41
    v_mul_f32 v118, v118, v120
    v_mul_f32 v119, v119, v121
    v_mul_f32 v122, v122, v124
    v_mul_f32 v123, v123, v125
    v_mul_f32 v126, v126, v128
    v_mul_f32 v127, v127, v129
    v_mul_f32 v130, v130, v132
    v_mul_f32 v131, v131, v133
    v_cvt_pk_bf16_f32 v141, v119, v118
    v_cvt_pk_bf16_f32 v140, v123, v122
    v_cvt_pk_bf16_f32 v139, v127, v126
    v_cvt_pk_bf16_f32 v138, v131, v130
    buffer_store_dwordx4 v[138:141], v12, s[8:11], s4 offen offset:1024
    v_dot2_f32_bf16 v102, v92, v197, 0
    v_dot2_f32_bf16 v103, v25, v197, 0
    v_dot2_f32_bf16 v106, v93, v197, 0
    v_dot2_f32_bf16 v107, v26, v197, 0
    v_dot2_f32_bf16 v110, v94, v197, 0
    v_dot2_f32_bf16 v111, v27, v197, 0
    v_dot2_f32_bf16 v114, v95, v197, 0
    v_dot2_f32_bf16 v115, v28, v197, 0
    v_dot2_f32_bf16 v102, v93, v196, v102
    v_dot2_f32_bf16 v103, v26, v196, v103
    v_dot2_f32_bf16 v106, v94, v196, v106
    v_dot2_f32_bf16 v107, v27, v196, v107
    v_dot2_f32_bf16 v110, v95, v196, v110
    v_dot2_f32_bf16 v111, v28, v196, v111
    v_dot2_f32_bf16 v114, v96, v196, v114
    v_dot2_f32_bf16 v115, v29, v196, v115
    v_lshlrev_b32 v104, 16, v42
    v_and_b32 v105, 0xffff0000, v42
    v_lshlrev_b32 v108, 16, v43
    v_and_b32 v109, 0xffff0000, v43
    v_lshlrev_b32 v112, 16, v44
    v_and_b32 v113, 0xffff0000, v44
    v_lshlrev_b32 v116, 16, v45
    v_and_b32 v117, 0xffff0000, v45
    v_mul_f32 v102, v102, v104
    v_mul_f32 v103, v103, v105
    v_mul_f32 v106, v106, v108
    v_mul_f32 v107, v107, v109
    v_mul_f32 v110, v110, v112
    v_mul_f32 v111, v111, v113
    v_mul_f32 v114, v114, v116
    v_mul_f32 v115, v115, v117
    v_cvt_pk_bf16_f32 v145, v103, v102
    v_cvt_pk_bf16_f32 v144, v107, v106
    v_cvt_pk_bf16_f32 v143, v111, v110
    v_cvt_pk_bf16_f32 v142, v115, v114
    buffer_store_dwordx4 v[142:145], v12, s[8:11], s4 offen offset:2048
    v_dot2_f32_bf16 v118, v96, v197, 0
    v_dot2_f32_bf16 v119, v29, v197, 0
    v_dot2_f32_bf16 v122, v97, v197, 0
    v_dot2_f32_bf16 v123, v30, v197, 0
    v_dot2_f32_bf16 v126, v98, v197, 0
    v_dot2_f32_bf16 v127, v31, v197, 0
    v_dot2_f32_bf16 v130, v99, v197, 0
    v_dot2_f32_bf16 v131, v32, v197, 0
    v_dot2_f32_bf16 v118, v97, v196, v118
    v_dot2_f32_bf16 v119, v30, v196, v119
    v_dot2_f32_bf16 v122, v98, v196, v122
    v_dot2_f32_bf16 v123, v31, v196, v123
    v_dot2_f32_bf16 v126, v99, v196, v126
    v_dot2_f32_bf16 v127, v32, v196, v127
    v_dot2_f32_bf16 v130, v100, v196, v130
    v_dot2_f32_bf16 v131, v33, v196, v131
    v_lshlrev_b32 v120, 16, v46
    v_and_b32 v121, 0xffff0000, v46
    v_lshlrev_b32 v124, 16, v47
    v_and_b32 v125, 0xffff0000, v47
    v_lshlrev_b32 v128, 16, v48
    v_and_b32 v129, 0xffff0000, v48
    v_lshlrev_b32 v132, 16, v49
    v_and_b32 v133, 0xffff0000, v49
    v_mul_f32 v118, v118, v120
    v_mul_f32 v119, v119, v121
    v_mul_f32 v122, v122, v124
    v_mul_f32 v123, v123, v125
    v_mul_f32 v126, v126, v128
    v_mul_f32 v127, v127, v129
    v_mul_f32 v130, v130, v132
    v_mul_f32 v131, v131, v133
    v_cvt_pk_bf16_f32 v149, v119, v118
    v_cvt_pk_bf16_f32 v148, v123, v122
    v_cvt_pk_bf16_f32 v147, v127, v126
    v_cvt_pk_bf16_f32 v146, v131, v130
    buffer_store_dwordx4 v[146:149], v12, s[8:11], s4 offen offset:3072
    v_alignbit_b32 v84, v51, v50, 16
    v_alignbit_b32 v85, v52, v51, 16
    v_alignbit_b32 v86, v53, v52, 16
    v_alignbit_b32 v87, v54, v53, 16
    v_alignbit_b32 v88, v55, v54, 16
    v_alignbit_b32 v89, v56, v55, 16
    v_alignbit_b32 v90, v57, v56, 16
    v_alignbit_b32 v91, v58, v57, 16
    v_alignbit_b32 v92, v59, v58, 16
    v_alignbit_b32 v93, v60, v59, 16
    v_alignbit_b32 v94, v61, v60, 16
    v_alignbit_b32 v95, v62, v61, 16
    v_alignbit_b32 v96, v63, v62, 16
    v_alignbit_b32 v97, v64, v63, 16
    v_alignbit_b32 v98, v65, v64, 16
    v_alignbit_b32 v99, v66, v65, 16
    v_alignbit_b32 v100, v67, v66, 16
    v_dot2_f32_bf16 v102, v84, v199, 0
    v_dot2_f32_bf16 v103, v51, v199, 0
    v_dot2_f32_bf16 v106, v85, v199, 0
    v_dot2_f32_bf16 v107, v52, v199, 0
    v_dot2_f32_bf16 v110, v86, v199, 0
    v_dot2_f32_bf16 v111, v53, v199, 0
    v_dot2_f32_bf16 v114, v87, v199, 0
    v_dot2_f32_bf16 v115, v54, v199, 0
    v_dot2_f32_bf16 v102, v85, v198, v102
    v_dot2_f32_bf16 v103, v52, v198, v103
    v_dot2_f32_bf16 v106, v86, v198, v106
    v_dot2_f32_bf16 v107, v53, v198, v107
    v_dot2_f32_bf16 v110, v87, v198, v110
    v_dot2_f32_bf16 v111, v54, v198, v111
    v_dot2_f32_bf16 v114, v88, v198, v114
    v_dot2_f32_bf16 v115, v55, v198, v115
    v_lshlrev_b32 v104, 16, v68
    v_and_b32 v105, 0xffff0000, v68
    v_lshlrev_b32 v108, 16, v69
    v_and_b32 v109, 0xffff0000, v69
    v_lshlrev_b32 v112, 16, v70
    v_and_b32 v113, 0xffff0000, v70
    v_lshlrev_b32 v116, 16, v71
    v_and_b32 v117, 0xffff0000, v71
    v_mul_f32 v102, v102, v104
    v_mul_f32 v103, v103, v105
    v_mul_f32 v106, v106, v108
    v_mul_f32 v107, v107, v109
    v_mul_f32 v110, v110, v112
    v_mul_f32 v111, v111, v113
    v_mul_f32 v114, v114, v116
    v_mul_f32 v115, v115, v117
    v_cvt_pk_bf16_f32 v153, v103, v102
    v_cvt_pk_bf16_f32 v152, v107, v106
    v_cvt_pk_bf16_f32 v151, v111, v110
    v_cvt_pk_bf16_f32 v150, v115, v114
    s_add_u32 s4, s72, 65600
    buffer_store_dwordx4 v[150:153], v12, s[8:11], s4 offen offset:0
    v_dot2_f32_bf16 v118, v88, v199, 0
    v_dot2_f32_bf16 v119, v55, v199, 0
    v_dot2_f32_bf16 v122, v89, v199, 0
    v_dot2_f32_bf16 v123, v56, v199, 0
    v_dot2_f32_bf16 v126, v90, v199, 0
    v_dot2_f32_bf16 v127, v57, v199, 0
    v_dot2_f32_bf16 v130, v91, v199, 0
    v_dot2_f32_bf16 v131, v58, v199, 0
    v_dot2_f32_bf16 v118, v89, v198, v118
    v_dot2_f32_bf16 v119, v56, v198, v119
    v_dot2_f32_bf16 v122, v90, v198, v122
    v_dot2_f32_bf16 v123, v57, v198, v123
    v_dot2_f32_bf16 v126, v91, v198, v126
    v_dot2_f32_bf16 v127, v58, v198, v127
    v_dot2_f32_bf16 v130, v92, v198, v130
    v_dot2_f32_bf16 v131, v59, v198, v131
    v_lshlrev_b32 v120, 16, v72
    v_and_b32 v121, 0xffff0000, v72
    v_lshlrev_b32 v124, 16, v73
    v_and_b32 v125, 0xffff0000, v73
    v_lshlrev_b32 v128, 16, v74
    v_and_b32 v129, 0xffff0000, v74
    v_lshlrev_b32 v132, 16, v75
    v_and_b32 v133, 0xffff0000, v75
    v_mul_f32 v118, v118, v120
    v_mul_f32 v119, v119, v121
    v_mul_f32 v122, v122, v124
    v_mul_f32 v123, v123, v125
    v_mul_f32 v126, v126, v128
    v_mul_f32 v127, v127, v129
    v_mul_f32 v130, v130, v132
    v_mul_f32 v131, v131, v133
    v_cvt_pk_bf16_f32 v157, v119, v118
    v_cvt_pk_bf16_f32 v156, v123, v122
    v_cvt_pk_bf16_f32 v155, v127, v126
    v_cvt_pk_bf16_f32 v154, v131, v130
    buffer_store_dwordx4 v[154:157], v12, s[8:11], s4 offen offset:1024
    v_dot2_f32_bf16 v102, v92, v199, 0
    v_dot2_f32_bf16 v103, v59, v199, 0
    v_dot2_f32_bf16 v106, v93, v199, 0
    v_dot2_f32_bf16 v107, v60, v199, 0
    v_dot2_f32_bf16 v110, v94, v199, 0
    v_dot2_f32_bf16 v111, v61, v199, 0
    v_dot2_f32_bf16 v114, v95, v199, 0
    v_dot2_f32_bf16 v115, v62, v199, 0
    v_dot2_f32_bf16 v102, v93, v198, v102
    v_dot2_f32_bf16 v103, v60, v198, v103
    v_dot2_f32_bf16 v106, v94, v198, v106
    v_dot2_f32_bf16 v107, v61, v198, v107
    v_dot2_f32_bf16 v110, v95, v198, v110
    v_dot2_f32_bf16 v111, v62, v198, v111
    v_dot2_f32_bf16 v114, v96, v198, v114
    v_dot2_f32_bf16 v115, v63, v198, v115
    v_lshlrev_b32 v104, 16, v76
    v_and_b32 v105, 0xffff0000, v76
    v_lshlrev_b32 v108, 16, v77
    v_and_b32 v109, 0xffff0000, v77
    v_lshlrev_b32 v112, 16, v78
    v_and_b32 v113, 0xffff0000, v78
    v_lshlrev_b32 v116, 16, v79
    v_and_b32 v117, 0xffff0000, v79
    v_mul_f32 v102, v102, v104
    v_mul_f32 v103, v103, v105
    v_mul_f32 v106, v106, v108
    v_mul_f32 v107, v107, v109
    v_mul_f32 v110, v110, v112
    v_mul_f32 v111, v111, v113
    v_mul_f32 v114, v114, v116
    v_mul_f32 v115, v115, v117
    v_cvt_pk_bf16_f32 v161, v103, v102
    v_cvt_pk_bf16_f32 v160, v107, v106
    v_cvt_pk_bf16_f32 v159, v111, v110
    v_cvt_pk_bf16_f32 v158, v115, v114
    buffer_store_dwordx4 v[158:161], v12, s[8:11], s4 offen offset:2048
    v_dot2_f32_bf16 v118, v96, v199, 0
    v_dot2_f32_bf16 v119, v63, v199, 0
    v_dot2_f32_bf16 v122, v97, v199, 0
    v_dot2_f32_bf16 v123, v64, v199, 0
    v_dot2_f32_bf16 v126, v98, v199, 0
    v_dot2_f32_bf16 v127, v65, v199, 0
    v_dot2_f32_bf16 v130, v99, v199, 0
    v_dot2_f32_bf16 v131, v66, v199, 0
    v_dot2_f32_bf16 v118, v97, v198, v118
    v_dot2_f32_bf16 v119, v64, v198, v119
    v_dot2_f32_bf16 v122, v98, v198, v122
    v_dot2_f32_bf16 v123, v65, v198, v123
    v_dot2_f32_bf16 v126, v99, v198, v126
    v_dot2_f32_bf16 v127, v66, v198, v127
    v_dot2_f32_bf16 v130, v100, v198, v130
    v_dot2_f32_bf16 v131, v67, v198, v131
    v_lshlrev_b32 v120, 16, v80
    v_and_b32 v121, 0xffff0000, v80
    v_lshlrev_b32 v124, 16, v81
    v_and_b32 v125, 0xffff0000, v81
    v_lshlrev_b32 v128, 16, v82
    v_and_b32 v129, 0xffff0000, v82
    v_lshlrev_b32 v132, 16, v83
    v_and_b32 v133, 0xffff0000, v83
    v_mul_f32 v118, v118, v120
    v_mul_f32 v119, v119, v121
    v_mul_f32 v122, v122, v124
    v_mul_f32 v123, v123, v125
    v_mul_f32 v126, v126, v128
    v_mul_f32 v127, v127, v129
    v_mul_f32 v130, v130, v132
    v_mul_f32 v131, v131, v133
    v_cvt_pk_bf16_f32 v165, v119, v118
    v_cvt_pk_bf16_f32 v164, v123, v122
    v_cvt_pk_bf16_f32 v163, v127, v126
    v_cvt_pk_bf16_f32 v162, v131, v130
    buffer_store_dwordx4 v[162:165], v12, s[8:11], s4 offen offset:3072
    s_waitcnt vmcnt(25)
    ds_read_b64_tr_b16 v[16:17], v11 offset:0
    ds_read_b64_tr_b16 v[18:19], v11 offset:256
    ds_read_b64_tr_b16 v[20:21], v11 offset:512
    ds_read_b64_tr_b16 v[22:23], v11 offset:768
    ds_read_b64_tr_b16 v[24:25], v11 offset:1024
    ds_read_b64_tr_b16 v[26:27], v11 offset:1280
    ds_read_b64_tr_b16 v[28:29], v11 offset:1536
    ds_read_b64_tr_b16 v[30:31], v11 offset:1792
    ds_read_b64_tr_b16 v[32:33], v11 offset:2048
    ds_read_b64_tr_b16 v[34:35], v11 offset:8448
    ds_read_b64_tr_b16 v[36:37], v11 offset:8704
    ds_read_b64_tr_b16 v[38:39], v11 offset:8960
    ds_read_b64_tr_b16 v[40:41], v11 offset:9216
    ds_read_b64_tr_b16 v[42:43], v11 offset:9472
    ds_read_b64_tr_b16 v[44:45], v11 offset:9728
    ds_read_b64_tr_b16 v[46:47], v11 offset:9984
    ds_read_b64_tr_b16 v[48:49], v11 offset:10240
    ds_read_b64_tr_b16 v[50:51], v11 offset:32
    ds_read_b64_tr_b16 v[52:53], v11 offset:288
    ds_read_b64_tr_b16 v[54:55], v11 offset:544
    ds_read_b64_tr_b16 v[56:57], v11 offset:800
    ds_read_b64_tr_b16 v[58:59], v11 offset:1056
    ds_read_b64_tr_b16 v[60:61], v11 offset:1312
    ds_read_b64_tr_b16 v[62:63], v11 offset:1568
    ds_read_b64_tr_b16 v[64:65], v11 offset:1824
    ds_read_b64_tr_b16 v[66:67], v11 offset:2080
    ds_read_b64_tr_b16 v[68:69], v11 offset:8480
    ds_read_b64_tr_b16 v[70:71], v11 offset:8736
    ds_read_b64_tr_b16 v[72:73], v11 offset:8992
    ds_read_b64_tr_b16 v[74:75], v11 offset:9248
    ds_read_b64_tr_b16 v[76:77], v11 offset:9504
    ds_read_b64_tr_b16 v[78:79], v11 offset:9760
    ds_read_b64_tr_b16 v[80:81], v11 offset:10016
    ds_read_b64_tr_b16 v[82:83], v11 offset:10272
    s_waitcnt lgkmcnt(0)
    v_alignbit_b32 v84, v17, v16, 16
    v_alignbit_b32 v85, v18, v17, 16
    v_alignbit_b32 v86, v19, v18, 16
    v_alignbit_b32 v87, v20, v19, 16
    v_alignbit_b32 v88, v21, v20, 16
    v_alignbit_b32 v89, v22, v21, 16
    v_alignbit_b32 v90, v23, v22, 16
    v_alignbit_b32 v91, v24, v23, 16
    v_alignbit_b32 v92, v25, v24, 16
    v_alignbit_b32 v93, v26, v25, 16
    v_alignbit_b32 v94, v27, v26, 16
    v_alignbit_b32 v95, v28, v27, 16
    v_alignbit_b32 v96, v29, v28, 16
    v_alignbit_b32 v97, v30, v29, 16
    v_alignbit_b32 v98, v31, v30, 16
    v_alignbit_b32 v99, v32, v31, 16
    v_alignbit_b32 v100, v33, v32, 16
    v_dot2_f32_bf16 v102, v84, v197, 0
    v_dot2_f32_bf16 v103, v17, v197, 0
    v_dot2_f32_bf16 v106, v85, v197, 0
    v_dot2_f32_bf16 v107, v18, v197, 0
    v_dot2_f32_bf16 v110, v86, v197, 0
    v_dot2_f32_bf16 v111, v19, v197, 0
    v_dot2_f32_bf16 v114, v87, v197, 0
    v_dot2_f32_bf16 v115, v20, v197, 0
    v_dot2_f32_bf16 v102, v85, v196, v102
    v_dot2_f32_bf16 v103, v18, v196, v103
    v_dot2_f32_bf16 v106, v86, v196, v106
    v_dot2_f32_bf16 v107, v19, v196, v107
    v_dot2_f32_bf16 v110, v87, v196, v110
    v_dot2_f32_bf16 v111, v20, v196, v111
    v_dot2_f32_bf16 v114, v88, v196, v114
    v_dot2_f32_bf16 v115, v21, v196, v115
    v_lshlrev_b32 v104, 16, v34
    v_and_b32 v105, 0xffff0000, v34
    v_lshlrev_b32 v108, 16, v35
    v_and_b32 v109, 0xffff0000, v35
    v_lshlrev_b32 v112, 16, v36
    v_and_b32 v113, 0xffff0000, v36
    v_lshlrev_b32 v116, 16, v37
    v_and_b32 v117, 0xffff0000, v37
    v_mul_f32 v102, v102, v104
    v_mul_f32 v103, v103, v105
    v_mul_f32 v106, v106, v108
    v_mul_f32 v107, v107, v109
    v_mul_f32 v110, v110, v112
    v_mul_f32 v111, v111, v113
    v_mul_f32 v114, v114, v116
    v_mul_f32 v115, v115, v117
    v_cvt_pk_bf16_f32 v137, v103, v102
    v_cvt_pk_bf16_f32 v136, v107, v106
    v_cvt_pk_bf16_f32 v135, v111, v110
    v_cvt_pk_bf16_f32 v134, v115, v114
    s_add_u32 s4, s72, 128
    buffer_store_dwordx4 v[134:137], v12, s[8:11], s4 offen offset:0
    v_dot2_f32_bf16 v118, v88, v197, 0
    v_dot2_f32_bf16 v119, v21, v197, 0
    v_dot2_f32_bf16 v122, v89, v197, 0
    v_dot2_f32_bf16 v123, v22, v197, 0
    v_dot2_f32_bf16 v126, v90, v197, 0
    v_dot2_f32_bf16 v127, v23, v197, 0
    v_dot2_f32_bf16 v130, v91, v197, 0
    v_dot2_f32_bf16 v131, v24, v197, 0
    v_dot2_f32_bf16 v118, v89, v196, v118
    v_dot2_f32_bf16 v119, v22, v196, v119
    v_dot2_f32_bf16 v122, v90, v196, v122
    v_dot2_f32_bf16 v123, v23, v196, v123
    v_dot2_f32_bf16 v126, v91, v196, v126
    v_dot2_f32_bf16 v127, v24, v196, v127
    v_dot2_f32_bf16 v130, v92, v196, v130
    v_dot2_f32_bf16 v131, v25, v196, v131
    v_lshlrev_b32 v120, 16, v38
    v_and_b32 v121, 0xffff0000, v38
    v_lshlrev_b32 v124, 16, v39
    v_and_b32 v125, 0xffff0000, v39
    v_lshlrev_b32 v128, 16, v40
    v_and_b32 v129, 0xffff0000, v40
    v_lshlrev_b32 v132, 16, v41
    v_and_b32 v133, 0xffff0000, v41
    v_mul_f32 v118, v118, v120
    v_mul_f32 v119, v119, v121
    v_mul_f32 v122, v122, v124
    v_mul_f32 v123, v123, v125
    v_mul_f32 v126, v126, v128
    v_mul_f32 v127, v127, v129
    v_mul_f32 v130, v130, v132
    v_mul_f32 v131, v131, v133
    v_cvt_pk_bf16_f32 v141, v119, v118
    v_cvt_pk_bf16_f32 v140, v123, v122
    v_cvt_pk_bf16_f32 v139, v127, v126
    v_cvt_pk_bf16_f32 v138, v131, v130
    buffer_store_dwordx4 v[138:141], v12, s[8:11], s4 offen offset:1024
    v_dot2_f32_bf16 v102, v92, v197, 0
    v_dot2_f32_bf16 v103, v25, v197, 0
    v_dot2_f32_bf16 v106, v93, v197, 0
    v_dot2_f32_bf16 v107, v26, v197, 0
    v_dot2_f32_bf16 v110, v94, v197, 0
    v_dot2_f32_bf16 v111, v27, v197, 0
    v_dot2_f32_bf16 v114, v95, v197, 0
    v_dot2_f32_bf16 v115, v28, v197, 0
    v_dot2_f32_bf16 v102, v93, v196, v102
    v_dot2_f32_bf16 v103, v26, v196, v103
    v_dot2_f32_bf16 v106, v94, v196, v106
    v_dot2_f32_bf16 v107, v27, v196, v107
    v_dot2_f32_bf16 v110, v95, v196, v110
    v_dot2_f32_bf16 v111, v28, v196, v111
    v_dot2_f32_bf16 v114, v96, v196, v114
    v_dot2_f32_bf16 v115, v29, v196, v115
    v_lshlrev_b32 v104, 16, v42
    v_and_b32 v105, 0xffff0000, v42
    v_lshlrev_b32 v108, 16, v43
    v_and_b32 v109, 0xffff0000, v43
    v_lshlrev_b32 v112, 16, v44
    v_and_b32 v113, 0xffff0000, v44
    v_lshlrev_b32 v116, 16, v45
    v_and_b32 v117, 0xffff0000, v45
    v_mul_f32 v102, v102, v104
    v_mul_f32 v103, v103, v105
    v_mul_f32 v106, v106, v108
    v_mul_f32 v107, v107, v109
    v_mul_f32 v110, v110, v112
    v_mul_f32 v111, v111, v113
    v_mul_f32 v114, v114, v116
    v_mul_f32 v115, v115, v117
    v_cvt_pk_bf16_f32 v145, v103, v102
    v_cvt_pk_bf16_f32 v144, v107, v106
    v_cvt_pk_bf16_f32 v143, v111, v110
    v_cvt_pk_bf16_f32 v142, v115, v114
    buffer_store_dwordx4 v[142:145], v12, s[8:11], s4 offen offset:2048
    v_dot2_f32_bf16 v118, v96, v197, 0
    v_dot2_f32_bf16 v119, v29, v197, 0
    v_dot2_f32_bf16 v122, v97, v197, 0
    v_dot2_f32_bf16 v123, v30, v197, 0
    v_dot2_f32_bf16 v126, v98, v197, 0
    v_dot2_f32_bf16 v127, v31, v197, 0
    v_dot2_f32_bf16 v130, v99, v197, 0
    v_dot2_f32_bf16 v131, v32, v197, 0
    v_dot2_f32_bf16 v118, v97, v196, v118
    v_dot2_f32_bf16 v119, v30, v196, v119
    v_dot2_f32_bf16 v122, v98, v196, v122
    v_dot2_f32_bf16 v123, v31, v196, v123
    v_dot2_f32_bf16 v126, v99, v196, v126
    v_dot2_f32_bf16 v127, v32, v196, v127
    v_dot2_f32_bf16 v130, v100, v196, v130
    v_dot2_f32_bf16 v131, v33, v196, v131
    v_lshlrev_b32 v120, 16, v46
    v_and_b32 v121, 0xffff0000, v46
    v_lshlrev_b32 v124, 16, v47
    v_and_b32 v125, 0xffff0000, v47
    v_lshlrev_b32 v128, 16, v48
    v_and_b32 v129, 0xffff0000, v48
    v_lshlrev_b32 v132, 16, v49
    v_and_b32 v133, 0xffff0000, v49
    v_mul_f32 v118, v118, v120
    v_mul_f32 v119, v119, v121
    v_mul_f32 v122, v122, v124
    v_mul_f32 v123, v123, v125
    v_mul_f32 v126, v126, v128
    v_mul_f32 v127, v127, v129
    v_mul_f32 v130, v130, v132
    v_mul_f32 v131, v131, v133
    v_cvt_pk_bf16_f32 v149, v119, v118
    v_cvt_pk_bf16_f32 v148, v123, v122
    v_cvt_pk_bf16_f32 v147, v127, v126
    v_cvt_pk_bf16_f32 v146, v131, v130
    buffer_store_dwordx4 v[146:149], v12, s[8:11], s4 offen offset:3072
    v_alignbit_b32 v84, v51, v50, 16
    v_alignbit_b32 v85, v52, v51, 16
    v_alignbit_b32 v86, v53, v52, 16
    v_alignbit_b32 v87, v54, v53, 16
    v_alignbit_b32 v88, v55, v54, 16
    v_alignbit_b32 v89, v56, v55, 16
    v_alignbit_b32 v90, v57, v56, 16
    v_alignbit_b32 v91, v58, v57, 16
    v_alignbit_b32 v92, v59, v58, 16
    v_alignbit_b32 v93, v60, v59, 16
    v_alignbit_b32 v94, v61, v60, 16
    v_alignbit_b32 v95, v62, v61, 16
    v_alignbit_b32 v96, v63, v62, 16
    v_alignbit_b32 v97, v64, v63, 16
    v_alignbit_b32 v98, v65, v64, 16
    v_alignbit_b32 v99, v66, v65, 16
    v_alignbit_b32 v100, v67, v66, 16
    v_dot2_f32_bf16 v102, v84, v199, 0
    v_dot2_f32_bf16 v103, v51, v199, 0
    v_dot2_f32_bf16 v106, v85, v199, 0
    v_dot2_f32_bf16 v107, v52, v199, 0
    v_dot2_f32_bf16 v110, v86, v199, 0
    v_dot2_f32_bf16 v111, v53, v199, 0
    v_dot2_f32_bf16 v114, v87, v199, 0
    v_dot2_f32_bf16 v115, v54, v199, 0
    v_dot2_f32_bf16 v102, v85, v198, v102
    v_dot2_f32_bf16 v103, v52, v198, v103
    v_dot2_f32_bf16 v106, v86, v198, v106
    v_dot2_f32_bf16 v107, v53, v198, v107
    v_dot2_f32_bf16 v110, v87, v198, v110
    v_dot2_f32_bf16 v111, v54, v198, v111
    v_dot2_f32_bf16 v114, v88, v198, v114
    v_dot2_f32_bf16 v115, v55, v198, v115
    v_lshlrev_b32 v104, 16, v68
    v_and_b32 v105, 0xffff0000, v68
    v_lshlrev_b32 v108, 16, v69
    v_and_b32 v109, 0xffff0000, v69
    v_lshlrev_b32 v112, 16, v70
    v_and_b32 v113, 0xffff0000, v70
    v_lshlrev_b32 v116, 16, v71
    v_and_b32 v117, 0xffff0000, v71
    v_mul_f32 v102, v102, v104
    v_mul_f32 v103, v103, v105
    v_mul_f32 v106, v106, v108
    v_mul_f32 v107, v107, v109
    v_mul_f32 v110, v110, v112
    v_mul_f32 v111, v111, v113
    v_mul_f32 v114, v114, v116
    v_mul_f32 v115, v115, v117
    v_cvt_pk_bf16_f32 v153, v103, v102
    v_cvt_pk_bf16_f32 v152, v107, v106
    v_cvt_pk_bf16_f32 v151, v111, v110
    v_cvt_pk_bf16_f32 v150, v115, v114
    s_add_u32 s4, s72, 65664
    buffer_store_dwordx4 v[150:153], v12, s[8:11], s4 offen offset:0
    v_dot2_f32_bf16 v118, v88, v199, 0
    v_dot2_f32_bf16 v119, v55, v199, 0
    v_dot2_f32_bf16 v122, v89, v199, 0
    v_dot2_f32_bf16 v123, v56, v199, 0
    v_dot2_f32_bf16 v126, v90, v199, 0
    v_dot2_f32_bf16 v127, v57, v199, 0
    v_dot2_f32_bf16 v130, v91, v199, 0
    v_dot2_f32_bf16 v131, v58, v199, 0
    v_dot2_f32_bf16 v118, v89, v198, v118
    v_dot2_f32_bf16 v119, v56, v198, v119
    v_dot2_f32_bf16 v122, v90, v198, v122
    v_dot2_f32_bf16 v123, v57, v198, v123
    v_dot2_f32_bf16 v126, v91, v198, v126
    v_dot2_f32_bf16 v127, v58, v198, v127
    v_dot2_f32_bf16 v130, v92, v198, v130
    v_dot2_f32_bf16 v131, v59, v198, v131
    v_lshlrev_b32 v120, 16, v72
    v_and_b32 v121, 0xffff0000, v72
    v_lshlrev_b32 v124, 16, v73
    v_and_b32 v125, 0xffff0000, v73
    v_lshlrev_b32 v128, 16, v74
    v_and_b32 v129, 0xffff0000, v74
    v_lshlrev_b32 v132, 16, v75
    v_and_b32 v133, 0xffff0000, v75
    v_mul_f32 v118, v118, v120
    v_mul_f32 v119, v119, v121
    v_mul_f32 v122, v122, v124
    v_mul_f32 v123, v123, v125
    v_mul_f32 v126, v126, v128
    v_mul_f32 v127, v127, v129
    v_mul_f32 v130, v130, v132
    v_mul_f32 v131, v131, v133
    v_cvt_pk_bf16_f32 v157, v119, v118
    v_cvt_pk_bf16_f32 v156, v123, v122
    v_cvt_pk_bf16_f32 v155, v127, v126
    v_cvt_pk_bf16_f32 v154, v131, v130
    buffer_store_dwordx4 v[154:157], v12, s[8:11], s4 offen offset:1024
    v_dot2_f32_bf16 v102, v92, v199, 0
    v_dot2_f32_bf16 v103, v59, v199, 0
    v_dot2_f32_bf16 v106, v93, v199, 0
    v_dot2_f32_bf16 v107, v60, v199, 0
    v_dot2_f32_bf16 v110, v94, v199, 0
    v_dot2_f32_bf16 v111, v61, v199, 0
    v_dot2_f32_bf16 v114, v95, v199, 0
    v_dot2_f32_bf16 v115, v62, v199, 0
    v_dot2_f32_bf16 v102, v93, v198, v102
    v_dot2_f32_bf16 v103, v60, v198, v103
    v_dot2_f32_bf16 v106, v94, v198, v106
    v_dot2_f32_bf16 v107, v61, v198, v107
    v_dot2_f32_bf16 v110, v95, v198, v110
    v_dot2_f32_bf16 v111, v62, v198, v111
    v_dot2_f32_bf16 v114, v96, v198, v114
    v_dot2_f32_bf16 v115, v63, v198, v115
    v_lshlrev_b32 v104, 16, v76
    v_and_b32 v105, 0xffff0000, v76
    v_lshlrev_b32 v108, 16, v77
    v_and_b32 v109, 0xffff0000, v77
    v_lshlrev_b32 v112, 16, v78
    v_and_b32 v113, 0xffff0000, v78
    v_lshlrev_b32 v116, 16, v79
    v_and_b32 v117, 0xffff0000, v79
    v_mul_f32 v102, v102, v104
    v_mul_f32 v103, v103, v105
    v_mul_f32 v106, v106, v108
    v_mul_f32 v107, v107, v109
    v_mul_f32 v110, v110, v112
    v_mul_f32 v111, v111, v113
    v_mul_f32 v114, v114, v116
    v_mul_f32 v115, v115, v117
    v_cvt_pk_bf16_f32 v161, v103, v102
    v_cvt_pk_bf16_f32 v160, v107, v106
    v_cvt_pk_bf16_f32 v159, v111, v110
    v_cvt_pk_bf16_f32 v158, v115, v114
    buffer_store_dwordx4 v[158:161], v12, s[8:11], s4 offen offset:2048
    v_dot2_f32_bf16 v118, v96, v199, 0
    v_dot2_f32_bf16 v119, v63, v199, 0
    v_dot2_f32_bf16 v122, v97, v199, 0
    v_dot2_f32_bf16 v123, v64, v199, 0
    v_dot2_f32_bf16 v126, v98, v199, 0
    v_dot2_f32_bf16 v127, v65, v199, 0
    v_dot2_f32_bf16 v130, v99, v199, 0
    v_dot2_f32_bf16 v131, v66, v199, 0
    v_dot2_f32_bf16 v118, v97, v198, v118
    v_dot2_f32_bf16 v119, v64, v198, v119
    v_dot2_f32_bf16 v122, v98, v198, v122
    v_dot2_f32_bf16 v123, v65, v198, v123
    v_dot2_f32_bf16 v126, v99, v198, v126
    v_dot2_f32_bf16 v127, v66, v198, v127
    v_dot2_f32_bf16 v130, v100, v198, v130
    v_dot2_f32_bf16 v131, v67, v198, v131
    v_lshlrev_b32 v120, 16, v80
    v_and_b32 v121, 0xffff0000, v80
    v_lshlrev_b32 v124, 16, v81
    v_and_b32 v125, 0xffff0000, v81
    v_lshlrev_b32 v128, 16, v82
    v_and_b32 v129, 0xffff0000, v82
    v_lshlrev_b32 v132, 16, v83
    v_and_b32 v133, 0xffff0000, v83
    v_mul_f32 v118, v118, v120
    v_mul_f32 v119, v119, v121
    v_mul_f32 v122, v122, v124
    v_mul_f32 v123, v123, v125
    v_mul_f32 v126, v126, v128
    v_mul_f32 v127, v127, v129
    v_mul_f32 v130, v130, v132
    v_mul_f32 v131, v131, v133
    v_cvt_pk_bf16_f32 v165, v119, v118
    v_cvt_pk_bf16_f32 v164, v123, v122
    v_cvt_pk_bf16_f32 v163, v127, v126
    v_cvt_pk_bf16_f32 v162, v131, v130
    buffer_store_dwordx4 v[162:165], v12, s[8:11], s4 offen offset:3072
    s_waitcnt vmcnt(8)
    ds_read_b64_tr_b16 v[16:17], v11 offset:16640
    ds_read_b64_tr_b16 v[18:19], v11 offset:16896
    ds_read_b64_tr_b16 v[20:21], v11 offset:17152
    ds_read_b64_tr_b16 v[22:23], v11 offset:17408
    ds_read_b64_tr_b16 v[24:25], v11 offset:17664
    ds_read_b64_tr_b16 v[26:27], v11 offset:17920
    ds_read_b64_tr_b16 v[28:29], v11 offset:18176
    ds_read_b64_tr_b16 v[30:31], v11 offset:18432
    ds_read_b64_tr_b16 v[32:33], v11 offset:18688
    ds_read_b64_tr_b16 v[34:35], v11 offset:25088
    ds_read_b64_tr_b16 v[36:37], v11 offset:25344
    ds_read_b64_tr_b16 v[38:39], v11 offset:25600
    ds_read_b64_tr_b16 v[40:41], v11 offset:25856
    ds_read_b64_tr_b16 v[42:43], v11 offset:26112
    ds_read_b64_tr_b16 v[44:45], v11 offset:26368
    ds_read_b64_tr_b16 v[46:47], v11 offset:26624
    ds_read_b64_tr_b16 v[48:49], v11 offset:26880
    ds_read_b64_tr_b16 v[50:51], v11 offset:16672
    ds_read_b64_tr_b16 v[52:53], v11 offset:16928
    ds_read_b64_tr_b16 v[54:55], v11 offset:17184
    ds_read_b64_tr_b16 v[56:57], v11 offset:17440
    ds_read_b64_tr_b16 v[58:59], v11 offset:17696
    ds_read_b64_tr_b16 v[60:61], v11 offset:17952
    ds_read_b64_tr_b16 v[62:63], v11 offset:18208
    ds_read_b64_tr_b16 v[64:65], v11 offset:18464
    ds_read_b64_tr_b16 v[66:67], v11 offset:18720
    ds_read_b64_tr_b16 v[68:69], v11 offset:25120
    ds_read_b64_tr_b16 v[70:71], v11 offset:25376
    ds_read_b64_tr_b16 v[72:73], v11 offset:25632
    ds_read_b64_tr_b16 v[74:75], v11 offset:25888
    ds_read_b64_tr_b16 v[76:77], v11 offset:26144
    ds_read_b64_tr_b16 v[78:79], v11 offset:26400
    ds_read_b64_tr_b16 v[80:81], v11 offset:26656
    ds_read_b64_tr_b16 v[82:83], v11 offset:26912
    s_waitcnt lgkmcnt(0)
    v_alignbit_b32 v84, v17, v16, 16
    v_alignbit_b32 v85, v18, v17, 16
    v_alignbit_b32 v86, v19, v18, 16
    v_alignbit_b32 v87, v20, v19, 16
    v_alignbit_b32 v88, v21, v20, 16
    v_alignbit_b32 v89, v22, v21, 16
    v_alignbit_b32 v90, v23, v22, 16
    v_alignbit_b32 v91, v24, v23, 16
    v_alignbit_b32 v92, v25, v24, 16
    v_alignbit_b32 v93, v26, v25, 16
    v_alignbit_b32 v94, v27, v26, 16
    v_alignbit_b32 v95, v28, v27, 16
    v_alignbit_b32 v96, v29, v28, 16
    v_alignbit_b32 v97, v30, v29, 16
    v_alignbit_b32 v98, v31, v30, 16
    v_alignbit_b32 v99, v32, v31, 16
    v_alignbit_b32 v100, v33, v32, 16
    v_dot2_f32_bf16 v102, v84, v197, 0
    v_dot2_f32_bf16 v103, v17, v197, 0
    v_dot2_f32_bf16 v106, v85, v197, 0
    v_dot2_f32_bf16 v107, v18, v197, 0
    v_dot2_f32_bf16 v110, v86, v197, 0
    v_dot2_f32_bf16 v111, v19, v197, 0
    v_dot2_f32_bf16 v114, v87, v197, 0
    v_dot2_f32_bf16 v115, v20, v197, 0
    v_dot2_f32_bf16 v102, v85, v196, v102
    v_dot2_f32_bf16 v103, v18, v196, v103
    v_dot2_f32_bf16 v106, v86, v196, v106
    v_dot2_f32_bf16 v107, v19, v196, v107
    v_dot2_f32_bf16 v110, v87, v196, v110
    v_dot2_f32_bf16 v111, v20, v196, v111
    v_dot2_f32_bf16 v114, v88, v196, v114
    v_dot2_f32_bf16 v115, v21, v196, v115
    v_lshlrev_b32 v104, 16, v34
    v_and_b32 v105, 0xffff0000, v34
    v_lshlrev_b32 v108, 16, v35
    v_and_b32 v109, 0xffff0000, v35
    v_lshlrev_b32 v112, 16, v36
    v_and_b32 v113, 0xffff0000, v36
    v_lshlrev_b32 v116, 16, v37
    v_and_b32 v117, 0xffff0000, v37
    v_mul_f32 v102, v102, v104
    v_mul_f32 v103, v103, v105
    v_mul_f32 v106, v106, v108
    v_mul_f32 v107, v107, v109
    v_mul_f32 v110, v110, v112
    v_mul_f32 v111, v111, v113
    v_mul_f32 v114, v114, v116
    v_mul_f32 v115, v115, v117
    v_cvt_pk_bf16_f32 v137, v103, v102
    v_cvt_pk_bf16_f32 v136, v107, v106
    v_cvt_pk_bf16_f32 v135, v111, v110
    v_cvt_pk_bf16_f32 v134, v115, v114
    s_add_u32 s4, s72, 192
    buffer_store_dwordx4 v[134:137], v12, s[8:11], s4 offen offset:0
    v_dot2_f32_bf16 v118, v88, v197, 0
    v_dot2_f32_bf16 v119, v21, v197, 0
    v_dot2_f32_bf16 v122, v89, v197, 0
    v_dot2_f32_bf16 v123, v22, v197, 0
    v_dot2_f32_bf16 v126, v90, v197, 0
    v_dot2_f32_bf16 v127, v23, v197, 0
    v_dot2_f32_bf16 v130, v91, v197, 0
    v_dot2_f32_bf16 v131, v24, v197, 0
    v_dot2_f32_bf16 v118, v89, v196, v118
    v_dot2_f32_bf16 v119, v22, v196, v119
    v_dot2_f32_bf16 v122, v90, v196, v122
    v_dot2_f32_bf16 v123, v23, v196, v123
    v_dot2_f32_bf16 v126, v91, v196, v126
    v_dot2_f32_bf16 v127, v24, v196, v127
    v_dot2_f32_bf16 v130, v92, v196, v130
    v_dot2_f32_bf16 v131, v25, v196, v131
    v_lshlrev_b32 v120, 16, v38
    v_and_b32 v121, 0xffff0000, v38
    v_lshlrev_b32 v124, 16, v39
    v_and_b32 v125, 0xffff0000, v39
    v_lshlrev_b32 v128, 16, v40
    v_and_b32 v129, 0xffff0000, v40
    v_lshlrev_b32 v132, 16, v41
    v_and_b32 v133, 0xffff0000, v41
    v_mul_f32 v118, v118, v120
    v_mul_f32 v119, v119, v121
    v_mul_f32 v122, v122, v124
    v_mul_f32 v123, v123, v125
    v_mul_f32 v126, v126, v128
    v_mul_f32 v127, v127, v129
    v_mul_f32 v130, v130, v132
    v_mul_f32 v131, v131, v133
    v_cvt_pk_bf16_f32 v141, v119, v118
    v_cvt_pk_bf16_f32 v140, v123, v122
    v_cvt_pk_bf16_f32 v139, v127, v126
    v_cvt_pk_bf16_f32 v138, v131, v130
    buffer_store_dwordx4 v[138:141], v12, s[8:11], s4 offen offset:1024
    v_dot2_f32_bf16 v102, v92, v197, 0
    v_dot2_f32_bf16 v103, v25, v197, 0
    v_dot2_f32_bf16 v106, v93, v197, 0
    v_dot2_f32_bf16 v107, v26, v197, 0
    v_dot2_f32_bf16 v110, v94, v197, 0
    v_dot2_f32_bf16 v111, v27, v197, 0
    v_dot2_f32_bf16 v114, v95, v197, 0
    v_dot2_f32_bf16 v115, v28, v197, 0
    v_dot2_f32_bf16 v102, v93, v196, v102
    v_dot2_f32_bf16 v103, v26, v196, v103
    v_dot2_f32_bf16 v106, v94, v196, v106
    v_dot2_f32_bf16 v107, v27, v196, v107
    v_dot2_f32_bf16 v110, v95, v196, v110
    v_dot2_f32_bf16 v111, v28, v196, v111
    v_dot2_f32_bf16 v114, v96, v196, v114
    v_dot2_f32_bf16 v115, v29, v196, v115
    v_lshlrev_b32 v104, 16, v42
    v_and_b32 v105, 0xffff0000, v42
    v_lshlrev_b32 v108, 16, v43
    v_and_b32 v109, 0xffff0000, v43
    v_lshlrev_b32 v112, 16, v44
    v_and_b32 v113, 0xffff0000, v44
    v_lshlrev_b32 v116, 16, v45
    v_and_b32 v117, 0xffff0000, v45
    v_mul_f32 v102, v102, v104
    v_mul_f32 v103, v103, v105
    v_mul_f32 v106, v106, v108
    v_mul_f32 v107, v107, v109
    v_mul_f32 v110, v110, v112
    v_mul_f32 v111, v111, v113
    v_mul_f32 v114, v114, v116
    v_mul_f32 v115, v115, v117
    v_cvt_pk_bf16_f32 v145, v103, v102
    v_cvt_pk_bf16_f32 v144, v107, v106
    v_cvt_pk_bf16_f32 v143, v111, v110
    v_cvt_pk_bf16_f32 v142, v115, v114
    buffer_store_dwordx4 v[142:145], v12, s[8:11], s4 offen offset:2048
    v_dot2_f32_bf16 v118, v96, v197, 0
    v_dot2_f32_bf16 v119, v29, v197, 0
    v_dot2_f32_bf16 v122, v97, v197, 0
    v_dot2_f32_bf16 v123, v30, v197, 0
    v_dot2_f32_bf16 v126, v98, v197, 0
    v_dot2_f32_bf16 v127, v31, v197, 0
    v_dot2_f32_bf16 v130, v99, v197, 0
    v_dot2_f32_bf16 v131, v32, v197, 0
    v_dot2_f32_bf16 v118, v97, v196, v118
    v_dot2_f32_bf16 v119, v30, v196, v119
    v_dot2_f32_bf16 v122, v98, v196, v122
    v_dot2_f32_bf16 v123, v31, v196, v123
    v_dot2_f32_bf16 v126, v99, v196, v126
    v_dot2_f32_bf16 v127, v32, v196, v127
    v_dot2_f32_bf16 v130, v100, v196, v130
    v_dot2_f32_bf16 v131, v33, v196, v131
    v_lshlrev_b32 v120, 16, v46
    v_and_b32 v121, 0xffff0000, v46
    v_lshlrev_b32 v124, 16, v47
    v_and_b32 v125, 0xffff0000, v47
    v_lshlrev_b32 v128, 16, v48
    v_and_b32 v129, 0xffff0000, v48
    v_lshlrev_b32 v132, 16, v49
    v_and_b32 v133, 0xffff0000, v49
    v_mul_f32 v118, v118, v120
    v_mul_f32 v119, v119, v121
    v_mul_f32 v122, v122, v124
    v_mul_f32 v123, v123, v125
    v_mul_f32 v126, v126, v128
    v_mul_f32 v127, v127, v129
    v_mul_f32 v130, v130, v132
    v_mul_f32 v131, v131, v133
    v_cvt_pk_bf16_f32 v149, v119, v118
    v_cvt_pk_bf16_f32 v148, v123, v122
    v_cvt_pk_bf16_f32 v147, v127, v126
    v_cvt_pk_bf16_f32 v146, v131, v130
    buffer_store_dwordx4 v[146:149], v12, s[8:11], s4 offen offset:3072
    v_alignbit_b32 v84, v51, v50, 16
    v_alignbit_b32 v85, v52, v51, 16
    v_alignbit_b32 v86, v53, v52, 16
    v_alignbit_b32 v87, v54, v53, 16
    v_alignbit_b32 v88, v55, v54, 16
    v_alignbit_b32 v89, v56, v55, 16
    v_alignbit_b32 v90, v57, v56, 16
    v_alignbit_b32 v91, v58, v57, 16
    v_alignbit_b32 v92, v59, v58, 16
    v_alignbit_b32 v93, v60, v59, 16
    v_alignbit_b32 v94, v61, v60, 16
    v_alignbit_b32 v95, v62, v61, 16
    v_alignbit_b32 v96, v63, v62, 16
    v_alignbit_b32 v97, v64, v63, 16
    v_alignbit_b32 v98, v65, v64, 16
    v_alignbit_b32 v99, v66, v65, 16
    v_alignbit_b32 v100, v67, v66, 16
    v_dot2_f32_bf16 v102, v84, v199, 0
    v_dot2_f32_bf16 v103, v51, v199, 0
    v_dot2_f32_bf16 v106, v85, v199, 0
    v_dot2_f32_bf16 v107, v52, v199, 0
    v_dot2_f32_bf16 v110, v86, v199, 0
    v_dot2_f32_bf16 v111, v53, v199, 0
    v_dot2_f32_bf16 v114, v87, v199, 0
    v_dot2_f32_bf16 v115, v54, v199, 0
    v_dot2_f32_bf16 v102, v85, v198, v102
    v_dot2_f32_bf16 v103, v52, v198, v103
    v_dot2_f32_bf16 v106, v86, v198, v106
    v_dot2_f32_bf16 v107, v53, v198, v107
    v_dot2_f32_bf16 v110, v87, v198, v110
    v_dot2_f32_bf16 v111, v54, v198, v111
    v_dot2_f32_bf16 v114, v88, v198, v114
    v_dot2_f32_bf16 v115, v55, v198, v115
    v_lshlrev_b32 v104, 16, v68
    v_and_b32 v105, 0xffff0000, v68
    v_lshlrev_b32 v108, 16, v69
    v_and_b32 v109, 0xffff0000, v69
    v_lshlrev_b32 v112, 16, v70
    v_and_b32 v113, 0xffff0000, v70
    v_lshlrev_b32 v116, 16, v71
    v_and_b32 v117, 0xffff0000, v71
    v_mul_f32 v102, v102, v104
    v_mul_f32 v103, v103, v105
    v_mul_f32 v106, v106, v108
    v_mul_f32 v107, v107, v109
    v_mul_f32 v110, v110, v112
    v_mul_f32 v111, v111, v113
    v_mul_f32 v114, v114, v116
    v_mul_f32 v115, v115, v117
    v_cvt_pk_bf16_f32 v153, v103, v102
    v_cvt_pk_bf16_f32 v152, v107, v106
    v_cvt_pk_bf16_f32 v151, v111, v110
    v_cvt_pk_bf16_f32 v150, v115, v114
    s_add_u32 s4, s72, 65728
    buffer_store_dwordx4 v[150:153], v12, s[8:11], s4 offen offset:0
    v_dot2_f32_bf16 v118, v88, v199, 0
    v_dot2_f32_bf16 v119, v55, v199, 0
    v_dot2_f32_bf16 v122, v89, v199, 0
    v_dot2_f32_bf16 v123, v56, v199, 0
    v_dot2_f32_bf16 v126, v90, v199, 0
    v_dot2_f32_bf16 v127, v57, v199, 0
    v_dot2_f32_bf16 v130, v91, v199, 0
    v_dot2_f32_bf16 v131, v58, v199, 0
    v_dot2_f32_bf16 v118, v89, v198, v118
    v_dot2_f32_bf16 v119, v56, v198, v119
    v_dot2_f32_bf16 v122, v90, v198, v122
    v_dot2_f32_bf16 v123, v57, v198, v123
    v_dot2_f32_bf16 v126, v91, v198, v126
    v_dot2_f32_bf16 v127, v58, v198, v127
    v_dot2_f32_bf16 v130, v92, v198, v130
    v_dot2_f32_bf16 v131, v59, v198, v131
    v_lshlrev_b32 v120, 16, v72
    v_and_b32 v121, 0xffff0000, v72
    v_lshlrev_b32 v124, 16, v73
    v_and_b32 v125, 0xffff0000, v73
    v_lshlrev_b32 v128, 16, v74
    v_and_b32 v129, 0xffff0000, v74
    v_lshlrev_b32 v132, 16, v75
    v_and_b32 v133, 0xffff0000, v75
    v_mul_f32 v118, v118, v120
    v_mul_f32 v119, v119, v121
    v_mul_f32 v122, v122, v124
    v_mul_f32 v123, v123, v125
    v_mul_f32 v126, v126, v128
    v_mul_f32 v127, v127, v129
    v_mul_f32 v130, v130, v132
    v_mul_f32 v131, v131, v133
    v_cvt_pk_bf16_f32 v157, v119, v118
    v_cvt_pk_bf16_f32 v156, v123, v122
    v_cvt_pk_bf16_f32 v155, v127, v126
    v_cvt_pk_bf16_f32 v154, v131, v130
    buffer_store_dwordx4 v[154:157], v12, s[8:11], s4 offen offset:1024
    v_dot2_f32_bf16 v102, v92, v199, 0
    v_dot2_f32_bf16 v103, v59, v199, 0
    v_dot2_f32_bf16 v106, v93, v199, 0
    v_dot2_f32_bf16 v107, v60, v199, 0
    v_dot2_f32_bf16 v110, v94, v199, 0
    v_dot2_f32_bf16 v111, v61, v199, 0
    v_dot2_f32_bf16 v114, v95, v199, 0
    v_dot2_f32_bf16 v115, v62, v199, 0
    v_dot2_f32_bf16 v102, v93, v198, v102
    v_dot2_f32_bf16 v103, v60, v198, v103
    v_dot2_f32_bf16 v106, v94, v198, v106
    v_dot2_f32_bf16 v107, v61, v198, v107
    v_dot2_f32_bf16 v110, v95, v198, v110
    v_dot2_f32_bf16 v111, v62, v198, v111
    v_dot2_f32_bf16 v114, v96, v198, v114
    v_dot2_f32_bf16 v115, v63, v198, v115
    v_lshlrev_b32 v104, 16, v76
    v_and_b32 v105, 0xffff0000, v76
    v_lshlrev_b32 v108, 16, v77
    v_and_b32 v109, 0xffff0000, v77
    v_lshlrev_b32 v112, 16, v78
    v_and_b32 v113, 0xffff0000, v78
    v_lshlrev_b32 v116, 16, v79
    v_and_b32 v117, 0xffff0000, v79
    v_mul_f32 v102, v102, v104
    v_mul_f32 v103, v103, v105
    v_mul_f32 v106, v106, v108
    v_mul_f32 v107, v107, v109
    v_mul_f32 v110, v110, v112
    v_mul_f32 v111, v111, v113
    v_mul_f32 v114, v114, v116
    v_mul_f32 v115, v115, v117
    v_cvt_pk_bf16_f32 v161, v103, v102
    v_cvt_pk_bf16_f32 v160, v107, v106
    v_cvt_pk_bf16_f32 v159, v111, v110
    v_cvt_pk_bf16_f32 v158, v115, v114
    buffer_store_dwordx4 v[158:161], v12, s[8:11], s4 offen offset:2048
    v_dot2_f32_bf16 v118, v96, v199, 0
    v_dot2_f32_bf16 v119, v63, v199, 0
    v_dot2_f32_bf16 v122, v97, v199, 0
    v_dot2_f32_bf16 v123, v64, v199, 0
    v_dot2_f32_bf16 v126, v98, v199, 0
    v_dot2_f32_bf16 v127, v65, v199, 0
    v_dot2_f32_bf16 v130, v99, v199, 0
    v_dot2_f32_bf16 v131, v66, v199, 0
    v_dot2_f32_bf16 v118, v97, v198, v118
    v_dot2_f32_bf16 v119, v64, v198, v119
    v_dot2_f32_bf16 v122, v98, v198, v122
    v_dot2_f32_bf16 v123, v65, v198, v123
    v_dot2_f32_bf16 v126, v99, v198, v126
    v_dot2_f32_bf16 v127, v66, v198, v127
    v_dot2_f32_bf16 v130, v100, v198, v130
    v_dot2_f32_bf16 v131, v67, v198, v131
    v_lshlrev_b32 v120, 16, v80
    v_and_b32 v121, 0xffff0000, v80
    v_lshlrev_b32 v124, 16, v81
    v_and_b32 v125, 0xffff0000, v81
    v_lshlrev_b32 v128, 16, v82
    v_and_b32 v129, 0xffff0000, v82
    v_lshlrev_b32 v132, 16, v83
    v_and_b32 v133, 0xffff0000, v83
    v_mul_f32 v118, v118, v120
    v_mul_f32 v119, v119, v121
    v_mul_f32 v122, v122, v124
    v_mul_f32 v123, v123, v125
    v_mul_f32 v126, v126, v128
    v_mul_f32 v127, v127, v129
    v_mul_f32 v130, v130, v132
    v_mul_f32 v131, v131, v133
    v_cvt_pk_bf16_f32 v165, v119, v118
    v_cvt_pk_bf16_f32 v164, v123, v122
    v_cvt_pk_bf16_f32 v163, v127, v126
    v_cvt_pk_bf16_f32 v162, v131, v130
    buffer_store_dwordx4 v[162:165], v12, s[8:11], s4 offen offset:3072
    s_waitcnt vmcnt(0)
    s_barrier
    s_load_dwordx4 s[52:55], s[0:1], 32
    s_lshl_b32 s3, s93, 5
    s_lshl_b32 s4, s24, 3
    s_add_u32 s3, s3, s4
    s_lshl_b32 s4, s3, 1
    s_waitcnt lgkmcnt(0)
    s_load_dwordx4 s[64:67], s[54:55], s4

    s_mov_b32 s28, s52
    s_and_b32 s29, s53, 0xffff
    s_mov_b32 s30, 0x400000
    s_mov_b32 s31, 0x00020000

    v_and_b32 v1, 63, v0
    v_and_b32 v2, 15, v1
    v_lshrrev_b32 v3, 4, v1

    s_lshl_b32 s32, s3, 12
    s_add_u32 s33, s32, 28672
    s_mul_i32 s34, s24, 38400
    s_add_u32 s35, s34, 33536
    s_add_u32 s38, s32, 117440512
    v_lshlrev_b32 v4, 4, v1
    v_add_u32 v5, s34, v4
    v_add_u32 v5, 64, v5
    v_sub_u32 v6, 7, v2
    v_and_b32 v6, 7, v6
    v_mul_u32_u24 v6, 4160, v6
    v_lshrrev_b32 v7, 3, v2
    v_sub_u32 v7, v7, v3
    v_add_u32 v7, 4, v7
    v_lshl_add_u32 v6, v7, 4, v6
    v_add_u32 v6, s34, v6
    v_mul_u32_u24 v7, 80, v3
    v_add_u32 v7, v7, v2
    v_lshlrev_b32 v7, 4, v7
    v_add_u32 v7, s34, v7
    v_add_u32 v7, 33296, v7
    v_lshlrev_b32 v228, 7, v2
    v_lshl_add_u32 v228, v3, 4, v228
    v_subrev_u32 v229, 16, v4
    v_max_i32 v230, 0, v229
    v_sub_u32 v232, 7, v2
    v_and_b32 v232, 7, v232
    v_and_b32 v233, 1, v232
    v_lshlrev_b32 v233, 4, v233
    v_mov_b32 v234, 0xffff
    v_lshlrev_b32 v233, v233, v234
    v_lshrrev_b32 v232, 1, v232
    v_lshrrev_b32 v234, 3, v2
    v_sub_u32 v234, v3, v234
    v_lshl_add_u32 v232, v234, 1, v232
    v_and_b32 v234, 1, v234
    v_lshl_add_u32 v232, v234, 8, v232

    v_cmp_eq_u32 vcc, 0, v232
    s_nop 1
    v_cndmask_b32 v8, 0, v233, vcc
    v_cmp_eq_u32 vcc, 1, v232
    s_nop 1
    v_cndmask_b32 v9, 0, v233, vcc
    v_cmp_eq_u32 vcc, 2, v232
    s_nop 1
    v_cndmask_b32 v10, 0, v233, vcc
    v_cmp_eq_u32 vcc, 3, v232
    s_nop 1
    v_cndmask_b32 v11, 0, v233, vcc
    v_cmp_eq_u32 vcc, 4, v232
    s_nop 1
    v_cndmask_b32 v12, 0, v233, vcc
    v_cmp_eq_u32 vcc, 5, v232
    s_nop 1
    v_cndmask_b32 v13, 0, v233, vcc
    v_cmp_eq_u32 vcc, 6, v232
    s_nop 1
    v_cndmask_b32 v14, 0, v233, vcc
    v_cmp_eq_u32 vcc, 7, v232
    s_nop 1
    v_cndmask_b32 v15, 0, v233, vcc
    v_mov_b32 v208, 0
    v_mov_b32 v209, 0
    v_mov_b32 v210, 0
    v_mov_b32 v211, 0
    v_lshrrev_b32 v232, 2, v1
    v_and_b32 v232, 7, v232
    v_mul_u32_u24 v232, 4160, v232
    v_and_b32 v233, 3, v1
    v_lshl_add_u32 v232, v233, 4, v232
    v_add_u32 v232, s34, v232
    ds_write_b128 v232, v[208:211]
    v_subrev_u32 v233, 16, v7
    ds_write_b128 v233, v[208:211]

    s_add_u32 s39, s32, 125829120
    buffer_load_dwordx4 v[176:179], v230, s[28:31], s32 offen offset:0
    buffer_load_dwordx4 v[180:183], v4, s[28:31], s32 offen offset:0
    buffer_load_dwordx4 v[184:187], v4, s[28:31], s32 offen offset:1008
    buffer_load_dwordx4 v[188:191], v4, s[28:31], s32 offen offset:1024
    buffer_load_dwordx4 v[192:195], v4, s[28:31], s32 offen offset:2032
    buffer_load_dwordx4 v[196:199], v4, s[28:31], s32 offen offset:2048
    buffer_load_dwordx4 v[200:203], v4, s[28:31], s32 offen offset:3056
    buffer_load_dwordx4 v[204:207], v4, s[28:31], s32 offen offset:3072
    s_add_u32 m0, s35, 0
    s_nop 0
    buffer_load_dwordx4 v4, s[8:11], s39 offen offset:0 lds
    s_add_u32 m0, s35, 256
    s_nop 0
    buffer_load_dwordx4 v4, s[8:11], s39 offen offset:1024 lds
    s_add_u32 m0, s35, 512
    s_nop 0
    buffer_load_dwordx4 v4, s[8:11], s39 offen offset:2048 lds
    s_add_u32 m0, s35, 768
    s_nop 0
    buffer_load_dwordx4 v4, s[8:11], s39 offen offset:3072 lds
    s_waitcnt vmcnt(0) lgkmcnt(0)
    s_pack_ll_b32_b16 s40, s64, s64
    s_add_u32 s36, s32, 4096
    s_add_u32 s37, s32, 8192
    s_add_u32 s39, s36, 125829120
    s_mov_b64 exec, 1
    v_mov_b32 v176, 0
    v_mov_b32 v177, 0
    v_mov_b32 v178, 0
    v_mov_b32 v179, 0
    s_mov_b64 exec, -1
    ds_write_b128 v5, v[180:183] offset:0
    ds_write_b128 v5, v[178:181] offset:16640
    v_mov_b32 v208, v177
    v_mov_b32 v209, v178
    v_mov_b32 v210, v179
    v_mov_b32 v211, v180
    ds_write_b128 v5, v[208:211] offset:24960
    v_mov_b32 v212, v181
    v_mov_b32 v213, v182
    ds_write_b128 v5, v[210:213] offset:8320
    v_alignbit_b32 v214, v177, v176, 16
    v_alignbit_b32 v215, v178, v177, 16
    v_alignbit_b32 v216, v179, v178, 16
    v_alignbit_b32 v217, v180, v179, 16
    ds_write_b128 v5, v[214:217] offset:29120
    v_alignbit_b32 v218, v181, v180, 16
    v_alignbit_b32 v219, v182, v181, 16
    ds_write_b128 v5, v[216:219] offset:12480
    v_alignbit_b32 v220, v178, v177, 16
    v_alignbit_b32 v221, v179, v178, 16
    v_alignbit_b32 v222, v180, v179, 16
    v_alignbit_b32 v223, v181, v180, 16
    ds_write_b128 v5, v[220:223] offset:20800
    v_alignbit_b32 v224, v182, v181, 16
    v_alignbit_b32 v225, v183, v182, 16
    ds_write_b128 v5, v[222:225] offset:4160
    buffer_load_dwordx4 v[176:179], v230, s[28:31], s36 offen offset:0
    buffer_load_dwordx4 v[180:183], v4, s[28:31], s36 offen offset:0
    ds_write_b128 v5, v[188:191] offset:1024
    ds_write_b128 v5, v[186:189] offset:17664
    v_mov_b32 v208, v185
    v_mov_b32 v209, v186
    v_mov_b32 v210, v187
    v_mov_b32 v211, v188
    ds_write_b128 v5, v[208:211] offset:25984
    v_mov_b32 v212, v189
    v_mov_b32 v213, v190
    ds_write_b128 v5, v[210:213] offset:9344
    v_alignbit_b32 v214, v185, v184, 16
    v_alignbit_b32 v215, v186, v185, 16
    v_alignbit_b32 v216, v187, v186, 16
    v_alignbit_b32 v217, v188, v187, 16
    ds_write_b128 v5, v[214:217] offset:30144
    v_alignbit_b32 v218, v189, v188, 16
    v_alignbit_b32 v219, v190, v189, 16
    ds_write_b128 v5, v[216:219] offset:13504
    v_alignbit_b32 v220, v186, v185, 16
    v_alignbit_b32 v221, v187, v186, 16
    v_alignbit_b32 v222, v188, v187, 16
    v_alignbit_b32 v223, v189, v188, 16
    ds_write_b128 v5, v[220:223] offset:21824
    v_alignbit_b32 v224, v190, v189, 16
    v_alignbit_b32 v225, v191, v190, 16
    ds_write_b128 v5, v[222:225] offset:5184
    buffer_load_dwordx4 v[184:187], v4, s[28:31], s36 offen offset:1008
    buffer_load_dwordx4 v[188:191], v4, s[28:31], s36 offen offset:1024
    v_and_b32 v236, s40, v8
    v_and_b32 v237, s40, v9
    v_and_b32 v238, s40, v10
    v_and_b32 v239, s40, v11
    v_and_b32 v240, s40, v12
    v_and_b32 v241, s40, v13
    v_and_b32 v242, s40, v14
    v_and_b32 v243, s40, v15
    ds_read_b128 a[60:63], v7 offset:240
    ds_read_b128 a[124:127], v7 offset:496
    ds_read_b128 a[188:191], v7 offset:752
    ds_read_b128 a[252:255], v7 offset:1008
    ds_read_b128 v[168:171], v6 offset:0
    ds_read_b128 v[172:175], v6 offset:32
    s_waitcnt vmcnt(0) lgkmcnt(0)
    s_mov_b32 s42, 0
.cvl_473:
    s_waitcnt lgkmcnt(5)
    v_mfma_f32_16x16x32_bf16 v[16:19], v[236:239], a[60:63], 0
    v_mfma_f32_16x16x32_bf16 v[32:35], v[240:243], a[60:63], 0
    s_waitcnt lgkmcnt(4)
    v_mfma_f32_16x16x32_bf16 v[20:23], v[236:239], a[124:127], 0
    v_mfma_f32_16x16x32_bf16 v[36:39], v[240:243], a[124:127], 0
    s_waitcnt lgkmcnt(3)
    v_mfma_f32_16x16x32_bf16 v[24:27], v[236:239], a[188:191], 0
    v_mfma_f32_16x16x32_bf16 v[40:43], v[240:243], a[188:191], 0
    ds_read_b128 a[56:59], v7 offset:224
    s_waitcnt lgkmcnt(3)
    v_mfma_f32_16x16x32_bf16 v[28:31], v[236:239], a[252:255], 0
    ds_read_b128 v[112:115], v6 offset:64
    v_mfma_f32_16x16x32_bf16 v[44:47], v[240:243], a[252:255], 0
    ds_read_b128 v[116:119], v6 offset:96
    s_waitcnt lgkmcnt(4)
    v_mfma_f32_16x16x32_bf16 v[16:19], v[168:171], a[60:63], v[16:19]
    ds_read_b128 a[120:123], v7 offset:480
    s_waitcnt lgkmcnt(4)
    v_mfma_f32_16x16x32_bf16 v[32:35], v[172:175], a[60:63], v[32:35]
    s_waitcnt vmcnt(18)
    v_mfma_f32_16x16x32_bf16 v[20:23], v[168:171], a[124:127], v[20:23]
    ds_read_b128 a[184:187], v7 offset:736
    v_mfma_f32_16x16x32_bf16 v[36:39], v[172:175], a[124:127], v[36:39]
    ds_write_b128 v5, v[196:199] offset:2048
    v_mfma_f32_16x16x32_bf16 v[24:27], v[168:171], a[188:191], v[24:27]
    ds_read_b128 a[248:251], v7 offset:992
    v_mfma_f32_16x16x32_bf16 v[40:43], v[172:175], a[188:191], v[40:43]
    ds_read_b128 a[52:55], v7 offset:208
    v_mfma_f32_16x16x32_bf16 v[28:31], v[168:171], a[252:255], v[28:31]
    ds_read_b128 v[120:123], v6 offset:128
    v_mfma_f32_16x16x32_bf16 v[44:47], v[172:175], a[252:255], v[44:47]
    ds_read_b128 v[124:127], v6 offset:160
    s_waitcnt lgkmcnt(8)
    v_mfma_f32_16x16x32_bf16 v[16:19], v[112:115], a[56:59], v[16:19]
    ds_read_b128 a[116:119], v7 offset:464
    s_waitcnt lgkmcnt(8)
    v_mfma_f32_16x16x32_bf16 v[32:35], v[116:119], a[56:59], v[32:35]
    ds_write_b128 v5, v[194:197] offset:18688
    s_waitcnt lgkmcnt(8)
    v_mfma_f32_16x16x32_bf16 v[20:23], v[112:115], a[120:123], v[20:23]
    ds_read_b128 a[180:183], v7 offset:720
    v_mfma_f32_16x16x32_bf16 v[36:39], v[116:119], a[120:123], v[36:39]
    v_mov_b32 v208, v193
    v_mov_b32 v209, v194
    s_waitcnt lgkmcnt(8)
    v_mfma_f32_16x16x32_bf16 v[24:27], v[112:115], a[184:187], v[24:27]
    ds_read_b128 a[244:247], v7 offset:976
    v_mfma_f32_16x16x32_bf16 v[40:43], v[116:119], a[184:187], v[40:43]
    ds_read_b128 a[48:51], v7 offset:192
    s_waitcnt lgkmcnt(8)
    v_mfma_f32_16x16x32_bf16 v[28:31], v[112:115], a[248:251], v[28:31]
    ds_read_b128 v[128:131], v6 offset:192
    v_mfma_f32_16x16x32_bf16 v[44:47], v[116:119], a[248:251], v[44:47]
    ds_read_b128 v[132:135], v6 offset:224
    s_waitcnt lgkmcnt(8)
    v_mfma_f32_16x16x32_bf16 v[16:19], v[120:123], a[52:55], v[16:19]
    ds_read_b128 a[112:115], v7 offset:448
    s_waitcnt lgkmcnt(8)
    v_mfma_f32_16x16x32_bf16 v[32:35], v[124:127], a[52:55], v[32:35]
    v_mov_b32 v210, v195
    v_mov_b32 v211, v196
    s_waitcnt lgkmcnt(7)
    v_mfma_f32_16x16x32_bf16 v[20:23], v[120:123], a[116:119], v[20:23]
    ds_read_b128 a[176:179], v7 offset:704
    v_mfma_f32_16x16x32_bf16 v[36:39], v[124:127], a[116:119], v[36:39]
    ds_write_b128 v5, v[208:211] offset:27008
    s_waitcnt lgkmcnt(7)
    v_mfma_f32_16x16x32_bf16 v[24:27], v[120:123], a[180:183], v[24:27]
    ds_read_b128 a[240:243], v7 offset:960
    v_mfma_f32_16x16x32_bf16 v[40:43], v[124:127], a[180:183], v[40:43]
    ds_read_b128 a[44:47], v7 offset:176
    s_waitcnt lgkmcnt(8)
    v_mfma_f32_16x16x32_bf16 v[28:31], v[120:123], a[244:247], v[28:31]
    ds_read_b128 v[136:139], v6 offset:256
    v_mfma_f32_16x16x32_bf16 v[44:47], v[124:127], a[244:247], v[44:47]
    ds_read_b128 v[140:143], v6 offset:288
    s_waitcnt lgkmcnt(8)
    v_mfma_f32_16x16x32_bf16 v[16:19], v[128:131], a[48:51], v[16:19]
    ds_read_b128 a[108:111], v7 offset:432
    s_waitcnt lgkmcnt(8)
    v_mfma_f32_16x16x32_bf16 v[32:35], v[132:135], a[48:51], v[32:35]
    v_mov_b32 v212, v197
    v_mov_b32 v213, v198
    s_waitcnt lgkmcnt(7)
    v_mfma_f32_16x16x32_bf16 v[20:23], v[128:131], a[112:115], v[20:23]
    ds_read_b128 a[172:175], v7 offset:688
    v_mfma_f32_16x16x32_bf16 v[36:39], v[132:135], a[112:115], v[36:39]
    ds_write_b128 v5, v[210:213] offset:10368
    s_waitcnt lgkmcnt(8)
    v_mfma_f32_16x16x32_bf16 v[24:27], v[128:131], a[176:179], v[24:27]
    ds_read_b128 a[236:239], v7 offset:944
    v_mfma_f32_16x16x32_bf16 v[40:43], v[132:135], a[176:179], v[40:43]
    ds_read_b128 a[40:43], v7 offset:160
    s_waitcnt lgkmcnt(8)
    v_mfma_f32_16x16x32_bf16 v[28:31], v[128:131], a[240:243], v[28:31]
    ds_read_b128 v[144:147], v6 offset:320
    v_mfma_f32_16x16x32_bf16 v[44:47], v[132:135], a[240:243], v[44:47]
    ds_read_b128 v[148:151], v6 offset:352
    s_waitcnt lgkmcnt(8)
    v_mfma_f32_16x16x32_bf16 v[16:19], v[136:139], a[44:47], v[16:19]
    ds_read_b128 a[104:107], v7 offset:416
    s_waitcnt lgkmcnt(8)
    v_mfma_f32_16x16x32_bf16 v[32:35], v[140:143], a[44:47], v[32:35]
    v_alignbit_b32 v214, v193, v192, 16
    v_alignbit_b32 v215, v194, v193, 16
    s_waitcnt lgkmcnt(7)
    v_mfma_f32_16x16x32_bf16 v[20:23], v[136:139], a[108:111], v[20:23]
    ds_read_b128 a[168:171], v7 offset:672
    v_mfma_f32_16x16x32_bf16 v[36:39], v[140:143], a[108:111], v[36:39]
    v_alignbit_b32 v216, v195, v194, 16
    v_alignbit_b32 v217, v196, v195, 16
    s_waitcnt lgkmcnt(7)
    v_mfma_f32_16x16x32_bf16 v[24:27], v[136:139], a[172:175], v[24:27]
    ds_read_b128 a[232:235], v7 offset:928
    v_mfma_f32_16x16x32_bf16 v[40:43], v[140:143], a[172:175], v[40:43]
    ds_read_b128 a[36:39], v7 offset:144
    s_waitcnt lgkmcnt(7)
    v_mfma_f32_16x16x32_bf16 v[28:31], v[136:139], a[236:239], v[28:31]
    ds_read_b128 v[152:155], v6 offset:384
    v_mfma_f32_16x16x32_bf16 v[44:47], v[140:143], a[236:239], v[44:47]
    ds_read_b128 v[156:159], v6 offset:416
    s_waitcnt lgkmcnt(7)
    v_mfma_f32_16x16x32_bf16 v[16:19], v[144:147], a[40:43], v[16:19]
    ds_read_b128 a[100:103], v7 offset:400
    s_waitcnt lgkmcnt(7)
    v_mfma_f32_16x16x32_bf16 v[32:35], v[148:151], a[40:43], v[32:35]
    ds_write_b128 v5, v[214:217] offset:31168
    s_waitcnt lgkmcnt(7)
    v_mfma_f32_16x16x32_bf16 v[20:23], v[144:147], a[104:107], v[20:23]
    ds_read_b128 a[164:167], v7 offset:656
    v_mfma_f32_16x16x32_bf16 v[36:39], v[148:151], a[104:107], v[36:39]
    v_alignbit_b32 v218, v197, v196, 16
    v_alignbit_b32 v219, v198, v197, 16
    s_waitcnt lgkmcnt(7)
    v_mfma_f32_16x16x32_bf16 v[24:27], v[144:147], a[168:171], v[24:27]
    ds_read_b128 a[228:231], v7 offset:912
    v_mfma_f32_16x16x32_bf16 v[40:43], v[148:151], a[168:171], v[40:43]
    ds_read_b128 a[32:35], v7 offset:128
    s_waitcnt lgkmcnt(8)
    v_mfma_f32_16x16x32_bf16 v[28:31], v[144:147], a[232:235], v[28:31]
    ds_read_b128 v[160:163], v6 offset:448
    v_mfma_f32_16x16x32_bf16 v[44:47], v[148:151], a[232:235], v[44:47]
    ds_read_b128 v[164:167], v6 offset:480
    s_waitcnt lgkmcnt(8)
    v_mfma_f32_16x16x32_bf16 v[16:19], v[152:155], a[36:39], v[16:19]
    ds_read_b128 a[96:99], v7 offset:384
    s_waitcnt lgkmcnt(8)
    v_mfma_f32_16x16x32_bf16 v[32:35], v[156:159], a[36:39], v[32:35]
    ds_write_b128 v5, v[216:219] offset:14528
    s_waitcnt lgkmcnt(8)
    v_mfma_f32_16x16x32_bf16 v[20:23], v[152:155], a[100:103], v[20:23]
    ds_read_b128 a[160:163], v7 offset:640
    v_mfma_f32_16x16x32_bf16 v[36:39], v[156:159], a[100:103], v[36:39]
    v_alignbit_b32 v220, v194, v193, 16
    v_alignbit_b32 v221, v195, v194, 16
    s_waitcnt lgkmcnt(7)
    v_mfma_f32_16x16x32_bf16 v[24:27], v[152:155], a[164:167], v[24:27]
    ds_read_b128 a[224:227], v7 offset:896
    v_mfma_f32_16x16x32_bf16 v[40:43], v[156:159], a[164:167], v[40:43]
    ds_read_b128 a[28:31], v7 offset:112
    s_waitcnt lgkmcnt(8)
    v_mfma_f32_16x16x32_bf16 v[28:31], v[152:155], a[228:231], v[28:31]
    ds_read_b128 v[168:171], v6 offset:512
    v_mfma_f32_16x16x32_bf16 v[44:47], v[156:159], a[228:231], v[44:47]
    ds_read_b128 v[172:175], v6 offset:544
    s_waitcnt lgkmcnt(8)
    v_mfma_f32_16x16x32_bf16 v[16:19], v[160:163], a[32:35], v[16:19]
    ds_read_b128 a[92:95], v7 offset:368
    s_waitcnt lgkmcnt(8)
    v_mfma_f32_16x16x32_bf16 v[32:35], v[164:167], a[32:35], v[32:35]
    v_alignbit_b32 v222, v196, v195, 16
    v_alignbit_b32 v223, v197, v196, 16
    s_waitcnt lgkmcnt(7)
    v_mfma_f32_16x16x32_bf16 v[20:23], v[160:163], a[96:99], v[20:23]
    ds_read_b128 a[156:159], v7 offset:624
    v_mfma_f32_16x16x32_bf16 v[36:39], v[164:167], a[96:99], v[36:39]
    ds_write_b128 v5, v[220:223] offset:22848
    s_waitcnt lgkmcnt(7)
    v_mfma_f32_16x16x32_bf16 v[24:27], v[160:163], a[160:163], v[24:27]
    ds_read_b128 a[220:223], v7 offset:880
    v_mfma_f32_16x16x32_bf16 v[40:43], v[164:167], a[160:163], v[40:43]
    ds_read_b128 a[24:27], v7 offset:96
    s_waitcnt lgkmcnt(8)
    v_mfma_f32_16x16x32_bf16 v[28:31], v[160:163], a[224:227], v[28:31]
    ds_read_b128 v[112:115], v6 offset:576
    v_mfma_f32_16x16x32_bf16 v[44:47], v[164:167], a[224:227], v[44:47]
    ds_read_b128 v[116:119], v6 offset:608
    s_waitcnt lgkmcnt(8)
    v_mfma_f32_16x16x32_bf16 v[16:19], v[168:171], a[28:31], v[16:19]
    ds_read_b128 a[88:91], v7 offset:352
    s_waitcnt lgkmcnt(8)
    v_mfma_f32_16x16x32_bf16 v[32:35], v[172:175], a[28:31], v[32:35]
    v_alignbit_b32 v224, v198, v197, 16
    v_alignbit_b32 v225, v199, v198, 16
    s_waitcnt lgkmcnt(7)
    v_mfma_f32_16x16x32_bf16 v[20:23], v[168:171], a[92:95], v[20:23]
    ds_read_b128 a[152:155], v7 offset:608
    v_mfma_f32_16x16x32_bf16 v[36:39], v[172:175], a[92:95], v[36:39]
    ds_write_b128 v5, v[222:225] offset:6208
    s_waitcnt lgkmcnt(8)
    v_mfma_f32_16x16x32_bf16 v[24:27], v[168:171], a[156:159], v[24:27]
    ds_read_b128 a[216:219], v7 offset:864
    v_mfma_f32_16x16x32_bf16 v[40:43], v[172:175], a[156:159], v[40:43]
    ds_read_b128 a[20:23], v7 offset:80
    s_waitcnt lgkmcnt(8)
    v_mfma_f32_16x16x32_bf16 v[28:31], v[168:171], a[220:223], v[28:31]
    ds_read_b128 v[120:123], v6 offset:640
    v_mfma_f32_16x16x32_bf16 v[44:47], v[172:175], a[220:223], v[44:47]
    ds_read_b128 v[124:127], v6 offset:672
    s_waitcnt lgkmcnt(8)
    v_mfma_f32_16x16x32_bf16 v[16:19], v[112:115], a[24:27], v[16:19]
    ds_read_b128 a[84:87], v7 offset:336
    s_waitcnt lgkmcnt(8)
    v_mfma_f32_16x16x32_bf16 v[32:35], v[116:119], a[24:27], v[32:35]
    buffer_load_dwordx4 v[192:195], v4, s[28:31], s36 offen offset:2032
    s_waitcnt lgkmcnt(7)
    v_mfma_f32_16x16x32_bf16 v[20:23], v[112:115], a[88:91], v[20:23]
    ds_read_b128 a[148:151], v7 offset:592
    v_mfma_f32_16x16x32_bf16 v[36:39], v[116:119], a[88:91], v[36:39]
    buffer_load_dwordx4 v[196:199], v4, s[28:31], s36 offen offset:2048
    s_waitcnt lgkmcnt(7)
    v_mfma_f32_16x16x32_bf16 v[24:27], v[112:115], a[152:155], v[24:27]
    ds_read_b128 a[212:215], v7 offset:848
    v_mfma_f32_16x16x32_bf16 v[40:43], v[116:119], a[152:155], v[40:43]
    ds_read_b128 a[16:19], v7 offset:64
    s_waitcnt lgkmcnt(7)
    v_mfma_f32_16x16x32_bf16 v[28:31], v[112:115], a[216:219], v[28:31]
    ds_read_b128 v[128:131], v6 offset:704
    v_mfma_f32_16x16x32_bf16 v[44:47], v[116:119], a[216:219], v[44:47]
    ds_read_b128 v[132:135], v6 offset:736
    s_waitcnt lgkmcnt(7)
    v_mfma_f32_16x16x32_bf16 v[16:19], v[120:123], a[20:23], v[16:19]
    ds_read_b128 a[80:83], v7 offset:320
    s_waitcnt lgkmcnt(7)
    v_mfma_f32_16x16x32_bf16 v[32:35], v[124:127], a[20:23], v[32:35]
    s_waitcnt vmcnt(18)
    s_waitcnt lgkmcnt(6)
    v_mfma_f32_16x16x32_bf16 v[20:23], v[120:123], a[84:87], v[20:23]
    ds_read_b128 a[144:147], v7 offset:576
    v_mfma_f32_16x16x32_bf16 v[36:39], v[124:127], a[84:87], v[36:39]
    ds_write_b128 v5, v[204:207] offset:3072
    s_waitcnt lgkmcnt(7)
    v_mfma_f32_16x16x32_bf16 v[24:27], v[120:123], a[148:151], v[24:27]
    ds_read_b128 a[208:211], v7 offset:832
    v_mfma_f32_16x16x32_bf16 v[40:43], v[124:127], a[148:151], v[40:43]
    ds_read_b128 a[12:15], v7 offset:48
    s_waitcnt lgkmcnt(8)
    v_mfma_f32_16x16x32_bf16 v[28:31], v[120:123], a[212:215], v[28:31]
    ds_read_b128 v[136:139], v6 offset:768
    v_mfma_f32_16x16x32_bf16 v[44:47], v[124:127], a[212:215], v[44:47]
    ds_read_b128 v[140:143], v6 offset:800
    s_waitcnt lgkmcnt(8)
    v_mfma_f32_16x16x32_bf16 v[16:19], v[128:131], a[16:19], v[16:19]
    ds_read_b128 a[76:79], v7 offset:304
    s_waitcnt lgkmcnt(8)
    v_mfma_f32_16x16x32_bf16 v[32:35], v[132:135], a[16:19], v[32:35]
    ds_write_b128 v5, v[202:205] offset:19712
    s_waitcnt lgkmcnt(8)
    v_mfma_f32_16x16x32_bf16 v[20:23], v[128:131], a[80:83], v[20:23]
    ds_read_b128 a[140:143], v7 offset:560
    v_mfma_f32_16x16x32_bf16 v[36:39], v[132:135], a[80:83], v[36:39]
    v_mov_b32 v208, v201
    v_mov_b32 v209, v202
    s_waitcnt lgkmcnt(8)
    v_mfma_f32_16x16x32_bf16 v[24:27], v[128:131], a[144:147], v[24:27]
    ds_read_b128 a[204:207], v7 offset:816
    v_mfma_f32_16x16x32_bf16 v[40:43], v[132:135], a[144:147], v[40:43]
    ds_read_b128 a[8:11], v7 offset:32
    s_waitcnt lgkmcnt(8)
    v_mfma_f32_16x16x32_bf16 v[28:31], v[128:131], a[208:211], v[28:31]
    ds_read_b128 v[144:147], v6 offset:832
    v_mfma_f32_16x16x32_bf16 v[44:47], v[132:135], a[208:211], v[44:47]
    ds_read_b128 v[148:151], v6 offset:864
    s_waitcnt lgkmcnt(8)
    v_mfma_f32_16x16x32_bf16 v[16:19], v[136:139], a[12:15], v[16:19]
    ds_read_b128 a[72:75], v7 offset:288
    s_waitcnt lgkmcnt(8)
    v_mfma_f32_16x16x32_bf16 v[32:35], v[140:143], a[12:15], v[32:35]
    v_mov_b32 v210, v203
    v_mov_b32 v211, v204
    s_waitcnt lgkmcnt(7)
    v_mfma_f32_16x16x32_bf16 v[20:23], v[136:139], a[76:79], v[20:23]
    ds_read_b128 a[136:139], v7 offset:544
    v_mfma_f32_16x16x32_bf16 v[36:39], v[140:143], a[76:79], v[36:39]
    ds_write_b128 v5, v[208:211] offset:28032
    s_waitcnt lgkmcnt(7)
    v_mfma_f32_16x16x32_bf16 v[24:27], v[136:139], a[140:143], v[24:27]
    ds_read_b128 a[200:203], v7 offset:800
    v_mfma_f32_16x16x32_bf16 v[40:43], v[140:143], a[140:143], v[40:43]
    ds_read_b128 a[4:7], v7 offset:16
    s_waitcnt lgkmcnt(8)
    v_mfma_f32_16x16x32_bf16 v[28:31], v[136:139], a[204:207], v[28:31]
    ds_read_b128 v[152:155], v6 offset:896
    v_mfma_f32_16x16x32_bf16 v[44:47], v[140:143], a[204:207], v[44:47]
    ds_read_b128 v[156:159], v6 offset:928
    s_waitcnt lgkmcnt(8)
    v_mfma_f32_16x16x32_bf16 v[16:19], v[144:147], a[8:11], v[16:19]
    ds_read_b128 a[68:71], v7 offset:272
    s_waitcnt lgkmcnt(8)
    v_mfma_f32_16x16x32_bf16 v[32:35], v[148:151], a[8:11], v[32:35]
    v_mov_b32 v212, v205
    v_mov_b32 v213, v206
    s_waitcnt lgkmcnt(7)
    v_mfma_f32_16x16x32_bf16 v[20:23], v[144:147], a[72:75], v[20:23]
    ds_read_b128 a[132:135], v7 offset:528
    v_mfma_f32_16x16x32_bf16 v[36:39], v[148:151], a[72:75], v[36:39]
    ds_write_b128 v5, v[210:213] offset:11392
    s_waitcnt lgkmcnt(8)
    v_mfma_f32_16x16x32_bf16 v[24:27], v[144:147], a[136:139], v[24:27]
    ds_read_b128 a[196:199], v7 offset:784
    v_mfma_f32_16x16x32_bf16 v[40:43], v[148:151], a[136:139], v[40:43]
    ds_read_b128 a[0:3], v7 offset:0
    s_waitcnt lgkmcnt(8)
    v_mfma_f32_16x16x32_bf16 v[28:31], v[144:147], a[200:203], v[28:31]
    ds_read_b128 v[160:163], v6 offset:960
    v_mfma_f32_16x16x32_bf16 v[44:47], v[148:151], a[200:203], v[44:47]
    ds_read_b128 v[164:167], v6 offset:992
    s_waitcnt lgkmcnt(8)
    v_mfma_f32_16x16x32_bf16 v[16:19], v[152:155], a[4:7], v[16:19]
    ds_read_b128 a[64:67], v7 offset:256
    s_waitcnt lgkmcnt(8)
    v_mfma_f32_16x16x32_bf16 v[32:35], v[156:159], a[4:7], v[32:35]
    v_alignbit_b32 v214, v201, v200, 16
    v_alignbit_b32 v215, v202, v201, 16
    s_waitcnt lgkmcnt(7)
    v_mfma_f32_16x16x32_bf16 v[20:23], v[152:155], a[68:71], v[20:23]
    ds_read_b128 a[128:131], v7 offset:512
    v_mfma_f32_16x16x32_bf16 v[36:39], v[156:159], a[68:71], v[36:39]
    v_alignbit_b32 v216, v203, v202, 16
    v_alignbit_b32 v217, v204, v203, 16
    s_waitcnt lgkmcnt(7)
    v_mfma_f32_16x16x32_bf16 v[24:27], v[152:155], a[132:135], v[24:27]
    ds_read_b128 a[192:195], v7 offset:768
    v_mfma_f32_16x16x32_bf16 v[40:43], v[156:159], a[132:135], v[40:43]
    ds_write_b128 v5, v[214:217] offset:32192
    s_waitcnt lgkmcnt(7)
    v_mfma_f32_16x16x32_bf16 v[28:31], v[152:155], a[196:199], v[28:31]
    ds_read_b128 v[168:171], v6 offset:1024
    v_mfma_f32_16x16x32_bf16 v[44:47], v[156:159], a[196:199], v[44:47]
    ds_read_b128 v[172:175], v6 offset:1056
    s_waitcnt lgkmcnt(7)
    v_mfma_f32_16x16x32_bf16 v[16:19], v[160:163], a[0:3], v[16:19]
    v_alignbit_b32 v218, v205, v204, 16
    v_alignbit_b32 v219, v206, v205, 16
    s_waitcnt lgkmcnt(6)
    v_mfma_f32_16x16x32_bf16 v[32:35], v[164:167], a[0:3], v[32:35]
    ds_write_b128 v5, v[216:219] offset:15552
    s_waitcnt lgkmcnt(6)
    v_mfma_f32_16x16x32_bf16 v[20:23], v[160:163], a[64:67], v[20:23]
    v_alignbit_b32 v220, v202, v201, 16
    v_alignbit_b32 v221, v203, v202, 16
    v_mfma_f32_16x16x32_bf16 v[36:39], v[164:167], a[64:67], v[36:39]
    v_alignbit_b32 v222, v204, v203, 16
    v_alignbit_b32 v223, v205, v204, 16
    s_waitcnt lgkmcnt(5)
    v_mfma_f32_16x16x32_bf16 v[24:27], v[160:163], a[128:131], v[24:27]
    ds_read_b128 v[112:115], v6 offset:1088
    v_mfma_f32_16x16x32_bf16 v[40:43], v[164:167], a[128:131], v[40:43]
    ds_read_b128 v[116:119], v6 offset:1120
    s_waitcnt lgkmcnt(6)
    v_mfma_f32_16x16x32_bf16 v[28:31], v[160:163], a[192:195], v[28:31]
    ds_write_b128 v5, v[220:223] offset:23872
    v_mfma_f32_16x16x32_bf16 v[44:47], v[164:167], a[192:195], v[44:47]
    v_alignbit_b32 v224, v206, v205, 16
    v_alignbit_b32 v225, v207, v206, 16
    s_waitcnt lgkmcnt(5)
    v_mfma_f32_16x16x32_bf16 v[20:23], v[168:171], a[60:63], v[20:23]
    ds_write_b128 v5, v[222:225] offset:7232
    s_waitcnt lgkmcnt(5)
    v_mfma_f32_16x16x32_bf16 v[36:39], v[172:175], a[60:63], v[36:39]
    buffer_load_dwordx4 v[200:203], v4, s[28:31], s36 offen offset:3056
    v_mfma_f32_16x16x32_bf16 v[24:27], v[168:171], a[124:127], v[24:27]
    ds_read_b128 v[120:123], v6 offset:1152
    v_mfma_f32_16x16x32_bf16 v[40:43], v[172:175], a[124:127], v[40:43]
    ds_read_b128 v[124:127], v6 offset:1184
    v_mfma_f32_16x16x32_bf16 v[28:31], v[168:171], a[188:191], v[28:31]
    buffer_load_dwordx4 v[204:207], v4, s[28:31], s36 offen offset:3072
    v_mfma_f32_16x16x32_bf16 v[44:47], v[172:175], a[188:191], v[44:47]
    s_waitcnt vmcnt(18)
    s_mov_b64 exec, 1
    v_mov_b32 v176, 0
    v_mov_b32 v177, 0
    v_mov_b32 v178, 0
    v_mov_b32 v179, 0
    s_mov_b64 exec, -1
    s_waitcnt lgkmcnt(5)
    v_mfma_f32_16x16x32_bf16 v[20:23], v[112:115], a[56:59], v[20:23]
    ds_write_b128 v5, v[180:183] offset:0
    s_waitcnt lgkmcnt(5)
    v_mfma_f32_16x16x32_bf16 v[36:39], v[116:119], a[56:59], v[36:39]
    ds_write_b128 v5, v[178:181] offset:16640
    v_mfma_f32_16x16x32_bf16 v[24:27], v[112:115], a[120:123], v[24:27]
    ds_read_b128 v[128:131], v6 offset:1216
    v_mfma_f32_16x16x32_bf16 v[40:43], v[116:119], a[120:123], v[40:43]
    ds_read_b128 v[132:135], v6 offset:1248
    v_mfma_f32_16x16x32_bf16 v[28:31], v[112:115], a[184:187], v[28:31]
    v_mov_b32 v208, v177
    v_mov_b32 v209, v178
    v_mfma_f32_16x16x32_bf16 v[44:47], v[116:119], a[184:187], v[44:47]
    v_mov_b32 v210, v179
    v_mov_b32 v211, v180
    s_waitcnt lgkmcnt(5)
    v_mfma_f32_16x16x32_bf16 v[20:23], v[120:123], a[52:55], v[20:23]
    ds_write_b128 v5, v[208:211] offset:24960
    s_waitcnt lgkmcnt(5)
    v_mfma_f32_16x16x32_bf16 v[36:39], v[124:127], a[52:55], v[36:39]
    v_mov_b32 v212, v181
    v_mov_b32 v213, v182
    v_mfma_f32_16x16x32_bf16 v[24:27], v[120:123], a[116:119], v[24:27]
    ds_read_b128 v[136:139], v6 offset:1280
    v_mfma_f32_16x16x32_bf16 v[40:43], v[124:127], a[116:119], v[40:43]
    ds_read_b128 v[140:143], v6 offset:1312
    v_mfma_f32_16x16x32_bf16 v[28:31], v[120:123], a[180:183], v[28:31]
    ds_write_b128 v5, v[210:213] offset:8320
    v_mfma_f32_16x16x32_bf16 v[44:47], v[124:127], a[180:183], v[44:47]
    v_alignbit_b32 v214, v177, v176, 16
    v_alignbit_b32 v215, v178, v177, 16
    s_waitcnt lgkmcnt(5)
    v_mfma_f32_16x16x32_bf16 v[20:23], v[128:131], a[48:51], v[20:23]
    v_alignbit_b32 v216, v179, v178, 16
    v_alignbit_b32 v217, v180, v179, 16
    s_waitcnt lgkmcnt(4)
    v_mfma_f32_16x16x32_bf16 v[36:39], v[132:135], a[48:51], v[36:39]
    ds_write_b128 v5, v[214:217] offset:29120
    v_mfma_f32_16x16x32_bf16 v[24:27], v[128:131], a[112:115], v[24:27]
    ds_read_b128 v[144:147], v6 offset:1344
    v_mfma_f32_16x16x32_bf16 v[40:43], v[132:135], a[112:115], v[40:43]
    ds_read_b128 v[148:151], v6 offset:1376
    v_mfma_f32_16x16x32_bf16 v[28:31], v[128:131], a[176:179], v[28:31]
    v_alignbit_b32 v218, v181, v180, 16
    v_alignbit_b32 v219, v182, v181, 16
    v_mfma_f32_16x16x32_bf16 v[44:47], v[132:135], a[176:179], v[44:47]
    ds_write_b128 v5, v[216:219] offset:12480
    s_waitcnt lgkmcnt(6)
    v_mfma_f32_16x16x32_bf16 v[20:23], v[136:139], a[44:47], v[20:23]
    v_alignbit_b32 v220, v178, v177, 16
    v_alignbit_b32 v221, v179, v178, 16
    s_waitcnt lgkmcnt(5)
    v_mfma_f32_16x16x32_bf16 v[36:39], v[140:143], a[44:47], v[36:39]
    v_alignbit_b32 v222, v180, v179, 16
    v_alignbit_b32 v223, v181, v180, 16
    v_mfma_f32_16x16x32_bf16 v[24:27], v[136:139], a[108:111], v[24:27]
    ds_read_b128 v[152:155], v6 offset:1408
    v_mfma_f32_16x16x32_bf16 v[40:43], v[140:143], a[108:111], v[40:43]
    ds_read_b128 v[156:159], v6 offset:1440
    v_mfma_f32_16x16x32_bf16 v[28:31], v[136:139], a[172:175], v[28:31]
    ds_write_b128 v5, v[220:223] offset:20800
    v_mfma_f32_16x16x32_bf16 v[44:47], v[140:143], a[172:175], v[44:47]
    v_alignbit_b32 v224, v182, v181, 16
    v_alignbit_b32 v225, v183, v182, 16
    s_waitcnt lgkmcnt(5)
    v_mfma_f32_16x16x32_bf16 v[20:23], v[144:147], a[40:43], v[20:23]
    ds_write_b128 v5, v[222:225] offset:4160
    s_waitcnt lgkmcnt(5)
    v_mfma_f32_16x16x32_bf16 v[36:39], v[148:151], a[40:43], v[36:39]
    buffer_load_dwordx4 v[176:179], v230, s[28:31], s37 offen offset:0
    v_mfma_f32_16x16x32_bf16 v[24:27], v[144:147], a[104:107], v[24:27]
    ds_read_b128 v[160:163], v6 offset:1472
    v_mfma_f32_16x16x32_bf16 v[40:43], v[148:151], a[104:107], v[40:43]
    ds_read_b128 v[164:167], v6 offset:1504
    v_mfma_f32_16x16x32_bf16 v[28:31], v[144:147], a[168:171], v[28:31]
    buffer_load_dwordx4 v[180:183], v4, s[28:31], s37 offen offset:0
    v_mfma_f32_16x16x32_bf16 v[44:47], v[148:151], a[168:171], v[44:47]
    s_add_u32 m0, s35, 0
    s_waitcnt lgkmcnt(5)
    v_mfma_f32_16x16x32_bf16 v[20:23], v[152:155], a[36:39], v[20:23]
    buffer_load_dwordx4 v4, s[8:11], s39 offen offset:0 lds
    s_waitcnt lgkmcnt(4)
    v_mfma_f32_16x16x32_bf16 v[36:39], v[156:159], a[36:39], v[36:39]
    s_add_u32 m0, s35, 256
    v_mfma_f32_16x16x32_bf16 v[24:27], v[152:155], a[100:103], v[24:27]
    ds_read_b128 v[168:171], v6 offset:1536
    v_mfma_f32_16x16x32_bf16 v[40:43], v[156:159], a[100:103], v[40:43]
    ds_read_b128 v[172:175], v6 offset:1568
    v_mfma_f32_16x16x32_bf16 v[28:31], v[152:155], a[164:167], v[28:31]
    buffer_load_dwordx4 v4, s[8:11], s39 offen offset:1024 lds
    v_mfma_f32_16x16x32_bf16 v[44:47], v[156:159], a[164:167], v[44:47]
    s_add_u32 m0, s35, 512
    s_waitcnt lgkmcnt(3)
    v_mfma_f32_16x16x32_bf16 v[20:23], v[160:163], a[32:35], v[20:23]
    buffer_load_dwordx4 v4, s[8:11], s39 offen offset:2048 lds
    s_waitcnt lgkmcnt(2)
    v_mfma_f32_16x16x32_bf16 v[36:39], v[164:167], a[32:35], v[36:39]
    s_add_u32 m0, s35, 768
    v_mfma_f32_16x16x32_bf16 v[24:27], v[160:163], a[96:99], v[24:27]
    ds_read_b128 v[112:115], v6 offset:1600
    v_mfma_f32_16x16x32_bf16 v[40:43], v[164:167], a[96:99], v[40:43]
    ds_read_b128 v[116:119], v6 offset:1632
    v_mfma_f32_16x16x32_bf16 v[28:31], v[160:163], a[160:163], v[28:31]
    buffer_load_dwordx4 v4, s[8:11], s39 offen offset:3072 lds
    v_mfma_f32_16x16x32_bf16 v[44:47], v[164:167], a[160:163], v[44:47]
    s_waitcnt lgkmcnt(3)
    v_mfma_f32_16x16x32_bf16 v[20:23], v[168:171], a[28:31], v[20:23]
    s_waitcnt lgkmcnt(2)
    v_mfma_f32_16x16x32_bf16 v[36:39], v[172:175], a[28:31], v[36:39]
    v_mfma_f32_16x16x32_bf16 v[24:27], v[168:171], a[92:95], v[24:27]
    ds_read_b128 v[120:123], v6 offset:1664
    v_mfma_f32_16x16x32_bf16 v[40:43], v[172:175], a[92:95], v[40:43]
    ds_read_b128 v[124:127], v6 offset:1696
    v_mfma_f32_16x16x32_bf16 v[28:31], v[168:171], a[156:159], v[28:31]
    v_mfma_f32_16x16x32_bf16 v[44:47], v[172:175], a[156:159], v[44:47]
    s_waitcnt lgkmcnt(3)
    v_mfma_f32_16x16x32_bf16 v[20:23], v[112:115], a[24:27], v[20:23]
    s_waitcnt lgkmcnt(2)
    v_mfma_f32_16x16x32_bf16 v[36:39], v[116:119], a[24:27], v[36:39]
    v_mfma_f32_16x16x32_bf16 v[24:27], v[112:115], a[88:91], v[24:27]
    ds_read_b128 v[128:131], v6 offset:1728
    v_mfma_f32_16x16x32_bf16 v[40:43], v[116:119], a[88:91], v[40:43]
    ds_read_b128 v[132:135], v6 offset:1760
    v_mfma_f32_16x16x32_bf16 v[28:31], v[112:115], a[152:155], v[28:31]
    v_mfma_f32_16x16x32_bf16 v[44:47], v[116:119], a[152:155], v[44:47]
    s_waitcnt lgkmcnt(3)
    v_mfma_f32_16x16x32_bf16 v[20:23], v[120:123], a[20:23], v[20:23]
    s_waitcnt lgkmcnt(2)
    v_mfma_f32_16x16x32_bf16 v[36:39], v[124:127], a[20:23], v[36:39]
    v_mfma_f32_16x16x32_bf16 v[24:27], v[120:123], a[84:87], v[24:27]
    ds_read_b128 v[136:139], v6 offset:1792
    v_mfma_f32_16x16x32_bf16 v[40:43], v[124:127], a[84:87], v[40:43]
    ds_read_b128 v[140:143], v6 offset:1824
    v_mfma_f32_16x16x32_bf16 v[28:31], v[120:123], a[148:151], v[28:31]
    v_mfma_f32_16x16x32_bf16 v[44:47], v[124:127], a[148:151], v[44:47]
    s_waitcnt lgkmcnt(3)
    v_mfma_f32_16x16x32_bf16 v[20:23], v[128:131], a[16:19], v[20:23]
    s_waitcnt lgkmcnt(2)
    v_mfma_f32_16x16x32_bf16 v[36:39], v[132:135], a[16:19], v[36:39]
    v_mfma_f32_16x16x32_bf16 v[24:27], v[128:131], a[80:83], v[24:27]
    ds_read_b128 v[144:147], v6 offset:1856
    v_mfma_f32_16x16x32_bf16 v[40:43], v[132:135], a[80:83], v[40:43]
    ds_read_b128 v[148:151], v6 offset:1888
    v_mfma_f32_16x16x32_bf16 v[28:31], v[128:131], a[144:147], v[28:31]
    v_mfma_f32_16x16x32_bf16 v[44:47], v[132:135], a[144:147], v[44:47]
    s_waitcnt lgkmcnt(3)
    v_mfma_f32_16x16x32_bf16 v[20:23], v[136:139], a[12:15], v[20:23]
    s_waitcnt lgkmcnt(2)
    v_mfma_f32_16x16x32_bf16 v[36:39], v[140:143], a[12:15], v[36:39]
    v_mfma_f32_16x16x32_bf16 v[24:27], v[136:139], a[76:79], v[24:27]
    ds_read_b128 v[152:155], v6 offset:1920
    v_mfma_f32_16x16x32_bf16 v[40:43], v[140:143], a[76:79], v[40:43]
    ds_read_b128 v[156:159], v6 offset:1952
    v_mfma_f32_16x16x32_bf16 v[28:31], v[136:139], a[140:143], v[28:31]
    v_mfma_f32_16x16x32_bf16 v[44:47], v[140:143], a[140:143], v[44:47]
    s_waitcnt lgkmcnt(3)
    v_mfma_f32_16x16x32_bf16 v[20:23], v[144:147], a[8:11], v[20:23]
    s_waitcnt lgkmcnt(2)
    v_mfma_f32_16x16x32_bf16 v[36:39], v[148:151], a[8:11], v[36:39]
    v_mfma_f32_16x16x32_bf16 v[24:27], v[144:147], a[72:75], v[24:27]
    ds_read_b128 v[160:163], v6 offset:1984
    v_mfma_f32_16x16x32_bf16 v[40:43], v[148:151], a[72:75], v[40:43]
    ds_read_b128 v[164:167], v6 offset:2016
    v_mfma_f32_16x16x32_bf16 v[28:31], v[144:147], a[136:139], v[28:31]
    v_mfma_f32_16x16x32_bf16 v[44:47], v[148:151], a[136:139], v[44:47]
    s_waitcnt lgkmcnt(3)
    v_mfma_f32_16x16x32_bf16 v[20:23], v[152:155], a[4:7], v[20:23]
    s_waitcnt lgkmcnt(2)
    v_mfma_f32_16x16x32_bf16 v[36:39], v[156:159], a[4:7], v[36:39]
    v_mfma_f32_16x16x32_bf16 v[24:27], v[152:155], a[68:71], v[24:27]
    ds_read_b128 v[168:171], v6 offset:2048
    v_mfma_f32_16x16x32_bf16 v[40:43], v[156:159], a[68:71], v[40:43]
    ds_read_b128 v[172:175], v6 offset:2080
    v_mfma_f32_16x16x32_bf16 v[28:31], v[152:155], a[132:135], v[28:31]
    s_waitcnt vmcnt(18)
    v_mfma_f32_16x16x32_bf16 v[44:47], v[156:159], a[132:135], v[44:47]
    ds_write_b128 v5, v[188:191] offset:1024
    s_waitcnt lgkmcnt(4)
    v_mfma_f32_16x16x32_bf16 v[20:23], v[160:163], a[0:3], v[20:23]
    ds_read_b128 v[112:115], v6 offset:2112
    s_waitcnt lgkmcnt(4)
    v_mfma_f32_16x16x32_bf16 v[36:39], v[164:167], a[0:3], v[36:39]
    ds_read_b128 v[116:119], v6 offset:2144
    v_mfma_f32_16x16x32_bf16 v[24:27], v[160:163], a[64:67], v[24:27]
    ds_write_b128 v5, v[186:189] offset:17664
    v_mfma_f32_16x16x32_bf16 v[40:43], v[164:167], a[64:67], v[40:43]
    v_mov_b32 v208, v185
    v_mov_b32 v209, v186
    v_mfma_f32_16x16x32_bf16 v[28:31], v[160:163], a[128:131], v[28:31]
    ds_read_b128 v[120:123], v6 offset:2176
    v_mfma_f32_16x16x32_bf16 v[44:47], v[164:167], a[128:131], v[44:47]
    ds_read_b128 v[124:127], v6 offset:2208
    s_waitcnt lgkmcnt(7)
    v_mfma_f32_16x16x32_bf16 v[24:27], v[168:171], a[60:63], v[24:27]
    v_mov_b32 v210, v187
    v_mov_b32 v211, v188
    s_waitcnt lgkmcnt(6)
    v_mfma_f32_16x16x32_bf16 v[40:43], v[172:175], a[60:63], v[40:43]
    ds_write_b128 v5, v[208:211] offset:25984
    v_mfma_f32_16x16x32_bf16 v[28:31], v[168:171], a[124:127], v[28:31]
    ds_read_b128 v[128:131], v6 offset:2240
    v_mfma_f32_16x16x32_bf16 v[44:47], v[172:175], a[124:127], v[44:47]
    ds_read_b128 v[132:135], v6 offset:2272
    s_waitcnt lgkmcnt(7)
    v_mfma_f32_16x16x32_bf16 v[24:27], v[112:115], a[56:59], v[24:27]
    v_mov_b32 v212, v189
    v_mov_b32 v213, v190
    s_waitcnt lgkmcnt(6)
    v_mfma_f32_16x16x32_bf16 v[40:43], v[116:119], a[56:59], v[40:43]
    ds_write_b128 v5, v[210:213] offset:9344
    v_mfma_f32_16x16x32_bf16 v[28:31], v[112:115], a[120:123], v[28:31]
    ds_read_b128 v[136:139], v6 offset:2304
    v_mfma_f32_16x16x32_bf16 v[44:47], v[116:119], a[120:123], v[44:47]
    ds_read_b128 v[140:143], v6 offset:2336
    s_waitcnt lgkmcnt(7)
    v_mfma_f32_16x16x32_bf16 v[24:27], v[120:123], a[52:55], v[24:27]
    v_alignbit_b32 v214, v185, v184, 16
    v_alignbit_b32 v215, v186, v185, 16
    s_waitcnt lgkmcnt(6)
    v_mfma_f32_16x16x32_bf16 v[40:43], v[124:127], a[52:55], v[40:43]
    v_alignbit_b32 v216, v187, v186, 16
    v_alignbit_b32 v217, v188, v187, 16
    v_mfma_f32_16x16x32_bf16 v[28:31], v[120:123], a[116:119], v[28:31]
    ds_read_b128 v[144:147], v6 offset:2368
    v_mfma_f32_16x16x32_bf16 v[44:47], v[124:127], a[116:119], v[44:47]
    ds_read_b128 v[148:151], v6 offset:2400
    s_waitcnt lgkmcnt(6)
    v_mfma_f32_16x16x32_bf16 v[24:27], v[128:131], a[48:51], v[24:27]
    ds_write_b128 v5, v[214:217] offset:30144
    s_waitcnt lgkmcnt(6)
    v_mfma_f32_16x16x32_bf16 v[40:43], v[132:135], a[48:51], v[40:43]
    v_alignbit_b32 v218, v189, v188, 16
    v_alignbit_b32 v219, v190, v189, 16
    v_mfma_f32_16x16x32_bf16 v[28:31], v[128:131], a[112:115], v[28:31]
    ds_read_b128 v[152:155], v6 offset:2432
    v_mfma_f32_16x16x32_bf16 v[44:47], v[132:135], a[112:115], v[44:47]
    ds_read_b128 v[156:159], v6 offset:2464
    s_waitcnt lgkmcnt(6)
    v_mfma_f32_16x16x32_bf16 v[24:27], v[136:139], a[44:47], v[24:27]
    ds_write_b128 v5, v[216:219] offset:13504
    s_waitcnt lgkmcnt(6)
    v_mfma_f32_16x16x32_bf16 v[40:43], v[140:143], a[44:47], v[40:43]
    v_alignbit_b32 v220, v186, v185, 16
    v_alignbit_b32 v221, v187, v186, 16
    v_mfma_f32_16x16x32_bf16 v[28:31], v[136:139], a[108:111], v[28:31]
    ds_read_b128 v[160:163], v6 offset:2496
    v_mfma_f32_16x16x32_bf16 v[44:47], v[140:143], a[108:111], v[44:47]
    ds_read_b128 v[164:167], v6 offset:2528
    s_waitcnt lgkmcnt(7)
    v_mfma_f32_16x16x32_bf16 v[24:27], v[144:147], a[40:43], v[24:27]
    v_alignbit_b32 v222, v188, v187, 16
    v_alignbit_b32 v223, v189, v188, 16
    s_waitcnt lgkmcnt(6)
    v_mfma_f32_16x16x32_bf16 v[40:43], v[148:151], a[40:43], v[40:43]
    ds_write_b128 v5, v[220:223] offset:21824
    v_mfma_f32_16x16x32_bf16 v[28:31], v[144:147], a[104:107], v[28:31]
    ds_read_b128 v[168:171], v6 offset:2560
    v_mfma_f32_16x16x32_bf16 v[44:47], v[148:151], a[104:107], v[44:47]
    ds_read_b128 v[172:175], v6 offset:2592
    s_waitcnt lgkmcnt(7)
    v_mfma_f32_16x16x32_bf16 v[24:27], v[152:155], a[36:39], v[24:27]
    v_alignbit_b32 v224, v190, v189, 16
    v_alignbit_b32 v225, v191, v190, 16
    s_waitcnt lgkmcnt(6)
    v_mfma_f32_16x16x32_bf16 v[40:43], v[156:159], a[36:39], v[40:43]
    ds_write_b128 v5, v[222:225] offset:5184
    v_mfma_f32_16x16x32_bf16 v[28:31], v[152:155], a[100:103], v[28:31]
    ds_read_b128 v[112:115], v6 offset:2624
    v_mfma_f32_16x16x32_bf16 v[44:47], v[156:159], a[100:103], v[44:47]
    ds_read_b128 v[116:119], v6 offset:2656
    s_waitcnt lgkmcnt(7)
    v_mfma_f32_16x16x32_bf16 v[24:27], v[160:163], a[32:35], v[24:27]
    buffer_load_dwordx4 v[184:187], v4, s[28:31], s37 offen offset:1008
    s_waitcnt lgkmcnt(6)
    v_mfma_f32_16x16x32_bf16 v[40:43], v[164:167], a[32:35], v[40:43]
    buffer_load_dwordx4 v[188:191], v4, s[28:31], s37 offen offset:1024
    v_mfma_f32_16x16x32_bf16 v[28:31], v[160:163], a[96:99], v[28:31]
    ds_read_b128 v[120:123], v6 offset:2688
    v_mfma_f32_16x16x32_bf16 v[44:47], v[164:167], a[96:99], v[44:47]
    ds_read_b128 v[124:127], v6 offset:2720
    s_waitcnt lgkmcnt(6)
    v_mfma_f32_16x16x32_bf16 v[24:27], v[168:171], a[28:31], v[24:27]
    s_mov_b32 s36, s37
    s_add_u32 s39, s37, 125829120
    s_add_u32 s37, s37, 4096
    s_min_u32 s37, s37, s33

    s_pack_hh_b32_b16 s40, s64, s64
    v_and_b32 v236, s40, v8
    s_waitcnt lgkmcnt(5)
    v_mfma_f32_16x16x32_bf16 v[40:43], v[172:175], a[28:31], v[40:43]
    v_and_b32 v237, s40, v9
    v_and_b32 v238, s40, v10
    v_mfma_f32_16x16x32_bf16 v[28:31], v[168:171], a[92:95], v[28:31]
    ds_read_b128 v[128:131], v6 offset:2752
    v_mfma_f32_16x16x32_bf16 v[44:47], v[172:175], a[92:95], v[44:47]
    ds_read_b128 v[132:135], v6 offset:2784
    s_waitcnt lgkmcnt(5)
    v_mfma_f32_16x16x32_bf16 v[24:27], v[112:115], a[24:27], v[24:27]
    v_and_b32 v239, s40, v11
    v_and_b32 v240, s40, v12
    s_waitcnt lgkmcnt(4)
    v_mfma_f32_16x16x32_bf16 v[40:43], v[116:119], a[24:27], v[40:43]
    v_and_b32 v241, s40, v13
    v_and_b32 v242, s40, v14
    v_mfma_f32_16x16x32_bf16 v[28:31], v[112:115], a[88:91], v[28:31]
    ds_read_b128 v[136:139], v6 offset:2816
    v_mfma_f32_16x16x32_bf16 v[44:47], v[116:119], a[88:91], v[44:47]
    ds_read_b128 v[140:143], v6 offset:2848
    s_waitcnt lgkmcnt(5)
    v_mfma_f32_16x16x32_bf16 v[24:27], v[120:123], a[20:23], v[24:27]
    v_and_b32 v243, s40, v15
    s_waitcnt lgkmcnt(4)
    v_mfma_f32_16x16x32_bf16 v[40:43], v[124:127], a[20:23], v[40:43]
    v_mfma_f32_16x16x32_bf16 v[28:31], v[120:123], a[84:87], v[28:31]
    ds_read_b128 v[144:147], v6 offset:2880
    v_mfma_f32_16x16x32_bf16 v[44:47], v[124:127], a[84:87], v[44:47]
    ds_read_b128 v[148:151], v6 offset:2912
    s_waitcnt lgkmcnt(5)
    v_mfma_f32_16x16x32_bf16 v[24:27], v[128:131], a[16:19], v[24:27]
    s_waitcnt lgkmcnt(4)
    v_mfma_f32_16x16x32_bf16 v[40:43], v[132:135], a[16:19], v[40:43]
    v_mfma_f32_16x16x32_bf16 v[28:31], v[128:131], a[80:83], v[28:31]
    ds_read_b128 v[152:155], v6 offset:2944
    v_mfma_f32_16x16x32_bf16 v[44:47], v[132:135], a[80:83], v[44:47]
    ds_read_b128 v[156:159], v6 offset:2976
    s_waitcnt lgkmcnt(5)
    v_mfma_f32_16x16x32_bf16 v[24:27], v[136:139], a[12:15], v[24:27]
    s_waitcnt lgkmcnt(4)
    v_mfma_f32_16x16x32_bf16 v[40:43], v[140:143], a[12:15], v[40:43]
    v_mfma_f32_16x16x32_bf16 v[28:31], v[136:139], a[76:79], v[28:31]
    ds_read_b128 v[160:163], v6 offset:3008
    v_mfma_f32_16x16x32_bf16 v[44:47], v[140:143], a[76:79], v[44:47]
    ds_read_b128 v[164:167], v6 offset:3040
    s_waitcnt lgkmcnt(5)
    v_mfma_f32_16x16x32_bf16 v[24:27], v[144:147], a[8:11], v[24:27]
    s_waitcnt lgkmcnt(4)
    v_mfma_f32_16x16x32_bf16 v[40:43], v[148:151], a[8:11], v[40:43]
    v_mfma_f32_16x16x32_bf16 v[28:31], v[144:147], a[72:75], v[28:31]
    ds_read_b128 v[168:171], v6 offset:3072
    v_mfma_f32_16x16x32_bf16 v[44:47], v[148:151], a[72:75], v[44:47]
    ds_read_b128 v[172:175], v6 offset:3104
    s_waitcnt lgkmcnt(5)
    v_mfma_f32_16x16x32_bf16 v[24:27], v[152:155], a[4:7], v[24:27]
    ds_read_b128 v[112:115], v6 offset:3136
    s_waitcnt lgkmcnt(5)
    v_mfma_f32_16x16x32_bf16 v[40:43], v[156:159], a[4:7], v[40:43]
    ds_read_b128 v[116:119], v6 offset:3168
    v_mfma_f32_16x16x32_bf16 v[28:31], v[152:155], a[68:71], v[28:31]
    ds_read_b128 v[120:123], v6 offset:3200
    v_mfma_f32_16x16x32_bf16 v[44:47], v[156:159], a[68:71], v[44:47]
    ds_read_b128 v[124:127], v6 offset:3232
    s_waitcnt lgkmcnt(7)
    v_mfma_f32_16x16x32_bf16 v[24:27], v[160:163], a[0:3], v[24:27]
    ds_read_b128 v[128:131], v6 offset:3264
    s_waitcnt lgkmcnt(7)
    v_mfma_f32_16x16x32_bf16 v[40:43], v[164:167], a[0:3], v[40:43]
    ds_read_b128 v[132:135], v6 offset:3296
    v_mfma_f32_16x16x32_bf16 v[28:31], v[160:163], a[64:67], v[28:31]
    ds_read_b128 v[136:139], v6 offset:3328
    v_mfma_f32_16x16x32_bf16 v[44:47], v[164:167], a[64:67], v[44:47]
    ds_read_b128 v[140:143], v6 offset:3360
    s_waitcnt lgkmcnt(9)
    v_mfma_f32_16x16x32_bf16 v[28:31], v[168:171], a[60:63], v[28:31]
    ds_read_b128 v[144:147], v6 offset:3392
    s_waitcnt lgkmcnt(9)
    v_mfma_f32_16x16x32_bf16 v[44:47], v[172:175], a[60:63], v[44:47]
    ds_read_b128 v[148:151], v6 offset:3424
    s_waitcnt lgkmcnt(9)
    v_mfma_f32_16x16x32_bf16 v[28:31], v[112:115], a[56:59], v[28:31]
    ds_read_b128 v[152:155], v6 offset:3456
    s_waitcnt lgkmcnt(9)
    v_mfma_f32_16x16x32_bf16 v[44:47], v[116:119], a[56:59], v[44:47]
    ds_read_b128 v[156:159], v6 offset:3488
    s_waitcnt lgkmcnt(9)
    v_mfma_f32_16x16x32_bf16 v[28:31], v[120:123], a[52:55], v[28:31]
    ds_read_b128 v[160:163], v6 offset:3520
    s_waitcnt lgkmcnt(9)
    v_mfma_f32_16x16x32_bf16 v[44:47], v[124:127], a[52:55], v[44:47]
    ds_read_b128 v[164:167], v6 offset:3552
    s_waitcnt lgkmcnt(9)
    v_mfma_f32_16x16x32_bf16 v[28:31], v[128:131], a[48:51], v[28:31]
    ds_read_b128 v[168:171], v6 offset:3584
    s_waitcnt lgkmcnt(9)
    v_mfma_f32_16x16x32_bf16 v[44:47], v[132:135], a[48:51], v[44:47]
    ds_read_b128 v[172:175], v6 offset:3616
    s_waitcnt lgkmcnt(9)
    v_mfma_f32_16x16x32_bf16 v[28:31], v[136:139], a[44:47], v[28:31]
    ds_read_b128 v[112:115], v6 offset:3648
    s_waitcnt lgkmcnt(9)
    v_mfma_f32_16x16x32_bf16 v[44:47], v[140:143], a[44:47], v[44:47]
    ds_read_b128 v[116:119], v6 offset:3680
    s_waitcnt lgkmcnt(9)
    v_mfma_f32_16x16x32_bf16 v[28:31], v[144:147], a[40:43], v[28:31]
    ds_read_b128 v[120:123], v6 offset:3712
    s_waitcnt lgkmcnt(9)
    v_mfma_f32_16x16x32_bf16 v[44:47], v[148:151], a[40:43], v[44:47]
    ds_read_b128 v[124:127], v6 offset:3744
    s_waitcnt lgkmcnt(9)
    v_mfma_f32_16x16x32_bf16 v[28:31], v[152:155], a[36:39], v[28:31]
    ds_read_b128 v[128:131], v6 offset:3776
    s_waitcnt lgkmcnt(9)
    v_mfma_f32_16x16x32_bf16 v[44:47], v[156:159], a[36:39], v[44:47]
    ds_read_b128 v[132:135], v6 offset:3808
    s_waitcnt lgkmcnt(9)
    v_mfma_f32_16x16x32_bf16 v[28:31], v[160:163], a[32:35], v[28:31]
    ds_read_b128 v[136:139], v6 offset:3840
    s_waitcnt lgkmcnt(9)
    v_mfma_f32_16x16x32_bf16 v[44:47], v[164:167], a[32:35], v[44:47]
    ds_read_b128 v[140:143], v6 offset:3872
    s_waitcnt lgkmcnt(9)
    v_mfma_f32_16x16x32_bf16 v[28:31], v[168:171], a[28:31], v[28:31]
    ds_read_b128 v[144:147], v6 offset:3904
    s_waitcnt lgkmcnt(9)
    v_mfma_f32_16x16x32_bf16 v[44:47], v[172:175], a[28:31], v[44:47]
    ds_read_b128 v[148:151], v6 offset:3936
    s_waitcnt lgkmcnt(9)
    v_mfma_f32_16x16x32_bf16 v[28:31], v[112:115], a[24:27], v[28:31]
    ds_read_b128 v[152:155], v6 offset:3968
    s_waitcnt lgkmcnt(9)
    v_mfma_f32_16x16x32_bf16 v[44:47], v[116:119], a[24:27], v[44:47]
    ds_read_b128 v[156:159], v6 offset:4000
    s_waitcnt lgkmcnt(9)
    v_mfma_f32_16x16x32_bf16 v[28:31], v[120:123], a[20:23], v[28:31]
    ds_read_b128 v[160:163], v6 offset:4032
    s_waitcnt lgkmcnt(9)
    v_mfma_f32_16x16x32_bf16 v[44:47], v[124:127], a[20:23], v[44:47]
    ds_read_b128 v[164:167], v6 offset:4064
    s_waitcnt lgkmcnt(9)
    v_mfma_f32_16x16x32_bf16 v[28:31], v[128:131], a[16:19], v[28:31]
    s_waitcnt vmcnt(2)
    ds_read_b128 a[60:63], v7 offset:240
    s_waitcnt lgkmcnt(9)
    v_mfma_f32_16x16x32_bf16 v[44:47], v[132:135], a[16:19], v[44:47]
    s_waitcnt lgkmcnt(8)
    v_mfma_f32_16x16x32_bf16 v[28:31], v[136:139], a[12:15], v[28:31]
    ds_read_b128 a[124:127], v7 offset:496
    s_waitcnt lgkmcnt(8)
    v_mfma_f32_16x16x32_bf16 v[44:47], v[140:143], a[12:15], v[44:47]
    s_waitcnt lgkmcnt(7)
    v_mfma_f32_16x16x32_bf16 v[28:31], v[144:147], a[8:11], v[28:31]
    ds_read_b128 a[188:191], v7 offset:752
    s_waitcnt lgkmcnt(7)
    v_mfma_f32_16x16x32_bf16 v[44:47], v[148:151], a[8:11], v[44:47]
    s_waitcnt lgkmcnt(6)
    v_mfma_f32_16x16x32_bf16 v[28:31], v[152:155], a[4:7], v[28:31]
    ds_read_b128 a[252:255], v7 offset:1008
    s_waitcnt lgkmcnt(6)
    v_mfma_f32_16x16x32_bf16 v[44:47], v[156:159], a[4:7], v[44:47]
    s_waitcnt lgkmcnt(5)
    v_mfma_f32_16x16x32_bf16 v[28:31], v[160:163], a[0:3], v[28:31]
    ds_read_b128 v[168:171], v6 offset:0
    s_waitcnt lgkmcnt(5)
    v_mfma_f32_16x16x32_bf16 v[44:47], v[164:167], a[0:3], v[44:47]
    ds_read_b128 v[172:175], v6 offset:32
    s_waitcnt lgkmcnt(5)
    v_mfma_f32_16x16x32_bf16 v[48:51], v[236:239], a[60:63], 0
    v_mfma_f32_16x16x32_bf16 v[64:67], v[240:243], a[60:63], 0
    s_waitcnt lgkmcnt(4)
    v_mfma_f32_16x16x32_bf16 v[52:55], v[236:239], a[124:127], 0
    v_mfma_f32_16x16x32_bf16 v[68:71], v[240:243], a[124:127], 0
    s_waitcnt lgkmcnt(3)
    v_mfma_f32_16x16x32_bf16 v[56:59], v[236:239], a[188:191], 0
    v_mfma_f32_16x16x32_bf16 v[72:75], v[240:243], a[188:191], 0
    ds_read_b128 a[56:59], v7 offset:224
    s_waitcnt lgkmcnt(3)
    v_mfma_f32_16x16x32_bf16 v[60:63], v[236:239], a[252:255], 0
    ds_read_b128 v[112:115], v6 offset:64
    v_mfma_f32_16x16x32_bf16 v[76:79], v[240:243], a[252:255], 0
    ds_read_b128 v[116:119], v6 offset:96
    s_waitcnt lgkmcnt(4)
    v_mfma_f32_16x16x32_bf16 v[48:51], v[168:171], a[60:63], v[48:51]
    ds_read_b128 a[120:123], v7 offset:480
    s_waitcnt lgkmcnt(4)
    v_mfma_f32_16x16x32_bf16 v[64:67], v[172:175], a[60:63], v[64:67]
    s_waitcnt vmcnt(10)
    v_mfma_f32_16x16x32_bf16 v[52:55], v[168:171], a[124:127], v[52:55]
    ds_read_b128 a[184:187], v7 offset:736
    v_mfma_f32_16x16x32_bf16 v[68:71], v[172:175], a[124:127], v[68:71]
    ds_write_b128 v5, v[196:199] offset:2048
    v_mfma_f32_16x16x32_bf16 v[56:59], v[168:171], a[188:191], v[56:59]
    ds_read_b128 a[248:251], v7 offset:992
    v_mfma_f32_16x16x32_bf16 v[72:75], v[172:175], a[188:191], v[72:75]
    ds_read_b128 a[52:55], v7 offset:208
    v_mfma_f32_16x16x32_bf16 v[60:63], v[168:171], a[252:255], v[60:63]
    ds_read_b128 v[120:123], v6 offset:128
    v_mfma_f32_16x16x32_bf16 v[76:79], v[172:175], a[252:255], v[76:79]
    ds_read_b128 v[124:127], v6 offset:160
    s_waitcnt lgkmcnt(8)
    v_mfma_f32_16x16x32_bf16 v[48:51], v[112:115], a[56:59], v[48:51]
    ds_read_b128 a[116:119], v7 offset:464
    s_waitcnt lgkmcnt(8)
    v_mfma_f32_16x16x32_bf16 v[64:67], v[116:119], a[56:59], v[64:67]
    ds_write_b128 v5, v[194:197] offset:18688
    s_waitcnt lgkmcnt(8)
    v_mfma_f32_16x16x32_bf16 v[52:55], v[112:115], a[120:123], v[52:55]
    ds_read_b128 a[180:183], v7 offset:720
    v_mfma_f32_16x16x32_bf16 v[68:71], v[116:119], a[120:123], v[68:71]
    v_mov_b32 v208, v193
    v_mov_b32 v209, v194
    s_waitcnt lgkmcnt(8)
    v_mfma_f32_16x16x32_bf16 v[56:59], v[112:115], a[184:187], v[56:59]
    ds_read_b128 a[244:247], v7 offset:976
    v_mfma_f32_16x16x32_bf16 v[72:75], v[116:119], a[184:187], v[72:75]
    ds_read_b128 a[48:51], v7 offset:192
    s_waitcnt lgkmcnt(8)
    v_mfma_f32_16x16x32_bf16 v[60:63], v[112:115], a[248:251], v[60:63]
    ds_read_b128 v[128:131], v6 offset:192
    v_mfma_f32_16x16x32_bf16 v[76:79], v[116:119], a[248:251], v[76:79]
    ds_read_b128 v[132:135], v6 offset:224
    s_waitcnt lgkmcnt(8)
    v_mfma_f32_16x16x32_bf16 v[48:51], v[120:123], a[52:55], v[48:51]
    ds_read_b128 a[112:115], v7 offset:448
    s_waitcnt lgkmcnt(8)
    v_mfma_f32_16x16x32_bf16 v[64:67], v[124:127], a[52:55], v[64:67]
    v_mov_b32 v210, v195
    v_mov_b32 v211, v196
    s_waitcnt lgkmcnt(7)
    v_mfma_f32_16x16x32_bf16 v[52:55], v[120:123], a[116:119], v[52:55]
    ds_read_b128 a[176:179], v7 offset:704
    v_mfma_f32_16x16x32_bf16 v[68:71], v[124:127], a[116:119], v[68:71]
    ds_write_b128 v5, v[208:211] offset:27008
    s_waitcnt lgkmcnt(7)
    v_mfma_f32_16x16x32_bf16 v[56:59], v[120:123], a[180:183], v[56:59]
    ds_read_b128 a[240:243], v7 offset:960
    v_mfma_f32_16x16x32_bf16 v[72:75], v[124:127], a[180:183], v[72:75]
    ds_read_b128 a[44:47], v7 offset:176
    s_waitcnt lgkmcnt(8)
    v_mfma_f32_16x16x32_bf16 v[60:63], v[120:123], a[244:247], v[60:63]
    ds_read_b128 v[136:139], v6 offset:256
    v_mfma_f32_16x16x32_bf16 v[76:79], v[124:127], a[244:247], v[76:79]
    ds_read_b128 v[140:143], v6 offset:288
    s_waitcnt lgkmcnt(8)
    v_mfma_f32_16x16x32_bf16 v[48:51], v[128:131], a[48:51], v[48:51]
    ds_read_b128 a[108:111], v7 offset:432
    s_waitcnt lgkmcnt(8)
    v_mfma_f32_16x16x32_bf16 v[64:67], v[132:135], a[48:51], v[64:67]
    v_mov_b32 v212, v197
    v_mov_b32 v213, v198
    s_waitcnt lgkmcnt(7)
    v_mfma_f32_16x16x32_bf16 v[52:55], v[128:131], a[112:115], v[52:55]
    ds_read_b128 a[172:175], v7 offset:688
    v_mfma_f32_16x16x32_bf16 v[68:71], v[132:135], a[112:115], v[68:71]
    ds_write_b128 v5, v[210:213] offset:10368
    s_waitcnt lgkmcnt(8)
    v_mfma_f32_16x16x32_bf16 v[56:59], v[128:131], a[176:179], v[56:59]
    ds_read_b128 a[236:239], v7 offset:944
    v_mfma_f32_16x16x32_bf16 v[72:75], v[132:135], a[176:179], v[72:75]
    ds_read_b128 a[40:43], v7 offset:160
    s_waitcnt lgkmcnt(8)
    v_mfma_f32_16x16x32_bf16 v[60:63], v[128:131], a[240:243], v[60:63]
    ds_read_b128 v[144:147], v6 offset:320
    v_mfma_f32_16x16x32_bf16 v[76:79], v[132:135], a[240:243], v[76:79]
    ds_read_b128 v[148:151], v6 offset:352
    s_waitcnt lgkmcnt(8)
    v_mfma_f32_16x16x32_bf16 v[48:51], v[136:139], a[44:47], v[48:51]
    ds_read_b128 a[104:107], v7 offset:416
    s_waitcnt lgkmcnt(8)
    v_mfma_f32_16x16x32_bf16 v[64:67], v[140:143], a[44:47], v[64:67]
    v_alignbit_b32 v214, v193, v192, 16
    v_alignbit_b32 v215, v194, v193, 16
    s_waitcnt lgkmcnt(7)
    v_mfma_f32_16x16x32_bf16 v[52:55], v[136:139], a[108:111], v[52:55]
    ds_read_b128 a[168:171], v7 offset:672
    v_mfma_f32_16x16x32_bf16 v[68:71], v[140:143], a[108:111], v[68:71]
    v_alignbit_b32 v216, v195, v194, 16
    v_alignbit_b32 v217, v196, v195, 16
    s_waitcnt lgkmcnt(7)
    v_mfma_f32_16x16x32_bf16 v[56:59], v[136:139], a[172:175], v[56:59]
    ds_read_b128 a[232:235], v7 offset:928
    v_mfma_f32_16x16x32_bf16 v[72:75], v[140:143], a[172:175], v[72:75]
    ds_read_b128 a[36:39], v7 offset:144
    s_waitcnt lgkmcnt(7)
    v_mfma_f32_16x16x32_bf16 v[60:63], v[136:139], a[236:239], v[60:63]
    ds_read_b128 v[152:155], v6 offset:384
    v_mfma_f32_16x16x32_bf16 v[76:79], v[140:143], a[236:239], v[76:79]
    ds_read_b128 v[156:159], v6 offset:416
    s_waitcnt lgkmcnt(7)
    v_mfma_f32_16x16x32_bf16 v[48:51], v[144:147], a[40:43], v[48:51]
    ds_read_b128 a[100:103], v7 offset:400
    s_waitcnt lgkmcnt(7)
    v_mfma_f32_16x16x32_bf16 v[64:67], v[148:151], a[40:43], v[64:67]
    ds_write_b128 v5, v[214:217] offset:31168
    s_waitcnt lgkmcnt(7)
    v_mfma_f32_16x16x32_bf16 v[52:55], v[144:147], a[104:107], v[52:55]
    ds_read_b128 a[164:167], v7 offset:656
    v_mfma_f32_16x16x32_bf16 v[68:71], v[148:151], a[104:107], v[68:71]
    v_alignbit_b32 v218, v197, v196, 16
    v_alignbit_b32 v219, v198, v197, 16
    s_waitcnt lgkmcnt(7)
    v_mfma_f32_16x16x32_bf16 v[56:59], v[144:147], a[168:171], v[56:59]
    ds_read_b128 a[228:231], v7 offset:912
    v_mfma_f32_16x16x32_bf16 v[72:75], v[148:151], a[168:171], v[72:75]
    ds_read_b128 a[32:35], v7 offset:128
    s_waitcnt lgkmcnt(8)
    v_mfma_f32_16x16x32_bf16 v[60:63], v[144:147], a[232:235], v[60:63]
    ds_read_b128 v[160:163], v6 offset:448
    v_mfma_f32_16x16x32_bf16 v[76:79], v[148:151], a[232:235], v[76:79]
    ds_read_b128 v[164:167], v6 offset:480
    s_waitcnt lgkmcnt(8)
    v_mfma_f32_16x16x32_bf16 v[48:51], v[152:155], a[36:39], v[48:51]
    ds_read_b128 a[96:99], v7 offset:384
    s_waitcnt lgkmcnt(8)
    v_mfma_f32_16x16x32_bf16 v[64:67], v[156:159], a[36:39], v[64:67]
    ds_write_b128 v5, v[216:219] offset:14528
    s_waitcnt lgkmcnt(8)
    v_mfma_f32_16x16x32_bf16 v[52:55], v[152:155], a[100:103], v[52:55]
    ds_read_b128 a[160:163], v7 offset:640
    v_mfma_f32_16x16x32_bf16 v[68:71], v[156:159], a[100:103], v[68:71]
    v_alignbit_b32 v220, v194, v193, 16
    v_alignbit_b32 v221, v195, v194, 16
    s_waitcnt lgkmcnt(7)
    v_mfma_f32_16x16x32_bf16 v[56:59], v[152:155], a[164:167], v[56:59]
    ds_read_b128 a[224:227], v7 offset:896
    v_mfma_f32_16x16x32_bf16 v[72:75], v[156:159], a[164:167], v[72:75]
    ds_read_b128 a[28:31], v7 offset:112
    s_waitcnt lgkmcnt(8)
    v_mfma_f32_16x16x32_bf16 v[60:63], v[152:155], a[228:231], v[60:63]
    ds_read_b128 v[168:171], v6 offset:512
    v_mfma_f32_16x16x32_bf16 v[76:79], v[156:159], a[228:231], v[76:79]
    ds_read_b128 v[172:175], v6 offset:544
    s_waitcnt lgkmcnt(8)
    v_mfma_f32_16x16x32_bf16 v[48:51], v[160:163], a[32:35], v[48:51]
    ds_read_b128 a[92:95], v7 offset:368
    s_waitcnt lgkmcnt(8)
    v_mfma_f32_16x16x32_bf16 v[64:67], v[164:167], a[32:35], v[64:67]
    v_alignbit_b32 v222, v196, v195, 16
    v_alignbit_b32 v223, v197, v196, 16
    s_waitcnt lgkmcnt(7)
    v_mfma_f32_16x16x32_bf16 v[52:55], v[160:163], a[96:99], v[52:55]
    ds_read_b128 a[156:159], v7 offset:624
    v_mfma_f32_16x16x32_bf16 v[68:71], v[164:167], a[96:99], v[68:71]
    ds_write_b128 v5, v[220:223] offset:22848
    s_waitcnt lgkmcnt(7)
    v_mfma_f32_16x16x32_bf16 v[56:59], v[160:163], a[160:163], v[56:59]
    ds_read_b128 a[220:223], v7 offset:880
    v_mfma_f32_16x16x32_bf16 v[72:75], v[164:167], a[160:163], v[72:75]
    ds_read_b128 a[24:27], v7 offset:96
    s_waitcnt lgkmcnt(8)
    v_mfma_f32_16x16x32_bf16 v[60:63], v[160:163], a[224:227], v[60:63]
    ds_read_b128 v[112:115], v6 offset:576
    v_mfma_f32_16x16x32_bf16 v[76:79], v[164:167], a[224:227], v[76:79]
    ds_read_b128 v[116:119], v6 offset:608
    s_waitcnt lgkmcnt(8)
    v_mfma_f32_16x16x32_bf16 v[48:51], v[168:171], a[28:31], v[48:51]
    ds_read_b128 a[88:91], v7 offset:352
    s_waitcnt lgkmcnt(8)
    v_mfma_f32_16x16x32_bf16 v[64:67], v[172:175], a[28:31], v[64:67]
    v_alignbit_b32 v224, v198, v197, 16
    v_alignbit_b32 v225, v199, v198, 16
    s_waitcnt lgkmcnt(7)
    v_mfma_f32_16x16x32_bf16 v[52:55], v[168:171], a[92:95], v[52:55]
    ds_read_b128 a[152:155], v7 offset:608
    v_mfma_f32_16x16x32_bf16 v[68:71], v[172:175], a[92:95], v[68:71]
    ds_write_b128 v5, v[222:225] offset:6208
    s_waitcnt lgkmcnt(8)
    v_mfma_f32_16x16x32_bf16 v[56:59], v[168:171], a[156:159], v[56:59]
    ds_read_b128 a[216:219], v7 offset:864
    v_mfma_f32_16x16x32_bf16 v[72:75], v[172:175], a[156:159], v[72:75]
    ds_read_b128 a[20:23], v7 offset:80
    s_waitcnt lgkmcnt(8)
    v_mfma_f32_16x16x32_bf16 v[60:63], v[168:171], a[220:223], v[60:63]
    ds_read_b128 v[120:123], v6 offset:640
    v_mfma_f32_16x16x32_bf16 v[76:79], v[172:175], a[220:223], v[76:79]
    ds_read_b128 v[124:127], v6 offset:672
    s_waitcnt lgkmcnt(8)
    v_mfma_f32_16x16x32_bf16 v[48:51], v[112:115], a[24:27], v[48:51]
    ds_read_b128 a[84:87], v7 offset:336
    s_waitcnt lgkmcnt(8)
    v_mfma_f32_16x16x32_bf16 v[64:67], v[116:119], a[24:27], v[64:67]
    buffer_load_dwordx4 v[192:195], v4, s[28:31], s36 offen offset:2032
    s_waitcnt lgkmcnt(7)
    v_mfma_f32_16x16x32_bf16 v[52:55], v[112:115], a[88:91], v[52:55]
    ds_read_b128 a[148:151], v7 offset:592
    v_mfma_f32_16x16x32_bf16 v[68:71], v[116:119], a[88:91], v[68:71]
    buffer_load_dwordx4 v[196:199], v4, s[28:31], s36 offen offset:2048
    s_waitcnt lgkmcnt(7)
    v_mfma_f32_16x16x32_bf16 v[56:59], v[112:115], a[152:155], v[56:59]
    ds_read_b128 a[212:215], v7 offset:848
    v_mfma_f32_16x16x32_bf16 v[72:75], v[116:119], a[152:155], v[72:75]
    ds_read_b128 a[16:19], v7 offset:64
    s_waitcnt lgkmcnt(7)
    v_mfma_f32_16x16x32_bf16 v[60:63], v[112:115], a[216:219], v[60:63]
    ds_read_b128 v[128:131], v6 offset:704
    v_mfma_f32_16x16x32_bf16 v[76:79], v[116:119], a[216:219], v[76:79]
    ds_read_b128 v[132:135], v6 offset:736
    s_waitcnt lgkmcnt(7)
    v_mfma_f32_16x16x32_bf16 v[48:51], v[120:123], a[20:23], v[48:51]
    ds_read_b128 a[80:83], v7 offset:320
    s_waitcnt lgkmcnt(7)
    v_mfma_f32_16x16x32_bf16 v[64:67], v[124:127], a[20:23], v[64:67]
    s_waitcnt vmcnt(10)
    s_waitcnt lgkmcnt(6)
    v_mfma_f32_16x16x32_bf16 v[52:55], v[120:123], a[84:87], v[52:55]
    ds_read_b128 a[144:147], v7 offset:576
    v_mfma_f32_16x16x32_bf16 v[68:71], v[124:127], a[84:87], v[68:71]
    ds_write_b128 v5, v[204:207] offset:3072
    s_waitcnt lgkmcnt(7)
    v_mfma_f32_16x16x32_bf16 v[56:59], v[120:123], a[148:151], v[56:59]
    ds_read_b128 a[208:211], v7 offset:832
    v_mfma_f32_16x16x32_bf16 v[72:75], v[124:127], a[148:151], v[72:75]
    ds_read_b128 a[12:15], v7 offset:48
    s_waitcnt lgkmcnt(8)
    v_mfma_f32_16x16x32_bf16 v[60:63], v[120:123], a[212:215], v[60:63]
    ds_read_b128 v[136:139], v6 offset:768
    v_mfma_f32_16x16x32_bf16 v[76:79], v[124:127], a[212:215], v[76:79]
    ds_read_b128 v[140:143], v6 offset:800
    s_waitcnt lgkmcnt(8)
    v_mfma_f32_16x16x32_bf16 v[48:51], v[128:131], a[16:19], v[48:51]
    ds_read_b128 a[76:79], v7 offset:304
    s_waitcnt lgkmcnt(8)
    v_mfma_f32_16x16x32_bf16 v[64:67], v[132:135], a[16:19], v[64:67]
    ds_write_b128 v5, v[202:205] offset:19712
    s_waitcnt lgkmcnt(8)
    v_mfma_f32_16x16x32_bf16 v[52:55], v[128:131], a[80:83], v[52:55]
    ds_read_b128 a[140:143], v7 offset:560
    v_mfma_f32_16x16x32_bf16 v[68:71], v[132:135], a[80:83], v[68:71]
    v_mov_b32 v208, v201
    v_mov_b32 v209, v202
    s_waitcnt lgkmcnt(8)
    v_mfma_f32_16x16x32_bf16 v[56:59], v[128:131], a[144:147], v[56:59]
    ds_read_b128 a[204:207], v7 offset:816
    v_mfma_f32_16x16x32_bf16 v[72:75], v[132:135], a[144:147], v[72:75]
    ds_read_b128 a[8:11], v7 offset:32
    s_waitcnt lgkmcnt(8)
    v_mfma_f32_16x16x32_bf16 v[60:63], v[128:131], a[208:211], v[60:63]
    ds_read_b128 v[144:147], v6 offset:832
    v_mfma_f32_16x16x32_bf16 v[76:79], v[132:135], a[208:211], v[76:79]
    ds_read_b128 v[148:151], v6 offset:864
    s_waitcnt lgkmcnt(8)
    v_mfma_f32_16x16x32_bf16 v[48:51], v[136:139], a[12:15], v[48:51]
    ds_read_b128 a[72:75], v7 offset:288
    s_waitcnt lgkmcnt(8)
    v_mfma_f32_16x16x32_bf16 v[64:67], v[140:143], a[12:15], v[64:67]
    v_mov_b32 v210, v203
    v_mov_b32 v211, v204
    s_waitcnt lgkmcnt(7)
    v_mfma_f32_16x16x32_bf16 v[52:55], v[136:139], a[76:79], v[52:55]
    ds_read_b128 a[136:139], v7 offset:544
    v_mfma_f32_16x16x32_bf16 v[68:71], v[140:143], a[76:79], v[68:71]
    ds_write_b128 v5, v[208:211] offset:28032
    s_waitcnt lgkmcnt(7)
    v_mfma_f32_16x16x32_bf16 v[56:59], v[136:139], a[140:143], v[56:59]
    ds_read_b128 a[200:203], v7 offset:800
    v_mfma_f32_16x16x32_bf16 v[72:75], v[140:143], a[140:143], v[72:75]
    ds_read_b128 a[4:7], v7 offset:16
    s_waitcnt lgkmcnt(8)
    v_mfma_f32_16x16x32_bf16 v[60:63], v[136:139], a[204:207], v[60:63]
    ds_read_b128 v[152:155], v6 offset:896
    v_mfma_f32_16x16x32_bf16 v[76:79], v[140:143], a[204:207], v[76:79]
    ds_read_b128 v[156:159], v6 offset:928
    s_waitcnt lgkmcnt(8)
    v_mfma_f32_16x16x32_bf16 v[48:51], v[144:147], a[8:11], v[48:51]
    ds_read_b128 a[68:71], v7 offset:272
    s_waitcnt lgkmcnt(8)
    v_mfma_f32_16x16x32_bf16 v[64:67], v[148:151], a[8:11], v[64:67]
    v_mov_b32 v212, v205
    v_mov_b32 v213, v206
    s_waitcnt lgkmcnt(7)
    v_mfma_f32_16x16x32_bf16 v[52:55], v[144:147], a[72:75], v[52:55]
    ds_read_b128 a[132:135], v7 offset:528
    v_mfma_f32_16x16x32_bf16 v[68:71], v[148:151], a[72:75], v[68:71]
    ds_write_b128 v5, v[210:213] offset:11392
    s_waitcnt lgkmcnt(8)
    v_mfma_f32_16x16x32_bf16 v[56:59], v[144:147], a[136:139], v[56:59]
    ds_read_b128 a[196:199], v7 offset:784
    v_mfma_f32_16x16x32_bf16 v[72:75], v[148:151], a[136:139], v[72:75]
    ds_read_b128 a[0:3], v7 offset:0
    s_waitcnt lgkmcnt(8)
    v_mfma_f32_16x16x32_bf16 v[60:63], v[144:147], a[200:203], v[60:63]
    ds_read_b128 v[160:163], v6 offset:960
    v_mfma_f32_16x16x32_bf16 v[76:79], v[148:151], a[200:203], v[76:79]
    ds_read_b128 v[164:167], v6 offset:992
    s_waitcnt lgkmcnt(8)
    v_mfma_f32_16x16x32_bf16 v[48:51], v[152:155], a[4:7], v[48:51]
    ds_read_b128 a[64:67], v7 offset:256
    s_waitcnt lgkmcnt(8)
    v_mfma_f32_16x16x32_bf16 v[64:67], v[156:159], a[4:7], v[64:67]
    v_alignbit_b32 v214, v201, v200, 16
    v_alignbit_b32 v215, v202, v201, 16
    s_waitcnt lgkmcnt(7)
    v_mfma_f32_16x16x32_bf16 v[52:55], v[152:155], a[68:71], v[52:55]
    ds_read_b128 a[128:131], v7 offset:512
    v_mfma_f32_16x16x32_bf16 v[68:71], v[156:159], a[68:71], v[68:71]
    v_alignbit_b32 v216, v203, v202, 16
    v_alignbit_b32 v217, v204, v203, 16
    s_waitcnt lgkmcnt(7)
    v_mfma_f32_16x16x32_bf16 v[56:59], v[152:155], a[132:135], v[56:59]
    ds_read_b128 a[192:195], v7 offset:768
    v_mfma_f32_16x16x32_bf16 v[72:75], v[156:159], a[132:135], v[72:75]
    ds_write_b128 v5, v[214:217] offset:32192
    s_waitcnt lgkmcnt(7)
    v_mfma_f32_16x16x32_bf16 v[60:63], v[152:155], a[196:199], v[60:63]
    ds_read_b128 v[168:171], v6 offset:1024
    v_mfma_f32_16x16x32_bf16 v[76:79], v[156:159], a[196:199], v[76:79]
    ds_read_b128 v[172:175], v6 offset:1056
    s_waitcnt lgkmcnt(7)
    v_mfma_f32_16x16x32_bf16 v[48:51], v[160:163], a[0:3], v[48:51]
    v_alignbit_b32 v218, v205, v204, 16
    v_alignbit_b32 v219, v206, v205, 16
    s_waitcnt lgkmcnt(6)
    v_mfma_f32_16x16x32_bf16 v[64:67], v[164:167], a[0:3], v[64:67]
    ds_write_b128 v5, v[216:219] offset:15552
    s_waitcnt lgkmcnt(6)
    v_mfma_f32_16x16x32_bf16 v[52:55], v[160:163], a[64:67], v[52:55]
    v_alignbit_b32 v220, v202, v201, 16
    v_alignbit_b32 v221, v203, v202, 16
    v_mfma_f32_16x16x32_bf16 v[68:71], v[164:167], a[64:67], v[68:71]
    v_alignbit_b32 v222, v204, v203, 16
    v_alignbit_b32 v223, v205, v204, 16
    s_waitcnt lgkmcnt(5)
    v_mfma_f32_16x16x32_bf16 v[56:59], v[160:163], a[128:131], v[56:59]
    ds_read_b128 v[112:115], v6 offset:1088
    v_mfma_f32_16x16x32_bf16 v[72:75], v[164:167], a[128:131], v[72:75]
    ds_read_b128 v[116:119], v6 offset:1120
    s_waitcnt lgkmcnt(6)
    v_mfma_f32_16x16x32_bf16 v[60:63], v[160:163], a[192:195], v[60:63]
    ds_write_b128 v5, v[220:223] offset:23872
    v_mfma_f32_16x16x32_bf16 v[76:79], v[164:167], a[192:195], v[76:79]
    v_alignbit_b32 v224, v206, v205, 16
    v_alignbit_b32 v225, v207, v206, 16
    s_waitcnt lgkmcnt(5)
    v_mfma_f32_16x16x32_bf16 v[52:55], v[168:171], a[60:63], v[52:55]
    ds_write_b128 v5, v[222:225] offset:7232
    s_waitcnt lgkmcnt(5)
    v_mfma_f32_16x16x32_bf16 v[68:71], v[172:175], a[60:63], v[68:71]
    buffer_load_dwordx4 v[200:203], v4, s[28:31], s36 offen offset:3056
    v_mfma_f32_16x16x32_bf16 v[56:59], v[168:171], a[124:127], v[56:59]
    ds_read_b128 v[120:123], v6 offset:1152
    v_mfma_f32_16x16x32_bf16 v[72:75], v[172:175], a[124:127], v[72:75]
    ds_read_b128 v[124:127], v6 offset:1184
    v_mfma_f32_16x16x32_bf16 v[60:63], v[168:171], a[188:191], v[60:63]
    buffer_load_dwordx4 v[204:207], v4, s[28:31], s36 offen offset:3072
    v_mfma_f32_16x16x32_bf16 v[76:79], v[172:175], a[188:191], v[76:79]
    s_waitcnt vmcnt(10)
    s_mov_b64 exec, 1
    v_mov_b32 v176, 0
    v_mov_b32 v177, 0
    v_mov_b32 v178, 0
    v_mov_b32 v179, 0
    s_mov_b64 exec, -1
    s_waitcnt lgkmcnt(5)
    v_mfma_f32_16x16x32_bf16 v[52:55], v[112:115], a[56:59], v[52:55]
    ds_write_b128 v5, v[180:183] offset:0
    s_waitcnt lgkmcnt(5)
    v_mfma_f32_16x16x32_bf16 v[68:71], v[116:119], a[56:59], v[68:71]
    ds_write_b128 v5, v[178:181] offset:16640
    v_mfma_f32_16x16x32_bf16 v[56:59], v[112:115], a[120:123], v[56:59]
    ds_read_b128 v[128:131], v6 offset:1216
    v_mfma_f32_16x16x32_bf16 v[72:75], v[116:119], a[120:123], v[72:75]
    ds_read_b128 v[132:135], v6 offset:1248
    v_mfma_f32_16x16x32_bf16 v[60:63], v[112:115], a[184:187], v[60:63]
    v_mov_b32 v208, v177
    v_mov_b32 v209, v178
    v_mfma_f32_16x16x32_bf16 v[76:79], v[116:119], a[184:187], v[76:79]
    v_mov_b32 v210, v179
    v_mov_b32 v211, v180
    s_waitcnt lgkmcnt(5)
    v_mfma_f32_16x16x32_bf16 v[52:55], v[120:123], a[52:55], v[52:55]
    ds_write_b128 v5, v[208:211] offset:24960
    s_waitcnt lgkmcnt(5)
    v_mfma_f32_16x16x32_bf16 v[68:71], v[124:127], a[52:55], v[68:71]
    v_mov_b32 v212, v181
    v_mov_b32 v213, v182
    v_mfma_f32_16x16x32_bf16 v[56:59], v[120:123], a[116:119], v[56:59]
    ds_read_b128 v[136:139], v6 offset:1280
    v_mfma_f32_16x16x32_bf16 v[72:75], v[124:127], a[116:119], v[72:75]
    ds_read_b128 v[140:143], v6 offset:1312
    v_mfma_f32_16x16x32_bf16 v[60:63], v[120:123], a[180:183], v[60:63]
    ds_write_b128 v5, v[210:213] offset:8320
    v_mfma_f32_16x16x32_bf16 v[76:79], v[124:127], a[180:183], v[76:79]
    v_alignbit_b32 v214, v177, v176, 16
    v_alignbit_b32 v215, v178, v177, 16
    s_waitcnt lgkmcnt(5)
    v_mfma_f32_16x16x32_bf16 v[52:55], v[128:131], a[48:51], v[52:55]
    v_alignbit_b32 v216, v179, v178, 16
    v_alignbit_b32 v217, v180, v179, 16
    s_waitcnt lgkmcnt(4)
    v_mfma_f32_16x16x32_bf16 v[68:71], v[132:135], a[48:51], v[68:71]
    ds_write_b128 v5, v[214:217] offset:29120
    v_mfma_f32_16x16x32_bf16 v[56:59], v[128:131], a[112:115], v[56:59]
    ds_read_b128 v[144:147], v6 offset:1344
    v_mfma_f32_16x16x32_bf16 v[72:75], v[132:135], a[112:115], v[72:75]
    ds_read_b128 v[148:151], v6 offset:1376
    v_mfma_f32_16x16x32_bf16 v[60:63], v[128:131], a[176:179], v[60:63]
    v_alignbit_b32 v218, v181, v180, 16
    v_alignbit_b32 v219, v182, v181, 16
    v_mfma_f32_16x16x32_bf16 v[76:79], v[132:135], a[176:179], v[76:79]
    ds_write_b128 v5, v[216:219] offset:12480
    s_waitcnt lgkmcnt(6)
    v_mfma_f32_16x16x32_bf16 v[52:55], v[136:139], a[44:47], v[52:55]
    v_alignbit_b32 v220, v178, v177, 16
    v_alignbit_b32 v221, v179, v178, 16
    s_waitcnt lgkmcnt(5)
    v_mfma_f32_16x16x32_bf16 v[68:71], v[140:143], a[44:47], v[68:71]
    v_alignbit_b32 v222, v180, v179, 16
    v_alignbit_b32 v223, v181, v180, 16
    v_mfma_f32_16x16x32_bf16 v[56:59], v[136:139], a[108:111], v[56:59]
    ds_read_b128 v[152:155], v6 offset:1408
    v_mfma_f32_16x16x32_bf16 v[72:75], v[140:143], a[108:111], v[72:75]
    ds_read_b128 v[156:159], v6 offset:1440
    v_mfma_f32_16x16x32_bf16 v[60:63], v[136:139], a[172:175], v[60:63]
    ds_write_b128 v5, v[220:223] offset:20800
    v_mfma_f32_16x16x32_bf16 v[76:79], v[140:143], a[172:175], v[76:79]
    v_alignbit_b32 v224, v182, v181, 16
    v_alignbit_b32 v225, v183, v182, 16
    s_waitcnt lgkmcnt(5)
    v_mfma_f32_16x16x32_bf16 v[52:55], v[144:147], a[40:43], v[52:55]
    ds_write_b128 v5, v[222:225] offset:4160
    s_waitcnt lgkmcnt(5)
    v_mfma_f32_16x16x32_bf16 v[68:71], v[148:151], a[40:43], v[68:71]
    buffer_load_dwordx4 v[176:179], v230, s[28:31], s37 offen offset:0
    v_mfma_f32_16x16x32_bf16 v[56:59], v[144:147], a[104:107], v[56:59]
    ds_read_b128 v[160:163], v6 offset:1472
    v_mfma_f32_16x16x32_bf16 v[72:75], v[148:151], a[104:107], v[72:75]
    ds_read_b128 v[164:167], v6 offset:1504
    v_mfma_f32_16x16x32_bf16 v[60:63], v[144:147], a[168:171], v[60:63]
    buffer_load_dwordx4 v[180:183], v4, s[28:31], s37 offen offset:0
    v_mfma_f32_16x16x32_bf16 v[76:79], v[148:151], a[168:171], v[76:79]
    s_add_u32 m0, s35, 0
    s_waitcnt lgkmcnt(5)
    v_mfma_f32_16x16x32_bf16 v[52:55], v[152:155], a[36:39], v[52:55]
    buffer_load_dwordx4 v4, s[8:11], s39 offen offset:0 lds
    s_waitcnt lgkmcnt(4)
    v_mfma_f32_16x16x32_bf16 v[68:71], v[156:159], a[36:39], v[68:71]
    s_add_u32 m0, s35, 256
    v_mfma_f32_16x16x32_bf16 v[56:59], v[152:155], a[100:103], v[56:59]
    ds_read_b128 v[168:171], v6 offset:1536
    v_mfma_f32_16x16x32_bf16 v[72:75], v[156:159], a[100:103], v[72:75]
    ds_read_b128 v[172:175], v6 offset:1568
    v_mfma_f32_16x16x32_bf16 v[60:63], v[152:155], a[164:167], v[60:63]
    buffer_load_dwordx4 v4, s[8:11], s39 offen offset:1024 lds
    v_mfma_f32_16x16x32_bf16 v[76:79], v[156:159], a[164:167], v[76:79]
    s_add_u32 m0, s35, 512
    s_waitcnt lgkmcnt(3)
    v_mfma_f32_16x16x32_bf16 v[52:55], v[160:163], a[32:35], v[52:55]
    buffer_load_dwordx4 v4, s[8:11], s39 offen offset:2048 lds
    s_waitcnt lgkmcnt(2)
    v_mfma_f32_16x16x32_bf16 v[68:71], v[164:167], a[32:35], v[68:71]
    s_add_u32 m0, s35, 768
    v_mfma_f32_16x16x32_bf16 v[56:59], v[160:163], a[96:99], v[56:59]
    ds_read_b128 v[112:115], v6 offset:1600
    v_mfma_f32_16x16x32_bf16 v[72:75], v[164:167], a[96:99], v[72:75]
    ds_read_b128 v[116:119], v6 offset:1632
    v_mfma_f32_16x16x32_bf16 v[60:63], v[160:163], a[160:163], v[60:63]
    buffer_load_dwordx4 v4, s[8:11], s39 offen offset:3072 lds
    v_mfma_f32_16x16x32_bf16 v[76:79], v[164:167], a[160:163], v[76:79]
    s_waitcnt lgkmcnt(3)
    v_mfma_f32_16x16x32_bf16 v[52:55], v[168:171], a[28:31], v[52:55]
    s_waitcnt lgkmcnt(2)
    v_mfma_f32_16x16x32_bf16 v[68:71], v[172:175], a[28:31], v[68:71]
    v_mfma_f32_16x16x32_bf16 v[56:59], v[168:171], a[92:95], v[56:59]
    ds_read_b128 v[120:123], v6 offset:1664
    v_mfma_f32_16x16x32_bf16 v[72:75], v[172:175], a[92:95], v[72:75]
    ds_read_b128 v[124:127], v6 offset:1696
    v_mfma_f32_16x16x32_bf16 v[60:63], v[168:171], a[156:159], v[60:63]
    v_mfma_f32_16x16x32_bf16 v[76:79], v[172:175], a[156:159], v[76:79]
    s_waitcnt lgkmcnt(3)
    v_mfma_f32_16x16x32_bf16 v[52:55], v[112:115], a[24:27], v[52:55]
    s_waitcnt lgkmcnt(2)
    v_mfma_f32_16x16x32_bf16 v[68:71], v[116:119], a[24:27], v[68:71]
    v_mfma_f32_16x16x32_bf16 v[56:59], v[112:115], a[88:91], v[56:59]
    ds_read_b128 v[128:131], v6 offset:1728
    v_mfma_f32_16x16x32_bf16 v[72:75], v[116:119], a[88:91], v[72:75]
    ds_read_b128 v[132:135], v6 offset:1760
    v_mfma_f32_16x16x32_bf16 v[60:63], v[112:115], a[152:155], v[60:63]
    v_mfma_f32_16x16x32_bf16 v[76:79], v[116:119], a[152:155], v[76:79]
    s_waitcnt lgkmcnt(3)
    v_mfma_f32_16x16x32_bf16 v[52:55], v[120:123], a[20:23], v[52:55]
    s_waitcnt lgkmcnt(2)
    v_mfma_f32_16x16x32_bf16 v[68:71], v[124:127], a[20:23], v[68:71]
    v_mfma_f32_16x16x32_bf16 v[56:59], v[120:123], a[84:87], v[56:59]
    ds_read_b128 v[136:139], v6 offset:1792
    v_mfma_f32_16x16x32_bf16 v[72:75], v[124:127], a[84:87], v[72:75]
    ds_read_b128 v[140:143], v6 offset:1824
    v_mfma_f32_16x16x32_bf16 v[60:63], v[120:123], a[148:151], v[60:63]
    v_mfma_f32_16x16x32_bf16 v[76:79], v[124:127], a[148:151], v[76:79]
    s_waitcnt lgkmcnt(3)
    v_mfma_f32_16x16x32_bf16 v[52:55], v[128:131], a[16:19], v[52:55]
    s_waitcnt lgkmcnt(2)
    v_mfma_f32_16x16x32_bf16 v[68:71], v[132:135], a[16:19], v[68:71]
    v_mfma_f32_16x16x32_bf16 v[56:59], v[128:131], a[80:83], v[56:59]
    ds_read_b128 v[144:147], v6 offset:1856
    v_mfma_f32_16x16x32_bf16 v[72:75], v[132:135], a[80:83], v[72:75]
    ds_read_b128 v[148:151], v6 offset:1888
    v_mfma_f32_16x16x32_bf16 v[60:63], v[128:131], a[144:147], v[60:63]
    v_mfma_f32_16x16x32_bf16 v[76:79], v[132:135], a[144:147], v[76:79]
    s_waitcnt lgkmcnt(3)
    v_mfma_f32_16x16x32_bf16 v[52:55], v[136:139], a[12:15], v[52:55]
    s_waitcnt lgkmcnt(2)
    v_mfma_f32_16x16x32_bf16 v[68:71], v[140:143], a[12:15], v[68:71]
    v_mfma_f32_16x16x32_bf16 v[56:59], v[136:139], a[76:79], v[56:59]
    ds_read_b128 v[152:155], v6 offset:1920
    v_mfma_f32_16x16x32_bf16 v[72:75], v[140:143], a[76:79], v[72:75]
    ds_read_b128 v[156:159], v6 offset:1952
    v_mfma_f32_16x16x32_bf16 v[60:63], v[136:139], a[140:143], v[60:63]
    v_mfma_f32_16x16x32_bf16 v[76:79], v[140:143], a[140:143], v[76:79]
    s_waitcnt lgkmcnt(3)
    v_mfma_f32_16x16x32_bf16 v[52:55], v[144:147], a[8:11], v[52:55]
    s_waitcnt lgkmcnt(2)
    v_mfma_f32_16x16x32_bf16 v[68:71], v[148:151], a[8:11], v[68:71]
    v_mfma_f32_16x16x32_bf16 v[56:59], v[144:147], a[72:75], v[56:59]
    ds_read_b128 v[160:163], v6 offset:1984
    v_mfma_f32_16x16x32_bf16 v[72:75], v[148:151], a[72:75], v[72:75]
    ds_read_b128 v[164:167], v6 offset:2016
    v_mfma_f32_16x16x32_bf16 v[60:63], v[144:147], a[136:139], v[60:63]
    v_mfma_f32_16x16x32_bf16 v[76:79], v[148:151], a[136:139], v[76:79]
    s_waitcnt lgkmcnt(3)
    v_mfma_f32_16x16x32_bf16 v[52:55], v[152:155], a[4:7], v[52:55]
    s_waitcnt lgkmcnt(2)
    v_mfma_f32_16x16x32_bf16 v[68:71], v[156:159], a[4:7], v[68:71]
    v_mfma_f32_16x16x32_bf16 v[56:59], v[152:155], a[68:71], v[56:59]
    ds_read_b128 v[168:171], v6 offset:2048
    v_mfma_f32_16x16x32_bf16 v[72:75], v[156:159], a[68:71], v[72:75]
    ds_read_b128 v[172:175], v6 offset:2080
    v_mfma_f32_16x16x32_bf16 v[60:63], v[152:155], a[132:135], v[60:63]
    s_waitcnt vmcnt(10)
    v_mfma_f32_16x16x32_bf16 v[76:79], v[156:159], a[132:135], v[76:79]
    ds_write_b128 v5, v[188:191] offset:1024
    s_waitcnt lgkmcnt(4)
    v_mfma_f32_16x16x32_bf16 v[52:55], v[160:163], a[0:3], v[52:55]
    ds_read_b128 v[112:115], v6 offset:2112
    s_waitcnt lgkmcnt(4)
    v_mfma_f32_16x16x32_bf16 v[68:71], v[164:167], a[0:3], v[68:71]
    ds_read_b128 v[116:119], v6 offset:2144
    v_mfma_f32_16x16x32_bf16 v[56:59], v[160:163], a[64:67], v[56:59]
    ds_write_b128 v5, v[186:189] offset:17664
    v_mfma_f32_16x16x32_bf16 v[72:75], v[164:167], a[64:67], v[72:75]
    v_mov_b32 v208, v185
    v_mov_b32 v209, v186
    v_mfma_f32_16x16x32_bf16 v[60:63], v[160:163], a[128:131], v[60:63]
    ds_read_b128 v[120:123], v6 offset:2176
    v_mfma_f32_16x16x32_bf16 v[76:79], v[164:167], a[128:131], v[76:79]
    ds_read_b128 v[124:127], v6 offset:2208
    s_waitcnt lgkmcnt(7)
    v_mfma_f32_16x16x32_bf16 v[56:59], v[168:171], a[60:63], v[56:59]
    v_mov_b32 v210, v187
    v_mov_b32 v211, v188
    s_waitcnt lgkmcnt(6)
    v_mfma_f32_16x16x32_bf16 v[72:75], v[172:175], a[60:63], v[72:75]
    ds_write_b128 v5, v[208:211] offset:25984
    v_mfma_f32_16x16x32_bf16 v[60:63], v[168:171], a[124:127], v[60:63]
    ds_read_b128 v[128:131], v6 offset:2240
    v_mfma_f32_16x16x32_bf16 v[76:79], v[172:175], a[124:127], v[76:79]
    ds_read_b128 v[132:135], v6 offset:2272
    s_waitcnt lgkmcnt(7)
    v_mfma_f32_16x16x32_bf16 v[56:59], v[112:115], a[56:59], v[56:59]
    v_mov_b32 v212, v189
    v_mov_b32 v213, v190
    s_waitcnt lgkmcnt(6)
    v_mfma_f32_16x16x32_bf16 v[72:75], v[116:119], a[56:59], v[72:75]
    ds_write_b128 v5, v[210:213] offset:9344
    v_mfma_f32_16x16x32_bf16 v[60:63], v[112:115], a[120:123], v[60:63]
    ds_read_b128 v[136:139], v6 offset:2304
    v_mfma_f32_16x16x32_bf16 v[76:79], v[116:119], a[120:123], v[76:79]
    ds_read_b128 v[140:143], v6 offset:2336
    s_waitcnt lgkmcnt(7)
    v_mfma_f32_16x16x32_bf16 v[56:59], v[120:123], a[52:55], v[56:59]
    v_alignbit_b32 v214, v185, v184, 16
    v_alignbit_b32 v215, v186, v185, 16
    s_waitcnt lgkmcnt(6)
    v_mfma_f32_16x16x32_bf16 v[72:75], v[124:127], a[52:55], v[72:75]
    v_alignbit_b32 v216, v187, v186, 16
    v_alignbit_b32 v217, v188, v187, 16
    v_mfma_f32_16x16x32_bf16 v[60:63], v[120:123], a[116:119], v[60:63]
    ds_read_b128 v[144:147], v6 offset:2368
    v_mfma_f32_16x16x32_bf16 v[76:79], v[124:127], a[116:119], v[76:79]
    ds_read_b128 v[148:151], v6 offset:2400
    s_waitcnt lgkmcnt(6)
    v_mfma_f32_16x16x32_bf16 v[56:59], v[128:131], a[48:51], v[56:59]
    ds_write_b128 v5, v[214:217] offset:30144
    s_waitcnt lgkmcnt(6)
    v_mfma_f32_16x16x32_bf16 v[72:75], v[132:135], a[48:51], v[72:75]
    v_alignbit_b32 v218, v189, v188, 16
    v_alignbit_b32 v219, v190, v189, 16
    v_mfma_f32_16x16x32_bf16 v[60:63], v[128:131], a[112:115], v[60:63]
    ds_read_b128 v[152:155], v6 offset:2432
    v_mfma_f32_16x16x32_bf16 v[76:79], v[132:135], a[112:115], v[76:79]
    ds_read_b128 v[156:159], v6 offset:2464
    s_waitcnt lgkmcnt(6)
    v_mfma_f32_16x16x32_bf16 v[56:59], v[136:139], a[44:47], v[56:59]
    ds_write_b128 v5, v[216:219] offset:13504
    s_waitcnt lgkmcnt(6)
    v_mfma_f32_16x16x32_bf16 v[72:75], v[140:143], a[44:47], v[72:75]
    v_alignbit_b32 v220, v186, v185, 16
    v_alignbit_b32 v221, v187, v186, 16
    v_mfma_f32_16x16x32_bf16 v[60:63], v[136:139], a[108:111], v[60:63]
    ds_read_b128 v[160:163], v6 offset:2496
    v_mfma_f32_16x16x32_bf16 v[76:79], v[140:143], a[108:111], v[76:79]
    ds_read_b128 v[164:167], v6 offset:2528
    s_waitcnt lgkmcnt(7)
    v_mfma_f32_16x16x32_bf16 v[56:59], v[144:147], a[40:43], v[56:59]
    v_alignbit_b32 v222, v188, v187, 16
    v_alignbit_b32 v223, v189, v188, 16
    s_waitcnt lgkmcnt(6)
    v_mfma_f32_16x16x32_bf16 v[72:75], v[148:151], a[40:43], v[72:75]
    ds_write_b128 v5, v[220:223] offset:21824
    v_mfma_f32_16x16x32_bf16 v[60:63], v[144:147], a[104:107], v[60:63]
    ds_read_b128 v[168:171], v6 offset:2560
    v_mfma_f32_16x16x32_bf16 v[76:79], v[148:151], a[104:107], v[76:79]
    ds_read_b128 v[172:175], v6 offset:2592
    s_waitcnt lgkmcnt(7)
    v_mfma_f32_16x16x32_bf16 v[56:59], v[152:155], a[36:39], v[56:59]
    v_alignbit_b32 v224, v190, v189, 16
    v_alignbit_b32 v225, v191, v190, 16
    s_waitcnt lgkmcnt(6)
    v_mfma_f32_16x16x32_bf16 v[72:75], v[156:159], a[36:39], v[72:75]
    ds_write_b128 v5, v[222:225] offset:5184
    v_mfma_f32_16x16x32_bf16 v[60:63], v[152:155], a[100:103], v[60:63]
    ds_read_b128 v[112:115], v6 offset:2624
    v_mfma_f32_16x16x32_bf16 v[76:79], v[156:159], a[100:103], v[76:79]
    ds_read_b128 v[116:119], v6 offset:2656
    s_waitcnt lgkmcnt(7)
    v_mfma_f32_16x16x32_bf16 v[56:59], v[160:163], a[32:35], v[56:59]
    buffer_load_dwordx4 v[184:187], v4, s[28:31], s37 offen offset:1008
    s_waitcnt lgkmcnt(6)
    v_mfma_f32_16x16x32_bf16 v[72:75], v[164:167], a[32:35], v[72:75]
    buffer_load_dwordx4 v[188:191], v4, s[28:31], s37 offen offset:1024
    v_mfma_f32_16x16x32_bf16 v[60:63], v[160:163], a[96:99], v[60:63]
    ds_read_b128 v[120:123], v6 offset:2688
    v_mfma_f32_16x16x32_bf16 v[76:79], v[164:167], a[96:99], v[76:79]
    ds_read_b128 v[124:127], v6 offset:2720
    s_waitcnt lgkmcnt(6)
    v_mfma_f32_16x16x32_bf16 v[56:59], v[168:171], a[28:31], v[56:59]
    s_mov_b32 s36, s37
    s_add_u32 s39, s37, 125829120
    s_add_u32 s37, s37, 4096
    s_min_u32 s37, s37, s33

    s_pack_ll_b32_b16 s40, s65, s65
    s_mov_b32 s64, s65
    s_mov_b32 s65, s66
    s_mov_b32 s66, s67
    v_and_b32 v236, s40, v8
    s_waitcnt lgkmcnt(5)
    v_mfma_f32_16x16x32_bf16 v[72:75], v[172:175], a[28:31], v[72:75]
    v_and_b32 v237, s40, v9
    v_and_b32 v238, s40, v10
    v_mfma_f32_16x16x32_bf16 v[60:63], v[168:171], a[92:95], v[60:63]
    ds_read_b128 v[128:131], v6 offset:2752
    v_mfma_f32_16x16x32_bf16 v[76:79], v[172:175], a[92:95], v[76:79]
    ds_read_b128 v[132:135], v6 offset:2784
    s_waitcnt lgkmcnt(5)
    v_mfma_f32_16x16x32_bf16 v[56:59], v[112:115], a[24:27], v[56:59]
    v_and_b32 v239, s40, v11
    v_and_b32 v240, s40, v12
    s_waitcnt lgkmcnt(4)
    v_mfma_f32_16x16x32_bf16 v[72:75], v[116:119], a[24:27], v[72:75]
    v_and_b32 v241, s40, v13
    v_and_b32 v242, s40, v14
    v_mfma_f32_16x16x32_bf16 v[60:63], v[112:115], a[88:91], v[60:63]
    ds_read_b128 v[136:139], v6 offset:2816
    v_mfma_f32_16x16x32_bf16 v[76:79], v[116:119], a[88:91], v[76:79]
    ds_read_b128 v[140:143], v6 offset:2848
    s_waitcnt lgkmcnt(5)
    v_mfma_f32_16x16x32_bf16 v[56:59], v[120:123], a[20:23], v[56:59]
    v_and_b32 v243, s40, v15
    s_waitcnt lgkmcnt(4)
    v_mfma_f32_16x16x32_bf16 v[72:75], v[124:127], a[20:23], v[72:75]
    v_mfma_f32_16x16x32_bf16 v[60:63], v[120:123], a[84:87], v[60:63]
    ds_read_b128 v[144:147], v6 offset:2880
    v_mfma_f32_16x16x32_bf16 v[76:79], v[124:127], a[84:87], v[76:79]
    ds_read_b128 v[148:151], v6 offset:2912
    s_waitcnt lgkmcnt(5)
    v_mfma_f32_16x16x32_bf16 v[56:59], v[128:131], a[16:19], v[56:59]
    s_waitcnt lgkmcnt(4)
    v_mfma_f32_16x16x32_bf16 v[72:75], v[132:135], a[16:19], v[72:75]
    v_mfma_f32_16x16x32_bf16 v[60:63], v[128:131], a[80:83], v[60:63]
    ds_read_b128 v[152:155], v6 offset:2944
    v_mfma_f32_16x16x32_bf16 v[76:79], v[132:135], a[80:83], v[76:79]
    ds_read_b128 v[156:159], v6 offset:2976
    s_waitcnt lgkmcnt(5)
    v_mfma_f32_16x16x32_bf16 v[56:59], v[136:139], a[12:15], v[56:59]
    s_waitcnt lgkmcnt(4)
    v_mfma_f32_16x16x32_bf16 v[72:75], v[140:143], a[12:15], v[72:75]
    v_mfma_f32_16x16x32_bf16 v[60:63], v[136:139], a[76:79], v[60:63]
    ds_read_b128 v[160:163], v6 offset:3008
    v_mfma_f32_16x16x32_bf16 v[76:79], v[140:143], a[76:79], v[76:79]
    ds_read_b128 v[164:167], v6 offset:3040
    s_waitcnt lgkmcnt(5)
    v_mfma_f32_16x16x32_bf16 v[56:59], v[144:147], a[8:11], v[56:59]
    s_waitcnt lgkmcnt(4)
    v_mfma_f32_16x16x32_bf16 v[72:75], v[148:151], a[8:11], v[72:75]
    v_mfma_f32_16x16x32_bf16 v[60:63], v[144:147], a[72:75], v[60:63]
    ds_read_b128 v[168:171], v6 offset:3072
    v_mfma_f32_16x16x32_bf16 v[76:79], v[148:151], a[72:75], v[76:79]
    ds_read_b128 v[172:175], v6 offset:3104
    s_waitcnt lgkmcnt(5)
    v_mfma_f32_16x16x32_bf16 v[56:59], v[152:155], a[4:7], v[56:59]
    ds_read_b128 v[112:115], v6 offset:3136
    s_waitcnt lgkmcnt(5)
    v_mfma_f32_16x16x32_bf16 v[72:75], v[156:159], a[4:7], v[72:75]
    ds_read_b128 v[116:119], v6 offset:3168
    v_mfma_f32_16x16x32_bf16 v[60:63], v[152:155], a[68:71], v[60:63]
    ds_read_b128 v[120:123], v6 offset:3200
    v_mfma_f32_16x16x32_bf16 v[76:79], v[156:159], a[68:71], v[76:79]
    ds_read_b128 v[124:127], v6 offset:3232
    s_waitcnt lgkmcnt(7)
    v_mfma_f32_16x16x32_bf16 v[56:59], v[160:163], a[0:3], v[56:59]
    ds_read_b128 v[128:131], v6 offset:3264
    s_waitcnt lgkmcnt(7)
    v_mfma_f32_16x16x32_bf16 v[72:75], v[164:167], a[0:3], v[72:75]
    ds_read_b128 v[132:135], v6 offset:3296
    v_mfma_f32_16x16x32_bf16 v[60:63], v[160:163], a[64:67], v[60:63]
    ds_read_b128 v[136:139], v6 offset:3328
    v_mfma_f32_16x16x32_bf16 v[76:79], v[164:167], a[64:67], v[76:79]
    ds_read_b128 v[140:143], v6 offset:3360
    s_waitcnt lgkmcnt(9)
    v_mfma_f32_16x16x32_bf16 v[60:63], v[168:171], a[60:63], v[60:63]
    ds_read_b128 v[144:147], v6 offset:3392
    s_waitcnt lgkmcnt(9)
    v_mfma_f32_16x16x32_bf16 v[76:79], v[172:175], a[60:63], v[76:79]
    ds_read_b128 v[148:151], v6 offset:3424
    s_waitcnt lgkmcnt(9)
    v_mfma_f32_16x16x32_bf16 v[60:63], v[112:115], a[56:59], v[60:63]
    ds_read_b128 v[152:155], v6 offset:3456
    s_waitcnt lgkmcnt(9)
    v_mfma_f32_16x16x32_bf16 v[76:79], v[116:119], a[56:59], v[76:79]
    ds_read_b128 v[156:159], v6 offset:3488
    s_waitcnt lgkmcnt(9)
    v_mfma_f32_16x16x32_bf16 v[60:63], v[120:123], a[52:55], v[60:63]
    ds_read_b128 v[160:163], v6 offset:3520
    s_waitcnt lgkmcnt(9)
    v_mfma_f32_16x16x32_bf16 v[76:79], v[124:127], a[52:55], v[76:79]
    ds_read_b128 v[164:167], v6 offset:3552
    s_waitcnt lgkmcnt(9)
    v_mfma_f32_16x16x32_bf16 v[60:63], v[128:131], a[48:51], v[60:63]
    ds_read_b128 v[168:171], v6 offset:3584
    s_waitcnt lgkmcnt(9)
    v_mfma_f32_16x16x32_bf16 v[76:79], v[132:135], a[48:51], v[76:79]
    ds_read_b128 v[172:175], v6 offset:3616
    s_waitcnt lgkmcnt(9)
    v_mfma_f32_16x16x32_bf16 v[60:63], v[136:139], a[44:47], v[60:63]
    ds_read_b128 v[112:115], v6 offset:3648
    s_waitcnt lgkmcnt(9)
    v_mfma_f32_16x16x32_bf16 v[76:79], v[140:143], a[44:47], v[76:79]
    ds_read_b128 v[116:119], v6 offset:3680
    s_waitcnt lgkmcnt(9)
    v_mfma_f32_16x16x32_bf16 v[60:63], v[144:147], a[40:43], v[60:63]
    ds_read_b128 v[120:123], v6 offset:3712
    s_waitcnt lgkmcnt(9)
    v_mfma_f32_16x16x32_bf16 v[76:79], v[148:151], a[40:43], v[76:79]
    ds_read_b128 v[124:127], v6 offset:3744
    s_waitcnt lgkmcnt(9)
    v_mfma_f32_16x16x32_bf16 v[60:63], v[152:155], a[36:39], v[60:63]
    ds_read_b128 v[128:131], v6 offset:3776
    s_waitcnt lgkmcnt(9)
    v_mfma_f32_16x16x32_bf16 v[76:79], v[156:159], a[36:39], v[76:79]
    ds_read_b128 v[132:135], v6 offset:3808
    s_waitcnt lgkmcnt(9)
    v_mfma_f32_16x16x32_bf16 v[60:63], v[160:163], a[32:35], v[60:63]
    ds_read_b128 v[136:139], v6 offset:3840
    s_waitcnt lgkmcnt(9)
    v_mfma_f32_16x16x32_bf16 v[76:79], v[164:167], a[32:35], v[76:79]
    ds_read_b128 v[140:143], v6 offset:3872
    s_waitcnt lgkmcnt(9)
    v_mfma_f32_16x16x32_bf16 v[60:63], v[168:171], a[28:31], v[60:63]
    ds_read_b128 v[144:147], v6 offset:3904
    s_waitcnt lgkmcnt(9)
    v_mfma_f32_16x16x32_bf16 v[76:79], v[172:175], a[28:31], v[76:79]
    ds_read_b128 v[148:151], v6 offset:3936
    s_waitcnt lgkmcnt(9)
    v_mfma_f32_16x16x32_bf16 v[60:63], v[112:115], a[24:27], v[60:63]
    ds_read_b128 v[152:155], v6 offset:3968
    s_waitcnt lgkmcnt(9)
    v_mfma_f32_16x16x32_bf16 v[76:79], v[116:119], a[24:27], v[76:79]
    ds_read_b128 v[156:159], v6 offset:4000
    s_waitcnt lgkmcnt(9)
    v_mfma_f32_16x16x32_bf16 v[60:63], v[120:123], a[20:23], v[60:63]
    ds_read_b128 v[160:163], v6 offset:4032
    s_waitcnt lgkmcnt(9)
    v_mfma_f32_16x16x32_bf16 v[76:79], v[124:127], a[20:23], v[76:79]
    ds_read_b128 v[164:167], v6 offset:4064
    s_waitcnt lgkmcnt(9)
    v_mfma_f32_16x16x32_bf16 v[60:63], v[128:131], a[16:19], v[60:63]
    s_waitcnt vmcnt(2)
    ds_read_b128 a[60:63], v7 offset:240
    s_waitcnt lgkmcnt(9)
    v_mfma_f32_16x16x32_bf16 v[76:79], v[132:135], a[16:19], v[76:79]
    s_waitcnt lgkmcnt(8)
    v_mfma_f32_16x16x32_bf16 v[60:63], v[136:139], a[12:15], v[60:63]
    ds_read_b128 a[124:127], v7 offset:496
    s_waitcnt lgkmcnt(8)
    v_mfma_f32_16x16x32_bf16 v[76:79], v[140:143], a[12:15], v[76:79]
    s_waitcnt lgkmcnt(7)
    v_mfma_f32_16x16x32_bf16 v[60:63], v[144:147], a[8:11], v[60:63]
    ds_read_b128 a[188:191], v7 offset:752
    s_waitcnt lgkmcnt(7)
    v_mfma_f32_16x16x32_bf16 v[76:79], v[148:151], a[8:11], v[76:79]
    s_waitcnt lgkmcnt(6)
    v_mfma_f32_16x16x32_bf16 v[60:63], v[152:155], a[4:7], v[60:63]
    ds_read_b128 a[252:255], v7 offset:1008
    s_waitcnt lgkmcnt(6)
    v_mfma_f32_16x16x32_bf16 v[76:79], v[156:159], a[4:7], v[76:79]
    s_waitcnt lgkmcnt(5)
    v_mfma_f32_16x16x32_bf16 v[60:63], v[160:163], a[0:3], v[60:63]
    ds_read_b128 v[168:171], v6 offset:0
    s_waitcnt lgkmcnt(5)
    v_mfma_f32_16x16x32_bf16 v[76:79], v[164:167], a[0:3], v[76:79]
    ds_read_b128 v[172:175], v6 offset:32
    s_add_u32 s41, s38, 4096
    v_cvt_pk_bf16_f32 v80, v16, v48
    v_cvt_pk_bf16_f32 v81, v17, v49
    v_cvt_pk_bf16_f32 v82, v18, v50
    v_cvt_pk_bf16_f32 v83, v19, v51
    buffer_store_dwordx4 v[80:83], v228, s[8:11], s38 offen offset:0 sc1
    v_cvt_pk_bf16_f32 v84, v32, v64
    v_cvt_pk_bf16_f32 v85, v33, v65
    v_cvt_pk_bf16_f32 v86, v34, v66
    v_cvt_pk_bf16_f32 v87, v35, v67
    buffer_store_dwordx4 v[84:87], v228, s[8:11], s38 offen offset:64 sc1
    v_cvt_pk_bf16_f32 v88, v20, v52
    v_cvt_pk_bf16_f32 v89, v21, v53
    v_cvt_pk_bf16_f32 v90, v22, v54
    v_cvt_pk_bf16_f32 v91, v23, v55
    buffer_store_dwordx4 v[88:91], v228, s[8:11], s38 offen offset:2048 sc1
    v_cvt_pk_bf16_f32 v92, v36, v68
    v_cvt_pk_bf16_f32 v93, v37, v69
    v_cvt_pk_bf16_f32 v94, v38, v70
    v_cvt_pk_bf16_f32 v95, v39, v71
    buffer_store_dwordx4 v[92:95], v228, s[8:11], s38 offen offset:2112 sc1
    v_cvt_pk_bf16_f32 v96, v24, v56
    v_cvt_pk_bf16_f32 v97, v25, v57
    v_cvt_pk_bf16_f32 v98, v26, v58
    v_cvt_pk_bf16_f32 v99, v27, v59
    buffer_store_dwordx4 v[96:99], v228, s[8:11], s41 offen offset:0 sc1
    v_cvt_pk_bf16_f32 v100, v40, v72
    v_cvt_pk_bf16_f32 v101, v41, v73
    v_cvt_pk_bf16_f32 v102, v42, v74
    v_cvt_pk_bf16_f32 v103, v43, v75
    buffer_store_dwordx4 v[100:103], v228, s[8:11], s41 offen offset:64 sc1
    v_cvt_pk_bf16_f32 v104, v28, v60
    v_cvt_pk_bf16_f32 v105, v29, v61
    v_cvt_pk_bf16_f32 v106, v30, v62
    v_cvt_pk_bf16_f32 v107, v31, v63
    buffer_store_dwordx4 v[104:107], v228, s[8:11], s41 offen offset:2048 sc1
    v_cvt_pk_bf16_f32 v108, v44, v76
    v_cvt_pk_bf16_f32 v109, v45, v77
    v_cvt_pk_bf16_f32 v110, v46, v78
    v_cvt_pk_bf16_f32 v111, v47, v79
    buffer_store_dwordx4 v[108:111], v228, s[8:11], s41 offen offset:2112 sc1
    s_add_u32 s38, s38, 8192
    s_add_u32 s42, s42, 1
    s_cmp_lt_u32 s42, 4
    s_cbranch_scc1 .cvl_473

    s_waitcnt vmcnt(0) lgkmcnt(0)
    s_barrier
    s_mov_b32 s5, 160
    s_cmp_lg_u32 s24, 0
    s_cbranch_scc1 .sg_474
    s_mov_b64 exec, 1
    v_mov_b32 v4, 1
    v_mov_b32 v5, 0
    buffer_atomic_add v4, v5, s[20:23], s5 offen sc1
    s_mov_b64 exec, -1

.sg_474:
    v_and_b32 v1, 63, v0
    v_and_b32 v2, 15, v1
    v_lshrrev_b32 v3, 4, v1

    s_sub_u32 s4, s26, 24
    s_lshr_b32 s25, s4, 1
    s_and_b32 s4, s4, 1
    s_lshl_b32 s4, s4, 2
    s_lshl_b32 s5, s91, 3
    s_add_u32 s4, s4, s5
    s_add_u32 s26, s4, s24
    s_lshl_b32 s35, s26, 8
    s_add_u32 s35, s35, 92274688
    s_mov_b32 s37, 0x3db504f3
    s_mov_b32 s38, 0x3fb8aa3b
    v_lshlrev_b32 v8, 4, v1
    v_min_u32 v9, 2, v1
    v_lshlrev_b32 v9, 13, v9
    v_lshlrev_b32 v6, 4, v3
    v_and_b32 v5, 7, v2
    v_add_u32 v10, v6, v5
    v_lshlrev_b32 v10, 4, v10
    v_lshlrev_b32 v11, 4, v2
    v_lshlrev_b32 v5, 3, v3
    v_add_u32 v11, v11, v5
    v_cmp_gt_u32 s[60:61], 32, v1
    v_lshlrev_b32 v5, 2, v3
    v_mov_b32 v12, 0
    v_mov_b32 v13, 0
    v_mov_b32 v14, 0xff800000
    v_lshlrev_b32 v204, 9, v1
    v_add_u32 v204, 4604, v204
    s_lshl_b32 s4, s25, 5
    s_add_u32 s4, s4, s26
    s_lshl_b32 s27, s4, 13
    s_mul_i32 s33, s4, 6144
    s_add_u32 s33, s33, 67108864
    s_add_u32 s36, s25, 1

    v_add_u32 v7, 0, v5
    v_cmp_le_u32 s[40:41], v7, v2
    v_add_u32 v7, 1, v5
    v_cmp_le_u32 s[42:43], v7, v2
    v_add_u32 v7, 2, v5
    v_cmp_le_u32 s[44:45], v7, v2
    v_add_u32 v7, 3, v5
    v_cmp_le_u32 s[46:47], v7, v2
    v_mov_b32 v112, 0
    v_mov_b32 v113, 0
    v_mov_b32 v114, 0
    v_mov_b32 v115, 0
    v_mov_b32 v116, 0
    v_mov_b32 v117, 0
    v_mov_b32 v118, 0
    v_mov_b32 v119, 0
    v_mov_b32 v120, 0
    v_mov_b32 v121, 0
    v_mov_b32 v122, 0
    v_mov_b32 v123, 0
    v_mov_b32 v124, 0
    v_mov_b32 v125, 0
    v_mov_b32 v126, 0
    v_mov_b32 v127, 0
    v_mov_b32 v128, 0
    v_mov_b32 v129, 0
    v_mov_b32 v130, 0
    v_mov_b32 v131, 0
    v_mov_b32 v132, 0
    v_mov_b32 v133, 0
    v_mov_b32 v134, 0
    v_mov_b32 v135, 0
    v_mov_b32 v136, 0
    v_mov_b32 v137, 0
    v_mov_b32 v138, 0
    v_mov_b32 v139, 0
    v_mov_b32 v140, 0
    v_mov_b32 v141, 0
    v_mov_b32 v142, 0
    v_mov_b32 v143, 0
    s_bitcmp1_b32 s97, 4
    s_cselect_b32 s96, 999, 64
    v_mov_b32 v15, -1
    s_mov_b32 s62, 0
    s_mov_b64 exec, 7
.wf_475:
    buffer_load_dword v15, v9, s[8:11], s35 offen sc1
    s_waitcnt vmcnt(0)
    v_cmp_gt_u32 vcc, s36, v15
    s_cbranch_vccz .wfd_476
    s_sleep 2
    s_add_u32 s62, s62, 1
    s_cmp_gt_u32 s62, 0x400000
    s_cbranch_scc1 .mg_end_1
    s_branch .wf_475

.wfd_476:
    s_mov_b64 exec, -1
    s_add_u32 s28, s27, 4096
    s_add_u32 s29, s27, 16777216
    s_add_u32 s30, s27, 16781312
    s_add_u32 s31, s27, 33554432
    s_add_u32 s32, s27, 33558528

    buffer_load_dwordx4 a[0:3], v8, s[8:11], s27 offen offset:0
    buffer_load_dwordx4 a[16:19], v8, s[8:11], s28 offen offset:0
    buffer_load_dwordx4 a[32:35], v8, s[8:11], s29 offen offset:0
    buffer_load_dwordx4 a[48:51], v8, s[8:11], s30 offen offset:0
    buffer_load_dwordx4 a[4:7], v8, s[8:11], s27 offen offset:1024
    buffer_load_dwordx4 a[20:23], v8, s[8:11], s28 offen offset:1024
    buffer_load_dwordx4 a[36:39], v8, s[8:11], s29 offen offset:1024
    buffer_load_dwordx4 a[52:55], v8, s[8:11], s30 offen offset:1024
    buffer_load_dwordx4 a[8:11], v8, s[8:11], s27 offen offset:2048
    buffer_load_dwordx4 a[24:27], v8, s[8:11], s28 offen offset:2048
    buffer_load_dwordx4 a[40:43], v8, s[8:11], s29 offen offset:2048
    buffer_load_dwordx4 a[56:59], v8, s[8:11], s30 offen offset:2048
    buffer_load_dwordx4 a[12:15], v8, s[8:11], s27 offen offset:3072
    buffer_load_dwordx4 a[28:31], v8, s[8:11], s28 offen offset:3072
    buffer_load_dwordx4 a[44:47], v8, s[8:11], s29 offen offset:3072
    buffer_load_dwordx4 a[60:63], v8, s[8:11], s30 offen offset:3072
    buffer_load_dwordx4 a[64:67], v8, s[8:11], s31 offen offset:0
    buffer_load_dwordx4 a[68:71], v8, s[8:11], s31 offen offset:1024
    buffer_load_dwordx4 a[72:75], v8, s[8:11], s31 offen offset:2048
    buffer_load_dwordx4 a[76:79], v8, s[8:11], s31 offen offset:3072
    buffer_load_dwordx4 a[80:83], v8, s[8:11], s32 offen offset:0
    buffer_load_dwordx4 a[84:87], v8, s[8:11], s32 offen offset:1024
    buffer_load_dwordx4 a[88:91], v8, s[8:11], s32 offen offset:2048
    buffer_load_dwordx4 a[92:95], v8, s[8:11], s32 offen offset:3072
    buffer_load_dwordx4 v[80:83], v10, s[8:11], s33 offen offset:2048 sc1
    buffer_load_dwordx4 v[84:87], v10, s[8:11], s33 offen offset:2176 sc1
    buffer_load_dwordx4 v[88:91], v10, s[8:11], s33 offen offset:3072 sc1
    buffer_load_dwordx4 v[92:95], v10, s[8:11], s33 offen offset:3200 sc1
    s_add_u32 s4, s33, 4096
    s_mov_b64 exec, s[60:61]
    buffer_load_dwordx2 v[128:129], v11, s[8:11], s4 offen offset:0 sc1
    buffer_load_dwordx2 v[130:131], v11, s[8:11], s4 offen offset:256 sc1
    buffer_load_dwordx2 v[132:133], v11, s[8:11], s4 offen offset:512 sc1
    buffer_load_dwordx2 v[134:135], v11, s[8:11], s4 offen offset:768 sc1
    buffer_load_dwordx2 v[136:137], v11, s[8:11], s4 offen offset:1024 sc1
    buffer_load_dwordx2 v[138:139], v11, s[8:11], s4 offen offset:1280 sc1
    buffer_load_dwordx2 v[140:141], v11, s[8:11], s4 offen offset:1536 sc1
    buffer_load_dwordx2 v[142:143], v11, s[8:11], s4 offen offset:1792 sc1
    s_mov_b64 exec, -1
    s_waitcnt vmcnt(0)
.att_477:
    s_mov_b32 s34, s33
    s_add_u32 s50, s27, 0
    s_add_u32 s51, s27, 4096
    s_cmp_lt_u32 s25, 60
    s_cselect_b32 s4, 4, 0
    s_cselect_b32 s5, 1048576, 0
    s_cselect_b32 s6, 786432, 0

    s_add_u32 s36, s36, s4
    s_add_u32 s27, s27, s5
    s_add_u32 s33, s33, s6
    s_waitcnt vmcnt(8)

    v_cmp_gt_u32 vcc, s36, v15
    s_cbranch_vccnz .atw_481
.atb_482:
    s_add_u32 s28, s27, 4096
    s_add_u32 s29, s27, 16777216
    s_add_u32 s30, s27, 16781312
    s_add_u32 s31, s27, 33554432
    s_add_u32 s32, s27, 33558528

    buffer_load_dwordx4 a[96:99], v8, s[8:11], s27 offen offset:0
    buffer_load_dwordx4 a[112:115], v8, s[8:11], s28 offen offset:0
    buffer_load_dwordx4 a[128:131], v8, s[8:11], s29 offen offset:0
    buffer_load_dwordx4 a[144:147], v8, s[8:11], s30 offen offset:0
    buffer_load_dwordx4 a[100:103], v8, s[8:11], s27 offen offset:1024
    buffer_load_dwordx4 a[116:119], v8, s[8:11], s28 offen offset:1024
    buffer_load_dwordx4 a[132:135], v8, s[8:11], s29 offen offset:1024
    buffer_load_dwordx4 a[148:151], v8, s[8:11], s30 offen offset:1024
    buffer_load_dwordx4 a[104:107], v8, s[8:11], s27 offen offset:2048
    buffer_load_dwordx4 a[120:123], v8, s[8:11], s28 offen offset:2048
    buffer_load_dwordx4 a[136:139], v8, s[8:11], s29 offen offset:2048
    buffer_load_dwordx4 a[152:155], v8, s[8:11], s30 offen offset:2048
    buffer_load_dwordx4 a[108:111], v8, s[8:11], s27 offen offset:3072
    buffer_load_dwordx4 a[124:127], v8, s[8:11], s28 offen offset:3072
    buffer_load_dwordx4 a[140:143], v8, s[8:11], s29 offen offset:3072
    buffer_load_dwordx4 a[156:159], v8, s[8:11], s30 offen offset:3072
    buffer_load_dwordx4 a[160:163], v8, s[8:11], s31 offen offset:0
    buffer_load_dwordx4 a[164:167], v8, s[8:11], s31 offen offset:1024
    buffer_load_dwordx4 a[168:171], v8, s[8:11], s31 offen offset:2048
    buffer_load_dwordx4 a[172:175], v8, s[8:11], s31 offen offset:3072
    buffer_load_dwordx4 a[176:179], v8, s[8:11], s32 offen offset:0
    buffer_load_dwordx4 a[180:183], v8, s[8:11], s32 offen offset:1024
    buffer_load_dwordx4 a[184:187], v8, s[8:11], s32 offen offset:2048
    buffer_load_dwordx4 a[188:191], v8, s[8:11], s32 offen offset:3072
    buffer_load_dwordx4 v[96:99], v10, s[8:11], s33 offen offset:2048 sc1
    buffer_load_dwordx4 v[100:103], v10, s[8:11], s33 offen offset:2176 sc1
    buffer_load_dwordx4 v[104:107], v10, s[8:11], s33 offen offset:3072 sc1
    buffer_load_dwordx4 v[108:111], v10, s[8:11], s33 offen offset:3200 sc1
    s_add_u32 s4, s33, 4096
    s_mov_b64 exec, s[60:61]
    buffer_load_dwordx2 v[112:113], v11, s[8:11], s4 offen offset:0 sc1
    buffer_load_dwordx2 v[114:115], v11, s[8:11], s4 offen offset:256 sc1
    buffer_load_dwordx2 v[116:117], v11, s[8:11], s4 offen offset:512 sc1
    buffer_load_dwordx2 v[118:119], v11, s[8:11], s4 offen offset:768 sc1
    buffer_load_dwordx2 v[120:121], v11, s[8:11], s4 offen offset:1024 sc1
    buffer_load_dwordx2 v[122:123], v11, s[8:11], s4 offen offset:1280 sc1
    buffer_load_dwordx2 v[124:125], v11, s[8:11], s4 offen offset:1536 sc1
    buffer_load_dwordx2 v[126:127], v11, s[8:11], s4 offen offset:1792 sc1
    s_mov_b64 exec, -1
    v_mfma_f32_16x16x32_bf16 v[144:147], a[32:35], a[0:3], 0
    v_mfma_f32_16x16x32_bf16 v[156:159], a[32:35], a[16:19], 0
    v_mfma_f32_16x16x32_bf16 v[160:163], a[48:51], a[16:19], 0
    v_mfma_f32_16x16x32_bf16 v[144:147], a[36:39], a[4:7], v[144:147]
    v_mfma_f32_16x16x32_bf16 v[156:159], a[36:39], a[20:23], v[156:159]
    v_mfma_f32_16x16x32_bf16 v[160:163], a[52:55], a[20:23], v[160:163]
    v_mfma_f32_16x16x32_bf16 v[144:147], a[40:43], a[8:11], v[144:147]
    v_mfma_f32_16x16x32_bf16 v[156:159], a[40:43], a[24:27], v[156:159]
    v_mfma_f32_16x16x32_bf16 v[160:163], a[56:59], a[24:27], v[160:163]
    v_mfma_f32_16x16x32_bf16 v[144:147], a[44:47], a[12:15], v[144:147]
    v_mfma_f32_16x16x32_bf16 v[156:159], a[44:47], a[28:31], v[156:159]
    v_mfma_f32_16x16x32_bf16 v[160:163], a[60:63], a[28:31], v[160:163]
    s_nop 7
    v_cvt_pk_bf16_f32 v168, v144, v145
    v_cvt_pk_bf16_f32 v170, v146, v147
    v_and_b32 v169, 0xffff0000, v168
    v_lshlrev_b32 v168, 16, v168
    v_and_b32 v171, 0xffff0000, v170
    v_lshlrev_b32 v170, 16, v170
    v_mul_f32 v168, s37, v168
    v_mul_f32 v169, s37, v169
    v_mul_f32 v170, s37, v170
    v_mul_f32 v171, s37, v171
    v_cvt_pk_bf16_f32 v144, v168, v169
    v_cvt_pk_bf16_f32 v146, v170, v171
    v_and_b32 v145, 0xffff0000, v144
    v_lshlrev_b32 v144, 16, v144
    v_and_b32 v147, 0xffff0000, v146
    v_lshlrev_b32 v146, 16, v146
    v_cvt_pk_bf16_f32 v192, v156, v157
    v_cvt_pk_bf16_f32 v194, v158, v159
    v_cvt_pk_bf16_f32 v196, v160, v161
    v_cvt_pk_bf16_f32 v198, v162, v163
    v_and_b32 v193, 0xffff0000, v192
    v_lshlrev_b32 v192, 16, v192
    v_and_b32 v195, 0xffff0000, v194
    v_lshlrev_b32 v194, 16, v194
    v_and_b32 v197, 0xffff0000, v196
    v_lshlrev_b32 v196, 16, v196
    v_and_b32 v199, 0xffff0000, v198
    v_lshlrev_b32 v198, 16, v198
    v_mul_f32 v192, s37, v192
    v_mul_f32 v193, s37, v193
    v_mul_f32 v194, s37, v194
    v_mul_f32 v195, s37, v195
    v_mul_f32 v196, s37, v196
    v_mul_f32 v197, s37, v197
    v_mul_f32 v198, s37, v198
    v_mul_f32 v199, s37, v199
    v_cvt_pk_bf16_f32 v156, v192, v193
    v_cvt_pk_bf16_f32 v158, v194, v195
    v_cvt_pk_bf16_f32 v160, v196, v197
    v_cvt_pk_bf16_f32 v162, v198, v199
    v_and_b32 v157, 0xffff0000, v156
    v_lshlrev_b32 v156, 16, v156
    v_and_b32 v159, 0xffff0000, v158
    v_lshlrev_b32 v158, 16, v158
    v_and_b32 v161, 0xffff0000, v160
    v_lshlrev_b32 v160, 16, v160
    v_and_b32 v163, 0xffff0000, v162
    v_lshlrev_b32 v162, 16, v162
    v_cndmask_b32 v144, v14, v144, s[40:41]
    v_cndmask_b32 v145, v14, v145, s[42:43]
    v_cndmask_b32 v146, v14, v146, s[44:45]
    v_cndmask_b32 v147, v14, v147, s[46:47]
    v_cndmask_b32 v160, v14, v160, s[40:41]
    v_cndmask_b32 v161, v14, v161, s[42:43]
    v_cndmask_b32 v162, v14, v162, s[44:45]
    v_cndmask_b32 v163, v14, v163, s[46:47]
    s_mov_b32 s62, 0
.kmp_483:
    v_max3_u32 v4, v80, v81, v82
    v_max3_u32 v5, v83, v84, v85
    v_max3_u32 v4, v4, v86, v87
    v_max3_u32 v5, v5, v88, v89
    v_max3_u32 v4, v4, v90, v91
    v_max3_u32 v5, v5, v92, v93
    v_max3_u32 v4, v4, v94, v95
    v_max3_u32 v5, v5, v128, v129
    v_max3_u32 v4, v4, v130, v131
    v_max3_u32 v5, v5, v132, v133
    v_max3_u32 v4, v4, v134, v135
    v_max3_u32 v5, v5, v136, v137
    v_max3_u32 v4, v4, v138, v139
    v_max3_u32 v5, v5, v140, v141
    v_max3_u32 v4, v4, v142, v143
    v_max_u32 v4, v4, v5
    v_cmp_eq_u32 vcc, -1, v4
    s_cbranch_vccnz .kmf_484

    v_mfma_f32_16x16x32_bf16 v[152:155], v[80:83], a[0:3], 0
    v_mfma_f32_16x16x32_bf16 v[164:167], v[80:83], a[16:19], 0
    v_mfma_f32_16x16x32_bf16 v[152:155], v[84:87], a[4:7], v[152:155]
    v_mfma_f32_16x16x32_bf16 v[164:167], v[84:87], a[20:23], v[164:167]
    v_mfma_f32_16x16x32_bf16 v[152:155], v[88:91], a[8:11], v[152:155]
    v_mfma_f32_16x16x32_bf16 v[164:167], v[88:91], a[24:27], v[164:167]
    v_mfma_f32_16x16x32_bf16 v[152:155], v[92:95], a[12:15], v[152:155]
    v_mfma_f32_16x16x32_bf16 v[164:167], v[92:95], a[28:31], v[164:167]
    s_nop 5
    v_cvt_pk_bf16_f32 v176, v152, v153
    v_cvt_pk_bf16_f32 v178, v154, v155
    v_and_b32 v177, 0xffff0000, v176
    v_lshlrev_b32 v176, 16, v176
    v_and_b32 v179, 0xffff0000, v178
    v_lshlrev_b32 v178, 16, v178
    v_mul_f32 v176, s37, v176
    v_mul_f32 v177, s37, v177
    v_mul_f32 v178, s37, v178
    v_mul_f32 v179, s37, v179
    v_cvt_pk_bf16_f32 v152, v176, v177
    v_cvt_pk_bf16_f32 v154, v178, v179
    v_and_b32 v153, 0xffff0000, v152
    v_lshlrev_b32 v152, 16, v152
    v_and_b32 v155, 0xffff0000, v154
    v_lshlrev_b32 v154, 16, v154
    v_cndmask_b32 v152, v14, v152, s[60:61]
    v_cndmask_b32 v153, v14, v153, s[60:61]
    v_cndmask_b32 v154, v14, v154, s[60:61]
    v_cndmask_b32 v155, v14, v155, s[60:61]
    v_cvt_pk_bf16_f32 v200, v164, v165
    v_cvt_pk_bf16_f32 v202, v166, v167
    v_and_b32 v201, 0xffff0000, v200
    v_lshlrev_b32 v200, 16, v200
    v_and_b32 v203, 0xffff0000, v202
    v_lshlrev_b32 v202, 16, v202
    v_mul_f32 v200, s37, v200
    v_mul_f32 v201, s37, v201
    v_mul_f32 v202, s37, v202
    v_mul_f32 v203, s37, v203
    v_cvt_pk_bf16_f32 v164, v200, v201
    v_cvt_pk_bf16_f32 v166, v202, v203
    v_and_b32 v165, 0xffff0000, v164
    v_lshlrev_b32 v164, 16, v164
    v_and_b32 v167, 0xffff0000, v166
    v_lshlrev_b32 v166, 16, v166
    v_cndmask_b32 v164, v14, v164, s[60:61]
    v_cndmask_b32 v165, v14, v165, s[60:61]
    v_cndmask_b32 v166, v14, v166, s[60:61]
    v_cndmask_b32 v167, v14, v167, s[60:61]
    v_max3_f32 v4, v144, v145, v146
    v_max3_f32 v5, v147, v152, v153
    v_max3_f32 v4, v4, v154, v155
    v_max_f32 v4, v4, v5

    v_max3_f32 v6, v156, v157, v158
    v_max3_f32 v7, v159, v160, v161
    v_max3_f32 v6, v6, v162, v163
    v_max3_f32 v7, v7, v164, v165
    v_max3_f32 v6, v6, v166, v167
    v_max_f32 v6, v6, v7

    v_mov_b32 v5, v4
    v_mov_b32 v7, v6
    s_nop 0
    v_permlane32_swap_b32 v4, v5
    v_permlane32_swap_b32 v6, v7
    v_max_f32 v4, v4, v5
    v_max_f32 v6, v6, v7

    v_mov_b32 v5, v4
    v_mov_b32 v7, v6
    s_nop 0
    v_permlane16_swap_b32 v4, v5
    v_permlane16_swap_b32 v6, v7
    v_max_f32 v4, v4, v5
    v_max_f32 v6, v6, v7

    v_mul_f32 v4, s38, v4
    v_mul_f32 v6, s38, v6
    v_fma_f32 v168, v144, s38, -v4
    v_fma_f32 v169, v145, s38, -v4
    v_fma_f32 v170, v146, s38, -v4
    v_fma_f32 v171, v147, s38, -v4
    v_fma_f32 v176, v152, s38, -v4
    v_fma_f32 v177, v153, s38, -v4
    v_fma_f32 v178, v154, s38, -v4
    v_fma_f32 v179, v155, s38, -v4
    v_fma_f32 v192, v156, s38, -v6
    v_fma_f32 v193, v157, s38, -v6
    v_fma_f32 v194, v158, s38, -v6
    v_fma_f32 v195, v159, s38, -v6
    v_fma_f32 v196, v160, s38, -v6
    v_fma_f32 v197, v161, s38, -v6
    v_fma_f32 v198, v162, s38, -v6
    v_fma_f32 v199, v163, s38, -v6
    v_fma_f32 v200, v164, s38, -v6
    v_fma_f32 v201, v165, s38, -v6
    v_fma_f32 v202, v166, s38, -v6
    v_fma_f32 v203, v167, s38, -v6
    v_exp_f32 v168, v168
    v_exp_f32 v169, v169
    v_exp_f32 v170, v170
    v_exp_f32 v171, v171
    v_exp_f32 v176, v176
    v_exp_f32 v177, v177
    v_exp_f32 v178, v178
    v_exp_f32 v179, v179
    v_exp_f32 v192, v192
    v_exp_f32 v193, v193
    v_exp_f32 v194, v194
    v_exp_f32 v195, v195
    v_exp_f32 v196, v196
    v_exp_f32 v197, v197
    v_exp_f32 v198, v198
    v_exp_f32 v199, v199
    v_exp_f32 v200, v200
    v_exp_f32 v201, v201
    v_exp_f32 v202, v202
    v_exp_f32 v203, v203
    v_add_f32 v4, v168, v169
    v_add_f32 v5, v170, v171
    v_add_f32 v4, v4, v176
    v_add_f32 v5, v5, v177
    v_add_f32 v4, v4, v178
    v_add_f32 v5, v5, v179
    v_add_f32 v4, v4, v5
    v_add_f32 v6, v192, v193
    v_add_f32 v7, v194, v195
    v_add_f32 v6, v6, v196
    v_add_f32 v7, v7, v197
    v_add_f32 v6, v6, v198
    v_add_f32 v7, v7, v199
    v_add_f32 v6, v6, v200
    v_add_f32 v7, v7, v201
    v_add_f32 v6, v6, v202
    v_add_f32 v7, v7, v203
    v_add_f32 v6, v6, v7
    v_mov_b32 v5, v4
    v_mov_b32 v7, v6
    s_nop 0
    v_permlane32_swap_b32 v4, v5
    v_permlane32_swap_b32 v6, v7
    v_add_f32 v4, v4, v5
    v_add_f32 v6, v6, v7

    v_mov_b32 v5, v4
    v_mov_b32 v7, v6
    s_nop 0
    v_permlane16_swap_b32 v4, v5
    v_permlane16_swap_b32 v6, v7
    v_add_f32 v4, v4, v5
    v_add_f32 v6, v6, v7

    v_rcp_f32 v4, v4
    v_rcp_f32 v6, v6
    v_mov_b32 v182, 0
    v_mov_b32 v183, 0
    v_mul_f32 v168, v4, v168
    v_mul_f32 v169, v4, v169
    v_mul_f32 v170, v4, v170
    v_mul_f32 v171, v4, v171
    v_mul_f32 v176, v4, v176
    v_mul_f32 v177, v4, v177
    v_mul_f32 v178, v4, v178
    v_mul_f32 v179, v4, v179
    v_cvt_pk_bf16_f32 v180, v168, v169
    v_cvt_pk_bf16_f32 v181, v170, v171
    v_cvt_pk_bf16_f32 v184, v176, v177
    v_cvt_pk_bf16_f32 v185, v178, v179
    v_mul_f32 v192, v6, v192
    v_mul_f32 v193, v6, v193
    v_mul_f32 v194, v6, v194
    v_mul_f32 v195, v6, v195
    v_mul_f32 v196, v6, v196
    v_mul_f32 v197, v6, v197
    v_mul_f32 v198, v6, v198
    v_mul_f32 v199, v6, v199
    v_mul_f32 v200, v6, v200
    v_mul_f32 v201, v6, v201
    v_mul_f32 v202, v6, v202
    v_mul_f32 v203, v6, v203
    v_cvt_pk_bf16_f32 v186, v192, v193
    v_cvt_pk_bf16_f32 v187, v194, v195
    v_cvt_pk_bf16_f32 v188, v196, v197
    v_cvt_pk_bf16_f32 v189, v198, v199
    v_cvt_pk_bf16_f32 v190, v200, v201
    v_cvt_pk_bf16_f32 v191, v202, v203
    s_add_u32 s25, s25, 4

    v_mfma_f32_16x16x32_bf16 v[16:19], a[64:67], v[180:183], 0
    v_mfma_f32_16x16x32_bf16 v[20:23], a[68:71], v[180:183], 0
    v_mfma_f32_16x16x32_bf16 v[24:27], a[72:75], v[180:183], 0
    v_mfma_f32_16x16x32_bf16 v[28:31], a[76:79], v[180:183], 0
    v_mfma_f32_16x16x32_bf16 v[32:35], a[80:83], v[180:183], 0
    v_mfma_f32_16x16x32_bf16 v[36:39], a[84:87], v[180:183], 0
    v_mfma_f32_16x16x32_bf16 v[40:43], a[88:91], v[180:183], 0
    v_mfma_f32_16x16x32_bf16 v[44:47], a[92:95], v[180:183], 0
    v_mfma_f32_16x16x32_bf16 v[48:51], a[64:67], v[186:189], 0
    v_mfma_f32_16x16x32_bf16 v[52:55], a[68:71], v[186:189], 0
    v_mfma_f32_16x16x32_bf16 v[56:59], a[72:75], v[186:189], 0
    v_mfma_f32_16x16x32_bf16 v[60:63], a[76:79], v[186:189], 0
    v_mfma_f32_16x16x32_bf16 v[64:67], a[80:83], v[186:189], 0
    v_mfma_f32_16x16x32_bf16 v[68:71], a[84:87], v[186:189], 0
    v_mfma_f32_16x16x32_bf16 v[72:75], a[88:91], v[186:189], 0
    v_mfma_f32_16x16x32_bf16 v[76:79], a[92:95], v[186:189], 0
    s_waitcnt vmcnt(36)
    s_bitcmp1_b32 s97, 4
    s_mov_b64 exec, 1
    s_cbranch_scc1 .fs_485
    buffer_store_dword v12, v13, s[8:11], s92 offen
.fj_486:
    s_mov_b64 exec, -1
    s_cmp_lt_u32 s25, s96
    s_cbranch_scc1 .os_487
    v_mfma_f32_16x16x16_bf16 v[16:19], v[128:129], v[184:185], v[16:19]
    v_mfma_f32_16x16x16_bf16 v[20:23], v[130:131], v[184:185], v[20:23]
    v_add_u32 v12, 1, v12
    v_mfma_f32_16x16x16_bf16 v[24:27], v[132:133], v[184:185], v[24:27]
    v_mfma_f32_16x16x16_bf16 v[28:31], v[134:135], v[184:185], v[28:31]
    v_mfma_f32_16x16x16_bf16 v[32:35], v[136:137], v[184:185], v[32:35]
    v_mfma_f32_16x16x16_bf16 v[36:39], v[138:139], v[184:185], v[36:39]
    v_cvt_pk_bf16_f32 v208, v16, v17
    v_cvt_pk_bf16_f32 v209, v18, v19
    v_cvt_pk_bf16_f32 v210, v20, v21
    v_cvt_pk_bf16_f32 v211, v22, v23
    buffer_store_dwordx4 v[208:211], v8, s[8:11], s50 offen offset:0
    v_mfma_f32_16x16x16_bf16 v[40:43], v[140:141], v[184:185], v[40:43]
    v_mfma_f32_16x16x16_bf16 v[44:47], v[142:143], v[184:185], v[44:47]
    v_cvt_pk_bf16_f32 v212, v24, v25
    v_cvt_pk_bf16_f32 v213, v26, v27
    v_cvt_pk_bf16_f32 v214, v28, v29
    v_cvt_pk_bf16_f32 v215, v30, v31
    buffer_store_dwordx4 v[212:215], v8, s[8:11], s50 offen offset:1024
    v_mfma_f32_16x16x16_bf16 v[48:51], v[128:129], v[190:191], v[48:51]
    v_mfma_f32_16x16x16_bf16 v[52:55], v[130:131], v[190:191], v[52:55]
    v_cvt_pk_bf16_f32 v216, v32, v33
    v_cvt_pk_bf16_f32 v217, v34, v35
    v_cvt_pk_bf16_f32 v218, v36, v37
    v_cvt_pk_bf16_f32 v219, v38, v39
    buffer_store_dwordx4 v[216:219], v8, s[8:11], s50 offen offset:2048
    v_mfma_f32_16x16x16_bf16 v[56:59], v[132:133], v[190:191], v[56:59]
    v_mfma_f32_16x16x16_bf16 v[60:63], v[134:135], v[190:191], v[60:63]
    v_cvt_pk_bf16_f32 v220, v40, v41
    v_cvt_pk_bf16_f32 v221, v42, v43
    v_cvt_pk_bf16_f32 v222, v44, v45
    v_cvt_pk_bf16_f32 v223, v46, v47
    buffer_store_dwordx4 v[220:223], v8, s[8:11], s50 offen offset:3072
    v_mfma_f32_16x16x16_bf16 v[64:67], v[136:137], v[190:191], v[64:67]
    v_mfma_f32_16x16x16_bf16 v[68:71], v[138:139], v[190:191], v[68:71]
    v_cvt_pk_bf16_f32 v224, v48, v49
    v_cvt_pk_bf16_f32 v225, v50, v51
    v_cvt_pk_bf16_f32 v226, v52, v53
    v_cvt_pk_bf16_f32 v227, v54, v55
    buffer_store_dwordx4 v[224:227], v8, s[8:11], s51 offen offset:0
    v_mfma_f32_16x16x16_bf16 v[72:75], v[140:141], v[190:191], v[72:75]
    v_mfma_f32_16x16x16_bf16 v[76:79], v[142:143], v[190:191], v[76:79]
    v_cvt_pk_bf16_f32 v228, v56, v57
    v_cvt_pk_bf16_f32 v229, v58, v59
    v_cvt_pk_bf16_f32 v230, v60, v61
    v_cvt_pk_bf16_f32 v231, v62, v63
    buffer_store_dwordx4 v[228:231], v8, s[8:11], s51 offen offset:1024
    s_nop 3
    v_cvt_pk_bf16_f32 v232, v64, v65
    v_cvt_pk_bf16_f32 v233, v66, v67
    v_cvt_pk_bf16_f32 v234, v68, v69
    v_cvt_pk_bf16_f32 v235, v70, v71
    buffer_store_dwordx4 v[232:235], v8, s[8:11], s51 offen offset:2048
    v_cvt_pk_bf16_f32 v236, v72, v73
    v_cvt_pk_bf16_f32 v237, v74, v75
    v_cvt_pk_bf16_f32 v238, v76, v77
    v_cvt_pk_bf16_f32 v239, v78, v79
    buffer_store_dwordx4 v[236:239], v8, s[8:11], s51 offen offset:3072
.oj_488:
    s_cmp_eq_u32 s25, 63
    s_cbranch_scc1 .ah1_479
    s_mov_b32 s34, s33
    s_add_u32 s50, s27, 0
    s_add_u32 s51, s27, 4096
    s_cmp_lt_u32 s25, 60
    s_cselect_b32 s4, 4, 0
    s_cselect_b32 s5, 1048576, 0
    s_cselect_b32 s6, 786432, 0

    s_cmp_eq_u32 s25, 60
    s_cselect_b32 s4, 3, s4
    s_cselect_b32 s5, 786432, s5
    s_cselect_b32 s6, 589824, s6

    s_add_u32 s36, s36, s4
    s_add_u32 s27, s27, s5
    s_add_u32 s33, s33, s6
    s_waitcnt vmcnt(8)

    v_cmp_gt_u32 vcc, s36, v15
    s_cbranch_vccnz .atw_489
.atb_490:
    s_add_u32 s28, s27, 4096
    s_add_u32 s29, s27, 16777216
    s_add_u32 s30, s27, 16781312
    s_add_u32 s31, s27, 33554432
    s_add_u32 s32, s27, 33558528

    buffer_load_dwordx4 a[0:3], v8, s[8:11], s27 offen offset:0
    buffer_load_dwordx4 a[16:19], v8, s[8:11], s28 offen offset:0
    buffer_load_dwordx4 a[32:35], v8, s[8:11], s29 offen offset:0
    buffer_load_dwordx4 a[48:51], v8, s[8:11], s30 offen offset:0
    buffer_load_dwordx4 a[4:7], v8, s[8:11], s27 offen offset:1024
    buffer_load_dwordx4 a[20:23], v8, s[8:11], s28 offen offset:1024
    buffer_load_dwordx4 a[36:39], v8, s[8:11], s29 offen offset:1024
    buffer_load_dwordx4 a[52:55], v8, s[8:11], s30 offen offset:1024
    buffer_load_dwordx4 a[8:11], v8, s[8:11], s27 offen offset:2048
    buffer_load_dwordx4 a[24:27], v8, s[8:11], s28 offen offset:2048
    buffer_load_dwordx4 a[40:43], v8, s[8:11], s29 offen offset:2048
    buffer_load_dwordx4 a[56:59], v8, s[8:11], s30 offen offset:2048
    buffer_load_dwordx4 a[12:15], v8, s[8:11], s27 offen offset:3072
    buffer_load_dwordx4 a[28:31], v8, s[8:11], s28 offen offset:3072
    buffer_load_dwordx4 a[44:47], v8, s[8:11], s29 offen offset:3072
    buffer_load_dwordx4 a[60:63], v8, s[8:11], s30 offen offset:3072
    buffer_load_dwordx4 a[64:67], v8, s[8:11], s31 offen offset:0
    buffer_load_dwordx4 a[68:71], v8, s[8:11], s31 offen offset:1024
    buffer_load_dwordx4 a[72:75], v8, s[8:11], s31 offen offset:2048
    buffer_load_dwordx4 a[76:79], v8, s[8:11], s31 offen offset:3072
    buffer_load_dwordx4 a[80:83], v8, s[8:11], s32 offen offset:0
    buffer_load_dwordx4 a[84:87], v8, s[8:11], s32 offen offset:1024
    buffer_load_dwordx4 a[88:91], v8, s[8:11], s32 offen offset:2048
    buffer_load_dwordx4 a[92:95], v8, s[8:11], s32 offen offset:3072
    buffer_load_dwordx4 v[80:83], v10, s[8:11], s33 offen offset:2048 sc1
    buffer_load_dwordx4 v[84:87], v10, s[8:11], s33 offen offset:2176 sc1
    buffer_load_dwordx4 v[88:91], v10, s[8:11], s33 offen offset:3072 sc1
    buffer_load_dwordx4 v[92:95], v10, s[8:11], s33 offen offset:3200 sc1
    s_add_u32 s4, s33, 4096
    s_mov_b64 exec, s[60:61]
    buffer_load_dwordx2 v[128:129], v11, s[8:11], s4 offen offset:0 sc1
    buffer_load_dwordx2 v[130:131], v11, s[8:11], s4 offen offset:256 sc1
    buffer_load_dwordx2 v[132:133], v11, s[8:11], s4 offen offset:512 sc1
    buffer_load_dwordx2 v[134:135], v11, s[8:11], s4 offen offset:768 sc1
    buffer_load_dwordx2 v[136:137], v11, s[8:11], s4 offen offset:1024 sc1
    buffer_load_dwordx2 v[138:139], v11, s[8:11], s4 offen offset:1280 sc1
    buffer_load_dwordx2 v[140:141], v11, s[8:11], s4 offen offset:1536 sc1
    buffer_load_dwordx2 v[142:143], v11, s[8:11], s4 offen offset:1792 sc1
    s_mov_b64 exec, -1
    v_mfma_f32_16x16x32_bf16 v[144:147], a[128:131], a[96:99], 0
    v_mfma_f32_16x16x32_bf16 v[156:159], a[128:131], a[112:115], 0
    v_mfma_f32_16x16x32_bf16 v[160:163], a[144:147], a[112:115], 0
    v_mfma_f32_16x16x32_bf16 v[144:147], a[132:135], a[100:103], v[144:147]
    v_mfma_f32_16x16x32_bf16 v[156:159], a[132:135], a[116:119], v[156:159]
    v_mfma_f32_16x16x32_bf16 v[160:163], a[148:151], a[116:119], v[160:163]
    v_mfma_f32_16x16x32_bf16 v[144:147], a[136:139], a[104:107], v[144:147]
    v_mfma_f32_16x16x32_bf16 v[156:159], a[136:139], a[120:123], v[156:159]
    v_mfma_f32_16x16x32_bf16 v[160:163], a[152:155], a[120:123], v[160:163]
    v_mfma_f32_16x16x32_bf16 v[144:147], a[140:143], a[108:111], v[144:147]
    v_mfma_f32_16x16x32_bf16 v[156:159], a[140:143], a[124:127], v[156:159]
    v_mfma_f32_16x16x32_bf16 v[160:163], a[156:159], a[124:127], v[160:163]
    s_nop 7
    v_cvt_pk_bf16_f32 v168, v144, v145
    v_cvt_pk_bf16_f32 v170, v146, v147
    v_and_b32 v169, 0xffff0000, v168
    v_lshlrev_b32 v168, 16, v168
    v_and_b32 v171, 0xffff0000, v170
    v_lshlrev_b32 v170, 16, v170
    v_mul_f32 v168, s37, v168
    v_mul_f32 v169, s37, v169
    v_mul_f32 v170, s37, v170
    v_mul_f32 v171, s37, v171
    v_cvt_pk_bf16_f32 v144, v168, v169
    v_cvt_pk_bf16_f32 v146, v170, v171
    v_and_b32 v145, 0xffff0000, v144
    v_lshlrev_b32 v144, 16, v144
    v_and_b32 v147, 0xffff0000, v146
    v_lshlrev_b32 v146, 16, v146
    v_cvt_pk_bf16_f32 v192, v156, v157
    v_cvt_pk_bf16_f32 v194, v158, v159
    v_cvt_pk_bf16_f32 v196, v160, v161
    v_cvt_pk_bf16_f32 v198, v162, v163
    v_and_b32 v193, 0xffff0000, v192
    v_lshlrev_b32 v192, 16, v192
    v_and_b32 v195, 0xffff0000, v194
    v_lshlrev_b32 v194, 16, v194
    v_and_b32 v197, 0xffff0000, v196
    v_lshlrev_b32 v196, 16, v196
    v_and_b32 v199, 0xffff0000, v198
    v_lshlrev_b32 v198, 16, v198
    v_mul_f32 v192, s37, v192
    v_mul_f32 v193, s37, v193
    v_mul_f32 v194, s37, v194
    v_mul_f32 v195, s37, v195
    v_mul_f32 v196, s37, v196
    v_mul_f32 v197, s37, v197
    v_mul_f32 v198, s37, v198
    v_mul_f32 v199, s37, v199
    v_cvt_pk_bf16_f32 v156, v192, v193
    v_cvt_pk_bf16_f32 v158, v194, v195
    v_cvt_pk_bf16_f32 v160, v196, v197
    v_cvt_pk_bf16_f32 v162, v198, v199
    v_and_b32 v157, 0xffff0000, v156
    v_lshlrev_b32 v156, 16, v156
    v_and_b32 v159, 0xffff0000, v158
    v_lshlrev_b32 v158, 16, v158
    v_and_b32 v161, 0xffff0000, v160
    v_lshlrev_b32 v160, 16, v160
    v_and_b32 v163, 0xffff0000, v162
    v_lshlrev_b32 v162, 16, v162
    v_cndmask_b32 v144, v14, v144, s[40:41]
    v_cndmask_b32 v145, v14, v145, s[42:43]
    v_cndmask_b32 v146, v14, v146, s[44:45]
    v_cndmask_b32 v147, v14, v147, s[46:47]
    v_cndmask_b32 v160, v14, v160, s[40:41]
    v_cndmask_b32 v161, v14, v161, s[42:43]
    v_cndmask_b32 v162, v14, v162, s[44:45]
    v_cndmask_b32 v163, v14, v163, s[46:47]
    s_mov_b32 s62, 0
.kmp_491:
    v_max3_u32 v4, v96, v97, v98
    v_max3_u32 v5, v99, v100, v101
    v_max3_u32 v4, v4, v102, v103
    v_max3_u32 v5, v5, v104, v105
    v_max3_u32 v4, v4, v106, v107
    v_max3_u32 v5, v5, v108, v109
    v_max3_u32 v4, v4, v110, v111
    v_max3_u32 v5, v5, v112, v113
    v_max3_u32 v4, v4, v114, v115
    v_max3_u32 v5, v5, v116, v117
    v_max3_u32 v4, v4, v118, v119
    v_max3_u32 v5, v5, v120, v121
    v_max3_u32 v4, v4, v122, v123
    v_max3_u32 v5, v5, v124, v125
    v_max3_u32 v4, v4, v126, v127
    v_max_u32 v4, v4, v5
    v_cmp_eq_u32 vcc, -1, v4
    s_cbranch_vccnz .kmf_492

    v_mfma_f32_16x16x32_bf16 v[152:155], v[96:99], a[96:99], 0
    v_mfma_f32_16x16x32_bf16 v[164:167], v[96:99], a[112:115], 0
    v_mfma_f32_16x16x32_bf16 v[152:155], v[100:103], a[100:103], v[152:155]
    v_mfma_f32_16x16x32_bf16 v[164:167], v[100:103], a[116:119], v[164:167]
    v_mfma_f32_16x16x32_bf16 v[152:155], v[104:107], a[104:107], v[152:155]
    v_mfma_f32_16x16x32_bf16 v[164:167], v[104:107], a[120:123], v[164:167]
    v_mfma_f32_16x16x32_bf16 v[152:155], v[108:111], a[108:111], v[152:155]
    v_mfma_f32_16x16x32_bf16 v[164:167], v[108:111], a[124:127], v[164:167]
    s_nop 5
    v_cvt_pk_bf16_f32 v176, v152, v153
    v_cvt_pk_bf16_f32 v178, v154, v155
    v_and_b32 v177, 0xffff0000, v176
    v_lshlrev_b32 v176, 16, v176
    v_and_b32 v179, 0xffff0000, v178
    v_lshlrev_b32 v178, 16, v178
    v_mul_f32 v176, s37, v176
    v_mul_f32 v177, s37, v177
    v_mul_f32 v178, s37, v178
    v_mul_f32 v179, s37, v179
    v_cvt_pk_bf16_f32 v152, v176, v177
    v_cvt_pk_bf16_f32 v154, v178, v179
    v_and_b32 v153, 0xffff0000, v152
    v_lshlrev_b32 v152, 16, v152
    v_and_b32 v155, 0xffff0000, v154
    v_lshlrev_b32 v154, 16, v154
    v_cndmask_b32 v152, v14, v152, s[60:61]
    v_cndmask_b32 v153, v14, v153, s[60:61]
    v_cndmask_b32 v154, v14, v154, s[60:61]
    v_cndmask_b32 v155, v14, v155, s[60:61]
    v_cvt_pk_bf16_f32 v200, v164, v165
    v_cvt_pk_bf16_f32 v202, v166, v167
    v_and_b32 v201, 0xffff0000, v200
    v_lshlrev_b32 v200, 16, v200
    v_and_b32 v203, 0xffff0000, v202
    v_lshlrev_b32 v202, 16, v202
    v_mul_f32 v200, s37, v200
    v_mul_f32 v201, s37, v201
    v_mul_f32 v202, s37, v202
    v_mul_f32 v203, s37, v203
    v_cvt_pk_bf16_f32 v164, v200, v201
    v_cvt_pk_bf16_f32 v166, v202, v203
    v_and_b32 v165, 0xffff0000, v164
    v_lshlrev_b32 v164, 16, v164
    v_and_b32 v167, 0xffff0000, v166
    v_lshlrev_b32 v166, 16, v166
    v_cndmask_b32 v164, v14, v164, s[60:61]
    v_cndmask_b32 v165, v14, v165, s[60:61]
    v_cndmask_b32 v166, v14, v166, s[60:61]
    v_cndmask_b32 v167, v14, v167, s[60:61]
    v_max3_f32 v4, v144, v145, v146
    v_max3_f32 v5, v147, v152, v153
    v_max3_f32 v4, v4, v154, v155
    v_max_f32 v4, v4, v5

    v_max3_f32 v6, v156, v157, v158
    v_max3_f32 v7, v159, v160, v161
    v_max3_f32 v6, v6, v162, v163
    v_max3_f32 v7, v7, v164, v165
    v_max3_f32 v6, v6, v166, v167
    v_max_f32 v6, v6, v7

    v_mov_b32 v5, v4
    v_mov_b32 v7, v6
    s_nop 0
    v_permlane32_swap_b32 v4, v5
    v_permlane32_swap_b32 v6, v7
    v_max_f32 v4, v4, v5
    v_max_f32 v6, v6, v7

    v_mov_b32 v5, v4
    v_mov_b32 v7, v6
    s_nop 0
    v_permlane16_swap_b32 v4, v5
    v_permlane16_swap_b32 v6, v7
    v_max_f32 v4, v4, v5
    v_max_f32 v6, v6, v7

    v_mul_f32 v4, s38, v4
    v_mul_f32 v6, s38, v6
    v_fma_f32 v168, v144, s38, -v4
    v_fma_f32 v169, v145, s38, -v4
    v_fma_f32 v170, v146, s38, -v4
    v_fma_f32 v171, v147, s38, -v4
    v_fma_f32 v176, v152, s38, -v4
    v_fma_f32 v177, v153, s38, -v4
    v_fma_f32 v178, v154, s38, -v4
    v_fma_f32 v179, v155, s38, -v4
    v_fma_f32 v192, v156, s38, -v6
    v_fma_f32 v193, v157, s38, -v6
    v_fma_f32 v194, v158, s38, -v6
    v_fma_f32 v195, v159, s38, -v6
    v_fma_f32 v196, v160, s38, -v6
    v_fma_f32 v197, v161, s38, -v6
    v_fma_f32 v198, v162, s38, -v6
    v_fma_f32 v199, v163, s38, -v6
    v_fma_f32 v200, v164, s38, -v6
    v_fma_f32 v201, v165, s38, -v6
    v_fma_f32 v202, v166, s38, -v6
    v_fma_f32 v203, v167, s38, -v6
    v_exp_f32 v168, v168
    v_exp_f32 v169, v169
    v_exp_f32 v170, v170
    v_exp_f32 v171, v171
    v_exp_f32 v176, v176
    v_exp_f32 v177, v177
    v_exp_f32 v178, v178
    v_exp_f32 v179, v179
    v_exp_f32 v192, v192
    v_exp_f32 v193, v193
    v_exp_f32 v194, v194
    v_exp_f32 v195, v195
    v_exp_f32 v196, v196
    v_exp_f32 v197, v197
    v_exp_f32 v198, v198
    v_exp_f32 v199, v199
    v_exp_f32 v200, v200
    v_exp_f32 v201, v201
    v_exp_f32 v202, v202
    v_exp_f32 v203, v203
    v_add_f32 v4, v168, v169
    v_add_f32 v5, v170, v171
    v_add_f32 v4, v4, v176
    v_add_f32 v5, v5, v177
    v_add_f32 v4, v4, v178
    v_add_f32 v5, v5, v179
    v_add_f32 v4, v4, v5
    v_add_f32 v6, v192, v193
    v_add_f32 v7, v194, v195
    v_add_f32 v6, v6, v196
    v_add_f32 v7, v7, v197
    v_add_f32 v6, v6, v198
    v_add_f32 v7, v7, v199
    v_add_f32 v6, v6, v200
    v_add_f32 v7, v7, v201
    v_add_f32 v6, v6, v202
    v_add_f32 v7, v7, v203
    v_add_f32 v6, v6, v7
    v_mov_b32 v5, v4
    v_mov_b32 v7, v6
    s_nop 0
    v_permlane32_swap_b32 v4, v5
    v_permlane32_swap_b32 v6, v7
    v_add_f32 v4, v4, v5
    v_add_f32 v6, v6, v7

    v_mov_b32 v5, v4
    v_mov_b32 v7, v6
    s_nop 0
    v_permlane16_swap_b32 v4, v5
    v_permlane16_swap_b32 v6, v7
    v_add_f32 v4, v4, v5
    v_add_f32 v6, v6, v7

    v_rcp_f32 v4, v4
    v_rcp_f32 v6, v6
    v_mov_b32 v182, 0
    v_mov_b32 v183, 0
    v_mul_f32 v168, v4, v168
    v_mul_f32 v169, v4, v169
    v_mul_f32 v170, v4, v170
    v_mul_f32 v171, v4, v171
    v_mul_f32 v176, v4, v176
    v_mul_f32 v177, v4, v177
    v_mul_f32 v178, v4, v178
    v_mul_f32 v179, v4, v179
    v_cvt_pk_bf16_f32 v180, v168, v169
    v_cvt_pk_bf16_f32 v181, v170, v171
    v_cvt_pk_bf16_f32 v184, v176, v177
    v_cvt_pk_bf16_f32 v185, v178, v179
    v_mul_f32 v192, v6, v192
    v_mul_f32 v193, v6, v193
    v_mul_f32 v194, v6, v194
    v_mul_f32 v195, v6, v195
    v_mul_f32 v196, v6, v196
    v_mul_f32 v197, v6, v197
    v_mul_f32 v198, v6, v198
    v_mul_f32 v199, v6, v199
    v_mul_f32 v200, v6, v200
    v_mul_f32 v201, v6, v201
    v_mul_f32 v202, v6, v202
    v_mul_f32 v203, v6, v203
    v_cvt_pk_bf16_f32 v186, v192, v193
    v_cvt_pk_bf16_f32 v187, v194, v195
    v_cvt_pk_bf16_f32 v188, v196, v197
    v_cvt_pk_bf16_f32 v189, v198, v199
    v_cvt_pk_bf16_f32 v190, v200, v201
    v_cvt_pk_bf16_f32 v191, v202, v203
    s_add_u32 s25, s25, 4

    v_mfma_f32_16x16x32_bf16 v[16:19], a[160:163], v[180:183], 0
    v_mfma_f32_16x16x32_bf16 v[20:23], a[164:167], v[180:183], 0
    v_mfma_f32_16x16x32_bf16 v[24:27], a[168:171], v[180:183], 0
    v_mfma_f32_16x16x32_bf16 v[28:31], a[172:175], v[180:183], 0
    v_mfma_f32_16x16x32_bf16 v[32:35], a[176:179], v[180:183], 0
    v_mfma_f32_16x16x32_bf16 v[36:39], a[180:183], v[180:183], 0
    v_mfma_f32_16x16x32_bf16 v[40:43], a[184:187], v[180:183], 0
    v_mfma_f32_16x16x32_bf16 v[44:47], a[188:191], v[180:183], 0
    v_mfma_f32_16x16x32_bf16 v[48:51], a[160:163], v[186:189], 0
    v_mfma_f32_16x16x32_bf16 v[52:55], a[164:167], v[186:189], 0
    v_mfma_f32_16x16x32_bf16 v[56:59], a[168:171], v[186:189], 0
    v_mfma_f32_16x16x32_bf16 v[60:63], a[172:175], v[186:189], 0
    v_mfma_f32_16x16x32_bf16 v[64:67], a[176:179], v[186:189], 0
    v_mfma_f32_16x16x32_bf16 v[68:71], a[180:183], v[186:189], 0
    v_mfma_f32_16x16x32_bf16 v[72:75], a[184:187], v[186:189], 0
    v_mfma_f32_16x16x32_bf16 v[76:79], a[188:191], v[186:189], 0
    s_waitcnt vmcnt(36)
    s_bitcmp1_b32 s97, 4
    s_mov_b64 exec, 1
    s_cbranch_scc1 .fs_493
    buffer_store_dword v12, v13, s[8:11], s92 offen
.fj_494:
    s_mov_b64 exec, -1
    s_cmp_lt_u32 s25, s96
    s_cbranch_scc1 .os_495
    v_mfma_f32_16x16x16_bf16 v[16:19], v[112:113], v[184:185], v[16:19]
    v_mfma_f32_16x16x16_bf16 v[20:23], v[114:115], v[184:185], v[20:23]
    v_add_u32 v12, 1, v12
    v_mfma_f32_16x16x16_bf16 v[24:27], v[116:117], v[184:185], v[24:27]
    v_mfma_f32_16x16x16_bf16 v[28:31], v[118:119], v[184:185], v[28:31]
    v_mfma_f32_16x16x16_bf16 v[32:35], v[120:121], v[184:185], v[32:35]
    v_mfma_f32_16x16x16_bf16 v[36:39], v[122:123], v[184:185], v[36:39]
    v_cvt_pk_bf16_f32 v208, v16, v17
    v_cvt_pk_bf16_f32 v209, v18, v19
    v_cvt_pk_bf16_f32 v210, v20, v21
    v_cvt_pk_bf16_f32 v211, v22, v23
    buffer_store_dwordx4 v[208:211], v8, s[8:11], s50 offen offset:0
    v_mfma_f32_16x16x16_bf16 v[40:43], v[124:125], v[184:185], v[40:43]
    v_mfma_f32_16x16x16_bf16 v[44:47], v[126:127], v[184:185], v[44:47]
    v_cvt_pk_bf16_f32 v212, v24, v25
    v_cvt_pk_bf16_f32 v213, v26, v27
    v_cvt_pk_bf16_f32 v214, v28, v29
    v_cvt_pk_bf16_f32 v215, v30, v31
    buffer_store_dwordx4 v[212:215], v8, s[8:11], s50 offen offset:1024
    v_mfma_f32_16x16x16_bf16 v[48:51], v[112:113], v[190:191], v[48:51]
    v_mfma_f32_16x16x16_bf16 v[52:55], v[114:115], v[190:191], v[52:55]
    v_cvt_pk_bf16_f32 v216, v32, v33
    v_cvt_pk_bf16_f32 v217, v34, v35
    v_cvt_pk_bf16_f32 v218, v36, v37
    v_cvt_pk_bf16_f32 v219, v38, v39
    buffer_store_dwordx4 v[216:219], v8, s[8:11], s50 offen offset:2048
    v_mfma_f32_16x16x16_bf16 v[56:59], v[116:117], v[190:191], v[56:59]
    v_mfma_f32_16x16x16_bf16 v[60:63], v[118:119], v[190:191], v[60:63]
    v_cvt_pk_bf16_f32 v220, v40, v41
    v_cvt_pk_bf16_f32 v221, v42, v43
    v_cvt_pk_bf16_f32 v222, v44, v45
    v_cvt_pk_bf16_f32 v223, v46, v47
    buffer_store_dwordx4 v[220:223], v8, s[8:11], s50 offen offset:3072
    v_mfma_f32_16x16x16_bf16 v[64:67], v[120:121], v[190:191], v[64:67]
    v_mfma_f32_16x16x16_bf16 v[68:71], v[122:123], v[190:191], v[68:71]
    v_cvt_pk_bf16_f32 v224, v48, v49
    v_cvt_pk_bf16_f32 v225, v50, v51
    v_cvt_pk_bf16_f32 v226, v52, v53
    v_cvt_pk_bf16_f32 v227, v54, v55
    buffer_store_dwordx4 v[224:227], v8, s[8:11], s51 offen offset:0
    v_mfma_f32_16x16x16_bf16 v[72:75], v[124:125], v[190:191], v[72:75]
    v_mfma_f32_16x16x16_bf16 v[76:79], v[126:127], v[190:191], v[76:79]
    v_cvt_pk_bf16_f32 v228, v56, v57
    v_cvt_pk_bf16_f32 v229, v58, v59
    v_cvt_pk_bf16_f32 v230, v60, v61
    v_cvt_pk_bf16_f32 v231, v62, v63
    buffer_store_dwordx4 v[228:231], v8, s[8:11], s51 offen offset:1024
    s_nop 3
    v_cvt_pk_bf16_f32 v232, v64, v65
    v_cvt_pk_bf16_f32 v233, v66, v67
    v_cvt_pk_bf16_f32 v234, v68, v69
    v_cvt_pk_bf16_f32 v235, v70, v71
    buffer_store_dwordx4 v[232:235], v8, s[8:11], s51 offen offset:2048
    v_cvt_pk_bf16_f32 v236, v72, v73
    v_cvt_pk_bf16_f32 v237, v74, v75
    v_cvt_pk_bf16_f32 v238, v76, v77
    v_cvt_pk_bf16_f32 v239, v78, v79
    buffer_store_dwordx4 v[236:239], v8, s[8:11], s51 offen offset:3072
.oj_496:
    s_cmp_lt_u32 s25, 64
    s_cbranch_scc1 .att_477

    s_cmp_eq_u32 s25, 64
    s_cbranch_scc1 .ah0_478
.ahz_480:
    s_waitcnt vmcnt(0)
    s_bitcmp1_b32 s97, 4
    s_mov_b64 exec, 1
    s_cbranch_scc1 .fs_498
    buffer_store_dword v12, v13, s[8:11], s92 offen
.fj_499:
    s_mov_b64 exec, -1
    s_branch .ate_497
.atw_481:
    s_mov_b32 s62, 0
    s_mov_b64 exec, 7
.wf_500:
    buffer_load_dword v15, v9, s[8:11], s35 offen sc1
    s_waitcnt vmcnt(0)
    v_cmp_gt_u32 vcc, s36, v15
    s_cbranch_vccz .wfd_501
    s_sleep 2
    s_add_u32 s62, s62, 1
    s_cmp_gt_u32 s62, 0x400000
    s_cbranch_scc1 .mg_end_1
    s_branch .wf_500

.wfd_501:
    s_mov_b64 exec, -1
    s_branch .atb_482
.kmf_484:
    s_cmp_lg_u32 s62, 0
    s_cbranch_scc1 .kmn_502
    s_waitcnt vmcnt(36)
    s_bitcmp1_b32 s97, 4
    s_mov_b64 exec, 1
    s_cbranch_scc1 .fs_503
    buffer_store_dword v12, v13, s[8:11], s92 offen
.fj_504:
    s_mov_b64 exec, -1
    s_cmp_lt_u32 s25, 60
    s_cselect_b32 s5, 0, 196608
    s_sub_u32 s5, s34, s5
    s_mov_b64 exec, 15

.kml_505:
    s_sleep 4
    buffer_load_dword v4, v204, s[8:11], s5 offen sc1
    s_add_u32 s62, s62, 1
    s_cmp_gt_u32 s62, 0x200000
    s_cbranch_scc1 .mg_end_1
    s_waitcnt vmcnt(0)
    v_cmp_eq_u32 vcc, -1, v4
    s_cbranch_vccnz .kml_505
    s_mov_b64 exec, -1

.kmn_502:
    s_sleep 1
    buffer_load_dwordx4 v[80:83], v10, s[8:11], s34 offen offset:2048 sc1
    buffer_load_dwordx4 v[84:87], v10, s[8:11], s34 offen offset:2176 sc1
    buffer_load_dwordx4 v[88:91], v10, s[8:11], s34 offen offset:3072 sc1
    buffer_load_dwordx4 v[92:95], v10, s[8:11], s34 offen offset:3200 sc1
    s_add_u32 s4, s34, 4096
    s_mov_b64 exec, s[60:61]
    buffer_load_dwordx2 v[128:129], v11, s[8:11], s4 offen offset:0 sc1
    buffer_load_dwordx2 v[130:131], v11, s[8:11], s4 offen offset:256 sc1
    buffer_load_dwordx2 v[132:133], v11, s[8:11], s4 offen offset:512 sc1
    buffer_load_dwordx2 v[134:135], v11, s[8:11], s4 offen offset:768 sc1
    buffer_load_dwordx2 v[136:137], v11, s[8:11], s4 offen offset:1024 sc1
    buffer_load_dwordx2 v[138:139], v11, s[8:11], s4 offen offset:1280 sc1
    buffer_load_dwordx2 v[140:141], v11, s[8:11], s4 offen offset:1536 sc1
    buffer_load_dwordx2 v[142:143], v11, s[8:11], s4 offen offset:1792 sc1
    s_mov_b64 exec, -1
    s_add_u32 s62, s62, 1
    s_cmp_gt_u32 s62, 0x200000
    s_cbranch_scc1 .mg_end_1
    s_waitcnt vmcnt(0)
    s_branch .kmp_483

.fs_485:
    buffer_store_dword v12, v13, s[8:11], s92 offen sc1
    s_branch .fj_486
.os_487:
    v_mfma_f32_16x16x16_bf16 v[16:19], v[128:129], v[184:185], v[16:19]
    v_mfma_f32_16x16x16_bf16 v[20:23], v[130:131], v[184:185], v[20:23]
    v_add_u32 v12, 1, v12
    v_mfma_f32_16x16x16_bf16 v[24:27], v[132:133], v[184:185], v[24:27]
    v_mfma_f32_16x16x16_bf16 v[28:31], v[134:135], v[184:185], v[28:31]
    v_mfma_f32_16x16x16_bf16 v[32:35], v[136:137], v[184:185], v[32:35]
    v_mfma_f32_16x16x16_bf16 v[36:39], v[138:139], v[184:185], v[36:39]
    v_cvt_pk_bf16_f32 v208, v16, v17
    v_cvt_pk_bf16_f32 v209, v18, v19
    v_cvt_pk_bf16_f32 v210, v20, v21
    v_cvt_pk_bf16_f32 v211, v22, v23
    buffer_store_dwordx4 v[208:211], v8, s[8:11], s50 offen offset:0 sc1
    v_mfma_f32_16x16x16_bf16 v[40:43], v[140:141], v[184:185], v[40:43]
    v_mfma_f32_16x16x16_bf16 v[44:47], v[142:143], v[184:185], v[44:47]
    v_cvt_pk_bf16_f32 v212, v24, v25
    v_cvt_pk_bf16_f32 v213, v26, v27
    v_cvt_pk_bf16_f32 v214, v28, v29
    v_cvt_pk_bf16_f32 v215, v30, v31
    buffer_store_dwordx4 v[212:215], v8, s[8:11], s50 offen offset:1024 sc1
    v_mfma_f32_16x16x16_bf16 v[48:51], v[128:129], v[190:191], v[48:51]
    v_mfma_f32_16x16x16_bf16 v[52:55], v[130:131], v[190:191], v[52:55]
    v_cvt_pk_bf16_f32 v216, v32, v33
    v_cvt_pk_bf16_f32 v217, v34, v35
    v_cvt_pk_bf16_f32 v218, v36, v37
    v_cvt_pk_bf16_f32 v219, v38, v39
    buffer_store_dwordx4 v[216:219], v8, s[8:11], s50 offen offset:2048 sc1
    v_mfma_f32_16x16x16_bf16 v[56:59], v[132:133], v[190:191], v[56:59]
    v_mfma_f32_16x16x16_bf16 v[60:63], v[134:135], v[190:191], v[60:63]
    v_cvt_pk_bf16_f32 v220, v40, v41
    v_cvt_pk_bf16_f32 v221, v42, v43
    v_cvt_pk_bf16_f32 v222, v44, v45
    v_cvt_pk_bf16_f32 v223, v46, v47
    buffer_store_dwordx4 v[220:223], v8, s[8:11], s50 offen offset:3072 sc1
    v_mfma_f32_16x16x16_bf16 v[64:67], v[136:137], v[190:191], v[64:67]
    v_mfma_f32_16x16x16_bf16 v[68:71], v[138:139], v[190:191], v[68:71]
    v_cvt_pk_bf16_f32 v224, v48, v49
    v_cvt_pk_bf16_f32 v225, v50, v51
    v_cvt_pk_bf16_f32 v226, v52, v53
    v_cvt_pk_bf16_f32 v227, v54, v55
    buffer_store_dwordx4 v[224:227], v8, s[8:11], s51 offen offset:0 sc1
    v_mfma_f32_16x16x16_bf16 v[72:75], v[140:141], v[190:191], v[72:75]
    v_mfma_f32_16x16x16_bf16 v[76:79], v[142:143], v[190:191], v[76:79]
    v_cvt_pk_bf16_f32 v228, v56, v57
    v_cvt_pk_bf16_f32 v229, v58, v59
    v_cvt_pk_bf16_f32 v230, v60, v61
    v_cvt_pk_bf16_f32 v231, v62, v63
    buffer_store_dwordx4 v[228:231], v8, s[8:11], s51 offen offset:1024 sc1
    s_nop 3
    v_cvt_pk_bf16_f32 v232, v64, v65
    v_cvt_pk_bf16_f32 v233, v66, v67
    v_cvt_pk_bf16_f32 v234, v68, v69
    v_cvt_pk_bf16_f32 v235, v70, v71
    buffer_store_dwordx4 v[232:235], v8, s[8:11], s51 offen offset:2048 sc1
    v_cvt_pk_bf16_f32 v236, v72, v73
    v_cvt_pk_bf16_f32 v237, v74, v75
    v_cvt_pk_bf16_f32 v238, v76, v77
    v_cvt_pk_bf16_f32 v239, v78, v79
    buffer_store_dwordx4 v[236:239], v8, s[8:11], s51 offen offset:3072 sc1
    s_branch .oj_488
.atw_489:
    s_mov_b32 s62, 0
    s_mov_b64 exec, 7
.wf_506:
    buffer_load_dword v15, v9, s[8:11], s35 offen sc1
    s_waitcnt vmcnt(0)
    v_cmp_gt_u32 vcc, s36, v15
    s_cbranch_vccz .wfd_507
    s_sleep 2
    s_add_u32 s62, s62, 1
    s_cmp_gt_u32 s62, 0x400000
    s_cbranch_scc1 .mg_end_1
    s_branch .wf_506

.wfd_507:
    s_mov_b64 exec, -1
    s_branch .atb_490
.kmf_492:
    s_cmp_lg_u32 s62, 0
    s_cbranch_scc1 .kmn_508
    s_waitcnt vmcnt(36)
    s_bitcmp1_b32 s97, 4
    s_mov_b64 exec, 1
    s_cbranch_scc1 .fs_509
    buffer_store_dword v12, v13, s[8:11], s92 offen
.fj_510:
    s_mov_b64 exec, -1
    s_cmp_lt_u32 s25, 60
    s_cselect_b32 s5, 0, 196608
    s_sub_u32 s5, s34, s5
    s_mov_b64 exec, 15

.kml_511:
    s_sleep 4
    buffer_load_dword v4, v204, s[8:11], s5 offen sc1
    s_add_u32 s62, s62, 1
    s_cmp_gt_u32 s62, 0x200000
    s_cbranch_scc1 .mg_end_1
    s_waitcnt vmcnt(0)
    v_cmp_eq_u32 vcc, -1, v4
    s_cbranch_vccnz .kml_511
    s_mov_b64 exec, -1

.kmn_508:
    s_sleep 1
    buffer_load_dwordx4 v[96:99], v10, s[8:11], s34 offen offset:2048 sc1
    buffer_load_dwordx4 v[100:103], v10, s[8:11], s34 offen offset:2176 sc1
    buffer_load_dwordx4 v[104:107], v10, s[8:11], s34 offen offset:3072 sc1
    buffer_load_dwordx4 v[108:111], v10, s[8:11], s34 offen offset:3200 sc1
    s_add_u32 s4, s34, 4096
    s_mov_b64 exec, s[60:61]
    buffer_load_dwordx2 v[112:113], v11, s[8:11], s4 offen offset:0 sc1
    buffer_load_dwordx2 v[114:115], v11, s[8:11], s4 offen offset:256 sc1
    buffer_load_dwordx2 v[116:117], v11, s[8:11], s4 offen offset:512 sc1
    buffer_load_dwordx2 v[118:119], v11, s[8:11], s4 offen offset:768 sc1
    buffer_load_dwordx2 v[120:121], v11, s[8:11], s4 offen offset:1024 sc1
    buffer_load_dwordx2 v[122:123], v11, s[8:11], s4 offen offset:1280 sc1
    buffer_load_dwordx2 v[124:125], v11, s[8:11], s4 offen offset:1536 sc1
    buffer_load_dwordx2 v[126:127], v11, s[8:11], s4 offen offset:1792 sc1
    s_mov_b64 exec, -1
    s_add_u32 s62, s62, 1
    s_cmp_gt_u32 s62, 0x200000
    s_cbranch_scc1 .mg_end_1
    s_waitcnt vmcnt(0)
    s_branch .kmp_491

.fs_493:
    buffer_store_dword v12, v13, s[8:11], s92 offen sc1
    s_branch .fj_494
.os_495:
    v_mfma_f32_16x16x16_bf16 v[16:19], v[112:113], v[184:185], v[16:19]
    v_mfma_f32_16x16x16_bf16 v[20:23], v[114:115], v[184:185], v[20:23]
    v_add_u32 v12, 1, v12
    v_mfma_f32_16x16x16_bf16 v[24:27], v[116:117], v[184:185], v[24:27]
    v_mfma_f32_16x16x16_bf16 v[28:31], v[118:119], v[184:185], v[28:31]
    v_mfma_f32_16x16x16_bf16 v[32:35], v[120:121], v[184:185], v[32:35]
    v_mfma_f32_16x16x16_bf16 v[36:39], v[122:123], v[184:185], v[36:39]
    v_cvt_pk_bf16_f32 v208, v16, v17
    v_cvt_pk_bf16_f32 v209, v18, v19
    v_cvt_pk_bf16_f32 v210, v20, v21
    v_cvt_pk_bf16_f32 v211, v22, v23
    buffer_store_dwordx4 v[208:211], v8, s[8:11], s50 offen offset:0 sc1
    v_mfma_f32_16x16x16_bf16 v[40:43], v[124:125], v[184:185], v[40:43]
    v_mfma_f32_16x16x16_bf16 v[44:47], v[126:127], v[184:185], v[44:47]
    v_cvt_pk_bf16_f32 v212, v24, v25
    v_cvt_pk_bf16_f32 v213, v26, v27
    v_cvt_pk_bf16_f32 v214, v28, v29
    v_cvt_pk_bf16_f32 v215, v30, v31
    buffer_store_dwordx4 v[212:215], v8, s[8:11], s50 offen offset:1024 sc1
    v_mfma_f32_16x16x16_bf16 v[48:51], v[112:113], v[190:191], v[48:51]
    v_mfma_f32_16x16x16_bf16 v[52:55], v[114:115], v[190:191], v[52:55]
    v_cvt_pk_bf16_f32 v216, v32, v33
    v_cvt_pk_bf16_f32 v217, v34, v35
    v_cvt_pk_bf16_f32 v218, v36, v37
    v_cvt_pk_bf16_f32 v219, v38, v39
    buffer_store_dwordx4 v[216:219], v8, s[8:11], s50 offen offset:2048 sc1
    v_mfma_f32_16x16x16_bf16 v[56:59], v[116:117], v[190:191], v[56:59]
    v_mfma_f32_16x16x16_bf16 v[60:63], v[118:119], v[190:191], v[60:63]
    v_cvt_pk_bf16_f32 v220, v40, v41
    v_cvt_pk_bf16_f32 v221, v42, v43
    v_cvt_pk_bf16_f32 v222, v44, v45
    v_cvt_pk_bf16_f32 v223, v46, v47
    buffer_store_dwordx4 v[220:223], v8, s[8:11], s50 offen offset:3072 sc1
    v_mfma_f32_16x16x16_bf16 v[64:67], v[120:121], v[190:191], v[64:67]
    v_mfma_f32_16x16x16_bf16 v[68:71], v[122:123], v[190:191], v[68:71]
    v_cvt_pk_bf16_f32 v224, v48, v49
    v_cvt_pk_bf16_f32 v225, v50, v51
    v_cvt_pk_bf16_f32 v226, v52, v53
    v_cvt_pk_bf16_f32 v227, v54, v55
    buffer_store_dwordx4 v[224:227], v8, s[8:11], s51 offen offset:0 sc1
    v_mfma_f32_16x16x16_bf16 v[72:75], v[124:125], v[190:191], v[72:75]
    v_mfma_f32_16x16x16_bf16 v[76:79], v[126:127], v[190:191], v[76:79]
    v_cvt_pk_bf16_f32 v228, v56, v57
    v_cvt_pk_bf16_f32 v229, v58, v59
    v_cvt_pk_bf16_f32 v230, v60, v61
    v_cvt_pk_bf16_f32 v231, v62, v63
    buffer_store_dwordx4 v[228:231], v8, s[8:11], s51 offen offset:1024 sc1
    s_nop 3
    v_cvt_pk_bf16_f32 v232, v64, v65
    v_cvt_pk_bf16_f32 v233, v66, v67
    v_cvt_pk_bf16_f32 v234, v68, v69
    v_cvt_pk_bf16_f32 v235, v70, v71
    buffer_store_dwordx4 v[232:235], v8, s[8:11], s51 offen offset:2048 sc1
    v_cvt_pk_bf16_f32 v236, v72, v73
    v_cvt_pk_bf16_f32 v237, v74, v75
    v_cvt_pk_bf16_f32 v238, v76, v77
    v_cvt_pk_bf16_f32 v239, v78, v79
    buffer_store_dwordx4 v[236:239], v8, s[8:11], s51 offen offset:3072 sc1
    s_branch .oj_496
.ah0_478:
    s_mov_b32 s34, s33
    s_add_u32 s50, s27, 0
    s_mov_b32 s39, 0x3e0293ee
    v_lshlrev_b32 v5, 2, v8
    s_waitcnt vmcnt(8)
    buffer_load_dword v205, v5, s[8:11], s50 offen
    s_add_u32 s25, s25, 4

    s_mov_b32 s52, 1
    s_branch .hd_512
.hb_513:
    s_mov_b32 s52, 0
    v_mfma_f32_16x16x32_bf16 v[144:147], a[32:35], a[0:3], 0
    v_mfma_f32_16x16x32_bf16 v[144:147], a[36:39], a[4:7], v[144:147]
    v_mfma_f32_16x16x32_bf16 v[144:147], a[40:43], a[8:11], v[144:147]
    v_mfma_f32_16x16x32_bf16 v[144:147], a[44:47], a[12:15], v[144:147]
    s_nop 7
    v_cvt_pk_bf16_f32 v168, v144, v145
    v_cvt_pk_bf16_f32 v170, v146, v147
    v_and_b32 v169, 0xffff0000, v168
    v_lshlrev_b32 v168, 16, v168
    v_and_b32 v171, 0xffff0000, v170
    v_lshlrev_b32 v170, 16, v170
    v_mul_f32 v168, s37, v168
    v_mul_f32 v169, s37, v169
    v_mul_f32 v170, s37, v170
    v_mul_f32 v171, s37, v171
    v_cvt_pk_bf16_f32 v144, v168, v169
    v_cvt_pk_bf16_f32 v146, v170, v171
    v_and_b32 v145, 0xffff0000, v144
    v_lshlrev_b32 v144, 16, v144
    v_and_b32 v147, 0xffff0000, v146
    v_lshlrev_b32 v146, 16, v146
    v_cndmask_b32 v144, v14, v144, s[40:41]
    v_cndmask_b32 v145, v14, v145, s[42:43]
    v_cndmask_b32 v146, v14, v146, s[44:45]
    v_cndmask_b32 v147, v14, v147, s[46:47]
    v_max3_f32 v192, v144, v145, v146
    v_max_f32 v192, v192, v147
    v_mov_b32 v5, v192
    s_nop 1
    v_permlane32_swap_b32 v192, v5
    v_max_f32 v192, v192, v5
    v_mov_b32 v5, v192
    s_nop 1
    v_permlane16_swap_b32 v192, v5
    v_max_f32 v192, v192, v5
    v_mul_f32 v192, s38, v192
    v_mov_b32 v182, 0
    v_mov_b32 v183, 0
    v_fma_f32 v168, v144, s38, -v192
    v_fma_f32 v169, v145, s38, -v192
    v_fma_f32 v170, v146, s38, -v192
    v_fma_f32 v171, v147, s38, -v192
    v_exp_f32 v168, v168
    v_exp_f32 v169, v169
    v_exp_f32 v170, v170
    v_exp_f32 v171, v171
    s_nop 0
    v_cvt_pk_bf16_f32 v180, v168, v169
    v_cvt_pk_bf16_f32 v181, v170, v171
    v_add_f32 v193, v168, v169
    v_add_f32 v193, v193, v170
    v_add_f32 v193, v193, v171
    v_mfma_f32_16x16x32_bf16 v[16:19], a[64:67], v[180:183], 0
    v_mfma_f32_16x16x32_bf16 v[20:23], a[68:71], v[180:183], 0
    v_mfma_f32_16x16x32_bf16 v[24:27], a[72:75], v[180:183], 0
    v_mfma_f32_16x16x32_bf16 v[28:31], a[76:79], v[180:183], 0
    v_mfma_f32_16x16x32_bf16 v[32:35], a[80:83], v[180:183], 0
    v_mfma_f32_16x16x32_bf16 v[36:39], a[84:87], v[180:183], 0
    v_mfma_f32_16x16x32_bf16 v[40:43], a[88:91], v[180:183], 0
    v_mfma_f32_16x16x32_bf16 v[44:47], a[92:95], v[180:183], 0
    v_mov_b32 v5, v193
    s_nop 1
    v_permlane32_swap_b32 v193, v5
    v_add_f32 v193, v193, v5
    v_mov_b32 v5, v193
    s_nop 1
    v_permlane16_swap_b32 v193, v5
    v_add_f32 v193, v193, v5
    s_waitcnt vmcnt(0)
    s_bitcmp1_b32 s97, 4
    s_mov_b64 exec, 1
    s_cbranch_scc1 .fs_514
    buffer_store_dword v12, v13, s[8:11], s92 offen
.fj_515:
    s_mov_b64 exec, -1
    v_add_u32 v12, 1, v12
    s_mov_b32 s62, 0
.hk_516:
    v_max3_u32 v4, v80, v84, v88
    v_max3_u32 v5, v92, v128, v130
    v_max3_u32 v4, v4, v132, v134
    v_max3_u32 v5, v5, v136, v138
    v_max3_u32 v4, v4, v140, v142
    v_max_u32 v4, v4, v5
    v_cmp_eq_u32 vcc, -1, v4
    s_cbranch_vccnz .hf_517

.hd_512:
    v_mfma_f32_16x16x32_bf16 v[152:155], v[80:83], a[0:3], 0
    v_mfma_f32_16x16x32_bf16 v[152:155], v[84:87], a[4:7], v[152:155]
    v_mfma_f32_16x16x32_bf16 v[152:155], v[88:91], a[8:11], v[152:155]
    v_mfma_f32_16x16x32_bf16 v[152:155], v[92:95], a[12:15], v[152:155]
    s_nop 7
    v_cndmask_b32 v152, v14, v152, s[60:61]
    v_cndmask_b32 v153, v14, v153, s[60:61]
    v_cndmask_b32 v154, v14, v154, s[60:61]
    v_cndmask_b32 v155, v14, v155, s[60:61]
    v_max3_f32 v4, v152, v153, v154
    v_max_f32 v4, v4, v155
    v_mov_b32 v5, v4
    s_nop 1
    v_permlane32_swap_b32 v4, v5
    v_max_f32 v4, v4, v5
    v_mov_b32 v5, v4
    s_nop 1
    v_permlane16_swap_b32 v4, v5
    v_max_f32 v4, v4, v5
    v_mul_f32 v4, s39, v4
    v_max_f32 v4, v4, v192
    v_sub_f32 v6, v192, v4
    v_fma_f32 v176, v152, s39, -v4
    v_fma_f32 v177, v153, s39, -v4
    v_fma_f32 v178, v154, s39, -v4
    v_fma_f32 v179, v155, s39, -v4
    v_exp_f32 v176, v176
    v_exp_f32 v177, v177
    v_exp_f32 v178, v178
    v_exp_f32 v179, v179
    v_exp_f32 v6, v6
    v_add_f32 v4, v176, v177
    v_add_f32 v5, v178, v179
    v_add_f32 v4, v4, v5

    v_mov_b32 v5, v4
    s_nop 1
    v_permlane32_swap_b32 v4, v5
    v_add_f32 v4, v4, v5
    v_mov_b32 v5, v4
    s_nop 1
    v_permlane16_swap_b32 v4, v5
    v_add_f32 v4, v4, v5
    v_fma_f32 v4, v6, v193, v4
    v_rcp_f32 v4, v4
    s_nop 0
    v_mul_f32 v6, v6, v4
    v_pk_mul_f32 v[176:177], v[176:177], v[4:5] op_sel_hi:[1,0]
    v_pk_mul_f32 v[178:179], v[178:179], v[4:5] op_sel_hi:[1,0]

    v_cvt_pk_bf16_f32 v184, v176, v177
    v_cvt_pk_bf16_f32 v185, v178, v179
    v_pk_mul_f32 v[16:17], v[16:17], v[6:7] op_sel_hi:[1,0]
    v_pk_mul_f32 v[18:19], v[18:19], v[6:7] op_sel_hi:[1,0]
    v_pk_mul_f32 v[20:21], v[20:21], v[6:7] op_sel_hi:[1,0]
    v_pk_mul_f32 v[22:23], v[22:23], v[6:7] op_sel_hi:[1,0]
    s_cmp_lt_u32 s25, s96
    s_cbranch_scc1 .hs_520
    v_mfma_f32_16x16x16_bf16 v[16:19], v[128:129], v[184:185], v[16:19]
    v_pk_mul_f32 v[24:25], v[24:25], v[6:7] op_sel_hi:[1,0]
    v_pk_mul_f32 v[26:27], v[26:27], v[6:7] op_sel_hi:[1,0]
    v_mfma_f32_16x16x16_bf16 v[20:23], v[130:131], v[184:185], v[20:23]
    v_pk_mul_f32 v[28:29], v[28:29], v[6:7] op_sel_hi:[1,0]
    v_pk_mul_f32 v[30:31], v[30:31], v[6:7] op_sel_hi:[1,0]
    v_mfma_f32_16x16x16_bf16 v[24:27], v[132:133], v[184:185], v[24:27]
    v_pk_mul_f32 v[32:33], v[32:33], v[6:7] op_sel_hi:[1,0]
    v_pk_mul_f32 v[34:35], v[34:35], v[6:7] op_sel_hi:[1,0]
    v_mfma_f32_16x16x16_bf16 v[28:31], v[134:135], v[184:185], v[28:31]
    v_pk_mul_f32 v[36:37], v[36:37], v[6:7] op_sel_hi:[1,0]
    v_pk_mul_f32 v[38:39], v[38:39], v[6:7] op_sel_hi:[1,0]
    v_mfma_f32_16x16x16_bf16 v[32:35], v[136:137], v[184:185], v[32:35]
    v_pk_mul_f32 v[40:41], v[40:41], v[6:7] op_sel_hi:[1,0]
    v_pk_mul_f32 v[42:43], v[42:43], v[6:7] op_sel_hi:[1,0]
    v_mfma_f32_16x16x16_bf16 v[36:39], v[138:139], v[184:185], v[36:39]
    v_pk_mul_f32 v[44:45], v[44:45], v[6:7] op_sel_hi:[1,0]
    v_pk_mul_f32 v[46:47], v[46:47], v[6:7] op_sel_hi:[1,0]
    v_mfma_f32_16x16x16_bf16 v[40:43], v[140:141], v[184:185], v[40:43]
    v_cvt_pk_bf16_f32 v208, v16, v17
    v_cvt_pk_bf16_f32 v209, v18, v19
    v_cvt_pk_bf16_f32 v210, v20, v21
    v_cvt_pk_bf16_f32 v211, v22, v23
    buffer_store_dwordx4 v[208:211], v8, s[8:11], s50 offen offset:0
    v_mfma_f32_16x16x16_bf16 v[44:47], v[142:143], v[184:185], v[44:47]
    v_cvt_pk_bf16_f32 v212, v24, v25
    v_cvt_pk_bf16_f32 v213, v26, v27
    v_cvt_pk_bf16_f32 v214, v28, v29
    v_cvt_pk_bf16_f32 v215, v30, v31
    buffer_store_dwordx4 v[212:215], v8, s[8:11], s50 offen offset:1024
    v_cvt_pk_bf16_f32 v216, v32, v33
    v_cvt_pk_bf16_f32 v217, v34, v35
    v_cvt_pk_bf16_f32 v218, v36, v37
    v_cvt_pk_bf16_f32 v219, v38, v39
    buffer_store_dwordx4 v[216:219], v8, s[8:11], s50 offen offset:2048
    v_cvt_pk_bf16_f32 v220, v40, v41
    v_cvt_pk_bf16_f32 v221, v42, v43
    v_cvt_pk_bf16_f32 v222, v44, v45
    v_cvt_pk_bf16_f32 v223, v46, v47
    buffer_store_dwordx4 v[220:223], v8, s[8:11], s50 offen offset:3072
    s_cmp_lg_u32 s52, 0
    s_cbranch_scc1 .hb_513
    s_waitcnt vmcnt(0)
    s_mov_b64 exec, 1
    buffer_store_dword v12, v13, s[8:11], s92 offen
    s_mov_b64 exec, -1
    s_branch .ate_497
.ah1_479:
    s_mov_b32 s34, s33
    s_add_u32 s50, s27, 4096
    s_mov_b32 s39, 0x3e0293ee
    v_lshlrev_b32 v5, 2, v8
    s_waitcnt vmcnt(8)
    buffer_load_dword v205, v5, s[8:11], s50 offen
    s_add_u32 s25, s25, 4

    s_mov_b32 s52, 1
    s_branch .hd_521
.hb_522:
    s_mov_b32 s52, 0
    v_mfma_f32_16x16x32_bf16 v[144:147], a[128:131], a[112:115], 0
    v_mfma_f32_16x16x32_bf16 v[148:151], a[144:147], a[112:115], 0
    v_mfma_f32_16x16x32_bf16 v[144:147], a[132:135], a[116:119], v[144:147]
    v_mfma_f32_16x16x32_bf16 v[148:151], a[148:151], a[116:119], v[148:151]
    v_mfma_f32_16x16x32_bf16 v[144:147], a[136:139], a[120:123], v[144:147]
    v_mfma_f32_16x16x32_bf16 v[148:151], a[152:155], a[120:123], v[148:151]
    v_mfma_f32_16x16x32_bf16 v[144:147], a[140:143], a[124:127], v[144:147]
    v_mfma_f32_16x16x32_bf16 v[148:151], a[156:159], a[124:127], v[148:151]
    s_nop 7
    v_cvt_pk_bf16_f32 v168, v144, v145
    v_cvt_pk_bf16_f32 v170, v146, v147
    v_cvt_pk_bf16_f32 v172, v148, v149
    v_cvt_pk_bf16_f32 v174, v150, v151
    v_and_b32 v169, 0xffff0000, v168
    v_lshlrev_b32 v168, 16, v168
    v_and_b32 v171, 0xffff0000, v170
    v_lshlrev_b32 v170, 16, v170
    v_and_b32 v173, 0xffff0000, v172
    v_lshlrev_b32 v172, 16, v172
    v_and_b32 v175, 0xffff0000, v174
    v_lshlrev_b32 v174, 16, v174
    v_mul_f32 v168, s37, v168
    v_mul_f32 v169, s37, v169
    v_mul_f32 v170, s37, v170
    v_mul_f32 v171, s37, v171
    v_mul_f32 v172, s37, v172
    v_mul_f32 v173, s37, v173
    v_mul_f32 v174, s37, v174
    v_mul_f32 v175, s37, v175
    v_cvt_pk_bf16_f32 v144, v168, v169
    v_cvt_pk_bf16_f32 v146, v170, v171
    v_cvt_pk_bf16_f32 v148, v172, v173
    v_cvt_pk_bf16_f32 v150, v174, v175
    v_and_b32 v145, 0xffff0000, v144
    v_lshlrev_b32 v144, 16, v144
    v_and_b32 v147, 0xffff0000, v146
    v_lshlrev_b32 v146, 16, v146
    v_and_b32 v149, 0xffff0000, v148
    v_lshlrev_b32 v148, 16, v148
    v_and_b32 v151, 0xffff0000, v150
    v_lshlrev_b32 v150, 16, v150
    v_cndmask_b32 v148, v14, v148, s[40:41]
    v_cndmask_b32 v149, v14, v149, s[42:43]
    v_cndmask_b32 v150, v14, v150, s[44:45]
    v_cndmask_b32 v151, v14, v151, s[46:47]
    v_max3_f32 v192, v144, v145, v146
    v_max_f32 v192, v192, v147
    v_max3_f32 v192, v192, v148, v149
    v_max3_f32 v192, v192, v150, v151
    v_mov_b32 v5, v192
    s_nop 1
    v_permlane32_swap_b32 v192, v5
    v_max_f32 v192, v192, v5
    v_mov_b32 v5, v192
    s_nop 1
    v_permlane16_swap_b32 v192, v5
    v_max_f32 v192, v192, v5
    v_mul_f32 v192, s38, v192
    v_mov_b32 v182, 0
    v_mov_b32 v183, 0
    v_fma_f32 v168, v144, s38, -v192
    v_fma_f32 v169, v145, s38, -v192
    v_fma_f32 v170, v146, s38, -v192
    v_fma_f32 v171, v147, s38, -v192
    v_fma_f32 v172, v148, s38, -v192
    v_fma_f32 v173, v149, s38, -v192
    v_fma_f32 v174, v150, s38, -v192
    v_fma_f32 v175, v151, s38, -v192
    v_exp_f32 v168, v168
    v_exp_f32 v169, v169
    v_exp_f32 v170, v170
    v_exp_f32 v171, v171
    v_exp_f32 v172, v172
    v_exp_f32 v173, v173
    v_exp_f32 v174, v174
    v_exp_f32 v175, v175
    s_nop 0
    v_cvt_pk_bf16_f32 v180, v168, v169
    v_cvt_pk_bf16_f32 v181, v170, v171
    v_cvt_pk_bf16_f32 v182, v172, v173
    v_cvt_pk_bf16_f32 v183, v174, v175
    v_add_f32 v193, v168, v169
    v_add_f32 v193, v193, v170
    v_add_f32 v193, v193, v171
    v_add_f32 v193, v193, v172
    v_add_f32 v193, v193, v173
    v_add_f32 v193, v193, v174
    v_add_f32 v193, v193, v175
    v_mfma_f32_16x16x32_bf16 v[16:19], a[160:163], v[180:183], 0
    v_mfma_f32_16x16x32_bf16 v[20:23], a[164:167], v[180:183], 0
    v_mfma_f32_16x16x32_bf16 v[24:27], a[168:171], v[180:183], 0
    v_mfma_f32_16x16x32_bf16 v[28:31], a[172:175], v[180:183], 0
    v_mfma_f32_16x16x32_bf16 v[32:35], a[176:179], v[180:183], 0
    v_mfma_f32_16x16x32_bf16 v[36:39], a[180:183], v[180:183], 0
    v_mfma_f32_16x16x32_bf16 v[40:43], a[184:187], v[180:183], 0
    v_mfma_f32_16x16x32_bf16 v[44:47], a[188:191], v[180:183], 0
    v_mov_b32 v5, v193
    s_nop 1
    v_permlane32_swap_b32 v193, v5
    v_add_f32 v193, v193, v5
    v_mov_b32 v5, v193
    s_nop 1
    v_permlane16_swap_b32 v193, v5
    v_add_f32 v193, v193, v5
    s_waitcnt vmcnt(0)
    s_bitcmp1_b32 s97, 4
    s_mov_b64 exec, 1
    s_cbranch_scc1 .fs_523
    buffer_store_dword v12, v13, s[8:11], s92 offen
.fj_524:
    s_mov_b64 exec, -1
    v_add_u32 v12, 1, v12
    s_mov_b32 s62, 0
.hk_525:
    v_max3_u32 v4, v96, v100, v104
    v_max3_u32 v5, v108, v112, v114
    v_max3_u32 v4, v4, v116, v118
    v_max3_u32 v5, v5, v120, v122
    v_max3_u32 v4, v4, v124, v126
    v_max_u32 v4, v4, v5
    v_cmp_eq_u32 vcc, -1, v4
    s_cbranch_vccnz .hf_526

.hd_521:
    v_mfma_f32_16x16x32_bf16 v[152:155], v[96:99], a[112:115], 0
    v_mfma_f32_16x16x32_bf16 v[152:155], v[100:103], a[116:119], v[152:155]
    v_mfma_f32_16x16x32_bf16 v[152:155], v[104:107], a[120:123], v[152:155]
    v_mfma_f32_16x16x32_bf16 v[152:155], v[108:111], a[124:127], v[152:155]
    s_nop 7
    v_cndmask_b32 v152, v14, v152, s[60:61]
    v_cndmask_b32 v153, v14, v153, s[60:61]
    v_cndmask_b32 v154, v14, v154, s[60:61]
    v_cndmask_b32 v155, v14, v155, s[60:61]
    v_max3_f32 v4, v152, v153, v154
    v_max_f32 v4, v4, v155
    v_mov_b32 v5, v4
    s_nop 1
    v_permlane32_swap_b32 v4, v5
    v_max_f32 v4, v4, v5
    v_mov_b32 v5, v4
    s_nop 1
    v_permlane16_swap_b32 v4, v5
    v_max_f32 v4, v4, v5
    v_mul_f32 v4, s39, v4
    v_max_f32 v4, v4, v192
    v_sub_f32 v6, v192, v4
    v_fma_f32 v176, v152, s39, -v4
    v_fma_f32 v177, v153, s39, -v4
    v_fma_f32 v178, v154, s39, -v4
    v_fma_f32 v179, v155, s39, -v4
    v_exp_f32 v176, v176
    v_exp_f32 v177, v177
    v_exp_f32 v178, v178
    v_exp_f32 v179, v179
    v_exp_f32 v6, v6
    v_add_f32 v4, v176, v177
    v_add_f32 v5, v178, v179
    v_add_f32 v4, v4, v5

    v_mov_b32 v5, v4
    s_nop 1
    v_permlane32_swap_b32 v4, v5
    v_add_f32 v4, v4, v5
    v_mov_b32 v5, v4
    s_nop 1
    v_permlane16_swap_b32 v4, v5
    v_add_f32 v4, v4, v5
    v_fma_f32 v4, v6, v193, v4
    v_rcp_f32 v4, v4
    s_nop 0
    v_mul_f32 v6, v6, v4
    v_pk_mul_f32 v[176:177], v[176:177], v[4:5] op_sel_hi:[1,0]
    v_pk_mul_f32 v[178:179], v[178:179], v[4:5] op_sel_hi:[1,0]

    v_cvt_pk_bf16_f32 v184, v176, v177
    v_cvt_pk_bf16_f32 v185, v178, v179
    v_pk_mul_f32 v[16:17], v[16:17], v[6:7] op_sel_hi:[1,0]
    v_pk_mul_f32 v[18:19], v[18:19], v[6:7] op_sel_hi:[1,0]
    v_pk_mul_f32 v[20:21], v[20:21], v[6:7] op_sel_hi:[1,0]
    v_pk_mul_f32 v[22:23], v[22:23], v[6:7] op_sel_hi:[1,0]
    s_cmp_lt_u32 s25, s96
    s_cbranch_scc1 .hs_529
    v_mfma_f32_16x16x16_bf16 v[16:19], v[112:113], v[184:185], v[16:19]
    v_pk_mul_f32 v[24:25], v[24:25], v[6:7] op_sel_hi:[1,0]
    v_pk_mul_f32 v[26:27], v[26:27], v[6:7] op_sel_hi:[1,0]
    v_mfma_f32_16x16x16_bf16 v[20:23], v[114:115], v[184:185], v[20:23]
    v_pk_mul_f32 v[28:29], v[28:29], v[6:7] op_sel_hi:[1,0]
    v_pk_mul_f32 v[30:31], v[30:31], v[6:7] op_sel_hi:[1,0]
    v_mfma_f32_16x16x16_bf16 v[24:27], v[116:117], v[184:185], v[24:27]
    v_pk_mul_f32 v[32:33], v[32:33], v[6:7] op_sel_hi:[1,0]
    v_pk_mul_f32 v[34:35], v[34:35], v[6:7] op_sel_hi:[1,0]
    v_mfma_f32_16x16x16_bf16 v[28:31], v[118:119], v[184:185], v[28:31]
    v_pk_mul_f32 v[36:37], v[36:37], v[6:7] op_sel_hi:[1,0]
    v_pk_mul_f32 v[38:39], v[38:39], v[6:7] op_sel_hi:[1,0]
    v_mfma_f32_16x16x16_bf16 v[32:35], v[120:121], v[184:185], v[32:35]
    v_pk_mul_f32 v[40:41], v[40:41], v[6:7] op_sel_hi:[1,0]
    v_pk_mul_f32 v[42:43], v[42:43], v[6:7] op_sel_hi:[1,0]
    v_mfma_f32_16x16x16_bf16 v[36:39], v[122:123], v[184:185], v[36:39]
    v_pk_mul_f32 v[44:45], v[44:45], v[6:7] op_sel_hi:[1,0]
    v_pk_mul_f32 v[46:47], v[46:47], v[6:7] op_sel_hi:[1,0]
    v_mfma_f32_16x16x16_bf16 v[40:43], v[124:125], v[184:185], v[40:43]
    v_cvt_pk_bf16_f32 v208, v16, v17
    v_cvt_pk_bf16_f32 v209, v18, v19
    v_cvt_pk_bf16_f32 v210, v20, v21
    v_cvt_pk_bf16_f32 v211, v22, v23
    buffer_store_dwordx4 v[208:211], v8, s[8:11], s50 offen offset:0
    v_mfma_f32_16x16x16_bf16 v[44:47], v[126:127], v[184:185], v[44:47]
    v_cvt_pk_bf16_f32 v212, v24, v25
    v_cvt_pk_bf16_f32 v213, v26, v27
    v_cvt_pk_bf16_f32 v214, v28, v29
    v_cvt_pk_bf16_f32 v215, v30, v31
    buffer_store_dwordx4 v[212:215], v8, s[8:11], s50 offen offset:1024
    v_cvt_pk_bf16_f32 v216, v32, v33
    v_cvt_pk_bf16_f32 v217, v34, v35
    v_cvt_pk_bf16_f32 v218, v36, v37
    v_cvt_pk_bf16_f32 v219, v38, v39
    buffer_store_dwordx4 v[216:219], v8, s[8:11], s50 offen offset:2048
    v_cvt_pk_bf16_f32 v220, v40, v41
    v_cvt_pk_bf16_f32 v221, v42, v43
    v_cvt_pk_bf16_f32 v222, v44, v45
    v_cvt_pk_bf16_f32 v223, v46, v47
    buffer_store_dwordx4 v[220:223], v8, s[8:11], s50 offen offset:3072
    s_cmp_lg_u32 s52, 0
    s_cbranch_scc1 .hb_522
    s_waitcnt vmcnt(0)
    s_mov_b64 exec, 1
    buffer_store_dword v12, v13, s[8:11], s92 offen
    s_mov_b64 exec, -1
    s_branch .ate_497
.fs_498:
    buffer_store_dword v12, v13, s[8:11], s92 offen sc1
    s_branch .fj_499
.fs_503:
    buffer_store_dword v12, v13, s[8:11], s92 offen sc1
    s_branch .fj_504
.fs_509:
    buffer_store_dword v12, v13, s[8:11], s92 offen sc1
    s_branch .fj_510
.fs_514:
    buffer_store_dword v12, v13, s[8:11], s92 offen sc1
    s_branch .fj_515
.hf_517:
    s_cmp_lg_u32 s62, 0
    s_cbranch_scc1 .hn_518
    s_sub_u32 s5, s34, 196608
    s_mov_b64 exec, 15

.hq_519:
    s_sleep 4
    buffer_load_dword v4, v204, s[8:11], s5 offen sc1
    s_add_u32 s62, s62, 1
    s_cmp_gt_u32 s62, 0x200000
    s_cbranch_scc1 .mg_end_1
    s_waitcnt vmcnt(0)
    v_cmp_eq_u32 vcc, -1, v4
    s_cbranch_vccnz .hq_519
    s_mov_b64 exec, -1

.hn_518:
    s_sleep 1
    buffer_load_dwordx4 v[80:83], v10, s[8:11], s34 offen offset:2048 sc1
    buffer_load_dwordx4 v[84:87], v10, s[8:11], s34 offen offset:2176 sc1
    buffer_load_dwordx4 v[88:91], v10, s[8:11], s34 offen offset:3072 sc1
    buffer_load_dwordx4 v[92:95], v10, s[8:11], s34 offen offset:3200 sc1
    s_add_u32 s4, s34, 4096
    s_mov_b64 exec, s[60:61]
    buffer_load_dwordx2 v[128:129], v11, s[8:11], s4 offen offset:0 sc1
    buffer_load_dwordx2 v[130:131], v11, s[8:11], s4 offen offset:256 sc1
    buffer_load_dwordx2 v[132:133], v11, s[8:11], s4 offen offset:512 sc1
    buffer_load_dwordx2 v[134:135], v11, s[8:11], s4 offen offset:768 sc1
    buffer_load_dwordx2 v[136:137], v11, s[8:11], s4 offen offset:1024 sc1
    buffer_load_dwordx2 v[138:139], v11, s[8:11], s4 offen offset:1280 sc1
    buffer_load_dwordx2 v[140:141], v11, s[8:11], s4 offen offset:1536 sc1
    buffer_load_dwordx2 v[142:143], v11, s[8:11], s4 offen offset:1792 sc1
    s_mov_b64 exec, -1
    s_add_u32 s62, s62, 1
    s_cmp_gt_u32 s62, 0x200000
    s_cbranch_scc1 .mg_end_1
    s_waitcnt vmcnt(0)
    s_branch .hk_516

.hs_520:
    v_mfma_f32_16x16x16_bf16 v[16:19], v[128:129], v[184:185], v[16:19]
    v_pk_mul_f32 v[24:25], v[24:25], v[6:7] op_sel_hi:[1,0]
    v_pk_mul_f32 v[26:27], v[26:27], v[6:7] op_sel_hi:[1,0]
    v_mfma_f32_16x16x16_bf16 v[20:23], v[130:131], v[184:185], v[20:23]
    v_pk_mul_f32 v[28:29], v[28:29], v[6:7] op_sel_hi:[1,0]
    v_pk_mul_f32 v[30:31], v[30:31], v[6:7] op_sel_hi:[1,0]
    v_mfma_f32_16x16x16_bf16 v[24:27], v[132:133], v[184:185], v[24:27]
    v_pk_mul_f32 v[32:33], v[32:33], v[6:7] op_sel_hi:[1,0]
    v_pk_mul_f32 v[34:35], v[34:35], v[6:7] op_sel_hi:[1,0]
    v_mfma_f32_16x16x16_bf16 v[28:31], v[134:135], v[184:185], v[28:31]
    v_pk_mul_f32 v[36:37], v[36:37], v[6:7] op_sel_hi:[1,0]
    v_pk_mul_f32 v[38:39], v[38:39], v[6:7] op_sel_hi:[1,0]
    v_mfma_f32_16x16x16_bf16 v[32:35], v[136:137], v[184:185], v[32:35]
    v_pk_mul_f32 v[40:41], v[40:41], v[6:7] op_sel_hi:[1,0]
    v_pk_mul_f32 v[42:43], v[42:43], v[6:7] op_sel_hi:[1,0]
    v_mfma_f32_16x16x16_bf16 v[36:39], v[138:139], v[184:185], v[36:39]
    v_pk_mul_f32 v[44:45], v[44:45], v[6:7] op_sel_hi:[1,0]
    v_pk_mul_f32 v[46:47], v[46:47], v[6:7] op_sel_hi:[1,0]
    v_mfma_f32_16x16x16_bf16 v[40:43], v[140:141], v[184:185], v[40:43]
    v_cvt_pk_bf16_f32 v208, v16, v17
    v_cvt_pk_bf16_f32 v209, v18, v19
    v_cvt_pk_bf16_f32 v210, v20, v21
    v_cvt_pk_bf16_f32 v211, v22, v23
    buffer_store_dwordx4 v[208:211], v8, s[8:11], s50 offen offset:0 sc1
    v_mfma_f32_16x16x16_bf16 v[44:47], v[142:143], v[184:185], v[44:47]
    v_cvt_pk_bf16_f32 v212, v24, v25
    v_cvt_pk_bf16_f32 v213, v26, v27
    v_cvt_pk_bf16_f32 v214, v28, v29
    v_cvt_pk_bf16_f32 v215, v30, v31
    buffer_store_dwordx4 v[212:215], v8, s[8:11], s50 offen offset:1024 sc1
    v_cvt_pk_bf16_f32 v216, v32, v33
    v_cvt_pk_bf16_f32 v217, v34, v35
    v_cvt_pk_bf16_f32 v218, v36, v37
    v_cvt_pk_bf16_f32 v219, v38, v39
    buffer_store_dwordx4 v[216:219], v8, s[8:11], s50 offen offset:2048 sc1
    v_cvt_pk_bf16_f32 v220, v40, v41
    v_cvt_pk_bf16_f32 v221, v42, v43
    v_cvt_pk_bf16_f32 v222, v44, v45
    v_cvt_pk_bf16_f32 v223, v46, v47
    buffer_store_dwordx4 v[220:223], v8, s[8:11], s50 offen offset:3072 sc1
    s_cmp_lg_u32 s52, 0
    s_cbranch_scc1 .hb_513
    s_branch .ahz_480
.fs_523:
    buffer_store_dword v12, v13, s[8:11], s92 offen sc1
    s_branch .fj_524
.hf_526:
    s_cmp_lg_u32 s62, 0
    s_cbranch_scc1 .hn_527
    s_sub_u32 s5, s34, 196608
    s_mov_b64 exec, 15

.hq_528:
    s_sleep 4
    buffer_load_dword v4, v204, s[8:11], s5 offen sc1
    s_add_u32 s62, s62, 1
    s_cmp_gt_u32 s62, 0x200000
    s_cbranch_scc1 .mg_end_1
    s_waitcnt vmcnt(0)
    v_cmp_eq_u32 vcc, -1, v4
    s_cbranch_vccnz .hq_528
    s_mov_b64 exec, -1

.hn_527:
    s_sleep 1
    buffer_load_dwordx4 v[96:99], v10, s[8:11], s34 offen offset:2048 sc1
    buffer_load_dwordx4 v[100:103], v10, s[8:11], s34 offen offset:2176 sc1
    buffer_load_dwordx4 v[104:107], v10, s[8:11], s34 offen offset:3072 sc1
    buffer_load_dwordx4 v[108:111], v10, s[8:11], s34 offen offset:3200 sc1
    s_add_u32 s4, s34, 4096
    s_mov_b64 exec, s[60:61]
    buffer_load_dwordx2 v[112:113], v11, s[8:11], s4 offen offset:0 sc1
    buffer_load_dwordx2 v[114:115], v11, s[8:11], s4 offen offset:256 sc1
    buffer_load_dwordx2 v[116:117], v11, s[8:11], s4 offen offset:512 sc1
    buffer_load_dwordx2 v[118:119], v11, s[8:11], s4 offen offset:768 sc1
    buffer_load_dwordx2 v[120:121], v11, s[8:11], s4 offen offset:1024 sc1
    buffer_load_dwordx2 v[122:123], v11, s[8:11], s4 offen offset:1280 sc1
    buffer_load_dwordx2 v[124:125], v11, s[8:11], s4 offen offset:1536 sc1
    buffer_load_dwordx2 v[126:127], v11, s[8:11], s4 offen offset:1792 sc1
    s_mov_b64 exec, -1
    s_add_u32 s62, s62, 1
    s_cmp_gt_u32 s62, 0x200000
    s_cbranch_scc1 .mg_end_1
    s_waitcnt vmcnt(0)
    s_branch .hk_525

.hs_529:
    v_mfma_f32_16x16x16_bf16 v[16:19], v[112:113], v[184:185], v[16:19]
    v_pk_mul_f32 v[24:25], v[24:25], v[6:7] op_sel_hi:[1,0]
    v_pk_mul_f32 v[26:27], v[26:27], v[6:7] op_sel_hi:[1,0]
    v_mfma_f32_16x16x16_bf16 v[20:23], v[114:115], v[184:185], v[20:23]
    v_pk_mul_f32 v[28:29], v[28:29], v[6:7] op_sel_hi:[1,0]
    v_pk_mul_f32 v[30:31], v[30:31], v[6:7] op_sel_hi:[1,0]
    v_mfma_f32_16x16x16_bf16 v[24:27], v[116:117], v[184:185], v[24:27]
    v_pk_mul_f32 v[32:33], v[32:33], v[6:7] op_sel_hi:[1,0]
    v_pk_mul_f32 v[34:35], v[34:35], v[6:7] op_sel_hi:[1,0]
    v_mfma_f32_16x16x16_bf16 v[28:31], v[118:119], v[184:185], v[28:31]
    v_pk_mul_f32 v[36:37], v[36:37], v[6:7] op_sel_hi:[1,0]
    v_pk_mul_f32 v[38:39], v[38:39], v[6:7] op_sel_hi:[1,0]
    v_mfma_f32_16x16x16_bf16 v[32:35], v[120:121], v[184:185], v[32:35]
    v_pk_mul_f32 v[40:41], v[40:41], v[6:7] op_sel_hi:[1,0]
    v_pk_mul_f32 v[42:43], v[42:43], v[6:7] op_sel_hi:[1,0]
    v_mfma_f32_16x16x16_bf16 v[36:39], v[122:123], v[184:185], v[36:39]
    v_pk_mul_f32 v[44:45], v[44:45], v[6:7] op_sel_hi:[1,0]
    v_pk_mul_f32 v[46:47], v[46:47], v[6:7] op_sel_hi:[1,0]
    v_mfma_f32_16x16x16_bf16 v[40:43], v[124:125], v[184:185], v[40:43]
    v_cvt_pk_bf16_f32 v208, v16, v17
    v_cvt_pk_bf16_f32 v209, v18, v19
    v_cvt_pk_bf16_f32 v210, v20, v21
    v_cvt_pk_bf16_f32 v211, v22, v23
    buffer_store_dwordx4 v[208:211], v8, s[8:11], s50 offen offset:0 sc1
    v_mfma_f32_16x16x16_bf16 v[44:47], v[126:127], v[184:185], v[44:47]
    v_cvt_pk_bf16_f32 v212, v24, v25
    v_cvt_pk_bf16_f32 v213, v26, v27
    v_cvt_pk_bf16_f32 v214, v28, v29
    v_cvt_pk_bf16_f32 v215, v30, v31
    buffer_store_dwordx4 v[212:215], v8, s[8:11], s50 offen offset:1024 sc1
    v_cvt_pk_bf16_f32 v216, v32, v33
    v_cvt_pk_bf16_f32 v217, v34, v35
    v_cvt_pk_bf16_f32 v218, v36, v37
    v_cvt_pk_bf16_f32 v219, v38, v39
    buffer_store_dwordx4 v[216:219], v8, s[8:11], s50 offen offset:2048 sc1
    v_cvt_pk_bf16_f32 v220, v40, v41
    v_cvt_pk_bf16_f32 v221, v42, v43
    v_cvt_pk_bf16_f32 v222, v44, v45
    v_cvt_pk_bf16_f32 v223, v46, v47
    buffer_store_dwordx4 v[220:223], v8, s[8:11], s50 offen offset:3072 sc1
    s_cmp_lg_u32 s52, 0
    s_cbranch_scc1 .hb_522
    s_branch .ahz_480
.ate_497:
.mg_end_1:
    s_endpgm
.section .rodata,"a"
.p2align 6
.amdhsa_kernel mega_kernel
  .amdhsa_next_free_vgpr 512
  .amdhsa_next_free_sgpr 102
  .amdhsa_accum_offset 256
  .amdhsa_group_segment_fixed_size 0
  .amdhsa_kernarg_size 136
  .amdhsa_user_sgpr_count 2
  .amdhsa_user_sgpr_kernarg_segment_ptr 1
  .amdhsa_system_sgpr_workgroup_id_x 1
.end_amdhsa_kernel
```

```asm
; @launch kernel=mega_kernel grid=(256,1,1) block=(256,1,1) lds=163840
.amdgcn_target "amdgcn-amd-amdhsa--gfx950"
.text
.globl mega_kernel
.p2align 8
.type mega_kernel,@function
mega_kernel:
    s_cmp_ge_u32 s2, 256
    s_cbranch_scc1 .mg_end_1

    s_load_dwordx4 s[52:55], s[0:1], 120
    s_load_dwordx2 s[40:41], s[0:1], 56
    s_getreg_b32 s3, hwreg(HW_REG_XCC_ID)
    v_and_b32 v1, 63, v0
    v_lshrrev_b32 v4, 6, v0
    s_and_b32 s3, s3, 7
    v_readfirstlane_b32 s24, v4
    s_waitcnt lgkmcnt(0)

    s_mov_b32 s8, s54
    s_and_b32 s9, s55, 0xffff
    s_mov_b32 s10, 0x10000000
    s_mov_b32 s11, 0x00020000

    s_mov_b32 s20, s52
    s_and_b32 s21, s53, 0xffff
    s_mov_b32 s22, 0x100
    s_mov_b32 s23, 0x00020000

    s_mov_b32 s100, s54
    s_cmp_lg_u32 s24, 0
    s_cbranch_scc1 .noat_4
    s_mov_b64 exec, 1
    v_mov_b32 v5, 1
    s_lshl_b32 s4, s3, 2
    s_lshl_b32 s4, s3, 5
    s_add_u32 s4, s4, 28
    v_mov_b32 v6, s4
    buffer_atomic_add v5, v6, s[20:23], 0 offen sc0 sc1
    v_mov_b32 v7, 163776
    s_waitcnt vmcnt(0)
    ds_write_b32 v7, v5
    v_cmp_lt_u32 vcc, 31, v5
    s_cbranch_vccz .nb_5
    v_mov_b32 v6, 136
    buffer_store_dword v7, v6, s[20:23], 0 offen sc1

.nb_5:
    s_waitcnt lgkmcnt(0)
    s_mov_b64 exec, -1

.noat_4:
    s_barrier
    v_mov_b32 v7, 163776
    ds_read_b32 v5, v7
    s_waitcnt lgkmcnt(0)
    v_readfirstlane_b32 s26, v5
    s_mov_b32 s25, s3
    s_mov_b32 s27, 0
    s_mov_b32 s97, 128
    s_cmp_lt_u32 s26, 32
    s_cselect_b32 s99, 1, 0
    s_and_b32 s26, s26, 31

.mg_role_3:
    s_cmp_ge_u32 s25, 4
    s_cbranch_scc1 .mg_bg_2

    s_load_dwordx8 s[44:51], s[0:1], 64
    s_load_dwordx2 s[40:41], s[0:1], 56
    v_and_b32 v1, 63, v0
    v_and_b32 v2, 15, v1
    v_lshrrev_b32 v3, 4, v1

    s_lshr_b32 s79, s26, 2
    s_xor_b32 s63, s26, 4
    s_and_b32 s78, s24, 1
    s_lshl_b32 s34, s25, 19
    s_add_u32 s34, s34, 83886080
    v_lshlrev_b32 v14, 4, v1
    v_lshrrev_b32 v6, 1, v3
    s_sub_u32 s101, 0, s100
    s_and_b32 s101, s101, 0x1fffff
    s_add_u32 s101, s101, 100663296

    v_mov_b32 v188, -1
    v_mov_b32 v189, -1
    v_mov_b32 v190, -1
    v_mov_b32 v191, -1
    s_lshl_b32 s5, s26, 10
    s_add_u32 s5, s5, 40960
    v_add_u32 v235, s5, v14
    s_lshr_b32 s4, s63, 3
    s_mul_i32 s4, s4, 1024
    s_lshl_b32 s5, s63, 9
    s_add_u32 s76, s4, s5
    s_lshl_b32 s5, s26, 9
    s_xor_b32 s5, s5, 1024
    s_lshr_b32 s4, s26, 4
    s_mul_i32 s4, s4, 0
    s_add_u32 s77, s4, s5
    s_add_u32 s77, s77, 20480
    s_sub_u32 s4, s77, s76
    v_and_b32 v4, 31, v1
    v_lshlrev_b32 v236, 4, v4
    v_mad_u32_u24 v236, v6, s4, v236
    v_add_u32 v236, s76, v236
    s_and_b32 s5, s63, 7
    s_lshl_b32 s4, s5, 10
    s_lshr_b32 s5, s63, 3
    s_lshl_b32 s5, s5, 14
    s_add_u32 s4, s4, s5
    s_add_u32 s35, s4, s101
    s_lshl_b32 s5, s25, 16
    v_add_u32 v238, s5, v14
    s_lshl_b32 s4, s25, 3
    s_add_u32 s7, s4, s79
    s_mul_i32 s36, s7, 6144
    s_add_u32 s36, s36, 67108864

    s_cmp_eq_u32 s78, 0
    s_cselect_b64 vcc, -1, 0
    s_lshr_b32 s6, s24, 1
    s_lshl_b32 s4, s6, 17
    s_add_u32 s4, s4, s34
    v_cndmask_b32 v4, v235, v236, vcc
    s_mul_i32 s5, s6, 1048576
    s_lshl_b32 s6, s78, 13
    buffer_store_dwordx4 v[188:191], v4, s[8:11], s4 offen sc1
    s_add_u32 s5, s5, s6
    s_add_u32 s5, s5, s35

    buffer_store_dwordx4 v[188:191], v238, s[8:11], s5 offen sc1
    s_add_u32 s5, s5, 262144
    buffer_store_dwordx4 v[188:191], v238, s[8:11], s5 offen sc1
    s_add_u32 s5, s5, 262144
    s_lshl_b32 s4, s25, 11
    s_lshl_b32 s5, s26, 6
    s_add_u32 s4, s4, s5
    s_lshl_b32 s5, s24, 21
    s_add_u32 s4, s4, s5
    v_lshrrev_b32 v4, 2, v1
    v_and_b32 v5, 3, v1
    v_lshlrev_b32 v5, 4, v5
    v_lshlrev_b32 v6, 13, v4
    v_add_u32 v6, v6, v5
    v_add_u32 v240, s4, v6
    s_lshl_b32 s4, s25, 2
    s_and_b32 s5, s24, 1
    s_lshl_b32 s5, s5, 1
    s_add_u32 s4, s4, s5
    s_lshr_b32 s5, s24, 1
    s_lshl_b32 s80, s5, 1
    s_lshl_b32 s4, s4, 19
    s_lshl_b32 s5, s63, 6
    s_add_u32 s4, s4, s5
    v_xor_b32 v224, 128, v240
    v_lshlrev_b32 v6, 11, v4
    v_add_u32 v6, v6, v5
    v_add_u32 v241, s4, v6
    s_lshl_b32 s98, s24, 15
    s_waitcnt lgkmcnt(0)

    s_add_u32 s80, s80, s79
    s_add_u32 s81, s80, 2
    s_add_u32 s80, s80, 1
    s_and_b32 s80, s80, 3
    s_and_b32 s81, s81, 3
    s_lshl_b32 s80, s80, 18
    s_lshl_b32 s81, s81, 18

    s_barrier
    s_bitcmp1_b32 s26, 0
    s_cbranch_scc1 .po_7
    s_mov_b32 s16, s44
    s_and_b32 s17, s45, 0xffff
    s_mov_b32 s18, 0x800000
    s_mov_b32 s19, 0x00020000

    s_add_u32 m0, s98, 0
    s_mov_b32 s5, 0
    buffer_load_dwordx4 v240, s[16:19], s5 offen  lds

    s_add_u32 m0, s98, 1024
    s_mov_b32 s5, 131072
    buffer_load_dwordx4 v240, s[16:19], s5 offen  lds

    s_add_u32 m0, s98, 2048
    s_mov_b32 s5, 262144
    buffer_load_dwordx4 v240, s[16:19], s5 offen  lds

    s_add_u32 m0, s98, 3072
    s_mov_b32 s5, 393216
    buffer_load_dwordx4 v240, s[16:19], s5 offen  lds

    s_add_u32 m0, s98, 4096
    s_mov_b32 s5, 524288
    buffer_load_dwordx4 v240, s[16:19], s5 offen  lds

    s_add_u32 m0, s98, 5120
    s_mov_b32 s5, 655360
    buffer_load_dwordx4 v240, s[16:19], s5 offen  lds

    s_add_u32 m0, s98, 6144
    s_mov_b32 s5, 786432
    buffer_load_dwordx4 v240, s[16:19], s5 offen  lds

    s_add_u32 m0, s98, 7168
    s_mov_b32 s5, 917504
    buffer_load_dwordx4 v240, s[16:19], s5 offen  lds

    s_branch .pj_8
.po_7:
    s_mov_b32 s16, s44
    s_and_b32 s17, s45, 0xffff
    s_mov_b32 s18, 0x800000
    s_mov_b32 s19, 0x00020000

    s_add_u32 m0, s98, 8192
    s_mov_b32 s5, 1048576
    buffer_load_dwordx4 v240, s[16:19], s5 offen  lds

    s_add_u32 m0, s98, 9216
    s_mov_b32 s5, 1179648
    buffer_load_dwordx4 v240, s[16:19], s5 offen  lds

    s_add_u32 m0, s98, 10240
    s_mov_b32 s5, 1310720
    buffer_load_dwordx4 v240, s[16:19], s5 offen  lds

    s_add_u32 m0, s98, 11264
    s_mov_b32 s5, 1441792
    buffer_load_dwordx4 v240, s[16:19], s5 offen  lds

    s_add_u32 m0, s98, 12288
    s_mov_b32 s5, 1572864
    buffer_load_dwordx4 v240, s[16:19], s5 offen  lds

    s_add_u32 m0, s98, 13312
    s_mov_b32 s5, 1703936
    buffer_load_dwordx4 v240, s[16:19], s5 offen  lds

    s_add_u32 m0, s98, 14336
    s_mov_b32 s5, 1835008
    buffer_load_dwordx4 v240, s[16:19], s5 offen  lds

    s_add_u32 m0, s98, 15360
    s_mov_b32 s5, 1966080
    buffer_load_dwordx4 v240, s[16:19], s5 offen  lds

.pj_8:
    s_waitcnt vmcnt(8)
    s_barrier
    v_mov_b32 v243, s99
    v_mov_b32 v242, 0
    s_cmp_lg_u32 s24, 3
    s_cbranch_scc1 .a1_9
    v_mov_b32 v242, s26
    v_lshlrev_b32 v242, 6, v242
    v_add_u32 v242, s97, v242
    v_and_b32 v242, 255, v242
    s_mov_b64 exec, 1
    buffer_atomic_add v243, v242, s[20:23], 0 offen sc1
    s_mov_b64 exec, -1

.a1_9:
    s_bitcmp1_b32 s26, 0
    s_cbranch_scc1 .po_11
    s_add_u32 m0, s98, 8192
    s_mov_b32 s5, 1048576
    buffer_load_dwordx4 v240, s[16:19], s5 offen  lds

    s_add_u32 m0, s98, 9216
    s_mov_b32 s5, 1179648
    buffer_load_dwordx4 v240, s[16:19], s5 offen  lds

    s_add_u32 m0, s98, 10240
    s_mov_b32 s5, 1310720
    buffer_load_dwordx4 v240, s[16:19], s5 offen  lds

    s_add_u32 m0, s98, 11264
    s_mov_b32 s5, 1441792
    buffer_load_dwordx4 v240, s[16:19], s5 offen  lds

    s_add_u32 m0, s98, 12288
    s_mov_b32 s5, 1572864
    buffer_load_dwordx4 v240, s[16:19], s5 offen  lds

    s_add_u32 m0, s98, 13312
    s_mov_b32 s5, 1703936
    buffer_load_dwordx4 v240, s[16:19], s5 offen  lds

    s_add_u32 m0, s98, 14336
    s_mov_b32 s5, 1835008
    buffer_load_dwordx4 v240, s[16:19], s5 offen  lds

    s_add_u32 m0, s98, 15360
    s_mov_b32 s5, 1966080
    buffer_load_dwordx4 v240, s[16:19], s5 offen  lds

    s_mov_b32 s16, s46
    s_and_b32 s17, s47, 0xffff
    s_mov_b32 s18, 0x800000
    s_mov_b32 s19, 0x00020000

    s_add_u32 m0, s98, 16384
    s_mov_b32 s5, 0
    buffer_load_dwordx4 v240, s[16:19], s5 offen  lds

    s_add_u32 m0, s98, 17408
    s_mov_b32 s5, 131072
    buffer_load_dwordx4 v240, s[16:19], s5 offen  lds

    s_add_u32 m0, s98, 18432
    s_mov_b32 s5, 262144
    buffer_load_dwordx4 v240, s[16:19], s5 offen  lds

    s_add_u32 m0, s98, 19456
    s_mov_b32 s5, 393216
    buffer_load_dwordx4 v240, s[16:19], s5 offen  lds

    s_add_u32 m0, s98, 20480
    s_mov_b32 s5, 524288
    buffer_load_dwordx4 v240, s[16:19], s5 offen  lds

    s_add_u32 m0, s98, 21504
    s_mov_b32 s5, 655360
    buffer_load_dwordx4 v240, s[16:19], s5 offen  lds

    s_add_u32 m0, s98, 22528
    s_mov_b32 s5, 786432
    buffer_load_dwordx4 v240, s[16:19], s5 offen  lds

    s_add_u32 m0, s98, 23552
    s_mov_b32 s5, 917504
    buffer_load_dwordx4 v240, s[16:19], s5 offen  lds

    s_add_u32 m0, s98, 24576
    s_mov_b32 s5, 1048576
    buffer_load_dwordx4 v240, s[16:19], s5 offen  lds

    s_add_u32 m0, s98, 25600
    s_mov_b32 s5, 1179648
    buffer_load_dwordx4 v240, s[16:19], s5 offen  lds

    s_add_u32 m0, s98, 26624
    s_mov_b32 s5, 1310720
    buffer_load_dwordx4 v240, s[16:19], s5 offen  lds

    s_add_u32 m0, s98, 27648
    s_mov_b32 s5, 1441792
    buffer_load_dwordx4 v240, s[16:19], s5 offen  lds

    s_add_u32 m0, s98, 28672
    s_mov_b32 s5, 1572864
    buffer_load_dwordx4 v240, s[16:19], s5 offen  lds

    s_add_u32 m0, s98, 29696
    s_mov_b32 s5, 1703936
    buffer_load_dwordx4 v240, s[16:19], s5 offen  lds

    s_add_u32 m0, s98, 30720
    s_mov_b32 s5, 1835008
    buffer_load_dwordx4 v240, s[16:19], s5 offen  lds

    s_add_u32 m0, s98, 31744
    s_mov_b32 s5, 1966080
    buffer_load_dwordx4 v240, s[16:19], s5 offen  lds

    s_branch .pj_12
.po_11:
    s_add_u32 m0, s98, 0
    s_mov_b32 s5, 0
    buffer_load_dwordx4 v240, s[16:19], s5 offen  lds

    s_add_u32 m0, s98, 1024
    s_mov_b32 s5, 131072
    buffer_load_dwordx4 v240, s[16:19], s5 offen  lds

    s_add_u32 m0, s98, 2048
    s_mov_b32 s5, 262144
    buffer_load_dwordx4 v240, s[16:19], s5 offen  lds

    s_add_u32 m0, s98, 3072
    s_mov_b32 s5, 393216
    buffer_load_dwordx4 v240, s[16:19], s5 offen  lds

    s_add_u32 m0, s98, 4096
    s_mov_b32 s5, 524288
    buffer_load_dwordx4 v240, s[16:19], s5 offen  lds

    s_add_u32 m0, s98, 5120
    s_mov_b32 s5, 655360
    buffer_load_dwordx4 v240, s[16:19], s5 offen  lds

    s_add_u32 m0, s98, 6144
    s_mov_b32 s5, 786432
    buffer_load_dwordx4 v240, s[16:19], s5 offen  lds

    s_add_u32 m0, s98, 7168
    s_mov_b32 s5, 917504
    buffer_load_dwordx4 v240, s[16:19], s5 offen  lds

    s_mov_b32 s16, s46
    s_and_b32 s17, s47, 0xffff
    s_mov_b32 s18, 0x800000
    s_mov_b32 s19, 0x00020000

    s_add_u32 m0, s98, 24576
    s_mov_b32 s5, 1048576
    buffer_load_dwordx4 v240, s[16:19], s5 offen  lds

    s_add_u32 m0, s98, 25600
    s_mov_b32 s5, 1179648
    buffer_load_dwordx4 v240, s[16:19], s5 offen  lds

    s_add_u32 m0, s98, 26624
    s_mov_b32 s5, 1310720
    buffer_load_dwordx4 v240, s[16:19], s5 offen  lds

    s_add_u32 m0, s98, 27648
    s_mov_b32 s5, 1441792
    buffer_load_dwordx4 v240, s[16:19], s5 offen  lds

    s_add_u32 m0, s98, 28672
    s_mov_b32 s5, 1572864
    buffer_load_dwordx4 v240, s[16:19], s5 offen  lds

    s_add_u32 m0, s98, 29696
    s_mov_b32 s5, 1703936
    buffer_load_dwordx4 v240, s[16:19], s5 offen  lds

    s_add_u32 m0, s98, 30720
    s_mov_b32 s5, 1835008
    buffer_load_dwordx4 v240, s[16:19], s5 offen  lds

    s_add_u32 m0, s98, 31744
    s_mov_b32 s5, 1966080
    buffer_load_dwordx4 v240, s[16:19], s5 offen  lds

    s_add_u32 m0, s98, 16384
    s_mov_b32 s5, 0
    buffer_load_dwordx4 v240, s[16:19], s5 offen  lds

    s_add_u32 m0, s98, 17408
    s_mov_b32 s5, 131072
    buffer_load_dwordx4 v240, s[16:19], s5 offen  lds

    s_add_u32 m0, s98, 18432
    s_mov_b32 s5, 262144
    buffer_load_dwordx4 v240, s[16:19], s5 offen  lds

    s_add_u32 m0, s98, 19456
    s_mov_b32 s5, 393216
    buffer_load_dwordx4 v240, s[16:19], s5 offen  lds

    s_add_u32 m0, s98, 20480
    s_mov_b32 s5, 524288
    buffer_load_dwordx4 v240, s[16:19], s5 offen  lds

    s_add_u32 m0, s98, 21504
    s_mov_b32 s5, 655360
    buffer_load_dwordx4 v240, s[16:19], s5 offen  lds

    s_add_u32 m0, s98, 22528
    s_mov_b32 s5, 786432
    buffer_load_dwordx4 v240, s[16:19], s5 offen  lds

    s_add_u32 m0, s98, 23552
    s_mov_b32 s5, 917504
    buffer_load_dwordx4 v240, s[16:19], s5 offen  lds

.pj_12:
    s_mov_b32 s12, s40
    s_and_b32 s13, s41, 0xffff
    s_mov_b32 s14, 0x4000
    s_mov_b32 s15, 0x00020000

    v_bfe_u32 v4, v2, 2, 1
    v_lshrrev_b32 v5, 3, v2
    v_lshrrev_b32 v8, 1, v3
    v_and_b32 v9, 1, v3
    v_lshl_add_u32 v6, v5, 3, v4
    v_lshl_add_u32 v6, v8, 4, v6
    v_lshl_add_u32 v6, v9, 2, v6
    v_lshl_add_u32 v7, v5, 2, v4
    v_lshl_add_u32 v7, v8, 3, v7
    v_lshl_add_u32 v7, v9, 4, v7
    v_and_b32 v5, 3, v2
    v_lshlrev_b32 v5, 3, v5
    v_lshl_add_u32 v6, v6, 6, v5
    v_lshl_add_u32 v7, v7, 6, v5
    v_add_u32 v254, s98, v6
    v_add_u32 v255, s98, v7
    v_sub_u32 v252, v254, v5
    v_and_b32 v5, 1, v2
    v_lshl_add_u32 v252, v5, 5, v252
    v_bfe_u32 v5, v2, 1, 1
    v_lshl_add_u32 v252, v5, 3, v252

    s_and_b32 s96, s26, 3
    s_lshl_b32 s4, s25, 3
    s_add_u32 s7, s4, s79
    s_mul_i32 s5, s24, 5120
    v_add_u32 v8, s5, v14
    v_and_b32 v5, 7, v2
    v_lshrrev_b32 v6, 1, v3
    v_and_b32 v7, 1, v3
    v_lshlrev_b32 v7, 3, v7
    v_lshlrev_b32 v17, 11, v5
    v_lshl_add_u32 v17, v3, 5, v17
    v_lshrrev_b32 v4, 3, v2
    v_lshl_add_u32 v17, v4, 4, v17
    s_lshl_b32 s5, s24, 9
    v_add_u32 v17, s5, v17

    buffer_load_dwordx4 v[20:23], v17, s[12:15], 0 offen offset:0
    buffer_load_dwordx4 v[24:27], v17, s[12:15], 0 offen offset:128
    buffer_load_dwordx4 v[28:31], v17, s[12:15], 0 offen offset:256
    buffer_load_dwordx4 v[32:35], v17, s[12:15], 0 offen offset:384
    v_lshlrev_b32 v4, 7, v2
    v_lshl_add_u32 v18, s26, 10, v4
    v_add_u32 v18, 40960, v18
    v_and_b32 v4, 0x180, v4
    v_add_u32 v4, s76, v4
    v_bfe_u32 v19, v2, 2, 1
    s_sub_u32 s4, s77, s76
    v_mad_u32_u24 v4, v19, s4, v4
    v_cmp_gt_u32 vcc, 8, v2
    s_lshl_b32 s4, s24, 17
    s_add_u32 s4, s4, s34
    v_cndmask_b32 v4, v4, v18, vcc

    v_add_u32 v226, s4, v4

    s_mov_b64 exec, 0xffff
    buffer_load_dword v227, v4, s[8:11], s4 offen
    s_mov_b64 exec, -1
    s_lshl_b32 s4, s79, 12
    s_add_u32 s4, s4, 40960

    s_add_u32 s5, s96, 1
    s_and_b32 s5, s5, 3
    s_lshl_b32 s5, s5, 10
    s_add_u32 s5, s5, s4
    v_add_u32 v232, s5, v14

    s_add_u32 s5, s96, 2
    s_and_b32 s5, s5, 3
    s_lshl_b32 s5, s5, 10
    s_add_u32 s5, s5, s4
    v_add_u32 v233, s5, v14

    s_add_u32 s5, s96, 3
    s_and_b32 s5, s5, 3
    s_lshl_b32 s5, s5, 10
    s_add_u32 s5, s5, s4
    v_add_u32 v234, s5, v14

    s_lshl_b32 s5, s78, 9
    v_lshlrev_b32 v10, 8, v6
    v_lshl_add_u32 v10, v2, 4, v10
    v_add_u32 v10, v10, v7
    v_lshlrev_b32 v18, 6, v6
    v_xor_b32 v10, v10, v18
    v_add_u32 v10, s5, v10
    v_add_u32 v18, 16384, v10
    s_lshl_b32 s5, s26, 10
    s_add_u32 s5, s5, 40960
    v_add_u32 v10, s5, v10
    v_lshlrev_b32 v11, 8, v3
    v_lshl_add_u32 v11, v5, 4, v11
    s_lshr_b32 s4, s96, 1
    s_lshl_b32 s4, s4, 10
    s_and_b32 s5, s96, 1
    s_lshl_b32 s5, s5, 7
    s_add_u32 s4, s4, s5
    s_add_u32 s4, s4, 2048
    v_add_u32 v11, s4, v11
    v_lshlrev_b32 v12, 8, v6
    v_lshl_add_u32 v12, v2, 4, v12
    s_lshl_b32 s4, s96, 9
    s_xor_b32 s4, s4, 5120
    v_add_u32 v12, s4, v12
    v_lshlrev_b32 v13, 7, v3
    v_lshl_add_u32 v13, v5, 4, v13
    v_add_u32 v13, s77, v13
    v_lshlrev_b32 v15, 7, v6
    v_lshl_add_u32 v15, v5, 4, v15
    v_add_u32 v15, v15, v7
    s_lshl_b32 s5, s78, 8
    s_add_u32 s5, s5, s76
    v_add_u32 v15, s5, v15
    v_lshlrev_b32 v16, 8, v6
    v_lshl_add_u32 v16, v2, 4, v16
    v_add_u32 v16, v16, v7
    s_lshl_b32 s5, s24, 9
    v_add_u32 v16, s5, v16
    s_lshl_b32 s5, s24, 11
    v_add_u32 v17, s5, v14
    v_cmp_gt_u32 s[58:59], 8, v2
    v_cmp_gt_u32 s[60:61], 32, v1
    v_mov_b32 v4, 0x4444
    v_mov_b32 v9, 0xeeee
    v_cndmask_b32 v9, v9, v4, s[58:59]
    s_not_b64 s[66:67], s[58:59]
    s_cmp_lt_u32 s24, 2
    s_cselect_b64 s[64:65], s[66:67], s[58:59]
    s_mov_b32 s56, 0x0000ffff
    s_mov_b32 s57, 0x0000ffff
    s_cmp_eq_u32 s24, 1
    s_cselect_b64 vcc, -1, 0
    s_cselect_b64 s[66:67], s[56:57], s[66:67]
    s_lshl_b32 s5, s78, 10
    v_add_u32 v19, s5, v14
    v_and_b32 v19, 8, v2
    v_xor_b32 v19, v19, v16
    v_cndmask_b32 v11, v11, v12, vcc
    v_cndmask_b32 v235, v235, v236, vcc
    v_mov_b32 v4, 0xff800000
    v_cndmask_b32 v116, 0, v4, s[60:61]
    v_mov_b32 v117, v116
    v_mov_b32 v118, v116
    v_mov_b32 v119, v116
    s_mul_i32 s5, s78, 8192
    v_add_u32 v246, s5, v14
    v_lshlrev_b32 v247, 9, v6
    v_lshl_add_u32 v247, v2, 4, v247
    s_lshl_b32 s5, s78, 8
    s_add_u32 s5, s5, 12288
    v_add_u32 v247, s5, v247
    v_and_b32 v4, 31, v1
    v_lshlrev_b32 v248, 4, v4
    s_lshl_b32 s5, s78, 9
    s_add_u32 s5, s5, 12288
    v_add_u32 v248, s5, v248
    s_lshl_b32 s5, s25, 16
    v_and_b32 v7, 1, v3
    v_lshlrev_b32 v237, 18, v7
    v_lshl_add_u32 v237, v6, 8, v237
    v_lshl_add_u32 v237, v2, 4, v237
    v_add_u32 v237, s5, v237
    s_lshl_b32 s6, s78, 9
    v_add_u32 v237, s6, v237
    s_lshl_b32 s6, s78, 8
    v_lshlrev_b32 v249, 9, v7
    v_lshl_add_u32 v249, v2, 4, v249
    v_add_u32 v249, s6, v249
    v_add_u32 v4, s25, v6
    v_add_u32 v4, 1, v4
    v_and_b32 v4, 3, v4
    v_lshl_add_u32 v239, v4, 16, v249
    s_add_u32 s6, s25, 3
    s_and_b32 s6, s6, 3
    s_lshl_b32 s6, s6, 16
    v_add_u32 v249, s6, v249
    v_and_b32 v4, 1, v5
    v_lshlrev_b32 v4, 4, v4
    v_mov_b32 v6, 0x3f80
    v_lshlrev_b32 v6, v4, v6
    v_lshrrev_b32 v4, 1, v5

    v_cmp_eq_u32 vcc, 0, v4
    s_nop 1
    v_cndmask_b32 v84, 0, v6, vcc
    v_cmp_eq_u32 vcc, 1, v4
    s_nop 1
    v_cndmask_b32 v85, 0, v6, vcc
    v_cmp_eq_u32 vcc, 2, v4
    s_nop 1
    v_cndmask_b32 v86, 0, v6, vcc
    v_cmp_eq_u32 vcc, 3, v4
    s_nop 1
    v_cndmask_b32 v87, 0, v6, vcc
    v_mov_b32 v120, 0x3f803f80
    v_cndmask_b32 v112, 0, v84, s[60:61]
    v_mov_b32 v121, 0x3f803f80
    v_cndmask_b32 v113, 0, v85, s[60:61]
    v_mov_b32 v122, 0x3f803f80
    v_cndmask_b32 v114, 0, v86, s[60:61]
    v_mov_b32 v123, 0x3f803f80
    v_cndmask_b32 v115, 0, v87, s[60:61]
    v_mov_b32 v170, 0
    v_mov_b32 v171, 0
    v_mov_b32 v174, 0
    v_mov_b32 v175, 0
    v_mov_b32 v182, 0
    v_mov_b32 v183, 0
    s_add_u32 s5, s96, 0
    s_and_b32 s5, s5, 3
    s_lshl_b32 s5, s5, 10
    s_add_u32 s5, s5, 20480
    v_add_u32 v228, s5, v14

    s_add_u32 s5, s96, 1
    s_and_b32 s5, s5, 3
    s_lshl_b32 s5, s5, 10
    s_add_u32 s5, s5, 20480
    v_add_u32 v229, s5, v14

    s_add_u32 s5, s96, 2
    s_and_b32 s5, s5, 3
    s_lshl_b32 s5, s5, 10
    s_add_u32 s5, s5, 20480
    v_add_u32 v230, s5, v14

    s_add_u32 s5, s96, 3
    s_and_b32 s5, s5, 3
    s_lshl_b32 s5, s5, 10
    s_add_u32 s5, s5, 20480
    v_add_u32 v231, s5, v14

    s_lshl_b32 s89, s7, 8
    s_add_u32 s89, s89, 92282880
    v_lshlrev_b32 v253, 13, v1
    s_lshl_b32 s4, s7, 13
    s_add_u32 s38, s4, 16777216
    s_lshl_b32 s5, s96, 11
    s_add_u32 s39, s4, s5
    s_add_u32 s30, s39, 17039360
    s_xor_b32 s39, s39, 4096
    s_add_u32 s39, s39, 33554432
    s_lshl_b32 s5, s78, 24
    s_add_u32 s30, s30, s5
    s_lshl_b32 s5, s78, 12
    s_add_u32 s38, s38, s5
    s_add_u32 s90, s5, 20480
    s_lshl_b32 s5, s78, 10
    s_add_u32 s39, s39, s5
    s_add_u32 s91, s5, 28672
    s_mov_b32 s37, 0x3e0293ee
    s_mov_b32 s28, 0

    v_and_b32 v4, 31, v1
    v_lshlrev_b32 v225, 6, v4
    v_lshrrev_b32 v4, 5, v1
    v_lshl_add_u32 v225, v4, 24, v225

    v_mov_b32 v52, 0
    v_mov_b32 v53, 0
    v_mov_b32 v54, 0
    v_mov_b32 v55, 0
    v_mov_b32 v56, 0
    v_mov_b32 v57, 0
    v_mov_b32 v58, 0
    v_mov_b32 v59, 0
    v_mov_b32 v60, 0
    v_mov_b32 v61, 0
    v_mov_b32 v62, 0
    v_mov_b32 v63, 0
    v_mov_b32 v64, 0
    v_mov_b32 v65, 0
    v_mov_b32 v66, 0
    v_mov_b32 v67, 0
    v_mov_b32 v68, 0
    v_mov_b32 v69, 0
    v_mov_b32 v70, 0
    v_mov_b32 v71, 0
    v_mov_b32 v72, 0
    v_mov_b32 v73, 0
    v_mov_b32 v74, 0
    v_mov_b32 v75, 0
    v_mov_b32 v76, 0
    v_mov_b32 v77, 0
    v_mov_b32 v78, 0
    v_mov_b32 v79, 0
    v_mov_b32 v80, 0
    v_mov_b32 v81, 0
    v_mov_b32 v82, 0
    v_mov_b32 v83, 0
    v_mov_b32 v92, -1
    v_mov_b32 v93, -1
    v_mov_b32 v94, -1
    v_mov_b32 v95, -1
    v_mov_b32 v96, -1
    v_mov_b32 v97, -1
    v_mov_b32 v98, -1
    v_mov_b32 v99, -1
    v_mov_b32 v100, -1
    v_mov_b32 v101, -1
    v_mov_b32 v102, -1
    v_mov_b32 v103, -1
    v_mov_b32 v192, -1
    v_mov_b32 v193, -1
    v_mov_b32 v194, -1
    v_mov_b32 v195, -1
    v_mov_b32 v196, -1
    v_mov_b32 v197, -1
    v_mov_b32 v198, -1
    v_mov_b32 v199, -1
    v_mov_b32 v200, -1
    v_mov_b32 v201, -1
    v_mov_b32 v202, -1
    v_mov_b32 v203, -1
    v_mov_b32 v204, -1
    v_mov_b32 v205, -1
    v_mov_b32 v206, -1
    v_mov_b32 v207, -1
    v_mov_b32 v208, -1
    v_mov_b32 v209, -1
    v_mov_b32 v210, -1
    v_mov_b32 v211, -1
    v_mov_b32 v212, -1
    v_mov_b32 v213, -1
    v_mov_b32 v214, -1
    v_mov_b32 v215, -1
    v_mov_b32 v216, -1
    v_mov_b32 v217, -1
    v_mov_b32 v218, -1
    v_mov_b32 v219, -1
    v_mov_b32 v220, -1
    v_mov_b32 v221, -1
    v_mov_b32 v222, -1
    v_mov_b32 v223, -1
    s_bitcmp1_b32 s26, 0
    s_cbranch_scc1 .po_13
    s_waitcnt vmcnt(29)
    ds_read_b64_tr_b16 a[0:1], v252 offset:0
    ds_read_b64_tr_b16 a[2:3], v252 offset:128
    ds_read_b64_tr_b16 a[4:5], v252 offset:2048
    ds_read_b64_tr_b16 a[6:7], v252 offset:2176
    ds_read_b64_tr_b16 a[8:9], v252 offset:4096
    ds_read_b64_tr_b16 a[10:11], v252 offset:4224
    ds_read_b64_tr_b16 a[12:13], v252 offset:6144
    ds_read_b64_tr_b16 a[14:15], v252 offset:6272
    ds_read_b64_tr_b16 a[32:33], v252 offset:16
    ds_read_b64_tr_b16 a[34:35], v252 offset:144
    ds_read_b64_tr_b16 a[36:37], v252 offset:2064
    ds_read_b64_tr_b16 a[38:39], v252 offset:2192
    ds_read_b64_tr_b16 a[40:41], v252 offset:4112
    ds_read_b64_tr_b16 a[42:43], v252 offset:4240
    ds_read_b64_tr_b16 a[44:45], v252 offset:6160
    ds_read_b64_tr_b16 a[46:47], v252 offset:6288
    s_waitcnt lgkmcnt(0)
    s_mov_b32 s16, s48
    s_and_b32 s17, s49, 0xffff
    s_mov_b32 s18, 0x800000
    s_mov_b32 s19, 0x00020000

    s_add_u32 m0, s98, 0
    s_mov_b32 s5, 0
    buffer_load_dwordx4 v224, s[16:19], s5 offen  lds

    s_add_u32 m0, s98, 1024
    s_mov_b32 s5, 131072
    buffer_load_dwordx4 v224, s[16:19], s5 offen  lds

    s_add_u32 m0, s98, 2048
    s_mov_b32 s5, 262144
    buffer_load_dwordx4 v224, s[16:19], s5 offen  lds

    s_add_u32 m0, s98, 3072
    s_mov_b32 s5, 393216
    buffer_load_dwordx4 v224, s[16:19], s5 offen  lds

    s_add_u32 m0, s98, 4096
    s_mov_b32 s5, 524288
    buffer_load_dwordx4 v224, s[16:19], s5 offen  lds

    s_add_u32 m0, s98, 5120
    s_mov_b32 s5, 655360
    buffer_load_dwordx4 v224, s[16:19], s5 offen  lds

    s_add_u32 m0, s98, 6144
    s_mov_b32 s5, 786432
    buffer_load_dwordx4 v224, s[16:19], s5 offen  lds

    s_add_u32 m0, s98, 7168
    s_mov_b32 s5, 917504
    buffer_load_dwordx4 v224, s[16:19], s5 offen  lds

    s_waitcnt vmcnt(29)
    ds_read_b64_tr_b16 a[16:17], v252 offset:8192
    ds_read_b64_tr_b16 a[18:19], v252 offset:8320
    ds_read_b64_tr_b16 a[20:21], v252 offset:10240
    ds_read_b64_tr_b16 a[22:23], v252 offset:10368
    ds_read_b64_tr_b16 a[24:25], v252 offset:12288
    ds_read_b64_tr_b16 a[26:27], v252 offset:12416
    ds_read_b64_tr_b16 a[28:29], v252 offset:14336
    ds_read_b64_tr_b16 a[30:31], v252 offset:14464
    ds_read_b64_tr_b16 a[48:49], v252 offset:8208
    ds_read_b64_tr_b16 a[50:51], v252 offset:8336
    ds_read_b64_tr_b16 a[52:53], v252 offset:10256
    ds_read_b64_tr_b16 a[54:55], v252 offset:10384
    ds_read_b64_tr_b16 a[56:57], v252 offset:12304
    ds_read_b64_tr_b16 a[58:59], v252 offset:12432
    ds_read_b64_tr_b16 a[60:61], v252 offset:14352
    ds_read_b64_tr_b16 a[62:63], v252 offset:14480
    s_waitcnt lgkmcnt(0)
    s_add_u32 m0, s98, 8192
    s_mov_b32 s5, 1048576
    buffer_load_dwordx4 v224, s[16:19], s5 offen  lds

    s_add_u32 m0, s98, 9216
    s_mov_b32 s5, 1179648
    buffer_load_dwordx4 v224, s[16:19], s5 offen  lds

    s_add_u32 m0, s98, 10240
    s_mov_b32 s5, 1310720
    buffer_load_dwordx4 v224, s[16:19], s5 offen  lds

    s_add_u32 m0, s98, 11264
    s_mov_b32 s5, 1441792
    buffer_load_dwordx4 v224, s[16:19], s5 offen  lds

    s_add_u32 m0, s98, 12288
    s_mov_b32 s5, 1572864
    buffer_load_dwordx4 v224, s[16:19], s5 offen  lds

    s_add_u32 m0, s98, 13312
    s_mov_b32 s5, 1703936
    buffer_load_dwordx4 v224, s[16:19], s5 offen  lds

    s_add_u32 m0, s98, 14336
    s_mov_b32 s5, 1835008
    buffer_load_dwordx4 v224, s[16:19], s5 offen  lds

    s_add_u32 m0, s98, 15360
    s_mov_b32 s5, 1966080
    buffer_load_dwordx4 v224, s[16:19], s5 offen  lds

    s_waitcnt vmcnt(29)
    ds_read_b64_tr_b16 a[64:65], v252 offset:16384
    ds_read_b64_tr_b16 a[66:67], v252 offset:16512
    ds_read_b64_tr_b16 a[68:69], v252 offset:18432
    ds_read_b64_tr_b16 a[70:71], v252 offset:18560
    ds_read_b64_tr_b16 a[72:73], v252 offset:20480
    ds_read_b64_tr_b16 a[74:75], v252 offset:20608
    ds_read_b64_tr_b16 a[76:77], v252 offset:22528
    ds_read_b64_tr_b16 a[78:79], v252 offset:22656
    ds_read_b64_tr_b16 a[96:97], v252 offset:16400
    ds_read_b64_tr_b16 a[98:99], v252 offset:16528
    ds_read_b64_tr_b16 a[100:101], v252 offset:18448
    ds_read_b64_tr_b16 a[102:103], v252 offset:18576
    ds_read_b64_tr_b16 a[104:105], v252 offset:20496
    ds_read_b64_tr_b16 a[106:107], v252 offset:20624
    ds_read_b64_tr_b16 a[108:109], v252 offset:22544
    ds_read_b64_tr_b16 a[110:111], v252 offset:22672
    s_waitcnt lgkmcnt(0)
    s_mov_b32 s16, s50
    s_and_b32 s17, s51, 0xffff
    s_mov_b32 s18, 0x800000
    s_mov_b32 s19, 0x00020000

    s_add_u32 m0, s98, 16384
    s_add_u32 s5, s80, 0
    buffer_load_dwordx4 v241, s[16:19], s5 offen  lds

    s_add_u32 m0, s98, 17408
    s_add_u32 s5, s80, 32768
    buffer_load_dwordx4 v241, s[16:19], s5 offen  lds

    s_add_u32 m0, s98, 18432
    s_add_u32 s5, s80, 65536
    buffer_load_dwordx4 v241, s[16:19], s5 offen  lds

    s_add_u32 m0, s98, 19456
    s_add_u32 s5, s80, 98304
    buffer_load_dwordx4 v241, s[16:19], s5 offen  lds

    s_add_u32 m0, s98, 20480
    s_add_u32 s5, s80, 131072
    buffer_load_dwordx4 v241, s[16:19], s5 offen  lds

    s_add_u32 m0, s98, 21504
    s_add_u32 s5, s80, 163840
    buffer_load_dwordx4 v241, s[16:19], s5 offen  lds

    s_add_u32 m0, s98, 22528
    s_add_u32 s5, s80, 196608
    buffer_load_dwordx4 v241, s[16:19], s5 offen  lds

    s_add_u32 m0, s98, 23552
    s_add_u32 s5, s80, 229376
    buffer_load_dwordx4 v241, s[16:19], s5 offen  lds

    s_waitcnt vmcnt(29)
    ds_read_b64_tr_b16 a[80:81], v252 offset:24576
    ds_read_b64_tr_b16 a[82:83], v252 offset:24704
    ds_read_b64_tr_b16 a[84:85], v252 offset:26624
    ds_read_b64_tr_b16 a[86:87], v252 offset:26752
    ds_read_b64_tr_b16 a[88:89], v252 offset:28672
    ds_read_b64_tr_b16 a[90:91], v252 offset:28800
    ds_read_b64_tr_b16 a[92:93], v252 offset:30720
    ds_read_b64_tr_b16 a[94:95], v252 offset:30848
    ds_read_b64_tr_b16 a[112:113], v252 offset:24592
    ds_read_b64_tr_b16 a[114:115], v252 offset:24720
    ds_read_b64_tr_b16 a[116:117], v252 offset:26640
    ds_read_b64_tr_b16 a[118:119], v252 offset:26768
    ds_read_b64_tr_b16 a[120:121], v252 offset:28688
    ds_read_b64_tr_b16 a[122:123], v252 offset:28816
    ds_read_b64_tr_b16 a[124:125], v252 offset:30736
    ds_read_b64_tr_b16 a[126:127], v252 offset:30864
    s_waitcnt lgkmcnt(0)
    s_add_u32 m0, s98, 24576
    s_add_u32 s5, s81, 0
    buffer_load_dwordx4 v241, s[16:19], s5 offen  lds

    s_add_u32 m0, s98, 25600
    s_add_u32 s5, s81, 32768
    buffer_load_dwordx4 v241, s[16:19], s5 offen  lds

    s_add_u32 m0, s98, 26624
    s_add_u32 s5, s81, 65536
    buffer_load_dwordx4 v241, s[16:19], s5 offen  lds

    s_add_u32 m0, s98, 27648
    s_add_u32 s5, s81, 98304
    buffer_load_dwordx4 v241, s[16:19], s5 offen  lds

    s_add_u32 m0, s98, 28672
    s_add_u32 s5, s81, 131072
    buffer_load_dwordx4 v241, s[16:19], s5 offen  lds

    s_add_u32 m0, s98, 29696
    s_add_u32 s5, s81, 163840
    buffer_load_dwordx4 v241, s[16:19], s5 offen  lds

    s_add_u32 m0, s98, 30720
    s_add_u32 s5, s81, 196608
    buffer_load_dwordx4 v241, s[16:19], s5 offen  lds

    s_add_u32 m0, s98, 31744
    s_add_u32 s5, s81, 229376
    buffer_load_dwordx4 v241, s[16:19], s5 offen  lds

    v_and_b32 v241, 3, v0
    v_lshlrev_b32 v241, 2, v241

    v_and_b32 v240, 12, v0
    v_lshl_add_u32 v241, v240, 4, v241
    v_add_u32 v241, s97, v241
    v_and_b32 v241, 255, v241

    buffer_load_dword v240, v241, s[20:23], 0 offen sc1
    s_waitcnt vmcnt(25)
    ds_read_b64_tr_b16 a[128:129], v254 offset:0
    ds_read_b64_tr_b16 a[130:131], v254 offset:128
    ds_read_b64_tr_b16 a[132:133], v254 offset:2048
    ds_read_b64_tr_b16 a[134:135], v254 offset:2176
    ds_read_b64_tr_b16 a[136:137], v254 offset:4096
    ds_read_b64_tr_b16 a[138:139], v254 offset:4224
    ds_read_b64_tr_b16 a[140:141], v254 offset:6144
    ds_read_b64_tr_b16 a[142:143], v254 offset:6272
    ds_read_b64_tr_b16 a[160:161], v254 offset:32
    ds_read_b64_tr_b16 a[162:163], v254 offset:160
    ds_read_b64_tr_b16 a[164:165], v254 offset:2080
    ds_read_b64_tr_b16 a[166:167], v254 offset:2208
    ds_read_b64_tr_b16 a[168:169], v254 offset:4128
    ds_read_b64_tr_b16 a[170:171], v254 offset:4256
    ds_read_b64_tr_b16 a[172:173], v254 offset:6176
    ds_read_b64_tr_b16 a[174:175], v254 offset:6304
    s_waitcnt vmcnt(17)
    ds_read_b64_tr_b16 a[144:145], v254 offset:8192
    ds_read_b64_tr_b16 a[146:147], v254 offset:8320
    ds_read_b64_tr_b16 a[148:149], v254 offset:10240
    ds_read_b64_tr_b16 a[150:151], v254 offset:10368
    ds_read_b64_tr_b16 a[152:153], v254 offset:12288
    ds_read_b64_tr_b16 a[154:155], v254 offset:12416
    ds_read_b64_tr_b16 a[156:157], v254 offset:14336
    ds_read_b64_tr_b16 a[158:159], v254 offset:14464
    ds_read_b64_tr_b16 a[176:177], v254 offset:8224
    ds_read_b64_tr_b16 a[178:179], v254 offset:8352
    ds_read_b64_tr_b16 a[180:181], v254 offset:10272
    ds_read_b64_tr_b16 a[182:183], v254 offset:10400
    ds_read_b64_tr_b16 a[184:185], v254 offset:12320
    ds_read_b64_tr_b16 a[186:187], v254 offset:12448
    ds_read_b64_tr_b16 a[188:189], v254 offset:14368
    ds_read_b64_tr_b16 a[190:191], v254 offset:14496
    s_waitcnt vmcnt(9)
    s_mov_b64 exec, 0xffff
    s_mov_b32 exec_hi, 0
    buffer_load_dword v227, v226, s[8:11], 0 offen
    s_mov_b64 exec, -1
    ds_read_b64_tr_b16 a[192:193], v255 offset:16384
    ds_read_b64_tr_b16 a[194:195], v255 offset:16512
    ds_read_b64_tr_b16 a[196:197], v255 offset:18432
    ds_read_b64_tr_b16 a[198:199], v255 offset:18560
    ds_read_b64_tr_b16 a[200:201], v255 offset:20480
    ds_read_b64_tr_b16 a[202:203], v255 offset:20608
    ds_read_b64_tr_b16 a[204:205], v255 offset:22528
    ds_read_b64_tr_b16 a[206:207], v255 offset:22656
    ds_read_b64_tr_b16 a[224:225], v255 offset:16416
    ds_read_b64_tr_b16 a[226:227], v255 offset:16544
    ds_read_b64_tr_b16 a[228:229], v255 offset:18464
    ds_read_b64_tr_b16 a[230:231], v255 offset:18592
    ds_read_b64_tr_b16 a[232:233], v255 offset:20512
    ds_read_b64_tr_b16 a[234:235], v255 offset:20640
    ds_read_b64_tr_b16 a[236:237], v255 offset:22560
    ds_read_b64_tr_b16 a[238:239], v255 offset:22688
    s_waitcnt vmcnt(2)
    ds_read_b64_tr_b16 a[208:209], v255 offset:24576
    ds_read_b64_tr_b16 a[210:211], v255 offset:24704
    ds_read_b64_tr_b16 a[212:213], v255 offset:26624
    ds_read_b64_tr_b16 a[214:215], v255 offset:26752
    ds_read_b64_tr_b16 a[216:217], v255 offset:28672
    ds_read_b64_tr_b16 a[218:219], v255 offset:28800
    ds_read_b64_tr_b16 a[220:221], v255 offset:30720
    ds_read_b64_tr_b16 a[222:223], v255 offset:30848
    ds_read_b64_tr_b16 a[240:241], v255 offset:24608
    ds_read_b64_tr_b16 a[242:243], v255 offset:24736
    ds_read_b64_tr_b16 a[244:245], v255 offset:26656
    ds_read_b64_tr_b16 a[246:247], v255 offset:26784
    ds_read_b64_tr_b16 a[248:249], v255 offset:28704
    ds_read_b64_tr_b16 a[250:251], v255 offset:28832
    ds_read_b64_tr_b16 a[252:253], v255 offset:30752
    ds_read_b64_tr_b16 a[254:255], v255 offset:30880
    s_branch .pj_14
.po_13:
    s_waitcnt vmcnt(29)
    ds_read_b64_tr_b16 a[16:17], v252 offset:8192
    ds_read_b64_tr_b16 a[18:19], v252 offset:8320
    ds_read_b64_tr_b16 a[20:21], v252 offset:10240
    ds_read_b64_tr_b16 a[22:23], v252 offset:10368
    ds_read_b64_tr_b16 a[24:25], v252 offset:12288
    ds_read_b64_tr_b16 a[26:27], v252 offset:12416
    ds_read_b64_tr_b16 a[28:29], v252 offset:14336
    ds_read_b64_tr_b16 a[30:31], v252 offset:14464
    ds_read_b64_tr_b16 a[48:49], v252 offset:8208
    ds_read_b64_tr_b16 a[50:51], v252 offset:8336
    ds_read_b64_tr_b16 a[52:53], v252 offset:10256
    ds_read_b64_tr_b16 a[54:55], v252 offset:10384
    ds_read_b64_tr_b16 a[56:57], v252 offset:12304
    ds_read_b64_tr_b16 a[58:59], v252 offset:12432
    ds_read_b64_tr_b16 a[60:61], v252 offset:14352
    ds_read_b64_tr_b16 a[62:63], v252 offset:14480
    s_waitcnt lgkmcnt(0)
    s_mov_b32 s16, s48
    s_and_b32 s17, s49, 0xffff
    s_mov_b32 s18, 0x800000
    s_mov_b32 s19, 0x00020000

    s_add_u32 m0, s98, 8192
    s_mov_b32 s5, 1048576
    buffer_load_dwordx4 v224, s[16:19], s5 offen  lds

    s_add_u32 m0, s98, 9216
    s_mov_b32 s5, 1179648
    buffer_load_dwordx4 v224, s[16:19], s5 offen  lds

    s_add_u32 m0, s98, 10240
    s_mov_b32 s5, 1310720
    buffer_load_dwordx4 v224, s[16:19], s5 offen  lds

    s_add_u32 m0, s98, 11264
    s_mov_b32 s5, 1441792
    buffer_load_dwordx4 v224, s[16:19], s5 offen  lds

    s_add_u32 m0, s98, 12288
    s_mov_b32 s5, 1572864
    buffer_load_dwordx4 v224, s[16:19], s5 offen  lds

    s_add_u32 m0, s98, 13312
    s_mov_b32 s5, 1703936
    buffer_load_dwordx4 v224, s[16:19], s5 offen  lds

    s_add_u32 m0, s98, 14336
    s_mov_b32 s5, 1835008
    buffer_load_dwordx4 v224, s[16:19], s5 offen  lds

    s_add_u32 m0, s98, 15360
    s_mov_b32 s5, 1966080
    buffer_load_dwordx4 v224, s[16:19], s5 offen  lds

    s_waitcnt vmcnt(29)
    ds_read_b64_tr_b16 a[0:1], v252 offset:0
    ds_read_b64_tr_b16 a[2:3], v252 offset:128
    ds_read_b64_tr_b16 a[4:5], v252 offset:2048
    ds_read_b64_tr_b16 a[6:7], v252 offset:2176
    ds_read_b64_tr_b16 a[8:9], v252 offset:4096
    ds_read_b64_tr_b16 a[10:11], v252 offset:4224
    ds_read_b64_tr_b16 a[12:13], v252 offset:6144
    ds_read_b64_tr_b16 a[14:15], v252 offset:6272
    ds_read_b64_tr_b16 a[32:33], v252 offset:16
    ds_read_b64_tr_b16 a[34:35], v252 offset:144
    ds_read_b64_tr_b16 a[36:37], v252 offset:2064
    ds_read_b64_tr_b16 a[38:39], v252 offset:2192
    ds_read_b64_tr_b16 a[40:41], v252 offset:4112
    ds_read_b64_tr_b16 a[42:43], v252 offset:4240
    ds_read_b64_tr_b16 a[44:45], v252 offset:6160
    ds_read_b64_tr_b16 a[46:47], v252 offset:6288
    s_waitcnt lgkmcnt(0)
    s_add_u32 m0, s98, 0
    s_mov_b32 s5, 0
    buffer_load_dwordx4 v224, s[16:19], s5 offen  lds

    s_add_u32 m0, s98, 1024
    s_mov_b32 s5, 131072
    buffer_load_dwordx4 v224, s[16:19], s5 offen  lds

    s_add_u32 m0, s98, 2048
    s_mov_b32 s5, 262144
    buffer_load_dwordx4 v224, s[16:19], s5 offen  lds

    s_add_u32 m0, s98, 3072
    s_mov_b32 s5, 393216
    buffer_load_dwordx4 v224, s[16:19], s5 offen  lds

    s_add_u32 m0, s98, 4096
    s_mov_b32 s5, 524288
    buffer_load_dwordx4 v224, s[16:19], s5 offen  lds

    s_add_u32 m0, s98, 5120
    s_mov_b32 s5, 655360
    buffer_load_dwordx4 v224, s[16:19], s5 offen  lds

    s_add_u32 m0, s98, 6144
    s_mov_b32 s5, 786432
    buffer_load_dwordx4 v224, s[16:19], s5 offen  lds

    s_add_u32 m0, s98, 7168
    s_mov_b32 s5, 917504
    buffer_load_dwordx4 v224, s[16:19], s5 offen  lds

    s_waitcnt vmcnt(29)
    ds_read_b64_tr_b16 a[80:81], v252 offset:24576
    ds_read_b64_tr_b16 a[82:83], v252 offset:24704
    ds_read_b64_tr_b16 a[84:85], v252 offset:26624
    ds_read_b64_tr_b16 a[86:87], v252 offset:26752
    ds_read_b64_tr_b16 a[88:89], v252 offset:28672
    ds_read_b64_tr_b16 a[90:91], v252 offset:28800
    ds_read_b64_tr_b16 a[92:93], v252 offset:30720
    ds_read_b64_tr_b16 a[94:95], v252 offset:30848
    ds_read_b64_tr_b16 a[112:113], v252 offset:24592
    ds_read_b64_tr_b16 a[114:115], v252 offset:24720
    ds_read_b64_tr_b16 a[116:117], v252 offset:26640
    ds_read_b64_tr_b16 a[118:119], v252 offset:26768
    ds_read_b64_tr_b16 a[120:121], v252 offset:28688
    ds_read_b64_tr_b16 a[122:123], v252 offset:28816
    ds_read_b64_tr_b16 a[124:125], v252 offset:30736
    ds_read_b64_tr_b16 a[126:127], v252 offset:30864
    s_waitcnt lgkmcnt(0)
    s_mov_b32 s16, s50
    s_and_b32 s17, s51, 0xffff
    s_mov_b32 s18, 0x800000
    s_mov_b32 s19, 0x00020000

    s_add_u32 m0, s98, 24576
    s_add_u32 s5, s81, 0
    buffer_load_dwordx4 v241, s[16:19], s5 offen  lds

    s_add_u32 m0, s98, 25600
    s_add_u32 s5, s81, 32768
    buffer_load_dwordx4 v241, s[16:19], s5 offen  lds

    s_add_u32 m0, s98, 26624
    s_add_u32 s5, s81, 65536
    buffer_load_dwordx4 v241, s[16:19], s5 offen  lds

    s_add_u32 m0, s98, 27648
    s_add_u32 s5, s81, 98304
    buffer_load_dwordx4 v241, s[16:19], s5 offen  lds

    s_add_u32 m0, s98, 28672
    s_add_u32 s5, s81, 131072
    buffer_load_dwordx4 v241, s[16:19], s5 offen  lds

    s_add_u32 m0, s98, 29696
    s_add_u32 s5, s81, 163840
    buffer_load_dwordx4 v241, s[16:19], s5 offen  lds

    s_add_u32 m0, s98, 30720
    s_add_u32 s5, s81, 196608
    buffer_load_dwordx4 v241, s[16:19], s5 offen  lds

    s_add_u32 m0, s98, 31744
    s_add_u32 s5, s81, 229376
    buffer_load_dwordx4 v241, s[16:19], s5 offen  lds

    s_waitcnt vmcnt(29)
    ds_read_b64_tr_b16 a[64:65], v252 offset:16384
    ds_read_b64_tr_b16 a[66:67], v252 offset:16512
    ds_read_b64_tr_b16 a[68:69], v252 offset:18432
    ds_read_b64_tr_b16 a[70:71], v252 offset:18560
    ds_read_b64_tr_b16 a[72:73], v252 offset:20480
    ds_read_b64_tr_b16 a[74:75], v252 offset:20608
    ds_read_b64_tr_b16 a[76:77], v252 offset:22528
    ds_read_b64_tr_b16 a[78:79], v252 offset:22656
    ds_read_b64_tr_b16 a[96:97], v252 offset:16400
    ds_read_b64_tr_b16 a[98:99], v252 offset:16528
    ds_read_b64_tr_b16 a[100:101], v252 offset:18448
    ds_read_b64_tr_b16 a[102:103], v252 offset:18576
    ds_read_b64_tr_b16 a[104:105], v252 offset:20496
    ds_read_b64_tr_b16 a[106:107], v252 offset:20624
    ds_read_b64_tr_b16 a[108:109], v252 offset:22544
    ds_read_b64_tr_b16 a[110:111], v252 offset:22672
    s_waitcnt lgkmcnt(0)
    s_add_u32 m0, s98, 16384
    s_add_u32 s5, s80, 0
    buffer_load_dwordx4 v241, s[16:19], s5 offen  lds

    s_add_u32 m0, s98, 17408
    s_add_u32 s5, s80, 32768
    buffer_load_dwordx4 v241, s[16:19], s5 offen  lds

    s_add_u32 m0, s98, 18432
    s_add_u32 s5, s80, 65536
    buffer_load_dwordx4 v241, s[16:19], s5 offen  lds

    s_add_u32 m0, s98, 19456
    s_add_u32 s5, s80, 98304
    buffer_load_dwordx4 v241, s[16:19], s5 offen  lds

    s_add_u32 m0, s98, 20480
    s_add_u32 s5, s80, 131072
    buffer_load_dwordx4 v241, s[16:19], s5 offen  lds

    s_add_u32 m0, s98, 21504
    s_add_u32 s5, s80, 163840
    buffer_load_dwordx4 v241, s[16:19], s5 offen  lds

    s_add_u32 m0, s98, 22528
    s_add_u32 s5, s80, 196608
    buffer_load_dwordx4 v241, s[16:19], s5 offen  lds

    s_add_u32 m0, s98, 23552
    s_add_u32 s5, s80, 229376
    buffer_load_dwordx4 v241, s[16:19], s5 offen  lds

    v_and_b32 v241, 3, v0
    v_lshlrev_b32 v241, 2, v241

    v_and_b32 v240, 12, v0
    v_lshl_add_u32 v241, v240, 4, v241
    v_add_u32 v241, s97, v241
    v_and_b32 v241, 255, v241

    buffer_load_dword v240, v241, s[20:23], 0 offen sc1
    s_waitcnt vmcnt(25)
    ds_read_b64_tr_b16 a[144:145], v254 offset:8192
    ds_read_b64_tr_b16 a[146:147], v254 offset:8320
    ds_read_b64_tr_b16 a[148:149], v254 offset:10240
    ds_read_b64_tr_b16 a[150:151], v254 offset:10368
    ds_read_b64_tr_b16 a[152:153], v254 offset:12288
    ds_read_b64_tr_b16 a[154:155], v254 offset:12416
    ds_read_b64_tr_b16 a[156:157], v254 offset:14336
    ds_read_b64_tr_b16 a[158:159], v254 offset:14464
    ds_read_b64_tr_b16 a[176:177], v254 offset:8224
    ds_read_b64_tr_b16 a[178:179], v254 offset:8352
    ds_read_b64_tr_b16 a[180:181], v254 offset:10272
    ds_read_b64_tr_b16 a[182:183], v254 offset:10400
    ds_read_b64_tr_b16 a[184:185], v254 offset:12320
    ds_read_b64_tr_b16 a[186:187], v254 offset:12448
    ds_read_b64_tr_b16 a[188:189], v254 offset:14368
    ds_read_b64_tr_b16 a[190:191], v254 offset:14496
    s_waitcnt vmcnt(17)
    ds_read_b64_tr_b16 a[128:129], v254 offset:0
    ds_read_b64_tr_b16 a[130:131], v254 offset:128
    ds_read_b64_tr_b16 a[132:133], v254 offset:2048
    ds_read_b64_tr_b16 a[134:135], v254 offset:2176
    ds_read_b64_tr_b16 a[136:137], v254 offset:4096
    ds_read_b64_tr_b16 a[138:139], v254 offset:4224
    ds_read_b64_tr_b16 a[140:141], v254 offset:6144
    ds_read_b64_tr_b16 a[142:143], v254 offset:6272
    ds_read_b64_tr_b16 a[160:161], v254 offset:32
    ds_read_b64_tr_b16 a[162:163], v254 offset:160
    ds_read_b64_tr_b16 a[164:165], v254 offset:2080
    ds_read_b64_tr_b16 a[166:167], v254 offset:2208
    ds_read_b64_tr_b16 a[168:169], v254 offset:4128
    ds_read_b64_tr_b16 a[170:171], v254 offset:4256
    ds_read_b64_tr_b16 a[172:173], v254 offset:6176
    ds_read_b64_tr_b16 a[174:175], v254 offset:6304
    s_waitcnt vmcnt(9)
    s_mov_b64 exec, 0xffff
    s_mov_b32 exec_hi, 0
    buffer_load_dword v227, v226, s[8:11], 0 offen
    s_mov_b64 exec, -1
    ds_read_b64_tr_b16 a[208:209], v255 offset:24576
    ds_read_b64_tr_b16 a[210:211], v255 offset:24704
    ds_read_b64_tr_b16 a[212:213], v255 offset:26624
    ds_read_b64_tr_b16 a[214:215], v255 offset:26752
    ds_read_b64_tr_b16 a[216:217], v255 offset:28672
    ds_read_b64_tr_b16 a[218:219], v255 offset:28800
    ds_read_b64_tr_b16 a[220:221], v255 offset:30720
    ds_read_b64_tr_b16 a[222:223], v255 offset:30848
    ds_read_b64_tr_b16 a[240:241], v255 offset:24608
    ds_read_b64_tr_b16 a[242:243], v255 offset:24736
    ds_read_b64_tr_b16 a[244:245], v255 offset:26656
    ds_read_b64_tr_b16 a[246:247], v255 offset:26784
    ds_read_b64_tr_b16 a[248:249], v255 offset:28704
    ds_read_b64_tr_b16 a[250:251], v255 offset:28832
    ds_read_b64_tr_b16 a[252:253], v255 offset:30752
    ds_read_b64_tr_b16 a[254:255], v255 offset:30880
    s_waitcnt vmcnt(2)
    ds_read_b64_tr_b16 a[192:193], v255 offset:16384
    ds_read_b64_tr_b16 a[194:195], v255 offset:16512
    ds_read_b64_tr_b16 a[196:197], v255 offset:18432
    ds_read_b64_tr_b16 a[198:199], v255 offset:18560
    ds_read_b64_tr_b16 a[200:201], v255 offset:20480
    ds_read_b64_tr_b16 a[202:203], v255 offset:20608
    ds_read_b64_tr_b16 a[204:205], v255 offset:22528
    ds_read_b64_tr_b16 a[206:207], v255 offset:22656
    ds_read_b64_tr_b16 a[224:225], v255 offset:16416
    ds_read_b64_tr_b16 a[226:227], v255 offset:16544
    ds_read_b64_tr_b16 a[228:229], v255 offset:18464
    ds_read_b64_tr_b16 a[230:231], v255 offset:18592
    ds_read_b64_tr_b16 a[232:233], v255 offset:20512
    ds_read_b64_tr_b16 a[234:235], v255 offset:20640
    ds_read_b64_tr_b16 a[236:237], v255 offset:22560
    ds_read_b64_tr_b16 a[238:239], v255 offset:22688
.pj_14:
    v_min_u32 v20, 0xfffffffe, v20
    v_min_u32 v21, 0xfffffffe, v21
    v_min_u32 v22, 0xfffffffe, v22
    v_min_u32 v23, 0xfffffffe, v23
    v_min_u32 v24, 0xfffffffe, v24
    v_min_u32 v25, 0xfffffffe, v25
    v_min_u32 v26, 0xfffffffe, v26
    v_min_u32 v27, 0xfffffffe, v27
    v_min_u32 v28, 0xfffffffe, v28
    v_min_u32 v29, 0xfffffffe, v29
    v_min_u32 v30, 0xfffffffe, v30
    v_min_u32 v31, 0xfffffffe, v31
    v_min_u32 v32, 0xfffffffe, v32
    v_min_u32 v33, 0xfffffffe, v33
    v_min_u32 v34, 0xfffffffe, v34
    v_min_u32 v35, 0xfffffffe, v35
    s_barrier
    s_cmp_ge_u32 s24, 2
    s_cbranch_scc1 .px_15
    v_xor_b32 v255, 0x10000, v255
    ds_read_b64_tr_b16 v[124:125], v255 offset:16384
    ds_read_b64_tr_b16 v[126:127], v255 offset:16512
    ds_read_b64_tr_b16 v[128:129], v255 offset:18432
    ds_read_b64_tr_b16 v[130:131], v255 offset:18560
    ds_read_b64_tr_b16 v[132:133], v255 offset:20480
    ds_read_b64_tr_b16 v[134:135], v255 offset:20608
    ds_read_b64_tr_b16 v[136:137], v255 offset:22528
    ds_read_b64_tr_b16 v[138:139], v255 offset:22656
    ds_read_b64_tr_b16 v[156:157], v255 offset:16416
    ds_read_b64_tr_b16 v[158:159], v255 offset:16544
    ds_read_b64_tr_b16 v[160:161], v255 offset:18464
    ds_read_b64_tr_b16 v[162:163], v255 offset:18592
    ds_read_b64_tr_b16 v[164:165], v255 offset:20512
    ds_read_b64_tr_b16 v[166:167], v255 offset:20640
    ds_read_b64_tr_b16 v[168:169], v255 offset:22560
    ds_read_b64_tr_b16 v[170:171], v255 offset:22688
    ds_read_b64_tr_b16 v[140:141], v255 offset:24576
    ds_read_b64_tr_b16 v[142:143], v255 offset:24704
    ds_read_b64_tr_b16 v[144:145], v255 offset:26624
    ds_read_b64_tr_b16 v[146:147], v255 offset:26752
    ds_read_b64_tr_b16 v[148:149], v255 offset:28672
    ds_read_b64_tr_b16 v[150:151], v255 offset:28800
    ds_read_b64_tr_b16 v[152:153], v255 offset:30720
    ds_read_b64_tr_b16 v[154:155], v255 offset:30848
    ds_read_b64_tr_b16 v[172:173], v255 offset:24608
    ds_read_b64_tr_b16 v[174:175], v255 offset:24736
    ds_read_b64_tr_b16 v[176:177], v255 offset:26656
    ds_read_b64_tr_b16 v[178:179], v255 offset:26784
    ds_read_b64_tr_b16 v[180:181], v255 offset:28704
    ds_read_b64_tr_b16 v[182:183], v255 offset:28832
    ds_read_b64_tr_b16 v[184:185], v255 offset:30752
    ds_read_b64_tr_b16 v[186:187], v255 offset:30880
.px_15:
    s_waitcnt vmcnt(0)
    s_mov_b32 s62, 0
.vp_18:
    v_readlane_b32 s4, v240, 0
    v_readlane_b32 s7, v240, 1
    v_readlane_b32 s6, v240, 2

    v_readlane_b32 s5, v240, 4
    s_add_u32 s4, s4, s5
    v_readlane_b32 s5, v240, 8
    s_add_u32 s4, s4, s5
    v_readlane_b32 s5, v240, 12
    s_add_u32 s4, s4, s5
    s_lshr_b32 s5, s7, 21
    s_min_u32 s4, s4, s5
    s_cmp_ge_u32 s4, 256
    s_cbranch_scc1 .vd_19
    s_cmp_lg_u32 s6, 0
    s_cbranch_scc1 .vs_20
    s_add_u32 s62, s62, 1
    s_cmp_gt_u32 s62, 0x100000
    s_cbranch_scc1 .mg_end_1
    s_sleep 8
    buffer_load_dword v240, v241, s[20:23], 0 offen sc1
    s_waitcnt vmcnt(0)
    s_branch .vp_18

.vs_20:
    s_lshr_b32 s25, s2, 5
    s_and_b32 s26, s2, 31
    s_mov_b32 s27, 1
    s_mov_b32 s99, 1
    s_mov_b32 s97, 144
    s_waitcnt vmcnt(0) lgkmcnt(0)
    s_barrier
    s_branch .mg_role_3

.vd_19:
    s_waitcnt lgkmcnt(0)
    s_barrier
    s_add_u32 s4, s79, 1
    s_and_b32 s4, s4, 3
    s_lshl_b32 s4, s4, 11
    v_add_u32 v243, s4, v246
    s_add_u32 s4, s79, 2
    s_and_b32 s4, s4, 3
    s_lshl_b32 s4, s4, 11
    v_add_u32 v252, s4, v246
    s_add_u32 s4, s79, 3
    s_and_b32 s4, s4, 3
    s_lshl_b32 s4, s4, 11
    v_add_u32 v254, s4, v246
    s_add_u32 s4, s79, 4
    s_and_b32 s4, s4, 3
    s_lshl_b32 s4, s4, 11
    v_add_u32 v246, s4, v246
    s_bfe_u32 s4, s7, 393216
    s_cmp_gt_u32 s4, 8
    s_cselect_b32 s4, 8192, 0
    s_add_u32 s4, s4, s35
    s_add_u32 s68, s4, 0

    s_bfe_u32 s4, s7, 393216
    s_cmp_gt_u32 s4, 8
    s_cselect_b32 s4, 8192, 0
    s_add_u32 s4, s4, s35
    s_add_u32 s69, s4, 1048576

    s_bfe_u32 s4, s7, 393222
    s_cmp_gt_u32 s4, 8
    s_cselect_b32 s4, 8192, 0
    s_add_u32 s4, s4, s35
    s_add_u32 s70, s4, 2097152

    s_bfe_u32 s4, s7, 393222
    s_cmp_gt_u32 s4, 8
    s_cselect_b32 s4, 8192, 0
    s_add_u32 s4, s4, s35
    s_add_u32 s71, s4, 3145728

    s_mov_b32 s62, 0x1000000
    s_cmp_ge_u32 s24, 2
    s_cbranch_scc1 .nd_21
    s_mov_b32 s62, 0
    s_mov_b64 exec, 3
.wf_23:
    buffer_load_dword v244, v253, s[8:11], s89 offen sc1
    s_waitcnt vmcnt(0)
    v_cmp_gt_u32 vcc, 1, v244
    s_cbranch_vccz .wfd_24
    s_sleep 2
    s_add_u32 s62, s62, 1
    s_cmp_gt_u32 s62, 0x400000
    s_cbranch_scc1 .mg_end_1
    s_branch .wf_23

.wfd_24:
    s_mov_b64 exec, -1
    v_readlane_b32 s4, v244, 0
    v_readlane_b32 s93, v244, 1
    s_min_u32 s93, s93, s4
    s_mov_b32 s62, 0x1000000
    s_mov_b32 m0, s90
    s_nop 0
    buffer_load_dwordx4 v14, s[8:11], s38 offen offset:0 lds
    buffer_load_dwordx4 v14, s[8:11], s38 offen offset:1024 lds
    buffer_load_dwordx4 v14, s[8:11], s38 offen offset:2048 lds
    buffer_load_dwordx4 v14, s[8:11], s38 offen offset:3072 lds
    s_mov_b32 m0, s91
    s_nop 0
    buffer_load_dwordx4 v14, s[8:11], s39 offen lds
    s_mov_b64 exec, 3
    buffer_load_dword v244, v253, s[8:11], s89 offen sc1
    s_mov_b64 exec, -1
    s_waitcnt vmcnt(0)
.kd_22:
    v_readlane_b32 s4, v244, 0
    v_readlane_b32 s93, v244, 1
    s_min_u32 s93, s93, s4
    v_mov_b32 v4, s93
    v_mov_b32 v5, 19968
    ds_write_b32 v5, v4
.nd_21:
    s_waitcnt vmcnt(0) lgkmcnt(0)
    s_add_u32 s38, s38, 262144
    s_add_u32 s39, s39, 262144
    s_and_b32 s4, s28, 3
    s_lshl_b32 s5, s4, 17
    s_add_u32 s29, s5, s34
    s_xor_b32 s6, s5, 262144
    s_add_u32 s31, s6, s34
    s_add_u32 s32, s29, 20480
    s_add_u32 s33, s29, 24576
    s_mov_b64 s[14:15], 0
    s_barrier
    s_cmp_lt_u32 s24, 2
    s_cbranch_scc1 .k0_27
    ds_read_b128 v[128:131], v228 offset:0
    ds_read_b128 v[144:147], v228 offset:4096
    ds_read_b128 v[132:135], v229 offset:0
    ds_read_b128 v[148:151], v229 offset:4096
    ds_read_b128 v[136:139], v230 offset:0
    ds_read_b128 v[152:155], v230 offset:4096
    ds_read_b128 v[140:143], v231 offset:0
    ds_read_b128 v[156:159], v231 offset:4096
    ds_read_b128 v[160:163], v14 offset:28672
    ds_read_b128 v[164:167], v14 offset:29696
.k0_27:
    s_cmp_lg_u32 s27, 0
    s_cbranch_scc1 .ent1_26
    s_branch .ent0_25
.p2align 6
    s_endpgm
    s_endpgm
    s_endpgm
    s_endpgm
    s_endpgm
    s_endpgm
    s_endpgm
    s_endpgm
.top_36:
    s_barrier
.tp2_40:
    buffer_load_dwordx4 v[20:23], v8, s[8:11], s29 offen offset:0 sc1
    v_mov_b32 v52, 0
    buffer_load_dwordx4 v[24:27], v8, s[8:11], s29 offen offset:1024 sc1
    v_mov_b32 v53, 0
    buffer_load_dwordx4 v[28:31], v8, s[8:11], s29 offen offset:2048 sc1
    v_mov_b32 v54, 0
    buffer_load_dwordx4 v[32:35], v8, s[8:11], s29 offen offset:3072 sc1
.ent0_25:
    s_waitcnt vmcnt(3)
    v_max_u32 v4, v20, v22
    v_cmp_eq_u32 vcc, -1, v4
    s_cbranch_vccnz .A_42
.W_43:
    v_smfmac_f32_16x16x64_bf16 v[52:55], v[20:23], a[0:7], v9
    s_waitcnt vmcnt(2)
    v_max_u32 v4, v24, v26
    v_cmp_eq_u32 vcc, -1, v4
    v_smfmac_f32_16x16x64_bf16 v[56:59], v[20:23], a[32:39], v9
    v_smfmac_f32_16x16x64_bf16 v[60:63], v[20:23], a[64:71], v9
    v_smfmac_f32_16x16x64_bf16 v[64:67], v[20:23], a[96:103], v9
    s_cbranch_vccnz .A_44
.W_45:
    v_smfmac_f32_16x16x64_bf16 v[52:55], v[24:27], a[8:15], v9
    s_waitcnt vmcnt(1)
    v_max_u32 v4, v28, v30
    v_cmp_eq_u32 vcc, -1, v4
    v_smfmac_f32_16x16x64_bf16 v[56:59], v[24:27], a[40:47], v9
    v_smfmac_f32_16x16x64_bf16 v[60:63], v[24:27], a[72:79], v9
    v_smfmac_f32_16x16x64_bf16 v[64:67], v[24:27], a[104:111], v9
    s_cbranch_vccnz .A_46
.W_47:
    v_smfmac_f32_16x16x64_bf16 v[52:55], v[28:31], a[16:23], v9
    s_waitcnt vmcnt(0)
    v_max_u32 v4, v32, v34
    v_cmp_eq_u32 vcc, -1, v4
    v_smfmac_f32_16x16x64_bf16 v[56:59], v[28:31], a[48:55], v9
    v_smfmac_f32_16x16x64_bf16 v[60:63], v[28:31], a[80:87], v9
    v_smfmac_f32_16x16x64_bf16 v[64:67], v[28:31], a[112:119], v9
    s_cbranch_vccnz .A_48
.W_49:
    v_smfmac_f32_16x16x64_bf16 v[52:55], v[32:35], a[24:31], v9
    v_smfmac_f32_16x16x64_bf16 v[56:59], v[32:35], a[56:63], v9
    v_smfmac_f32_16x16x64_bf16 v[60:63], v[32:35], a[88:95], v9
    s_nop 0
    v_cvt_pk_bf16_f32 v104, v52, v53
    v_cvt_pk_bf16_f32 v105, v54, v55
    v_smfmac_f32_16x16x64_bf16 v[64:67], v[32:35], a[120:127], v9
.mj_41:
    ds_write_b64 v19, v[104:105] offset:4096
    v_cvt_pk_bf16_f32 v106, v56, v57
    v_cvt_pk_bf16_f32 v107, v58, v59
    ds_write_b64 v19, v[106:107] offset:6144
    v_cvt_pk_bf16_f32 v108, v60, v61
    v_cvt_pk_bf16_f32 v109, v62, v63
    ds_write_b64 v19, v[108:109] offset:0
    s_nop 0
    v_cvt_pk_bf16_f32 v110, v64, v65
    v_cvt_pk_bf16_f32 v111, v66, v67
    ds_write_b64 v19, v[110:111] offset:2048
    v_smfmac_f32_16x16x64_bf16 v[68:71], v[20:23], a[128:135], v9
    s_waitcnt lgkmcnt(0)
    s_barrier
    ds_read_b128 v[36:39], v17 offset:0
    ds_read_b128 v[40:43], v17 offset:1024
    v_smfmac_f32_16x16x64_bf16 v[72:75], v[20:23], a[160:167], v9
    v_smfmac_f32_16x16x64_bf16 v[68:71], v[24:27], a[136:143], v9
    s_waitcnt lgkmcnt(1)
    v_mfma_f32_16x16x32_bf16 v[44:47], v[36:39], v[84:87], 0
    s_waitcnt lgkmcnt(0)
    v_mfma_f32_16x16x32_bf16 v[44:47], v[40:43], v[84:87], v[44:47]
    v_smfmac_f32_16x16x64_bf16 v[72:75], v[24:27], a[168:175], v9
    v_smfmac_f32_16x16x64_bf16 v[68:71], v[28:31], a[144:151], v9
    s_mov_b64 exec, s[64:65]
    v_cvt_pk_bf16_f32 v48, v44, v45
    v_cvt_pk_bf16_f32 v49, v46, v47

    buffer_store_dwordx2 v[48:49], v10, s[8:11], s29 offen

    ds_write_b64 v18, v[48:49]
    s_mov_b64 exec, -1

    v_smfmac_f32_16x16x64_bf16 v[72:75], v[28:31], a[176:183], v9
    v_smfmac_f32_16x16x64_bf16 v[68:71], v[32:35], a[152:159], v9
    v_smfmac_f32_16x16x64_bf16 v[72:75], v[32:35], a[184:191], v9
    s_nop 3
    v_cvt_pk_bf16_f32 v104, v68, v69
    v_cvt_pk_bf16_f32 v105, v70, v71
    ds_write_b64 v16, v[104:105] offset:8192
    s_nop 0
    v_cvt_pk_bf16_f32 v106, v72, v73
    v_cvt_pk_bf16_f32 v107, v74, v75
    ds_write_b64 v16, v[106:107] offset:10240
    s_cmp_lg_u32 s24, 2
    s_waitcnt lgkmcnt(0)
    s_barrier
    s_cbranch_scc1 .oth_37
    buffer_load_dwordx4 v[92:95], v232, s[8:11], s29 offen sc1
    buffer_load_dwordx4 v[96:99], v233, s[8:11], s29 offen sc1
    buffer_load_dwordx4 v[100:103], v234, s[8:11], s29 offen sc1
    ds_read_b128 v[88:91], v14 offset:16384
    s_cmp_eq_u32 s28, 63
    s_cbranch_scc1 .rec_fin_6
.en_32:
    s_waitcnt lgkmcnt(0)
    v_mfma_f32_16x16x32_bf16 v[208:211], v[128:131], v[88:91], 0
    v_mfma_f32_16x16x32_bf16 v[212:215], v[144:147], v[88:91], 0
    v_mfma_f32_16x16x32_bf16 v[216:219], v[88:91], v[88:91], v[116:119]
    s_waitcnt vmcnt(2)
    v_max_u32 v4, v92, v94
    v_cmp_eq_u32 vcc, -1, v4
    s_cbranch_vccnz .A_51
.W_52:
    v_mfma_f32_16x16x32_bf16 v[208:211], v[132:135], v[92:95], v[208:211]
    s_waitcnt vmcnt(1)
    v_max_u32 v4, v96, v98
    v_cmp_eq_u32 vcc, -1, v4
    v_mfma_f32_16x16x32_bf16 v[212:215], v[148:151], v[92:95], v[212:215]
    v_mfma_f32_16x16x32_bf16 v[216:219], v[92:95], v[92:95], v[216:219]
    s_cbranch_vccnz .A_53
.W_54:
    v_mfma_f32_16x16x32_bf16 v[208:211], v[136:139], v[96:99], v[208:211]
    s_waitcnt vmcnt(0)
    v_max_u32 v4, v100, v102
    v_cmp_eq_u32 vcc, -1, v4
    v_mfma_f32_16x16x32_bf16 v[212:215], v[152:155], v[96:99], v[212:215]
    v_mfma_f32_16x16x32_bf16 v[216:219], v[96:99], v[96:99], v[216:219]
    s_cbranch_vccnz .A_55
.W_56:
    v_mfma_f32_16x16x32_bf16 v[208:211], v[140:143], v[100:103], v[208:211]
    s_barrier
    v_mfma_f32_16x16x32_bf16 v[212:215], v[156:159], v[100:103], v[212:215]
    v_mfma_f32_16x16x32_bf16 v[216:219], v[100:103], v[100:103], v[216:219]
.mj_50:
    ds_read_b64 v[168:169], v14 offset:18432
    v_max3_f32 v4, v208, v209, v210
    ds_read_b64 v[172:173], v14 offset:18440
    s_nop 0
    v_max3_f32 v5, v211, v212, v213
    v_max3_f32 v4, v4, v214, v215
    v_mov_b32_dpp v208, v212 row_ror:8 row_mask:0xf bank_mask:0xc
    v_mov_b32_dpp v209, v213 row_ror:8 row_mask:0xf bank_mask:0xc
    v_max3_f32 v5, v5, v216, v217
    v_max3_f32 v4, v4, v218, v219
    v_max_f32 v6, v4, v5
    v_max_f32 v4, v4, v5
    v_mov_b32_dpp v210, v214 row_ror:8 row_mask:0xf bank_mask:0xc
    v_mov_b32_dpp v211, v215 row_ror:8 row_mask:0xf bank_mask:0xc
    v_permlane32_swap_b32 v4, v6
    v_max_f32 v5, v4, v6
    v_max_f32 v4, v4, v6
    v_mov_b32_dpp v216, v218 row_ror:8 row_mask:0xf bank_mask:0xc
    v_mov_b32_dpp v217, v219 row_ror:8 row_mask:0xf bank_mask:0xc
    v_permlane16_swap_b32 v4, v5
    v_max_f32 v4, v4, v5
    s_nop 1
    v_mov_b32_dpp v4, v4 row_ror:8 row_mask:0xf bank_mask:0xc
    v_mul_f32 v4, s37, v4

    v_pk_fma_f32 v[104:105], v[208:209], s[36:37], v[4:5] op_sel:[0,1,0] op_sel_hi:[1,1,0] neg_lo:[0,0,1] neg_hi:[0,0,1]
    v_pk_fma_f32 v[106:107], v[210:211], s[36:37], v[4:5] op_sel:[0,1,0] op_sel_hi:[1,1,0] neg_lo:[0,0,1] neg_hi:[0,0,1]
    v_pk_fma_f32 v[108:109], v[216:217], s[36:37], v[4:5] op_sel:[0,1,0] op_sel_hi:[1,1,0] neg_lo:[0,0,1] neg_hi:[0,0,1]
    v_exp_f32 v104, v104
    v_exp_f32 v105, v105
    v_exp_f32 v106, v106
    v_exp_f32 v107, v107
    v_cvt_pk_bf16_f32 v176, v104, v105
    v_cvt_pk_bf16_f32 v177, v106, v107
    v_exp_f32 v108, v108
    v_mov_b32_dpp v178, v176 row_ror:8 row_mask:0xf bank_mask:0xf
    v_mov_b32_dpp v179, v177 row_ror:8 row_mask:0xf bank_mask:0xf
    s_waitcnt lgkmcnt(0)
    s_nop 0

    v_mfma_f32_16x16x32_bf16 v[208:211], v[120:123], v[176:179], 0
    v_exp_f32 v109, v109
    v_mfma_f32_16x16x32_bf16 v[212:215], v[160:163], v[176:179], 0
    v_cvt_pk_bf16_f32 v180, v108, v109
    s_nop 0
    v_mfma_f32_16x16x32_bf16 v[216:219], v[164:167], v[176:179], 0
    v_mov_b32_dpp v181, v180 row_ror:8 row_mask:0xf bank_mask:0xf
    s_nop 1
    v_mfma_f32_16x16x32_bf16 v[208:211], v[120:123], v[180:183], v[208:211]
    v_mfma_f32_16x16x32_bf16 v[212:215], v[168:171], v[180:183], v[212:215]
    v_mfma_f32_16x16x32_bf16 v[216:219], v[172:175], v[180:183], v[216:219]
    s_mov_b64 exec, s[58:59]
    v_rcp_f32 v4, v208
    s_nop 0
    v_pk_mul_f32 v[212:213], v[212:213], v[4:5] op_sel_hi:[1,0]
    v_pk_mul_f32 v[214:215], v[214:215], v[4:5] op_sel_hi:[1,0]

    v_cvt_pk_bf16_f32 v184, v212, v213
    v_cvt_pk_bf16_f32 v185, v214, v215
    v_pk_mul_f32 v[216:217], v[216:217], v[4:5] op_sel_hi:[1,0]
    v_pk_mul_f32 v[218:219], v[218:219], v[4:5] op_sel_hi:[1,0]

    v_cvt_pk_bf16_f32 v186, v216, v217
    v_cvt_pk_bf16_f32 v187, v218, v219
    buffer_store_dwordx4 v[184:187], v13, s[8:11], s29 offen
    s_mov_b64 exec, -1

.gp_39:
    s_barrier
    v_mov_b32 v5, 19968
    ds_read_b32 v4, v5
    s_mov_b32 s99, s68
    s_waitcnt vmcnt(0)
    s_cmp_eq_u32 s24, 3
    s_cbranch_scc1 .u3_57
    s_add_u32 s6, s28, 3
    s_add_u32 s7, s30, 262144
    s_waitcnt lgkmcnt(0)
    v_readfirstlane_b32 s5, v4
    s_cmp_lt_u32 s5, s6
    s_barrier
    s_cbranch_scc1 .np_59
    buffer_load_dword v226, v225, s[8:11], s7 offen

.np_59:
    s_add_u32 s4, s70, 0
    buffer_store_dwordx4 v[188:191], v238, s[8:11], s4 offen sc1
    s_add_u32 s4, s70, 262144
    buffer_store_dwordx4 v[188:191], v238, s[8:11], s4 offen sc1
    s_branch .u4_58
.u3_57:
    s_sub_u32 s4, s36, 0
    s_barrier
    s_mov_b64 exec, s[66:67]
    buffer_store_dwordx4 v[88:91], v11, s[8:11], s4 offen sc1
    s_mov_b64 exec, s[56:57]
    buffer_store_dwordx4 v[172:175], v12, s[8:11], s4 offen sc1
    s_mov_b64 exec, -1

.u4_58:
    s_barrier
    s_add_u32 s28, s28, 1
    s_add_u32 s36, s36, 196608
    s_cmp_lt_u32 s28, 63
    s_cselect_b32 s4, 262144, 0
    s_add_u32 s38, s38, s4
    s_add_u32 s39, s39, s4
    s_add_u32 s30, s30, s4
    s_mov_b32 s4, s68
    s_mov_b32 s68, s69
    s_mov_b32 s69, s70
    s_mov_b32 s70, s71
    s_mov_b32 s71, s4
    s_and_b32 s4, s28, 3
    s_lshl_b32 s5, s4, 17
    s_add_u32 s29, s5, s34
    s_xor_b32 s6, s5, 262144
    s_add_u32 s31, s6, s34
    s_add_u32 s32, s29, 20480
    s_add_u32 s33, s29, 24576
    v_mov_b32 v55, 0
    v_mov_b32 v56, 0
    v_mov_b32 v57, 0
    v_mov_b32 v58, 0
    v_mov_b32 v59, 0
    v_mov_b32 v60, 0
    v_mov_b32 v61, 0
    v_mov_b32 v62, 0
    v_mov_b32 v63, 0
    v_mov_b32 v64, 0
    v_mov_b32 v65, 0
    v_mov_b32 v66, 0
    v_mov_b32 v67, 0
    v_mov_b32 v68, 0
    v_mov_b32 v69, 0
    v_mov_b32 v70, 0
    v_mov_b32 v71, 0
    v_mov_b32 v72, 0
    v_mov_b32 v73, 0
    v_mov_b32 v74, 0
    v_mov_b32 v75, 0
    v_mov_b32 v20, -1
    v_mov_b32 v21, -1
    v_mov_b32 v22, -1
    v_mov_b32 v23, -1
    v_mov_b32 v24, -1
    v_mov_b32 v25, -1
    v_mov_b32 v26, -1
    v_mov_b32 v27, -1
    v_mov_b32 v28, -1
    v_mov_b32 v29, -1
    v_mov_b32 v30, -1
    v_mov_b32 v31, -1
    v_mov_b32 v32, -1
    v_mov_b32 v33, -1
    v_mov_b32 v34, -1
    v_mov_b32 v35, -1
    v_mov_b32 v92, -1
    v_mov_b32 v93, -1
    v_mov_b32 v94, -1
    v_mov_b32 v95, -1
    v_mov_b32 v96, -1
    v_mov_b32 v97, -1
    v_mov_b32 v98, -1
    v_mov_b32 v99, -1
    v_mov_b32 v100, -1
    v_mov_b32 v101, -1
    v_mov_b32 v102, -1
    v_mov_b32 v103, -1
    s_add_u32 s4, s99, 0
    buffer_load_dwordx4 v[192:195], v239, s[8:11], s4 offen sc1
    buffer_load_dwordx4 v[196:199], v249, s[8:11], s4 offen sc1

    ds_read_b128 v[128:131], v228 offset:0
    ds_read_b128 v[144:147], v228 offset:4096
    ds_read_b128 v[132:135], v229 offset:0
    ds_read_b128 v[148:151], v229 offset:4096
    ds_read_b128 v[136:139], v230 offset:0
    ds_read_b128 v[152:155], v230 offset:4096
    ds_read_b128 v[140:143], v231 offset:0
    ds_read_b128 v[156:159], v231 offset:4096
    ds_read_b128 v[160:163], v14 offset:28672
    ds_read_b128 v[164:167], v14 offset:29696
    ds_read_b128 v[108:111], v248
    s_waitcnt lgkmcnt(0)
    v_mfma_f32_16x16x32_bf16 v[76:79], v[108:111], v[112:115], 0
    s_add_u32 s4, s99, 262144
    buffer_load_dwordx4 v[200:203], v239, s[8:11], s4 offen sc1
    buffer_load_dwordx4 v[204:207], v249, s[8:11], s4 offen sc1

.gc_60:
    s_waitcnt vmcnt(2)

    v_mfma_f32_16x16x32_bf16 v[80:83], v[192:195], v[84:87], v[76:79]
    v_max_u32 v4, v192, v196
    v_cmp_eq_u32 vcc, -1, v4
    v_mfma_f32_16x16x32_bf16 v[80:83], v[196:199], v[112:115], v[80:83]
    s_nop 3
    s_cbranch_vccnz .gf_61
    s_mov_b64 exec, s[58:59]
    s_nop 1
    v_cvt_pk_bf16_f32 v104, v80, v81
    v_cvt_pk_bf16_f32 v105, v82, v83

    buffer_store_dwordx2 v[104:105], v15, s[8:11], s29 offen
    s_mov_b64 exec, -1

    s_branch .top_36
.gf_61:
    s_add_u32 s4, s99, 0
    buffer_load_dwordx4 v[192:195], v239, s[8:11], s4 offen sc1
    buffer_load_dwordx4 v[196:199], v249, s[8:11], s4 offen sc1

    s_waitcnt vmcnt(2)

    v_mfma_f32_16x16x32_bf16 v[80:83], v[200:203], v[84:87], v[76:79]
    v_max_u32 v4, v200, v204
    v_cmp_eq_u32 vcc, -1, v4
    v_mfma_f32_16x16x32_bf16 v[80:83], v[204:207], v[112:115], v[80:83]
    s_nop 3
    s_cbranch_vccnz .gf_62
    s_mov_b64 exec, s[58:59]
    s_nop 1
    v_cvt_pk_bf16_f32 v104, v80, v81
    v_cvt_pk_bf16_f32 v105, v82, v83

    buffer_store_dwordx2 v[104:105], v15, s[8:11], s29 offen
    s_mov_b64 exec, -1

    s_branch .top_36
.gf_62:
    s_add_u32 s4, s99, 262144
    buffer_load_dwordx4 v[200:203], v239, s[8:11], s4 offen sc1
    buffer_load_dwordx4 v[204:207], v249, s[8:11], s4 offen sc1

    s_sub_u32 s62, s62, 1
    s_cbranch_scc1 .mg_end_1
    s_branch .gc_60
.oth_37:
    s_cmp_eq_u32 s24, 3
    s_cbranch_scc1 .w3_38
    s_cmp_eq_u32 s28, 63
    s_cbranch_scc1 .rec_fin_6
    s_min_u32 s4, s14, s15
    s_max_u32 s93, s93, s4
    v_mov_b32 v4, s93
    v_mov_b32 v5, 19968
    ds_write_b32 v5, v4
    s_waitcnt vmcnt(0)
    v_mov_b32 v57, 0
    v_mov_b32 v58, 0
    v_mov_b32 v59, 0
    v_mov_b32 v60, 0
    v_mov_b32 v61, 0
    v_mov_b32 v62, 0
    v_mov_b32 v63, 0
    v_mov_b32 v64, 0
    v_mov_b32 v65, 0
    v_mov_b32 v66, 0
    v_mov_b32 v67, 0
    s_barrier
.en_28:
    s_add_u32 s6, s28, 2
    s_min_u32 s6, s6, 64
    s_cmp_lt_u32 s93, s6
    s_cbranch_scc1 .kf_63
.kb_64:
    s_mov_b32 m0, s90
    s_nop 0
    buffer_load_dwordx4 v14, s[8:11], s38 offen offset:0 lds
    buffer_load_dwordx4 v14, s[8:11], s38 offen offset:1024 lds
    buffer_load_dwordx4 v14, s[8:11], s38 offen offset:2048 lds
    buffer_load_dwordx4 v14, s[8:11], s38 offen offset:3072 lds
    s_mov_b32 m0, s91
    s_nop 0
    buffer_load_dwordx4 v14, s[8:11], s39 offen lds
    s_waitcnt lgkmcnt(0)
    s_barrier
    v_mov_b32 v20, -1
    v_mov_b32 v21, -1
    v_mov_b32 v22, -1
    v_mov_b32 v23, -1
    v_mov_b32 v24, -1
    v_mov_b32 v25, -1
    v_mov_b32 v26, -1
    v_mov_b32 v27, -1
    v_mov_b32 v28, -1
    v_mov_b32 v29, -1
    v_mov_b32 v30, -1
    v_mov_b32 v31, -1
    v_mov_b32 v32, -1
    v_mov_b32 v33, -1
    v_mov_b32 v34, -1
    v_mov_b32 v35, -1
    v_mov_b32 v55, 0
    v_mov_b32 v56, 0
    buffer_load_dwordx4 v[192:195], v243, s[8:11], s32 offen offset:0 sc1
    buffer_load_dwordx4 v[196:199], v243, s[8:11], s32 offen offset:1024 sc1
    v_mov_b32 v76, 0
    buffer_load_dwordx4 v[200:203], v252, s[8:11], s32 offen offset:0 sc1
    buffer_load_dwordx4 v[204:207], v252, s[8:11], s32 offen offset:1024 sc1
    v_mov_b32 v77, 0
    buffer_load_dwordx4 v[208:211], v254, s[8:11], s32 offen offset:0 sc1
    buffer_load_dwordx4 v[212:215], v254, s[8:11], s32 offen offset:1024 sc1
    v_mov_b32 v78, 0
    buffer_load_dwordx4 v[216:219], v246, s[8:11], s32 offen offset:0 sc1
    buffer_load_dwordx4 v[220:223], v246, s[8:11], s32 offen offset:1024 sc1
    s_waitcnt vmcnt(6)
    v_max_u32 v4, v192, v196
    v_cmp_eq_u32 vcc, -1, v4
    s_cbranch_vccnz .A_66
.W_67:
    v_smfmac_f32_16x16x64_bf16 v[76:79], v[192:195], a[192:199], v9
    s_waitcnt vmcnt(4)
    v_max_u32 v4, v200, v204
    v_cmp_eq_u32 vcc, -1, v4
    v_smfmac_f32_16x16x64_bf16 v[80:83], v[192:195], a[224:231], v9
    v_smfmac_f32_16x16x64_bf16 v[76:79], v[196:199], a[200:207], v9
    v_smfmac_f32_16x16x64_bf16 v[80:83], v[196:199], a[232:239], v9
    s_cbranch_vccnz .A_68
.W_69:
    v_smfmac_f32_16x16x64_bf16 v[76:79], v[200:203], a[208:215], v9
    s_waitcnt vmcnt(2)
    v_max_u32 v4, v208, v212
    v_cmp_eq_u32 vcc, -1, v4
    v_smfmac_f32_16x16x64_bf16 v[80:83], v[200:203], a[240:247], v9
    v_smfmac_f32_16x16x64_bf16 v[76:79], v[204:207], a[216:223], v9
    v_smfmac_f32_16x16x64_bf16 v[80:83], v[204:207], a[248:255], v9
    s_cbranch_vccnz .A_70
.W_71:
    v_smfmac_f32_16x16x64_bf16 v[76:79], v[208:211], v[124:131], v9
    s_waitcnt vmcnt(0)
    v_max_u32 v4, v216, v220
    v_cmp_eq_u32 vcc, -1, v4
    v_smfmac_f32_16x16x64_bf16 v[80:83], v[208:211], v[156:163], v9
    v_smfmac_f32_16x16x64_bf16 v[76:79], v[212:215], v[132:139], v9
    v_smfmac_f32_16x16x64_bf16 v[80:83], v[212:215], v[164:171], v9
    s_cbranch_vccnz .A_72
.W_73:
    s_barrier
    v_smfmac_f32_16x16x64_bf16 v[76:79], v[216:219], v[140:147], v9
    v_smfmac_f32_16x16x64_bf16 v[80:83], v[216:219], v[172:179], v9
    v_smfmac_f32_16x16x64_bf16 v[76:79], v[220:223], v[148:155], v9
    v_smfmac_f32_16x16x64_bf16 v[80:83], v[220:223], v[180:187], v9
.mj_65:
    v_mov_b32 v68, 0
    v_mov_b32 v69, 0
    v_mov_b32 v70, 0
    v_mov_b32 v71, 0
    v_mov_b32 v72, 0
    v_mov_b32 v73, 0
    v_mov_b32 v74, 0
    v_mov_b32 v75, 0
    v_permlane32_swap_b32 v76, v80
    v_permlane32_swap_b32 v77, v81
    v_permlane32_swap_b32 v78, v82
    v_permlane32_swap_b32 v79, v83
    v_pk_add_f32 v[76:77], v[76:77], v[80:81]
    v_pk_add_f32 v[78:79], v[78:79], v[82:83]
    v_cvt_pk_bf16_f32 v104, v76, v77
    v_cvt_pk_bf16_f32 v106, v76, v77
    v_cvt_pk_bf16_f32 v105, v78, v79
    v_cvt_pk_bf16_f32 v107, v78, v79
    v_permlane16_swap_b32 v104, v106
    s_nop 0
    v_permlane16_swap_b32 v105, v107

    buffer_store_dwordx4 v[104:107], v237, s[8:11], s68 offen sc1

    ds_write_b128 v247, v[104:107]
    s_waitcnt lgkmcnt(0)
    s_barrier
    v_mov_b32 v79, 0
    v_mov_b32 v80, 0
    v_mov_b32 v81, 0
    v_mov_b32 v82, 0
    v_mov_b32 v83, 0
    s_waitcnt vmcnt(1)
    v_mov_b32 v192, -1
    v_mov_b32 v193, -1
    v_mov_b32 v194, -1
    v_mov_b32 v195, -1
    v_mov_b32 v196, -1
    v_mov_b32 v197, -1
    v_mov_b32 v198, -1
    v_mov_b32 v199, -1
    v_mov_b32 v200, -1
    v_mov_b32 v201, -1
    v_mov_b32 v202, -1
    v_mov_b32 v203, -1
    v_mov_b32 v204, -1
    v_mov_b32 v205, -1
    v_mov_b32 v206, -1
    v_mov_b32 v207, -1
    v_mov_b32 v208, -1
    v_mov_b32 v209, -1
    v_mov_b32 v210, -1
    v_mov_b32 v211, -1
    v_mov_b32 v212, -1
    v_mov_b32 v213, -1
    v_mov_b32 v214, -1
    v_mov_b32 v215, -1
    v_mov_b32 v216, -1
    v_mov_b32 v217, -1
    v_mov_b32 v218, -1
    v_mov_b32 v219, -1
    v_mov_b32 v220, -1
    v_mov_b32 v221, -1
    v_mov_b32 v222, -1
    v_mov_b32 v223, -1
    s_add_u32 s6, s28, 4
    s_cmp_ge_u32 s93, s6
    s_cbranch_scc1 .nl_74
    s_buffer_load_dword s14, s[8:11], s89 glc
    s_buffer_load_dword s15, s[8:11], s89 offset:8192 glc

.nl_74:
    s_add_u32 s28, s28, 1
    s_add_u32 s36, s36, 196608
    s_cmp_lt_u32 s28, 63
    s_cselect_b32 s4, 262144, 0
    s_add_u32 s38, s38, s4
    s_add_u32 s39, s39, s4
    s_add_u32 s30, s30, s4
    s_mov_b32 s4, s68
    s_mov_b32 s68, s69
    s_mov_b32 s69, s70
    s_mov_b32 s70, s71
    s_mov_b32 s71, s4
    s_and_b32 s4, s28, 3
    s_lshl_b32 s5, s4, 17
    s_add_u32 s29, s5, s34
    s_xor_b32 s6, s5, 262144
    s_add_u32 s31, s6, s34
    s_add_u32 s32, s29, 20480
    s_add_u32 s33, s29, 24576
    s_branch .top_36
.w3_38:
    ds_read_b128 v[36:39], v14 offset:8192
    ds_read_b128 v[40:43], v14 offset:9216
    ds_read_b128 v[44:47], v14 offset:10240
    ds_read_b128 v[48:51], v14 offset:11264
    ds_read_b128 v[88:91], v14 offset:16384
    s_waitcnt lgkmcnt(0)
    v_mfma_f32_16x16x32_bf16 v[104:107], v[84:87], v[36:39], 0
    v_mfma_f32_16x16x32_bf16 v[108:111], v[84:87], v[44:47], 0
    v_mfma_f32_16x16x32_bf16 v[104:107], v[84:87], v[40:43], v[104:107]
    v_mfma_f32_16x16x32_bf16 v[108:111], v[84:87], v[48:51], v[108:111]
    s_nop 7
    v_cvt_pk_bf16_f32 v168, v104, v105
    v_cvt_pk_bf16_f32 v169, v106, v107
    v_cvt_pk_bf16_f32 v170, v108, v109
    v_cvt_pk_bf16_f32 v171, v110, v111
    ds_write_b128 v14, v[168:171] offset:18432
    s_cmp_ge_u32 s28, 62
    s_cbranch_scc1 .sk_75
.sb_76:
.en_34:
    s_waitcnt lgkmcnt(0)
    s_barrier
    buffer_store_dwordx4 v[188:191], v235, s[8:11], s31 offen
    buffer_store_dwordx4 v[188:191], v236, s[8:11], s31 offen

    v_cndmask_b32 v172, v170, v168, s[60:61]
    v_cndmask_b32 v173, v171, v169, s[60:61]

    v_mov_b32 v174, v172
    v_mov_b32 v175, v173
    s_nop 0
    s_nop 0
    v_permlane16_swap_b32 v172, v174
    v_permlane16_swap_b32 v173, v175
    ds_write_b128 v14, v[172:175] offset:17408

    s_branch .gp_39
.A_77:
    s_mov_b64 exec, vcc
    buffer_load_dwordx4 v[32:35], v8, s[8:11], s29 offen offset:3072 sc1
    s_mov_b64 exec, -1
    s_sub_u32 s62, s62, 1
    s_cbranch_scc1 .mg_end_1
    s_waitcnt vmcnt(3)
    v_max_u32 v4, v20, v22
    v_cmp_eq_u32 vcc, -1, v4
    s_cbranch_vccz .W_43
.A_42:
    s_mov_b64 exec, vcc
    buffer_load_dwordx4 v[20:23], v8, s[8:11], s29 offen offset:0 sc1
    s_mov_b64 exec, -1
    s_waitcnt vmcnt(3)
    v_max_u32 v4, v24, v26
    v_cmp_eq_u32 vcc, -1, v4
    s_cbranch_vccz .W_78
.A_79:
    s_mov_b64 exec, vcc
    buffer_load_dwordx4 v[24:27], v8, s[8:11], s29 offen offset:1024 sc1
    s_mov_b64 exec, -1
    s_waitcnt vmcnt(3)
    v_max_u32 v4, v28, v30
    v_cmp_eq_u32 vcc, -1, v4
    s_cbranch_vccz .W_80
.A_81:
    s_mov_b64 exec, vcc
    buffer_load_dwordx4 v[28:31], v8, s[8:11], s29 offen offset:2048 sc1
    s_mov_b64 exec, -1
    s_waitcnt vmcnt(3)
    v_max_u32 v4, v32, v34
    v_cmp_eq_u32 vcc, -1, v4
    s_cbranch_vccnz .A_77
.W_82:
    v_smfmac_f32_16x16x64_bf16 v[52:55], v[32:35], a[24:31], v9
    s_waitcnt vmcnt(2)
    v_max_u32 v4, v20, v22
    v_cmp_eq_u32 vcc, -1, v4
    v_smfmac_f32_16x16x64_bf16 v[56:59], v[32:35], a[56:63], v9
    v_smfmac_f32_16x16x64_bf16 v[60:63], v[32:35], a[88:95], v9
    v_smfmac_f32_16x16x64_bf16 v[64:67], v[32:35], a[120:127], v9
    s_cbranch_vccnz .A_83
.W_84:
    v_smfmac_f32_16x16x64_bf16 v[52:55], v[20:23], a[0:7], v9
    s_waitcnt vmcnt(1)
    v_max_u32 v4, v24, v26
    v_cmp_eq_u32 vcc, -1, v4
    v_smfmac_f32_16x16x64_bf16 v[56:59], v[20:23], a[32:39], v9
    v_smfmac_f32_16x16x64_bf16 v[60:63], v[20:23], a[64:71], v9
    v_smfmac_f32_16x16x64_bf16 v[64:67], v[20:23], a[96:103], v9
    s_cbranch_vccnz .A_85
.W_86:
    v_smfmac_f32_16x16x64_bf16 v[52:55], v[24:27], a[8:15], v9
    s_waitcnt vmcnt(0)
    v_max_u32 v4, v28, v30
    v_cmp_eq_u32 vcc, -1, v4
    v_smfmac_f32_16x16x64_bf16 v[56:59], v[24:27], a[40:47], v9
    v_smfmac_f32_16x16x64_bf16 v[60:63], v[24:27], a[72:79], v9
    v_smfmac_f32_16x16x64_bf16 v[64:67], v[24:27], a[104:111], v9
    s_cbranch_vccnz .A_87
.W_88:
    v_smfmac_f32_16x16x64_bf16 v[52:55], v[28:31], a[16:23], v9
    v_smfmac_f32_16x16x64_bf16 v[56:59], v[28:31], a[48:55], v9
    v_smfmac_f32_16x16x64_bf16 v[60:63], v[28:31], a[80:87], v9
    s_nop 0
    v_cvt_pk_bf16_f32 v104, v52, v53
    v_cvt_pk_bf16_f32 v105, v54, v55
    v_smfmac_f32_16x16x64_bf16 v[64:67], v[28:31], a[112:119], v9
    s_branch .mj_41
.W_78:
    v_smfmac_f32_16x16x64_bf16 v[52:55], v[24:27], a[8:15], v9
    s_waitcnt vmcnt(2)
    v_max_u32 v4, v28, v30
    v_cmp_eq_u32 vcc, -1, v4
    v_smfmac_f32_16x16x64_bf16 v[56:59], v[24:27], a[40:47], v9
    v_smfmac_f32_16x16x64_bf16 v[60:63], v[24:27], a[72:79], v9
    v_smfmac_f32_16x16x64_bf16 v[64:67], v[24:27], a[104:111], v9
    s_cbranch_vccnz .A_89
.W_90:
    v_smfmac_f32_16x16x64_bf16 v[52:55], v[28:31], a[16:23], v9
    s_waitcnt vmcnt(1)
    v_max_u32 v4, v32, v34
    v_cmp_eq_u32 vcc, -1, v4
    v_smfmac_f32_16x16x64_bf16 v[56:59], v[28:31], a[48:55], v9
    v_smfmac_f32_16x16x64_bf16 v[60:63], v[28:31], a[80:87], v9
    v_smfmac_f32_16x16x64_bf16 v[64:67], v[28:31], a[112:119], v9
    s_cbranch_vccnz .A_91
.W_92:
    v_smfmac_f32_16x16x64_bf16 v[52:55], v[32:35], a[24:31], v9
    s_waitcnt vmcnt(0)
    v_max_u32 v4, v20, v22
    v_cmp_eq_u32 vcc, -1, v4
    v_smfmac_f32_16x16x64_bf16 v[56:59], v[32:35], a[56:63], v9
    v_smfmac_f32_16x16x64_bf16 v[60:63], v[32:35], a[88:95], v9
    v_smfmac_f32_16x16x64_bf16 v[64:67], v[32:35], a[120:127], v9
    s_cbranch_vccnz .A_93
.W_94:
    v_smfmac_f32_16x16x64_bf16 v[52:55], v[20:23], a[0:7], v9
    v_smfmac_f32_16x16x64_bf16 v[56:59], v[20:23], a[32:39], v9
    v_smfmac_f32_16x16x64_bf16 v[60:63], v[20:23], a[64:71], v9
    s_nop 0
    v_cvt_pk_bf16_f32 v104, v52, v53
    v_cvt_pk_bf16_f32 v105, v54, v55
    v_smfmac_f32_16x16x64_bf16 v[64:67], v[20:23], a[96:103], v9
    s_branch .mj_41
.W_80:
    v_smfmac_f32_16x16x64_bf16 v[52:55], v[28:31], a[16:23], v9
    s_waitcnt vmcnt(2)
    v_max_u32 v4, v32, v34
    v_cmp_eq_u32 vcc, -1, v4
    v_smfmac_f32_16x16x64_bf16 v[56:59], v[28:31], a[48:55], v9
    v_smfmac_f32_16x16x64_bf16 v[60:63], v[28:31], a[80:87], v9
    v_smfmac_f32_16x16x64_bf16 v[64:67], v[28:31], a[112:119], v9
    s_cbranch_vccnz .A_95
.W_96:
    v_smfmac_f32_16x16x64_bf16 v[52:55], v[32:35], a[24:31], v9
    s_waitcnt vmcnt(1)
    v_max_u32 v4, v20, v22
    v_cmp_eq_u32 vcc, -1, v4
    v_smfmac_f32_16x16x64_bf16 v[56:59], v[32:35], a[56:63], v9
    v_smfmac_f32_16x16x64_bf16 v[60:63], v[32:35], a[88:95], v9
    v_smfmac_f32_16x16x64_bf16 v[64:67], v[32:35], a[120:127], v9
    s_cbranch_vccnz .A_97
.W_98:
    v_smfmac_f32_16x16x64_bf16 v[52:55], v[20:23], a[0:7], v9
    s_waitcnt vmcnt(0)
    v_max_u32 v4, v24, v26
    v_cmp_eq_u32 vcc, -1, v4
    v_smfmac_f32_16x16x64_bf16 v[56:59], v[20:23], a[32:39], v9
    v_smfmac_f32_16x16x64_bf16 v[60:63], v[20:23], a[64:71], v9
    v_smfmac_f32_16x16x64_bf16 v[64:67], v[20:23], a[96:103], v9
    s_cbranch_vccnz .A_99
.W_100:
    v_smfmac_f32_16x16x64_bf16 v[52:55], v[24:27], a[8:15], v9
    v_smfmac_f32_16x16x64_bf16 v[56:59], v[24:27], a[40:47], v9
    v_smfmac_f32_16x16x64_bf16 v[60:63], v[24:27], a[72:79], v9
    s_nop 0
    v_cvt_pk_bf16_f32 v104, v52, v53
    v_cvt_pk_bf16_f32 v105, v54, v55
    v_smfmac_f32_16x16x64_bf16 v[64:67], v[24:27], a[104:111], v9
    s_branch .mj_41
.A_101:
    s_mov_b64 exec, vcc
    buffer_load_dwordx4 v[28:31], v8, s[8:11], s29 offen offset:2048 sc1
    s_mov_b64 exec, -1
    s_sub_u32 s62, s62, 1
    s_cbranch_scc1 .mg_end_1
    s_waitcnt vmcnt(2)
    v_max_u32 v4, v20, v22
    v_cmp_eq_u32 vcc, -1, v4
    s_cbranch_vccz .W_84
.A_83:
    s_mov_b64 exec, vcc
    buffer_load_dwordx4 v[20:23], v8, s[8:11], s29 offen offset:0 sc1
    s_mov_b64 exec, -1
    s_waitcnt vmcnt(2)
    v_max_u32 v4, v24, v26
    v_cmp_eq_u32 vcc, -1, v4
    s_cbranch_vccz .W_102
.A_103:
    s_mov_b64 exec, vcc
    buffer_load_dwordx4 v[24:27], v8, s[8:11], s29 offen offset:1024 sc1
    s_mov_b64 exec, -1
    s_waitcnt vmcnt(2)
    v_max_u32 v4, v28, v30
    v_cmp_eq_u32 vcc, -1, v4
    s_cbranch_vccnz .A_101
.W_104:
    v_smfmac_f32_16x16x64_bf16 v[52:55], v[28:31], a[16:23], v9
    s_waitcnt vmcnt(1)
    v_max_u32 v4, v20, v22
    v_cmp_eq_u32 vcc, -1, v4
    v_smfmac_f32_16x16x64_bf16 v[56:59], v[28:31], a[48:55], v9
    v_smfmac_f32_16x16x64_bf16 v[60:63], v[28:31], a[80:87], v9
    v_smfmac_f32_16x16x64_bf16 v[64:67], v[28:31], a[112:119], v9
    s_cbranch_vccz .W_98
    s_branch .A_97
.W_102:
    v_smfmac_f32_16x16x64_bf16 v[52:55], v[24:27], a[8:15], v9
    s_waitcnt vmcnt(1)
    v_max_u32 v4, v28, v30
    v_cmp_eq_u32 vcc, -1, v4
    v_smfmac_f32_16x16x64_bf16 v[56:59], v[24:27], a[40:47], v9
    v_smfmac_f32_16x16x64_bf16 v[60:63], v[24:27], a[72:79], v9
    v_smfmac_f32_16x16x64_bf16 v[64:67], v[24:27], a[104:111], v9
    s_cbranch_vccnz .A_105
.W_106:
    v_smfmac_f32_16x16x64_bf16 v[52:55], v[28:31], a[16:23], v9
    s_waitcnt vmcnt(0)
    v_max_u32 v4, v20, v22
    v_cmp_eq_u32 vcc, -1, v4
    v_smfmac_f32_16x16x64_bf16 v[56:59], v[28:31], a[48:55], v9
    v_smfmac_f32_16x16x64_bf16 v[60:63], v[28:31], a[80:87], v9
    v_smfmac_f32_16x16x64_bf16 v[64:67], v[28:31], a[112:119], v9
    s_cbranch_vccz .W_94
    s_branch .A_93
.A_107:
    s_mov_b64 exec, vcc
    buffer_load_dwordx4 v[24:27], v8, s[8:11], s29 offen offset:1024 sc1
    s_mov_b64 exec, -1
    s_sub_u32 s62, s62, 1
    s_cbranch_scc1 .mg_end_1
    s_waitcnt vmcnt(2)
    v_max_u32 v4, v32, v34
    v_cmp_eq_u32 vcc, -1, v4
    s_cbranch_vccz .W_96
.A_95:
    s_mov_b64 exec, vcc
    buffer_load_dwordx4 v[32:35], v8, s[8:11], s29 offen offset:3072 sc1
    s_mov_b64 exec, -1
    s_waitcnt vmcnt(2)
    v_max_u32 v4, v20, v22
    v_cmp_eq_u32 vcc, -1, v4
    s_cbranch_vccz .W_108
.A_109:
    s_mov_b64 exec, vcc
    buffer_load_dwordx4 v[20:23], v8, s[8:11], s29 offen offset:0 sc1
    s_mov_b64 exec, -1
    s_waitcnt vmcnt(2)
    v_max_u32 v4, v24, v26
    v_cmp_eq_u32 vcc, -1, v4
    s_cbranch_vccnz .A_107
.W_110:
    v_smfmac_f32_16x16x64_bf16 v[52:55], v[24:27], a[8:15], v9
    s_waitcnt vmcnt(1)
    v_max_u32 v4, v32, v34
    v_cmp_eq_u32 vcc, -1, v4
    v_smfmac_f32_16x16x64_bf16 v[56:59], v[24:27], a[40:47], v9
    v_smfmac_f32_16x16x64_bf16 v[60:63], v[24:27], a[72:79], v9
    v_smfmac_f32_16x16x64_bf16 v[64:67], v[24:27], a[104:111], v9
    s_cbranch_vccz .W_92
    s_branch .A_91
.W_108:
    v_smfmac_f32_16x16x64_bf16 v[52:55], v[20:23], a[0:7], v9
    s_waitcnt vmcnt(1)
    v_max_u32 v4, v24, v26
    v_cmp_eq_u32 vcc, -1, v4
    v_smfmac_f32_16x16x64_bf16 v[56:59], v[20:23], a[32:39], v9
    v_smfmac_f32_16x16x64_bf16 v[60:63], v[20:23], a[64:71], v9
    v_smfmac_f32_16x16x64_bf16 v[64:67], v[20:23], a[96:103], v9
    s_cbranch_vccnz .A_111
.W_112:
    v_smfmac_f32_16x16x64_bf16 v[52:55], v[24:27], a[8:15], v9
    s_waitcnt vmcnt(0)
    v_max_u32 v4, v32, v34
    v_cmp_eq_u32 vcc, -1, v4
    v_smfmac_f32_16x16x64_bf16 v[56:59], v[24:27], a[40:47], v9
    v_smfmac_f32_16x16x64_bf16 v[60:63], v[24:27], a[72:79], v9
    v_smfmac_f32_16x16x64_bf16 v[64:67], v[24:27], a[104:111], v9
    s_cbranch_vccz .W_49
    s_branch .A_48
.A_113:
    s_mov_b64 exec, vcc
    buffer_load_dwordx4 v[32:35], v8, s[8:11], s29 offen offset:3072 sc1
    s_mov_b64 exec, -1
    s_sub_u32 s62, s62, 1
    s_cbranch_scc1 .mg_end_1
    s_waitcnt vmcnt(2)
    v_max_u32 v4, v20, v22
    v_cmp_eq_u32 vcc, -1, v4
    s_cbranch_vccz .W_114
.A_115:
    s_mov_b64 exec, vcc
    buffer_load_dwordx4 v[20:23], v8, s[8:11], s29 offen offset:0 sc1
    s_mov_b64 exec, -1
    s_waitcnt vmcnt(2)
    v_max_u32 v4, v28, v30
    v_cmp_eq_u32 vcc, -1, v4
    s_cbranch_vccz .W_90
.A_89:
    s_mov_b64 exec, vcc
    buffer_load_dwordx4 v[28:31], v8, s[8:11], s29 offen offset:2048 sc1
    s_mov_b64 exec, -1
    s_waitcnt vmcnt(2)
    v_max_u32 v4, v32, v34
    v_cmp_eq_u32 vcc, -1, v4
    s_cbranch_vccnz .A_113
.W_116:
    v_smfmac_f32_16x16x64_bf16 v[52:55], v[32:35], a[24:31], v9
    s_waitcnt vmcnt(1)
    v_max_u32 v4, v20, v22
    v_cmp_eq_u32 vcc, -1, v4
    v_smfmac_f32_16x16x64_bf16 v[56:59], v[32:35], a[56:63], v9
    v_smfmac_f32_16x16x64_bf16 v[60:63], v[32:35], a[88:95], v9
    v_smfmac_f32_16x16x64_bf16 v[64:67], v[32:35], a[120:127], v9
    s_cbranch_vccnz .A_117
.W_118:
    v_smfmac_f32_16x16x64_bf16 v[52:55], v[20:23], a[0:7], v9
    s_waitcnt vmcnt(0)
    v_max_u32 v4, v28, v30
    v_cmp_eq_u32 vcc, -1, v4
    v_smfmac_f32_16x16x64_bf16 v[56:59], v[20:23], a[32:39], v9
    v_smfmac_f32_16x16x64_bf16 v[60:63], v[20:23], a[64:71], v9
    v_smfmac_f32_16x16x64_bf16 v[64:67], v[20:23], a[96:103], v9
    s_cbranch_vccz .W_88
    s_branch .A_87
.W_114:
    v_smfmac_f32_16x16x64_bf16 v[52:55], v[20:23], a[0:7], v9
    s_waitcnt vmcnt(1)
    v_max_u32 v4, v28, v30
    v_cmp_eq_u32 vcc, -1, v4
    v_smfmac_f32_16x16x64_bf16 v[56:59], v[20:23], a[32:39], v9
    v_smfmac_f32_16x16x64_bf16 v[60:63], v[20:23], a[64:71], v9
    v_smfmac_f32_16x16x64_bf16 v[64:67], v[20:23], a[96:103], v9
    s_cbranch_vccz .W_47
    s_branch .A_46
.A_119:
    s_mov_b64 exec, vcc
    buffer_load_dwordx4 v[32:35], v8, s[8:11], s29 offen offset:3072 sc1
    s_mov_b64 exec, -1
    s_sub_u32 s62, s62, 1
    s_cbranch_scc1 .mg_end_1
    s_waitcnt vmcnt(2)
    v_max_u32 v4, v24, v26
    v_cmp_eq_u32 vcc, -1, v4
    s_cbranch_vccz .W_45
.A_44:
    s_mov_b64 exec, vcc
    buffer_load_dwordx4 v[24:27], v8, s[8:11], s29 offen offset:1024 sc1
    s_mov_b64 exec, -1
    s_waitcnt vmcnt(2)
    v_max_u32 v4, v28, v30
    v_cmp_eq_u32 vcc, -1, v4
    s_cbranch_vccz .W_120
.A_121:
    s_mov_b64 exec, vcc
    buffer_load_dwordx4 v[28:31], v8, s[8:11], s29 offen offset:2048 sc1
    s_mov_b64 exec, -1
    s_waitcnt vmcnt(2)
    v_max_u32 v4, v32, v34
    v_cmp_eq_u32 vcc, -1, v4
    s_cbranch_vccnz .A_119
.W_122:
    v_smfmac_f32_16x16x64_bf16 v[52:55], v[32:35], a[24:31], v9
    s_waitcnt vmcnt(1)
    v_max_u32 v4, v24, v26
    v_cmp_eq_u32 vcc, -1, v4
    v_smfmac_f32_16x16x64_bf16 v[56:59], v[32:35], a[56:63], v9
    v_smfmac_f32_16x16x64_bf16 v[60:63], v[32:35], a[88:95], v9
    v_smfmac_f32_16x16x64_bf16 v[64:67], v[32:35], a[120:127], v9
    s_cbranch_vccz .W_86
    s_branch .A_85
.W_120:
    v_smfmac_f32_16x16x64_bf16 v[52:55], v[28:31], a[16:23], v9
    s_waitcnt vmcnt(1)
    v_max_u32 v4, v32, v34
    v_cmp_eq_u32 vcc, -1, v4
    v_smfmac_f32_16x16x64_bf16 v[56:59], v[28:31], a[48:55], v9
    v_smfmac_f32_16x16x64_bf16 v[60:63], v[28:31], a[80:87], v9
    v_smfmac_f32_16x16x64_bf16 v[64:67], v[28:31], a[112:119], v9
    s_cbranch_vccnz .A_123
.W_124:
    v_smfmac_f32_16x16x64_bf16 v[52:55], v[32:35], a[24:31], v9
    s_waitcnt vmcnt(0)
    v_max_u32 v4, v24, v26
    v_cmp_eq_u32 vcc, -1, v4
    v_smfmac_f32_16x16x64_bf16 v[56:59], v[32:35], a[56:63], v9
    v_smfmac_f32_16x16x64_bf16 v[60:63], v[32:35], a[88:95], v9
    v_smfmac_f32_16x16x64_bf16 v[64:67], v[32:35], a[120:127], v9
    s_cbranch_vccz .W_100
    s_branch .A_99
.A_125:
    s_mov_b64 exec, vcc
    buffer_load_dwordx4 v[24:27], v8, s[8:11], s29 offen offset:1024 sc1
    s_mov_b64 exec, -1
    s_sub_u32 s62, s62, 1
    s_cbranch_scc1 .mg_end_1
    s_waitcnt vmcnt(1)
    v_max_u32 v4, v20, v22
    v_cmp_eq_u32 vcc, -1, v4
    s_cbranch_vccz .W_98
.A_97:
    s_mov_b64 exec, vcc
    buffer_load_dwordx4 v[20:23], v8, s[8:11], s29 offen offset:0 sc1
    s_mov_b64 exec, -1
    s_waitcnt vmcnt(1)
    v_max_u32 v4, v24, v26
    v_cmp_eq_u32 vcc, -1, v4
    s_cbranch_vccnz .A_125
.W_126:
    v_smfmac_f32_16x16x64_bf16 v[52:55], v[24:27], a[8:15], v9
    s_waitcnt vmcnt(0)
    v_max_u32 v4, v20, v22
    v_cmp_eq_u32 vcc, -1, v4
    v_smfmac_f32_16x16x64_bf16 v[56:59], v[24:27], a[40:47], v9
    v_smfmac_f32_16x16x64_bf16 v[60:63], v[24:27], a[72:79], v9
    v_smfmac_f32_16x16x64_bf16 v[64:67], v[24:27], a[104:111], v9
    s_cbranch_vccz .W_94
    s_branch .A_93
.A_105:
    s_mov_b64 exec, vcc
    buffer_load_dwordx4 v[28:31], v8, s[8:11], s29 offen offset:2048 sc1
    s_mov_b64 exec, -1
    s_sub_u32 s62, s62, 1
    s_cbranch_scc1 .mg_end_1
    s_waitcnt vmcnt(1)
    v_max_u32 v4, v20, v22
    v_cmp_eq_u32 vcc, -1, v4
    s_cbranch_vccz .W_118
.A_117:
    s_mov_b64 exec, vcc
    buffer_load_dwordx4 v[20:23], v8, s[8:11], s29 offen offset:0 sc1
    s_mov_b64 exec, -1
    s_waitcnt vmcnt(1)
    v_max_u32 v4, v28, v30
    v_cmp_eq_u32 vcc, -1, v4
    s_cbranch_vccnz .A_105
    s_branch .W_106
.A_127:
    s_mov_b64 exec, vcc
    buffer_load_dwordx4 v[20:23], v8, s[8:11], s29 offen offset:0 sc1
    s_mov_b64 exec, -1
    s_sub_u32 s62, s62, 1
    s_cbranch_scc1 .mg_end_1
    s_waitcnt vmcnt(1)
    v_max_u32 v4, v32, v34
    v_cmp_eq_u32 vcc, -1, v4
    s_cbranch_vccz .W_92
.A_91:
    s_mov_b64 exec, vcc
    buffer_load_dwordx4 v[32:35], v8, s[8:11], s29 offen offset:3072 sc1
    s_mov_b64 exec, -1
    s_waitcnt vmcnt(1)
    v_max_u32 v4, v20, v22
    v_cmp_eq_u32 vcc, -1, v4
    s_cbranch_vccnz .A_127
.W_128:
    v_smfmac_f32_16x16x64_bf16 v[52:55], v[20:23], a[0:7], v9
    s_waitcnt vmcnt(0)
    v_max_u32 v4, v32, v34
    v_cmp_eq_u32 vcc, -1, v4
    v_smfmac_f32_16x16x64_bf16 v[56:59], v[20:23], a[32:39], v9
    v_smfmac_f32_16x16x64_bf16 v[60:63], v[20:23], a[64:71], v9
    v_smfmac_f32_16x16x64_bf16 v[64:67], v[20:23], a[96:103], v9
    s_cbranch_vccz .W_49
    s_branch .A_48
.A_129:
    s_mov_b64 exec, vcc
    buffer_load_dwordx4 v[28:31], v8, s[8:11], s29 offen offset:2048 sc1
    s_mov_b64 exec, -1
    s_sub_u32 s62, s62, 1
    s_cbranch_scc1 .mg_end_1
    s_waitcnt vmcnt(1)
    v_max_u32 v4, v24, v26
    v_cmp_eq_u32 vcc, -1, v4
    s_cbranch_vccz .W_86
.A_85:
    s_mov_b64 exec, vcc
    buffer_load_dwordx4 v[24:27], v8, s[8:11], s29 offen offset:1024 sc1
    s_mov_b64 exec, -1
    s_waitcnt vmcnt(1)
    v_max_u32 v4, v28, v30
    v_cmp_eq_u32 vcc, -1, v4
    s_cbranch_vccnz .A_129
.W_130:
    v_smfmac_f32_16x16x64_bf16 v[52:55], v[28:31], a[16:23], v9
    s_waitcnt vmcnt(0)
    v_max_u32 v4, v24, v26
    v_cmp_eq_u32 vcc, -1, v4
    v_smfmac_f32_16x16x64_bf16 v[56:59], v[28:31], a[48:55], v9
    v_smfmac_f32_16x16x64_bf16 v[60:63], v[28:31], a[80:87], v9
    v_smfmac_f32_16x16x64_bf16 v[64:67], v[28:31], a[112:119], v9
    s_cbranch_vccz .W_100
    s_branch .A_99
.A_123:
    s_mov_b64 exec, vcc
    buffer_load_dwordx4 v[32:35], v8, s[8:11], s29 offen offset:3072 sc1
    s_mov_b64 exec, -1
    s_sub_u32 s62, s62, 1
    s_cbranch_scc1 .mg_end_1
    s_waitcnt vmcnt(1)
    v_max_u32 v4, v24, v26
    v_cmp_eq_u32 vcc, -1, v4
    s_cbranch_vccz .W_112
.A_111:
    s_mov_b64 exec, vcc
    buffer_load_dwordx4 v[24:27], v8, s[8:11], s29 offen offset:1024 sc1
    s_mov_b64 exec, -1
    s_waitcnt vmcnt(1)
    v_max_u32 v4, v32, v34
    v_cmp_eq_u32 vcc, -1, v4
    s_cbranch_vccnz .A_123
    s_branch .W_124
.A_131:
    s_mov_b64 exec, vcc
    buffer_load_dwordx4 v[32:35], v8, s[8:11], s29 offen offset:3072 sc1
    s_mov_b64 exec, -1
    s_sub_u32 s62, s62, 1
    s_cbranch_scc1 .mg_end_1
    s_waitcnt vmcnt(1)
    v_max_u32 v4, v28, v30
    v_cmp_eq_u32 vcc, -1, v4
    s_cbranch_vccz .W_47
.A_46:
    s_mov_b64 exec, vcc
    buffer_load_dwordx4 v[28:31], v8, s[8:11], s29 offen offset:2048 sc1
    s_mov_b64 exec, -1
    s_waitcnt vmcnt(1)
    v_max_u32 v4, v32, v34
    v_cmp_eq_u32 vcc, -1, v4
    s_cbranch_vccnz .A_131
.W_132:
    v_smfmac_f32_16x16x64_bf16 v[52:55], v[32:35], a[24:31], v9
    s_waitcnt vmcnt(0)
    v_max_u32 v4, v28, v30
    v_cmp_eq_u32 vcc, -1, v4
    v_smfmac_f32_16x16x64_bf16 v[56:59], v[32:35], a[56:63], v9
    v_smfmac_f32_16x16x64_bf16 v[60:63], v[32:35], a[88:95], v9
    v_smfmac_f32_16x16x64_bf16 v[64:67], v[32:35], a[120:127], v9
    s_cbranch_vccz .W_88
    s_branch .A_87
.A_93:
    s_mov_b64 exec, vcc
    buffer_load_dwordx4 v[20:23], v8, s[8:11], s29 offen offset:0 sc1
    s_mov_b64 exec, -1
    s_sub_u32 s62, s62, 1
    s_cbranch_scc1 .mg_end_1
    s_waitcnt vmcnt(1)
    v_max3_u32 v4, v20, v21, v22
    v_max_u32 v4, v4, v23
    v_cmp_eq_u32 vcc, -1, v4
    s_cbranch_vccnz .A_93
    v_smfmac_f32_16x16x64_bf16 v[52:55], v[20:23], a[0:7], v9
    v_smfmac_f32_16x16x64_bf16 v[56:59], v[20:23], a[32:39], v9
    v_smfmac_f32_16x16x64_bf16 v[60:63], v[20:23], a[64:71], v9
    s_nop 0
    v_cvt_pk_bf16_f32 v104, v52, v53
    v_cvt_pk_bf16_f32 v105, v54, v55
    v_smfmac_f32_16x16x64_bf16 v[64:67], v[20:23], a[96:103], v9
    s_branch .mj_41
.A_99:
    s_mov_b64 exec, vcc
    buffer_load_dwordx4 v[24:27], v8, s[8:11], s29 offen offset:1024 sc1
    s_mov_b64 exec, -1
    s_sub_u32 s62, s62, 1
    s_cbranch_scc1 .mg_end_1
    s_waitcnt vmcnt(1)
    v_max3_u32 v4, v24, v25, v26
    v_max_u32 v4, v4, v27
    v_cmp_eq_u32 vcc, -1, v4
    s_cbranch_vccnz .A_99
    v_smfmac_f32_16x16x64_bf16 v[52:55], v[24:27], a[8:15], v9
    v_smfmac_f32_16x16x64_bf16 v[56:59], v[24:27], a[40:47], v9
    v_smfmac_f32_16x16x64_bf16 v[60:63], v[24:27], a[72:79], v9
    s_nop 0
    v_cvt_pk_bf16_f32 v104, v52, v53
    v_cvt_pk_bf16_f32 v105, v54, v55
    v_smfmac_f32_16x16x64_bf16 v[64:67], v[24:27], a[104:111], v9
    s_branch .mj_41
.A_87:
    s_mov_b64 exec, vcc
    buffer_load_dwordx4 v[28:31], v8, s[8:11], s29 offen offset:2048 sc1
    s_mov_b64 exec, -1
    s_sub_u32 s62, s62, 1
    s_cbranch_scc1 .mg_end_1
    s_waitcnt vmcnt(1)
    v_max3_u32 v4, v28, v29, v30
    v_max_u32 v4, v4, v31
    v_cmp_eq_u32 vcc, -1, v4
    s_cbranch_vccnz .A_87
    v_smfmac_f32_16x16x64_bf16 v[52:55], v[28:31], a[16:23], v9
    v_smfmac_f32_16x16x64_bf16 v[56:59], v[28:31], a[48:55], v9
    v_smfmac_f32_16x16x64_bf16 v[60:63], v[28:31], a[80:87], v9
    s_nop 0
    v_cvt_pk_bf16_f32 v104, v52, v53
    v_cvt_pk_bf16_f32 v105, v54, v55
    v_smfmac_f32_16x16x64_bf16 v[64:67], v[28:31], a[112:119], v9
    s_branch .mj_41
.A_48:
    s_mov_b64 exec, vcc
    buffer_load_dwordx4 v[32:35], v8, s[8:11], s29 offen offset:3072 sc1
    s_mov_b64 exec, -1
    s_sub_u32 s62, s62, 1
    s_cbranch_scc1 .mg_end_1
    s_waitcnt vmcnt(1)
    v_max3_u32 v4, v32, v33, v34
    v_max_u32 v4, v4, v35
    v_cmp_eq_u32 vcc, -1, v4
    s_cbranch_vccnz .A_48
    v_smfmac_f32_16x16x64_bf16 v[52:55], v[32:35], a[24:31], v9
    v_smfmac_f32_16x16x64_bf16 v[56:59], v[32:35], a[56:63], v9
    v_smfmac_f32_16x16x64_bf16 v[60:63], v[32:35], a[88:95], v9
    s_nop 0
    v_cvt_pk_bf16_f32 v104, v52, v53
    v_cvt_pk_bf16_f32 v105, v54, v55
    v_smfmac_f32_16x16x64_bf16 v[64:67], v[32:35], a[120:127], v9
    s_branch .mj_41
.A_133:
    buffer_load_dwordx4 v[100:103], v234, s[8:11], s29 offen sc1
    s_sub_u32 s62, s62, 1
    s_cbranch_scc1 .mg_end_1
    s_waitcnt vmcnt(2)
    v_max_u32 v4, v92, v94
    v_cmp_eq_u32 vcc, -1, v4
    s_cbranch_vccz .W_52
.A_51:
    buffer_load_dwordx4 v[92:95], v232, s[8:11], s29 offen sc1
    s_waitcnt vmcnt(2)
    v_max_u32 v4, v96, v98
    v_cmp_eq_u32 vcc, -1, v4
    s_cbranch_vccz .W_134
.A_135:
    buffer_load_dwordx4 v[96:99], v233, s[8:11], s29 offen sc1
    s_waitcnt vmcnt(2)
    v_max_u32 v4, v100, v102
    v_cmp_eq_u32 vcc, -1, v4
    s_cbranch_vccnz .A_133
.W_136:
    v_mfma_f32_16x16x32_bf16 v[208:211], v[140:143], v[100:103], v[208:211]
    s_waitcnt vmcnt(1)
    v_max_u32 v4, v92, v94
    v_cmp_eq_u32 vcc, -1, v4
    v_mfma_f32_16x16x32_bf16 v[212:215], v[156:159], v[100:103], v[212:215]
    v_mfma_f32_16x16x32_bf16 v[216:219], v[100:103], v[100:103], v[216:219]
    s_cbranch_vccnz .A_137
.W_138:
    v_mfma_f32_16x16x32_bf16 v[208:211], v[132:135], v[92:95], v[208:211]
    s_waitcnt vmcnt(0)
    v_max_u32 v4, v96, v98
    v_cmp_eq_u32 vcc, -1, v4
    v_mfma_f32_16x16x32_bf16 v[212:215], v[148:151], v[92:95], v[212:215]
    v_mfma_f32_16x16x32_bf16 v[216:219], v[92:95], v[92:95], v[216:219]
    s_cbranch_vccnz .A_139
.W_140:
    v_mfma_f32_16x16x32_bf16 v[208:211], v[136:139], v[96:99], v[208:211]
    s_barrier
    v_mfma_f32_16x16x32_bf16 v[212:215], v[152:155], v[96:99], v[212:215]
    v_mfma_f32_16x16x32_bf16 v[216:219], v[96:99], v[96:99], v[216:219]
    s_branch .mj_50
.W_134:
    v_mfma_f32_16x16x32_bf16 v[208:211], v[136:139], v[96:99], v[208:211]
    s_waitcnt vmcnt(1)
    v_max_u32 v4, v100, v102
    v_cmp_eq_u32 vcc, -1, v4
    v_mfma_f32_16x16x32_bf16 v[212:215], v[152:155], v[96:99], v[212:215]
    v_mfma_f32_16x16x32_bf16 v[216:219], v[96:99], v[96:99], v[216:219]
    s_cbranch_vccnz .A_141
.W_142:
    v_mfma_f32_16x16x32_bf16 v[208:211], v[140:143], v[100:103], v[208:211]
    s_waitcnt vmcnt(0)
    v_max_u32 v4, v92, v94
    v_cmp_eq_u32 vcc, -1, v4
    v_mfma_f32_16x16x32_bf16 v[212:215], v[156:159], v[100:103], v[212:215]
    v_mfma_f32_16x16x32_bf16 v[216:219], v[100:103], v[100:103], v[216:219]
    s_cbranch_vccnz .A_143
.W_144:
    v_mfma_f32_16x16x32_bf16 v[208:211], v[132:135], v[92:95], v[208:211]
    s_barrier
    v_mfma_f32_16x16x32_bf16 v[212:215], v[148:151], v[92:95], v[212:215]
    v_mfma_f32_16x16x32_bf16 v[216:219], v[92:95], v[92:95], v[216:219]
    s_branch .mj_50
.A_145:
    buffer_load_dwordx4 v[96:99], v233, s[8:11], s29 offen sc1
    s_sub_u32 s62, s62, 1
    s_cbranch_scc1 .mg_end_1
    s_waitcnt vmcnt(1)
    v_max_u32 v4, v92, v94
    v_cmp_eq_u32 vcc, -1, v4
    s_cbranch_vccz .W_138
.A_137:
    buffer_load_dwordx4 v[92:95], v232, s[8:11], s29 offen sc1
    s_waitcnt vmcnt(1)
    v_max_u32 v4, v96, v98
    v_cmp_eq_u32 vcc, -1, v4
    s_cbranch_vccnz .A_145
.W_146:
    v_mfma_f32_16x16x32_bf16 v[208:211], v[136:139], v[96:99], v[208:211]
    s_waitcnt vmcnt(0)
    v_max_u32 v4, v92, v94
    v_cmp_eq_u32 vcc, -1, v4
    v_mfma_f32_16x16x32_bf16 v[212:215], v[152:155], v[96:99], v[212:215]
    v_mfma_f32_16x16x32_bf16 v[216:219], v[96:99], v[96:99], v[216:219]
    s_cbranch_vccz .W_144
    s_branch .A_143
.A_147:
    buffer_load_dwordx4 v[92:95], v232, s[8:11], s29 offen sc1
    s_sub_u32 s62, s62, 1
    s_cbranch_scc1 .mg_end_1
    s_waitcnt vmcnt(1)
    v_max_u32 v4, v100, v102
    v_cmp_eq_u32 vcc, -1, v4
    s_cbranch_vccz .W_142
.A_141:
    buffer_load_dwordx4 v[100:103], v234, s[8:11], s29 offen sc1
    s_waitcnt vmcnt(1)
    v_max_u32 v4, v92, v94
    v_cmp_eq_u32 vcc, -1, v4
    s_cbranch_vccnz .A_147
.W_148:
    v_mfma_f32_16x16x32_bf16 v[208:211], v[132:135], v[92:95], v[208:211]
    s_waitcnt vmcnt(0)
    v_max_u32 v4, v100, v102
    v_cmp_eq_u32 vcc, -1, v4
    v_mfma_f32_16x16x32_bf16 v[212:215], v[148:151], v[92:95], v[212:215]
    v_mfma_f32_16x16x32_bf16 v[216:219], v[92:95], v[92:95], v[216:219]
    s_cbranch_vccz .W_56
    s_branch .A_55
.A_149:
    buffer_load_dwordx4 v[100:103], v234, s[8:11], s29 offen sc1
    s_sub_u32 s62, s62, 1
    s_cbranch_scc1 .mg_end_1
    s_waitcnt vmcnt(1)
    v_max_u32 v4, v96, v98
    v_cmp_eq_u32 vcc, -1, v4
    s_cbranch_vccz .W_54
.A_53:
    buffer_load_dwordx4 v[96:99], v233, s[8:11], s29 offen sc1
    s_waitcnt vmcnt(1)
    v_max_u32 v4, v100, v102
    v_cmp_eq_u32 vcc, -1, v4
    s_cbranch_vccnz .A_149
.W_150:
    v_mfma_f32_16x16x32_bf16 v[208:211], v[140:143], v[100:103], v[208:211]
    s_waitcnt vmcnt(0)
    v_max_u32 v4, v96, v98
    v_cmp_eq_u32 vcc, -1, v4
    v_mfma_f32_16x16x32_bf16 v[212:215], v[156:159], v[100:103], v[212:215]
    v_mfma_f32_16x16x32_bf16 v[216:219], v[100:103], v[100:103], v[216:219]
    s_cbranch_vccz .W_140
    s_branch .A_139
.A_143:
    buffer_load_dwordx4 v[92:95], v232, s[8:11], s29 offen sc1
    s_sub_u32 s62, s62, 1
    s_cbranch_scc1 .mg_end_1
    s_waitcnt vmcnt(1)
    v_max3_u32 v4, v92, v93, v94
    v_max_u32 v4, v4, v95
    v_cmp_eq_u32 vcc, -1, v4
    s_cbranch_vccnz .A_143
    v_mfma_f32_16x16x32_bf16 v[208:211], v[132:135], v[92:95], v[208:211]
    s_barrier
    v_mfma_f32_16x16x32_bf16 v[212:215], v[148:151], v[92:95], v[212:215]
    v_mfma_f32_16x16x32_bf16 v[216:219], v[92:95], v[92:95], v[216:219]
    s_branch .mj_50
.A_139:
    buffer_load_dwordx4 v[96:99], v233, s[8:11], s29 offen sc1
    s_sub_u32 s62, s62, 1
    s_cbranch_scc1 .mg_end_1
    s_waitcnt vmcnt(1)
    v_max3_u32 v4, v96, v97, v98
    v_max_u32 v4, v4, v99
    v_cmp_eq_u32 vcc, -1, v4
    s_cbranch_vccnz .A_139
    v_mfma_f32_16x16x32_bf16 v[208:211], v[136:139], v[96:99], v[208:211]
    s_barrier
    v_mfma_f32_16x16x32_bf16 v[212:215], v[152:155], v[96:99], v[212:215]
    v_mfma_f32_16x16x32_bf16 v[216:219], v[96:99], v[96:99], v[216:219]
    s_branch .mj_50
.A_55:
    buffer_load_dwordx4 v[100:103], v234, s[8:11], s29 offen sc1
    s_sub_u32 s62, s62, 1
    s_cbranch_scc1 .mg_end_1
    s_waitcnt vmcnt(1)
    v_max3_u32 v4, v100, v101, v102
    v_max_u32 v4, v4, v103
    v_cmp_eq_u32 vcc, -1, v4
    s_cbranch_vccnz .A_55
    v_mfma_f32_16x16x32_bf16 v[208:211], v[140:143], v[100:103], v[208:211]
    s_barrier
    v_mfma_f32_16x16x32_bf16 v[212:215], v[156:159], v[100:103], v[212:215]
    v_mfma_f32_16x16x32_bf16 v[216:219], v[100:103], v[100:103], v[216:219]
    s_branch .mj_50
.kf_63:
    s_mov_b32 s62, 0
    s_mov_b64 exec, 3
.wf_151:
    buffer_load_dword v244, v253, s[8:11], s89 offen sc1
    s_waitcnt vmcnt(0)
    v_cmp_gt_u32 vcc, s6, v244
    s_cbranch_vccz .wfd_152
    s_sleep 2
    s_add_u32 s62, s62, 1
    s_cmp_gt_u32 s62, 0x400000
    s_cbranch_scc1 .mg_end_1
    s_branch .wf_151

.wfd_152:
    s_mov_b64 exec, -1
    v_readlane_b32 s4, v244, 0
    v_readlane_b32 s93, v244, 1
    s_min_u32 s93, s93, s4
    s_mov_b32 s62, 0x1000000
    s_branch .kb_64
.A_153:
    buffer_load_dwordx4 v[216:219], v246, s[8:11], s32 offen offset:0 sc1
    buffer_load_dwordx4 v[220:223], v246, s[8:11], s32 offen offset:1024 sc1
    s_sub_u32 s62, s62, 1
    s_cbranch_scc1 .mg_end_1
    s_waitcnt vmcnt(6)
    v_max_u32 v4, v192, v196
    v_cmp_eq_u32 vcc, -1, v4
    s_cbranch_vccz .W_67
.A_66:
    buffer_load_dwordx4 v[192:195], v243, s[8:11], s32 offen offset:0 sc1
    buffer_load_dwordx4 v[196:199], v243, s[8:11], s32 offen offset:1024 sc1
    s_waitcnt vmcnt(6)
    v_max_u32 v4, v200, v204
    v_cmp_eq_u32 vcc, -1, v4
    s_cbranch_vccz .W_154
.A_155:
    buffer_load_dwordx4 v[200:203], v252, s[8:11], s32 offen offset:0 sc1
    buffer_load_dwordx4 v[204:207], v252, s[8:11], s32 offen offset:1024 sc1
    s_waitcnt vmcnt(6)
    v_max_u32 v4, v208, v212
    v_cmp_eq_u32 vcc, -1, v4
    s_cbranch_vccz .W_156
.A_157:
    buffer_load_dwordx4 v[208:211], v254, s[8:11], s32 offen offset:0 sc1
    buffer_load_dwordx4 v[212:215], v254, s[8:11], s32 offen offset:1024 sc1
    s_waitcnt vmcnt(6)
    v_max_u32 v4, v216, v220
    v_cmp_eq_u32 vcc, -1, v4
    s_cbranch_vccnz .A_153
.W_158:
    v_smfmac_f32_16x16x64_bf16 v[76:79], v[216:219], v[140:147], v9
    s_waitcnt vmcnt(4)
    v_max_u32 v4, v192, v196
    v_cmp_eq_u32 vcc, -1, v4
    v_smfmac_f32_16x16x64_bf16 v[80:83], v[216:219], v[172:179], v9
    v_smfmac_f32_16x16x64_bf16 v[76:79], v[220:223], v[148:155], v9
    v_smfmac_f32_16x16x64_bf16 v[80:83], v[220:223], v[180:187], v9
    s_cbranch_vccnz .A_159
.W_160:
    v_smfmac_f32_16x16x64_bf16 v[76:79], v[192:195], a[192:199], v9
    s_waitcnt vmcnt(2)
    v_max_u32 v4, v200, v204
    v_cmp_eq_u32 vcc, -1, v4
    v_smfmac_f32_16x16x64_bf16 v[80:83], v[192:195], a[224:231], v9
    v_smfmac_f32_16x16x64_bf16 v[76:79], v[196:199], a[200:207], v9
    v_smfmac_f32_16x16x64_bf16 v[80:83], v[196:199], a[232:239], v9
    s_cbranch_vccnz .A_161
.W_162:
    v_smfmac_f32_16x16x64_bf16 v[76:79], v[200:203], a[208:215], v9
    s_waitcnt vmcnt(0)
    v_max_u32 v4, v208, v212
    v_cmp_eq_u32 vcc, -1, v4
    v_smfmac_f32_16x16x64_bf16 v[80:83], v[200:203], a[240:247], v9
    v_smfmac_f32_16x16x64_bf16 v[76:79], v[204:207], a[216:223], v9
    v_smfmac_f32_16x16x64_bf16 v[80:83], v[204:207], a[248:255], v9
    s_cbranch_vccnz .A_163
.W_164:
    s_barrier
    v_smfmac_f32_16x16x64_bf16 v[76:79], v[208:211], v[124:131], v9
    v_smfmac_f32_16x16x64_bf16 v[80:83], v[208:211], v[156:163], v9
    v_smfmac_f32_16x16x64_bf16 v[76:79], v[212:215], v[132:139], v9
    v_smfmac_f32_16x16x64_bf16 v[80:83], v[212:215], v[164:171], v9
    s_branch .mj_65
.W_154:
    v_smfmac_f32_16x16x64_bf16 v[76:79], v[200:203], a[208:215], v9
    s_waitcnt vmcnt(4)
    v_max_u32 v4, v208, v212
    v_cmp_eq_u32 vcc, -1, v4
    v_smfmac_f32_16x16x64_bf16 v[80:83], v[200:203], a[240:247], v9
    v_smfmac_f32_16x16x64_bf16 v[76:79], v[204:207], a[216:223], v9
    v_smfmac_f32_16x16x64_bf16 v[80:83], v[204:207], a[248:255], v9
    s_cbranch_vccnz .A_165
.W_166:
    v_smfmac_f32_16x16x64_bf16 v[76:79], v[208:211], v[124:131], v9
    s_waitcnt vmcnt(2)
    v_max_u32 v4, v216, v220
    v_cmp_eq_u32 vcc, -1, v4
    v_smfmac_f32_16x16x64_bf16 v[80:83], v[208:211], v[156:163], v9
    v_smfmac_f32_16x16x64_bf16 v[76:79], v[212:215], v[132:139], v9
    v_smfmac_f32_16x16x64_bf16 v[80:83], v[212:215], v[164:171], v9
    s_cbranch_vccnz .A_167
.W_168:
    v_smfmac_f32_16x16x64_bf16 v[76:79], v[216:219], v[140:147], v9
    s_waitcnt vmcnt(0)
    v_max_u32 v4, v192, v196
    v_cmp_eq_u32 vcc, -1, v4
    v_smfmac_f32_16x16x64_bf16 v[80:83], v[216:219], v[172:179], v9
    v_smfmac_f32_16x16x64_bf16 v[76:79], v[220:223], v[148:155], v9
    v_smfmac_f32_16x16x64_bf16 v[80:83], v[220:223], v[180:187], v9
    s_cbranch_vccnz .A_169
.W_170:
    s_barrier
    v_smfmac_f32_16x16x64_bf16 v[76:79], v[192:195], a[192:199], v9
    v_smfmac_f32_16x16x64_bf16 v[80:83], v[192:195], a[224:231], v9
    v_smfmac_f32_16x16x64_bf16 v[76:79], v[196:199], a[200:207], v9
    v_smfmac_f32_16x16x64_bf16 v[80:83], v[196:199], a[232:239], v9
    s_branch .mj_65
.W_156:
    v_smfmac_f32_16x16x64_bf16 v[76:79], v[208:211], v[124:131], v9
    s_waitcnt vmcnt(4)
    v_max_u32 v4, v216, v220
    v_cmp_eq_u32 vcc, -1, v4
    v_smfmac_f32_16x16x64_bf16 v[80:83], v[208:211], v[156:163], v9
    v_smfmac_f32_16x16x64_bf16 v[76:79], v[212:215], v[132:139], v9
    v_smfmac_f32_16x16x64_bf16 v[80:83], v[212:215], v[164:171], v9
    s_cbranch_vccnz .A_171
.W_172:
    v_smfmac_f32_16x16x64_bf16 v[76:79], v[216:219], v[140:147], v9
    s_waitcnt vmcnt(2)
    v_max_u32 v4, v192, v196
    v_cmp_eq_u32 vcc, -1, v4
    v_smfmac_f32_16x16x64_bf16 v[80:83], v[216:219], v[172:179], v9
    v_smfmac_f32_16x16x64_bf16 v[76:79], v[220:223], v[148:155], v9
    v_smfmac_f32_16x16x64_bf16 v[80:83], v[220:223], v[180:187], v9
    s_cbranch_vccnz .A_173
.W_174:
    v_smfmac_f32_16x16x64_bf16 v[76:79], v[192:195], a[192:199], v9
    s_waitcnt vmcnt(0)
    v_max_u32 v4, v200, v204
    v_cmp_eq_u32 vcc, -1, v4
    v_smfmac_f32_16x16x64_bf16 v[80:83], v[192:195], a[224:231], v9
    v_smfmac_f32_16x16x64_bf16 v[76:79], v[196:199], a[200:207], v9
    v_smfmac_f32_16x16x64_bf16 v[80:83], v[196:199], a[232:239], v9
    s_cbranch_vccnz .A_175
.W_176:
    s_barrier
    v_smfmac_f32_16x16x64_bf16 v[76:79], v[200:203], a[208:215], v9
    v_smfmac_f32_16x16x64_bf16 v[80:83], v[200:203], a[240:247], v9
    v_smfmac_f32_16x16x64_bf16 v[76:79], v[204:207], a[216:223], v9
    v_smfmac_f32_16x16x64_bf16 v[80:83], v[204:207], a[248:255], v9
    s_branch .mj_65
.A_177:
    buffer_load_dwordx4 v[208:211], v254, s[8:11], s32 offen offset:0 sc1
    buffer_load_dwordx4 v[212:215], v254, s[8:11], s32 offen offset:1024 sc1
    s_sub_u32 s62, s62, 1
    s_cbranch_scc1 .mg_end_1
    s_waitcnt vmcnt(4)
    v_max_u32 v4, v192, v196
    v_cmp_eq_u32 vcc, -1, v4
    s_cbranch_vccz .W_160
.A_159:
    buffer_load_dwordx4 v[192:195], v243, s[8:11], s32 offen offset:0 sc1
    buffer_load_dwordx4 v[196:199], v243, s[8:11], s32 offen offset:1024 sc1
    s_waitcnt vmcnt(4)
    v_max_u32 v4, v200, v204
    v_cmp_eq_u32 vcc, -1, v4
    s_cbranch_vccz .W_178
.A_179:
    buffer_load_dwordx4 v[200:203], v252, s[8:11], s32 offen offset:0 sc1
    buffer_load_dwordx4 v[204:207], v252, s[8:11], s32 offen offset:1024 sc1
    s_waitcnt vmcnt(4)
    v_max_u32 v4, v208, v212
    v_cmp_eq_u32 vcc, -1, v4
    s_cbranch_vccnz .A_177
.W_180:
    v_smfmac_f32_16x16x64_bf16 v[76:79], v[208:211], v[124:131], v9
    s_waitcnt vmcnt(2)
    v_max_u32 v4, v192, v196
    v_cmp_eq_u32 vcc, -1, v4
    v_smfmac_f32_16x16x64_bf16 v[80:83], v[208:211], v[156:163], v9
    v_smfmac_f32_16x16x64_bf16 v[76:79], v[212:215], v[132:139], v9
    v_smfmac_f32_16x16x64_bf16 v[80:83], v[212:215], v[164:171], v9
    s_cbranch_vccz .W_174
    s_branch .A_173
.W_178:
    v_smfmac_f32_16x16x64_bf16 v[76:79], v[200:203], a[208:215], v9
    s_waitcnt vmcnt(2)
    v_max_u32 v4, v208, v212
    v_cmp_eq_u32 vcc, -1, v4
    v_smfmac_f32_16x16x64_bf16 v[80:83], v[200:203], a[240:247], v9
    v_smfmac_f32_16x16x64_bf16 v[76:79], v[204:207], a[216:223], v9
    v_smfmac_f32_16x16x64_bf16 v[80:83], v[204:207], a[248:255], v9
    s_cbranch_vccnz .A_181
.W_182:
    v_smfmac_f32_16x16x64_bf16 v[76:79], v[208:211], v[124:131], v9
    s_waitcnt vmcnt(0)
    v_max_u32 v4, v192, v196
    v_cmp_eq_u32 vcc, -1, v4
    v_smfmac_f32_16x16x64_bf16 v[80:83], v[208:211], v[156:163], v9
    v_smfmac_f32_16x16x64_bf16 v[76:79], v[212:215], v[132:139], v9
    v_smfmac_f32_16x16x64_bf16 v[80:83], v[212:215], v[164:171], v9
    s_cbranch_vccz .W_170
    s_branch .A_169
.A_183:
    buffer_load_dwordx4 v[200:203], v252, s[8:11], s32 offen offset:0 sc1
    buffer_load_dwordx4 v[204:207], v252, s[8:11], s32 offen offset:1024 sc1
    s_sub_u32 s62, s62, 1
    s_cbranch_scc1 .mg_end_1
    s_waitcnt vmcnt(4)
    v_max_u32 v4, v216, v220
    v_cmp_eq_u32 vcc, -1, v4
    s_cbranch_vccz .W_172
.A_171:
    buffer_load_dwordx4 v[216:219], v246, s[8:11], s32 offen offset:0 sc1
    buffer_load_dwordx4 v[220:223], v246, s[8:11], s32 offen offset:1024 sc1
    s_waitcnt vmcnt(4)
    v_max_u32 v4, v192, v196
    v_cmp_eq_u32 vcc, -1, v4
    s_cbranch_vccz .W_184
.A_185:
    buffer_load_dwordx4 v[192:195], v243, s[8:11], s32 offen offset:0 sc1
    buffer_load_dwordx4 v[196:199], v243, s[8:11], s32 offen offset:1024 sc1
    s_waitcnt vmcnt(4)
    v_max_u32 v4, v200, v204
    v_cmp_eq_u32 vcc, -1, v4
    s_cbranch_vccnz .A_183
.W_186:
    v_smfmac_f32_16x16x64_bf16 v[76:79], v[200:203], a[208:215], v9
    s_waitcnt vmcnt(2)
    v_max_u32 v4, v216, v220
    v_cmp_eq_u32 vcc, -1, v4
    v_smfmac_f32_16x16x64_bf16 v[80:83], v[200:203], a[240:247], v9
    v_smfmac_f32_16x16x64_bf16 v[76:79], v[204:207], a[216:223], v9
    v_smfmac_f32_16x16x64_bf16 v[80:83], v[204:207], a[248:255], v9
    s_cbranch_vccz .W_168
    s_branch .A_167
.W_184:
    v_smfmac_f32_16x16x64_bf16 v[76:79], v[192:195], a[192:199], v9
    s_waitcnt vmcnt(2)
    v_max_u32 v4, v200, v204
    v_cmp_eq_u32 vcc, -1, v4
    v_smfmac_f32_16x16x64_bf16 v[80:83], v[192:195], a[224:231], v9
    v_smfmac_f32_16x16x64_bf16 v[76:79], v[196:199], a[200:207], v9
    v_smfmac_f32_16x16x64_bf16 v[80:83], v[196:199], a[232:239], v9
    s_cbranch_vccnz .A_187
.W_188:
    v_smfmac_f32_16x16x64_bf16 v[76:79], v[200:203], a[208:215], v9
    s_waitcnt vmcnt(0)
    v_max_u32 v4, v216, v220
    v_cmp_eq_u32 vcc, -1, v4
    v_smfmac_f32_16x16x64_bf16 v[80:83], v[200:203], a[240:247], v9
    v_smfmac_f32_16x16x64_bf16 v[76:79], v[204:207], a[216:223], v9
    v_smfmac_f32_16x16x64_bf16 v[80:83], v[204:207], a[248:255], v9
    s_cbranch_vccz .W_73
    s_branch .A_72
.A_189:
    buffer_load_dwordx4 v[216:219], v246, s[8:11], s32 offen offset:0 sc1
    buffer_load_dwordx4 v[220:223], v246, s[8:11], s32 offen offset:1024 sc1
    s_sub_u32 s62, s62, 1
    s_cbranch_scc1 .mg_end_1
    s_waitcnt vmcnt(4)
    v_max_u32 v4, v192, v196
    v_cmp_eq_u32 vcc, -1, v4
    s_cbranch_vccz .W_190
.A_191:
    buffer_load_dwordx4 v[192:195], v243, s[8:11], s32 offen offset:0 sc1
    buffer_load_dwordx4 v[196:199], v243, s[8:11], s32 offen offset:1024 sc1
    s_waitcnt vmcnt(4)
    v_max_u32 v4, v208, v212
    v_cmp_eq_u32 vcc, -1, v4
    s_cbranch_vccz .W_166
.A_165:
    buffer_load_dwordx4 v[208:211], v254, s[8:11], s32 offen offset:0 sc1
    buffer_load_dwordx4 v[212:215], v254, s[8:11], s32 offen offset:1024 sc1
    s_waitcnt vmcnt(4)
    v_max_u32 v4, v216, v220
    v_cmp_eq_u32 vcc, -1, v4
    s_cbranch_vccnz .A_189
.W_192:
    v_smfmac_f32_16x16x64_bf16 v[76:79], v[216:219], v[140:147], v9
    s_waitcnt vmcnt(2)
    v_max_u32 v4, v192, v196
    v_cmp_eq_u32 vcc, -1, v4
    v_smfmac_f32_16x16x64_bf16 v[80:83], v[216:219], v[172:179], v9
    v_smfmac_f32_16x16x64_bf16 v[76:79], v[220:223], v[148:155], v9
    v_smfmac_f32_16x16x64_bf16 v[80:83], v[220:223], v[180:187], v9
    s_cbranch_vccnz .A_193
.W_194:
    v_smfmac_f32_16x16x64_bf16 v[76:79], v[192:195], a[192:199], v9
    s_waitcnt vmcnt(0)
    v_max_u32 v4, v208, v212
    v_cmp_eq_u32 vcc, -1, v4
    v_smfmac_f32_16x16x64_bf16 v[80:83], v[192:195], a[224:231], v9
    v_smfmac_f32_16x16x64_bf16 v[76:79], v[196:199], a[200:207], v9
    v_smfmac_f32_16x16x64_bf16 v[80:83], v[196:199], a[232:239], v9
    s_cbranch_vccz .W_164
    s_branch .A_163
.W_190:
    v_smfmac_f32_16x16x64_bf16 v[76:79], v[192:195], a[192:199], v9
    s_waitcnt vmcnt(2)
    v_max_u32 v4, v208, v212
    v_cmp_eq_u32 vcc, -1, v4
    v_smfmac_f32_16x16x64_bf16 v[80:83], v[192:195], a[224:231], v9
    v_smfmac_f32_16x16x64_bf16 v[76:79], v[196:199], a[200:207], v9
    v_smfmac_f32_16x16x64_bf16 v[80:83], v[196:199], a[232:239], v9
    s_cbranch_vccz .W_71
    s_branch .A_70
.A_195:
    buffer_load_dwordx4 v[216:219], v246, s[8:11], s32 offen offset:0 sc1
    buffer_load_dwordx4 v[220:223], v246, s[8:11], s32 offen offset:1024 sc1
    s_sub_u32 s62, s62, 1
    s_cbranch_scc1 .mg_end_1
    s_waitcnt vmcnt(4)
    v_max_u32 v4, v200, v204
    v_cmp_eq_u32 vcc, -1, v4
    s_cbranch_vccz .W_69
.A_68:
    buffer_load_dwordx4 v[200:203], v252, s[8:11], s32 offen offset:0 sc1
    buffer_load_dwordx4 v[204:207], v252, s[8:11], s32 offen offset:1024 sc1
    s_waitcnt vmcnt(4)
    v_max_u32 v4, v208, v212
    v_cmp_eq_u32 vcc, -1, v4
    s_cbranch_vccz .W_196
.A_197:
    buffer_load_dwordx4 v[208:211], v254, s[8:11], s32 offen offset:0 sc1
    buffer_load_dwordx4 v[212:215], v254, s[8:11], s32 offen offset:1024 sc1
    s_waitcnt vmcnt(4)
    v_max_u32 v4, v216, v220
    v_cmp_eq_u32 vcc, -1, v4
    s_cbranch_vccnz .A_195
.W_198:
    v_smfmac_f32_16x16x64_bf16 v[76:79], v[216:219], v[140:147], v9
    s_waitcnt vmcnt(2)
    v_max_u32 v4, v200, v204
    v_cmp_eq_u32 vcc, -1, v4
    v_smfmac_f32_16x16x64_bf16 v[80:83], v[216:219], v[172:179], v9
    v_smfmac_f32_16x16x64_bf16 v[76:79], v[220:223], v[148:155], v9
    v_smfmac_f32_16x16x64_bf16 v[80:83], v[220:223], v[180:187], v9
    s_cbranch_vccz .W_162
    s_branch .A_161
.W_196:
    v_smfmac_f32_16x16x64_bf16 v[76:79], v[208:211], v[124:131], v9
    s_waitcnt vmcnt(2)
    v_max_u32 v4, v216, v220
    v_cmp_eq_u32 vcc, -1, v4
    v_smfmac_f32_16x16x64_bf16 v[80:83], v[208:211], v[156:163], v9
    v_smfmac_f32_16x16x64_bf16 v[76:79], v[212:215], v[132:139], v9
    v_smfmac_f32_16x16x64_bf16 v[80:83], v[212:215], v[164:171], v9
    s_cbranch_vccnz .A_199
.W_200:
    v_smfmac_f32_16x16x64_bf16 v[76:79], v[216:219], v[140:147], v9
    s_waitcnt vmcnt(0)
    v_max_u32 v4, v200, v204
    v_cmp_eq_u32 vcc, -1, v4
    v_smfmac_f32_16x16x64_bf16 v[80:83], v[216:219], v[172:179], v9
    v_smfmac_f32_16x16x64_bf16 v[76:79], v[220:223], v[148:155], v9
    v_smfmac_f32_16x16x64_bf16 v[80:83], v[220:223], v[180:187], v9
    s_cbranch_vccz .W_176
    s_branch .A_175
.A_201:
    buffer_load_dwordx4 v[200:203], v252, s[8:11], s32 offen offset:0 sc1
    buffer_load_dwordx4 v[204:207], v252, s[8:11], s32 offen offset:1024 sc1
    s_sub_u32 s62, s62, 1
    s_cbranch_scc1 .mg_end_1
    s_waitcnt vmcnt(2)
    v_max_u32 v4, v192, v196
    v_cmp_eq_u32 vcc, -1, v4
    s_cbranch_vccz .W_174
.A_173:
    buffer_load_dwordx4 v[192:195], v243, s[8:11], s32 offen offset:0 sc1
    buffer_load_dwordx4 v[196:199], v243, s[8:11], s32 offen offset:1024 sc1
    s_waitcnt vmcnt(2)
    v_max_u32 v4, v200, v204
    v_cmp_eq_u32 vcc, -1, v4
    s_cbranch_vccnz .A_201
.W_202:
    v_smfmac_f32_16x16x64_bf16 v[76:79], v[200:203], a[208:215], v9
    s_waitcnt vmcnt(0)
    v_max_u32 v4, v192, v196
    v_cmp_eq_u32 vcc, -1, v4
    v_smfmac_f32_16x16x64_bf16 v[80:83], v[200:203], a[240:247], v9
    v_smfmac_f32_16x16x64_bf16 v[76:79], v[204:207], a[216:223], v9
    v_smfmac_f32_16x16x64_bf16 v[80:83], v[204:207], a[248:255], v9
    s_cbranch_vccz .W_170
    s_branch .A_169
.A_181:
    buffer_load_dwordx4 v[208:211], v254, s[8:11], s32 offen offset:0 sc1
    buffer_load_dwordx4 v[212:215], v254, s[8:11], s32 offen offset:1024 sc1
    s_sub_u32 s62, s62, 1
    s_cbranch_scc1 .mg_end_1
    s_waitcnt vmcnt(2)
    v_max_u32 v4, v192, v196
    v_cmp_eq_u32 vcc, -1, v4
    s_cbranch_vccz .W_194
.A_193:
    buffer_load_dwordx4 v[192:195], v243, s[8:11], s32 offen offset:0 sc1
    buffer_load_dwordx4 v[196:199], v243, s[8:11], s32 offen offset:1024 sc1
    s_waitcnt vmcnt(2)
    v_max_u32 v4, v208, v212
    v_cmp_eq_u32 vcc, -1, v4
    s_cbranch_vccnz .A_181
    s_branch .W_182
.A_203:
    buffer_load_dwordx4 v[192:195], v243, s[8:11], s32 offen offset:0 sc1
    buffer_load_dwordx4 v[196:199], v243, s[8:11], s32 offen offset:1024 sc1
    s_sub_u32 s62, s62, 1
    s_cbranch_scc1 .mg_end_1
    s_waitcnt vmcnt(2)
    v_max_u32 v4, v216, v220
    v_cmp_eq_u32 vcc, -1, v4
    s_cbranch_vccz .W_168
.A_167:
    buffer_load_dwordx4 v[216:219], v246, s[8:11], s32 offen offset:0 sc1
    buffer_load_dwordx4 v[220:223], v246, s[8:11], s32 offen offset:1024 sc1
    s_waitcnt vmcnt(2)
    v_max_u32 v4, v192, v196
    v_cmp_eq_u32 vcc, -1, v4
    s_cbranch_vccnz .A_203
.W_204:
    v_smfmac_f32_16x16x64_bf16 v[76:79], v[192:195], a[192:199], v9
    s_waitcnt vmcnt(0)
    v_max_u32 v4, v216, v220
    v_cmp_eq_u32 vcc, -1, v4
    v_smfmac_f32_16x16x64_bf16 v[80:83], v[192:195], a[224:231], v9
    v_smfmac_f32_16x16x64_bf16 v[76:79], v[196:199], a[200:207], v9
    v_smfmac_f32_16x16x64_bf16 v[80:83], v[196:199], a[232:239], v9
    s_cbranch_vccz .W_73
    s_branch .A_72
.A_205:
    buffer_load_dwordx4 v[208:211], v254, s[8:11], s32 offen offset:0 sc1
    buffer_load_dwordx4 v[212:215], v254, s[8:11], s32 offen offset:1024 sc1
    s_sub_u32 s62, s62, 1
    s_cbranch_scc1 .mg_end_1
    s_waitcnt vmcnt(2)
    v_max_u32 v4, v200, v204
    v_cmp_eq_u32 vcc, -1, v4
    s_cbranch_vccz .W_162
.A_161:
    buffer_load_dwordx4 v[200:203], v252, s[8:11], s32 offen offset:0 sc1
    buffer_load_dwordx4 v[204:207], v252, s[8:11], s32 offen offset:1024 sc1
    s_waitcnt vmcnt(2)
    v_max_u32 v4, v208, v212
    v_cmp_eq_u32 vcc, -1, v4
    s_cbranch_vccnz .A_205
.W_206:
    v_smfmac_f32_16x16x64_bf16 v[76:79], v[208:211], v[124:131], v9
    s_waitcnt vmcnt(0)
    v_max_u32 v4, v200, v204
    v_cmp_eq_u32 vcc, -1, v4
    v_smfmac_f32_16x16x64_bf16 v[80:83], v[208:211], v[156:163], v9
    v_smfmac_f32_16x16x64_bf16 v[76:79], v[212:215], v[132:139], v9
    v_smfmac_f32_16x16x64_bf16 v[80:83], v[212:215], v[164:171], v9
    s_cbranch_vccz .W_176
    s_branch .A_175
.A_199:
    buffer_load_dwordx4 v[216:219], v246, s[8:11], s32 offen offset:0 sc1
    buffer_load_dwordx4 v[220:223], v246, s[8:11], s32 offen offset:1024 sc1
    s_sub_u32 s62, s62, 1
    s_cbranch_scc1 .mg_end_1
    s_waitcnt vmcnt(2)
    v_max_u32 v4, v200, v204
    v_cmp_eq_u32 vcc, -1, v4
    s_cbranch_vccz .W_188
.A_187:
    buffer_load_dwordx4 v[200:203], v252, s[8:11], s32 offen offset:0 sc1
    buffer_load_dwordx4 v[204:207], v252, s[8:11], s32 offen offset:1024 sc1
    s_waitcnt vmcnt(2)
    v_max_u32 v4, v216, v220
    v_cmp_eq_u32 vcc, -1, v4
    s_cbranch_vccnz .A_199
    s_branch .W_200
.A_207:
    buffer_load_dwordx4 v[216:219], v246, s[8:11], s32 offen offset:0 sc1
    buffer_load_dwordx4 v[220:223], v246, s[8:11], s32 offen offset:1024 sc1
    s_sub_u32 s62, s62, 1
    s_cbranch_scc1 .mg_end_1
    s_waitcnt vmcnt(2)
    v_max_u32 v4, v208, v212
    v_cmp_eq_u32 vcc, -1, v4
    s_cbranch_vccz .W_71
.A_70:
    buffer_load_dwordx4 v[208:211], v254, s[8:11], s32 offen offset:0 sc1
    buffer_load_dwordx4 v[212:215], v254, s[8:11], s32 offen offset:1024 sc1
    s_waitcnt vmcnt(2)
    v_max_u32 v4, v216, v220
    v_cmp_eq_u32 vcc, -1, v4
    s_cbranch_vccnz .A_207
.W_208:
    v_smfmac_f32_16x16x64_bf16 v[76:79], v[216:219], v[140:147], v9
    s_waitcnt vmcnt(0)
    v_max_u32 v4, v208, v212
    v_cmp_eq_u32 vcc, -1, v4
    v_smfmac_f32_16x16x64_bf16 v[80:83], v[216:219], v[172:179], v9
    v_smfmac_f32_16x16x64_bf16 v[76:79], v[220:223], v[148:155], v9
    v_smfmac_f32_16x16x64_bf16 v[80:83], v[220:223], v[180:187], v9
    s_cbranch_vccz .W_164
    s_branch .A_163
.A_169:
    buffer_load_dwordx4 v[192:195], v243, s[8:11], s32 offen offset:0 sc1
    buffer_load_dwordx4 v[196:199], v243, s[8:11], s32 offen offset:1024 sc1
    s_sub_u32 s62, s62, 1
    s_cbranch_scc1 .mg_end_1
    s_waitcnt vmcnt(2)
    v_max3_u32 v4, v192, v193, v194
    v_max3_u32 v5, v195, v196, v197
    v_max3_u32 v4, v4, v198, v199
    v_max_u32 v4, v4, v5
    v_cmp_eq_u32 vcc, -1, v4
    s_cbranch_vccnz .A_169
    s_barrier
    v_smfmac_f32_16x16x64_bf16 v[76:79], v[192:195], a[192:199], v9
    v_smfmac_f32_16x16x64_bf16 v[80:83], v[192:195], a[224:231], v9
    v_smfmac_f32_16x16x64_bf16 v[76:79], v[196:199], a[200:207], v9
    v_smfmac_f32_16x16x64_bf16 v[80:83], v[196:199], a[232:239], v9
    s_branch .mj_65
.A_175:
    buffer_load_dwordx4 v[200:203], v252, s[8:11], s32 offen offset:0 sc1
    buffer_load_dwordx4 v[204:207], v252, s[8:11], s32 offen offset:1024 sc1
    s_sub_u32 s62, s62, 1
    s_cbranch_scc1 .mg_end_1
    s_waitcnt vmcnt(2)
    v_max3_u32 v4, v200, v201, v202
    v_max3_u32 v5, v203, v204, v205
    v_max3_u32 v4, v4, v206, v207
    v_max_u32 v4, v4, v5
    v_cmp_eq_u32 vcc, -1, v4
    s_cbranch_vccnz .A_175
    s_barrier
    v_smfmac_f32_16x16x64_bf16 v[76:79], v[200:203], a[208:215], v9
    v_smfmac_f32_16x16x64_bf16 v[80:83], v[200:203], a[240:247], v9
    v_smfmac_f32_16x16x64_bf16 v[76:79], v[204:207], a[216:223], v9
    v_smfmac_f32_16x16x64_bf16 v[80:83], v[204:207], a[248:255], v9
    s_branch .mj_65
.A_163:
    buffer_load_dwordx4 v[208:211], v254, s[8:11], s32 offen offset:0 sc1
    buffer_load_dwordx4 v[212:215], v254, s[8:11], s32 offen offset:1024 sc1
    s_sub_u32 s62, s62, 1
    s_cbranch_scc1 .mg_end_1
    s_waitcnt vmcnt(2)
    v_max3_u32 v4, v208, v209, v210
    v_max3_u32 v5, v211, v212, v213
    v_max3_u32 v4, v4, v214, v215
    v_max_u32 v4, v4, v5
    v_cmp_eq_u32 vcc, -1, v4
    s_cbranch_vccnz .A_163
    s_barrier
    v_smfmac_f32_16x16x64_bf16 v[76:79], v[208:211], v[124:131], v9
    v_smfmac_f32_16x16x64_bf16 v[80:83], v[208:211], v[156:163], v9
    v_smfmac_f32_16x16x64_bf16 v[76:79], v[212:215], v[132:139], v9
    v_smfmac_f32_16x16x64_bf16 v[80:83], v[212:215], v[164:171], v9
    s_branch .mj_65
.A_72:
    buffer_load_dwordx4 v[216:219], v246, s[8:11], s32 offen offset:0 sc1
    buffer_load_dwordx4 v[220:223], v246, s[8:11], s32 offen offset:1024 sc1
    s_sub_u32 s62, s62, 1
    s_cbranch_scc1 .mg_end_1
    s_waitcnt vmcnt(2)
    v_max3_u32 v4, v216, v217, v218
    v_max3_u32 v5, v219, v220, v221
    v_max3_u32 v4, v4, v222, v223
    v_max_u32 v4, v4, v5
    v_cmp_eq_u32 vcc, -1, v4
    s_cbranch_vccnz .A_72
    s_barrier
    v_smfmac_f32_16x16x64_bf16 v[76:79], v[216:219], v[140:147], v9
    v_smfmac_f32_16x16x64_bf16 v[80:83], v[216:219], v[172:179], v9
    v_smfmac_f32_16x16x64_bf16 v[76:79], v[220:223], v[148:155], v9
    v_smfmac_f32_16x16x64_bf16 v[80:83], v[220:223], v[180:187], v9
    s_branch .mj_65
.sk_75:
    v_cndmask_b32 v172, v170, v168, s[60:61]
    v_cndmask_b32 v173, v171, v169, s[60:61]

    v_mov_b32 v174, v172
    v_mov_b32 v175, v173
    s_nop 0
    s_nop 0
    v_permlane16_swap_b32 v172, v174
    v_permlane16_swap_b32 v173, v175
    ds_write_b128 v14, v[172:175] offset:17408

    s_mov_b64 exec, s[66:67]
    buffer_store_dwordx4 v[88:91], v11, s[8:11], s36 offen sc1
    s_mov_b64 exec, s[56:57]
    buffer_store_dwordx4 v[172:175], v12, s[8:11], s36 offen sc1
    s_mov_b64 exec, -1

    s_cmp_lt_u32 s28, 63
    s_cbranch_scc1 .sb_76
    s_branch .rec_fin_6
.p2align 6
    s_endpgm
    s_endpgm
    s_endpgm
    s_endpgm
    s_endpgm
    s_endpgm
    s_endpgm
    s_endpgm
.top_209:
    s_barrier
.tp2_213:
    buffer_load_dwordx4 v[20:23], v8, s[8:11], s29 offen offset:0 sc1
    v_mov_b32 v52, 0
    buffer_load_dwordx4 v[24:27], v8, s[8:11], s29 offen offset:1024 sc1
    v_mov_b32 v53, 0
    buffer_load_dwordx4 v[28:31], v8, s[8:11], s29 offen offset:2048 sc1
    v_mov_b32 v54, 0
    buffer_load_dwordx4 v[32:35], v8, s[8:11], s29 offen offset:3072 sc1
.ent1_26:
    s_waitcnt vmcnt(3)
    v_max_u32 v4, v20, v22
    v_cmp_eq_u32 vcc, -1, v4
    s_cbranch_vccnz .A_215
.W_216:
    v_smfmac_f32_16x16x64_bf16 v[52:55], v[20:23], a[0:7], v9
    s_waitcnt vmcnt(2)
    v_max_u32 v4, v24, v26
    v_cmp_eq_u32 vcc, -1, v4
    v_smfmac_f32_16x16x64_bf16 v[56:59], v[20:23], a[32:39], v9
    v_smfmac_f32_16x16x64_bf16 v[60:63], v[20:23], a[64:71], v9
    v_smfmac_f32_16x16x64_bf16 v[64:67], v[20:23], a[96:103], v9
    s_cbranch_vccnz .A_217
.W_218:
    v_smfmac_f32_16x16x64_bf16 v[52:55], v[24:27], a[8:15], v9
    s_waitcnt vmcnt(1)
    v_max_u32 v4, v28, v30
    v_cmp_eq_u32 vcc, -1, v4
    v_smfmac_f32_16x16x64_bf16 v[56:59], v[24:27], a[40:47], v9
    v_smfmac_f32_16x16x64_bf16 v[60:63], v[24:27], a[72:79], v9
    v_smfmac_f32_16x16x64_bf16 v[64:67], v[24:27], a[104:111], v9
    s_cbranch_vccnz .A_219
.W_220:
    v_smfmac_f32_16x16x64_bf16 v[52:55], v[28:31], a[16:23], v9
    s_waitcnt vmcnt(0)
    v_max_u32 v4, v32, v34
    v_cmp_eq_u32 vcc, -1, v4
    v_smfmac_f32_16x16x64_bf16 v[56:59], v[28:31], a[48:55], v9
    v_smfmac_f32_16x16x64_bf16 v[60:63], v[28:31], a[80:87], v9
    v_smfmac_f32_16x16x64_bf16 v[64:67], v[28:31], a[112:119], v9
    s_cbranch_vccnz .A_221
.W_222:
    v_smfmac_f32_16x16x64_bf16 v[52:55], v[32:35], a[24:31], v9
    v_smfmac_f32_16x16x64_bf16 v[56:59], v[32:35], a[56:63], v9
    v_smfmac_f32_16x16x64_bf16 v[60:63], v[32:35], a[88:95], v9
    s_nop 0
    v_cvt_pk_bf16_f32 v104, v52, v53
    v_cvt_pk_bf16_f32 v105, v54, v55
    v_smfmac_f32_16x16x64_bf16 v[64:67], v[32:35], a[120:127], v9
.mj_214:
    ds_write_b64 v19, v[104:105] offset:4096
    v_cvt_pk_bf16_f32 v106, v56, v57
    v_cvt_pk_bf16_f32 v107, v58, v59
    ds_write_b64 v19, v[106:107] offset:6144
    v_cvt_pk_bf16_f32 v108, v60, v61
    v_cvt_pk_bf16_f32 v109, v62, v63
    ds_write_b64 v19, v[108:109] offset:0
    s_nop 0
    v_cvt_pk_bf16_f32 v110, v64, v65
    v_cvt_pk_bf16_f32 v111, v66, v67
    ds_write_b64 v19, v[110:111] offset:2048
    v_smfmac_f32_16x16x64_bf16 v[68:71], v[20:23], a[128:135], v9
    s_waitcnt lgkmcnt(0)
    s_barrier
    ds_read_b128 v[36:39], v17 offset:0
    ds_read_b128 v[40:43], v17 offset:1024
    v_smfmac_f32_16x16x64_bf16 v[72:75], v[20:23], a[160:167], v9
    v_smfmac_f32_16x16x64_bf16 v[68:71], v[24:27], a[136:143], v9
    s_waitcnt lgkmcnt(1)
    v_mfma_f32_16x16x32_bf16 v[44:47], v[36:39], v[84:87], 0
    s_waitcnt lgkmcnt(0)
    v_mfma_f32_16x16x32_bf16 v[44:47], v[40:43], v[84:87], v[44:47]
    v_smfmac_f32_16x16x64_bf16 v[72:75], v[24:27], a[168:175], v9
    v_smfmac_f32_16x16x64_bf16 v[68:71], v[28:31], a[144:151], v9
    s_mov_b64 exec, s[64:65]
    v_cvt_pk_bf16_f32 v48, v44, v45
    v_cvt_pk_bf16_f32 v49, v46, v47

    buffer_store_dwordx2 v[48:49], v10, s[8:11], s29 offen sc1

    ds_write_b64 v18, v[48:49]
    s_mov_b64 exec, -1

    v_smfmac_f32_16x16x64_bf16 v[72:75], v[28:31], a[176:183], v9
    v_smfmac_f32_16x16x64_bf16 v[68:71], v[32:35], a[152:159], v9
    v_smfmac_f32_16x16x64_bf16 v[72:75], v[32:35], a[184:191], v9
    s_nop 3
    v_cvt_pk_bf16_f32 v104, v68, v69
    v_cvt_pk_bf16_f32 v105, v70, v71
    ds_write_b64 v16, v[104:105] offset:8192
    s_nop 0
    v_cvt_pk_bf16_f32 v106, v72, v73
    v_cvt_pk_bf16_f32 v107, v74, v75
    ds_write_b64 v16, v[106:107] offset:10240
    s_cmp_lg_u32 s24, 2
    s_waitcnt lgkmcnt(0)
    s_barrier
    s_cbranch_scc1 .oth_210
    buffer_load_dwordx4 v[92:95], v232, s[8:11], s29 offen sc1
    buffer_load_dwordx4 v[96:99], v233, s[8:11], s29 offen sc1
    buffer_load_dwordx4 v[100:103], v234, s[8:11], s29 offen sc1
    ds_read_b128 v[88:91], v14 offset:16384
    s_cmp_eq_u32 s28, 63
    s_cbranch_scc1 .rec_fin_6
.en_33:
    s_waitcnt lgkmcnt(0)
    v_mfma_f32_16x16x32_bf16 v[208:211], v[128:131], v[88:91], 0
    v_mfma_f32_16x16x32_bf16 v[212:215], v[144:147], v[88:91], 0
    v_mfma_f32_16x16x32_bf16 v[216:219], v[88:91], v[88:91], v[116:119]
    s_waitcnt vmcnt(2)
    v_max_u32 v4, v92, v94
    v_cmp_eq_u32 vcc, -1, v4
    s_cbranch_vccnz .A_224
.W_225:
    v_mfma_f32_16x16x32_bf16 v[208:211], v[132:135], v[92:95], v[208:211]
    s_waitcnt vmcnt(1)
    v_max_u32 v4, v96, v98
    v_cmp_eq_u32 vcc, -1, v4
    v_mfma_f32_16x16x32_bf16 v[212:215], v[148:151], v[92:95], v[212:215]
    v_mfma_f32_16x16x32_bf16 v[216:219], v[92:95], v[92:95], v[216:219]
    s_cbranch_vccnz .A_226
.W_227:
    v_mfma_f32_16x16x32_bf16 v[208:211], v[136:139], v[96:99], v[208:211]
    s_waitcnt vmcnt(0)
    v_max_u32 v4, v100, v102
    v_cmp_eq_u32 vcc, -1, v4
    v_mfma_f32_16x16x32_bf16 v[212:215], v[152:155], v[96:99], v[212:215]
    v_mfma_f32_16x16x32_bf16 v[216:219], v[96:99], v[96:99], v[216:219]
    s_cbranch_vccnz .A_228
.W_229:
    v_mfma_f32_16x16x32_bf16 v[208:211], v[140:143], v[100:103], v[208:211]
    s_barrier
    v_mfma_f32_16x16x32_bf16 v[212:215], v[156:159], v[100:103], v[212:215]
    v_mfma_f32_16x16x32_bf16 v[216:219], v[100:103], v[100:103], v[216:219]
.mj_223:
    ds_read_b64 v[168:169], v14 offset:18432
    v_max3_f32 v4, v208, v209, v210
    ds_read_b64 v[172:173], v14 offset:18440
    s_nop 0
    v_max3_f32 v5, v211, v212, v213
    v_max3_f32 v4, v4, v214, v215
    v_mov_b32_dpp v208, v212 row_ror:8 row_mask:0xf bank_mask:0xc
    v_mov_b32_dpp v209, v213 row_ror:8 row_mask:0xf bank_mask:0xc
    v_max3_f32 v5, v5, v216, v217
    v_max3_f32 v4, v4, v218, v219
    v_max_f32 v6, v4, v5
    v_max_f32 v4, v4, v5
    v_mov_b32_dpp v210, v214 row_ror:8 row_mask:0xf bank_mask:0xc
    v_mov_b32_dpp v211, v215 row_ror:8 row_mask:0xf bank_mask:0xc
    v_permlane32_swap_b32 v4, v6
    v_max_f32 v5, v4, v6
    v_max_f32 v4, v4, v6
    v_mov_b32_dpp v216, v218 row_ror:8 row_mask:0xf bank_mask:0xc
    v_mov_b32_dpp v217, v219 row_ror:8 row_mask:0xf bank_mask:0xc
    v_permlane16_swap_b32 v4, v5
    v_max_f32 v4, v4, v5
    s_nop 1
    v_mov_b32_dpp v4, v4 row_ror:8 row_mask:0xf bank_mask:0xc
    v_mul_f32 v4, s37, v4

    v_pk_fma_f32 v[104:105], v[208:209], s[36:37], v[4:5] op_sel:[0,1,0] op_sel_hi:[1,1,0] neg_lo:[0,0,1] neg_hi:[0,0,1]
    v_pk_fma_f32 v[106:107], v[210:211], s[36:37], v[4:5] op_sel:[0,1,0] op_sel_hi:[1,1,0] neg_lo:[0,0,1] neg_hi:[0,0,1]
    v_pk_fma_f32 v[108:109], v[216:217], s[36:37], v[4:5] op_sel:[0,1,0] op_sel_hi:[1,1,0] neg_lo:[0,0,1] neg_hi:[0,0,1]
    v_exp_f32 v104, v104
    v_exp_f32 v105, v105
    v_exp_f32 v106, v106
    v_exp_f32 v107, v107
    v_cvt_pk_bf16_f32 v176, v104, v105
    v_cvt_pk_bf16_f32 v177, v106, v107
    v_exp_f32 v108, v108
    v_mov_b32_dpp v178, v176 row_ror:8 row_mask:0xf bank_mask:0xf
    v_mov_b32_dpp v179, v177 row_ror:8 row_mask:0xf bank_mask:0xf
    s_waitcnt lgkmcnt(0)
    s_nop 0

    v_mfma_f32_16x16x32_bf16 v[208:211], v[120:123], v[176:179], 0
    v_exp_f32 v109, v109
    v_mfma_f32_16x16x32_bf16 v[212:215], v[160:163], v[176:179], 0
    v_cvt_pk_bf16_f32 v180, v108, v109
    s_nop 0
    v_mfma_f32_16x16x32_bf16 v[216:219], v[164:167], v[176:179], 0
    v_mov_b32_dpp v181, v180 row_ror:8 row_mask:0xf bank_mask:0xf
    s_nop 1
    v_mfma_f32_16x16x32_bf16 v[208:211], v[120:123], v[180:183], v[208:211]
    v_mfma_f32_16x16x32_bf16 v[212:215], v[168:171], v[180:183], v[212:215]
    v_mfma_f32_16x16x32_bf16 v[216:219], v[172:175], v[180:183], v[216:219]
    s_mov_b64 exec, s[58:59]
    v_rcp_f32 v4, v208
    s_nop 0
    v_pk_mul_f32 v[212:213], v[212:213], v[4:5] op_sel_hi:[1,0]
    v_pk_mul_f32 v[214:215], v[214:215], v[4:5] op_sel_hi:[1,0]

    v_cvt_pk_bf16_f32 v184, v212, v213
    v_cvt_pk_bf16_f32 v185, v214, v215
    v_pk_mul_f32 v[216:217], v[216:217], v[4:5] op_sel_hi:[1,0]
    v_pk_mul_f32 v[218:219], v[218:219], v[4:5] op_sel_hi:[1,0]

    v_cvt_pk_bf16_f32 v186, v216, v217
    v_cvt_pk_bf16_f32 v187, v218, v219
    buffer_store_dwordx4 v[184:187], v13, s[8:11], s29 offen sc1
    s_mov_b64 exec, -1

.gp_212:
    s_barrier
    v_mov_b32 v5, 19968
    ds_read_b32 v4, v5
    s_mov_b32 s99, s68
    s_waitcnt vmcnt(0)
    s_cmp_eq_u32 s24, 3
    s_cbranch_scc1 .u3_230
    s_add_u32 s6, s28, 3
    s_add_u32 s7, s30, 262144
    s_waitcnt lgkmcnt(0)
    v_readfirstlane_b32 s5, v4
    s_cmp_lt_u32 s5, s6
    s_barrier
    s_cbranch_scc1 .np_232
    buffer_load_dword v226, v225, s[8:11], s7 offen

.np_232:
    s_add_u32 s4, s70, 0
    buffer_store_dwordx4 v[188:191], v238, s[8:11], s4 offen sc1
    s_add_u32 s4, s70, 262144
    buffer_store_dwordx4 v[188:191], v238, s[8:11], s4 offen sc1
    s_branch .u4_231
.u3_230:
    s_sub_u32 s4, s36, 0
    s_barrier
    s_mov_b64 exec, s[66:67]
    buffer_store_dwordx4 v[88:91], v11, s[8:11], s4 offen sc1
    s_mov_b64 exec, s[56:57]
    buffer_store_dwordx4 v[172:175], v12, s[8:11], s4 offen sc1
    s_mov_b64 exec, -1

.u4_231:
    s_barrier
    s_add_u32 s28, s28, 1
    s_add_u32 s36, s36, 196608
    s_cmp_lt_u32 s28, 63
    s_cselect_b32 s4, 262144, 0
    s_add_u32 s38, s38, s4
    s_add_u32 s39, s39, s4
    s_add_u32 s30, s30, s4
    s_mov_b32 s4, s68
    s_mov_b32 s68, s69
    s_mov_b32 s69, s70
    s_mov_b32 s70, s71
    s_mov_b32 s71, s4
    s_and_b32 s4, s28, 3
    s_lshl_b32 s5, s4, 17
    s_add_u32 s29, s5, s34
    s_xor_b32 s6, s5, 262144
    s_add_u32 s31, s6, s34
    s_add_u32 s32, s29, 20480
    s_add_u32 s33, s29, 24576
    v_mov_b32 v55, 0
    v_mov_b32 v56, 0
    v_mov_b32 v57, 0
    v_mov_b32 v58, 0
    v_mov_b32 v59, 0
    v_mov_b32 v60, 0
    v_mov_b32 v61, 0
    v_mov_b32 v62, 0
    v_mov_b32 v63, 0
    v_mov_b32 v64, 0
    v_mov_b32 v65, 0
    v_mov_b32 v66, 0
    v_mov_b32 v67, 0
    v_mov_b32 v68, 0
    v_mov_b32 v69, 0
    v_mov_b32 v70, 0
    v_mov_b32 v71, 0
    v_mov_b32 v72, 0
    v_mov_b32 v73, 0
    v_mov_b32 v74, 0
    v_mov_b32 v75, 0
    v_mov_b32 v20, -1
    v_mov_b32 v21, -1
    v_mov_b32 v22, -1
    v_mov_b32 v23, -1
    v_mov_b32 v24, -1
    v_mov_b32 v25, -1
    v_mov_b32 v26, -1
    v_mov_b32 v27, -1
    v_mov_b32 v28, -1
    v_mov_b32 v29, -1
    v_mov_b32 v30, -1
    v_mov_b32 v31, -1
    v_mov_b32 v32, -1
    v_mov_b32 v33, -1
    v_mov_b32 v34, -1
    v_mov_b32 v35, -1
    v_mov_b32 v92, -1
    v_mov_b32 v93, -1
    v_mov_b32 v94, -1
    v_mov_b32 v95, -1
    v_mov_b32 v96, -1
    v_mov_b32 v97, -1
    v_mov_b32 v98, -1
    v_mov_b32 v99, -1
    v_mov_b32 v100, -1
    v_mov_b32 v101, -1
    v_mov_b32 v102, -1
    v_mov_b32 v103, -1
    s_add_u32 s4, s99, 0
    buffer_load_dwordx4 v[192:195], v239, s[8:11], s4 offen sc1
    buffer_load_dwordx4 v[196:199], v249, s[8:11], s4 offen sc1

    ds_read_b128 v[128:131], v228 offset:0
    ds_read_b128 v[144:147], v228 offset:4096
    ds_read_b128 v[132:135], v229 offset:0
    ds_read_b128 v[148:151], v229 offset:4096
    ds_read_b128 v[136:139], v230 offset:0
    ds_read_b128 v[152:155], v230 offset:4096
    ds_read_b128 v[140:143], v231 offset:0
    ds_read_b128 v[156:159], v231 offset:4096
    ds_read_b128 v[160:163], v14 offset:28672
    ds_read_b128 v[164:167], v14 offset:29696
    ds_read_b128 v[108:111], v248
    s_waitcnt lgkmcnt(0)
    v_mfma_f32_16x16x32_bf16 v[76:79], v[108:111], v[112:115], 0
    s_add_u32 s4, s99, 262144
    buffer_load_dwordx4 v[200:203], v239, s[8:11], s4 offen sc1
    buffer_load_dwordx4 v[204:207], v249, s[8:11], s4 offen sc1

.gc_233:
    s_waitcnt vmcnt(2)

    v_mfma_f32_16x16x32_bf16 v[80:83], v[192:195], v[84:87], v[76:79]
    v_max_u32 v4, v192, v196
    v_cmp_eq_u32 vcc, -1, v4
    v_mfma_f32_16x16x32_bf16 v[80:83], v[196:199], v[112:115], v[80:83]
    s_nop 3
    s_cbranch_vccnz .gf_234
    s_mov_b64 exec, s[58:59]
    s_nop 1
    v_cvt_pk_bf16_f32 v104, v80, v81
    v_cvt_pk_bf16_f32 v105, v82, v83

    buffer_store_dwordx2 v[104:105], v15, s[8:11], s29 offen sc1
    s_mov_b64 exec, -1

    s_branch .top_209
.gf_234:
    s_add_u32 s4, s99, 0
    buffer_load_dwordx4 v[192:195], v239, s[8:11], s4 offen sc1
    buffer_load_dwordx4 v[196:199], v249, s[8:11], s4 offen sc1

    s_waitcnt vmcnt(2)

    v_mfma_f32_16x16x32_bf16 v[80:83], v[200:203], v[84:87], v[76:79]
    v_max_u32 v4, v200, v204
    v_cmp_eq_u32 vcc, -1, v4
    v_mfma_f32_16x16x32_bf16 v[80:83], v[204:207], v[112:115], v[80:83]
    s_nop 3
    s_cbranch_vccnz .gf_235
    s_mov_b64 exec, s[58:59]
    s_nop 1
    v_cvt_pk_bf16_f32 v104, v80, v81
    v_cvt_pk_bf16_f32 v105, v82, v83

    buffer_store_dwordx2 v[104:105], v15, s[8:11], s29 offen sc1
    s_mov_b64 exec, -1

    s_branch .top_209
.gf_235:
    s_add_u32 s4, s99, 262144
    buffer_load_dwordx4 v[200:203], v239, s[8:11], s4 offen sc1
    buffer_load_dwordx4 v[204:207], v249, s[8:11], s4 offen sc1

    s_sub_u32 s62, s62, 1
    s_cbranch_scc1 .mg_end_1
    s_branch .gc_233
.oth_210:
    s_cmp_eq_u32 s24, 3
    s_cbranch_scc1 .w3_211
    s_cmp_eq_u32 s28, 63
    s_cbranch_scc1 .rec_fin_6
    s_min_u32 s4, s14, s15
    s_max_u32 s93, s93, s4
    v_mov_b32 v4, s93
    v_mov_b32 v5, 19968
    ds_write_b32 v5, v4
    s_waitcnt vmcnt(0)
    v_mov_b32 v57, 0
    v_mov_b32 v58, 0
    v_mov_b32 v59, 0
    v_mov_b32 v60, 0
    v_mov_b32 v61, 0
    v_mov_b32 v62, 0
    v_mov_b32 v63, 0
    v_mov_b32 v64, 0
    v_mov_b32 v65, 0
    v_mov_b32 v66, 0
    v_mov_b32 v67, 0
    s_barrier
.en_29:
    s_add_u32 s6, s28, 2
    s_min_u32 s6, s6, 64
    s_cmp_lt_u32 s93, s6
    s_cbranch_scc1 .kf_236
.kb_237:
    s_mov_b32 m0, s90
    s_nop 0
    buffer_load_dwordx4 v14, s[8:11], s38 offen offset:0 lds
    buffer_load_dwordx4 v14, s[8:11], s38 offen offset:1024 lds
    buffer_load_dwordx4 v14, s[8:11], s38 offen offset:2048 lds
    buffer_load_dwordx4 v14, s[8:11], s38 offen offset:3072 lds
    s_mov_b32 m0, s91
    s_nop 0
    buffer_load_dwordx4 v14, s[8:11], s39 offen lds
    s_waitcnt lgkmcnt(0)
    s_barrier
    v_mov_b32 v20, -1
    v_mov_b32 v21, -1
    v_mov_b32 v22, -1
    v_mov_b32 v23, -1
    v_mov_b32 v24, -1
    v_mov_b32 v25, -1
    v_mov_b32 v26, -1
    v_mov_b32 v27, -1
    v_mov_b32 v28, -1
    v_mov_b32 v29, -1
    v_mov_b32 v30, -1
    v_mov_b32 v31, -1
    v_mov_b32 v32, -1
    v_mov_b32 v33, -1
    v_mov_b32 v34, -1
    v_mov_b32 v35, -1
    v_mov_b32 v55, 0
    v_mov_b32 v56, 0
    buffer_load_dwordx4 v[192:195], v243, s[8:11], s32 offen offset:0 sc1
    buffer_load_dwordx4 v[196:199], v243, s[8:11], s32 offen offset:1024 sc1
    v_mov_b32 v76, 0
    buffer_load_dwordx4 v[200:203], v252, s[8:11], s32 offen offset:0 sc1
    buffer_load_dwordx4 v[204:207], v252, s[8:11], s32 offen offset:1024 sc1
    v_mov_b32 v77, 0
    buffer_load_dwordx4 v[208:211], v254, s[8:11], s32 offen offset:0 sc1
    buffer_load_dwordx4 v[212:215], v254, s[8:11], s32 offen offset:1024 sc1
    v_mov_b32 v78, 0
    buffer_load_dwordx4 v[216:219], v246, s[8:11], s32 offen offset:0 sc1
    buffer_load_dwordx4 v[220:223], v246, s[8:11], s32 offen offset:1024 sc1
    s_waitcnt vmcnt(6)
    v_max_u32 v4, v192, v196
    v_cmp_eq_u32 vcc, -1, v4
    s_cbranch_vccnz .A_239
.W_240:
    v_smfmac_f32_16x16x64_bf16 v[76:79], v[192:195], a[192:199], v9
    s_waitcnt vmcnt(4)
    v_max_u32 v4, v200, v204
    v_cmp_eq_u32 vcc, -1, v4
    v_smfmac_f32_16x16x64_bf16 v[80:83], v[192:195], a[224:231], v9
    v_smfmac_f32_16x16x64_bf16 v[76:79], v[196:199], a[200:207], v9
    v_smfmac_f32_16x16x64_bf16 v[80:83], v[196:199], a[232:239], v9
    s_cbranch_vccnz .A_241
.W_242:
    v_smfmac_f32_16x16x64_bf16 v[76:79], v[200:203], a[208:215], v9
    s_waitcnt vmcnt(2)
    v_max_u32 v4, v208, v212
    v_cmp_eq_u32 vcc, -1, v4
    v_smfmac_f32_16x16x64_bf16 v[80:83], v[200:203], a[240:247], v9
    v_smfmac_f32_16x16x64_bf16 v[76:79], v[204:207], a[216:223], v9
    v_smfmac_f32_16x16x64_bf16 v[80:83], v[204:207], a[248:255], v9
    s_cbranch_vccnz .A_243
.W_244:
    v_smfmac_f32_16x16x64_bf16 v[76:79], v[208:211], v[124:131], v9
    s_waitcnt vmcnt(0)
    v_max_u32 v4, v216, v220
    v_cmp_eq_u32 vcc, -1, v4
    v_smfmac_f32_16x16x64_bf16 v[80:83], v[208:211], v[156:163], v9
    v_smfmac_f32_16x16x64_bf16 v[76:79], v[212:215], v[132:139], v9
    v_smfmac_f32_16x16x64_bf16 v[80:83], v[212:215], v[164:171], v9
    s_cbranch_vccnz .A_245
.W_246:
    s_barrier
    v_smfmac_f32_16x16x64_bf16 v[76:79], v[216:219], v[140:147], v9
    v_smfmac_f32_16x16x64_bf16 v[80:83], v[216:219], v[172:179], v9
    v_smfmac_f32_16x16x64_bf16 v[76:79], v[220:223], v[148:155], v9
    v_smfmac_f32_16x16x64_bf16 v[80:83], v[220:223], v[180:187], v9
.mj_238:
    v_mov_b32 v68, 0
    v_mov_b32 v69, 0
    v_mov_b32 v70, 0
    v_mov_b32 v71, 0
    v_mov_b32 v72, 0
    v_mov_b32 v73, 0
    v_mov_b32 v74, 0
    v_mov_b32 v75, 0
    v_permlane32_swap_b32 v76, v80
    v_permlane32_swap_b32 v77, v81
    v_permlane32_swap_b32 v78, v82
    v_permlane32_swap_b32 v79, v83
    v_pk_add_f32 v[76:77], v[76:77], v[80:81]
    v_pk_add_f32 v[78:79], v[78:79], v[82:83]
    v_cvt_pk_bf16_f32 v104, v76, v77
    v_cvt_pk_bf16_f32 v106, v76, v77
    v_cvt_pk_bf16_f32 v105, v78, v79
    v_cvt_pk_bf16_f32 v107, v78, v79
    v_permlane16_swap_b32 v104, v106
    s_nop 0
    v_permlane16_swap_b32 v105, v107

    buffer_store_dwordx4 v[104:107], v237, s[8:11], s68 offen sc1

    ds_write_b128 v247, v[104:107]
    s_waitcnt lgkmcnt(0)
    s_barrier
    v_mov_b32 v79, 0
    v_mov_b32 v80, 0
    v_mov_b32 v81, 0
    v_mov_b32 v82, 0
    v_mov_b32 v83, 0
    s_waitcnt vmcnt(1)
    v_mov_b32 v192, -1
    v_mov_b32 v193, -1
    v_mov_b32 v194, -1
    v_mov_b32 v195, -1
    v_mov_b32 v196, -1
    v_mov_b32 v197, -1
    v_mov_b32 v198, -1
    v_mov_b32 v199, -1
    v_mov_b32 v200, -1
    v_mov_b32 v201, -1
    v_mov_b32 v202, -1
    v_mov_b32 v203, -1
    v_mov_b32 v204, -1
    v_mov_b32 v205, -1
    v_mov_b32 v206, -1
    v_mov_b32 v207, -1
    v_mov_b32 v208, -1
    v_mov_b32 v209, -1
    v_mov_b32 v210, -1
    v_mov_b32 v211, -1
    v_mov_b32 v212, -1
    v_mov_b32 v213, -1
    v_mov_b32 v214, -1
    v_mov_b32 v215, -1
    v_mov_b32 v216, -1
    v_mov_b32 v217, -1
    v_mov_b32 v218, -1
    v_mov_b32 v219, -1
    v_mov_b32 v220, -1
    v_mov_b32 v221, -1
    v_mov_b32 v222, -1
    v_mov_b32 v223, -1
    s_add_u32 s6, s28, 4
    s_cmp_ge_u32 s93, s6
    s_cbranch_scc1 .nl_247
    s_buffer_load_dword s14, s[8:11], s89 glc
    s_buffer_load_dword s15, s[8:11], s89 offset:8192 glc

.nl_247:
    s_add_u32 s28, s28, 1
    s_add_u32 s36, s36, 196608
    s_cmp_lt_u32 s28, 63
    s_cselect_b32 s4, 262144, 0
    s_add_u32 s38, s38, s4
    s_add_u32 s39, s39, s4
    s_add_u32 s30, s30, s4
    s_mov_b32 s4, s68
    s_mov_b32 s68, s69
    s_mov_b32 s69, s70
    s_mov_b32 s70, s71
    s_mov_b32 s71, s4
    s_and_b32 s4, s28, 3
    s_lshl_b32 s5, s4, 17
    s_add_u32 s29, s5, s34
    s_xor_b32 s6, s5, 262144
    s_add_u32 s31, s6, s34
    s_add_u32 s32, s29, 20480
    s_add_u32 s33, s29, 24576
    s_branch .top_209
.w3_211:
    ds_read_b128 v[36:39], v14 offset:8192
    ds_read_b128 v[40:43], v14 offset:9216
    ds_read_b128 v[44:47], v14 offset:10240
    ds_read_b128 v[48:51], v14 offset:11264
    ds_read_b128 v[88:91], v14 offset:16384
    s_waitcnt lgkmcnt(0)
    v_mfma_f32_16x16x32_bf16 v[104:107], v[84:87], v[36:39], 0
    v_mfma_f32_16x16x32_bf16 v[108:111], v[84:87], v[44:47], 0
    v_mfma_f32_16x16x32_bf16 v[104:107], v[84:87], v[40:43], v[104:107]
    v_mfma_f32_16x16x32_bf16 v[108:111], v[84:87], v[48:51], v[108:111]
    s_nop 7
    v_cvt_pk_bf16_f32 v168, v104, v105
    v_cvt_pk_bf16_f32 v169, v106, v107
    v_cvt_pk_bf16_f32 v170, v108, v109
    v_cvt_pk_bf16_f32 v171, v110, v111
    ds_write_b128 v14, v[168:171] offset:18432
    s_cmp_ge_u32 s28, 62
    s_cbranch_scc1 .sk_248
.sb_249:
.en_35:
    s_waitcnt lgkmcnt(0)
    s_barrier
    buffer_store_dwordx4 v[188:191], v235, s[8:11], s31 offen sc1
    buffer_store_dwordx4 v[188:191], v236, s[8:11], s31 offen sc1

    v_cndmask_b32 v172, v170, v168, s[60:61]
    v_cndmask_b32 v173, v171, v169, s[60:61]

    v_mov_b32 v174, v172
    v_mov_b32 v175, v173
    s_nop 0
    s_nop 0
    v_permlane16_swap_b32 v172, v174
    v_permlane16_swap_b32 v173, v175
    ds_write_b128 v14, v[172:175] offset:17408

    s_branch .gp_212
.A_250:
    s_mov_b64 exec, vcc
    buffer_load_dwordx4 v[32:35], v8, s[8:11], s29 offen offset:3072 sc1
    s_mov_b64 exec, -1
    s_sub_u32 s62, s62, 1
    s_cbranch_scc1 .mg_end_1
    s_waitcnt vmcnt(3)
    v_max_u32 v4, v20, v22
    v_cmp_eq_u32 vcc, -1, v4
    s_cbranch_vccz .W_216
.A_215:
    s_mov_b64 exec, vcc
    buffer_load_dwordx4 v[20:23], v8, s[8:11], s29 offen offset:0 sc1
    s_mov_b64 exec, -1
    s_waitcnt vmcnt(3)
    v_max_u32 v4, v24, v26
    v_cmp_eq_u32 vcc, -1, v4
    s_cbranch_vccz .W_251
.A_252:
    s_mov_b64 exec, vcc
    buffer_load_dwordx4 v[24:27], v8, s[8:11], s29 offen offset:1024 sc1
    s_mov_b64 exec, -1
    s_waitcnt vmcnt(3)
    v_max_u32 v4, v28, v30
    v_cmp_eq_u32 vcc, -1, v4
    s_cbranch_vccz .W_253
.A_254:
    s_mov_b64 exec, vcc
    buffer_load_dwordx4 v[28:31], v8, s[8:11], s29 offen offset:2048 sc1
    s_mov_b64 exec, -1
    s_waitcnt vmcnt(3)
    v_max_u32 v4, v32, v34
    v_cmp_eq_u32 vcc, -1, v4
    s_cbranch_vccnz .A_250
.W_255:
    v_smfmac_f32_16x16x64_bf16 v[52:55], v[32:35], a[24:31], v9
    s_waitcnt vmcnt(2)
    v_max_u32 v4, v20, v22
    v_cmp_eq_u32 vcc, -1, v4
    v_smfmac_f32_16x16x64_bf16 v[56:59], v[32:35], a[56:63], v9
    v_smfmac_f32_16x16x64_bf16 v[60:63], v[32:35], a[88:95], v9
    v_smfmac_f32_16x16x64_bf16 v[64:67], v[32:35], a[120:127], v9
    s_cbranch_vccnz .A_256
.W_257:
    v_smfmac_f32_16x16x64_bf16 v[52:55], v[20:23], a[0:7], v9
    s_waitcnt vmcnt(1)
    v_max_u32 v4, v24, v26
    v_cmp_eq_u32 vcc, -1, v4
    v_smfmac_f32_16x16x64_bf16 v[56:59], v[20:23], a[32:39], v9
    v_smfmac_f32_16x16x64_bf16 v[60:63], v[20:23], a[64:71], v9
    v_smfmac_f32_16x16x64_bf16 v[64:67], v[20:23], a[96:103], v9
    s_cbranch_vccnz .A_258
.W_259:
    v_smfmac_f32_16x16x64_bf16 v[52:55], v[24:27], a[8:15], v9
    s_waitcnt vmcnt(0)
    v_max_u32 v4, v28, v30
    v_cmp_eq_u32 vcc, -1, v4
    v_smfmac_f32_16x16x64_bf16 v[56:59], v[24:27], a[40:47], v9
    v_smfmac_f32_16x16x64_bf16 v[60:63], v[24:27], a[72:79], v9
    v_smfmac_f32_16x16x64_bf16 v[64:67], v[24:27], a[104:111], v9
    s_cbranch_vccnz .A_260
.W_261:
    v_smfmac_f32_16x16x64_bf16 v[52:55], v[28:31], a[16:23], v9
    v_smfmac_f32_16x16x64_bf16 v[56:59], v[28:31], a[48:55], v9
    v_smfmac_f32_16x16x64_bf16 v[60:63], v[28:31], a[80:87], v9
    s_nop 0
    v_cvt_pk_bf16_f32 v104, v52, v53
    v_cvt_pk_bf16_f32 v105, v54, v55
    v_smfmac_f32_16x16x64_bf16 v[64:67], v[28:31], a[112:119], v9
    s_branch .mj_214
.W_251:
    v_smfmac_f32_16x16x64_bf16 v[52:55], v[24:27], a[8:15], v9
    s_waitcnt vmcnt(2)
    v_max_u32 v4, v28, v30
    v_cmp_eq_u32 vcc, -1, v4
    v_smfmac_f32_16x16x64_bf16 v[56:59], v[24:27], a[40:47], v9
    v_smfmac_f32_16x16x64_bf16 v[60:63], v[24:27], a[72:79], v9
    v_smfmac_f32_16x16x64_bf16 v[64:67], v[24:27], a[104:111], v9
    s_cbranch_vccnz .A_262
.W_263:
    v_smfmac_f32_16x16x64_bf16 v[52:55], v[28:31], a[16:23], v9
    s_waitcnt vmcnt(1)
    v_max_u32 v4, v32, v34
    v_cmp_eq_u32 vcc, -1, v4
    v_smfmac_f32_16x16x64_bf16 v[56:59], v[28:31], a[48:55], v9
    v_smfmac_f32_16x16x64_bf16 v[60:63], v[28:31], a[80:87], v9
    v_smfmac_f32_16x16x64_bf16 v[64:67], v[28:31], a[112:119], v9
    s_cbranch_vccnz .A_264
.W_265:
    v_smfmac_f32_16x16x64_bf16 v[52:55], v[32:35], a[24:31], v9
    s_waitcnt vmcnt(0)
    v_max_u32 v4, v20, v22
    v_cmp_eq_u32 vcc, -1, v4
    v_smfmac_f32_16x16x64_bf16 v[56:59], v[32:35], a[56:63], v9
    v_smfmac_f32_16x16x64_bf16 v[60:63], v[32:35], a[88:95], v9
    v_smfmac_f32_16x16x64_bf16 v[64:67], v[32:35], a[120:127], v9
    s_cbranch_vccnz .A_266
.W_267:
    v_smfmac_f32_16x16x64_bf16 v[52:55], v[20:23], a[0:7], v9
    v_smfmac_f32_16x16x64_bf16 v[56:59], v[20:23], a[32:39], v9
    v_smfmac_f32_16x16x64_bf16 v[60:63], v[20:23], a[64:71], v9
    s_nop 0
    v_cvt_pk_bf16_f32 v104, v52, v53
    v_cvt_pk_bf16_f32 v105, v54, v55
    v_smfmac_f32_16x16x64_bf16 v[64:67], v[20:23], a[96:103], v9
    s_branch .mj_214
.W_253:
    v_smfmac_f32_16x16x64_bf16 v[52:55], v[28:31], a[16:23], v9
    s_waitcnt vmcnt(2)
    v_max_u32 v4, v32, v34
    v_cmp_eq_u32 vcc, -1, v4
    v_smfmac_f32_16x16x64_bf16 v[56:59], v[28:31], a[48:55], v9
    v_smfmac_f32_16x16x64_bf16 v[60:63], v[28:31], a[80:87], v9
    v_smfmac_f32_16x16x64_bf16 v[64:67], v[28:31], a[112:119], v9
    s_cbranch_vccnz .A_268
.W_269:
    v_smfmac_f32_16x16x64_bf16 v[52:55], v[32:35], a[24:31], v9
    s_waitcnt vmcnt(1)
    v_max_u32 v4, v20, v22
    v_cmp_eq_u32 vcc, -1, v4
    v_smfmac_f32_16x16x64_bf16 v[56:59], v[32:35], a[56:63], v9
    v_smfmac_f32_16x16x64_bf16 v[60:63], v[32:35], a[88:95], v9
    v_smfmac_f32_16x16x64_bf16 v[64:67], v[32:35], a[120:127], v9
    s_cbranch_vccnz .A_270
.W_271:
    v_smfmac_f32_16x16x64_bf16 v[52:55], v[20:23], a[0:7], v9
    s_waitcnt vmcnt(0)
    v_max_u32 v4, v24, v26
    v_cmp_eq_u32 vcc, -1, v4
    v_smfmac_f32_16x16x64_bf16 v[56:59], v[20:23], a[32:39], v9
    v_smfmac_f32_16x16x64_bf16 v[60:63], v[20:23], a[64:71], v9
    v_smfmac_f32_16x16x64_bf16 v[64:67], v[20:23], a[96:103], v9
    s_cbranch_vccnz .A_272
.W_273:
    v_smfmac_f32_16x16x64_bf16 v[52:55], v[24:27], a[8:15], v9
    v_smfmac_f32_16x16x64_bf16 v[56:59], v[24:27], a[40:47], v9
    v_smfmac_f32_16x16x64_bf16 v[60:63], v[24:27], a[72:79], v9
    s_nop 0
    v_cvt_pk_bf16_f32 v104, v52, v53
    v_cvt_pk_bf16_f32 v105, v54, v55
    v_smfmac_f32_16x16x64_bf16 v[64:67], v[24:27], a[104:111], v9
    s_branch .mj_214
.A_274:
    s_mov_b64 exec, vcc
    buffer_load_dwordx4 v[28:31], v8, s[8:11], s29 offen offset:2048 sc1
    s_mov_b64 exec, -1
    s_sub_u32 s62, s62, 1
    s_cbranch_scc1 .mg_end_1
    s_waitcnt vmcnt(2)
    v_max_u32 v4, v20, v22
    v_cmp_eq_u32 vcc, -1, v4
    s_cbranch_vccz .W_257
.A_256:
    s_mov_b64 exec, vcc
    buffer_load_dwordx4 v[20:23], v8, s[8:11], s29 offen offset:0 sc1
    s_mov_b64 exec, -1
    s_waitcnt vmcnt(2)
    v_max_u32 v4, v24, v26
    v_cmp_eq_u32 vcc, -1, v4
    s_cbranch_vccz .W_275
.A_276:
    s_mov_b64 exec, vcc
    buffer_load_dwordx4 v[24:27], v8, s[8:11], s29 offen offset:1024 sc1
    s_mov_b64 exec, -1
    s_waitcnt vmcnt(2)
    v_max_u32 v4, v28, v30
    v_cmp_eq_u32 vcc, -1, v4
    s_cbranch_vccnz .A_274
.W_277:
    v_smfmac_f32_16x16x64_bf16 v[52:55], v[28:31], a[16:23], v9
    s_waitcnt vmcnt(1)
    v_max_u32 v4, v20, v22
    v_cmp_eq_u32 vcc, -1, v4
    v_smfmac_f32_16x16x64_bf16 v[56:59], v[28:31], a[48:55], v9
    v_smfmac_f32_16x16x64_bf16 v[60:63], v[28:31], a[80:87], v9
    v_smfmac_f32_16x16x64_bf16 v[64:67], v[28:31], a[112:119], v9
    s_cbranch_vccz .W_271
    s_branch .A_270
.W_275:
    v_smfmac_f32_16x16x64_bf16 v[52:55], v[24:27], a[8:15], v9
    s_waitcnt vmcnt(1)
    v_max_u32 v4, v28, v30
    v_cmp_eq_u32 vcc, -1, v4
    v_smfmac_f32_16x16x64_bf16 v[56:59], v[24:27], a[40:47], v9
    v_smfmac_f32_16x16x64_bf16 v[60:63], v[24:27], a[72:79], v9
    v_smfmac_f32_16x16x64_bf16 v[64:67], v[24:27], a[104:111], v9
    s_cbranch_vccnz .A_278
.W_279:
    v_smfmac_f32_16x16x64_bf16 v[52:55], v[28:31], a[16:23], v9
    s_waitcnt vmcnt(0)
    v_max_u32 v4, v20, v22
    v_cmp_eq_u32 vcc, -1, v4
    v_smfmac_f32_16x16x64_bf16 v[56:59], v[28:31], a[48:55], v9
    v_smfmac_f32_16x16x64_bf16 v[60:63], v[28:31], a[80:87], v9
    v_smfmac_f32_16x16x64_bf16 v[64:67], v[28:31], a[112:119], v9
    s_cbranch_vccz .W_267
    s_branch .A_266
.A_280:
    s_mov_b64 exec, vcc
    buffer_load_dwordx4 v[24:27], v8, s[8:11], s29 offen offset:1024 sc1
    s_mov_b64 exec, -1
    s_sub_u32 s62, s62, 1
    s_cbranch_scc1 .mg_end_1
    s_waitcnt vmcnt(2)
    v_max_u32 v4, v32, v34
    v_cmp_eq_u32 vcc, -1, v4
    s_cbranch_vccz .W_269
.A_268:
    s_mov_b64 exec, vcc
    buffer_load_dwordx4 v[32:35], v8, s[8:11], s29 offen offset:3072 sc1
    s_mov_b64 exec, -1
    s_waitcnt vmcnt(2)
    v_max_u32 v4, v20, v22
    v_cmp_eq_u32 vcc, -1, v4
    s_cbranch_vccz .W_281
.A_282:
    s_mov_b64 exec, vcc
    buffer_load_dwordx4 v[20:23], v8, s[8:11], s29 offen offset:0 sc1
    s_mov_b64 exec, -1
    s_waitcnt vmcnt(2)
    v_max_u32 v4, v24, v26
    v_cmp_eq_u32 vcc, -1, v4
    s_cbranch_vccnz .A_280
.W_283:
    v_smfmac_f32_16x16x64_bf16 v[52:55], v[24:27], a[8:15], v9
    s_waitcnt vmcnt(1)
    v_max_u32 v4, v32, v34
    v_cmp_eq_u32 vcc, -1, v4
    v_smfmac_f32_16x16x64_bf16 v[56:59], v[24:27], a[40:47], v9
    v_smfmac_f32_16x16x64_bf16 v[60:63], v[24:27], a[72:79], v9
    v_smfmac_f32_16x16x64_bf16 v[64:67], v[24:27], a[104:111], v9
    s_cbranch_vccz .W_265
    s_branch .A_264
.W_281:
    v_smfmac_f32_16x16x64_bf16 v[52:55], v[20:23], a[0:7], v9
    s_waitcnt vmcnt(1)
    v_max_u32 v4, v24, v26
    v_cmp_eq_u32 vcc, -1, v4
    v_smfmac_f32_16x16x64_bf16 v[56:59], v[20:23], a[32:39], v9
    v_smfmac_f32_16x16x64_bf16 v[60:63], v[20:23], a[64:71], v9
    v_smfmac_f32_16x16x64_bf16 v[64:67], v[20:23], a[96:103], v9
    s_cbranch_vccnz .A_284
.W_285:
    v_smfmac_f32_16x16x64_bf16 v[52:55], v[24:27], a[8:15], v9
    s_waitcnt vmcnt(0)
    v_max_u32 v4, v32, v34
    v_cmp_eq_u32 vcc, -1, v4
    v_smfmac_f32_16x16x64_bf16 v[56:59], v[24:27], a[40:47], v9
    v_smfmac_f32_16x16x64_bf16 v[60:63], v[24:27], a[72:79], v9
    v_smfmac_f32_16x16x64_bf16 v[64:67], v[24:27], a[104:111], v9
    s_cbranch_vccz .W_222
    s_branch .A_221
.A_286:
    s_mov_b64 exec, vcc
    buffer_load_dwordx4 v[32:35], v8, s[8:11], s29 offen offset:3072 sc1
    s_mov_b64 exec, -1
    s_sub_u32 s62, s62, 1
    s_cbranch_scc1 .mg_end_1
    s_waitcnt vmcnt(2)
    v_max_u32 v4, v20, v22
    v_cmp_eq_u32 vcc, -1, v4
    s_cbranch_vccz .W_287
.A_288:
    s_mov_b64 exec, vcc
    buffer_load_dwordx4 v[20:23], v8, s[8:11], s29 offen offset:0 sc1
    s_mov_b64 exec, -1
    s_waitcnt vmcnt(2)
    v_max_u32 v4, v28, v30
    v_cmp_eq_u32 vcc, -1, v4
    s_cbranch_vccz .W_263
.A_262:
    s_mov_b64 exec, vcc
    buffer_load_dwordx4 v[28:31], v8, s[8:11], s29 offen offset:2048 sc1
    s_mov_b64 exec, -1
    s_waitcnt vmcnt(2)
    v_max_u32 v4, v32, v34
    v_cmp_eq_u32 vcc, -1, v4
    s_cbranch_vccnz .A_286
.W_289:
    v_smfmac_f32_16x16x64_bf16 v[52:55], v[32:35], a[24:31], v9
    s_waitcnt vmcnt(1)
    v_max_u32 v4, v20, v22
    v_cmp_eq_u32 vcc, -1, v4
    v_smfmac_f32_16x16x64_bf16 v[56:59], v[32:35], a[56:63], v9
    v_smfmac_f32_16x16x64_bf16 v[60:63], v[32:35], a[88:95], v9
    v_smfmac_f32_16x16x64_bf16 v[64:67], v[32:35], a[120:127], v9
    s_cbranch_vccnz .A_290
.W_291:
    v_smfmac_f32_16x16x64_bf16 v[52:55], v[20:23], a[0:7], v9
    s_waitcnt vmcnt(0)
    v_max_u32 v4, v28, v30
    v_cmp_eq_u32 vcc, -1, v4
    v_smfmac_f32_16x16x64_bf16 v[56:59], v[20:23], a[32:39], v9
    v_smfmac_f32_16x16x64_bf16 v[60:63], v[20:23], a[64:71], v9
    v_smfmac_f32_16x16x64_bf16 v[64:67], v[20:23], a[96:103], v9
    s_cbranch_vccz .W_261
    s_branch .A_260
.W_287:
    v_smfmac_f32_16x16x64_bf16 v[52:55], v[20:23], a[0:7], v9
    s_waitcnt vmcnt(1)
    v_max_u32 v4, v28, v30
    v_cmp_eq_u32 vcc, -1, v4
    v_smfmac_f32_16x16x64_bf16 v[56:59], v[20:23], a[32:39], v9
    v_smfmac_f32_16x16x64_bf16 v[60:63], v[20:23], a[64:71], v9
    v_smfmac_f32_16x16x64_bf16 v[64:67], v[20:23], a[96:103], v9
    s_cbranch_vccz .W_220
    s_branch .A_219
.A_292:
    s_mov_b64 exec, vcc
    buffer_load_dwordx4 v[32:35], v8, s[8:11], s29 offen offset:3072 sc1
    s_mov_b64 exec, -1
    s_sub_u32 s62, s62, 1
    s_cbranch_scc1 .mg_end_1
    s_waitcnt vmcnt(2)
    v_max_u32 v4, v24, v26
    v_cmp_eq_u32 vcc, -1, v4
    s_cbranch_vccz .W_218
.A_217:
    s_mov_b64 exec, vcc
    buffer_load_dwordx4 v[24:27], v8, s[8:11], s29 offen offset:1024 sc1
    s_mov_b64 exec, -1
    s_waitcnt vmcnt(2)
    v_max_u32 v4, v28, v30
    v_cmp_eq_u32 vcc, -1, v4
    s_cbranch_vccz .W_293
.A_294:
    s_mov_b64 exec, vcc
    buffer_load_dwordx4 v[28:31], v8, s[8:11], s29 offen offset:2048 sc1
    s_mov_b64 exec, -1
    s_waitcnt vmcnt(2)
    v_max_u32 v4, v32, v34
    v_cmp_eq_u32 vcc, -1, v4
    s_cbranch_vccnz .A_292
.W_295:
    v_smfmac_f32_16x16x64_bf16 v[52:55], v[32:35], a[24:31], v9
    s_waitcnt vmcnt(1)
    v_max_u32 v4, v24, v26
    v_cmp_eq_u32 vcc, -1, v4
    v_smfmac_f32_16x16x64_bf16 v[56:59], v[32:35], a[56:63], v9
    v_smfmac_f32_16x16x64_bf16 v[60:63], v[32:35], a[88:95], v9
    v_smfmac_f32_16x16x64_bf16 v[64:67], v[32:35], a[120:127], v9
    s_cbranch_vccz .W_259
    s_branch .A_258
.W_293:
    v_smfmac_f32_16x16x64_bf16 v[52:55], v[28:31], a[16:23], v9
    s_waitcnt vmcnt(1)
    v_max_u32 v4, v32, v34
    v_cmp_eq_u32 vcc, -1, v4
    v_smfmac_f32_16x16x64_bf16 v[56:59], v[28:31], a[48:55], v9
    v_smfmac_f32_16x16x64_bf16 v[60:63], v[28:31], a[80:87], v9
    v_smfmac_f32_16x16x64_bf16 v[64:67], v[28:31], a[112:119], v9
    s_cbranch_vccnz .A_296
.W_297:
    v_smfmac_f32_16x16x64_bf16 v[52:55], v[32:35], a[24:31], v9
    s_waitcnt vmcnt(0)
    v_max_u32 v4, v24, v26
    v_cmp_eq_u32 vcc, -1, v4
    v_smfmac_f32_16x16x64_bf16 v[56:59], v[32:35], a[56:63], v9
    v_smfmac_f32_16x16x64_bf16 v[60:63], v[32:35], a[88:95], v9
    v_smfmac_f32_16x16x64_bf16 v[64:67], v[32:35], a[120:127], v9
    s_cbranch_vccz .W_273
    s_branch .A_272
.A_298:
    s_mov_b64 exec, vcc
    buffer_load_dwordx4 v[24:27], v8, s[8:11], s29 offen offset:1024 sc1
    s_mov_b64 exec, -1
    s_sub_u32 s62, s62, 1
    s_cbranch_scc1 .mg_end_1
    s_waitcnt vmcnt(1)
    v_max_u32 v4, v20, v22
    v_cmp_eq_u32 vcc, -1, v4
    s_cbranch_vccz .W_271
.A_270:
    s_mov_b64 exec, vcc
    buffer_load_dwordx4 v[20:23], v8, s[8:11], s29 offen offset:0 sc1
    s_mov_b64 exec, -1
    s_waitcnt vmcnt(1)
    v_max_u32 v4, v24, v26
    v_cmp_eq_u32 vcc, -1, v4
    s_cbranch_vccnz .A_298
.W_299:
    v_smfmac_f32_16x16x64_bf16 v[52:55], v[24:27], a[8:15], v9
    s_waitcnt vmcnt(0)
    v_max_u32 v4, v20, v22
    v_cmp_eq_u32 vcc, -1, v4
    v_smfmac_f32_16x16x64_bf16 v[56:59], v[24:27], a[40:47], v9
    v_smfmac_f32_16x16x64_bf16 v[60:63], v[24:27], a[72:79], v9
    v_smfmac_f32_16x16x64_bf16 v[64:67], v[24:27], a[104:111], v9
    s_cbranch_vccz .W_267
    s_branch .A_266
.A_278:
    s_mov_b64 exec, vcc
    buffer_load_dwordx4 v[28:31], v8, s[8:11], s29 offen offset:2048 sc1
    s_mov_b64 exec, -1
    s_sub_u32 s62, s62, 1
    s_cbranch_scc1 .mg_end_1
    s_waitcnt vmcnt(1)
    v_max_u32 v4, v20, v22
    v_cmp_eq_u32 vcc, -1, v4
    s_cbranch_vccz .W_291
.A_290:
    s_mov_b64 exec, vcc
    buffer_load_dwordx4 v[20:23], v8, s[8:11], s29 offen offset:0 sc1
    s_mov_b64 exec, -1
    s_waitcnt vmcnt(1)
    v_max_u32 v4, v28, v30
    v_cmp_eq_u32 vcc, -1, v4
    s_cbranch_vccnz .A_278
    s_branch .W_279
.A_300:
    s_mov_b64 exec, vcc
    buffer_load_dwordx4 v[20:23], v8, s[8:11], s29 offen offset:0 sc1
    s_mov_b64 exec, -1
    s_sub_u32 s62, s62, 1
    s_cbranch_scc1 .mg_end_1
    s_waitcnt vmcnt(1)
    v_max_u32 v4, v32, v34
    v_cmp_eq_u32 vcc, -1, v4
    s_cbranch_vccz .W_265
.A_264:
    s_mov_b64 exec, vcc
    buffer_load_dwordx4 v[32:35], v8, s[8:11], s29 offen offset:3072 sc1
    s_mov_b64 exec, -1
    s_waitcnt vmcnt(1)
    v_max_u32 v4, v20, v22
    v_cmp_eq_u32 vcc, -1, v4
    s_cbranch_vccnz .A_300
.W_301:
    v_smfmac_f32_16x16x64_bf16 v[52:55], v[20:23], a[0:7], v9
    s_waitcnt vmcnt(0)
    v_max_u32 v4, v32, v34
    v_cmp_eq_u32 vcc, -1, v4
    v_smfmac_f32_16x16x64_bf16 v[56:59], v[20:23], a[32:39], v9
    v_smfmac_f32_16x16x64_bf16 v[60:63], v[20:23], a[64:71], v9
    v_smfmac_f32_16x16x64_bf16 v[64:67], v[20:23], a[96:103], v9
    s_cbranch_vccz .W_222
    s_branch .A_221
.A_302:
    s_mov_b64 exec, vcc
    buffer_load_dwordx4 v[28:31], v8, s[8:11], s29 offen offset:2048 sc1
    s_mov_b64 exec, -1
    s_sub_u32 s62, s62, 1
    s_cbranch_scc1 .mg_end_1
    s_waitcnt vmcnt(1)
    v_max_u32 v4, v24, v26
    v_cmp_eq_u32 vcc, -1, v4
    s_cbranch_vccz .W_259
.A_258:
    s_mov_b64 exec, vcc
    buffer_load_dwordx4 v[24:27], v8, s[8:11], s29 offen offset:1024 sc1
    s_mov_b64 exec, -1
    s_waitcnt vmcnt(1)
    v_max_u32 v4, v28, v30
    v_cmp_eq_u32 vcc, -1, v4
    s_cbranch_vccnz .A_302
.W_303:
    v_smfmac_f32_16x16x64_bf16 v[52:55], v[28:31], a[16:23], v9
    s_waitcnt vmcnt(0)
    v_max_u32 v4, v24, v26
    v_cmp_eq_u32 vcc, -1, v4
    v_smfmac_f32_16x16x64_bf16 v[56:59], v[28:31], a[48:55], v9
    v_smfmac_f32_16x16x64_bf16 v[60:63], v[28:31], a[80:87], v9
    v_smfmac_f32_16x16x64_bf16 v[64:67], v[28:31], a[112:119], v9
    s_cbranch_vccz .W_273
    s_branch .A_272
.A_296:
    s_mov_b64 exec, vcc
    buffer_load_dwordx4 v[32:35], v8, s[8:11], s29 offen offset:3072 sc1
    s_mov_b64 exec, -1
    s_sub_u32 s62, s62, 1
    s_cbranch_scc1 .mg_end_1
    s_waitcnt vmcnt(1)
    v_max_u32 v4, v24, v26
    v_cmp_eq_u32 vcc, -1, v4
    s_cbranch_vccz .W_285
.A_284:
    s_mov_b64 exec, vcc
    buffer_load_dwordx4 v[24:27], v8, s[8:11], s29 offen offset:1024 sc1
    s_mov_b64 exec, -1
    s_waitcnt vmcnt(1)
    v_max_u32 v4, v32, v34
    v_cmp_eq_u32 vcc, -1, v4
    s_cbranch_vccnz .A_296
    s_branch .W_297
.A_304:
    s_mov_b64 exec, vcc
    buffer_load_dwordx4 v[32:35], v8, s[8:11], s29 offen offset:3072 sc1
    s_mov_b64 exec, -1
    s_sub_u32 s62, s62, 1
    s_cbranch_scc1 .mg_end_1
    s_waitcnt vmcnt(1)
    v_max_u32 v4, v28, v30
    v_cmp_eq_u32 vcc, -1, v4
    s_cbranch_vccz .W_220
.A_219:
    s_mov_b64 exec, vcc
    buffer_load_dwordx4 v[28:31], v8, s[8:11], s29 offen offset:2048 sc1
    s_mov_b64 exec, -1
    s_waitcnt vmcnt(1)
    v_max_u32 v4, v32, v34
    v_cmp_eq_u32 vcc, -1, v4
    s_cbranch_vccnz .A_304
.W_305:
    v_smfmac_f32_16x16x64_bf16 v[52:55], v[32:35], a[24:31], v9
    s_waitcnt vmcnt(0)
    v_max_u32 v4, v28, v30
    v_cmp_eq_u32 vcc, -1, v4
    v_smfmac_f32_16x16x64_bf16 v[56:59], v[32:35], a[56:63], v9
    v_smfmac_f32_16x16x64_bf16 v[60:63], v[32:35], a[88:95], v9
    v_smfmac_f32_16x16x64_bf16 v[64:67], v[32:35], a[120:127], v9
    s_cbranch_vccz .W_261
    s_branch .A_260
.A_266:
    s_mov_b64 exec, vcc
    buffer_load_dwordx4 v[20:23], v8, s[8:11], s29 offen offset:0 sc1
    s_mov_b64 exec, -1
    s_sub_u32 s62, s62, 1
    s_cbranch_scc1 .mg_end_1
    s_waitcnt vmcnt(1)
    v_max3_u32 v4, v20, v21, v22
    v_max_u32 v4, v4, v23
    v_cmp_eq_u32 vcc, -1, v4
    s_cbranch_vccnz .A_266
    v_smfmac_f32_16x16x64_bf16 v[52:55], v[20:23], a[0:7], v9
    v_smfmac_f32_16x16x64_bf16 v[56:59], v[20:23], a[32:39], v9
    v_smfmac_f32_16x16x64_bf16 v[60:63], v[20:23], a[64:71], v9
    s_nop 0
    v_cvt_pk_bf16_f32 v104, v52, v53
    v_cvt_pk_bf16_f32 v105, v54, v55
    v_smfmac_f32_16x16x64_bf16 v[64:67], v[20:23], a[96:103], v9
    s_branch .mj_214
.A_272:
    s_mov_b64 exec, vcc
    buffer_load_dwordx4 v[24:27], v8, s[8:11], s29 offen offset:1024 sc1
    s_mov_b64 exec, -1
    s_sub_u32 s62, s62, 1
    s_cbranch_scc1 .mg_end_1
    s_waitcnt vmcnt(1)
    v_max3_u32 v4, v24, v25, v26
    v_max_u32 v4, v4, v27
    v_cmp_eq_u32 vcc, -1, v4
    s_cbranch_vccnz .A_272
    v_smfmac_f32_16x16x64_bf16 v[52:55], v[24:27], a[8:15], v9
    v_smfmac_f32_16x16x64_bf16 v[56:59], v[24:27], a[40:47], v9
    v_smfmac_f32_16x16x64_bf16 v[60:63], v[24:27], a[72:79], v9
    s_nop 0
    v_cvt_pk_bf16_f32 v104, v52, v53
    v_cvt_pk_bf16_f32 v105, v54, v55
    v_smfmac_f32_16x16x64_bf16 v[64:67], v[24:27], a[104:111], v9
    s_branch .mj_214
.A_260:
    s_mov_b64 exec, vcc
    buffer_load_dwordx4 v[28:31], v8, s[8:11], s29 offen offset:2048 sc1
    s_mov_b64 exec, -1
    s_sub_u32 s62, s62, 1
    s_cbranch_scc1 .mg_end_1
    s_waitcnt vmcnt(1)
    v_max3_u32 v4, v28, v29, v30
    v_max_u32 v4, v4, v31
    v_cmp_eq_u32 vcc, -1, v4
    s_cbranch_vccnz .A_260
    v_smfmac_f32_16x16x64_bf16 v[52:55], v[28:31], a[16:23], v9
    v_smfmac_f32_16x16x64_bf16 v[56:59], v[28:31], a[48:55], v9
    v_smfmac_f32_16x16x64_bf16 v[60:63], v[28:31], a[80:87], v9
    s_nop 0
    v_cvt_pk_bf16_f32 v104, v52, v53
    v_cvt_pk_bf16_f32 v105, v54, v55
    v_smfmac_f32_16x16x64_bf16 v[64:67], v[28:31], a[112:119], v9
    s_branch .mj_214
.A_221:
    s_mov_b64 exec, vcc
    buffer_load_dwordx4 v[32:35], v8, s[8:11], s29 offen offset:3072 sc1
    s_mov_b64 exec, -1
    s_sub_u32 s62, s62, 1
    s_cbranch_scc1 .mg_end_1
    s_waitcnt vmcnt(1)
    v_max3_u32 v4, v32, v33, v34
    v_max_u32 v4, v4, v35
    v_cmp_eq_u32 vcc, -1, v4
    s_cbranch_vccnz .A_221
    v_smfmac_f32_16x16x64_bf16 v[52:55], v[32:35], a[24:31], v9
    v_smfmac_f32_16x16x64_bf16 v[56:59], v[32:35], a[56:63], v9
    v_smfmac_f32_16x16x64_bf16 v[60:63], v[32:35], a[88:95], v9
    s_nop 0
    v_cvt_pk_bf16_f32 v104, v52, v53
    v_cvt_pk_bf16_f32 v105, v54, v55
    v_smfmac_f32_16x16x64_bf16 v[64:67], v[32:35], a[120:127], v9
    s_branch .mj_214
.A_306:
    buffer_load_dwordx4 v[100:103], v234, s[8:11], s29 offen sc1
    s_sub_u32 s62, s62, 1
    s_cbranch_scc1 .mg_end_1
    s_waitcnt vmcnt(2)
    v_max_u32 v4, v92, v94
    v_cmp_eq_u32 vcc, -1, v4
    s_cbranch_vccz .W_225
.A_224:
    buffer_load_dwordx4 v[92:95], v232, s[8:11], s29 offen sc1
    s_waitcnt vmcnt(2)
    v_max_u32 v4, v96, v98
    v_cmp_eq_u32 vcc, -1, v4
    s_cbranch_vccz .W_307
.A_308:
    buffer_load_dwordx4 v[96:99], v233, s[8:11], s29 offen sc1
    s_waitcnt vmcnt(2)
    v_max_u32 v4, v100, v102
    v_cmp_eq_u32 vcc, -1, v4
    s_cbranch_vccnz .A_306
.W_309:
    v_mfma_f32_16x16x32_bf16 v[208:211], v[140:143], v[100:103], v[208:211]
    s_waitcnt vmcnt(1)
    v_max_u32 v4, v92, v94
    v_cmp_eq_u32 vcc, -1, v4
    v_mfma_f32_16x16x32_bf16 v[212:215], v[156:159], v[100:103], v[212:215]
    v_mfma_f32_16x16x32_bf16 v[216:219], v[100:103], v[100:103], v[216:219]
    s_cbranch_vccnz .A_310
.W_311:
    v_mfma_f32_16x16x32_bf16 v[208:211], v[132:135], v[92:95], v[208:211]
    s_waitcnt vmcnt(0)
    v_max_u32 v4, v96, v98
    v_cmp_eq_u32 vcc, -1, v4
    v_mfma_f32_16x16x32_bf16 v[212:215], v[148:151], v[92:95], v[212:215]
    v_mfma_f32_16x16x32_bf16 v[216:219], v[92:95], v[92:95], v[216:219]
    s_cbranch_vccnz .A_312
.W_313:
    v_mfma_f32_16x16x32_bf16 v[208:211], v[136:139], v[96:99], v[208:211]
    s_barrier
    v_mfma_f32_16x16x32_bf16 v[212:215], v[152:155], v[96:99], v[212:215]
    v_mfma_f32_16x16x32_bf16 v[216:219], v[96:99], v[96:99], v[216:219]
    s_branch .mj_223
.W_307:
    v_mfma_f32_16x16x32_bf16 v[208:211], v[136:139], v[96:99], v[208:211]
    s_waitcnt vmcnt(1)
    v_max_u32 v4, v100, v102
    v_cmp_eq_u32 vcc, -1, v4
    v_mfma_f32_16x16x32_bf16 v[212:215], v[152:155], v[96:99], v[212:215]
    v_mfma_f32_16x16x32_bf16 v[216:219], v[96:99], v[96:99], v[216:219]
    s_cbranch_vccnz .A_314
.W_315:
    v_mfma_f32_16x16x32_bf16 v[208:211], v[140:143], v[100:103], v[208:211]
    s_waitcnt vmcnt(0)
    v_max_u32 v4, v92, v94
    v_cmp_eq_u32 vcc, -1, v4
    v_mfma_f32_16x16x32_bf16 v[212:215], v[156:159], v[100:103], v[212:215]
    v_mfma_f32_16x16x32_bf16 v[216:219], v[100:103], v[100:103], v[216:219]
    s_cbranch_vccnz .A_316
.W_317:
    v_mfma_f32_16x16x32_bf16 v[208:211], v[132:135], v[92:95], v[208:211]
    s_barrier
    v_mfma_f32_16x16x32_bf16 v[212:215], v[148:151], v[92:95], v[212:215]
    v_mfma_f32_16x16x32_bf16 v[216:219], v[92:95], v[92:95], v[216:219]
    s_branch .mj_223
.A_318:
    buffer_load_dwordx4 v[96:99], v233, s[8:11], s29 offen sc1
    s_sub_u32 s62, s62, 1
    s_cbranch_scc1 .mg_end_1
    s_waitcnt vmcnt(1)
    v_max_u32 v4, v92, v94
    v_cmp_eq_u32 vcc, -1, v4
    s_cbranch_vccz .W_311
.A_310:
    buffer_load_dwordx4 v[92:95], v232, s[8:11], s29 offen sc1
    s_waitcnt vmcnt(1)
    v_max_u32 v4, v96, v98
    v_cmp_eq_u32 vcc, -1, v4
    s_cbranch_vccnz .A_318
.W_319:
    v_mfma_f32_16x16x32_bf16 v[208:211], v[136:139], v[96:99], v[208:211]
    s_waitcnt vmcnt(0)
    v_max_u32 v4, v92, v94
    v_cmp_eq_u32 vcc, -1, v4
    v_mfma_f32_16x16x32_bf16 v[212:215], v[152:155], v[96:99], v[212:215]
    v_mfma_f32_16x16x32_bf16 v[216:219], v[96:99], v[96:99], v[216:219]
    s_cbranch_vccz .W_317
    s_branch .A_316
.A_320:
    buffer_load_dwordx4 v[92:95], v232, s[8:11], s29 offen sc1
    s_sub_u32 s62, s62, 1
    s_cbranch_scc1 .mg_end_1
    s_waitcnt vmcnt(1)
    v_max_u32 v4, v100, v102
    v_cmp_eq_u32 vcc, -1, v4
    s_cbranch_vccz .W_315
.A_314:
    buffer_load_dwordx4 v[100:103], v234, s[8:11], s29 offen sc1
    s_waitcnt vmcnt(1)
    v_max_u32 v4, v92, v94
    v_cmp_eq_u32 vcc, -1, v4
    s_cbranch_vccnz .A_320
.W_321:
    v_mfma_f32_16x16x32_bf16 v[208:211], v[132:135], v[92:95], v[208:211]
    s_waitcnt vmcnt(0)
    v_max_u32 v4, v100, v102
    v_cmp_eq_u32 vcc, -1, v4
    v_mfma_f32_16x16x32_bf16 v[212:215], v[148:151], v[92:95], v[212:215]
    v_mfma_f32_16x16x32_bf16 v[216:219], v[92:95], v[92:95], v[216:219]
    s_cbranch_vccz .W_229
    s_branch .A_228
.A_322:
    buffer_load_dwordx4 v[100:103], v234, s[8:11], s29 offen sc1
    s_sub_u32 s62, s62, 1
    s_cbranch_scc1 .mg_end_1
    s_waitcnt vmcnt(1)
    v_max_u32 v4, v96, v98
    v_cmp_eq_u32 vcc, -1, v4
    s_cbranch_vccz .W_227
.A_226:
    buffer_load_dwordx4 v[96:99], v233, s[8:11], s29 offen sc1
    s_waitcnt vmcnt(1)
    v_max_u32 v4, v100, v102
    v_cmp_eq_u32 vcc, -1, v4
    s_cbranch_vccnz .A_322
.W_323:
    v_mfma_f32_16x16x32_bf16 v[208:211], v[140:143], v[100:103], v[208:211]
    s_waitcnt vmcnt(0)
    v_max_u32 v4, v96, v98
    v_cmp_eq_u32 vcc, -1, v4
    v_mfma_f32_16x16x32_bf16 v[212:215], v[156:159], v[100:103], v[212:215]
    v_mfma_f32_16x16x32_bf16 v[216:219], v[100:103], v[100:103], v[216:219]
    s_cbranch_vccz .W_313
    s_branch .A_312
.A_316:
    buffer_load_dwordx4 v[92:95], v232, s[8:11], s29 offen sc1
    s_sub_u32 s62, s62, 1
    s_cbranch_scc1 .mg_end_1
    s_waitcnt vmcnt(1)
    v_max3_u32 v4, v92, v93, v94
    v_max_u32 v4, v4, v95
    v_cmp_eq_u32 vcc, -1, v4
    s_cbranch_vccnz .A_316
    v_mfma_f32_16x16x32_bf16 v[208:211], v[132:135], v[92:95], v[208:211]
    s_barrier
    v_mfma_f32_16x16x32_bf16 v[212:215], v[148:151], v[92:95], v[212:215]
    v_mfma_f32_16x16x32_bf16 v[216:219], v[92:95], v[92:95], v[216:219]
    s_branch .mj_223
.A_312:
    buffer_load_dwordx4 v[96:99], v233, s[8:11], s29 offen sc1
    s_sub_u32 s62, s62, 1
    s_cbranch_scc1 .mg_end_1
    s_waitcnt vmcnt(1)
    v_max3_u32 v4, v96, v97, v98
    v_max_u32 v4, v4, v99
    v_cmp_eq_u32 vcc, -1, v4
    s_cbranch_vccnz .A_312
    v_mfma_f32_16x16x32_bf16 v[208:211], v[136:139], v[96:99], v[208:211]
    s_barrier
    v_mfma_f32_16x16x32_bf16 v[212:215], v[152:155], v[96:99], v[212:215]
    v_mfma_f32_16x16x32_bf16 v[216:219], v[96:99], v[96:99], v[216:219]
    s_branch .mj_223
.A_228:
    buffer_load_dwordx4 v[100:103], v234, s[8:11], s29 offen sc1
    s_sub_u32 s62, s62, 1
    s_cbranch_scc1 .mg_end_1
    s_waitcnt vmcnt(1)
    v_max3_u32 v4, v100, v101, v102
    v_max_u32 v4, v4, v103
    v_cmp_eq_u32 vcc, -1, v4
    s_cbranch_vccnz .A_228
    v_mfma_f32_16x16x32_bf16 v[208:211], v[140:143], v[100:103], v[208:211]
    s_barrier
    v_mfma_f32_16x16x32_bf16 v[212:215], v[156:159], v[100:103], v[212:215]
    v_mfma_f32_16x16x32_bf16 v[216:219], v[100:103], v[100:103], v[216:219]
    s_branch .mj_223
.kf_236:
    s_mov_b32 s62, 0
    s_mov_b64 exec, 3
.wf_324:
    buffer_load_dword v244, v253, s[8:11], s89 offen sc1
    s_waitcnt vmcnt(0)
    v_cmp_gt_u32 vcc, s6, v244
    s_cbranch_vccz .wfd_325
    s_sleep 2
    s_add_u32 s62, s62, 1
    s_cmp_gt_u32 s62, 0x400000
    s_cbranch_scc1 .mg_end_1
    s_branch .wf_324

.wfd_325:
    s_mov_b64 exec, -1
    v_readlane_b32 s4, v244, 0
    v_readlane_b32 s93, v244, 1
    s_min_u32 s93, s93, s4
    s_mov_b32 s62, 0x1000000
    s_branch .kb_237
.A_326:
    buffer_load_dwordx4 v[216:219], v246, s[8:11], s32 offen offset:0 sc1
    buffer_load_dwordx4 v[220:223], v246, s[8:11], s32 offen offset:1024 sc1
    s_sub_u32 s62, s62, 1
    s_cbranch_scc1 .mg_end_1
    s_waitcnt vmcnt(6)
    v_max_u32 v4, v192, v196
    v_cmp_eq_u32 vcc, -1, v4
    s_cbranch_vccz .W_240
.A_239:
    buffer_load_dwordx4 v[192:195], v243, s[8:11], s32 offen offset:0 sc1
    buffer_load_dwordx4 v[196:199], v243, s[8:11], s32 offen offset:1024 sc1
    s_waitcnt vmcnt(6)
    v_max_u32 v4, v200, v204
    v_cmp_eq_u32 vcc, -1, v4
    s_cbranch_vccz .W_327
.A_328:
    buffer_load_dwordx4 v[200:203], v252, s[8:11], s32 offen offset:0 sc1
    buffer_load_dwordx4 v[204:207], v252, s[8:11], s32 offen offset:1024 sc1
    s_waitcnt vmcnt(6)
    v_max_u32 v4, v208, v212
    v_cmp_eq_u32 vcc, -1, v4
    s_cbranch_vccz .W_329
.A_330:
    buffer_load_dwordx4 v[208:211], v254, s[8:11], s32 offen offset:0 sc1
    buffer_load_dwordx4 v[212:215], v254, s[8:11], s32 offen offset:1024 sc1
    s_waitcnt vmcnt(6)
    v_max_u32 v4, v216, v220
    v_cmp_eq_u32 vcc, -1, v4
    s_cbranch_vccnz .A_326
.W_331:
    v_smfmac_f32_16x16x64_bf16 v[76:79], v[216:219], v[140:147], v9
    s_waitcnt vmcnt(4)
    v_max_u32 v4, v192, v196
    v_cmp_eq_u32 vcc, -1, v4
    v_smfmac_f32_16x16x64_bf16 v[80:83], v[216:219], v[172:179], v9
    v_smfmac_f32_16x16x64_bf16 v[76:79], v[220:223], v[148:155], v9
    v_smfmac_f32_16x16x64_bf16 v[80:83], v[220:223], v[180:187], v9
    s_cbranch_vccnz .A_332
.W_333:
    v_smfmac_f32_16x16x64_bf16 v[76:79], v[192:195], a[192:199], v9
    s_waitcnt vmcnt(2)
    v_max_u32 v4, v200, v204
    v_cmp_eq_u32 vcc, -1, v4
    v_smfmac_f32_16x16x64_bf16 v[80:83], v[192:195], a[224:231], v9
    v_smfmac_f32_16x16x64_bf16 v[76:79], v[196:199], a[200:207], v9
    v_smfmac_f32_16x16x64_bf16 v[80:83], v[196:199], a[232:239], v9
    s_cbranch_vccnz .A_334
.W_335:
    v_smfmac_f32_16x16x64_bf16 v[76:79], v[200:203], a[208:215], v9
    s_waitcnt vmcnt(0)
    v_max_u32 v4, v208, v212
    v_cmp_eq_u32 vcc, -1, v4
    v_smfmac_f32_16x16x64_bf16 v[80:83], v[200:203], a[240:247], v9
    v_smfmac_f32_16x16x64_bf16 v[76:79], v[204:207], a[216:223], v9
    v_smfmac_f32_16x16x64_bf16 v[80:83], v[204:207], a[248:255], v9
    s_cbranch_vccnz .A_336
.W_337:
    s_barrier
    v_smfmac_f32_16x16x64_bf16 v[76:79], v[208:211], v[124:131], v9
    v_smfmac_f32_16x16x64_bf16 v[80:83], v[208:211], v[156:163], v9
    v_smfmac_f32_16x16x64_bf16 v[76:79], v[212:215], v[132:139], v9
    v_smfmac_f32_16x16x64_bf16 v[80:83], v[212:215], v[164:171], v9
    s_branch .mj_238
.W_327:
    v_smfmac_f32_16x16x64_bf16 v[76:79], v[200:203], a[208:215], v9
    s_waitcnt vmcnt(4)
    v_max_u32 v4, v208, v212
    v_cmp_eq_u32 vcc, -1, v4
    v_smfmac_f32_16x16x64_bf16 v[80:83], v[200:203], a[240:247], v9
    v_smfmac_f32_16x16x64_bf16 v[76:79], v[204:207], a[216:223], v9
    v_smfmac_f32_16x16x64_bf16 v[80:83], v[204:207], a[248:255], v9
    s_cbranch_vccnz .A_338
.W_339:
    v_smfmac_f32_16x16x64_bf16 v[76:79], v[208:211], v[124:131], v9
    s_waitcnt vmcnt(2)
    v_max_u32 v4, v216, v220
    v_cmp_eq_u32 vcc, -1, v4
    v_smfmac_f32_16x16x64_bf16 v[80:83], v[208:211], v[156:163], v9
    v_smfmac_f32_16x16x64_bf16 v[76:79], v[212:215], v[132:139], v9
    v_smfmac_f32_16x16x64_bf16 v[80:83], v[212:215], v[164:171], v9
    s_cbranch_vccnz .A_340
.W_341:
    v_smfmac_f32_16x16x64_bf16 v[76:79], v[216:219], v[140:147], v9
    s_waitcnt vmcnt(0)
    v_max_u32 v4, v192, v196
    v_cmp_eq_u32 vcc, -1, v4
    v_smfmac_f32_16x16x64_bf16 v[80:83], v[216:219], v[172:179], v9
    v_smfmac_f32_16x16x64_bf16 v[76:79], v[220:223], v[148:155], v9
    v_smfmac_f32_16x16x64_bf16 v[80:83], v[220:223], v[180:187], v9
    s_cbranch_vccnz .A_342
.W_343:
    s_barrier
    v_smfmac_f32_16x16x64_bf16 v[76:79], v[192:195], a[192:199], v9
    v_smfmac_f32_16x16x64_bf16 v[80:83], v[192:195], a[224:231], v9
    v_smfmac_f32_16x16x64_bf16 v[76:79], v[196:199], a[200:207], v9
    v_smfmac_f32_16x16x64_bf16 v[80:83], v[196:199], a[232:239], v9
    s_branch .mj_238
.W_329:
    v_smfmac_f32_16x16x64_bf16 v[76:79], v[208:211], v[124:131], v9
    s_waitcnt vmcnt(4)
    v_max_u32 v4, v216, v220
    v_cmp_eq_u32 vcc, -1, v4
    v_smfmac_f32_16x16x64_bf16 v[80:83], v[208:211], v[156:163], v9
    v_smfmac_f32_16x16x64_bf16 v[76:79], v[212:215], v[132:139], v9
    v_smfmac_f32_16x16x64_bf16 v[80:83], v[212:215], v[164:171], v9
    s_cbranch_vccnz .A_344
.W_345:
    v_smfmac_f32_16x16x64_bf16 v[76:79], v[216:219], v[140:147], v9
    s_waitcnt vmcnt(2)
    v_max_u32 v4, v192, v196
    v_cmp_eq_u32 vcc, -1, v4
    v_smfmac_f32_16x16x64_bf16 v[80:83], v[216:219], v[172:179], v9
    v_smfmac_f32_16x16x64_bf16 v[76:79], v[220:223], v[148:155], v9
    v_smfmac_f32_16x16x64_bf16 v[80:83], v[220:223], v[180:187], v9
    s_cbranch_vccnz .A_346
.W_347:
    v_smfmac_f32_16x16x64_bf16 v[76:79], v[192:195], a[192:199], v9
    s_waitcnt vmcnt(0)
    v_max_u32 v4, v200, v204
    v_cmp_eq_u32 vcc, -1, v4
    v_smfmac_f32_16x16x64_bf16 v[80:83], v[192:195], a[224:231], v9
    v_smfmac_f32_16x16x64_bf16 v[76:79], v[196:199], a[200:207], v9
    v_smfmac_f32_16x16x64_bf16 v[80:83], v[196:199], a[232:239], v9
    s_cbranch_vccnz .A_348
.W_349:
    s_barrier
    v_smfmac_f32_16x16x64_bf16 v[76:79], v[200:203], a[208:215], v9
    v_smfmac_f32_16x16x64_bf16 v[80:83], v[200:203], a[240:247], v9
    v_smfmac_f32_16x16x64_bf16 v[76:79], v[204:207], a[216:223], v9
    v_smfmac_f32_16x16x64_bf16 v[80:83], v[204:207], a[248:255], v9
    s_branch .mj_238
.A_350:
    buffer_load_dwordx4 v[208:211], v254, s[8:11], s32 offen offset:0 sc1
    buffer_load_dwordx4 v[212:215], v254, s[8:11], s32 offen offset:1024 sc1
    s_sub_u32 s62, s62, 1
    s_cbranch_scc1 .mg_end_1
    s_waitcnt vmcnt(4)
    v_max_u32 v4, v192, v196
    v_cmp_eq_u32 vcc, -1, v4
    s_cbranch_vccz .W_333
.A_332:
    buffer_load_dwordx4 v[192:195], v243, s[8:11], s32 offen offset:0 sc1
    buffer_load_dwordx4 v[196:199], v243, s[8:11], s32 offen offset:1024 sc1
    s_waitcnt vmcnt(4)
    v_max_u32 v4, v200, v204
    v_cmp_eq_u32 vcc, -1, v4
    s_cbranch_vccz .W_351
.A_352:
    buffer_load_dwordx4 v[200:203], v252, s[8:11], s32 offen offset:0 sc1
    buffer_load_dwordx4 v[204:207], v252, s[8:11], s32 offen offset:1024 sc1
    s_waitcnt vmcnt(4)
    v_max_u32 v4, v208, v212
    v_cmp_eq_u32 vcc, -1, v4
    s_cbranch_vccnz .A_350
.W_353:
    v_smfmac_f32_16x16x64_bf16 v[76:79], v[208:211], v[124:131], v9
    s_waitcnt vmcnt(2)
    v_max_u32 v4, v192, v196
    v_cmp_eq_u32 vcc, -1, v4
    v_smfmac_f32_16x16x64_bf16 v[80:83], v[208:211], v[156:163], v9
    v_smfmac_f32_16x16x64_bf16 v[76:79], v[212:215], v[132:139], v9
    v_smfmac_f32_16x16x64_bf16 v[80:83], v[212:215], v[164:171], v9
    s_cbranch_vccz .W_347
    s_branch .A_346
.W_351:
    v_smfmac_f32_16x16x64_bf16 v[76:79], v[200:203], a[208:215], v9
    s_waitcnt vmcnt(2)
    v_max_u32 v4, v208, v212
    v_cmp_eq_u32 vcc, -1, v4
    v_smfmac_f32_16x16x64_bf16 v[80:83], v[200:203], a[240:247], v9
    v_smfmac_f32_16x16x64_bf16 v[76:79], v[204:207], a[216:223], v9
    v_smfmac_f32_16x16x64_bf16 v[80:83], v[204:207], a[248:255], v9
    s_cbranch_vccnz .A_354
.W_355:
    v_smfmac_f32_16x16x64_bf16 v[76:79], v[208:211], v[124:131], v9
    s_waitcnt vmcnt(0)
    v_max_u32 v4, v192, v196
    v_cmp_eq_u32 vcc, -1, v4
    v_smfmac_f32_16x16x64_bf16 v[80:83], v[208:211], v[156:163], v9
    v_smfmac_f32_16x16x64_bf16 v[76:79], v[212:215], v[132:139], v9
    v_smfmac_f32_16x16x64_bf16 v[80:83], v[212:215], v[164:171], v9
    s_cbranch_vccz .W_343
    s_branch .A_342
.A_356:
    buffer_load_dwordx4 v[200:203], v252, s[8:11], s32 offen offset:0 sc1
    buffer_load_dwordx4 v[204:207], v252, s[8:11], s32 offen offset:1024 sc1
    s_sub_u32 s62, s62, 1
    s_cbranch_scc1 .mg_end_1
    s_waitcnt vmcnt(4)
    v_max_u32 v4, v216, v220
    v_cmp_eq_u32 vcc, -1, v4
    s_cbranch_vccz .W_345
.A_344:
    buffer_load_dwordx4 v[216:219], v246, s[8:11], s32 offen offset:0 sc1
    buffer_load_dwordx4 v[220:223], v246, s[8:11], s32 offen offset:1024 sc1
    s_waitcnt vmcnt(4)
    v_max_u32 v4, v192, v196
    v_cmp_eq_u32 vcc, -1, v4
    s_cbranch_vccz .W_357
.A_358:
    buffer_load_dwordx4 v[192:195], v243, s[8:11], s32 offen offset:0 sc1
    buffer_load_dwordx4 v[196:199], v243, s[8:11], s32 offen offset:1024 sc1
    s_waitcnt vmcnt(4)
    v_max_u32 v4, v200, v204
    v_cmp_eq_u32 vcc, -1, v4
    s_cbranch_vccnz .A_356
.W_359:
    v_smfmac_f32_16x16x64_bf16 v[76:79], v[200:203], a[208:215], v9
    s_waitcnt vmcnt(2)
    v_max_u32 v4, v216, v220
    v_cmp_eq_u32 vcc, -1, v4
    v_smfmac_f32_16x16x64_bf16 v[80:83], v[200:203], a[240:247], v9
    v_smfmac_f32_16x16x64_bf16 v[76:79], v[204:207], a[216:223], v9
    v_smfmac_f32_16x16x64_bf16 v[80:83], v[204:207], a[248:255], v9
    s_cbranch_vccz .W_341
    s_branch .A_340
.W_357:
    v_smfmac_f32_16x16x64_bf16 v[76:79], v[192:195], a[192:199], v9
    s_waitcnt vmcnt(2)
    v_max_u32 v4, v200, v204
    v_cmp_eq_u32 vcc, -1, v4
    v_smfmac_f32_16x16x64_bf16 v[80:83], v[192:195], a[224:231], v9
    v_smfmac_f32_16x16x64_bf16 v[76:79], v[196:199], a[200:207], v9
    v_smfmac_f32_16x16x64_bf16 v[80:83], v[196:199], a[232:239], v9
    s_cbranch_vccnz .A_360
.W_361:
    v_smfmac_f32_16x16x64_bf16 v[76:79], v[200:203], a[208:215], v9
    s_waitcnt vmcnt(0)
    v_max_u32 v4, v216, v220
    v_cmp_eq_u32 vcc, -1, v4
    v_smfmac_f32_16x16x64_bf16 v[80:83], v[200:203], a[240:247], v9
    v_smfmac_f32_16x16x64_bf16 v[76:79], v[204:207], a[216:223], v9
    v_smfmac_f32_16x16x64_bf16 v[80:83], v[204:207], a[248:255], v9
    s_cbranch_vccz .W_246
    s_branch .A_245
.A_362:
    buffer_load_dwordx4 v[216:219], v246, s[8:11], s32 offen offset:0 sc1
    buffer_load_dwordx4 v[220:223], v246, s[8:11], s32 offen offset:1024 sc1
    s_sub_u32 s62, s62, 1
    s_cbranch_scc1 .mg_end_1
    s_waitcnt vmcnt(4)
    v_max_u32 v4, v192, v196
    v_cmp_eq_u32 vcc, -1, v4
    s_cbranch_vccz .W_363
.A_364:
    buffer_load_dwordx4 v[192:195], v243, s[8:11], s32 offen offset:0 sc1
    buffer_load_dwordx4 v[196:199], v243, s[8:11], s32 offen offset:1024 sc1
    s_waitcnt vmcnt(4)
    v_max_u32 v4, v208, v212
    v_cmp_eq_u32 vcc, -1, v4
    s_cbranch_vccz .W_339
.A_338:
    buffer_load_dwordx4 v[208:211], v254, s[8:11], s32 offen offset:0 sc1
    buffer_load_dwordx4 v[212:215], v254, s[8:11], s32 offen offset:1024 sc1
    s_waitcnt vmcnt(4)
    v_max_u32 v4, v216, v220
    v_cmp_eq_u32 vcc, -1, v4
    s_cbranch_vccnz .A_362
.W_365:
    v_smfmac_f32_16x16x64_bf16 v[76:79], v[216:219], v[140:147], v9
    s_waitcnt vmcnt(2)
    v_max_u32 v4, v192, v196
    v_cmp_eq_u32 vcc, -1, v4
    v_smfmac_f32_16x16x64_bf16 v[80:83], v[216:219], v[172:179], v9
    v_smfmac_f32_16x16x64_bf16 v[76:79], v[220:223], v[148:155], v9
    v_smfmac_f32_16x16x64_bf16 v[80:83], v[220:223], v[180:187], v9
    s_cbranch_vccnz .A_366
.W_367:
    v_smfmac_f32_16x16x64_bf16 v[76:79], v[192:195], a[192:199], v9
    s_waitcnt vmcnt(0)
    v_max_u32 v4, v208, v212
    v_cmp_eq_u32 vcc, -1, v4
    v_smfmac_f32_16x16x64_bf16 v[80:83], v[192:195], a[224:231], v9
    v_smfmac_f32_16x16x64_bf16 v[76:79], v[196:199], a[200:207], v9
    v_smfmac_f32_16x16x64_bf16 v[80:83], v[196:199], a[232:239], v9
    s_cbranch_vccz .W_337
    s_branch .A_336
.W_363:
    v_smfmac_f32_16x16x64_bf16 v[76:79], v[192:195], a[192:199], v9
    s_waitcnt vmcnt(2)
    v_max_u32 v4, v208, v212
    v_cmp_eq_u32 vcc, -1, v4
    v_smfmac_f32_16x16x64_bf16 v[80:83], v[192:195], a[224:231], v9
    v_smfmac_f32_16x16x64_bf16 v[76:79], v[196:199], a[200:207], v9
    v_smfmac_f32_16x16x64_bf16 v[80:83], v[196:199], a[232:239], v9
    s_cbranch_vccz .W_244
    s_branch .A_243
.A_368:
    buffer_load_dwordx4 v[216:219], v246, s[8:11], s32 offen offset:0 sc1
    buffer_load_dwordx4 v[220:223], v246, s[8:11], s32 offen offset:1024 sc1
    s_sub_u32 s62, s62, 1
    s_cbranch_scc1 .mg_end_1
    s_waitcnt vmcnt(4)
    v_max_u32 v4, v200, v204
    v_cmp_eq_u32 vcc, -1, v4
    s_cbranch_vccz .W_242
.A_241:
    buffer_load_dwordx4 v[200:203], v252, s[8:11], s32 offen offset:0 sc1
    buffer_load_dwordx4 v[204:207], v252, s[8:11], s32 offen offset:1024 sc1
    s_waitcnt vmcnt(4)
    v_max_u32 v4, v208, v212
    v_cmp_eq_u32 vcc, -1, v4
    s_cbranch_vccz .W_369
.A_370:
    buffer_load_dwordx4 v[208:211], v254, s[8:11], s32 offen offset:0 sc1
    buffer_load_dwordx4 v[212:215], v254, s[8:11], s32 offen offset:1024 sc1
    s_waitcnt vmcnt(4)
    v_max_u32 v4, v216, v220
    v_cmp_eq_u32 vcc, -1, v4
    s_cbranch_vccnz .A_368
.W_371:
    v_smfmac_f32_16x16x64_bf16 v[76:79], v[216:219], v[140:147], v9
    s_waitcnt vmcnt(2)
    v_max_u32 v4, v200, v204
    v_cmp_eq_u32 vcc, -1, v4
    v_smfmac_f32_16x16x64_bf16 v[80:83], v[216:219], v[172:179], v9
    v_smfmac_f32_16x16x64_bf16 v[76:79], v[220:223], v[148:155], v9
    v_smfmac_f32_16x16x64_bf16 v[80:83], v[220:223], v[180:187], v9
    s_cbranch_vccz .W_335
    s_branch .A_334
.W_369:
    v_smfmac_f32_16x16x64_bf16 v[76:79], v[208:211], v[124:131], v9
    s_waitcnt vmcnt(2)
    v_max_u32 v4, v216, v220
    v_cmp_eq_u32 vcc, -1, v4
    v_smfmac_f32_16x16x64_bf16 v[80:83], v[208:211], v[156:163], v9
    v_smfmac_f32_16x16x64_bf16 v[76:79], v[212:215], v[132:139], v9
    v_smfmac_f32_16x16x64_bf16 v[80:83], v[212:215], v[164:171], v9
    s_cbranch_vccnz .A_372
.W_373:
    v_smfmac_f32_16x16x64_bf16 v[76:79], v[216:219], v[140:147], v9
    s_waitcnt vmcnt(0)
    v_max_u32 v4, v200, v204
    v_cmp_eq_u32 vcc, -1, v4
    v_smfmac_f32_16x16x64_bf16 v[80:83], v[216:219], v[172:179], v9
    v_smfmac_f32_16x16x64_bf16 v[76:79], v[220:223], v[148:155], v9
    v_smfmac_f32_16x16x64_bf16 v[80:83], v[220:223], v[180:187], v9
    s_cbranch_vccz .W_349
    s_branch .A_348
.A_374:
    buffer_load_dwordx4 v[200:203], v252, s[8:11], s32 offen offset:0 sc1
    buffer_load_dwordx4 v[204:207], v252, s[8:11], s32 offen offset:1024 sc1
    s_sub_u32 s62, s62, 1
    s_cbranch_scc1 .mg_end_1
    s_waitcnt vmcnt(2)
    v_max_u32 v4, v192, v196
    v_cmp_eq_u32 vcc, -1, v4
    s_cbranch_vccz .W_347
.A_346:
    buffer_load_dwordx4 v[192:195], v243, s[8:11], s32 offen offset:0 sc1
    buffer_load_dwordx4 v[196:199], v243, s[8:11], s32 offen offset:1024 sc1
    s_waitcnt vmcnt(2)
    v_max_u32 v4, v200, v204
    v_cmp_eq_u32 vcc, -1, v4
    s_cbranch_vccnz .A_374
.W_375:
    v_smfmac_f32_16x16x64_bf16 v[76:79], v[200:203], a[208:215], v9
    s_waitcnt vmcnt(0)
    v_max_u32 v4, v192, v196
    v_cmp_eq_u32 vcc, -1, v4
    v_smfmac_f32_16x16x64_bf16 v[80:83], v[200:203], a[240:247], v9
    v_smfmac_f32_16x16x64_bf16 v[76:79], v[204:207], a[216:223], v9
    v_smfmac_f32_16x16x64_bf16 v[80:83], v[204:207], a[248:255], v9
    s_cbranch_vccz .W_343
    s_branch .A_342
.A_354:
    buffer_load_dwordx4 v[208:211], v254, s[8:11], s32 offen offset:0 sc1
    buffer_load_dwordx4 v[212:215], v254, s[8:11], s32 offen offset:1024 sc1
    s_sub_u32 s62, s62, 1
    s_cbranch_scc1 .mg_end_1
    s_waitcnt vmcnt(2)
    v_max_u32 v4, v192, v196
    v_cmp_eq_u32 vcc, -1, v4
    s_cbranch_vccz .W_367
.A_366:
    buffer_load_dwordx4 v[192:195], v243, s[8:11], s32 offen offset:0 sc1
    buffer_load_dwordx4 v[196:199], v243, s[8:11], s32 offen offset:1024 sc1
    s_waitcnt vmcnt(2)
    v_max_u32 v4, v208, v212
    v_cmp_eq_u32 vcc, -1, v4
    s_cbranch_vccnz .A_354
    s_branch .W_355
.A_376:
    buffer_load_dwordx4 v[192:195], v243, s[8:11], s32 offen offset:0 sc1
    buffer_load_dwordx4 v[196:199], v243, s[8:11], s32 offen offset:1024 sc1
    s_sub_u32 s62, s62, 1
    s_cbranch_scc1 .mg_end_1
    s_waitcnt vmcnt(2)
    v_max_u32 v4, v216, v220
    v_cmp_eq_u32 vcc, -1, v4
    s_cbranch_vccz .W_341
.A_340:
    buffer_load_dwordx4 v[216:219], v246, s[8:11], s32 offen offset:0 sc1
    buffer_load_dwordx4 v[220:223], v246, s[8:11], s32 offen offset:1024 sc1
    s_waitcnt vmcnt(2)
    v_max_u32 v4, v192, v196
    v_cmp_eq_u32 vcc, -1, v4
    s_cbranch_vccnz .A_376
.W_377:
    v_smfmac_f32_16x16x64_bf16 v[76:79], v[192:195], a[192:199], v9
    s_waitcnt vmcnt(0)
    v_max_u32 v4, v216, v220
    v_cmp_eq_u32 vcc, -1, v4
    v_smfmac_f32_16x16x64_bf16 v[80:83], v[192:195], a[224:231], v9
    v_smfmac_f32_16x16x64_bf16 v[76:79], v[196:199], a[200:207], v9
    v_smfmac_f32_16x16x64_bf16 v[80:83], v[196:199], a[232:239], v9
    s_cbranch_vccz .W_246
    s_branch .A_245
.A_378:
    buffer_load_dwordx4 v[208:211], v254, s[8:11], s32 offen offset:0 sc1
    buffer_load_dwordx4 v[212:215], v254, s[8:11], s32 offen offset:1024 sc1
    s_sub_u32 s62, s62, 1
    s_cbranch_scc1 .mg_end_1
    s_waitcnt vmcnt(2)
    v_max_u32 v4, v200, v204
    v_cmp_eq_u32 vcc, -1, v4
    s_cbranch_vccz .W_335
.A_334:
    buffer_load_dwordx4 v[200:203], v252, s[8:11], s32 offen offset:0 sc1
    buffer_load_dwordx4 v[204:207], v252, s[8:11], s32 offen offset:1024 sc1
    s_waitcnt vmcnt(2)
    v_max_u32 v4, v208, v212
    v_cmp_eq_u32 vcc, -1, v4
    s_cbranch_vccnz .A_378
.W_379:
    v_smfmac_f32_16x16x64_bf16 v[76:79], v[208:211], v[124:131], v9
    s_waitcnt vmcnt(0)
    v_max_u32 v4, v200, v204
    v_cmp_eq_u32 vcc, -1, v4
    v_smfmac_f32_16x16x64_bf16 v[80:83], v[208:211], v[156:163], v9
    v_smfmac_f32_16x16x64_bf16 v[76:79], v[212:215], v[132:139], v9
    v_smfmac_f32_16x16x64_bf16 v[80:83], v[212:215], v[164:171], v9
    s_cbranch_vccz .W_349
    s_branch .A_348
.A_372:
    buffer_load_dwordx4 v[216:219], v246, s[8:11], s32 offen offset:0 sc1
    buffer_load_dwordx4 v[220:223], v246, s[8:11], s32 offen offset:1024 sc1
    s_sub_u32 s62, s62, 1
    s_cbranch_scc1 .mg_end_1
    s_waitcnt vmcnt(2)
    v_max_u32 v4, v200, v204
    v_cmp_eq_u32 vcc, -1, v4
    s_cbranch_vccz .W_361
.A_360:
    buffer_load_dwordx4 v[200:203], v252, s[8:11], s32 offen offset:0 sc1
    buffer_load_dwordx4 v[204:207], v252, s[8:11], s32 offen offset:1024 sc1
    s_waitcnt vmcnt(2)
    v_max_u32 v4, v216, v220
    v_cmp_eq_u32 vcc, -1, v4
    s_cbranch_vccnz .A_372
    s_branch .W_373
.A_380:
    buffer_load_dwordx4 v[216:219], v246, s[8:11], s32 offen offset:0 sc1
    buffer_load_dwordx4 v[220:223], v246, s[8:11], s32 offen offset:1024 sc1
    s_sub_u32 s62, s62, 1
    s_cbranch_scc1 .mg_end_1
    s_waitcnt vmcnt(2)
    v_max_u32 v4, v208, v212
    v_cmp_eq_u32 vcc, -1, v4
    s_cbranch_vccz .W_244
.A_243:
    buffer_load_dwordx4 v[208:211], v254, s[8:11], s32 offen offset:0 sc1
    buffer_load_dwordx4 v[212:215], v254, s[8:11], s32 offen offset:1024 sc1
    s_waitcnt vmcnt(2)
    v_max_u32 v4, v216, v220
    v_cmp_eq_u32 vcc, -1, v4
    s_cbranch_vccnz .A_380
.W_381:
    v_smfmac_f32_16x16x64_bf16 v[76:79], v[216:219], v[140:147], v9
    s_waitcnt vmcnt(0)
    v_max_u32 v4, v208, v212
    v_cmp_eq_u32 vcc, -1, v4
    v_smfmac_f32_16x16x64_bf16 v[80:83], v[216:219], v[172:179], v9
    v_smfmac_f32_16x16x64_bf16 v[76:79], v[220:223], v[148:155], v9
    v_smfmac_f32_16x16x64_bf16 v[80:83], v[220:223], v[180:187], v9
    s_cbranch_vccz .W_337
    s_branch .A_336
.A_342:
    buffer_load_dwordx4 v[192:195], v243, s[8:11], s32 offen offset:0 sc1
    buffer_load_dwordx4 v[196:199], v243, s[8:11], s32 offen offset:1024 sc1
    s_sub_u32 s62, s62, 1
    s_cbranch_scc1 .mg_end_1
    s_waitcnt vmcnt(2)
    v_max3_u32 v4, v192, v193, v194
    v_max3_u32 v5, v195, v196, v197
    v_max3_u32 v4, v4, v198, v199
    v_max_u32 v4, v4, v5
    v_cmp_eq_u32 vcc, -1, v4
    s_cbranch_vccnz .A_342
    s_barrier
    v_smfmac_f32_16x16x64_bf16 v[76:79], v[192:195], a[192:199], v9
    v_smfmac_f32_16x16x64_bf16 v[80:83], v[192:195], a[224:231], v9
    v_smfmac_f32_16x16x64_bf16 v[76:79], v[196:199], a[200:207], v9
    v_smfmac_f32_16x16x64_bf16 v[80:83], v[196:199], a[232:239], v9
    s_branch .mj_238
.A_348:
    buffer_load_dwordx4 v[200:203], v252, s[8:11], s32 offen offset:0 sc1
    buffer_load_dwordx4 v[204:207], v252, s[8:11], s32 offen offset:1024 sc1
    s_sub_u32 s62, s62, 1
    s_cbranch_scc1 .mg_end_1
    s_waitcnt vmcnt(2)
    v_max3_u32 v4, v200, v201, v202
    v_max3_u32 v5, v203, v204, v205
    v_max3_u32 v4, v4, v206, v207
    v_max_u32 v4, v4, v5
    v_cmp_eq_u32 vcc, -1, v4
    s_cbranch_vccnz .A_348
    s_barrier
    v_smfmac_f32_16x16x64_bf16 v[76:79], v[200:203], a[208:215], v9
    v_smfmac_f32_16x16x64_bf16 v[80:83], v[200:203], a[240:247], v9
    v_smfmac_f32_16x16x64_bf16 v[76:79], v[204:207], a[216:223], v9
    v_smfmac_f32_16x16x64_bf16 v[80:83], v[204:207], a[248:255], v9
    s_branch .mj_238
.A_336:
    buffer_load_dwordx4 v[208:211], v254, s[8:11], s32 offen offset:0 sc1
    buffer_load_dwordx4 v[212:215], v254, s[8:11], s32 offen offset:1024 sc1
    s_sub_u32 s62, s62, 1
    s_cbranch_scc1 .mg_end_1
    s_waitcnt vmcnt(2)
    v_max3_u32 v4, v208, v209, v210
    v_max3_u32 v5, v211, v212, v213
    v_max3_u32 v4, v4, v214, v215
    v_max_u32 v4, v4, v5
    v_cmp_eq_u32 vcc, -1, v4
    s_cbranch_vccnz .A_336
    s_barrier
    v_smfmac_f32_16x16x64_bf16 v[76:79], v[208:211], v[124:131], v9
    v_smfmac_f32_16x16x64_bf16 v[80:83], v[208:211], v[156:163], v9
    v_smfmac_f32_16x16x64_bf16 v[76:79], v[212:215], v[132:139], v9
    v_smfmac_f32_16x16x64_bf16 v[80:83], v[212:215], v[164:171], v9
    s_branch .mj_238
.A_245:
    buffer_load_dwordx4 v[216:219], v246, s[8:11], s32 offen offset:0 sc1
    buffer_load_dwordx4 v[220:223], v246, s[8:11], s32 offen offset:1024 sc1
    s_sub_u32 s62, s62, 1
    s_cbranch_scc1 .mg_end_1
    s_waitcnt vmcnt(2)
    v_max3_u32 v4, v216, v217, v218
    v_max3_u32 v5, v219, v220, v221
    v_max3_u32 v4, v4, v222, v223
    v_max_u32 v4, v4, v5
    v_cmp_eq_u32 vcc, -1, v4
    s_cbranch_vccnz .A_245
    s_barrier
    v_smfmac_f32_16x16x64_bf16 v[76:79], v[216:219], v[140:147], v9
    v_smfmac_f32_16x16x64_bf16 v[80:83], v[216:219], v[172:179], v9
    v_smfmac_f32_16x16x64_bf16 v[76:79], v[220:223], v[148:155], v9
    v_smfmac_f32_16x16x64_bf16 v[80:83], v[220:223], v[180:187], v9
    s_branch .mj_238
.sk_248:
    v_cndmask_b32 v172, v170, v168, s[60:61]
    v_cndmask_b32 v173, v171, v169, s[60:61]

    v_mov_b32 v174, v172
    v_mov_b32 v175, v173
    s_nop 0
    s_nop 0
    v_permlane16_swap_b32 v172, v174
    v_permlane16_swap_b32 v173, v175
    ds_write_b128 v14, v[172:175] offset:17408

    s_mov_b64 exec, s[66:67]
    buffer_store_dwordx4 v[88:91], v11, s[8:11], s36 offen sc1
    s_mov_b64 exec, s[56:57]
    buffer_store_dwordx4 v[172:175], v12, s[8:11], s36 offen sc1
    s_mov_b64 exec, -1

    s_cmp_lt_u32 s28, 63
    s_cbranch_scc1 .sb_249
    s_branch .rec_fin_6
.rec_fin_6:
    s_mov_b64 exec, -1
    s_endpgm
.mg_bg_2:
    s_sub_u32 s91, s25, 4
    s_lshl_b32 s90, s91, 5
    s_add_u32 s90, s90, s26
    s_cmp_ge_u32 s26, 24
    s_cbranch_scc1 .cvrole_382
    s_lshr_b32 s30, s26, 3
    s_sub_u32 s30, 2, s30
    s_and_b32 s31, s26, 7
    s_lshl_b32 s4, s91, 3
    s_add_u32 s31, s31, s4

    s_lshl_b32 s4, s30, 5
    s_add_u32 s4, s4, s31
    s_lshl_b32 s4, s4, 8
    s_add_u32 s4, s4, 92274688
    v_mov_b32 v4, 0
    s_mov_b64 exec, 1
    buffer_store_dword v4, v4, s[8:11], s4 offen sc1
    s_mov_b64 exec, -1

    s_load_dwordx2 s[40:41], s[0:1], 0
    s_load_dwordx4 s[44:47], s[0:1], 64
    s_load_dwordx2 s[42:43], s[0:1], 80

    v_and_b32 v1, 63, v0
    v_and_b32 v2, 15, v1
    v_lshrrev_b32 v3, 4, v1

    s_lshl_b32 s28, s31, 8
    s_waitcnt lgkmcnt(0)
    s_mov_b64 s[48:49], s[42:43]
    s_cmp_eq_u32 s30, 0
    s_cselect_b64 s[42:43], s[44:45], s[42:43]
    s_cmp_eq_u32 s30, 1
    s_cselect_b64 s[42:43], s[46:47], s[42:43]

    s_mov_b32 s16, s40
    s_and_b32 s17, s41, 0xffff
    s_mov_b32 s18, 0x400000
    s_mov_b32 s19, 0x00020000

    s_mov_b32 s12, s42
    s_and_b32 s13, s43, 0xffff
    s_mov_b32 s14, 0x800000
    s_mov_b32 s15, 0x00020000

    v_lshrrev_b32 v4, 1, v2
    v_xor_b32 v4, v4, v3
    v_lshlrev_b32 v4, 1, v4
    v_and_b32 v5, 1, v1
    v_or_b32 v4, v4, v5
    v_lshlrev_b32 v4, 4, v4
    v_lshlrev_b32 v5, 13, v3
    v_add_u32 v10, v4, v5
    v_xor_b32 v11, 0x80, v10
    s_lshl_b32 s4, s24, 18
    s_add_u32 s28, s28, s4
    s_lshl_b32 s29, s24, 13
    v_lshrrev_b32 v4, 2, v2
    v_and_b32 v5, 1, v3
    v_lshl_or_b32 v5, v5, 2, v4
    s_lshl_b32 s4, s24, 1
    v_xor_b32 v5, s4, v5
    v_lshlrev_b32 v5, 5, v5
    v_lshl_add_u32 v4, v3, 3, v4
    v_lshl_add_u32 v5, v4, 8, v5
    v_and_b32 v4, 3, v2
    v_lshl_add_u32 v12, v4, 3, v5
    v_xor_b32 v13, 32, v12
    v_add_u32 v14, 0x10000, v12
    v_add_u32 v15, 0x10000, v13

    s_mov_b32 s63, 0
    s_cmp_lg_u32 s30, 0
    s_cbranch_scc1 .qh_383
    s_cmp_lt_u32 s24, 2
    s_cselect_b64 s[48:49], s[46:47], s[48:49]

    s_mov_b32 s64, s48
    s_and_b32 s65, s49, 0xffff
    s_mov_b32 s66, 0x800000
    s_mov_b32 s67, 0x00020000

    v_lshlrev_b32 v4, 13, v1
    s_and_b32 s4, s24, 1
    s_lshl_b32 s4, s4, 7
    s_lshl_b32 s5, s31, 8
    s_add_u32 s4, s4, s5
    s_add_u32 s4, s4, 3145728
    s_waitcnt vmcnt(0)

    v_mov_b32 v243, s99
    v_mov_b32 v242, 0
    s_cmp_lg_u32 s24, 0
    s_cbranch_scc1 .a1_384
    v_mov_b32 v242, s26
    v_lshlrev_b32 v242, 6, v242
    v_add_u32 v242, s97, v242
    v_and_b32 v242, 255, v242
    s_mov_b64 exec, 1
    buffer_atomic_add v243, v242, s[20:23], 0 offen sc1
    s_mov_b64 exec, -1

.a1_384:
    buffer_load_dword v31, v4, s[64:67], s4 offen
    s_add_u32 s4, s4, 524288
    buffer_load_dword v31, v4, s[64:67], s4 offen
    s_add_u32 s4, s4, 524288
    buffer_load_dword v31, v4, s[64:67], s4 offen
    s_add_u32 s4, s4, 524288
    buffer_load_dword v31, v4, s[64:67], s4 offen
    s_add_u32 s4, s4, 524288
    buffer_load_dword v31, v4, s[64:67], s4 offen
    s_add_u32 s4, s4, 524288
    buffer_load_dword v31, v4, s[64:67], s4 offen
    s_add_u32 s4, s4, 524288
    buffer_load_dword v31, v4, s[64:67], s4 offen
    s_add_u32 s4, s4, 524288
    buffer_load_dword v31, v4, s[64:67], s4 offen
    s_add_u32 s4, s4, 524288
    buffer_load_dword v31, v4, s[64:67], s4 offen
    s_add_u32 s4, s4, 524288
    buffer_load_dword v31, v4, s[64:67], s4 offen
    s_add_u32 s4, s4, 524288
    s_waitcnt vmcnt(0)
    s_mov_b32 s63, 99
.qh_383:
    s_and_b32 s4, s26, 7
    s_lshl_b32 s4, s4, 1
    s_lshr_b32 s5, s24, 1
    s_add_u32 s4, s4, s5
    s_lshl_b32 s4, s4, 6
    v_add_u32 v4, s4, v1
    v_lshlrev_b32 v4, 13, v4
    s_and_b32 s4, s24, 1
    s_lshl_b32 s4, s4, 10
    s_lshl_b32 s5, s91, 11
    s_add_u32 s4, s4, s5
    buffer_load_dword v31, v4, s[12:15], s4 offen offset:384

    s_add_u32 m0, s29, 98304
    s_add_u32 s4, s28, 0
    buffer_load_dwordx4 v10, s[12:15], s4 offen lds

    s_add_u32 m0, s29, 99328
    s_add_u32 s4, s28, 32768
    buffer_load_dwordx4 v10, s[12:15], s4 offen lds

    s_add_u32 m0, s29, 100352
    s_add_u32 s4, s28, 65536
    buffer_load_dwordx4 v11, s[12:15], s4 offen lds

    s_add_u32 m0, s29, 101376
    s_add_u32 s4, s28, 98304
    buffer_load_dwordx4 v11, s[12:15], s4 offen lds

    s_add_u32 m0, s29, 102400
    s_add_u32 s4, s28, 131072
    buffer_load_dwordx4 v10, s[12:15], s4 offen lds

    s_add_u32 m0, s29, 103424
    s_add_u32 s4, s28, 163840
    buffer_load_dwordx4 v10, s[12:15], s4 offen lds

    s_add_u32 m0, s29, 104448
    s_add_u32 s4, s28, 196608
    buffer_load_dwordx4 v11, s[12:15], s4 offen lds

    s_add_u32 m0, s29, 105472
    s_add_u32 s4, s28, 229376
    buffer_load_dwordx4 v11, s[12:15], s4 offen lds

    s_waitcnt vmcnt(9)
    v_mov_b32 v243, s99
    v_mov_b32 v242, 0
    s_cmp_lg_u32 s24, s63
    s_cbranch_scc1 .a1_386
    v_mov_b32 v242, s26
    v_lshlrev_b32 v242, 6, v242
    v_add_u32 v242, s97, v242
    v_and_b32 v242, 255, v242
    s_mov_b64 exec, 1
    buffer_atomic_add v243, v242, s[20:23], 0 offen sc1
    s_mov_b64 exec, -1

.a1_386:
    v_lshrrev_b32 v4, 3, v1
    v_and_b32 v5, 7, v1
    v_xor_b32 v5, v5, v4
    v_lshlrev_b32 v5, 4, v5
    v_lshl_add_u32 v16, v4, 11, v5
    s_lshl_b32 s4, s24, 14
    v_add_u32 v16, s4, v16
    v_and_b32 v4, 7, v2
    v_xor_b32 v5, v4, v3
    v_lshlrev_b32 v5, 4, v5
    v_lshl_add_u32 v5, v4, 7, v5
    v_lshrrev_b32 v4, 3, v2
    v_lshl_add_u32 v17, v4, 13, v5
    v_xor_b32 v18, 64, v17
    v_add_u32 v19, 0x10000, v17
    v_add_u32 v20, 0x10000, v18
    v_lshlrev_b32 v21, 4, v1
    s_lshl_b32 s32, s30, 24
    s_lshl_b32 s4, s31, 13
    s_add_u32 s32, s32, s4
    s_lshr_b32 s5, s30, 1
    s_add_u32 s5, s5, 10
    s_lshl_b32 s4, s24, s5
    s_add_u32 s39, s32, s4
    s_mov_b32 s32, s39
    s_add_u32 s38, s39, 4096
    s_mul_i32 s49, s31, 6144
    s_lshl_b32 s4, s30, 11
    s_add_u32 s49, s49, s4
    s_lshl_b32 s4, s24, 9
    s_add_u32 s49, s49, s4
    s_add_u32 s49, s49, 67108864
    s_mov_b32 s48, s49
    v_mov_b32 v23, -1
    s_lshl_b32 s4, s30, 5
    s_add_u32 s4, s4, s31
    s_lshl_b32 s4, s4, 8
    s_add_u32 s33, s4, 92274688
    s_cmp_eq_u32 s24, 0
    s_cselect_b32 s36, 1, 0
    s_mov_b32 s37, 0
    v_mov_b32 v22, 0
    s_mov_b32 s34, 0
    s_mov_b32 s35, 0
    s_and_b32 s4, s26, 7
    s_lshl_b32 s4, s4, 2
    s_add_u32 s4, s4, s24
    s_lshl_b32 s4, s4, 11
    v_lshlrev_b32 v111, 5, v1
    v_add_u32 v111, s4, v111

    s_mul_i32 s47, s26, 1507328
    s_lshl_b32 s4, s24, 10
    s_add_u32 s47, s47, s4
    s_add_u32 s47, s47, 184549376
    v_mov_b32 v24, -1
    v_mov_b32 v25, -1
    v_mov_b32 v26, -1
    v_mov_b32 v27, -1

    s_xor_b32 s4, s91, 1
    s_lshl_b32 s5, s4, 14
    s_lshl_b32 s6, s91, 12
    s_add_u32 s5, s5, s6
    v_add_u32 v28, s5, v21
    s_lshl_b32 s5, s91, 14
    s_lshl_b32 s6, s4, 12
    s_add_u32 s5, s5, s6
    v_add_u32 v7, s5, v21

    s_xor_b32 s4, s91, 2
    s_lshl_b32 s5, s4, 14
    s_lshl_b32 s6, s91, 12
    s_add_u32 s5, s5, s6
    v_add_u32 v29, s5, v21
    s_lshl_b32 s5, s91, 14
    s_lshl_b32 s6, s4, 12
    s_add_u32 s5, s5, s6
    v_add_u32 v8, s5, v21

    s_xor_b32 s4, s91, 3
    s_lshl_b32 s5, s4, 14
    s_lshl_b32 s6, s91, 12
    s_add_u32 s5, s5, s6
    v_add_u32 v30, s5, v21
    s_lshl_b32 s5, s91, 14
    s_lshl_b32 s6, s4, 12
    s_add_u32 s5, s5, s6
    v_add_u32 v9, s5, v21

    s_mov_b64 s[44:45], -1
    s_mov_b32 s46, s47
    s_add_u32 s39, s39, 262144
    s_add_u32 s49, s49, 196608
    v_mov_b32 v23, 0
    v_add_u32 v113, 0x20000, v17
    v_add_u32 v114, 0x20000, v18
    s_barrier

    s_add_u32 m0, s29, 131072
    s_nop 0
    buffer_load_dwordx4 v16, s[16:19], s34 offen offset:0 lds
    s_add_u32 m0, s29, 131968
    s_nop 0
    buffer_load_dwordx4 v16, s[16:19], s34 offen offset:128 lds
    s_add_u32 m0, s29, 132864
    s_nop 0
    buffer_load_dwordx4 v16, s[16:19], s34 offen offset:256 lds
    s_add_u32 m0, s29, 133760
    s_nop 0
    buffer_load_dwordx4 v16, s[16:19], s34 offen offset:384 lds
    s_add_u32 m0, s29, 134656
    s_nop 0
    buffer_load_dwordx4 v16, s[16:19], s34 offen offset:512 lds
    s_add_u32 m0, s29, 135552
    s_nop 0
    buffer_load_dwordx4 v16, s[16:19], s34 offen offset:640 lds
    s_add_u32 m0, s29, 136448
    s_nop 0
    buffer_load_dwordx4 v16, s[16:19], s34 offen offset:768 lds
    s_add_u32 m0, s29, 137344
    s_nop 0
    buffer_load_dwordx4 v16, s[16:19], s34 offen offset:896 lds
    s_add_u32 s34, s34, 1024
    s_add_u32 m0, s29, 0
    s_add_u32 s4, s28, 1048576
    buffer_load_dwordx4 v10, s[12:15], s4 offen lds

    s_add_u32 m0, s29, 1024
    s_add_u32 s4, s28, 1081344
    buffer_load_dwordx4 v10, s[12:15], s4 offen lds

    s_add_u32 m0, s29, 2048
    s_add_u32 s4, s28, 1114112
    buffer_load_dwordx4 v11, s[12:15], s4 offen lds

    s_add_u32 m0, s29, 3072
    s_add_u32 s4, s28, 1146880
    buffer_load_dwordx4 v11, s[12:15], s4 offen lds

    s_add_u32 m0, s29, 4096
    s_add_u32 s4, s28, 1179648
    buffer_load_dwordx4 v10, s[12:15], s4 offen lds

    s_add_u32 m0, s29, 5120
    s_add_u32 s4, s28, 1212416
    buffer_load_dwordx4 v10, s[12:15], s4 offen lds

    s_add_u32 m0, s29, 6144
    s_add_u32 s4, s28, 1245184
    buffer_load_dwordx4 v11, s[12:15], s4 offen lds

    s_add_u32 m0, s29, 7168
    s_add_u32 s4, s28, 1277952
    buffer_load_dwordx4 v11, s[12:15], s4 offen lds

    s_add_u32 m0, s29, 65536
    s_add_u32 s4, s28, 2097152
    buffer_load_dwordx4 v10, s[12:15], s4 offen lds

    s_add_u32 m0, s29, 66560
    s_add_u32 s4, s28, 2129920
    buffer_load_dwordx4 v10, s[12:15], s4 offen lds

    s_add_u32 m0, s29, 67584
    s_add_u32 s4, s28, 2162688
    buffer_load_dwordx4 v11, s[12:15], s4 offen lds

    s_add_u32 m0, s29, 68608
    s_add_u32 s4, s28, 2195456
    buffer_load_dwordx4 v11, s[12:15], s4 offen lds

    s_add_u32 m0, s29, 69632
    s_add_u32 s4, s28, 2228224
    buffer_load_dwordx4 v10, s[12:15], s4 offen lds

    s_add_u32 m0, s29, 70656
    s_add_u32 s4, s28, 2260992
    buffer_load_dwordx4 v10, s[12:15], s4 offen lds

    s_add_u32 m0, s29, 71680
    s_add_u32 s4, s28, 2293760
    buffer_load_dwordx4 v11, s[12:15], s4 offen lds

    s_add_u32 m0, s29, 72704
    s_add_u32 s4, s28, 2326528
    buffer_load_dwordx4 v11, s[12:15], s4 offen lds

    s_waitcnt vmcnt(16)
    s_barrier
    ds_read_b64_tr_b16 a[0:1], v14 offset:32768
    ds_read_b64_tr_b16 a[2:3], v14 offset:33792
    ds_read_b64_tr_b16 a[4:5], v15 offset:32768
    ds_read_b64_tr_b16 a[6:7], v15 offset:33792
    ds_read_b64_tr_b16 a[8:9], v14 offset:40960
    ds_read_b64_tr_b16 a[10:11], v14 offset:41984
    ds_read_b64_tr_b16 a[12:13], v15 offset:40960
    ds_read_b64_tr_b16 a[14:15], v15 offset:41984
    ds_read_b64_tr_b16 a[16:17], v14 offset:49152
    ds_read_b64_tr_b16 a[18:19], v14 offset:50176
    ds_read_b64_tr_b16 a[20:21], v15 offset:49152
    ds_read_b64_tr_b16 a[22:23], v15 offset:50176
    ds_read_b64_tr_b16 a[24:25], v14 offset:57344
    ds_read_b64_tr_b16 a[26:27], v14 offset:58368
    ds_read_b64_tr_b16 a[28:29], v15 offset:57344
    ds_read_b64_tr_b16 a[30:31], v15 offset:58368
    ds_read_b128 v[32:35], v113 offset:0
    ds_read_b128 v[36:39], v113 offset:16384
    ds_read_b128 v[40:43], v114 offset:0
    ds_read_b128 v[44:47], v114 offset:16384
    ds_read_b128 v[48:51], v113 offset:1024
    ds_read_b128 v[52:55], v113 offset:17408
    ds_read_b128 v[56:59], v114 offset:1024
    ds_read_b128 v[60:63], v114 offset:17408
    s_waitcnt lgkmcnt(0)
    s_barrier
    s_add_u32 m0, s29, 98304
    s_add_u32 s4, s28, 3145728
    buffer_load_dwordx4 v10, s[12:15], s4 offen lds

    s_add_u32 m0, s29, 99328
    s_add_u32 s4, s28, 3178496
    buffer_load_dwordx4 v10, s[12:15], s4 offen lds

    s_add_u32 m0, s29, 100352
    s_add_u32 s4, s28, 3211264
    buffer_load_dwordx4 v11, s[12:15], s4 offen lds

    s_add_u32 m0, s29, 101376
    s_add_u32 s4, s28, 3244032
    buffer_load_dwordx4 v11, s[12:15], s4 offen lds

    s_add_u32 m0, s29, 102400
    s_add_u32 s4, s28, 3276800
    buffer_load_dwordx4 v10, s[12:15], s4 offen lds

    s_add_u32 m0, s29, 103424
    s_add_u32 s4, s28, 3309568
    buffer_load_dwordx4 v10, s[12:15], s4 offen lds

    s_add_u32 m0, s29, 104448
    s_add_u32 s4, s28, 3342336
    buffer_load_dwordx4 v11, s[12:15], s4 offen lds

    s_add_u32 m0, s29, 105472
    s_add_u32 s4, s28, 3375104
    buffer_load_dwordx4 v11, s[12:15], s4 offen lds

    s_add_u32 m0, s29, 32768
    s_nop 0
    buffer_load_dwordx4 v16, s[16:19], s34 offen offset:0 lds
    s_add_u32 m0, s29, 33664
    s_nop 0
    buffer_load_dwordx4 v16, s[16:19], s34 offen offset:128 lds
    s_add_u32 m0, s29, 34560
    s_nop 0
    buffer_load_dwordx4 v16, s[16:19], s34 offen offset:256 lds
    s_add_u32 m0, s29, 35456
    s_nop 0
    buffer_load_dwordx4 v16, s[16:19], s34 offen offset:384 lds
    s_add_u32 m0, s29, 36352
    s_nop 0
    buffer_load_dwordx4 v16, s[16:19], s34 offen offset:512 lds
    s_add_u32 m0, s29, 37248
    s_nop 0
    buffer_load_dwordx4 v16, s[16:19], s34 offen offset:640 lds
    s_add_u32 m0, s29, 38144
    s_nop 0
    buffer_load_dwordx4 v16, s[16:19], s34 offen offset:768 lds
    s_add_u32 m0, s29, 39040
    s_nop 0
    buffer_load_dwordx4 v16, s[16:19], s34 offen offset:896 lds
    s_add_u32 s34, s34, 64512
    s_min_u32 s34, s34, 4128768
    s_cmp_eq_u32 s30, 2
    s_cbranch_scc1 .s0v_390
    v_mfma_f32_16x16x32_bf16 v[64:67], a[0:3], v[32:35], 0
    v_mfma_f32_16x16x32_bf16 v[68:71], a[4:7], v[32:35], 0
    v_mfma_f32_16x16x32_bf16 v[72:75], a[0:3], v[36:39], 0
    v_mfma_f32_16x16x32_bf16 v[76:79], a[4:7], v[36:39], 0
    v_mfma_f32_16x16x32_bf16 v[64:67], a[8:11], v[40:43], v[64:67]
    v_mfma_f32_16x16x32_bf16 v[68:71], a[12:15], v[40:43], v[68:71]
    v_mfma_f32_16x16x32_bf16 v[72:75], a[8:11], v[44:47], v[72:75]
    v_mfma_f32_16x16x32_bf16 v[76:79], a[12:15], v[44:47], v[76:79]
    v_mfma_f32_16x16x32_bf16 v[64:67], a[16:19], v[48:51], v[64:67]
    v_mfma_f32_16x16x32_bf16 v[68:71], a[20:23], v[48:51], v[68:71]
    v_mfma_f32_16x16x32_bf16 v[72:75], a[16:19], v[52:55], v[72:75]
    v_mfma_f32_16x16x32_bf16 v[76:79], a[20:23], v[52:55], v[76:79]
    v_mfma_f32_16x16x32_bf16 v[64:67], a[24:27], v[56:59], v[64:67]
    v_mfma_f32_16x16x32_bf16 v[68:71], a[28:31], v[56:59], v[68:71]
    v_mfma_f32_16x16x32_bf16 v[72:75], a[24:27], v[60:63], v[72:75]
    v_mfma_f32_16x16x32_bf16 v[76:79], a[28:31], v[60:63], v[76:79]
    s_branch .s0j_391
.s0v_390:
    v_mfma_f32_16x16x32_bf16 v[64:67], v[32:35], a[0:3], 0
    v_mfma_f32_16x16x32_bf16 v[68:71], v[32:35], a[4:7], 0
    v_mfma_f32_16x16x32_bf16 v[72:75], v[36:39], a[0:3], 0
    v_mfma_f32_16x16x32_bf16 v[76:79], v[36:39], a[4:7], 0
    v_mfma_f32_16x16x32_bf16 v[64:67], v[40:43], a[8:11], v[64:67]
    v_mfma_f32_16x16x32_bf16 v[68:71], v[40:43], a[12:15], v[68:71]
    v_mfma_f32_16x16x32_bf16 v[72:75], v[44:47], a[8:11], v[72:75]
    v_mfma_f32_16x16x32_bf16 v[76:79], v[44:47], a[12:15], v[76:79]
    v_mfma_f32_16x16x32_bf16 v[64:67], v[48:51], a[16:19], v[64:67]
    v_mfma_f32_16x16x32_bf16 v[68:71], v[48:51], a[20:23], v[68:71]
    v_mfma_f32_16x16x32_bf16 v[72:75], v[52:55], a[16:19], v[72:75]
    v_mfma_f32_16x16x32_bf16 v[76:79], v[52:55], a[20:23], v[76:79]
    v_mfma_f32_16x16x32_bf16 v[64:67], v[56:59], a[24:27], v[64:67]
    v_mfma_f32_16x16x32_bf16 v[68:71], v[56:59], a[28:31], v[68:71]
    v_mfma_f32_16x16x32_bf16 v[72:75], v[60:63], a[24:27], v[72:75]
    v_mfma_f32_16x16x32_bf16 v[76:79], v[60:63], a[28:31], v[76:79]
.s0j_391:
    s_waitcnt vmcnt(24)
    s_barrier
    ds_read_b64_tr_b16 a[32:33], v12 offset:0
    ds_read_b64_tr_b16 a[34:35], v12 offset:1024
    ds_read_b64_tr_b16 a[36:37], v13 offset:0
    ds_read_b64_tr_b16 a[38:39], v13 offset:1024
    ds_read_b64_tr_b16 a[40:41], v12 offset:8192
    ds_read_b64_tr_b16 a[42:43], v12 offset:9216
    ds_read_b64_tr_b16 a[44:45], v13 offset:8192
    ds_read_b64_tr_b16 a[46:47], v13 offset:9216
    ds_read_b64_tr_b16 a[48:49], v12 offset:16384
    ds_read_b64_tr_b16 a[50:51], v12 offset:17408
    ds_read_b64_tr_b16 a[52:53], v13 offset:16384
    ds_read_b64_tr_b16 a[54:55], v13 offset:17408
    ds_read_b64_tr_b16 a[56:57], v12 offset:24576
    ds_read_b64_tr_b16 a[58:59], v12 offset:25600
    ds_read_b64_tr_b16 a[60:61], v13 offset:24576
    ds_read_b64_tr_b16 a[62:63], v13 offset:25600
    ds_read_b128 v[32:35], v113 offset:2048
    ds_read_b128 v[36:39], v113 offset:18432
    ds_read_b128 v[40:43], v114 offset:2048
    ds_read_b128 v[44:47], v114 offset:18432
    ds_read_b128 v[48:51], v113 offset:3072
    ds_read_b128 v[52:55], v113 offset:19456
    ds_read_b128 v[56:59], v114 offset:3072
    ds_read_b128 v[60:63], v114 offset:19456
    s_waitcnt lgkmcnt(0)
    s_barrier
    s_add_u32 m0, s29, 0
    s_add_u32 s4, s28, 4194304
    buffer_load_dwordx4 v10, s[12:15], s4 offen lds

    s_add_u32 m0, s29, 1024
    s_add_u32 s4, s28, 4227072
    buffer_load_dwordx4 v10, s[12:15], s4 offen lds

    s_add_u32 m0, s29, 2048
    s_add_u32 s4, s28, 4259840
    buffer_load_dwordx4 v11, s[12:15], s4 offen lds

    s_add_u32 m0, s29, 3072
    s_add_u32 s4, s28, 4292608
    buffer_load_dwordx4 v11, s[12:15], s4 offen lds

    s_add_u32 m0, s29, 4096
    s_add_u32 s4, s28, 4325376
    buffer_load_dwordx4 v10, s[12:15], s4 offen lds

    s_add_u32 m0, s29, 5120
    s_add_u32 s4, s28, 4358144
    buffer_load_dwordx4 v10, s[12:15], s4 offen lds

    s_add_u32 m0, s29, 6144
    s_add_u32 s4, s28, 4390912
    buffer_load_dwordx4 v11, s[12:15], s4 offen lds

    s_add_u32 m0, s29, 7168
    s_add_u32 s4, s28, 4423680
    buffer_load_dwordx4 v11, s[12:15], s4 offen lds

    s_cmp_eq_u32 s30, 2
    s_cbranch_scc1 .s0v_392
    v_mfma_f32_16x16x32_bf16 v[64:67], a[32:35], v[32:35], v[64:67]
    v_mfma_f32_16x16x32_bf16 v[68:71], a[36:39], v[32:35], v[68:71]
    v_mfma_f32_16x16x32_bf16 v[72:75], a[32:35], v[36:39], v[72:75]
    v_mfma_f32_16x16x32_bf16 v[76:79], a[36:39], v[36:39], v[76:79]
    v_mfma_f32_16x16x32_bf16 v[64:67], a[40:43], v[40:43], v[64:67]
    v_mfma_f32_16x16x32_bf16 v[68:71], a[44:47], v[40:43], v[68:71]
    v_mfma_f32_16x16x32_bf16 v[72:75], a[40:43], v[44:47], v[72:75]
    v_mfma_f32_16x16x32_bf16 v[76:79], a[44:47], v[44:47], v[76:79]
    v_mfma_f32_16x16x32_bf16 v[64:67], a[48:51], v[48:51], v[64:67]
    v_mfma_f32_16x16x32_bf16 v[68:71], a[52:55], v[48:51], v[68:71]
    v_mfma_f32_16x16x32_bf16 v[72:75], a[48:51], v[52:55], v[72:75]
    v_mfma_f32_16x16x32_bf16 v[76:79], a[52:55], v[52:55], v[76:79]
    v_mfma_f32_16x16x32_bf16 v[64:67], a[56:59], v[56:59], v[64:67]
    v_mfma_f32_16x16x32_bf16 v[68:71], a[60:63], v[56:59], v[68:71]
    v_mfma_f32_16x16x32_bf16 v[72:75], a[56:59], v[60:63], v[72:75]
    v_mfma_f32_16x16x32_bf16 v[76:79], a[60:63], v[60:63], v[76:79]
    s_branch .s0j_393
.s0v_392:
    v_mfma_f32_16x16x32_bf16 v[64:67], v[32:35], a[32:35], v[64:67]
    v_mfma_f32_16x16x32_bf16 v[68:71], v[32:35], a[36:39], v[68:71]
    v_mfma_f32_16x16x32_bf16 v[72:75], v[36:39], a[32:35], v[72:75]
    v_mfma_f32_16x16x32_bf16 v[76:79], v[36:39], a[36:39], v[76:79]
    v_mfma_f32_16x16x32_bf16 v[64:67], v[40:43], a[40:43], v[64:67]
    v_mfma_f32_16x16x32_bf16 v[68:71], v[40:43], a[44:47], v[68:71]
    v_mfma_f32_16x16x32_bf16 v[72:75], v[44:47], a[40:43], v[72:75]
    v_mfma_f32_16x16x32_bf16 v[76:79], v[44:47], a[44:47], v[76:79]
    v_mfma_f32_16x16x32_bf16 v[64:67], v[48:51], a[48:51], v[64:67]
    v_mfma_f32_16x16x32_bf16 v[68:71], v[48:51], a[52:55], v[68:71]
    v_mfma_f32_16x16x32_bf16 v[72:75], v[52:55], a[48:51], v[72:75]
    v_mfma_f32_16x16x32_bf16 v[76:79], v[52:55], a[52:55], v[76:79]
    v_mfma_f32_16x16x32_bf16 v[64:67], v[56:59], a[56:59], v[64:67]
    v_mfma_f32_16x16x32_bf16 v[68:71], v[56:59], a[60:63], v[68:71]
    v_mfma_f32_16x16x32_bf16 v[72:75], v[60:63], a[56:59], v[72:75]
    v_mfma_f32_16x16x32_bf16 v[76:79], v[60:63], a[60:63], v[76:79]
.s0j_393:
    s_waitcnt vmcnt(24)
    s_barrier
    ds_read_b64_tr_b16 a[64:65], v14 offset:0
    ds_read_b64_tr_b16 a[66:67], v14 offset:1024
    ds_read_b64_tr_b16 a[68:69], v15 offset:0
    ds_read_b64_tr_b16 a[70:71], v15 offset:1024
    ds_read_b64_tr_b16 a[72:73], v14 offset:8192
    ds_read_b64_tr_b16 a[74:75], v14 offset:9216
    ds_read_b64_tr_b16 a[76:77], v15 offset:8192
    ds_read_b64_tr_b16 a[78:79], v15 offset:9216
    ds_read_b64_tr_b16 a[80:81], v14 offset:16384
    ds_read_b64_tr_b16 a[82:83], v14 offset:17408
    ds_read_b64_tr_b16 a[84:85], v15 offset:16384
    ds_read_b64_tr_b16 a[86:87], v15 offset:17408
    ds_read_b64_tr_b16 a[88:89], v14 offset:24576
    ds_read_b64_tr_b16 a[90:91], v14 offset:25600
    ds_read_b64_tr_b16 a[92:93], v15 offset:24576
    ds_read_b64_tr_b16 a[94:95], v15 offset:25600
    ds_read_b128 v[32:35], v113 offset:4096
    ds_read_b128 v[36:39], v113 offset:20480
    ds_read_b128 v[40:43], v114 offset:4096
    ds_read_b128 v[44:47], v114 offset:20480
    ds_read_b128 v[48:51], v113 offset:5120
    ds_read_b128 v[52:55], v113 offset:21504
    ds_read_b128 v[56:59], v114 offset:5120
    ds_read_b128 v[60:63], v114 offset:21504
    s_waitcnt lgkmcnt(0)
    s_barrier
    s_add_u32 m0, s29, 65536
    s_add_u32 s4, s28, 5242880
    buffer_load_dwordx4 v10, s[12:15], s4 offen lds

    s_add_u32 m0, s29, 66560
    s_add_u32 s4, s28, 5275648
    buffer_load_dwordx4 v10, s[12:15], s4 offen lds

    s_add_u32 m0, s29, 67584
    s_add_u32 s4, s28, 5308416
    buffer_load_dwordx4 v11, s[12:15], s4 offen lds

    s_add_u32 m0, s29, 68608
    s_add_u32 s4, s28, 5341184
    buffer_load_dwordx4 v11, s[12:15], s4 offen lds

    s_add_u32 m0, s29, 69632
    s_add_u32 s4, s28, 5373952
    buffer_load_dwordx4 v10, s[12:15], s4 offen lds

    s_add_u32 m0, s29, 70656
    s_add_u32 s4, s28, 5406720
    buffer_load_dwordx4 v10, s[12:15], s4 offen lds

    s_add_u32 m0, s29, 71680
    s_add_u32 s4, s28, 5439488
    buffer_load_dwordx4 v11, s[12:15], s4 offen lds

    s_add_u32 m0, s29, 72704
    s_add_u32 s4, s28, 5472256
    buffer_load_dwordx4 v11, s[12:15], s4 offen lds

    s_cmp_eq_u32 s30, 2
    s_cbranch_scc1 .s0v_394
    v_mfma_f32_16x16x32_bf16 v[64:67], a[64:67], v[32:35], v[64:67]
    v_mfma_f32_16x16x32_bf16 v[68:71], a[68:71], v[32:35], v[68:71]
    v_mfma_f32_16x16x32_bf16 v[72:75], a[64:67], v[36:39], v[72:75]
    v_mfma_f32_16x16x32_bf16 v[76:79], a[68:71], v[36:39], v[76:79]
    v_mfma_f32_16x16x32_bf16 v[64:67], a[72:75], v[40:43], v[64:67]
    v_mfma_f32_16x16x32_bf16 v[68:71], a[76:79], v[40:43], v[68:71]
    v_mfma_f32_16x16x32_bf16 v[72:75], a[72:75], v[44:47], v[72:75]
    v_mfma_f32_16x16x32_bf16 v[76:79], a[76:79], v[44:47], v[76:79]
    v_mfma_f32_16x16x32_bf16 v[64:67], a[80:83], v[48:51], v[64:67]
    v_mfma_f32_16x16x32_bf16 v[68:71], a[84:87], v[48:51], v[68:71]
    v_mfma_f32_16x16x32_bf16 v[72:75], a[80:83], v[52:55], v[72:75]
    v_mfma_f32_16x16x32_bf16 v[76:79], a[84:87], v[52:55], v[76:79]
    v_mfma_f32_16x16x32_bf16 v[64:67], a[88:91], v[56:59], v[64:67]
    v_mfma_f32_16x16x32_bf16 v[68:71], a[92:95], v[56:59], v[68:71]
    v_mfma_f32_16x16x32_bf16 v[72:75], a[88:91], v[60:63], v[72:75]
    v_mfma_f32_16x16x32_bf16 v[76:79], a[92:95], v[60:63], v[76:79]
    s_branch .s0j_395
.s0v_394:
    v_mfma_f32_16x16x32_bf16 v[64:67], v[32:35], a[64:67], v[64:67]
    v_mfma_f32_16x16x32_bf16 v[68:71], v[32:35], a[68:71], v[68:71]
    v_mfma_f32_16x16x32_bf16 v[72:75], v[36:39], a[64:67], v[72:75]
    v_mfma_f32_16x16x32_bf16 v[76:79], v[36:39], a[68:71], v[76:79]
    v_mfma_f32_16x16x32_bf16 v[64:67], v[40:43], a[72:75], v[64:67]
    v_mfma_f32_16x16x32_bf16 v[68:71], v[40:43], a[76:79], v[68:71]
    v_mfma_f32_16x16x32_bf16 v[72:75], v[44:47], a[72:75], v[72:75]
    v_mfma_f32_16x16x32_bf16 v[76:79], v[44:47], a[76:79], v[76:79]
    v_mfma_f32_16x16x32_bf16 v[64:67], v[48:51], a[80:83], v[64:67]
    v_mfma_f32_16x16x32_bf16 v[68:71], v[48:51], a[84:87], v[68:71]
    v_mfma_f32_16x16x32_bf16 v[72:75], v[52:55], a[80:83], v[72:75]
    v_mfma_f32_16x16x32_bf16 v[76:79], v[52:55], a[84:87], v[76:79]
    v_mfma_f32_16x16x32_bf16 v[64:67], v[56:59], a[88:91], v[64:67]
    v_mfma_f32_16x16x32_bf16 v[68:71], v[56:59], a[92:95], v[68:71]
    v_mfma_f32_16x16x32_bf16 v[72:75], v[60:63], a[88:91], v[72:75]
    v_mfma_f32_16x16x32_bf16 v[76:79], v[60:63], a[92:95], v[76:79]
.s0j_395:
    s_waitcnt vmcnt(24)
    s_barrier
    ds_read_b64_tr_b16 a[96:97], v14 offset:32768
    ds_read_b64_tr_b16 a[98:99], v14 offset:33792
    ds_read_b64_tr_b16 a[100:101], v15 offset:32768
    ds_read_b64_tr_b16 a[102:103], v15 offset:33792
    ds_read_b64_tr_b16 a[104:105], v14 offset:40960
    ds_read_b64_tr_b16 a[106:107], v14 offset:41984
    ds_read_b64_tr_b16 a[108:109], v15 offset:40960
    ds_read_b64_tr_b16 a[110:111], v15 offset:41984
    ds_read_b64_tr_b16 a[112:113], v14 offset:49152
    ds_read_b64_tr_b16 a[114:115], v14 offset:50176
    ds_read_b64_tr_b16 a[116:117], v15 offset:49152
    ds_read_b64_tr_b16 a[118:119], v15 offset:50176
    ds_read_b64_tr_b16 a[120:121], v14 offset:57344
    ds_read_b64_tr_b16 a[122:123], v14 offset:58368
    ds_read_b64_tr_b16 a[124:125], v15 offset:57344
    ds_read_b64_tr_b16 a[126:127], v15 offset:58368
    ds_read_b128 v[32:35], v113 offset:6144
    ds_read_b128 v[36:39], v113 offset:22528
    ds_read_b128 v[40:43], v114 offset:6144
    ds_read_b128 v[44:47], v114 offset:22528
    ds_read_b128 v[48:51], v113 offset:7168
    ds_read_b128 v[52:55], v113 offset:23552
    ds_read_b128 v[56:59], v114 offset:7168
    ds_read_b128 v[60:63], v114 offset:23552
    s_waitcnt lgkmcnt(0)
    s_barrier
    s_add_u32 m0, s29, 98304
    s_add_u32 s4, s28, 6291456
    buffer_load_dwordx4 v10, s[12:15], s4 offen lds

    s_add_u32 m0, s29, 99328
    s_add_u32 s4, s28, 6324224
    buffer_load_dwordx4 v10, s[12:15], s4 offen lds

    s_add_u32 m0, s29, 100352
    s_add_u32 s4, s28, 6356992
    buffer_load_dwordx4 v11, s[12:15], s4 offen lds

    s_add_u32 m0, s29, 101376
    s_add_u32 s4, s28, 6389760
    buffer_load_dwordx4 v11, s[12:15], s4 offen lds

    s_add_u32 m0, s29, 102400
    s_add_u32 s4, s28, 6422528
    buffer_load_dwordx4 v10, s[12:15], s4 offen lds

    s_add_u32 m0, s29, 103424
    s_add_u32 s4, s28, 6455296
    buffer_load_dwordx4 v10, s[12:15], s4 offen lds

    s_add_u32 m0, s29, 104448
    s_add_u32 s4, s28, 6488064
    buffer_load_dwordx4 v11, s[12:15], s4 offen lds

    s_add_u32 m0, s29, 105472
    s_add_u32 s4, s28, 6520832
    buffer_load_dwordx4 v11, s[12:15], s4 offen lds

    v_and_b32 v241, 3, v0
    v_lshlrev_b32 v241, 2, v241

    v_and_b32 v240, 12, v0
    v_lshl_add_u32 v241, v240, 4, v241
    v_add_u32 v241, s97, v241
    v_and_b32 v241, 255, v241

    buffer_load_dword v240, v241, s[20:23], 0 offen sc1
    s_cmp_eq_u32 s30, 2
    s_cbranch_scc1 .s0v_396
    v_mfma_f32_16x16x32_bf16 v[64:67], a[96:99], v[32:35], v[64:67]
    v_mfma_f32_16x16x32_bf16 v[68:71], a[100:103], v[32:35], v[68:71]
    v_mfma_f32_16x16x32_bf16 v[72:75], a[96:99], v[36:39], v[72:75]
    v_mfma_f32_16x16x32_bf16 v[76:79], a[100:103], v[36:39], v[76:79]
    v_mfma_f32_16x16x32_bf16 v[64:67], a[104:107], v[40:43], v[64:67]
    v_mfma_f32_16x16x32_bf16 v[68:71], a[108:111], v[40:43], v[68:71]
    v_mfma_f32_16x16x32_bf16 v[72:75], a[104:107], v[44:47], v[72:75]
    v_mfma_f32_16x16x32_bf16 v[76:79], a[108:111], v[44:47], v[76:79]
    v_mfma_f32_16x16x32_bf16 v[64:67], a[112:115], v[48:51], v[64:67]
    v_mfma_f32_16x16x32_bf16 v[68:71], a[116:119], v[48:51], v[68:71]
    v_mfma_f32_16x16x32_bf16 v[72:75], a[112:115], v[52:55], v[72:75]
    v_mfma_f32_16x16x32_bf16 v[76:79], a[116:119], v[52:55], v[76:79]
    v_mfma_f32_16x16x32_bf16 v[64:67], a[120:123], v[56:59], v[64:67]
    v_mfma_f32_16x16x32_bf16 v[68:71], a[124:127], v[56:59], v[68:71]
    v_mfma_f32_16x16x32_bf16 v[72:75], a[120:123], v[60:63], v[72:75]
    v_mfma_f32_16x16x32_bf16 v[76:79], a[124:127], v[60:63], v[76:79]
    s_branch .s0j_397
.s0v_396:
    v_mfma_f32_16x16x32_bf16 v[64:67], v[32:35], a[96:99], v[64:67]
    v_mfma_f32_16x16x32_bf16 v[68:71], v[32:35], a[100:103], v[68:71]
    v_mfma_f32_16x16x32_bf16 v[72:75], v[36:39], a[96:99], v[72:75]
    v_mfma_f32_16x16x32_bf16 v[76:79], v[36:39], a[100:103], v[76:79]
    v_mfma_f32_16x16x32_bf16 v[64:67], v[40:43], a[104:107], v[64:67]
    v_mfma_f32_16x16x32_bf16 v[68:71], v[40:43], a[108:111], v[68:71]
    v_mfma_f32_16x16x32_bf16 v[72:75], v[44:47], a[104:107], v[72:75]
    v_mfma_f32_16x16x32_bf16 v[76:79], v[44:47], a[108:111], v[76:79]
    v_mfma_f32_16x16x32_bf16 v[64:67], v[48:51], a[112:115], v[64:67]
    v_mfma_f32_16x16x32_bf16 v[68:71], v[48:51], a[116:119], v[68:71]
    v_mfma_f32_16x16x32_bf16 v[72:75], v[52:55], a[112:115], v[72:75]
    v_mfma_f32_16x16x32_bf16 v[76:79], v[52:55], a[116:119], v[76:79]
    v_mfma_f32_16x16x32_bf16 v[64:67], v[56:59], a[120:123], v[64:67]
    v_mfma_f32_16x16x32_bf16 v[68:71], v[56:59], a[124:127], v[68:71]
    v_mfma_f32_16x16x32_bf16 v[72:75], v[60:63], a[120:123], v[72:75]
    v_mfma_f32_16x16x32_bf16 v[76:79], v[60:63], a[124:127], v[76:79]
.s0j_397:
    s_waitcnt vmcnt(17)
    s_barrier
    ds_read_b64_tr_b16 a[128:129], v12 offset:0
    ds_read_b64_tr_b16 a[130:131], v12 offset:1024
    ds_read_b64_tr_b16 a[132:133], v13 offset:0
    ds_read_b64_tr_b16 a[134:135], v13 offset:1024
    ds_read_b64_tr_b16 a[136:137], v12 offset:8192
    ds_read_b64_tr_b16 a[138:139], v12 offset:9216
    ds_read_b64_tr_b16 a[140:141], v13 offset:8192
    ds_read_b64_tr_b16 a[142:143], v13 offset:9216
    ds_read_b64_tr_b16 a[144:145], v12 offset:16384
    ds_read_b64_tr_b16 a[146:147], v12 offset:17408
    ds_read_b64_tr_b16 a[148:149], v13 offset:16384
    ds_read_b64_tr_b16 a[150:151], v13 offset:17408
    ds_read_b64_tr_b16 a[152:153], v12 offset:24576
    ds_read_b64_tr_b16 a[154:155], v12 offset:25600
    ds_read_b64_tr_b16 a[156:157], v13 offset:24576
    ds_read_b64_tr_b16 a[158:159], v13 offset:25600
    ds_read_b128 v[32:35], v17 offset:32768
    ds_read_b128 v[36:39], v17 offset:49152
    ds_read_b128 v[40:43], v18 offset:32768
    ds_read_b128 v[44:47], v18 offset:49152
    ds_read_b128 v[48:51], v17 offset:33792
    ds_read_b128 v[52:55], v17 offset:50176
    ds_read_b128 v[56:59], v18 offset:33792
    ds_read_b128 v[60:63], v18 offset:50176
    s_waitcnt lgkmcnt(0)
    s_barrier
    s_add_u32 m0, s29, 0
    s_add_u32 s4, s28, 7340032
    buffer_load_dwordx4 v10, s[12:15], s4 offen lds

    s_add_u32 m0, s29, 1024
    s_add_u32 s4, s28, 7372800
    buffer_load_dwordx4 v10, s[12:15], s4 offen lds

    s_add_u32 m0, s29, 2048
    s_add_u32 s4, s28, 7405568
    buffer_load_dwordx4 v11, s[12:15], s4 offen lds

    s_add_u32 m0, s29, 3072
    s_add_u32 s4, s28, 7438336
    buffer_load_dwordx4 v11, s[12:15], s4 offen lds

    s_add_u32 m0, s29, 4096
    s_add_u32 s4, s28, 7471104
    buffer_load_dwordx4 v10, s[12:15], s4 offen lds

    s_add_u32 m0, s29, 5120
    s_add_u32 s4, s28, 7503872
    buffer_load_dwordx4 v10, s[12:15], s4 offen lds

    s_add_u32 m0, s29, 6144
    s_add_u32 s4, s28, 7536640
    buffer_load_dwordx4 v11, s[12:15], s4 offen lds

    s_add_u32 m0, s29, 7168
    s_add_u32 s4, s28, 7569408
    buffer_load_dwordx4 v11, s[12:15], s4 offen lds

    s_cmp_eq_u32 s30, 2
    s_cbranch_scc1 .s0v_398
    v_mfma_f32_16x16x32_bf16 v[64:67], a[128:131], v[32:35], v[64:67]
    v_mfma_f32_16x16x32_bf16 v[68:71], a[132:135], v[32:35], v[68:71]
    v_mfma_f32_16x16x32_bf16 v[72:75], a[128:131], v[36:39], v[72:75]
    v_mfma_f32_16x16x32_bf16 v[76:79], a[132:135], v[36:39], v[76:79]
    v_mfma_f32_16x16x32_bf16 v[64:67], a[136:139], v[40:43], v[64:67]
    v_mfma_f32_16x16x32_bf16 v[68:71], a[140:143], v[40:43], v[68:71]
    v_mfma_f32_16x16x32_bf16 v[72:75], a[136:139], v[44:47], v[72:75]
    v_mfma_f32_16x16x32_bf16 v[76:79], a[140:143], v[44:47], v[76:79]
    v_mfma_f32_16x16x32_bf16 v[64:67], a[144:147], v[48:51], v[64:67]
    v_mfma_f32_16x16x32_bf16 v[68:71], a[148:151], v[48:51], v[68:71]
    v_mfma_f32_16x16x32_bf16 v[72:75], a[144:147], v[52:55], v[72:75]
    v_mfma_f32_16x16x32_bf16 v[76:79], a[148:151], v[52:55], v[76:79]
    v_mfma_f32_16x16x32_bf16 v[64:67], a[152:155], v[56:59], v[64:67]
    v_mfma_f32_16x16x32_bf16 v[68:71], a[156:159], v[56:59], v[68:71]
    v_mfma_f32_16x16x32_bf16 v[72:75], a[152:155], v[60:63], v[72:75]
    v_mfma_f32_16x16x32_bf16 v[76:79], a[156:159], v[60:63], v[76:79]
    s_branch .s0j_399
.s0v_398:
    v_mfma_f32_16x16x32_bf16 v[64:67], v[32:35], a[128:131], v[64:67]
    v_mfma_f32_16x16x32_bf16 v[68:71], v[32:35], a[132:135], v[68:71]
    v_mfma_f32_16x16x32_bf16 v[72:75], v[36:39], a[128:131], v[72:75]
    v_mfma_f32_16x16x32_bf16 v[76:79], v[36:39], a[132:135], v[76:79]
    v_mfma_f32_16x16x32_bf16 v[64:67], v[40:43], a[136:139], v[64:67]
    v_mfma_f32_16x16x32_bf16 v[68:71], v[40:43], a[140:143], v[68:71]
    v_mfma_f32_16x16x32_bf16 v[72:75], v[44:47], a[136:139], v[72:75]
    v_mfma_f32_16x16x32_bf16 v[76:79], v[44:47], a[140:143], v[76:79]
    v_mfma_f32_16x16x32_bf16 v[64:67], v[48:51], a[144:147], v[64:67]
    v_mfma_f32_16x16x32_bf16 v[68:71], v[48:51], a[148:151], v[68:71]
    v_mfma_f32_16x16x32_bf16 v[72:75], v[52:55], a[144:147], v[72:75]
    v_mfma_f32_16x16x32_bf16 v[76:79], v[52:55], a[148:151], v[76:79]
    v_mfma_f32_16x16x32_bf16 v[64:67], v[56:59], a[152:155], v[64:67]
    v_mfma_f32_16x16x32_bf16 v[68:71], v[56:59], a[156:159], v[68:71]
    v_mfma_f32_16x16x32_bf16 v[72:75], v[60:63], a[152:155], v[72:75]
    v_mfma_f32_16x16x32_bf16 v[76:79], v[60:63], a[156:159], v[76:79]
.s0j_399:
    s_waitcnt vmcnt(17)
    s_barrier
    ds_read_b64_tr_b16 a[160:161], v14 offset:0
    ds_read_b64_tr_b16 a[162:163], v14 offset:1024
    ds_read_b64_tr_b16 a[164:165], v15 offset:0
    ds_read_b64_tr_b16 a[166:167], v15 offset:1024
    ds_read_b64_tr_b16 a[168:169], v14 offset:8192
    ds_read_b64_tr_b16 a[170:171], v14 offset:9216
    ds_read_b64_tr_b16 a[172:173], v15 offset:8192
    ds_read_b64_tr_b16 a[174:175], v15 offset:9216
    ds_read_b64_tr_b16 a[176:177], v14 offset:16384
    ds_read_b64_tr_b16 a[178:179], v14 offset:17408
    ds_read_b64_tr_b16 a[180:181], v15 offset:16384
    ds_read_b64_tr_b16 a[182:183], v15 offset:17408
    ds_read_b64_tr_b16 a[184:185], v14 offset:24576
    ds_read_b64_tr_b16 a[186:187], v14 offset:25600
    ds_read_b64_tr_b16 a[188:189], v15 offset:24576
    ds_read_b64_tr_b16 a[190:191], v15 offset:25600
    ds_read_b128 v[32:35], v17 offset:34816
    ds_read_b128 v[36:39], v17 offset:51200
    ds_read_b128 v[40:43], v18 offset:34816
    ds_read_b128 v[44:47], v18 offset:51200
    ds_read_b128 v[48:51], v17 offset:35840
    ds_read_b128 v[52:55], v17 offset:52224
    ds_read_b128 v[56:59], v18 offset:35840
    ds_read_b128 v[60:63], v18 offset:52224
    s_waitcnt lgkmcnt(0)
    s_barrier
    s_add_u32 m0, s29, 65536
    s_nop 0
    buffer_load_dwordx4 v16, s[16:19], s34 offen offset:0 lds
    s_add_u32 m0, s29, 66432
    s_nop 0
    buffer_load_dwordx4 v16, s[16:19], s34 offen offset:128 lds
    s_add_u32 m0, s29, 67328
    s_nop 0
    buffer_load_dwordx4 v16, s[16:19], s34 offen offset:256 lds
    s_add_u32 m0, s29, 68224
    s_nop 0
    buffer_load_dwordx4 v16, s[16:19], s34 offen offset:384 lds
    s_add_u32 m0, s29, 69120
    s_nop 0
    buffer_load_dwordx4 v16, s[16:19], s34 offen offset:512 lds
    s_add_u32 m0, s29, 70016
    s_nop 0
    buffer_load_dwordx4 v16, s[16:19], s34 offen offset:640 lds
    s_add_u32 m0, s29, 70912
    s_nop 0
    buffer_load_dwordx4 v16, s[16:19], s34 offen offset:768 lds
    s_add_u32 m0, s29, 71808
    s_nop 0
    buffer_load_dwordx4 v16, s[16:19], s34 offen offset:896 lds
    s_add_u32 s34, s34, 1024
    s_cmp_eq_u32 s30, 2
    s_cbranch_scc1 .s0v_400
    v_mfma_f32_16x16x32_bf16 v[64:67], a[160:163], v[32:35], v[64:67]
    v_mfma_f32_16x16x32_bf16 v[68:71], a[164:167], v[32:35], v[68:71]
    v_mfma_f32_16x16x32_bf16 v[72:75], a[160:163], v[36:39], v[72:75]
    v_mfma_f32_16x16x32_bf16 v[76:79], a[164:167], v[36:39], v[76:79]
    v_mfma_f32_16x16x32_bf16 v[64:67], a[168:171], v[40:43], v[64:67]
    v_mfma_f32_16x16x32_bf16 v[68:71], a[172:175], v[40:43], v[68:71]
    v_mfma_f32_16x16x32_bf16 v[72:75], a[168:171], v[44:47], v[72:75]
    v_mfma_f32_16x16x32_bf16 v[76:79], a[172:175], v[44:47], v[76:79]
    v_mfma_f32_16x16x32_bf16 v[64:67], a[176:179], v[48:51], v[64:67]
    v_mfma_f32_16x16x32_bf16 v[68:71], a[180:183], v[48:51], v[68:71]
    v_mfma_f32_16x16x32_bf16 v[72:75], a[176:179], v[52:55], v[72:75]
    v_mfma_f32_16x16x32_bf16 v[76:79], a[180:183], v[52:55], v[76:79]
    v_mfma_f32_16x16x32_bf16 v[64:67], a[184:187], v[56:59], v[64:67]
    v_mfma_f32_16x16x32_bf16 v[68:71], a[188:191], v[56:59], v[68:71]
    v_mfma_f32_16x16x32_bf16 v[72:75], a[184:187], v[60:63], v[72:75]
    v_mfma_f32_16x16x32_bf16 v[76:79], a[188:191], v[60:63], v[76:79]
    s_branch .s0j_401
.s0v_400:
    v_mfma_f32_16x16x32_bf16 v[64:67], v[32:35], a[160:163], v[64:67]
    v_mfma_f32_16x16x32_bf16 v[68:71], v[32:35], a[164:167], v[68:71]
    v_mfma_f32_16x16x32_bf16 v[72:75], v[36:39], a[160:163], v[72:75]
    v_mfma_f32_16x16x32_bf16 v[76:79], v[36:39], a[164:167], v[76:79]
    v_mfma_f32_16x16x32_bf16 v[64:67], v[40:43], a[168:171], v[64:67]
    v_mfma_f32_16x16x32_bf16 v[68:71], v[40:43], a[172:175], v[68:71]
    v_mfma_f32_16x16x32_bf16 v[72:75], v[44:47], a[168:171], v[72:75]
    v_mfma_f32_16x16x32_bf16 v[76:79], v[44:47], a[172:175], v[76:79]
    v_mfma_f32_16x16x32_bf16 v[64:67], v[48:51], a[176:179], v[64:67]
    v_mfma_f32_16x16x32_bf16 v[68:71], v[48:51], a[180:183], v[68:71]
    v_mfma_f32_16x16x32_bf16 v[72:75], v[52:55], a[176:179], v[72:75]
    v_mfma_f32_16x16x32_bf16 v[76:79], v[52:55], a[180:183], v[76:79]
    v_mfma_f32_16x16x32_bf16 v[64:67], v[56:59], a[184:187], v[64:67]
    v_mfma_f32_16x16x32_bf16 v[68:71], v[56:59], a[188:191], v[68:71]
    v_mfma_f32_16x16x32_bf16 v[72:75], v[60:63], a[184:187], v[72:75]
    v_mfma_f32_16x16x32_bf16 v[76:79], v[60:63], a[188:191], v[76:79]
.s0j_401:
    s_waitcnt vmcnt(17)
    s_barrier
    ds_read_b64_tr_b16 a[192:193], v14 offset:32768
    ds_read_b64_tr_b16 a[194:195], v14 offset:33792
    ds_read_b64_tr_b16 a[196:197], v15 offset:32768
    ds_read_b64_tr_b16 a[198:199], v15 offset:33792
    ds_read_b64_tr_b16 a[200:201], v14 offset:40960
    ds_read_b64_tr_b16 a[202:203], v14 offset:41984
    ds_read_b64_tr_b16 a[204:205], v15 offset:40960
    ds_read_b64_tr_b16 a[206:207], v15 offset:41984
    ds_read_b64_tr_b16 a[208:209], v14 offset:49152
    ds_read_b64_tr_b16 a[210:211], v14 offset:50176
    ds_read_b64_tr_b16 a[212:213], v15 offset:49152
    ds_read_b64_tr_b16 a[214:215], v15 offset:50176
    ds_read_b64_tr_b16 a[216:217], v14 offset:57344
    ds_read_b64_tr_b16 a[218:219], v14 offset:58368
    ds_read_b64_tr_b16 a[220:221], v15 offset:57344
    ds_read_b64_tr_b16 a[222:223], v15 offset:58368
    ds_read_b128 v[32:35], v17 offset:36864
    ds_read_b128 v[36:39], v17 offset:53248
    ds_read_b128 v[40:43], v18 offset:36864
    ds_read_b128 v[44:47], v18 offset:53248
    ds_read_b128 v[48:51], v17 offset:37888
    ds_read_b128 v[52:55], v17 offset:54272
    ds_read_b128 v[56:59], v18 offset:37888
    ds_read_b128 v[60:63], v18 offset:54272
    s_waitcnt lgkmcnt(0)
    s_barrier
    s_add_u32 m0, s29, 98304
    s_nop 0
    buffer_load_dwordx4 v16, s[16:19], s34 offen offset:0 lds
    s_add_u32 m0, s29, 99200
    s_nop 0
    buffer_load_dwordx4 v16, s[16:19], s34 offen offset:128 lds
    s_add_u32 m0, s29, 100096
    s_nop 0
    buffer_load_dwordx4 v16, s[16:19], s34 offen offset:256 lds
    s_add_u32 m0, s29, 100992
    s_nop 0
    buffer_load_dwordx4 v16, s[16:19], s34 offen offset:384 lds
    s_add_u32 m0, s29, 101888
    s_nop 0
    buffer_load_dwordx4 v16, s[16:19], s34 offen offset:512 lds
    s_add_u32 m0, s29, 102784
    s_nop 0
    buffer_load_dwordx4 v16, s[16:19], s34 offen offset:640 lds
    s_add_u32 m0, s29, 103680
    s_nop 0
    buffer_load_dwordx4 v16, s[16:19], s34 offen offset:768 lds
    s_add_u32 m0, s29, 104576
    s_nop 0
    buffer_load_dwordx4 v16, s[16:19], s34 offen offset:896 lds
    s_add_u32 s34, s34, 64512
    s_min_u32 s34, s34, 4128768
    s_cmp_eq_u32 s30, 2
    s_cbranch_scc1 .s0v_402
    v_mfma_f32_16x16x32_bf16 v[64:67], a[192:195], v[32:35], v[64:67]
    v_mfma_f32_16x16x32_bf16 v[68:71], a[196:199], v[32:35], v[68:71]
    v_mfma_f32_16x16x32_bf16 v[72:75], a[192:195], v[36:39], v[72:75]
    v_mfma_f32_16x16x32_bf16 v[76:79], a[196:199], v[36:39], v[76:79]
    v_mfma_f32_16x16x32_bf16 v[64:67], a[200:203], v[40:43], v[64:67]
    v_mfma_f32_16x16x32_bf16 v[68:71], a[204:207], v[40:43], v[68:71]
    v_mfma_f32_16x16x32_bf16 v[72:75], a[200:203], v[44:47], v[72:75]
    v_mfma_f32_16x16x32_bf16 v[76:79], a[204:207], v[44:47], v[76:79]
    v_mfma_f32_16x16x32_bf16 v[64:67], a[208:211], v[48:51], v[64:67]
    v_mfma_f32_16x16x32_bf16 v[68:71], a[212:215], v[48:51], v[68:71]
    v_mfma_f32_16x16x32_bf16 v[72:75], a[208:211], v[52:55], v[72:75]
    v_mfma_f32_16x16x32_bf16 v[76:79], a[212:215], v[52:55], v[76:79]
    v_mfma_f32_16x16x32_bf16 v[64:67], a[216:219], v[56:59], v[64:67]
    v_mfma_f32_16x16x32_bf16 v[68:71], a[220:223], v[56:59], v[68:71]
    v_mfma_f32_16x16x32_bf16 v[72:75], a[216:219], v[60:63], v[72:75]
    v_mfma_f32_16x16x32_bf16 v[76:79], a[220:223], v[60:63], v[76:79]
    s_branch .s0j_403
.s0v_402:
    v_mfma_f32_16x16x32_bf16 v[64:67], v[32:35], a[192:195], v[64:67]
    v_mfma_f32_16x16x32_bf16 v[68:71], v[32:35], a[196:199], v[68:71]
    v_mfma_f32_16x16x32_bf16 v[72:75], v[36:39], a[192:195], v[72:75]
    v_mfma_f32_16x16x32_bf16 v[76:79], v[36:39], a[196:199], v[76:79]
    v_mfma_f32_16x16x32_bf16 v[64:67], v[40:43], a[200:203], v[64:67]
    v_mfma_f32_16x16x32_bf16 v[68:71], v[40:43], a[204:207], v[68:71]
    v_mfma_f32_16x16x32_bf16 v[72:75], v[44:47], a[200:203], v[72:75]
    v_mfma_f32_16x16x32_bf16 v[76:79], v[44:47], a[204:207], v[76:79]
    v_mfma_f32_16x16x32_bf16 v[64:67], v[48:51], a[208:211], v[64:67]
    v_mfma_f32_16x16x32_bf16 v[68:71], v[48:51], a[212:215], v[68:71]
    v_mfma_f32_16x16x32_bf16 v[72:75], v[52:55], a[208:211], v[72:75]
    v_mfma_f32_16x16x32_bf16 v[76:79], v[52:55], a[212:215], v[76:79]
    v_mfma_f32_16x16x32_bf16 v[64:67], v[56:59], a[216:219], v[64:67]
    v_mfma_f32_16x16x32_bf16 v[68:71], v[56:59], a[220:223], v[68:71]
    v_mfma_f32_16x16x32_bf16 v[72:75], v[60:63], a[216:219], v[72:75]
    v_mfma_f32_16x16x32_bf16 v[76:79], v[60:63], a[220:223], v[76:79]
.s0j_403:
    s_waitcnt vmcnt(16)
    s_barrier
    ds_read_b64_tr_b16 a[224:225], v12 offset:0
    ds_read_b64_tr_b16 a[226:227], v12 offset:1024
    ds_read_b64_tr_b16 a[228:229], v13 offset:0
    ds_read_b64_tr_b16 a[230:231], v13 offset:1024
    ds_read_b64_tr_b16 a[232:233], v12 offset:8192
    ds_read_b64_tr_b16 a[234:235], v12 offset:9216
    ds_read_b64_tr_b16 a[236:237], v13 offset:8192
    ds_read_b64_tr_b16 a[238:239], v13 offset:9216
    ds_read_b64_tr_b16 a[240:241], v12 offset:16384
    ds_read_b64_tr_b16 a[242:243], v12 offset:17408
    ds_read_b64_tr_b16 a[244:245], v13 offset:16384
    ds_read_b64_tr_b16 a[246:247], v13 offset:17408
    ds_read_b64_tr_b16 a[248:249], v12 offset:24576
    ds_read_b64_tr_b16 a[250:251], v12 offset:25600
    ds_read_b64_tr_b16 a[252:253], v13 offset:24576
    ds_read_b64_tr_b16 a[254:255], v13 offset:25600
    ds_read_b128 v[32:35], v17 offset:38912
    ds_read_b128 v[36:39], v17 offset:55296
    ds_read_b128 v[40:43], v18 offset:38912
    ds_read_b128 v[44:47], v18 offset:55296
    ds_read_b128 v[48:51], v17 offset:39936
    ds_read_b128 v[52:55], v17 offset:56320
    ds_read_b128 v[56:59], v18 offset:39936
    ds_read_b128 v[60:63], v18 offset:56320
    s_mov_b32 s62, 0
.vp_404:
    v_readlane_b32 s4, v240, 0
    v_readlane_b32 s7, v240, 1
    v_readlane_b32 s6, v240, 2

    v_readlane_b32 s5, v240, 4
    s_add_u32 s4, s4, s5
    v_readlane_b32 s5, v240, 8
    s_add_u32 s4, s4, s5
    v_readlane_b32 s5, v240, 12
    s_add_u32 s4, s4, s5
    s_cmp_ge_u32 s4, 256
    s_cbranch_scc1 .vd_405
    s_cmp_lg_u32 s6, 0
    s_cbranch_scc1 .vs_406
    s_add_u32 s62, s62, 1
    s_cmp_gt_u32 s62, 0x100000
    s_cbranch_scc1 .mg_end_1
    s_sleep 8
    buffer_load_dword v240, v241, s[20:23], 0 offen sc1
    s_waitcnt vmcnt(0)
    s_branch .vp_404

.vs_406:
    s_lshr_b32 s25, s2, 5
    s_and_b32 s26, s2, 31
    s_mov_b32 s27, 1
    s_mov_b32 s99, 1
    s_mov_b32 s97, 144
    s_waitcnt vmcnt(0) lgkmcnt(0)
    s_barrier
    s_branch .mg_role_3

.vd_405:
    s_waitcnt lgkmcnt(0)
    s_barrier
    s_add_u32 m0, s29, 0
    s_nop 0
    buffer_load_dwordx4 v16, s[16:19], s34 offen offset:0 lds
    s_add_u32 m0, s29, 896
    s_nop 0
    buffer_load_dwordx4 v16, s[16:19], s34 offen offset:128 lds
    s_add_u32 m0, s29, 1792
    s_nop 0
    buffer_load_dwordx4 v16, s[16:19], s34 offen offset:256 lds
    s_add_u32 m0, s29, 2688
    s_nop 0
    buffer_load_dwordx4 v16, s[16:19], s34 offen offset:384 lds
    s_add_u32 m0, s29, 3584
    s_nop 0
    buffer_load_dwordx4 v16, s[16:19], s34 offen offset:512 lds
    s_add_u32 m0, s29, 4480
    s_nop 0
    buffer_load_dwordx4 v16, s[16:19], s34 offen offset:640 lds
    s_add_u32 m0, s29, 5376
    s_nop 0
    buffer_load_dwordx4 v16, s[16:19], s34 offen offset:768 lds
    s_add_u32 m0, s29, 6272
    s_nop 0
    buffer_load_dwordx4 v16, s[16:19], s34 offen offset:896 lds
    s_add_u32 s34, s34, 1024
    s_cmp_eq_u32 s30, 2
    s_cbranch_scc1 .s0v_407
    v_mfma_f32_16x16x32_bf16 v[64:67], a[224:227], v[32:35], v[64:67]
    v_mfma_f32_16x16x32_bf16 v[68:71], a[228:231], v[32:35], v[68:71]
    v_mfma_f32_16x16x32_bf16 v[72:75], a[224:227], v[36:39], v[72:75]
    v_mfma_f32_16x16x32_bf16 v[76:79], a[228:231], v[36:39], v[76:79]
    v_mfma_f32_16x16x32_bf16 v[64:67], a[232:235], v[40:43], v[64:67]
    v_mfma_f32_16x16x32_bf16 v[68:71], a[236:239], v[40:43], v[68:71]
    v_mfma_f32_16x16x32_bf16 v[72:75], a[232:235], v[44:47], v[72:75]
    v_mfma_f32_16x16x32_bf16 v[76:79], a[236:239], v[44:47], v[76:79]
    v_mfma_f32_16x16x32_bf16 v[64:67], a[240:243], v[48:51], v[64:67]
    v_mfma_f32_16x16x32_bf16 v[68:71], a[244:247], v[48:51], v[68:71]
    v_mfma_f32_16x16x32_bf16 v[72:75], a[240:243], v[52:55], v[72:75]
    v_mfma_f32_16x16x32_bf16 v[76:79], a[244:247], v[52:55], v[76:79]
    v_mfma_f32_16x16x32_bf16 v[64:67], a[248:251], v[56:59], v[64:67]
    v_mfma_f32_16x16x32_bf16 v[68:71], a[252:255], v[56:59], v[68:71]
    v_mfma_f32_16x16x32_bf16 v[72:75], a[248:251], v[60:63], v[72:75]
    v_mfma_f32_16x16x32_bf16 v[76:79], a[252:255], v[60:63], v[76:79]
    s_branch .s0j_408
.s0v_407:
    v_mfma_f32_16x16x32_bf16 v[64:67], v[32:35], a[224:227], v[64:67]
    v_mfma_f32_16x16x32_bf16 v[68:71], v[32:35], a[228:231], v[68:71]
    v_mfma_f32_16x16x32_bf16 v[72:75], v[36:39], a[224:227], v[72:75]
    v_mfma_f32_16x16x32_bf16 v[76:79], v[36:39], a[228:231], v[76:79]
    v_mfma_f32_16x16x32_bf16 v[64:67], v[40:43], a[232:235], v[64:67]
    v_mfma_f32_16x16x32_bf16 v[68:71], v[40:43], a[236:239], v[68:71]
    v_mfma_f32_16x16x32_bf16 v[72:75], v[44:47], a[232:235], v[72:75]
    v_mfma_f32_16x16x32_bf16 v[76:79], v[44:47], a[236:239], v[76:79]
    v_mfma_f32_16x16x32_bf16 v[64:67], v[48:51], a[240:243], v[64:67]
    v_mfma_f32_16x16x32_bf16 v[68:71], v[48:51], a[244:247], v[68:71]
    v_mfma_f32_16x16x32_bf16 v[72:75], v[52:55], a[240:243], v[72:75]
    v_mfma_f32_16x16x32_bf16 v[76:79], v[52:55], a[244:247], v[76:79]
    v_mfma_f32_16x16x32_bf16 v[64:67], v[56:59], a[248:251], v[64:67]
    v_mfma_f32_16x16x32_bf16 v[68:71], v[56:59], a[252:255], v[68:71]
    v_mfma_f32_16x16x32_bf16 v[72:75], v[60:63], a[248:251], v[72:75]
    v_mfma_f32_16x16x32_bf16 v[76:79], v[60:63], a[252:255], v[76:79]
.s0j_408:
    buffer_store_dwordx4 v[24:27], v28, s[8:11], s46 offen sc1
    buffer_store_dwordx4 v[24:27], v29, s[8:11], s46 offen sc1
    s_cmp_eq_u32 s30, 2
    s_cbranch_scc1 .qv_388
    s_waitcnt vmcnt(16)
    s_barrier
    ds_read_b128 v[32:35], v19 offset:0
    ds_read_b128 v[36:39], v19 offset:16384
    ds_read_b128 v[40:43], v20 offset:0
    ds_read_b128 v[44:47], v20 offset:16384
    s_add_u32 m0, s29, 32768
    s_nop 0
    buffer_load_dwordx4 v16, s[16:19], s34 offen offset:0 lds
    ds_read_b128 v[48:51], v19 offset:1024
    ds_read_b128 v[52:55], v19 offset:17408
    s_branch .qe_410
.p2align 6
.ql_409:
    s_waitcnt lgkmcnt(4)
    v_mfma_f32_16x16x32_bf16 v[64:67], a[0:3], v[32:35], 0
    ds_read_b128 v[56:59], v18 offset:1024
    s_add_u32 m0, s29, 99200
    v_mfma_f32_16x16x32_bf16 v[68:71], a[4:7], v[32:35], 0
    buffer_load_dwordx4 v16, s[16:19], s34 offen offset:128 lds
    v_mfma_f32_16x16x32_bf16 v[72:75], a[0:3], v[36:39], 0
    ds_read_b128 v[60:63], v18 offset:17408
    v_mfma_f32_16x16x32_bf16 v[76:79], a[4:7], v[36:39], 0
    s_mov_b32 exec_hi, 0
    buffer_store_dwordx4 v[24:27], v21, s[8:11], s48 offen sc1
    s_mov_b32 exec_hi, -1

    s_waitcnt lgkmcnt(4)
    v_mfma_f32_16x16x32_bf16 v[64:67], a[8:11], v[40:43], v[64:67]
    ds_read_b128 v[32:35], v17 offset:2048
    v_mfma_f32_16x16x32_bf16 v[68:71], a[12:15], v[40:43], v[68:71]
    v_cvt_pk_bf16_f32 v96, v80, v81
    v_cvt_pk_bf16_f32 v97, v82, v83
    v_cvt_pk_bf16_f32 v98, v84, v85
    v_mfma_f32_16x16x32_bf16 v[72:75], a[8:11], v[44:47], v[72:75]
    ds_read_b128 v[36:39], v17 offset:18432
    v_mfma_f32_16x16x32_bf16 v[76:79], a[12:15], v[44:47], v[76:79]
    v_cvt_pk_bf16_f32 v99, v86, v87
    v_cvt_pk_bf16_f32 v100, v88, v89
    buffer_store_dwordx4 v[96:99], v21, s[8:11], s32 offen sc1
    s_waitcnt lgkmcnt(4)
    v_mfma_f32_16x16x32_bf16 v[64:67], a[16:19], v[48:51], v[64:67]
    ds_read_b128 v[40:43], v18 offset:2048
    s_add_u32 m0, s29, 100096
    v_mfma_f32_16x16x32_bf16 v[68:71], a[20:23], v[48:51], v[68:71]
    buffer_load_dwordx4 v16, s[16:19], s34 offen offset:256 lds
    v_mfma_f32_16x16x32_bf16 v[72:75], a[16:19], v[52:55], v[72:75]
    ds_read_b128 v[44:47], v18 offset:18432
    v_mfma_f32_16x16x32_bf16 v[76:79], a[20:23], v[52:55], v[76:79]
    v_cvt_pk_bf16_f32 v101, v90, v91
    v_cvt_pk_bf16_f32 v102, v92, v93
    v_cvt_pk_bf16_f32 v103, v94, v95
    s_waitcnt lgkmcnt(4)
    v_mfma_f32_16x16x32_bf16 v[64:67], a[24:27], v[56:59], v[64:67]
    ds_read_b128 v[48:51], v17 offset:3072
    v_mfma_f32_16x16x32_bf16 v[68:71], a[28:31], v[56:59], v[68:71]
    buffer_store_dwordx4 v[100:103], v21, s[8:11], s38 offen sc1
    v_mfma_f32_16x16x32_bf16 v[72:75], a[24:27], v[60:63], v[72:75]
    ds_read_b128 v[52:55], v17 offset:19456
    v_mfma_f32_16x16x32_bf16 v[76:79], a[28:31], v[60:63], v[76:79]
    s_waitcnt lgkmcnt(4)
    v_mfma_f32_16x16x32_bf16 v[64:67], a[32:35], v[32:35], v[64:67]
    ds_read_b128 v[56:59], v18 offset:3072
    s_add_u32 m0, s29, 100992
    v_mfma_f32_16x16x32_bf16 v[68:71], a[36:39], v[32:35], v[68:71]
    buffer_load_dwordx4 v16, s[16:19], s34 offen offset:384 lds
    v_mfma_f32_16x16x32_bf16 v[72:75], a[32:35], v[36:39], v[72:75]
    ds_read_b128 v[60:63], v18 offset:19456
    v_mfma_f32_16x16x32_bf16 v[76:79], a[36:39], v[36:39], v[76:79]
    s_waitcnt lgkmcnt(4)
    v_mfma_f32_16x16x32_bf16 v[64:67], a[40:43], v[40:43], v[64:67]
    ds_read_b128 v[32:35], v17 offset:4096
    v_mfma_f32_16x16x32_bf16 v[68:71], a[44:47], v[40:43], v[68:71]
    v_mfma_f32_16x16x32_bf16 v[72:75], a[40:43], v[44:47], v[72:75]
    ds_read_b128 v[36:39], v17 offset:20480
    v_mfma_f32_16x16x32_bf16 v[76:79], a[44:47], v[44:47], v[76:79]
    s_waitcnt lgkmcnt(4)
    v_mfma_f32_16x16x32_bf16 v[64:67], a[48:51], v[48:51], v[64:67]
    ds_read_b128 v[40:43], v18 offset:4096
    s_add_u32 m0, s29, 101888
    v_mfma_f32_16x16x32_bf16 v[68:71], a[52:55], v[48:51], v[68:71]
    buffer_load_dwordx4 v16, s[16:19], s34 offen offset:512 lds
    v_mfma_f32_16x16x32_bf16 v[72:75], a[48:51], v[52:55], v[72:75]
    ds_read_b128 v[44:47], v18 offset:20480
    v_mfma_f32_16x16x32_bf16 v[76:79], a[52:55], v[52:55], v[76:79]
    s_waitcnt lgkmcnt(4)
    v_mfma_f32_16x16x32_bf16 v[64:67], a[56:59], v[56:59], v[64:67]
    ds_read_b128 v[48:51], v17 offset:5120
    v_mfma_f32_16x16x32_bf16 v[68:71], a[60:63], v[56:59], v[68:71]
    v_mfma_f32_16x16x32_bf16 v[72:75], a[56:59], v[60:63], v[72:75]
    ds_read_b128 v[52:55], v17 offset:21504
    v_mfma_f32_16x16x32_bf16 v[76:79], a[60:63], v[60:63], v[76:79]
    s_waitcnt lgkmcnt(4)
    v_mfma_f32_16x16x32_bf16 v[64:67], a[64:67], v[32:35], v[64:67]
    ds_read_b128 v[56:59], v18 offset:5120
    s_add_u32 m0, s29, 102784
    v_mfma_f32_16x16x32_bf16 v[68:71], a[68:71], v[32:35], v[68:71]
    buffer_load_dwordx4 v16, s[16:19], s34 offen offset:640 lds
    v_mfma_f32_16x16x32_bf16 v[72:75], a[64:67], v[36:39], v[72:75]
    ds_read_b128 v[60:63], v18 offset:21504
    v_mfma_f32_16x16x32_bf16 v[76:79], a[68:71], v[36:39], v[76:79]
    s_waitcnt lgkmcnt(4)
    v_mfma_f32_16x16x32_bf16 v[64:67], a[72:75], v[40:43], v[64:67]
    ds_read_b128 v[32:35], v17 offset:6144
    v_mfma_f32_16x16x32_bf16 v[68:71], a[76:79], v[40:43], v[68:71]
    s_mov_b32 s32, s39
    s_add_u32 s38, s39, 4096
    v_mfma_f32_16x16x32_bf16 v[72:75], a[72:75], v[44:47], v[72:75]
    ds_read_b128 v[36:39], v17 offset:22528
    s_add_u32 s39, s39, 262144
    s_mov_b32 s48, s49
    v_mfma_f32_16x16x32_bf16 v[76:79], a[76:79], v[44:47], v[76:79]
    s_add_u32 s49, s49, 196608
    v_add_u32 v23, 1, v23
    s_waitcnt lgkmcnt(4)
    v_mfma_f32_16x16x32_bf16 v[64:67], a[80:83], v[48:51], v[64:67]
    ds_read_b128 v[40:43], v18 offset:6144
    s_add_u32 m0, s29, 103680
    v_mfma_f32_16x16x32_bf16 v[68:71], a[84:87], v[48:51], v[68:71]
    buffer_load_dwordx4 v16, s[16:19], s34 offen offset:768 lds
    v_mfma_f32_16x16x32_bf16 v[72:75], a[80:83], v[52:55], v[72:75]
    ds_read_b128 v[44:47], v18 offset:22528
    v_mfma_f32_16x16x32_bf16 v[76:79], a[84:87], v[52:55], v[76:79]
    s_waitcnt lgkmcnt(4)
    v_mfma_f32_16x16x32_bf16 v[64:67], a[88:91], v[56:59], v[64:67]
    ds_read_b128 v[48:51], v17 offset:7168
    v_mfma_f32_16x16x32_bf16 v[68:71], a[92:95], v[56:59], v[68:71]
    s_mov_b64 exec, s[44:45]
    buffer_store_dwordx4 v[24:27], v28, s[8:11], s46 offen sc1
    s_mov_b64 exec, -1
    v_mfma_f32_16x16x32_bf16 v[72:75], a[88:91], v[60:63], v[72:75]
    ds_read_b128 v[52:55], v17 offset:23552
    v_mfma_f32_16x16x32_bf16 v[76:79], a[92:95], v[60:63], v[76:79]
    s_waitcnt lgkmcnt(4)
    v_mfma_f32_16x16x32_bf16 v[64:67], a[96:99], v[32:35], v[64:67]
    ds_read_b128 v[56:59], v18 offset:7168
    s_add_u32 m0, s29, 104576
    v_mfma_f32_16x16x32_bf16 v[68:71], a[100:103], v[32:35], v[68:71]
    buffer_load_dwordx4 v16, s[16:19], s34 offen offset:896 lds
    v_mfma_f32_16x16x32_bf16 v[72:75], a[96:99], v[36:39], v[72:75]
    ds_read_b128 v[60:63], v18 offset:23552
    v_mfma_f32_16x16x32_bf16 v[76:79], a[100:103], v[36:39], v[76:79]
    s_waitcnt lgkmcnt(4)
    v_mfma_f32_16x16x32_bf16 v[64:67], a[104:107], v[40:43], v[64:67]
    s_add_u32 s34, s34, 64512
    s_min_u32 s34, s34, 4128768
    v_mfma_f32_16x16x32_bf16 v[68:71], a[108:111], v[40:43], v[68:71]
    v_mfma_f32_16x16x32_bf16 v[72:75], a[104:107], v[44:47], v[72:75]
    v_mfma_f32_16x16x32_bf16 v[76:79], a[108:111], v[44:47], v[76:79]
    s_waitcnt lgkmcnt(0)
    s_cmp_lt_u32 s35, 2
    s_cselect_b64 s[70:71], s[36:37], 0
    s_cbranch_scc1 .ew_412
.ef_411:
    s_waitcnt vmcnt(19)
    s_barrier
    ds_read_b128 v[32:35], v17 offset:32768
    ds_read_b128 v[36:39], v17 offset:49152
    v_mfma_f32_16x16x32_bf16 v[64:67], a[112:115], v[48:51], v[64:67]
    ds_read_b128 v[40:43], v18 offset:32768
    s_add_u32 m0, s29, 0
    v_mfma_f32_16x16x32_bf16 v[68:71], a[116:119], v[48:51], v[68:71]
    buffer_load_dwordx4 v16, s[16:19], s34 offen offset:0 lds
    v_mfma_f32_16x16x32_bf16 v[72:75], a[112:115], v[52:55], v[72:75]
    ds_read_b128 v[44:47], v18 offset:49152
    v_mfma_f32_16x16x32_bf16 v[76:79], a[116:119], v[52:55], v[76:79]
    v_mfma_f32_16x16x32_bf16 v[64:67], a[120:123], v[56:59], v[64:67]
    ds_read_b128 v[48:51], v17 offset:33792
    v_mfma_f32_16x16x32_bf16 v[68:71], a[124:127], v[56:59], v[68:71]
    v_mfma_f32_16x16x32_bf16 v[72:75], a[120:123], v[60:63], v[72:75]
    ds_read_b128 v[52:55], v17 offset:50176
    v_mfma_f32_16x16x32_bf16 v[76:79], a[124:127], v[60:63], v[76:79]
    s_mov_b64 exec, s[70:71]
    buffer_store_dword v23, v22, s[8:11], s33 offen sc1
    s_mov_b64 exec, -1

    s_waitcnt lgkmcnt(4)
    v_mfma_f32_16x16x32_bf16 v[64:67], a[128:131], v[32:35], v[64:67]
    ds_read_b128 v[56:59], v18 offset:33792
    s_add_u32 m0, s29, 896
    v_mfma_f32_16x16x32_bf16 v[68:71], a[132:135], v[32:35], v[68:71]
    buffer_load_dwordx4 v16, s[16:19], s34 offen offset:128 lds
    v_mfma_f32_16x16x32_bf16 v[72:75], a[128:131], v[36:39], v[72:75]
    ds_read_b128 v[60:63], v18 offset:50176
    v_mfma_f32_16x16x32_bf16 v[76:79], a[132:135], v[36:39], v[76:79]
    s_waitcnt lgkmcnt(4)
    v_mfma_f32_16x16x32_bf16 v[64:67], a[136:139], v[40:43], v[64:67]
    ds_read_b128 v[32:35], v17 offset:34816
    v_mfma_f32_16x16x32_bf16 v[68:71], a[140:143], v[40:43], v[68:71]
    v_mfma_f32_16x16x32_bf16 v[72:75], a[136:139], v[44:47], v[72:75]
    ds_read_b128 v[36:39], v17 offset:51200
    v_mfma_f32_16x16x32_bf16 v[76:79], a[140:143], v[44:47], v[76:79]
    s_waitcnt lgkmcnt(4)
    v_mfma_f32_16x16x32_bf16 v[64:67], a[144:147], v[48:51], v[64:67]
    ds_read_b128 v[40:43], v18 offset:34816
    s_add_u32 m0, s29, 1792
    v_mfma_f32_16x16x32_bf16 v[68:71], a[148:151], v[48:51], v[68:71]
    buffer_load_dwordx4 v16, s[16:19], s34 offen offset:256 lds
    v_mfma_f32_16x16x32_bf16 v[72:75], a[144:147], v[52:55], v[72:75]
    ds_read_b128 v[44:47], v18 offset:51200
    v_mfma_f32_16x16x32_bf16 v[76:79], a[148:151], v[52:55], v[76:79]
    s_waitcnt lgkmcnt(4)
    v_mfma_f32_16x16x32_bf16 v[64:67], a[152:155], v[56:59], v[64:67]
    ds_read_b128 v[48:51], v17 offset:35840
    v_mfma_f32_16x16x32_bf16 v[68:71], a[156:159], v[56:59], v[68:71]
    v_mfma_f32_16x16x32_bf16 v[72:75], a[152:155], v[60:63], v[72:75]
    ds_read_b128 v[52:55], v17 offset:52224
    v_mfma_f32_16x16x32_bf16 v[76:79], a[156:159], v[60:63], v[76:79]
    s_waitcnt lgkmcnt(4)
    v_mfma_f32_16x16x32_bf16 v[64:67], a[160:163], v[32:35], v[64:67]
    ds_read_b128 v[56:59], v18 offset:35840
    s_add_u32 m0, s29, 2688
    v_mfma_f32_16x16x32_bf16 v[68:71], a[164:167], v[32:35], v[68:71]
    buffer_load_dwordx4 v16, s[16:19], s34 offen offset:384 lds
    v_mfma_f32_16x16x32_bf16 v[72:75], a[160:163], v[36:39], v[72:75]
    ds_read_b128 v[60:63], v18 offset:52224
    v_mfma_f32_16x16x32_bf16 v[76:79], a[164:167], v[36:39], v[76:79]
    s_waitcnt lgkmcnt(4)
    v_mfma_f32_16x16x32_bf16 v[64:67], a[168:171], v[40:43], v[64:67]
    ds_read_b128 v[32:35], v17 offset:36864
    v_mfma_f32_16x16x32_bf16 v[68:71], a[172:175], v[40:43], v[68:71]
    v_mfma_f32_16x16x32_bf16 v[72:75], a[168:171], v[44:47], v[72:75]
    ds_read_b128 v[36:39], v17 offset:53248
    v_mfma_f32_16x16x32_bf16 v[76:79], a[172:175], v[44:47], v[76:79]
    s_waitcnt lgkmcnt(4)
    v_mfma_f32_16x16x32_bf16 v[64:67], a[176:179], v[48:51], v[64:67]
    ds_read_b128 v[40:43], v18 offset:36864
    s_add_u32 m0, s29, 3584
    v_mfma_f32_16x16x32_bf16 v[68:71], a[180:183], v[48:51], v[68:71]
    buffer_load_dwordx4 v16, s[16:19], s34 offen offset:512 lds
    v_mfma_f32_16x16x32_bf16 v[72:75], a[176:179], v[52:55], v[72:75]
    ds_read_b128 v[44:47], v18 offset:53248
    v_mfma_f32_16x16x32_bf16 v[76:79], a[180:183], v[52:55], v[76:79]
    s_waitcnt lgkmcnt(4)
    v_mfma_f32_16x16x32_bf16 v[64:67], a[184:187], v[56:59], v[64:67]
    ds_read_b128 v[48:51], v17 offset:37888
    v_mfma_f32_16x16x32_bf16 v[68:71], a[188:191], v[56:59], v[68:71]
    v_mfma_f32_16x16x32_bf16 v[72:75], a[184:187], v[60:63], v[72:75]
    ds_read_b128 v[52:55], v17 offset:54272
    v_mfma_f32_16x16x32_bf16 v[76:79], a[188:191], v[60:63], v[76:79]
    s_waitcnt lgkmcnt(4)
    v_mfma_f32_16x16x32_bf16 v[64:67], a[192:195], v[32:35], v[64:67]
    ds_read_b128 v[56:59], v18 offset:37888
    s_add_u32 m0, s29, 4480
    v_mfma_f32_16x16x32_bf16 v[68:71], a[196:199], v[32:35], v[68:71]
    buffer_load_dwordx4 v16, s[16:19], s34 offen offset:640 lds
    v_mfma_f32_16x16x32_bf16 v[72:75], a[192:195], v[36:39], v[72:75]
    ds_read_b128 v[60:63], v18 offset:54272
    v_mfma_f32_16x16x32_bf16 v[76:79], a[196:199], v[36:39], v[76:79]
    s_waitcnt lgkmcnt(4)
    v_mfma_f32_16x16x32_bf16 v[64:67], a[200:203], v[40:43], v[64:67]
    ds_read_b128 v[32:35], v17 offset:38912
    v_mfma_f32_16x16x32_bf16 v[68:71], a[204:207], v[40:43], v[68:71]
    v_mfma_f32_16x16x32_bf16 v[72:75], a[200:203], v[44:47], v[72:75]
    ds_read_b128 v[36:39], v17 offset:55296
    v_mfma_f32_16x16x32_bf16 v[76:79], a[204:207], v[44:47], v[76:79]
    s_waitcnt lgkmcnt(4)
    v_mfma_f32_16x16x32_bf16 v[64:67], a[208:211], v[48:51], v[64:67]
    ds_read_b128 v[40:43], v18 offset:38912
    s_add_u32 m0, s29, 5376
    v_mfma_f32_16x16x32_bf16 v[68:71], a[212:215], v[48:51], v[68:71]
    buffer_load_dwordx4 v16, s[16:19], s34 offen offset:768 lds
    v_mfma_f32_16x16x32_bf16 v[72:75], a[208:211], v[52:55], v[72:75]
    ds_read_b128 v[44:47], v18 offset:55296
    v_mfma_f32_16x16x32_bf16 v[76:79], a[212:215], v[52:55], v[76:79]
    s_waitcnt lgkmcnt(4)
    v_mfma_f32_16x16x32_bf16 v[64:67], a[216:219], v[56:59], v[64:67]
    ds_read_b128 v[48:51], v17 offset:39936
    v_mfma_f32_16x16x32_bf16 v[68:71], a[220:223], v[56:59], v[68:71]
    s_mov_b64 exec, s[44:45]
    buffer_store_dwordx4 v[24:27], v29, s[8:11], s46 offen sc1
    s_mov_b64 exec, -1
    v_mfma_f32_16x16x32_bf16 v[72:75], a[216:219], v[60:63], v[72:75]
    ds_read_b128 v[52:55], v17 offset:56320
    v_mfma_f32_16x16x32_bf16 v[76:79], a[220:223], v[60:63], v[76:79]
    s_waitcnt lgkmcnt(4)
    v_mfma_f32_16x16x32_bf16 v[64:67], a[224:227], v[32:35], v[64:67]
    ds_read_b128 v[56:59], v18 offset:39936
    s_add_u32 m0, s29, 6272
    v_mfma_f32_16x16x32_bf16 v[68:71], a[228:231], v[32:35], v[68:71]
    buffer_load_dwordx4 v16, s[16:19], s34 offen offset:896 lds
    v_mfma_f32_16x16x32_bf16 v[72:75], a[224:227], v[36:39], v[72:75]
    ds_read_b128 v[60:63], v18 offset:56320
    v_mfma_f32_16x16x32_bf16 v[76:79], a[228:231], v[36:39], v[76:79]
    s_waitcnt lgkmcnt(4)
    v_mfma_f32_16x16x32_bf16 v[64:67], a[232:235], v[40:43], v[64:67]
    s_add_u32 s34, s34, 1024
    v_mfma_f32_16x16x32_bf16 v[68:71], a[236:239], v[40:43], v[68:71]
    v_mfma_f32_16x16x32_bf16 v[72:75], a[232:235], v[44:47], v[72:75]
    v_mfma_f32_16x16x32_bf16 v[76:79], a[236:239], v[44:47], v[76:79]
    s_waitcnt lgkmcnt(0)
    s_waitcnt vmcnt(13)
    s_barrier
    ds_read_b128 v[32:35], v19 offset:0
    ds_read_b128 v[36:39], v19 offset:16384
    v_mfma_f32_16x16x32_bf16 v[64:67], a[240:243], v[48:51], v[64:67]
    ds_read_b128 v[40:43], v20 offset:0
    s_add_u32 m0, s29, 32768
    v_mfma_f32_16x16x32_bf16 v[68:71], a[244:247], v[48:51], v[68:71]
    buffer_load_dwordx4 v16, s[16:19], s34 offen offset:0 lds
    v_mfma_f32_16x16x32_bf16 v[72:75], a[240:243], v[52:55], v[72:75]
    ds_read_b128 v[44:47], v20 offset:16384
    v_mfma_f32_16x16x32_bf16 v[76:79], a[244:247], v[52:55], v[76:79]
    v_mfma_f32_16x16x32_bf16 v[64:67], a[248:251], v[56:59], v[64:67]
    ds_read_b128 v[48:51], v19 offset:1024
    v_mfma_f32_16x16x32_bf16 v[68:71], a[252:255], v[56:59], v[68:71]
    v_mfma_f32_16x16x32_bf16 v[72:75], a[248:251], v[60:63], v[72:75]
    ds_read_b128 v[52:55], v19 offset:17408
    v_mfma_f32_16x16x32_bf16 v[76:79], a[252:255], v[60:63], v[76:79]
    s_mov_b64 exec, s[36:37]
    buffer_store_dword v23, v22, s[8:11], s33 offen sc1
    s_mov_b64 exec, -1

.qe_410:
    s_waitcnt lgkmcnt(4)
    v_mfma_f32_16x16x32_bf16 v[80:83], a[0:3], v[32:35], 0
    ds_read_b128 v[56:59], v20 offset:1024
    s_add_u32 m0, s29, 33664
    v_mfma_f32_16x16x32_bf16 v[84:87], a[4:7], v[32:35], 0
    buffer_load_dwordx4 v16, s[16:19], s34 offen offset:128 lds
    v_mfma_f32_16x16x32_bf16 v[88:91], a[0:3], v[36:39], 0
    ds_read_b128 v[60:63], v20 offset:17408
    v_mfma_f32_16x16x32_bf16 v[92:95], a[4:7], v[36:39], 0
    s_mov_b32 exec_hi, 0
    buffer_store_dwordx4 v[24:27], v21, s[8:11], s48 offen sc1
    s_mov_b32 exec_hi, -1

    s_waitcnt lgkmcnt(4)
    v_mfma_f32_16x16x32_bf16 v[80:83], a[8:11], v[40:43], v[80:83]
    ds_read_b128 v[32:35], v19 offset:2048
    v_mfma_f32_16x16x32_bf16 v[84:87], a[12:15], v[40:43], v[84:87]
    v_cvt_pk_bf16_f32 v96, v64, v65
    v_cvt_pk_bf16_f32 v97, v66, v67
    v_cvt_pk_bf16_f32 v98, v68, v69
    v_mfma_f32_16x16x32_bf16 v[88:91], a[8:11], v[44:47], v[88:91]
    ds_read_b128 v[36:39], v19 offset:18432
    v_mfma_f32_16x16x32_bf16 v[92:95], a[12:15], v[44:47], v[92:95]
    v_cvt_pk_bf16_f32 v99, v70, v71
    v_cvt_pk_bf16_f32 v100, v72, v73
    buffer_store_dwordx4 v[96:99], v21, s[8:11], s32 offen sc1
    s_waitcnt lgkmcnt(4)
    v_mfma_f32_16x16x32_bf16 v[80:83], a[16:19], v[48:51], v[80:83]
    ds_read_b128 v[40:43], v20 offset:2048
    s_add_u32 m0, s29, 34560
    v_mfma_f32_16x16x32_bf16 v[84:87], a[20:23], v[48:51], v[84:87]
    buffer_load_dwordx4 v16, s[16:19], s34 offen offset:256 lds
    v_mfma_f32_16x16x32_bf16 v[88:91], a[16:19], v[52:55], v[88:91]
    ds_read_b128 v[44:47], v20 offset:18432
    v_mfma_f32_16x16x32_bf16 v[92:95], a[20:23], v[52:55], v[92:95]
    v_cvt_pk_bf16_f32 v101, v74, v75
    v_cvt_pk_bf16_f32 v102, v76, v77
    v_cvt_pk_bf16_f32 v103, v78, v79
    s_waitcnt lgkmcnt(4)
    v_mfma_f32_16x16x32_bf16 v[80:83], a[24:27], v[56:59], v[80:83]
    ds_read_b128 v[48:51], v19 offset:3072
    v_mfma_f32_16x16x32_bf16 v[84:87], a[28:31], v[56:59], v[84:87]
    buffer_store_dwordx4 v[100:103], v21, s[8:11], s38 offen sc1
    v_mfma_f32_16x16x32_bf16 v[88:91], a[24:27], v[60:63], v[88:91]
    ds_read_b128 v[52:55], v19 offset:19456
    v_mfma_f32_16x16x32_bf16 v[92:95], a[28:31], v[60:63], v[92:95]
    s_waitcnt lgkmcnt(4)
    v_mfma_f32_16x16x32_bf16 v[80:83], a[32:35], v[32:35], v[80:83]
    ds_read_b128 v[56:59], v20 offset:3072
    s_add_u32 m0, s29, 35456
    v_mfma_f32_16x16x32_bf16 v[84:87], a[36:39], v[32:35], v[84:87]
    buffer_load_dwordx4 v16, s[16:19], s34 offen offset:384 lds
    v_mfma_f32_16x16x32_bf16 v[88:91], a[32:35], v[36:39], v[88:91]
    ds_read_b128 v[60:63], v20 offset:19456
    v_mfma_f32_16x16x32_bf16 v[92:95], a[36:39], v[36:39], v[92:95]
    s_waitcnt lgkmcnt(4)
    v_mfma_f32_16x16x32_bf16 v[80:83], a[40:43], v[40:43], v[80:83]
    ds_read_b128 v[32:35], v19 offset:4096
    v_mfma_f32_16x16x32_bf16 v[84:87], a[44:47], v[40:43], v[84:87]
    v_mfma_f32_16x16x32_bf16 v[88:91], a[40:43], v[44:47], v[88:91]
    ds_read_b128 v[36:39], v19 offset:20480
    v_mfma_f32_16x16x32_bf16 v[92:95], a[44:47], v[44:47], v[92:95]
    s_waitcnt lgkmcnt(4)
    v_mfma_f32_16x16x32_bf16 v[80:83], a[48:51], v[48:51], v[80:83]
    ds_read_b128 v[40:43], v20 offset:4096
    s_add_u32 m0, s29, 36352
    v_mfma_f32_16x16x32_bf16 v[84:87], a[52:55], v[48:51], v[84:87]
    buffer_load_dwordx4 v16, s[16:19], s34 offen offset:512 lds
    v_mfma_f32_16x16x32_bf16 v[88:91], a[48:51], v[52:55], v[88:91]
    ds_read_b128 v[44:47], v20 offset:20480
    v_mfma_f32_16x16x32_bf16 v[92:95], a[52:55], v[52:55], v[92:95]
    s_waitcnt lgkmcnt(4)
    v_mfma_f32_16x16x32_bf16 v[80:83], a[56:59], v[56:59], v[80:83]
    ds_read_b128 v[48:51], v19 offset:5120
    v_mfma_f32_16x16x32_bf16 v[84:87], a[60:63], v[56:59], v[84:87]
    v_mfma_f32_16x16x32_bf16 v[88:91], a[56:59], v[60:63], v[88:91]
    ds_read_b128 v[52:55], v19 offset:21504
    v_mfma_f32_16x16x32_bf16 v[92:95], a[60:63], v[60:63], v[92:95]
    s_waitcnt lgkmcnt(4)
    v_mfma_f32_16x16x32_bf16 v[80:83], a[64:67], v[32:35], v[80:83]
    ds_read_b128 v[56:59], v20 offset:5120
    s_add_u32 m0, s29, 37248
    v_mfma_f32_16x16x32_bf16 v[84:87], a[68:71], v[32:35], v[84:87]
    buffer_load_dwordx4 v16, s[16:19], s34 offen offset:640 lds
    v_mfma_f32_16x16x32_bf16 v[88:91], a[64:67], v[36:39], v[88:91]
    ds_read_b128 v[60:63], v20 offset:21504
    v_mfma_f32_16x16x32_bf16 v[92:95], a[68:71], v[36:39], v[92:95]
    s_waitcnt lgkmcnt(4)
    v_mfma_f32_16x16x32_bf16 v[80:83], a[72:75], v[40:43], v[80:83]
    ds_read_b128 v[32:35], v19 offset:6144
    v_mfma_f32_16x16x32_bf16 v[84:87], a[76:79], v[40:43], v[84:87]
    s_mov_b32 s32, s39
    s_add_u32 s38, s39, 4096
    v_mfma_f32_16x16x32_bf16 v[88:91], a[72:75], v[44:47], v[88:91]
    ds_read_b128 v[36:39], v19 offset:22528
    s_add_u32 s39, s39, 262144
    s_mov_b32 s48, s49
    v_mfma_f32_16x16x32_bf16 v[92:95], a[76:79], v[44:47], v[92:95]
    s_add_u32 s49, s49, 196608
    v_add_u32 v23, 1, v23
    s_waitcnt lgkmcnt(4)
    v_mfma_f32_16x16x32_bf16 v[80:83], a[80:83], v[48:51], v[80:83]
    ds_read_b128 v[40:43], v20 offset:6144
    s_add_u32 m0, s29, 38144
    v_mfma_f32_16x16x32_bf16 v[84:87], a[84:87], v[48:51], v[84:87]
    buffer_load_dwordx4 v16, s[16:19], s34 offen offset:768 lds
    v_mfma_f32_16x16x32_bf16 v[88:91], a[80:83], v[52:55], v[88:91]
    ds_read_b128 v[44:47], v20 offset:22528
    v_mfma_f32_16x16x32_bf16 v[92:95], a[84:87], v[52:55], v[92:95]
    s_waitcnt lgkmcnt(4)
    v_mfma_f32_16x16x32_bf16 v[80:83], a[88:91], v[56:59], v[80:83]
    ds_read_b128 v[48:51], v19 offset:7168
    v_mfma_f32_16x16x32_bf16 v[84:87], a[92:95], v[56:59], v[84:87]
    s_mov_b64 exec, s[44:45]
    buffer_store_dwordx4 v[24:27], v30, s[8:11], s46 offen sc1
    s_mov_b64 exec, -1
    v_mfma_f32_16x16x32_bf16 v[88:91], a[88:91], v[60:63], v[88:91]
    ds_read_b128 v[52:55], v19 offset:23552
    v_mfma_f32_16x16x32_bf16 v[92:95], a[92:95], v[60:63], v[92:95]
    s_waitcnt lgkmcnt(4)
    v_mfma_f32_16x16x32_bf16 v[80:83], a[96:99], v[32:35], v[80:83]
    ds_read_b128 v[56:59], v20 offset:7168
    s_add_u32 m0, s29, 39040
    v_mfma_f32_16x16x32_bf16 v[84:87], a[100:103], v[32:35], v[84:87]
    buffer_load_dwordx4 v16, s[16:19], s34 offen offset:896 lds
    v_mfma_f32_16x16x32_bf16 v[88:91], a[96:99], v[36:39], v[88:91]
    ds_read_b128 v[60:63], v20 offset:23552
    v_mfma_f32_16x16x32_bf16 v[92:95], a[100:103], v[36:39], v[92:95]
    s_waitcnt lgkmcnt(4)
    v_mfma_f32_16x16x32_bf16 v[80:83], a[104:107], v[40:43], v[80:83]
    s_add_u32 s34, s34, 64512
    s_min_u32 s34, s34, 4128768
    v_mfma_f32_16x16x32_bf16 v[84:87], a[108:111], v[40:43], v[84:87]
    v_mfma_f32_16x16x32_bf16 v[88:91], a[104:107], v[44:47], v[88:91]
    v_mfma_f32_16x16x32_bf16 v[92:95], a[108:111], v[44:47], v[92:95]
    s_waitcnt lgkmcnt(0)
    s_cmp_lt_u32 s35, 2
    s_cselect_b64 s[70:71], s[36:37], 0
    s_cbranch_scc1 .ew_414
.ef_413:
    s_waitcnt vmcnt(19)
    s_barrier
    ds_read_b128 v[32:35], v19 offset:32768
    ds_read_b128 v[36:39], v19 offset:49152
    v_mfma_f32_16x16x32_bf16 v[80:83], a[112:115], v[48:51], v[80:83]
    ds_read_b128 v[40:43], v20 offset:32768
    s_add_u32 m0, s29, 65536
    v_mfma_f32_16x16x32_bf16 v[84:87], a[116:119], v[48:51], v[84:87]
    buffer_load_dwordx4 v16, s[16:19], s34 offen offset:0 lds
    v_mfma_f32_16x16x32_bf16 v[88:91], a[112:115], v[52:55], v[88:91]
    ds_read_b128 v[44:47], v20 offset:49152
    v_mfma_f32_16x16x32_bf16 v[92:95], a[116:119], v[52:55], v[92:95]
    v_mfma_f32_16x16x32_bf16 v[80:83], a[120:123], v[56:59], v[80:83]
    ds_read_b128 v[48:51], v19 offset:33792
    v_mfma_f32_16x16x32_bf16 v[84:87], a[124:127], v[56:59], v[84:87]
    v_mfma_f32_16x16x32_bf16 v[88:91], a[120:123], v[60:63], v[88:91]
    ds_read_b128 v[52:55], v19 offset:50176
    v_mfma_f32_16x16x32_bf16 v[92:95], a[124:127], v[60:63], v[92:95]
    s_mov_b64 exec, s[70:71]
    buffer_store_dword v23, v22, s[8:11], s33 offen sc1
    s_mov_b64 exec, -1

    s_waitcnt lgkmcnt(4)
    v_mfma_f32_16x16x32_bf16 v[80:83], a[128:131], v[32:35], v[80:83]
    ds_read_b128 v[56:59], v20 offset:33792
    s_add_u32 m0, s29, 66432
    v_mfma_f32_16x16x32_bf16 v[84:87], a[132:135], v[32:35], v[84:87]
    buffer_load_dwordx4 v16, s[16:19], s34 offen offset:128 lds
    v_mfma_f32_16x16x32_bf16 v[88:91], a[128:131], v[36:39], v[88:91]
    ds_read_b128 v[60:63], v20 offset:50176
    v_mfma_f32_16x16x32_bf16 v[92:95], a[132:135], v[36:39], v[92:95]
    s_waitcnt lgkmcnt(4)
    v_mfma_f32_16x16x32_bf16 v[80:83], a[136:139], v[40:43], v[80:83]
    ds_read_b128 v[32:35], v19 offset:34816
    v_mfma_f32_16x16x32_bf16 v[84:87], a[140:143], v[40:43], v[84:87]
    v_mfma_f32_16x16x32_bf16 v[88:91], a[136:139], v[44:47], v[88:91]
    ds_read_b128 v[36:39], v19 offset:51200
    v_mfma_f32_16x16x32_bf16 v[92:95], a[140:143], v[44:47], v[92:95]
    s_waitcnt lgkmcnt(4)
    v_mfma_f32_16x16x32_bf16 v[80:83], a[144:147], v[48:51], v[80:83]
    ds_read_b128 v[40:43], v20 offset:34816
    s_add_u32 m0, s29, 67328
    v_mfma_f32_16x16x32_bf16 v[84:87], a[148:151], v[48:51], v[84:87]
    buffer_load_dwordx4 v16, s[16:19], s34 offen offset:256 lds
    v_mfma_f32_16x16x32_bf16 v[88:91], a[144:147], v[52:55], v[88:91]
    ds_read_b128 v[44:47], v20 offset:51200
    v_mfma_f32_16x16x32_bf16 v[92:95], a[148:151], v[52:55], v[92:95]
    s_waitcnt lgkmcnt(4)
    v_mfma_f32_16x16x32_bf16 v[80:83], a[152:155], v[56:59], v[80:83]
    ds_read_b128 v[48:51], v19 offset:35840
    v_mfma_f32_16x16x32_bf16 v[84:87], a[156:159], v[56:59], v[84:87]
    v_mfma_f32_16x16x32_bf16 v[88:91], a[152:155], v[60:63], v[88:91]
    ds_read_b128 v[52:55], v19 offset:52224
    v_mfma_f32_16x16x32_bf16 v[92:95], a[156:159], v[60:63], v[92:95]
    s_waitcnt lgkmcnt(4)
    v_mfma_f32_16x16x32_bf16 v[80:83], a[160:163], v[32:35], v[80:83]
    ds_read_b128 v[56:59], v20 offset:35840
    s_add_u32 m0, s29, 68224
    v_mfma_f32_16x16x32_bf16 v[84:87], a[164:167], v[32:35], v[84:87]
    buffer_load_dwordx4 v16, s[16:19], s34 offen offset:384 lds
    v_mfma_f32_16x16x32_bf16 v[88:91], a[160:163], v[36:39], v[88:91]
    ds_read_b128 v[60:63], v20 offset:52224
    v_mfma_f32_16x16x32_bf16 v[92:95], a[164:167], v[36:39], v[92:95]
    s_waitcnt lgkmcnt(4)
    v_mfma_f32_16x16x32_bf16 v[80:83], a[168:171], v[40:43], v[80:83]
    ds_read_b128 v[32:35], v19 offset:36864
    v_mfma_f32_16x16x32_bf16 v[84:87], a[172:175], v[40:43], v[84:87]
    v_mfma_f32_16x16x32_bf16 v[88:91], a[168:171], v[44:47], v[88:91]
    ds_read_b128 v[36:39], v19 offset:53248
    v_mfma_f32_16x16x32_bf16 v[92:95], a[172:175], v[44:47], v[92:95]
    s_waitcnt lgkmcnt(4)
    v_mfma_f32_16x16x32_bf16 v[80:83], a[176:179], v[48:51], v[80:83]
    ds_read_b128 v[40:43], v20 offset:36864
    s_add_u32 m0, s29, 69120
    v_mfma_f32_16x16x32_bf16 v[84:87], a[180:183], v[48:51], v[84:87]
    buffer_load_dwordx4 v16, s[16:19], s34 offen offset:512 lds
    v_mfma_f32_16x16x32_bf16 v[88:91], a[176:179], v[52:55], v[88:91]
    ds_read_b128 v[44:47], v20 offset:53248
    v_mfma_f32_16x16x32_bf16 v[92:95], a[180:183], v[52:55], v[92:95]
    s_waitcnt lgkmcnt(4)
    v_mfma_f32_16x16x32_bf16 v[80:83], a[184:187], v[56:59], v[80:83]
    ds_read_b128 v[48:51], v19 offset:37888
    v_mfma_f32_16x16x32_bf16 v[84:87], a[188:191], v[56:59], v[84:87]
    v_mfma_f32_16x16x32_bf16 v[88:91], a[184:187], v[60:63], v[88:91]
    ds_read_b128 v[52:55], v19 offset:54272
    v_mfma_f32_16x16x32_bf16 v[92:95], a[188:191], v[60:63], v[92:95]
    s_waitcnt lgkmcnt(4)
    v_mfma_f32_16x16x32_bf16 v[80:83], a[192:195], v[32:35], v[80:83]
    ds_read_b128 v[56:59], v20 offset:37888
    s_add_u32 m0, s29, 70016
    v_mfma_f32_16x16x32_bf16 v[84:87], a[196:199], v[32:35], v[84:87]
    buffer_load_dwordx4 v16, s[16:19], s34 offen offset:640 lds
    v_mfma_f32_16x16x32_bf16 v[88:91], a[192:195], v[36:39], v[88:91]
    ds_read_b128 v[60:63], v20 offset:54272
    v_mfma_f32_16x16x32_bf16 v[92:95], a[196:199], v[36:39], v[92:95]
    s_waitcnt lgkmcnt(4)
    v_mfma_f32_16x16x32_bf16 v[80:83], a[200:203], v[40:43], v[80:83]
    ds_read_b128 v[32:35], v19 offset:38912
    v_mfma_f32_16x16x32_bf16 v[84:87], a[204:207], v[40:43], v[84:87]
    v_mfma_f32_16x16x32_bf16 v[88:91], a[200:203], v[44:47], v[88:91]
    ds_read_b128 v[36:39], v19 offset:55296
    v_mfma_f32_16x16x32_bf16 v[92:95], a[204:207], v[44:47], v[92:95]
    s_waitcnt lgkmcnt(4)
    v_mfma_f32_16x16x32_bf16 v[80:83], a[208:211], v[48:51], v[80:83]
    ds_read_b128 v[40:43], v20 offset:38912
    s_add_u32 m0, s29, 70912
    v_mfma_f32_16x16x32_bf16 v[84:87], a[212:215], v[48:51], v[84:87]
    buffer_load_dwordx4 v16, s[16:19], s34 offen offset:768 lds
    v_mfma_f32_16x16x32_bf16 v[88:91], a[208:211], v[52:55], v[88:91]
    ds_read_b128 v[44:47], v20 offset:55296
    v_mfma_f32_16x16x32_bf16 v[92:95], a[212:215], v[52:55], v[92:95]
    s_waitcnt lgkmcnt(4)
    v_mfma_f32_16x16x32_bf16 v[80:83], a[216:219], v[56:59], v[80:83]
    ds_read_b128 v[48:51], v19 offset:39936
    v_mfma_f32_16x16x32_bf16 v[84:87], a[220:223], v[56:59], v[84:87]
    s_cmp_lt_u32 s35, 22
    s_cselect_b64 s[44:45], -1, 0
    v_mfma_f32_16x16x32_bf16 v[88:91], a[216:219], v[60:63], v[88:91]
    ds_read_b128 v[52:55], v19 offset:56320
    v_mfma_f32_16x16x32_bf16 v[92:95], a[220:223], v[60:63], v[92:95]
    s_cselect_b32 s4, 0x10000, 0
    s_add_u32 s46, s46, s4
    s_waitcnt lgkmcnt(4)
    v_mfma_f32_16x16x32_bf16 v[80:83], a[224:227], v[32:35], v[80:83]
    ds_read_b128 v[56:59], v20 offset:39936
    s_add_u32 m0, s29, 71808
    v_mfma_f32_16x16x32_bf16 v[84:87], a[228:231], v[32:35], v[84:87]
    buffer_load_dwordx4 v16, s[16:19], s34 offen offset:896 lds
    v_mfma_f32_16x16x32_bf16 v[88:91], a[224:227], v[36:39], v[88:91]
    ds_read_b128 v[60:63], v20 offset:56320
    v_mfma_f32_16x16x32_bf16 v[92:95], a[228:231], v[36:39], v[92:95]
    s_waitcnt lgkmcnt(4)
    v_mfma_f32_16x16x32_bf16 v[80:83], a[232:235], v[40:43], v[80:83]
    s_add_u32 s34, s34, 1024
    v_mfma_f32_16x16x32_bf16 v[84:87], a[236:239], v[40:43], v[84:87]
    v_mfma_f32_16x16x32_bf16 v[88:91], a[232:235], v[44:47], v[88:91]
    v_mfma_f32_16x16x32_bf16 v[92:95], a[236:239], v[44:47], v[92:95]
    s_waitcnt lgkmcnt(0)
    s_waitcnt vmcnt(13)
    s_barrier
    ds_read_b128 v[32:35], v17 offset:0
    ds_read_b128 v[36:39], v17 offset:16384
    v_mfma_f32_16x16x32_bf16 v[80:83], a[240:243], v[48:51], v[80:83]
    ds_read_b128 v[40:43], v18 offset:0
    s_add_u32 m0, s29, 98304
    v_mfma_f32_16x16x32_bf16 v[84:87], a[244:247], v[48:51], v[84:87]
    buffer_load_dwordx4 v16, s[16:19], s34 offen offset:0 lds
    v_mfma_f32_16x16x32_bf16 v[88:91], a[240:243], v[52:55], v[88:91]
    ds_read_b128 v[44:47], v18 offset:16384
    v_mfma_f32_16x16x32_bf16 v[92:95], a[244:247], v[52:55], v[92:95]
    v_mfma_f32_16x16x32_bf16 v[80:83], a[248:251], v[56:59], v[80:83]
    ds_read_b128 v[48:51], v17 offset:1024
    v_mfma_f32_16x16x32_bf16 v[84:87], a[252:255], v[56:59], v[84:87]
    v_mfma_f32_16x16x32_bf16 v[88:91], a[248:251], v[60:63], v[88:91]
    ds_read_b128 v[52:55], v17 offset:17408
    v_mfma_f32_16x16x32_bf16 v[92:95], a[252:255], v[60:63], v[92:95]
    s_mov_b64 exec, s[36:37]
    buffer_store_dword v23, v22, s[8:11], s33 offen sc1
    s_mov_b64 exec, -1

    s_add_u32 s35, s35, 1
    s_cmp_lt_u32 s35, 32
    s_cbranch_scc1 .ql_409

    s_nop 7
    v_cvt_pk_bf16_f32 v96, v80, v81
    v_cvt_pk_bf16_f32 v97, v82, v83
    v_cvt_pk_bf16_f32 v98, v84, v85
    v_cvt_pk_bf16_f32 v99, v86, v87
    buffer_store_dwordx4 v[96:99], v21, s[8:11], s32 offen sc1
    v_cvt_pk_bf16_f32 v100, v88, v89
    v_cvt_pk_bf16_f32 v101, v90, v91
    v_cvt_pk_bf16_f32 v102, v92, v93
    v_cvt_pk_bf16_f32 v103, v94, v95
    buffer_store_dwordx4 v[100:103], v21, s[8:11], s38 offen sc1
    s_mov_b32 exec_hi, 0
    buffer_store_dwordx4 v[24:27], v21, s[8:11], s48 offen sc1
    s_mov_b32 exec_hi, -1

    v_mov_b32 v23, 64
    s_waitcnt vmcnt(0) lgkmcnt(0)
    s_barrier
    s_mov_b64 exec, s[36:37]
    buffer_store_dword v23, v22, s[8:11], s33 offen sc1
    s_mov_b64 exec, -1

    s_branch .qd_389
.qv_388:
    s_waitcnt vmcnt(16)
    s_barrier
    ds_read_b128 v[32:35], v19 offset:0
    ds_read_b128 v[36:39], v19 offset:16384
    ds_read_b128 v[40:43], v20 offset:0
    ds_read_b128 v[44:47], v20 offset:16384
    s_add_u32 m0, s29, 32768
    s_nop 0
    buffer_load_dwordx4 v16, s[16:19], s34 offen offset:0 lds
    ds_read_b128 v[48:51], v19 offset:1024
    ds_read_b128 v[52:55], v19 offset:17408
    s_branch .qe_416
.p2align 6
.ql_415:
    s_waitcnt lgkmcnt(4)
    v_mfma_f32_16x16x32_bf16 v[64:67], v[32:35], a[0:3], 0
    ds_read_b128 v[56:59], v18 offset:1024
    s_add_u32 m0, s29, 99200
    v_mfma_f32_16x16x32_bf16 v[68:71], v[32:35], a[4:7], 0
    buffer_load_dwordx4 v16, s[16:19], s34 offen offset:128 lds
    v_mfma_f32_16x16x32_bf16 v[72:75], v[36:39], a[0:3], 0
    ds_read_b128 v[60:63], v18 offset:17408
    v_mfma_f32_16x16x32_bf16 v[76:79], v[36:39], a[4:7], 0
    s_mov_b32 exec_hi, 0
    buffer_store_dwordx4 v[24:27], v21, s[8:11], s48 offen sc1
    s_mov_b32 exec_hi, -1

    s_waitcnt lgkmcnt(4)
    v_mfma_f32_16x16x32_bf16 v[64:67], v[40:43], a[8:11], v[64:67]
    ds_read_b128 v[32:35], v17 offset:2048
    v_mfma_f32_16x16x32_bf16 v[68:71], v[40:43], a[12:15], v[68:71]
    v_cvt_pk_bf16_f32 v96, v80, v81
    v_cvt_pk_bf16_f32 v97, v82, v83
    v_cvt_pk_bf16_f32 v98, v88, v89
    v_mfma_f32_16x16x32_bf16 v[72:75], v[44:47], a[8:11], v[72:75]
    ds_read_b128 v[36:39], v17 offset:18432
    v_mfma_f32_16x16x32_bf16 v[76:79], v[44:47], a[12:15], v[76:79]
    v_cvt_pk_bf16_f32 v99, v90, v91
    v_cvt_pk_bf16_f32 v100, v84, v85
    buffer_store_dwordx4 v[96:99], v21, s[8:11], s32 offen offset:0 sc1
    s_waitcnt lgkmcnt(4)
    v_mfma_f32_16x16x32_bf16 v[64:67], v[48:51], a[16:19], v[64:67]
    ds_read_b128 v[40:43], v18 offset:2048
    s_add_u32 m0, s29, 100096
    v_mfma_f32_16x16x32_bf16 v[68:71], v[48:51], a[20:23], v[68:71]
    buffer_load_dwordx4 v16, s[16:19], s34 offen offset:256 lds
    v_mfma_f32_16x16x32_bf16 v[72:75], v[52:55], a[16:19], v[72:75]
    ds_read_b128 v[44:47], v18 offset:18432
    v_mfma_f32_16x16x32_bf16 v[76:79], v[52:55], a[20:23], v[76:79]
    v_cvt_pk_bf16_f32 v101, v86, v87
    v_cvt_pk_bf16_f32 v102, v92, v93
    v_cvt_pk_bf16_f32 v103, v94, v95
    s_waitcnt lgkmcnt(4)
    v_mfma_f32_16x16x32_bf16 v[64:67], v[56:59], a[24:27], v[64:67]
    ds_read_b128 v[48:51], v17 offset:3072
    v_mfma_f32_16x16x32_bf16 v[68:71], v[56:59], a[28:31], v[68:71]
    buffer_store_dwordx4 v[100:103], v21, s[8:11], s32 offen offset:1024 sc1
    v_mfma_f32_16x16x32_bf16 v[72:75], v[60:63], a[24:27], v[72:75]
    ds_read_b128 v[52:55], v17 offset:19456
    v_mfma_f32_16x16x32_bf16 v[76:79], v[60:63], a[28:31], v[76:79]
    s_waitcnt lgkmcnt(4)
    v_mfma_f32_16x16x32_bf16 v[64:67], v[32:35], a[32:35], v[64:67]
    ds_read_b128 v[56:59], v18 offset:3072
    s_add_u32 m0, s29, 100992
    v_mfma_f32_16x16x32_bf16 v[68:71], v[32:35], a[36:39], v[68:71]
    buffer_load_dwordx4 v16, s[16:19], s34 offen offset:384 lds
    v_mfma_f32_16x16x32_bf16 v[72:75], v[36:39], a[32:35], v[72:75]
    ds_read_b128 v[60:63], v18 offset:19456
    v_mfma_f32_16x16x32_bf16 v[76:79], v[36:39], a[36:39], v[76:79]
    s_waitcnt lgkmcnt(4)
    v_mfma_f32_16x16x32_bf16 v[64:67], v[40:43], a[40:43], v[64:67]
    ds_read_b128 v[32:35], v17 offset:4096
    v_mfma_f32_16x16x32_bf16 v[68:71], v[40:43], a[44:47], v[68:71]
    v_mfma_f32_16x16x32_bf16 v[72:75], v[44:47], a[40:43], v[72:75]
    ds_read_b128 v[36:39], v17 offset:20480
    v_mfma_f32_16x16x32_bf16 v[76:79], v[44:47], a[44:47], v[76:79]
    s_waitcnt lgkmcnt(4)
    v_mfma_f32_16x16x32_bf16 v[64:67], v[48:51], a[48:51], v[64:67]
    ds_read_b128 v[40:43], v18 offset:4096
    s_add_u32 m0, s29, 101888
    v_mfma_f32_16x16x32_bf16 v[68:71], v[48:51], a[52:55], v[68:71]
    buffer_load_dwordx4 v16, s[16:19], s34 offen offset:512 lds
    v_mfma_f32_16x16x32_bf16 v[72:75], v[52:55], a[48:51], v[72:75]
    ds_read_b128 v[44:47], v18 offset:20480
    v_mfma_f32_16x16x32_bf16 v[76:79], v[52:55], a[52:55], v[76:79]
    s_waitcnt lgkmcnt(4)
    v_mfma_f32_16x16x32_bf16 v[64:67], v[56:59], a[56:59], v[64:67]
    ds_read_b128 v[48:51], v17 offset:5120
    v_mfma_f32_16x16x32_bf16 v[68:71], v[56:59], a[60:63], v[68:71]
    v_mfma_f32_16x16x32_bf16 v[72:75], v[60:63], a[56:59], v[72:75]
    ds_read_b128 v[52:55], v17 offset:21504
    v_mfma_f32_16x16x32_bf16 v[76:79], v[60:63], a[60:63], v[76:79]
    s_waitcnt lgkmcnt(4)
    v_mfma_f32_16x16x32_bf16 v[64:67], v[32:35], a[64:67], v[64:67]
    ds_read_b128 v[56:59], v18 offset:5120
    s_add_u32 m0, s29, 102784
    v_mfma_f32_16x16x32_bf16 v[68:71], v[32:35], a[68:71], v[68:71]
    buffer_load_dwordx4 v16, s[16:19], s34 offen offset:640 lds
    v_mfma_f32_16x16x32_bf16 v[72:75], v[36:39], a[64:67], v[72:75]
    ds_read_b128 v[60:63], v18 offset:21504
    v_mfma_f32_16x16x32_bf16 v[76:79], v[36:39], a[68:71], v[76:79]
    s_waitcnt lgkmcnt(4)
    v_mfma_f32_16x16x32_bf16 v[64:67], v[40:43], a[72:75], v[64:67]
    ds_read_b128 v[32:35], v17 offset:6144
    v_mfma_f32_16x16x32_bf16 v[68:71], v[40:43], a[76:79], v[68:71]
    s_mov_b32 s32, s39
    s_add_u32 s38, s39, 4096
    v_mfma_f32_16x16x32_bf16 v[72:75], v[44:47], a[72:75], v[72:75]
    ds_read_b128 v[36:39], v17 offset:22528
    s_add_u32 s39, s39, 262144
    s_mov_b32 s48, s49
    v_mfma_f32_16x16x32_bf16 v[76:79], v[44:47], a[76:79], v[76:79]
    s_add_u32 s49, s49, 196608
    v_add_u32 v23, 1, v23
    s_waitcnt lgkmcnt(4)
    v_mfma_f32_16x16x32_bf16 v[64:67], v[48:51], a[80:83], v[64:67]
    ds_read_b128 v[40:43], v18 offset:6144
    s_add_u32 m0, s29, 103680
    v_mfma_f32_16x16x32_bf16 v[68:71], v[48:51], a[84:87], v[68:71]
    buffer_load_dwordx4 v16, s[16:19], s34 offen offset:768 lds
    v_mfma_f32_16x16x32_bf16 v[72:75], v[52:55], a[80:83], v[72:75]
    ds_read_b128 v[44:47], v18 offset:22528
    v_mfma_f32_16x16x32_bf16 v[76:79], v[52:55], a[84:87], v[76:79]
    s_waitcnt lgkmcnt(4)
    v_mfma_f32_16x16x32_bf16 v[64:67], v[56:59], a[88:91], v[64:67]
    ds_read_b128 v[48:51], v17 offset:7168
    v_mfma_f32_16x16x32_bf16 v[68:71], v[56:59], a[92:95], v[68:71]
    s_mov_b64 exec, s[44:45]
    buffer_store_dwordx4 v[24:27], v28, s[8:11], s46 offen sc1
    s_mov_b64 exec, -1
    v_mfma_f32_16x16x32_bf16 v[72:75], v[60:63], a[88:91], v[72:75]
    ds_read_b128 v[52:55], v17 offset:23552
    v_mfma_f32_16x16x32_bf16 v[76:79], v[60:63], a[92:95], v[76:79]
    s_waitcnt lgkmcnt(4)
    v_mfma_f32_16x16x32_bf16 v[64:67], v[32:35], a[96:99], v[64:67]
    ds_read_b128 v[56:59], v18 offset:7168
    s_add_u32 m0, s29, 104576
    v_mfma_f32_16x16x32_bf16 v[68:71], v[32:35], a[100:103], v[68:71]
    buffer_load_dwordx4 v16, s[16:19], s34 offen offset:896 lds
    v_mfma_f32_16x16x32_bf16 v[72:75], v[36:39], a[96:99], v[72:75]
    ds_read_b128 v[60:63], v18 offset:23552
    v_mfma_f32_16x16x32_bf16 v[76:79], v[36:39], a[100:103], v[76:79]
    s_waitcnt lgkmcnt(4)
    v_mfma_f32_16x16x32_bf16 v[64:67], v[40:43], a[104:107], v[64:67]
    s_add_u32 s34, s34, 64512
    s_min_u32 s34, s34, 4128768
    v_mfma_f32_16x16x32_bf16 v[68:71], v[40:43], a[108:111], v[68:71]
    v_mfma_f32_16x16x32_bf16 v[72:75], v[44:47], a[104:107], v[72:75]
    v_mfma_f32_16x16x32_bf16 v[76:79], v[44:47], a[108:111], v[76:79]
    s_waitcnt lgkmcnt(0)
    s_cmp_lt_u32 s35, 2
    s_cselect_b64 s[70:71], s[36:37], 0
    s_cbranch_scc1 .ew_418
.ef_417:
    s_waitcnt vmcnt(19)
    s_barrier
    ds_read_b128 v[32:35], v17 offset:32768
    ds_read_b128 v[36:39], v17 offset:49152
    v_mfma_f32_16x16x32_bf16 v[64:67], v[48:51], a[112:115], v[64:67]
    ds_read_b128 v[40:43], v18 offset:32768
    s_add_u32 m0, s29, 0
    v_mfma_f32_16x16x32_bf16 v[68:71], v[48:51], a[116:119], v[68:71]
    buffer_load_dwordx4 v16, s[16:19], s34 offen offset:0 lds
    v_mfma_f32_16x16x32_bf16 v[72:75], v[52:55], a[112:115], v[72:75]
    ds_read_b128 v[44:47], v18 offset:49152
    v_mfma_f32_16x16x32_bf16 v[76:79], v[52:55], a[116:119], v[76:79]
    v_mfma_f32_16x16x32_bf16 v[64:67], v[56:59], a[120:123], v[64:67]
    ds_read_b128 v[48:51], v17 offset:33792
    v_mfma_f32_16x16x32_bf16 v[68:71], v[56:59], a[124:127], v[68:71]
    v_mfma_f32_16x16x32_bf16 v[72:75], v[60:63], a[120:123], v[72:75]
    ds_read_b128 v[52:55], v17 offset:50176
    v_mfma_f32_16x16x32_bf16 v[76:79], v[60:63], a[124:127], v[76:79]
    s_mov_b64 exec, s[70:71]
    buffer_store_dword v23, v22, s[8:11], s33 offen sc1
    s_mov_b64 exec, -1

    s_waitcnt lgkmcnt(4)
    v_mfma_f32_16x16x32_bf16 v[64:67], v[32:35], a[128:131], v[64:67]
    ds_read_b128 v[56:59], v18 offset:33792
    s_add_u32 m0, s29, 896
    v_mfma_f32_16x16x32_bf16 v[68:71], v[32:35], a[132:135], v[68:71]
    buffer_load_dwordx4 v16, s[16:19], s34 offen offset:128 lds
    v_mfma_f32_16x16x32_bf16 v[72:75], v[36:39], a[128:131], v[72:75]
    ds_read_b128 v[60:63], v18 offset:50176
    v_mfma_f32_16x16x32_bf16 v[76:79], v[36:39], a[132:135], v[76:79]
    s_waitcnt lgkmcnt(4)
    v_mfma_f32_16x16x32_bf16 v[64:67], v[40:43], a[136:139], v[64:67]
    ds_read_b128 v[32:35], v17 offset:34816
    v_mfma_f32_16x16x32_bf16 v[68:71], v[40:43], a[140:143], v[68:71]
    v_mfma_f32_16x16x32_bf16 v[72:75], v[44:47], a[136:139], v[72:75]
    ds_read_b128 v[36:39], v17 offset:51200
    v_mfma_f32_16x16x32_bf16 v[76:79], v[44:47], a[140:143], v[76:79]
    s_waitcnt lgkmcnt(4)
    v_mfma_f32_16x16x32_bf16 v[64:67], v[48:51], a[144:147], v[64:67]
    ds_read_b128 v[40:43], v18 offset:34816
    s_add_u32 m0, s29, 1792
    v_mfma_f32_16x16x32_bf16 v[68:71], v[48:51], a[148:151], v[68:71]
    buffer_load_dwordx4 v16, s[16:19], s34 offen offset:256 lds
    v_mfma_f32_16x16x32_bf16 v[72:75], v[52:55], a[144:147], v[72:75]
    ds_read_b128 v[44:47], v18 offset:51200
    v_mfma_f32_16x16x32_bf16 v[76:79], v[52:55], a[148:151], v[76:79]
    s_waitcnt lgkmcnt(4)
    v_mfma_f32_16x16x32_bf16 v[64:67], v[56:59], a[152:155], v[64:67]
    ds_read_b128 v[48:51], v17 offset:35840
    v_mfma_f32_16x16x32_bf16 v[68:71], v[56:59], a[156:159], v[68:71]
    v_mfma_f32_16x16x32_bf16 v[72:75], v[60:63], a[152:155], v[72:75]
    ds_read_b128 v[52:55], v17 offset:52224
    v_mfma_f32_16x16x32_bf16 v[76:79], v[60:63], a[156:159], v[76:79]
    s_waitcnt lgkmcnt(4)
    v_mfma_f32_16x16x32_bf16 v[64:67], v[32:35], a[160:163], v[64:67]
    ds_read_b128 v[56:59], v18 offset:35840
    s_add_u32 m0, s29, 2688
    v_mfma_f32_16x16x32_bf16 v[68:71], v[32:35], a[164:167], v[68:71]
    buffer_load_dwordx4 v16, s[16:19], s34 offen offset:384 lds
    v_mfma_f32_16x16x32_bf16 v[72:75], v[36:39], a[160:163], v[72:75]
    ds_read_b128 v[60:63], v18 offset:52224
    v_mfma_f32_16x16x32_bf16 v[76:79], v[36:39], a[164:167], v[76:79]
    s_waitcnt lgkmcnt(4)
    v_mfma_f32_16x16x32_bf16 v[64:67], v[40:43], a[168:171], v[64:67]
    ds_read_b128 v[32:35], v17 offset:36864
    v_mfma_f32_16x16x32_bf16 v[68:71], v[40:43], a[172:175], v[68:71]
    v_mfma_f32_16x16x32_bf16 v[72:75], v[44:47], a[168:171], v[72:75]
    ds_read_b128 v[36:39], v17 offset:53248
    v_mfma_f32_16x16x32_bf16 v[76:79], v[44:47], a[172:175], v[76:79]
    s_waitcnt lgkmcnt(4)
    v_mfma_f32_16x16x32_bf16 v[64:67], v[48:51], a[176:179], v[64:67]
    ds_read_b128 v[40:43], v18 offset:36864
    s_add_u32 m0, s29, 3584
    v_mfma_f32_16x16x32_bf16 v[68:71], v[48:51], a[180:183], v[68:71]
    buffer_load_dwordx4 v16, s[16:19], s34 offen offset:512 lds
    v_mfma_f32_16x16x32_bf16 v[72:75], v[52:55], a[176:179], v[72:75]
    ds_read_b128 v[44:47], v18 offset:53248
    v_mfma_f32_16x16x32_bf16 v[76:79], v[52:55], a[180:183], v[76:79]
    s_waitcnt lgkmcnt(4)
    v_mfma_f32_16x16x32_bf16 v[64:67], v[56:59], a[184:187], v[64:67]
    ds_read_b128 v[48:51], v17 offset:37888
    v_mfma_f32_16x16x32_bf16 v[68:71], v[56:59], a[188:191], v[68:71]
    v_mfma_f32_16x16x32_bf16 v[72:75], v[60:63], a[184:187], v[72:75]
    ds_read_b128 v[52:55], v17 offset:54272
    v_mfma_f32_16x16x32_bf16 v[76:79], v[60:63], a[188:191], v[76:79]
    s_waitcnt lgkmcnt(4)
    v_mfma_f32_16x16x32_bf16 v[64:67], v[32:35], a[192:195], v[64:67]
    ds_read_b128 v[56:59], v18 offset:37888
    s_add_u32 m0, s29, 4480
    v_mfma_f32_16x16x32_bf16 v[68:71], v[32:35], a[196:199], v[68:71]
    buffer_load_dwordx4 v16, s[16:19], s34 offen offset:640 lds
    v_mfma_f32_16x16x32_bf16 v[72:75], v[36:39], a[192:195], v[72:75]
    ds_read_b128 v[60:63], v18 offset:54272
    v_mfma_f32_16x16x32_bf16 v[76:79], v[36:39], a[196:199], v[76:79]
    s_waitcnt lgkmcnt(4)
    v_mfma_f32_16x16x32_bf16 v[64:67], v[40:43], a[200:203], v[64:67]
    ds_read_b128 v[32:35], v17 offset:38912
    v_mfma_f32_16x16x32_bf16 v[68:71], v[40:43], a[204:207], v[68:71]
    v_mfma_f32_16x16x32_bf16 v[72:75], v[44:47], a[200:203], v[72:75]
    ds_read_b128 v[36:39], v17 offset:55296
    v_mfma_f32_16x16x32_bf16 v[76:79], v[44:47], a[204:207], v[76:79]
    s_waitcnt lgkmcnt(4)
    v_mfma_f32_16x16x32_bf16 v[64:67], v[48:51], a[208:211], v[64:67]
    ds_read_b128 v[40:43], v18 offset:38912
    s_add_u32 m0, s29, 5376
    v_mfma_f32_16x16x32_bf16 v[68:71], v[48:51], a[212:215], v[68:71]
    buffer_load_dwordx4 v16, s[16:19], s34 offen offset:768 lds
    v_mfma_f32_16x16x32_bf16 v[72:75], v[52:55], a[208:211], v[72:75]
    ds_read_b128 v[44:47], v18 offset:55296
    v_mfma_f32_16x16x32_bf16 v[76:79], v[52:55], a[212:215], v[76:79]
    s_waitcnt lgkmcnt(4)
    v_mfma_f32_16x16x32_bf16 v[64:67], v[56:59], a[216:219], v[64:67]
    ds_read_b128 v[48:51], v17 offset:39936
    v_mfma_f32_16x16x32_bf16 v[68:71], v[56:59], a[220:223], v[68:71]
    s_mov_b64 exec, s[44:45]
    buffer_store_dwordx4 v[24:27], v29, s[8:11], s46 offen sc1
    s_mov_b64 exec, -1
    v_mfma_f32_16x16x32_bf16 v[72:75], v[60:63], a[216:219], v[72:75]
    ds_read_b128 v[52:55], v17 offset:56320
    v_mfma_f32_16x16x32_bf16 v[76:79], v[60:63], a[220:223], v[76:79]
    s_waitcnt lgkmcnt(4)
    v_mfma_f32_16x16x32_bf16 v[64:67], v[32:35], a[224:227], v[64:67]
    ds_read_b128 v[56:59], v18 offset:39936
    s_add_u32 m0, s29, 6272
    v_mfma_f32_16x16x32_bf16 v[68:71], v[32:35], a[228:231], v[68:71]
    buffer_load_dwordx4 v16, s[16:19], s34 offen offset:896 lds
    v_mfma_f32_16x16x32_bf16 v[72:75], v[36:39], a[224:227], v[72:75]
    ds_read_b128 v[60:63], v18 offset:56320
    v_mfma_f32_16x16x32_bf16 v[76:79], v[36:39], a[228:231], v[76:79]
    s_waitcnt lgkmcnt(4)
    v_mfma_f32_16x16x32_bf16 v[64:67], v[40:43], a[232:235], v[64:67]
    s_add_u32 s34, s34, 1024
    v_mfma_f32_16x16x32_bf16 v[68:71], v[40:43], a[236:239], v[68:71]
    v_mfma_f32_16x16x32_bf16 v[72:75], v[44:47], a[232:235], v[72:75]
    v_mfma_f32_16x16x32_bf16 v[76:79], v[44:47], a[236:239], v[76:79]
    s_waitcnt lgkmcnt(0)
    s_waitcnt vmcnt(13)
    s_barrier
    ds_read_b128 v[32:35], v19 offset:0
    ds_read_b128 v[36:39], v19 offset:16384
    v_mfma_f32_16x16x32_bf16 v[64:67], v[48:51], a[240:243], v[64:67]
    ds_read_b128 v[40:43], v20 offset:0
    s_add_u32 m0, s29, 32768
    v_mfma_f32_16x16x32_bf16 v[68:71], v[48:51], a[244:247], v[68:71]
    buffer_load_dwordx4 v16, s[16:19], s34 offen offset:0 lds
    v_mfma_f32_16x16x32_bf16 v[72:75], v[52:55], a[240:243], v[72:75]
    ds_read_b128 v[44:47], v20 offset:16384
    v_mfma_f32_16x16x32_bf16 v[76:79], v[52:55], a[244:247], v[76:79]
    v_mfma_f32_16x16x32_bf16 v[64:67], v[56:59], a[248:251], v[64:67]
    ds_read_b128 v[48:51], v19 offset:1024
    v_mfma_f32_16x16x32_bf16 v[68:71], v[56:59], a[252:255], v[68:71]
    v_mfma_f32_16x16x32_bf16 v[72:75], v[60:63], a[248:251], v[72:75]
    ds_read_b128 v[52:55], v19 offset:17408
    v_mfma_f32_16x16x32_bf16 v[76:79], v[60:63], a[252:255], v[76:79]
    s_mov_b64 exec, s[36:37]
    buffer_store_dword v23, v22, s[8:11], s33 offen sc1
    s_mov_b64 exec, -1

.qe_416:
    s_waitcnt lgkmcnt(4)
    v_mfma_f32_16x16x32_bf16 v[80:83], v[32:35], a[0:3], 0
    ds_read_b128 v[56:59], v20 offset:1024
    s_add_u32 m0, s29, 33664
    v_mfma_f32_16x16x32_bf16 v[84:87], v[32:35], a[4:7], 0
    buffer_load_dwordx4 v16, s[16:19], s34 offen offset:128 lds
    v_mfma_f32_16x16x32_bf16 v[88:91], v[36:39], a[0:3], 0
    ds_read_b128 v[60:63], v20 offset:17408
    v_mfma_f32_16x16x32_bf16 v[92:95], v[36:39], a[4:7], 0
    s_mov_b32 exec_hi, 0
    buffer_store_dwordx4 v[24:27], v21, s[8:11], s48 offen sc1
    s_mov_b32 exec_hi, -1

    s_waitcnt lgkmcnt(4)
    v_mfma_f32_16x16x32_bf16 v[80:83], v[40:43], a[8:11], v[80:83]
    ds_read_b128 v[32:35], v19 offset:2048
    v_mfma_f32_16x16x32_bf16 v[84:87], v[40:43], a[12:15], v[84:87]
    v_cvt_pk_bf16_f32 v96, v64, v65
    v_cvt_pk_bf16_f32 v97, v66, v67
    v_cvt_pk_bf16_f32 v98, v72, v73
    v_mfma_f32_16x16x32_bf16 v[88:91], v[44:47], a[8:11], v[88:91]
    ds_read_b128 v[36:39], v19 offset:18432
    v_mfma_f32_16x16x32_bf16 v[92:95], v[44:47], a[12:15], v[92:95]
    v_cvt_pk_bf16_f32 v99, v74, v75
    v_cvt_pk_bf16_f32 v100, v68, v69
    buffer_store_dwordx4 v[96:99], v21, s[8:11], s32 offen offset:0 sc1
    s_waitcnt lgkmcnt(4)
    v_mfma_f32_16x16x32_bf16 v[80:83], v[48:51], a[16:19], v[80:83]
    ds_read_b128 v[40:43], v20 offset:2048
    s_add_u32 m0, s29, 34560
    v_mfma_f32_16x16x32_bf16 v[84:87], v[48:51], a[20:23], v[84:87]
    buffer_load_dwordx4 v16, s[16:19], s34 offen offset:256 lds
    v_mfma_f32_16x16x32_bf16 v[88:91], v[52:55], a[16:19], v[88:91]
    ds_read_b128 v[44:47], v20 offset:18432
    v_mfma_f32_16x16x32_bf16 v[92:95], v[52:55], a[20:23], v[92:95]
    v_cvt_pk_bf16_f32 v101, v70, v71
    v_cvt_pk_bf16_f32 v102, v76, v77
    v_cvt_pk_bf16_f32 v103, v78, v79
    s_waitcnt lgkmcnt(4)
    v_mfma_f32_16x16x32_bf16 v[80:83], v[56:59], a[24:27], v[80:83]
    ds_read_b128 v[48:51], v19 offset:3072
    v_mfma_f32_16x16x32_bf16 v[84:87], v[56:59], a[28:31], v[84:87]
    buffer_store_dwordx4 v[100:103], v21, s[8:11], s32 offen offset:1024 sc1
    v_mfma_f32_16x16x32_bf16 v[88:91], v[60:63], a[24:27], v[88:91]
    ds_read_b128 v[52:55], v19 offset:19456
    v_mfma_f32_16x16x32_bf16 v[92:95], v[60:63], a[28:31], v[92:95]
    s_waitcnt lgkmcnt(4)
    v_mfma_f32_16x16x32_bf16 v[80:83], v[32:35], a[32:35], v[80:83]
    ds_read_b128 v[56:59], v20 offset:3072
    s_add_u32 m0, s29, 35456
    v_mfma_f32_16x16x32_bf16 v[84:87], v[32:35], a[36:39], v[84:87]
    buffer_load_dwordx4 v16, s[16:19], s34 offen offset:384 lds
    v_mfma_f32_16x16x32_bf16 v[88:91], v[36:39], a[32:35], v[88:91]
    ds_read_b128 v[60:63], v20 offset:19456
    v_mfma_f32_16x16x32_bf16 v[92:95], v[36:39], a[36:39], v[92:95]
    s_waitcnt lgkmcnt(4)
    v_mfma_f32_16x16x32_bf16 v[80:83], v[40:43], a[40:43], v[80:83]
    ds_read_b128 v[32:35], v19 offset:4096
    v_mfma_f32_16x16x32_bf16 v[84:87], v[40:43], a[44:47], v[84:87]
    v_mfma_f32_16x16x32_bf16 v[88:91], v[44:47], a[40:43], v[88:91]
    ds_read_b128 v[36:39], v19 offset:20480
    v_mfma_f32_16x16x32_bf16 v[92:95], v[44:47], a[44:47], v[92:95]
    s_waitcnt lgkmcnt(4)
    v_mfma_f32_16x16x32_bf16 v[80:83], v[48:51], a[48:51], v[80:83]
    ds_read_b128 v[40:43], v20 offset:4096
    s_add_u32 m0, s29, 36352
    v_mfma_f32_16x16x32_bf16 v[84:87], v[48:51], a[52:55], v[84:87]
    buffer_load_dwordx4 v16, s[16:19], s34 offen offset:512 lds
    v_mfma_f32_16x16x32_bf16 v[88:91], v[52:55], a[48:51], v[88:91]
    ds_read_b128 v[44:47], v20 offset:20480
    v_mfma_f32_16x16x32_bf16 v[92:95], v[52:55], a[52:55], v[92:95]
    s_waitcnt lgkmcnt(4)
    v_mfma_f32_16x16x32_bf16 v[80:83], v[56:59], a[56:59], v[80:83]
    ds_read_b128 v[48:51], v19 offset:5120
    v_mfma_f32_16x16x32_bf16 v[84:87], v[56:59], a[60:63], v[84:87]
    v_mfma_f32_16x16x32_bf16 v[88:91], v[60:63], a[56:59], v[88:91]
    ds_read_b128 v[52:55], v19 offset:21504
    v_mfma_f32_16x16x32_bf16 v[92:95], v[60:63], a[60:63], v[92:95]
    s_waitcnt lgkmcnt(4)
    v_mfma_f32_16x16x32_bf16 v[80:83], v[32:35], a[64:67], v[80:83]
    ds_read_b128 v[56:59], v20 offset:5120
    s_add_u32 m0, s29, 37248
    v_mfma_f32_16x16x32_bf16 v[84:87], v[32:35], a[68:71], v[84:87]
    buffer_load_dwordx4 v16, s[16:19], s34 offen offset:640 lds
    v_mfma_f32_16x16x32_bf16 v[88:91], v[36:39], a[64:67], v[88:91]
    ds_read_b128 v[60:63], v20 offset:21504
    v_mfma_f32_16x16x32_bf16 v[92:95], v[36:39], a[68:71], v[92:95]
    s_waitcnt lgkmcnt(4)
    v_mfma_f32_16x16x32_bf16 v[80:83], v[40:43], a[72:75], v[80:83]
    ds_read_b128 v[32:35], v19 offset:6144
    v_mfma_f32_16x16x32_bf16 v[84:87], v[40:43], a[76:79], v[84:87]
    s_mov_b32 s32, s39
    s_add_u32 s38, s39, 4096
    v_mfma_f32_16x16x32_bf16 v[88:91], v[44:47], a[72:75], v[88:91]
    ds_read_b128 v[36:39], v19 offset:22528
    s_add_u32 s39, s39, 262144
    s_mov_b32 s48, s49
    v_mfma_f32_16x16x32_bf16 v[92:95], v[44:47], a[76:79], v[92:95]
    s_add_u32 s49, s49, 196608
    v_add_u32 v23, 1, v23
    s_waitcnt lgkmcnt(4)
    v_mfma_f32_16x16x32_bf16 v[80:83], v[48:51], a[80:83], v[80:83]
    ds_read_b128 v[40:43], v20 offset:6144
    s_add_u32 m0, s29, 38144
    v_mfma_f32_16x16x32_bf16 v[84:87], v[48:51], a[84:87], v[84:87]
    buffer_load_dwordx4 v16, s[16:19], s34 offen offset:768 lds
    v_mfma_f32_16x16x32_bf16 v[88:91], v[52:55], a[80:83], v[88:91]
    ds_read_b128 v[44:47], v20 offset:22528
    v_mfma_f32_16x16x32_bf16 v[92:95], v[52:55], a[84:87], v[92:95]
    s_waitcnt lgkmcnt(4)
    v_mfma_f32_16x16x32_bf16 v[80:83], v[56:59], a[88:91], v[80:83]
    ds_read_b128 v[48:51], v19 offset:7168
    v_mfma_f32_16x16x32_bf16 v[84:87], v[56:59], a[92:95], v[84:87]
    s_mov_b64 exec, s[44:45]
    buffer_store_dwordx4 v[24:27], v30, s[8:11], s46 offen sc1
    s_mov_b64 exec, -1
    v_mfma_f32_16x16x32_bf16 v[88:91], v[60:63], a[88:91], v[88:91]
    ds_read_b128 v[52:55], v19 offset:23552
    v_mfma_f32_16x16x32_bf16 v[92:95], v[60:63], a[92:95], v[92:95]
    s_waitcnt lgkmcnt(4)
    v_mfma_f32_16x16x32_bf16 v[80:83], v[32:35], a[96:99], v[80:83]
    ds_read_b128 v[56:59], v20 offset:7168
    s_add_u32 m0, s29, 39040
    v_mfma_f32_16x16x32_bf16 v[84:87], v[32:35], a[100:103], v[84:87]
    buffer_load_dwordx4 v16, s[16:19], s34 offen offset:896 lds
    v_mfma_f32_16x16x32_bf16 v[88:91], v[36:39], a[96:99], v[88:91]
    ds_read_b128 v[60:63], v20 offset:23552
    v_mfma_f32_16x16x32_bf16 v[92:95], v[36:39], a[100:103], v[92:95]
    s_waitcnt lgkmcnt(4)
    v_mfma_f32_16x16x32_bf16 v[80:83], v[40:43], a[104:107], v[80:83]
    s_add_u32 s34, s34, 64512
    s_min_u32 s34, s34, 4128768
    v_mfma_f32_16x16x32_bf16 v[84:87], v[40:43], a[108:111], v[84:87]
    v_mfma_f32_16x16x32_bf16 v[88:91], v[44:47], a[104:107], v[88:91]
    v_mfma_f32_16x16x32_bf16 v[92:95], v[44:47], a[108:111], v[92:95]
    s_waitcnt lgkmcnt(0)
    s_cmp_lt_u32 s35, 2
    s_cselect_b64 s[70:71], s[36:37], 0
    s_cbranch_scc1 .ew_420
.ef_419:
    s_waitcnt vmcnt(19)
    s_barrier
    ds_read_b128 v[32:35], v19 offset:32768
    ds_read_b128 v[36:39], v19 offset:49152
    v_mfma_f32_16x16x32_bf16 v[80:83], v[48:51], a[112:115], v[80:83]
    ds_read_b128 v[40:43], v20 offset:32768
    s_add_u32 m0, s29, 65536
    v_mfma_f32_16x16x32_bf16 v[84:87], v[48:51], a[116:119], v[84:87]
    buffer_load_dwordx4 v16, s[16:19], s34 offen offset:0 lds
    v_mfma_f32_16x16x32_bf16 v[88:91], v[52:55], a[112:115], v[88:91]
    ds_read_b128 v[44:47], v20 offset:49152
    v_mfma_f32_16x16x32_bf16 v[92:95], v[52:55], a[116:119], v[92:95]
    v_mfma_f32_16x16x32_bf16 v[80:83], v[56:59], a[120:123], v[80:83]
    ds_read_b128 v[48:51], v19 offset:33792
    v_mfma_f32_16x16x32_bf16 v[84:87], v[56:59], a[124:127], v[84:87]
    v_mfma_f32_16x16x32_bf16 v[88:91], v[60:63], a[120:123], v[88:91]
    ds_read_b128 v[52:55], v19 offset:50176
    v_mfma_f32_16x16x32_bf16 v[92:95], v[60:63], a[124:127], v[92:95]
    s_mov_b64 exec, s[70:71]
    buffer_store_dword v23, v22, s[8:11], s33 offen sc1
    s_mov_b64 exec, -1

    s_waitcnt lgkmcnt(4)
    v_mfma_f32_16x16x32_bf16 v[80:83], v[32:35], a[128:131], v[80:83]
    ds_read_b128 v[56:59], v20 offset:33792
    s_add_u32 m0, s29, 66432
    v_mfma_f32_16x16x32_bf16 v[84:87], v[32:35], a[132:135], v[84:87]
    buffer_load_dwordx4 v16, s[16:19], s34 offen offset:128 lds
    v_mfma_f32_16x16x32_bf16 v[88:91], v[36:39], a[128:131], v[88:91]
    ds_read_b128 v[60:63], v20 offset:50176
    v_mfma_f32_16x16x32_bf16 v[92:95], v[36:39], a[132:135], v[92:95]
    s_waitcnt lgkmcnt(4)
    v_mfma_f32_16x16x32_bf16 v[80:83], v[40:43], a[136:139], v[80:83]
    ds_read_b128 v[32:35], v19 offset:34816
    v_mfma_f32_16x16x32_bf16 v[84:87], v[40:43], a[140:143], v[84:87]
    v_mfma_f32_16x16x32_bf16 v[88:91], v[44:47], a[136:139], v[88:91]
    ds_read_b128 v[36:39], v19 offset:51200
    v_mfma_f32_16x16x32_bf16 v[92:95], v[44:47], a[140:143], v[92:95]
    s_waitcnt lgkmcnt(4)
    v_mfma_f32_16x16x32_bf16 v[80:83], v[48:51], a[144:147], v[80:83]
    ds_read_b128 v[40:43], v20 offset:34816
    s_add_u32 m0, s29, 67328
    v_mfma_f32_16x16x32_bf16 v[84:87], v[48:51], a[148:151], v[84:87]
    buffer_load_dwordx4 v16, s[16:19], s34 offen offset:256 lds
    v_mfma_f32_16x16x32_bf16 v[88:91], v[52:55], a[144:147], v[88:91]
    ds_read_b128 v[44:47], v20 offset:51200
    v_mfma_f32_16x16x32_bf16 v[92:95], v[52:55], a[148:151], v[92:95]
    s_waitcnt lgkmcnt(4)
    v_mfma_f32_16x16x32_bf16 v[80:83], v[56:59], a[152:155], v[80:83]
    ds_read_b128 v[48:51], v19 offset:35840
    v_mfma_f32_16x16x32_bf16 v[84:87], v[56:59], a[156:159], v[84:87]
    v_mfma_f32_16x16x32_bf16 v[88:91], v[60:63], a[152:155], v[88:91]
    ds_read_b128 v[52:55], v19 offset:52224
    v_mfma_f32_16x16x32_bf16 v[92:95], v[60:63], a[156:159], v[92:95]
    s_waitcnt lgkmcnt(4)
    v_mfma_f32_16x16x32_bf16 v[80:83], v[32:35], a[160:163], v[80:83]
    ds_read_b128 v[56:59], v20 offset:35840
    s_add_u32 m0, s29, 68224
    v_mfma_f32_16x16x32_bf16 v[84:87], v[32:35], a[164:167], v[84:87]
    buffer_load_dwordx4 v16, s[16:19], s34 offen offset:384 lds
    v_mfma_f32_16x16x32_bf16 v[88:91], v[36:39], a[160:163], v[88:91]
    ds_read_b128 v[60:63], v20 offset:52224
    v_mfma_f32_16x16x32_bf16 v[92:95], v[36:39], a[164:167], v[92:95]
    s_waitcnt lgkmcnt(4)
    v_mfma_f32_16x16x32_bf16 v[80:83], v[40:43], a[168:171], v[80:83]
    ds_read_b128 v[32:35], v19 offset:36864
    v_mfma_f32_16x16x32_bf16 v[84:87], v[40:43], a[172:175], v[84:87]
    v_mfma_f32_16x16x32_bf16 v[88:91], v[44:47], a[168:171], v[88:91]
    ds_read_b128 v[36:39], v19 offset:53248
    v_mfma_f32_16x16x32_bf16 v[92:95], v[44:47], a[172:175], v[92:95]
    s_waitcnt lgkmcnt(4)
    v_mfma_f32_16x16x32_bf16 v[80:83], v[48:51], a[176:179], v[80:83]
    ds_read_b128 v[40:43], v20 offset:36864
    s_add_u32 m0, s29, 69120
    v_mfma_f32_16x16x32_bf16 v[84:87], v[48:51], a[180:183], v[84:87]
    buffer_load_dwordx4 v16, s[16:19], s34 offen offset:512 lds
    v_mfma_f32_16x16x32_bf16 v[88:91], v[52:55], a[176:179], v[88:91]
    ds_read_b128 v[44:47], v20 offset:53248
    v_mfma_f32_16x16x32_bf16 v[92:95], v[52:55], a[180:183], v[92:95]
    s_waitcnt lgkmcnt(4)
    v_mfma_f32_16x16x32_bf16 v[80:83], v[56:59], a[184:187], v[80:83]
    ds_read_b128 v[48:51], v19 offset:37888
    v_mfma_f32_16x16x32_bf16 v[84:87], v[56:59], a[188:191], v[84:87]
    v_mfma_f32_16x16x32_bf16 v[88:91], v[60:63], a[184:187], v[88:91]
    ds_read_b128 v[52:55], v19 offset:54272
    v_mfma_f32_16x16x32_bf16 v[92:95], v[60:63], a[188:191], v[92:95]
    s_waitcnt lgkmcnt(4)
    v_mfma_f32_16x16x32_bf16 v[80:83], v[32:35], a[192:195], v[80:83]
    ds_read_b128 v[56:59], v20 offset:37888
    s_add_u32 m0, s29, 70016
    v_mfma_f32_16x16x32_bf16 v[84:87], v[32:35], a[196:199], v[84:87]
    buffer_load_dwordx4 v16, s[16:19], s34 offen offset:640 lds
    v_mfma_f32_16x16x32_bf16 v[88:91], v[36:39], a[192:195], v[88:91]
    ds_read_b128 v[60:63], v20 offset:54272
    v_mfma_f32_16x16x32_bf16 v[92:95], v[36:39], a[196:199], v[92:95]
    s_waitcnt lgkmcnt(4)
    v_mfma_f32_16x16x32_bf16 v[80:83], v[40:43], a[200:203], v[80:83]
    ds_read_b128 v[32:35], v19 offset:38912
    v_mfma_f32_16x16x32_bf16 v[84:87], v[40:43], a[204:207], v[84:87]
    v_mfma_f32_16x16x32_bf16 v[88:91], v[44:47], a[200:203], v[88:91]
    ds_read_b128 v[36:39], v19 offset:55296
    v_mfma_f32_16x16x32_bf16 v[92:95], v[44:47], a[204:207], v[92:95]
    s_waitcnt lgkmcnt(4)
    v_mfma_f32_16x16x32_bf16 v[80:83], v[48:51], a[208:211], v[80:83]
    ds_read_b128 v[40:43], v20 offset:38912
    s_add_u32 m0, s29, 70912
    v_mfma_f32_16x16x32_bf16 v[84:87], v[48:51], a[212:215], v[84:87]
    buffer_load_dwordx4 v16, s[16:19], s34 offen offset:768 lds
    v_mfma_f32_16x16x32_bf16 v[88:91], v[52:55], a[208:211], v[88:91]
    ds_read_b128 v[44:47], v20 offset:55296
    v_mfma_f32_16x16x32_bf16 v[92:95], v[52:55], a[212:215], v[92:95]
    s_waitcnt lgkmcnt(4)
    v_mfma_f32_16x16x32_bf16 v[80:83], v[56:59], a[216:219], v[80:83]
    ds_read_b128 v[48:51], v19 offset:39936
    v_mfma_f32_16x16x32_bf16 v[84:87], v[56:59], a[220:223], v[84:87]
    s_cmp_lt_u32 s35, 22
    s_cselect_b64 s[44:45], -1, 0
    v_mfma_f32_16x16x32_bf16 v[88:91], v[60:63], a[216:219], v[88:91]
    ds_read_b128 v[52:55], v19 offset:56320
    v_mfma_f32_16x16x32_bf16 v[92:95], v[60:63], a[220:223], v[92:95]
    s_cselect_b32 s4, 0x10000, 0
    s_add_u32 s46, s46, s4
    s_waitcnt lgkmcnt(4)
    v_mfma_f32_16x16x32_bf16 v[80:83], v[32:35], a[224:227], v[80:83]
    ds_read_b128 v[56:59], v20 offset:39936
    s_add_u32 m0, s29, 71808
    v_mfma_f32_16x16x32_bf16 v[84:87], v[32:35], a[228:231], v[84:87]
    buffer_load_dwordx4 v16, s[16:19], s34 offen offset:896 lds
    v_mfma_f32_16x16x32_bf16 v[88:91], v[36:39], a[224:227], v[88:91]
    ds_read_b128 v[60:63], v20 offset:56320
    v_mfma_f32_16x16x32_bf16 v[92:95], v[36:39], a[228:231], v[92:95]
    s_waitcnt lgkmcnt(4)
    v_mfma_f32_16x16x32_bf16 v[80:83], v[40:43], a[232:235], v[80:83]
    s_add_u32 s34, s34, 1024
    v_mfma_f32_16x16x32_bf16 v[84:87], v[40:43], a[236:239], v[84:87]
    v_mfma_f32_16x16x32_bf16 v[88:91], v[44:47], a[232:235], v[88:91]
    v_mfma_f32_16x16x32_bf16 v[92:95], v[44:47], a[236:239], v[92:95]
    s_waitcnt lgkmcnt(0)
    s_waitcnt vmcnt(13)
    s_barrier
    ds_read_b128 v[32:35], v17 offset:0
    ds_read_b128 v[36:39], v17 offset:16384
    v_mfma_f32_16x16x32_bf16 v[80:83], v[48:51], a[240:243], v[80:83]
    ds_read_b128 v[40:43], v18 offset:0
    s_add_u32 m0, s29, 98304
    v_mfma_f32_16x16x32_bf16 v[84:87], v[48:51], a[244:247], v[84:87]
    buffer_load_dwordx4 v16, s[16:19], s34 offen offset:0 lds
    v_mfma_f32_16x16x32_bf16 v[88:91], v[52:55], a[240:243], v[88:91]
    ds_read_b128 v[44:47], v18 offset:16384
    v_mfma_f32_16x16x32_bf16 v[92:95], v[52:55], a[244:247], v[92:95]
    v_mfma_f32_16x16x32_bf16 v[80:83], v[56:59], a[248:251], v[80:83]
    ds_read_b128 v[48:51], v17 offset:1024
    v_mfma_f32_16x16x32_bf16 v[84:87], v[56:59], a[252:255], v[84:87]
    v_mfma_f32_16x16x32_bf16 v[88:91], v[60:63], a[248:251], v[88:91]
    ds_read_b128 v[52:55], v17 offset:17408
    v_mfma_f32_16x16x32_bf16 v[92:95], v[60:63], a[252:255], v[92:95]
    s_mov_b64 exec, s[36:37]
    buffer_store_dword v23, v22, s[8:11], s33 offen sc1
    s_mov_b64 exec, -1

    s_add_u32 s35, s35, 1
    s_cmp_lt_u32 s35, 32
    s_cbranch_scc1 .ql_415

    s_nop 7
    v_cvt_pk_bf16_f32 v96, v80, v81
    v_cvt_pk_bf16_f32 v97, v82, v83
    v_cvt_pk_bf16_f32 v98, v88, v89
    v_cvt_pk_bf16_f32 v99, v90, v91
    buffer_store_dwordx4 v[96:99], v21, s[8:11], s32 offen offset:0 sc1
    v_cvt_pk_bf16_f32 v100, v84, v85
    v_cvt_pk_bf16_f32 v101, v86, v87
    v_cvt_pk_bf16_f32 v102, v92, v93
    v_cvt_pk_bf16_f32 v103, v94, v95
    buffer_store_dwordx4 v[100:103], v21, s[8:11], s32 offen offset:1024 sc1
    s_mov_b32 exec_hi, 0
    buffer_store_dwordx4 v[24:27], v21, s[8:11], s48 offen sc1
    s_mov_b32 exec_hi, -1

    v_mov_b32 v23, 64
    s_waitcnt vmcnt(0) lgkmcnt(0)
    s_barrier
    s_mov_b64 exec, s[36:37]
    buffer_store_dword v23, v22, s[8:11], s33 offen sc1
    s_mov_b64 exec, -1

    s_branch .qd_389
.ew_412:
    s_waitcnt vmcnt(5)
    s_branch .ef_411
.ew_414:
    s_waitcnt vmcnt(5)
    s_branch .ef_413
.ew_418:
    s_waitcnt vmcnt(5)
    s_branch .ef_417
.ew_420:
    s_waitcnt vmcnt(5)
    s_branch .ef_419
.qd_389:
    s_load_dwordx2 s[40:41], s[0:1], 88
    s_load_dwordx2 s[42:43], s[0:1], 112
    s_and_b32 s4, s33, 0xffffe7ff
    s_mov_b32 s57, s4
    s_mov_b32 s34, s47
    s_and_b32 s30, s26, 7
    s_lshr_b32 s31, s26, 3
    s_lshl_b32 s28, s91, 21
    s_lshl_b32 s4, s30, 8
    s_add_u32 s28, s28, s4
    s_waitcnt lgkmcnt(0)

    s_mov_b32 s12, s40
    s_and_b32 s13, s41, 0xffff
    s_mov_b32 s14, 0x800000
    s_mov_b32 s15, 0x00020000

    s_mov_b32 s44, s42
    s_and_b32 s45, s43, 0xffff
    s_mov_b32 s46, 0x400000
    s_mov_b32 s47, 0x00020000

    v_lshrrev_b32 v4, 1, v2
    v_xor_b32 v4, v4, v3
    v_lshlrev_b32 v4, 1, v4
    v_and_b32 v5, 1, v1
    v_or_b32 v4, v4, v5
    v_lshlrev_b32 v4, 4, v4
    v_lshlrev_b32 v5, 11, v3
    v_add_u32 v10, v4, v5
    v_xor_b32 v11, 0x80, v10
    s_lshl_b32 s4, s24, 16
    s_add_u32 s28, s28, s4
    s_lshl_b32 s29, s24, 13
    v_lshrrev_b32 v4, 2, v2
    v_and_b32 v5, 1, v3
    v_lshl_or_b32 v5, v5, 2, v4
    s_lshl_b32 s4, s24, 1
    v_xor_b32 v5, s4, v5
    v_lshlrev_b32 v5, 5, v5
    v_lshl_add_u32 v4, v3, 2, v4
    v_lshl_add_u32 v5, v4, 8, v5
    v_and_b32 v4, 3, v2
    v_lshl_add_u32 v12, v4, 3, v5
    v_xor_b32 v13, 32, v12
    v_add_u32 v14, 0x10000, v12
    v_add_u32 v15, 0x10000, v13

    s_and_b32 s4, s91, 1
    s_lshl_b32 s4, s4, 5
    v_xor_b32 v12, s4, v12
    v_xor_b32 v13, s4, v13
    v_xor_b32 v14, s4, v14
    v_xor_b32 v15, s4, v15

    s_and_b32 s4, s26, 7
    s_lshl_b32 s4, s4, 1
    s_lshr_b32 s5, s24, 1
    s_add_u32 s4, s4, s5
    s_lshl_b32 s4, s4, 6
    v_add_u32 v4, s4, v1
    v_lshlrev_b32 v4, 11, v4
    s_and_b32 s4, s24, 1
    s_lshl_b32 s4, s4, 10
    s_lshl_b32 s5, s91, 21
    s_add_u32 s4, s4, s5
    buffer_load_dword v31, v4, s[12:15], s4 offen offset:384

    s_add_u32 m0, s29, 0
    s_add_u32 s4, s28, 0
    buffer_load_dwordx4 v10, s[12:15], s4 offen lds

    s_add_u32 m0, s29, 1024
    s_add_u32 s4, s28, 8192
    buffer_load_dwordx4 v11, s[12:15], s4 offen lds

    s_add_u32 m0, s29, 2048
    s_add_u32 s4, s28, 16384
    buffer_load_dwordx4 v10, s[12:15], s4 offen lds

    s_add_u32 m0, s29, 3072
    s_add_u32 s4, s28, 24576
    buffer_load_dwordx4 v11, s[12:15], s4 offen lds

    s_add_u32 m0, s29, 4096
    s_add_u32 s4, s28, 32768
    buffer_load_dwordx4 v10, s[12:15], s4 offen lds

    s_add_u32 m0, s29, 5120
    s_add_u32 s4, s28, 40960
    buffer_load_dwordx4 v11, s[12:15], s4 offen lds

    s_add_u32 m0, s29, 6144
    s_add_u32 s4, s28, 49152
    buffer_load_dwordx4 v10, s[12:15], s4 offen lds

    s_add_u32 m0, s29, 7168
    s_add_u32 s4, s28, 57344
    buffer_load_dwordx4 v11, s[12:15], s4 offen lds

    s_add_u32 m0, s29, 32768
    s_add_u32 s4, s28, 262144
    buffer_load_dwordx4 v10, s[12:15], s4 offen lds

    s_add_u32 m0, s29, 33792
    s_add_u32 s4, s28, 270336
    buffer_load_dwordx4 v11, s[12:15], s4 offen lds

    s_add_u32 m0, s29, 34816
    s_add_u32 s4, s28, 278528
    buffer_load_dwordx4 v10, s[12:15], s4 offen lds

    s_add_u32 m0, s29, 35840
    s_add_u32 s4, s28, 286720
    buffer_load_dwordx4 v11, s[12:15], s4 offen lds

    s_add_u32 m0, s29, 36864
    s_add_u32 s4, s28, 294912
    buffer_load_dwordx4 v10, s[12:15], s4 offen lds

    s_add_u32 m0, s29, 37888
    s_add_u32 s4, s28, 303104
    buffer_load_dwordx4 v11, s[12:15], s4 offen lds

    s_add_u32 m0, s29, 38912
    s_add_u32 s4, s28, 311296
    buffer_load_dwordx4 v10, s[12:15], s4 offen lds

    s_add_u32 m0, s29, 39936
    s_add_u32 s4, s28, 319488
    buffer_load_dwordx4 v11, s[12:15], s4 offen lds

    s_add_u32 m0, s29, 65536
    s_add_u32 s4, s28, 524288
    buffer_load_dwordx4 v10, s[12:15], s4 offen lds

    s_add_u32 m0, s29, 66560
    s_add_u32 s4, s28, 532480
    buffer_load_dwordx4 v11, s[12:15], s4 offen lds

    s_add_u32 m0, s29, 67584
    s_add_u32 s4, s28, 540672
    buffer_load_dwordx4 v10, s[12:15], s4 offen lds

    s_add_u32 m0, s29, 68608
    s_add_u32 s4, s28, 548864
    buffer_load_dwordx4 v11, s[12:15], s4 offen lds

    s_add_u32 m0, s29, 69632
    s_add_u32 s4, s28, 557056
    buffer_load_dwordx4 v10, s[12:15], s4 offen lds

    s_add_u32 m0, s29, 70656
    s_add_u32 s4, s28, 565248
    buffer_load_dwordx4 v11, s[12:15], s4 offen lds

    s_add_u32 m0, s29, 71680
    s_add_u32 s4, s28, 573440
    buffer_load_dwordx4 v10, s[12:15], s4 offen lds

    s_add_u32 m0, s29, 72704
    s_add_u32 s4, s28, 581632
    buffer_load_dwordx4 v11, s[12:15], s4 offen lds

    s_add_u32 m0, s29, 98304
    s_add_u32 s4, s28, 786432
    buffer_load_dwordx4 v10, s[12:15], s4 offen lds

    s_add_u32 m0, s29, 99328
    s_add_u32 s4, s28, 794624
    buffer_load_dwordx4 v11, s[12:15], s4 offen lds

    s_add_u32 m0, s29, 100352
    s_add_u32 s4, s28, 802816
    buffer_load_dwordx4 v10, s[12:15], s4 offen lds

    s_add_u32 m0, s29, 101376
    s_add_u32 s4, s28, 811008
    buffer_load_dwordx4 v11, s[12:15], s4 offen lds

    s_add_u32 m0, s29, 102400
    s_add_u32 s4, s28, 819200
    buffer_load_dwordx4 v10, s[12:15], s4 offen lds

    s_add_u32 m0, s29, 103424
    s_add_u32 s4, s28, 827392
    buffer_load_dwordx4 v11, s[12:15], s4 offen lds

    s_add_u32 m0, s29, 104448
    s_add_u32 s4, s28, 835584
    buffer_load_dwordx4 v10, s[12:15], s4 offen lds

    s_add_u32 m0, s29, 105472
    s_add_u32 s4, s28, 843776
    buffer_load_dwordx4 v11, s[12:15], s4 offen lds

    s_waitcnt vmcnt(24)
    s_barrier
    ds_read_b64_tr_b16 a[0:1], v12 offset:0
    ds_read_b64_tr_b16 a[2:3], v12 offset:4096
    ds_read_b64_tr_b16 a[4:5], v13 offset:0
    ds_read_b64_tr_b16 a[6:7], v13 offset:4096
    ds_read_b64_tr_b16 a[8:9], v12 offset:8192
    ds_read_b64_tr_b16 a[10:11], v12 offset:12288
    ds_read_b64_tr_b16 a[12:13], v13 offset:8192
    ds_read_b64_tr_b16 a[14:15], v13 offset:12288
    ds_read_b64_tr_b16 a[16:17], v12 offset:16384
    ds_read_b64_tr_b16 a[18:19], v12 offset:20480
    ds_read_b64_tr_b16 a[20:21], v13 offset:16384
    ds_read_b64_tr_b16 a[22:23], v13 offset:20480
    ds_read_b64_tr_b16 a[24:25], v12 offset:24576
    ds_read_b64_tr_b16 a[26:27], v12 offset:28672
    ds_read_b64_tr_b16 a[28:29], v13 offset:24576
    ds_read_b64_tr_b16 a[30:31], v13 offset:28672
    s_waitcnt lgkmcnt(0)
    s_barrier
    s_add_u32 m0, s29, 0
    s_add_u32 s4, s28, 1048576
    buffer_load_dwordx4 v10, s[12:15], s4 offen lds

    s_add_u32 m0, s29, 1024
    s_add_u32 s4, s28, 1056768
    buffer_load_dwordx4 v11, s[12:15], s4 offen lds

    s_add_u32 m0, s29, 2048
    s_add_u32 s4, s28, 1064960
    buffer_load_dwordx4 v10, s[12:15], s4 offen lds

    s_add_u32 m0, s29, 3072
    s_add_u32 s4, s28, 1073152
    buffer_load_dwordx4 v11, s[12:15], s4 offen lds

    s_add_u32 m0, s29, 4096
    s_add_u32 s4, s28, 1081344
    buffer_load_dwordx4 v10, s[12:15], s4 offen lds

    s_add_u32 m0, s29, 5120
    s_add_u32 s4, s28, 1089536
    buffer_load_dwordx4 v11, s[12:15], s4 offen lds

    s_add_u32 m0, s29, 6144
    s_add_u32 s4, s28, 1097728
    buffer_load_dwordx4 v10, s[12:15], s4 offen lds

    s_add_u32 m0, s29, 7168
    s_add_u32 s4, s28, 1105920
    buffer_load_dwordx4 v11, s[12:15], s4 offen lds

    s_waitcnt vmcnt(24)
    s_barrier
    ds_read_b64_tr_b16 a[32:33], v12 offset:32768
    ds_read_b64_tr_b16 a[34:35], v12 offset:36864
    ds_read_b64_tr_b16 a[36:37], v13 offset:32768
    ds_read_b64_tr_b16 a[38:39], v13 offset:36864
    ds_read_b64_tr_b16 a[40:41], v12 offset:40960
    ds_read_b64_tr_b16 a[42:43], v12 offset:45056
    ds_read_b64_tr_b16 a[44:45], v13 offset:40960
    ds_read_b64_tr_b16 a[46:47], v13 offset:45056
    ds_read_b64_tr_b16 a[48:49], v12 offset:49152
    ds_read_b64_tr_b16 a[50:51], v12 offset:53248
    ds_read_b64_tr_b16 a[52:53], v13 offset:49152
    ds_read_b64_tr_b16 a[54:55], v13 offset:53248
    ds_read_b64_tr_b16 a[56:57], v12 offset:57344
    ds_read_b64_tr_b16 a[58:59], v12 offset:61440
    ds_read_b64_tr_b16 a[60:61], v13 offset:57344
    ds_read_b64_tr_b16 a[62:63], v13 offset:61440
    s_waitcnt lgkmcnt(0)
    s_barrier
    s_add_u32 m0, s29, 32768
    s_add_u32 s4, s28, 1310720
    buffer_load_dwordx4 v10, s[12:15], s4 offen lds

    s_add_u32 m0, s29, 33792
    s_add_u32 s4, s28, 1318912
    buffer_load_dwordx4 v11, s[12:15], s4 offen lds

    s_add_u32 m0, s29, 34816
    s_add_u32 s4, s28, 1327104
    buffer_load_dwordx4 v10, s[12:15], s4 offen lds

    s_add_u32 m0, s29, 35840
    s_add_u32 s4, s28, 1335296
    buffer_load_dwordx4 v11, s[12:15], s4 offen lds

    s_add_u32 m0, s29, 36864
    s_add_u32 s4, s28, 1343488
    buffer_load_dwordx4 v10, s[12:15], s4 offen lds

    s_add_u32 m0, s29, 37888
    s_add_u32 s4, s28, 1351680
    buffer_load_dwordx4 v11, s[12:15], s4 offen lds

    s_add_u32 m0, s29, 38912
    s_add_u32 s4, s28, 1359872
    buffer_load_dwordx4 v10, s[12:15], s4 offen lds

    s_add_u32 m0, s29, 39936
    s_add_u32 s4, s28, 1368064
    buffer_load_dwordx4 v11, s[12:15], s4 offen lds

    s_waitcnt vmcnt(24)
    s_barrier
    ds_read_b64_tr_b16 a[64:65], v14 offset:0
    ds_read_b64_tr_b16 a[66:67], v14 offset:4096
    ds_read_b64_tr_b16 a[68:69], v15 offset:0
    ds_read_b64_tr_b16 a[70:71], v15 offset:4096
    ds_read_b64_tr_b16 a[72:73], v14 offset:8192
    ds_read_b64_tr_b16 a[74:75], v14 offset:12288
    ds_read_b64_tr_b16 a[76:77], v15 offset:8192
    ds_read_b64_tr_b16 a[78:79], v15 offset:12288
    ds_read_b64_tr_b16 a[80:81], v14 offset:16384
    ds_read_b64_tr_b16 a[82:83], v14 offset:20480
    ds_read_b64_tr_b16 a[84:85], v15 offset:16384
    ds_read_b64_tr_b16 a[86:87], v15 offset:20480
    ds_read_b64_tr_b16 a[88:89], v14 offset:24576
    ds_read_b64_tr_b16 a[90:91], v14 offset:28672
    ds_read_b64_tr_b16 a[92:93], v15 offset:24576
    ds_read_b64_tr_b16 a[94:95], v15 offset:28672
    s_waitcnt lgkmcnt(0)
    s_barrier
    s_add_u32 m0, s29, 65536
    s_add_u32 s4, s28, 1572864
    buffer_load_dwordx4 v10, s[12:15], s4 offen lds

    s_add_u32 m0, s29, 66560
    s_add_u32 s4, s28, 1581056
    buffer_load_dwordx4 v11, s[12:15], s4 offen lds

    s_add_u32 m0, s29, 67584
    s_add_u32 s4, s28, 1589248
    buffer_load_dwordx4 v10, s[12:15], s4 offen lds

    s_add_u32 m0, s29, 68608
    s_add_u32 s4, s28, 1597440
    buffer_load_dwordx4 v11, s[12:15], s4 offen lds

    s_add_u32 m0, s29, 69632
    s_add_u32 s4, s28, 1605632
    buffer_load_dwordx4 v10, s[12:15], s4 offen lds

    s_add_u32 m0, s29, 70656
    s_add_u32 s4, s28, 1613824
    buffer_load_dwordx4 v11, s[12:15], s4 offen lds

    s_add_u32 m0, s29, 71680
    s_add_u32 s4, s28, 1622016
    buffer_load_dwordx4 v10, s[12:15], s4 offen lds

    s_add_u32 m0, s29, 72704
    s_add_u32 s4, s28, 1630208
    buffer_load_dwordx4 v11, s[12:15], s4 offen lds

    s_waitcnt vmcnt(24)
    s_barrier
    ds_read_b64_tr_b16 a[96:97], v14 offset:32768
    ds_read_b64_tr_b16 a[98:99], v14 offset:36864
    ds_read_b64_tr_b16 a[100:101], v15 offset:32768
    ds_read_b64_tr_b16 a[102:103], v15 offset:36864
    ds_read_b64_tr_b16 a[104:105], v14 offset:40960
    ds_read_b64_tr_b16 a[106:107], v14 offset:45056
    ds_read_b64_tr_b16 a[108:109], v15 offset:40960
    ds_read_b64_tr_b16 a[110:111], v15 offset:45056
    ds_read_b64_tr_b16 a[112:113], v14 offset:49152
    ds_read_b64_tr_b16 a[114:115], v14 offset:53248
    ds_read_b64_tr_b16 a[116:117], v15 offset:49152
    ds_read_b64_tr_b16 a[118:119], v15 offset:53248
    ds_read_b64_tr_b16 a[120:121], v14 offset:57344
    ds_read_b64_tr_b16 a[122:123], v14 offset:61440
    ds_read_b64_tr_b16 a[124:125], v15 offset:57344
    ds_read_b64_tr_b16 a[126:127], v15 offset:61440
    s_waitcnt lgkmcnt(0)
    s_barrier
    s_add_u32 m0, s29, 98304
    s_add_u32 s4, s28, 1835008
    buffer_load_dwordx4 v10, s[12:15], s4 offen lds

    s_add_u32 m0, s29, 99328
    s_add_u32 s4, s28, 1843200
    buffer_load_dwordx4 v11, s[12:15], s4 offen lds

    s_add_u32 m0, s29, 100352
    s_add_u32 s4, s28, 1851392
    buffer_load_dwordx4 v10, s[12:15], s4 offen lds

    s_add_u32 m0, s29, 101376
    s_add_u32 s4, s28, 1859584
    buffer_load_dwordx4 v11, s[12:15], s4 offen lds

    s_add_u32 m0, s29, 102400
    s_add_u32 s4, s28, 1867776
    buffer_load_dwordx4 v10, s[12:15], s4 offen lds

    s_add_u32 m0, s29, 103424
    s_add_u32 s4, s28, 1875968
    buffer_load_dwordx4 v11, s[12:15], s4 offen lds

    s_add_u32 m0, s29, 104448
    s_add_u32 s4, s28, 1884160
    buffer_load_dwordx4 v10, s[12:15], s4 offen lds

    s_add_u32 m0, s29, 105472
    s_add_u32 s4, s28, 1892352
    buffer_load_dwordx4 v11, s[12:15], s4 offen lds

    s_waitcnt vmcnt(24)
    s_barrier
    ds_read_b64_tr_b16 a[128:129], v12 offset:0
    ds_read_b64_tr_b16 a[130:131], v12 offset:4096
    ds_read_b64_tr_b16 a[132:133], v13 offset:0
    ds_read_b64_tr_b16 a[134:135], v13 offset:4096
    ds_read_b64_tr_b16 a[136:137], v12 offset:8192
    ds_read_b64_tr_b16 a[138:139], v12 offset:12288
    ds_read_b64_tr_b16 a[140:141], v13 offset:8192
    ds_read_b64_tr_b16 a[142:143], v13 offset:12288
    ds_read_b64_tr_b16 a[144:145], v12 offset:16384
    ds_read_b64_tr_b16 a[146:147], v12 offset:20480
    ds_read_b64_tr_b16 a[148:149], v13 offset:16384
    ds_read_b64_tr_b16 a[150:151], v13 offset:20480
    ds_read_b64_tr_b16 a[152:153], v12 offset:24576
    ds_read_b64_tr_b16 a[154:155], v12 offset:28672
    ds_read_b64_tr_b16 a[156:157], v13 offset:24576
    ds_read_b64_tr_b16 a[158:159], v13 offset:28672
    s_waitcnt lgkmcnt(0)
    s_barrier
    s_waitcnt vmcnt(16)
    s_barrier
    ds_read_b64_tr_b16 a[160:161], v12 offset:32768
    ds_read_b64_tr_b16 a[162:163], v12 offset:36864
    ds_read_b64_tr_b16 a[164:165], v13 offset:32768
    ds_read_b64_tr_b16 a[166:167], v13 offset:36864
    ds_read_b64_tr_b16 a[168:169], v12 offset:40960
    ds_read_b64_tr_b16 a[170:171], v12 offset:45056
    ds_read_b64_tr_b16 a[172:173], v13 offset:40960
    ds_read_b64_tr_b16 a[174:175], v13 offset:45056
    ds_read_b64_tr_b16 a[176:177], v12 offset:49152
    ds_read_b64_tr_b16 a[178:179], v12 offset:53248
    ds_read_b64_tr_b16 a[180:181], v13 offset:49152
    ds_read_b64_tr_b16 a[182:183], v13 offset:53248
    ds_read_b64_tr_b16 a[184:185], v12 offset:57344
    ds_read_b64_tr_b16 a[186:187], v12 offset:61440
    ds_read_b64_tr_b16 a[188:189], v13 offset:57344
    ds_read_b64_tr_b16 a[190:191], v13 offset:61440
    s_waitcnt lgkmcnt(0)
    s_barrier
    s_waitcnt vmcnt(8)
    s_barrier
    ds_read_b64_tr_b16 a[192:193], v14 offset:0
    ds_read_b64_tr_b16 a[194:195], v14 offset:4096
    ds_read_b64_tr_b16 a[196:197], v15 offset:0
    ds_read_b64_tr_b16 a[198:199], v15 offset:4096
    ds_read_b64_tr_b16 a[200:201], v14 offset:8192
    ds_read_b64_tr_b16 a[202:203], v14 offset:12288
    ds_read_b64_tr_b16 a[204:205], v15 offset:8192
    ds_read_b64_tr_b16 a[206:207], v15 offset:12288
    ds_read_b64_tr_b16 a[208:209], v14 offset:16384
    ds_read_b64_tr_b16 a[210:211], v14 offset:20480
    ds_read_b64_tr_b16 a[212:213], v15 offset:16384
    ds_read_b64_tr_b16 a[214:215], v15 offset:20480
    ds_read_b64_tr_b16 a[216:217], v14 offset:24576
    ds_read_b64_tr_b16 a[218:219], v14 offset:28672
    ds_read_b64_tr_b16 a[220:221], v15 offset:24576
    ds_read_b64_tr_b16 a[222:223], v15 offset:28672
    s_waitcnt lgkmcnt(0)
    s_barrier
    s_waitcnt vmcnt(0)
    s_barrier
    ds_read_b64_tr_b16 a[224:225], v14 offset:32768
    ds_read_b64_tr_b16 a[226:227], v14 offset:36864
    ds_read_b64_tr_b16 a[228:229], v15 offset:32768
    ds_read_b64_tr_b16 a[230:231], v15 offset:36864
    ds_read_b64_tr_b16 a[232:233], v14 offset:40960
    ds_read_b64_tr_b16 a[234:235], v14 offset:45056
    ds_read_b64_tr_b16 a[236:237], v15 offset:40960
    ds_read_b64_tr_b16 a[238:239], v15 offset:45056
    ds_read_b64_tr_b16 a[240:241], v14 offset:49152
    ds_read_b64_tr_b16 a[242:243], v14 offset:53248
    ds_read_b64_tr_b16 a[244:245], v15 offset:49152
    ds_read_b64_tr_b16 a[246:247], v15 offset:53248
    ds_read_b64_tr_b16 a[248:249], v14 offset:57344
    ds_read_b64_tr_b16 a[250:251], v14 offset:61440
    ds_read_b64_tr_b16 a[252:253], v15 offset:57344
    ds_read_b64_tr_b16 a[254:255], v15 offset:61440
    s_waitcnt lgkmcnt(0)
    s_barrier
    v_lshlrev_b32 v21, 4, v1
    s_lshr_b32 s4, s91, 1
    s_lshl_b32 s5, s4, 12
    v_add_u32 v17, s5, v21
    v_xor_b32 v18, 0x1000, v17
    s_lshl_b32 s4, s4, 4
    v_add_u32 v4, s4, v2
    s_lshl_b32 s5, s30, 5
    s_lshl_b32 s6, s24, 3
    s_add_u32 s5, s5, s6
    s_and_b32 s6, s91, 1
    s_lshl_b32 s6, s6, 2
    s_add_u32 s5, s5, s6
    v_add_u32 v5, s5, v3
    v_lshlrev_b32 v6, 3, v5
    v_lshl_add_u32 v22, v4, 11, v6
    v_lshlrev_b32 v6, 14, v5
    v_lshl_add_u32 v23, v4, 2, v6
    v_lshlrev_b32 v16, 2, v4
    v_bfe_u32 v4, v1, 2, 3
    v_lshlrev_b32 v19, 8, v4
    v_and_b32 v4, 3, v1
    v_lshl_add_u32 v19, v4, 2, v19
    s_lshl_b32 s33, s91, 11
    s_add_u32 s33, s33, 92299264
    s_lshl_b32 s35, s24, 10
    s_lshl_b32 s36, s91, 16
    s_add_u32 s36, s36, s35
    s_add_u32 s36, s36, 0
    s_mov_b32 s37, 0
    s_lshl_b32 s4, s91, 3
    s_add_u32 s4, s4, s30
    s_lshl_b32 s4, s4, 2
    s_add_u32 s4, s4, s24
    s_lshl_b32 s4, s4, 11
    s_add_u32 s4, s4, 0
    v_lshlrev_b32 v111, 5, v1
    v_add_u32 v111, s4, v111
    s_mov_b32 s52, 0
    s_mov_b32 s39, 0
    v_lshlrev_b32 v6, 11, v1

    s_mov_b32 s69, 3
    s_mov_b32 s54, 0
    s_mul_i32 s4, s31, 3
    s_add_u32 s4, s4, 2
    s_sub_u32 s5, s31, s4
    s_cmp_lt_u32 s31, 1
    s_cselect_b32 s69, s5, 3
    s_cselect_b32 s4, s4, s31
    s_cmp_eq_u32 s31, 2
    s_cselect_b32 s31, 5, s4

    s_mov_b32 s62, 0
    s_mov_b64 exec, 15
.wf_421:
    buffer_load_dword v4, v6, s[8:11], s57 offen sc1
    s_waitcnt vmcnt(0)
    v_cmp_gt_u32 vcc, 64, v4
    s_cbranch_vccz .wfd_422
    s_sleep 2
    s_add_u32 s62, s62, 1
    s_cmp_gt_u32 s62, 0x400000
    s_cbranch_scc1 .mg_end_1
    s_branch .wf_421

.wfd_422:
    s_mov_b64 exec, -1
    v_mov_b32 v5, 0
    s_mov_b32 s62, 0
    s_mov_b32 s5, 160
.wc_423:
    buffer_load_dword v4, v5, s[20:23], s5 offen sc1
    s_waitcnt vmcnt(0)
    v_readfirstlane_b32 s4, v4
    s_lshr_b32 s4, s4, 0
    s_and_b32 s4, s4, 0xffff
    s_cmp_ge_u32 s4, 32
    s_cbranch_scc1 .wcd_424
    s_sleep 6
    s_add_u32 s62, s62, 1
    s_cmp_gt_u32 s62, 0x400000
    s_cbranch_scc1 .mg_end_1
    s_branch .wc_423

.wcd_424:
.g2blk_425:
    s_mov_b32 s62, 0
    s_mov_b64 s[64:65], 0
    s_mov_b32 s38, 0
    s_cmp_ge_u32 s31, 63
    s_cbranch_scc1 .g2h_434
.g2bw_433:
    buffer_load_dword v20, v19, s[8:11], s33 offen sc1
    s_waitcnt vmcnt(0)
    s_lshr_b32 s6, s31, 2
    s_and_b32 s4, s31, 3
    v_cmp_ge_u32 vcc, s6, v20
    s_lshl_b32 s4, s4, 3
    s_lshr_b32 s5, vcc_lo, s4
    s_and_b32 s5, s5, 0xff
    s_cmp_eq_u32 s5, 0

    s_cbranch_scc1 .g2rd_435
    s_lshl_b64 exec, 0xff, s4

    s_add_u32 s62, s62, 1
    s_cmp_gt_u32 s62, 0x400000
    s_cbranch_scc1 .mg_end_1
    s_branch .g2bw_433

.g2rd_435:
    s_mov_b64 exec, -1
    s_lshl_b32 s48, s31, 18
    s_add_u32 s48, s48, s36
    s_add_u32 s49, s39, s35
    s_xor_b32 s39, s39, 0x10000

    s_add_u32 m0, s49, 0
    s_add_u32 s50, s48, 0
    buffer_load_dwordx4 v21, s[8:11], s50 offen offset:0 sc1 lds
    s_add_u32 m0, s49, 4096
    s_add_u32 s50, s48, 4096
    buffer_load_dwordx4 v21, s[8:11], s50 offen offset:0 sc1 lds
    s_add_u32 m0, s49, 8192
    s_add_u32 s50, s48, 8192
    buffer_load_dwordx4 v21, s[8:11], s50 offen offset:0 sc1 lds
    s_add_u32 m0, s49, 12288
    s_add_u32 s50, s48, 12288
    buffer_load_dwordx4 v21, s[8:11], s50 offen offset:0 sc1 lds
    s_add_u32 m0, s49, 16384
    s_add_u32 s50, s48, 16384
    buffer_load_dwordx4 v21, s[8:11], s50 offen offset:0 sc1 lds
    s_add_u32 m0, s49, 20480
    s_add_u32 s50, s48, 20480
    buffer_load_dwordx4 v21, s[8:11], s50 offen offset:0 sc1 lds
    s_add_u32 m0, s49, 24576
    s_add_u32 s50, s48, 24576
    buffer_load_dwordx4 v21, s[8:11], s50 offen offset:0 sc1 lds
    s_add_u32 m0, s49, 28672
    s_add_u32 s50, s48, 28672
    buffer_load_dwordx4 v21, s[8:11], s50 offen offset:0 sc1 lds
    s_add_u32 s53, s31, s69
    s_lshr_b32 s6, s53, 2
    s_and_b32 s4, s53, 3
    v_cmp_ge_u32 vcc, s6, v20
    s_lshl_b32 s4, s4, 3
    s_lshr_b32 s5, vcc_lo, s4
    s_and_b32 s5, s5, 0xff
    s_cmp_eq_u32 s5, 0

    s_cselect_b32 s56, 1, 0
    s_cmp_lt_u32 s53, 63
    s_cselect_b32 s56, s56, 0
    s_cmp_eq_u32 s56, 0
    s_cbranch_scc1 .g2fb_436
    s_add_u32 m0, s49, 32768
    s_add_u32 s50, s48, 32768
    buffer_load_dwordx4 v21, s[8:11], s50 offen offset:0 sc1 lds
    s_add_u32 m0, s49, 36864
    s_add_u32 s50, s48, 36864
    buffer_load_dwordx4 v21, s[8:11], s50 offen offset:0 sc1 lds
    s_add_u32 m0, s49, 40960
    s_add_u32 s50, s48, 40960
    buffer_load_dwordx4 v21, s[8:11], s50 offen offset:0 sc1 lds
    s_add_u32 m0, s49, 45056
    s_add_u32 s50, s48, 45056
    buffer_load_dwordx4 v21, s[8:11], s50 offen offset:0 sc1 lds
    s_add_u32 m0, s49, 49152
    s_add_u32 s50, s48, 49152
    buffer_load_dwordx4 v21, s[8:11], s50 offen offset:0 sc1 lds
    s_add_u32 m0, s49, 53248
    s_add_u32 s50, s48, 53248
    buffer_load_dwordx4 v21, s[8:11], s50 offen offset:0 sc1 lds
    s_add_u32 m0, s49, 57344
    s_add_u32 s50, s48, 57344
    buffer_load_dwordx4 v21, s[8:11], s50 offen offset:0 sc1 lds
    s_add_u32 m0, s49, 61440
    s_add_u32 s50, s48, 61440
    buffer_load_dwordx4 v21, s[8:11], s50 offen offset:0 sc1 lds
    s_waitcnt vmcnt(0)
.g2go_426:
    s_barrier
    ds_read_b128 v[32:35], v17 offset:0
    ds_read_b128 v[36:39], v18 offset:0
    ds_read_b128 v[40:43], v17 offset:1024
    ds_read_b128 v[44:47], v18 offset:1024
    ds_read_b128 v[48:51], v17 offset:2048
    ds_read_b128 v[52:55], v18 offset:2048
    s_add_u32 s53, s31, s69
    s_sub_u32 s55, s37, 0x10000
    s_add_u32 s61, s53, 3
    s_lshr_b32 s6, s53, 2
    s_and_b32 s4, s53, 3
    v_cmp_ge_u32 vcc, s6, v20
    s_lshl_b32 s4, s4, 3
    s_lshr_b32 s5, vcc_lo, s4
    s_and_b32 s5, s5, 0xff
    s_cmp_eq_u32 s5, 0

    s_cselect_b32 s56, 1, 0
    s_cmp_lt_u32 s53, 63
    s_cselect_b32 s56, s56, 0
    s_cmp_eq_u32 s56, 0
    s_cbranch_scc1 .g2nd_429
    s_lshr_b32 s6, s61, 2
    s_and_b32 s4, s61, 3
    v_cmp_ge_u32 vcc, s6, v20
    s_lshl_b32 s4, s4, 3
    s_lshr_b32 s5, vcc_lo, s4
    s_and_b32 s5, s5, 0xff
    s_cmp_eq_u32 s5, 0

    s_cbranch_scc1 .g2nf_428
    buffer_load_dword v20, v19, s[8:11], s33 offen sc1
    s_branch .g2pd_438
.g2nf_428:
    s_lshl_b32 s4, s61, 18
    buffer_load_dword v31, v111, s[8:11], s4 offen
.g2pd_438:
    s_lshl_b32 s48, s53, 18
    s_add_u32 s48, s48, s36
    s_add_u32 s49, s39, s35
    s_xor_b32 s39, s39, 0x10000

    s_waitcnt lgkmcnt(4)
    v_mfma_f32_16x16x32_bf16 v[64:67], a[0:3], v[32:35], 0
    ds_read_b128 v[56:59], v17 offset:3072
    s_add_u32 m0, s49, 0
    s_add_u32 s50, s48, 0
    v_mfma_f32_16x16x32_bf16 v[68:71], a[4:7], v[32:35], 0
    buffer_load_dwordx4 v21, s[8:11], s50 offen offset:0 sc1 lds
    v_mfma_f32_16x16x32_bf16 v[72:75], a[0:3], v[36:39], 0
    ds_read_b128 v[60:63], v18 offset:3072
    v_mfma_f32_16x16x32_bf16 v[76:79], a[4:7], v[36:39], 0
    s_waitcnt lgkmcnt(4)
    v_mfma_f32_16x16x32_bf16 v[64:67], a[8:11], v[40:43], v[64:67]
    ds_read_b128 v[32:35], v17 offset:8192
    v_mfma_f32_16x16x32_bf16 v[68:71], a[12:15], v[40:43], v[68:71]
    v_mfma_f32_16x16x32_bf16 v[72:75], a[8:11], v[44:47], v[72:75]
    ds_read_b128 v[36:39], v18 offset:8192
    s_add_u32 m0, s49, 4096
    s_add_u32 s50, s48, 4096
    v_mfma_f32_16x16x32_bf16 v[76:79], a[12:15], v[44:47], v[76:79]
    buffer_load_dwordx4 v21, s[8:11], s50 offen offset:0 sc1 lds
    s_waitcnt lgkmcnt(4)
    v_mfma_f32_16x16x32_bf16 v[64:67], a[16:19], v[48:51], v[64:67]
    ds_read_b128 v[40:43], v17 offset:9216
    v_mfma_f32_16x16x32_bf16 v[68:71], a[20:23], v[48:51], v[68:71]
    v_mfma_f32_16x16x32_bf16 v[72:75], a[16:19], v[52:55], v[72:75]
    ds_read_b128 v[44:47], v18 offset:9216
    v_mfma_f32_16x16x32_bf16 v[76:79], a[20:23], v[52:55], v[76:79]
    s_waitcnt lgkmcnt(4)
    v_mfma_f32_16x16x32_bf16 v[64:67], a[24:27], v[56:59], v[64:67]
    ds_read_b128 v[48:51], v17 offset:10240
    s_add_u32 m0, s49, 8192
    s_add_u32 s50, s48, 8192
    v_mfma_f32_16x16x32_bf16 v[68:71], a[28:31], v[56:59], v[68:71]
    buffer_load_dwordx4 v21, s[8:11], s50 offen offset:0 sc1 lds
    v_mfma_f32_16x16x32_bf16 v[72:75], a[24:27], v[60:63], v[72:75]
    ds_read_b128 v[52:55], v18 offset:10240
    v_mfma_f32_16x16x32_bf16 v[76:79], a[28:31], v[60:63], v[76:79]
    s_waitcnt lgkmcnt(4)
    v_mfma_f32_16x16x32_bf16 v[64:67], a[32:35], v[32:35], v[64:67]
    ds_read_b128 v[56:59], v17 offset:11264
    v_mfma_f32_16x16x32_bf16 v[68:71], a[36:39], v[32:35], v[68:71]
    v_mfma_f32_16x16x32_bf16 v[72:75], a[32:35], v[36:39], v[72:75]
    ds_read_b128 v[60:63], v18 offset:11264
    s_add_u32 m0, s49, 12288
    s_add_u32 s50, s48, 12288
    v_mfma_f32_16x16x32_bf16 v[76:79], a[36:39], v[36:39], v[76:79]
    buffer_load_dwordx4 v21, s[8:11], s50 offen offset:0 sc1 lds
    s_waitcnt lgkmcnt(4)
    v_mfma_f32_16x16x32_bf16 v[64:67], a[40:43], v[40:43], v[64:67]
    s_barrier
    ds_read_b128 v[32:35], v17 offset:16384
    v_mfma_f32_16x16x32_bf16 v[68:71], a[44:47], v[40:43], v[68:71]
    v_mfma_f32_16x16x32_bf16 v[72:75], a[40:43], v[44:47], v[72:75]
    ds_read_b128 v[36:39], v18 offset:16384
    v_mfma_f32_16x16x32_bf16 v[76:79], a[44:47], v[44:47], v[76:79]
    s_waitcnt lgkmcnt(4)
    v_mfma_f32_16x16x32_bf16 v[64:67], a[48:51], v[48:51], v[64:67]
    ds_read_b128 v[40:43], v17 offset:17408
    s_add_u32 m0, s49, 16384
    s_add_u32 s50, s48, 16384
    v_mfma_f32_16x16x32_bf16 v[68:71], a[52:55], v[48:51], v[68:71]
    buffer_load_dwordx4 v21, s[8:11], s50 offen offset:0 sc1 lds
    s_waitcnt vmcnt(9)
    v_mfma_f32_16x16x32_bf16 v[72:75], a[48:51], v[52:55], v[72:75]
    ds_read_b128 v[44:47], v18 offset:17408
    v_mfma_f32_16x16x32_bf16 v[76:79], a[52:55], v[52:55], v[76:79]
    s_mov_b32 s62, 0
.cc_439:
    v_max3_u32 v4, v84, v88, v92
    v_cmp_eq_u32 vcc, -1, v4
    s_and_b64 vcc, vcc, s[64:65]
    s_cbranch_vccnz .cf_440
    s_waitcnt lgkmcnt(4)
    v_mfma_f32_16x16x32_bf16 v[64:67], a[56:59], v[56:59], v[64:67]
    ds_read_b128 v[48:51], v17 offset:18432
    v_add_f32 v84, v84, v88
    v_mfma_f32_16x16x32_bf16 v[68:71], a[60:63], v[56:59], v[68:71]
    v_add_f32 v92, v112, v92
    v_add_f32 v85, v85, v89
    v_mfma_f32_16x16x32_bf16 v[72:75], a[56:59], v[60:63], v[72:75]
    ds_read_b128 v[52:55], v18 offset:18432
    s_add_u32 m0, s49, 20480
    s_add_u32 s50, s48, 20480
    v_mfma_f32_16x16x32_bf16 v[76:79], a[60:63], v[60:63], v[76:79]
    buffer_load_dwordx4 v21, s[8:11], s50 offen offset:0 sc1 lds
    s_waitcnt lgkmcnt(4)
    v_mfma_f32_16x16x32_bf16 v[64:67], a[64:67], v[32:35], v[64:67]
    ds_read_b128 v[56:59], v17 offset:19456
    v_add_f32 v93, v113, v93
    v_mfma_f32_16x16x32_bf16 v[68:71], a[68:71], v[32:35], v[68:71]
    v_add_f32 v86, v86, v90
    v_add_f32 v94, v114, v94
    v_mfma_f32_16x16x32_bf16 v[72:75], a[64:67], v[36:39], v[72:75]
    ds_read_b128 v[60:63], v18 offset:19456
    v_add_f32 v87, v87, v91
    v_mfma_f32_16x16x32_bf16 v[76:79], a[68:71], v[36:39], v[76:79]
    v_add_f32 v95, v115, v95
    s_waitcnt lgkmcnt(4)
    v_mfma_f32_16x16x32_bf16 v[64:67], a[72:75], v[40:43], v[64:67]
    ds_read_b128 v[32:35], v17 offset:24576
    s_add_u32 m0, s49, 24576
    s_add_u32 s50, s48, 24576
    v_mfma_f32_16x16x32_bf16 v[68:71], a[76:79], v[40:43], v[68:71]
    buffer_load_dwordx4 v21, s[8:11], s50 offen offset:0 sc1 lds
    v_add_f32 v84, v92, v84
    v_mfma_f32_16x16x32_bf16 v[72:75], a[72:75], v[44:47], v[72:75]
    ds_read_b128 v[36:39], v18 offset:24576
    v_add_f32 v85, v93, v85
    v_mfma_f32_16x16x32_bf16 v[76:79], a[76:79], v[44:47], v[76:79]
    v_add_f32 v86, v94, v86
    s_waitcnt lgkmcnt(4)
    v_mfma_f32_16x16x32_bf16 v[64:67], a[80:83], v[48:51], v[64:67]
    ds_read_b128 v[40:43], v17 offset:25600
    v_add_f32 v87, v95, v87
    v_mfma_f32_16x16x32_bf16 v[68:71], a[84:87], v[48:51], v[68:71]
    v_sub_f32 v104, 1.0, v100
    v_cvt_pk_bf16_f32 v104, v104, v104
    v_mfma_f32_16x16x32_bf16 v[72:75], a[80:83], v[52:55], v[72:75]
    ds_read_b128 v[44:47], v18 offset:25600
    s_add_u32 m0, s49, 28672
    s_add_u32 s50, s48, 28672
    v_mfma_f32_16x16x32_bf16 v[76:79], a[84:87], v[52:55], v[76:79]
    buffer_load_dwordx4 v21, s[8:11], s50 offen offset:0 sc1 lds
    s_waitcnt lgkmcnt(4)
    v_mfma_f32_16x16x32_bf16 v[64:67], a[88:91], v[56:59], v[64:67]
    ds_read_b128 v[48:51], v17 offset:26624
    v_lshlrev_b32 v104, 16, v104
    v_mfma_f32_16x16x32_bf16 v[68:71], a[92:95], v[56:59], v[68:71]
    v_cvt_pk_bf16_f32 v105, v84, v85
    v_lshlrev_b32 v107, 16, v96
    v_mfma_f32_16x16x32_bf16 v[72:75], a[88:91], v[60:63], v[72:75]
    ds_read_b128 v[52:55], v18 offset:26624
    v_and_b32 v108, 0xffff0000, v96
    v_mfma_f32_16x16x32_bf16 v[76:79], a[92:95], v[60:63], v[76:79]
    v_lshlrev_b32 v109, 16, v98
    s_waitcnt lgkmcnt(4)
    v_mfma_f32_16x16x32_bf16 v[64:67], a[96:99], v[32:35], v[64:67]
    ds_read_b128 v[56:59], v17 offset:27648
    s_add_u32 m0, s49, 32768
    s_add_u32 s50, s48, 32768
    v_mfma_f32_16x16x32_bf16 v[68:71], a[100:103], v[32:35], v[68:71]
    buffer_load_dwordx4 v21, s[8:11], s50 offen offset:0 sc1 lds
    v_and_b32 v110, 0xffff0000, v98
    v_mfma_f32_16x16x32_bf16 v[72:75], a[96:99], v[36:39], v[72:75]
    ds_read_b128 v[60:63], v18 offset:27648
    v_and_b32 v106, 0xffff0000, v105
    v_mfma_f32_16x16x32_bf16 v[76:79], a[100:103], v[36:39], v[76:79]
    v_lshlrev_b32 v105, 16, v105
    s_waitcnt lgkmcnt(4)
    v_mfma_f32_16x16x32_bf16 v[64:67], a[104:107], v[40:43], v[64:67]
    s_barrier
    ds_read_b128 v[32:35], v17 offset:32768
    v_mfma_f32_16x16x32_bf16 v[68:71], a[108:111], v[40:43], v[68:71]
    v_mul_f32 v107, v107, v109
    v_mul_f32 v108, v108, v110
    v_mfma_f32_16x16x32_bf16 v[72:75], a[104:107], v[44:47], v[72:75]
    ds_read_b128 v[36:39], v18 offset:32768
    s_add_u32 m0, s49, 36864
    s_add_u32 s50, s48, 36864
    v_mfma_f32_16x16x32_bf16 v[76:79], a[108:111], v[44:47], v[76:79]
    buffer_load_dwordx4 v21, s[8:11], s50 offen offset:0 sc1 lds
    s_waitcnt lgkmcnt(4)
    v_mfma_f32_16x16x32_bf16 v[64:67], a[112:115], v[48:51], v[64:67]
    ds_read_b128 v[40:43], v17 offset:33792
    v_mul_f32 v105, v104, v105
    v_mfma_f32_16x16x32_bf16 v[68:71], a[116:119], v[48:51], v[68:71]
    v_mul_f32 v106, v104, v106
    v_cvt_pk_bf16_f32 v107, v107, v108
    v_mfma_f32_16x16x32_bf16 v[72:75], a[112:115], v[52:55], v[72:75]
    ds_read_b128 v[44:47], v18 offset:33792
    v_cvt_pk_bf16_f32 v105, v105, v106
    v_mfma_f32_16x16x32_bf16 v[76:79], a[116:119], v[52:55], v[76:79]
    v_and_b32 v108, 0xffff0000, v107
    s_waitcnt lgkmcnt(4)
    v_mfma_f32_16x16x32_bf16 v[64:67], a[120:123], v[56:59], v[64:67]
    ds_read_b128 v[48:51], v17 offset:34816
    s_add_u32 m0, s49, 40960
    s_add_u32 s50, s48, 40960
    v_mfma_f32_16x16x32_bf16 v[68:71], a[124:127], v[56:59], v[68:71]
    buffer_load_dwordx4 v21, s[8:11], s50 offen offset:0 sc1 lds
    v_lshlrev_b32 v107, 16, v107
    v_mfma_f32_16x16x32_bf16 v[72:75], a[120:123], v[60:63], v[72:75]
    ds_read_b128 v[52:55], v18 offset:34816
    v_and_b32 v106, 0xffff0000, v105
    v_mfma_f32_16x16x32_bf16 v[76:79], a[124:127], v[60:63], v[76:79]
    v_lshlrev_b32 v105, 16, v105
    s_waitcnt lgkmcnt(4)
    v_mfma_f32_16x16x32_bf16 v[64:67], a[128:131], v[32:35], v[64:67]
    ds_read_b128 v[56:59], v17 offset:35840
    v_mul_f32 v107, v100, v107
    v_mfma_f32_16x16x32_bf16 v[68:71], a[132:135], v[32:35], v[68:71]
    v_mul_f32 v108, v100, v108
    v_cvt_pk_bf16_f32 v107, v107, v108
    v_mfma_f32_16x16x32_bf16 v[72:75], a[128:131], v[36:39], v[72:75]
    ds_read_b128 v[60:63], v18 offset:35840
    s_add_u32 m0, s49, 45056
    s_add_u32 s50, s48, 45056
    v_mfma_f32_16x16x32_bf16 v[76:79], a[132:135], v[36:39], v[76:79]
    buffer_load_dwordx4 v21, s[8:11], s50 offen offset:0 sc1 lds
    s_waitcnt lgkmcnt(4)
    v_mfma_f32_16x16x32_bf16 v[64:67], a[136:139], v[40:43], v[64:67]
    ds_read_b128 v[32:35], v17 offset:40960
    v_and_b32 v108, 0xffff0000, v107
    v_mfma_f32_16x16x32_bf16 v[68:71], a[140:143], v[40:43], v[68:71]
    v_lshlrev_b32 v107, 16, v107
    v_add_f32 v105, v105, v107
    v_mfma_f32_16x16x32_bf16 v[72:75], a[136:139], v[44:47], v[72:75]
    ds_read_b128 v[36:39], v18 offset:40960
    v_add_f32 v106, v106, v108
    v_mfma_f32_16x16x32_bf16 v[76:79], a[140:143], v[44:47], v[76:79]
    v_cvt_pk_bf16_f32 v102, v105, v106
    s_waitcnt lgkmcnt(4)
    v_mfma_f32_16x16x32_bf16 v[64:67], a[144:147], v[48:51], v[64:67]
    ds_read_b128 v[40:43], v17 offset:41984
    s_add_u32 m0, s49, 49152
    s_add_u32 s50, s48, 49152
    v_mfma_f32_16x16x32_bf16 v[68:71], a[148:151], v[48:51], v[68:71]
    buffer_load_dwordx4 v21, s[8:11], s50 offen offset:0 sc1 lds
    v_cvt_pk_bf16_f32 v105, v86, v87
    v_mfma_f32_16x16x32_bf16 v[72:75], a[144:147], v[52:55], v[72:75]
    ds_read_b128 v[44:47], v18 offset:41984
    v_lshlrev_b32 v107, 16, v97
    v_mfma_f32_16x16x32_bf16 v[76:79], a[148:151], v[52:55], v[76:79]
    v_and_b32 v108, 0xffff0000, v97
    s_waitcnt lgkmcnt(4)
    v_mfma_f32_16x16x32_bf16 v[64:67], a[152:155], v[56:59], v[64:67]
    ds_read_b128 v[48:51], v17 offset:43008
    v_lshlrev_b32 v109, 16, v99
    v_mfma_f32_16x16x32_bf16 v[68:71], a[156:159], v[56:59], v[68:71]
    v_and_b32 v110, 0xffff0000, v99
    v_and_b32 v106, 0xffff0000, v105
    v_mfma_f32_16x16x32_bf16 v[72:75], a[152:155], v[60:63], v[72:75]
    ds_read_b128 v[52:55], v18 offset:43008
    s_add_u32 m0, s49, 53248
    s_add_u32 s50, s48, 53248
    v_mfma_f32_16x16x32_bf16 v[76:79], a[156:159], v[60:63], v[76:79]
    buffer_load_dwordx4 v21, s[8:11], s50 offen offset:0 sc1 lds
    s_waitcnt lgkmcnt(4)
    v_mfma_f32_16x16x32_bf16 v[64:67], a[160:163], v[32:35], v[64:67]
    ds_read_b128 v[56:59], v17 offset:44032
    v_lshlrev_b32 v105, 16, v105
    v_mfma_f32_16x16x32_bf16 v[68:71], a[164:167], v[32:35], v[68:71]
    v_mul_f32 v107, v107, v109
    v_mul_f32 v108, v108, v110
    v_mfma_f32_16x16x32_bf16 v[72:75], a[160:163], v[36:39], v[72:75]
    ds_read_b128 v[60:63], v18 offset:44032
    v_mul_f32 v105, v104, v105
    v_mfma_f32_16x16x32_bf16 v[76:79], a[164:167], v[36:39], v[76:79]
    v_mul_f32 v106, v104, v106
    s_waitcnt lgkmcnt(4)
    v_mfma_f32_16x16x32_bf16 v[64:67], a[168:171], v[40:43], v[64:67]
    s_barrier
    ds_read_b128 v[32:35], v17 offset:49152
    s_add_u32 m0, s49, 57344
    s_add_u32 s50, s48, 57344
    v_mfma_f32_16x16x32_bf16 v[68:71], a[172:175], v[40:43], v[68:71]
    buffer_load_dwordx4 v21, s[8:11], s50 offen offset:0 sc1 lds
    v_cvt_pk_bf16_f32 v107, v107, v108
    v_mfma_f32_16x16x32_bf16 v[72:75], a[168:171], v[44:47], v[72:75]
    ds_read_b128 v[36:39], v18 offset:49152
    v_cvt_pk_bf16_f32 v105, v105, v106
    v_mfma_f32_16x16x32_bf16 v[76:79], a[172:175], v[44:47], v[76:79]
    v_and_b32 v108, 0xffff0000, v107
    s_waitcnt lgkmcnt(4)
    v_mfma_f32_16x16x32_bf16 v[64:67], a[176:179], v[48:51], v[64:67]
    ds_read_b128 v[40:43], v17 offset:50176
    v_lshlrev_b32 v107, 16, v107
    v_mfma_f32_16x16x32_bf16 v[68:71], a[180:183], v[48:51], v[68:71]
    v_and_b32 v106, 0xffff0000, v105
    v_lshlrev_b32 v105, 16, v105
    v_mfma_f32_16x16x32_bf16 v[72:75], a[176:179], v[52:55], v[72:75]
    ds_read_b128 v[44:47], v18 offset:50176
    s_add_u32 m0, s49, 61440
    s_add_u32 s50, s48, 61440
    v_mfma_f32_16x16x32_bf16 v[76:79], a[180:183], v[52:55], v[76:79]
    buffer_load_dwordx4 v21, s[8:11], s50 offen offset:0 sc1 lds
    s_waitcnt lgkmcnt(4)
    v_mfma_f32_16x16x32_bf16 v[64:67], a[184:187], v[56:59], v[64:67]
    ds_read_b128 v[48:51], v17 offset:51200
    v_mul_f32 v107, v100, v107
    v_mfma_f32_16x16x32_bf16 v[68:71], a[188:191], v[56:59], v[68:71]
    v_mul_f32 v108, v100, v108
    v_cvt_pk_bf16_f32 v107, v107, v108
    v_mfma_f32_16x16x32_bf16 v[72:75], a[184:187], v[60:63], v[72:75]
    ds_read_b128 v[52:55], v18 offset:51200
    v_and_b32 v108, 0xffff0000, v107
    v_mfma_f32_16x16x32_bf16 v[76:79], a[188:191], v[60:63], v[76:79]
    v_lshlrev_b32 v107, 16, v107
    s_waitcnt lgkmcnt(4)
    v_mfma_f32_16x16x32_bf16 v[64:67], a[192:195], v[32:35], v[64:67]
    ds_read_b128 v[56:59], v17 offset:52224
    v_add_f32 v105, v105, v107
    v_mfma_f32_16x16x32_bf16 v[68:71], a[196:199], v[32:35], v[68:71]
    v_add_f32 v106, v106, v108
    v_cvt_pk_bf16_f32 v103, v105, v106
    v_mfma_f32_16x16x32_bf16 v[72:75], a[192:195], v[36:39], v[72:75]
    ds_read_b128 v[60:63], v18 offset:52224
    v_mfma_f32_16x16x32_bf16 v[76:79], a[196:199], v[36:39], v[76:79]
    s_waitcnt lgkmcnt(4)
    v_mfma_f32_16x16x32_bf16 v[64:67], a[200:203], v[40:43], v[64:67]
    ds_read_b128 v[32:35], v17 offset:57344
    v_mfma_f32_16x16x32_bf16 v[68:71], a[204:207], v[40:43], v[68:71]
    s_mov_b64 exec, s[64:65]
    buffer_store_dwordx2 v[102:103], v22, s[44:47], s52 offen
    s_mov_b64 exec, -1
    v_mfma_f32_16x16x32_bf16 v[72:75], a[200:203], v[44:47], v[72:75]
    ds_read_b128 v[36:39], v18 offset:57344
    v_mfma_f32_16x16x32_bf16 v[76:79], a[204:207], v[44:47], v[76:79]
    s_waitcnt lgkmcnt(4)
    v_mfma_f32_16x16x32_bf16 v[64:67], a[208:211], v[48:51], v[64:67]
    ds_read_b128 v[40:43], v17 offset:58368
    v_mfma_f32_16x16x32_bf16 v[68:71], a[212:215], v[48:51], v[68:71]
    v_mfma_f32_16x16x32_bf16 v[72:75], a[208:211], v[52:55], v[72:75]
    ds_read_b128 v[44:47], v18 offset:58368
    v_mfma_f32_16x16x32_bf16 v[76:79], a[212:215], v[52:55], v[76:79]
    s_waitcnt lgkmcnt(4)
    v_mfma_f32_16x16x32_bf16 v[64:67], a[216:219], v[56:59], v[64:67]
    ds_read_b128 v[48:51], v17 offset:59392
    v_mfma_f32_16x16x32_bf16 v[68:71], a[220:223], v[56:59], v[68:71]
    v_mfma_f32_16x16x32_bf16 v[72:75], a[216:219], v[60:63], v[72:75]
    ds_read_b128 v[52:55], v18 offset:59392
    v_mfma_f32_16x16x32_bf16 v[76:79], a[220:223], v[60:63], v[76:79]
    s_add_u32 s51, s34, s55
    s_lshl_b32 s52, s54, 16
    s_lshl_b32 s60, s54, 7
    s_add_u32 s58, s60, 117440512
    s_add_u32 s59, s60, 117448704
    s_add_u32 s60, s60, 121634816

    s_cmp_eq_u32 s38, 0
    s_waitcnt lgkmcnt(4)
    v_mfma_f32_16x16x32_bf16 v[64:67], a[224:227], v[32:35], v[64:67]
    ds_read_b128 v[56:59], v17 offset:60416
    v_mfma_f32_16x16x32_bf16 v[68:71], a[228:231], v[32:35], v[68:71]
    buffer_load_dwordx2 v[96:97], v22, s[16:19], s52 offen
    v_mfma_f32_16x16x32_bf16 v[72:75], a[224:227], v[36:39], v[72:75]
    ds_read_b128 v[60:63], v18 offset:60416
    v_mfma_f32_16x16x32_bf16 v[76:79], a[228:231], v[36:39], v[76:79]
    buffer_load_dword v98, v23, s[8:11], s58 offen
    s_waitcnt lgkmcnt(4)
    v_mfma_f32_16x16x32_bf16 v[64:67], a[232:235], v[40:43], v[64:67]
    v_mfma_f32_16x16x32_bf16 v[68:71], a[236:239], v[40:43], v[68:71]
    buffer_load_dword v99, v23, s[8:11], s59 offen
    v_mfma_f32_16x16x32_bf16 v[72:75], a[232:235], v[44:47], v[72:75]
    v_mfma_f32_16x16x32_bf16 v[76:79], a[236:239], v[44:47], v[76:79]
    buffer_load_dword v100, v16, s[8:11], s60 offen
    s_waitcnt lgkmcnt(2)
    v_mfma_f32_16x16x32_bf16 v[64:67], a[240:243], v[48:51], v[64:67]
    v_mfma_f32_16x16x32_bf16 v[68:71], a[244:247], v[48:51], v[68:71]
    buffer_load_dwordx4 v[84:87], v7, s[8:11], s51 offen sc1
    v_mfma_f32_16x16x32_bf16 v[72:75], a[240:243], v[52:55], v[72:75]
    v_mfma_f32_16x16x32_bf16 v[76:79], a[244:247], v[52:55], v[76:79]
    buffer_load_dwordx4 v[88:91], v8, s[8:11], s51 offen sc1
    s_waitcnt lgkmcnt(0)
    v_mfma_f32_16x16x32_bf16 v[64:67], a[248:251], v[56:59], v[64:67]
    v_mfma_f32_16x16x32_bf16 v[68:71], a[252:255], v[56:59], v[68:71]
    buffer_load_dwordx4 v[92:95], v9, s[8:11], s51 offen sc1
    v_mfma_f32_16x16x32_bf16 v[72:75], a[248:251], v[60:63], v[72:75]
    v_mfma_f32_16x16x32_bf16 v[76:79], a[252:255], v[60:63], v[76:79]
    v_xor_b32 v17, 0x10000, v17
    v_xor_b32 v18, 0x10000, v18
    s_cselect_b64 s[64:65], 0, -1
    s_add_u32 s4, s34, s37

    v_mov_b32 v112, v80
    v_mov_b32 v113, v81
    v_mov_b32 v114, v82
    v_mov_b32 v115, v83
    s_branch .g2st_430
.g2nd_429:
    s_waitcnt lgkmcnt(4)
    v_mfma_f32_16x16x32_bf16 v[64:67], a[0:3], v[32:35], 0
    ds_read_b128 v[56:59], v17 offset:3072
    v_mfma_f32_16x16x32_bf16 v[68:71], a[4:7], v[32:35], 0
    v_mfma_f32_16x16x32_bf16 v[72:75], a[0:3], v[36:39], 0
    ds_read_b128 v[60:63], v18 offset:3072
    v_mfma_f32_16x16x32_bf16 v[76:79], a[4:7], v[36:39], 0
    s_waitcnt lgkmcnt(4)
    v_mfma_f32_16x16x32_bf16 v[64:67], a[8:11], v[40:43], v[64:67]
    ds_read_b128 v[32:35], v17 offset:8192
    v_mfma_f32_16x16x32_bf16 v[68:71], a[12:15], v[40:43], v[68:71]
    v_mfma_f32_16x16x32_bf16 v[72:75], a[8:11], v[44:47], v[72:75]
    ds_read_b128 v[36:39], v18 offset:8192
    v_mfma_f32_16x16x32_bf16 v[76:79], a[12:15], v[44:47], v[76:79]
    s_waitcnt lgkmcnt(4)
    v_mfma_f32_16x16x32_bf16 v[64:67], a[16:19], v[48:51], v[64:67]
    ds_read_b128 v[40:43], v17 offset:9216
    v_mfma_f32_16x16x32_bf16 v[68:71], a[20:23], v[48:51], v[68:71]
    v_mfma_f32_16x16x32_bf16 v[72:75], a[16:19], v[52:55], v[72:75]
    ds_read_b128 v[44:47], v18 offset:9216
    v_mfma_f32_16x16x32_bf16 v[76:79], a[20:23], v[52:55], v[76:79]
    s_waitcnt lgkmcnt(4)
    v_mfma_f32_16x16x32_bf16 v[64:67], a[24:27], v[56:59], v[64:67]
    ds_read_b128 v[48:51], v17 offset:10240
    v_mfma_f32_16x16x32_bf16 v[68:71], a[28:31], v[56:59], v[68:71]
    v_mfma_f32_16x16x32_bf16 v[72:75], a[24:27], v[60:63], v[72:75]
    ds_read_b128 v[52:55], v18 offset:10240
    v_mfma_f32_16x16x32_bf16 v[76:79], a[28:31], v[60:63], v[76:79]
    s_waitcnt lgkmcnt(4)
    v_mfma_f32_16x16x32_bf16 v[64:67], a[32:35], v[32:35], v[64:67]
    ds_read_b128 v[56:59], v17 offset:11264
    v_mfma_f32_16x16x32_bf16 v[68:71], a[36:39], v[32:35], v[68:71]
    v_mfma_f32_16x16x32_bf16 v[72:75], a[32:35], v[36:39], v[72:75]
    ds_read_b128 v[60:63], v18 offset:11264
    v_mfma_f32_16x16x32_bf16 v[76:79], a[36:39], v[36:39], v[76:79]
    s_waitcnt lgkmcnt(4)
    v_mfma_f32_16x16x32_bf16 v[64:67], a[40:43], v[40:43], v[64:67]
    s_barrier
    ds_read_b128 v[32:35], v17 offset:16384
    v_mfma_f32_16x16x32_bf16 v[68:71], a[44:47], v[40:43], v[68:71]
    v_mfma_f32_16x16x32_bf16 v[72:75], a[40:43], v[44:47], v[72:75]
    ds_read_b128 v[36:39], v18 offset:16384
    v_mfma_f32_16x16x32_bf16 v[76:79], a[44:47], v[44:47], v[76:79]
    s_waitcnt lgkmcnt(4)
    v_mfma_f32_16x16x32_bf16 v[64:67], a[48:51], v[48:51], v[64:67]
    ds_read_b128 v[40:43], v17 offset:17408
    v_mfma_f32_16x16x32_bf16 v[68:71], a[52:55], v[48:51], v[68:71]
    s_waitcnt vmcnt(3)
    v_mfma_f32_16x16x32_bf16 v[72:75], a[48:51], v[52:55], v[72:75]
    ds_read_b128 v[44:47], v18 offset:17408
    v_mfma_f32_16x16x32_bf16 v[76:79], a[52:55], v[52:55], v[76:79]
    s_mov_b32 s62, 0
.cc_441:
    v_max3_u32 v4, v84, v88, v92
    v_cmp_eq_u32 vcc, -1, v4
    s_and_b64 vcc, vcc, s[64:65]
    s_cbranch_vccnz .cf_442
    s_waitcnt lgkmcnt(4)
    v_mfma_f32_16x16x32_bf16 v[64:67], a[56:59], v[56:59], v[64:67]
    ds_read_b128 v[48:51], v17 offset:18432
    v_add_f32 v84, v84, v88
    v_mfma_f32_16x16x32_bf16 v[68:71], a[60:63], v[56:59], v[68:71]
    v_add_f32 v92, v112, v92
    v_add_f32 v85, v85, v89
    v_mfma_f32_16x16x32_bf16 v[72:75], a[56:59], v[60:63], v[72:75]
    ds_read_b128 v[52:55], v18 offset:18432
    v_add_f32 v93, v113, v93
    v_mfma_f32_16x16x32_bf16 v[76:79], a[60:63], v[60:63], v[76:79]
    v_add_f32 v86, v86, v90
    s_waitcnt lgkmcnt(4)
    v_mfma_f32_16x16x32_bf16 v[64:67], a[64:67], v[32:35], v[64:67]
    ds_read_b128 v[56:59], v17 offset:19456
    v_add_f32 v94, v114, v94
    v_mfma_f32_16x16x32_bf16 v[68:71], a[68:71], v[32:35], v[68:71]
    v_add_f32 v87, v87, v91
    v_add_f32 v95, v115, v95
    v_mfma_f32_16x16x32_bf16 v[72:75], a[64:67], v[36:39], v[72:75]
    ds_read_b128 v[60:63], v18 offset:19456
    v_add_f32 v84, v92, v84
    v_mfma_f32_16x16x32_bf16 v[76:79], a[68:71], v[36:39], v[76:79]
    v_add_f32 v85, v93, v85
    s_waitcnt lgkmcnt(4)
    v_mfma_f32_16x16x32_bf16 v[64:67], a[72:75], v[40:43], v[64:67]
    ds_read_b128 v[32:35], v17 offset:24576
    v_add_f32 v86, v94, v86
    v_mfma_f32_16x16x32_bf16 v[68:71], a[76:79], v[40:43], v[68:71]
    v_add_f32 v87, v95, v87
    v_sub_f32 v104, 1.0, v100
    v_mfma_f32_16x16x32_bf16 v[72:75], a[72:75], v[44:47], v[72:75]
    ds_read_b128 v[36:39], v18 offset:24576
    v_cvt_pk_bf16_f32 v104, v104, v104
    v_mfma_f32_16x16x32_bf16 v[76:79], a[76:79], v[44:47], v[76:79]
    v_lshlrev_b32 v104, 16, v104
    s_waitcnt lgkmcnt(4)
    v_mfma_f32_16x16x32_bf16 v[64:67], a[80:83], v[48:51], v[64:67]
    ds_read_b128 v[40:43], v17 offset:25600
    v_cvt_pk_bf16_f32 v105, v84, v85
    v_mfma_f32_16x16x32_bf16 v[68:71], a[84:87], v[48:51], v[68:71]
    v_lshlrev_b32 v107, 16, v96
    v_and_b32 v108, 0xffff0000, v96
    v_mfma_f32_16x16x32_bf16 v[72:75], a[80:83], v[52:55], v[72:75]
    ds_read_b128 v[44:47], v18 offset:25600
    v_lshlrev_b32 v109, 16, v98
    v_mfma_f32_16x16x32_bf16 v[76:79], a[84:87], v[52:55], v[76:79]
    v_and_b32 v110, 0xffff0000, v98
    s_waitcnt lgkmcnt(4)
    v_mfma_f32_16x16x32_bf16 v[64:67], a[88:91], v[56:59], v[64:67]
    ds_read_b128 v[48:51], v17 offset:26624
    v_and_b32 v106, 0xffff0000, v105
    v_mfma_f32_16x16x32_bf16 v[68:71], a[92:95], v[56:59], v[68:71]
    v_lshlrev_b32 v105, 16, v105
    v_mul_f32 v107, v107, v109
    v_mfma_f32_16x16x32_bf16 v[72:75], a[88:91], v[60:63], v[72:75]
    ds_read_b128 v[52:55], v18 offset:26624
    v_mul_f32 v108, v108, v110
    v_mfma_f32_16x16x32_bf16 v[76:79], a[92:95], v[60:63], v[76:79]
    v_mul_f32 v105, v104, v105
    s_waitcnt lgkmcnt(4)
    v_mfma_f32_16x16x32_bf16 v[64:67], a[96:99], v[32:35], v[64:67]
    ds_read_b128 v[56:59], v17 offset:27648
    v_mul_f32 v106, v104, v106
    v_mfma_f32_16x16x32_bf16 v[68:71], a[100:103], v[32:35], v[68:71]
    v_cvt_pk_bf16_f32 v107, v107, v108
    v_cvt_pk_bf16_f32 v105, v105, v106
    v_mfma_f32_16x16x32_bf16 v[72:75], a[96:99], v[36:39], v[72:75]
    ds_read_b128 v[60:63], v18 offset:27648
    v_and_b32 v108, 0xffff0000, v107
    v_mfma_f32_16x16x32_bf16 v[76:79], a[100:103], v[36:39], v[76:79]
    v_lshlrev_b32 v107, 16, v107
    s_waitcnt lgkmcnt(4)
    v_mfma_f32_16x16x32_bf16 v[64:67], a[104:107], v[40:43], v[64:67]
    s_barrier
    ds_read_b128 v[32:35], v17 offset:32768
    v_mfma_f32_16x16x32_bf16 v[68:71], a[108:111], v[40:43], v[68:71]
    v_and_b32 v106, 0xffff0000, v105
    v_lshlrev_b32 v105, 16, v105
    v_mfma_f32_16x16x32_bf16 v[72:75], a[104:107], v[44:47], v[72:75]
    ds_read_b128 v[36:39], v18 offset:32768
    v_mul_f32 v107, v100, v107
    v_mfma_f32_16x16x32_bf16 v[76:79], a[108:111], v[44:47], v[76:79]
    v_mul_f32 v108, v100, v108
    s_waitcnt lgkmcnt(4)
    v_mfma_f32_16x16x32_bf16 v[64:67], a[112:115], v[48:51], v[64:67]
    ds_read_b128 v[40:43], v17 offset:33792
    v_cvt_pk_bf16_f32 v107, v107, v108
    v_mfma_f32_16x16x32_bf16 v[68:71], a[116:119], v[48:51], v[68:71]
    v_and_b32 v108, 0xffff0000, v107
    v_lshlrev_b32 v107, 16, v107
    v_mfma_f32_16x16x32_bf16 v[72:75], a[112:115], v[52:55], v[72:75]
    ds_read_b128 v[44:47], v18 offset:33792
    v_add_f32 v105, v105, v107
    v_mfma_f32_16x16x32_bf16 v[76:79], a[116:119], v[52:55], v[76:79]
    v_add_f32 v106, v106, v108
    s_waitcnt lgkmcnt(4)
    v_mfma_f32_16x16x32_bf16 v[64:67], a[120:123], v[56:59], v[64:67]
    ds_read_b128 v[48:51], v17 offset:34816
    v_cvt_pk_bf16_f32 v102, v105, v106
    v_mfma_f32_16x16x32_bf16 v[68:71], a[124:127], v[56:59], v[68:71]
    v_cvt_pk_bf16_f32 v105, v86, v87
    v_lshlrev_b32 v107, 16, v97
    v_mfma_f32_16x16x32_bf16 v[72:75], a[120:123], v[60:63], v[72:75]
    ds_read_b128 v[52:55], v18 offset:34816
    v_and_b32 v108, 0xffff0000, v97
    v_mfma_f32_16x16x32_bf16 v[76:79], a[124:127], v[60:63], v[76:79]
    v_lshlrev_b32 v109, 16, v99
    s_waitcnt lgkmcnt(4)
    v_mfma_f32_16x16x32_bf16 v[64:67], a[128:131], v[32:35], v[64:67]
    ds_read_b128 v[56:59], v17 offset:35840
    v_and_b32 v110, 0xffff0000, v99
    v_mfma_f32_16x16x32_bf16 v[68:71], a[132:135], v[32:35], v[68:71]
    v_and_b32 v106, 0xffff0000, v105
    v_lshlrev_b32 v105, 16, v105
    v_mfma_f32_16x16x32_bf16 v[72:75], a[128:131], v[36:39], v[72:75]
    ds_read_b128 v[60:63], v18 offset:35840
    v_mul_f32 v107, v107, v109
    v_mfma_f32_16x16x32_bf16 v[76:79], a[132:135], v[36:39], v[76:79]
    v_mul_f32 v108, v108, v110
    s_waitcnt lgkmcnt(4)
    v_mfma_f32_16x16x32_bf16 v[64:67], a[136:139], v[40:43], v[64:67]
    ds_read_b128 v[32:35], v17 offset:40960
    v_mul_f32 v105, v104, v105
    v_mfma_f32_16x16x32_bf16 v[68:71], a[140:143], v[40:43], v[68:71]
    v_mul_f32 v106, v104, v106
    v_cvt_pk_bf16_f32 v107, v107, v108
    v_mfma_f32_16x16x32_bf16 v[72:75], a[136:139], v[44:47], v[72:75]
    ds_read_b128 v[36:39], v18 offset:40960
    v_cvt_pk_bf16_f32 v105, v105, v106
    v_mfma_f32_16x16x32_bf16 v[76:79], a[140:143], v[44:47], v[76:79]
    v_and_b32 v108, 0xffff0000, v107
    s_waitcnt lgkmcnt(4)
    v_mfma_f32_16x16x32_bf16 v[64:67], a[144:147], v[48:51], v[64:67]
    ds_read_b128 v[40:43], v17 offset:41984
    v_lshlrev_b32 v107, 16, v107
    v_mfma_f32_16x16x32_bf16 v[68:71], a[148:151], v[48:51], v[68:71]
    v_and_b32 v106, 0xffff0000, v105
    v_lshlrev_b32 v105, 16, v105
    v_mfma_f32_16x16x32_bf16 v[72:75], a[144:147], v[52:55], v[72:75]
    ds_read_b128 v[44:47], v18 offset:41984
    v_mul_f32 v107, v100, v107
    v_mfma_f32_16x16x32_bf16 v[76:79], a[148:151], v[52:55], v[76:79]
    v_mul_f32 v108, v100, v108
    s_waitcnt lgkmcnt(4)
    v_mfma_f32_16x16x32_bf16 v[64:67], a[152:155], v[56:59], v[64:67]
    ds_read_b128 v[48:51], v17 offset:43008
    v_cvt_pk_bf16_f32 v107, v107, v108
    v_mfma_f32_16x16x32_bf16 v[68:71], a[156:159], v[56:59], v[68:71]
    v_and_b32 v108, 0xffff0000, v107
    v_lshlrev_b32 v107, 16, v107
    v_mfma_f32_16x16x32_bf16 v[72:75], a[152:155], v[60:63], v[72:75]
    ds_read_b128 v[52:55], v18 offset:43008
    v_add_f32 v105, v105, v107
    v_mfma_f32_16x16x32_bf16 v[76:79], a[156:159], v[60:63], v[76:79]
    v_add_f32 v106, v106, v108
    s_waitcnt lgkmcnt(4)
    v_mfma_f32_16x16x32_bf16 v[64:67], a[160:163], v[32:35], v[64:67]
    ds_read_b128 v[56:59], v17 offset:44032
    v_cvt_pk_bf16_f32 v103, v105, v106
    v_mfma_f32_16x16x32_bf16 v[68:71], a[164:167], v[32:35], v[68:71]
    s_mov_b64 exec, s[64:65]
    buffer_store_dwordx2 v[102:103], v22, s[44:47], s52 offen
    s_mov_b64 exec, -1
    v_mfma_f32_16x16x32_bf16 v[72:75], a[160:163], v[36:39], v[72:75]
    ds_read_b128 v[60:63], v18 offset:44032
    v_mfma_f32_16x16x32_bf16 v[76:79], a[164:167], v[36:39], v[76:79]
    s_waitcnt lgkmcnt(4)
    v_mfma_f32_16x16x32_bf16 v[64:67], a[168:171], v[40:43], v[64:67]
    s_barrier
    ds_read_b128 v[32:35], v17 offset:49152
    v_mfma_f32_16x16x32_bf16 v[68:71], a[172:175], v[40:43], v[68:71]
    v_mfma_f32_16x16x32_bf16 v[72:75], a[168:171], v[44:47], v[72:75]
    ds_read_b128 v[36:39], v18 offset:49152
    v_mfma_f32_16x16x32_bf16 v[76:79], a[172:175], v[44:47], v[76:79]
    s_waitcnt lgkmcnt(4)
    v_mfma_f32_16x16x32_bf16 v[64:67], a[176:179], v[48:51], v[64:67]
    ds_read_b128 v[40:43], v17 offset:50176
    v_mfma_f32_16x16x32_bf16 v[68:71], a[180:183], v[48:51], v[68:71]
    v_mfma_f32_16x16x32_bf16 v[72:75], a[176:179], v[52:55], v[72:75]
    ds_read_b128 v[44:47], v18 offset:50176
    v_mfma_f32_16x16x32_bf16 v[76:79], a[180:183], v[52:55], v[76:79]
    s_waitcnt lgkmcnt(4)
    v_mfma_f32_16x16x32_bf16 v[64:67], a[184:187], v[56:59], v[64:67]
    ds_read_b128 v[48:51], v17 offset:51200
    v_mfma_f32_16x16x32_bf16 v[68:71], a[188:191], v[56:59], v[68:71]
    v_mfma_f32_16x16x32_bf16 v[72:75], a[184:187], v[60:63], v[72:75]
    ds_read_b128 v[52:55], v18 offset:51200
    v_mfma_f32_16x16x32_bf16 v[76:79], a[188:191], v[60:63], v[76:79]
    s_waitcnt lgkmcnt(4)
    v_mfma_f32_16x16x32_bf16 v[64:67], a[192:195], v[32:35], v[64:67]
    ds_read_b128 v[56:59], v17 offset:52224
    v_mfma_f32_16x16x32_bf16 v[68:71], a[196:199], v[32:35], v[68:71]
    v_mfma_f32_16x16x32_bf16 v[72:75], a[192:195], v[36:39], v[72:75]
    ds_read_b128 v[60:63], v18 offset:52224
    v_mfma_f32_16x16x32_bf16 v[76:79], a[196:199], v[36:39], v[76:79]
    s_waitcnt lgkmcnt(4)
    v_mfma_f32_16x16x32_bf16 v[64:67], a[200:203], v[40:43], v[64:67]
    ds_read_b128 v[32:35], v17 offset:57344
    v_mfma_f32_16x16x32_bf16 v[68:71], a[204:207], v[40:43], v[68:71]
    v_mfma_f32_16x16x32_bf16 v[72:75], a[200:203], v[44:47], v[72:75]
    ds_read_b128 v[36:39], v18 offset:57344
    v_mfma_f32_16x16x32_bf16 v[76:79], a[204:207], v[44:47], v[76:79]
    s_waitcnt lgkmcnt(4)
    v_mfma_f32_16x16x32_bf16 v[64:67], a[208:211], v[48:51], v[64:67]
    ds_read_b128 v[40:43], v17 offset:58368
    v_mfma_f32_16x16x32_bf16 v[68:71], a[212:215], v[48:51], v[68:71]
    v_mfma_f32_16x16x32_bf16 v[72:75], a[208:211], v[52:55], v[72:75]
    ds_read_b128 v[44:47], v18 offset:58368
    v_mfma_f32_16x16x32_bf16 v[76:79], a[212:215], v[52:55], v[76:79]
    s_waitcnt lgkmcnt(4)
    v_mfma_f32_16x16x32_bf16 v[64:67], a[216:219], v[56:59], v[64:67]
    ds_read_b128 v[48:51], v17 offset:59392
    v_mfma_f32_16x16x32_bf16 v[68:71], a[220:223], v[56:59], v[68:71]
    v_mfma_f32_16x16x32_bf16 v[72:75], a[216:219], v[60:63], v[72:75]
    ds_read_b128 v[52:55], v18 offset:59392
    v_mfma_f32_16x16x32_bf16 v[76:79], a[220:223], v[60:63], v[76:79]
    s_add_u32 s51, s34, s55
    s_lshl_b32 s52, s54, 16
    s_lshl_b32 s60, s54, 7
    s_add_u32 s58, s60, 117440512
    s_add_u32 s59, s60, 117448704
    s_add_u32 s60, s60, 121634816

    s_cmp_eq_u32 s38, 0
    s_waitcnt lgkmcnt(4)
    v_mfma_f32_16x16x32_bf16 v[64:67], a[224:227], v[32:35], v[64:67]
    ds_read_b128 v[56:59], v17 offset:60416
    v_mfma_f32_16x16x32_bf16 v[68:71], a[228:231], v[32:35], v[68:71]
    buffer_load_dwordx2 v[96:97], v22, s[16:19], s52 offen
    v_mfma_f32_16x16x32_bf16 v[72:75], a[224:227], v[36:39], v[72:75]
    ds_read_b128 v[60:63], v18 offset:60416
    v_mfma_f32_16x16x32_bf16 v[76:79], a[228:231], v[36:39], v[76:79]
    buffer_load_dword v98, v23, s[8:11], s58 offen
    s_waitcnt lgkmcnt(4)
    v_mfma_f32_16x16x32_bf16 v[64:67], a[232:235], v[40:43], v[64:67]
    v_mfma_f32_16x16x32_bf16 v[68:71], a[236:239], v[40:43], v[68:71]
    buffer_load_dword v99, v23, s[8:11], s59 offen
    v_mfma_f32_16x16x32_bf16 v[72:75], a[232:235], v[44:47], v[72:75]
    v_mfma_f32_16x16x32_bf16 v[76:79], a[236:239], v[44:47], v[76:79]
    buffer_load_dword v100, v16, s[8:11], s60 offen
    s_waitcnt lgkmcnt(2)
    v_mfma_f32_16x16x32_bf16 v[64:67], a[240:243], v[48:51], v[64:67]
    v_mfma_f32_16x16x32_bf16 v[68:71], a[244:247], v[48:51], v[68:71]
    buffer_load_dwordx4 v[84:87], v7, s[8:11], s51 offen sc1
    v_mfma_f32_16x16x32_bf16 v[72:75], a[240:243], v[52:55], v[72:75]
    v_mfma_f32_16x16x32_bf16 v[76:79], a[244:247], v[52:55], v[76:79]
    buffer_load_dwordx4 v[88:91], v8, s[8:11], s51 offen sc1
    s_waitcnt lgkmcnt(0)
    v_mfma_f32_16x16x32_bf16 v[64:67], a[248:251], v[56:59], v[64:67]
    v_mfma_f32_16x16x32_bf16 v[68:71], a[252:255], v[56:59], v[68:71]
    buffer_load_dwordx4 v[92:95], v9, s[8:11], s51 offen sc1
    v_mfma_f32_16x16x32_bf16 v[72:75], a[248:251], v[60:63], v[72:75]
    v_mfma_f32_16x16x32_bf16 v[76:79], a[252:255], v[60:63], v[76:79]
    v_xor_b32 v17, 0x10000, v17
    v_xor_b32 v18, 0x10000, v18
    s_cselect_b64 s[64:65], 0, -1
    s_add_u32 s4, s34, s37

    v_mov_b32 v112, v80
    v_mov_b32 v113, v81
    v_mov_b32 v114, v82
    v_mov_b32 v115, v83
.g2st_430:
    v_min_u32 v68, 0xfffffffe, v68
    buffer_store_dwordx4 v[68:71], v28, s[8:11], s4 offen sc1
    v_min_u32 v72, 0xfffffffe, v72
    buffer_store_dwordx4 v[72:75], v29, s[8:11], s4 offen sc1
    v_min_u32 v76, 0xfffffffe, v76
    buffer_store_dwordx4 v[76:79], v30, s[8:11], s4 offen sc1
    v_mov_b32 v80, v64
    v_mov_b32 v81, v65
    v_mov_b32 v82, v66
    v_mov_b32 v83, v67
    s_cmp_lg_u32 s56, 0
    s_cbranch_scc1 .g2pf_443
    s_cmp_eq_u32 s38, 0
    s_cbranch_scc1 .g2nc_431
    s_waitcnt vmcnt(0)
    s_mov_b32 s62, 0
.cc_444:
    v_max3_u32 v4, v84, v88, v92
    v_cmp_eq_u32 vcc, -1, v4
    s_cbranch_vccnz .cf_445
    v_add_f32 v84, v84, v88
    v_add_f32 v92, v112, v92
    v_add_f32 v85, v85, v89
    v_add_f32 v93, v113, v93
    v_add_f32 v86, v86, v90
    v_add_f32 v94, v114, v94
    v_add_f32 v87, v87, v91
    v_add_f32 v95, v115, v95
    v_add_f32 v84, v92, v84
    v_add_f32 v85, v93, v85
    v_add_f32 v86, v94, v86
    v_add_f32 v87, v95, v87
    v_sub_f32 v104, 1.0, v100
    v_cvt_pk_bf16_f32 v104, v104, v104
    v_lshlrev_b32 v104, 16, v104
    v_cvt_pk_bf16_f32 v105, v84, v85
    v_lshlrev_b32 v107, 16, v96
    v_and_b32 v108, 0xffff0000, v96
    v_lshlrev_b32 v109, 16, v98
    v_and_b32 v110, 0xffff0000, v98
    v_and_b32 v106, 0xffff0000, v105
    v_lshlrev_b32 v105, 16, v105
    v_mul_f32 v107, v107, v109
    v_mul_f32 v108, v108, v110
    v_mul_f32 v105, v104, v105
    v_mul_f32 v106, v104, v106
    v_cvt_pk_bf16_f32 v107, v107, v108
    v_cvt_pk_bf16_f32 v105, v105, v106
    v_and_b32 v108, 0xffff0000, v107
    v_lshlrev_b32 v107, 16, v107
    v_and_b32 v106, 0xffff0000, v105
    v_lshlrev_b32 v105, 16, v105
    v_mul_f32 v107, v100, v107
    v_mul_f32 v108, v100, v108
    v_cvt_pk_bf16_f32 v107, v107, v108
    v_and_b32 v108, 0xffff0000, v107
    v_lshlrev_b32 v107, 16, v107
    v_add_f32 v105, v105, v107
    v_add_f32 v106, v106, v108
    v_cvt_pk_bf16_f32 v102, v105, v106
    v_cvt_pk_bf16_f32 v105, v86, v87
    v_lshlrev_b32 v107, 16, v97
    v_and_b32 v108, 0xffff0000, v97
    v_lshlrev_b32 v109, 16, v99
    v_and_b32 v110, 0xffff0000, v99
    v_and_b32 v106, 0xffff0000, v105
    v_lshlrev_b32 v105, 16, v105
    v_mul_f32 v107, v107, v109
    v_mul_f32 v108, v108, v110
    v_mul_f32 v105, v104, v105
    v_mul_f32 v106, v104, v106
    v_cvt_pk_bf16_f32 v107, v107, v108
    v_cvt_pk_bf16_f32 v105, v105, v106
    v_and_b32 v108, 0xffff0000, v107
    v_lshlrev_b32 v107, 16, v107
    v_and_b32 v106, 0xffff0000, v105
    v_lshlrev_b32 v105, 16, v105
    v_mul_f32 v107, v100, v107
    v_mul_f32 v108, v100, v108
    v_cvt_pk_bf16_f32 v107, v107, v108
    v_and_b32 v108, 0xffff0000, v107
    v_lshlrev_b32 v107, 16, v107
    v_add_f32 v105, v105, v107
    v_add_f32 v106, v106, v108
    v_cvt_pk_bf16_f32 v103, v105, v106
    buffer_store_dwordx2 v[102:103], v22, s[44:47], s52 offen
.g2nc_431:
    s_add_u32 s51, s34, s37
    s_lshl_b32 s52, s31, 16
    s_lshl_b32 s60, s31, 7
    s_add_u32 s58, s60, 117440512
    s_add_u32 s59, s60, 117448704
    s_add_u32 s60, s60, 121634816

    buffer_load_dwordx2 v[96:97], v22, s[16:19], s52 offen
    buffer_load_dword v98, v23, s[8:11], s58 offen
    buffer_load_dword v99, v23, s[8:11], s59 offen
    buffer_load_dword v100, v16, s[8:11], s60 offen
    buffer_load_dwordx4 v[84:87], v7, s[8:11], s51 offen sc1
    buffer_load_dwordx4 v[88:91], v8, s[8:11], s51 offen sc1
    buffer_load_dwordx4 v[92:95], v9, s[8:11], s51 offen sc1
    s_waitcnt vmcnt(0)
    s_mov_b32 s62, 0
.cc_446:
    v_max3_u32 v4, v84, v88, v92
    v_cmp_eq_u32 vcc, -1, v4
    s_cbranch_vccnz .cf_447
    v_add_f32 v84, v84, v88
    v_add_f32 v92, v80, v92
    v_add_f32 v85, v85, v89
    v_add_f32 v93, v81, v93
    v_add_f32 v86, v86, v90
    v_add_f32 v94, v82, v94
    v_add_f32 v87, v87, v91
    v_add_f32 v95, v83, v95
    v_add_f32 v84, v92, v84
    v_add_f32 v85, v93, v85
    v_add_f32 v86, v94, v86
    v_add_f32 v87, v95, v87
    v_sub_f32 v104, 1.0, v100
    v_cvt_pk_bf16_f32 v104, v104, v104
    v_lshlrev_b32 v104, 16, v104
    v_cvt_pk_bf16_f32 v105, v84, v85
    v_lshlrev_b32 v107, 16, v96
    v_and_b32 v108, 0xffff0000, v96
    v_lshlrev_b32 v109, 16, v98
    v_and_b32 v110, 0xffff0000, v98
    v_and_b32 v106, 0xffff0000, v105
    v_lshlrev_b32 v105, 16, v105
    v_mul_f32 v107, v107, v109
    v_mul_f32 v108, v108, v110
    v_mul_f32 v105, v104, v105
    v_mul_f32 v106, v104, v106
    v_cvt_pk_bf16_f32 v107, v107, v108
    v_cvt_pk_bf16_f32 v105, v105, v106
    v_and_b32 v108, 0xffff0000, v107
    v_lshlrev_b32 v107, 16, v107
    v_and_b32 v106, 0xffff0000, v105
    v_lshlrev_b32 v105, 16, v105
    v_mul_f32 v107, v100, v107
    v_mul_f32 v108, v100, v108
    v_cvt_pk_bf16_f32 v107, v107, v108
    v_and_b32 v108, 0xffff0000, v107
    v_lshlrev_b32 v107, 16, v107
    v_add_f32 v105, v105, v107
    v_add_f32 v106, v106, v108
    v_cvt_pk_bf16_f32 v102, v105, v106
    v_cvt_pk_bf16_f32 v105, v86, v87
    v_lshlrev_b32 v107, 16, v97
    v_and_b32 v108, 0xffff0000, v97
    v_lshlrev_b32 v109, 16, v99
    v_and_b32 v110, 0xffff0000, v99
    v_and_b32 v106, 0xffff0000, v105
    v_lshlrev_b32 v105, 16, v105
    v_mul_f32 v107, v107, v109
    v_mul_f32 v108, v108, v110
    v_mul_f32 v105, v104, v105
    v_mul_f32 v106, v104, v106
    v_cvt_pk_bf16_f32 v107, v107, v108
    v_cvt_pk_bf16_f32 v105, v105, v106
    v_and_b32 v108, 0xffff0000, v107
    v_lshlrev_b32 v107, 16, v107
    v_and_b32 v106, 0xffff0000, v105
    v_lshlrev_b32 v105, 16, v105
    v_mul_f32 v107, v100, v107
    v_mul_f32 v108, v100, v108
    v_cvt_pk_bf16_f32 v107, v107, v108
    v_and_b32 v108, 0xffff0000, v107
    v_lshlrev_b32 v107, 16, v107
    v_add_f32 v105, v105, v107
    v_add_f32 v106, v106, v108
    v_cvt_pk_bf16_f32 v103, v105, v106
    buffer_store_dwordx2 v[102:103], v22, s[44:47], s52 offen
.g2nx_437:
    s_mov_b32 s54, s31
    s_mov_b32 s31, s53
    s_mov_b32 s69, 3
    s_add_u32 s37, s37, 0x10000
    s_cmp_lt_u32 s31, 65
    s_cbranch_scc1 .g2blk_425
    s_branch .g2fin_432

.g2pf_443:
    s_mov_b32 s54, s31
    s_mov_b32 s31, s53
    s_mov_b32 s69, 3
    s_add_u32 s37, s37, 0x10000
    s_cmp_eq_u32 s38, 0
    s_mov_b32 s38, 1

    s_waitcnt vmcnt(10)
    s_branch .g2go_426

.g2w3_427:
    s_waitcnt vmcnt(3)
    s_branch .g2go_426
.g2h_434:
    s_mov_b32 s53, 63
    s_and_b32 s54, s31, 1
    s_lshr_b32 s4, s91, 1
    s_xor_b32 s55, s54, s4
    s_lshl_b32 s4, s55, 12
    v_xor_b32 v17, s4, v17

    s_add_u32 s51, s34, s37
    s_lshl_b32 s52, s53, 16
    s_lshl_b32 s60, s53, 7
    s_add_u32 s58, s60, 117440512
    s_add_u32 s59, s60, 117448704
    s_add_u32 s60, s60, 121634816

    s_lshl_b32 s48, s53, 18
    s_add_u32 s48, s48, s36
    s_add_u32 s49, s39, s35
    s_xor_b32 s39, s39, 0x10000

    s_lshl_b32 s4, s54, 12
    s_add_u32 s48, s48, s4
    s_add_u32 s49, s49, s4
    buffer_load_dwordx2 v[96:97], v22, s[16:19], s52 offen
    buffer_load_dword v98, v23, s[8:11], s58 offen
    buffer_load_dword v99, v23, s[8:11], s59 offen
    buffer_load_dword v100, v16, s[8:11], s60 offen
    s_waitcnt vmcnt(0)
    v_sub_f32 v104, 1.0, v100
    v_cvt_pk_bf16_f32 v104, v104, v104
    v_lshlrev_b32 v104, 16, v104
    v_lshlrev_b32 v107, 16, v96
    v_and_b32 v108, 0xffff0000, v96
    v_lshlrev_b32 v109, 16, v98
    v_and_b32 v110, 0xffff0000, v98
    v_mul_f32 v107, v107, v109
    v_mul_f32 v108, v108, v110
    v_cvt_pk_bf16_f32 v107, v107, v108
    v_and_b32 v108, 0xffff0000, v107
    v_lshlrev_b32 v107, 16, v107
    v_mul_f32 v107, v100, v107
    v_mul_f32 v108, v100, v108
    v_cvt_pk_bf16_f32 v107, v107, v108
    v_and_b32 v113, 0xffff0000, v107
    v_lshlrev_b32 v112, 16, v107
    v_lshlrev_b32 v107, 16, v97
    v_and_b32 v108, 0xffff0000, v97
    v_lshlrev_b32 v109, 16, v99
    v_and_b32 v110, 0xffff0000, v99
    v_mul_f32 v107, v107, v109
    v_mul_f32 v108, v108, v110
    v_cvt_pk_bf16_f32 v107, v107, v108
    v_and_b32 v108, 0xffff0000, v107
    v_lshlrev_b32 v107, 16, v107
    v_mul_f32 v107, v100, v107
    v_mul_f32 v108, v100, v108
    v_cvt_pk_bf16_f32 v107, v107, v108
    v_and_b32 v115, 0xffff0000, v107
    v_lshlrev_b32 v114, 16, v107
.hp_448:
    buffer_load_dword v20, v19, s[8:11], s33 offen sc1
    s_waitcnt vmcnt(0)
    s_lshr_b32 s6, s31, 2
    s_and_b32 s4, s31, 3
    v_cmp_ge_u32 vcc, s6, v20
    s_lshl_b32 s4, s4, 3
    s_lshr_b32 s5, vcc_lo, s4
    s_and_b32 s5, s5, 0xff
    s_cmp_eq_u32 s5, 0

    s_cbranch_scc1 .hr_449
    s_lshl_b64 exec, 0xff, s4
    s_add_u32 s62, s62, 1
    s_cmp_gt_u32 s62, 0x400000
    s_cbranch_scc1 .mg_end_1
    s_branch .hp_448

.hr_449:
    s_mov_b64 exec, -1
    s_add_u32 m0, s49, 0
    s_add_u32 s50, s48, 0
    buffer_load_dwordx4 v21, s[8:11], s50 offen offset:0 sc1 lds
    s_add_u32 m0, s49, 8192
    s_add_u32 s50, s48, 8192
    buffer_load_dwordx4 v21, s[8:11], s50 offen offset:0 sc1 lds
    s_add_u32 m0, s49, 16384
    s_add_u32 s50, s48, 16384
    buffer_load_dwordx4 v21, s[8:11], s50 offen offset:0 sc1 lds
    s_add_u32 m0, s49, 24576
    s_add_u32 s50, s48, 24576
    buffer_load_dwordx4 v21, s[8:11], s50 offen offset:0 sc1 lds
    s_add_u32 m0, s49, 32768
    s_add_u32 s50, s48, 32768
    buffer_load_dwordx4 v21, s[8:11], s50 offen offset:0 sc1 lds
    s_add_u32 m0, s49, 40960
    s_add_u32 s50, s48, 40960
    buffer_load_dwordx4 v21, s[8:11], s50 offen offset:0 sc1 lds
    s_add_u32 m0, s49, 49152
    s_add_u32 s50, s48, 49152
    buffer_load_dwordx4 v21, s[8:11], s50 offen offset:0 sc1 lds
    s_add_u32 m0, s49, 57344
    s_add_u32 s50, s48, 57344
    buffer_load_dwordx4 v21, s[8:11], s50 offen offset:0 sc1 lds
    s_waitcnt vmcnt(6)
    s_barrier
    ds_read_b128 v[32:35], v17 offset:0
    ds_read_b128 v[36:39], v17 offset:1024
    ds_read_b128 v[40:43], v17 offset:2048
    ds_read_b128 v[44:47], v17 offset:3072
    ds_read_b128 v[48:51], v17 offset:8192
    ds_read_b128 v[52:55], v17 offset:9216
    s_waitcnt lgkmcnt(5)
    v_mfma_f32_16x16x32_bf16 v[64:67], a[0:3], v[32:35], 0
    ds_read_b128 v[56:59], v17 offset:10240
    v_mfma_f32_16x16x32_bf16 v[68:71], a[4:7], v[32:35], 0
    s_waitcnt lgkmcnt(5)
    v_mfma_f32_16x16x32_bf16 v[72:75], a[8:11], v[36:39], 0
    ds_read_b128 v[60:63], v17 offset:11264
    v_mfma_f32_16x16x32_bf16 v[76:79], a[12:15], v[36:39], 0
    s_waitcnt lgkmcnt(5)
    v_mfma_f32_16x16x32_bf16 v[64:67], a[16:19], v[40:43], v[64:67]
    s_waitcnt vmcnt(4)
    s_barrier
    ds_read_b128 v[32:35], v17 offset:16384
    v_mfma_f32_16x16x32_bf16 v[68:71], a[20:23], v[40:43], v[68:71]
    s_waitcnt lgkmcnt(5)
    v_mfma_f32_16x16x32_bf16 v[72:75], a[24:27], v[44:47], v[72:75]
    ds_read_b128 v[36:39], v17 offset:17408
    v_mfma_f32_16x16x32_bf16 v[76:79], a[28:31], v[44:47], v[76:79]
    s_waitcnt lgkmcnt(5)
    v_mfma_f32_16x16x32_bf16 v[64:67], a[32:35], v[48:51], v[64:67]
    ds_read_b128 v[40:43], v17 offset:18432
    v_mfma_f32_16x16x32_bf16 v[68:71], a[36:39], v[48:51], v[68:71]
    s_waitcnt lgkmcnt(5)
    v_mfma_f32_16x16x32_bf16 v[72:75], a[40:43], v[52:55], v[72:75]
    ds_read_b128 v[44:47], v17 offset:19456
    v_mfma_f32_16x16x32_bf16 v[76:79], a[44:47], v[52:55], v[76:79]
    s_waitcnt lgkmcnt(5)
    v_mfma_f32_16x16x32_bf16 v[64:67], a[48:51], v[56:59], v[64:67]
    ds_read_b128 v[48:51], v17 offset:24576
    v_mfma_f32_16x16x32_bf16 v[68:71], a[52:55], v[56:59], v[68:71]
    s_waitcnt lgkmcnt(5)
    v_mfma_f32_16x16x32_bf16 v[72:75], a[56:59], v[60:63], v[72:75]
    ds_read_b128 v[52:55], v17 offset:25600
    v_mfma_f32_16x16x32_bf16 v[76:79], a[60:63], v[60:63], v[76:79]
    s_waitcnt lgkmcnt(5)
    v_mfma_f32_16x16x32_bf16 v[64:67], a[64:67], v[32:35], v[64:67]
    ds_read_b128 v[56:59], v17 offset:26624
    v_mfma_f32_16x16x32_bf16 v[68:71], a[68:71], v[32:35], v[68:71]
    s_waitcnt lgkmcnt(5)
    v_mfma_f32_16x16x32_bf16 v[72:75], a[72:75], v[36:39], v[72:75]
    ds_read_b128 v[60:63], v17 offset:27648
    v_mfma_f32_16x16x32_bf16 v[76:79], a[76:79], v[36:39], v[76:79]
    s_waitcnt lgkmcnt(5)
    v_mfma_f32_16x16x32_bf16 v[64:67], a[80:83], v[40:43], v[64:67]
    s_waitcnt vmcnt(2)
    s_barrier
    ds_read_b128 v[32:35], v17 offset:32768
    v_mfma_f32_16x16x32_bf16 v[68:71], a[84:87], v[40:43], v[68:71]
    s_waitcnt lgkmcnt(5)
    v_mfma_f32_16x16x32_bf16 v[72:75], a[88:91], v[44:47], v[72:75]
    ds_read_b128 v[36:39], v17 offset:33792
    v_mfma_f32_16x16x32_bf16 v[76:79], a[92:95], v[44:47], v[76:79]
    s_waitcnt lgkmcnt(5)
    v_mfma_f32_16x16x32_bf16 v[64:67], a[96:99], v[48:51], v[64:67]
    ds_read_b128 v[40:43], v17 offset:34816
    v_mfma_f32_16x16x32_bf16 v[68:71], a[100:103], v[48:51], v[68:71]
    s_waitcnt lgkmcnt(5)
    v_mfma_f32_16x16x32_bf16 v[72:75], a[104:107], v[52:55], v[72:75]
    ds_read_b128 v[44:47], v17 offset:35840
    v_mfma_f32_16x16x32_bf16 v[76:79], a[108:111], v[52:55], v[76:79]
    s_waitcnt lgkmcnt(5)
    v_mfma_f32_16x16x32_bf16 v[64:67], a[112:115], v[56:59], v[64:67]
    ds_read_b128 v[48:51], v17 offset:40960
    v_mfma_f32_16x16x32_bf16 v[68:71], a[116:119], v[56:59], v[68:71]
    s_waitcnt lgkmcnt(5)
    v_mfma_f32_16x16x32_bf16 v[72:75], a[120:123], v[60:63], v[72:75]
    ds_read_b128 v[52:55], v17 offset:41984
    v_mfma_f32_16x16x32_bf16 v[76:79], a[124:127], v[60:63], v[76:79]
    s_waitcnt lgkmcnt(5)
    v_mfma_f32_16x16x32_bf16 v[64:67], a[128:131], v[32:35], v[64:67]
    ds_read_b128 v[56:59], v17 offset:43008
    v_mfma_f32_16x16x32_bf16 v[68:71], a[132:135], v[32:35], v[68:71]
    s_waitcnt lgkmcnt(5)
    v_mfma_f32_16x16x32_bf16 v[72:75], a[136:139], v[36:39], v[72:75]
    ds_read_b128 v[60:63], v17 offset:44032
    v_mfma_f32_16x16x32_bf16 v[76:79], a[140:143], v[36:39], v[76:79]
    s_waitcnt lgkmcnt(5)
    v_mfma_f32_16x16x32_bf16 v[64:67], a[144:147], v[40:43], v[64:67]
    s_waitcnt vmcnt(0)
    s_barrier
    ds_read_b128 v[32:35], v17 offset:49152
    v_mfma_f32_16x16x32_bf16 v[68:71], a[148:151], v[40:43], v[68:71]
    s_waitcnt lgkmcnt(5)
    v_mfma_f32_16x16x32_bf16 v[72:75], a[152:155], v[44:47], v[72:75]
    ds_read_b128 v[36:39], v17 offset:50176
    v_mfma_f32_16x16x32_bf16 v[76:79], a[156:159], v[44:47], v[76:79]
    s_waitcnt lgkmcnt(5)
    v_mfma_f32_16x16x32_bf16 v[64:67], a[160:163], v[48:51], v[64:67]
    ds_read_b128 v[40:43], v17 offset:51200
    v_mfma_f32_16x16x32_bf16 v[68:71], a[164:167], v[48:51], v[68:71]
    s_waitcnt lgkmcnt(5)
    v_mfma_f32_16x16x32_bf16 v[72:75], a[168:171], v[52:55], v[72:75]
    ds_read_b128 v[44:47], v17 offset:52224
    v_mfma_f32_16x16x32_bf16 v[76:79], a[172:175], v[52:55], v[76:79]
    s_waitcnt lgkmcnt(5)
    v_mfma_f32_16x16x32_bf16 v[64:67], a[176:179], v[56:59], v[64:67]
    ds_read_b128 v[48:51], v17 offset:57344
    v_mfma_f32_16x16x32_bf16 v[68:71], a[180:183], v[56:59], v[68:71]
    s_waitcnt lgkmcnt(5)
    v_mfma_f32_16x16x32_bf16 v[72:75], a[184:187], v[60:63], v[72:75]
    ds_read_b128 v[52:55], v17 offset:58368
    v_mfma_f32_16x16x32_bf16 v[76:79], a[188:191], v[60:63], v[76:79]
    s_waitcnt lgkmcnt(5)
    v_mfma_f32_16x16x32_bf16 v[64:67], a[192:195], v[32:35], v[64:67]
    ds_read_b128 v[56:59], v17 offset:59392
    v_mfma_f32_16x16x32_bf16 v[68:71], a[196:199], v[32:35], v[68:71]
    s_waitcnt lgkmcnt(5)
    v_mfma_f32_16x16x32_bf16 v[72:75], a[200:203], v[36:39], v[72:75]
    ds_read_b128 v[60:63], v17 offset:60416
    v_mfma_f32_16x16x32_bf16 v[76:79], a[204:207], v[36:39], v[76:79]
    s_waitcnt lgkmcnt(5)
    v_mfma_f32_16x16x32_bf16 v[64:67], a[208:211], v[40:43], v[64:67]
    v_mfma_f32_16x16x32_bf16 v[68:71], a[212:215], v[40:43], v[68:71]
    s_waitcnt lgkmcnt(4)
    v_mfma_f32_16x16x32_bf16 v[72:75], a[216:219], v[44:47], v[72:75]
    v_mfma_f32_16x16x32_bf16 v[76:79], a[220:223], v[44:47], v[76:79]
    s_waitcnt lgkmcnt(3)
    v_mfma_f32_16x16x32_bf16 v[64:67], a[224:227], v[48:51], v[64:67]
    v_mfma_f32_16x16x32_bf16 v[68:71], a[228:231], v[48:51], v[68:71]
    s_waitcnt lgkmcnt(2)
    v_mfma_f32_16x16x32_bf16 v[72:75], a[232:235], v[52:55], v[72:75]
    v_mfma_f32_16x16x32_bf16 v[76:79], a[236:239], v[52:55], v[76:79]
    s_waitcnt lgkmcnt(1)
    v_mfma_f32_16x16x32_bf16 v[64:67], a[240:243], v[56:59], v[64:67]
    v_mfma_f32_16x16x32_bf16 v[68:71], a[244:247], v[56:59], v[68:71]
    s_waitcnt lgkmcnt(0)
    v_mfma_f32_16x16x32_bf16 v[72:75], a[248:251], v[60:63], v[72:75]
    v_mfma_f32_16x16x32_bf16 v[76:79], a[252:255], v[60:63], v[76:79]
    s_cmp_lg_u32 s55, 0
    s_nop 6
    v_pk_add_f32 v[68:69], v[68:69], v[76:77]
    v_pk_add_f32 v[70:71], v[70:71], v[78:79]
    v_pk_add_f32 v[64:65], v[64:65], v[72:73]
    v_pk_add_f32 v[66:67], v[66:67], v[74:75]
    v_min_u32 v68, 0xfffffffe, v68
    s_cbranch_scc1 .hs_450
    buffer_store_dwordx4 v[68:71], v28, s[8:11], s51 offen sc1
    s_waitcnt vmcnt(0)
    buffer_load_dwordx4 v[84:87], v7, s[8:11], s51 offen sc1
    buffer_load_dwordx4 v[88:91], v8, s[8:11], s51 offen sc1
    buffer_load_dwordx4 v[92:95], v9, s[8:11], s51 offen sc1
    s_waitcnt vmcnt(0)
    s_mov_b32 s62, 0
.cc_452:
    v_max3_u32 v4, v84, v88, v92
    v_cmp_eq_u32 vcc, -1, v4
    s_cbranch_vccnz .cf_453
    v_add_f32 v84, v84, v88
    v_add_f32 v92, v64, v92
    v_add_f32 v85, v85, v89
    v_add_f32 v93, v65, v93
    v_add_f32 v86, v86, v90
    v_add_f32 v94, v66, v94
    v_add_f32 v87, v87, v91
    v_add_f32 v95, v67, v95
    v_add_f32 v84, v92, v84
    v_add_f32 v85, v93, v85
    v_add_f32 v86, v94, v86
    v_add_f32 v87, v95, v87
    v_cvt_pk_bf16_f32 v105, v84, v85
    v_cvt_pk_bf16_f32 v107, v86, v87
    v_and_b32 v106, 0xffff0000, v105
    v_lshlrev_b32 v105, 16, v105
    v_and_b32 v108, 0xffff0000, v107
    v_lshlrev_b32 v107, 16, v107
    v_mul_f32 v105, v104, v105
    v_mul_f32 v106, v104, v106
    v_mul_f32 v107, v104, v107
    v_mul_f32 v108, v104, v108
    v_cvt_pk_bf16_f32 v105, v105, v106
    v_cvt_pk_bf16_f32 v107, v107, v108
    v_and_b32 v106, 0xffff0000, v105
    v_lshlrev_b32 v105, 16, v105
    v_and_b32 v108, 0xffff0000, v107
    v_lshlrev_b32 v107, 16, v107
    v_add_f32 v105, v105, v112
    v_add_f32 v106, v106, v113
    v_add_f32 v107, v107, v114
    v_add_f32 v108, v108, v115
    v_cvt_pk_bf16_f32 v102, v105, v106
    v_cvt_pk_bf16_f32 v103, v107, v108
    buffer_store_dwordx2 v[102:103], v22, s[44:47], s52 offen
    s_branch .g2fin_432
.hs_450:
    v_min_u32 v64, 0xfffffffe, v64
    buffer_store_dwordx4 v[68:71], v30, s[8:11], s51 offen sc1
    buffer_store_dwordx4 v[64:67], v29, s[8:11], s51 offen sc1

    s_branch .g2fin_432
.g2fb_436:
    s_add_u32 s51, s34, s37
    s_lshl_b32 s52, s31, 16
    s_lshl_b32 s60, s31, 7
    s_add_u32 s58, s60, 117440512
    s_add_u32 s59, s60, 117448704
    s_add_u32 s60, s60, 121634816

    s_waitcnt vmcnt(4)
    s_barrier
    ds_read_b128 v[32:35], v17 offset:0
    ds_read_b128 v[36:39], v18 offset:0
    ds_read_b128 v[40:43], v17 offset:1024
    ds_read_b128 v[44:47], v18 offset:1024
    ds_read_b128 v[48:51], v17 offset:2048
    ds_read_b128 v[52:55], v18 offset:2048
    s_waitcnt lgkmcnt(4)
    v_mfma_f32_16x16x32_bf16 v[64:67], a[0:3], v[32:35], 0
    ds_read_b128 v[56:59], v17 offset:3072
    v_mfma_f32_16x16x32_bf16 v[68:71], a[4:7], v[32:35], 0
    s_add_u32 m0, s49, 32768
    s_add_u32 s50, s48, 32768
    v_mfma_f32_16x16x32_bf16 v[72:75], a[0:3], v[36:39], 0
    ds_read_b128 v[60:63], v18 offset:3072
    v_mfma_f32_16x16x32_bf16 v[76:79], a[4:7], v[36:39], 0
    buffer_load_dwordx4 v21, s[8:11], s50 offen offset:0 sc1 lds
    s_waitcnt lgkmcnt(4)
    v_mfma_f32_16x16x32_bf16 v[64:67], a[8:11], v[40:43], v[64:67]
    ds_read_b128 v[32:35], v17 offset:8192
    v_mfma_f32_16x16x32_bf16 v[68:71], a[12:15], v[40:43], v[68:71]
    s_add_u32 m0, s49, 36864
    s_add_u32 s50, s48, 36864
    v_mfma_f32_16x16x32_bf16 v[72:75], a[8:11], v[44:47], v[72:75]
    ds_read_b128 v[36:39], v18 offset:8192
    v_mfma_f32_16x16x32_bf16 v[76:79], a[12:15], v[44:47], v[76:79]
    buffer_load_dwordx4 v21, s[8:11], s50 offen offset:0 sc1 lds
    s_waitcnt lgkmcnt(4)
    v_mfma_f32_16x16x32_bf16 v[64:67], a[16:19], v[48:51], v[64:67]
    ds_read_b128 v[40:43], v17 offset:9216
    v_mfma_f32_16x16x32_bf16 v[68:71], a[20:23], v[48:51], v[68:71]
    s_add_u32 m0, s49, 40960
    s_add_u32 s50, s48, 40960
    v_mfma_f32_16x16x32_bf16 v[72:75], a[16:19], v[52:55], v[72:75]
    ds_read_b128 v[44:47], v18 offset:9216
    v_mfma_f32_16x16x32_bf16 v[76:79], a[20:23], v[52:55], v[76:79]
    buffer_load_dwordx4 v21, s[8:11], s50 offen offset:0 sc1 lds
    s_waitcnt lgkmcnt(4)
    v_mfma_f32_16x16x32_bf16 v[64:67], a[24:27], v[56:59], v[64:67]
    ds_read_b128 v[48:51], v17 offset:10240
    v_mfma_f32_16x16x32_bf16 v[68:71], a[28:31], v[56:59], v[68:71]
    s_add_u32 m0, s49, 45056
    s_add_u32 s50, s48, 45056
    v_mfma_f32_16x16x32_bf16 v[72:75], a[24:27], v[60:63], v[72:75]
    ds_read_b128 v[52:55], v18 offset:10240
    v_mfma_f32_16x16x32_bf16 v[76:79], a[28:31], v[60:63], v[76:79]
    buffer_load_dwordx4 v21, s[8:11], s50 offen offset:0 sc1 lds
    s_waitcnt lgkmcnt(4)
    v_mfma_f32_16x16x32_bf16 v[64:67], a[32:35], v[32:35], v[64:67]
    ds_read_b128 v[56:59], v17 offset:11264
    v_mfma_f32_16x16x32_bf16 v[68:71], a[36:39], v[32:35], v[68:71]
    s_add_u32 m0, s49, 49152
    s_add_u32 s50, s48, 49152
    v_mfma_f32_16x16x32_bf16 v[72:75], a[32:35], v[36:39], v[72:75]
    ds_read_b128 v[60:63], v18 offset:11264
    v_mfma_f32_16x16x32_bf16 v[76:79], a[36:39], v[36:39], v[76:79]
    buffer_load_dwordx4 v21, s[8:11], s50 offen offset:0 sc1 lds
    s_waitcnt lgkmcnt(4)
    v_mfma_f32_16x16x32_bf16 v[64:67], a[40:43], v[40:43], v[64:67]
    s_waitcnt vmcnt(5)
    s_barrier
    ds_read_b128 v[32:35], v17 offset:16384
    v_mfma_f32_16x16x32_bf16 v[68:71], a[44:47], v[40:43], v[68:71]
    s_add_u32 m0, s49, 53248
    s_add_u32 s50, s48, 53248
    v_mfma_f32_16x16x32_bf16 v[72:75], a[40:43], v[44:47], v[72:75]
    ds_read_b128 v[36:39], v18 offset:16384
    v_mfma_f32_16x16x32_bf16 v[76:79], a[44:47], v[44:47], v[76:79]
    buffer_load_dwordx4 v21, s[8:11], s50 offen offset:0 sc1 lds
    s_waitcnt lgkmcnt(4)
    v_mfma_f32_16x16x32_bf16 v[64:67], a[48:51], v[48:51], v[64:67]
    ds_read_b128 v[40:43], v17 offset:17408
    v_mfma_f32_16x16x32_bf16 v[68:71], a[52:55], v[48:51], v[68:71]
    s_add_u32 m0, s49, 57344
    s_add_u32 s50, s48, 57344
    v_mfma_f32_16x16x32_bf16 v[72:75], a[48:51], v[52:55], v[72:75]
    ds_read_b128 v[44:47], v18 offset:17408
    v_mfma_f32_16x16x32_bf16 v[76:79], a[52:55], v[52:55], v[76:79]
    buffer_load_dwordx4 v21, s[8:11], s50 offen offset:0 sc1 lds
    s_waitcnt lgkmcnt(4)
    v_mfma_f32_16x16x32_bf16 v[64:67], a[56:59], v[56:59], v[64:67]
    ds_read_b128 v[48:51], v17 offset:18432
    v_mfma_f32_16x16x32_bf16 v[68:71], a[60:63], v[56:59], v[68:71]
    s_add_u32 m0, s49, 61440
    s_add_u32 s50, s48, 61440
    v_mfma_f32_16x16x32_bf16 v[72:75], a[56:59], v[60:63], v[72:75]
    ds_read_b128 v[52:55], v18 offset:18432
    v_mfma_f32_16x16x32_bf16 v[76:79], a[60:63], v[60:63], v[76:79]
    buffer_load_dwordx4 v21, s[8:11], s50 offen offset:0 sc1 lds
    s_waitcnt lgkmcnt(4)
    v_mfma_f32_16x16x32_bf16 v[64:67], a[64:67], v[32:35], v[64:67]
    ds_read_b128 v[56:59], v17 offset:19456
    v_mfma_f32_16x16x32_bf16 v[68:71], a[68:71], v[32:35], v[68:71]
    v_mfma_f32_16x16x32_bf16 v[72:75], a[64:67], v[36:39], v[72:75]
    ds_read_b128 v[60:63], v18 offset:19456
    v_mfma_f32_16x16x32_bf16 v[76:79], a[68:71], v[36:39], v[76:79]
    buffer_load_dwordx2 v[96:97], v22, s[16:19], s52 offen
    s_waitcnt lgkmcnt(4)
    v_mfma_f32_16x16x32_bf16 v[64:67], a[72:75], v[40:43], v[64:67]
    ds_read_b128 v[32:35], v17 offset:24576
    v_mfma_f32_16x16x32_bf16 v[68:71], a[76:79], v[40:43], v[68:71]
    v_mfma_f32_16x16x32_bf16 v[72:75], a[72:75], v[44:47], v[72:75]
    ds_read_b128 v[36:39], v18 offset:24576
    v_mfma_f32_16x16x32_bf16 v[76:79], a[76:79], v[44:47], v[76:79]
    buffer_load_dword v98, v23, s[8:11], s58 offen
    s_waitcnt lgkmcnt(4)
    v_mfma_f32_16x16x32_bf16 v[64:67], a[80:83], v[48:51], v[64:67]
    ds_read_b128 v[40:43], v17 offset:25600
    v_mfma_f32_16x16x32_bf16 v[68:71], a[84:87], v[48:51], v[68:71]
    v_mfma_f32_16x16x32_bf16 v[72:75], a[80:83], v[52:55], v[72:75]
    ds_read_b128 v[44:47], v18 offset:25600
    v_mfma_f32_16x16x32_bf16 v[76:79], a[84:87], v[52:55], v[76:79]
    buffer_load_dword v99, v23, s[8:11], s59 offen
    s_waitcnt lgkmcnt(4)
    v_mfma_f32_16x16x32_bf16 v[64:67], a[88:91], v[56:59], v[64:67]
    ds_read_b128 v[48:51], v17 offset:26624
    v_mfma_f32_16x16x32_bf16 v[68:71], a[92:95], v[56:59], v[68:71]
    v_mfma_f32_16x16x32_bf16 v[72:75], a[88:91], v[60:63], v[72:75]
    ds_read_b128 v[52:55], v18 offset:26624
    v_mfma_f32_16x16x32_bf16 v[76:79], a[92:95], v[60:63], v[76:79]
    buffer_load_dword v100, v16, s[8:11], s60 offen
    s_waitcnt lgkmcnt(4)
    v_mfma_f32_16x16x32_bf16 v[64:67], a[96:99], v[32:35], v[64:67]
    ds_read_b128 v[56:59], v17 offset:27648
    v_mfma_f32_16x16x32_bf16 v[68:71], a[100:103], v[32:35], v[68:71]
    v_mfma_f32_16x16x32_bf16 v[72:75], a[96:99], v[36:39], v[72:75]
    ds_read_b128 v[60:63], v18 offset:27648
    v_mfma_f32_16x16x32_bf16 v[76:79], a[100:103], v[36:39], v[76:79]
    s_waitcnt lgkmcnt(4)
    v_mfma_f32_16x16x32_bf16 v[64:67], a[104:107], v[40:43], v[64:67]
    s_waitcnt vmcnt(8)
    s_barrier
    ds_read_b128 v[32:35], v17 offset:32768
    v_mfma_f32_16x16x32_bf16 v[68:71], a[108:111], v[40:43], v[68:71]
    v_mfma_f32_16x16x32_bf16 v[72:75], a[104:107], v[44:47], v[72:75]
    ds_read_b128 v[36:39], v18 offset:32768
    v_mfma_f32_16x16x32_bf16 v[76:79], a[108:111], v[44:47], v[76:79]
    s_waitcnt lgkmcnt(4)
    v_mfma_f32_16x16x32_bf16 v[64:67], a[112:115], v[48:51], v[64:67]
    ds_read_b128 v[40:43], v17 offset:33792
    v_mfma_f32_16x16x32_bf16 v[68:71], a[116:119], v[48:51], v[68:71]
    v_mfma_f32_16x16x32_bf16 v[72:75], a[112:115], v[52:55], v[72:75]
    ds_read_b128 v[44:47], v18 offset:33792
    v_mfma_f32_16x16x32_bf16 v[76:79], a[116:119], v[52:55], v[76:79]
    s_waitcnt lgkmcnt(4)
    v_mfma_f32_16x16x32_bf16 v[64:67], a[120:123], v[56:59], v[64:67]
    ds_read_b128 v[48:51], v17 offset:34816
    v_mfma_f32_16x16x32_bf16 v[68:71], a[124:127], v[56:59], v[68:71]
    v_mfma_f32_16x16x32_bf16 v[72:75], a[120:123], v[60:63], v[72:75]
    ds_read_b128 v[52:55], v18 offset:34816
    v_mfma_f32_16x16x32_bf16 v[76:79], a[124:127], v[60:63], v[76:79]
    s_waitcnt lgkmcnt(4)
    v_mfma_f32_16x16x32_bf16 v[64:67], a[128:131], v[32:35], v[64:67]
    ds_read_b128 v[56:59], v17 offset:35840
    v_mfma_f32_16x16x32_bf16 v[68:71], a[132:135], v[32:35], v[68:71]
    v_mfma_f32_16x16x32_bf16 v[72:75], a[128:131], v[36:39], v[72:75]
    ds_read_b128 v[60:63], v18 offset:35840
    v_mfma_f32_16x16x32_bf16 v[76:79], a[132:135], v[36:39], v[76:79]
    s_waitcnt lgkmcnt(4)
    v_mfma_f32_16x16x32_bf16 v[64:67], a[136:139], v[40:43], v[64:67]
    ds_read_b128 v[32:35], v17 offset:40960
    v_mfma_f32_16x16x32_bf16 v[68:71], a[140:143], v[40:43], v[68:71]
    v_mfma_f32_16x16x32_bf16 v[72:75], a[136:139], v[44:47], v[72:75]
    ds_read_b128 v[36:39], v18 offset:40960
    v_mfma_f32_16x16x32_bf16 v[76:79], a[140:143], v[44:47], v[76:79]
    s_waitcnt lgkmcnt(4)
    v_mfma_f32_16x16x32_bf16 v[64:67], a[144:147], v[48:51], v[64:67]
    ds_read_b128 v[40:43], v17 offset:41984
    v_mfma_f32_16x16x32_bf16 v[68:71], a[148:151], v[48:51], v[68:71]
    v_mfma_f32_16x16x32_bf16 v[72:75], a[144:147], v[52:55], v[72:75]
    ds_read_b128 v[44:47], v18 offset:41984
    v_mfma_f32_16x16x32_bf16 v[76:79], a[148:151], v[52:55], v[76:79]
    s_waitcnt lgkmcnt(4)
    v_mfma_f32_16x16x32_bf16 v[64:67], a[152:155], v[56:59], v[64:67]
    ds_read_b128 v[48:51], v17 offset:43008
    v_mfma_f32_16x16x32_bf16 v[68:71], a[156:159], v[56:59], v[68:71]
    v_mfma_f32_16x16x32_bf16 v[72:75], a[152:155], v[60:63], v[72:75]
    ds_read_b128 v[52:55], v18 offset:43008
    v_mfma_f32_16x16x32_bf16 v[76:79], a[156:159], v[60:63], v[76:79]
    s_waitcnt lgkmcnt(4)
    v_mfma_f32_16x16x32_bf16 v[64:67], a[160:163], v[32:35], v[64:67]
    ds_read_b128 v[56:59], v17 offset:44032
    v_mfma_f32_16x16x32_bf16 v[68:71], a[164:167], v[32:35], v[68:71]
    v_mfma_f32_16x16x32_bf16 v[72:75], a[160:163], v[36:39], v[72:75]
    ds_read_b128 v[60:63], v18 offset:44032
    v_mfma_f32_16x16x32_bf16 v[76:79], a[164:167], v[36:39], v[76:79]
    s_waitcnt lgkmcnt(4)
    v_mfma_f32_16x16x32_bf16 v[64:67], a[168:171], v[40:43], v[64:67]
    s_waitcnt vmcnt(4)
    s_barrier
    ds_read_b128 v[32:35], v17 offset:49152
    v_mfma_f32_16x16x32_bf16 v[68:71], a[172:175], v[40:43], v[68:71]
    v_mfma_f32_16x16x32_bf16 v[72:75], a[168:171], v[44:47], v[72:75]
    ds_read_b128 v[36:39], v18 offset:49152
    v_mfma_f32_16x16x32_bf16 v[76:79], a[172:175], v[44:47], v[76:79]
    s_waitcnt lgkmcnt(4)
    v_mfma_f32_16x16x32_bf16 v[64:67], a[176:179], v[48:51], v[64:67]
    ds_read_b128 v[40:43], v17 offset:50176
    v_mfma_f32_16x16x32_bf16 v[68:71], a[180:183], v[48:51], v[68:71]
    v_mfma_f32_16x16x32_bf16 v[72:75], a[176:179], v[52:55], v[72:75]
    ds_read_b128 v[44:47], v18 offset:50176
    v_mfma_f32_16x16x32_bf16 v[76:79], a[180:183], v[52:55], v[76:79]
    s_waitcnt lgkmcnt(4)
    v_mfma_f32_16x16x32_bf16 v[64:67], a[184:187], v[56:59], v[64:67]
    ds_read_b128 v[48:51], v17 offset:51200
    v_mfma_f32_16x16x32_bf16 v[68:71], a[188:191], v[56:59], v[68:71]
    v_mfma_f32_16x16x32_bf16 v[72:75], a[184:187], v[60:63], v[72:75]
    ds_read_b128 v[52:55], v18 offset:51200
    v_mfma_f32_16x16x32_bf16 v[76:79], a[188:191], v[60:63], v[76:79]
    s_waitcnt lgkmcnt(4)
    v_mfma_f32_16x16x32_bf16 v[64:67], a[192:195], v[32:35], v[64:67]
    ds_read_b128 v[56:59], v17 offset:52224
    v_mfma_f32_16x16x32_bf16 v[68:71], a[196:199], v[32:35], v[68:71]
    v_mfma_f32_16x16x32_bf16 v[72:75], a[192:195], v[36:39], v[72:75]
    ds_read_b128 v[60:63], v18 offset:52224
    v_mfma_f32_16x16x32_bf16 v[76:79], a[196:199], v[36:39], v[76:79]
    s_waitcnt lgkmcnt(4)
    v_mfma_f32_16x16x32_bf16 v[64:67], a[200:203], v[40:43], v[64:67]
    ds_read_b128 v[32:35], v17 offset:57344
    v_mfma_f32_16x16x32_bf16 v[68:71], a[204:207], v[40:43], v[68:71]
    v_mfma_f32_16x16x32_bf16 v[72:75], a[200:203], v[44:47], v[72:75]
    ds_read_b128 v[36:39], v18 offset:57344
    v_mfma_f32_16x16x32_bf16 v[76:79], a[204:207], v[44:47], v[76:79]
    s_waitcnt lgkmcnt(4)
    v_mfma_f32_16x16x32_bf16 v[64:67], a[208:211], v[48:51], v[64:67]
    ds_read_b128 v[40:43], v17 offset:58368
    v_mfma_f32_16x16x32_bf16 v[68:71], a[212:215], v[48:51], v[68:71]
    v_mfma_f32_16x16x32_bf16 v[72:75], a[208:211], v[52:55], v[72:75]
    ds_read_b128 v[44:47], v18 offset:58368
    v_mfma_f32_16x16x32_bf16 v[76:79], a[212:215], v[52:55], v[76:79]
    s_waitcnt lgkmcnt(4)
    v_mfma_f32_16x16x32_bf16 v[64:67], a[216:219], v[56:59], v[64:67]
    ds_read_b128 v[48:51], v17 offset:59392
    v_mfma_f32_16x16x32_bf16 v[68:71], a[220:223], v[56:59], v[68:71]
    v_mfma_f32_16x16x32_bf16 v[72:75], a[216:219], v[60:63], v[72:75]
    ds_read_b128 v[52:55], v18 offset:59392
    v_mfma_f32_16x16x32_bf16 v[76:79], a[220:223], v[60:63], v[76:79]
    s_waitcnt lgkmcnt(4)
    v_mfma_f32_16x16x32_bf16 v[64:67], a[224:227], v[32:35], v[64:67]
    ds_read_b128 v[56:59], v17 offset:60416
    v_mfma_f32_16x16x32_bf16 v[68:71], a[228:231], v[32:35], v[68:71]
    v_mfma_f32_16x16x32_bf16 v[72:75], a[224:227], v[36:39], v[72:75]
    ds_read_b128 v[60:63], v18 offset:60416
    v_mfma_f32_16x16x32_bf16 v[76:79], a[228:231], v[36:39], v[76:79]
    s_waitcnt lgkmcnt(4)
    v_mfma_f32_16x16x32_bf16 v[64:67], a[232:235], v[40:43], v[64:67]
    v_mfma_f32_16x16x32_bf16 v[68:71], a[236:239], v[40:43], v[68:71]
    v_mfma_f32_16x16x32_bf16 v[72:75], a[232:235], v[44:47], v[72:75]
    v_mfma_f32_16x16x32_bf16 v[76:79], a[236:239], v[44:47], v[76:79]
    s_waitcnt lgkmcnt(2)
    v_mfma_f32_16x16x32_bf16 v[64:67], a[240:243], v[48:51], v[64:67]
    v_mfma_f32_16x16x32_bf16 v[68:71], a[244:247], v[48:51], v[68:71]
    v_mfma_f32_16x16x32_bf16 v[72:75], a[240:243], v[52:55], v[72:75]
    v_mfma_f32_16x16x32_bf16 v[76:79], a[244:247], v[52:55], v[76:79]
    s_waitcnt lgkmcnt(0)
    v_mfma_f32_16x16x32_bf16 v[64:67], a[248:251], v[56:59], v[64:67]
    v_mfma_f32_16x16x32_bf16 v[68:71], a[252:255], v[56:59], v[68:71]
    v_mfma_f32_16x16x32_bf16 v[72:75], a[248:251], v[60:63], v[72:75]
    v_mfma_f32_16x16x32_bf16 v[76:79], a[252:255], v[60:63], v[76:79]
    v_xor_b32 v17, 0x10000, v17
    v_xor_b32 v18, 0x10000, v18
    s_nop 3
    v_min_u32 v68, 0xfffffffe, v68
    buffer_store_dwordx4 v[68:71], v28, s[8:11], s51 offen sc1
    v_min_u32 v72, 0xfffffffe, v72
    buffer_store_dwordx4 v[72:75], v29, s[8:11], s51 offen sc1
    v_min_u32 v76, 0xfffffffe, v76
    buffer_store_dwordx4 v[76:79], v30, s[8:11], s51 offen sc1
    s_waitcnt vmcnt(3)
    v_sub_f32 v104, 1.0, v100
    v_cvt_pk_bf16_f32 v104, v104, v104
    v_lshlrev_b32 v104, 16, v104
    v_lshlrev_b32 v107, 16, v96
    v_and_b32 v108, 0xffff0000, v96
    v_lshlrev_b32 v109, 16, v98
    v_and_b32 v110, 0xffff0000, v98
    v_mul_f32 v107, v107, v109
    v_mul_f32 v108, v108, v110
    v_cvt_pk_bf16_f32 v107, v107, v108
    v_and_b32 v108, 0xffff0000, v107
    v_lshlrev_b32 v107, 16, v107
    v_mul_f32 v107, v100, v107
    v_mul_f32 v108, v100, v108
    v_cvt_pk_bf16_f32 v107, v107, v108
    v_and_b32 v113, 0xffff0000, v107
    v_lshlrev_b32 v112, 16, v107
    v_lshlrev_b32 v107, 16, v97
    v_and_b32 v108, 0xffff0000, v97
    v_lshlrev_b32 v109, 16, v99
    v_and_b32 v110, 0xffff0000, v99
    v_mul_f32 v107, v107, v109
    v_mul_f32 v108, v108, v110
    v_cvt_pk_bf16_f32 v107, v107, v108
    v_and_b32 v108, 0xffff0000, v107
    v_lshlrev_b32 v107, 16, v107
    v_mul_f32 v107, v100, v107
    v_mul_f32 v108, v100, v108
    v_cvt_pk_bf16_f32 v107, v107, v108
    v_and_b32 v115, 0xffff0000, v107
    v_lshlrev_b32 v114, 16, v107
    s_waitcnt vmcnt(0)
    buffer_load_dwordx4 v[84:87], v7, s[8:11], s51 offen sc1
    buffer_load_dwordx4 v[88:91], v8, s[8:11], s51 offen sc1
    buffer_load_dwordx4 v[92:95], v9, s[8:11], s51 offen sc1
    s_waitcnt vmcnt(0)
    s_mov_b32 s62, 0
.cc_454:
    v_max3_u32 v4, v84, v88, v92
    v_cmp_eq_u32 vcc, -1, v4
    s_cbranch_vccnz .cf_455
    v_add_f32 v84, v84, v88
    v_add_f32 v92, v64, v92
    v_add_f32 v85, v85, v89
    v_add_f32 v93, v65, v93
    v_add_f32 v86, v86, v90
    v_add_f32 v94, v66, v94
    v_add_f32 v87, v87, v91
    v_add_f32 v95, v67, v95
    v_add_f32 v84, v92, v84
    v_add_f32 v85, v93, v85
    v_add_f32 v86, v94, v86
    v_add_f32 v87, v95, v87
    v_cvt_pk_bf16_f32 v105, v84, v85
    v_cvt_pk_bf16_f32 v107, v86, v87
    v_and_b32 v106, 0xffff0000, v105
    v_lshlrev_b32 v105, 16, v105
    v_and_b32 v108, 0xffff0000, v107
    v_lshlrev_b32 v107, 16, v107
    v_mul_f32 v105, v104, v105
    v_mul_f32 v106, v104, v106
    v_mul_f32 v107, v104, v107
    v_mul_f32 v108, v104, v108
    v_cvt_pk_bf16_f32 v105, v105, v106
    v_cvt_pk_bf16_f32 v107, v107, v108
    v_and_b32 v106, 0xffff0000, v105
    v_lshlrev_b32 v105, 16, v105
    v_and_b32 v108, 0xffff0000, v107
    v_lshlrev_b32 v107, 16, v107
    v_add_f32 v105, v105, v112
    v_add_f32 v106, v106, v113
    v_add_f32 v107, v107, v114
    v_add_f32 v108, v108, v115
    v_cvt_pk_bf16_f32 v102, v105, v106
    v_cvt_pk_bf16_f32 v103, v107, v108
    buffer_store_dwordx2 v[102:103], v22, s[44:47], s52 offen
    s_branch .g2nx_437
.cf_440:
    buffer_load_dwordx4 v[84:87], v7, s[8:11], s51 offen sc1
    buffer_load_dwordx4 v[88:91], v8, s[8:11], s51 offen sc1
    buffer_load_dwordx4 v[92:95], v9, s[8:11], s51 offen sc1
    s_add_u32 s62, s62, 1
    s_cmp_gt_u32 s62, 0x400000
    s_cbranch_scc1 .mg_end_1
    s_waitcnt vmcnt(0)
    s_branch .cc_439

.cf_442:
    buffer_load_dwordx4 v[84:87], v7, s[8:11], s51 offen sc1
    buffer_load_dwordx4 v[88:91], v8, s[8:11], s51 offen sc1
    buffer_load_dwordx4 v[92:95], v9, s[8:11], s51 offen sc1
    s_add_u32 s62, s62, 1
    s_cmp_gt_u32 s62, 0x400000
    s_cbranch_scc1 .mg_end_1
    s_waitcnt vmcnt(0)
    s_branch .cc_441

.cf_445:
    buffer_load_dwordx4 v[84:87], v7, s[8:11], s51 offen sc1
    buffer_load_dwordx4 v[88:91], v8, s[8:11], s51 offen sc1
    buffer_load_dwordx4 v[92:95], v9, s[8:11], s51 offen sc1
    s_add_u32 s62, s62, 1
    s_cmp_gt_u32 s62, 0x400000
    s_cbranch_scc1 .mg_end_1
    s_waitcnt vmcnt(0)
    s_branch .cc_444

.cf_447:
    buffer_load_dwordx4 v[84:87], v7, s[8:11], s51 offen sc1
    buffer_load_dwordx4 v[88:91], v8, s[8:11], s51 offen sc1
    buffer_load_dwordx4 v[92:95], v9, s[8:11], s51 offen sc1
    s_add_u32 s62, s62, 1
    s_cmp_gt_u32 s62, 0x400000
    s_cbranch_scc1 .mg_end_1
    s_waitcnt vmcnt(0)
    s_branch .cc_446

.cf_453:
    buffer_load_dwordx4 v[84:87], v7, s[8:11], s51 offen sc1
    buffer_load_dwordx4 v[88:91], v8, s[8:11], s51 offen sc1
    buffer_load_dwordx4 v[92:95], v9, s[8:11], s51 offen sc1
    s_add_u32 s62, s62, 1
    s_cmp_gt_u32 s62, 0x400000
    s_cbranch_scc1 .mg_end_1
    s_waitcnt vmcnt(0)
    s_branch .cc_452

.cf_455:
    buffer_load_dwordx4 v[84:87], v7, s[8:11], s51 offen sc1
    buffer_load_dwordx4 v[88:91], v8, s[8:11], s51 offen sc1
    buffer_load_dwordx4 v[92:95], v9, s[8:11], s51 offen sc1
    s_add_u32 s62, s62, 1
    s_cmp_gt_u32 s62, 0x400000
    s_cbranch_scc1 .mg_end_1
    s_waitcnt vmcnt(0)
    s_branch .cc_454

.g2fin_432:
    s_endpgm
.cvrole_382:
    s_lshl_b32 s4, s91, 3
    s_add_u32 s4, s4, s26
    s_add_u32 s4, s4, 72
    s_lshl_b32 s4, s4, 8
    s_add_u32 s92, s4, 92274688
    s_lshl_b32 s4, s24, 2
    s_add_u32 s92, s92, s4
    v_mov_b32 v4, 0
    s_mov_b64 exec, 1
    buffer_store_dword v4, v4, s[8:11], s92 offen sc1
    s_mov_b64 exec, -1

    s_waitcnt vmcnt(0)
    s_barrier
    v_mov_b32 v243, s99
    v_mov_b32 v242, 0
    s_cmp_lg_u32 s24, 0
    s_cbranch_scc1 .a1_456
    v_mov_b32 v242, s26
    v_lshlrev_b32 v242, 6, v242
    v_add_u32 v242, s97, v242
    v_and_b32 v242, 255, v242
    s_mov_b64 exec, 1
    buffer_atomic_add v243, v242, s[20:23], 0 offen sc1
    s_mov_b64 exec, -1

.a1_456:
    s_waitcnt vmcnt(0)
    s_cmp_lg_u32 s24, 0
    s_cbranch_scc1 .pm_458
    s_lshl_b32 s93, s91, 3
    s_add_u32 s93, s93, s26
    s_sub_u32 s93, s93, 24
    s_and_b32 s94, s93, 1
    s_sub_u32 s5, 0, s100
    s_and_b32 s5, s5, 0x1fffff
    s_add_u32 s5, s5, 100663296
    s_lshl_b32 s4, s94, 21
    s_add_u32 s5, s5, s4
    s_lshl_b32 s4, s93, 8
    s_add_u32 s5, s5, s4
    s_add_u32 s6, s5, 8192
    v_and_b32 v4, 63, v0
    v_lshlrev_b32 v4, 2, v4
    v_mov_b32 v5, -1
    s_mov_b32 s82, 0x7fffffff
    s_mov_b32 s83, 0x7fffffff
    buffer_store_dword v5, v4, s[8:11], s5 offen sc1
    s_waitcnt vmcnt(0)

    s_memtime s[72:73]
    s_waitcnt lgkmcnt(0)
    buffer_store_dword v5, v4, s[8:11], s6 offen sc1
    s_waitcnt vmcnt(0)
    s_memtime s[84:85]
    s_waitcnt lgkmcnt(0)
    s_sub_u32 s84, s84, s72
    s_min_u32 s83, s83, s84

    s_memtime s[72:73]
    s_waitcnt lgkmcnt(0)
    buffer_store_dword v5, v4, s[8:11], s5 offen sc1
    s_waitcnt vmcnt(0)
    s_memtime s[84:85]
    s_waitcnt lgkmcnt(0)
    s_sub_u32 s84, s84, s72
    s_min_u32 s82, s82, s84

    s_memtime s[72:73]
    s_waitcnt lgkmcnt(0)
    buffer_store_dword v5, v4, s[8:11], s6 offen sc1
    s_waitcnt vmcnt(0)
    s_memtime s[84:85]
    s_waitcnt lgkmcnt(0)
    s_sub_u32 s84, s84, s72
    s_min_u32 s83, s83, s84

    s_memtime s[72:73]
    s_waitcnt lgkmcnt(0)
    buffer_store_dword v5, v4, s[8:11], s5 offen sc1
    s_waitcnt vmcnt(0)
    s_memtime s[84:85]
    s_waitcnt lgkmcnt(0)
    s_sub_u32 s84, s84, s72
    s_min_u32 s82, s82, s84

    s_memtime s[72:73]
    s_waitcnt lgkmcnt(0)
    buffer_store_dword v5, v4, s[8:11], s6 offen sc1
    s_waitcnt vmcnt(0)
    s_memtime s[84:85]
    s_waitcnt lgkmcnt(0)
    s_sub_u32 s84, s84, s72
    s_min_u32 s83, s83, s84

    s_memtime s[72:73]
    s_waitcnt lgkmcnt(0)
    buffer_store_dword v5, v4, s[8:11], s5 offen sc1
    s_waitcnt vmcnt(0)
    s_memtime s[84:85]
    s_waitcnt lgkmcnt(0)
    s_sub_u32 s84, s84, s72
    s_min_u32 s82, s82, s84

    s_memtime s[72:73]
    s_waitcnt lgkmcnt(0)
    buffer_store_dword v5, v4, s[8:11], s6 offen sc1
    s_waitcnt vmcnt(0)
    s_memtime s[84:85]
    s_waitcnt lgkmcnt(0)
    s_sub_u32 s84, s84, s72
    s_min_u32 s83, s83, s84

    s_memtime s[72:73]
    s_waitcnt lgkmcnt(0)
    buffer_store_dword v5, v4, s[8:11], s5 offen sc1
    s_waitcnt vmcnt(0)
    s_memtime s[84:85]
    s_waitcnt lgkmcnt(0)
    s_sub_u32 s84, s84, s72
    s_min_u32 s82, s82, s84

    s_cmp_lt_u32 s82, s83
    s_cselect_b32 s4, 1, 0
    s_mul_i32 s94, s94, 6
    s_lshl_b32 s4, s4, s94
    s_add_u32 s95, s4, 0x1000000

.pm_458:
    s_cmp_lg_u32 s24, 0
    s_cbranch_scc1 .pv_459
    s_mov_b64 exec, 1
    v_mov_b32 v4, s95
    v_mov_b32 v5, 4
    buffer_atomic_add v4, v5, s[20:23], s97 offen sc1
    s_mov_b64 exec, -1

.pv_459:
    s_barrier
    s_lshl_b32 s93, s91, 3
    s_add_u32 s93, s93, s26
    s_sub_u32 s93, s93, 24

    s_load_dwordx2 s[40:41], s[0:1], 0
    s_load_dwordx2 s[42:43], s[0:1], 104

    v_and_b32 v1, 63, v0
    v_and_b32 v2, 15, v1
    v_lshrrev_b32 v3, 4, v1

    s_waitcnt lgkmcnt(0)
    s_mov_b32 s12, s40
    s_and_b32 s13, s41, 0xffff
    s_mov_b32 s14, 0x400000
    s_mov_b32 s15, 0x00020000

    s_mov_b32 s16, s42
    s_and_b32 s17, s43, 0xffff
    s_mov_b32 s18, 0x800
    s_mov_b32 s19, 0x00020000

    s_lshl_b32 s3, s93, 6
    s_lshl_b32 s4, s24, 4
    s_add_u32 s3, s3, s4
    v_lshlrev_b32 v8, 4, v1
    buffer_load_dwordx4 v[16:19], v8, s[16:19], 0 offen
    buffer_load_dwordx4 v[20:23], v8, s[16:19], 0 offen offset:1024
    s_lshl_b32 s5, s3, 11

    buffer_load_dwordx4 v[64:67], v8, s[12:15], s5 offen
    buffer_load_dwordx4 v[68:71], v8, s[12:15], s5 offen offset:1024
    s_add_u32 s5, s5, 2048

    buffer_load_dwordx4 v[72:75], v8, s[12:15], s5 offen
    buffer_load_dwordx4 v[76:79], v8, s[12:15], s5 offen offset:1024
    s_add_u32 s5, s5, 2048

    buffer_load_dwordx4 v[80:83], v8, s[12:15], s5 offen
    buffer_load_dwordx4 v[84:87], v8, s[12:15], s5 offen offset:1024
    s_add_u32 s5, s5, 2048

    buffer_load_dwordx4 v[88:91], v8, s[12:15], s5 offen
    buffer_load_dwordx4 v[92:95], v8, s[12:15], s5 offen offset:1024
    s_add_u32 s5, s5, 2048

    buffer_load_dwordx4 v[96:99], v8, s[12:15], s5 offen
    buffer_load_dwordx4 v[100:103], v8, s[12:15], s5 offen offset:1024
    s_add_u32 s5, s5, 2048

    buffer_load_dwordx4 v[104:107], v8, s[12:15], s5 offen
    buffer_load_dwordx4 v[108:111], v8, s[12:15], s5 offen offset:1024
    s_add_u32 s5, s5, 2048

    buffer_load_dwordx4 v[112:115], v8, s[12:15], s5 offen
    buffer_load_dwordx4 v[116:119], v8, s[12:15], s5 offen offset:1024
    s_add_u32 s5, s5, 2048

    buffer_load_dwordx4 v[120:123], v8, s[12:15], s5 offen
    buffer_load_dwordx4 v[124:127], v8, s[12:15], s5 offen offset:1024
    s_add_u32 s5, s5, 2048

    buffer_load_dwordx4 v[128:131], v8, s[12:15], s5 offen
    buffer_load_dwordx4 v[132:135], v8, s[12:15], s5 offen offset:1024
    s_add_u32 s5, s5, 2048

    buffer_load_dwordx4 v[136:139], v8, s[12:15], s5 offen
    buffer_load_dwordx4 v[140:143], v8, s[12:15], s5 offen offset:1024
    s_add_u32 s5, s5, 2048

    buffer_load_dwordx4 v[144:147], v8, s[12:15], s5 offen
    buffer_load_dwordx4 v[148:151], v8, s[12:15], s5 offen offset:1024
    s_add_u32 s5, s5, 2048

    buffer_load_dwordx4 v[152:155], v8, s[12:15], s5 offen
    buffer_load_dwordx4 v[156:159], v8, s[12:15], s5 offen offset:1024
    s_add_u32 s5, s5, 2048

    buffer_load_dwordx4 v[160:163], v8, s[12:15], s5 offen
    buffer_load_dwordx4 v[164:167], v8, s[12:15], s5 offen offset:1024
    s_add_u32 s5, s5, 2048

    buffer_load_dwordx4 v[168:171], v8, s[12:15], s5 offen
    buffer_load_dwordx4 v[172:175], v8, s[12:15], s5 offen offset:1024
    s_add_u32 s5, s5, 2048

    buffer_load_dwordx4 v[176:179], v8, s[12:15], s5 offen
    buffer_load_dwordx4 v[180:183], v8, s[12:15], s5 offen offset:1024
    s_add_u32 s5, s5, 2048

    buffer_load_dwordx4 v[184:187], v8, s[12:15], s5 offen
    buffer_load_dwordx4 v[188:191], v8, s[12:15], s5 offen offset:1024
    s_add_u32 s5, s5, 2048

    v_and_b32 v241, 3, v0
    v_lshlrev_b32 v241, 2, v241

    v_and_b32 v240, 12, v0
    v_lshl_add_u32 v241, v240, 4, v241
    v_add_u32 v241, s97, v241
    v_and_b32 v241, 255, v241

    buffer_load_dword v240, v241, s[20:23], 0 offen sc1
    s_load_dwordx4 s[52:55], s[0:1], 8
    s_load_dwordx2 s[56:57], s[0:1], 32
    v_and_b32 v9, 63, v0
    v_lshlrev_b32 v9, 7, v9
    s_lshl_b32 s6, s93, 17
    s_lshl_b32 s7, s24, 15
    s_add_u32 s6, s6, s7
    s_waitcnt lgkmcnt(0)

    s_mov_b32 s80, s52
    s_and_b32 s81, s53, 0xffff
    s_mov_b32 s82, 0x400000
    s_mov_b32 s83, 0x00020000

    s_add_u32 s7, s6, 0
    buffer_load_dword v250, v9, s[80:83], s7 offen
    s_add_u32 s7, s6, 8192
    buffer_load_dword v250, v9, s[80:83], s7 offen
    s_add_u32 s7, s6, 16384
    buffer_load_dword v250, v9, s[80:83], s7 offen
    s_add_u32 s7, s6, 24576
    buffer_load_dword v250, v9, s[80:83], s7 offen
    s_mov_b32 s80, s54
    s_and_b32 s81, s55, 0xffff
    s_mov_b32 s82, 0x400000
    s_mov_b32 s83, 0x00020000

    s_add_u32 s7, s6, 0
    buffer_load_dword v250, v9, s[80:83], s7 offen
    s_add_u32 s7, s6, 8192
    buffer_load_dword v250, v9, s[80:83], s7 offen
    s_add_u32 s7, s6, 16384
    buffer_load_dword v250, v9, s[80:83], s7 offen
    s_add_u32 s7, s6, 24576
    buffer_load_dword v250, v9, s[80:83], s7 offen
    s_mov_b32 s80, s56
    s_and_b32 s81, s57, 0xffff
    s_mov_b32 s82, 0x400000
    s_mov_b32 s83, 0x00020000

    s_add_u32 s7, s6, 0
    buffer_load_dword v250, v9, s[80:83], s7 offen
    s_add_u32 s7, s6, 8192
    buffer_load_dword v250, v9, s[80:83], s7 offen
    s_add_u32 s7, s6, 16384
    buffer_load_dword v250, v9, s[80:83], s7 offen
    s_add_u32 s7, s6, 24576
    buffer_load_dword v250, v9, s[80:83], s7 offen
    s_waitcnt vmcnt(41)
    v_dot2_f32_bf16 v24, v64, v16, 0
    v_dot2_f32_bf16 v25, v72, v16, 0
    v_dot2_f32_bf16 v24, v65, v17, v24
    v_dot2_f32_bf16 v25, v73, v17, v25
    v_dot2_f32_bf16 v24, v66, v18, v24
    v_dot2_f32_bf16 v25, v74, v18, v25
    v_dot2_f32_bf16 v24, v67, v19, v24
    v_dot2_f32_bf16 v25, v75, v19, v25
    v_dot2_f32_bf16 v24, v68, v20, v24
    v_dot2_f32_bf16 v25, v76, v20, v25
    v_dot2_f32_bf16 v24, v69, v21, v24
    v_dot2_f32_bf16 v25, v77, v21, v25
    v_dot2_f32_bf16 v24, v70, v22, v24
    v_dot2_f32_bf16 v25, v78, v22, v25
    v_dot2_f32_bf16 v24, v71, v23, v24
    v_dot2_f32_bf16 v25, v79, v23, v25
    s_waitcnt vmcnt(37)
    v_dot2_f32_bf16 v26, v80, v16, 0
    v_dot2_f32_bf16 v27, v88, v16, 0
    v_dot2_f32_bf16 v26, v81, v17, v26
    v_dot2_f32_bf16 v27, v89, v17, v27
    v_dot2_f32_bf16 v26, v82, v18, v26
    v_dot2_f32_bf16 v27, v90, v18, v27
    v_dot2_f32_bf16 v26, v83, v19, v26
    v_dot2_f32_bf16 v27, v91, v19, v27
    v_dot2_f32_bf16 v26, v84, v20, v26
    v_dot2_f32_bf16 v27, v92, v20, v27
    v_dot2_f32_bf16 v26, v85, v21, v26
    v_dot2_f32_bf16 v27, v93, v21, v27
    v_dot2_f32_bf16 v26, v86, v22, v26
    v_dot2_f32_bf16 v27, v94, v22, v27
    v_dot2_f32_bf16 v26, v87, v23, v26
    v_dot2_f32_bf16 v27, v95, v23, v27
    s_waitcnt vmcnt(33)
    v_dot2_f32_bf16 v28, v96, v16, 0
    v_dot2_f32_bf16 v29, v104, v16, 0
    v_dot2_f32_bf16 v28, v97, v17, v28
    v_dot2_f32_bf16 v29, v105, v17, v29
    v_dot2_f32_bf16 v28, v98, v18, v28
    v_dot2_f32_bf16 v29, v106, v18, v29
    v_dot2_f32_bf16 v28, v99, v19, v28
    v_dot2_f32_bf16 v29, v107, v19, v29
    v_dot2_f32_bf16 v28, v100, v20, v28
    v_dot2_f32_bf16 v29, v108, v20, v29
    v_dot2_f32_bf16 v28, v101, v21, v28
    v_dot2_f32_bf16 v29, v109, v21, v29
    v_dot2_f32_bf16 v28, v102, v22, v28
    v_dot2_f32_bf16 v29, v110, v22, v29
    v_dot2_f32_bf16 v28, v103, v23, v28
    v_dot2_f32_bf16 v29, v111, v23, v29
    s_waitcnt vmcnt(29)
    v_dot2_f32_bf16 v30, v112, v16, 0
    v_dot2_f32_bf16 v31, v120, v16, 0
    v_dot2_f32_bf16 v30, v113, v17, v30
    v_dot2_f32_bf16 v31, v121, v17, v31
    v_dot2_f32_bf16 v30, v114, v18, v30
    v_dot2_f32_bf16 v31, v122, v18, v31
    v_dot2_f32_bf16 v30, v115, v19, v30
    v_dot2_f32_bf16 v31, v123, v19, v31
    v_dot2_f32_bf16 v30, v116, v20, v30
    v_dot2_f32_bf16 v31, v124, v20, v31
    v_dot2_f32_bf16 v30, v117, v21, v30
    v_dot2_f32_bf16 v31, v125, v21, v31
    v_dot2_f32_bf16 v30, v118, v22, v30
    v_dot2_f32_bf16 v31, v126, v22, v31
    v_dot2_f32_bf16 v30, v119, v23, v30
    v_dot2_f32_bf16 v31, v127, v23, v31
    s_waitcnt vmcnt(25)
    v_dot2_f32_bf16 v32, v128, v16, 0
    v_dot2_f32_bf16 v33, v136, v16, 0
    v_dot2_f32_bf16 v32, v129, v17, v32
    v_dot2_f32_bf16 v33, v137, v17, v33
    v_dot2_f32_bf16 v32, v130, v18, v32
    v_dot2_f32_bf16 v33, v138, v18, v33
    v_dot2_f32_bf16 v32, v131, v19, v32
    v_dot2_f32_bf16 v33, v139, v19, v33
    v_dot2_f32_bf16 v32, v132, v20, v32
    v_dot2_f32_bf16 v33, v140, v20, v33
    v_dot2_f32_bf16 v32, v133, v21, v32
    v_dot2_f32_bf16 v33, v141, v21, v33
    v_dot2_f32_bf16 v32, v134, v22, v32
    v_dot2_f32_bf16 v33, v142, v22, v33
    v_dot2_f32_bf16 v32, v135, v23, v32
    v_dot2_f32_bf16 v33, v143, v23, v33
    s_waitcnt vmcnt(21)
    v_dot2_f32_bf16 v34, v144, v16, 0
    v_dot2_f32_bf16 v35, v152, v16, 0
    v_dot2_f32_bf16 v34, v145, v17, v34
    v_dot2_f32_bf16 v35, v153, v17, v35
    v_dot2_f32_bf16 v34, v146, v18, v34
    v_dot2_f32_bf16 v35, v154, v18, v35
    v_dot2_f32_bf16 v34, v147, v19, v34
    v_dot2_f32_bf16 v35, v155, v19, v35
    v_dot2_f32_bf16 v34, v148, v20, v34
    v_dot2_f32_bf16 v35, v156, v20, v35
    v_dot2_f32_bf16 v34, v149, v21, v34
    v_dot2_f32_bf16 v35, v157, v21, v35
    v_dot2_f32_bf16 v34, v150, v22, v34
    v_dot2_f32_bf16 v35, v158, v22, v35
    v_dot2_f32_bf16 v34, v151, v23, v34
    v_dot2_f32_bf16 v35, v159, v23, v35
    s_waitcnt vmcnt(17)
    v_dot2_f32_bf16 v36, v160, v16, 0
    v_dot2_f32_bf16 v37, v168, v16, 0
    v_dot2_f32_bf16 v36, v161, v17, v36
    v_dot2_f32_bf16 v37, v169, v17, v37
    v_dot2_f32_bf16 v36, v162, v18, v36
    v_dot2_f32_bf16 v37, v170, v18, v37
    v_dot2_f32_bf16 v36, v163, v19, v36
    v_dot2_f32_bf16 v37, v171, v19, v37
    v_dot2_f32_bf16 v36, v164, v20, v36
    v_dot2_f32_bf16 v37, v172, v20, v37
    v_dot2_f32_bf16 v36, v165, v21, v36
    v_dot2_f32_bf16 v37, v173, v21, v37
    v_dot2_f32_bf16 v36, v166, v22, v36
    v_dot2_f32_bf16 v37, v174, v22, v37
    v_dot2_f32_bf16 v36, v167, v23, v36
    v_dot2_f32_bf16 v37, v175, v23, v37
    s_waitcnt vmcnt(13)
    v_dot2_f32_bf16 v38, v176, v16, 0
    v_dot2_f32_bf16 v39, v184, v16, 0
    v_dot2_f32_bf16 v38, v177, v17, v38
    v_dot2_f32_bf16 v39, v185, v17, v39
    v_dot2_f32_bf16 v38, v178, v18, v38
    v_dot2_f32_bf16 v39, v186, v18, v39
    v_dot2_f32_bf16 v38, v179, v19, v38
    v_dot2_f32_bf16 v39, v187, v19, v39
    v_dot2_f32_bf16 v38, v180, v20, v38
    v_dot2_f32_bf16 v39, v188, v20, v39
    v_dot2_f32_bf16 v38, v181, v21, v38
    v_dot2_f32_bf16 v39, v189, v21, v39
    v_dot2_f32_bf16 v38, v182, v22, v38
    v_dot2_f32_bf16 v39, v190, v22, v39
    v_dot2_f32_bf16 v38, v183, v23, v38
    v_dot2_f32_bf16 v39, v191, v23, v39
    s_waitcnt vmcnt(12)
    s_mov_b32 s62, 0
.vp_460:
    v_readlane_b32 s4, v240, 0
    v_readlane_b32 s7, v240, 1
    v_readlane_b32 s6, v240, 2

    v_readlane_b32 s5, v240, 4
    s_add_u32 s4, s4, s5
    v_readlane_b32 s5, v240, 8
    s_add_u32 s4, s4, s5
    v_readlane_b32 s5, v240, 12
    s_add_u32 s4, s4, s5
    s_cmp_ge_u32 s4, 256
    s_cbranch_scc1 .vd_461
    s_cmp_lg_u32 s6, 0
    s_cbranch_scc1 .vs_462
    s_add_u32 s62, s62, 1
    s_cmp_gt_u32 s62, 0x100000
    s_cbranch_scc1 .mg_end_1
    s_sleep 8
    buffer_load_dword v240, v241, s[20:23], 0 offen sc1
    s_waitcnt vmcnt(0)
    s_branch .vp_460

.vs_462:
    s_lshr_b32 s25, s2, 5
    s_and_b32 s26, s2, 31
    s_mov_b32 s27, 1
    s_mov_b32 s99, 1
    s_mov_b32 s97, 144
    s_waitcnt vmcnt(0) lgkmcnt(0)
    s_barrier
    s_branch .mg_role_3

.vd_461:
    v_permlane32_swap_b32 v24, v26
    v_permlane32_swap_b32 v25, v27
    v_permlane32_swap_b32 v28, v30
    v_permlane32_swap_b32 v29, v31
    v_permlane32_swap_b32 v32, v34
    v_permlane32_swap_b32 v33, v35
    v_permlane32_swap_b32 v36, v38
    v_permlane32_swap_b32 v37, v39
    v_add_f32 v24, v24, v26
    v_add_f32 v25, v25, v27
    v_add_f32 v28, v28, v30
    v_add_f32 v29, v29, v31
    v_add_f32 v32, v32, v34
    v_add_f32 v33, v33, v35
    v_add_f32 v36, v36, v38
    v_add_f32 v37, v37, v39
    s_nop 0
    v_permlane16_swap_b32 v24, v25
    v_permlane16_swap_b32 v28, v29
    v_permlane16_swap_b32 v32, v33
    v_permlane16_swap_b32 v36, v37
    v_add_f32 v24, v24, v25
    v_add_f32 v28, v28, v29
    v_add_f32 v32, v32, v33
    v_add_f32 v36, v36, v37
    v_add_f32_dpp v24, v24, v24 row_ror:8 row_mask:0xf bank_mask:0xf
    v_add_f32_dpp v28, v28, v28 row_ror:8 row_mask:0xf bank_mask:0xf
    v_add_f32_dpp v32, v32, v32 row_ror:8 row_mask:0xf bank_mask:0xf
    v_add_f32_dpp v36, v36, v36 row_ror:8 row_mask:0xf bank_mask:0xf
    v_add_f32_dpp v24, v24, v24 row_ror:4 row_mask:0xf bank_mask:0xf
    v_add_f32_dpp v28, v28, v28 row_ror:4 row_mask:0xf bank_mask:0xf
    v_add_f32_dpp v32, v32, v32 row_ror:4 row_mask:0xf bank_mask:0xf
    v_add_f32_dpp v36, v36, v36 row_ror:4 row_mask:0xf bank_mask:0xf
    v_add_f32_dpp v24, v24, v24 row_ror:2 row_mask:0xf bank_mask:0xf
    v_add_f32_dpp v28, v28, v28 row_ror:2 row_mask:0xf bank_mask:0xf
    v_add_f32_dpp v32, v32, v32 row_ror:2 row_mask:0xf bank_mask:0xf
    v_add_f32_dpp v36, v36, v36 row_ror:2 row_mask:0xf bank_mask:0xf
    v_add_f32_dpp v24, v24, v24 row_ror:1 row_mask:0xf bank_mask:0xf
    v_add_f32_dpp v28, v28, v28 row_ror:1 row_mask:0xf bank_mask:0xf
    v_add_f32_dpp v32, v32, v32 row_ror:1 row_mask:0xf bank_mask:0xf
    v_add_f32_dpp v36, v36, v36 row_ror:1 row_mask:0xf bank_mask:0xf
    v_cmp_eq_u32 vcc, 1, v2
    s_nop 1
    v_cndmask_b32 v24, v24, v28, vcc
    v_cmp_eq_u32 vcc, 2, v2
    s_nop 1
    v_cndmask_b32 v24, v24, v32, vcc
    v_cmp_eq_u32 vcc, 3, v2
    s_nop 1
    v_cndmask_b32 v24, v24, v36, vcc
    v_cvt_pk_bf16_f32 v24, v24, v24
    s_mov_b32 s38, 0xbfb8aa3b
    v_lshlrev_b32 v24, 16, v24
    v_mul_f32 v24, s38, v24
    v_exp_f32 v24, v24
    v_lshlrev_b32 v8, 4, v2
    v_add_f32 v24, 1.0, v24
    v_rcp_f32 v24, v24
    v_lshl_add_u32 v8, v3, 2, v8
    v_cvt_pk_bf16_f32 v24, v24, v24
    v_cmp_gt_u32 vcc, 4, v2
    s_lshl_b32 s5, s3, 2
    s_add_u32 s5, s5, 121634816
    v_lshlrev_b32 v24, 16, v24
    s_mov_b64 exec, vcc
    buffer_store_dword v24, v8, s[8:11], s5 offen sc1
    s_mov_b64 exec, -1

    s_load_dwordx4 s[52:55], s[0:1], 8
    s_load_dwordx2 s[56:57], s[0:1], 24

    v_and_b32 v1, 63, v0
    v_and_b32 v2, 15, v1
    v_lshrrev_b32 v3, 4, v1

    v_lshrrev_b32 v4, 2, v1
    v_and_b32 v5, 3, v1
    v_lshlrev_b32 v10, 11, v4
    v_lshl_add_u32 v10, v5, 4, v10
    s_lshl_b32 s4, s93, 6
    v_add_u32 v10, s4, v10
    s_lshl_b32 s70, s24, 20
    s_mul_i32 s71, s24, 33280
    v_lshrrev_b32 v4, 2, v2
    v_lshl_add_u32 v4, v3, 5, v4
    v_lshlrev_b32 v4, 6, v4
    v_lshl_add_u32 v11, v5, 3, v4
    v_add_u32 v11, s71, v11
    s_lshl_b32 s4, s93, 17
    s_lshl_b32 s5, s24, 8
    s_add_u32 s72, s4, s5
    s_add_u32 s72, s72, 125829120
    v_lshlrev_b32 v12, 12, v2
    v_lshl_add_u32 v12, v3, 4, v12
    v_lshlrev_b32 v13, 3, v2
    s_lshl_b32 s6, s93, 8
    s_waitcnt lgkmcnt(0)

    s_mov_b32 s80, s52
    s_and_b32 s81, s53, 0xffff
    s_mov_b32 s82, 0x400000
    s_mov_b32 s83, 0x00020000

    s_mov_b32 s84, s54
    s_and_b32 s85, s55, 0xffff
    s_mov_b32 s86, 0x400000
    s_mov_b32 s87, 0x00020000

    s_mov_b32 s76, s56
    s_and_b32 s77, s57, 0xffff
    s_mov_b32 s78, 0x2000
    s_mov_b32 s79, 0x00020000

    buffer_load_dwordx2 v[196:197], v13, s[76:79], s6 offen
    buffer_load_dwordx2 v[198:199], v13, s[76:79], s6 offen offset:128

    s_add_u32 s4, s70, 0
    s_add_u32 m0, s71, 0
    s_sub_u32 s5, s4, 8192
    s_max_i32 s5, s5, 0
    s_mov_b64 exec, 0xffff
    buffer_load_dwordx4 v10, s[80:83], s5 offen lds
    s_mov_b64 exec, -1

    s_add_u32 m0, s71, 256
    s_nop 0
    buffer_load_dwordx4 v10, s[80:83], s4 offen lds
    s_add_u32 m0, s71, 8448
    s_nop 0
    buffer_load_dwordx4 v10, s[84:87], s4 offen lds
    s_add_u32 m0, s71, 1280
    s_add_u32 s4, s4, 32768
    buffer_load_dwordx4 v10, s[80:83], s4 offen lds
    s_add_u32 m0, s71, 9472
    s_nop 0
    buffer_load_dwordx4 v10, s[84:87], s4 offen lds
    s_add_u32 m0, s71, 2304
    s_add_u32 s4, s4, 32768
    buffer_load_dwordx4 v10, s[80:83], s4 offen lds
    s_add_u32 m0, s71, 10496
    s_nop 0
    buffer_load_dwordx4 v10, s[84:87], s4 offen lds
    s_add_u32 m0, s71, 3328
    s_add_u32 s4, s4, 32768
    buffer_load_dwordx4 v10, s[80:83], s4 offen lds
    s_add_u32 m0, s71, 11520
    s_nop 0
    buffer_load_dwordx4 v10, s[84:87], s4 offen lds
    s_add_u32 m0, s71, 4352
    s_add_u32 s4, s4, 32768
    buffer_load_dwordx4 v10, s[80:83], s4 offen lds
    s_add_u32 m0, s71, 12544
    s_nop 0
    buffer_load_dwordx4 v10, s[84:87], s4 offen lds
    s_add_u32 m0, s71, 5376
    s_add_u32 s4, s4, 32768
    buffer_load_dwordx4 v10, s[80:83], s4 offen lds
    s_add_u32 m0, s71, 13568
    s_nop 0
    buffer_load_dwordx4 v10, s[84:87], s4 offen lds
    s_add_u32 m0, s71, 6400
    s_add_u32 s4, s4, 32768
    buffer_load_dwordx4 v10, s[80:83], s4 offen lds
    s_add_u32 m0, s71, 14592
    s_nop 0
    buffer_load_dwordx4 v10, s[84:87], s4 offen lds
    s_add_u32 m0, s71, 7424
    s_add_u32 s4, s4, 32768
    buffer_load_dwordx4 v10, s[80:83], s4 offen lds
    s_add_u32 m0, s71, 15616
    s_nop 0
    buffer_load_dwordx4 v10, s[84:87], s4 offen lds
    s_add_u32 s4, s70, 262144
    s_add_u32 m0, s71, 16640
    s_sub_u32 s5, s4, 8192
    s_max_i32 s5, s5, 0
    s_mov_b64 exec, 0xffff
    buffer_load_dwordx4 v10, s[80:83], s5 offen lds
    s_mov_b64 exec, -1

    s_add_u32 m0, s71, 16896
    s_nop 0
    buffer_load_dwordx4 v10, s[80:83], s4 offen lds
    s_add_u32 m0, s71, 25088
    s_nop 0
    buffer_load_dwordx4 v10, s[84:87], s4 offen lds
    s_add_u32 m0, s71, 17920
    s_add_u32 s4, s4, 32768
    buffer_load_dwordx4 v10, s[80:83], s4 offen lds
    s_add_u32 m0, s71, 26112
    s_nop 0
    buffer_load_dwordx4 v10, s[84:87], s4 offen lds
    s_add_u32 m0, s71, 18944
    s_add_u32 s4, s4, 32768
    buffer_load_dwordx4 v10, s[80:83], s4 offen lds
    s_add_u32 m0, s71, 27136
    s_nop 0
    buffer_load_dwordx4 v10, s[84:87], s4 offen lds
    s_add_u32 m0, s71, 19968
    s_add_u32 s4, s4, 32768
    buffer_load_dwordx4 v10, s[80:83], s4 offen lds
    s_add_u32 m0, s71, 28160
    s_nop 0
    buffer_load_dwordx4 v10, s[84:87], s4 offen lds
    s_add_u32 m0, s71, 20992
    s_add_u32 s4, s4, 32768
    buffer_load_dwordx4 v10, s[80:83], s4 offen lds
    s_add_u32 m0, s71, 29184
    s_nop 0
    buffer_load_dwordx4 v10, s[84:87], s4 offen lds
    s_add_u32 m0, s71, 22016
    s_add_u32 s4, s4, 32768
    buffer_load_dwordx4 v10, s[80:83], s4 offen lds
    s_add_u32 m0, s71, 30208
    s_nop 0
    buffer_load_dwordx4 v10, s[84:87], s4 offen lds
    s_add_u32 m0, s71, 23040
    s_add_u32 s4, s4, 32768
    buffer_load_dwordx4 v10, s[80:83], s4 offen lds
    s_add_u32 m0, s71, 31232
    s_nop 0
    buffer_load_dwordx4 v10, s[84:87], s4 offen lds
    s_add_u32 m0, s71, 24064
    s_add_u32 s4, s4, 32768
    buffer_load_dwordx4 v10, s[80:83], s4 offen lds
    s_add_u32 m0, s71, 32256
    s_nop 0
    buffer_load_dwordx4 v10, s[84:87], s4 offen lds
    s_waitcnt vmcnt(17)
    v_alignbit_b32 v196, v196, v196, 16
    v_alignbit_b32 v197, v197, v197, 16
    v_alignbit_b32 v198, v198, v198, 16
    v_alignbit_b32 v199, v199, v199, 16
    ds_read_b64_tr_b16 v[16:17], v11 offset:0
    ds_read_b64_tr_b16 v[18:19], v11 offset:256
    ds_read_b64_tr_b16 v[20:21], v11 offset:512
    ds_read_b64_tr_b16 v[22:23], v11 offset:768
    ds_read_b64_tr_b16 v[24:25], v11 offset:1024
    ds_read_b64_tr_b16 v[26:27], v11 offset:1280
    ds_read_b64_tr_b16 v[28:29], v11 offset:1536
    ds_read_b64_tr_b16 v[30:31], v11 offset:1792
    ds_read_b64_tr_b16 v[32:33], v11 offset:2048
    ds_read_b64_tr_b16 v[34:35], v11 offset:8448
    ds_read_b64_tr_b16 v[36:37], v11 offset:8704
    ds_read_b64_tr_b16 v[38:39], v11 offset:8960
    ds_read_b64_tr_b16 v[40:41], v11 offset:9216
    ds_read_b64_tr_b16 v[42:43], v11 offset:9472
    ds_read_b64_tr_b16 v[44:45], v11 offset:9728
    ds_read_b64_tr_b16 v[46:47], v11 offset:9984
    ds_read_b64_tr_b16 v[48:49], v11 offset:10240
    ds_read_b64_tr_b16 v[50:51], v11 offset:32
    ds_read_b64_tr_b16 v[52:53], v11 offset:288
    ds_read_b64_tr_b16 v[54:55], v11 offset:544
    ds_read_b64_tr_b16 v[56:57], v11 offset:800
    ds_read_b64_tr_b16 v[58:59], v11 offset:1056
    ds_read_b64_tr_b16 v[60:61], v11 offset:1312
    ds_read_b64_tr_b16 v[62:63], v11 offset:1568
    ds_read_b64_tr_b16 v[64:65], v11 offset:1824
    ds_read_b64_tr_b16 v[66:67], v11 offset:2080
    ds_read_b64_tr_b16 v[68:69], v11 offset:8480
    ds_read_b64_tr_b16 v[70:71], v11 offset:8736
    ds_read_b64_tr_b16 v[72:73], v11 offset:8992
    ds_read_b64_tr_b16 v[74:75], v11 offset:9248
    ds_read_b64_tr_b16 v[76:77], v11 offset:9504
    ds_read_b64_tr_b16 v[78:79], v11 offset:9760
    ds_read_b64_tr_b16 v[80:81], v11 offset:10016
    ds_read_b64_tr_b16 v[82:83], v11 offset:10272
    s_waitcnt lgkmcnt(0)
    s_cmp_eq_u32 s24, 0
    s_cselect_b32 exec_lo, 0xffff, 0
    s_mov_b32 exec_hi, 0
    v_mov_b32 v16, 0
    v_mov_b32 v17, 0
    v_mov_b32 v50, 0
    v_mov_b32 v51, 0
    s_mov_b64 exec, -1
    s_add_u32 s4, s70, 524288
    s_add_u32 m0, s71, 0
    s_sub_u32 s5, s4, 8192
    s_max_i32 s5, s5, 0
    s_mov_b64 exec, 0xffff
    buffer_load_dwordx4 v10, s[80:83], s5 offen lds
    s_mov_b64 exec, -1

    s_add_u32 m0, s71, 256
    s_nop 0
    buffer_load_dwordx4 v10, s[80:83], s4 offen lds
    s_add_u32 m0, s71, 8448
    s_nop 0
    buffer_load_dwordx4 v10, s[84:87], s4 offen lds
    s_add_u32 m0, s71, 1280
    s_add_u32 s4, s4, 32768
    buffer_load_dwordx4 v10, s[80:83], s4 offen lds
    s_add_u32 m0, s71, 9472
    s_nop 0
    buffer_load_dwordx4 v10, s[84:87], s4 offen lds
    s_add_u32 m0, s71, 2304
    s_add_u32 s4, s4, 32768
    buffer_load_dwordx4 v10, s[80:83], s4 offen lds
    s_add_u32 m0, s71, 10496
    s_nop 0
    buffer_load_dwordx4 v10, s[84:87], s4 offen lds
    s_add_u32 m0, s71, 3328
    s_add_u32 s4, s4, 32768
    buffer_load_dwordx4 v10, s[80:83], s4 offen lds
    s_add_u32 m0, s71, 11520
    s_nop 0
    buffer_load_dwordx4 v10, s[84:87], s4 offen lds
    s_add_u32 m0, s71, 4352
    s_add_u32 s4, s4, 32768
    buffer_load_dwordx4 v10, s[80:83], s4 offen lds
    s_add_u32 m0, s71, 12544
    s_nop 0
    buffer_load_dwordx4 v10, s[84:87], s4 offen lds
    s_add_u32 m0, s71, 5376
    s_add_u32 s4, s4, 32768
    buffer_load_dwordx4 v10, s[80:83], s4 offen lds
    s_add_u32 m0, s71, 13568
    s_nop 0
    buffer_load_dwordx4 v10, s[84:87], s4 offen lds
    s_add_u32 m0, s71, 6400
    s_add_u32 s4, s4, 32768
    buffer_load_dwordx4 v10, s[80:83], s4 offen lds
    s_add_u32 m0, s71, 14592
    s_nop 0
    buffer_load_dwordx4 v10, s[84:87], s4 offen lds
    s_add_u32 m0, s71, 7424
    s_add_u32 s4, s4, 32768
    buffer_load_dwordx4 v10, s[80:83], s4 offen lds
    s_add_u32 m0, s71, 15616
    s_nop 0
    buffer_load_dwordx4 v10, s[84:87], s4 offen lds
    v_alignbit_b32 v84, v17, v16, 16
    v_alignbit_b32 v85, v18, v17, 16
    v_alignbit_b32 v86, v19, v18, 16
    v_alignbit_b32 v87, v20, v19, 16
    v_alignbit_b32 v88, v21, v20, 16
    v_alignbit_b32 v89, v22, v21, 16
    v_alignbit_b32 v90, v23, v22, 16
    v_alignbit_b32 v91, v24, v23, 16
    v_alignbit_b32 v92, v25, v24, 16
    v_alignbit_b32 v93, v26, v25, 16
    v_alignbit_b32 v94, v27, v26, 16
    v_alignbit_b32 v95, v28, v27, 16
    v_alignbit_b32 v96, v29, v28, 16
    v_alignbit_b32 v97, v30, v29, 16
    v_alignbit_b32 v98, v31, v30, 16
    v_alignbit_b32 v99, v32, v31, 16
    v_alignbit_b32 v100, v33, v32, 16
    v_dot2_f32_bf16 v102, v84, v197, 0
    v_dot2_f32_bf16 v103, v17, v197, 0
    v_dot2_f32_bf16 v106, v85, v197, 0
    v_dot2_f32_bf16 v107, v18, v197, 0
    v_dot2_f32_bf16 v110, v86, v197, 0
    v_dot2_f32_bf16 v111, v19, v197, 0
    v_dot2_f32_bf16 v114, v87, v197, 0
    v_dot2_f32_bf16 v115, v20, v197, 0
    v_dot2_f32_bf16 v102, v85, v196, v102
    v_dot2_f32_bf16 v103, v18, v196, v103
    v_dot2_f32_bf16 v106, v86, v196, v106
    v_dot2_f32_bf16 v107, v19, v196, v107
    v_dot2_f32_bf16 v110, v87, v196, v110
    v_dot2_f32_bf16 v111, v20, v196, v111
    v_dot2_f32_bf16 v114, v88, v196, v114
    v_dot2_f32_bf16 v115, v21, v196, v115
    v_lshlrev_b32 v104, 16, v34
    v_and_b32 v105, 0xffff0000, v34
    v_lshlrev_b32 v108, 16, v35
    v_and_b32 v109, 0xffff0000, v35
    v_lshlrev_b32 v112, 16, v36
    v_and_b32 v113, 0xffff0000, v36
    v_lshlrev_b32 v116, 16, v37
    v_and_b32 v117, 0xffff0000, v37
    v_mul_f32 v102, v102, v104
    v_mul_f32 v103, v103, v105
    v_mul_f32 v106, v106, v108
    v_mul_f32 v107, v107, v109
    v_mul_f32 v110, v110, v112
    v_mul_f32 v111, v111, v113
    v_mul_f32 v114, v114, v116
    v_mul_f32 v115, v115, v117
    v_cvt_pk_bf16_f32 v137, v103, v102
    v_cvt_pk_bf16_f32 v136, v107, v106
    v_cvt_pk_bf16_f32 v135, v111, v110
    v_cvt_pk_bf16_f32 v134, v115, v114
    s_add_u32 s4, s72, 0
    buffer_store_dwordx4 v[134:137], v12, s[8:11], s4 offen offset:0
    v_dot2_f32_bf16 v118, v88, v197, 0
    v_dot2_f32_bf16 v119, v21, v197, 0
    v_dot2_f32_bf16 v122, v89, v197, 0
    v_dot2_f32_bf16 v123, v22, v197, 0
    v_dot2_f32_bf16 v126, v90, v197, 0
    v_dot2_f32_bf16 v127, v23, v197, 0
    v_dot2_f32_bf16 v130, v91, v197, 0
    v_dot2_f32_bf16 v131, v24, v197, 0
    v_dot2_f32_bf16 v118, v89, v196, v118
    v_dot2_f32_bf16 v119, v22, v196, v119
    v_dot2_f32_bf16 v122, v90, v196, v122
    v_dot2_f32_bf16 v123, v23, v196, v123
    v_dot2_f32_bf16 v126, v91, v196, v126
    v_dot2_f32_bf16 v127, v24, v196, v127
    v_dot2_f32_bf16 v130, v92, v196, v130
    v_dot2_f32_bf16 v131, v25, v196, v131
    v_lshlrev_b32 v120, 16, v38
    v_and_b32 v121, 0xffff0000, v38
    v_lshlrev_b32 v124, 16, v39
    v_and_b32 v125, 0xffff0000, v39
    v_lshlrev_b32 v128, 16, v40
    v_and_b32 v129, 0xffff0000, v40
    v_lshlrev_b32 v132, 16, v41
    v_and_b32 v133, 0xffff0000, v41
    v_mul_f32 v118, v118, v120
    v_mul_f32 v119, v119, v121
    v_mul_f32 v122, v122, v124
    v_mul_f32 v123, v123, v125
    v_mul_f32 v126, v126, v128
    v_mul_f32 v127, v127, v129
    v_mul_f32 v130, v130, v132
    v_mul_f32 v131, v131, v133
    v_cvt_pk_bf16_f32 v141, v119, v118
    v_cvt_pk_bf16_f32 v140, v123, v122
    v_cvt_pk_bf16_f32 v139, v127, v126
    v_cvt_pk_bf16_f32 v138, v131, v130
    buffer_store_dwordx4 v[138:141], v12, s[8:11], s4 offen offset:1024
    v_dot2_f32_bf16 v102, v92, v197, 0
    v_dot2_f32_bf16 v103, v25, v197, 0
    v_dot2_f32_bf16 v106, v93, v197, 0
    v_dot2_f32_bf16 v107, v26, v197, 0
    v_dot2_f32_bf16 v110, v94, v197, 0
    v_dot2_f32_bf16 v111, v27, v197, 0
    v_dot2_f32_bf16 v114, v95, v197, 0
    v_dot2_f32_bf16 v115, v28, v197, 0
    v_dot2_f32_bf16 v102, v93, v196, v102
    v_dot2_f32_bf16 v103, v26, v196, v103
    v_dot2_f32_bf16 v106, v94, v196, v106
    v_dot2_f32_bf16 v107, v27, v196, v107
    v_dot2_f32_bf16 v110, v95, v196, v110
    v_dot2_f32_bf16 v111, v28, v196, v111
    v_dot2_f32_bf16 v114, v96, v196, v114
    v_dot2_f32_bf16 v115, v29, v196, v115
    v_lshlrev_b32 v104, 16, v42
    v_and_b32 v105, 0xffff0000, v42
    v_lshlrev_b32 v108, 16, v43
    v_and_b32 v109, 0xffff0000, v43
    v_lshlrev_b32 v112, 16, v44
    v_and_b32 v113, 0xffff0000, v44
    v_lshlrev_b32 v116, 16, v45
    v_and_b32 v117, 0xffff0000, v45
    v_mul_f32 v102, v102, v104
    v_mul_f32 v103, v103, v105
    v_mul_f32 v106, v106, v108
    v_mul_f32 v107, v107, v109
    v_mul_f32 v110, v110, v112
    v_mul_f32 v111, v111, v113
    v_mul_f32 v114, v114, v116
    v_mul_f32 v115, v115, v117
    v_cvt_pk_bf16_f32 v145, v103, v102
    v_cvt_pk_bf16_f32 v144, v107, v106
    v_cvt_pk_bf16_f32 v143, v111, v110
    v_cvt_pk_bf16_f32 v142, v115, v114
    buffer_store_dwordx4 v[142:145], v12, s[8:11], s4 offen offset:2048
    v_dot2_f32_bf16 v118, v96, v197, 0
    v_dot2_f32_bf16 v119, v29, v197, 0
    v_dot2_f32_bf16 v122, v97, v197, 0
    v_dot2_f32_bf16 v123, v30, v197, 0
    v_dot2_f32_bf16 v126, v98, v197, 0
    v_dot2_f32_bf16 v127, v31, v197, 0
    v_dot2_f32_bf16 v130, v99, v197, 0
    v_dot2_f32_bf16 v131, v32, v197, 0
    v_dot2_f32_bf16 v118, v97, v196, v118
    v_dot2_f32_bf16 v119, v30, v196, v119
    v_dot2_f32_bf16 v122, v98, v196, v122
    v_dot2_f32_bf16 v123, v31, v196, v123
    v_dot2_f32_bf16 v126, v99, v196, v126
    v_dot2_f32_bf16 v127, v32, v196, v127
    v_dot2_f32_bf16 v130, v100, v196, v130
    v_dot2_f32_bf16 v131, v33, v196, v131
    v_lshlrev_b32 v120, 16, v46
    v_and_b32 v121, 0xffff0000, v46
    v_lshlrev_b32 v124, 16, v47
    v_and_b32 v125, 0xffff0000, v47
    v_lshlrev_b32 v128, 16, v48
    v_and_b32 v129, 0xffff0000, v48
    v_lshlrev_b32 v132, 16, v49
    v_and_b32 v133, 0xffff0000, v49
    v_mul_f32 v118, v118, v120
    v_mul_f32 v119, v119, v121
    v_mul_f32 v122, v122, v124
    v_mul_f32 v123, v123, v125
    v_mul_f32 v126, v126, v128
    v_mul_f32 v127, v127, v129
    v_mul_f32 v130, v130, v132
    v_mul_f32 v131, v131, v133
    v_cvt_pk_bf16_f32 v149, v119, v118
    v_cvt_pk_bf16_f32 v148, v123, v122
    v_cvt_pk_bf16_f32 v147, v127, v126
    v_cvt_pk_bf16_f32 v146, v131, v130
    buffer_store_dwordx4 v[146:149], v12, s[8:11], s4 offen offset:3072
    v_alignbit_b32 v84, v51, v50, 16
    v_alignbit_b32 v85, v52, v51, 16
    v_alignbit_b32 v86, v53, v52, 16
    v_alignbit_b32 v87, v54, v53, 16
    v_alignbit_b32 v88, v55, v54, 16
    v_alignbit_b32 v89, v56, v55, 16
    v_alignbit_b32 v90, v57, v56, 16
    v_alignbit_b32 v91, v58, v57, 16
    v_alignbit_b32 v92, v59, v58, 16
    v_alignbit_b32 v93, v60, v59, 16
    v_alignbit_b32 v94, v61, v60, 16
    v_alignbit_b32 v95, v62, v61, 16
    v_alignbit_b32 v96, v63, v62, 16
    v_alignbit_b32 v97, v64, v63, 16
    v_alignbit_b32 v98, v65, v64, 16
    v_alignbit_b32 v99, v66, v65, 16
    v_alignbit_b32 v100, v67, v66, 16
    v_dot2_f32_bf16 v102, v84, v199, 0
    v_dot2_f32_bf16 v103, v51, v199, 0
    v_dot2_f32_bf16 v106, v85, v199, 0
    v_dot2_f32_bf16 v107, v52, v199, 0
    v_dot2_f32_bf16 v110, v86, v199, 0
    v_dot2_f32_bf16 v111, v53, v199, 0
    v_dot2_f32_bf16 v114, v87, v199, 0
    v_dot2_f32_bf16 v115, v54, v199, 0
    v_dot2_f32_bf16 v102, v85, v198, v102
    v_dot2_f32_bf16 v103, v52, v198, v103
    v_dot2_f32_bf16 v106, v86, v198, v106
    v_dot2_f32_bf16 v107, v53, v198, v107
    v_dot2_f32_bf16 v110, v87, v198, v110
    v_dot2_f32_bf16 v111, v54, v198, v111
    v_dot2_f32_bf16 v114, v88, v198, v114
    v_dot2_f32_bf16 v115, v55, v198, v115
    v_lshlrev_b32 v104, 16, v68
    v_and_b32 v105, 0xffff0000, v68
    v_lshlrev_b32 v108, 16, v69
    v_and_b32 v109, 0xffff0000, v69
    v_lshlrev_b32 v112, 16, v70
    v_and_b32 v113, 0xffff0000, v70
    v_lshlrev_b32 v116, 16, v71
    v_and_b32 v117, 0xffff0000, v71
    v_mul_f32 v102, v102, v104
    v_mul_f32 v103, v103, v105
    v_mul_f32 v106, v106, v108
    v_mul_f32 v107, v107, v109
    v_mul_f32 v110, v110, v112
    v_mul_f32 v111, v111, v113
    v_mul_f32 v114, v114, v116
    v_mul_f32 v115, v115, v117
    v_cvt_pk_bf16_f32 v153, v103, v102
    v_cvt_pk_bf16_f32 v152, v107, v106
    v_cvt_pk_bf16_f32 v151, v111, v110
    v_cvt_pk_bf16_f32 v150, v115, v114
    s_add_u32 s4, s72, 65536
    buffer_store_dwordx4 v[150:153], v12, s[8:11], s4 offen offset:0
    v_dot2_f32_bf16 v118, v88, v199, 0
    v_dot2_f32_bf16 v119, v55, v199, 0
    v_dot2_f32_bf16 v122, v89, v199, 0
    v_dot2_f32_bf16 v123, v56, v199, 0
    v_dot2_f32_bf16 v126, v90, v199, 0
    v_dot2_f32_bf16 v127, v57, v199, 0
    v_dot2_f32_bf16 v130, v91, v199, 0
    v_dot2_f32_bf16 v131, v58, v199, 0
    v_dot2_f32_bf16 v118, v89, v198, v118
    v_dot2_f32_bf16 v119, v56, v198, v119
    v_dot2_f32_bf16 v122, v90, v198, v122
    v_dot2_f32_bf16 v123, v57, v198, v123
    v_dot2_f32_bf16 v126, v91, v198, v126
    v_dot2_f32_bf16 v127, v58, v198, v127
    v_dot2_f32_bf16 v130, v92, v198, v130
    v_dot2_f32_bf16 v131, v59, v198, v131
    v_lshlrev_b32 v120, 16, v72
    v_and_b32 v121, 0xffff0000, v72
    v_lshlrev_b32 v124, 16, v73
    v_and_b32 v125, 0xffff0000, v73
    v_lshlrev_b32 v128, 16, v74
    v_and_b32 v129, 0xffff0000, v74
    v_lshlrev_b32 v132, 16, v75
    v_and_b32 v133, 0xffff0000, v75
    v_mul_f32 v118, v118, v120
    v_mul_f32 v119, v119, v121
    v_mul_f32 v122, v122, v124
    v_mul_f32 v123, v123, v125
    v_mul_f32 v126, v126, v128
    v_mul_f32 v127, v127, v129
    v_mul_f32 v130, v130, v132
    v_mul_f32 v131, v131, v133
    v_cvt_pk_bf16_f32 v157, v119, v118
    v_cvt_pk_bf16_f32 v156, v123, v122
    v_cvt_pk_bf16_f32 v155, v127, v126
    v_cvt_pk_bf16_f32 v154, v131, v130
    buffer_store_dwordx4 v[154:157], v12, s[8:11], s4 offen offset:1024
    v_dot2_f32_bf16 v102, v92, v199, 0
    v_dot2_f32_bf16 v103, v59, v199, 0
    v_dot2_f32_bf16 v106, v93, v199, 0
    v_dot2_f32_bf16 v107, v60, v199, 0
    v_dot2_f32_bf16 v110, v94, v199, 0
    v_dot2_f32_bf16 v111, v61, v199, 0
    v_dot2_f32_bf16 v114, v95, v199, 0
    v_dot2_f32_bf16 v115, v62, v199, 0
    v_dot2_f32_bf16 v102, v93, v198, v102
    v_dot2_f32_bf16 v103, v60, v198, v103
    v_dot2_f32_bf16 v106, v94, v198, v106
    v_dot2_f32_bf16 v107, v61, v198, v107
    v_dot2_f32_bf16 v110, v95, v198, v110
    v_dot2_f32_bf16 v111, v62, v198, v111
    v_dot2_f32_bf16 v114, v96, v198, v114
    v_dot2_f32_bf16 v115, v63, v198, v115
    v_lshlrev_b32 v104, 16, v76
    v_and_b32 v105, 0xffff0000, v76
    v_lshlrev_b32 v108, 16, v77
    v_and_b32 v109, 0xffff0000, v77
    v_lshlrev_b32 v112, 16, v78
    v_and_b32 v113, 0xffff0000, v78
    v_lshlrev_b32 v116, 16, v79
    v_and_b32 v117, 0xffff0000, v79
    v_mul_f32 v102, v102, v104
    v_mul_f32 v103, v103, v105
    v_mul_f32 v106, v106, v108
    v_mul_f32 v107, v107, v109
    v_mul_f32 v110, v110, v112
    v_mul_f32 v111, v111, v113
    v_mul_f32 v114, v114, v116
    v_mul_f32 v115, v115, v117
    v_cvt_pk_bf16_f32 v161, v103, v102
    v_cvt_pk_bf16_f32 v160, v107, v106
    v_cvt_pk_bf16_f32 v159, v111, v110
    v_cvt_pk_bf16_f32 v158, v115, v114
    buffer_store_dwordx4 v[158:161], v12, s[8:11], s4 offen offset:2048
    v_dot2_f32_bf16 v118, v96, v199, 0
    v_dot2_f32_bf16 v119, v63, v199, 0
    v_dot2_f32_bf16 v122, v97, v199, 0
    v_dot2_f32_bf16 v123, v64, v199, 0
    v_dot2_f32_bf16 v126, v98, v199, 0
    v_dot2_f32_bf16 v127, v65, v199, 0
    v_dot2_f32_bf16 v130, v99, v199, 0
    v_dot2_f32_bf16 v131, v66, v199, 0
    v_dot2_f32_bf16 v118, v97, v198, v118
    v_dot2_f32_bf16 v119, v64, v198, v119
    v_dot2_f32_bf16 v122, v98, v198, v122
    v_dot2_f32_bf16 v123, v65, v198, v123
    v_dot2_f32_bf16 v126, v99, v198, v126
    v_dot2_f32_bf16 v127, v66, v198, v127
    v_dot2_f32_bf16 v130, v100, v198, v130
    v_dot2_f32_bf16 v131, v67, v198, v131
    v_lshlrev_b32 v120, 16, v80
    v_and_b32 v121, 0xffff0000, v80
    v_lshlrev_b32 v124, 16, v81
    v_and_b32 v125, 0xffff0000, v81
    v_lshlrev_b32 v128, 16, v82
    v_and_b32 v129, 0xffff0000, v82
    v_lshlrev_b32 v132, 16, v83
    v_and_b32 v133, 0xffff0000, v83
    v_mul_f32 v118, v118, v120
    v_mul_f32 v119, v119, v121
    v_mul_f32 v122, v122, v124
    v_mul_f32 v123, v123, v125
    v_mul_f32 v126, v126, v128
    v_mul_f32 v127, v127, v129
    v_mul_f32 v130, v130, v132
    v_mul_f32 v131, v131, v133
    v_cvt_pk_bf16_f32 v165, v119, v118
    v_cvt_pk_bf16_f32 v164, v123, v122
    v_cvt_pk_bf16_f32 v163, v127, v126
    v_cvt_pk_bf16_f32 v162, v131, v130
    buffer_store_dwordx4 v[162:165], v12, s[8:11], s4 offen offset:3072
    s_waitcnt vmcnt(25)
    ds_read_b64_tr_b16 v[16:17], v11 offset:16640
    ds_read_b64_tr_b16 v[18:19], v11 offset:16896
    ds_read_b64_tr_b16 v[20:21], v11 offset:17152
    ds_read_b64_tr_b16 v[22:23], v11 offset:17408
    ds_read_b64_tr_b16 v[24:25], v11 offset:17664
    ds_read_b64_tr_b16 v[26:27], v11 offset:17920
    ds_read_b64_tr_b16 v[28:29], v11 offset:18176
    ds_read_b64_tr_b16 v[30:31], v11 offset:18432
    ds_read_b64_tr_b16 v[32:33], v11 offset:18688
    ds_read_b64_tr_b16 v[34:35], v11 offset:25088
    ds_read_b64_tr_b16 v[36:37], v11 offset:25344
    ds_read_b64_tr_b16 v[38:39], v11 offset:25600
    ds_read_b64_tr_b16 v[40:41], v11 offset:25856
    ds_read_b64_tr_b16 v[42:43], v11 offset:26112
    ds_read_b64_tr_b16 v[44:45], v11 offset:26368
    ds_read_b64_tr_b16 v[46:47], v11 offset:26624
    ds_read_b64_tr_b16 v[48:49], v11 offset:26880
    ds_read_b64_tr_b16 v[50:51], v11 offset:16672
    ds_read_b64_tr_b16 v[52:53], v11 offset:16928
    ds_read_b64_tr_b16 v[54:55], v11 offset:17184
    ds_read_b64_tr_b16 v[56:57], v11 offset:17440
    ds_read_b64_tr_b16 v[58:59], v11 offset:17696
    ds_read_b64_tr_b16 v[60:61], v11 offset:17952
    ds_read_b64_tr_b16 v[62:63], v11 offset:18208
    ds_read_b64_tr_b16 v[64:65], v11 offset:18464
    ds_read_b64_tr_b16 v[66:67], v11 offset:18720
    ds_read_b64_tr_b16 v[68:69], v11 offset:25120
    ds_read_b64_tr_b16 v[70:71], v11 offset:25376
    ds_read_b64_tr_b16 v[72:73], v11 offset:25632
    ds_read_b64_tr_b16 v[74:75], v11 offset:25888
    ds_read_b64_tr_b16 v[76:77], v11 offset:26144
    ds_read_b64_tr_b16 v[78:79], v11 offset:26400
    ds_read_b64_tr_b16 v[80:81], v11 offset:26656
    ds_read_b64_tr_b16 v[82:83], v11 offset:26912
    s_waitcnt lgkmcnt(0)
    s_add_u32 s4, s70, 786432
    s_add_u32 m0, s71, 16640
    s_sub_u32 s5, s4, 8192
    s_max_i32 s5, s5, 0
    s_mov_b64 exec, 0xffff
    buffer_load_dwordx4 v10, s[80:83], s5 offen lds
    s_mov_b64 exec, -1

    s_add_u32 m0, s71, 16896
    s_nop 0
    buffer_load_dwordx4 v10, s[80:83], s4 offen lds
    s_add_u32 m0, s71, 25088
    s_nop 0
    buffer_load_dwordx4 v10, s[84:87], s4 offen lds
    s_add_u32 m0, s71, 17920
    s_add_u32 s4, s4, 32768
    buffer_load_dwordx4 v10, s[80:83], s4 offen lds
    s_add_u32 m0, s71, 26112
    s_nop 0
    buffer_load_dwordx4 v10, s[84:87], s4 offen lds
    s_add_u32 m0, s71, 18944
    s_add_u32 s4, s4, 32768
    buffer_load_dwordx4 v10, s[80:83], s4 offen lds
    s_add_u32 m0, s71, 27136
    s_nop 0
    buffer_load_dwordx4 v10, s[84:87], s4 offen lds
    s_add_u32 m0, s71, 19968
    s_add_u32 s4, s4, 32768
    buffer_load_dwordx4 v10, s[80:83], s4 offen lds
    s_add_u32 m0, s71, 28160
    s_nop 0
    buffer_load_dwordx4 v10, s[84:87], s4 offen lds
    s_add_u32 m0, s71, 20992
    s_add_u32 s4, s4, 32768
    buffer_load_dwordx4 v10, s[80:83], s4 offen lds
    s_add_u32 m0, s71, 29184
    s_nop 0
    buffer_load_dwordx4 v10, s[84:87], s4 offen lds
    s_add_u32 m0, s71, 22016
    s_add_u32 s4, s4, 32768
    buffer_load_dwordx4 v10, s[80:83], s4 offen lds
    s_add_u32 m0, s71, 30208
    s_nop 0
    buffer_load_dwordx4 v10, s[84:87], s4 offen lds
    s_add_u32 m0, s71, 23040
    s_add_u32 s4, s4, 32768
    buffer_load_dwordx4 v10, s[80:83], s4 offen lds
    s_add_u32 m0, s71, 31232
    s_nop 0
    buffer_load_dwordx4 v10, s[84:87], s4 offen lds
    s_add_u32 m0, s71, 24064
    s_add_u32 s4, s4, 32768
    buffer_load_dwordx4 v10, s[80:83], s4 offen lds
    s_add_u32 m0, s71, 32256
    s_nop 0
    buffer_load_dwordx4 v10, s[84:87], s4 offen lds
    v_alignbit_b32 v84, v17, v16, 16
    v_alignbit_b32 v85, v18, v17, 16
    v_alignbit_b32 v86, v19, v18, 16
    v_alignbit_b32 v87, v20, v19, 16
    v_alignbit_b32 v88, v21, v20, 16
    v_alignbit_b32 v89, v22, v21, 16
    v_alignbit_b32 v90, v23, v22, 16
    v_alignbit_b32 v91, v24, v23, 16
    v_alignbit_b32 v92, v25, v24, 16
    v_alignbit_b32 v93, v26, v25, 16
    v_alignbit_b32 v94, v27, v26, 16
    v_alignbit_b32 v95, v28, v27, 16
    v_alignbit_b32 v96, v29, v28, 16
    v_alignbit_b32 v97, v30, v29, 16
    v_alignbit_b32 v98, v31, v30, 16
    v_alignbit_b32 v99, v32, v31, 16
    v_alignbit_b32 v100, v33, v32, 16
    v_dot2_f32_bf16 v102, v84, v197, 0
    v_dot2_f32_bf16 v103, v17, v197, 0
    v_dot2_f32_bf16 v106, v85, v197, 0
    v_dot2_f32_bf16 v107, v18, v197, 0
    v_dot2_f32_bf16 v110, v86, v197, 0
    v_dot2_f32_bf16 v111, v19, v197, 0
    v_dot2_f32_bf16 v114, v87, v197, 0
    v_dot2_f32_bf16 v115, v20, v197, 0
    v_dot2_f32_bf16 v102, v85, v196, v102
    v_dot2_f32_bf16 v103, v18, v196, v103
    v_dot2_f32_bf16 v106, v86, v196, v106
    v_dot2_f32_bf16 v107, v19, v196, v107
    v_dot2_f32_bf16 v110, v87, v196, v110
    v_dot2_f32_bf16 v111, v20, v196, v111
    v_dot2_f32_bf16 v114, v88, v196, v114
    v_dot2_f32_bf16 v115, v21, v196, v115
    v_lshlrev_b32 v104, 16, v34
    v_and_b32 v105, 0xffff0000, v34
    v_lshlrev_b32 v108, 16, v35
    v_and_b32 v109, 0xffff0000, v35
    v_lshlrev_b32 v112, 16, v36
    v_and_b32 v113, 0xffff0000, v36
    v_lshlrev_b32 v116, 16, v37
    v_and_b32 v117, 0xffff0000, v37
    v_mul_f32 v102, v102, v104
    v_mul_f32 v103, v103, v105
    v_mul_f32 v106, v106, v108
    v_mul_f32 v107, v107, v109
    v_mul_f32 v110, v110, v112
    v_mul_f32 v111, v111, v113
    v_mul_f32 v114, v114, v116
    v_mul_f32 v115, v115, v117
    v_cvt_pk_bf16_f32 v137, v103, v102
    v_cvt_pk_bf16_f32 v136, v107, v106
    v_cvt_pk_bf16_f32 v135, v111, v110
    v_cvt_pk_bf16_f32 v134, v115, v114
    s_add_u32 s4, s72, 64
    buffer_store_dwordx4 v[134:137], v12, s[8:11], s4 offen offset:0
    v_dot2_f32_bf16 v118, v88, v197, 0
    v_dot2_f32_bf16 v119, v21, v197, 0
    v_dot2_f32_bf16 v122, v89, v197, 0
    v_dot2_f32_bf16 v123, v22, v197, 0
    v_dot2_f32_bf16 v126, v90, v197, 0
    v_dot2_f32_bf16 v127, v23, v197, 0
    v_dot2_f32_bf16 v130, v91, v197, 0
    v_dot2_f32_bf16 v131, v24, v197, 0
    v_dot2_f32_bf16 v118, v89, v196, v118
    v_dot2_f32_bf16 v119, v22, v196, v119
    v_dot2_f32_bf16 v122, v90, v196, v122
    v_dot2_f32_bf16 v123, v23, v196, v123
    v_dot2_f32_bf16 v126, v91, v196, v126
    v_dot2_f32_bf16 v127, v24, v196, v127
    v_dot2_f32_bf16 v130, v92, v196, v130
    v_dot2_f32_bf16 v131, v25, v196, v131
    v_lshlrev_b32 v120, 16, v38
    v_and_b32 v121, 0xffff0000, v38
    v_lshlrev_b32 v124, 16, v39
    v_and_b32 v125, 0xffff0000, v39
    v_lshlrev_b32 v128, 16, v40
    v_and_b32 v129, 0xffff0000, v40
    v_lshlrev_b32 v132, 16, v41
    v_and_b32 v133, 0xffff0000, v41
    v_mul_f32 v118, v118, v120
    v_mul_f32 v119, v119, v121
    v_mul_f32 v122, v122, v124
    v_mul_f32 v123, v123, v125
    v_mul_f32 v126, v126, v128
    v_mul_f32 v127, v127, v129
    v_mul_f32 v130, v130, v132
    v_mul_f32 v131, v131, v133
    v_cvt_pk_bf16_f32 v141, v119, v118
    v_cvt_pk_bf16_f32 v140, v123, v122
    v_cvt_pk_bf16_f32 v139, v127, v126
    v_cvt_pk_bf16_f32 v138, v131, v130
    buffer_store_dwordx4 v[138:141], v12, s[8:11], s4 offen offset:1024
    v_dot2_f32_bf16 v102, v92, v197, 0
    v_dot2_f32_bf16 v103, v25, v197, 0
    v_dot2_f32_bf16 v106, v93, v197, 0
    v_dot2_f32_bf16 v107, v26, v197, 0
    v_dot2_f32_bf16 v110, v94, v197, 0
    v_dot2_f32_bf16 v111, v27, v197, 0
    v_dot2_f32_bf16 v114, v95, v197, 0
    v_dot2_f32_bf16 v115, v28, v197, 0
    v_dot2_f32_bf16 v102, v93, v196, v102
    v_dot2_f32_bf16 v103, v26, v196, v103
    v_dot2_f32_bf16 v106, v94, v196, v106
    v_dot2_f32_bf16 v107, v27, v196, v107
    v_dot2_f32_bf16 v110, v95, v196, v110
    v_dot2_f32_bf16 v111, v28, v196, v111
    v_dot2_f32_bf16 v114, v96, v196, v114
    v_dot2_f32_bf16 v115, v29, v196, v115
    v_lshlrev_b32 v104, 16, v42
    v_and_b32 v105, 0xffff0000, v42
    v_lshlrev_b32 v108, 16, v43
    v_and_b32 v109, 0xffff0000, v43
    v_lshlrev_b32 v112, 16, v44
    v_and_b32 v113, 0xffff0000, v44
    v_lshlrev_b32 v116, 16, v45
    v_and_b32 v117, 0xffff0000, v45
    v_mul_f32 v102, v102, v104
    v_mul_f32 v103, v103, v105
    v_mul_f32 v106, v106, v108
    v_mul_f32 v107, v107, v109
    v_mul_f32 v110, v110, v112
    v_mul_f32 v111, v111, v113
    v_mul_f32 v114, v114, v116
    v_mul_f32 v115, v115, v117
    v_cvt_pk_bf16_f32 v145, v103, v102
    v_cvt_pk_bf16_f32 v144, v107, v106
    v_cvt_pk_bf16_f32 v143, v111, v110
    v_cvt_pk_bf16_f32 v142, v115, v114
    buffer_store_dwordx4 v[142:145], v12, s[8:11], s4 offen offset:2048
    v_dot2_f32_bf16 v118, v96, v197, 0
    v_dot2_f32_bf16 v119, v29, v197, 0
    v_dot2_f32_bf16 v122, v97, v197, 0
    v_dot2_f32_bf16 v123, v30, v197, 0
    v_dot2_f32_bf16 v126, v98, v197, 0
    v_dot2_f32_bf16 v127, v31, v197, 0
    v_dot2_f32_bf16 v130, v99, v197, 0
    v_dot2_f32_bf16 v131, v32, v197, 0
    v_dot2_f32_bf16 v118, v97, v196, v118
    v_dot2_f32_bf16 v119, v30, v196, v119
    v_dot2_f32_bf16 v122, v98, v196, v122
    v_dot2_f32_bf16 v123, v31, v196, v123
    v_dot2_f32_bf16 v126, v99, v196, v126
    v_dot2_f32_bf16 v127, v32, v196, v127
    v_dot2_f32_bf16 v130, v100, v196, v130
    v_dot2_f32_bf16 v131, v33, v196, v131
    v_lshlrev_b32 v120, 16, v46
    v_and_b32 v121, 0xffff0000, v46
    v_lshlrev_b32 v124, 16, v47
    v_and_b32 v125, 0xffff0000, v47
    v_lshlrev_b32 v128, 16, v48
    v_and_b32 v129, 0xffff0000, v48
    v_lshlrev_b32 v132, 16, v49
    v_and_b32 v133, 0xffff0000, v49
    v_mul_f32 v118, v118, v120
    v_mul_f32 v119, v119, v121
    v_mul_f32 v122, v122, v124
    v_mul_f32 v123, v123, v125
    v_mul_f32 v126, v126, v128
    v_mul_f32 v127, v127, v129
    v_mul_f32 v130, v130, v132
    v_mul_f32 v131, v131, v133
    v_cvt_pk_bf16_f32 v149, v119, v118
    v_cvt_pk_bf16_f32 v148, v123, v122
    v_cvt_pk_bf16_f32 v147, v127, v126
    v_cvt_pk_bf16_f32 v146, v131, v130
    buffer_store_dwordx4 v[146:149], v12, s[8:11], s4 offen offset:3072
    v_alignbit_b32 v84, v51, v50, 16
    v_alignbit_b32 v85, v52, v51, 16
    v_alignbit_b32 v86, v53, v52, 16
    v_alignbit_b32 v87, v54, v53, 16
    v_alignbit_b32 v88, v55, v54, 16
    v_alignbit_b32 v89, v56, v55, 16
    v_alignbit_b32 v90, v57, v56, 16
    v_alignbit_b32 v91, v58, v57, 16
    v_alignbit_b32 v92, v59, v58, 16
    v_alignbit_b32 v93, v60, v59, 16
    v_alignbit_b32 v94, v61, v60, 16
    v_alignbit_b32 v95, v62, v61, 16
    v_alignbit_b32 v96, v63, v62, 16
    v_alignbit_b32 v97, v64, v63, 16
    v_alignbit_b32 v98, v65, v64, 16
    v_alignbit_b32 v99, v66, v65, 16
    v_alignbit_b32 v100, v67, v66, 16
    v_dot2_f32_bf16 v102, v84, v199, 0
    v_dot2_f32_bf16 v103, v51, v199, 0
    v_dot2_f32_bf16 v106, v85, v199, 0
    v_dot2_f32_bf16 v107, v52, v199, 0
    v_dot2_f32_bf16 v110, v86, v199, 0
    v_dot2_f32_bf16 v111, v53, v199, 0
    v_dot2_f32_bf16 v114, v87, v199, 0
    v_dot2_f32_bf16 v115, v54, v199, 0
    v_dot2_f32_bf16 v102, v85, v198, v102
    v_dot2_f32_bf16 v103, v52, v198, v103
    v_dot2_f32_bf16 v106, v86, v198, v106
    v_dot2_f32_bf16 v107, v53, v198, v107
    v_dot2_f32_bf16 v110, v87, v198, v110
    v_dot2_f32_bf16 v111, v54, v198, v111
    v_dot2_f32_bf16 v114, v88, v198, v114
    v_dot2_f32_bf16 v115, v55, v198, v115
    v_lshlrev_b32 v104, 16, v68
    v_and_b32 v105, 0xffff0000, v68
    v_lshlrev_b32 v108, 16, v69
    v_and_b32 v109, 0xffff0000, v69
    v_lshlrev_b32 v112, 16, v70
    v_and_b32 v113, 0xffff0000, v70
    v_lshlrev_b32 v116, 16, v71
    v_and_b32 v117, 0xffff0000, v71
    v_mul_f32 v102, v102, v104
    v_mul_f32 v103, v103, v105
    v_mul_f32 v106, v106, v108
    v_mul_f32 v107, v107, v109
    v_mul_f32 v110, v110, v112
    v_mul_f32 v111, v111, v113
    v_mul_f32 v114, v114, v116
    v_mul_f32 v115, v115, v117
    v_cvt_pk_bf16_f32 v153, v103, v102
    v_cvt_pk_bf16_f32 v152, v107, v106
    v_cvt_pk_bf16_f32 v151, v111, v110
    v_cvt_pk_bf16_f32 v150, v115, v114
    s_add_u32 s4, s72, 65600
    buffer_store_dwordx4 v[150:153], v12, s[8:11], s4 offen offset:0
    v_dot2_f32_bf16 v118, v88, v199, 0
    v_dot2_f32_bf16 v119, v55, v199, 0
    v_dot2_f32_bf16 v122, v89, v199, 0
    v_dot2_f32_bf16 v123, v56, v199, 0
    v_dot2_f32_bf16 v126, v90, v199, 0
    v_dot2_f32_bf16 v127, v57, v199, 0
    v_dot2_f32_bf16 v130, v91, v199, 0
    v_dot2_f32_bf16 v131, v58, v199, 0
    v_dot2_f32_bf16 v118, v89, v198, v118
    v_dot2_f32_bf16 v119, v56, v198, v119
    v_dot2_f32_bf16 v122, v90, v198, v122
    v_dot2_f32_bf16 v123, v57, v198, v123
    v_dot2_f32_bf16 v126, v91, v198, v126
    v_dot2_f32_bf16 v127, v58, v198, v127
    v_dot2_f32_bf16 v130, v92, v198, v130
    v_dot2_f32_bf16 v131, v59, v198, v131
    v_lshlrev_b32 v120, 16, v72
    v_and_b32 v121, 0xffff0000, v72
    v_lshlrev_b32 v124, 16, v73
    v_and_b32 v125, 0xffff0000, v73
    v_lshlrev_b32 v128, 16, v74
    v_and_b32 v129, 0xffff0000, v74
    v_lshlrev_b32 v132, 16, v75
    v_and_b32 v133, 0xffff0000, v75
    v_mul_f32 v118, v118, v120
    v_mul_f32 v119, v119, v121
    v_mul_f32 v122, v122, v124
    v_mul_f32 v123, v123, v125
    v_mul_f32 v126, v126, v128
    v_mul_f32 v127, v127, v129
    v_mul_f32 v130, v130, v132
    v_mul_f32 v131, v131, v133
    v_cvt_pk_bf16_f32 v157, v119, v118
    v_cvt_pk_bf16_f32 v156, v123, v122
    v_cvt_pk_bf16_f32 v155, v127, v126
    v_cvt_pk_bf16_f32 v154, v131, v130
    buffer_store_dwordx4 v[154:157], v12, s[8:11], s4 offen offset:1024
    v_dot2_f32_bf16 v102, v92, v199, 0
    v_dot2_f32_bf16 v103, v59, v199, 0
    v_dot2_f32_bf16 v106, v93, v199, 0
    v_dot2_f32_bf16 v107, v60, v199, 0
    v_dot2_f32_bf16 v110, v94, v199, 0
    v_dot2_f32_bf16 v111, v61, v199, 0
    v_dot2_f32_bf16 v114, v95, v199, 0
    v_dot2_f32_bf16 v115, v62, v199, 0
    v_dot2_f32_bf16 v102, v93, v198, v102
    v_dot2_f32_bf16 v103, v60, v198, v103
    v_dot2_f32_bf16 v106, v94, v198, v106
    v_dot2_f32_bf16 v107, v61, v198, v107
    v_dot2_f32_bf16 v110, v95, v198, v110
    v_dot2_f32_bf16 v111, v62, v198, v111
    v_dot2_f32_bf16 v114, v96, v198, v114
    v_dot2_f32_bf16 v115, v63, v198, v115
    v_lshlrev_b32 v104, 16, v76
    v_and_b32 v105, 0xffff0000, v76
    v_lshlrev_b32 v108, 16, v77
    v_and_b32 v109, 0xffff0000, v77
    v_lshlrev_b32 v112, 16, v78
    v_and_b32 v113, 0xffff0000, v78
    v_lshlrev_b32 v116, 16, v79
    v_and_b32 v117, 0xffff0000, v79
    v_mul_f32 v102, v102, v104
    v_mul_f32 v103, v103, v105
    v_mul_f32 v106, v106, v108
    v_mul_f32 v107, v107, v109
    v_mul_f32 v110, v110, v112
    v_mul_f32 v111, v111, v113
    v_mul_f32 v114, v114, v116
    v_mul_f32 v115, v115, v117
    v_cvt_pk_bf16_f32 v161, v103, v102
    v_cvt_pk_bf16_f32 v160, v107, v106
    v_cvt_pk_bf16_f32 v159, v111, v110
    v_cvt_pk_bf16_f32 v158, v115, v114
    buffer_store_dwordx4 v[158:161], v12, s[8:11], s4 offen offset:2048
    v_dot2_f32_bf16 v118, v96, v199, 0
    v_dot2_f32_bf16 v119, v63, v199, 0
    v_dot2_f32_bf16 v122, v97, v199, 0
    v_dot2_f32_bf16 v123, v64, v199, 0
    v_dot2_f32_bf16 v126, v98, v199, 0
    v_dot2_f32_bf16 v127, v65, v199, 0
    v_dot2_f32_bf16 v130, v99, v199, 0
    v_dot2_f32_bf16 v131, v66, v199, 0
    v_dot2_f32_bf16 v118, v97, v198, v118
    v_dot2_f32_bf16 v119, v64, v198, v119
    v_dot2_f32_bf16 v122, v98, v198, v122
    v_dot2_f32_bf16 v123, v65, v198, v123
    v_dot2_f32_bf16 v126, v99, v198, v126
    v_dot2_f32_bf16 v127, v66, v198, v127
    v_dot2_f32_bf16 v130, v100, v198, v130
    v_dot2_f32_bf16 v131, v67, v198, v131
    v_lshlrev_b32 v120, 16, v80
    v_and_b32 v121, 0xffff0000, v80
    v_lshlrev_b32 v124, 16, v81
    v_and_b32 v125, 0xffff0000, v81
    v_lshlrev_b32 v128, 16, v82
    v_and_b32 v129, 0xffff0000, v82
    v_lshlrev_b32 v132, 16, v83
    v_and_b32 v133, 0xffff0000, v83
    v_mul_f32 v118, v118, v120
    v_mul_f32 v119, v119, v121
    v_mul_f32 v122, v122, v124
    v_mul_f32 v123, v123, v125
    v_mul_f32 v126, v126, v128
    v_mul_f32 v127, v127, v129
    v_mul_f32 v130, v130, v132
    v_mul_f32 v131, v131, v133
    v_cvt_pk_bf16_f32 v165, v119, v118
    v_cvt_pk_bf16_f32 v164, v123, v122
    v_cvt_pk_bf16_f32 v163, v127, v126
    v_cvt_pk_bf16_f32 v162, v131, v130
    buffer_store_dwordx4 v[162:165], v12, s[8:11], s4 offen offset:3072
    s_waitcnt vmcnt(25)
    ds_read_b64_tr_b16 v[16:17], v11 offset:0
    ds_read_b64_tr_b16 v[18:19], v11 offset:256
    ds_read_b64_tr_b16 v[20:21], v11 offset:512
    ds_read_b64_tr_b16 v[22:23], v11 offset:768
    ds_read_b64_tr_b16 v[24:25], v11 offset:1024
    ds_read_b64_tr_b16 v[26:27], v11 offset:1280
    ds_read_b64_tr_b16 v[28:29], v11 offset:1536
    ds_read_b64_tr_b16 v[30:31], v11 offset:1792
    ds_read_b64_tr_b16 v[32:33], v11 offset:2048
    ds_read_b64_tr_b16 v[34:35], v11 offset:8448
    ds_read_b64_tr_b16 v[36:37], v11 offset:8704
    ds_read_b64_tr_b16 v[38:39], v11 offset:8960
    ds_read_b64_tr_b16 v[40:41], v11 offset:9216
    ds_read_b64_tr_b16 v[42:43], v11 offset:9472
    ds_read_b64_tr_b16 v[44:45], v11 offset:9728
    ds_read_b64_tr_b16 v[46:47], v11 offset:9984
    ds_read_b64_tr_b16 v[48:49], v11 offset:10240
    ds_read_b64_tr_b16 v[50:51], v11 offset:32
    ds_read_b64_tr_b16 v[52:53], v11 offset:288
    ds_read_b64_tr_b16 v[54:55], v11 offset:544
    ds_read_b64_tr_b16 v[56:57], v11 offset:800
    ds_read_b64_tr_b16 v[58:59], v11 offset:1056
    ds_read_b64_tr_b16 v[60:61], v11 offset:1312
    ds_read_b64_tr_b16 v[62:63], v11 offset:1568
    ds_read_b64_tr_b16 v[64:65], v11 offset:1824
    ds_read_b64_tr_b16 v[66:67], v11 offset:2080
    ds_read_b64_tr_b16 v[68:69], v11 offset:8480
    ds_read_b64_tr_b16 v[70:71], v11 offset:8736
    ds_read_b64_tr_b16 v[72:73], v11 offset:8992
    ds_read_b64_tr_b16 v[74:75], v11 offset:9248
    ds_read_b64_tr_b16 v[76:77], v11 offset:9504
    ds_read_b64_tr_b16 v[78:79], v11 offset:9760
    ds_read_b64_tr_b16 v[80:81], v11 offset:10016
    ds_read_b64_tr_b16 v[82:83], v11 offset:10272
    s_waitcnt lgkmcnt(0)
    v_alignbit_b32 v84, v17, v16, 16
    v_alignbit_b32 v85, v18, v17, 16
    v_alignbit_b32 v86, v19, v18, 16
    v_alignbit_b32 v87, v20, v19, 16
    v_alignbit_b32 v88, v21, v20, 16
    v_alignbit_b32 v89, v22, v21, 16
    v_alignbit_b32 v90, v23, v22, 16
    v_alignbit_b32 v91, v24, v23, 16
    v_alignbit_b32 v92, v25, v24, 16
    v_alignbit_b32 v93, v26, v25, 16
    v_alignbit_b32 v94, v27, v26, 16
    v_alignbit_b32 v95, v28, v27, 16
    v_alignbit_b32 v96, v29, v28, 16
    v_alignbit_b32 v97, v30, v29, 16
    v_alignbit_b32 v98, v31, v30, 16
    v_alignbit_b32 v99, v32, v31, 16
    v_alignbit_b32 v100, v33, v32, 16
    v_dot2_f32_bf16 v102, v84, v197, 0
    v_dot2_f32_bf16 v103, v17, v197, 0
    v_dot2_f32_bf16 v106, v85, v197, 0
    v_dot2_f32_bf16 v107, v18, v197, 0
    v_dot2_f32_bf16 v110, v86, v197, 0
    v_dot2_f32_bf16 v111, v19, v197, 0
    v_dot2_f32_bf16 v114, v87, v197, 0
    v_dot2_f32_bf16 v115, v20, v197, 0
    v_dot2_f32_bf16 v102, v85, v196, v102
    v_dot2_f32_bf16 v103, v18, v196, v103
    v_dot2_f32_bf16 v106, v86, v196, v106
    v_dot2_f32_bf16 v107, v19, v196, v107
    v_dot2_f32_bf16 v110, v87, v196, v110
    v_dot2_f32_bf16 v111, v20, v196, v111
    v_dot2_f32_bf16 v114, v88, v196, v114
    v_dot2_f32_bf16 v115, v21, v196, v115
    v_lshlrev_b32 v104, 16, v34
    v_and_b32 v105, 0xffff0000, v34
    v_lshlrev_b32 v108, 16, v35
    v_and_b32 v109, 0xffff0000, v35
    v_lshlrev_b32 v112, 16, v36
    v_and_b32 v113, 0xffff0000, v36
    v_lshlrev_b32 v116, 16, v37
    v_and_b32 v117, 0xffff0000, v37
    v_mul_f32 v102, v102, v104
    v_mul_f32 v103, v103, v105
    v_mul_f32 v106, v106, v108
    v_mul_f32 v107, v107, v109
    v_mul_f32 v110, v110, v112
    v_mul_f32 v111, v111, v113
    v_mul_f32 v114, v114, v116
    v_mul_f32 v115, v115, v117
    v_cvt_pk_bf16_f32 v137, v103, v102
    v_cvt_pk_bf16_f32 v136, v107, v106
    v_cvt_pk_bf16_f32 v135, v111, v110
    v_cvt_pk_bf16_f32 v134, v115, v114
    s_add_u32 s4, s72, 128
    buffer_store_dwordx4 v[134:137], v12, s[8:11], s4 offen offset:0
    v_dot2_f32_bf16 v118, v88, v197, 0
    v_dot2_f32_bf16 v119, v21, v197, 0
    v_dot2_f32_bf16 v122, v89, v197, 0
    v_dot2_f32_bf16 v123, v22, v197, 0
    v_dot2_f32_bf16 v126, v90, v197, 0
    v_dot2_f32_bf16 v127, v23, v197, 0
    v_dot2_f32_bf16 v130, v91, v197, 0
    v_dot2_f32_bf16 v131, v24, v197, 0
    v_dot2_f32_bf16 v118, v89, v196, v118
    v_dot2_f32_bf16 v119, v22, v196, v119
    v_dot2_f32_bf16 v122, v90, v196, v122
    v_dot2_f32_bf16 v123, v23, v196, v123
    v_dot2_f32_bf16 v126, v91, v196, v126
    v_dot2_f32_bf16 v127, v24, v196, v127
    v_dot2_f32_bf16 v130, v92, v196, v130
    v_dot2_f32_bf16 v131, v25, v196, v131
    v_lshlrev_b32 v120, 16, v38
    v_and_b32 v121, 0xffff0000, v38
    v_lshlrev_b32 v124, 16, v39
    v_and_b32 v125, 0xffff0000, v39
    v_lshlrev_b32 v128, 16, v40
    v_and_b32 v129, 0xffff0000, v40
    v_lshlrev_b32 v132, 16, v41
    v_and_b32 v133, 0xffff0000, v41
    v_mul_f32 v118, v118, v120
    v_mul_f32 v119, v119, v121
    v_mul_f32 v122, v122, v124
    v_mul_f32 v123, v123, v125
    v_mul_f32 v126, v126, v128
    v_mul_f32 v127, v127, v129
    v_mul_f32 v130, v130, v132
    v_mul_f32 v131, v131, v133
    v_cvt_pk_bf16_f32 v141, v119, v118
    v_cvt_pk_bf16_f32 v140, v123, v122
    v_cvt_pk_bf16_f32 v139, v127, v126
    v_cvt_pk_bf16_f32 v138, v131, v130
    buffer_store_dwordx4 v[138:141], v12, s[8:11], s4 offen offset:1024
    v_dot2_f32_bf16 v102, v92, v197, 0
    v_dot2_f32_bf16 v103, v25, v197, 0
    v_dot2_f32_bf16 v106, v93, v197, 0
    v_dot2_f32_bf16 v107, v26, v197, 0
    v_dot2_f32_bf16 v110, v94, v197, 0
    v_dot2_f32_bf16 v111, v27, v197, 0
    v_dot2_f32_bf16 v114, v95, v197, 0
    v_dot2_f32_bf16 v115, v28, v197, 0
    v_dot2_f32_bf16 v102, v93, v196, v102
    v_dot2_f32_bf16 v103, v26, v196, v103
    v_dot2_f32_bf16 v106, v94, v196, v106
    v_dot2_f32_bf16 v107, v27, v196, v107
    v_dot2_f32_bf16 v110, v95, v196, v110
    v_dot2_f32_bf16 v111, v28, v196, v111
    v_dot2_f32_bf16 v114, v96, v196, v114
    v_dot2_f32_bf16 v115, v29, v196, v115
    v_lshlrev_b32 v104, 16, v42
    v_and_b32 v105, 0xffff0000, v42
    v_lshlrev_b32 v108, 16, v43
    v_and_b32 v109, 0xffff0000, v43
    v_lshlrev_b32 v112, 16, v44
    v_and_b32 v113, 0xffff0000, v44
    v_lshlrev_b32 v116, 16, v45
    v_and_b32 v117, 0xffff0000, v45
    v_mul_f32 v102, v102, v104
    v_mul_f32 v103, v103, v105
    v_mul_f32 v106, v106, v108
    v_mul_f32 v107, v107, v109
    v_mul_f32 v110, v110, v112
    v_mul_f32 v111, v111, v113
    v_mul_f32 v114, v114, v116
    v_mul_f32 v115, v115, v117
    v_cvt_pk_bf16_f32 v145, v103, v102
    v_cvt_pk_bf16_f32 v144, v107, v106
    v_cvt_pk_bf16_f32 v143, v111, v110
    v_cvt_pk_bf16_f32 v142, v115, v114
    buffer_store_dwordx4 v[142:145], v12, s[8:11], s4 offen offset:2048
    v_dot2_f32_bf16 v118, v96, v197, 0
    v_dot2_f32_bf16 v119, v29, v197, 0
    v_dot2_f32_bf16 v122, v97, v197, 0
    v_dot2_f32_bf16 v123, v30, v197, 0
    v_dot2_f32_bf16 v126, v98, v197, 0
    v_dot2_f32_bf16 v127, v31, v197, 0
    v_dot2_f32_bf16 v130, v99, v197, 0
    v_dot2_f32_bf16 v131, v32, v197, 0
    v_dot2_f32_bf16 v118, v97, v196, v118
    v_dot2_f32_bf16 v119, v30, v196, v119
    v_dot2_f32_bf16 v122, v98, v196, v122
    v_dot2_f32_bf16 v123, v31, v196, v123
    v_dot2_f32_bf16 v126, v99, v196, v126
    v_dot2_f32_bf16 v127, v32, v196, v127
    v_dot2_f32_bf16 v130, v100, v196, v130
    v_dot2_f32_bf16 v131, v33, v196, v131
    v_lshlrev_b32 v120, 16, v46
    v_and_b32 v121, 0xffff0000, v46
    v_lshlrev_b32 v124, 16, v47
    v_and_b32 v125, 0xffff0000, v47
    v_lshlrev_b32 v128, 16, v48
    v_and_b32 v129, 0xffff0000, v48
    v_lshlrev_b32 v132, 16, v49
    v_and_b32 v133, 0xffff0000, v49
    v_mul_f32 v118, v118, v120
    v_mul_f32 v119, v119, v121
    v_mul_f32 v122, v122, v124
    v_mul_f32 v123, v123, v125
    v_mul_f32 v126, v126, v128
    v_mul_f32 v127, v127, v129
    v_mul_f32 v130, v130, v132
    v_mul_f32 v131, v131, v133
    v_cvt_pk_bf16_f32 v149, v119, v118
    v_cvt_pk_bf16_f32 v148, v123, v122
    v_cvt_pk_bf16_f32 v147, v127, v126
    v_cvt_pk_bf16_f32 v146, v131, v130
    buffer_store_dwordx4 v[146:149], v12, s[8:11], s4 offen offset:3072
    v_alignbit_b32 v84, v51, v50, 16
    v_alignbit_b32 v85, v52, v51, 16
    v_alignbit_b32 v86, v53, v52, 16
    v_alignbit_b32 v87, v54, v53, 16
    v_alignbit_b32 v88, v55, v54, 16
    v_alignbit_b32 v89, v56, v55, 16
    v_alignbit_b32 v90, v57, v56, 16
    v_alignbit_b32 v91, v58, v57, 16
    v_alignbit_b32 v92, v59, v58, 16
    v_alignbit_b32 v93, v60, v59, 16
    v_alignbit_b32 v94, v61, v60, 16
    v_alignbit_b32 v95, v62, v61, 16
    v_alignbit_b32 v96, v63, v62, 16
    v_alignbit_b32 v97, v64, v63, 16
    v_alignbit_b32 v98, v65, v64, 16
    v_alignbit_b32 v99, v66, v65, 16
    v_alignbit_b32 v100, v67, v66, 16
    v_dot2_f32_bf16 v102, v84, v199, 0
    v_dot2_f32_bf16 v103, v51, v199, 0
    v_dot2_f32_bf16 v106, v85, v199, 0
    v_dot2_f32_bf16 v107, v52, v199, 0
    v_dot2_f32_bf16 v110, v86, v199, 0
    v_dot2_f32_bf16 v111, v53, v199, 0
    v_dot2_f32_bf16 v114, v87, v199, 0
    v_dot2_f32_bf16 v115, v54, v199, 0
    v_dot2_f32_bf16 v102, v85, v198, v102
    v_dot2_f32_bf16 v103, v52, v198, v103
    v_dot2_f32_bf16 v106, v86, v198, v106
    v_dot2_f32_bf16 v107, v53, v198, v107
    v_dot2_f32_bf16 v110, v87, v198, v110
    v_dot2_f32_bf16 v111, v54, v198, v111
    v_dot2_f32_bf16 v114, v88, v198, v114
    v_dot2_f32_bf16 v115, v55, v198, v115
    v_lshlrev_b32 v104, 16, v68
    v_and_b32 v105, 0xffff0000, v68
    v_lshlrev_b32 v108, 16, v69
    v_and_b32 v109, 0xffff0000, v69
    v_lshlrev_b32 v112, 16, v70
    v_and_b32 v113, 0xffff0000, v70
    v_lshlrev_b32 v116, 16, v71
    v_and_b32 v117, 0xffff0000, v71
    v_mul_f32 v102, v102, v104
    v_mul_f32 v103, v103, v105
    v_mul_f32 v106, v106, v108
    v_mul_f32 v107, v107, v109
    v_mul_f32 v110, v110, v112
    v_mul_f32 v111, v111, v113
    v_mul_f32 v114, v114, v116
    v_mul_f32 v115, v115, v117
    v_cvt_pk_bf16_f32 v153, v103, v102
    v_cvt_pk_bf16_f32 v152, v107, v106
    v_cvt_pk_bf16_f32 v151, v111, v110
    v_cvt_pk_bf16_f32 v150, v115, v114
    s_add_u32 s4, s72, 65664
    buffer_store_dwordx4 v[150:153], v12, s[8:11], s4 offen offset:0
    v_dot2_f32_bf16 v118, v88, v199, 0
    v_dot2_f32_bf16 v119, v55, v199, 0
    v_dot2_f32_bf16 v122, v89, v199, 0
    v_dot2_f32_bf16 v123, v56, v199, 0
    v_dot2_f32_bf16 v126, v90, v199, 0
    v_dot2_f32_bf16 v127, v57, v199, 0
    v_dot2_f32_bf16 v130, v91, v199, 0
    v_dot2_f32_bf16 v131, v58, v199, 0
    v_dot2_f32_bf16 v118, v89, v198, v118
    v_dot2_f32_bf16 v119, v56, v198, v119
    v_dot2_f32_bf16 v122, v90, v198, v122
    v_dot2_f32_bf16 v123, v57, v198, v123
    v_dot2_f32_bf16 v126, v91, v198, v126
    v_dot2_f32_bf16 v127, v58, v198, v127
    v_dot2_f32_bf16 v130, v92, v198, v130
    v_dot2_f32_bf16 v131, v59, v198, v131
    v_lshlrev_b32 v120, 16, v72
    v_and_b32 v121, 0xffff0000, v72
    v_lshlrev_b32 v124, 16, v73
    v_and_b32 v125, 0xffff0000, v73
    v_lshlrev_b32 v128, 16, v74
    v_and_b32 v129, 0xffff0000, v74
    v_lshlrev_b32 v132, 16, v75
    v_and_b32 v133, 0xffff0000, v75
    v_mul_f32 v118, v118, v120
    v_mul_f32 v119, v119, v121
    v_mul_f32 v122, v122, v124
    v_mul_f32 v123, v123, v125
    v_mul_f32 v126, v126, v128
    v_mul_f32 v127, v127, v129
    v_mul_f32 v130, v130, v132
    v_mul_f32 v131, v131, v133
    v_cvt_pk_bf16_f32 v157, v119, v118
    v_cvt_pk_bf16_f32 v156, v123, v122
    v_cvt_pk_bf16_f32 v155, v127, v126
    v_cvt_pk_bf16_f32 v154, v131, v130
    buffer_store_dwordx4 v[154:157], v12, s[8:11], s4 offen offset:1024
    v_dot2_f32_bf16 v102, v92, v199, 0
    v_dot2_f32_bf16 v103, v59, v199, 0
    v_dot2_f32_bf16 v106, v93, v199, 0
    v_dot2_f32_bf16 v107, v60, v199, 0
    v_dot2_f32_bf16 v110, v94, v199, 0
    v_dot2_f32_bf16 v111, v61, v199, 0
    v_dot2_f32_bf16 v114, v95, v199, 0
    v_dot2_f32_bf16 v115, v62, v199, 0
    v_dot2_f32_bf16 v102, v93, v198, v102
    v_dot2_f32_bf16 v103, v60, v198, v103
    v_dot2_f32_bf16 v106, v94, v198, v106
    v_dot2_f32_bf16 v107, v61, v198, v107
    v_dot2_f32_bf16 v110, v95, v198, v110
    v_dot2_f32_bf16 v111, v62, v198, v111
    v_dot2_f32_bf16 v114, v96, v198, v114
    v_dot2_f32_bf16 v115, v63, v198, v115
    v_lshlrev_b32 v104, 16, v76
    v_and_b32 v105, 0xffff0000, v76
    v_lshlrev_b32 v108, 16, v77
    v_and_b32 v109, 0xffff0000, v77
    v_lshlrev_b32 v112, 16, v78
    v_and_b32 v113, 0xffff0000, v78
    v_lshlrev_b32 v116, 16, v79
    v_and_b32 v117, 0xffff0000, v79
    v_mul_f32 v102, v102, v104
    v_mul_f32 v103, v103, v105
    v_mul_f32 v106, v106, v108
    v_mul_f32 v107, v107, v109
    v_mul_f32 v110, v110, v112
    v_mul_f32 v111, v111, v113
    v_mul_f32 v114, v114, v116
    v_mul_f32 v115, v115, v117
    v_cvt_pk_bf16_f32 v161, v103, v102
    v_cvt_pk_bf16_f32 v160, v107, v106
    v_cvt_pk_bf16_f32 v159, v111, v110
    v_cvt_pk_bf16_f32 v158, v115, v114
    buffer_store_dwordx4 v[158:161], v12, s[8:11], s4 offen offset:2048
    v_dot2_f32_bf16 v118, v96, v199, 0
    v_dot2_f32_bf16 v119, v63, v199, 0
    v_dot2_f32_bf16 v122, v97, v199, 0
    v_dot2_f32_bf16 v123, v64, v199, 0
    v_dot2_f32_bf16 v126, v98, v199, 0
    v_dot2_f32_bf16 v127, v65, v199, 0
    v_dot2_f32_bf16 v130, v99, v199, 0
    v_dot2_f32_bf16 v131, v66, v199, 0
    v_dot2_f32_bf16 v118, v97, v198, v118
    v_dot2_f32_bf16 v119, v64, v198, v119
    v_dot2_f32_bf16 v122, v98, v198, v122
    v_dot2_f32_bf16 v123, v65, v198, v123
    v_dot2_f32_bf16 v126, v99, v198, v126
    v_dot2_f32_bf16 v127, v66, v198, v127
    v_dot2_f32_bf16 v130, v100, v198, v130
    v_dot2_f32_bf16 v131, v67, v198, v131
    v_lshlrev_b32 v120, 16, v80
    v_and_b32 v121, 0xffff0000, v80
    v_lshlrev_b32 v124, 16, v81
    v_and_b32 v125, 0xffff0000, v81
    v_lshlrev_b32 v128, 16, v82
    v_and_b32 v129, 0xffff0000, v82
    v_lshlrev_b32 v132, 16, v83
    v_and_b32 v133, 0xffff0000, v83
    v_mul_f32 v118, v118, v120
    v_mul_f32 v119, v119, v121
    v_mul_f32 v122, v122, v124
    v_mul_f32 v123, v123, v125
    v_mul_f32 v126, v126, v128
    v_mul_f32 v127, v127, v129
    v_mul_f32 v130, v130, v132
    v_mul_f32 v131, v131, v133
    v_cvt_pk_bf16_f32 v165, v119, v118
    v_cvt_pk_bf16_f32 v164, v123, v122
    v_cvt_pk_bf16_f32 v163, v127, v126
    v_cvt_pk_bf16_f32 v162, v131, v130
    buffer_store_dwordx4 v[162:165], v12, s[8:11], s4 offen offset:3072
    s_waitcnt vmcnt(8)
    ds_read_b64_tr_b16 v[16:17], v11 offset:16640
    ds_read_b64_tr_b16 v[18:19], v11 offset:16896
    ds_read_b64_tr_b16 v[20:21], v11 offset:17152
    ds_read_b64_tr_b16 v[22:23], v11 offset:17408
    ds_read_b64_tr_b16 v[24:25], v11 offset:17664
    ds_read_b64_tr_b16 v[26:27], v11 offset:17920
    ds_read_b64_tr_b16 v[28:29], v11 offset:18176
    ds_read_b64_tr_b16 v[30:31], v11 offset:18432
    ds_read_b64_tr_b16 v[32:33], v11 offset:18688
    ds_read_b64_tr_b16 v[34:35], v11 offset:25088
    ds_read_b64_tr_b16 v[36:37], v11 offset:25344
    ds_read_b64_tr_b16 v[38:39], v11 offset:25600
    ds_read_b64_tr_b16 v[40:41], v11 offset:25856
    ds_read_b64_tr_b16 v[42:43], v11 offset:26112
    ds_read_b64_tr_b16 v[44:45], v11 offset:26368
    ds_read_b64_tr_b16 v[46:47], v11 offset:26624
    ds_read_b64_tr_b16 v[48:49], v11 offset:26880
    ds_read_b64_tr_b16 v[50:51], v11 offset:16672
    ds_read_b64_tr_b16 v[52:53], v11 offset:16928
    ds_read_b64_tr_b16 v[54:55], v11 offset:17184
    ds_read_b64_tr_b16 v[56:57], v11 offset:17440
    ds_read_b64_tr_b16 v[58:59], v11 offset:17696
    ds_read_b64_tr_b16 v[60:61], v11 offset:17952
    ds_read_b64_tr_b16 v[62:63], v11 offset:18208
    ds_read_b64_tr_b16 v[64:65], v11 offset:18464
    ds_read_b64_tr_b16 v[66:67], v11 offset:18720
    ds_read_b64_tr_b16 v[68:69], v11 offset:25120
    ds_read_b64_tr_b16 v[70:71], v11 offset:25376
    ds_read_b64_tr_b16 v[72:73], v11 offset:25632
    ds_read_b64_tr_b16 v[74:75], v11 offset:25888
    ds_read_b64_tr_b16 v[76:77], v11 offset:26144
    ds_read_b64_tr_b16 v[78:79], v11 offset:26400
    ds_read_b64_tr_b16 v[80:81], v11 offset:26656
    ds_read_b64_tr_b16 v[82:83], v11 offset:26912
    s_waitcnt lgkmcnt(0)
    v_alignbit_b32 v84, v17, v16, 16
    v_alignbit_b32 v85, v18, v17, 16
    v_alignbit_b32 v86, v19, v18, 16
    v_alignbit_b32 v87, v20, v19, 16
    v_alignbit_b32 v88, v21, v20, 16
    v_alignbit_b32 v89, v22, v21, 16
    v_alignbit_b32 v90, v23, v22, 16
    v_alignbit_b32 v91, v24, v23, 16
    v_alignbit_b32 v92, v25, v24, 16
    v_alignbit_b32 v93, v26, v25, 16
    v_alignbit_b32 v94, v27, v26, 16
    v_alignbit_b32 v95, v28, v27, 16
    v_alignbit_b32 v96, v29, v28, 16
    v_alignbit_b32 v97, v30, v29, 16
    v_alignbit_b32 v98, v31, v30, 16
    v_alignbit_b32 v99, v32, v31, 16
    v_alignbit_b32 v100, v33, v32, 16
    v_dot2_f32_bf16 v102, v84, v197, 0
    v_dot2_f32_bf16 v103, v17, v197, 0
    v_dot2_f32_bf16 v106, v85, v197, 0
    v_dot2_f32_bf16 v107, v18, v197, 0
    v_dot2_f32_bf16 v110, v86, v197, 0
    v_dot2_f32_bf16 v111, v19, v197, 0
    v_dot2_f32_bf16 v114, v87, v197, 0
    v_dot2_f32_bf16 v115, v20, v197, 0
    v_dot2_f32_bf16 v102, v85, v196, v102
    v_dot2_f32_bf16 v103, v18, v196, v103
    v_dot2_f32_bf16 v106, v86, v196, v106
    v_dot2_f32_bf16 v107, v19, v196, v107
    v_dot2_f32_bf16 v110, v87, v196, v110
    v_dot2_f32_bf16 v111, v20, v196, v111
    v_dot2_f32_bf16 v114, v88, v196, v114
    v_dot2_f32_bf16 v115, v21, v196, v115
    v_lshlrev_b32 v104, 16, v34
    v_and_b32 v105, 0xffff0000, v34
    v_lshlrev_b32 v108, 16, v35
    v_and_b32 v109, 0xffff0000, v35
    v_lshlrev_b32 v112, 16, v36
    v_and_b32 v113, 0xffff0000, v36
    v_lshlrev_b32 v116, 16, v37
    v_and_b32 v117, 0xffff0000, v37
    v_mul_f32 v102, v102, v104
    v_mul_f32 v103, v103, v105
    v_mul_f32 v106, v106, v108
    v_mul_f32 v107, v107, v109
    v_mul_f32 v110, v110, v112
    v_mul_f32 v111, v111, v113
    v_mul_f32 v114, v114, v116
    v_mul_f32 v115, v115, v117
    v_cvt_pk_bf16_f32 v137, v103, v102
    v_cvt_pk_bf16_f32 v136, v107, v106
    v_cvt_pk_bf16_f32 v135, v111, v110
    v_cvt_pk_bf16_f32 v134, v115, v114
    s_add_u32 s4, s72, 192
    buffer_store_dwordx4 v[134:137], v12, s[8:11], s4 offen offset:0
    v_dot2_f32_bf16 v118, v88, v197, 0
    v_dot2_f32_bf16 v119, v21, v197, 0
    v_dot2_f32_bf16 v122, v89, v197, 0
    v_dot2_f32_bf16 v123, v22, v197, 0
    v_dot2_f32_bf16 v126, v90, v197, 0
    v_dot2_f32_bf16 v127, v23, v197, 0
    v_dot2_f32_bf16 v130, v91, v197, 0
    v_dot2_f32_bf16 v131, v24, v197, 0
    v_dot2_f32_bf16 v118, v89, v196, v118
    v_dot2_f32_bf16 v119, v22, v196, v119
    v_dot2_f32_bf16 v122, v90, v196, v122
    v_dot2_f32_bf16 v123, v23, v196, v123
    v_dot2_f32_bf16 v126, v91, v196, v126
    v_dot2_f32_bf16 v127, v24, v196, v127
    v_dot2_f32_bf16 v130, v92, v196, v130
    v_dot2_f32_bf16 v131, v25, v196, v131
    v_lshlrev_b32 v120, 16, v38
    v_and_b32 v121, 0xffff0000, v38
    v_lshlrev_b32 v124, 16, v39
    v_and_b32 v125, 0xffff0000, v39
    v_lshlrev_b32 v128, 16, v40
    v_and_b32 v129, 0xffff0000, v40
    v_lshlrev_b32 v132, 16, v41
    v_and_b32 v133, 0xffff0000, v41
    v_mul_f32 v118, v118, v120
    v_mul_f32 v119, v119, v121
    v_mul_f32 v122, v122, v124
    v_mul_f32 v123, v123, v125
    v_mul_f32 v126, v126, v128
    v_mul_f32 v127, v127, v129
    v_mul_f32 v130, v130, v132
    v_mul_f32 v131, v131, v133
    v_cvt_pk_bf16_f32 v141, v119, v118
    v_cvt_pk_bf16_f32 v140, v123, v122
    v_cvt_pk_bf16_f32 v139, v127, v126
    v_cvt_pk_bf16_f32 v138, v131, v130
    buffer_store_dwordx4 v[138:141], v12, s[8:11], s4 offen offset:1024
    v_dot2_f32_bf16 v102, v92, v197, 0
    v_dot2_f32_bf16 v103, v25, v197, 0
    v_dot2_f32_bf16 v106, v93, v197, 0
    v_dot2_f32_bf16 v107, v26, v197, 0
    v_dot2_f32_bf16 v110, v94, v197, 0
    v_dot2_f32_bf16 v111, v27, v197, 0
    v_dot2_f32_bf16 v114, v95, v197, 0
    v_dot2_f32_bf16 v115, v28, v197, 0
    v_dot2_f32_bf16 v102, v93, v196, v102
    v_dot2_f32_bf16 v103, v26, v196, v103
    v_dot2_f32_bf16 v106, v94, v196, v106
    v_dot2_f32_bf16 v107, v27, v196, v107
    v_dot2_f32_bf16 v110, v95, v196, v110
    v_dot2_f32_bf16 v111, v28, v196, v111
    v_dot2_f32_bf16 v114, v96, v196, v114
    v_dot2_f32_bf16 v115, v29, v196, v115
    v_lshlrev_b32 v104, 16, v42
    v_and_b32 v105, 0xffff0000, v42
    v_lshlrev_b32 v108, 16, v43
    v_and_b32 v109, 0xffff0000, v43
    v_lshlrev_b32 v112, 16, v44
    v_and_b32 v113, 0xffff0000, v44
    v_lshlrev_b32 v116, 16, v45
    v_and_b32 v117, 0xffff0000, v45
    v_mul_f32 v102, v102, v104
    v_mul_f32 v103, v103, v105
    v_mul_f32 v106, v106, v108
    v_mul_f32 v107, v107, v109
    v_mul_f32 v110, v110, v112
    v_mul_f32 v111, v111, v113
    v_mul_f32 v114, v114, v116
    v_mul_f32 v115, v115, v117
    v_cvt_pk_bf16_f32 v145, v103, v102
    v_cvt_pk_bf16_f32 v144, v107, v106
    v_cvt_pk_bf16_f32 v143, v111, v110
    v_cvt_pk_bf16_f32 v142, v115, v114
    buffer_store_dwordx4 v[142:145], v12, s[8:11], s4 offen offset:2048
    v_dot2_f32_bf16 v118, v96, v197, 0
    v_dot2_f32_bf16 v119, v29, v197, 0
    v_dot2_f32_bf16 v122, v97, v197, 0
    v_dot2_f32_bf16 v123, v30, v197, 0
    v_dot2_f32_bf16 v126, v98, v197, 0
    v_dot2_f32_bf16 v127, v31, v197, 0
    v_dot2_f32_bf16 v130, v99, v197, 0
    v_dot2_f32_bf16 v131, v32, v197, 0
    v_dot2_f32_bf16 v118, v97, v196, v118
    v_dot2_f32_bf16 v119, v30, v196, v119
    v_dot2_f32_bf16 v122, v98, v196, v122
    v_dot2_f32_bf16 v123, v31, v196, v123
    v_dot2_f32_bf16 v126, v99, v196, v126
    v_dot2_f32_bf16 v127, v32, v196, v127
    v_dot2_f32_bf16 v130, v100, v196, v130
    v_dot2_f32_bf16 v131, v33, v196, v131
    v_lshlrev_b32 v120, 16, v46
    v_and_b32 v121, 0xffff0000, v46
    v_lshlrev_b32 v124, 16, v47
    v_and_b32 v125, 0xffff0000, v47
    v_lshlrev_b32 v128, 16, v48
    v_and_b32 v129, 0xffff0000, v48
    v_lshlrev_b32 v132, 16, v49
    v_and_b32 v133, 0xffff0000, v49
    v_mul_f32 v118, v118, v120
    v_mul_f32 v119, v119, v121
    v_mul_f32 v122, v122, v124
    v_mul_f32 v123, v123, v125
    v_mul_f32 v126, v126, v128
    v_mul_f32 v127, v127, v129
    v_mul_f32 v130, v130, v132
    v_mul_f32 v131, v131, v133
    v_cvt_pk_bf16_f32 v149, v119, v118
    v_cvt_pk_bf16_f32 v148, v123, v122
    v_cvt_pk_bf16_f32 v147, v127, v126
    v_cvt_pk_bf16_f32 v146, v131, v130
    buffer_store_dwordx4 v[146:149], v12, s[8:11], s4 offen offset:3072
    v_alignbit_b32 v84, v51, v50, 16
    v_alignbit_b32 v85, v52, v51, 16
    v_alignbit_b32 v86, v53, v52, 16
    v_alignbit_b32 v87, v54, v53, 16
    v_alignbit_b32 v88, v55, v54, 16
    v_alignbit_b32 v89, v56, v55, 16
    v_alignbit_b32 v90, v57, v56, 16
    v_alignbit_b32 v91, v58, v57, 16
    v_alignbit_b32 v92, v59, v58, 16
    v_alignbit_b32 v93, v60, v59, 16
    v_alignbit_b32 v94, v61, v60, 16
    v_alignbit_b32 v95, v62, v61, 16
    v_alignbit_b32 v96, v63, v62, 16
    v_alignbit_b32 v97, v64, v63, 16
    v_alignbit_b32 v98, v65, v64, 16
    v_alignbit_b32 v99, v66, v65, 16
    v_alignbit_b32 v100, v67, v66, 16
    v_dot2_f32_bf16 v102, v84, v199, 0
    v_dot2_f32_bf16 v103, v51, v199, 0
    v_dot2_f32_bf16 v106, v85, v199, 0
    v_dot2_f32_bf16 v107, v52, v199, 0
    v_dot2_f32_bf16 v110, v86, v199, 0
    v_dot2_f32_bf16 v111, v53, v199, 0
    v_dot2_f32_bf16 v114, v87, v199, 0
    v_dot2_f32_bf16 v115, v54, v199, 0
    v_dot2_f32_bf16 v102, v85, v198, v102
    v_dot2_f32_bf16 v103, v52, v198, v103
    v_dot2_f32_bf16 v106, v86, v198, v106
    v_dot2_f32_bf16 v107, v53, v198, v107
    v_dot2_f32_bf16 v110, v87, v198, v110
    v_dot2_f32_bf16 v111, v54, v198, v111
    v_dot2_f32_bf16 v114, v88, v198, v114
    v_dot2_f32_bf16 v115, v55, v198, v115
    v_lshlrev_b32 v104, 16, v68
    v_and_b32 v105, 0xffff0000, v68
    v_lshlrev_b32 v108, 16, v69
    v_and_b32 v109, 0xffff0000, v69
    v_lshlrev_b32 v112, 16, v70
    v_and_b32 v113, 0xffff0000, v70
    v_lshlrev_b32 v116, 16, v71
    v_and_b32 v117, 0xffff0000, v71
    v_mul_f32 v102, v102, v104
    v_mul_f32 v103, v103, v105
    v_mul_f32 v106, v106, v108
    v_mul_f32 v107, v107, v109
    v_mul_f32 v110, v110, v112
    v_mul_f32 v111, v111, v113
    v_mul_f32 v114, v114, v116
    v_mul_f32 v115, v115, v117
    v_cvt_pk_bf16_f32 v153, v103, v102
    v_cvt_pk_bf16_f32 v152, v107, v106
    v_cvt_pk_bf16_f32 v151, v111, v110
    v_cvt_pk_bf16_f32 v150, v115, v114
    s_add_u32 s4, s72, 65728
    buffer_store_dwordx4 v[150:153], v12, s[8:11], s4 offen offset:0
    v_dot2_f32_bf16 v118, v88, v199, 0
    v_dot2_f32_bf16 v119, v55, v199, 0
    v_dot2_f32_bf16 v122, v89, v199, 0
    v_dot2_f32_bf16 v123, v56, v199, 0
    v_dot2_f32_bf16 v126, v90, v199, 0
    v_dot2_f32_bf16 v127, v57, v199, 0
    v_dot2_f32_bf16 v130, v91, v199, 0
    v_dot2_f32_bf16 v131, v58, v199, 0
    v_dot2_f32_bf16 v118, v89, v198, v118
    v_dot2_f32_bf16 v119, v56, v198, v119
    v_dot2_f32_bf16 v122, v90, v198, v122
    v_dot2_f32_bf16 v123, v57, v198, v123
    v_dot2_f32_bf16 v126, v91, v198, v126
    v_dot2_f32_bf16 v127, v58, v198, v127
    v_dot2_f32_bf16 v130, v92, v198, v130
    v_dot2_f32_bf16 v131, v59, v198, v131
    v_lshlrev_b32 v120, 16, v72
    v_and_b32 v121, 0xffff0000, v72
    v_lshlrev_b32 v124, 16, v73
    v_and_b32 v125, 0xffff0000, v73
    v_lshlrev_b32 v128, 16, v74
    v_and_b32 v129, 0xffff0000, v74
    v_lshlrev_b32 v132, 16, v75
    v_and_b32 v133, 0xffff0000, v75
    v_mul_f32 v118, v118, v120
    v_mul_f32 v119, v119, v121
    v_mul_f32 v122, v122, v124
    v_mul_f32 v123, v123, v125
    v_mul_f32 v126, v126, v128
    v_mul_f32 v127, v127, v129
    v_mul_f32 v130, v130, v132
    v_mul_f32 v131, v131, v133
    v_cvt_pk_bf16_f32 v157, v119, v118
    v_cvt_pk_bf16_f32 v156, v123, v122
    v_cvt_pk_bf16_f32 v155, v127, v126
    v_cvt_pk_bf16_f32 v154, v131, v130
    buffer_store_dwordx4 v[154:157], v12, s[8:11], s4 offen offset:1024
    v_dot2_f32_bf16 v102, v92, v199, 0
    v_dot2_f32_bf16 v103, v59, v199, 0
    v_dot2_f32_bf16 v106, v93, v199, 0
    v_dot2_f32_bf16 v107, v60, v199, 0
    v_dot2_f32_bf16 v110, v94, v199, 0
    v_dot2_f32_bf16 v111, v61, v199, 0
    v_dot2_f32_bf16 v114, v95, v199, 0
    v_dot2_f32_bf16 v115, v62, v199, 0
    v_dot2_f32_bf16 v102, v93, v198, v102
    v_dot2_f32_bf16 v103, v60, v198, v103
    v_dot2_f32_bf16 v106, v94, v198, v106
    v_dot2_f32_bf16 v107, v61, v198, v107
    v_dot2_f32_bf16 v110, v95, v198, v110
    v_dot2_f32_bf16 v111, v62, v198, v111
    v_dot2_f32_bf16 v114, v96, v198, v114
    v_dot2_f32_bf16 v115, v63, v198, v115
    v_lshlrev_b32 v104, 16, v76
    v_and_b32 v105, 0xffff0000, v76
    v_lshlrev_b32 v108, 16, v77
    v_and_b32 v109, 0xffff0000, v77
    v_lshlrev_b32 v112, 16, v78
    v_and_b32 v113, 0xffff0000, v78
    v_lshlrev_b32 v116, 16, v79
    v_and_b32 v117, 0xffff0000, v79
    v_mul_f32 v102, v102, v104
    v_mul_f32 v103, v103, v105
    v_mul_f32 v106, v106, v108
    v_mul_f32 v107, v107, v109
    v_mul_f32 v110, v110, v112
    v_mul_f32 v111, v111, v113
    v_mul_f32 v114, v114, v116
    v_mul_f32 v115, v115, v117
    v_cvt_pk_bf16_f32 v161, v103, v102
    v_cvt_pk_bf16_f32 v160, v107, v106
    v_cvt_pk_bf16_f32 v159, v111, v110
    v_cvt_pk_bf16_f32 v158, v115, v114
    buffer_store_dwordx4 v[158:161], v12, s[8:11], s4 offen offset:2048
    v_dot2_f32_bf16 v118, v96, v199, 0
    v_dot2_f32_bf16 v119, v63, v199, 0
    v_dot2_f32_bf16 v122, v97, v199, 0
    v_dot2_f32_bf16 v123, v64, v199, 0
    v_dot2_f32_bf16 v126, v98, v199, 0
    v_dot2_f32_bf16 v127, v65, v199, 0
    v_dot2_f32_bf16 v130, v99, v199, 0
    v_dot2_f32_bf16 v131, v66, v199, 0
    v_dot2_f32_bf16 v118, v97, v198, v118
    v_dot2_f32_bf16 v119, v64, v198, v119
    v_dot2_f32_bf16 v122, v98, v198, v122
    v_dot2_f32_bf16 v123, v65, v198, v123
    v_dot2_f32_bf16 v126, v99, v198, v126
    v_dot2_f32_bf16 v127, v66, v198, v127
    v_dot2_f32_bf16 v130, v100, v198, v130
    v_dot2_f32_bf16 v131, v67, v198, v131
    v_lshlrev_b32 v120, 16, v80
    v_and_b32 v121, 0xffff0000, v80
    v_lshlrev_b32 v124, 16, v81
    v_and_b32 v125, 0xffff0000, v81
    v_lshlrev_b32 v128, 16, v82
    v_and_b32 v129, 0xffff0000, v82
    v_lshlrev_b32 v132, 16, v83
    v_and_b32 v133, 0xffff0000, v83
    v_mul_f32 v118, v118, v120
    v_mul_f32 v119, v119, v121
    v_mul_f32 v122, v122, v124
    v_mul_f32 v123, v123, v125
    v_mul_f32 v126, v126, v128
    v_mul_f32 v127, v127, v129
    v_mul_f32 v130, v130, v132
    v_mul_f32 v131, v131, v133
    v_cvt_pk_bf16_f32 v165, v119, v118
    v_cvt_pk_bf16_f32 v164, v123, v122
    v_cvt_pk_bf16_f32 v163, v127, v126
    v_cvt_pk_bf16_f32 v162, v131, v130
    buffer_store_dwordx4 v[162:165], v12, s[8:11], s4 offen offset:3072
    s_waitcnt vmcnt(0)
    s_barrier
    s_load_dwordx4 s[52:55], s[0:1], 32
    s_lshl_b32 s3, s93, 5
    s_lshl_b32 s4, s24, 3
    s_add_u32 s3, s3, s4
    s_lshl_b32 s4, s3, 1
    s_waitcnt lgkmcnt(0)
    s_load_dwordx4 s[64:67], s[54:55], s4

    s_mov_b32 s28, s52
    s_and_b32 s29, s53, 0xffff
    s_mov_b32 s30, 0x400000
    s_mov_b32 s31, 0x00020000

    v_and_b32 v1, 63, v0
    v_and_b32 v2, 15, v1
    v_lshrrev_b32 v3, 4, v1

    s_lshl_b32 s32, s3, 12
    s_add_u32 s33, s32, 28672
    s_mul_i32 s34, s24, 38400
    s_add_u32 s35, s34, 33536
    s_add_u32 s38, s32, 117440512
    v_lshlrev_b32 v4, 4, v1
    v_add_u32 v5, s34, v4
    v_add_u32 v5, 64, v5
    v_sub_u32 v6, 7, v2
    v_and_b32 v6, 7, v6
    v_mul_u32_u24 v6, 4160, v6
    v_lshrrev_b32 v7, 3, v2
    v_sub_u32 v7, v7, v3
    v_add_u32 v7, 4, v7
    v_lshl_add_u32 v6, v7, 4, v6
    v_add_u32 v6, s34, v6
    v_mul_u32_u24 v7, 80, v3
    v_add_u32 v7, v7, v2
    v_lshlrev_b32 v7, 4, v7
    v_add_u32 v7, s34, v7
    v_add_u32 v7, 33296, v7
    v_lshlrev_b32 v228, 7, v2
    v_lshl_add_u32 v228, v3, 4, v228
    v_subrev_u32 v229, 16, v4
    v_max_i32 v230, 0, v229
    v_sub_u32 v232, 7, v2
    v_and_b32 v232, 7, v232
    v_and_b32 v233, 1, v232
    v_lshlrev_b32 v233, 4, v233
    v_mov_b32 v234, 0xffff
    v_lshlrev_b32 v233, v233, v234
    v_lshrrev_b32 v232, 1, v232
    v_lshrrev_b32 v234, 3, v2
    v_sub_u32 v234, v3, v234
    v_lshl_add_u32 v232, v234, 1, v232
    v_and_b32 v234, 1, v234
    v_lshl_add_u32 v232, v234, 8, v232

    v_cmp_eq_u32 vcc, 0, v232
    s_nop 1
    v_cndmask_b32 v8, 0, v233, vcc
    v_cmp_eq_u32 vcc, 1, v232
    s_nop 1
    v_cndmask_b32 v9, 0, v233, vcc
    v_cmp_eq_u32 vcc, 2, v232
    s_nop 1
    v_cndmask_b32 v10, 0, v233, vcc
    v_cmp_eq_u32 vcc, 3, v232
    s_nop 1
    v_cndmask_b32 v11, 0, v233, vcc
    v_cmp_eq_u32 vcc, 4, v232
    s_nop 1
    v_cndmask_b32 v12, 0, v233, vcc
    v_cmp_eq_u32 vcc, 5, v232
    s_nop 1
    v_cndmask_b32 v13, 0, v233, vcc
    v_cmp_eq_u32 vcc, 6, v232
    s_nop 1
    v_cndmask_b32 v14, 0, v233, vcc
    v_cmp_eq_u32 vcc, 7, v232
    s_nop 1
    v_cndmask_b32 v15, 0, v233, vcc
    v_mov_b32 v208, 0
    v_mov_b32 v209, 0
    v_mov_b32 v210, 0
    v_mov_b32 v211, 0
    v_lshrrev_b32 v232, 2, v1
    v_and_b32 v232, 7, v232
    v_mul_u32_u24 v232, 4160, v232
    v_and_b32 v233, 3, v1
    v_lshl_add_u32 v232, v233, 4, v232
    v_add_u32 v232, s34, v232
    ds_write_b128 v232, v[208:211]
    v_subrev_u32 v233, 16, v7
    ds_write_b128 v233, v[208:211]

    s_add_u32 s39, s32, 125829120
    buffer_load_dwordx4 v[176:179], v230, s[28:31], s32 offen offset:0
    buffer_load_dwordx4 v[180:183], v4, s[28:31], s32 offen offset:0
    buffer_load_dwordx4 v[184:187], v4, s[28:31], s32 offen offset:1008
    buffer_load_dwordx4 v[188:191], v4, s[28:31], s32 offen offset:1024
    buffer_load_dwordx4 v[192:195], v4, s[28:31], s32 offen offset:2032
    buffer_load_dwordx4 v[196:199], v4, s[28:31], s32 offen offset:2048
    buffer_load_dwordx4 v[200:203], v4, s[28:31], s32 offen offset:3056
    buffer_load_dwordx4 v[204:207], v4, s[28:31], s32 offen offset:3072
    s_add_u32 m0, s35, 0
    s_nop 0
    buffer_load_dwordx4 v4, s[8:11], s39 offen offset:0 lds
    s_add_u32 m0, s35, 256
    s_nop 0
    buffer_load_dwordx4 v4, s[8:11], s39 offen offset:1024 lds
    s_add_u32 m0, s35, 512
    s_nop 0
    buffer_load_dwordx4 v4, s[8:11], s39 offen offset:2048 lds
    s_add_u32 m0, s35, 768
    s_nop 0
    buffer_load_dwordx4 v4, s[8:11], s39 offen offset:3072 lds
    s_waitcnt vmcnt(0) lgkmcnt(0)
    s_pack_ll_b32_b16 s40, s64, s64
    s_add_u32 s36, s32, 4096
    s_add_u32 s37, s32, 8192
    s_add_u32 s39, s36, 125829120
    s_mov_b64 exec, 1
    v_mov_b32 v176, 0
    v_mov_b32 v177, 0
    v_mov_b32 v178, 0
    v_mov_b32 v179, 0
    s_mov_b64 exec, -1
    ds_write_b128 v5, v[180:183] offset:0
    ds_write_b128 v5, v[178:181] offset:16640
    v_mov_b32 v208, v177
    v_mov_b32 v209, v178
    v_mov_b32 v210, v179
    v_mov_b32 v211, v180
    ds_write_b128 v5, v[208:211] offset:24960
    v_mov_b32 v212, v181
    v_mov_b32 v213, v182
    ds_write_b128 v5, v[210:213] offset:8320
    v_alignbit_b32 v214, v177, v176, 16
    v_alignbit_b32 v215, v178, v177, 16
    v_alignbit_b32 v216, v179, v178, 16
    v_alignbit_b32 v217, v180, v179, 16
    ds_write_b128 v5, v[214:217] offset:29120
    v_alignbit_b32 v218, v181, v180, 16
    v_alignbit_b32 v219, v182, v181, 16
    ds_write_b128 v5, v[216:219] offset:12480
    v_alignbit_b32 v220, v178, v177, 16
    v_alignbit_b32 v221, v179, v178, 16
    v_alignbit_b32 v222, v180, v179, 16
    v_alignbit_b32 v223, v181, v180, 16
    ds_write_b128 v5, v[220:223] offset:20800
    v_alignbit_b32 v224, v182, v181, 16
    v_alignbit_b32 v225, v183, v182, 16
    ds_write_b128 v5, v[222:225] offset:4160
    buffer_load_dwordx4 v[176:179], v230, s[28:31], s36 offen offset:0
    buffer_load_dwordx4 v[180:183], v4, s[28:31], s36 offen offset:0
    ds_write_b128 v5, v[188:191] offset:1024
    ds_write_b128 v5, v[186:189] offset:17664
    v_mov_b32 v208, v185
    v_mov_b32 v209, v186
    v_mov_b32 v210, v187
    v_mov_b32 v211, v188
    ds_write_b128 v5, v[208:211] offset:25984
    v_mov_b32 v212, v189
    v_mov_b32 v213, v190
    ds_write_b128 v5, v[210:213] offset:9344
    v_alignbit_b32 v214, v185, v184, 16
    v_alignbit_b32 v215, v186, v185, 16
    v_alignbit_b32 v216, v187, v186, 16
    v_alignbit_b32 v217, v188, v187, 16
    ds_write_b128 v5, v[214:217] offset:30144
    v_alignbit_b32 v218, v189, v188, 16
    v_alignbit_b32 v219, v190, v189, 16
    ds_write_b128 v5, v[216:219] offset:13504
    v_alignbit_b32 v220, v186, v185, 16
    v_alignbit_b32 v221, v187, v186, 16
    v_alignbit_b32 v222, v188, v187, 16
    v_alignbit_b32 v223, v189, v188, 16
    ds_write_b128 v5, v[220:223] offset:21824
    v_alignbit_b32 v224, v190, v189, 16
    v_alignbit_b32 v225, v191, v190, 16
    ds_write_b128 v5, v[222:225] offset:5184
    buffer_load_dwordx4 v[184:187], v4, s[28:31], s36 offen offset:1008
    buffer_load_dwordx4 v[188:191], v4, s[28:31], s36 offen offset:1024
    v_and_b32 v236, s40, v8
    v_and_b32 v237, s40, v9
    v_and_b32 v238, s40, v10
    v_and_b32 v239, s40, v11
    v_and_b32 v240, s40, v12
    v_and_b32 v241, s40, v13
    v_and_b32 v242, s40, v14
    v_and_b32 v243, s40, v15
    ds_read_b128 a[60:63], v7 offset:240
    ds_read_b128 a[124:127], v7 offset:496
    ds_read_b128 a[188:191], v7 offset:752
    ds_read_b128 a[252:255], v7 offset:1008
    ds_read_b128 v[168:171], v6 offset:0
    ds_read_b128 v[172:175], v6 offset:32
    s_waitcnt vmcnt(0) lgkmcnt(0)
    s_mov_b32 s42, 0
.cvl_463:
    s_waitcnt lgkmcnt(5)
    v_mfma_f32_16x16x32_bf16 v[16:19], v[236:239], a[60:63], 0
    v_mfma_f32_16x16x32_bf16 v[32:35], v[240:243], a[60:63], 0
    s_waitcnt lgkmcnt(4)
    v_mfma_f32_16x16x32_bf16 v[20:23], v[236:239], a[124:127], 0
    v_mfma_f32_16x16x32_bf16 v[36:39], v[240:243], a[124:127], 0
    s_waitcnt lgkmcnt(3)
    v_mfma_f32_16x16x32_bf16 v[24:27], v[236:239], a[188:191], 0
    v_mfma_f32_16x16x32_bf16 v[40:43], v[240:243], a[188:191], 0
    ds_read_b128 a[56:59], v7 offset:224
    s_waitcnt lgkmcnt(3)
    v_mfma_f32_16x16x32_bf16 v[28:31], v[236:239], a[252:255], 0
    ds_read_b128 v[112:115], v6 offset:64
    v_mfma_f32_16x16x32_bf16 v[44:47], v[240:243], a[252:255], 0
    ds_read_b128 v[116:119], v6 offset:96
    s_waitcnt lgkmcnt(4)
    v_mfma_f32_16x16x32_bf16 v[16:19], v[168:171], a[60:63], v[16:19]
    ds_read_b128 a[120:123], v7 offset:480
    s_waitcnt lgkmcnt(4)
    v_mfma_f32_16x16x32_bf16 v[32:35], v[172:175], a[60:63], v[32:35]
    s_waitcnt vmcnt(18)
    v_mfma_f32_16x16x32_bf16 v[20:23], v[168:171], a[124:127], v[20:23]
    ds_read_b128 a[184:187], v7 offset:736
    v_mfma_f32_16x16x32_bf16 v[36:39], v[172:175], a[124:127], v[36:39]
    ds_write_b128 v5, v[196:199] offset:2048
    v_mfma_f32_16x16x32_bf16 v[24:27], v[168:171], a[188:191], v[24:27]
    ds_read_b128 a[248:251], v7 offset:992
    v_mfma_f32_16x16x32_bf16 v[40:43], v[172:175], a[188:191], v[40:43]
    ds_read_b128 a[52:55], v7 offset:208
    v_mfma_f32_16x16x32_bf16 v[28:31], v[168:171], a[252:255], v[28:31]
    ds_read_b128 v[120:123], v6 offset:128
    v_mfma_f32_16x16x32_bf16 v[44:47], v[172:175], a[252:255], v[44:47]
    ds_read_b128 v[124:127], v6 offset:160
    s_waitcnt lgkmcnt(8)
    v_mfma_f32_16x16x32_bf16 v[16:19], v[112:115], a[56:59], v[16:19]
    ds_read_b128 a[116:119], v7 offset:464
    s_waitcnt lgkmcnt(8)
    v_mfma_f32_16x16x32_bf16 v[32:35], v[116:119], a[56:59], v[32:35]
    ds_write_b128 v5, v[194:197] offset:18688
    s_waitcnt lgkmcnt(8)
    v_mfma_f32_16x16x32_bf16 v[20:23], v[112:115], a[120:123], v[20:23]
    ds_read_b128 a[180:183], v7 offset:720
    v_mfma_f32_16x16x32_bf16 v[36:39], v[116:119], a[120:123], v[36:39]
    v_mov_b32 v208, v193
    v_mov_b32 v209, v194
    s_waitcnt lgkmcnt(8)
    v_mfma_f32_16x16x32_bf16 v[24:27], v[112:115], a[184:187], v[24:27]
    ds_read_b128 a[244:247], v7 offset:976
    v_mfma_f32_16x16x32_bf16 v[40:43], v[116:119], a[184:187], v[40:43]
    ds_read_b128 a[48:51], v7 offset:192
    s_waitcnt lgkmcnt(8)
    v_mfma_f32_16x16x32_bf16 v[28:31], v[112:115], a[248:251], v[28:31]
    ds_read_b128 v[128:131], v6 offset:192
    v_mfma_f32_16x16x32_bf16 v[44:47], v[116:119], a[248:251], v[44:47]
    ds_read_b128 v[132:135], v6 offset:224
    s_waitcnt lgkmcnt(8)
    v_mfma_f32_16x16x32_bf16 v[16:19], v[120:123], a[52:55], v[16:19]
    ds_read_b128 a[112:115], v7 offset:448
    s_waitcnt lgkmcnt(8)
    v_mfma_f32_16x16x32_bf16 v[32:35], v[124:127], a[52:55], v[32:35]
    v_mov_b32 v210, v195
    v_mov_b32 v211, v196
    s_waitcnt lgkmcnt(7)
    v_mfma_f32_16x16x32_bf16 v[20:23], v[120:123], a[116:119], v[20:23]
    ds_read_b128 a[176:179], v7 offset:704
    v_mfma_f32_16x16x32_bf16 v[36:39], v[124:127], a[116:119], v[36:39]
    ds_write_b128 v5, v[208:211] offset:27008
    s_waitcnt lgkmcnt(7)
    v_mfma_f32_16x16x32_bf16 v[24:27], v[120:123], a[180:183], v[24:27]
    ds_read_b128 a[240:243], v7 offset:960
    v_mfma_f32_16x16x32_bf16 v[40:43], v[124:127], a[180:183], v[40:43]
    ds_read_b128 a[44:47], v7 offset:176
    s_waitcnt lgkmcnt(8)
    v_mfma_f32_16x16x32_bf16 v[28:31], v[120:123], a[244:247], v[28:31]
    ds_read_b128 v[136:139], v6 offset:256
    v_mfma_f32_16x16x32_bf16 v[44:47], v[124:127], a[244:247], v[44:47]
    ds_read_b128 v[140:143], v6 offset:288
    s_waitcnt lgkmcnt(8)
    v_mfma_f32_16x16x32_bf16 v[16:19], v[128:131], a[48:51], v[16:19]
    ds_read_b128 a[108:111], v7 offset:432
    s_waitcnt lgkmcnt(8)
    v_mfma_f32_16x16x32_bf16 v[32:35], v[132:135], a[48:51], v[32:35]
    v_mov_b32 v212, v197
    v_mov_b32 v213, v198
    s_waitcnt lgkmcnt(7)
    v_mfma_f32_16x16x32_bf16 v[20:23], v[128:131], a[112:115], v[20:23]
    ds_read_b128 a[172:175], v7 offset:688
    v_mfma_f32_16x16x32_bf16 v[36:39], v[132:135], a[112:115], v[36:39]
    ds_write_b128 v5, v[210:213] offset:10368
    s_waitcnt lgkmcnt(8)
    v_mfma_f32_16x16x32_bf16 v[24:27], v[128:131], a[176:179], v[24:27]
    ds_read_b128 a[236:239], v7 offset:944
    v_mfma_f32_16x16x32_bf16 v[40:43], v[132:135], a[176:179], v[40:43]
    ds_read_b128 a[40:43], v7 offset:160
    s_waitcnt lgkmcnt(8)
    v_mfma_f32_16x16x32_bf16 v[28:31], v[128:131], a[240:243], v[28:31]
    ds_read_b128 v[144:147], v6 offset:320
    v_mfma_f32_16x16x32_bf16 v[44:47], v[132:135], a[240:243], v[44:47]
    ds_read_b128 v[148:151], v6 offset:352
    s_waitcnt lgkmcnt(8)
    v_mfma_f32_16x16x32_bf16 v[16:19], v[136:139], a[44:47], v[16:19]
    ds_read_b128 a[104:107], v7 offset:416
    s_waitcnt lgkmcnt(8)
    v_mfma_f32_16x16x32_bf16 v[32:35], v[140:143], a[44:47], v[32:35]
    v_alignbit_b32 v214, v193, v192, 16
    v_alignbit_b32 v215, v194, v193, 16
    s_waitcnt lgkmcnt(7)
    v_mfma_f32_16x16x32_bf16 v[20:23], v[136:139], a[108:111], v[20:23]
    ds_read_b128 a[168:171], v7 offset:672
    v_mfma_f32_16x16x32_bf16 v[36:39], v[140:143], a[108:111], v[36:39]
    v_alignbit_b32 v216, v195, v194, 16
    v_alignbit_b32 v217, v196, v195, 16
    s_waitcnt lgkmcnt(7)
    v_mfma_f32_16x16x32_bf16 v[24:27], v[136:139], a[172:175], v[24:27]
    ds_read_b128 a[232:235], v7 offset:928
    v_mfma_f32_16x16x32_bf16 v[40:43], v[140:143], a[172:175], v[40:43]
    ds_read_b128 a[36:39], v7 offset:144
    s_waitcnt lgkmcnt(7)
    v_mfma_f32_16x16x32_bf16 v[28:31], v[136:139], a[236:239], v[28:31]
    ds_read_b128 v[152:155], v6 offset:384
    v_mfma_f32_16x16x32_bf16 v[44:47], v[140:143], a[236:239], v[44:47]
    ds_read_b128 v[156:159], v6 offset:416
    s_waitcnt lgkmcnt(7)
    v_mfma_f32_16x16x32_bf16 v[16:19], v[144:147], a[40:43], v[16:19]
    ds_read_b128 a[100:103], v7 offset:400
    s_waitcnt lgkmcnt(7)
    v_mfma_f32_16x16x32_bf16 v[32:35], v[148:151], a[40:43], v[32:35]
    ds_write_b128 v5, v[214:217] offset:31168
    s_waitcnt lgkmcnt(7)
    v_mfma_f32_16x16x32_bf16 v[20:23], v[144:147], a[104:107], v[20:23]
    ds_read_b128 a[164:167], v7 offset:656
    v_mfma_f32_16x16x32_bf16 v[36:39], v[148:151], a[104:107], v[36:39]
    v_alignbit_b32 v218, v197, v196, 16
    v_alignbit_b32 v219, v198, v197, 16
    s_waitcnt lgkmcnt(7)
    v_mfma_f32_16x16x32_bf16 v[24:27], v[144:147], a[168:171], v[24:27]
    ds_read_b128 a[228:231], v7 offset:912
    v_mfma_f32_16x16x32_bf16 v[40:43], v[148:151], a[168:171], v[40:43]
    ds_read_b128 a[32:35], v7 offset:128
    s_waitcnt lgkmcnt(8)
    v_mfma_f32_16x16x32_bf16 v[28:31], v[144:147], a[232:235], v[28:31]
    ds_read_b128 v[160:163], v6 offset:448
    v_mfma_f32_16x16x32_bf16 v[44:47], v[148:151], a[232:235], v[44:47]
    ds_read_b128 v[164:167], v6 offset:480
    s_waitcnt lgkmcnt(8)
    v_mfma_f32_16x16x32_bf16 v[16:19], v[152:155], a[36:39], v[16:19]
    ds_read_b128 a[96:99], v7 offset:384
    s_waitcnt lgkmcnt(8)
    v_mfma_f32_16x16x32_bf16 v[32:35], v[156:159], a[36:39], v[32:35]
    ds_write_b128 v5, v[216:219] offset:14528
    s_waitcnt lgkmcnt(8)
    v_mfma_f32_16x16x32_bf16 v[20:23], v[152:155], a[100:103], v[20:23]
    ds_read_b128 a[160:163], v7 offset:640
    v_mfma_f32_16x16x32_bf16 v[36:39], v[156:159], a[100:103], v[36:39]
    v_alignbit_b32 v220, v194, v193, 16
    v_alignbit_b32 v221, v195, v194, 16
    s_waitcnt lgkmcnt(7)
    v_mfma_f32_16x16x32_bf16 v[24:27], v[152:155], a[164:167], v[24:27]
    ds_read_b128 a[224:227], v7 offset:896
    v_mfma_f32_16x16x32_bf16 v[40:43], v[156:159], a[164:167], v[40:43]
    ds_read_b128 a[28:31], v7 offset:112
    s_waitcnt lgkmcnt(8)
    v_mfma_f32_16x16x32_bf16 v[28:31], v[152:155], a[228:231], v[28:31]
    ds_read_b128 v[168:171], v6 offset:512
    v_mfma_f32_16x16x32_bf16 v[44:47], v[156:159], a[228:231], v[44:47]
    ds_read_b128 v[172:175], v6 offset:544
    s_waitcnt lgkmcnt(8)
    v_mfma_f32_16x16x32_bf16 v[16:19], v[160:163], a[32:35], v[16:19]
    ds_read_b128 a[92:95], v7 offset:368
    s_waitcnt lgkmcnt(8)
    v_mfma_f32_16x16x32_bf16 v[32:35], v[164:167], a[32:35], v[32:35]
    v_alignbit_b32 v222, v196, v195, 16
    v_alignbit_b32 v223, v197, v196, 16
    s_waitcnt lgkmcnt(7)
    v_mfma_f32_16x16x32_bf16 v[20:23], v[160:163], a[96:99], v[20:23]
    ds_read_b128 a[156:159], v7 offset:624
    v_mfma_f32_16x16x32_bf16 v[36:39], v[164:167], a[96:99], v[36:39]
    ds_write_b128 v5, v[220:223] offset:22848
    s_waitcnt lgkmcnt(7)
    v_mfma_f32_16x16x32_bf16 v[24:27], v[160:163], a[160:163], v[24:27]
    ds_read_b128 a[220:223], v7 offset:880
    v_mfma_f32_16x16x32_bf16 v[40:43], v[164:167], a[160:163], v[40:43]
    ds_read_b128 a[24:27], v7 offset:96
    s_waitcnt lgkmcnt(8)
    v_mfma_f32_16x16x32_bf16 v[28:31], v[160:163], a[224:227], v[28:31]
    ds_read_b128 v[112:115], v6 offset:576
    v_mfma_f32_16x16x32_bf16 v[44:47], v[164:167], a[224:227], v[44:47]
    ds_read_b128 v[116:119], v6 offset:608
    s_waitcnt lgkmcnt(8)
    v_mfma_f32_16x16x32_bf16 v[16:19], v[168:171], a[28:31], v[16:19]
    ds_read_b128 a[88:91], v7 offset:352
    s_waitcnt lgkmcnt(8)
    v_mfma_f32_16x16x32_bf16 v[32:35], v[172:175], a[28:31], v[32:35]
    v_alignbit_b32 v224, v198, v197, 16
    v_alignbit_b32 v225, v199, v198, 16
    s_waitcnt lgkmcnt(7)
    v_mfma_f32_16x16x32_bf16 v[20:23], v[168:171], a[92:95], v[20:23]
    ds_read_b128 a[152:155], v7 offset:608
    v_mfma_f32_16x16x32_bf16 v[36:39], v[172:175], a[92:95], v[36:39]
    ds_write_b128 v5, v[222:225] offset:6208
    s_waitcnt lgkmcnt(8)
    v_mfma_f32_16x16x32_bf16 v[24:27], v[168:171], a[156:159], v[24:27]
    ds_read_b128 a[216:219], v7 offset:864
    v_mfma_f32_16x16x32_bf16 v[40:43], v[172:175], a[156:159], v[40:43]
    ds_read_b128 a[20:23], v7 offset:80
    s_waitcnt lgkmcnt(8)
    v_mfma_f32_16x16x32_bf16 v[28:31], v[168:171], a[220:223], v[28:31]
    ds_read_b128 v[120:123], v6 offset:640
    v_mfma_f32_16x16x32_bf16 v[44:47], v[172:175], a[220:223], v[44:47]
    ds_read_b128 v[124:127], v6 offset:672
    s_waitcnt lgkmcnt(8)
    v_mfma_f32_16x16x32_bf16 v[16:19], v[112:115], a[24:27], v[16:19]
    ds_read_b128 a[84:87], v7 offset:336
    s_waitcnt lgkmcnt(8)
    v_mfma_f32_16x16x32_bf16 v[32:35], v[116:119], a[24:27], v[32:35]
    buffer_load_dwordx4 v[192:195], v4, s[28:31], s36 offen offset:2032
    s_waitcnt lgkmcnt(7)
    v_mfma_f32_16x16x32_bf16 v[20:23], v[112:115], a[88:91], v[20:23]
    ds_read_b128 a[148:151], v7 offset:592
    v_mfma_f32_16x16x32_bf16 v[36:39], v[116:119], a[88:91], v[36:39]
    buffer_load_dwordx4 v[196:199], v4, s[28:31], s36 offen offset:2048
    s_waitcnt lgkmcnt(7)
    v_mfma_f32_16x16x32_bf16 v[24:27], v[112:115], a[152:155], v[24:27]
    ds_read_b128 a[212:215], v7 offset:848
    v_mfma_f32_16x16x32_bf16 v[40:43], v[116:119], a[152:155], v[40:43]
    ds_read_b128 a[16:19], v7 offset:64
    s_waitcnt lgkmcnt(7)
    v_mfma_f32_16x16x32_bf16 v[28:31], v[112:115], a[216:219], v[28:31]
    ds_read_b128 v[128:131], v6 offset:704
    v_mfma_f32_16x16x32_bf16 v[44:47], v[116:119], a[216:219], v[44:47]
    ds_read_b128 v[132:135], v6 offset:736
    s_waitcnt lgkmcnt(7)
    v_mfma_f32_16x16x32_bf16 v[16:19], v[120:123], a[20:23], v[16:19]
    ds_read_b128 a[80:83], v7 offset:320
    s_waitcnt lgkmcnt(7)
    v_mfma_f32_16x16x32_bf16 v[32:35], v[124:127], a[20:23], v[32:35]
    s_waitcnt vmcnt(18)
    s_waitcnt lgkmcnt(6)
    v_mfma_f32_16x16x32_bf16 v[20:23], v[120:123], a[84:87], v[20:23]
    ds_read_b128 a[144:147], v7 offset:576
    v_mfma_f32_16x16x32_bf16 v[36:39], v[124:127], a[84:87], v[36:39]
    ds_write_b128 v5, v[204:207] offset:3072
    s_waitcnt lgkmcnt(7)
    v_mfma_f32_16x16x32_bf16 v[24:27], v[120:123], a[148:151], v[24:27]
    ds_read_b128 a[208:211], v7 offset:832
    v_mfma_f32_16x16x32_bf16 v[40:43], v[124:127], a[148:151], v[40:43]
    ds_read_b128 a[12:15], v7 offset:48
    s_waitcnt lgkmcnt(8)
    v_mfma_f32_16x16x32_bf16 v[28:31], v[120:123], a[212:215], v[28:31]
    ds_read_b128 v[136:139], v6 offset:768
    v_mfma_f32_16x16x32_bf16 v[44:47], v[124:127], a[212:215], v[44:47]
    ds_read_b128 v[140:143], v6 offset:800
    s_waitcnt lgkmcnt(8)
    v_mfma_f32_16x16x32_bf16 v[16:19], v[128:131], a[16:19], v[16:19]
    ds_read_b128 a[76:79], v7 offset:304
    s_waitcnt lgkmcnt(8)
    v_mfma_f32_16x16x32_bf16 v[32:35], v[132:135], a[16:19], v[32:35]
    ds_write_b128 v5, v[202:205] offset:19712
    s_waitcnt lgkmcnt(8)
    v_mfma_f32_16x16x32_bf16 v[20:23], v[128:131], a[80:83], v[20:23]
    ds_read_b128 a[140:143], v7 offset:560
    v_mfma_f32_16x16x32_bf16 v[36:39], v[132:135], a[80:83], v[36:39]
    v_mov_b32 v208, v201
    v_mov_b32 v209, v202
    s_waitcnt lgkmcnt(8)
    v_mfma_f32_16x16x32_bf16 v[24:27], v[128:131], a[144:147], v[24:27]
    ds_read_b128 a[204:207], v7 offset:816
    v_mfma_f32_16x16x32_bf16 v[40:43], v[132:135], a[144:147], v[40:43]
    ds_read_b128 a[8:11], v7 offset:32
    s_waitcnt lgkmcnt(8)
    v_mfma_f32_16x16x32_bf16 v[28:31], v[128:131], a[208:211], v[28:31]
    ds_read_b128 v[144:147], v6 offset:832
    v_mfma_f32_16x16x32_bf16 v[44:47], v[132:135], a[208:211], v[44:47]
    ds_read_b128 v[148:151], v6 offset:864
    s_waitcnt lgkmcnt(8)
    v_mfma_f32_16x16x32_bf16 v[16:19], v[136:139], a[12:15], v[16:19]
    ds_read_b128 a[72:75], v7 offset:288
    s_waitcnt lgkmcnt(8)
    v_mfma_f32_16x16x32_bf16 v[32:35], v[140:143], a[12:15], v[32:35]
    v_mov_b32 v210, v203
    v_mov_b32 v211, v204
    s_waitcnt lgkmcnt(7)
    v_mfma_f32_16x16x32_bf16 v[20:23], v[136:139], a[76:79], v[20:23]
    ds_read_b128 a[136:139], v7 offset:544
    v_mfma_f32_16x16x32_bf16 v[36:39], v[140:143], a[76:79], v[36:39]
    ds_write_b128 v5, v[208:211] offset:28032
    s_waitcnt lgkmcnt(7)
    v_mfma_f32_16x16x32_bf16 v[24:27], v[136:139], a[140:143], v[24:27]
    ds_read_b128 a[200:203], v7 offset:800
    v_mfma_f32_16x16x32_bf16 v[40:43], v[140:143], a[140:143], v[40:43]
    ds_read_b128 a[4:7], v7 offset:16
    s_waitcnt lgkmcnt(8)
    v_mfma_f32_16x16x32_bf16 v[28:31], v[136:139], a[204:207], v[28:31]
    ds_read_b128 v[152:155], v6 offset:896
    v_mfma_f32_16x16x32_bf16 v[44:47], v[140:143], a[204:207], v[44:47]
    ds_read_b128 v[156:159], v6 offset:928
    s_waitcnt lgkmcnt(8)
    v_mfma_f32_16x16x32_bf16 v[16:19], v[144:147], a[8:11], v[16:19]
    ds_read_b128 a[68:71], v7 offset:272
    s_waitcnt lgkmcnt(8)
    v_mfma_f32_16x16x32_bf16 v[32:35], v[148:151], a[8:11], v[32:35]
    v_mov_b32 v212, v205
    v_mov_b32 v213, v206
    s_waitcnt lgkmcnt(7)
    v_mfma_f32_16x16x32_bf16 v[20:23], v[144:147], a[72:75], v[20:23]
    ds_read_b128 a[132:135], v7 offset:528
    v_mfma_f32_16x16x32_bf16 v[36:39], v[148:151], a[72:75], v[36:39]
    ds_write_b128 v5, v[210:213] offset:11392
    s_waitcnt lgkmcnt(8)
    v_mfma_f32_16x16x32_bf16 v[24:27], v[144:147], a[136:139], v[24:27]
    ds_read_b128 a[196:199], v7 offset:784
    v_mfma_f32_16x16x32_bf16 v[40:43], v[148:151], a[136:139], v[40:43]
    ds_read_b128 a[0:3], v7 offset:0
    s_waitcnt lgkmcnt(8)
    v_mfma_f32_16x16x32_bf16 v[28:31], v[144:147], a[200:203], v[28:31]
    ds_read_b128 v[160:163], v6 offset:960
    v_mfma_f32_16x16x32_bf16 v[44:47], v[148:151], a[200:203], v[44:47]
    ds_read_b128 v[164:167], v6 offset:992
    s_waitcnt lgkmcnt(8)
    v_mfma_f32_16x16x32_bf16 v[16:19], v[152:155], a[4:7], v[16:19]
    ds_read_b128 a[64:67], v7 offset:256
    s_waitcnt lgkmcnt(8)
    v_mfma_f32_16x16x32_bf16 v[32:35], v[156:159], a[4:7], v[32:35]
    v_alignbit_b32 v214, v201, v200, 16
    v_alignbit_b32 v215, v202, v201, 16
    s_waitcnt lgkmcnt(7)
    v_mfma_f32_16x16x32_bf16 v[20:23], v[152:155], a[68:71], v[20:23]
    ds_read_b128 a[128:131], v7 offset:512
    v_mfma_f32_16x16x32_bf16 v[36:39], v[156:159], a[68:71], v[36:39]
    v_alignbit_b32 v216, v203, v202, 16
    v_alignbit_b32 v217, v204, v203, 16
    s_waitcnt lgkmcnt(7)
    v_mfma_f32_16x16x32_bf16 v[24:27], v[152:155], a[132:135], v[24:27]
    ds_read_b128 a[192:195], v7 offset:768
    v_mfma_f32_16x16x32_bf16 v[40:43], v[156:159], a[132:135], v[40:43]
    ds_write_b128 v5, v[214:217] offset:32192
    s_waitcnt lgkmcnt(7)
    v_mfma_f32_16x16x32_bf16 v[28:31], v[152:155], a[196:199], v[28:31]
    ds_read_b128 v[168:171], v6 offset:1024
    v_mfma_f32_16x16x32_bf16 v[44:47], v[156:159], a[196:199], v[44:47]
    ds_read_b128 v[172:175], v6 offset:1056
    s_waitcnt lgkmcnt(7)
    v_mfma_f32_16x16x32_bf16 v[16:19], v[160:163], a[0:3], v[16:19]
    v_alignbit_b32 v218, v205, v204, 16
    v_alignbit_b32 v219, v206, v205, 16
    s_waitcnt lgkmcnt(6)
    v_mfma_f32_16x16x32_bf16 v[32:35], v[164:167], a[0:3], v[32:35]
    ds_write_b128 v5, v[216:219] offset:15552
    s_waitcnt lgkmcnt(6)
    v_mfma_f32_16x16x32_bf16 v[20:23], v[160:163], a[64:67], v[20:23]
    v_alignbit_b32 v220, v202, v201, 16
    v_alignbit_b32 v221, v203, v202, 16
    v_mfma_f32_16x16x32_bf16 v[36:39], v[164:167], a[64:67], v[36:39]
    v_alignbit_b32 v222, v204, v203, 16
    v_alignbit_b32 v223, v205, v204, 16
    s_waitcnt lgkmcnt(5)
    v_mfma_f32_16x16x32_bf16 v[24:27], v[160:163], a[128:131], v[24:27]
    ds_read_b128 v[112:115], v6 offset:1088
    v_mfma_f32_16x16x32_bf16 v[40:43], v[164:167], a[128:131], v[40:43]
    ds_read_b128 v[116:119], v6 offset:1120
    s_waitcnt lgkmcnt(6)
    v_mfma_f32_16x16x32_bf16 v[28:31], v[160:163], a[192:195], v[28:31]
    ds_write_b128 v5, v[220:223] offset:23872
    v_mfma_f32_16x16x32_bf16 v[44:47], v[164:167], a[192:195], v[44:47]
    v_alignbit_b32 v224, v206, v205, 16
    v_alignbit_b32 v225, v207, v206, 16
    s_waitcnt lgkmcnt(5)
    v_mfma_f32_16x16x32_bf16 v[20:23], v[168:171], a[60:63], v[20:23]
    ds_write_b128 v5, v[222:225] offset:7232
    s_waitcnt lgkmcnt(5)
    v_mfma_f32_16x16x32_bf16 v[36:39], v[172:175], a[60:63], v[36:39]
    buffer_load_dwordx4 v[200:203], v4, s[28:31], s36 offen offset:3056
    v_mfma_f32_16x16x32_bf16 v[24:27], v[168:171], a[124:127], v[24:27]
    ds_read_b128 v[120:123], v6 offset:1152
    v_mfma_f32_16x16x32_bf16 v[40:43], v[172:175], a[124:127], v[40:43]
    ds_read_b128 v[124:127], v6 offset:1184
    v_mfma_f32_16x16x32_bf16 v[28:31], v[168:171], a[188:191], v[28:31]
    buffer_load_dwordx4 v[204:207], v4, s[28:31], s36 offen offset:3072
    v_mfma_f32_16x16x32_bf16 v[44:47], v[172:175], a[188:191], v[44:47]
    s_waitcnt vmcnt(18)
    s_mov_b64 exec, 1
    v_mov_b32 v176, 0
    v_mov_b32 v177, 0
    v_mov_b32 v178, 0
    v_mov_b32 v179, 0
    s_mov_b64 exec, -1
    s_waitcnt lgkmcnt(5)
    v_mfma_f32_16x16x32_bf16 v[20:23], v[112:115], a[56:59], v[20:23]
    ds_write_b128 v5, v[180:183] offset:0
    s_waitcnt lgkmcnt(5)
    v_mfma_f32_16x16x32_bf16 v[36:39], v[116:119], a[56:59], v[36:39]
    ds_write_b128 v5, v[178:181] offset:16640
    v_mfma_f32_16x16x32_bf16 v[24:27], v[112:115], a[120:123], v[24:27]
    ds_read_b128 v[128:131], v6 offset:1216
    v_mfma_f32_16x16x32_bf16 v[40:43], v[116:119], a[120:123], v[40:43]
    ds_read_b128 v[132:135], v6 offset:1248
    v_mfma_f32_16x16x32_bf16 v[28:31], v[112:115], a[184:187], v[28:31]
    v_mov_b32 v208, v177
    v_mov_b32 v209, v178
    v_mfma_f32_16x16x32_bf16 v[44:47], v[116:119], a[184:187], v[44:47]
    v_mov_b32 v210, v179
    v_mov_b32 v211, v180
    s_waitcnt lgkmcnt(5)
    v_mfma_f32_16x16x32_bf16 v[20:23], v[120:123], a[52:55], v[20:23]
    ds_write_b128 v5, v[208:211] offset:24960
    s_waitcnt lgkmcnt(5)
    v_mfma_f32_16x16x32_bf16 v[36:39], v[124:127], a[52:55], v[36:39]
    v_mov_b32 v212, v181
    v_mov_b32 v213, v182
    v_mfma_f32_16x16x32_bf16 v[24:27], v[120:123], a[116:119], v[24:27]
    ds_read_b128 v[136:139], v6 offset:1280
    v_mfma_f32_16x16x32_bf16 v[40:43], v[124:127], a[116:119], v[40:43]
    ds_read_b128 v[140:143], v6 offset:1312
    v_mfma_f32_16x16x32_bf16 v[28:31], v[120:123], a[180:183], v[28:31]
    ds_write_b128 v5, v[210:213] offset:8320
    v_mfma_f32_16x16x32_bf16 v[44:47], v[124:127], a[180:183], v[44:47]
    v_alignbit_b32 v214, v177, v176, 16
    v_alignbit_b32 v215, v178, v177, 16
    s_waitcnt lgkmcnt(5)
    v_mfma_f32_16x16x32_bf16 v[20:23], v[128:131], a[48:51], v[20:23]
    v_alignbit_b32 v216, v179, v178, 16
    v_alignbit_b32 v217, v180, v179, 16
    s_waitcnt lgkmcnt(4)
    v_mfma_f32_16x16x32_bf16 v[36:39], v[132:135], a[48:51], v[36:39]
    ds_write_b128 v5, v[214:217] offset:29120
    v_mfma_f32_16x16x32_bf16 v[24:27], v[128:131], a[112:115], v[24:27]
    ds_read_b128 v[144:147], v6 offset:1344
    v_mfma_f32_16x16x32_bf16 v[40:43], v[132:135], a[112:115], v[40:43]
    ds_read_b128 v[148:151], v6 offset:1376
    v_mfma_f32_16x16x32_bf16 v[28:31], v[128:131], a[176:179], v[28:31]
    v_alignbit_b32 v218, v181, v180, 16
    v_alignbit_b32 v219, v182, v181, 16
    v_mfma_f32_16x16x32_bf16 v[44:47], v[132:135], a[176:179], v[44:47]
    ds_write_b128 v5, v[216:219] offset:12480
    s_waitcnt lgkmcnt(6)
    v_mfma_f32_16x16x32_bf16 v[20:23], v[136:139], a[44:47], v[20:23]
    v_alignbit_b32 v220, v178, v177, 16
    v_alignbit_b32 v221, v179, v178, 16
    s_waitcnt lgkmcnt(5)
    v_mfma_f32_16x16x32_bf16 v[36:39], v[140:143], a[44:47], v[36:39]
    v_alignbit_b32 v222, v180, v179, 16
    v_alignbit_b32 v223, v181, v180, 16
    v_mfma_f32_16x16x32_bf16 v[24:27], v[136:139], a[108:111], v[24:27]
    ds_read_b128 v[152:155], v6 offset:1408
    v_mfma_f32_16x16x32_bf16 v[40:43], v[140:143], a[108:111], v[40:43]
    ds_read_b128 v[156:159], v6 offset:1440
    v_mfma_f32_16x16x32_bf16 v[28:31], v[136:139], a[172:175], v[28:31]
    ds_write_b128 v5, v[220:223] offset:20800
    v_mfma_f32_16x16x32_bf16 v[44:47], v[140:143], a[172:175], v[44:47]
    v_alignbit_b32 v224, v182, v181, 16
    v_alignbit_b32 v225, v183, v182, 16
    s_waitcnt lgkmcnt(5)
    v_mfma_f32_16x16x32_bf16 v[20:23], v[144:147], a[40:43], v[20:23]
    ds_write_b128 v5, v[222:225] offset:4160
    s_waitcnt lgkmcnt(5)
    v_mfma_f32_16x16x32_bf16 v[36:39], v[148:151], a[40:43], v[36:39]
    buffer_load_dwordx4 v[176:179], v230, s[28:31], s37 offen offset:0
    v_mfma_f32_16x16x32_bf16 v[24:27], v[144:147], a[104:107], v[24:27]
    ds_read_b128 v[160:163], v6 offset:1472
    v_mfma_f32_16x16x32_bf16 v[40:43], v[148:151], a[104:107], v[40:43]
    ds_read_b128 v[164:167], v6 offset:1504
    v_mfma_f32_16x16x32_bf16 v[28:31], v[144:147], a[168:171], v[28:31]
    buffer_load_dwordx4 v[180:183], v4, s[28:31], s37 offen offset:0
    v_mfma_f32_16x16x32_bf16 v[44:47], v[148:151], a[168:171], v[44:47]
    s_add_u32 m0, s35, 0
    s_waitcnt lgkmcnt(5)
    v_mfma_f32_16x16x32_bf16 v[20:23], v[152:155], a[36:39], v[20:23]
    buffer_load_dwordx4 v4, s[8:11], s39 offen offset:0 lds
    s_waitcnt lgkmcnt(4)
    v_mfma_f32_16x16x32_bf16 v[36:39], v[156:159], a[36:39], v[36:39]
    s_add_u32 m0, s35, 256
    v_mfma_f32_16x16x32_bf16 v[24:27], v[152:155], a[100:103], v[24:27]
    ds_read_b128 v[168:171], v6 offset:1536
    v_mfma_f32_16x16x32_bf16 v[40:43], v[156:159], a[100:103], v[40:43]
    ds_read_b128 v[172:175], v6 offset:1568
    v_mfma_f32_16x16x32_bf16 v[28:31], v[152:155], a[164:167], v[28:31]
    buffer_load_dwordx4 v4, s[8:11], s39 offen offset:1024 lds
    v_mfma_f32_16x16x32_bf16 v[44:47], v[156:159], a[164:167], v[44:47]
    s_add_u32 m0, s35, 512
    s_waitcnt lgkmcnt(3)
    v_mfma_f32_16x16x32_bf16 v[20:23], v[160:163], a[32:35], v[20:23]
    buffer_load_dwordx4 v4, s[8:11], s39 offen offset:2048 lds
    s_waitcnt lgkmcnt(2)
    v_mfma_f32_16x16x32_bf16 v[36:39], v[164:167], a[32:35], v[36:39]
    s_add_u32 m0, s35, 768
    v_mfma_f32_16x16x32_bf16 v[24:27], v[160:163], a[96:99], v[24:27]
    ds_read_b128 v[112:115], v6 offset:1600
    v_mfma_f32_16x16x32_bf16 v[40:43], v[164:167], a[96:99], v[40:43]
    ds_read_b128 v[116:119], v6 offset:1632
    v_mfma_f32_16x16x32_bf16 v[28:31], v[160:163], a[160:163], v[28:31]
    buffer_load_dwordx4 v4, s[8:11], s39 offen offset:3072 lds
    v_mfma_f32_16x16x32_bf16 v[44:47], v[164:167], a[160:163], v[44:47]
    s_waitcnt lgkmcnt(3)
    v_mfma_f32_16x16x32_bf16 v[20:23], v[168:171], a[28:31], v[20:23]
    s_waitcnt lgkmcnt(2)
    v_mfma_f32_16x16x32_bf16 v[36:39], v[172:175], a[28:31], v[36:39]
    v_mfma_f32_16x16x32_bf16 v[24:27], v[168:171], a[92:95], v[24:27]
    ds_read_b128 v[120:123], v6 offset:1664
    v_mfma_f32_16x16x32_bf16 v[40:43], v[172:175], a[92:95], v[40:43]
    ds_read_b128 v[124:127], v6 offset:1696
    v_mfma_f32_16x16x32_bf16 v[28:31], v[168:171], a[156:159], v[28:31]
    v_mfma_f32_16x16x32_bf16 v[44:47], v[172:175], a[156:159], v[44:47]
    s_waitcnt lgkmcnt(3)
    v_mfma_f32_16x16x32_bf16 v[20:23], v[112:115], a[24:27], v[20:23]
    s_waitcnt lgkmcnt(2)
    v_mfma_f32_16x16x32_bf16 v[36:39], v[116:119], a[24:27], v[36:39]
    v_mfma_f32_16x16x32_bf16 v[24:27], v[112:115], a[88:91], v[24:27]
    ds_read_b128 v[128:131], v6 offset:1728
    v_mfma_f32_16x16x32_bf16 v[40:43], v[116:119], a[88:91], v[40:43]
    ds_read_b128 v[132:135], v6 offset:1760
    v_mfma_f32_16x16x32_bf16 v[28:31], v[112:115], a[152:155], v[28:31]
    v_mfma_f32_16x16x32_bf16 v[44:47], v[116:119], a[152:155], v[44:47]
    s_waitcnt lgkmcnt(3)
    v_mfma_f32_16x16x32_bf16 v[20:23], v[120:123], a[20:23], v[20:23]
    s_waitcnt lgkmcnt(2)
    v_mfma_f32_16x16x32_bf16 v[36:39], v[124:127], a[20:23], v[36:39]
    v_mfma_f32_16x16x32_bf16 v[24:27], v[120:123], a[84:87], v[24:27]
    ds_read_b128 v[136:139], v6 offset:1792
    v_mfma_f32_16x16x32_bf16 v[40:43], v[124:127], a[84:87], v[40:43]
    ds_read_b128 v[140:143], v6 offset:1824
    v_mfma_f32_16x16x32_bf16 v[28:31], v[120:123], a[148:151], v[28:31]
    v_mfma_f32_16x16x32_bf16 v[44:47], v[124:127], a[148:151], v[44:47]
    s_waitcnt lgkmcnt(3)
    v_mfma_f32_16x16x32_bf16 v[20:23], v[128:131], a[16:19], v[20:23]
    s_waitcnt lgkmcnt(2)
    v_mfma_f32_16x16x32_bf16 v[36:39], v[132:135], a[16:19], v[36:39]
    v_mfma_f32_16x16x32_bf16 v[24:27], v[128:131], a[80:83], v[24:27]
    ds_read_b128 v[144:147], v6 offset:1856
    v_mfma_f32_16x16x32_bf16 v[40:43], v[132:135], a[80:83], v[40:43]
    ds_read_b128 v[148:151], v6 offset:1888
    v_mfma_f32_16x16x32_bf16 v[28:31], v[128:131], a[144:147], v[28:31]
    v_mfma_f32_16x16x32_bf16 v[44:47], v[132:135], a[144:147], v[44:47]
    s_waitcnt lgkmcnt(3)
    v_mfma_f32_16x16x32_bf16 v[20:23], v[136:139], a[12:15], v[20:23]
    s_waitcnt lgkmcnt(2)
    v_mfma_f32_16x16x32_bf16 v[36:39], v[140:143], a[12:15], v[36:39]
    v_mfma_f32_16x16x32_bf16 v[24:27], v[136:139], a[76:79], v[24:27]
    ds_read_b128 v[152:155], v6 offset:1920
    v_mfma_f32_16x16x32_bf16 v[40:43], v[140:143], a[76:79], v[40:43]
    ds_read_b128 v[156:159], v6 offset:1952
    v_mfma_f32_16x16x32_bf16 v[28:31], v[136:139], a[140:143], v[28:31]
    v_mfma_f32_16x16x32_bf16 v[44:47], v[140:143], a[140:143], v[44:47]
    s_waitcnt lgkmcnt(3)
    v_mfma_f32_16x16x32_bf16 v[20:23], v[144:147], a[8:11], v[20:23]
    s_waitcnt lgkmcnt(2)
    v_mfma_f32_16x16x32_bf16 v[36:39], v[148:151], a[8:11], v[36:39]
    v_mfma_f32_16x16x32_bf16 v[24:27], v[144:147], a[72:75], v[24:27]
    ds_read_b128 v[160:163], v6 offset:1984
    v_mfma_f32_16x16x32_bf16 v[40:43], v[148:151], a[72:75], v[40:43]
    ds_read_b128 v[164:167], v6 offset:2016
    v_mfma_f32_16x16x32_bf16 v[28:31], v[144:147], a[136:139], v[28:31]
    v_mfma_f32_16x16x32_bf16 v[44:47], v[148:151], a[136:139], v[44:47]
    s_waitcnt lgkmcnt(3)
    v_mfma_f32_16x16x32_bf16 v[20:23], v[152:155], a[4:7], v[20:23]
    s_waitcnt lgkmcnt(2)
    v_mfma_f32_16x16x32_bf16 v[36:39], v[156:159], a[4:7], v[36:39]
    v_mfma_f32_16x16x32_bf16 v[24:27], v[152:155], a[68:71], v[24:27]
    ds_read_b128 v[168:171], v6 offset:2048
    v_mfma_f32_16x16x32_bf16 v[40:43], v[156:159], a[68:71], v[40:43]
    ds_read_b128 v[172:175], v6 offset:2080
    v_mfma_f32_16x16x32_bf16 v[28:31], v[152:155], a[132:135], v[28:31]
    s_waitcnt vmcnt(18)
    v_mfma_f32_16x16x32_bf16 v[44:47], v[156:159], a[132:135], v[44:47]
    ds_write_b128 v5, v[188:191] offset:1024
    s_waitcnt lgkmcnt(4)
    v_mfma_f32_16x16x32_bf16 v[20:23], v[160:163], a[0:3], v[20:23]
    ds_read_b128 v[112:115], v6 offset:2112
    s_waitcnt lgkmcnt(4)
    v_mfma_f32_16x16x32_bf16 v[36:39], v[164:167], a[0:3], v[36:39]
    ds_read_b128 v[116:119], v6 offset:2144
    v_mfma_f32_16x16x32_bf16 v[24:27], v[160:163], a[64:67], v[24:27]
    ds_write_b128 v5, v[186:189] offset:17664
    v_mfma_f32_16x16x32_bf16 v[40:43], v[164:167], a[64:67], v[40:43]
    v_mov_b32 v208, v185
    v_mov_b32 v209, v186
    v_mfma_f32_16x16x32_bf16 v[28:31], v[160:163], a[128:131], v[28:31]
    ds_read_b128 v[120:123], v6 offset:2176
    v_mfma_f32_16x16x32_bf16 v[44:47], v[164:167], a[128:131], v[44:47]
    ds_read_b128 v[124:127], v6 offset:2208
    s_waitcnt lgkmcnt(7)
    v_mfma_f32_16x16x32_bf16 v[24:27], v[168:171], a[60:63], v[24:27]
    v_mov_b32 v210, v187
    v_mov_b32 v211, v188
    s_waitcnt lgkmcnt(6)
    v_mfma_f32_16x16x32_bf16 v[40:43], v[172:175], a[60:63], v[40:43]
    ds_write_b128 v5, v[208:211] offset:25984
    v_mfma_f32_16x16x32_bf16 v[28:31], v[168:171], a[124:127], v[28:31]
    ds_read_b128 v[128:131], v6 offset:2240
    v_mfma_f32_16x16x32_bf16 v[44:47], v[172:175], a[124:127], v[44:47]
    ds_read_b128 v[132:135], v6 offset:2272
    s_waitcnt lgkmcnt(7)
    v_mfma_f32_16x16x32_bf16 v[24:27], v[112:115], a[56:59], v[24:27]
    v_mov_b32 v212, v189
    v_mov_b32 v213, v190
    s_waitcnt lgkmcnt(6)
    v_mfma_f32_16x16x32_bf16 v[40:43], v[116:119], a[56:59], v[40:43]
    ds_write_b128 v5, v[210:213] offset:9344
    v_mfma_f32_16x16x32_bf16 v[28:31], v[112:115], a[120:123], v[28:31]
    ds_read_b128 v[136:139], v6 offset:2304
    v_mfma_f32_16x16x32_bf16 v[44:47], v[116:119], a[120:123], v[44:47]
    ds_read_b128 v[140:143], v6 offset:2336
    s_waitcnt lgkmcnt(7)
    v_mfma_f32_16x16x32_bf16 v[24:27], v[120:123], a[52:55], v[24:27]
    v_alignbit_b32 v214, v185, v184, 16
    v_alignbit_b32 v215, v186, v185, 16
    s_waitcnt lgkmcnt(6)
    v_mfma_f32_16x16x32_bf16 v[40:43], v[124:127], a[52:55], v[40:43]
    v_alignbit_b32 v216, v187, v186, 16
    v_alignbit_b32 v217, v188, v187, 16
    v_mfma_f32_16x16x32_bf16 v[28:31], v[120:123], a[116:119], v[28:31]
    ds_read_b128 v[144:147], v6 offset:2368
    v_mfma_f32_16x16x32_bf16 v[44:47], v[124:127], a[116:119], v[44:47]
    ds_read_b128 v[148:151], v6 offset:2400
    s_waitcnt lgkmcnt(6)
    v_mfma_f32_16x16x32_bf16 v[24:27], v[128:131], a[48:51], v[24:27]
    ds_write_b128 v5, v[214:217] offset:30144
    s_waitcnt lgkmcnt(6)
    v_mfma_f32_16x16x32_bf16 v[40:43], v[132:135], a[48:51], v[40:43]
    v_alignbit_b32 v218, v189, v188, 16
    v_alignbit_b32 v219, v190, v189, 16
    v_mfma_f32_16x16x32_bf16 v[28:31], v[128:131], a[112:115], v[28:31]
    ds_read_b128 v[152:155], v6 offset:2432
    v_mfma_f32_16x16x32_bf16 v[44:47], v[132:135], a[112:115], v[44:47]
    ds_read_b128 v[156:159], v6 offset:2464
    s_waitcnt lgkmcnt(6)
    v_mfma_f32_16x16x32_bf16 v[24:27], v[136:139], a[44:47], v[24:27]
    ds_write_b128 v5, v[216:219] offset:13504
    s_waitcnt lgkmcnt(6)
    v_mfma_f32_16x16x32_bf16 v[40:43], v[140:143], a[44:47], v[40:43]
    v_alignbit_b32 v220, v186, v185, 16
    v_alignbit_b32 v221, v187, v186, 16
    v_mfma_f32_16x16x32_bf16 v[28:31], v[136:139], a[108:111], v[28:31]
    ds_read_b128 v[160:163], v6 offset:2496
    v_mfma_f32_16x16x32_bf16 v[44:47], v[140:143], a[108:111], v[44:47]
    ds_read_b128 v[164:167], v6 offset:2528
    s_waitcnt lgkmcnt(7)
    v_mfma_f32_16x16x32_bf16 v[24:27], v[144:147], a[40:43], v[24:27]
    v_alignbit_b32 v222, v188, v187, 16
    v_alignbit_b32 v223, v189, v188, 16
    s_waitcnt lgkmcnt(6)
    v_mfma_f32_16x16x32_bf16 v[40:43], v[148:151], a[40:43], v[40:43]
    ds_write_b128 v5, v[220:223] offset:21824
    v_mfma_f32_16x16x32_bf16 v[28:31], v[144:147], a[104:107], v[28:31]
    ds_read_b128 v[168:171], v6 offset:2560
    v_mfma_f32_16x16x32_bf16 v[44:47], v[148:151], a[104:107], v[44:47]
    ds_read_b128 v[172:175], v6 offset:2592
    s_waitcnt lgkmcnt(7)
    v_mfma_f32_16x16x32_bf16 v[24:27], v[152:155], a[36:39], v[24:27]
    v_alignbit_b32 v224, v190, v189, 16
    v_alignbit_b32 v225, v191, v190, 16
    s_waitcnt lgkmcnt(6)
    v_mfma_f32_16x16x32_bf16 v[40:43], v[156:159], a[36:39], v[40:43]
    ds_write_b128 v5, v[222:225] offset:5184
    v_mfma_f32_16x16x32_bf16 v[28:31], v[152:155], a[100:103], v[28:31]
    ds_read_b128 v[112:115], v6 offset:2624
    v_mfma_f32_16x16x32_bf16 v[44:47], v[156:159], a[100:103], v[44:47]
    ds_read_b128 v[116:119], v6 offset:2656
    s_waitcnt lgkmcnt(7)
    v_mfma_f32_16x16x32_bf16 v[24:27], v[160:163], a[32:35], v[24:27]
    buffer_load_dwordx4 v[184:187], v4, s[28:31], s37 offen offset:1008
    s_waitcnt lgkmcnt(6)
    v_mfma_f32_16x16x32_bf16 v[40:43], v[164:167], a[32:35], v[40:43]
    buffer_load_dwordx4 v[188:191], v4, s[28:31], s37 offen offset:1024
    v_mfma_f32_16x16x32_bf16 v[28:31], v[160:163], a[96:99], v[28:31]
    ds_read_b128 v[120:123], v6 offset:2688
    v_mfma_f32_16x16x32_bf16 v[44:47], v[164:167], a[96:99], v[44:47]
    ds_read_b128 v[124:127], v6 offset:2720
    s_waitcnt lgkmcnt(6)
    v_mfma_f32_16x16x32_bf16 v[24:27], v[168:171], a[28:31], v[24:27]
    s_mov_b32 s36, s37
    s_add_u32 s39, s37, 125829120
    s_add_u32 s37, s37, 4096
    s_min_u32 s37, s37, s33

    s_pack_hh_b32_b16 s40, s64, s64
    v_and_b32 v236, s40, v8
    s_waitcnt lgkmcnt(5)
    v_mfma_f32_16x16x32_bf16 v[40:43], v[172:175], a[28:31], v[40:43]
    v_and_b32 v237, s40, v9
    v_and_b32 v238, s40, v10
    v_mfma_f32_16x16x32_bf16 v[28:31], v[168:171], a[92:95], v[28:31]
    ds_read_b128 v[128:131], v6 offset:2752
    v_mfma_f32_16x16x32_bf16 v[44:47], v[172:175], a[92:95], v[44:47]
    ds_read_b128 v[132:135], v6 offset:2784
    s_waitcnt lgkmcnt(5)
    v_mfma_f32_16x16x32_bf16 v[24:27], v[112:115], a[24:27], v[24:27]
    v_and_b32 v239, s40, v11
    v_and_b32 v240, s40, v12
    s_waitcnt lgkmcnt(4)
    v_mfma_f32_16x16x32_bf16 v[40:43], v[116:119], a[24:27], v[40:43]
    v_and_b32 v241, s40, v13
    v_and_b32 v242, s40, v14
    v_mfma_f32_16x16x32_bf16 v[28:31], v[112:115], a[88:91], v[28:31]
    ds_read_b128 v[136:139], v6 offset:2816
    v_mfma_f32_16x16x32_bf16 v[44:47], v[116:119], a[88:91], v[44:47]
    ds_read_b128 v[140:143], v6 offset:2848
    s_waitcnt lgkmcnt(5)
    v_mfma_f32_16x16x32_bf16 v[24:27], v[120:123], a[20:23], v[24:27]
    v_and_b32 v243, s40, v15
    s_waitcnt lgkmcnt(4)
    v_mfma_f32_16x16x32_bf16 v[40:43], v[124:127], a[20:23], v[40:43]
    v_mfma_f32_16x16x32_bf16 v[28:31], v[120:123], a[84:87], v[28:31]
    ds_read_b128 v[144:147], v6 offset:2880
    v_mfma_f32_16x16x32_bf16 v[44:47], v[124:127], a[84:87], v[44:47]
    ds_read_b128 v[148:151], v6 offset:2912
    s_waitcnt lgkmcnt(5)
    v_mfma_f32_16x16x32_bf16 v[24:27], v[128:131], a[16:19], v[24:27]
    s_waitcnt lgkmcnt(4)
    v_mfma_f32_16x16x32_bf16 v[40:43], v[132:135], a[16:19], v[40:43]
    v_mfma_f32_16x16x32_bf16 v[28:31], v[128:131], a[80:83], v[28:31]
    ds_read_b128 v[152:155], v6 offset:2944
    v_mfma_f32_16x16x32_bf16 v[44:47], v[132:135], a[80:83], v[44:47]
    ds_read_b128 v[156:159], v6 offset:2976
    s_waitcnt lgkmcnt(5)
    v_mfma_f32_16x16x32_bf16 v[24:27], v[136:139], a[12:15], v[24:27]
    s_waitcnt lgkmcnt(4)
    v_mfma_f32_16x16x32_bf16 v[40:43], v[140:143], a[12:15], v[40:43]
    v_mfma_f32_16x16x32_bf16 v[28:31], v[136:139], a[76:79], v[28:31]
    ds_read_b128 v[160:163], v6 offset:3008
    v_mfma_f32_16x16x32_bf16 v[44:47], v[140:143], a[76:79], v[44:47]
    ds_read_b128 v[164:167], v6 offset:3040
    s_waitcnt lgkmcnt(5)
    v_mfma_f32_16x16x32_bf16 v[24:27], v[144:147], a[8:11], v[24:27]
    s_waitcnt lgkmcnt(4)
    v_mfma_f32_16x16x32_bf16 v[40:43], v[148:151], a[8:11], v[40:43]
    v_mfma_f32_16x16x32_bf16 v[28:31], v[144:147], a[72:75], v[28:31]
    ds_read_b128 v[168:171], v6 offset:3072
    v_mfma_f32_16x16x32_bf16 v[44:47], v[148:151], a[72:75], v[44:47]
    ds_read_b128 v[172:175], v6 offset:3104
    s_waitcnt lgkmcnt(5)
    v_mfma_f32_16x16x32_bf16 v[24:27], v[152:155], a[4:7], v[24:27]
    ds_read_b128 v[112:115], v6 offset:3136
    s_waitcnt lgkmcnt(5)
    v_mfma_f32_16x16x32_bf16 v[40:43], v[156:159], a[4:7], v[40:43]
    ds_read_b128 v[116:119], v6 offset:3168
    v_mfma_f32_16x16x32_bf16 v[28:31], v[152:155], a[68:71], v[28:31]
    ds_read_b128 v[120:123], v6 offset:3200
    v_mfma_f32_16x16x32_bf16 v[44:47], v[156:159], a[68:71], v[44:47]
    ds_read_b128 v[124:127], v6 offset:3232
    s_waitcnt lgkmcnt(7)
    v_mfma_f32_16x16x32_bf16 v[24:27], v[160:163], a[0:3], v[24:27]
    ds_read_b128 v[128:131], v6 offset:3264
    s_waitcnt lgkmcnt(7)
    v_mfma_f32_16x16x32_bf16 v[40:43], v[164:167], a[0:3], v[40:43]
    ds_read_b128 v[132:135], v6 offset:3296
    v_mfma_f32_16x16x32_bf16 v[28:31], v[160:163], a[64:67], v[28:31]
    ds_read_b128 v[136:139], v6 offset:3328
    v_mfma_f32_16x16x32_bf16 v[44:47], v[164:167], a[64:67], v[44:47]
    ds_read_b128 v[140:143], v6 offset:3360
    s_waitcnt lgkmcnt(9)
    v_mfma_f32_16x16x32_bf16 v[28:31], v[168:171], a[60:63], v[28:31]
    ds_read_b128 v[144:147], v6 offset:3392
    s_waitcnt lgkmcnt(9)
    v_mfma_f32_16x16x32_bf16 v[44:47], v[172:175], a[60:63], v[44:47]
    ds_read_b128 v[148:151], v6 offset:3424
    s_waitcnt lgkmcnt(9)
    v_mfma_f32_16x16x32_bf16 v[28:31], v[112:115], a[56:59], v[28:31]
    ds_read_b128 v[152:155], v6 offset:3456
    s_waitcnt lgkmcnt(9)
    v_mfma_f32_16x16x32_bf16 v[44:47], v[116:119], a[56:59], v[44:47]
    ds_read_b128 v[156:159], v6 offset:3488
    s_waitcnt lgkmcnt(9)
    v_mfma_f32_16x16x32_bf16 v[28:31], v[120:123], a[52:55], v[28:31]
    ds_read_b128 v[160:163], v6 offset:3520
    s_waitcnt lgkmcnt(9)
    v_mfma_f32_16x16x32_bf16 v[44:47], v[124:127], a[52:55], v[44:47]
    ds_read_b128 v[164:167], v6 offset:3552
    s_waitcnt lgkmcnt(9)
    v_mfma_f32_16x16x32_bf16 v[28:31], v[128:131], a[48:51], v[28:31]
    ds_read_b128 v[168:171], v6 offset:3584
    s_waitcnt lgkmcnt(9)
    v_mfma_f32_16x16x32_bf16 v[44:47], v[132:135], a[48:51], v[44:47]
    ds_read_b128 v[172:175], v6 offset:3616
    s_waitcnt lgkmcnt(9)
    v_mfma_f32_16x16x32_bf16 v[28:31], v[136:139], a[44:47], v[28:31]
    ds_read_b128 v[112:115], v6 offset:3648
    s_waitcnt lgkmcnt(9)
    v_mfma_f32_16x16x32_bf16 v[44:47], v[140:143], a[44:47], v[44:47]
    ds_read_b128 v[116:119], v6 offset:3680
    s_waitcnt lgkmcnt(9)
    v_mfma_f32_16x16x32_bf16 v[28:31], v[144:147], a[40:43], v[28:31]
    ds_read_b128 v[120:123], v6 offset:3712
    s_waitcnt lgkmcnt(9)
    v_mfma_f32_16x16x32_bf16 v[44:47], v[148:151], a[40:43], v[44:47]
    ds_read_b128 v[124:127], v6 offset:3744
    s_waitcnt lgkmcnt(9)
    v_mfma_f32_16x16x32_bf16 v[28:31], v[152:155], a[36:39], v[28:31]
    ds_read_b128 v[128:131], v6 offset:3776
    s_waitcnt lgkmcnt(9)
    v_mfma_f32_16x16x32_bf16 v[44:47], v[156:159], a[36:39], v[44:47]
    ds_read_b128 v[132:135], v6 offset:3808
    s_waitcnt lgkmcnt(9)
    v_mfma_f32_16x16x32_bf16 v[28:31], v[160:163], a[32:35], v[28:31]
    ds_read_b128 v[136:139], v6 offset:3840
    s_waitcnt lgkmcnt(9)
    v_mfma_f32_16x16x32_bf16 v[44:47], v[164:167], a[32:35], v[44:47]
    ds_read_b128 v[140:143], v6 offset:3872
    s_waitcnt lgkmcnt(9)
    v_mfma_f32_16x16x32_bf16 v[28:31], v[168:171], a[28:31], v[28:31]
    ds_read_b128 v[144:147], v6 offset:3904
    s_waitcnt lgkmcnt(9)
    v_mfma_f32_16x16x32_bf16 v[44:47], v[172:175], a[28:31], v[44:47]
    ds_read_b128 v[148:151], v6 offset:3936
    s_waitcnt lgkmcnt(9)
    v_mfma_f32_16x16x32_bf16 v[28:31], v[112:115], a[24:27], v[28:31]
    ds_read_b128 v[152:155], v6 offset:3968
    s_waitcnt lgkmcnt(9)
    v_mfma_f32_16x16x32_bf16 v[44:47], v[116:119], a[24:27], v[44:47]
    ds_read_b128 v[156:159], v6 offset:4000
    s_waitcnt lgkmcnt(9)
    v_mfma_f32_16x16x32_bf16 v[28:31], v[120:123], a[20:23], v[28:31]
    ds_read_b128 v[160:163], v6 offset:4032
    s_waitcnt lgkmcnt(9)
    v_mfma_f32_16x16x32_bf16 v[44:47], v[124:127], a[20:23], v[44:47]
    ds_read_b128 v[164:167], v6 offset:4064
    s_waitcnt lgkmcnt(9)
    v_mfma_f32_16x16x32_bf16 v[28:31], v[128:131], a[16:19], v[28:31]
    s_waitcnt vmcnt(2)
    ds_read_b128 a[60:63], v7 offset:240
    s_waitcnt lgkmcnt(9)
    v_mfma_f32_16x16x32_bf16 v[44:47], v[132:135], a[16:19], v[44:47]
    s_waitcnt lgkmcnt(8)
    v_mfma_f32_16x16x32_bf16 v[28:31], v[136:139], a[12:15], v[28:31]
    ds_read_b128 a[124:127], v7 offset:496
    s_waitcnt lgkmcnt(8)
    v_mfma_f32_16x16x32_bf16 v[44:47], v[140:143], a[12:15], v[44:47]
    s_waitcnt lgkmcnt(7)
    v_mfma_f32_16x16x32_bf16 v[28:31], v[144:147], a[8:11], v[28:31]
    ds_read_b128 a[188:191], v7 offset:752
    s_waitcnt lgkmcnt(7)
    v_mfma_f32_16x16x32_bf16 v[44:47], v[148:151], a[8:11], v[44:47]
    s_waitcnt lgkmcnt(6)
    v_mfma_f32_16x16x32_bf16 v[28:31], v[152:155], a[4:7], v[28:31]
    ds_read_b128 a[252:255], v7 offset:1008
    s_waitcnt lgkmcnt(6)
    v_mfma_f32_16x16x32_bf16 v[44:47], v[156:159], a[4:7], v[44:47]
    s_waitcnt lgkmcnt(5)
    v_mfma_f32_16x16x32_bf16 v[28:31], v[160:163], a[0:3], v[28:31]
    ds_read_b128 v[168:171], v6 offset:0
    s_waitcnt lgkmcnt(5)
    v_mfma_f32_16x16x32_bf16 v[44:47], v[164:167], a[0:3], v[44:47]
    ds_read_b128 v[172:175], v6 offset:32
    s_waitcnt lgkmcnt(5)
    v_mfma_f32_16x16x32_bf16 v[48:51], v[236:239], a[60:63], 0
    v_mfma_f32_16x16x32_bf16 v[64:67], v[240:243], a[60:63], 0
    s_waitcnt lgkmcnt(4)
    v_mfma_f32_16x16x32_bf16 v[52:55], v[236:239], a[124:127], 0
    v_mfma_f32_16x16x32_bf16 v[68:71], v[240:243], a[124:127], 0
    s_waitcnt lgkmcnt(3)
    v_mfma_f32_16x16x32_bf16 v[56:59], v[236:239], a[188:191], 0
    v_mfma_f32_16x16x32_bf16 v[72:75], v[240:243], a[188:191], 0
    ds_read_b128 a[56:59], v7 offset:224
    s_waitcnt lgkmcnt(3)
    v_mfma_f32_16x16x32_bf16 v[60:63], v[236:239], a[252:255], 0
    ds_read_b128 v[112:115], v6 offset:64
    v_mfma_f32_16x16x32_bf16 v[76:79], v[240:243], a[252:255], 0
    ds_read_b128 v[116:119], v6 offset:96
    s_waitcnt lgkmcnt(4)
    v_mfma_f32_16x16x32_bf16 v[48:51], v[168:171], a[60:63], v[48:51]
    ds_read_b128 a[120:123], v7 offset:480
    s_waitcnt lgkmcnt(4)
    v_mfma_f32_16x16x32_bf16 v[64:67], v[172:175], a[60:63], v[64:67]
    s_waitcnt vmcnt(10)
    v_mfma_f32_16x16x32_bf16 v[52:55], v[168:171], a[124:127], v[52:55]
    ds_read_b128 a[184:187], v7 offset:736
    v_mfma_f32_16x16x32_bf16 v[68:71], v[172:175], a[124:127], v[68:71]
    ds_write_b128 v5, v[196:199] offset:2048
    v_mfma_f32_16x16x32_bf16 v[56:59], v[168:171], a[188:191], v[56:59]
    ds_read_b128 a[248:251], v7 offset:992
    v_mfma_f32_16x16x32_bf16 v[72:75], v[172:175], a[188:191], v[72:75]
    ds_read_b128 a[52:55], v7 offset:208
    v_mfma_f32_16x16x32_bf16 v[60:63], v[168:171], a[252:255], v[60:63]
    ds_read_b128 v[120:123], v6 offset:128
    v_mfma_f32_16x16x32_bf16 v[76:79], v[172:175], a[252:255], v[76:79]
    ds_read_b128 v[124:127], v6 offset:160
    s_waitcnt lgkmcnt(8)
    v_mfma_f32_16x16x32_bf16 v[48:51], v[112:115], a[56:59], v[48:51]
    ds_read_b128 a[116:119], v7 offset:464
    s_waitcnt lgkmcnt(8)
    v_mfma_f32_16x16x32_bf16 v[64:67], v[116:119], a[56:59], v[64:67]
    ds_write_b128 v5, v[194:197] offset:18688
    s_waitcnt lgkmcnt(8)
    v_mfma_f32_16x16x32_bf16 v[52:55], v[112:115], a[120:123], v[52:55]
    ds_read_b128 a[180:183], v7 offset:720
    v_mfma_f32_16x16x32_bf16 v[68:71], v[116:119], a[120:123], v[68:71]
    v_mov_b32 v208, v193
    v_mov_b32 v209, v194
    s_waitcnt lgkmcnt(8)
    v_mfma_f32_16x16x32_bf16 v[56:59], v[112:115], a[184:187], v[56:59]
    ds_read_b128 a[244:247], v7 offset:976
    v_mfma_f32_16x16x32_bf16 v[72:75], v[116:119], a[184:187], v[72:75]
    ds_read_b128 a[48:51], v7 offset:192
    s_waitcnt lgkmcnt(8)
    v_mfma_f32_16x16x32_bf16 v[60:63], v[112:115], a[248:251], v[60:63]
    ds_read_b128 v[128:131], v6 offset:192
    v_mfma_f32_16x16x32_bf16 v[76:79], v[116:119], a[248:251], v[76:79]
    ds_read_b128 v[132:135], v6 offset:224
    s_waitcnt lgkmcnt(8)
    v_mfma_f32_16x16x32_bf16 v[48:51], v[120:123], a[52:55], v[48:51]
    ds_read_b128 a[112:115], v7 offset:448
    s_waitcnt lgkmcnt(8)
    v_mfma_f32_16x16x32_bf16 v[64:67], v[124:127], a[52:55], v[64:67]
    v_mov_b32 v210, v195
    v_mov_b32 v211, v196
    s_waitcnt lgkmcnt(7)
    v_mfma_f32_16x16x32_bf16 v[52:55], v[120:123], a[116:119], v[52:55]
    ds_read_b128 a[176:179], v7 offset:704
    v_mfma_f32_16x16x32_bf16 v[68:71], v[124:127], a[116:119], v[68:71]
    ds_write_b128 v5, v[208:211] offset:27008
    s_waitcnt lgkmcnt(7)
    v_mfma_f32_16x16x32_bf16 v[56:59], v[120:123], a[180:183], v[56:59]
    ds_read_b128 a[240:243], v7 offset:960
    v_mfma_f32_16x16x32_bf16 v[72:75], v[124:127], a[180:183], v[72:75]
    ds_read_b128 a[44:47], v7 offset:176
    s_waitcnt lgkmcnt(8)
    v_mfma_f32_16x16x32_bf16 v[60:63], v[120:123], a[244:247], v[60:63]
    ds_read_b128 v[136:139], v6 offset:256
    v_mfma_f32_16x16x32_bf16 v[76:79], v[124:127], a[244:247], v[76:79]
    ds_read_b128 v[140:143], v6 offset:288
    s_waitcnt lgkmcnt(8)
    v_mfma_f32_16x16x32_bf16 v[48:51], v[128:131], a[48:51], v[48:51]
    ds_read_b128 a[108:111], v7 offset:432
    s_waitcnt lgkmcnt(8)
    v_mfma_f32_16x16x32_bf16 v[64:67], v[132:135], a[48:51], v[64:67]
    v_mov_b32 v212, v197
    v_mov_b32 v213, v198
    s_waitcnt lgkmcnt(7)
    v_mfma_f32_16x16x32_bf16 v[52:55], v[128:131], a[112:115], v[52:55]
    ds_read_b128 a[172:175], v7 offset:688
    v_mfma_f32_16x16x32_bf16 v[68:71], v[132:135], a[112:115], v[68:71]
    ds_write_b128 v5, v[210:213] offset:10368
    s_waitcnt lgkmcnt(8)
    v_mfma_f32_16x16x32_bf16 v[56:59], v[128:131], a[176:179], v[56:59]
    ds_read_b128 a[236:239], v7 offset:944
    v_mfma_f32_16x16x32_bf16 v[72:75], v[132:135], a[176:179], v[72:75]
    ds_read_b128 a[40:43], v7 offset:160
    s_waitcnt lgkmcnt(8)
    v_mfma_f32_16x16x32_bf16 v[60:63], v[128:131], a[240:243], v[60:63]
    ds_read_b128 v[144:147], v6 offset:320
    v_mfma_f32_16x16x32_bf16 v[76:79], v[132:135], a[240:243], v[76:79]
    ds_read_b128 v[148:151], v6 offset:352
    s_waitcnt lgkmcnt(8)
    v_mfma_f32_16x16x32_bf16 v[48:51], v[136:139], a[44:47], v[48:51]
    ds_read_b128 a[104:107], v7 offset:416
    s_waitcnt lgkmcnt(8)
    v_mfma_f32_16x16x32_bf16 v[64:67], v[140:143], a[44:47], v[64:67]
    v_alignbit_b32 v214, v193, v192, 16
    v_alignbit_b32 v215, v194, v193, 16
    s_waitcnt lgkmcnt(7)
    v_mfma_f32_16x16x32_bf16 v[52:55], v[136:139], a[108:111], v[52:55]
    ds_read_b128 a[168:171], v7 offset:672
    v_mfma_f32_16x16x32_bf16 v[68:71], v[140:143], a[108:111], v[68:71]
    v_alignbit_b32 v216, v195, v194, 16
    v_alignbit_b32 v217, v196, v195, 16
    s_waitcnt lgkmcnt(7)
    v_mfma_f32_16x16x32_bf16 v[56:59], v[136:139], a[172:175], v[56:59]
    ds_read_b128 a[232:235], v7 offset:928
    v_mfma_f32_16x16x32_bf16 v[72:75], v[140:143], a[172:175], v[72:75]
    ds_read_b128 a[36:39], v7 offset:144
    s_waitcnt lgkmcnt(7)
    v_mfma_f32_16x16x32_bf16 v[60:63], v[136:139], a[236:239], v[60:63]
    ds_read_b128 v[152:155], v6 offset:384
    v_mfma_f32_16x16x32_bf16 v[76:79], v[140:143], a[236:239], v[76:79]
    ds_read_b128 v[156:159], v6 offset:416
    s_waitcnt lgkmcnt(7)
    v_mfma_f32_16x16x32_bf16 v[48:51], v[144:147], a[40:43], v[48:51]
    ds_read_b128 a[100:103], v7 offset:400
    s_waitcnt lgkmcnt(7)
    v_mfma_f32_16x16x32_bf16 v[64:67], v[148:151], a[40:43], v[64:67]
    ds_write_b128 v5, v[214:217] offset:31168
    s_waitcnt lgkmcnt(7)
    v_mfma_f32_16x16x32_bf16 v[52:55], v[144:147], a[104:107], v[52:55]
    ds_read_b128 a[164:167], v7 offset:656
    v_mfma_f32_16x16x32_bf16 v[68:71], v[148:151], a[104:107], v[68:71]
    v_alignbit_b32 v218, v197, v196, 16
    v_alignbit_b32 v219, v198, v197, 16
    s_waitcnt lgkmcnt(7)
    v_mfma_f32_16x16x32_bf16 v[56:59], v[144:147], a[168:171], v[56:59]
    ds_read_b128 a[228:231], v7 offset:912
    v_mfma_f32_16x16x32_bf16 v[72:75], v[148:151], a[168:171], v[72:75]
    ds_read_b128 a[32:35], v7 offset:128
    s_waitcnt lgkmcnt(8)
    v_mfma_f32_16x16x32_bf16 v[60:63], v[144:147], a[232:235], v[60:63]
    ds_read_b128 v[160:163], v6 offset:448
    v_mfma_f32_16x16x32_bf16 v[76:79], v[148:151], a[232:235], v[76:79]
    ds_read_b128 v[164:167], v6 offset:480
    s_waitcnt lgkmcnt(8)
    v_mfma_f32_16x16x32_bf16 v[48:51], v[152:155], a[36:39], v[48:51]
    ds_read_b128 a[96:99], v7 offset:384
    s_waitcnt lgkmcnt(8)
    v_mfma_f32_16x16x32_bf16 v[64:67], v[156:159], a[36:39], v[64:67]
    ds_write_b128 v5, v[216:219] offset:14528
    s_waitcnt lgkmcnt(8)
    v_mfma_f32_16x16x32_bf16 v[52:55], v[152:155], a[100:103], v[52:55]
    ds_read_b128 a[160:163], v7 offset:640
    v_mfma_f32_16x16x32_bf16 v[68:71], v[156:159], a[100:103], v[68:71]
    v_alignbit_b32 v220, v194, v193, 16
    v_alignbit_b32 v221, v195, v194, 16
    s_waitcnt lgkmcnt(7)
    v_mfma_f32_16x16x32_bf16 v[56:59], v[152:155], a[164:167], v[56:59]
    ds_read_b128 a[224:227], v7 offset:896
    v_mfma_f32_16x16x32_bf16 v[72:75], v[156:159], a[164:167], v[72:75]
    ds_read_b128 a[28:31], v7 offset:112
    s_waitcnt lgkmcnt(8)
    v_mfma_f32_16x16x32_bf16 v[60:63], v[152:155], a[228:231], v[60:63]
    ds_read_b128 v[168:171], v6 offset:512
    v_mfma_f32_16x16x32_bf16 v[76:79], v[156:159], a[228:231], v[76:79]
    ds_read_b128 v[172:175], v6 offset:544
    s_waitcnt lgkmcnt(8)
    v_mfma_f32_16x16x32_bf16 v[48:51], v[160:163], a[32:35], v[48:51]
    ds_read_b128 a[92:95], v7 offset:368
    s_waitcnt lgkmcnt(8)
    v_mfma_f32_16x16x32_bf16 v[64:67], v[164:167], a[32:35], v[64:67]
    v_alignbit_b32 v222, v196, v195, 16
    v_alignbit_b32 v223, v197, v196, 16
    s_waitcnt lgkmcnt(7)
    v_mfma_f32_16x16x32_bf16 v[52:55], v[160:163], a[96:99], v[52:55]
    ds_read_b128 a[156:159], v7 offset:624
    v_mfma_f32_16x16x32_bf16 v[68:71], v[164:167], a[96:99], v[68:71]
    ds_write_b128 v5, v[220:223] offset:22848
    s_waitcnt lgkmcnt(7)
    v_mfma_f32_16x16x32_bf16 v[56:59], v[160:163], a[160:163], v[56:59]
    ds_read_b128 a[220:223], v7 offset:880
    v_mfma_f32_16x16x32_bf16 v[72:75], v[164:167], a[160:163], v[72:75]
    ds_read_b128 a[24:27], v7 offset:96
    s_waitcnt lgkmcnt(8)
    v_mfma_f32_16x16x32_bf16 v[60:63], v[160:163], a[224:227], v[60:63]
    ds_read_b128 v[112:115], v6 offset:576
    v_mfma_f32_16x16x32_bf16 v[76:79], v[164:167], a[224:227], v[76:79]
    ds_read_b128 v[116:119], v6 offset:608
    s_waitcnt lgkmcnt(8)
    v_mfma_f32_16x16x32_bf16 v[48:51], v[168:171], a[28:31], v[48:51]
    ds_read_b128 a[88:91], v7 offset:352
    s_waitcnt lgkmcnt(8)
    v_mfma_f32_16x16x32_bf16 v[64:67], v[172:175], a[28:31], v[64:67]
    v_alignbit_b32 v224, v198, v197, 16
    v_alignbit_b32 v225, v199, v198, 16
    s_waitcnt lgkmcnt(7)
    v_mfma_f32_16x16x32_bf16 v[52:55], v[168:171], a[92:95], v[52:55]
    ds_read_b128 a[152:155], v7 offset:608
    v_mfma_f32_16x16x32_bf16 v[68:71], v[172:175], a[92:95], v[68:71]
    ds_write_b128 v5, v[222:225] offset:6208
    s_waitcnt lgkmcnt(8)
    v_mfma_f32_16x16x32_bf16 v[56:59], v[168:171], a[156:159], v[56:59]
    ds_read_b128 a[216:219], v7 offset:864
    v_mfma_f32_16x16x32_bf16 v[72:75], v[172:175], a[156:159], v[72:75]
    ds_read_b128 a[20:23], v7 offset:80
    s_waitcnt lgkmcnt(8)
    v_mfma_f32_16x16x32_bf16 v[60:63], v[168:171], a[220:223], v[60:63]
    ds_read_b128 v[120:123], v6 offset:640
    v_mfma_f32_16x16x32_bf16 v[76:79], v[172:175], a[220:223], v[76:79]
    ds_read_b128 v[124:127], v6 offset:672
    s_waitcnt lgkmcnt(8)
    v_mfma_f32_16x16x32_bf16 v[48:51], v[112:115], a[24:27], v[48:51]
    ds_read_b128 a[84:87], v7 offset:336
    s_waitcnt lgkmcnt(8)
    v_mfma_f32_16x16x32_bf16 v[64:67], v[116:119], a[24:27], v[64:67]
    buffer_load_dwordx4 v[192:195], v4, s[28:31], s36 offen offset:2032
    s_waitcnt lgkmcnt(7)
    v_mfma_f32_16x16x32_bf16 v[52:55], v[112:115], a[88:91], v[52:55]
    ds_read_b128 a[148:151], v7 offset:592
    v_mfma_f32_16x16x32_bf16 v[68:71], v[116:119], a[88:91], v[68:71]
    buffer_load_dwordx4 v[196:199], v4, s[28:31], s36 offen offset:2048
    s_waitcnt lgkmcnt(7)
    v_mfma_f32_16x16x32_bf16 v[56:59], v[112:115], a[152:155], v[56:59]
    ds_read_b128 a[212:215], v7 offset:848
    v_mfma_f32_16x16x32_bf16 v[72:75], v[116:119], a[152:155], v[72:75]
    ds_read_b128 a[16:19], v7 offset:64
    s_waitcnt lgkmcnt(7)
    v_mfma_f32_16x16x32_bf16 v[60:63], v[112:115], a[216:219], v[60:63]
    ds_read_b128 v[128:131], v6 offset:704
    v_mfma_f32_16x16x32_bf16 v[76:79], v[116:119], a[216:219], v[76:79]
    ds_read_b128 v[132:135], v6 offset:736
    s_waitcnt lgkmcnt(7)
    v_mfma_f32_16x16x32_bf16 v[48:51], v[120:123], a[20:23], v[48:51]
    ds_read_b128 a[80:83], v7 offset:320
    s_waitcnt lgkmcnt(7)
    v_mfma_f32_16x16x32_bf16 v[64:67], v[124:127], a[20:23], v[64:67]
    s_waitcnt vmcnt(10)
    s_waitcnt lgkmcnt(6)
    v_mfma_f32_16x16x32_bf16 v[52:55], v[120:123], a[84:87], v[52:55]
    ds_read_b128 a[144:147], v7 offset:576
    v_mfma_f32_16x16x32_bf16 v[68:71], v[124:127], a[84:87], v[68:71]
    ds_write_b128 v5, v[204:207] offset:3072
    s_waitcnt lgkmcnt(7)
    v_mfma_f32_16x16x32_bf16 v[56:59], v[120:123], a[148:151], v[56:59]
    ds_read_b128 a[208:211], v7 offset:832
    v_mfma_f32_16x16x32_bf16 v[72:75], v[124:127], a[148:151], v[72:75]
    ds_read_b128 a[12:15], v7 offset:48
    s_waitcnt lgkmcnt(8)
    v_mfma_f32_16x16x32_bf16 v[60:63], v[120:123], a[212:215], v[60:63]
    ds_read_b128 v[136:139], v6 offset:768
    v_mfma_f32_16x16x32_bf16 v[76:79], v[124:127], a[212:215], v[76:79]
    ds_read_b128 v[140:143], v6 offset:800
    s_waitcnt lgkmcnt(8)
    v_mfma_f32_16x16x32_bf16 v[48:51], v[128:131], a[16:19], v[48:51]
    ds_read_b128 a[76:79], v7 offset:304
    s_waitcnt lgkmcnt(8)
    v_mfma_f32_16x16x32_bf16 v[64:67], v[132:135], a[16:19], v[64:67]
    ds_write_b128 v5, v[202:205] offset:19712
    s_waitcnt lgkmcnt(8)
    v_mfma_f32_16x16x32_bf16 v[52:55], v[128:131], a[80:83], v[52:55]
    ds_read_b128 a[140:143], v7 offset:560
    v_mfma_f32_16x16x32_bf16 v[68:71], v[132:135], a[80:83], v[68:71]
    v_mov_b32 v208, v201
    v_mov_b32 v209, v202
    s_waitcnt lgkmcnt(8)
    v_mfma_f32_16x16x32_bf16 v[56:59], v[128:131], a[144:147], v[56:59]
    ds_read_b128 a[204:207], v7 offset:816
    v_mfma_f32_16x16x32_bf16 v[72:75], v[132:135], a[144:147], v[72:75]
    ds_read_b128 a[8:11], v7 offset:32
    s_waitcnt lgkmcnt(8)
    v_mfma_f32_16x16x32_bf16 v[60:63], v[128:131], a[208:211], v[60:63]
    ds_read_b128 v[144:147], v6 offset:832
    v_mfma_f32_16x16x32_bf16 v[76:79], v[132:135], a[208:211], v[76:79]
    ds_read_b128 v[148:151], v6 offset:864
    s_waitcnt lgkmcnt(8)
    v_mfma_f32_16x16x32_bf16 v[48:51], v[136:139], a[12:15], v[48:51]
    ds_read_b128 a[72:75], v7 offset:288
    s_waitcnt lgkmcnt(8)
    v_mfma_f32_16x16x32_bf16 v[64:67], v[140:143], a[12:15], v[64:67]
    v_mov_b32 v210, v203
    v_mov_b32 v211, v204
    s_waitcnt lgkmcnt(7)
    v_mfma_f32_16x16x32_bf16 v[52:55], v[136:139], a[76:79], v[52:55]
    ds_read_b128 a[136:139], v7 offset:544
    v_mfma_f32_16x16x32_bf16 v[68:71], v[140:143], a[76:79], v[68:71]
    ds_write_b128 v5, v[208:211] offset:28032
    s_waitcnt lgkmcnt(7)
    v_mfma_f32_16x16x32_bf16 v[56:59], v[136:139], a[140:143], v[56:59]
    ds_read_b128 a[200:203], v7 offset:800
    v_mfma_f32_16x16x32_bf16 v[72:75], v[140:143], a[140:143], v[72:75]
    ds_read_b128 a[4:7], v7 offset:16
    s_waitcnt lgkmcnt(8)
    v_mfma_f32_16x16x32_bf16 v[60:63], v[136:139], a[204:207], v[60:63]
    ds_read_b128 v[152:155], v6 offset:896
    v_mfma_f32_16x16x32_bf16 v[76:79], v[140:143], a[204:207], v[76:79]
    ds_read_b128 v[156:159], v6 offset:928
    s_waitcnt lgkmcnt(8)
    v_mfma_f32_16x16x32_bf16 v[48:51], v[144:147], a[8:11], v[48:51]
    ds_read_b128 a[68:71], v7 offset:272
    s_waitcnt lgkmcnt(8)
    v_mfma_f32_16x16x32_bf16 v[64:67], v[148:151], a[8:11], v[64:67]
    v_mov_b32 v212, v205
    v_mov_b32 v213, v206
    s_waitcnt lgkmcnt(7)
    v_mfma_f32_16x16x32_bf16 v[52:55], v[144:147], a[72:75], v[52:55]
    ds_read_b128 a[132:135], v7 offset:528
    v_mfma_f32_16x16x32_bf16 v[68:71], v[148:151], a[72:75], v[68:71]
    ds_write_b128 v5, v[210:213] offset:11392
    s_waitcnt lgkmcnt(8)
    v_mfma_f32_16x16x32_bf16 v[56:59], v[144:147], a[136:139], v[56:59]
    ds_read_b128 a[196:199], v7 offset:784
    v_mfma_f32_16x16x32_bf16 v[72:75], v[148:151], a[136:139], v[72:75]
    ds_read_b128 a[0:3], v7 offset:0
    s_waitcnt lgkmcnt(8)
    v_mfma_f32_16x16x32_bf16 v[60:63], v[144:147], a[200:203], v[60:63]
    ds_read_b128 v[160:163], v6 offset:960
    v_mfma_f32_16x16x32_bf16 v[76:79], v[148:151], a[200:203], v[76:79]
    ds_read_b128 v[164:167], v6 offset:992
    s_waitcnt lgkmcnt(8)
    v_mfma_f32_16x16x32_bf16 v[48:51], v[152:155], a[4:7], v[48:51]
    ds_read_b128 a[64:67], v7 offset:256
    s_waitcnt lgkmcnt(8)
    v_mfma_f32_16x16x32_bf16 v[64:67], v[156:159], a[4:7], v[64:67]
    v_alignbit_b32 v214, v201, v200, 16
    v_alignbit_b32 v215, v202, v201, 16
    s_waitcnt lgkmcnt(7)
    v_mfma_f32_16x16x32_bf16 v[52:55], v[152:155], a[68:71], v[52:55]
    ds_read_b128 a[128:131], v7 offset:512
    v_mfma_f32_16x16x32_bf16 v[68:71], v[156:159], a[68:71], v[68:71]
    v_alignbit_b32 v216, v203, v202, 16
    v_alignbit_b32 v217, v204, v203, 16
    s_waitcnt lgkmcnt(7)
    v_mfma_f32_16x16x32_bf16 v[56:59], v[152:155], a[132:135], v[56:59]
    ds_read_b128 a[192:195], v7 offset:768
    v_mfma_f32_16x16x32_bf16 v[72:75], v[156:159], a[132:135], v[72:75]
    ds_write_b128 v5, v[214:217] offset:32192
    s_waitcnt lgkmcnt(7)
    v_mfma_f32_16x16x32_bf16 v[60:63], v[152:155], a[196:199], v[60:63]
    ds_read_b128 v[168:171], v6 offset:1024
    v_mfma_f32_16x16x32_bf16 v[76:79], v[156:159], a[196:199], v[76:79]
    ds_read_b128 v[172:175], v6 offset:1056
    s_waitcnt lgkmcnt(7)
    v_mfma_f32_16x16x32_bf16 v[48:51], v[160:163], a[0:3], v[48:51]
    v_alignbit_b32 v218, v205, v204, 16
    v_alignbit_b32 v219, v206, v205, 16
    s_waitcnt lgkmcnt(6)
    v_mfma_f32_16x16x32_bf16 v[64:67], v[164:167], a[0:3], v[64:67]
    ds_write_b128 v5, v[216:219] offset:15552
    s_waitcnt lgkmcnt(6)
    v_mfma_f32_16x16x32_bf16 v[52:55], v[160:163], a[64:67], v[52:55]
    v_alignbit_b32 v220, v202, v201, 16
    v_alignbit_b32 v221, v203, v202, 16
    v_mfma_f32_16x16x32_bf16 v[68:71], v[164:167], a[64:67], v[68:71]
    v_alignbit_b32 v222, v204, v203, 16
    v_alignbit_b32 v223, v205, v204, 16
    s_waitcnt lgkmcnt(5)
    v_mfma_f32_16x16x32_bf16 v[56:59], v[160:163], a[128:131], v[56:59]
    ds_read_b128 v[112:115], v6 offset:1088
    v_mfma_f32_16x16x32_bf16 v[72:75], v[164:167], a[128:131], v[72:75]
    ds_read_b128 v[116:119], v6 offset:1120
    s_waitcnt lgkmcnt(6)
    v_mfma_f32_16x16x32_bf16 v[60:63], v[160:163], a[192:195], v[60:63]
    ds_write_b128 v5, v[220:223] offset:23872
    v_mfma_f32_16x16x32_bf16 v[76:79], v[164:167], a[192:195], v[76:79]
    v_alignbit_b32 v224, v206, v205, 16
    v_alignbit_b32 v225, v207, v206, 16
    s_waitcnt lgkmcnt(5)
    v_mfma_f32_16x16x32_bf16 v[52:55], v[168:171], a[60:63], v[52:55]
    ds_write_b128 v5, v[222:225] offset:7232
    s_waitcnt lgkmcnt(5)
    v_mfma_f32_16x16x32_bf16 v[68:71], v[172:175], a[60:63], v[68:71]
    buffer_load_dwordx4 v[200:203], v4, s[28:31], s36 offen offset:3056
    v_mfma_f32_16x16x32_bf16 v[56:59], v[168:171], a[124:127], v[56:59]
    ds_read_b128 v[120:123], v6 offset:1152
    v_mfma_f32_16x16x32_bf16 v[72:75], v[172:175], a[124:127], v[72:75]
    ds_read_b128 v[124:127], v6 offset:1184
    v_mfma_f32_16x16x32_bf16 v[60:63], v[168:171], a[188:191], v[60:63]
    buffer_load_dwordx4 v[204:207], v4, s[28:31], s36 offen offset:3072
    v_mfma_f32_16x16x32_bf16 v[76:79], v[172:175], a[188:191], v[76:79]
    s_waitcnt vmcnt(10)
    s_mov_b64 exec, 1
    v_mov_b32 v176, 0
    v_mov_b32 v177, 0
    v_mov_b32 v178, 0
    v_mov_b32 v179, 0
    s_mov_b64 exec, -1
    s_waitcnt lgkmcnt(5)
    v_mfma_f32_16x16x32_bf16 v[52:55], v[112:115], a[56:59], v[52:55]
    ds_write_b128 v5, v[180:183] offset:0
    s_waitcnt lgkmcnt(5)
    v_mfma_f32_16x16x32_bf16 v[68:71], v[116:119], a[56:59], v[68:71]
    ds_write_b128 v5, v[178:181] offset:16640
    v_mfma_f32_16x16x32_bf16 v[56:59], v[112:115], a[120:123], v[56:59]
    ds_read_b128 v[128:131], v6 offset:1216
    v_mfma_f32_16x16x32_bf16 v[72:75], v[116:119], a[120:123], v[72:75]
    ds_read_b128 v[132:135], v6 offset:1248
    v_mfma_f32_16x16x32_bf16 v[60:63], v[112:115], a[184:187], v[60:63]
    v_mov_b32 v208, v177
    v_mov_b32 v209, v178
    v_mfma_f32_16x16x32_bf16 v[76:79], v[116:119], a[184:187], v[76:79]
    v_mov_b32 v210, v179
    v_mov_b32 v211, v180
    s_waitcnt lgkmcnt(5)
    v_mfma_f32_16x16x32_bf16 v[52:55], v[120:123], a[52:55], v[52:55]
    ds_write_b128 v5, v[208:211] offset:24960
    s_waitcnt lgkmcnt(5)
    v_mfma_f32_16x16x32_bf16 v[68:71], v[124:127], a[52:55], v[68:71]
    v_mov_b32 v212, v181
    v_mov_b32 v213, v182
    v_mfma_f32_16x16x32_bf16 v[56:59], v[120:123], a[116:119], v[56:59]
    ds_read_b128 v[136:139], v6 offset:1280
    v_mfma_f32_16x16x32_bf16 v[72:75], v[124:127], a[116:119], v[72:75]
    ds_read_b128 v[140:143], v6 offset:1312
    v_mfma_f32_16x16x32_bf16 v[60:63], v[120:123], a[180:183], v[60:63]
    ds_write_b128 v5, v[210:213] offset:8320
    v_mfma_f32_16x16x32_bf16 v[76:79], v[124:127], a[180:183], v[76:79]
    v_alignbit_b32 v214, v177, v176, 16
    v_alignbit_b32 v215, v178, v177, 16
    s_waitcnt lgkmcnt(5)
    v_mfma_f32_16x16x32_bf16 v[52:55], v[128:131], a[48:51], v[52:55]
    v_alignbit_b32 v216, v179, v178, 16
    v_alignbit_b32 v217, v180, v179, 16
    s_waitcnt lgkmcnt(4)
    v_mfma_f32_16x16x32_bf16 v[68:71], v[132:135], a[48:51], v[68:71]
    ds_write_b128 v5, v[214:217] offset:29120
    v_mfma_f32_16x16x32_bf16 v[56:59], v[128:131], a[112:115], v[56:59]
    ds_read_b128 v[144:147], v6 offset:1344
    v_mfma_f32_16x16x32_bf16 v[72:75], v[132:135], a[112:115], v[72:75]
    ds_read_b128 v[148:151], v6 offset:1376
    v_mfma_f32_16x16x32_bf16 v[60:63], v[128:131], a[176:179], v[60:63]
    v_alignbit_b32 v218, v181, v180, 16
    v_alignbit_b32 v219, v182, v181, 16
    v_mfma_f32_16x16x32_bf16 v[76:79], v[132:135], a[176:179], v[76:79]
    ds_write_b128 v5, v[216:219] offset:12480
    s_waitcnt lgkmcnt(6)
    v_mfma_f32_16x16x32_bf16 v[52:55], v[136:139], a[44:47], v[52:55]
    v_alignbit_b32 v220, v178, v177, 16
    v_alignbit_b32 v221, v179, v178, 16
    s_waitcnt lgkmcnt(5)
    v_mfma_f32_16x16x32_bf16 v[68:71], v[140:143], a[44:47], v[68:71]
    v_alignbit_b32 v222, v180, v179, 16
    v_alignbit_b32 v223, v181, v180, 16
    v_mfma_f32_16x16x32_bf16 v[56:59], v[136:139], a[108:111], v[56:59]
    ds_read_b128 v[152:155], v6 offset:1408
    v_mfma_f32_16x16x32_bf16 v[72:75], v[140:143], a[108:111], v[72:75]
    ds_read_b128 v[156:159], v6 offset:1440
    v_mfma_f32_16x16x32_bf16 v[60:63], v[136:139], a[172:175], v[60:63]
    ds_write_b128 v5, v[220:223] offset:20800
    v_mfma_f32_16x16x32_bf16 v[76:79], v[140:143], a[172:175], v[76:79]
    v_alignbit_b32 v224, v182, v181, 16
    v_alignbit_b32 v225, v183, v182, 16
    s_waitcnt lgkmcnt(5)
    v_mfma_f32_16x16x32_bf16 v[52:55], v[144:147], a[40:43], v[52:55]
    ds_write_b128 v5, v[222:225] offset:4160
    s_waitcnt lgkmcnt(5)
    v_mfma_f32_16x16x32_bf16 v[68:71], v[148:151], a[40:43], v[68:71]
    buffer_load_dwordx4 v[176:179], v230, s[28:31], s37 offen offset:0
    v_mfma_f32_16x16x32_bf16 v[56:59], v[144:147], a[104:107], v[56:59]
    ds_read_b128 v[160:163], v6 offset:1472
    v_mfma_f32_16x16x32_bf16 v[72:75], v[148:151], a[104:107], v[72:75]
    ds_read_b128 v[164:167], v6 offset:1504
    v_mfma_f32_16x16x32_bf16 v[60:63], v[144:147], a[168:171], v[60:63]
    buffer_load_dwordx4 v[180:183], v4, s[28:31], s37 offen offset:0
    v_mfma_f32_16x16x32_bf16 v[76:79], v[148:151], a[168:171], v[76:79]
    s_add_u32 m0, s35, 0
    s_waitcnt lgkmcnt(5)
    v_mfma_f32_16x16x32_bf16 v[52:55], v[152:155], a[36:39], v[52:55]
    buffer_load_dwordx4 v4, s[8:11], s39 offen offset:0 lds
    s_waitcnt lgkmcnt(4)
    v_mfma_f32_16x16x32_bf16 v[68:71], v[156:159], a[36:39], v[68:71]
    s_add_u32 m0, s35, 256
    v_mfma_f32_16x16x32_bf16 v[56:59], v[152:155], a[100:103], v[56:59]
    ds_read_b128 v[168:171], v6 offset:1536
    v_mfma_f32_16x16x32_bf16 v[72:75], v[156:159], a[100:103], v[72:75]
    ds_read_b128 v[172:175], v6 offset:1568
    v_mfma_f32_16x16x32_bf16 v[60:63], v[152:155], a[164:167], v[60:63]
    buffer_load_dwordx4 v4, s[8:11], s39 offen offset:1024 lds
    v_mfma_f32_16x16x32_bf16 v[76:79], v[156:159], a[164:167], v[76:79]
    s_add_u32 m0, s35, 512
    s_waitcnt lgkmcnt(3)
    v_mfma_f32_16x16x32_bf16 v[52:55], v[160:163], a[32:35], v[52:55]
    buffer_load_dwordx4 v4, s[8:11], s39 offen offset:2048 lds
    s_waitcnt lgkmcnt(2)
    v_mfma_f32_16x16x32_bf16 v[68:71], v[164:167], a[32:35], v[68:71]
    s_add_u32 m0, s35, 768
    v_mfma_f32_16x16x32_bf16 v[56:59], v[160:163], a[96:99], v[56:59]
    ds_read_b128 v[112:115], v6 offset:1600
    v_mfma_f32_16x16x32_bf16 v[72:75], v[164:167], a[96:99], v[72:75]
    ds_read_b128 v[116:119], v6 offset:1632
    v_mfma_f32_16x16x32_bf16 v[60:63], v[160:163], a[160:163], v[60:63]
    buffer_load_dwordx4 v4, s[8:11], s39 offen offset:3072 lds
    v_mfma_f32_16x16x32_bf16 v[76:79], v[164:167], a[160:163], v[76:79]
    s_waitcnt lgkmcnt(3)
    v_mfma_f32_16x16x32_bf16 v[52:55], v[168:171], a[28:31], v[52:55]
    s_waitcnt lgkmcnt(2)
    v_mfma_f32_16x16x32_bf16 v[68:71], v[172:175], a[28:31], v[68:71]
    v_mfma_f32_16x16x32_bf16 v[56:59], v[168:171], a[92:95], v[56:59]
    ds_read_b128 v[120:123], v6 offset:1664
    v_mfma_f32_16x16x32_bf16 v[72:75], v[172:175], a[92:95], v[72:75]
    ds_read_b128 v[124:127], v6 offset:1696
    v_mfma_f32_16x16x32_bf16 v[60:63], v[168:171], a[156:159], v[60:63]
    v_mfma_f32_16x16x32_bf16 v[76:79], v[172:175], a[156:159], v[76:79]
    s_waitcnt lgkmcnt(3)
    v_mfma_f32_16x16x32_bf16 v[52:55], v[112:115], a[24:27], v[52:55]
    s_waitcnt lgkmcnt(2)
    v_mfma_f32_16x16x32_bf16 v[68:71], v[116:119], a[24:27], v[68:71]
    v_mfma_f32_16x16x32_bf16 v[56:59], v[112:115], a[88:91], v[56:59]
    ds_read_b128 v[128:131], v6 offset:1728
    v_mfma_f32_16x16x32_bf16 v[72:75], v[116:119], a[88:91], v[72:75]
    ds_read_b128 v[132:135], v6 offset:1760
    v_mfma_f32_16x16x32_bf16 v[60:63], v[112:115], a[152:155], v[60:63]
    v_mfma_f32_16x16x32_bf16 v[76:79], v[116:119], a[152:155], v[76:79]
    s_waitcnt lgkmcnt(3)
    v_mfma_f32_16x16x32_bf16 v[52:55], v[120:123], a[20:23], v[52:55]
    s_waitcnt lgkmcnt(2)
    v_mfma_f32_16x16x32_bf16 v[68:71], v[124:127], a[20:23], v[68:71]
    v_mfma_f32_16x16x32_bf16 v[56:59], v[120:123], a[84:87], v[56:59]
    ds_read_b128 v[136:139], v6 offset:1792
    v_mfma_f32_16x16x32_bf16 v[72:75], v[124:127], a[84:87], v[72:75]
    ds_read_b128 v[140:143], v6 offset:1824
    v_mfma_f32_16x16x32_bf16 v[60:63], v[120:123], a[148:151], v[60:63]
    v_mfma_f32_16x16x32_bf16 v[76:79], v[124:127], a[148:151], v[76:79]
    s_waitcnt lgkmcnt(3)
    v_mfma_f32_16x16x32_bf16 v[52:55], v[128:131], a[16:19], v[52:55]
    s_waitcnt lgkmcnt(2)
    v_mfma_f32_16x16x32_bf16 v[68:71], v[132:135], a[16:19], v[68:71]
    v_mfma_f32_16x16x32_bf16 v[56:59], v[128:131], a[80:83], v[56:59]
    ds_read_b128 v[144:147], v6 offset:1856
    v_mfma_f32_16x16x32_bf16 v[72:75], v[132:135], a[80:83], v[72:75]
    ds_read_b128 v[148:151], v6 offset:1888
    v_mfma_f32_16x16x32_bf16 v[60:63], v[128:131], a[144:147], v[60:63]
    v_mfma_f32_16x16x32_bf16 v[76:79], v[132:135], a[144:147], v[76:79]
    s_waitcnt lgkmcnt(3)
    v_mfma_f32_16x16x32_bf16 v[52:55], v[136:139], a[12:15], v[52:55]
    s_waitcnt lgkmcnt(2)
    v_mfma_f32_16x16x32_bf16 v[68:71], v[140:143], a[12:15], v[68:71]
    v_mfma_f32_16x16x32_bf16 v[56:59], v[136:139], a[76:79], v[56:59]
    ds_read_b128 v[152:155], v6 offset:1920
    v_mfma_f32_16x16x32_bf16 v[72:75], v[140:143], a[76:79], v[72:75]
    ds_read_b128 v[156:159], v6 offset:1952
    v_mfma_f32_16x16x32_bf16 v[60:63], v[136:139], a[140:143], v[60:63]
    v_mfma_f32_16x16x32_bf16 v[76:79], v[140:143], a[140:143], v[76:79]
    s_waitcnt lgkmcnt(3)
    v_mfma_f32_16x16x32_bf16 v[52:55], v[144:147], a[8:11], v[52:55]
    s_waitcnt lgkmcnt(2)
    v_mfma_f32_16x16x32_bf16 v[68:71], v[148:151], a[8:11], v[68:71]
    v_mfma_f32_16x16x32_bf16 v[56:59], v[144:147], a[72:75], v[56:59]
    ds_read_b128 v[160:163], v6 offset:1984
    v_mfma_f32_16x16x32_bf16 v[72:75], v[148:151], a[72:75], v[72:75]
    ds_read_b128 v[164:167], v6 offset:2016
    v_mfma_f32_16x16x32_bf16 v[60:63], v[144:147], a[136:139], v[60:63]
    v_mfma_f32_16x16x32_bf16 v[76:79], v[148:151], a[136:139], v[76:79]
    s_waitcnt lgkmcnt(3)
    v_mfma_f32_16x16x32_bf16 v[52:55], v[152:155], a[4:7], v[52:55]
    s_waitcnt lgkmcnt(2)
    v_mfma_f32_16x16x32_bf16 v[68:71], v[156:159], a[4:7], v[68:71]
    v_mfma_f32_16x16x32_bf16 v[56:59], v[152:155], a[68:71], v[56:59]
    ds_read_b128 v[168:171], v6 offset:2048
    v_mfma_f32_16x16x32_bf16 v[72:75], v[156:159], a[68:71], v[72:75]
    ds_read_b128 v[172:175], v6 offset:2080
    v_mfma_f32_16x16x32_bf16 v[60:63], v[152:155], a[132:135], v[60:63]
    s_waitcnt vmcnt(10)
    v_mfma_f32_16x16x32_bf16 v[76:79], v[156:159], a[132:135], v[76:79]
    ds_write_b128 v5, v[188:191] offset:1024
    s_waitcnt lgkmcnt(4)
    v_mfma_f32_16x16x32_bf16 v[52:55], v[160:163], a[0:3], v[52:55]
    ds_read_b128 v[112:115], v6 offset:2112
    s_waitcnt lgkmcnt(4)
    v_mfma_f32_16x16x32_bf16 v[68:71], v[164:167], a[0:3], v[68:71]
    ds_read_b128 v[116:119], v6 offset:2144
    v_mfma_f32_16x16x32_bf16 v[56:59], v[160:163], a[64:67], v[56:59]
    ds_write_b128 v5, v[186:189] offset:17664
    v_mfma_f32_16x16x32_bf16 v[72:75], v[164:167], a[64:67], v[72:75]
    v_mov_b32 v208, v185
    v_mov_b32 v209, v186
    v_mfma_f32_16x16x32_bf16 v[60:63], v[160:163], a[128:131], v[60:63]
    ds_read_b128 v[120:123], v6 offset:2176
    v_mfma_f32_16x16x32_bf16 v[76:79], v[164:167], a[128:131], v[76:79]
    ds_read_b128 v[124:127], v6 offset:2208
    s_waitcnt lgkmcnt(7)
    v_mfma_f32_16x16x32_bf16 v[56:59], v[168:171], a[60:63], v[56:59]
    v_mov_b32 v210, v187
    v_mov_b32 v211, v188
    s_waitcnt lgkmcnt(6)
    v_mfma_f32_16x16x32_bf16 v[72:75], v[172:175], a[60:63], v[72:75]
    ds_write_b128 v5, v[208:211] offset:25984
    v_mfma_f32_16x16x32_bf16 v[60:63], v[168:171], a[124:127], v[60:63]
    ds_read_b128 v[128:131], v6 offset:2240
    v_mfma_f32_16x16x32_bf16 v[76:79], v[172:175], a[124:127], v[76:79]
    ds_read_b128 v[132:135], v6 offset:2272
    s_waitcnt lgkmcnt(7)
    v_mfma_f32_16x16x32_bf16 v[56:59], v[112:115], a[56:59], v[56:59]
    v_mov_b32 v212, v189
    v_mov_b32 v213, v190
    s_waitcnt lgkmcnt(6)
    v_mfma_f32_16x16x32_bf16 v[72:75], v[116:119], a[56:59], v[72:75]
    ds_write_b128 v5, v[210:213] offset:9344
    v_mfma_f32_16x16x32_bf16 v[60:63], v[112:115], a[120:123], v[60:63]
    ds_read_b128 v[136:139], v6 offset:2304
    v_mfma_f32_16x16x32_bf16 v[76:79], v[116:119], a[120:123], v[76:79]
    ds_read_b128 v[140:143], v6 offset:2336
    s_waitcnt lgkmcnt(7)
    v_mfma_f32_16x16x32_bf16 v[56:59], v[120:123], a[52:55], v[56:59]
    v_alignbit_b32 v214, v185, v184, 16
    v_alignbit_b32 v215, v186, v185, 16
    s_waitcnt lgkmcnt(6)
    v_mfma_f32_16x16x32_bf16 v[72:75], v[124:127], a[52:55], v[72:75]
    v_alignbit_b32 v216, v187, v186, 16
    v_alignbit_b32 v217, v188, v187, 16
    v_mfma_f32_16x16x32_bf16 v[60:63], v[120:123], a[116:119], v[60:63]
    ds_read_b128 v[144:147], v6 offset:2368
    v_mfma_f32_16x16x32_bf16 v[76:79], v[124:127], a[116:119], v[76:79]
    ds_read_b128 v[148:151], v6 offset:2400
    s_waitcnt lgkmcnt(6)
    v_mfma_f32_16x16x32_bf16 v[56:59], v[128:131], a[48:51], v[56:59]
    ds_write_b128 v5, v[214:217] offset:30144
    s_waitcnt lgkmcnt(6)
    v_mfma_f32_16x16x32_bf16 v[72:75], v[132:135], a[48:51], v[72:75]
    v_alignbit_b32 v218, v189, v188, 16
    v_alignbit_b32 v219, v190, v189, 16
    v_mfma_f32_16x16x32_bf16 v[60:63], v[128:131], a[112:115], v[60:63]
    ds_read_b128 v[152:155], v6 offset:2432
    v_mfma_f32_16x16x32_bf16 v[76:79], v[132:135], a[112:115], v[76:79]
    ds_read_b128 v[156:159], v6 offset:2464
    s_waitcnt lgkmcnt(6)
    v_mfma_f32_16x16x32_bf16 v[56:59], v[136:139], a[44:47], v[56:59]
    ds_write_b128 v5, v[216:219] offset:13504
    s_waitcnt lgkmcnt(6)
    v_mfma_f32_16x16x32_bf16 v[72:75], v[140:143], a[44:47], v[72:75]
    v_alignbit_b32 v220, v186, v185, 16
    v_alignbit_b32 v221, v187, v186, 16
    v_mfma_f32_16x16x32_bf16 v[60:63], v[136:139], a[108:111], v[60:63]
    ds_read_b128 v[160:163], v6 offset:2496
    v_mfma_f32_16x16x32_bf16 v[76:79], v[140:143], a[108:111], v[76:79]
    ds_read_b128 v[164:167], v6 offset:2528
    s_waitcnt lgkmcnt(7)
    v_mfma_f32_16x16x32_bf16 v[56:59], v[144:147], a[40:43], v[56:59]
    v_alignbit_b32 v222, v188, v187, 16
    v_alignbit_b32 v223, v189, v188, 16
    s_waitcnt lgkmcnt(6)
    v_mfma_f32_16x16x32_bf16 v[72:75], v[148:151], a[40:43], v[72:75]
    ds_write_b128 v5, v[220:223] offset:21824
    v_mfma_f32_16x16x32_bf16 v[60:63], v[144:147], a[104:107], v[60:63]
    ds_read_b128 v[168:171], v6 offset:2560
    v_mfma_f32_16x16x32_bf16 v[76:79], v[148:151], a[104:107], v[76:79]
    ds_read_b128 v[172:175], v6 offset:2592
    s_waitcnt lgkmcnt(7)
    v_mfma_f32_16x16x32_bf16 v[56:59], v[152:155], a[36:39], v[56:59]
    v_alignbit_b32 v224, v190, v189, 16
    v_alignbit_b32 v225, v191, v190, 16
    s_waitcnt lgkmcnt(6)
    v_mfma_f32_16x16x32_bf16 v[72:75], v[156:159], a[36:39], v[72:75]
    ds_write_b128 v5, v[222:225] offset:5184
    v_mfma_f32_16x16x32_bf16 v[60:63], v[152:155], a[100:103], v[60:63]
    ds_read_b128 v[112:115], v6 offset:2624
    v_mfma_f32_16x16x32_bf16 v[76:79], v[156:159], a[100:103], v[76:79]
    ds_read_b128 v[116:119], v6 offset:2656
    s_waitcnt lgkmcnt(7)
    v_mfma_f32_16x16x32_bf16 v[56:59], v[160:163], a[32:35], v[56:59]
    buffer_load_dwordx4 v[184:187], v4, s[28:31], s37 offen offset:1008
    s_waitcnt lgkmcnt(6)
    v_mfma_f32_16x16x32_bf16 v[72:75], v[164:167], a[32:35], v[72:75]
    buffer_load_dwordx4 v[188:191], v4, s[28:31], s37 offen offset:1024
    v_mfma_f32_16x16x32_bf16 v[60:63], v[160:163], a[96:99], v[60:63]
    ds_read_b128 v[120:123], v6 offset:2688
    v_mfma_f32_16x16x32_bf16 v[76:79], v[164:167], a[96:99], v[76:79]
    ds_read_b128 v[124:127], v6 offset:2720
    s_waitcnt lgkmcnt(6)
    v_mfma_f32_16x16x32_bf16 v[56:59], v[168:171], a[28:31], v[56:59]
    s_mov_b32 s36, s37
    s_add_u32 s39, s37, 125829120
    s_add_u32 s37, s37, 4096
    s_min_u32 s37, s37, s33

    s_pack_ll_b32_b16 s40, s65, s65
    s_mov_b32 s64, s65
    s_mov_b32 s65, s66
    s_mov_b32 s66, s67
    v_and_b32 v236, s40, v8
    s_waitcnt lgkmcnt(5)
    v_mfma_f32_16x16x32_bf16 v[72:75], v[172:175], a[28:31], v[72:75]
    v_and_b32 v237, s40, v9
    v_and_b32 v238, s40, v10
    v_mfma_f32_16x16x32_bf16 v[60:63], v[168:171], a[92:95], v[60:63]
    ds_read_b128 v[128:131], v6 offset:2752
    v_mfma_f32_16x16x32_bf16 v[76:79], v[172:175], a[92:95], v[76:79]
    ds_read_b128 v[132:135], v6 offset:2784
    s_waitcnt lgkmcnt(5)
    v_mfma_f32_16x16x32_bf16 v[56:59], v[112:115], a[24:27], v[56:59]
    v_and_b32 v239, s40, v11
    v_and_b32 v240, s40, v12
    s_waitcnt lgkmcnt(4)
    v_mfma_f32_16x16x32_bf16 v[72:75], v[116:119], a[24:27], v[72:75]
    v_and_b32 v241, s40, v13
    v_and_b32 v242, s40, v14
    v_mfma_f32_16x16x32_bf16 v[60:63], v[112:115], a[88:91], v[60:63]
    ds_read_b128 v[136:139], v6 offset:2816
    v_mfma_f32_16x16x32_bf16 v[76:79], v[116:119], a[88:91], v[76:79]
    ds_read_b128 v[140:143], v6 offset:2848
    s_waitcnt lgkmcnt(5)
    v_mfma_f32_16x16x32_bf16 v[56:59], v[120:123], a[20:23], v[56:59]
    v_and_b32 v243, s40, v15
    s_waitcnt lgkmcnt(4)
    v_mfma_f32_16x16x32_bf16 v[72:75], v[124:127], a[20:23], v[72:75]
    v_mfma_f32_16x16x32_bf16 v[60:63], v[120:123], a[84:87], v[60:63]
    ds_read_b128 v[144:147], v6 offset:2880
    v_mfma_f32_16x16x32_bf16 v[76:79], v[124:127], a[84:87], v[76:79]
    ds_read_b128 v[148:151], v6 offset:2912
    s_waitcnt lgkmcnt(5)
    v_mfma_f32_16x16x32_bf16 v[56:59], v[128:131], a[16:19], v[56:59]
    s_waitcnt lgkmcnt(4)
    v_mfma_f32_16x16x32_bf16 v[72:75], v[132:135], a[16:19], v[72:75]
    v_mfma_f32_16x16x32_bf16 v[60:63], v[128:131], a[80:83], v[60:63]
    ds_read_b128 v[152:155], v6 offset:2944
    v_mfma_f32_16x16x32_bf16 v[76:79], v[132:135], a[80:83], v[76:79]
    ds_read_b128 v[156:159], v6 offset:2976
    s_waitcnt lgkmcnt(5)
    v_mfma_f32_16x16x32_bf16 v[56:59], v[136:139], a[12:15], v[56:59]
    s_waitcnt lgkmcnt(4)
    v_mfma_f32_16x16x32_bf16 v[72:75], v[140:143], a[12:15], v[72:75]
    v_mfma_f32_16x16x32_bf16 v[60:63], v[136:139], a[76:79], v[60:63]
    ds_read_b128 v[160:163], v6 offset:3008
    v_mfma_f32_16x16x32_bf16 v[76:79], v[140:143], a[76:79], v[76:79]
    ds_read_b128 v[164:167], v6 offset:3040
    s_waitcnt lgkmcnt(5)
    v_mfma_f32_16x16x32_bf16 v[56:59], v[144:147], a[8:11], v[56:59]
    s_waitcnt lgkmcnt(4)
    v_mfma_f32_16x16x32_bf16 v[72:75], v[148:151], a[8:11], v[72:75]
    v_mfma_f32_16x16x32_bf16 v[60:63], v[144:147], a[72:75], v[60:63]
    ds_read_b128 v[168:171], v6 offset:3072
    v_mfma_f32_16x16x32_bf16 v[76:79], v[148:151], a[72:75], v[76:79]
    ds_read_b128 v[172:175], v6 offset:3104
    s_waitcnt lgkmcnt(5)
    v_mfma_f32_16x16x32_bf16 v[56:59], v[152:155], a[4:7], v[56:59]
    ds_read_b128 v[112:115], v6 offset:3136
    s_waitcnt lgkmcnt(5)
    v_mfma_f32_16x16x32_bf16 v[72:75], v[156:159], a[4:7], v[72:75]
    ds_read_b128 v[116:119], v6 offset:3168
    v_mfma_f32_16x16x32_bf16 v[60:63], v[152:155], a[68:71], v[60:63]
    ds_read_b128 v[120:123], v6 offset:3200
    v_mfma_f32_16x16x32_bf16 v[76:79], v[156:159], a[68:71], v[76:79]
    ds_read_b128 v[124:127], v6 offset:3232
    s_waitcnt lgkmcnt(7)
    v_mfma_f32_16x16x32_bf16 v[56:59], v[160:163], a[0:3], v[56:59]
    ds_read_b128 v[128:131], v6 offset:3264
    s_waitcnt lgkmcnt(7)
    v_mfma_f32_16x16x32_bf16 v[72:75], v[164:167], a[0:3], v[72:75]
    ds_read_b128 v[132:135], v6 offset:3296
    v_mfma_f32_16x16x32_bf16 v[60:63], v[160:163], a[64:67], v[60:63]
    ds_read_b128 v[136:139], v6 offset:3328
    v_mfma_f32_16x16x32_bf16 v[76:79], v[164:167], a[64:67], v[76:79]
    ds_read_b128 v[140:143], v6 offset:3360
    s_waitcnt lgkmcnt(9)
    v_mfma_f32_16x16x32_bf16 v[60:63], v[168:171], a[60:63], v[60:63]
    ds_read_b128 v[144:147], v6 offset:3392
    s_waitcnt lgkmcnt(9)
    v_mfma_f32_16x16x32_bf16 v[76:79], v[172:175], a[60:63], v[76:79]
    ds_read_b128 v[148:151], v6 offset:3424
    s_waitcnt lgkmcnt(9)
    v_mfma_f32_16x16x32_bf16 v[60:63], v[112:115], a[56:59], v[60:63]
    ds_read_b128 v[152:155], v6 offset:3456
    s_waitcnt lgkmcnt(9)
    v_mfma_f32_16x16x32_bf16 v[76:79], v[116:119], a[56:59], v[76:79]
    ds_read_b128 v[156:159], v6 offset:3488
    s_waitcnt lgkmcnt(9)
    v_mfma_f32_16x16x32_bf16 v[60:63], v[120:123], a[52:55], v[60:63]
    ds_read_b128 v[160:163], v6 offset:3520
    s_waitcnt lgkmcnt(9)
    v_mfma_f32_16x16x32_bf16 v[76:79], v[124:127], a[52:55], v[76:79]
    ds_read_b128 v[164:167], v6 offset:3552
    s_waitcnt lgkmcnt(9)
    v_mfma_f32_16x16x32_bf16 v[60:63], v[128:131], a[48:51], v[60:63]
    ds_read_b128 v[168:171], v6 offset:3584
    s_waitcnt lgkmcnt(9)
    v_mfma_f32_16x16x32_bf16 v[76:79], v[132:135], a[48:51], v[76:79]
    ds_read_b128 v[172:175], v6 offset:3616
    s_waitcnt lgkmcnt(9)
    v_mfma_f32_16x16x32_bf16 v[60:63], v[136:139], a[44:47], v[60:63]
    ds_read_b128 v[112:115], v6 offset:3648
    s_waitcnt lgkmcnt(9)
    v_mfma_f32_16x16x32_bf16 v[76:79], v[140:143], a[44:47], v[76:79]
    ds_read_b128 v[116:119], v6 offset:3680
    s_waitcnt lgkmcnt(9)
    v_mfma_f32_16x16x32_bf16 v[60:63], v[144:147], a[40:43], v[60:63]
    ds_read_b128 v[120:123], v6 offset:3712
    s_waitcnt lgkmcnt(9)
    v_mfma_f32_16x16x32_bf16 v[76:79], v[148:151], a[40:43], v[76:79]
    ds_read_b128 v[124:127], v6 offset:3744
    s_waitcnt lgkmcnt(9)
    v_mfma_f32_16x16x32_bf16 v[60:63], v[152:155], a[36:39], v[60:63]
    ds_read_b128 v[128:131], v6 offset:3776
    s_waitcnt lgkmcnt(9)
    v_mfma_f32_16x16x32_bf16 v[76:79], v[156:159], a[36:39], v[76:79]
    ds_read_b128 v[132:135], v6 offset:3808
    s_waitcnt lgkmcnt(9)
    v_mfma_f32_16x16x32_bf16 v[60:63], v[160:163], a[32:35], v[60:63]
    ds_read_b128 v[136:139], v6 offset:3840
    s_waitcnt lgkmcnt(9)
    v_mfma_f32_16x16x32_bf16 v[76:79], v[164:167], a[32:35], v[76:79]
    ds_read_b128 v[140:143], v6 offset:3872
    s_waitcnt lgkmcnt(9)
    v_mfma_f32_16x16x32_bf16 v[60:63], v[168:171], a[28:31], v[60:63]
    ds_read_b128 v[144:147], v6 offset:3904
    s_waitcnt lgkmcnt(9)
    v_mfma_f32_16x16x32_bf16 v[76:79], v[172:175], a[28:31], v[76:79]
    ds_read_b128 v[148:151], v6 offset:3936
    s_waitcnt lgkmcnt(9)
    v_mfma_f32_16x16x32_bf16 v[60:63], v[112:115], a[24:27], v[60:63]
    ds_read_b128 v[152:155], v6 offset:3968
    s_waitcnt lgkmcnt(9)
    v_mfma_f32_16x16x32_bf16 v[76:79], v[116:119], a[24:27], v[76:79]
    ds_read_b128 v[156:159], v6 offset:4000
    s_waitcnt lgkmcnt(9)
    v_mfma_f32_16x16x32_bf16 v[60:63], v[120:123], a[20:23], v[60:63]
    ds_read_b128 v[160:163], v6 offset:4032
    s_waitcnt lgkmcnt(9)
    v_mfma_f32_16x16x32_bf16 v[76:79], v[124:127], a[20:23], v[76:79]
    ds_read_b128 v[164:167], v6 offset:4064
    s_waitcnt lgkmcnt(9)
    v_mfma_f32_16x16x32_bf16 v[60:63], v[128:131], a[16:19], v[60:63]
    s_waitcnt vmcnt(2)
    ds_read_b128 a[60:63], v7 offset:240
    s_waitcnt lgkmcnt(9)
    v_mfma_f32_16x16x32_bf16 v[76:79], v[132:135], a[16:19], v[76:79]
    s_waitcnt lgkmcnt(8)
    v_mfma_f32_16x16x32_bf16 v[60:63], v[136:139], a[12:15], v[60:63]
    ds_read_b128 a[124:127], v7 offset:496
    s_waitcnt lgkmcnt(8)
    v_mfma_f32_16x16x32_bf16 v[76:79], v[140:143], a[12:15], v[76:79]
    s_waitcnt lgkmcnt(7)
    v_mfma_f32_16x16x32_bf16 v[60:63], v[144:147], a[8:11], v[60:63]
    ds_read_b128 a[188:191], v7 offset:752
    s_waitcnt lgkmcnt(7)
    v_mfma_f32_16x16x32_bf16 v[76:79], v[148:151], a[8:11], v[76:79]
    s_waitcnt lgkmcnt(6)
    v_mfma_f32_16x16x32_bf16 v[60:63], v[152:155], a[4:7], v[60:63]
    ds_read_b128 a[252:255], v7 offset:1008
    s_waitcnt lgkmcnt(6)
    v_mfma_f32_16x16x32_bf16 v[76:79], v[156:159], a[4:7], v[76:79]
    s_waitcnt lgkmcnt(5)
    v_mfma_f32_16x16x32_bf16 v[60:63], v[160:163], a[0:3], v[60:63]
    ds_read_b128 v[168:171], v6 offset:0
    s_waitcnt lgkmcnt(5)
    v_mfma_f32_16x16x32_bf16 v[76:79], v[164:167], a[0:3], v[76:79]
    ds_read_b128 v[172:175], v6 offset:32
    s_add_u32 s41, s38, 4096
    v_cvt_pk_bf16_f32 v80, v16, v48
    v_cvt_pk_bf16_f32 v81, v17, v49
    v_cvt_pk_bf16_f32 v82, v18, v50
    v_cvt_pk_bf16_f32 v83, v19, v51
    buffer_store_dwordx4 v[80:83], v228, s[8:11], s38 offen offset:0 sc1
    v_cvt_pk_bf16_f32 v84, v32, v64
    v_cvt_pk_bf16_f32 v85, v33, v65
    v_cvt_pk_bf16_f32 v86, v34, v66
    v_cvt_pk_bf16_f32 v87, v35, v67
    buffer_store_dwordx4 v[84:87], v228, s[8:11], s38 offen offset:64 sc1
    v_cvt_pk_bf16_f32 v88, v20, v52
    v_cvt_pk_bf16_f32 v89, v21, v53
    v_cvt_pk_bf16_f32 v90, v22, v54
    v_cvt_pk_bf16_f32 v91, v23, v55
    buffer_store_dwordx4 v[88:91], v228, s[8:11], s38 offen offset:2048 sc1
    v_cvt_pk_bf16_f32 v92, v36, v68
    v_cvt_pk_bf16_f32 v93, v37, v69
    v_cvt_pk_bf16_f32 v94, v38, v70
    v_cvt_pk_bf16_f32 v95, v39, v71
    buffer_store_dwordx4 v[92:95], v228, s[8:11], s38 offen offset:2112 sc1
    v_cvt_pk_bf16_f32 v96, v24, v56
    v_cvt_pk_bf16_f32 v97, v25, v57
    v_cvt_pk_bf16_f32 v98, v26, v58
    v_cvt_pk_bf16_f32 v99, v27, v59
    buffer_store_dwordx4 v[96:99], v228, s[8:11], s41 offen offset:0 sc1
    v_cvt_pk_bf16_f32 v100, v40, v72
    v_cvt_pk_bf16_f32 v101, v41, v73
    v_cvt_pk_bf16_f32 v102, v42, v74
    v_cvt_pk_bf16_f32 v103, v43, v75
    buffer_store_dwordx4 v[100:103], v228, s[8:11], s41 offen offset:64 sc1
    v_cvt_pk_bf16_f32 v104, v28, v60
    v_cvt_pk_bf16_f32 v105, v29, v61
    v_cvt_pk_bf16_f32 v106, v30, v62
    v_cvt_pk_bf16_f32 v107, v31, v63
    buffer_store_dwordx4 v[104:107], v228, s[8:11], s41 offen offset:2048 sc1
    v_cvt_pk_bf16_f32 v108, v44, v76
    v_cvt_pk_bf16_f32 v109, v45, v77
    v_cvt_pk_bf16_f32 v110, v46, v78
    v_cvt_pk_bf16_f32 v111, v47, v79
    buffer_store_dwordx4 v[108:111], v228, s[8:11], s41 offen offset:2112 sc1
    s_add_u32 s38, s38, 8192
    s_add_u32 s42, s42, 1
    s_cmp_lt_u32 s42, 4
    s_cbranch_scc1 .cvl_463

    s_waitcnt vmcnt(0) lgkmcnt(0)
    s_barrier
    s_mov_b32 s5, 160
    s_cmp_lg_u32 s24, 0
    s_cbranch_scc1 .sg_464
    s_mov_b64 exec, 1
    v_mov_b32 v4, 1
    v_mov_b32 v5, 0
    buffer_atomic_add v4, v5, s[20:23], s5 offen sc1
    s_mov_b64 exec, -1

.sg_464:
    v_and_b32 v1, 63, v0
    v_and_b32 v2, 15, v1
    v_lshrrev_b32 v3, 4, v1

    s_sub_u32 s4, s26, 24
    s_lshr_b32 s25, s4, 1
    s_and_b32 s4, s4, 1
    s_lshl_b32 s4, s4, 2
    s_lshl_b32 s5, s91, 3
    s_add_u32 s4, s4, s5
    s_add_u32 s26, s4, s24
    s_lshl_b32 s35, s26, 8
    s_add_u32 s35, s35, 92274688
    s_mov_b32 s37, 0x3db504f3
    s_mov_b32 s38, 0x3fb8aa3b
    v_lshlrev_b32 v8, 4, v1
    v_min_u32 v9, 2, v1
    v_lshlrev_b32 v9, 13, v9
    v_lshlrev_b32 v6, 4, v3
    v_and_b32 v5, 7, v2
    v_add_u32 v10, v6, v5
    v_lshlrev_b32 v10, 4, v10
    v_lshlrev_b32 v11, 4, v2
    v_lshlrev_b32 v5, 3, v3
    v_add_u32 v11, v11, v5
    v_cmp_gt_u32 s[60:61], 32, v1
    v_lshlrev_b32 v5, 2, v3
    v_mov_b32 v12, 0
    v_mov_b32 v13, 0
    v_mov_b32 v14, 0xff800000
    v_lshlrev_b32 v204, 9, v1
    v_add_u32 v204, 4604, v204
    s_lshl_b32 s4, s25, 5
    s_add_u32 s4, s4, s26
    s_lshl_b32 s27, s4, 13
    s_mul_i32 s33, s4, 6144
    s_add_u32 s33, s33, 67108864
    s_add_u32 s36, s25, 1

    v_add_u32 v7, 0, v5
    v_cmp_le_u32 s[40:41], v7, v2
    v_add_u32 v7, 1, v5
    v_cmp_le_u32 s[42:43], v7, v2
    v_add_u32 v7, 2, v5
    v_cmp_le_u32 s[44:45], v7, v2
    v_add_u32 v7, 3, v5
    v_cmp_le_u32 s[46:47], v7, v2
    v_mov_b32 v112, 0
    v_mov_b32 v113, 0
    v_mov_b32 v114, 0
    v_mov_b32 v115, 0
    v_mov_b32 v116, 0
    v_mov_b32 v117, 0
    v_mov_b32 v118, 0
    v_mov_b32 v119, 0
    v_mov_b32 v120, 0
    v_mov_b32 v121, 0
    v_mov_b32 v122, 0
    v_mov_b32 v123, 0
    v_mov_b32 v124, 0
    v_mov_b32 v125, 0
    v_mov_b32 v126, 0
    v_mov_b32 v127, 0
    v_mov_b32 v128, 0
    v_mov_b32 v129, 0
    v_mov_b32 v130, 0
    v_mov_b32 v131, 0
    v_mov_b32 v132, 0
    v_mov_b32 v133, 0
    v_mov_b32 v134, 0
    v_mov_b32 v135, 0
    v_mov_b32 v136, 0
    v_mov_b32 v137, 0
    v_mov_b32 v138, 0
    v_mov_b32 v139, 0
    v_mov_b32 v140, 0
    v_mov_b32 v141, 0
    v_mov_b32 v142, 0
    v_mov_b32 v143, 0
    s_bitcmp1_b32 s97, 4
    s_cselect_b32 s96, 999, 64
    v_mov_b32 v15, -1
    s_mov_b32 s62, 0
    s_mov_b64 exec, 7
.wf_465:
    buffer_load_dword v15, v9, s[8:11], s35 offen sc1
    s_waitcnt vmcnt(0)
    v_cmp_gt_u32 vcc, s36, v15
    s_cbranch_vccz .wfd_466
    s_sleep 2
    s_add_u32 s62, s62, 1
    s_cmp_gt_u32 s62, 0x400000
    s_cbranch_scc1 .mg_end_1
    s_branch .wf_465

.wfd_466:
    s_mov_b64 exec, -1
    s_add_u32 s28, s27, 4096
    s_add_u32 s29, s27, 16777216
    s_add_u32 s30, s27, 16781312
    s_add_u32 s31, s27, 33554432
    s_add_u32 s32, s27, 33558528

    buffer_load_dwordx4 a[0:3], v8, s[8:11], s27 offen offset:0
    buffer_load_dwordx4 a[16:19], v8, s[8:11], s28 offen offset:0
    buffer_load_dwordx4 a[32:35], v8, s[8:11], s29 offen offset:0
    buffer_load_dwordx4 a[48:51], v8, s[8:11], s30 offen offset:0
    buffer_load_dwordx4 a[4:7], v8, s[8:11], s27 offen offset:1024
    buffer_load_dwordx4 a[20:23], v8, s[8:11], s28 offen offset:1024
    buffer_load_dwordx4 a[36:39], v8, s[8:11], s29 offen offset:1024
    buffer_load_dwordx4 a[52:55], v8, s[8:11], s30 offen offset:1024
    buffer_load_dwordx4 a[8:11], v8, s[8:11], s27 offen offset:2048
    buffer_load_dwordx4 a[24:27], v8, s[8:11], s28 offen offset:2048
    buffer_load_dwordx4 a[40:43], v8, s[8:11], s29 offen offset:2048
    buffer_load_dwordx4 a[56:59], v8, s[8:11], s30 offen offset:2048
    buffer_load_dwordx4 a[12:15], v8, s[8:11], s27 offen offset:3072
    buffer_load_dwordx4 a[28:31], v8, s[8:11], s28 offen offset:3072
    buffer_load_dwordx4 a[44:47], v8, s[8:11], s29 offen offset:3072
    buffer_load_dwordx4 a[60:63], v8, s[8:11], s30 offen offset:3072
    buffer_load_dwordx4 a[64:67], v8, s[8:11], s31 offen offset:0
    buffer_load_dwordx4 a[68:71], v8, s[8:11], s31 offen offset:1024
    buffer_load_dwordx4 a[72:75], v8, s[8:11], s31 offen offset:2048
    buffer_load_dwordx4 a[76:79], v8, s[8:11], s31 offen offset:3072
    buffer_load_dwordx4 a[80:83], v8, s[8:11], s32 offen offset:0
    buffer_load_dwordx4 a[84:87], v8, s[8:11], s32 offen offset:1024
    buffer_load_dwordx4 a[88:91], v8, s[8:11], s32 offen offset:2048
    buffer_load_dwordx4 a[92:95], v8, s[8:11], s32 offen offset:3072
    buffer_load_dwordx4 v[80:83], v10, s[8:11], s33 offen offset:2048 sc1
    buffer_load_dwordx4 v[84:87], v10, s[8:11], s33 offen offset:2176 sc1
    buffer_load_dwordx4 v[88:91], v10, s[8:11], s33 offen offset:3072 sc1
    buffer_load_dwordx4 v[92:95], v10, s[8:11], s33 offen offset:3200 sc1
    s_add_u32 s4, s33, 4096
    s_mov_b64 exec, s[60:61]
    buffer_load_dwordx2 v[128:129], v11, s[8:11], s4 offen offset:0 sc1
    buffer_load_dwordx2 v[130:131], v11, s[8:11], s4 offen offset:256 sc1
    buffer_load_dwordx2 v[132:133], v11, s[8:11], s4 offen offset:512 sc1
    buffer_load_dwordx2 v[134:135], v11, s[8:11], s4 offen offset:768 sc1
    buffer_load_dwordx2 v[136:137], v11, s[8:11], s4 offen offset:1024 sc1
    buffer_load_dwordx2 v[138:139], v11, s[8:11], s4 offen offset:1280 sc1
    buffer_load_dwordx2 v[140:141], v11, s[8:11], s4 offen offset:1536 sc1
    buffer_load_dwordx2 v[142:143], v11, s[8:11], s4 offen offset:1792 sc1
    s_mov_b64 exec, -1
    s_waitcnt vmcnt(0)
.att_467:
    s_mov_b32 s34, s33
    s_add_u32 s50, s27, 0
    s_add_u32 s51, s27, 4096
    s_cmp_lt_u32 s25, 60
    s_cselect_b32 s4, 4, 0
    s_cselect_b32 s5, 1048576, 0
    s_cselect_b32 s6, 786432, 0

    s_add_u32 s36, s36, s4
    s_add_u32 s27, s27, s5
    s_add_u32 s33, s33, s6
    s_waitcnt vmcnt(8)

    v_cmp_gt_u32 vcc, s36, v15
    s_cbranch_vccnz .atw_471
.atb_472:
    s_add_u32 s28, s27, 4096
    s_add_u32 s29, s27, 16777216
    s_add_u32 s30, s27, 16781312
    s_add_u32 s31, s27, 33554432
    s_add_u32 s32, s27, 33558528

    buffer_load_dwordx4 a[96:99], v8, s[8:11], s27 offen offset:0
    buffer_load_dwordx4 a[112:115], v8, s[8:11], s28 offen offset:0
    buffer_load_dwordx4 a[128:131], v8, s[8:11], s29 offen offset:0
    buffer_load_dwordx4 a[144:147], v8, s[8:11], s30 offen offset:0
    buffer_load_dwordx4 a[100:103], v8, s[8:11], s27 offen offset:1024
    buffer_load_dwordx4 a[116:119], v8, s[8:11], s28 offen offset:1024
    buffer_load_dwordx4 a[132:135], v8, s[8:11], s29 offen offset:1024
    buffer_load_dwordx4 a[148:151], v8, s[8:11], s30 offen offset:1024
    buffer_load_dwordx4 a[104:107], v8, s[8:11], s27 offen offset:2048
    buffer_load_dwordx4 a[120:123], v8, s[8:11], s28 offen offset:2048
    buffer_load_dwordx4 a[136:139], v8, s[8:11], s29 offen offset:2048
    buffer_load_dwordx4 a[152:155], v8, s[8:11], s30 offen offset:2048
    buffer_load_dwordx4 a[108:111], v8, s[8:11], s27 offen offset:3072
    buffer_load_dwordx4 a[124:127], v8, s[8:11], s28 offen offset:3072
    buffer_load_dwordx4 a[140:143], v8, s[8:11], s29 offen offset:3072
    buffer_load_dwordx4 a[156:159], v8, s[8:11], s30 offen offset:3072
    buffer_load_dwordx4 a[160:163], v8, s[8:11], s31 offen offset:0
    buffer_load_dwordx4 a[164:167], v8, s[8:11], s31 offen offset:1024
    buffer_load_dwordx4 a[168:171], v8, s[8:11], s31 offen offset:2048
    buffer_load_dwordx4 a[172:175], v8, s[8:11], s31 offen offset:3072
    buffer_load_dwordx4 a[176:179], v8, s[8:11], s32 offen offset:0
    buffer_load_dwordx4 a[180:183], v8, s[8:11], s32 offen offset:1024
    buffer_load_dwordx4 a[184:187], v8, s[8:11], s32 offen offset:2048
    buffer_load_dwordx4 a[188:191], v8, s[8:11], s32 offen offset:3072
    buffer_load_dwordx4 v[96:99], v10, s[8:11], s33 offen offset:2048 sc1
    buffer_load_dwordx4 v[100:103], v10, s[8:11], s33 offen offset:2176 sc1
    buffer_load_dwordx4 v[104:107], v10, s[8:11], s33 offen offset:3072 sc1
    buffer_load_dwordx4 v[108:111], v10, s[8:11], s33 offen offset:3200 sc1
    s_add_u32 s4, s33, 4096
    s_mov_b64 exec, s[60:61]
    buffer_load_dwordx2 v[112:113], v11, s[8:11], s4 offen offset:0 sc1
    buffer_load_dwordx2 v[114:115], v11, s[8:11], s4 offen offset:256 sc1
    buffer_load_dwordx2 v[116:117], v11, s[8:11], s4 offen offset:512 sc1
    buffer_load_dwordx2 v[118:119], v11, s[8:11], s4 offen offset:768 sc1
    buffer_load_dwordx2 v[120:121], v11, s[8:11], s4 offen offset:1024 sc1
    buffer_load_dwordx2 v[122:123], v11, s[8:11], s4 offen offset:1280 sc1
    buffer_load_dwordx2 v[124:125], v11, s[8:11], s4 offen offset:1536 sc1
    buffer_load_dwordx2 v[126:127], v11, s[8:11], s4 offen offset:1792 sc1
    s_mov_b64 exec, -1
    v_mfma_f32_16x16x32_bf16 v[144:147], a[32:35], a[0:3], 0
    v_mfma_f32_16x16x32_bf16 v[156:159], a[32:35], a[16:19], 0
    v_mfma_f32_16x16x32_bf16 v[160:163], a[48:51], a[16:19], 0
    v_mfma_f32_16x16x32_bf16 v[144:147], a[36:39], a[4:7], v[144:147]
    v_mfma_f32_16x16x32_bf16 v[156:159], a[36:39], a[20:23], v[156:159]
    v_mfma_f32_16x16x32_bf16 v[160:163], a[52:55], a[20:23], v[160:163]
    v_mfma_f32_16x16x32_bf16 v[144:147], a[40:43], a[8:11], v[144:147]
    v_mfma_f32_16x16x32_bf16 v[156:159], a[40:43], a[24:27], v[156:159]
    v_mfma_f32_16x16x32_bf16 v[160:163], a[56:59], a[24:27], v[160:163]
    v_mfma_f32_16x16x32_bf16 v[144:147], a[44:47], a[12:15], v[144:147]
    v_mfma_f32_16x16x32_bf16 v[156:159], a[44:47], a[28:31], v[156:159]
    v_mfma_f32_16x16x32_bf16 v[160:163], a[60:63], a[28:31], v[160:163]
    s_nop 7
    v_cvt_pk_bf16_f32 v168, v144, v145
    v_cvt_pk_bf16_f32 v170, v146, v147
    v_and_b32 v169, 0xffff0000, v168
    v_lshlrev_b32 v168, 16, v168
    v_and_b32 v171, 0xffff0000, v170
    v_lshlrev_b32 v170, 16, v170
    v_mul_f32 v168, s37, v168
    v_mul_f32 v169, s37, v169
    v_mul_f32 v170, s37, v170
    v_mul_f32 v171, s37, v171
    v_cvt_pk_bf16_f32 v144, v168, v169
    v_cvt_pk_bf16_f32 v146, v170, v171
    v_and_b32 v145, 0xffff0000, v144
    v_lshlrev_b32 v144, 16, v144
    v_and_b32 v147, 0xffff0000, v146
    v_lshlrev_b32 v146, 16, v146
    v_cvt_pk_bf16_f32 v192, v156, v157
    v_cvt_pk_bf16_f32 v194, v158, v159
    v_cvt_pk_bf16_f32 v196, v160, v161
    v_cvt_pk_bf16_f32 v198, v162, v163
    v_and_b32 v193, 0xffff0000, v192
    v_lshlrev_b32 v192, 16, v192
    v_and_b32 v195, 0xffff0000, v194
    v_lshlrev_b32 v194, 16, v194
    v_and_b32 v197, 0xffff0000, v196
    v_lshlrev_b32 v196, 16, v196
    v_and_b32 v199, 0xffff0000, v198
    v_lshlrev_b32 v198, 16, v198
    v_mul_f32 v192, s37, v192
    v_mul_f32 v193, s37, v193
    v_mul_f32 v194, s37, v194
    v_mul_f32 v195, s37, v195
    v_mul_f32 v196, s37, v196
    v_mul_f32 v197, s37, v197
    v_mul_f32 v198, s37, v198
    v_mul_f32 v199, s37, v199
    v_cvt_pk_bf16_f32 v156, v192, v193
    v_cvt_pk_bf16_f32 v158, v194, v195
    v_cvt_pk_bf16_f32 v160, v196, v197
    v_cvt_pk_bf16_f32 v162, v198, v199
    v_and_b32 v157, 0xffff0000, v156
    v_lshlrev_b32 v156, 16, v156
    v_and_b32 v159, 0xffff0000, v158
    v_lshlrev_b32 v158, 16, v158
    v_and_b32 v161, 0xffff0000, v160
    v_lshlrev_b32 v160, 16, v160
    v_and_b32 v163, 0xffff0000, v162
    v_lshlrev_b32 v162, 16, v162
    v_cndmask_b32 v144, v14, v144, s[40:41]
    v_cndmask_b32 v145, v14, v145, s[42:43]
    v_cndmask_b32 v146, v14, v146, s[44:45]
    v_cndmask_b32 v147, v14, v147, s[46:47]
    v_cndmask_b32 v160, v14, v160, s[40:41]
    v_cndmask_b32 v161, v14, v161, s[42:43]
    v_cndmask_b32 v162, v14, v162, s[44:45]
    v_cndmask_b32 v163, v14, v163, s[46:47]
    s_mov_b32 s62, 0
.kmp_473:
    v_max3_u32 v4, v80, v81, v82
    v_max3_u32 v5, v83, v84, v85
    v_max3_u32 v4, v4, v86, v87
    v_max3_u32 v5, v5, v88, v89
    v_max3_u32 v4, v4, v90, v91
    v_max3_u32 v5, v5, v92, v93
    v_max3_u32 v4, v4, v94, v95
    v_max3_u32 v5, v5, v128, v129
    v_max3_u32 v4, v4, v130, v131
    v_max3_u32 v5, v5, v132, v133
    v_max3_u32 v4, v4, v134, v135
    v_max3_u32 v5, v5, v136, v137
    v_max3_u32 v4, v4, v138, v139
    v_max3_u32 v5, v5, v140, v141
    v_max3_u32 v4, v4, v142, v143
    v_max_u32 v4, v4, v5
    v_cmp_eq_u32 vcc, -1, v4
    s_cbranch_vccnz .kmf_474

    v_mfma_f32_16x16x32_bf16 v[152:155], v[80:83], a[0:3], 0
    v_mfma_f32_16x16x32_bf16 v[164:167], v[80:83], a[16:19], 0
    v_mfma_f32_16x16x32_bf16 v[152:155], v[84:87], a[4:7], v[152:155]
    v_mfma_f32_16x16x32_bf16 v[164:167], v[84:87], a[20:23], v[164:167]
    v_mfma_f32_16x16x32_bf16 v[152:155], v[88:91], a[8:11], v[152:155]
    v_mfma_f32_16x16x32_bf16 v[164:167], v[88:91], a[24:27], v[164:167]
    v_mfma_f32_16x16x32_bf16 v[152:155], v[92:95], a[12:15], v[152:155]
    v_mfma_f32_16x16x32_bf16 v[164:167], v[92:95], a[28:31], v[164:167]
    s_nop 5
    v_cvt_pk_bf16_f32 v176, v152, v153
    v_cvt_pk_bf16_f32 v178, v154, v155
    v_and_b32 v177, 0xffff0000, v176
    v_lshlrev_b32 v176, 16, v176
    v_and_b32 v179, 0xffff0000, v178
    v_lshlrev_b32 v178, 16, v178
    v_mul_f32 v176, s37, v176
    v_mul_f32 v177, s37, v177
    v_mul_f32 v178, s37, v178
    v_mul_f32 v179, s37, v179
    v_cvt_pk_bf16_f32 v152, v176, v177
    v_cvt_pk_bf16_f32 v154, v178, v179
    v_and_b32 v153, 0xffff0000, v152
    v_lshlrev_b32 v152, 16, v152
    v_and_b32 v155, 0xffff0000, v154
    v_lshlrev_b32 v154, 16, v154
    v_cndmask_b32 v152, v14, v152, s[60:61]
    v_cndmask_b32 v153, v14, v153, s[60:61]
    v_cndmask_b32 v154, v14, v154, s[60:61]
    v_cndmask_b32 v155, v14, v155, s[60:61]
    v_cvt_pk_bf16_f32 v200, v164, v165
    v_cvt_pk_bf16_f32 v202, v166, v167
    v_and_b32 v201, 0xffff0000, v200
    v_lshlrev_b32 v200, 16, v200
    v_and_b32 v203, 0xffff0000, v202
    v_lshlrev_b32 v202, 16, v202
    v_mul_f32 v200, s37, v200
    v_mul_f32 v201, s37, v201
    v_mul_f32 v202, s37, v202
    v_mul_f32 v203, s37, v203
    v_cvt_pk_bf16_f32 v164, v200, v201
    v_cvt_pk_bf16_f32 v166, v202, v203
    v_and_b32 v165, 0xffff0000, v164
    v_lshlrev_b32 v164, 16, v164
    v_and_b32 v167, 0xffff0000, v166
    v_lshlrev_b32 v166, 16, v166
    v_cndmask_b32 v164, v14, v164, s[60:61]
    v_cndmask_b32 v165, v14, v165, s[60:61]
    v_cndmask_b32 v166, v14, v166, s[60:61]
    v_cndmask_b32 v167, v14, v167, s[60:61]
    v_max3_f32 v4, v144, v145, v146
    v_max3_f32 v5, v147, v152, v153
    v_max3_f32 v4, v4, v154, v155
    v_max_f32 v4, v4, v5

    v_max3_f32 v6, v156, v157, v158
    v_max3_f32 v7, v159, v160, v161
    v_max3_f32 v6, v6, v162, v163
    v_max3_f32 v7, v7, v164, v165
    v_max3_f32 v6, v6, v166, v167
    v_max_f32 v6, v6, v7

    v_mov_b32 v5, v4
    v_mov_b32 v7, v6
    s_nop 0
    v_permlane32_swap_b32 v4, v5
    v_permlane32_swap_b32 v6, v7
    v_max_f32 v4, v4, v5
    v_max_f32 v6, v6, v7

    v_mov_b32 v5, v4
    v_mov_b32 v7, v6
    s_nop 0
    v_permlane16_swap_b32 v4, v5
    v_permlane16_swap_b32 v6, v7
    v_max_f32 v4, v4, v5
    v_max_f32 v6, v6, v7

    v_mul_f32 v4, s38, v4
    v_mul_f32 v6, s38, v6
    v_fma_f32 v168, v144, s38, -v4
    v_fma_f32 v169, v145, s38, -v4
    v_fma_f32 v170, v146, s38, -v4
    v_fma_f32 v171, v147, s38, -v4
    v_fma_f32 v176, v152, s38, -v4
    v_fma_f32 v177, v153, s38, -v4
    v_fma_f32 v178, v154, s38, -v4
    v_fma_f32 v179, v155, s38, -v4
    v_fma_f32 v192, v156, s38, -v6
    v_fma_f32 v193, v157, s38, -v6
    v_fma_f32 v194, v158, s38, -v6
    v_fma_f32 v195, v159, s38, -v6
    v_fma_f32 v196, v160, s38, -v6
    v_fma_f32 v197, v161, s38, -v6
    v_fma_f32 v198, v162, s38, -v6
    v_fma_f32 v199, v163, s38, -v6
    v_fma_f32 v200, v164, s38, -v6
    v_fma_f32 v201, v165, s38, -v6
    v_fma_f32 v202, v166, s38, -v6
    v_fma_f32 v203, v167, s38, -v6
    v_exp_f32 v168, v168
    v_exp_f32 v169, v169
    v_exp_f32 v170, v170
    v_exp_f32 v171, v171
    v_exp_f32 v176, v176
    v_exp_f32 v177, v177
    v_exp_f32 v178, v178
    v_exp_f32 v179, v179
    v_exp_f32 v192, v192
    v_exp_f32 v193, v193
    v_exp_f32 v194, v194
    v_exp_f32 v195, v195
    v_exp_f32 v196, v196
    v_exp_f32 v197, v197
    v_exp_f32 v198, v198
    v_exp_f32 v199, v199
    v_exp_f32 v200, v200
    v_exp_f32 v201, v201
    v_exp_f32 v202, v202
    v_exp_f32 v203, v203
    v_add_f32 v4, v168, v169
    v_add_f32 v5, v170, v171
    v_add_f32 v4, v4, v176
    v_add_f32 v5, v5, v177
    v_add_f32 v4, v4, v178
    v_add_f32 v5, v5, v179
    v_add_f32 v4, v4, v5
    v_add_f32 v6, v192, v193
    v_add_f32 v7, v194, v195
    v_add_f32 v6, v6, v196
    v_add_f32 v7, v7, v197
    v_add_f32 v6, v6, v198
    v_add_f32 v7, v7, v199
    v_add_f32 v6, v6, v200
    v_add_f32 v7, v7, v201
    v_add_f32 v6, v6, v202
    v_add_f32 v7, v7, v203
    v_add_f32 v6, v6, v7
    v_mov_b32 v5, v4
    v_mov_b32 v7, v6
    s_nop 0
    v_permlane32_swap_b32 v4, v5
    v_permlane32_swap_b32 v6, v7
    v_add_f32 v4, v4, v5
    v_add_f32 v6, v6, v7

    v_mov_b32 v5, v4
    v_mov_b32 v7, v6
    s_nop 0
    v_permlane16_swap_b32 v4, v5
    v_permlane16_swap_b32 v6, v7
    v_add_f32 v4, v4, v5
    v_add_f32 v6, v6, v7

    v_rcp_f32 v4, v4
    v_rcp_f32 v6, v6
    v_mov_b32 v182, 0
    v_mov_b32 v183, 0
    v_mul_f32 v168, v4, v168
    v_mul_f32 v169, v4, v169
    v_mul_f32 v170, v4, v170
    v_mul_f32 v171, v4, v171
    v_mul_f32 v176, v4, v176
    v_mul_f32 v177, v4, v177
    v_mul_f32 v178, v4, v178
    v_mul_f32 v179, v4, v179
    v_cvt_pk_bf16_f32 v180, v168, v169
    v_cvt_pk_bf16_f32 v181, v170, v171
    v_cvt_pk_bf16_f32 v184, v176, v177
    v_cvt_pk_bf16_f32 v185, v178, v179
    v_mul_f32 v192, v6, v192
    v_mul_f32 v193, v6, v193
    v_mul_f32 v194, v6, v194
    v_mul_f32 v195, v6, v195
    v_mul_f32 v196, v6, v196
    v_mul_f32 v197, v6, v197
    v_mul_f32 v198, v6, v198
    v_mul_f32 v199, v6, v199
    v_mul_f32 v200, v6, v200
    v_mul_f32 v201, v6, v201
    v_mul_f32 v202, v6, v202
    v_mul_f32 v203, v6, v203
    v_cvt_pk_bf16_f32 v186, v192, v193
    v_cvt_pk_bf16_f32 v187, v194, v195
    v_cvt_pk_bf16_f32 v188, v196, v197
    v_cvt_pk_bf16_f32 v189, v198, v199
    v_cvt_pk_bf16_f32 v190, v200, v201
    v_cvt_pk_bf16_f32 v191, v202, v203
    s_add_u32 s25, s25, 4

    v_mfma_f32_16x16x32_bf16 v[16:19], a[64:67], v[180:183], 0
    v_mfma_f32_16x16x32_bf16 v[20:23], a[68:71], v[180:183], 0
    v_mfma_f32_16x16x32_bf16 v[24:27], a[72:75], v[180:183], 0
    v_mfma_f32_16x16x32_bf16 v[28:31], a[76:79], v[180:183], 0
    v_mfma_f32_16x16x32_bf16 v[32:35], a[80:83], v[180:183], 0
    v_mfma_f32_16x16x32_bf16 v[36:39], a[84:87], v[180:183], 0
    v_mfma_f32_16x16x32_bf16 v[40:43], a[88:91], v[180:183], 0
    v_mfma_f32_16x16x32_bf16 v[44:47], a[92:95], v[180:183], 0
    v_mfma_f32_16x16x32_bf16 v[48:51], a[64:67], v[186:189], 0
    v_mfma_f32_16x16x32_bf16 v[52:55], a[68:71], v[186:189], 0
    v_mfma_f32_16x16x32_bf16 v[56:59], a[72:75], v[186:189], 0
    v_mfma_f32_16x16x32_bf16 v[60:63], a[76:79], v[186:189], 0
    v_mfma_f32_16x16x32_bf16 v[64:67], a[80:83], v[186:189], 0
    v_mfma_f32_16x16x32_bf16 v[68:71], a[84:87], v[186:189], 0
    v_mfma_f32_16x16x32_bf16 v[72:75], a[88:91], v[186:189], 0
    v_mfma_f32_16x16x32_bf16 v[76:79], a[92:95], v[186:189], 0
    s_waitcnt vmcnt(36)
    s_bitcmp1_b32 s97, 4
    s_mov_b64 exec, 1
    s_cbranch_scc1 .fs_475
    buffer_store_dword v12, v13, s[8:11], s92 offen
.fj_476:
    s_mov_b64 exec, -1
    s_cmp_lt_u32 s25, s96
    s_cbranch_scc1 .os_477
    v_mfma_f32_16x16x16_bf16 v[16:19], v[128:129], v[184:185], v[16:19]
    v_mfma_f32_16x16x16_bf16 v[20:23], v[130:131], v[184:185], v[20:23]
    v_add_u32 v12, 1, v12
    v_mfma_f32_16x16x16_bf16 v[24:27], v[132:133], v[184:185], v[24:27]
    v_mfma_f32_16x16x16_bf16 v[28:31], v[134:135], v[184:185], v[28:31]
    v_mfma_f32_16x16x16_bf16 v[32:35], v[136:137], v[184:185], v[32:35]
    v_mfma_f32_16x16x16_bf16 v[36:39], v[138:139], v[184:185], v[36:39]
    v_cvt_pk_bf16_f32 v208, v16, v17
    v_cvt_pk_bf16_f32 v209, v18, v19
    v_cvt_pk_bf16_f32 v210, v20, v21
    v_cvt_pk_bf16_f32 v211, v22, v23
    buffer_store_dwordx4 v[208:211], v8, s[8:11], s50 offen offset:0
    v_mfma_f32_16x16x16_bf16 v[40:43], v[140:141], v[184:185], v[40:43]
    v_mfma_f32_16x16x16_bf16 v[44:47], v[142:143], v[184:185], v[44:47]
    v_cvt_pk_bf16_f32 v212, v24, v25
    v_cvt_pk_bf16_f32 v213, v26, v27
    v_cvt_pk_bf16_f32 v214, v28, v29
    v_cvt_pk_bf16_f32 v215, v30, v31
    buffer_store_dwordx4 v[212:215], v8, s[8:11], s50 offen offset:1024
    v_mfma_f32_16x16x16_bf16 v[48:51], v[128:129], v[190:191], v[48:51]
    v_mfma_f32_16x16x16_bf16 v[52:55], v[130:131], v[190:191], v[52:55]
    v_cvt_pk_bf16_f32 v216, v32, v33
    v_cvt_pk_bf16_f32 v217, v34, v35
    v_cvt_pk_bf16_f32 v218, v36, v37
    v_cvt_pk_bf16_f32 v219, v38, v39
    buffer_store_dwordx4 v[216:219], v8, s[8:11], s50 offen offset:2048
    v_mfma_f32_16x16x16_bf16 v[56:59], v[132:133], v[190:191], v[56:59]
    v_mfma_f32_16x16x16_bf16 v[60:63], v[134:135], v[190:191], v[60:63]
    v_cvt_pk_bf16_f32 v220, v40, v41
    v_cvt_pk_bf16_f32 v221, v42, v43
    v_cvt_pk_bf16_f32 v222, v44, v45
    v_cvt_pk_bf16_f32 v223, v46, v47
    buffer_store_dwordx4 v[220:223], v8, s[8:11], s50 offen offset:3072
    v_mfma_f32_16x16x16_bf16 v[64:67], v[136:137], v[190:191], v[64:67]
    v_mfma_f32_16x16x16_bf16 v[68:71], v[138:139], v[190:191], v[68:71]
    v_cvt_pk_bf16_f32 v224, v48, v49
    v_cvt_pk_bf16_f32 v225, v50, v51
    v_cvt_pk_bf16_f32 v226, v52, v53
    v_cvt_pk_bf16_f32 v227, v54, v55
    buffer_store_dwordx4 v[224:227], v8, s[8:11], s51 offen offset:0
    v_mfma_f32_16x16x16_bf16 v[72:75], v[140:141], v[190:191], v[72:75]
    v_mfma_f32_16x16x16_bf16 v[76:79], v[142:143], v[190:191], v[76:79]
    v_cvt_pk_bf16_f32 v228, v56, v57
    v_cvt_pk_bf16_f32 v229, v58, v59
    v_cvt_pk_bf16_f32 v230, v60, v61
    v_cvt_pk_bf16_f32 v231, v62, v63
    buffer_store_dwordx4 v[228:231], v8, s[8:11], s51 offen offset:1024
    s_nop 3
    v_cvt_pk_bf16_f32 v232, v64, v65
    v_cvt_pk_bf16_f32 v233, v66, v67
    v_cvt_pk_bf16_f32 v234, v68, v69
    v_cvt_pk_bf16_f32 v235, v70, v71
    buffer_store_dwordx4 v[232:235], v8, s[8:11], s51 offen offset:2048
    v_cvt_pk_bf16_f32 v236, v72, v73
    v_cvt_pk_bf16_f32 v237, v74, v75
    v_cvt_pk_bf16_f32 v238, v76, v77
    v_cvt_pk_bf16_f32 v239, v78, v79
    buffer_store_dwordx4 v[236:239], v8, s[8:11], s51 offen offset:3072
.oj_478:
    s_cmp_eq_u32 s25, 63
    s_cbranch_scc1 .ah1_469
    s_mov_b32 s34, s33
    s_add_u32 s50, s27, 0
    s_add_u32 s51, s27, 4096
    s_cmp_lt_u32 s25, 60
    s_cselect_b32 s4, 4, 0
    s_cselect_b32 s5, 1048576, 0
    s_cselect_b32 s6, 786432, 0

    s_cmp_eq_u32 s25, 60
    s_cselect_b32 s4, 3, s4
    s_cselect_b32 s5, 786432, s5
    s_cselect_b32 s6, 589824, s6

    s_add_u32 s36, s36, s4
    s_add_u32 s27, s27, s5
    s_add_u32 s33, s33, s6
    s_waitcnt vmcnt(8)

    v_cmp_gt_u32 vcc, s36, v15
    s_cbranch_vccnz .atw_479
.atb_480:
    s_add_u32 s28, s27, 4096
    s_add_u32 s29, s27, 16777216
    s_add_u32 s30, s27, 16781312
    s_add_u32 s31, s27, 33554432
    s_add_u32 s32, s27, 33558528

    buffer_load_dwordx4 a[0:3], v8, s[8:11], s27 offen offset:0
    buffer_load_dwordx4 a[16:19], v8, s[8:11], s28 offen offset:0
    buffer_load_dwordx4 a[32:35], v8, s[8:11], s29 offen offset:0
    buffer_load_dwordx4 a[48:51], v8, s[8:11], s30 offen offset:0
    buffer_load_dwordx4 a[4:7], v8, s[8:11], s27 offen offset:1024
    buffer_load_dwordx4 a[20:23], v8, s[8:11], s28 offen offset:1024
    buffer_load_dwordx4 a[36:39], v8, s[8:11], s29 offen offset:1024
    buffer_load_dwordx4 a[52:55], v8, s[8:11], s30 offen offset:1024
    buffer_load_dwordx4 a[8:11], v8, s[8:11], s27 offen offset:2048
    buffer_load_dwordx4 a[24:27], v8, s[8:11], s28 offen offset:2048
    buffer_load_dwordx4 a[40:43], v8, s[8:11], s29 offen offset:2048
    buffer_load_dwordx4 a[56:59], v8, s[8:11], s30 offen offset:2048
    buffer_load_dwordx4 a[12:15], v8, s[8:11], s27 offen offset:3072
    buffer_load_dwordx4 a[28:31], v8, s[8:11], s28 offen offset:3072
    buffer_load_dwordx4 a[44:47], v8, s[8:11], s29 offen offset:3072
    buffer_load_dwordx4 a[60:63], v8, s[8:11], s30 offen offset:3072
    buffer_load_dwordx4 a[64:67], v8, s[8:11], s31 offen offset:0
    buffer_load_dwordx4 a[68:71], v8, s[8:11], s31 offen offset:1024
    buffer_load_dwordx4 a[72:75], v8, s[8:11], s31 offen offset:2048
    buffer_load_dwordx4 a[76:79], v8, s[8:11], s31 offen offset:3072
    buffer_load_dwordx4 a[80:83], v8, s[8:11], s32 offen offset:0
    buffer_load_dwordx4 a[84:87], v8, s[8:11], s32 offen offset:1024
    buffer_load_dwordx4 a[88:91], v8, s[8:11], s32 offen offset:2048
    buffer_load_dwordx4 a[92:95], v8, s[8:11], s32 offen offset:3072
    buffer_load_dwordx4 v[80:83], v10, s[8:11], s33 offen offset:2048 sc1
    buffer_load_dwordx4 v[84:87], v10, s[8:11], s33 offen offset:2176 sc1
    buffer_load_dwordx4 v[88:91], v10, s[8:11], s33 offen offset:3072 sc1
    buffer_load_dwordx4 v[92:95], v10, s[8:11], s33 offen offset:3200 sc1
    s_add_u32 s4, s33, 4096
    s_mov_b64 exec, s[60:61]
    buffer_load_dwordx2 v[128:129], v11, s[8:11], s4 offen offset:0 sc1
    buffer_load_dwordx2 v[130:131], v11, s[8:11], s4 offen offset:256 sc1
    buffer_load_dwordx2 v[132:133], v11, s[8:11], s4 offen offset:512 sc1
    buffer_load_dwordx2 v[134:135], v11, s[8:11], s4 offen offset:768 sc1
    buffer_load_dwordx2 v[136:137], v11, s[8:11], s4 offen offset:1024 sc1
    buffer_load_dwordx2 v[138:139], v11, s[8:11], s4 offen offset:1280 sc1
    buffer_load_dwordx2 v[140:141], v11, s[8:11], s4 offen offset:1536 sc1
    buffer_load_dwordx2 v[142:143], v11, s[8:11], s4 offen offset:1792 sc1
    s_mov_b64 exec, -1
    v_mfma_f32_16x16x32_bf16 v[144:147], a[128:131], a[96:99], 0
    v_mfma_f32_16x16x32_bf16 v[156:159], a[128:131], a[112:115], 0
    v_mfma_f32_16x16x32_bf16 v[160:163], a[144:147], a[112:115], 0
    v_mfma_f32_16x16x32_bf16 v[144:147], a[132:135], a[100:103], v[144:147]
    v_mfma_f32_16x16x32_bf16 v[156:159], a[132:135], a[116:119], v[156:159]
    v_mfma_f32_16x16x32_bf16 v[160:163], a[148:151], a[116:119], v[160:163]
    v_mfma_f32_16x16x32_bf16 v[144:147], a[136:139], a[104:107], v[144:147]
    v_mfma_f32_16x16x32_bf16 v[156:159], a[136:139], a[120:123], v[156:159]
    v_mfma_f32_16x16x32_bf16 v[160:163], a[152:155], a[120:123], v[160:163]
    v_mfma_f32_16x16x32_bf16 v[144:147], a[140:143], a[108:111], v[144:147]
    v_mfma_f32_16x16x32_bf16 v[156:159], a[140:143], a[124:127], v[156:159]
    v_mfma_f32_16x16x32_bf16 v[160:163], a[156:159], a[124:127], v[160:163]
    s_nop 7
    v_cvt_pk_bf16_f32 v168, v144, v145
    v_cvt_pk_bf16_f32 v170, v146, v147
    v_and_b32 v169, 0xffff0000, v168
    v_lshlrev_b32 v168, 16, v168
    v_and_b32 v171, 0xffff0000, v170
    v_lshlrev_b32 v170, 16, v170
    v_mul_f32 v168, s37, v168
    v_mul_f32 v169, s37, v169
    v_mul_f32 v170, s37, v170
    v_mul_f32 v171, s37, v171
    v_cvt_pk_bf16_f32 v144, v168, v169
    v_cvt_pk_bf16_f32 v146, v170, v171
    v_and_b32 v145, 0xffff0000, v144
    v_lshlrev_b32 v144, 16, v144
    v_and_b32 v147, 0xffff0000, v146
    v_lshlrev_b32 v146, 16, v146
    v_cvt_pk_bf16_f32 v192, v156, v157
    v_cvt_pk_bf16_f32 v194, v158, v159
    v_cvt_pk_bf16_f32 v196, v160, v161
    v_cvt_pk_bf16_f32 v198, v162, v163
    v_and_b32 v193, 0xffff0000, v192
    v_lshlrev_b32 v192, 16, v192
    v_and_b32 v195, 0xffff0000, v194
    v_lshlrev_b32 v194, 16, v194
    v_and_b32 v197, 0xffff0000, v196
    v_lshlrev_b32 v196, 16, v196
    v_and_b32 v199, 0xffff0000, v198
    v_lshlrev_b32 v198, 16, v198
    v_mul_f32 v192, s37, v192
    v_mul_f32 v193, s37, v193
    v_mul_f32 v194, s37, v194
    v_mul_f32 v195, s37, v195
    v_mul_f32 v196, s37, v196
    v_mul_f32 v197, s37, v197
    v_mul_f32 v198, s37, v198
    v_mul_f32 v199, s37, v199
    v_cvt_pk_bf16_f32 v156, v192, v193
    v_cvt_pk_bf16_f32 v158, v194, v195
    v_cvt_pk_bf16_f32 v160, v196, v197
    v_cvt_pk_bf16_f32 v162, v198, v199
    v_and_b32 v157, 0xffff0000, v156
    v_lshlrev_b32 v156, 16, v156
    v_and_b32 v159, 0xffff0000, v158
    v_lshlrev_b32 v158, 16, v158
    v_and_b32 v161, 0xffff0000, v160
    v_lshlrev_b32 v160, 16, v160
    v_and_b32 v163, 0xffff0000, v162
    v_lshlrev_b32 v162, 16, v162
    v_cndmask_b32 v144, v14, v144, s[40:41]
    v_cndmask_b32 v145, v14, v145, s[42:43]
    v_cndmask_b32 v146, v14, v146, s[44:45]
    v_cndmask_b32 v147, v14, v147, s[46:47]
    v_cndmask_b32 v160, v14, v160, s[40:41]
    v_cndmask_b32 v161, v14, v161, s[42:43]
    v_cndmask_b32 v162, v14, v162, s[44:45]
    v_cndmask_b32 v163, v14, v163, s[46:47]
    s_mov_b32 s62, 0
.kmp_481:
    v_max3_u32 v4, v96, v97, v98
    v_max3_u32 v5, v99, v100, v101
    v_max3_u32 v4, v4, v102, v103
    v_max3_u32 v5, v5, v104, v105
    v_max3_u32 v4, v4, v106, v107
    v_max3_u32 v5, v5, v108, v109
    v_max3_u32 v4, v4, v110, v111
    v_max3_u32 v5, v5, v112, v113
    v_max3_u32 v4, v4, v114, v115
    v_max3_u32 v5, v5, v116, v117
    v_max3_u32 v4, v4, v118, v119
    v_max3_u32 v5, v5, v120, v121
    v_max3_u32 v4, v4, v122, v123
    v_max3_u32 v5, v5, v124, v125
    v_max3_u32 v4, v4, v126, v127
    v_max_u32 v4, v4, v5
    v_cmp_eq_u32 vcc, -1, v4
    s_cbranch_vccnz .kmf_482

    v_mfma_f32_16x16x32_bf16 v[152:155], v[96:99], a[96:99], 0
    v_mfma_f32_16x16x32_bf16 v[164:167], v[96:99], a[112:115], 0
    v_mfma_f32_16x16x32_bf16 v[152:155], v[100:103], a[100:103], v[152:155]
    v_mfma_f32_16x16x32_bf16 v[164:167], v[100:103], a[116:119], v[164:167]
    v_mfma_f32_16x16x32_bf16 v[152:155], v[104:107], a[104:107], v[152:155]
    v_mfma_f32_16x16x32_bf16 v[164:167], v[104:107], a[120:123], v[164:167]
    v_mfma_f32_16x16x32_bf16 v[152:155], v[108:111], a[108:111], v[152:155]
    v_mfma_f32_16x16x32_bf16 v[164:167], v[108:111], a[124:127], v[164:167]
    s_nop 5
    v_cvt_pk_bf16_f32 v176, v152, v153
    v_cvt_pk_bf16_f32 v178, v154, v155
    v_and_b32 v177, 0xffff0000, v176
    v_lshlrev_b32 v176, 16, v176
    v_and_b32 v179, 0xffff0000, v178
    v_lshlrev_b32 v178, 16, v178
    v_mul_f32 v176, s37, v176
    v_mul_f32 v177, s37, v177
    v_mul_f32 v178, s37, v178
    v_mul_f32 v179, s37, v179
    v_cvt_pk_bf16_f32 v152, v176, v177
    v_cvt_pk_bf16_f32 v154, v178, v179
    v_and_b32 v153, 0xffff0000, v152
    v_lshlrev_b32 v152, 16, v152
    v_and_b32 v155, 0xffff0000, v154
    v_lshlrev_b32 v154, 16, v154
    v_cndmask_b32 v152, v14, v152, s[60:61]
    v_cndmask_b32 v153, v14, v153, s[60:61]
    v_cndmask_b32 v154, v14, v154, s[60:61]
    v_cndmask_b32 v155, v14, v155, s[60:61]
    v_cvt_pk_bf16_f32 v200, v164, v165
    v_cvt_pk_bf16_f32 v202, v166, v167
    v_and_b32 v201, 0xffff0000, v200
    v_lshlrev_b32 v200, 16, v200
    v_and_b32 v203, 0xffff0000, v202
    v_lshlrev_b32 v202, 16, v202
    v_mul_f32 v200, s37, v200
    v_mul_f32 v201, s37, v201
    v_mul_f32 v202, s37, v202
    v_mul_f32 v203, s37, v203
    v_cvt_pk_bf16_f32 v164, v200, v201
    v_cvt_pk_bf16_f32 v166, v202, v203
    v_and_b32 v165, 0xffff0000, v164
    v_lshlrev_b32 v164, 16, v164
    v_and_b32 v167, 0xffff0000, v166
    v_lshlrev_b32 v166, 16, v166
    v_cndmask_b32 v164, v14, v164, s[60:61]
    v_cndmask_b32 v165, v14, v165, s[60:61]
    v_cndmask_b32 v166, v14, v166, s[60:61]
    v_cndmask_b32 v167, v14, v167, s[60:61]
    v_max3_f32 v4, v144, v145, v146
    v_max3_f32 v5, v147, v152, v153
    v_max3_f32 v4, v4, v154, v155
    v_max_f32 v4, v4, v5

    v_max3_f32 v6, v156, v157, v158
    v_max3_f32 v7, v159, v160, v161
    v_max3_f32 v6, v6, v162, v163
    v_max3_f32 v7, v7, v164, v165
    v_max3_f32 v6, v6, v166, v167
    v_max_f32 v6, v6, v7

    v_mov_b32 v5, v4
    v_mov_b32 v7, v6
    s_nop 0
    v_permlane32_swap_b32 v4, v5
    v_permlane32_swap_b32 v6, v7
    v_max_f32 v4, v4, v5
    v_max_f32 v6, v6, v7

    v_mov_b32 v5, v4
    v_mov_b32 v7, v6
    s_nop 0
    v_permlane16_swap_b32 v4, v5
    v_permlane16_swap_b32 v6, v7
    v_max_f32 v4, v4, v5
    v_max_f32 v6, v6, v7

    v_mul_f32 v4, s38, v4
    v_mul_f32 v6, s38, v6
    v_fma_f32 v168, v144, s38, -v4
    v_fma_f32 v169, v145, s38, -v4
    v_fma_f32 v170, v146, s38, -v4
    v_fma_f32 v171, v147, s38, -v4
    v_fma_f32 v176, v152, s38, -v4
    v_fma_f32 v177, v153, s38, -v4
    v_fma_f32 v178, v154, s38, -v4
    v_fma_f32 v179, v155, s38, -v4
    v_fma_f32 v192, v156, s38, -v6
    v_fma_f32 v193, v157, s38, -v6
    v_fma_f32 v194, v158, s38, -v6
    v_fma_f32 v195, v159, s38, -v6
    v_fma_f32 v196, v160, s38, -v6
    v_fma_f32 v197, v161, s38, -v6
    v_fma_f32 v198, v162, s38, -v6
    v_fma_f32 v199, v163, s38, -v6
    v_fma_f32 v200, v164, s38, -v6
    v_fma_f32 v201, v165, s38, -v6
    v_fma_f32 v202, v166, s38, -v6
    v_fma_f32 v203, v167, s38, -v6
    v_exp_f32 v168, v168
    v_exp_f32 v169, v169
    v_exp_f32 v170, v170
    v_exp_f32 v171, v171
    v_exp_f32 v176, v176
    v_exp_f32 v177, v177
    v_exp_f32 v178, v178
    v_exp_f32 v179, v179
    v_exp_f32 v192, v192
    v_exp_f32 v193, v193
    v_exp_f32 v194, v194
    v_exp_f32 v195, v195
    v_exp_f32 v196, v196
    v_exp_f32 v197, v197
    v_exp_f32 v198, v198
    v_exp_f32 v199, v199
    v_exp_f32 v200, v200
    v_exp_f32 v201, v201
    v_exp_f32 v202, v202
    v_exp_f32 v203, v203
    v_add_f32 v4, v168, v169
    v_add_f32 v5, v170, v171
    v_add_f32 v4, v4, v176
    v_add_f32 v5, v5, v177
    v_add_f32 v4, v4, v178
    v_add_f32 v5, v5, v179
    v_add_f32 v4, v4, v5
    v_add_f32 v6, v192, v193
    v_add_f32 v7, v194, v195
    v_add_f32 v6, v6, v196
    v_add_f32 v7, v7, v197
    v_add_f32 v6, v6, v198
    v_add_f32 v7, v7, v199
    v_add_f32 v6, v6, v200
    v_add_f32 v7, v7, v201
    v_add_f32 v6, v6, v202
    v_add_f32 v7, v7, v203
    v_add_f32 v6, v6, v7
    v_mov_b32 v5, v4
    v_mov_b32 v7, v6
    s_nop 0
    v_permlane32_swap_b32 v4, v5
    v_permlane32_swap_b32 v6, v7
    v_add_f32 v4, v4, v5
    v_add_f32 v6, v6, v7

    v_mov_b32 v5, v4
    v_mov_b32 v7, v6
    s_nop 0
    v_permlane16_swap_b32 v4, v5
    v_permlane16_swap_b32 v6, v7
    v_add_f32 v4, v4, v5
    v_add_f32 v6, v6, v7

    v_rcp_f32 v4, v4
    v_rcp_f32 v6, v6
    v_mov_b32 v182, 0
    v_mov_b32 v183, 0
    v_mul_f32 v168, v4, v168
    v_mul_f32 v169, v4, v169
    v_mul_f32 v170, v4, v170
    v_mul_f32 v171, v4, v171
    v_mul_f32 v176, v4, v176
    v_mul_f32 v177, v4, v177
    v_mul_f32 v178, v4, v178
    v_mul_f32 v179, v4, v179
    v_cvt_pk_bf16_f32 v180, v168, v169
    v_cvt_pk_bf16_f32 v181, v170, v171
    v_cvt_pk_bf16_f32 v184, v176, v177
    v_cvt_pk_bf16_f32 v185, v178, v179
    v_mul_f32 v192, v6, v192
    v_mul_f32 v193, v6, v193
    v_mul_f32 v194, v6, v194
    v_mul_f32 v195, v6, v195
    v_mul_f32 v196, v6, v196
    v_mul_f32 v197, v6, v197
    v_mul_f32 v198, v6, v198
    v_mul_f32 v199, v6, v199
    v_mul_f32 v200, v6, v200
    v_mul_f32 v201, v6, v201
    v_mul_f32 v202, v6, v202
    v_mul_f32 v203, v6, v203
    v_cvt_pk_bf16_f32 v186, v192, v193
    v_cvt_pk_bf16_f32 v187, v194, v195
    v_cvt_pk_bf16_f32 v188, v196, v197
    v_cvt_pk_bf16_f32 v189, v198, v199
    v_cvt_pk_bf16_f32 v190, v200, v201
    v_cvt_pk_bf16_f32 v191, v202, v203
    s_add_u32 s25, s25, 4

    v_mfma_f32_16x16x32_bf16 v[16:19], a[160:163], v[180:183], 0
    v_mfma_f32_16x16x32_bf16 v[20:23], a[164:167], v[180:183], 0
    v_mfma_f32_16x16x32_bf16 v[24:27], a[168:171], v[180:183], 0
    v_mfma_f32_16x16x32_bf16 v[28:31], a[172:175], v[180:183], 0
    v_mfma_f32_16x16x32_bf16 v[32:35], a[176:179], v[180:183], 0
    v_mfma_f32_16x16x32_bf16 v[36:39], a[180:183], v[180:183], 0
    v_mfma_f32_16x16x32_bf16 v[40:43], a[184:187], v[180:183], 0
    v_mfma_f32_16x16x32_bf16 v[44:47], a[188:191], v[180:183], 0
    v_mfma_f32_16x16x32_bf16 v[48:51], a[160:163], v[186:189], 0
    v_mfma_f32_16x16x32_bf16 v[52:55], a[164:167], v[186:189], 0
    v_mfma_f32_16x16x32_bf16 v[56:59], a[168:171], v[186:189], 0
    v_mfma_f32_16x16x32_bf16 v[60:63], a[172:175], v[186:189], 0
    v_mfma_f32_16x16x32_bf16 v[64:67], a[176:179], v[186:189], 0
    v_mfma_f32_16x16x32_bf16 v[68:71], a[180:183], v[186:189], 0
    v_mfma_f32_16x16x32_bf16 v[72:75], a[184:187], v[186:189], 0
    v_mfma_f32_16x16x32_bf16 v[76:79], a[188:191], v[186:189], 0
    s_waitcnt vmcnt(36)
    s_bitcmp1_b32 s97, 4
    s_mov_b64 exec, 1
    s_cbranch_scc1 .fs_483
    buffer_store_dword v12, v13, s[8:11], s92 offen
.fj_484:
    s_mov_b64 exec, -1
    s_cmp_lt_u32 s25, s96
    s_cbranch_scc1 .os_485
    v_mfma_f32_16x16x16_bf16 v[16:19], v[112:113], v[184:185], v[16:19]
    v_mfma_f32_16x16x16_bf16 v[20:23], v[114:115], v[184:185], v[20:23]
    v_add_u32 v12, 1, v12
    v_mfma_f32_16x16x16_bf16 v[24:27], v[116:117], v[184:185], v[24:27]
    v_mfma_f32_16x16x16_bf16 v[28:31], v[118:119], v[184:185], v[28:31]
    v_mfma_f32_16x16x16_bf16 v[32:35], v[120:121], v[184:185], v[32:35]
    v_mfma_f32_16x16x16_bf16 v[36:39], v[122:123], v[184:185], v[36:39]
    v_cvt_pk_bf16_f32 v208, v16, v17
    v_cvt_pk_bf16_f32 v209, v18, v19
    v_cvt_pk_bf16_f32 v210, v20, v21
    v_cvt_pk_bf16_f32 v211, v22, v23
    buffer_store_dwordx4 v[208:211], v8, s[8:11], s50 offen offset:0
    v_mfma_f32_16x16x16_bf16 v[40:43], v[124:125], v[184:185], v[40:43]
    v_mfma_f32_16x16x16_bf16 v[44:47], v[126:127], v[184:185], v[44:47]
    v_cvt_pk_bf16_f32 v212, v24, v25
    v_cvt_pk_bf16_f32 v213, v26, v27
    v_cvt_pk_bf16_f32 v214, v28, v29
    v_cvt_pk_bf16_f32 v215, v30, v31
    buffer_store_dwordx4 v[212:215], v8, s[8:11], s50 offen offset:1024
    v_mfma_f32_16x16x16_bf16 v[48:51], v[112:113], v[190:191], v[48:51]
    v_mfma_f32_16x16x16_bf16 v[52:55], v[114:115], v[190:191], v[52:55]
    v_cvt_pk_bf16_f32 v216, v32, v33
    v_cvt_pk_bf16_f32 v217, v34, v35
    v_cvt_pk_bf16_f32 v218, v36, v37
    v_cvt_pk_bf16_f32 v219, v38, v39
    buffer_store_dwordx4 v[216:219], v8, s[8:11], s50 offen offset:2048
    v_mfma_f32_16x16x16_bf16 v[56:59], v[116:117], v[190:191], v[56:59]
    v_mfma_f32_16x16x16_bf16 v[60:63], v[118:119], v[190:191], v[60:63]
    v_cvt_pk_bf16_f32 v220, v40, v41
    v_cvt_pk_bf16_f32 v221, v42, v43
    v_cvt_pk_bf16_f32 v222, v44, v45
    v_cvt_pk_bf16_f32 v223, v46, v47
    buffer_store_dwordx4 v[220:223], v8, s[8:11], s50 offen offset:3072
    v_mfma_f32_16x16x16_bf16 v[64:67], v[120:121], v[190:191], v[64:67]
    v_mfma_f32_16x16x16_bf16 v[68:71], v[122:123], v[190:191], v[68:71]
    v_cvt_pk_bf16_f32 v224, v48, v49
    v_cvt_pk_bf16_f32 v225, v50, v51
    v_cvt_pk_bf16_f32 v226, v52, v53
    v_cvt_pk_bf16_f32 v227, v54, v55
    buffer_store_dwordx4 v[224:227], v8, s[8:11], s51 offen offset:0
    v_mfma_f32_16x16x16_bf16 v[72:75], v[124:125], v[190:191], v[72:75]
    v_mfma_f32_16x16x16_bf16 v[76:79], v[126:127], v[190:191], v[76:79]
    v_cvt_pk_bf16_f32 v228, v56, v57
    v_cvt_pk_bf16_f32 v229, v58, v59
    v_cvt_pk_bf16_f32 v230, v60, v61
    v_cvt_pk_bf16_f32 v231, v62, v63
    buffer_store_dwordx4 v[228:231], v8, s[8:11], s51 offen offset:1024
    s_nop 3
    v_cvt_pk_bf16_f32 v232, v64, v65
    v_cvt_pk_bf16_f32 v233, v66, v67
    v_cvt_pk_bf16_f32 v234, v68, v69
    v_cvt_pk_bf16_f32 v235, v70, v71
    buffer_store_dwordx4 v[232:235], v8, s[8:11], s51 offen offset:2048
    v_cvt_pk_bf16_f32 v236, v72, v73
    v_cvt_pk_bf16_f32 v237, v74, v75
    v_cvt_pk_bf16_f32 v238, v76, v77
    v_cvt_pk_bf16_f32 v239, v78, v79
    buffer_store_dwordx4 v[236:239], v8, s[8:11], s51 offen offset:3072
.oj_486:
    s_cmp_lt_u32 s25, 64
    s_cbranch_scc1 .att_467

    s_cmp_eq_u32 s25, 64
    s_cbranch_scc1 .ah0_468
.ahz_470:
    s_waitcnt vmcnt(0)
    s_bitcmp1_b32 s97, 4
    s_mov_b64 exec, 1
    s_cbranch_scc1 .fs_488
    buffer_store_dword v12, v13, s[8:11], s92 offen
.fj_489:
    s_mov_b64 exec, -1
    s_branch .ate_487
.atw_471:
    s_mov_b32 s62, 0
    s_mov_b64 exec, 7
.wf_490:
    buffer_load_dword v15, v9, s[8:11], s35 offen sc1
    s_waitcnt vmcnt(0)
    v_cmp_gt_u32 vcc, s36, v15
    s_cbranch_vccz .wfd_491
    s_sleep 2
    s_add_u32 s62, s62, 1
    s_cmp_gt_u32 s62, 0x400000
    s_cbranch_scc1 .mg_end_1
    s_branch .wf_490

.wfd_491:
    s_mov_b64 exec, -1
    s_branch .atb_472
.kmf_474:
    s_cmp_lg_u32 s62, 0
    s_cbranch_scc1 .kmn_492
    s_waitcnt vmcnt(36)
    s_bitcmp1_b32 s97, 4
    s_mov_b64 exec, 1
    s_cbranch_scc1 .fs_493
    buffer_store_dword v12, v13, s[8:11], s92 offen
.fj_494:
    s_mov_b64 exec, -1
    s_cmp_lt_u32 s25, 60
    s_cselect_b32 s5, 0, 196608
    s_sub_u32 s5, s34, s5
    s_mov_b64 exec, 15

.kml_495:
    s_sleep 4
    buffer_load_dword v4, v204, s[8:11], s5 offen sc1
    s_add_u32 s62, s62, 1
    s_cmp_gt_u32 s62, 0x200000
    s_cbranch_scc1 .mg_end_1
    s_waitcnt vmcnt(0)
    v_cmp_eq_u32 vcc, -1, v4
    s_cbranch_vccnz .kml_495
    s_mov_b64 exec, -1

.kmn_492:
    s_sleep 1
    buffer_load_dwordx4 v[80:83], v10, s[8:11], s34 offen offset:2048 sc1
    buffer_load_dwordx4 v[84:87], v10, s[8:11], s34 offen offset:2176 sc1
    buffer_load_dwordx4 v[88:91], v10, s[8:11], s34 offen offset:3072 sc1
    buffer_load_dwordx4 v[92:95], v10, s[8:11], s34 offen offset:3200 sc1
    s_add_u32 s4, s34, 4096
    s_mov_b64 exec, s[60:61]
    buffer_load_dwordx2 v[128:129], v11, s[8:11], s4 offen offset:0 sc1
    buffer_load_dwordx2 v[130:131], v11, s[8:11], s4 offen offset:256 sc1
    buffer_load_dwordx2 v[132:133], v11, s[8:11], s4 offen offset:512 sc1
    buffer_load_dwordx2 v[134:135], v11, s[8:11], s4 offen offset:768 sc1
    buffer_load_dwordx2 v[136:137], v11, s[8:11], s4 offen offset:1024 sc1
    buffer_load_dwordx2 v[138:139], v11, s[8:11], s4 offen offset:1280 sc1
    buffer_load_dwordx2 v[140:141], v11, s[8:11], s4 offen offset:1536 sc1
    buffer_load_dwordx2 v[142:143], v11, s[8:11], s4 offen offset:1792 sc1
    s_mov_b64 exec, -1
    s_add_u32 s62, s62, 1
    s_cmp_gt_u32 s62, 0x200000
    s_cbranch_scc1 .mg_end_1
    s_waitcnt vmcnt(0)
    s_branch .kmp_473

.fs_475:
    buffer_store_dword v12, v13, s[8:11], s92 offen sc1
    s_branch .fj_476
.os_477:
    v_mfma_f32_16x16x16_bf16 v[16:19], v[128:129], v[184:185], v[16:19]
    v_mfma_f32_16x16x16_bf16 v[20:23], v[130:131], v[184:185], v[20:23]
    v_add_u32 v12, 1, v12
    v_mfma_f32_16x16x16_bf16 v[24:27], v[132:133], v[184:185], v[24:27]
    v_mfma_f32_16x16x16_bf16 v[28:31], v[134:135], v[184:185], v[28:31]
    v_mfma_f32_16x16x16_bf16 v[32:35], v[136:137], v[184:185], v[32:35]
    v_mfma_f32_16x16x16_bf16 v[36:39], v[138:139], v[184:185], v[36:39]
    v_cvt_pk_bf16_f32 v208, v16, v17
    v_cvt_pk_bf16_f32 v209, v18, v19
    v_cvt_pk_bf16_f32 v210, v20, v21
    v_cvt_pk_bf16_f32 v211, v22, v23
    buffer_store_dwordx4 v[208:211], v8, s[8:11], s50 offen offset:0 sc1
    v_mfma_f32_16x16x16_bf16 v[40:43], v[140:141], v[184:185], v[40:43]
    v_mfma_f32_16x16x16_bf16 v[44:47], v[142:143], v[184:185], v[44:47]
    v_cvt_pk_bf16_f32 v212, v24, v25
    v_cvt_pk_bf16_f32 v213, v26, v27
    v_cvt_pk_bf16_f32 v214, v28, v29
    v_cvt_pk_bf16_f32 v215, v30, v31
    buffer_store_dwordx4 v[212:215], v8, s[8:11], s50 offen offset:1024 sc1
    v_mfma_f32_16x16x16_bf16 v[48:51], v[128:129], v[190:191], v[48:51]
    v_mfma_f32_16x16x16_bf16 v[52:55], v[130:131], v[190:191], v[52:55]
    v_cvt_pk_bf16_f32 v216, v32, v33
    v_cvt_pk_bf16_f32 v217, v34, v35
    v_cvt_pk_bf16_f32 v218, v36, v37
    v_cvt_pk_bf16_f32 v219, v38, v39
    buffer_store_dwordx4 v[216:219], v8, s[8:11], s50 offen offset:2048 sc1
    v_mfma_f32_16x16x16_bf16 v[56:59], v[132:133], v[190:191], v[56:59]
    v_mfma_f32_16x16x16_bf16 v[60:63], v[134:135], v[190:191], v[60:63]
    v_cvt_pk_bf16_f32 v220, v40, v41
    v_cvt_pk_bf16_f32 v221, v42, v43
    v_cvt_pk_bf16_f32 v222, v44, v45
    v_cvt_pk_bf16_f32 v223, v46, v47
    buffer_store_dwordx4 v[220:223], v8, s[8:11], s50 offen offset:3072 sc1
    v_mfma_f32_16x16x16_bf16 v[64:67], v[136:137], v[190:191], v[64:67]
    v_mfma_f32_16x16x16_bf16 v[68:71], v[138:139], v[190:191], v[68:71]
    v_cvt_pk_bf16_f32 v224, v48, v49
    v_cvt_pk_bf16_f32 v225, v50, v51
    v_cvt_pk_bf16_f32 v226, v52, v53
    v_cvt_pk_bf16_f32 v227, v54, v55
    buffer_store_dwordx4 v[224:227], v8, s[8:11], s51 offen offset:0 sc1
    v_mfma_f32_16x16x16_bf16 v[72:75], v[140:141], v[190:191], v[72:75]
    v_mfma_f32_16x16x16_bf16 v[76:79], v[142:143], v[190:191], v[76:79]
    v_cvt_pk_bf16_f32 v228, v56, v57
    v_cvt_pk_bf16_f32 v229, v58, v59
    v_cvt_pk_bf16_f32 v230, v60, v61
    v_cvt_pk_bf16_f32 v231, v62, v63
    buffer_store_dwordx4 v[228:231], v8, s[8:11], s51 offen offset:1024 sc1
    s_nop 3
    v_cvt_pk_bf16_f32 v232, v64, v65
    v_cvt_pk_bf16_f32 v233, v66, v67
    v_cvt_pk_bf16_f32 v234, v68, v69
    v_cvt_pk_bf16_f32 v235, v70, v71
    buffer_store_dwordx4 v[232:235], v8, s[8:11], s51 offen offset:2048 sc1
    v_cvt_pk_bf16_f32 v236, v72, v73
    v_cvt_pk_bf16_f32 v237, v74, v75
    v_cvt_pk_bf16_f32 v238, v76, v77
    v_cvt_pk_bf16_f32 v239, v78, v79
    buffer_store_dwordx4 v[236:239], v8, s[8:11], s51 offen offset:3072 sc1
    s_branch .oj_478
.atw_479:
    s_mov_b32 s62, 0
    s_mov_b64 exec, 7
.wf_496:
    buffer_load_dword v15, v9, s[8:11], s35 offen sc1
    s_waitcnt vmcnt(0)
    v_cmp_gt_u32 vcc, s36, v15
    s_cbranch_vccz .wfd_497
    s_sleep 2
    s_add_u32 s62, s62, 1
    s_cmp_gt_u32 s62, 0x400000
    s_cbranch_scc1 .mg_end_1
    s_branch .wf_496

.wfd_497:
    s_mov_b64 exec, -1
    s_branch .atb_480
.kmf_482:
    s_cmp_lg_u32 s62, 0
    s_cbranch_scc1 .kmn_498
    s_waitcnt vmcnt(36)
    s_bitcmp1_b32 s97, 4
    s_mov_b64 exec, 1
    s_cbranch_scc1 .fs_499
    buffer_store_dword v12, v13, s[8:11], s92 offen
.fj_500:
    s_mov_b64 exec, -1
    s_cmp_lt_u32 s25, 60
    s_cselect_b32 s5, 0, 196608
    s_sub_u32 s5, s34, s5
    s_mov_b64 exec, 15

.kml_501:
    s_sleep 4
    buffer_load_dword v4, v204, s[8:11], s5 offen sc1
    s_add_u32 s62, s62, 1
    s_cmp_gt_u32 s62, 0x200000
    s_cbranch_scc1 .mg_end_1
    s_waitcnt vmcnt(0)
    v_cmp_eq_u32 vcc, -1, v4
    s_cbranch_vccnz .kml_501
    s_mov_b64 exec, -1

.kmn_498:
    s_sleep 1
    buffer_load_dwordx4 v[96:99], v10, s[8:11], s34 offen offset:2048 sc1
    buffer_load_dwordx4 v[100:103], v10, s[8:11], s34 offen offset:2176 sc1
    buffer_load_dwordx4 v[104:107], v10, s[8:11], s34 offen offset:3072 sc1
    buffer_load_dwordx4 v[108:111], v10, s[8:11], s34 offen offset:3200 sc1
    s_add_u32 s4, s34, 4096
    s_mov_b64 exec, s[60:61]
    buffer_load_dwordx2 v[112:113], v11, s[8:11], s4 offen offset:0 sc1
    buffer_load_dwordx2 v[114:115], v11, s[8:11], s4 offen offset:256 sc1
    buffer_load_dwordx2 v[116:117], v11, s[8:11], s4 offen offset:512 sc1
    buffer_load_dwordx2 v[118:119], v11, s[8:11], s4 offen offset:768 sc1
    buffer_load_dwordx2 v[120:121], v11, s[8:11], s4 offen offset:1024 sc1
    buffer_load_dwordx2 v[122:123], v11, s[8:11], s4 offen offset:1280 sc1
    buffer_load_dwordx2 v[124:125], v11, s[8:11], s4 offen offset:1536 sc1
    buffer_load_dwordx2 v[126:127], v11, s[8:11], s4 offen offset:1792 sc1
    s_mov_b64 exec, -1
    s_add_u32 s62, s62, 1
    s_cmp_gt_u32 s62, 0x200000
    s_cbranch_scc1 .mg_end_1
    s_waitcnt vmcnt(0)
    s_branch .kmp_481

.fs_483:
    buffer_store_dword v12, v13, s[8:11], s92 offen sc1
    s_branch .fj_484
.os_485:
    v_mfma_f32_16x16x16_bf16 v[16:19], v[112:113], v[184:185], v[16:19]
    v_mfma_f32_16x16x16_bf16 v[20:23], v[114:115], v[184:185], v[20:23]
    v_add_u32 v12, 1, v12
    v_mfma_f32_16x16x16_bf16 v[24:27], v[116:117], v[184:185], v[24:27]
    v_mfma_f32_16x16x16_bf16 v[28:31], v[118:119], v[184:185], v[28:31]
    v_mfma_f32_16x16x16_bf16 v[32:35], v[120:121], v[184:185], v[32:35]
    v_mfma_f32_16x16x16_bf16 v[36:39], v[122:123], v[184:185], v[36:39]
    v_cvt_pk_bf16_f32 v208, v16, v17
    v_cvt_pk_bf16_f32 v209, v18, v19
    v_cvt_pk_bf16_f32 v210, v20, v21
    v_cvt_pk_bf16_f32 v211, v22, v23
    buffer_store_dwordx4 v[208:211], v8, s[8:11], s50 offen offset:0 sc1
    v_mfma_f32_16x16x16_bf16 v[40:43], v[124:125], v[184:185], v[40:43]
    v_mfma_f32_16x16x16_bf16 v[44:47], v[126:127], v[184:185], v[44:47]
    v_cvt_pk_bf16_f32 v212, v24, v25
    v_cvt_pk_bf16_f32 v213, v26, v27
    v_cvt_pk_bf16_f32 v214, v28, v29
    v_cvt_pk_bf16_f32 v215, v30, v31
    buffer_store_dwordx4 v[212:215], v8, s[8:11], s50 offen offset:1024 sc1
    v_mfma_f32_16x16x16_bf16 v[48:51], v[112:113], v[190:191], v[48:51]
    v_mfma_f32_16x16x16_bf16 v[52:55], v[114:115], v[190:191], v[52:55]
    v_cvt_pk_bf16_f32 v216, v32, v33
    v_cvt_pk_bf16_f32 v217, v34, v35
    v_cvt_pk_bf16_f32 v218, v36, v37
    v_cvt_pk_bf16_f32 v219, v38, v39
    buffer_store_dwordx4 v[216:219], v8, s[8:11], s50 offen offset:2048 sc1
    v_mfma_f32_16x16x16_bf16 v[56:59], v[116:117], v[190:191], v[56:59]
    v_mfma_f32_16x16x16_bf16 v[60:63], v[118:119], v[190:191], v[60:63]
    v_cvt_pk_bf16_f32 v220, v40, v41
    v_cvt_pk_bf16_f32 v221, v42, v43
    v_cvt_pk_bf16_f32 v222, v44, v45
    v_cvt_pk_bf16_f32 v223, v46, v47
    buffer_store_dwordx4 v[220:223], v8, s[8:11], s50 offen offset:3072 sc1
    v_mfma_f32_16x16x16_bf16 v[64:67], v[120:121], v[190:191], v[64:67]
    v_mfma_f32_16x16x16_bf16 v[68:71], v[122:123], v[190:191], v[68:71]
    v_cvt_pk_bf16_f32 v224, v48, v49
    v_cvt_pk_bf16_f32 v225, v50, v51
    v_cvt_pk_bf16_f32 v226, v52, v53
    v_cvt_pk_bf16_f32 v227, v54, v55
    buffer_store_dwordx4 v[224:227], v8, s[8:11], s51 offen offset:0 sc1
    v_mfma_f32_16x16x16_bf16 v[72:75], v[124:125], v[190:191], v[72:75]
    v_mfma_f32_16x16x16_bf16 v[76:79], v[126:127], v[190:191], v[76:79]
    v_cvt_pk_bf16_f32 v228, v56, v57
    v_cvt_pk_bf16_f32 v229, v58, v59
    v_cvt_pk_bf16_f32 v230, v60, v61
    v_cvt_pk_bf16_f32 v231, v62, v63
    buffer_store_dwordx4 v[228:231], v8, s[8:11], s51 offen offset:1024 sc1
    s_nop 3
    v_cvt_pk_bf16_f32 v232, v64, v65
    v_cvt_pk_bf16_f32 v233, v66, v67
    v_cvt_pk_bf16_f32 v234, v68, v69
    v_cvt_pk_bf16_f32 v235, v70, v71
    buffer_store_dwordx4 v[232:235], v8, s[8:11], s51 offen offset:2048 sc1
    v_cvt_pk_bf16_f32 v236, v72, v73
    v_cvt_pk_bf16_f32 v237, v74, v75
    v_cvt_pk_bf16_f32 v238, v76, v77
    v_cvt_pk_bf16_f32 v239, v78, v79
    buffer_store_dwordx4 v[236:239], v8, s[8:11], s51 offen offset:3072 sc1
    s_branch .oj_486
.ah0_468:
    s_mov_b32 s34, s33
    s_add_u32 s50, s27, 0
    s_mov_b32 s39, 0x3e0293ee
    v_lshlrev_b32 v5, 2, v8
    s_waitcnt vmcnt(8)
    buffer_load_dword v205, v5, s[8:11], s50 offen
    s_add_u32 s25, s25, 4

    s_mov_b32 s52, 1
    s_branch .hd_502
.hb_503:
    s_mov_b32 s52, 0
    v_mfma_f32_16x16x32_bf16 v[144:147], a[32:35], a[0:3], 0
    v_mfma_f32_16x16x32_bf16 v[144:147], a[36:39], a[4:7], v[144:147]
    v_mfma_f32_16x16x32_bf16 v[144:147], a[40:43], a[8:11], v[144:147]
    v_mfma_f32_16x16x32_bf16 v[144:147], a[44:47], a[12:15], v[144:147]
    s_nop 7
    v_cvt_pk_bf16_f32 v168, v144, v145
    v_cvt_pk_bf16_f32 v170, v146, v147
    v_and_b32 v169, 0xffff0000, v168
    v_lshlrev_b32 v168, 16, v168
    v_and_b32 v171, 0xffff0000, v170
    v_lshlrev_b32 v170, 16, v170
    v_mul_f32 v168, s37, v168
    v_mul_f32 v169, s37, v169
    v_mul_f32 v170, s37, v170
    v_mul_f32 v171, s37, v171
    v_cvt_pk_bf16_f32 v144, v168, v169
    v_cvt_pk_bf16_f32 v146, v170, v171
    v_and_b32 v145, 0xffff0000, v144
    v_lshlrev_b32 v144, 16, v144
    v_and_b32 v147, 0xffff0000, v146
    v_lshlrev_b32 v146, 16, v146
    v_cndmask_b32 v144, v14, v144, s[40:41]
    v_cndmask_b32 v145, v14, v145, s[42:43]
    v_cndmask_b32 v146, v14, v146, s[44:45]
    v_cndmask_b32 v147, v14, v147, s[46:47]
    v_max3_f32 v192, v144, v145, v146
    v_max_f32 v192, v192, v147
    v_mov_b32 v5, v192
    s_nop 1
    v_permlane32_swap_b32 v192, v5
    v_max_f32 v192, v192, v5
    v_mov_b32 v5, v192
    s_nop 1
    v_permlane16_swap_b32 v192, v5
    v_max_f32 v192, v192, v5
    v_mul_f32 v192, s38, v192
    v_mov_b32 v182, 0
    v_mov_b32 v183, 0
    v_fma_f32 v168, v144, s38, -v192
    v_fma_f32 v169, v145, s38, -v192
    v_fma_f32 v170, v146, s38, -v192
    v_fma_f32 v171, v147, s38, -v192
    v_exp_f32 v168, v168
    v_exp_f32 v169, v169
    v_exp_f32 v170, v170
    v_exp_f32 v171, v171
    s_nop 0
    v_cvt_pk_bf16_f32 v180, v168, v169
    v_cvt_pk_bf16_f32 v181, v170, v171
    v_add_f32 v193, v168, v169
    v_add_f32 v193, v193, v170
    v_add_f32 v193, v193, v171
    v_mfma_f32_16x16x32_bf16 v[16:19], a[64:67], v[180:183], 0
    v_mfma_f32_16x16x32_bf16 v[20:23], a[68:71], v[180:183], 0
    v_mfma_f32_16x16x32_bf16 v[24:27], a[72:75], v[180:183], 0
    v_mfma_f32_16x16x32_bf16 v[28:31], a[76:79], v[180:183], 0
    v_mfma_f32_16x16x32_bf16 v[32:35], a[80:83], v[180:183], 0
    v_mfma_f32_16x16x32_bf16 v[36:39], a[84:87], v[180:183], 0
    v_mfma_f32_16x16x32_bf16 v[40:43], a[88:91], v[180:183], 0
    v_mfma_f32_16x16x32_bf16 v[44:47], a[92:95], v[180:183], 0
    v_mov_b32 v5, v193
    s_nop 1
    v_permlane32_swap_b32 v193, v5
    v_add_f32 v193, v193, v5
    v_mov_b32 v5, v193
    s_nop 1
    v_permlane16_swap_b32 v193, v5
    v_add_f32 v193, v193, v5
    s_waitcnt vmcnt(0)
    s_bitcmp1_b32 s97, 4
    s_mov_b64 exec, 1
    s_cbranch_scc1 .fs_504
    buffer_store_dword v12, v13, s[8:11], s92 offen
.fj_505:
    s_mov_b64 exec, -1
    v_add_u32 v12, 1, v12
    s_mov_b32 s62, 0
.hk_506:
    v_max3_u32 v4, v80, v84, v88
    v_max3_u32 v5, v92, v128, v130
    v_max3_u32 v4, v4, v132, v134
    v_max3_u32 v5, v5, v136, v138
    v_max3_u32 v4, v4, v140, v142
    v_max_u32 v4, v4, v5
    v_cmp_eq_u32 vcc, -1, v4
    s_cbranch_vccnz .hf_507

.hd_502:
    v_mfma_f32_16x16x32_bf16 v[152:155], v[80:83], a[0:3], 0
    v_mfma_f32_16x16x32_bf16 v[152:155], v[84:87], a[4:7], v[152:155]
    v_mfma_f32_16x16x32_bf16 v[152:155], v[88:91], a[8:11], v[152:155]
    v_mfma_f32_16x16x32_bf16 v[152:155], v[92:95], a[12:15], v[152:155]
    s_nop 7
    v_cndmask_b32 v152, v14, v152, s[60:61]
    v_cndmask_b32 v153, v14, v153, s[60:61]
    v_cndmask_b32 v154, v14, v154, s[60:61]
    v_cndmask_b32 v155, v14, v155, s[60:61]
    v_max3_f32 v4, v152, v153, v154
    v_max_f32 v4, v4, v155
    v_mov_b32 v5, v4
    s_nop 1
    v_permlane32_swap_b32 v4, v5
    v_max_f32 v4, v4, v5
    v_mov_b32 v5, v4
    s_nop 1
    v_permlane16_swap_b32 v4, v5
    v_max_f32 v4, v4, v5
    v_mul_f32 v4, s39, v4
    v_max_f32 v4, v4, v192
    v_sub_f32 v6, v192, v4
    v_fma_f32 v176, v152, s39, -v4
    v_fma_f32 v177, v153, s39, -v4
    v_fma_f32 v178, v154, s39, -v4
    v_fma_f32 v179, v155, s39, -v4
    v_exp_f32 v176, v176
    v_exp_f32 v177, v177
    v_exp_f32 v178, v178
    v_exp_f32 v179, v179
    v_exp_f32 v6, v6
    v_add_f32 v4, v176, v177
    v_add_f32 v5, v178, v179
    v_add_f32 v4, v4, v5

    v_mov_b32 v5, v4
    s_nop 1
    v_permlane32_swap_b32 v4, v5
    v_add_f32 v4, v4, v5
    v_mov_b32 v5, v4
    s_nop 1
    v_permlane16_swap_b32 v4, v5
    v_add_f32 v4, v4, v5
    v_fma_f32 v4, v6, v193, v4
    v_rcp_f32 v4, v4
    s_nop 0
    v_mul_f32 v6, v6, v4
    v_pk_mul_f32 v[176:177], v[176:177], v[4:5] op_sel_hi:[1,0]
    v_pk_mul_f32 v[178:179], v[178:179], v[4:5] op_sel_hi:[1,0]

    v_cvt_pk_bf16_f32 v184, v176, v177
    v_cvt_pk_bf16_f32 v185, v178, v179
    v_pk_mul_f32 v[16:17], v[16:17], v[6:7] op_sel_hi:[1,0]
    v_pk_mul_f32 v[18:19], v[18:19], v[6:7] op_sel_hi:[1,0]
    v_pk_mul_f32 v[20:21], v[20:21], v[6:7] op_sel_hi:[1,0]
    v_pk_mul_f32 v[22:23], v[22:23], v[6:7] op_sel_hi:[1,0]
    s_cmp_lt_u32 s25, s96
    s_cbranch_scc1 .hs_510
    v_mfma_f32_16x16x16_bf16 v[16:19], v[128:129], v[184:185], v[16:19]
    v_pk_mul_f32 v[24:25], v[24:25], v[6:7] op_sel_hi:[1,0]
    v_pk_mul_f32 v[26:27], v[26:27], v[6:7] op_sel_hi:[1,0]
    v_mfma_f32_16x16x16_bf16 v[20:23], v[130:131], v[184:185], v[20:23]
    v_pk_mul_f32 v[28:29], v[28:29], v[6:7] op_sel_hi:[1,0]
    v_pk_mul_f32 v[30:31], v[30:31], v[6:7] op_sel_hi:[1,0]
    v_mfma_f32_16x16x16_bf16 v[24:27], v[132:133], v[184:185], v[24:27]
    v_pk_mul_f32 v[32:33], v[32:33], v[6:7] op_sel_hi:[1,0]
    v_pk_mul_f32 v[34:35], v[34:35], v[6:7] op_sel_hi:[1,0]
    v_mfma_f32_16x16x16_bf16 v[28:31], v[134:135], v[184:185], v[28:31]
    v_pk_mul_f32 v[36:37], v[36:37], v[6:7] op_sel_hi:[1,0]
    v_pk_mul_f32 v[38:39], v[38:39], v[6:7] op_sel_hi:[1,0]
    v_mfma_f32_16x16x16_bf16 v[32:35], v[136:137], v[184:185], v[32:35]
    v_pk_mul_f32 v[40:41], v[40:41], v[6:7] op_sel_hi:[1,0]
    v_pk_mul_f32 v[42:43], v[42:43], v[6:7] op_sel_hi:[1,0]
    v_mfma_f32_16x16x16_bf16 v[36:39], v[138:139], v[184:185], v[36:39]
    v_pk_mul_f32 v[44:45], v[44:45], v[6:7] op_sel_hi:[1,0]
    v_pk_mul_f32 v[46:47], v[46:47], v[6:7] op_sel_hi:[1,0]
    v_mfma_f32_16x16x16_bf16 v[40:43], v[140:141], v[184:185], v[40:43]
    v_cvt_pk_bf16_f32 v208, v16, v17
    v_cvt_pk_bf16_f32 v209, v18, v19
    v_cvt_pk_bf16_f32 v210, v20, v21
    v_cvt_pk_bf16_f32 v211, v22, v23
    buffer_store_dwordx4 v[208:211], v8, s[8:11], s50 offen offset:0
    v_mfma_f32_16x16x16_bf16 v[44:47], v[142:143], v[184:185], v[44:47]
    v_cvt_pk_bf16_f32 v212, v24, v25
    v_cvt_pk_bf16_f32 v213, v26, v27
    v_cvt_pk_bf16_f32 v214, v28, v29
    v_cvt_pk_bf16_f32 v215, v30, v31
    buffer_store_dwordx4 v[212:215], v8, s[8:11], s50 offen offset:1024
    v_cvt_pk_bf16_f32 v216, v32, v33
    v_cvt_pk_bf16_f32 v217, v34, v35
    v_cvt_pk_bf16_f32 v218, v36, v37
    v_cvt_pk_bf16_f32 v219, v38, v39
    buffer_store_dwordx4 v[216:219], v8, s[8:11], s50 offen offset:2048
    v_cvt_pk_bf16_f32 v220, v40, v41
    v_cvt_pk_bf16_f32 v221, v42, v43
    v_cvt_pk_bf16_f32 v222, v44, v45
    v_cvt_pk_bf16_f32 v223, v46, v47
    buffer_store_dwordx4 v[220:223], v8, s[8:11], s50 offen offset:3072
    s_cmp_lg_u32 s52, 0
    s_cbranch_scc1 .hb_503
    s_waitcnt vmcnt(0)
    s_mov_b64 exec, 1
    buffer_store_dword v12, v13, s[8:11], s92 offen
    s_mov_b64 exec, -1
    s_branch .ate_487
.ah1_469:
    s_mov_b32 s34, s33
    s_add_u32 s50, s27, 4096
    s_mov_b32 s39, 0x3e0293ee
    v_lshlrev_b32 v5, 2, v8
    s_waitcnt vmcnt(8)
    buffer_load_dword v205, v5, s[8:11], s50 offen
    s_add_u32 s25, s25, 4

    s_mov_b32 s52, 1
    s_branch .hd_511
.hb_512:
    s_mov_b32 s52, 0
    v_mfma_f32_16x16x32_bf16 v[144:147], a[128:131], a[112:115], 0
    v_mfma_f32_16x16x32_bf16 v[148:151], a[144:147], a[112:115], 0
    v_mfma_f32_16x16x32_bf16 v[144:147], a[132:135], a[116:119], v[144:147]
    v_mfma_f32_16x16x32_bf16 v[148:151], a[148:151], a[116:119], v[148:151]
    v_mfma_f32_16x16x32_bf16 v[144:147], a[136:139], a[120:123], v[144:147]
    v_mfma_f32_16x16x32_bf16 v[148:151], a[152:155], a[120:123], v[148:151]
    v_mfma_f32_16x16x32_bf16 v[144:147], a[140:143], a[124:127], v[144:147]
    v_mfma_f32_16x16x32_bf16 v[148:151], a[156:159], a[124:127], v[148:151]
    s_nop 7
    v_cvt_pk_bf16_f32 v168, v144, v145
    v_cvt_pk_bf16_f32 v170, v146, v147
    v_cvt_pk_bf16_f32 v172, v148, v149
    v_cvt_pk_bf16_f32 v174, v150, v151
    v_and_b32 v169, 0xffff0000, v168
    v_lshlrev_b32 v168, 16, v168
    v_and_b32 v171, 0xffff0000, v170
    v_lshlrev_b32 v170, 16, v170
    v_and_b32 v173, 0xffff0000, v172
    v_lshlrev_b32 v172, 16, v172
    v_and_b32 v175, 0xffff0000, v174
    v_lshlrev_b32 v174, 16, v174
    v_mul_f32 v168, s37, v168
    v_mul_f32 v169, s37, v169
    v_mul_f32 v170, s37, v170
    v_mul_f32 v171, s37, v171
    v_mul_f32 v172, s37, v172
    v_mul_f32 v173, s37, v173
    v_mul_f32 v174, s37, v174
    v_mul_f32 v175, s37, v175
    v_cvt_pk_bf16_f32 v144, v168, v169
    v_cvt_pk_bf16_f32 v146, v170, v171
    v_cvt_pk_bf16_f32 v148, v172, v173
    v_cvt_pk_bf16_f32 v150, v174, v175
    v_and_b32 v145, 0xffff0000, v144
    v_lshlrev_b32 v144, 16, v144
    v_and_b32 v147, 0xffff0000, v146
    v_lshlrev_b32 v146, 16, v146
    v_and_b32 v149, 0xffff0000, v148
    v_lshlrev_b32 v148, 16, v148
    v_and_b32 v151, 0xffff0000, v150
    v_lshlrev_b32 v150, 16, v150
    v_cndmask_b32 v148, v14, v148, s[40:41]
    v_cndmask_b32 v149, v14, v149, s[42:43]
    v_cndmask_b32 v150, v14, v150, s[44:45]
    v_cndmask_b32 v151, v14, v151, s[46:47]
    v_max3_f32 v192, v144, v145, v146
    v_max_f32 v192, v192, v147
    v_max3_f32 v192, v192, v148, v149
    v_max3_f32 v192, v192, v150, v151
    v_mov_b32 v5, v192
    s_nop 1
    v_permlane32_swap_b32 v192, v5
    v_max_f32 v192, v192, v5
    v_mov_b32 v5, v192
    s_nop 1
    v_permlane16_swap_b32 v192, v5
    v_max_f32 v192, v192, v5
    v_mul_f32 v192, s38, v192
    v_mov_b32 v182, 0
    v_mov_b32 v183, 0
    v_fma_f32 v168, v144, s38, -v192
    v_fma_f32 v169, v145, s38, -v192
    v_fma_f32 v170, v146, s38, -v192
    v_fma_f32 v171, v147, s38, -v192
    v_fma_f32 v172, v148, s38, -v192
    v_fma_f32 v173, v149, s38, -v192
    v_fma_f32 v174, v150, s38, -v192
    v_fma_f32 v175, v151, s38, -v192
    v_exp_f32 v168, v168
    v_exp_f32 v169, v169
    v_exp_f32 v170, v170
    v_exp_f32 v171, v171
    v_exp_f32 v172, v172
    v_exp_f32 v173, v173
    v_exp_f32 v174, v174
    v_exp_f32 v175, v175
    s_nop 0
    v_cvt_pk_bf16_f32 v180, v168, v169
    v_cvt_pk_bf16_f32 v181, v170, v171
    v_cvt_pk_bf16_f32 v182, v172, v173
    v_cvt_pk_bf16_f32 v183, v174, v175
    v_add_f32 v193, v168, v169
    v_add_f32 v193, v193, v170
    v_add_f32 v193, v193, v171
    v_add_f32 v193, v193, v172
    v_add_f32 v193, v193, v173
    v_add_f32 v193, v193, v174
    v_add_f32 v193, v193, v175
    v_mfma_f32_16x16x32_bf16 v[16:19], a[160:163], v[180:183], 0
    v_mfma_f32_16x16x32_bf16 v[20:23], a[164:167], v[180:183], 0
    v_mfma_f32_16x16x32_bf16 v[24:27], a[168:171], v[180:183], 0
    v_mfma_f32_16x16x32_bf16 v[28:31], a[172:175], v[180:183], 0
    v_mfma_f32_16x16x32_bf16 v[32:35], a[176:179], v[180:183], 0
    v_mfma_f32_16x16x32_bf16 v[36:39], a[180:183], v[180:183], 0
    v_mfma_f32_16x16x32_bf16 v[40:43], a[184:187], v[180:183], 0
    v_mfma_f32_16x16x32_bf16 v[44:47], a[188:191], v[180:183], 0
    v_mov_b32 v5, v193
    s_nop 1
    v_permlane32_swap_b32 v193, v5
    v_add_f32 v193, v193, v5
    v_mov_b32 v5, v193
    s_nop 1
    v_permlane16_swap_b32 v193, v5
    v_add_f32 v193, v193, v5
    s_waitcnt vmcnt(0)
    s_bitcmp1_b32 s97, 4
    s_mov_b64 exec, 1
    s_cbranch_scc1 .fs_513
    buffer_store_dword v12, v13, s[8:11], s92 offen
.fj_514:
    s_mov_b64 exec, -1
    v_add_u32 v12, 1, v12
    s_mov_b32 s62, 0
.hk_515:
    v_max3_u32 v4, v96, v100, v104
    v_max3_u32 v5, v108, v112, v114
    v_max3_u32 v4, v4, v116, v118
    v_max3_u32 v5, v5, v120, v122
    v_max3_u32 v4, v4, v124, v126
    v_max_u32 v4, v4, v5
    v_cmp_eq_u32 vcc, -1, v4
    s_cbranch_vccnz .hf_516

.hd_511:
    v_mfma_f32_16x16x32_bf16 v[152:155], v[96:99], a[112:115], 0
    v_mfma_f32_16x16x32_bf16 v[152:155], v[100:103], a[116:119], v[152:155]
    v_mfma_f32_16x16x32_bf16 v[152:155], v[104:107], a[120:123], v[152:155]
    v_mfma_f32_16x16x32_bf16 v[152:155], v[108:111], a[124:127], v[152:155]
    s_nop 7
    v_cndmask_b32 v152, v14, v152, s[60:61]
    v_cndmask_b32 v153, v14, v153, s[60:61]
    v_cndmask_b32 v154, v14, v154, s[60:61]
    v_cndmask_b32 v155, v14, v155, s[60:61]
    v_max3_f32 v4, v152, v153, v154
    v_max_f32 v4, v4, v155
    v_mov_b32 v5, v4
    s_nop 1
    v_permlane32_swap_b32 v4, v5
    v_max_f32 v4, v4, v5
    v_mov_b32 v5, v4
    s_nop 1
    v_permlane16_swap_b32 v4, v5
    v_max_f32 v4, v4, v5
    v_mul_f32 v4, s39, v4
    v_max_f32 v4, v4, v192
    v_sub_f32 v6, v192, v4
    v_fma_f32 v176, v152, s39, -v4
    v_fma_f32 v177, v153, s39, -v4
    v_fma_f32 v178, v154, s39, -v4
    v_fma_f32 v179, v155, s39, -v4
    v_exp_f32 v176, v176
    v_exp_f32 v177, v177
    v_exp_f32 v178, v178
    v_exp_f32 v179, v179
    v_exp_f32 v6, v6
    v_add_f32 v4, v176, v177
    v_add_f32 v5, v178, v179
    v_add_f32 v4, v4, v5

    v_mov_b32 v5, v4
    s_nop 1
    v_permlane32_swap_b32 v4, v5
    v_add_f32 v4, v4, v5
    v_mov_b32 v5, v4
    s_nop 1
    v_permlane16_swap_b32 v4, v5
    v_add_f32 v4, v4, v5
    v_fma_f32 v4, v6, v193, v4
    v_rcp_f32 v4, v4
    s_nop 0
    v_mul_f32 v6, v6, v4
    v_pk_mul_f32 v[176:177], v[176:177], v[4:5] op_sel_hi:[1,0]
    v_pk_mul_f32 v[178:179], v[178:179], v[4:5] op_sel_hi:[1,0]

    v_cvt_pk_bf16_f32 v184, v176, v177
    v_cvt_pk_bf16_f32 v185, v178, v179
    v_pk_mul_f32 v[16:17], v[16:17], v[6:7] op_sel_hi:[1,0]
    v_pk_mul_f32 v[18:19], v[18:19], v[6:7] op_sel_hi:[1,0]
    v_pk_mul_f32 v[20:21], v[20:21], v[6:7] op_sel_hi:[1,0]
    v_pk_mul_f32 v[22:23], v[22:23], v[6:7] op_sel_hi:[1,0]
    s_cmp_lt_u32 s25, s96
    s_cbranch_scc1 .hs_519
    v_mfma_f32_16x16x16_bf16 v[16:19], v[112:113], v[184:185], v[16:19]
    v_pk_mul_f32 v[24:25], v[24:25], v[6:7] op_sel_hi:[1,0]
    v_pk_mul_f32 v[26:27], v[26:27], v[6:7] op_sel_hi:[1,0]
    v_mfma_f32_16x16x16_bf16 v[20:23], v[114:115], v[184:185], v[20:23]
    v_pk_mul_f32 v[28:29], v[28:29], v[6:7] op_sel_hi:[1,0]
    v_pk_mul_f32 v[30:31], v[30:31], v[6:7] op_sel_hi:[1,0]
    v_mfma_f32_16x16x16_bf16 v[24:27], v[116:117], v[184:185], v[24:27]
    v_pk_mul_f32 v[32:33], v[32:33], v[6:7] op_sel_hi:[1,0]
    v_pk_mul_f32 v[34:35], v[34:35], v[6:7] op_sel_hi:[1,0]
    v_mfma_f32_16x16x16_bf16 v[28:31], v[118:119], v[184:185], v[28:31]
    v_pk_mul_f32 v[36:37], v[36:37], v[6:7] op_sel_hi:[1,0]
    v_pk_mul_f32 v[38:39], v[38:39], v[6:7] op_sel_hi:[1,0]
    v_mfma_f32_16x16x16_bf16 v[32:35], v[120:121], v[184:185], v[32:35]
    v_pk_mul_f32 v[40:41], v[40:41], v[6:7] op_sel_hi:[1,0]
    v_pk_mul_f32 v[42:43], v[42:43], v[6:7] op_sel_hi:[1,0]
    v_mfma_f32_16x16x16_bf16 v[36:39], v[122:123], v[184:185], v[36:39]
    v_pk_mul_f32 v[44:45], v[44:45], v[6:7] op_sel_hi:[1,0]
    v_pk_mul_f32 v[46:47], v[46:47], v[6:7] op_sel_hi:[1,0]
    v_mfma_f32_16x16x16_bf16 v[40:43], v[124:125], v[184:185], v[40:43]
    v_cvt_pk_bf16_f32 v208, v16, v17
    v_cvt_pk_bf16_f32 v209, v18, v19
    v_cvt_pk_bf16_f32 v210, v20, v21
    v_cvt_pk_bf16_f32 v211, v22, v23
    buffer_store_dwordx4 v[208:211], v8, s[8:11], s50 offen offset:0
    v_mfma_f32_16x16x16_bf16 v[44:47], v[126:127], v[184:185], v[44:47]
    v_cvt_pk_bf16_f32 v212, v24, v25
    v_cvt_pk_bf16_f32 v213, v26, v27
    v_cvt_pk_bf16_f32 v214, v28, v29
    v_cvt_pk_bf16_f32 v215, v30, v31
    buffer_store_dwordx4 v[212:215], v8, s[8:11], s50 offen offset:1024
    v_cvt_pk_bf16_f32 v216, v32, v33
    v_cvt_pk_bf16_f32 v217, v34, v35
    v_cvt_pk_bf16_f32 v218, v36, v37
    v_cvt_pk_bf16_f32 v219, v38, v39
    buffer_store_dwordx4 v[216:219], v8, s[8:11], s50 offen offset:2048
    v_cvt_pk_bf16_f32 v220, v40, v41
    v_cvt_pk_bf16_f32 v221, v42, v43
    v_cvt_pk_bf16_f32 v222, v44, v45
    v_cvt_pk_bf16_f32 v223, v46, v47
    buffer_store_dwordx4 v[220:223], v8, s[8:11], s50 offen offset:3072
    s_cmp_lg_u32 s52, 0
    s_cbranch_scc1 .hb_512
    s_waitcnt vmcnt(0)
    s_mov_b64 exec, 1
    buffer_store_dword v12, v13, s[8:11], s92 offen
    s_mov_b64 exec, -1
    s_branch .ate_487
.fs_488:
    buffer_store_dword v12, v13, s[8:11], s92 offen sc1
    s_branch .fj_489
.fs_493:
    buffer_store_dword v12, v13, s[8:11], s92 offen sc1
    s_branch .fj_494
.fs_499:
    buffer_store_dword v12, v13, s[8:11], s92 offen sc1
    s_branch .fj_500
.fs_504:
    buffer_store_dword v12, v13, s[8:11], s92 offen sc1
    s_branch .fj_505
.hf_507:
    s_cmp_lg_u32 s62, 0
    s_cbranch_scc1 .hn_508
    s_sub_u32 s5, s34, 196608
    s_mov_b64 exec, 15

.hq_509:
    s_sleep 4
    buffer_load_dword v4, v204, s[8:11], s5 offen sc1
    s_add_u32 s62, s62, 1
    s_cmp_gt_u32 s62, 0x200000
    s_cbranch_scc1 .mg_end_1
    s_waitcnt vmcnt(0)
    v_cmp_eq_u32 vcc, -1, v4
    s_cbranch_vccnz .hq_509
    s_mov_b64 exec, -1

.hn_508:
    s_sleep 1
    buffer_load_dwordx4 v[80:83], v10, s[8:11], s34 offen offset:2048 sc1
    buffer_load_dwordx4 v[84:87], v10, s[8:11], s34 offen offset:2176 sc1
    buffer_load_dwordx4 v[88:91], v10, s[8:11], s34 offen offset:3072 sc1
    buffer_load_dwordx4 v[92:95], v10, s[8:11], s34 offen offset:3200 sc1
    s_add_u32 s4, s34, 4096
    s_mov_b64 exec, s[60:61]
    buffer_load_dwordx2 v[128:129], v11, s[8:11], s4 offen offset:0 sc1
    buffer_load_dwordx2 v[130:131], v11, s[8:11], s4 offen offset:256 sc1
    buffer_load_dwordx2 v[132:133], v11, s[8:11], s4 offen offset:512 sc1
    buffer_load_dwordx2 v[134:135], v11, s[8:11], s4 offen offset:768 sc1
    buffer_load_dwordx2 v[136:137], v11, s[8:11], s4 offen offset:1024 sc1
    buffer_load_dwordx2 v[138:139], v11, s[8:11], s4 offen offset:1280 sc1
    buffer_load_dwordx2 v[140:141], v11, s[8:11], s4 offen offset:1536 sc1
    buffer_load_dwordx2 v[142:143], v11, s[8:11], s4 offen offset:1792 sc1
    s_mov_b64 exec, -1
    s_add_u32 s62, s62, 1
    s_cmp_gt_u32 s62, 0x200000
    s_cbranch_scc1 .mg_end_1
    s_waitcnt vmcnt(0)
    s_branch .hk_506

.hs_510:
    v_mfma_f32_16x16x16_bf16 v[16:19], v[128:129], v[184:185], v[16:19]
    v_pk_mul_f32 v[24:25], v[24:25], v[6:7] op_sel_hi:[1,0]
    v_pk_mul_f32 v[26:27], v[26:27], v[6:7] op_sel_hi:[1,0]
    v_mfma_f32_16x16x16_bf16 v[20:23], v[130:131], v[184:185], v[20:23]
    v_pk_mul_f32 v[28:29], v[28:29], v[6:7] op_sel_hi:[1,0]
    v_pk_mul_f32 v[30:31], v[30:31], v[6:7] op_sel_hi:[1,0]
    v_mfma_f32_16x16x16_bf16 v[24:27], v[132:133], v[184:185], v[24:27]
    v_pk_mul_f32 v[32:33], v[32:33], v[6:7] op_sel_hi:[1,0]
    v_pk_mul_f32 v[34:35], v[34:35], v[6:7] op_sel_hi:[1,0]
    v_mfma_f32_16x16x16_bf16 v[28:31], v[134:135], v[184:185], v[28:31]
    v_pk_mul_f32 v[36:37], v[36:37], v[6:7] op_sel_hi:[1,0]
    v_pk_mul_f32 v[38:39], v[38:39], v[6:7] op_sel_hi:[1,0]
    v_mfma_f32_16x16x16_bf16 v[32:35], v[136:137], v[184:185], v[32:35]
    v_pk_mul_f32 v[40:41], v[40:41], v[6:7] op_sel_hi:[1,0]
    v_pk_mul_f32 v[42:43], v[42:43], v[6:7] op_sel_hi:[1,0]
    v_mfma_f32_16x16x16_bf16 v[36:39], v[138:139], v[184:185], v[36:39]
    v_pk_mul_f32 v[44:45], v[44:45], v[6:7] op_sel_hi:[1,0]
    v_pk_mul_f32 v[46:47], v[46:47], v[6:7] op_sel_hi:[1,0]
    v_mfma_f32_16x16x16_bf16 v[40:43], v[140:141], v[184:185], v[40:43]
    v_cvt_pk_bf16_f32 v208, v16, v17
    v_cvt_pk_bf16_f32 v209, v18, v19
    v_cvt_pk_bf16_f32 v210, v20, v21
    v_cvt_pk_bf16_f32 v211, v22, v23
    buffer_store_dwordx4 v[208:211], v8, s[8:11], s50 offen offset:0 sc1
    v_mfma_f32_16x16x16_bf16 v[44:47], v[142:143], v[184:185], v[44:47]
    v_cvt_pk_bf16_f32 v212, v24, v25
    v_cvt_pk_bf16_f32 v213, v26, v27
    v_cvt_pk_bf16_f32 v214, v28, v29
    v_cvt_pk_bf16_f32 v215, v30, v31
    buffer_store_dwordx4 v[212:215], v8, s[8:11], s50 offen offset:1024 sc1
    v_cvt_pk_bf16_f32 v216, v32, v33
    v_cvt_pk_bf16_f32 v217, v34, v35
    v_cvt_pk_bf16_f32 v218, v36, v37
    v_cvt_pk_bf16_f32 v219, v38, v39
    buffer_store_dwordx4 v[216:219], v8, s[8:11], s50 offen offset:2048 sc1
    v_cvt_pk_bf16_f32 v220, v40, v41
    v_cvt_pk_bf16_f32 v221, v42, v43
    v_cvt_pk_bf16_f32 v222, v44, v45
    v_cvt_pk_bf16_f32 v223, v46, v47
    buffer_store_dwordx4 v[220:223], v8, s[8:11], s50 offen offset:3072 sc1
    s_cmp_lg_u32 s52, 0
    s_cbranch_scc1 .hb_503
    s_branch .ahz_470
.fs_513:
    buffer_store_dword v12, v13, s[8:11], s92 offen sc1
    s_branch .fj_514
.hf_516:
    s_cmp_lg_u32 s62, 0
    s_cbranch_scc1 .hn_517
    s_sub_u32 s5, s34, 196608
    s_mov_b64 exec, 15

.hq_518:
    s_sleep 4
    buffer_load_dword v4, v204, s[8:11], s5 offen sc1
    s_add_u32 s62, s62, 1
    s_cmp_gt_u32 s62, 0x200000
    s_cbranch_scc1 .mg_end_1
    s_waitcnt vmcnt(0)
    v_cmp_eq_u32 vcc, -1, v4
    s_cbranch_vccnz .hq_518
    s_mov_b64 exec, -1

.hn_517:
    s_sleep 1
    buffer_load_dwordx4 v[96:99], v10, s[8:11], s34 offen offset:2048 sc1
    buffer_load_dwordx4 v[100:103], v10, s[8:11], s34 offen offset:2176 sc1
    buffer_load_dwordx4 v[104:107], v10, s[8:11], s34 offen offset:3072 sc1
    buffer_load_dwordx4 v[108:111], v10, s[8:11], s34 offen offset:3200 sc1
    s_add_u32 s4, s34, 4096
    s_mov_b64 exec, s[60:61]
    buffer_load_dwordx2 v[112:113], v11, s[8:11], s4 offen offset:0 sc1
    buffer_load_dwordx2 v[114:115], v11, s[8:11], s4 offen offset:256 sc1
    buffer_load_dwordx2 v[116:117], v11, s[8:11], s4 offen offset:512 sc1
    buffer_load_dwordx2 v[118:119], v11, s[8:11], s4 offen offset:768 sc1
    buffer_load_dwordx2 v[120:121], v11, s[8:11], s4 offen offset:1024 sc1
    buffer_load_dwordx2 v[122:123], v11, s[8:11], s4 offen offset:1280 sc1
    buffer_load_dwordx2 v[124:125], v11, s[8:11], s4 offen offset:1536 sc1
    buffer_load_dwordx2 v[126:127], v11, s[8:11], s4 offen offset:1792 sc1
    s_mov_b64 exec, -1
    s_add_u32 s62, s62, 1
    s_cmp_gt_u32 s62, 0x200000
    s_cbranch_scc1 .mg_end_1
    s_waitcnt vmcnt(0)
    s_branch .hk_515

.hs_519:
    v_mfma_f32_16x16x16_bf16 v[16:19], v[112:113], v[184:185], v[16:19]
    v_pk_mul_f32 v[24:25], v[24:25], v[6:7] op_sel_hi:[1,0]
    v_pk_mul_f32 v[26:27], v[26:27], v[6:7] op_sel_hi:[1,0]
    v_mfma_f32_16x16x16_bf16 v[20:23], v[114:115], v[184:185], v[20:23]
    v_pk_mul_f32 v[28:29], v[28:29], v[6:7] op_sel_hi:[1,0]
    v_pk_mul_f32 v[30:31], v[30:31], v[6:7] op_sel_hi:[1,0]
    v_mfma_f32_16x16x16_bf16 v[24:27], v[116:117], v[184:185], v[24:27]
    v_pk_mul_f32 v[32:33], v[32:33], v[6:7] op_sel_hi:[1,0]
    v_pk_mul_f32 v[34:35], v[34:35], v[6:7] op_sel_hi:[1,0]
    v_mfma_f32_16x16x16_bf16 v[28:31], v[118:119], v[184:185], v[28:31]
    v_pk_mul_f32 v[36:37], v[36:37], v[6:7] op_sel_hi:[1,0]
    v_pk_mul_f32 v[38:39], v[38:39], v[6:7] op_sel_hi:[1,0]
    v_mfma_f32_16x16x16_bf16 v[32:35], v[120:121], v[184:185], v[32:35]
    v_pk_mul_f32 v[40:41], v[40:41], v[6:7] op_sel_hi:[1,0]
    v_pk_mul_f32 v[42:43], v[42:43], v[6:7] op_sel_hi:[1,0]
    v_mfma_f32_16x16x16_bf16 v[36:39], v[122:123], v[184:185], v[36:39]
    v_pk_mul_f32 v[44:45], v[44:45], v[6:7] op_sel_hi:[1,0]
    v_pk_mul_f32 v[46:47], v[46:47], v[6:7] op_sel_hi:[1,0]
    v_mfma_f32_16x16x16_bf16 v[40:43], v[124:125], v[184:185], v[40:43]
    v_cvt_pk_bf16_f32 v208, v16, v17
    v_cvt_pk_bf16_f32 v209, v18, v19
    v_cvt_pk_bf16_f32 v210, v20, v21
    v_cvt_pk_bf16_f32 v211, v22, v23
    buffer_store_dwordx4 v[208:211], v8, s[8:11], s50 offen offset:0 sc1
    v_mfma_f32_16x16x16_bf16 v[44:47], v[126:127], v[184:185], v[44:47]
    v_cvt_pk_bf16_f32 v212, v24, v25
    v_cvt_pk_bf16_f32 v213, v26, v27
    v_cvt_pk_bf16_f32 v214, v28, v29
    v_cvt_pk_bf16_f32 v215, v30, v31
    buffer_store_dwordx4 v[212:215], v8, s[8:11], s50 offen offset:1024 sc1
    v_cvt_pk_bf16_f32 v216, v32, v33
    v_cvt_pk_bf16_f32 v217, v34, v35
    v_cvt_pk_bf16_f32 v218, v36, v37
    v_cvt_pk_bf16_f32 v219, v38, v39
    buffer_store_dwordx4 v[216:219], v8, s[8:11], s50 offen offset:2048 sc1
    v_cvt_pk_bf16_f32 v220, v40, v41
    v_cvt_pk_bf16_f32 v221, v42, v43
    v_cvt_pk_bf16_f32 v222, v44, v45
    v_cvt_pk_bf16_f32 v223, v46, v47
    buffer_store_dwordx4 v[220:223], v8, s[8:11], s50 offen offset:3072 sc1
    s_cmp_lg_u32 s52, 0
    s_cbranch_scc1 .hb_512
    s_branch .ahz_470
.ate_487:
.mg_end_1:
    s_endpgm
.section .rodata,"a"
.p2align 6
.amdhsa_kernel mega_kernel
  .amdhsa_next_free_vgpr 512
  .amdhsa_next_free_sgpr 102
  .amdhsa_accum_offset 256
  .amdhsa_group_segment_fixed_size 0
  .amdhsa_kernarg_size 136
  .amdhsa_user_sgpr_count 2
  .amdhsa_user_sgpr_kernarg_segment_ptr 1
  .amdhsa_system_sgpr_workgroup_id_x 1
.end_amdhsa_kernel
```
